```python
import torch

def _softmax(x, axis=-1):
    return torch.softmax(x, dim=axis)

def _gelu(x):
    return torch.nn.functional.gelu(x, approximate='tanh')

def _silu(x):
    return torch.nn.functional.silu(x)

def _sigmoid(x):
    return torch.sigmoid(x)

def _layernorm(x, axis=-1, eps=1e-05):
    m = x.mean(dim=axis, keepdim=True)
    v = x.var(dim=axis, keepdim=True, unbiased=False)
    return (x - m) / torch.sqrt(v + eps)

def _scatter_add(tgt, idx, src, axis=0):
    return tgt.clone().index_add_(axis, idx, src)

def _segment_sum(src, seg, n):
    out = torch.zeros((n,) + src.shape[1:], dtype=src.dtype)
    return out.index_add_(0, seg, src)

def _pad(x, pw):
    flat = tuple((v for pair in reversed(pw) for v in pair))
    return torch.nn.functional.pad(x, flat)
kernel_name = 'concat_heads__memory_aug_recurrent_mem_tr__ssm_conv_s4d__prompt'

def setup_inputs():

    _w = lambda a: (lambda t: t.to(torch.bfloat16) if t.is_floating_point() else t)(torch.as_tensor(a))

    def _A_setup():
        B, S, Dm = (1, 2048, 576)
        H, Dh = (32, 128)
        M, seg = (8, 32)
        seg = min(seg, S)
        S = S // seg * seg
        return {'x': _w((lambda *s: torch.randn(*s, dtype=torch.bfloat16) * 0.05)(B, S, Dm)), 'mem0': _w((lambda *s: torch.randn(*s, dtype=torch.bfloat16) * 0.4)(B, M, Dm)), 'Wq': _w((lambda *s: torch.randn(*s, dtype=torch.bfloat16) * 6.4)(Dm, H, Dh) * Dm ** (-0.5)), 'Wk': _w((lambda *s: torch.randn(*s, dtype=torch.bfloat16) * 6.4)(Dm, H, Dh) * Dm ** (-0.5)), 'Wv': _w((lambda *s: torch.randn(*s, dtype=torch.bfloat16) * 0.4)(Dm, H, Dh) * Dm ** (-0.5)), 'Wo': _w((lambda *s: torch.randn(*s, dtype=torch.bfloat16) * 0.4)(H, Dh, Dm) * (H * Dh) ** (-0.5)), 'seg_len': seg}
    _A_in = _A_setup()

    def _B_setup():
        Bsz, L, D, N = (1, 2048, 576, 128)
        return {'u': _w((lambda *s: torch.randn(*s, dtype=torch.bfloat16) * 0.05)(Bsz, L, D)), 'log_A_real': _w((lambda *s: torch.randn(*s, dtype=torch.bfloat16) * 3.2)(D, N) * 0.5), 'A_imag': _w((lambda *s: torch.randn(*s, dtype=torch.bfloat16) * 0.05)(D, N) * 3.14), 'C_real': _w((lambda *s: torch.randn(*s, dtype=torch.bfloat16) * 0.4)(D, N) / N ** 0.5), 'C_imag': _w((lambda *s: torch.randn(*s, dtype=torch.bfloat16) * 0.4)(D, N) / N ** 0.5), 'log_dt': _w((lambda *s: torch.randn(*s, dtype=torch.bfloat16) * 0.05)(D) * 0.5 - 4.0), 'D_skip': _w((lambda *s: torch.randn(*s, dtype=torch.bfloat16) * 0.05)(D))}
    _B_in = _B_setup()
    return {'A_x': _A_in['x'], 'A_mem0': _A_in['mem0'], 'A_Wq': _A_in['Wq'], 'A_Wk': _A_in['Wk'], 'A_Wv': _A_in['Wv'], 'A_Wo': _A_in['Wo'], 'A_seg_len': _A_in['seg_len'], 'B_u': _B_in['u'], 'B_log_A_real': _B_in['log_A_real'], 'B_A_imag': _B_in['A_imag'], 'B_C_real': _B_in['C_real'], 'B_C_imag': _B_in['C_imag'], 'B_log_dt': _B_in['log_dt'], 'B_D_skip': _B_in['D_skip']}

def reference(A_x, A_mem0, A_Wq, A_Wk, A_Wv, A_Wo, A_seg_len, B_u, B_log_A_real, B_A_imag, B_C_real, B_C_imag, B_log_dt, B_D_skip):

    def _A_ref(x, mem0, Wq, Wk, Wv, Wo, seg_len):
        B, S, Dm = x.shape
        H, Dh = (Wq.shape[1], Wq.shape[2])
        M = mem0.shape[1]
        scale = Dh ** (-0.5)
        n_seg = S // seg_len
        L = M + seg_len
        idx = torch.arange(L)
        mask = (idx[:, None] < M) | (idx[:, None] >= idx[None, :])
        mem = mem0
        outs = []
        for s in range(n_seg):
            xs = x[:, s * seg_len:(s + 1) * seg_len, :].clone()
            h = torch.concatenate([mem, xs], axis=1)
            q = torch.einsum('btd,dhe->bhte', h, Wq)
            k = torch.einsum('btd,dhe->bhte', h, Wk)
            v = torch.einsum('btd,dhe->bhte', h, Wv)
            scores = torch.einsum('bhqe,bhke->bhqk', q, k) * scale
            scores = torch.where(mask[None, None], scores, -1000000000.0)
            p = _softmax(scores, axis=-1)
            o = torch.einsum('bhqk,bhke->bhqe', p, v)
            o = torch.einsum('bhte,hed->btd', o, Wo)
            mem = o[:, :M, :].clone()
            outs.append(o[:, M:, :])
        return torch.concatenate(outs, axis=1)

    def _B_ref(u, log_A_real, A_imag, C_real, C_imag, log_dt, D_skip):
        L = u.shape[1]
        dt = torch.exp(log_dt)
        A = -torch.exp(log_A_real) + 1j * A_imag
        C = (C_real + 1j * C_imag) * dt[:, None]
        pos = (lambda x, dt: x.to(dt))(torch.arange(L), log_dt.dtype)
        P = torch.exp((A * dt[:, None])[:, :, None] * pos[None, None, :])
        K = 2.0 * torch.einsum('dn,dnl->dl', C, P).real
        L2 = 2 * L
        u_t = (lambda x, *d: x.permute(*d))(u, 0, 2, 1)
        Kf = (lambda x, *a, **k: torch.fft.rfft(x.float(), *a, **k))(K, L2)
        Uf = (lambda x, *a, **k: torch.fft.rfft(x.float(), *a, **k))(u_t, L2)
        y = (lambda x, *a, **k: torch.fft.irfft(x, *a, **k).to(torch.bfloat16))(Uf * Kf[None, :, :], L2)[:, :, :L]
        y = (lambda x, *d: x.permute(*d))(y, 0, 2, 1)
        return y + u * D_skip[None, None, :]
    a = _A_ref(A_x, A_mem0, A_Wq, A_Wk, A_Wv, A_Wo, A_seg_len)
    b = _B_ref(B_u, B_log_A_real, B_A_imag, B_C_real, B_C_imag, B_log_dt, B_D_skip)
    return torch.concatenate([a, b], axis=-1)
```

```asm
; @launch grid=(256,1,1) block=(256,1,1) lds=163840
.amdgcn_target "amdgcn-amd-amdhsa--gfx950"
.text
.globl concat_heads__memory_aug_recurrent_mem_tr__ssm_conv_s4d__prompt_kernel
.p2align 8
.type concat_heads__memory_aug_recurrent_mem_tr__ssm_conv_s4d__prompt_kernel,@function
concat_heads__memory_aug_recurrent_mem_tr__ssm_conv_s4d__prompt_kernel:
    s_cmp_ge_u32 s2, 256
    s_cbranch_scc1 L_exit
    s_load_dwordx4 s[80:83], s[0:1], 120
    s_load_dwordx16 s[48:63], s[0:1], 0
    s_memrealtime s[90:91]
    v_lshrrev_b32 v1, 6, v0
    s_nop 0
    v_readfirstlane_b32 s32, v1
    s_waitcnt lgkmcnt(0)
    s_mov_b32 s4, s82
    s_mov_b32 s5, s83
    s_mov_b32 s6, 268435456
    s_mov_b32 s7, 0x20000
    s_mov_b32 s96, s80
    s_mov_b32 s97, s81
    s_mov_b32 s98, 256
    s_mov_b32 s99, 0x20000
    s_cmp_lg_u32 s32, 0
    s_cbranch_scc1 L_nod0
L_nod0:
    s_cmp_lg_u32 s32, 3
    s_cbranch_scc1 L_nowarm
    s_getpc_b64 s[44:45]
L_pcw:
    v_and_b32 v1, 63, v0
    v_lshlrev_b32 v1, 7, v1
    v_min_u32 v2, L_exit-L_pcw, v1
    global_load_dword v210, v2, s[44:45]
    v_add_u32 v1, 8192, v1
    v_min_u32 v2, L_exit-L_pcw, v1
    global_load_dword v211, v2, s[44:45]
    v_add_u32 v1, 8192, v1
    v_min_u32 v2, L_exit-L_pcw, v1
    global_load_dword v212, v2, s[44:45]
    v_add_u32 v1, 8192, v1
    v_min_u32 v2, L_exit-L_pcw, v1
    global_load_dword v213, v2, s[44:45]
    v_add_u32 v1, 8192, v1
    v_min_u32 v2, L_exit-L_pcw, v1
    global_load_dword v214, v2, s[44:45]
    v_add_u32 v1, 8192, v1
    v_min_u32 v2, L_exit-L_pcw, v1
    global_load_dword v215, v2, s[44:45]
    v_add_u32 v1, 8192, v1
    v_min_u32 v2, L_exit-L_pcw, v1
    global_load_dword v216, v2, s[44:45]
    v_add_u32 v1, 8192, v1
    v_min_u32 v2, L_exit-L_pcw, v1
    global_load_dword v217, v2, s[44:45]
    v_add_u32 v1, 8192, v1
    v_min_u32 v2, L_exit-L_pcw, v1
    global_load_dword v218, v2, s[44:45]
    v_add_u32 v1, 8192, v1
L_nowarm:
    s_lshl_b32 s90, s90, 8
    s_or_b32 s90, s90, 1
    v_mov_b32 v200, s90
    v_mov_b32 v201, 0
    s_cmp_lg_u32 s32, 0
    s_cbranch_scc1 L_nn
    s_mov_b64 exec, 1
    buffer_atomic_cmpswap v[200:201], off, s[96:99], 0 offset:0 sc0
    s_mov_b64 exec, -1
L_nn:
    s_getreg_b32 s3, hwreg(HW_REG_XCC_ID)
    s_and_b32 s3, s3, 15
    s_cmp_lg_u32 s3, 0
    s_cbranch_scc1 L_h0
    s_mov_b32 s37, 128
    v_mov_b32 v250, 1
    v_mov_b32 v251, 163832
    v_cmp_eq_u32 vcc, 0, v0
    s_nop 0
    s_and_saveexec_b64 s[38:39], vcc
    s_cbranch_execz tk1
    buffer_atomic_add v250, off, s[96:99], s37 sc0
    s_waitcnt vmcnt(0)
    ds_write_b32 v251, v250
    s_waitcnt lgkmcnt(0)
tk1:
    s_mov_b64 exec, -1
    s_barrier
    ds_read_b32 v252, v251
    s_waitcnt lgkmcnt(0)
    v_readfirstlane_b32 s12, v252
    s_barrier
    s_nop 3
    s_waitcnt vmcnt(0)
    v_mov_b32 v251, 163832
    s_cmp_lg_u32 s32, 0
    s_cbranch_scc1 L_nn2
    v_mov_b32 v201, s90
    v_cmp_eq_u32 vcc, 0, v200
    s_nop 1
    v_cndmask_b32 v200, v200, v201, vcc
    s_mov_b64 exec, 1
    ds_write_b32 v251, v200 offset:4
    s_mov_b64 exec, -1
    s_waitcnt lgkmcnt(0)
L_nn2:
    s_barrier
    ds_read_b32 v252, v251 offset:4
    s_waitcnt lgkmcnt(0)
    v_readfirstlane_b32 s95, v252
    s_nop 1
    s_cmp_lt_u32 s12, 32
    s_cbranch_scc1 L_chain
    s_branch L_helper
L_h0:
    s_mov_b32 s37, 4
    v_mov_b32 v250, 1
    v_mov_b32 v251, 163832
    v_cmp_eq_u32 vcc, 0, v0
    s_nop 0
    s_and_saveexec_b64 s[38:39], vcc
    s_cbranch_execz tk2
    buffer_atomic_add v250, off, s[96:99], s37 sc0
    s_waitcnt vmcnt(0)
    ds_write_b32 v251, v250
    s_waitcnt lgkmcnt(0)
tk2:
    s_mov_b64 exec, -1
    s_barrier
    ds_read_b32 v252, v251
    s_waitcnt lgkmcnt(0)
    v_readfirstlane_b32 s36, v252
    s_barrier
    s_nop 3
    s_waitcnt vmcnt(0)
    v_mov_b32 v251, 163832
    s_cmp_lg_u32 s32, 0
    s_cbranch_scc1 L_nn3
    v_mov_b32 v201, s90
    v_cmp_eq_u32 vcc, 0, v200
    s_nop 1
    v_cndmask_b32 v200, v200, v201, vcc
    s_mov_b64 exec, 1
    ds_write_b32 v251, v200 offset:4
    s_mov_b64 exec, -1
    s_waitcnt lgkmcnt(0)
L_nn3:
    s_barrier
    ds_read_b32 v252, v251 offset:4
    s_waitcnt lgkmcnt(0)
    v_readfirstlane_b32 s95, v252
    s_nop 1
    s_branch L_helper1
L_chain:
    s_load_dwordx8 s[48:55], s[0:1], 8
    s_load_dwordx2 s[56:57], s[0:1], 40
    s_waitcnt lgkmcnt(0)
    v_lshrrev_b32 v24, 6, v0
    s_nop 0
    v_readfirstlane_b32 s13, v24
    v_lshlrev_b32 v61, 4, v0
    v_add_u32 v62, 57344, v61
    v_xor_b32 v63, 1024, v61
    v_add_u32 v63, 98304, v63
    v_xor_b32 v64, 2048, v61
    v_add_u32 v64, 98304, v64
    v_and_b32 v65, 1023, v61
    v_add_u32 v65, 98304, v65
    v_and_b32 v26, 15, v0
    v_bfe_u32 v27, v0, 4, 2
    v_mov_b32 v60, 0x4444
    v_mov_b32 v25, 0xeeee
    v_cmp_lt_u32 vcc, 7, v26
    s_nop 1
    v_cndmask_b32 v60, v60, v25, vcc
    v_and_b32 v67, 12, v26
    v_lshlrev_b32 v67, 3, v67
    v_and_b32 v25, 1, v26
    v_lshl_add_u32 v67, v25, 4, v67
    v_bfe_u32 v25, v26, 1, 1
    v_lshl_add_u32 v67, v25, 3, v67
    v_lshl_add_u32 v66, v27, 14, v67
    v_lshl_add_u32 v66, v24, 17, v66
    v_and_b32 v67, 63, v67
    v_lshrrev_b32 v25, 1, v24
    v_lshl_add_u32 v67, v25, 18, v67
    v_lshl_add_u32 v67, v27, 16, v67
    v_lshrrev_b32 v25, 3, v26
    v_lshl_add_u32 v67, v25, 15, v67
    v_and_b32 v25, 1, v24
    v_lshl_add_u32 v67, v25, 6, v67
    v_and_b32 v25, 31, v0
    v_lshlrev_b32 v70, 4, v25
    v_lshlrev_b32 v28, 3, v25
    v_lshl_add_u32 v28, v24, 8, v28
    v_add_u32 v28, 110592, v28
    v_lshrrev_b32 v25, 1, v24
    v_lshl_add_u32 v70, v25, 9, v70
    v_and_b32 v25, 1, v24
    v_lshl_add_u32 v70, v25, 3, v70
    v_add_u32 v70, 109568, v70
    v_cmp_gt_u32 vcc, 2, v27
    s_nop 1
    v_cndmask_b32 v70, v70, v28, vcc
    v_xor_b32 v71, 2048, v63
    v_lshrrev_b32 v68, 4, v0
    v_lshlrev_b32 v68, 7, v68
    v_and_b32 v25, 7, v26
    v_lshl_add_u32 v68, v25, 4, v68
    v_add_u32 v68, 116736, v68
    v_and_b32 v25, 1, v27
    v_lshlrev_b32 v69, 7, v25
    v_lshrrev_b32 v25, 1, v27
    v_lshl_add_u32 v69, v25, 3, v69
    v_and_b32 v25, 3, v26
    v_lshl_add_u32 v69, v25, 4, v69
    v_bfe_u32 v25, v26, 2, 1
    v_lshl_add_u32 v69, v25, 2, v69
    s_mov_b32 s32, 0x00ff00ff
    s_mov_b32 s33, 0x00ff00ff
    s_not_b64 s[34:35], s[32:33]
    s_lshr_b32 s31, s12, 1
    s_lshl_b32 s31, s31, 8
    s_and_b32 s40, s12, 1
    s_lshl_b32 s40, s40, 6
    s_add_u32 s31, s31, s40
    s_and_b32 s40, s13, 1
    s_lshl_b32 s40, s40, 12
    s_add_u32 s31, s31, s40
    s_lshl_b32 s19, s12, 14
    s_add_u32 s19, s19, 67076096
    s_add_u32 s41, s19, 8192
    s_add_u32 s19, s19, s40
    s_and_b32 s40, s12, 1
    s_lshl_b32 s40, s40, 2
    s_or_b32 s40, s40, s13
    s_cmp_eq_u32 s40, 5
    s_cselect_b32 s64, 0, s13
    s_cmp_lg_u32 s13, 1
    s_cbranch_scc1 cf_notx
    s_mov_b32 s32, 0xff
    s_mov_b32 s33, 0xff
    s_mov_b32 s19, s41
    s_lshr_b32 s31, s12, 3
    s_lshl_b32 s31, s31, 8
    s_and_b32 s40, s12, 2
    s_lshl_b32 s40, s40, 6
    s_add_u32 s31, s31, s40
    s_and_b32 s40, s12, 4
    s_lshl_b32 s40, s40, 4
    s_add_u32 s31, s31, s40
    s_add_u32 s31, s31, 8192
cf_notx:
    s_cmp_lg_u32 s13, 0
    s_cbranch_scc1 cf_notp
    s_min_u32 s40, s12, 23
    s_mul_i32 s40, s40, 384
    s_add_u32 s40, s40, 98304
    v_add_u32 v69, s40, v61
    v_mov_b32 v25, 118784
    v_cmp_lt_u32 vcc, 23, v0
    s_nop 1
    v_cndmask_b32 v69, v69, v25, vcc
cf_notp:
    s_nop 1
    v_mov_b32 v28, 1
    v_mov_b32 v29, 1
    v_mov_b32 v30, 1
    v_mov_b32 v31, 1
    s_lshl_b32 s40, s12, 14
    s_add_u32 s40, s40, 67174400
    s_add_u32 s41, s40, 0
    buffer_store_dwordx4 v[28:31], v61, s[4:7], s41 offen
    s_add_u32 s41, s40, 4096
    buffer_store_dwordx4 v[28:31], v61, s[4:7], s41 offen
    s_add_u32 s41, s40, 8192
    buffer_store_dwordx4 v[28:31], v61, s[4:7], s41 offen
    s_cmp_eq_u32 s64, 0
    s_cbranch_scc1 cf_init_done
    s_mov_b64 s[8:9], s[48:49]
    s_mov_b32 s10, 9216
    s_mov_b32 s11, 0x20000
    v_add_u32 v24, s31, v69
    v_bfe_u32 v25, v24, 4, 3
    v_mul_u32_u24 v25, 1152, v25
    v_lshrrev_b32 v26, 7, v24
    v_lshl_add_u32 v25, v26, 4, v25
    v_and_b32 v26, 15, v24
    v_add_u32 v25, v25, v26
    s_mov_b64 exec, s[32:33]
    buffer_load_dword v26, v25, s[8:11], 0 offen
    v_mov_b32 v27, -1
    s_add_u32 s40, s31, 67108864
    s_add_u32 s41, s40, 16384
    buffer_store_dword v27, v69, s[4:7], s41 offen
    s_add_u32 s41, s40, 32768
    buffer_store_dword v27, v69, s[4:7], s41 offen
    s_add_u32 s41, s40, 49152
    buffer_store_dword v27, v69, s[4:7], s41 offen
    s_waitcnt vmcnt(0)
    buffer_store_dword v26, v69, s[4:7], s40 offen
    s_mov_b64 exec, -1
cf_init_done:
    s_waitcnt vmcnt(0)
    v_and_b32 v57, 63, v0
    v_bfe_u32 v54, v57, 2, 1
    v_lshlrev_b32 v48, 13, v54
    v_bfe_u32 v54, v57, 3, 1
    v_lshl_add_u32 v48, v54, 15, v48
    v_bfe_u32 v54, v57, 4, 1
    v_lshl_add_u32 v48, v54, 14, v48
    v_bfe_u32 v54, v57, 5, 1
    v_lshl_add_u32 v48, v54, 16, v48
    v_lshrrev_b32 v55, 4, v57
    v_and_b32 v55, 2, v55
    v_xor_b32 v55, v55, v57
    v_and_b32 v55, 3, v55
    v_lshl_add_u32 v48, v55, 4, v48
    v_bfe_u32 v54, v57, 2, 1
    v_lshlrev_b32 v51, 6, v54
    v_bfe_u32 v54, v57, 3, 1
    v_lshl_add_u32 v51, v54, 9, v51
    v_bfe_u32 v54, v57, 4, 1
    v_lshl_add_u32 v51, v54, 7, v51
    v_bfe_u32 v54, v57, 5, 1
    v_lshl_add_u32 v51, v54, 12, v51
    v_bfe_u32 v54, v57, 0, 1
    v_lshl_add_u32 v51, v54, 3, v51
    v_bfe_u32 v54, v57, 1, 1
    v_lshl_add_u32 v51, v54, 4, v51
    v_bfe_u32 v54, v57, 3, 1
    v_lshl_add_u32 v51, v54, 5, v51
    v_lshrrev_b32 v55, 3, v57
    v_mul_u32_u24 v49, 1152, v55
    v_and_b32 v55, 7, v57
    v_lshl_add_u32 v49, v55, 4, v49
    v_bfe_u32 v54, v57, 4, 1
    v_lshlrev_b32 v52, 13, v54
    v_bfe_u32 v54, v57, 5, 1
    v_lshl_add_u32 v52, v54, 9, v52
    v_bfe_u32 v54, v57, 2, 1
    v_lshl_add_u32 v52, v54, 7, v52
    v_bfe_u32 v54, v57, 3, 1
    v_lshl_add_u32 v52, v54, 5, v52
    v_and_b32 v55, 3, v57
    v_lshl_add_u32 v52, v55, 3, v52
    v_lshrrev_b32 v55, 2, v57
    v_mul_u32_u24 v50, 1152, v55
    v_and_b32 v55, 3, v57
    v_lshl_add_u32 v50, v55, 4, v50
    v_bfe_u32 v54, v57, 4, 1
    v_lshlrev_b32 v53, 12, v54
    v_bfe_u32 v54, v57, 5, 1
    v_lshl_add_u32 v53, v54, 8, v53
    v_bfe_u32 v54, v57, 2, 1
    v_lshl_add_u32 v53, v54, 6, v53
    v_bfe_u32 v54, v57, 3, 1
    v_lshl_add_u32 v53, v54, 5, v53
    v_and_b32 v55, 3, v57
    v_lshl_add_u32 v53, v55, 3, v53
    s_lshl_b32 s66, s13, 10
    s_lshl_b32 s93, s13, 14
    s_lshl_b32 s67, s12, 8
    s_lshl_b32 s40, s13, 6
    s_add_u32 s67, s67, s40
    s_mul_i32 s92, s12, 147456
    v_add_u32 v51, s66, v51
    v_add_u32 v52, s66, v52
    v_add_u32 v53, s66, v53
    s_mov_b32 s10, 4718592
    s_mov_b32 s11, 0x20000
    s_mov_b64 s[8:9], s[52:53]
    s_xor_b32 s40, s93, 0
    s_add_u32 s40, s40, s66
    s_add_u32 m0, s40, 0
    s_add_u32 s41, s67, 2097152
    buffer_load_dwordx4 v48, s[8:11], s41 offen lds
    s_add_u32 m0, s40, 4096
    s_add_u32 s41, s67, 2228224
    buffer_load_dwordx4 v48, s[8:11], s41 offen lds
    s_add_u32 m0, s40, 8192
    s_add_u32 s41, s67, 2359296
    buffer_load_dwordx4 v48, s[8:11], s41 offen lds
    s_add_u32 m0, s40, 12288
    s_add_u32 s41, s67, 2490368
    buffer_load_dwordx4 v48, s[8:11], s41 offen lds
    s_xor_b32 s40, s93, 16384
    s_add_u32 s40, s40, s66
    s_add_u32 m0, s40, 0
    s_add_u32 s41, s67, 2621440
    buffer_load_dwordx4 v48, s[8:11], s41 offen lds
    s_add_u32 m0, s40, 4096
    s_add_u32 s41, s67, 2752512
    buffer_load_dwordx4 v48, s[8:11], s41 offen lds
    s_add_u32 m0, s40, 8192
    s_add_u32 s41, s67, 2883584
    buffer_load_dwordx4 v48, s[8:11], s41 offen lds
    s_add_u32 m0, s40, 12288
    s_add_u32 s41, s67, 3014656
    buffer_load_dwordx4 v48, s[8:11], s41 offen lds
    s_xor_b32 s40, s93, 32768
    s_add_u32 s40, s40, s66
    s_add_u32 m0, s40, 0
    s_add_u32 s41, s67, 3145728
    buffer_load_dwordx4 v48, s[8:11], s41 offen lds
    s_add_u32 m0, s40, 4096
    s_add_u32 s41, s67, 3276800
    buffer_load_dwordx4 v48, s[8:11], s41 offen lds
    s_add_u32 m0, s40, 8192
    s_add_u32 s41, s67, 3407872
    buffer_load_dwordx4 v48, s[8:11], s41 offen lds
    s_add_u32 m0, s40, 12288
    s_add_u32 s41, s67, 3538944
    buffer_load_dwordx4 v48, s[8:11], s41 offen lds
    s_xor_b32 s40, s93, 49152
    s_add_u32 s40, s40, s66
    s_add_u32 m0, s40, 0
    s_add_u32 s41, s67, 3670016
    buffer_load_dwordx4 v48, s[8:11], s41 offen lds
    s_add_u32 m0, s40, 4096
    s_add_u32 s41, s67, 3801088
    buffer_load_dwordx4 v48, s[8:11], s41 offen lds
    s_add_u32 m0, s40, 8192
    s_add_u32 s41, s67, 3932160
    buffer_load_dwordx4 v48, s[8:11], s41 offen lds
    s_add_u32 m0, s40, 12288
    s_add_u32 s41, s67, 4063232
    buffer_load_dwordx4 v48, s[8:11], s41 offen lds
    s_add_u32 m0, s66, 131072
    s_add_u32 s41, s67, 4194304
    buffer_load_dwordx4 v48, s[8:11], s41 offen lds
    s_add_u32 m0, s66, 135168
    s_add_u32 s41, s67, 4325376
    buffer_load_dwordx4 v48, s[8:11], s41 offen lds
    s_add_u32 m0, s66, 139264
    s_add_u32 s41, s67, 4456448
    buffer_load_dwordx4 v48, s[8:11], s41 offen lds
    s_add_u32 m0, s66, 143360
    s_add_u32 s41, s67, 4587520
    buffer_load_dwordx4 v48, s[8:11], s41 offen lds
    s_mov_b64 s[8:9], s[54:55]
    s_xor_b32 s40, s93, 0
    s_add_u32 s40, s40, s66
    s_add_u32 m0, s40, 65536
    s_add_u32 s41, s67, 0
    buffer_load_dwordx4 v48, s[8:11], s41 offen lds
    s_add_u32 m0, s40, 69632
    s_add_u32 s41, s67, 131072
    buffer_load_dwordx4 v48, s[8:11], s41 offen lds
    s_add_u32 m0, s40, 73728
    s_add_u32 s41, s67, 262144
    buffer_load_dwordx4 v48, s[8:11], s41 offen lds
    s_add_u32 m0, s40, 77824
    s_add_u32 s41, s67, 393216
    buffer_load_dwordx4 v48, s[8:11], s41 offen lds
    s_xor_b32 s40, s93, 16384
    s_add_u32 s40, s40, s66
    s_add_u32 m0, s40, 65536
    s_add_u32 s41, s67, 524288
    buffer_load_dwordx4 v48, s[8:11], s41 offen lds
    s_add_u32 m0, s40, 69632
    s_add_u32 s41, s67, 655360
    buffer_load_dwordx4 v48, s[8:11], s41 offen lds
    s_add_u32 m0, s40, 73728
    s_add_u32 s41, s67, 786432
    buffer_load_dwordx4 v48, s[8:11], s41 offen lds
    s_add_u32 m0, s40, 77824
    s_add_u32 s41, s67, 917504
    buffer_load_dwordx4 v48, s[8:11], s41 offen lds
    s_xor_b32 s40, s93, 32768
    s_add_u32 s40, s40, s66
    s_add_u32 m0, s40, 65536
    s_add_u32 s41, s67, 1048576
    buffer_load_dwordx4 v48, s[8:11], s41 offen lds
    s_add_u32 m0, s40, 69632
    s_add_u32 s41, s67, 1179648
    buffer_load_dwordx4 v48, s[8:11], s41 offen lds
    s_add_u32 m0, s40, 73728
    s_add_u32 s41, s67, 1310720
    buffer_load_dwordx4 v48, s[8:11], s41 offen lds
    s_add_u32 m0, s40, 77824
    s_add_u32 s41, s67, 1441792
    buffer_load_dwordx4 v48, s[8:11], s41 offen lds
    s_xor_b32 s40, s93, 49152
    s_add_u32 s40, s40, s66
    s_add_u32 m0, s40, 65536
    s_add_u32 s41, s67, 1572864
    buffer_load_dwordx4 v48, s[8:11], s41 offen lds
    s_add_u32 m0, s40, 69632
    s_add_u32 s41, s67, 1703936
    buffer_load_dwordx4 v48, s[8:11], s41 offen lds
    s_add_u32 m0, s40, 73728
    s_add_u32 s41, s67, 1835008
    buffer_load_dwordx4 v48, s[8:11], s41 offen lds
    s_add_u32 m0, s40, 77824
    s_add_u32 s41, s67, 1966080
    buffer_load_dwordx4 v48, s[8:11], s41 offen lds
    s_add_u32 m0, s66, 147456
    s_add_u32 s41, s67, 4194304
    buffer_load_dwordx4 v48, s[8:11], s41 offen lds
    s_add_u32 m0, s66, 151552
    s_add_u32 s41, s67, 4325376
    buffer_load_dwordx4 v48, s[8:11], s41 offen lds
    s_add_u32 m0, s66, 155648
    s_add_u32 s41, s67, 4456448
    buffer_load_dwordx4 v48, s[8:11], s41 offen lds
    s_add_u32 m0, s66, 159744
    s_add_u32 s41, s67, 4587520
    buffer_load_dwordx4 v48, s[8:11], s41 offen lds
    s_waitcnt vmcnt(24)
    v_add_u32 v55, 0, v51
    v_xor_b32 v56, 32, v55
    ds_read_b64_tr_b16 a[136:137], v55 offset:0
    ds_read_b64_tr_b16 a[138:139], v55 offset:256
    ds_read_b64_tr_b16 a[140:141], v55 offset:8192
    ds_read_b64_tr_b16 a[142:143], v55 offset:8448
    ds_read_b64_tr_b16 a[144:145], v56 offset:0
    ds_read_b64_tr_b16 a[146:147], v56 offset:256
    ds_read_b64_tr_b16 a[148:149], v56 offset:8192
    ds_read_b64_tr_b16 a[150:151], v56 offset:8448
    s_waitcnt lgkmcnt(0)
    v_add_u32 v55, 16384, v51
    v_xor_b32 v56, 32, v55
    ds_read_b64_tr_b16 a[152:153], v55 offset:0
    ds_read_b64_tr_b16 a[154:155], v55 offset:256
    ds_read_b64_tr_b16 a[156:157], v55 offset:8192
    ds_read_b64_tr_b16 a[158:159], v55 offset:8448
    ds_read_b64_tr_b16 a[160:161], v56 offset:0
    ds_read_b64_tr_b16 a[162:163], v56 offset:256
    ds_read_b64_tr_b16 a[164:165], v56 offset:8192
    ds_read_b64_tr_b16 a[166:167], v56 offset:8448
    s_waitcnt lgkmcnt(0)
    v_add_u32 v55, 32768, v51
    v_xor_b32 v56, 32, v55
    ds_read_b64_tr_b16 a[168:169], v55 offset:0
    ds_read_b64_tr_b16 a[170:171], v55 offset:256
    ds_read_b64_tr_b16 a[172:173], v55 offset:8192
    ds_read_b64_tr_b16 a[174:175], v55 offset:8448
    ds_read_b64_tr_b16 a[176:177], v56 offset:0
    ds_read_b64_tr_b16 a[178:179], v56 offset:256
    ds_read_b64_tr_b16 a[180:181], v56 offset:8192
    ds_read_b64_tr_b16 a[182:183], v56 offset:8448
    s_waitcnt lgkmcnt(0)
    v_add_u32 v55, 49152, v51
    v_xor_b32 v56, 32, v55
    ds_read_b64_tr_b16 a[184:185], v55 offset:0
    ds_read_b64_tr_b16 a[186:187], v55 offset:256
    ds_read_b64_tr_b16 a[188:189], v55 offset:8192
    ds_read_b64_tr_b16 a[190:191], v55 offset:8448
    ds_read_b64_tr_b16 a[192:193], v56 offset:0
    ds_read_b64_tr_b16 a[194:195], v56 offset:256
    ds_read_b64_tr_b16 a[196:197], v56 offset:8192
    ds_read_b64_tr_b16 a[198:199], v56 offset:8448
    s_waitcnt lgkmcnt(0)
    s_xor_b32 s40, s93, 0
    s_add_u32 s40, s40, s66
    s_add_u32 m0, s40, 0
    s_add_u32 s41, s67, 2097152
    buffer_load_dwordx4 v48, s[8:11], s41 offen lds
    s_add_u32 m0, s40, 4096
    s_add_u32 s41, s67, 2228224
    buffer_load_dwordx4 v48, s[8:11], s41 offen lds
    s_add_u32 m0, s40, 8192
    s_add_u32 s41, s67, 2359296
    buffer_load_dwordx4 v48, s[8:11], s41 offen lds
    s_add_u32 m0, s40, 12288
    s_add_u32 s41, s67, 2490368
    buffer_load_dwordx4 v48, s[8:11], s41 offen lds
    s_xor_b32 s40, s93, 16384
    s_add_u32 s40, s40, s66
    s_add_u32 m0, s40, 0
    s_add_u32 s41, s67, 2621440
    buffer_load_dwordx4 v48, s[8:11], s41 offen lds
    s_add_u32 m0, s40, 4096
    s_add_u32 s41, s67, 2752512
    buffer_load_dwordx4 v48, s[8:11], s41 offen lds
    s_add_u32 m0, s40, 8192
    s_add_u32 s41, s67, 2883584
    buffer_load_dwordx4 v48, s[8:11], s41 offen lds
    s_add_u32 m0, s40, 12288
    s_add_u32 s41, s67, 3014656
    buffer_load_dwordx4 v48, s[8:11], s41 offen lds
    s_xor_b32 s40, s93, 32768
    s_add_u32 s40, s40, s66
    s_add_u32 m0, s40, 0
    s_add_u32 s41, s67, 3145728
    buffer_load_dwordx4 v48, s[8:11], s41 offen lds
    s_add_u32 m0, s40, 4096
    s_add_u32 s41, s67, 3276800
    buffer_load_dwordx4 v48, s[8:11], s41 offen lds
    s_add_u32 m0, s40, 8192
    s_add_u32 s41, s67, 3407872
    buffer_load_dwordx4 v48, s[8:11], s41 offen lds
    s_add_u32 m0, s40, 12288
    s_add_u32 s41, s67, 3538944
    buffer_load_dwordx4 v48, s[8:11], s41 offen lds
    s_xor_b32 s40, s93, 49152
    s_add_u32 s40, s40, s66
    s_add_u32 m0, s40, 0
    s_add_u32 s41, s67, 3670016
    buffer_load_dwordx4 v48, s[8:11], s41 offen lds
    s_add_u32 m0, s40, 4096
    s_add_u32 s41, s67, 3801088
    buffer_load_dwordx4 v48, s[8:11], s41 offen lds
    s_add_u32 m0, s40, 8192
    s_add_u32 s41, s67, 3932160
    buffer_load_dwordx4 v48, s[8:11], s41 offen lds
    s_add_u32 m0, s40, 12288
    s_add_u32 s41, s67, 4063232
    buffer_load_dwordx4 v48, s[8:11], s41 offen lds
    s_waitcnt vmcnt(36)
    v_add_u32 v55, 131072, v51
    v_xor_b32 v56, 32, v55
    ds_read_b64_tr_b16 a[200:201], v55 offset:0
    ds_read_b64_tr_b16 a[202:203], v55 offset:256
    ds_read_b64_tr_b16 a[204:205], v55 offset:8192
    ds_read_b64_tr_b16 a[206:207], v55 offset:8448
    ds_read_b64_tr_b16 a[208:209], v56 offset:0
    ds_read_b64_tr_b16 a[210:211], v56 offset:256
    ds_read_b64_tr_b16 a[212:213], v56 offset:8192
    ds_read_b64_tr_b16 a[214:215], v56 offset:8448
    s_waitcnt lgkmcnt(0)
    s_mov_b64 s[8:9], s[50:51]
    s_add_u32 m0, s66, 131072
    s_add_u32 s41, s67, 4194304
    buffer_load_dwordx4 v48, s[8:11], s41 offen lds
    s_add_u32 m0, s66, 135168
    s_add_u32 s41, s67, 4325376
    buffer_load_dwordx4 v48, s[8:11], s41 offen lds
    s_add_u32 m0, s66, 139264
    s_add_u32 s41, s67, 4456448
    buffer_load_dwordx4 v48, s[8:11], s41 offen lds
    s_add_u32 m0, s66, 143360
    s_add_u32 s41, s67, 4587520
    buffer_load_dwordx4 v48, s[8:11], s41 offen lds
    s_waitcnt vmcnt(24)
    v_add_u32 v55, 65536, v51
    v_xor_b32 v56, 32, v55
    ds_read_b64_tr_b16 a[216:217], v55 offset:0
    ds_read_b64_tr_b16 a[218:219], v55 offset:256
    ds_read_b64_tr_b16 a[220:221], v55 offset:8192
    ds_read_b64_tr_b16 a[222:223], v55 offset:8448
    ds_read_b64_tr_b16 a[224:225], v56 offset:0
    ds_read_b64_tr_b16 a[226:227], v56 offset:256
    ds_read_b64_tr_b16 a[228:229], v56 offset:8192
    ds_read_b64_tr_b16 a[230:231], v56 offset:8448
    s_waitcnt lgkmcnt(0)
    v_add_u32 v55, 81920, v51
    v_xor_b32 v56, 32, v55
    ds_read_b64_tr_b16 a[232:233], v55 offset:0
    ds_read_b64_tr_b16 a[234:235], v55 offset:256
    ds_read_b64_tr_b16 a[236:237], v55 offset:8192
    ds_read_b64_tr_b16 a[238:239], v55 offset:8448
    ds_read_b64_tr_b16 a[240:241], v56 offset:0
    ds_read_b64_tr_b16 a[242:243], v56 offset:256
    ds_read_b64_tr_b16 a[244:245], v56 offset:8192
    ds_read_b64_tr_b16 a[246:247], v56 offset:8448
    s_waitcnt lgkmcnt(0)
    v_add_u32 v55, 98304, v51
    v_xor_b32 v56, 32, v55
    ds_read_b64_tr_b16 a[248:249], v55 offset:0
    ds_read_b64_tr_b16 a[250:251], v55 offset:256
    ds_read_b64_tr_b16 a[252:253], v55 offset:8192
    ds_read_b64_tr_b16 a[254:255], v55 offset:8448
    ds_read_b64_tr_b16 v[72:73], v56 offset:0
    ds_read_b64_tr_b16 v[74:75], v56 offset:256
    ds_read_b64_tr_b16 v[76:77], v56 offset:8192
    ds_read_b64_tr_b16 v[78:79], v56 offset:8448
    s_waitcnt lgkmcnt(0)
    v_add_u32 v55, 114688, v51
    v_xor_b32 v56, 32, v55
    ds_read_b64_tr_b16 v[80:81], v55 offset:0
    ds_read_b64_tr_b16 v[82:83], v55 offset:256
    ds_read_b64_tr_b16 v[84:85], v55 offset:8192
    ds_read_b64_tr_b16 v[86:87], v55 offset:8448
    ds_read_b64_tr_b16 v[88:89], v56 offset:0
    ds_read_b64_tr_b16 v[90:91], v56 offset:256
    ds_read_b64_tr_b16 v[92:93], v56 offset:8192
    ds_read_b64_tr_b16 v[94:95], v56 offset:8448
    s_waitcnt lgkmcnt(0)
    s_xor_b32 s40, s93, 0
    s_add_u32 s40, s40, s66
    s_add_u32 m0, s40, 65536
    s_add_u32 s41, s67, 2097152
    buffer_load_dwordx4 v48, s[8:11], s41 offen lds
    s_add_u32 m0, s40, 69632
    s_add_u32 s41, s67, 2228224
    buffer_load_dwordx4 v48, s[8:11], s41 offen lds
    s_add_u32 m0, s40, 73728
    s_add_u32 s41, s67, 2359296
    buffer_load_dwordx4 v48, s[8:11], s41 offen lds
    s_add_u32 m0, s40, 77824
    s_add_u32 s41, s67, 2490368
    buffer_load_dwordx4 v48, s[8:11], s41 offen lds
    s_xor_b32 s40, s93, 16384
    s_add_u32 s40, s40, s66
    s_add_u32 m0, s40, 65536
    s_add_u32 s41, s67, 2621440
    buffer_load_dwordx4 v48, s[8:11], s41 offen lds
    s_add_u32 m0, s40, 69632
    s_add_u32 s41, s67, 2752512
    buffer_load_dwordx4 v48, s[8:11], s41 offen lds
    s_add_u32 m0, s40, 73728
    s_add_u32 s41, s67, 2883584
    buffer_load_dwordx4 v48, s[8:11], s41 offen lds
    s_add_u32 m0, s40, 77824
    s_add_u32 s41, s67, 3014656
    buffer_load_dwordx4 v48, s[8:11], s41 offen lds
    s_xor_b32 s40, s93, 32768
    s_add_u32 s40, s40, s66
    s_add_u32 m0, s40, 65536
    s_add_u32 s41, s67, 3145728
    buffer_load_dwordx4 v48, s[8:11], s41 offen lds
    s_add_u32 m0, s40, 69632
    s_add_u32 s41, s67, 3276800
    buffer_load_dwordx4 v48, s[8:11], s41 offen lds
    s_add_u32 m0, s40, 73728
    s_add_u32 s41, s67, 3407872
    buffer_load_dwordx4 v48, s[8:11], s41 offen lds
    s_add_u32 m0, s40, 77824
    s_add_u32 s41, s67, 3538944
    buffer_load_dwordx4 v48, s[8:11], s41 offen lds
    s_xor_b32 s40, s93, 49152
    s_add_u32 s40, s40, s66
    s_add_u32 m0, s40, 65536
    s_add_u32 s41, s67, 3670016
    buffer_load_dwordx4 v48, s[8:11], s41 offen lds
    s_add_u32 m0, s40, 69632
    s_add_u32 s41, s67, 3801088
    buffer_load_dwordx4 v48, s[8:11], s41 offen lds
    s_add_u32 m0, s40, 73728
    s_add_u32 s41, s67, 3932160
    buffer_load_dwordx4 v48, s[8:11], s41 offen lds
    s_add_u32 m0, s40, 77824
    s_add_u32 s41, s67, 4063232
    buffer_load_dwordx4 v48, s[8:11], s41 offen lds
    s_waitcnt vmcnt(36)
    v_add_u32 v55, 147456, v51
    v_xor_b32 v56, 32, v55
    ds_read_b64_tr_b16 v[160:161], v55 offset:0
    ds_read_b64_tr_b16 v[162:163], v55 offset:256
    ds_read_b64_tr_b16 v[164:165], v55 offset:8192
    ds_read_b64_tr_b16 v[166:167], v55 offset:8448
    ds_read_b64_tr_b16 v[168:169], v56 offset:0
    ds_read_b64_tr_b16 v[170:171], v56 offset:256
    ds_read_b64_tr_b16 v[172:173], v56 offset:8192
    ds_read_b64_tr_b16 v[174:175], v56 offset:8448
    s_waitcnt lgkmcnt(0)
    s_waitcnt vmcnt(20)
    v_add_u32 v55, 0, v51
    v_xor_b32 v56, 32, v55
    ds_read_b64_tr_b16 v[96:97], v55 offset:0
    ds_read_b64_tr_b16 v[98:99], v55 offset:256
    ds_read_b64_tr_b16 v[100:101], v55 offset:8192
    ds_read_b64_tr_b16 v[102:103], v55 offset:8448
    ds_read_b64_tr_b16 v[104:105], v56 offset:0
    ds_read_b64_tr_b16 v[106:107], v56 offset:256
    ds_read_b64_tr_b16 v[108:109], v56 offset:8192
    ds_read_b64_tr_b16 v[110:111], v56 offset:8448
    s_waitcnt lgkmcnt(0)
    v_add_u32 v55, 16384, v51
    v_xor_b32 v56, 32, v55
    ds_read_b64_tr_b16 v[112:113], v55 offset:0
    ds_read_b64_tr_b16 v[114:115], v55 offset:256
    ds_read_b64_tr_b16 v[116:117], v55 offset:8192
    ds_read_b64_tr_b16 v[118:119], v55 offset:8448
    ds_read_b64_tr_b16 v[120:121], v56 offset:0
    ds_read_b64_tr_b16 v[122:123], v56 offset:256
    ds_read_b64_tr_b16 v[124:125], v56 offset:8192
    ds_read_b64_tr_b16 v[126:127], v56 offset:8448
    s_waitcnt lgkmcnt(0)
    v_add_u32 v55, 32768, v51
    v_xor_b32 v56, 32, v55
    ds_read_b64_tr_b16 v[128:129], v55 offset:0
    ds_read_b64_tr_b16 v[130:131], v55 offset:256
    ds_read_b64_tr_b16 v[132:133], v55 offset:8192
    ds_read_b64_tr_b16 v[134:135], v55 offset:8448
    ds_read_b64_tr_b16 v[136:137], v56 offset:0
    ds_read_b64_tr_b16 v[138:139], v56 offset:256
    ds_read_b64_tr_b16 v[140:141], v56 offset:8192
    ds_read_b64_tr_b16 v[142:143], v56 offset:8448
    s_waitcnt lgkmcnt(0)
    v_add_u32 v55, 49152, v51
    v_xor_b32 v56, 32, v55
    ds_read_b64_tr_b16 v[144:145], v55 offset:0
    ds_read_b64_tr_b16 v[146:147], v55 offset:256
    ds_read_b64_tr_b16 v[148:149], v55 offset:8192
    ds_read_b64_tr_b16 v[150:151], v55 offset:8448
    ds_read_b64_tr_b16 v[152:153], v56 offset:0
    ds_read_b64_tr_b16 v[154:155], v56 offset:256
    ds_read_b64_tr_b16 v[156:157], v56 offset:8192
    ds_read_b64_tr_b16 v[158:159], v56 offset:8448
    s_waitcnt lgkmcnt(0)
    s_xor_b32 s40, s93, 0
    s_add_u32 s40, s40, s66
    s_add_u32 m0, s40, 0
    s_add_u32 s41, s67, 0
    buffer_load_dwordx4 v48, s[8:11], s41 offen lds
    s_add_u32 m0, s40, 4096
    s_add_u32 s41, s67, 131072
    buffer_load_dwordx4 v48, s[8:11], s41 offen lds
    s_add_u32 m0, s40, 8192
    s_add_u32 s41, s67, 262144
    buffer_load_dwordx4 v48, s[8:11], s41 offen lds
    s_add_u32 m0, s40, 12288
    s_add_u32 s41, s67, 393216
    buffer_load_dwordx4 v48, s[8:11], s41 offen lds
    s_xor_b32 s40, s93, 16384
    s_add_u32 s40, s40, s66
    s_add_u32 m0, s40, 0
    s_add_u32 s41, s67, 524288
    buffer_load_dwordx4 v48, s[8:11], s41 offen lds
    s_add_u32 m0, s40, 4096
    s_add_u32 s41, s67, 655360
    buffer_load_dwordx4 v48, s[8:11], s41 offen lds
    s_add_u32 m0, s40, 8192
    s_add_u32 s41, s67, 786432
    buffer_load_dwordx4 v48, s[8:11], s41 offen lds
    s_add_u32 m0, s40, 12288
    s_add_u32 s41, s67, 917504
    buffer_load_dwordx4 v48, s[8:11], s41 offen lds
    s_xor_b32 s40, s93, 32768
    s_add_u32 s40, s40, s66
    s_add_u32 m0, s40, 0
    s_add_u32 s41, s67, 1048576
    buffer_load_dwordx4 v48, s[8:11], s41 offen lds
    s_add_u32 m0, s40, 4096
    s_add_u32 s41, s67, 1179648
    buffer_load_dwordx4 v48, s[8:11], s41 offen lds
    s_add_u32 m0, s40, 8192
    s_add_u32 s41, s67, 1310720
    buffer_load_dwordx4 v48, s[8:11], s41 offen lds
    s_add_u32 m0, s40, 12288
    s_add_u32 s41, s67, 1441792
    buffer_load_dwordx4 v48, s[8:11], s41 offen lds
    s_xor_b32 s40, s93, 49152
    s_add_u32 s40, s40, s66
    s_add_u32 m0, s40, 0
    s_add_u32 s41, s67, 1572864
    buffer_load_dwordx4 v48, s[8:11], s41 offen lds
    s_add_u32 m0, s40, 4096
    s_add_u32 s41, s67, 1703936
    buffer_load_dwordx4 v48, s[8:11], s41 offen lds
    s_add_u32 m0, s40, 8192
    s_add_u32 s41, s67, 1835008
    buffer_load_dwordx4 v48, s[8:11], s41 offen lds
    s_add_u32 m0, s40, 12288
    s_add_u32 s41, s67, 1966080
    buffer_load_dwordx4 v48, s[8:11], s41 offen lds
    s_waitcnt vmcnt(32)
    v_add_u32 v55, 131072, v51
    v_xor_b32 v56, 32, v55
    ds_read_b64_tr_b16 a[120:121], v55 offset:0
    ds_read_b64_tr_b16 a[122:123], v55 offset:256
    ds_read_b64_tr_b16 a[124:125], v55 offset:8192
    ds_read_b64_tr_b16 a[126:127], v55 offset:8448
    ds_read_b64_tr_b16 a[128:129], v56 offset:0
    ds_read_b64_tr_b16 a[130:131], v56 offset:256
    ds_read_b64_tr_b16 a[132:133], v56 offset:8192
    ds_read_b64_tr_b16 a[134:135], v56 offset:8448
    s_waitcnt lgkmcnt(0)
    s_mov_b64 s[8:9], s[56:57]
    s_xor_b32 s94, s13, 0
    s_mul_i32 s94, s94, 36864
    s_add_u32 s94, s94, s92
    s_lshl_b32 s40, s13, 7
    s_add_u32 s94, s94, s40
    s_add_u32 m0, s66, 131072
    s_add_u32 s41, s94, 0
    buffer_load_dwordx4 v49, s[8:11], s41 offen lds
    s_add_u32 m0, s66, 135168
    s_add_u32 s41, s94, 9216
    buffer_load_dwordx4 v49, s[8:11], s41 offen lds
    s_add_u32 m0, s66, 139264
    s_add_u32 s41, s94, 18432
    buffer_load_dwordx4 v49, s[8:11], s41 offen lds
    s_add_u32 m0, s66, 143360
    s_add_u32 s41, s94, 27648
    buffer_load_dwordx4 v49, s[8:11], s41 offen lds
    s_waitcnt vmcnt(20)
    v_add_u32 v55, 65536, v51
    v_xor_b32 v56, 32, v55
    ds_read_b64_tr_b16 a[56:57], v55 offset:0
    ds_read_b64_tr_b16 a[58:59], v55 offset:256
    ds_read_b64_tr_b16 a[60:61], v55 offset:8192
    ds_read_b64_tr_b16 a[62:63], v55 offset:8448
    ds_read_b64_tr_b16 a[64:65], v56 offset:0
    ds_read_b64_tr_b16 a[66:67], v56 offset:256
    ds_read_b64_tr_b16 a[68:69], v56 offset:8192
    ds_read_b64_tr_b16 a[70:71], v56 offset:8448
    s_waitcnt lgkmcnt(0)
    v_add_u32 v55, 81920, v51
    v_xor_b32 v56, 32, v55
    ds_read_b64_tr_b16 a[72:73], v55 offset:0
    ds_read_b64_tr_b16 a[74:75], v55 offset:256
    ds_read_b64_tr_b16 a[76:77], v55 offset:8192
    ds_read_b64_tr_b16 a[78:79], v55 offset:8448
    ds_read_b64_tr_b16 a[80:81], v56 offset:0
    ds_read_b64_tr_b16 a[82:83], v56 offset:256
    ds_read_b64_tr_b16 a[84:85], v56 offset:8192
    ds_read_b64_tr_b16 a[86:87], v56 offset:8448
    s_waitcnt lgkmcnt(0)
    v_add_u32 v55, 98304, v51
    v_xor_b32 v56, 32, v55
    ds_read_b64_tr_b16 a[88:89], v55 offset:0
    ds_read_b64_tr_b16 a[90:91], v55 offset:256
    ds_read_b64_tr_b16 a[92:93], v55 offset:8192
    ds_read_b64_tr_b16 a[94:95], v55 offset:8448
    ds_read_b64_tr_b16 a[96:97], v56 offset:0
    ds_read_b64_tr_b16 a[98:99], v56 offset:256
    ds_read_b64_tr_b16 a[100:101], v56 offset:8192
    ds_read_b64_tr_b16 a[102:103], v56 offset:8448
    s_waitcnt lgkmcnt(0)
    v_add_u32 v55, 114688, v51
    v_xor_b32 v56, 32, v55
    ds_read_b64_tr_b16 a[104:105], v55 offset:0
    ds_read_b64_tr_b16 a[106:107], v55 offset:256
    ds_read_b64_tr_b16 a[108:109], v55 offset:8192
    ds_read_b64_tr_b16 a[110:111], v55 offset:8448
    ds_read_b64_tr_b16 a[112:113], v56 offset:0
    ds_read_b64_tr_b16 a[114:115], v56 offset:256
    ds_read_b64_tr_b16 a[116:117], v56 offset:8192
    ds_read_b64_tr_b16 a[118:119], v56 offset:8448
    s_waitcnt lgkmcnt(0)
    s_xor_b32 s94, s13, 1
    s_mul_i32 s94, s94, 36864
    s_add_u32 s94, s94, s92
    s_lshl_b32 s40, s13, 7
    s_add_u32 s94, s94, s40
    s_add_u32 m0, s66, 65536
    s_add_u32 s41, s94, 0
    buffer_load_dwordx4 v49, s[8:11], s41 offen lds
    s_add_u32 m0, s66, 69632
    s_add_u32 s41, s94, 9216
    buffer_load_dwordx4 v49, s[8:11], s41 offen lds
    s_add_u32 m0, s66, 73728
    s_add_u32 s41, s94, 18432
    buffer_load_dwordx4 v49, s[8:11], s41 offen lds
    s_add_u32 m0, s66, 77824
    s_add_u32 s41, s94, 27648
    buffer_load_dwordx4 v49, s[8:11], s41 offen lds
    s_xor_b32 s94, s13, 2
    s_mul_i32 s94, s94, 36864
    s_add_u32 s94, s94, s92
    s_lshl_b32 s40, s13, 7
    s_add_u32 s94, s94, s40
    s_add_u32 m0, s66, 81920
    s_add_u32 s41, s94, 0
    buffer_load_dwordx4 v49, s[8:11], s41 offen lds
    s_add_u32 m0, s66, 86016
    s_add_u32 s41, s94, 9216
    buffer_load_dwordx4 v49, s[8:11], s41 offen lds
    s_add_u32 m0, s66, 90112
    s_add_u32 s41, s94, 18432
    buffer_load_dwordx4 v49, s[8:11], s41 offen lds
    s_add_u32 m0, s66, 94208
    s_add_u32 s41, s94, 27648
    buffer_load_dwordx4 v49, s[8:11], s41 offen lds
    s_xor_b32 s94, s13, 3
    s_mul_i32 s94, s94, 36864
    s_add_u32 s94, s94, s92
    s_lshl_b32 s40, s13, 7
    s_add_u32 s94, s94, s40
    s_add_u32 m0, s66, 98304
    s_add_u32 s41, s94, 0
    buffer_load_dwordx4 v49, s[8:11], s41 offen lds
    s_add_u32 m0, s66, 102400
    s_add_u32 s41, s94, 9216
    buffer_load_dwordx4 v49, s[8:11], s41 offen lds
    s_add_u32 m0, s66, 106496
    s_add_u32 s41, s94, 18432
    buffer_load_dwordx4 v49, s[8:11], s41 offen lds
    s_add_u32 m0, s66, 110592
    s_add_u32 s41, s94, 27648
    buffer_load_dwordx4 v49, s[8:11], s41 offen lds
    s_waitcnt vmcnt(16)
    v_add_u32 v55, 0, v51
    v_xor_b32 v56, 32, v55
    ds_read_b64_tr_b16 a[0:1], v55 offset:0
    ds_read_b64_tr_b16 a[2:3], v55 offset:256
    ds_read_b64_tr_b16 a[4:5], v55 offset:8192
    ds_read_b64_tr_b16 a[6:7], v55 offset:8448
    ds_read_b64_tr_b16 v[8:9], v56 offset:0
    ds_read_b64_tr_b16 v[10:11], v56 offset:256
    ds_read_b64_tr_b16 v[12:13], v56 offset:8192
    ds_read_b64_tr_b16 v[14:15], v56 offset:8448
    s_waitcnt lgkmcnt(0)
    s_barrier
    ds_write_b128 v63, v[8:11] offset:57344
    ds_write_b128 v63, v[12:15] offset:61440
    s_waitcnt lgkmcnt(0)
    v_add_u32 v55, 16384, v51
    v_xor_b32 v56, 32, v55
    ds_read_b64_tr_b16 a[8:9], v55 offset:0
    ds_read_b64_tr_b16 a[10:11], v55 offset:256
    ds_read_b64_tr_b16 a[12:13], v55 offset:8192
    ds_read_b64_tr_b16 a[14:15], v55 offset:8448
    ds_read_b64_tr_b16 a[16:17], v56 offset:0
    ds_read_b64_tr_b16 a[18:19], v56 offset:256
    ds_read_b64_tr_b16 a[20:21], v56 offset:8192
    ds_read_b64_tr_b16 a[22:23], v56 offset:8448
    s_waitcnt lgkmcnt(0)
    v_add_u32 v55, 32768, v51
    v_xor_b32 v56, 32, v55
    ds_read_b64_tr_b16 a[24:25], v55 offset:0
    ds_read_b64_tr_b16 a[26:27], v55 offset:256
    ds_read_b64_tr_b16 a[28:29], v55 offset:8192
    ds_read_b64_tr_b16 a[30:31], v55 offset:8448
    ds_read_b64_tr_b16 a[32:33], v56 offset:0
    ds_read_b64_tr_b16 a[34:35], v56 offset:256
    ds_read_b64_tr_b16 a[36:37], v56 offset:8192
    ds_read_b64_tr_b16 a[38:39], v56 offset:8448
    s_waitcnt lgkmcnt(0)
    v_add_u32 v55, 49152, v51
    v_xor_b32 v56, 32, v55
    ds_read_b64_tr_b16 a[40:41], v55 offset:0
    ds_read_b64_tr_b16 a[42:43], v55 offset:256
    ds_read_b64_tr_b16 a[44:45], v55 offset:8192
    ds_read_b64_tr_b16 a[46:47], v55 offset:8448
    ds_read_b64_tr_b16 a[48:49], v56 offset:0
    ds_read_b64_tr_b16 a[50:51], v56 offset:256
    ds_read_b64_tr_b16 a[52:53], v56 offset:8192
    ds_read_b64_tr_b16 a[54:55], v56 offset:8448
    s_waitcnt lgkmcnt(0)
    s_mov_b64 s[8:9], s[52:53]
    s_xor_b32 s40, s93, 0
    s_add_u32 s40, s40, s66
    s_add_u32 m0, s40, 0
    s_add_u32 s41, s67, 0
    buffer_load_dwordx4 v48, s[8:11], s41 offen lds
    s_add_u32 m0, s40, 4096
    s_add_u32 s41, s67, 131072
    buffer_load_dwordx4 v48, s[8:11], s41 offen lds
    s_add_u32 m0, s40, 8192
    s_add_u32 s41, s67, 262144
    buffer_load_dwordx4 v48, s[8:11], s41 offen lds
    s_add_u32 m0, s40, 12288
    s_add_u32 s41, s67, 393216
    buffer_load_dwordx4 v48, s[8:11], s41 offen lds
    s_xor_b32 s40, s93, 16384
    s_add_u32 s40, s40, s66
    s_add_u32 m0, s40, 0
    s_add_u32 s41, s67, 524288
    buffer_load_dwordx4 v48, s[8:11], s41 offen lds
    s_add_u32 m0, s40, 4096
    s_add_u32 s41, s67, 655360
    buffer_load_dwordx4 v48, s[8:11], s41 offen lds
    s_add_u32 m0, s40, 8192
    s_add_u32 s41, s67, 786432
    buffer_load_dwordx4 v48, s[8:11], s41 offen lds
    s_add_u32 m0, s40, 12288
    s_add_u32 s41, s67, 917504
    buffer_load_dwordx4 v48, s[8:11], s41 offen lds
    s_xor_b32 s40, s93, 32768
    s_add_u32 s40, s40, s66
    s_add_u32 m0, s40, 0
    s_add_u32 s41, s67, 1048576
    buffer_load_dwordx4 v48, s[8:11], s41 offen lds
    s_add_u32 m0, s40, 4096
    s_add_u32 s41, s67, 1179648
    buffer_load_dwordx4 v48, s[8:11], s41 offen lds
    s_add_u32 m0, s40, 8192
    s_add_u32 s41, s67, 1310720
    buffer_load_dwordx4 v48, s[8:11], s41 offen lds
    s_add_u32 m0, s40, 12288
    s_add_u32 s41, s67, 1441792
    buffer_load_dwordx4 v48, s[8:11], s41 offen lds
    s_xor_b32 s40, s93, 49152
    s_add_u32 s40, s40, s66
    s_add_u32 m0, s40, 0
    s_add_u32 s41, s67, 1572864
    buffer_load_dwordx4 v48, s[8:11], s41 offen lds
    s_add_u32 m0, s40, 4096
    s_add_u32 s41, s67, 1703936
    buffer_load_dwordx4 v48, s[8:11], s41 offen lds
    s_add_u32 m0, s40, 8192
    s_add_u32 s41, s67, 1835008
    buffer_load_dwordx4 v48, s[8:11], s41 offen lds
    s_add_u32 m0, s40, 12288
    s_add_u32 s41, s67, 1966080
    buffer_load_dwordx4 v48, s[8:11], s41 offen lds
    s_waitcnt vmcnt(28)
    v_add_u32 v55, 131072, v52
    ds_read_b64_tr_b16 v[176:177], v55 offset:0
    ds_read_b64_tr_b16 v[178:179], v55 offset:256
    ds_read_b64_tr_b16 v[180:181], v55 offset:4096
    ds_read_b64_tr_b16 v[182:183], v55 offset:4352
    ds_read_b64_tr_b16 v[208:209], v55 offset:64
    ds_read_b64_tr_b16 v[210:211], v55 offset:320
    ds_read_b64_tr_b16 v[212:213], v55 offset:4160
    ds_read_b64_tr_b16 v[214:215], v55 offset:4416
    s_waitcnt lgkmcnt(0)
    s_mov_b64 s[8:9], s[56:57]
    s_xor_b32 s94, s13, 3
    s_mul_i32 s94, s94, 36864
    s_add_u32 s94, s94, s92
    s_lshl_b32 s40, s13, 7
    s_add_u32 s94, s94, s40
    s_add_u32 m0, s66, 122880
    s_add_u32 s41, s94, 512
    buffer_load_dwordx4 v49, s[8:11], s41 offen lds
    s_add_u32 m0, s66, 126976
    s_add_u32 s41, s94, 9728
    buffer_load_dwordx4 v49, s[8:11], s41 offen lds
    s_add_u32 m0, s66, 131072
    s_add_u32 s41, s94, 18944
    buffer_load_dwordx4 v49, s[8:11], s41 offen lds
    s_add_u32 m0, s66, 135168
    s_add_u32 s41, s94, 28160
    buffer_load_dwordx4 v49, s[8:11], s41 offen lds
    s_xor_b32 s94, s13, 0
    s_mul_i32 s94, s94, 36864
    s_add_u32 s94, s94, s92
    s_lshr_b32 s40, s13, 1
    s_lshl_b32 s40, s40, 6
    s_add_u32 s94, s94, s40
    s_add_u32 m0, s66, 139264
    s_add_u32 s41, s94, 1024
    buffer_load_dwordx4 v50, s[8:11], s41 offen lds
    s_add_u32 m0, s66, 143360
    s_add_u32 s41, s94, 19456
    buffer_load_dwordx4 v50, s[8:11], s41 offen lds
    s_xor_b32 s94, s13, 2
    s_mul_i32 s94, s94, 36864
    s_add_u32 s94, s94, s92
    s_lshr_b32 s40, s13, 1
    s_lshl_b32 s40, s40, 6
    s_add_u32 s94, s94, s40
    s_add_u32 m0, s66, 147456
    s_add_u32 s41, s94, 1024
    buffer_load_dwordx4 v50, s[8:11], s41 offen lds
    s_add_u32 m0, s66, 151552
    s_add_u32 s41, s94, 19456
    buffer_load_dwordx4 v50, s[8:11], s41 offen lds
    s_waitcnt vmcnt(32)
    v_add_u32 v55, 65536, v52
    ds_read_b64_tr_b16 v[184:185], v55 offset:0
    ds_read_b64_tr_b16 v[186:187], v55 offset:256
    ds_read_b64_tr_b16 v[188:189], v55 offset:4096
    ds_read_b64_tr_b16 v[190:191], v55 offset:4352
    ds_read_b64_tr_b16 v[216:217], v55 offset:64
    ds_read_b64_tr_b16 v[218:219], v55 offset:320
    ds_read_b64_tr_b16 v[220:221], v55 offset:4160
    ds_read_b64_tr_b16 v[222:223], v55 offset:4416
    s_waitcnt lgkmcnt(0)
    s_xor_b32 s94, s13, 0
    s_mul_i32 s94, s94, 36864
    s_add_u32 s94, s94, s92
    s_lshl_b32 s40, s13, 7
    s_add_u32 s94, s94, s40
    s_add_u32 m0, s66, 65536
    s_add_u32 s41, s94, 512
    buffer_load_dwordx4 v49, s[8:11], s41 offen lds
    s_add_u32 m0, s66, 69632
    s_add_u32 s41, s94, 9728
    buffer_load_dwordx4 v49, s[8:11], s41 offen lds
    s_add_u32 m0, s66, 73728
    s_add_u32 s41, s94, 18944
    buffer_load_dwordx4 v49, s[8:11], s41 offen lds
    s_add_u32 m0, s66, 77824
    s_add_u32 s41, s94, 28160
    buffer_load_dwordx4 v49, s[8:11], s41 offen lds
    s_waitcnt vmcnt(32)
    v_add_u32 v55, 81920, v52
    ds_read_b64_tr_b16 v[192:193], v55 offset:0
    ds_read_b64_tr_b16 v[194:195], v55 offset:256
    ds_read_b64_tr_b16 v[196:197], v55 offset:4096
    ds_read_b64_tr_b16 v[198:199], v55 offset:4352
    ds_read_b64_tr_b16 v[224:225], v55 offset:64
    ds_read_b64_tr_b16 v[226:227], v55 offset:320
    ds_read_b64_tr_b16 v[228:229], v55 offset:4160
    ds_read_b64_tr_b16 v[230:231], v55 offset:4416
    s_waitcnt lgkmcnt(0)
    s_xor_b32 s94, s13, 2
    s_mul_i32 s94, s94, 36864
    s_add_u32 s94, s94, s92
    s_lshl_b32 s40, s13, 7
    s_add_u32 s94, s94, s40
    s_add_u32 m0, s66, 81920
    s_add_u32 s41, s94, 512
    buffer_load_dwordx4 v49, s[8:11], s41 offen lds
    s_add_u32 m0, s66, 86016
    s_add_u32 s41, s94, 9728
    buffer_load_dwordx4 v49, s[8:11], s41 offen lds
    s_add_u32 m0, s66, 90112
    s_add_u32 s41, s94, 18944
    buffer_load_dwordx4 v49, s[8:11], s41 offen lds
    s_add_u32 m0, s66, 94208
    s_add_u32 s41, s94, 28160
    buffer_load_dwordx4 v49, s[8:11], s41 offen lds
    s_waitcnt vmcnt(32)
    v_add_u32 v55, 98304, v52
    ds_read_b64_tr_b16 v[200:201], v55 offset:0
    ds_read_b64_tr_b16 v[202:203], v55 offset:256
    ds_read_b64_tr_b16 v[204:205], v55 offset:4096
    ds_read_b64_tr_b16 v[206:207], v55 offset:4352
    ds_read_b64_tr_b16 v[232:233], v55 offset:64
    ds_read_b64_tr_b16 v[234:235], v55 offset:320
    ds_read_b64_tr_b16 v[236:237], v55 offset:4160
    ds_read_b64_tr_b16 v[238:239], v55 offset:4416
    s_waitcnt lgkmcnt(0)
    s_xor_b32 s94, s13, 1
    s_mul_i32 s94, s94, 36864
    s_add_u32 s94, s94, s92
    s_lshl_b32 s40, s13, 7
    s_add_u32 s94, s94, s40
    s_add_u32 m0, s66, 98304
    s_add_u32 s41, s94, 512
    buffer_load_dwordx4 v49, s[8:11], s41 offen lds
    s_add_u32 m0, s66, 102400
    s_add_u32 s41, s94, 9728
    buffer_load_dwordx4 v49, s[8:11], s41 offen lds
    s_add_u32 m0, s66, 106496
    s_add_u32 s41, s94, 18944
    buffer_load_dwordx4 v49, s[8:11], s41 offen lds
    s_add_u32 m0, s66, 110592
    s_add_u32 s41, s94, 28160
    buffer_load_dwordx4 v49, s[8:11], s41 offen lds
    s_waitcnt vmcnt(20)
    v_add_u32 v55, 0, v51
    v_xor_b32 v56, 32, v55
    ds_read_b64_tr_b16 v[0:1], v55 offset:0
    ds_read_b64_tr_b16 v[2:3], v55 offset:256
    ds_read_b64_tr_b16 v[4:5], v55 offset:8192
    ds_read_b64_tr_b16 v[6:7], v55 offset:8448
    ds_read_b64_tr_b16 v[8:9], v56 offset:0
    ds_read_b64_tr_b16 v[10:11], v56 offset:256
    ds_read_b64_tr_b16 v[12:13], v56 offset:8192
    ds_read_b64_tr_b16 v[14:15], v56 offset:8448
    s_waitcnt lgkmcnt(0)
    ds_write_b128 v61, v[0:3] offset:0
    ds_write_b128 v61, v[4:7] offset:4096
    ds_write_b128 v61, v[8:11] offset:8192
    ds_write_b128 v61, v[12:15] offset:12288
    s_waitcnt lgkmcnt(0)
    v_add_u32 v55, 16384, v51
    v_xor_b32 v56, 32, v55
    ds_read_b64_tr_b16 v[0:1], v55 offset:0
    ds_read_b64_tr_b16 v[2:3], v55 offset:256
    ds_read_b64_tr_b16 v[4:5], v55 offset:8192
    ds_read_b64_tr_b16 v[6:7], v55 offset:8448
    ds_read_b64_tr_b16 v[8:9], v56 offset:0
    ds_read_b64_tr_b16 v[10:11], v56 offset:256
    ds_read_b64_tr_b16 v[12:13], v56 offset:8192
    ds_read_b64_tr_b16 v[14:15], v56 offset:8448
    s_waitcnt lgkmcnt(0)
    ds_write_b128 v61, v[0:3] offset:16384
    ds_write_b128 v61, v[4:7] offset:20480
    ds_write_b128 v61, v[8:11] offset:24576
    ds_write_b128 v61, v[12:15] offset:28672
    s_waitcnt lgkmcnt(0)
    v_add_u32 v55, 32768, v51
    v_xor_b32 v56, 32, v55
    ds_read_b64_tr_b16 v[0:1], v55 offset:0
    ds_read_b64_tr_b16 v[2:3], v55 offset:256
    ds_read_b64_tr_b16 v[4:5], v55 offset:8192
    ds_read_b64_tr_b16 v[6:7], v55 offset:8448
    ds_read_b64_tr_b16 v[8:9], v56 offset:0
    ds_read_b64_tr_b16 v[10:11], v56 offset:256
    ds_read_b64_tr_b16 v[12:13], v56 offset:8192
    ds_read_b64_tr_b16 v[14:15], v56 offset:8448
    s_waitcnt lgkmcnt(0)
    ds_write_b128 v61, v[0:3] offset:32768
    ds_write_b128 v61, v[4:7] offset:36864
    ds_write_b128 v61, v[8:11] offset:40960
    ds_write_b128 v61, v[12:15] offset:45056
    s_waitcnt lgkmcnt(0)
    v_add_u32 v55, 49152, v51
    v_xor_b32 v56, 32, v55
    ds_read_b64_tr_b16 v[0:1], v55 offset:0
    ds_read_b64_tr_b16 v[2:3], v55 offset:256
    ds_read_b64_tr_b16 v[4:5], v55 offset:8192
    ds_read_b64_tr_b16 v[6:7], v55 offset:8448
    ds_read_b64_tr_b16 v[8:9], v56 offset:0
    ds_read_b64_tr_b16 v[10:11], v56 offset:256
    ds_read_b64_tr_b16 v[12:13], v56 offset:8192
    ds_read_b64_tr_b16 v[14:15], v56 offset:8448
    s_waitcnt lgkmcnt(0)
    ds_write_b128 v61, v[0:3] offset:49152
    ds_write_b128 v61, v[4:7] offset:53248
    ds_write_b128 v61, v[8:11] offset:57344
    ds_write_b128 v61, v[12:15] offset:61440
    s_waitcnt lgkmcnt(0)
    s_waitcnt vmcnt(16)
    v_add_u32 v55, 122880, v52
    ds_read_b64_tr_b16 v[0:1], v55 offset:0
    ds_read_b64_tr_b16 v[2:3], v55 offset:256
    ds_read_b64_tr_b16 v[4:5], v55 offset:4096
    ds_read_b64_tr_b16 v[6:7], v55 offset:4352
    ds_read_b64_tr_b16 v[8:9], v55 offset:64
    ds_read_b64_tr_b16 v[10:11], v55 offset:320
    ds_read_b64_tr_b16 v[12:13], v55 offset:4160
    ds_read_b64_tr_b16 v[14:15], v55 offset:4416
    s_waitcnt lgkmcnt(0)
    s_barrier
    ds_write_b128 v63, v[0:3] offset:24576
    ds_write_b128 v63, v[4:7] offset:28672
    s_barrier
    ds_write_b128 v63, v[8:11] offset:32768
    ds_write_b128 v63, v[12:15] offset:36864
    s_waitcnt lgkmcnt(0)
    s_waitcnt vmcnt(12)
    v_add_u32 v55, 139264, v53
    ds_read_b64_tr_b16 v[0:1], v55 offset:0
    ds_read_b64_tr_b16 v[2:3], v55 offset:128
    ds_read_b64_tr_b16 v[4:5], v55 offset:512
    ds_read_b64_tr_b16 v[6:7], v55 offset:640
    ds_read_b64_tr_b16 v[8:9], v55 offset:8192
    ds_read_b64_tr_b16 v[10:11], v55 offset:8320
    ds_read_b64_tr_b16 v[12:13], v55 offset:8704
    ds_read_b64_tr_b16 v[14:15], v55 offset:8832
    s_waitcnt lgkmcnt(0)
    s_barrier
    ds_write_b128 v63, v[0:3] offset:40960
    ds_write_b128 v63, v[4:7] offset:45056
    s_barrier
    ds_write_b128 v63, v[8:11] offset:49152
    ds_write_b128 v63, v[12:15] offset:53248
    s_waitcnt lgkmcnt(0)
    s_waitcnt vmcnt(8)
    v_add_u32 v55, 65536, v52
    ds_read_b64_tr_b16 v[0:1], v55 offset:0
    ds_read_b64_tr_b16 v[2:3], v55 offset:256
    ds_read_b64_tr_b16 v[4:5], v55 offset:4096
    ds_read_b64_tr_b16 v[6:7], v55 offset:4352
    ds_read_b64_tr_b16 v[8:9], v55 offset:64
    ds_read_b64_tr_b16 v[10:11], v55 offset:320
    ds_read_b64_tr_b16 v[12:13], v55 offset:4160
    ds_read_b64_tr_b16 v[14:15], v55 offset:4416
    s_waitcnt lgkmcnt(0)
    ds_write_b128 v62, v[0:3] offset:8192
    ds_write_b128 v62, v[4:7] offset:12288
    ds_write_b128 v62, v[8:11] offset:16384
    ds_write_b128 v62, v[12:15] offset:20480
    s_waitcnt lgkmcnt(0)
    s_waitcnt vmcnt(4)
    v_add_u32 v55, 81920, v52
    ds_read_b64_tr_b16 v[0:1], v55 offset:0
    ds_read_b64_tr_b16 v[2:3], v55 offset:256
    ds_read_b64_tr_b16 v[4:5], v55 offset:4096
    ds_read_b64_tr_b16 v[6:7], v55 offset:4352
    ds_read_b64_tr_b16 v[8:9], v55 offset:64
    ds_read_b64_tr_b16 v[10:11], v55 offset:320
    ds_read_b64_tr_b16 v[12:13], v55 offset:4160
    ds_read_b64_tr_b16 v[14:15], v55 offset:4416
    s_waitcnt lgkmcnt(0)
    ds_write_b128 v62, v[0:3] offset:24576
    ds_write_b128 v62, v[4:7] offset:28672
    ds_write_b128 v62, v[8:11] offset:32768
    ds_write_b128 v62, v[12:15] offset:36864
    s_waitcnt lgkmcnt(0)
    s_waitcnt vmcnt(0)
    v_add_u32 v55, 98304, v52
    ds_read_b64_tr_b16 v[240:241], v55 offset:0
    ds_read_b64_tr_b16 v[242:243], v55 offset:256
    ds_read_b64_tr_b16 v[244:245], v55 offset:4096
    ds_read_b64_tr_b16 v[246:247], v55 offset:4352
    ds_read_b64_tr_b16 v[248:249], v55 offset:64
    ds_read_b64_tr_b16 v[250:251], v55 offset:320
    ds_read_b64_tr_b16 v[252:253], v55 offset:4160
    ds_read_b64_tr_b16 v[254:255], v55 offset:4416
    s_waitcnt lgkmcnt(0)
    s_barrier
    v_bfe_u32 v40, v61, 4, 4
    v_bfe_u32 v41, v61, 8, 1
    v_lshlrev_b32 v41, 2, v41
    v_sub_u32 v41, v40, v41
    v_mov_b32 v42, 0x3f80
    v_mov_b32 v43, 0x3f800000
    v_cmp_eq_u32 vcc, 0, v41
    s_nop 1
    v_cndmask_b32 v32, 0, v42, vcc
    v_cmp_eq_u32 vcc, 1, v41
    s_nop 1
    v_cndmask_b32 v32, v32, v43, vcc
    v_cmp_eq_u32 vcc, 0, v40
    s_nop 1
    v_cndmask_b32 v36, 0, v42, vcc
    v_cmp_eq_u32 vcc, 1, v40
    s_nop 1
    v_cndmask_b32 v36, v36, v43, vcc
    v_cmp_eq_u32 vcc, 2, v41
    s_nop 1
    v_cndmask_b32 v33, 0, v42, vcc
    v_cmp_eq_u32 vcc, 3, v41
    s_nop 1
    v_cndmask_b32 v33, v33, v43, vcc
    v_cmp_eq_u32 vcc, 2, v40
    s_nop 1
    v_cndmask_b32 v37, 0, v42, vcc
    v_cmp_eq_u32 vcc, 3, v40
    s_nop 1
    v_cndmask_b32 v37, v37, v43, vcc
    v_cmp_eq_u32 vcc, 8, v41
    s_nop 1
    v_cndmask_b32 v34, 0, v42, vcc
    v_cmp_eq_u32 vcc, 9, v41
    s_nop 1
    v_cndmask_b32 v34, v34, v43, vcc
    v_cmp_eq_u32 vcc, 4, v40
    s_nop 1
    v_cndmask_b32 v38, 0, v42, vcc
    v_cmp_eq_u32 vcc, 5, v40
    s_nop 1
    v_cndmask_b32 v38, v38, v43, vcc
    v_cmp_eq_u32 vcc, 10, v41
    s_nop 1
    v_cndmask_b32 v35, 0, v42, vcc
    v_cmp_eq_u32 vcc, 11, v41
    s_nop 1
    v_cndmask_b32 v35, v35, v43, vcc
    v_cmp_eq_u32 vcc, 6, v40
    s_nop 1
    v_cndmask_b32 v39, 0, v42, vcc
    v_cmp_eq_u32 vcc, 7, v40
    s_nop 1
    v_cndmask_b32 v39, v39, v43, vcc
    ds_write_b128 v65, v[32:35] offset:9216
    ds_write_b128 v65, v[36:39] offset:10240
    v_mov_b32 v44, s95
    v_mov_b32 v45, s95
    v_mov_b32 v46, s95
    v_mov_b32 v47, s95
    v_mov_b32 v48, 118784
    ds_write_b128 v48, v[44:47]
    s_waitcnt vmcnt(0) lgkmcnt(0)
    s_barrier
    v_mov_b32 v2, 1
    s_cmp_lg_u32 s13, 0
    s_cbranch_scc1 cf_noarr
    s_mov_b64 exec, 1
    buffer_atomic_add v2, off, s[96:99], 0 offset:132
    s_mov_b32 s40, 131072
    s_mov_b32 s42, 2
cf_startpoll:
    buffer_load_dword v3, off, s[96:99], 0 offset:132 sc1
    s_sub_u32 s40, s40, 1
    s_cbranch_scc1 cf_decide
    s_waitcnt vmcnt(0)
    v_readfirstlane_b32 s41, v3
    s_nop 1
    s_cmp_lt_u32 s41, 32
    s_cbranch_scc1 cf_startpoll
    s_mov_b32 s42, 1
cf_decide:
    v_mov_b32 v4, s42
    v_mov_b32 v5, 0
    buffer_atomic_cmpswap v[4:5], off, s[96:99], 0 offset:28 sc0
    s_waitcnt vmcnt(0)
    v_mov_b32 v5, s42
    v_cmp_eq_u32 vcc, 0, v4
    s_nop 1
    v_cndmask_b32 v4, v4, v5, vcc
    v_mov_b32 v5, 112640
    ds_write_b32 v5, v4
    s_waitcnt lgkmcnt(0)
    s_mov_b64 exec, -1
cf_noarr:
    s_barrier
    v_mov_b32 v5, 112640
    ds_read_b32 v4, v5
    s_waitcnt lgkmcnt(0)
    v_readfirstlane_b32 s41, v4
    s_nop 1
    s_cmp_eq_u32 s41, 1
    s_cbranch_scc1 cf_run
    v_lshrrev_b32 v0, 4, v61
    s_mov_b32 s32, s13
    s_load_dwordx16 s[48:63], s[0:1], 0
    s_waitcnt lgkmcnt(0)
    s_branch L_helper
cf_run:
    s_lshr_b32 s92, s12, 1
    s_lshl_b32 s92, s92, 8
    s_add_u32 s92, s92, 125829120
    s_add_u32 s93, s95, 4
    v_bfe_u32 v2, v61, 4, 6
    v_min_u32 v2, 11, v2
    v_lshlrev_b32 v2, 2, v2
    s_mov_b32 s94, 4194304
cf_kv0:
    buffer_load_dword v3, v2, s[4:7], s92 offen sc1
    s_sub_u32 s94, s94, 1
    s_cbranch_scc1 cf_kv0_go
    s_waitcnt vmcnt(0)
    v_subrev_u32 v3, s93, v3
    v_cmp_lt_u32 vcc, 64, v3
    s_cbranch_vccz cf_kv0_go
    s_sleep 2
    s_branch cf_kv0
cf_kv0_go:
    s_mov_b32 s44, 0x3e0293ee
    s_mov_b32 s45, s44
    s_or_b32 s46, s44, 0x80000000
    s_mov_b32 s47, 128
    s_mov_b32 s60, 0x3f803f80
    s_mov_b32 s61, s60
    s_mov_b32 s62, 0x3e803e80
    s_mov_b32 s63, s62
    s_mov_b32 s28, 0
    s_mov_b32 s14, 67108864
    s_lshl_b32 s24, s12, 14
    s_add_u32 s24, s24, 0
    s_mul_i32 s40, s13, 3072
    s_add_u32 s23, s24, s40
    s_lshl_b32 s20, s12, 7
    s_add_u32 s20, s20, 67174400
    s_add_u32 s21, s20, 65536
    s_add_u32 s38, s20, 4096
    s_add_u32 s39, s21, 4096
    s_lshl_b32 s22, s12, 7
    s_add_u32 s22, s22, 67182592
    s_lshl_b32 s40, s12, 12
    s_add_u32 s25, s40, 79560704
    s_add_u32 s26, s40, 88997888
    s_lshl_b32 s65, s12, 9
    s_add_u32 s65, s65, 90177536
    s_lshl_b32 s40, s13, 5
    s_or_b32 s40, s40, s12
    s_cmp_lt_u32 s40, 24
    s_cselect_b32 s36, 0x1ffffff, 0
    s_mov_b32 s37, 0
    s_lshl_b32 s27, s12, 7
    s_add_u32 s27, s27, 125845504
    s_lshl_b32 s40, s13, 2
    s_add_u32 s27, s27, s40
    s_mov_b32 m0, 111616
    v_lshlrev_b32 v56, 2, v61
    buffer_load_dword v56, s[4:7], s24 offen sc1 lds
    s_add_u32 s24, s24, 524288
    buffer_load_dword v56, s[4:7], s24 offen sc1 lds
    s_add_u32 s24, s24, 524288
    s_add_u32 s15, s14, 4096
    s_add_u32 s16, s14, 8192
    ds_read_b128 v[32:35], v63 offset:57344
    ds_read_b128 v[36:39], v63 offset:61440
    ds_read_b128 v[40:43], v61 offset:0
    ds_read_b128 v[44:47], v61 offset:4096
    ds_read_b128 v[48:51], v61 offset:8192
    ds_read_b128 v[52:55], v61 offset:12288
    s_mov_b32 s29, 1048576
    buffer_load_dwordx4 v[24:27], v61, s[4:7], s14 offen nt
.p2align 6
cf_loop:
    v_mov_b64 v[0:1], 0
    v_mov_b64 v[2:3], 0
    v_mov_b64 v[4:5], 0
    v_mov_b64 v[6:7], 0
    v_mov_b64 v[8:9], 0
    v_mov_b64 v[10:11], 0
    v_mov_b64 v[12:13], 0
    v_mov_b64 v[14:15], 0
    v_mov_b64 v[16:17], 0
    v_mov_b64 v[18:19], 0
cf_loop2:
    v_mov_b64 v[20:21], 0
    v_mov_b64 v[22:23], 0
    v_lshrrev_b32 v56, 2, v61
    v_add_u32 v58, 106496, v56
    s_mov_b32 s29, 1048576
    s_nop 15
    s_nop 3
    buffer_load_dwordx4 v[24:27], v61, s[4:7], s14 offen nt
    s_waitcnt lgkmcnt(0)
cf_chk0:
    s_waitcnt vmcnt(1)
    v_max3_u32 v57, v24, v25, v26
    v_max_u32 v57, v57, v27
    v_cmp_eq_u32 vcc, -1, v57
    ds_write_b128 v62, v[24:27] offset:40960
    s_cbranch_vccnz cf_spin0
    v_smfmac_f32_16x16x64_bf16 v[8:11], v[24:27], v[32:39], v60
    buffer_load_dwordx4 v[28:31], v61, s[4:7], s15 offen nt
    buffer_load_dword v59, v56, s[4:7], s16 offen nt
    v_smfmac_f32_16x16x64_bf16 v[4:7], v[24:27], v[40:47], v60
    ds_read_b128 v[32:35], v61 offset:16384
    v_smfmac_f32_16x16x64_bf16 v[12:15], v[24:27], v[48:55], v60
    ds_read_b128 v[36:39], v61 offset:20480
    s_waitcnt lgkmcnt(2)
    s_barrier
    ds_read_b128 v[48:51], v63 offset:0
    v_smfmac_f32_16x16x64_bf16 v[0:3], v[24:27], a[0:7], v60
    ds_read_b128 v[40:43], v61 offset:24576
    v_smfmac_f32_16x16x64_bf16 v[16:19], v[24:27], a[216:223], v60
    ds_read_b128 v[44:47], v61 offset:28672
    v_smfmac_f32_16x16x64_bf16 v[20:23], v[24:27], a[224:231], v60
    ds_read_b128 v[52:55], v64 offset:0
    s_waitcnt lgkmcnt(3)
    v_smfmac_f32_16x16x64_bf16 v[4:7], v[48:51], v[32:39], v60
    ds_read_b128 v[32:35], v61 offset:32768
    v_smfmac_f32_16x16x64_bf16 v[0:3], v[48:51], a[8:15], v60
    ds_read_b128 v[36:39], v61 offset:36864
    v_smfmac_f32_16x16x64_bf16 v[8:11], v[48:51], a[16:23], v60
    s_add_u32 s18, s14, s31
    s_add_u32 s41, s14, 16384
    s_waitcnt lgkmcnt(3)
    v_smfmac_f32_16x16x64_bf16 v[12:15], v[48:51], v[40:47], v60
    ds_read_b128 v[40:43], v61 offset:40960
    s_waitcnt lgkmcnt(3)
    v_smfmac_f32_16x16x64_bf16 v[0:3], v[52:55], a[24:31], v60
    ds_read_b128 v[44:47], v61 offset:45056
    v_smfmac_f32_16x16x64_bf16 v[8:11], v[52:55], a[32:39], v60
    ds_read_b128 v[48:51], v71 offset:0
    s_waitcnt lgkmcnt(3)
    v_smfmac_f32_16x16x64_bf16 v[4:7], v[52:55], v[32:39], v60
    ds_read_b128 v[32:35], v61 offset:49152
    s_waitcnt vmcnt(0)
    v_max3_u32 v57, v28, v29, v30
    ds_write_b128 v62, v[28:31] offset:45056
    v_max3_u32 v57, v57, v31, v59
    s_waitcnt lgkmcnt(3)
    v_smfmac_f32_16x16x64_bf16 v[12:15], v[52:55], v[40:47], v60
    ds_write_b32 v58, v59
    v_cmp_eq_u32 vcc, -1, v57
    s_waitcnt lgkmcnt(3)
    v_smfmac_f32_16x16x64_bf16 v[0:3], v[48:51], a[40:47], v60
    ds_read_b128 v[36:39], v61 offset:53248
    v_smfmac_f32_16x16x64_bf16 v[8:11], v[48:51], a[48:55], v60
    ds_read_b128 v[40:43], v61 offset:57344
    s_cbranch_vccnz cf_spin1
cf_go1:
    v_smfmac_f32_16x16x64_bf16 v[0:3], v[28:31], a[56:63], v60
    ds_read_b128 v[44:47], v61 offset:61440
    v_smfmac_f32_16x16x64_bf16 v[8:11], v[28:31], a[64:71], v60
    s_and_b32 s41, s41, 65535
    s_add_u32 s41, s41, 67108864
    v_smfmac_f32_16x16x64_bf16 v[4:7], v[28:31], a[136:143], v60
    s_waitcnt lgkmcnt(3)
    s_barrier
    ds_read_b128 v[52:55], v63 offset:4096
    s_waitcnt lgkmcnt(3)
    v_smfmac_f32_16x16x64_bf16 v[4:7], v[48:51], v[32:39], v60
    ds_read_b128 v[56:59], v71 offset:4096
    v_smfmac_f32_16x16x64_bf16 v[12:15], v[28:31], a[144:151], v60
    buffer_load_dwordx4 v[32:35], v61, s[4:7], s23 offen offset:0 sc1
    s_waitcnt lgkmcnt(2)
    v_smfmac_f32_16x16x64_bf16 v[12:15], v[48:51], v[40:47], v60
    ds_read_b128 v[24:27], v65 offset:8192
    v_smfmac_f32_16x16x64_bf16 v[16:19], v[28:31], v[96:103], v60
    ds_read_b128 v[48:51], v64 offset:4096
    v_smfmac_f32_16x16x64_bf16 v[20:23], v[28:31], v[104:111], v60
    buffer_load_dwordx4 v[36:39], v61, s[4:7], s23 offen offset:1024 sc1
    s_waitcnt lgkmcnt(3)
    v_smfmac_f32_16x16x64_bf16 v[0:3], v[52:55], a[72:79], v60
    v_lshlrev_b32 v28, 2, v61
    v_smfmac_f32_16x16x64_bf16 v[4:7], v[52:55], a[152:159], v60
    s_add_u32 s17, s41, s31
    s_and_b32 s30, s28, 1
    s_waitcnt lgkmcnt(2)
    v_smfmac_f32_16x16x64_bf16 v[0:3], v[56:59], a[104:111], v60
    buffer_load_dwordx4 v[40:43], v61, s[4:7], s23 offen offset:2048 sc1
    v_smfmac_f32_16x16x64_bf16 v[4:7], v[56:59], a[184:191], v60
    s_waitcnt lgkmcnt(1)
    v_smfmac_f32_16x16x64_bf16 v[0:3], v[24:27], a[120:127], v60
    v_smfmac_f32_16x16x64_bf16 v[4:7], v[24:27], a[200:207], v60
    buffer_load_dwordx4 v[44:47], v61, s[4:7], s23 offen offset:3072 sc1
    s_waitcnt lgkmcnt(0)
    v_smfmac_f32_16x16x64_bf16 v[0:3], v[48:51], a[88:95], v60
    v_smfmac_f32_16x16x64_bf16 v[4:7], v[48:51], a[168:175], v60
    s_barrier
    v_smfmac_f32_16x16x64_bf16 v[8:11], v[52:55], a[80:87], v60
    buffer_load_dword v28, s[4:7], s24 offen sc1 lds
    v_smfmac_f32_16x16x64_bf16 v[12:15], v[52:55], a[160:167], v60
    ds_read_b128 v[28:31], v65 offset:9216
    v_smfmac_f32_16x16x64_bf16 v[8:11], v[56:59], a[112:119], v60
    v_cvt_pk_bf16_f32 v0, v0, v1
    v_smfmac_f32_16x16x64_bf16 v[12:15], v[56:59], a[192:199], v60
    v_cvt_pk_bf16_f32 v1, v2, v3
    v_smfmac_f32_16x16x64_bf16 v[8:11], v[24:27], a[128:135], v60
    v_cvt_pk_bf16_f32 v2, v4, v5
    v_smfmac_f32_16x16x64_bf16 v[8:11], v[48:51], a[96:103], v60
    v_cvt_pk_bf16_f32 v3, v6, v7
    v_smfmac_f32_16x16x64_bf16 v[12:15], v[24:27], a[208:215], v60
    s_cmp_eq_u32 s28, 63
    v_smfmac_f32_16x16x64_bf16 v[12:15], v[48:51], a[176:183], v60
    s_waitcnt lgkmcnt(0)
    v_cvt_pk_bf16_f32 v8, v8, v9
    v_mfma_f32_16x16x32_bf16 v[4:7], v[0:3], v[28:31], 0
    v_cvt_pk_bf16_f32 v9, v10, v11
    s_waitcnt vmcnt(3)
    s_nop 1
    v_cvt_pk_bf16_f32 v10, v12, v13
    v_cvt_pk_bf16_f32 v11, v14, v15
    s_nop 1
    v_mfma_f32_16x16x32_bf16 v[12:15], v[8:11], v[28:31], 0
    v_cvt_pk_bf16_f32 v0, v4, v5
    v_cvt_pk_bf16_f32 v1, v6, v7
    v_smfmac_f32_16x16x64_bf16 v[16:19], v[24:27], v[160:167], v60
    s_mov_b64 exec, s[36:37]
    ds_read_b128 v[28:31], v69
    s_mov_b64 exec, -1
    s_nop 0
    v_cvt_pk_bf16_f32 v2, v12, v13
    v_cvt_pk_bf16_f32 v3, v14, v15
    s_cbranch_scc1 cf_last
    s_nop 0
    v_mfma_f32_16x16x32_bf16 v[8:11], v[0:3], v[0:3], 0
    v_mfma_f32_16x16x32_bf16 v[4:7], v[36:39], v[0:3], 0
    ds_read_b128 v[36:39], v64 offset:0
    v_mfma_f32_16x16x32_bf16 v[12:15], v[32:35], v[0:3], 0
    ds_read_b128 v[32:35], v63 offset:0
    v_mov_b32_dpp v8, v10 row_ror:8 row_mask:0xf bank_mask:0xc
    v_mov_b32_dpp v9, v11 row_ror:8 row_mask:0xf bank_mask:0xc
    ds_write_b64 v70, v[8:9]
    s_nop 3
    v_mov_b32_dpp v12, v4 row_ror:8 row_mask:0xf bank_mask:0xc
    v_mov_b32_dpp v13, v5 row_ror:8 row_mask:0xf bank_mask:0xc
    v_mov_b32_dpp v14, v6 row_ror:8 row_mask:0xf bank_mask:0xc
    v_mov_b32_dpp v15, v7 row_ror:8 row_mask:0xf bank_mask:0xc
    ds_write_b128 v62, v[12:15] offset:55296
    v_smfmac_f32_16x16x64_bf16 v[20:23], v[24:27], v[168:175], v60
    v_smfmac_f32_16x16x64_bf16 v[16:19], v[56:59], v[144:151], v60
    v_or_b32 v27, 512, v65
    v_smfmac_f32_16x16x64_bf16 v[20:23], v[56:59], v[152:159], v60
    s_waitcnt vmcnt(1)
    s_waitcnt lgkmcnt(4)
    s_mov_b64 exec, s[36:37]
    buffer_store_dwordx4 v[28:31], v61, s[4:7], s65 offen sc1
    s_mov_b64 exec, -1
    v_smfmac_f32_16x16x64_bf16 v[16:19], v[48:51], v[128:135], v60
    s_waitcnt lgkmcnt(0)
    s_barrier
    ds_read_b128 v[4:7], v63 offset:14336
    ds_read_b128 v[8:11], v64 offset:14336
    ds_read_b128 v[0:3], v71 offset:14336
    v_smfmac_f32_16x16x64_bf16 v[20:23], v[48:51], v[136:143], v60
    ds_read_b128 v[56:59], v27 offset:10752
    v_smfmac_f32_16x16x64_bf16 v[16:19], v[52:55], v[112:119], v60
    ds_read_b128 v[24:27], v27 offset:11264
    v_smfmac_f32_16x16x64_bf16 v[20:23], v[52:55], v[120:127], v60
    ds_read_b128 v[28:31], v71 offset:0
    v_smfmac_f32_16x16x64_bf16 v[16:19], v[32:35], a[232:239], v60
    v_smfmac_f32_16x16x64_bf16 v[20:23], v[32:35], a[240:247], v60
    s_waitcnt lgkmcnt(5)
    v_add_f32 v12, v12, v4
    v_smfmac_f32_16x16x64_bf16 v[16:19], v[36:39], a[248:255], v60
    v_add_f32 v13, v13, v5
    v_smfmac_f32_16x16x64_bf16 v[20:23], v[36:39], v[72:79], v60
    v_add_f32 v14, v14, v6
    s_waitcnt lgkmcnt(0)
    v_smfmac_f32_16x16x64_bf16 v[16:19], v[28:31], v[80:87], v60
    v_add_f32 v15, v15, v7
    v_smfmac_f32_16x16x64_bf16 v[20:23], v[28:31], v[88:95], v60
    v_add_f32 v8, v8, v0
    v_add_f32 v9, v9, v1
    v_add_f32 v10, v10, v2
    v_add_f32 v11, v11, v3
    v_pk_add_f32 v[56:57], v[56:57], v[58:59]
    v_pk_add_f32 v[24:25], v[24:25], v[26:27]
    v_pk_add_f32 v[12:13], v[12:13], v[8:9]
    v_pk_add_f32 v[14:15], v[14:15], v[10:11]
    v_pk_add_f32 v[56:57], v[56:57], v[24:25]
    v_max3_f32 v4, v12, v13, v14
    v_max3_f32 v5, v15, v56, v57
    v_max_f32 v4, v4, v5
    v_cvt_pk_bf16_f32 v16, v16, v17
    v_cvt_pk_bf16_f32 v17, v18, v19
    v_max_f32_dpp v4, v4, v4 row_ror:8 row_mask:0xf bank_mask:0xf
    v_mov_b32 v5, v4
    v_cvt_pk_bf16_f32 v18, v20, v21
    v_cvt_pk_bf16_f32 v19, v22, v23
    v_permlane32_swap_b32 v4, v5
    v_max_f32 v4, v4, v5
    v_mov_b32 v5, v4
    v_mov_b64 v[24:25], s[62:63]
    v_mov_b64 v[26:27], s[60:61]
    v_permlane16_swap_b32 v4, v5
    v_max_f32 v4, v4, v5
    v_mul_f32 v4, s46, v4
    v_pk_fma_f32 v[12:13], v[12:13], s[44:45], v[4:5] op_sel_hi:[1,1,0]
    v_pk_fma_f32 v[14:15], v[14:15], s[44:45], v[4:5] op_sel_hi:[1,1,0]
    v_pk_fma_f32 v[56:57], v[56:57], s[44:45], v[4:5] op_sel_hi:[1,1,0]
    v_exp_f32 v12, v12
    v_exp_f32 v13, v13
    v_exp_f32 v14, v14
    v_cvt_pk_bf16_f32 v8, v12, v13
    v_exp_f32 v15, v15
    v_exp_f32 v56, v56
    v_cvt_pk_bf16_f32 v9, v14, v15
    v_mov_b32_dpp v10, v8 row_ror:8 row_mask:0xf bank_mask:0xf
    v_exp_f32 v57, v57
    v_mov_b32_dpp v11, v9 row_ror:8 row_mask:0xf bank_mask:0xf
    v_cvt_pk_bf16_f32 v6, v56, v57
    s_nop 0
    v_mfma_f32_16x16x32_bf16 v[56:59], v[40:43], v[8:11], 0
    ds_read_b128 v[48:51], v62 offset:8192
    v_mov_b32_dpp v7, v6 row_ror:8 row_mask:0xf bank_mask:0xf
    v_mfma_f32_16x16x32_bf16 v[20:23], v[44:47], v[8:11], 0
    ds_read_b128 v[52:55], v62 offset:12288
    v_bfe_u32 v4, v61, 7, 1
    v_mfma_f32_16x16x32_bf16 v[28:31], v[24:27], v[6:9], 0
    v_lshl_add_u32 v4, v4, 3, v68
    v_mov_b64 v[32:33], 0
    v_mfma_f32_16x16x16_bf16 v[56:59], v[16:17], v[6:7], v[56:59]
    v_mov_b64 v[34:35], 0
    v_mov_b64 v[36:37], 0
    v_mfma_f32_16x16x16_bf16 v[20:23], v[18:19], v[6:7], v[20:23]
    v_add_f32_dpp v28, v28, v28 row_ror:8 row_mask:0xf bank_mask:0xf
    v_rcp_f32 v28, v28
    v_mov_b64 v[38:39], 0
    s_nop 0
    v_mul_f32 v56, v56, v28
    v_mul_f32 v57, v57, v28
    v_mul_f32 v58, v58, v28
    v_mul_f32 v59, v59, v28
    v_mul_f32_dpp v56, v20, v28 row_ror:8 row_mask:0xf bank_mask:0xc
    v_mul_f32_dpp v57, v21, v28 row_ror:8 row_mask:0xf bank_mask:0xc
    v_mul_f32_dpp v58, v22, v28 row_ror:8 row_mask:0xf bank_mask:0xc
    v_mul_f32_dpp v59, v23, v28 row_ror:8 row_mask:0xf bank_mask:0xc
    v_cvt_pk_bf16_f32 v56, v56, v57
    v_cvt_pk_bf16_f32 v57, v58, v59
    ds_write_b64 v4, v[56:57]
    ds_read_b128 v[0:3], v68
    ds_read_b128 v[40:43], v62 offset:16384
    ds_read_b128 v[44:47], v62 offset:20480
    v_xor_b32 v24, 512, v68
    v_xor_b32 v28, 1024, v68
    v_xor_b32 v58, 1536, v68
    v_mov_b64 v[8:9], 0
    v_mov_b64 v[10:11], 0
    v_mov_b64 v[12:13], 0
    v_mov_b64 v[14:15], 0
    s_waitcnt lgkmcnt(3)
    s_barrier
    ds_read_b128 v[24:27], v24
    ds_read_b128 v[28:31], v28
    s_waitcnt lgkmcnt(4)
    v_smfmac_f32_16x16x64_bf16 v[32:35], v[0:3], v[176:183], v60
    ds_read_b128 v[56:59], v58
    v_smfmac_f32_16x16x64_bf16 v[36:39], v[0:3], v[208:215], v60
    v_mov_b64 v[20:21], 0
    v_smfmac_f32_16x16x64_bf16 v[8:11], v[0:3], v[48:55], v60
    ds_read_b128 v[48:51], v63 offset:40960
    v_mov_b64 v[22:23], 0
    s_waitcnt lgkmcnt(3)
    v_smfmac_f32_16x16x64_bf16 v[32:35], v[24:27], v[184:191], v60
    ds_read_b128 v[52:55], v63 offset:45056
    s_waitcnt lgkmcnt(3)
    v_smfmac_f32_16x16x64_bf16 v[32:35], v[28:31], v[192:199], v60
    s_waitcnt lgkmcnt(2)
    v_smfmac_f32_16x16x64_bf16 v[32:35], v[56:59], v[200:207], v60
    v_smfmac_f32_16x16x64_bf16 v[36:39], v[24:27], v[216:223], v60
    v_smfmac_f32_16x16x64_bf16 v[36:39], v[28:31], v[224:231], v60
    v_cvt_pk_bf16_f32 v32, v32, v33
    v_smfmac_f32_16x16x64_bf16 v[36:39], v[56:59], v[232:239], v60
    v_cvt_pk_bf16_f32 v33, v34, v35
    v_smfmac_f32_16x16x64_bf16 v[12:15], v[0:3], v[40:47], v60
    ds_read_b128 v[40:43], v63 offset:49152
    v_and_or_b32 v32, v32, -2, s30
    s_waitcnt lgkmcnt(1)
    v_smfmac_f32_16x16x64_bf16 v[20:23], v[0:3], v[48:55], v60
    buffer_store_dwordx2 v[32:33], v66, s[4:7], s20 offen
    v_cvt_pk_bf16_f32 v36, v36, v37
    ds_read_b128 v[44:47], v63 offset:53248
    v_smfmac_f32_16x16x64_bf16 v[8:11], v[24:27], v[240:247], v60
    ds_read_b128 v[48:51], v62 offset:24576
    v_cvt_pk_bf16_f32 v37, v38, v39
    v_and_or_b32 v36, v36, -2, s30
    v_smfmac_f32_16x16x64_bf16 v[12:15], v[24:27], v[248:255], v60
    buffer_store_dwordx2 v[36:37], v66, s[4:7], s21 offen
    ds_read_b128 v[52:55], v62 offset:28672
    ds_read_b128 v[0:3], v63 offset:24576
    ds_read_b128 v[4:7], v63 offset:28672
    s_waitcnt lgkmcnt(4)
    v_smfmac_f32_16x16x64_bf16 v[20:23], v[28:31], v[40:47], v60
    ds_read_b128 v[32:35], v63 offset:32768
    ds_read_b128 v[36:39], v63 offset:36864
    ds_read_b128 v[40:43], v62 offset:32768
    ds_read_b128 v[44:47], v62 offset:36864
    s_waitcnt lgkmcnt(6)
    v_smfmac_f32_16x16x64_bf16 v[8:11], v[28:31], v[48:55], v60
    s_nop 1
    v_cvt_pk_bf16_f32 v20, v20, v21
    v_cvt_pk_bf16_f32 v21, v22, v23
    s_waitcnt lgkmcnt(4)
    v_smfmac_f32_16x16x64_bf16 v[8:11], v[56:59], v[0:7], v60
    v_and_or_b32 v20, v20, -2, s30
    buffer_store_dwordx2 v[20:21], v67, s[4:7], s22 offen
    s_waitcnt lgkmcnt(2)
    v_smfmac_f32_16x16x64_bf16 v[12:15], v[56:59], v[32:39], v60
    s_cmp_lg_u32 s13, 2
    s_waitcnt lgkmcnt(0)
    v_smfmac_f32_16x16x64_bf16 v[12:15], v[28:31], v[40:47], v60
    v_cvt_pk_bf16_f32 v8, v8, v9
    v_cvt_pk_bf16_f32 v9, v10, v11
    v_and_or_b32 v8, v8, -2, s30
    buffer_store_dwordx2 v[8:9], v66, s[4:7], s38 offen
    s_nop 3
    v_cvt_pk_bf16_f32 v12, v12, v13
    v_cvt_pk_bf16_f32 v13, v14, v15
    v_and_or_b32 v12, v12, -2, s30
    buffer_store_dwordx2 v[12:13], v66, s[4:7], s39 offen
    s_cbranch_scc1 cf_w013
    s_nop 15
    s_nop 15
    s_nop 15
    s_nop 6
    buffer_load_dwordx4 v[40:43], v65, s[4:7], s19 offen offset:0 nt
    buffer_load_dwordx4 v[44:47], v65, s[4:7], s19 offen offset:1024 nt
    buffer_load_dwordx4 v[48:51], v65, s[4:7], s19 offen offset:2048 nt
    buffer_load_dwordx4 v[52:55], v65, s[4:7], s19 offen offset:3072 nt
    ds_read_b128 v[56:59], v65 offset:10240
    s_add_u32 s28, s28, 1
    s_mov_b32 s14, s41
    s_add_u32 s23, s23, 524288
    s_add_u32 s24, s24, 524288
    s_add_u32 s15, s14, 4096
    s_add_u32 s16, s14, 8192
    v_mov_b32 v21, -1
    s_add_u32 s65, s65, 12288
    s_mov_b32 s40, 1
    v_mov_b64 v[0:1], 0
    v_mov_b64 v[2:3], 0
    v_mov_b64 v[4:5], 0
    v_mov_b64 v[6:7], 0
    v_mov_b64 v[8:9], 0
    v_mov_b64 v[10:11], 0
    v_mov_b64 v[12:13], 0
    v_mov_b64 v[14:15], 0
    v_mov_b64 v[16:17], 0
    v_mov_b64 v[18:19], 0
cf_chkF:
    v_mov_b32 v20, 0
    s_waitcnt vmcnt(3)
    s_waitcnt lgkmcnt(0)
    v_mfma_f32_16x16x32_bf16 v[28:31], v[40:43], v[56:59], 0
    v_bitop3_b32 v20, v20, v40, s30 bitop3:0xf6
    v_bitop3_b32 v20, v20, v42, s30 bitop3:0xf6
    s_waitcnt vmcnt(2)
    v_mfma_f32_16x16x32_bf16 v[28:31], v[44:47], v[56:59], v[28:31]
    v_bitop3_b32 v20, v20, v44, s30 bitop3:0xf6
    v_bitop3_b32 v20, v20, v46, s30 bitop3:0xf6
    s_waitcnt vmcnt(1)
    v_mfma_f32_16x16x32_bf16 v[28:31], v[48:51], v[56:59], v[28:31]
    v_bitop3_b32 v20, v20, v48, s30 bitop3:0xf6
    v_bitop3_b32 v20, v20, v50, s30 bitop3:0xf6
    s_waitcnt vmcnt(0)
    v_mfma_f32_16x16x32_bf16 v[28:31], v[52:55], v[56:59], v[28:31]
    v_bitop3_b32 v20, v20, v52, s30 bitop3:0xf6
    v_bitop3_b32 v20, v20, v54, s30 bitop3:0xf6
    v_and_b32 v20, s40, v20
    v_cmp_ne_u32 vcc, 0, v20
    s_cbranch_vccnz cf_spinF
    v_permlane32_swap_b32 v28, v30
    v_permlane32_swap_b32 v29, v31
    v_add_f32 v28, v28, v30
    v_add_f32 v30, v29, v31
    v_cvt_pk_bf16_f32 v28, v28, v30
    s_mov_b64 exec, s[32:33]
    buffer_store_dword v28, v69, s[4:7], s17 offen
    buffer_store_dword v21, v69, s[4:7], s18 offen
    s_mov_b64 exec, -1
    ds_read_b128 v[32:35], v63 offset:57344
    ds_read_b128 v[36:39], v63 offset:61440
    ds_read_b128 v[40:43], v61 offset:0
    ds_read_b128 v[44:47], v61 offset:4096
    ds_read_b128 v[48:51], v61 offset:8192
    ds_read_b128 v[52:55], v61 offset:12288
    s_nop 14
    buffer_load_dwordx4 v[24:27], v61, s[4:7], s14 offen nt
    s_branch cf_loop2
cf_w013:
    ds_read_b128 v[56:59], v65 offset:10240
    ds_read_b128 v[32:35], v63 offset:57344
    ds_read_b128 v[36:39], v63 offset:61440
    ds_read_b128 v[40:43], v61 offset:0
    ds_read_b128 v[44:47], v61 offset:4096
    ds_read_b128 v[48:51], v61 offset:8192
    ds_read_b128 v[52:55], v61 offset:12288
    s_add_u32 s28, s28, 1
    s_mov_b32 s14, s41
    s_add_u32 s23, s23, 524288
    s_add_u32 s24, s24, 524288
    s_add_u32 s15, s14, 4096
    s_add_u32 s16, s14, 8192
    v_mov_b32 v21, -1
    s_add_u32 s65, s65, 12288
    s_mov_b32 s40, 1
    s_cmp_eq_u32 s64, 0
    s_cbranch_scc1 cf_w0
    s_nop 15
    s_nop 15
    s_nop 12
    buffer_load_dwordx4 v[0:3], v65, s[4:7], s19 offen offset:0 nt
    buffer_load_dwordx4 v[4:7], v65, s[4:7], s19 offen offset:1024 nt
    buffer_load_dwordx4 v[8:11], v65, s[4:7], s19 offen offset:2048 nt
    buffer_load_dwordx4 v[12:15], v65, s[4:7], s19 offen offset:3072 nt
cf_chkG:
    v_mov_b32 v20, 0
    s_waitcnt vmcnt(3)
    s_waitcnt lgkmcnt(6)
    v_mfma_f32_16x16x32_bf16 v[28:31], v[0:3], v[56:59], 0
    v_bitop3_b32 v20, v20, v0, s30 bitop3:0xf6
    v_bitop3_b32 v20, v20, v2, s30 bitop3:0xf6
    s_waitcnt vmcnt(2)
    v_mfma_f32_16x16x32_bf16 v[28:31], v[4:7], v[56:59], v[28:31]
    v_bitop3_b32 v20, v20, v4, s30 bitop3:0xf6
    v_bitop3_b32 v20, v20, v6, s30 bitop3:0xf6
    s_waitcnt vmcnt(1)
    v_mfma_f32_16x16x32_bf16 v[28:31], v[8:11], v[56:59], v[28:31]
    v_bitop3_b32 v20, v20, v8, s30 bitop3:0xf6
    v_bitop3_b32 v20, v20, v10, s30 bitop3:0xf6
    s_waitcnt vmcnt(0)
    v_mfma_f32_16x16x32_bf16 v[28:31], v[12:15], v[56:59], v[28:31]
    v_bitop3_b32 v20, v20, v12, s30 bitop3:0xf6
    v_bitop3_b32 v20, v20, v14, s30 bitop3:0xf6
    v_and_b32 v20, s40, v20
    v_cmp_ne_u32 vcc, 0, v20
    s_cbranch_vccnz cf_spinG
    v_permlane32_swap_b32 v28, v30
    v_permlane32_swap_b32 v29, v31
    v_add_f32 v28, v28, v30
    v_add_f32 v30, v29, v31
    s_cmp_eq_u32 s13, 3
    s_cbranch_scc1 cf_w3
    v_mov_b32 v29, v28
    v_mov_b32 v31, v30
    s_nop 0
    v_permlane16_swap_b32 v28, v29
    v_permlane16_swap_b32 v30, v31
    v_add_f32 v28, v28, v29
    v_add_f32 v30, v30, v31
cf_w3:
    v_cvt_pk_bf16_f32 v28, v28, v30
    s_mov_b64 exec, s[32:33]
    buffer_store_dword v28, v69, s[4:7], s17 offen
    buffer_store_dword v21, v69, s[4:7], s18 offen
    s_mov_b64 exec, -1
    buffer_load_dwordx4 v[24:27], v61, s[4:7], s14 offen nt
    s_branch cf_loop
cf_w0:
    v_mov_b64 v[0:1], 0
    v_mov_b64 v[2:3], 0
    v_mov_b64 v[4:5], 0
    v_mov_b64 v[6:7], 0
    v_mov_b64 v[8:9], 0
    v_mov_b64 v[10:11], 0
    v_mov_b64 v[12:13], 0
    v_mov_b64 v[14:15], 0
    v_mov_b64 v[16:17], 0
    v_mov_b64 v[18:19], 0
    s_cmp_lg_u32 s28, 22
    s_cbranch_scc1 cf_nokv
    s_lshr_b32 s92, s12, 1
    s_lshl_b32 s92, s92, 8
    s_add_u32 s92, s92, 125829120
    s_add_u32 s93, s95, 63
    v_bfe_u32 v28, v61, 4, 6
    v_min_u32 v28, 11, v28
    v_lshlrev_b32 v28, 2, v28
    s_mov_b32 s94, 4194304
cf_kv1:
    buffer_load_dword v29, v28, s[4:7], s92 offen sc1
    s_sub_u32 s94, s94, 1
    s_cbranch_scc1 cf_kv1_go
    s_waitcnt vmcnt(0)
    v_subrev_u32 v29, s93, v29
    v_cmp_lt_u32 vcc, 64, v29
    s_cbranch_vccz cf_kv1_go
    s_sleep 2
    s_branch cf_kv1
cf_kv1_go:
cf_nokv:
    s_nop 15
    s_nop 15
    s_nop 15
    s_nop 15
    s_nop 15
    s_nop 15
    s_nop 15
    s_nop 7
    buffer_load_dwordx4 v[24:27], v61, s[4:7], s14 offen nt
    s_branch cf_loop2
cf_spinF:
    buffer_load_dwordx4 v[40:43], v65, s[4:7], s19 offen offset:0 nt
    buffer_load_dwordx4 v[44:47], v65, s[4:7], s19 offen offset:1024 nt
    buffer_load_dwordx4 v[48:51], v65, s[4:7], s19 offen offset:2048 nt
    buffer_load_dwordx4 v[52:55], v65, s[4:7], s19 offen offset:3072 nt
    s_sub_u32 s29, s29, 1
    s_cmp_lt_i32 s29, 0
    s_cselect_b32 s40, 0, 1
    s_branch cf_chkF
cf_spinG:
    buffer_load_dwordx4 v[0:3], v65, s[4:7], s19 offen offset:0 nt
    buffer_load_dwordx4 v[4:7], v65, s[4:7], s19 offen offset:1024 nt
    buffer_load_dwordx4 v[8:11], v65, s[4:7], s19 offen offset:2048 nt
    buffer_load_dwordx4 v[12:15], v65, s[4:7], s19 offen offset:3072 nt
    s_sub_u32 s29, s29, 1
    s_cmp_lt_i32 s29, 0
    s_cselect_b32 s40, 0, 1
    s_branch cf_chkG
cf_spin0:
    buffer_load_dwordx4 v[24:27], v61, s[4:7], s14 offen nt
    s_sub_u32 s29, s29, 1
    s_cmp_lt_i32 s29, 0
    s_cbranch_scc0 cf_chk0
    s_waitcnt vmcnt(0)
    v_min_u32 v24, -2, v24
    v_min_u32 v25, -2, v25
    v_min_u32 v26, -2, v26
    v_min_u32 v27, -2, v27
    s_branch cf_chk0
cf_spin1:
    buffer_load_dwordx4 v[28:31], v61, s[4:7], s15 offen nt
    buffer_load_dword v59, v56, s[4:7], s16 offen nt
    s_sub_u32 s29, s29, 1
    s_cmp_lt_i32 s29, 0
    s_waitcnt vmcnt(0)
    v_max3_u32 v57, v28, v29, v30
    v_max3_u32 v57, v57, v31, v59
    v_cmp_eq_u32 vcc, -1, v57
    ds_write_b128 v62, v[28:31] offset:45056
    ds_write_b32 v58, v59
    s_waitcnt lgkmcnt(0)
    s_cbranch_scc1 cf_go1
    s_cbranch_vccnz cf_spin1
    s_branch cf_go1
cf_last:
    s_nop 1
    s_waitcnt vmcnt(0) lgkmcnt(0)
    s_mov_b64 exec, s[36:37]
    ds_read_b128 v[40:43], v69
    s_mov_b64 exec, -1
    s_mov_b64 exec, s[34:35]
    buffer_store_dwordx4 v[0:3], v61, s[4:7], s25 offen sc1
    s_mov_b64 exec, -1
    ds_read_b128 v[32:35], v63 offset:0
    ds_read_b128 v[36:39], v64 offset:0
    ds_read_b128 v[28:31], v71 offset:0
    s_waitcnt lgkmcnt(3)
    s_mov_b64 exec, s[36:37]
    buffer_store_dwordx4 v[40:43], v61, s[4:7], s65 offen sc1
    s_mov_b64 exec, -1
    v_smfmac_f32_16x16x64_bf16 v[20:23], v[24:27], v[168:175], v60
    v_smfmac_f32_16x16x64_bf16 v[16:19], v[56:59], v[144:151], v60
    v_smfmac_f32_16x16x64_bf16 v[20:23], v[56:59], v[152:159], v60
    v_smfmac_f32_16x16x64_bf16 v[16:19], v[48:51], v[128:135], v60
    v_smfmac_f32_16x16x64_bf16 v[20:23], v[48:51], v[136:143], v60
    v_smfmac_f32_16x16x64_bf16 v[16:19], v[52:55], v[112:119], v60
    v_smfmac_f32_16x16x64_bf16 v[20:23], v[52:55], v[120:127], v60
    s_waitcnt lgkmcnt(2)
    v_smfmac_f32_16x16x64_bf16 v[16:19], v[32:35], a[232:239], v60
    v_smfmac_f32_16x16x64_bf16 v[20:23], v[32:35], a[240:247], v60
    s_waitcnt lgkmcnt(1)
    v_smfmac_f32_16x16x64_bf16 v[16:19], v[36:39], a[248:255], v60
    v_smfmac_f32_16x16x64_bf16 v[20:23], v[36:39], v[72:79], v60
    s_waitcnt lgkmcnt(0)
    v_smfmac_f32_16x16x64_bf16 v[16:19], v[28:31], v[80:87], v60
    v_smfmac_f32_16x16x64_bf16 v[20:23], v[28:31], v[88:95], v60
    s_nop 3
    v_cvt_pk_bf16_f32 v16, v16, v17
    v_cvt_pk_bf16_f32 v17, v18, v19
    s_nop 1
    v_cvt_pk_bf16_f32 v18, v20, v21
    v_cvt_pk_bf16_f32 v19, v22, v23
    buffer_store_dwordx4 v[16:19], v61, s[4:7], s26 offen sc1
    v_mov_b32 v32, s95
    s_waitcnt vmcnt(0)
    s_mov_b64 exec, 1
    buffer_store_dword v32, off, s[4:7], s27 sc1
    s_mov_b64 exec, -1
    s_endpgm
L_chain_safe:
    s_load_dwordx8 s[48:55], s[0:1], 8
    s_load_dwordx2 s[56:57], s[0:1], 40
    s_waitcnt lgkmcnt(0)
    v_lshrrev_b32 v24, 6, v0
    s_nop 0
    v_readfirstlane_b32 s13, v24
    v_lshlrev_b32 v61, 4, v0
    v_add_u32 v62, 57344, v61
    v_xor_b32 v63, 1024, v61
    v_add_u32 v63, 98304, v63
    v_xor_b32 v64, 2048, v61
    v_add_u32 v64, 98304, v64
    v_and_b32 v65, 1023, v61
    v_add_u32 v65, 98304, v65
    v_and_b32 v26, 15, v0
    v_bfe_u32 v27, v0, 4, 2
    v_mov_b32 v60, 0x4444
    v_mov_b32 v25, 0xeeee
    v_cmp_lt_u32 vcc, 7, v26
    s_nop 1
    v_cndmask_b32 v60, v60, v25, vcc
    v_and_b32 v67, 12, v26
    v_lshlrev_b32 v67, 3, v67
    v_and_b32 v25, 1, v26
    v_lshl_add_u32 v67, v25, 4, v67
    v_bfe_u32 v25, v26, 1, 1
    v_lshl_add_u32 v67, v25, 3, v67
    v_lshl_add_u32 v66, v27, 14, v67
    v_lshl_add_u32 v66, v24, 17, v66
    v_and_b32 v67, 63, v67
    v_lshrrev_b32 v25, 1, v24
    v_lshl_add_u32 v67, v25, 18, v67
    v_lshl_add_u32 v67, v27, 16, v67
    v_lshrrev_b32 v25, 3, v26
    v_lshl_add_u32 v67, v25, 15, v67
    v_and_b32 v25, 1, v24
    v_lshl_add_u32 v67, v25, 6, v67
    v_and_b32 v25, 31, v0
    v_lshlrev_b32 v70, 4, v25
    v_lshlrev_b32 v28, 3, v25
    v_lshl_add_u32 v28, v24, 8, v28
    v_add_u32 v28, 110592, v28
    v_lshrrev_b32 v25, 1, v24
    v_lshl_add_u32 v70, v25, 9, v70
    v_and_b32 v25, 1, v24
    v_lshl_add_u32 v70, v25, 3, v70
    v_add_u32 v70, 109568, v70
    v_cmp_gt_u32 vcc, 2, v27
    s_nop 1
    v_cndmask_b32 v70, v70, v28, vcc
    v_xor_b32 v71, 2048, v63
    v_lshrrev_b32 v68, 4, v0
    v_lshlrev_b32 v68, 7, v68
    v_and_b32 v25, 7, v26
    v_lshl_add_u32 v68, v25, 4, v68
    v_add_u32 v68, 116736, v68
    v_and_b32 v25, 1, v27
    v_lshlrev_b32 v69, 7, v25
    v_lshrrev_b32 v25, 1, v27
    v_lshl_add_u32 v69, v25, 3, v69
    v_and_b32 v25, 3, v26
    v_lshl_add_u32 v69, v25, 4, v69
    v_bfe_u32 v25, v26, 2, 1
    v_lshl_add_u32 v69, v25, 2, v69
    s_mov_b32 s32, 0x00ff00ff
    s_mov_b32 s33, 0x00ff00ff
    s_not_b64 s[34:35], s[32:33]
    s_lshr_b32 s31, s12, 1
    s_lshl_b32 s31, s31, 8
    s_and_b32 s40, s12, 1
    s_lshl_b32 s40, s40, 6
    s_add_u32 s31, s31, s40
    s_and_b32 s40, s13, 1
    s_lshl_b32 s40, s40, 12
    s_add_u32 s31, s31, s40
    s_lshl_b32 s19, s12, 14
    s_add_u32 s19, s19, 68124672
    s_add_u32 s41, s19, 8192
    s_add_u32 s19, s19, s40
    s_and_b32 s40, s12, 1
    s_lshl_b32 s40, s40, 2
    s_or_b32 s40, s40, s13
    s_cmp_eq_u32 s40, 5
    s_cselect_b32 s64, 0, s13
    s_cmp_lg_u32 s13, 1
    s_cbranch_scc1 cs_notx
    s_mov_b32 s32, 0xff
    s_mov_b32 s33, 0xff
    s_mov_b32 s19, s41
    s_lshr_b32 s31, s12, 3
    s_lshl_b32 s31, s31, 8
    s_and_b32 s40, s12, 2
    s_lshl_b32 s40, s40, 6
    s_add_u32 s31, s31, s40
    s_and_b32 s40, s12, 4
    s_lshl_b32 s40, s40, 4
    s_add_u32 s31, s31, s40
    s_add_u32 s31, s31, 8192
cs_notx:
    s_cmp_lg_u32 s13, 0
    s_cbranch_scc1 cs_notp
    s_min_u32 s40, s12, 23
    s_mul_i32 s40, s40, 384
    s_add_u32 s40, s40, 98304
    v_add_u32 v69, s40, v61
    v_mov_b32 v25, 118784
    v_cmp_lt_u32 vcc, 23, v0
    s_nop 1
    v_cndmask_b32 v69, v69, v25, vcc
cs_notp:
    s_nop 1
    v_mov_b32 v28, 1
    v_mov_b32 v29, 1
    v_mov_b32 v30, 1
    v_mov_b32 v31, 1
    s_lshl_b32 s40, s12, 14
    s_add_u32 s40, s40, 68222976
    s_add_u32 s41, s40, 0
    buffer_store_dwordx4 v[28:31], v61, s[4:7], s41 offen sc1
    s_add_u32 s41, s40, 4096
    buffer_store_dwordx4 v[28:31], v61, s[4:7], s41 offen sc1
    s_add_u32 s41, s40, 8192
    buffer_store_dwordx4 v[28:31], v61, s[4:7], s41 offen sc1
    s_cmp_eq_u32 s64, 0
    s_cbranch_scc1 cs_init_done
    s_mov_b64 s[8:9], s[48:49]
    s_mov_b32 s10, 9216
    s_mov_b32 s11, 0x20000
    v_add_u32 v24, s31, v69
    v_bfe_u32 v25, v24, 4, 3
    v_mul_u32_u24 v25, 1152, v25
    v_lshrrev_b32 v26, 7, v24
    v_lshl_add_u32 v25, v26, 4, v25
    v_and_b32 v26, 15, v24
    v_add_u32 v25, v25, v26
    s_mov_b64 exec, s[32:33]
    buffer_load_dword v26, v25, s[8:11], 0 offen
    v_mov_b32 v27, -1
    s_add_u32 s40, s31, 68157440
    s_add_u32 s41, s40, 16384
    buffer_store_dword v27, v69, s[4:7], s41 offen sc1
    s_add_u32 s41, s40, 32768
    buffer_store_dword v27, v69, s[4:7], s41 offen sc1
    s_add_u32 s41, s40, 49152
    buffer_store_dword v27, v69, s[4:7], s41 offen sc1
    s_waitcnt vmcnt(0)
    buffer_store_dword v26, v69, s[4:7], s40 offen sc1
    s_mov_b64 exec, -1
cs_init_done:
    s_waitcnt vmcnt(0)
    v_and_b32 v57, 63, v0
    v_bfe_u32 v54, v57, 2, 1
    v_lshlrev_b32 v48, 13, v54
    v_bfe_u32 v54, v57, 3, 1
    v_lshl_add_u32 v48, v54, 15, v48
    v_bfe_u32 v54, v57, 4, 1
    v_lshl_add_u32 v48, v54, 14, v48
    v_bfe_u32 v54, v57, 5, 1
    v_lshl_add_u32 v48, v54, 16, v48
    v_lshrrev_b32 v55, 4, v57
    v_and_b32 v55, 2, v55
    v_xor_b32 v55, v55, v57
    v_and_b32 v55, 3, v55
    v_lshl_add_u32 v48, v55, 4, v48
    v_bfe_u32 v54, v57, 2, 1
    v_lshlrev_b32 v51, 6, v54
    v_bfe_u32 v54, v57, 3, 1
    v_lshl_add_u32 v51, v54, 9, v51
    v_bfe_u32 v54, v57, 4, 1
    v_lshl_add_u32 v51, v54, 7, v51
    v_bfe_u32 v54, v57, 5, 1
    v_lshl_add_u32 v51, v54, 12, v51
    v_bfe_u32 v54, v57, 0, 1
    v_lshl_add_u32 v51, v54, 3, v51
    v_bfe_u32 v54, v57, 1, 1
    v_lshl_add_u32 v51, v54, 4, v51
    v_bfe_u32 v54, v57, 3, 1
    v_lshl_add_u32 v51, v54, 5, v51
    v_lshrrev_b32 v55, 3, v57
    v_mul_u32_u24 v49, 1152, v55
    v_and_b32 v55, 7, v57
    v_lshl_add_u32 v49, v55, 4, v49
    v_bfe_u32 v54, v57, 4, 1
    v_lshlrev_b32 v52, 13, v54
    v_bfe_u32 v54, v57, 5, 1
    v_lshl_add_u32 v52, v54, 9, v52
    v_bfe_u32 v54, v57, 2, 1
    v_lshl_add_u32 v52, v54, 7, v52
    v_bfe_u32 v54, v57, 3, 1
    v_lshl_add_u32 v52, v54, 5, v52
    v_and_b32 v55, 3, v57
    v_lshl_add_u32 v52, v55, 3, v52
    v_lshrrev_b32 v55, 2, v57
    v_mul_u32_u24 v50, 1152, v55
    v_and_b32 v55, 3, v57
    v_lshl_add_u32 v50, v55, 4, v50
    v_bfe_u32 v54, v57, 4, 1
    v_lshlrev_b32 v53, 12, v54
    v_bfe_u32 v54, v57, 5, 1
    v_lshl_add_u32 v53, v54, 8, v53
    v_bfe_u32 v54, v57, 2, 1
    v_lshl_add_u32 v53, v54, 6, v53
    v_bfe_u32 v54, v57, 3, 1
    v_lshl_add_u32 v53, v54, 5, v53
    v_and_b32 v55, 3, v57
    v_lshl_add_u32 v53, v55, 3, v53
    s_lshl_b32 s66, s13, 10
    s_lshl_b32 s93, s13, 14
    s_lshl_b32 s67, s12, 8
    s_lshl_b32 s40, s13, 6
    s_add_u32 s67, s67, s40
    s_mul_i32 s92, s12, 147456
    v_add_u32 v51, s66, v51
    v_add_u32 v52, s66, v52
    v_add_u32 v53, s66, v53
    s_mov_b32 s10, 4718592
    s_mov_b32 s11, 0x20000
    s_mov_b64 s[8:9], s[52:53]
    s_xor_b32 s40, s93, 0
    s_add_u32 s40, s40, s66
    s_add_u32 m0, s40, 0
    s_add_u32 s41, s67, 2097152
    buffer_load_dwordx4 v48, s[8:11], s41 offen lds
    s_add_u32 m0, s40, 4096
    s_add_u32 s41, s67, 2228224
    buffer_load_dwordx4 v48, s[8:11], s41 offen lds
    s_add_u32 m0, s40, 8192
    s_add_u32 s41, s67, 2359296
    buffer_load_dwordx4 v48, s[8:11], s41 offen lds
    s_add_u32 m0, s40, 12288
    s_add_u32 s41, s67, 2490368
    buffer_load_dwordx4 v48, s[8:11], s41 offen lds
    s_xor_b32 s40, s93, 16384
    s_add_u32 s40, s40, s66
    s_add_u32 m0, s40, 0
    s_add_u32 s41, s67, 2621440
    buffer_load_dwordx4 v48, s[8:11], s41 offen lds
    s_add_u32 m0, s40, 4096
    s_add_u32 s41, s67, 2752512
    buffer_load_dwordx4 v48, s[8:11], s41 offen lds
    s_add_u32 m0, s40, 8192
    s_add_u32 s41, s67, 2883584
    buffer_load_dwordx4 v48, s[8:11], s41 offen lds
    s_add_u32 m0, s40, 12288
    s_add_u32 s41, s67, 3014656
    buffer_load_dwordx4 v48, s[8:11], s41 offen lds
    s_xor_b32 s40, s93, 32768
    s_add_u32 s40, s40, s66
    s_add_u32 m0, s40, 0
    s_add_u32 s41, s67, 3145728
    buffer_load_dwordx4 v48, s[8:11], s41 offen lds
    s_add_u32 m0, s40, 4096
    s_add_u32 s41, s67, 3276800
    buffer_load_dwordx4 v48, s[8:11], s41 offen lds
    s_add_u32 m0, s40, 8192
    s_add_u32 s41, s67, 3407872
    buffer_load_dwordx4 v48, s[8:11], s41 offen lds
    s_add_u32 m0, s40, 12288
    s_add_u32 s41, s67, 3538944
    buffer_load_dwordx4 v48, s[8:11], s41 offen lds
    s_xor_b32 s40, s93, 49152
    s_add_u32 s40, s40, s66
    s_add_u32 m0, s40, 0
    s_add_u32 s41, s67, 3670016
    buffer_load_dwordx4 v48, s[8:11], s41 offen lds
    s_add_u32 m0, s40, 4096
    s_add_u32 s41, s67, 3801088
    buffer_load_dwordx4 v48, s[8:11], s41 offen lds
    s_add_u32 m0, s40, 8192
    s_add_u32 s41, s67, 3932160
    buffer_load_dwordx4 v48, s[8:11], s41 offen lds
    s_add_u32 m0, s40, 12288
    s_add_u32 s41, s67, 4063232
    buffer_load_dwordx4 v48, s[8:11], s41 offen lds
    s_add_u32 m0, s66, 131072
    s_add_u32 s41, s67, 4194304
    buffer_load_dwordx4 v48, s[8:11], s41 offen lds
    s_add_u32 m0, s66, 135168
    s_add_u32 s41, s67, 4325376
    buffer_load_dwordx4 v48, s[8:11], s41 offen lds
    s_add_u32 m0, s66, 139264
    s_add_u32 s41, s67, 4456448
    buffer_load_dwordx4 v48, s[8:11], s41 offen lds
    s_add_u32 m0, s66, 143360
    s_add_u32 s41, s67, 4587520
    buffer_load_dwordx4 v48, s[8:11], s41 offen lds
    s_mov_b64 s[8:9], s[54:55]
    s_xor_b32 s40, s93, 0
    s_add_u32 s40, s40, s66
    s_add_u32 m0, s40, 65536
    s_add_u32 s41, s67, 0
    buffer_load_dwordx4 v48, s[8:11], s41 offen lds
    s_add_u32 m0, s40, 69632
    s_add_u32 s41, s67, 131072
    buffer_load_dwordx4 v48, s[8:11], s41 offen lds
    s_add_u32 m0, s40, 73728
    s_add_u32 s41, s67, 262144
    buffer_load_dwordx4 v48, s[8:11], s41 offen lds
    s_add_u32 m0, s40, 77824
    s_add_u32 s41, s67, 393216
    buffer_load_dwordx4 v48, s[8:11], s41 offen lds
    s_xor_b32 s40, s93, 16384
    s_add_u32 s40, s40, s66
    s_add_u32 m0, s40, 65536
    s_add_u32 s41, s67, 524288
    buffer_load_dwordx4 v48, s[8:11], s41 offen lds
    s_add_u32 m0, s40, 69632
    s_add_u32 s41, s67, 655360
    buffer_load_dwordx4 v48, s[8:11], s41 offen lds
    s_add_u32 m0, s40, 73728
    s_add_u32 s41, s67, 786432
    buffer_load_dwordx4 v48, s[8:11], s41 offen lds
    s_add_u32 m0, s40, 77824
    s_add_u32 s41, s67, 917504
    buffer_load_dwordx4 v48, s[8:11], s41 offen lds
    s_xor_b32 s40, s93, 32768
    s_add_u32 s40, s40, s66
    s_add_u32 m0, s40, 65536
    s_add_u32 s41, s67, 1048576
    buffer_load_dwordx4 v48, s[8:11], s41 offen lds
    s_add_u32 m0, s40, 69632
    s_add_u32 s41, s67, 1179648
    buffer_load_dwordx4 v48, s[8:11], s41 offen lds
    s_add_u32 m0, s40, 73728
    s_add_u32 s41, s67, 1310720
    buffer_load_dwordx4 v48, s[8:11], s41 offen lds
    s_add_u32 m0, s40, 77824
    s_add_u32 s41, s67, 1441792
    buffer_load_dwordx4 v48, s[8:11], s41 offen lds
    s_xor_b32 s40, s93, 49152
    s_add_u32 s40, s40, s66
    s_add_u32 m0, s40, 65536
    s_add_u32 s41, s67, 1572864
    buffer_load_dwordx4 v48, s[8:11], s41 offen lds
    s_add_u32 m0, s40, 69632
    s_add_u32 s41, s67, 1703936
    buffer_load_dwordx4 v48, s[8:11], s41 offen lds
    s_add_u32 m0, s40, 73728
    s_add_u32 s41, s67, 1835008
    buffer_load_dwordx4 v48, s[8:11], s41 offen lds
    s_add_u32 m0, s40, 77824
    s_add_u32 s41, s67, 1966080
    buffer_load_dwordx4 v48, s[8:11], s41 offen lds
    s_add_u32 m0, s66, 147456
    s_add_u32 s41, s67, 4194304
    buffer_load_dwordx4 v48, s[8:11], s41 offen lds
    s_add_u32 m0, s66, 151552
    s_add_u32 s41, s67, 4325376
    buffer_load_dwordx4 v48, s[8:11], s41 offen lds
    s_add_u32 m0, s66, 155648
    s_add_u32 s41, s67, 4456448
    buffer_load_dwordx4 v48, s[8:11], s41 offen lds
    s_add_u32 m0, s66, 159744
    s_add_u32 s41, s67, 4587520
    buffer_load_dwordx4 v48, s[8:11], s41 offen lds
    s_waitcnt vmcnt(24)
    v_add_u32 v55, 0, v51
    v_xor_b32 v56, 32, v55
    ds_read_b64_tr_b16 a[136:137], v55 offset:0
    ds_read_b64_tr_b16 a[138:139], v55 offset:256
    ds_read_b64_tr_b16 a[140:141], v55 offset:8192
    ds_read_b64_tr_b16 a[142:143], v55 offset:8448
    ds_read_b64_tr_b16 a[144:145], v56 offset:0
    ds_read_b64_tr_b16 a[146:147], v56 offset:256
    ds_read_b64_tr_b16 a[148:149], v56 offset:8192
    ds_read_b64_tr_b16 a[150:151], v56 offset:8448
    s_waitcnt lgkmcnt(0)
    v_add_u32 v55, 16384, v51
    v_xor_b32 v56, 32, v55
    ds_read_b64_tr_b16 a[152:153], v55 offset:0
    ds_read_b64_tr_b16 a[154:155], v55 offset:256
    ds_read_b64_tr_b16 a[156:157], v55 offset:8192
    ds_read_b64_tr_b16 a[158:159], v55 offset:8448
    ds_read_b64_tr_b16 a[160:161], v56 offset:0
    ds_read_b64_tr_b16 a[162:163], v56 offset:256
    ds_read_b64_tr_b16 a[164:165], v56 offset:8192
    ds_read_b64_tr_b16 a[166:167], v56 offset:8448
    s_waitcnt lgkmcnt(0)
    v_add_u32 v55, 32768, v51
    v_xor_b32 v56, 32, v55
    ds_read_b64_tr_b16 a[168:169], v55 offset:0
    ds_read_b64_tr_b16 a[170:171], v55 offset:256
    ds_read_b64_tr_b16 a[172:173], v55 offset:8192
    ds_read_b64_tr_b16 a[174:175], v55 offset:8448
    ds_read_b64_tr_b16 a[176:177], v56 offset:0
    ds_read_b64_tr_b16 a[178:179], v56 offset:256
    ds_read_b64_tr_b16 a[180:181], v56 offset:8192
    ds_read_b64_tr_b16 a[182:183], v56 offset:8448
    s_waitcnt lgkmcnt(0)
    v_add_u32 v55, 49152, v51
    v_xor_b32 v56, 32, v55
    ds_read_b64_tr_b16 a[184:185], v55 offset:0
    ds_read_b64_tr_b16 a[186:187], v55 offset:256
    ds_read_b64_tr_b16 a[188:189], v55 offset:8192
    ds_read_b64_tr_b16 a[190:191], v55 offset:8448
    ds_read_b64_tr_b16 a[192:193], v56 offset:0
    ds_read_b64_tr_b16 a[194:195], v56 offset:256
    ds_read_b64_tr_b16 a[196:197], v56 offset:8192
    ds_read_b64_tr_b16 a[198:199], v56 offset:8448
    s_waitcnt lgkmcnt(0)
    s_xor_b32 s40, s93, 0
    s_add_u32 s40, s40, s66
    s_add_u32 m0, s40, 0
    s_add_u32 s41, s67, 2097152
    buffer_load_dwordx4 v48, s[8:11], s41 offen lds
    s_add_u32 m0, s40, 4096
    s_add_u32 s41, s67, 2228224
    buffer_load_dwordx4 v48, s[8:11], s41 offen lds
    s_add_u32 m0, s40, 8192
    s_add_u32 s41, s67, 2359296
    buffer_load_dwordx4 v48, s[8:11], s41 offen lds
    s_add_u32 m0, s40, 12288
    s_add_u32 s41, s67, 2490368
    buffer_load_dwordx4 v48, s[8:11], s41 offen lds
    s_xor_b32 s40, s93, 16384
    s_add_u32 s40, s40, s66
    s_add_u32 m0, s40, 0
    s_add_u32 s41, s67, 2621440
    buffer_load_dwordx4 v48, s[8:11], s41 offen lds
    s_add_u32 m0, s40, 4096
    s_add_u32 s41, s67, 2752512
    buffer_load_dwordx4 v48, s[8:11], s41 offen lds
    s_add_u32 m0, s40, 8192
    s_add_u32 s41, s67, 2883584
    buffer_load_dwordx4 v48, s[8:11], s41 offen lds
    s_add_u32 m0, s40, 12288
    s_add_u32 s41, s67, 3014656
    buffer_load_dwordx4 v48, s[8:11], s41 offen lds
    s_xor_b32 s40, s93, 32768
    s_add_u32 s40, s40, s66
    s_add_u32 m0, s40, 0
    s_add_u32 s41, s67, 3145728
    buffer_load_dwordx4 v48, s[8:11], s41 offen lds
    s_add_u32 m0, s40, 4096
    s_add_u32 s41, s67, 3276800
    buffer_load_dwordx4 v48, s[8:11], s41 offen lds
    s_add_u32 m0, s40, 8192
    s_add_u32 s41, s67, 3407872
    buffer_load_dwordx4 v48, s[8:11], s41 offen lds
    s_add_u32 m0, s40, 12288
    s_add_u32 s41, s67, 3538944
    buffer_load_dwordx4 v48, s[8:11], s41 offen lds
    s_xor_b32 s40, s93, 49152
    s_add_u32 s40, s40, s66
    s_add_u32 m0, s40, 0
    s_add_u32 s41, s67, 3670016
    buffer_load_dwordx4 v48, s[8:11], s41 offen lds
    s_add_u32 m0, s40, 4096
    s_add_u32 s41, s67, 3801088
    buffer_load_dwordx4 v48, s[8:11], s41 offen lds
    s_add_u32 m0, s40, 8192
    s_add_u32 s41, s67, 3932160
    buffer_load_dwordx4 v48, s[8:11], s41 offen lds
    s_add_u32 m0, s40, 12288
    s_add_u32 s41, s67, 4063232
    buffer_load_dwordx4 v48, s[8:11], s41 offen lds
    s_waitcnt vmcnt(36)
    v_add_u32 v55, 131072, v51
    v_xor_b32 v56, 32, v55
    ds_read_b64_tr_b16 a[200:201], v55 offset:0
    ds_read_b64_tr_b16 a[202:203], v55 offset:256
    ds_read_b64_tr_b16 a[204:205], v55 offset:8192
    ds_read_b64_tr_b16 a[206:207], v55 offset:8448
    ds_read_b64_tr_b16 a[208:209], v56 offset:0
    ds_read_b64_tr_b16 a[210:211], v56 offset:256
    ds_read_b64_tr_b16 a[212:213], v56 offset:8192
    ds_read_b64_tr_b16 a[214:215], v56 offset:8448
    s_waitcnt lgkmcnt(0)
    s_mov_b64 s[8:9], s[50:51]
    s_add_u32 m0, s66, 131072
    s_add_u32 s41, s67, 4194304
    buffer_load_dwordx4 v48, s[8:11], s41 offen lds
    s_add_u32 m0, s66, 135168
    s_add_u32 s41, s67, 4325376
    buffer_load_dwordx4 v48, s[8:11], s41 offen lds
    s_add_u32 m0, s66, 139264
    s_add_u32 s41, s67, 4456448
    buffer_load_dwordx4 v48, s[8:11], s41 offen lds
    s_add_u32 m0, s66, 143360
    s_add_u32 s41, s67, 4587520
    buffer_load_dwordx4 v48, s[8:11], s41 offen lds
    s_waitcnt vmcnt(24)
    v_add_u32 v55, 65536, v51
    v_xor_b32 v56, 32, v55
    ds_read_b64_tr_b16 a[216:217], v55 offset:0
    ds_read_b64_tr_b16 a[218:219], v55 offset:256
    ds_read_b64_tr_b16 a[220:221], v55 offset:8192
    ds_read_b64_tr_b16 a[222:223], v55 offset:8448
    ds_read_b64_tr_b16 a[224:225], v56 offset:0
    ds_read_b64_tr_b16 a[226:227], v56 offset:256
    ds_read_b64_tr_b16 a[228:229], v56 offset:8192
    ds_read_b64_tr_b16 a[230:231], v56 offset:8448
    s_waitcnt lgkmcnt(0)
    v_add_u32 v55, 81920, v51
    v_xor_b32 v56, 32, v55
    ds_read_b64_tr_b16 a[232:233], v55 offset:0
    ds_read_b64_tr_b16 a[234:235], v55 offset:256
    ds_read_b64_tr_b16 a[236:237], v55 offset:8192
    ds_read_b64_tr_b16 a[238:239], v55 offset:8448
    ds_read_b64_tr_b16 a[240:241], v56 offset:0
    ds_read_b64_tr_b16 a[242:243], v56 offset:256
    ds_read_b64_tr_b16 a[244:245], v56 offset:8192
    ds_read_b64_tr_b16 a[246:247], v56 offset:8448
    s_waitcnt lgkmcnt(0)
    v_add_u32 v55, 98304, v51
    v_xor_b32 v56, 32, v55
    ds_read_b64_tr_b16 a[248:249], v55 offset:0
    ds_read_b64_tr_b16 a[250:251], v55 offset:256
    ds_read_b64_tr_b16 a[252:253], v55 offset:8192
    ds_read_b64_tr_b16 a[254:255], v55 offset:8448
    ds_read_b64_tr_b16 v[72:73], v56 offset:0
    ds_read_b64_tr_b16 v[74:75], v56 offset:256
    ds_read_b64_tr_b16 v[76:77], v56 offset:8192
    ds_read_b64_tr_b16 v[78:79], v56 offset:8448
    s_waitcnt lgkmcnt(0)
    v_add_u32 v55, 114688, v51
    v_xor_b32 v56, 32, v55
    ds_read_b64_tr_b16 v[80:81], v55 offset:0
    ds_read_b64_tr_b16 v[82:83], v55 offset:256
    ds_read_b64_tr_b16 v[84:85], v55 offset:8192
    ds_read_b64_tr_b16 v[86:87], v55 offset:8448
    ds_read_b64_tr_b16 v[88:89], v56 offset:0
    ds_read_b64_tr_b16 v[90:91], v56 offset:256
    ds_read_b64_tr_b16 v[92:93], v56 offset:8192
    ds_read_b64_tr_b16 v[94:95], v56 offset:8448
    s_waitcnt lgkmcnt(0)
    s_xor_b32 s40, s93, 0
    s_add_u32 s40, s40, s66
    s_add_u32 m0, s40, 65536
    s_add_u32 s41, s67, 2097152
    buffer_load_dwordx4 v48, s[8:11], s41 offen lds
    s_add_u32 m0, s40, 69632
    s_add_u32 s41, s67, 2228224
    buffer_load_dwordx4 v48, s[8:11], s41 offen lds
    s_add_u32 m0, s40, 73728
    s_add_u32 s41, s67, 2359296
    buffer_load_dwordx4 v48, s[8:11], s41 offen lds
    s_add_u32 m0, s40, 77824
    s_add_u32 s41, s67, 2490368
    buffer_load_dwordx4 v48, s[8:11], s41 offen lds
    s_xor_b32 s40, s93, 16384
    s_add_u32 s40, s40, s66
    s_add_u32 m0, s40, 65536
    s_add_u32 s41, s67, 2621440
    buffer_load_dwordx4 v48, s[8:11], s41 offen lds
    s_add_u32 m0, s40, 69632
    s_add_u32 s41, s67, 2752512
    buffer_load_dwordx4 v48, s[8:11], s41 offen lds
    s_add_u32 m0, s40, 73728
    s_add_u32 s41, s67, 2883584
    buffer_load_dwordx4 v48, s[8:11], s41 offen lds
    s_add_u32 m0, s40, 77824
    s_add_u32 s41, s67, 3014656
    buffer_load_dwordx4 v48, s[8:11], s41 offen lds
    s_xor_b32 s40, s93, 32768
    s_add_u32 s40, s40, s66
    s_add_u32 m0, s40, 65536
    s_add_u32 s41, s67, 3145728
    buffer_load_dwordx4 v48, s[8:11], s41 offen lds
    s_add_u32 m0, s40, 69632
    s_add_u32 s41, s67, 3276800
    buffer_load_dwordx4 v48, s[8:11], s41 offen lds
    s_add_u32 m0, s40, 73728
    s_add_u32 s41, s67, 3407872
    buffer_load_dwordx4 v48, s[8:11], s41 offen lds
    s_add_u32 m0, s40, 77824
    s_add_u32 s41, s67, 3538944
    buffer_load_dwordx4 v48, s[8:11], s41 offen lds
    s_xor_b32 s40, s93, 49152
    s_add_u32 s40, s40, s66
    s_add_u32 m0, s40, 65536
    s_add_u32 s41, s67, 3670016
    buffer_load_dwordx4 v48, s[8:11], s41 offen lds
    s_add_u32 m0, s40, 69632
    s_add_u32 s41, s67, 3801088
    buffer_load_dwordx4 v48, s[8:11], s41 offen lds
    s_add_u32 m0, s40, 73728
    s_add_u32 s41, s67, 3932160
    buffer_load_dwordx4 v48, s[8:11], s41 offen lds
    s_add_u32 m0, s40, 77824
    s_add_u32 s41, s67, 4063232
    buffer_load_dwordx4 v48, s[8:11], s41 offen lds
    s_waitcnt vmcnt(36)
    v_add_u32 v55, 147456, v51
    v_xor_b32 v56, 32, v55
    ds_read_b64_tr_b16 v[160:161], v55 offset:0
    ds_read_b64_tr_b16 v[162:163], v55 offset:256
    ds_read_b64_tr_b16 v[164:165], v55 offset:8192
    ds_read_b64_tr_b16 v[166:167], v55 offset:8448
    ds_read_b64_tr_b16 v[168:169], v56 offset:0
    ds_read_b64_tr_b16 v[170:171], v56 offset:256
    ds_read_b64_tr_b16 v[172:173], v56 offset:8192
    ds_read_b64_tr_b16 v[174:175], v56 offset:8448
    s_waitcnt lgkmcnt(0)
    s_waitcnt vmcnt(20)
    v_add_u32 v55, 0, v51
    v_xor_b32 v56, 32, v55
    ds_read_b64_tr_b16 v[96:97], v55 offset:0
    ds_read_b64_tr_b16 v[98:99], v55 offset:256
    ds_read_b64_tr_b16 v[100:101], v55 offset:8192
    ds_read_b64_tr_b16 v[102:103], v55 offset:8448
    ds_read_b64_tr_b16 v[104:105], v56 offset:0
    ds_read_b64_tr_b16 v[106:107], v56 offset:256
    ds_read_b64_tr_b16 v[108:109], v56 offset:8192
    ds_read_b64_tr_b16 v[110:111], v56 offset:8448
    s_waitcnt lgkmcnt(0)
    v_add_u32 v55, 16384, v51
    v_xor_b32 v56, 32, v55
    ds_read_b64_tr_b16 v[112:113], v55 offset:0
    ds_read_b64_tr_b16 v[114:115], v55 offset:256
    ds_read_b64_tr_b16 v[116:117], v55 offset:8192
    ds_read_b64_tr_b16 v[118:119], v55 offset:8448
    ds_read_b64_tr_b16 v[120:121], v56 offset:0
    ds_read_b64_tr_b16 v[122:123], v56 offset:256
    ds_read_b64_tr_b16 v[124:125], v56 offset:8192
    ds_read_b64_tr_b16 v[126:127], v56 offset:8448
    s_waitcnt lgkmcnt(0)
    v_add_u32 v55, 32768, v51
    v_xor_b32 v56, 32, v55
    ds_read_b64_tr_b16 v[128:129], v55 offset:0
    ds_read_b64_tr_b16 v[130:131], v55 offset:256
    ds_read_b64_tr_b16 v[132:133], v55 offset:8192
    ds_read_b64_tr_b16 v[134:135], v55 offset:8448
    ds_read_b64_tr_b16 v[136:137], v56 offset:0
    ds_read_b64_tr_b16 v[138:139], v56 offset:256
    ds_read_b64_tr_b16 v[140:141], v56 offset:8192
    ds_read_b64_tr_b16 v[142:143], v56 offset:8448
    s_waitcnt lgkmcnt(0)
    v_add_u32 v55, 49152, v51
    v_xor_b32 v56, 32, v55
    ds_read_b64_tr_b16 v[144:145], v55 offset:0
    ds_read_b64_tr_b16 v[146:147], v55 offset:256
    ds_read_b64_tr_b16 v[148:149], v55 offset:8192
    ds_read_b64_tr_b16 v[150:151], v55 offset:8448
    ds_read_b64_tr_b16 v[152:153], v56 offset:0
    ds_read_b64_tr_b16 v[154:155], v56 offset:256
    ds_read_b64_tr_b16 v[156:157], v56 offset:8192
    ds_read_b64_tr_b16 v[158:159], v56 offset:8448
    s_waitcnt lgkmcnt(0)
    s_xor_b32 s40, s93, 0
    s_add_u32 s40, s40, s66
    s_add_u32 m0, s40, 0
    s_add_u32 s41, s67, 0
    buffer_load_dwordx4 v48, s[8:11], s41 offen lds
    s_add_u32 m0, s40, 4096
    s_add_u32 s41, s67, 131072
    buffer_load_dwordx4 v48, s[8:11], s41 offen lds
    s_add_u32 m0, s40, 8192
    s_add_u32 s41, s67, 262144
    buffer_load_dwordx4 v48, s[8:11], s41 offen lds
    s_add_u32 m0, s40, 12288
    s_add_u32 s41, s67, 393216
    buffer_load_dwordx4 v48, s[8:11], s41 offen lds
    s_xor_b32 s40, s93, 16384
    s_add_u32 s40, s40, s66
    s_add_u32 m0, s40, 0
    s_add_u32 s41, s67, 524288
    buffer_load_dwordx4 v48, s[8:11], s41 offen lds
    s_add_u32 m0, s40, 4096
    s_add_u32 s41, s67, 655360
    buffer_load_dwordx4 v48, s[8:11], s41 offen lds
    s_add_u32 m0, s40, 8192
    s_add_u32 s41, s67, 786432
    buffer_load_dwordx4 v48, s[8:11], s41 offen lds
    s_add_u32 m0, s40, 12288
    s_add_u32 s41, s67, 917504
    buffer_load_dwordx4 v48, s[8:11], s41 offen lds
    s_xor_b32 s40, s93, 32768
    s_add_u32 s40, s40, s66
    s_add_u32 m0, s40, 0
    s_add_u32 s41, s67, 1048576
    buffer_load_dwordx4 v48, s[8:11], s41 offen lds
    s_add_u32 m0, s40, 4096
    s_add_u32 s41, s67, 1179648
    buffer_load_dwordx4 v48, s[8:11], s41 offen lds
    s_add_u32 m0, s40, 8192
    s_add_u32 s41, s67, 1310720
    buffer_load_dwordx4 v48, s[8:11], s41 offen lds
    s_add_u32 m0, s40, 12288
    s_add_u32 s41, s67, 1441792
    buffer_load_dwordx4 v48, s[8:11], s41 offen lds
    s_xor_b32 s40, s93, 49152
    s_add_u32 s40, s40, s66
    s_add_u32 m0, s40, 0
    s_add_u32 s41, s67, 1572864
    buffer_load_dwordx4 v48, s[8:11], s41 offen lds
    s_add_u32 m0, s40, 4096
    s_add_u32 s41, s67, 1703936
    buffer_load_dwordx4 v48, s[8:11], s41 offen lds
    s_add_u32 m0, s40, 8192
    s_add_u32 s41, s67, 1835008
    buffer_load_dwordx4 v48, s[8:11], s41 offen lds
    s_add_u32 m0, s40, 12288
    s_add_u32 s41, s67, 1966080
    buffer_load_dwordx4 v48, s[8:11], s41 offen lds
    s_waitcnt vmcnt(32)
    v_add_u32 v55, 131072, v51
    v_xor_b32 v56, 32, v55
    ds_read_b64_tr_b16 a[120:121], v55 offset:0
    ds_read_b64_tr_b16 a[122:123], v55 offset:256
    ds_read_b64_tr_b16 a[124:125], v55 offset:8192
    ds_read_b64_tr_b16 a[126:127], v55 offset:8448
    ds_read_b64_tr_b16 a[128:129], v56 offset:0
    ds_read_b64_tr_b16 a[130:131], v56 offset:256
    ds_read_b64_tr_b16 a[132:133], v56 offset:8192
    ds_read_b64_tr_b16 a[134:135], v56 offset:8448
    s_waitcnt lgkmcnt(0)
    s_mov_b64 s[8:9], s[56:57]
    s_xor_b32 s94, s13, 0
    s_mul_i32 s94, s94, 36864
    s_add_u32 s94, s94, s92
    s_lshl_b32 s40, s13, 7
    s_add_u32 s94, s94, s40
    s_add_u32 m0, s66, 131072
    s_add_u32 s41, s94, 0
    buffer_load_dwordx4 v49, s[8:11], s41 offen lds
    s_add_u32 m0, s66, 135168
    s_add_u32 s41, s94, 9216
    buffer_load_dwordx4 v49, s[8:11], s41 offen lds
    s_add_u32 m0, s66, 139264
    s_add_u32 s41, s94, 18432
    buffer_load_dwordx4 v49, s[8:11], s41 offen lds
    s_add_u32 m0, s66, 143360
    s_add_u32 s41, s94, 27648
    buffer_load_dwordx4 v49, s[8:11], s41 offen lds
    s_waitcnt vmcnt(20)
    v_add_u32 v55, 65536, v51
    v_xor_b32 v56, 32, v55
    ds_read_b64_tr_b16 a[56:57], v55 offset:0
    ds_read_b64_tr_b16 a[58:59], v55 offset:256
    ds_read_b64_tr_b16 a[60:61], v55 offset:8192
    ds_read_b64_tr_b16 a[62:63], v55 offset:8448
    ds_read_b64_tr_b16 a[64:65], v56 offset:0
    ds_read_b64_tr_b16 a[66:67], v56 offset:256
    ds_read_b64_tr_b16 a[68:69], v56 offset:8192
    ds_read_b64_tr_b16 a[70:71], v56 offset:8448
    s_waitcnt lgkmcnt(0)
    v_add_u32 v55, 81920, v51
    v_xor_b32 v56, 32, v55
    ds_read_b64_tr_b16 a[72:73], v55 offset:0
    ds_read_b64_tr_b16 a[74:75], v55 offset:256
    ds_read_b64_tr_b16 a[76:77], v55 offset:8192
    ds_read_b64_tr_b16 a[78:79], v55 offset:8448
    ds_read_b64_tr_b16 a[80:81], v56 offset:0
    ds_read_b64_tr_b16 a[82:83], v56 offset:256
    ds_read_b64_tr_b16 a[84:85], v56 offset:8192
    ds_read_b64_tr_b16 a[86:87], v56 offset:8448
    s_waitcnt lgkmcnt(0)
    v_add_u32 v55, 98304, v51
    v_xor_b32 v56, 32, v55
    ds_read_b64_tr_b16 a[88:89], v55 offset:0
    ds_read_b64_tr_b16 a[90:91], v55 offset:256
    ds_read_b64_tr_b16 a[92:93], v55 offset:8192
    ds_read_b64_tr_b16 a[94:95], v55 offset:8448
    ds_read_b64_tr_b16 a[96:97], v56 offset:0
    ds_read_b64_tr_b16 a[98:99], v56 offset:256
    ds_read_b64_tr_b16 a[100:101], v56 offset:8192
    ds_read_b64_tr_b16 a[102:103], v56 offset:8448
    s_waitcnt lgkmcnt(0)
    v_add_u32 v55, 114688, v51
    v_xor_b32 v56, 32, v55
    ds_read_b64_tr_b16 a[104:105], v55 offset:0
    ds_read_b64_tr_b16 a[106:107], v55 offset:256
    ds_read_b64_tr_b16 a[108:109], v55 offset:8192
    ds_read_b64_tr_b16 a[110:111], v55 offset:8448
    ds_read_b64_tr_b16 a[112:113], v56 offset:0
    ds_read_b64_tr_b16 a[114:115], v56 offset:256
    ds_read_b64_tr_b16 a[116:117], v56 offset:8192
    ds_read_b64_tr_b16 a[118:119], v56 offset:8448
    s_waitcnt lgkmcnt(0)
    s_xor_b32 s94, s13, 1
    s_mul_i32 s94, s94, 36864
    s_add_u32 s94, s94, s92
    s_lshl_b32 s40, s13, 7
    s_add_u32 s94, s94, s40
    s_add_u32 m0, s66, 65536
    s_add_u32 s41, s94, 0
    buffer_load_dwordx4 v49, s[8:11], s41 offen lds
    s_add_u32 m0, s66, 69632
    s_add_u32 s41, s94, 9216
    buffer_load_dwordx4 v49, s[8:11], s41 offen lds
    s_add_u32 m0, s66, 73728
    s_add_u32 s41, s94, 18432
    buffer_load_dwordx4 v49, s[8:11], s41 offen lds
    s_add_u32 m0, s66, 77824
    s_add_u32 s41, s94, 27648
    buffer_load_dwordx4 v49, s[8:11], s41 offen lds
    s_xor_b32 s94, s13, 2
    s_mul_i32 s94, s94, 36864
    s_add_u32 s94, s94, s92
    s_lshl_b32 s40, s13, 7
    s_add_u32 s94, s94, s40
    s_add_u32 m0, s66, 81920
    s_add_u32 s41, s94, 0
    buffer_load_dwordx4 v49, s[8:11], s41 offen lds
    s_add_u32 m0, s66, 86016
    s_add_u32 s41, s94, 9216
    buffer_load_dwordx4 v49, s[8:11], s41 offen lds
    s_add_u32 m0, s66, 90112
    s_add_u32 s41, s94, 18432
    buffer_load_dwordx4 v49, s[8:11], s41 offen lds
    s_add_u32 m0, s66, 94208
    s_add_u32 s41, s94, 27648
    buffer_load_dwordx4 v49, s[8:11], s41 offen lds
    s_xor_b32 s94, s13, 3
    s_mul_i32 s94, s94, 36864
    s_add_u32 s94, s94, s92
    s_lshl_b32 s40, s13, 7
    s_add_u32 s94, s94, s40
    s_add_u32 m0, s66, 98304
    s_add_u32 s41, s94, 0
    buffer_load_dwordx4 v49, s[8:11], s41 offen lds
    s_add_u32 m0, s66, 102400
    s_add_u32 s41, s94, 9216
    buffer_load_dwordx4 v49, s[8:11], s41 offen lds
    s_add_u32 m0, s66, 106496
    s_add_u32 s41, s94, 18432
    buffer_load_dwordx4 v49, s[8:11], s41 offen lds
    s_add_u32 m0, s66, 110592
    s_add_u32 s41, s94, 27648
    buffer_load_dwordx4 v49, s[8:11], s41 offen lds
    s_waitcnt vmcnt(16)
    v_add_u32 v55, 0, v51
    v_xor_b32 v56, 32, v55
    ds_read_b64_tr_b16 a[0:1], v55 offset:0
    ds_read_b64_tr_b16 a[2:3], v55 offset:256
    ds_read_b64_tr_b16 a[4:5], v55 offset:8192
    ds_read_b64_tr_b16 a[6:7], v55 offset:8448
    ds_read_b64_tr_b16 v[8:9], v56 offset:0
    ds_read_b64_tr_b16 v[10:11], v56 offset:256
    ds_read_b64_tr_b16 v[12:13], v56 offset:8192
    ds_read_b64_tr_b16 v[14:15], v56 offset:8448
    s_waitcnt lgkmcnt(0)
    s_barrier
    ds_write_b128 v63, v[8:11] offset:57344
    ds_write_b128 v63, v[12:15] offset:61440
    s_waitcnt lgkmcnt(0)
    v_add_u32 v55, 16384, v51
    v_xor_b32 v56, 32, v55
    ds_read_b64_tr_b16 a[8:9], v55 offset:0
    ds_read_b64_tr_b16 a[10:11], v55 offset:256
    ds_read_b64_tr_b16 a[12:13], v55 offset:8192
    ds_read_b64_tr_b16 a[14:15], v55 offset:8448
    ds_read_b64_tr_b16 a[16:17], v56 offset:0
    ds_read_b64_tr_b16 a[18:19], v56 offset:256
    ds_read_b64_tr_b16 a[20:21], v56 offset:8192
    ds_read_b64_tr_b16 a[22:23], v56 offset:8448
    s_waitcnt lgkmcnt(0)
    v_add_u32 v55, 32768, v51
    v_xor_b32 v56, 32, v55
    ds_read_b64_tr_b16 a[24:25], v55 offset:0
    ds_read_b64_tr_b16 a[26:27], v55 offset:256
    ds_read_b64_tr_b16 a[28:29], v55 offset:8192
    ds_read_b64_tr_b16 a[30:31], v55 offset:8448
    ds_read_b64_tr_b16 a[32:33], v56 offset:0
    ds_read_b64_tr_b16 a[34:35], v56 offset:256
    ds_read_b64_tr_b16 a[36:37], v56 offset:8192
    ds_read_b64_tr_b16 a[38:39], v56 offset:8448
    s_waitcnt lgkmcnt(0)
    v_add_u32 v55, 49152, v51
    v_xor_b32 v56, 32, v55
    ds_read_b64_tr_b16 a[40:41], v55 offset:0
    ds_read_b64_tr_b16 a[42:43], v55 offset:256
    ds_read_b64_tr_b16 a[44:45], v55 offset:8192
    ds_read_b64_tr_b16 a[46:47], v55 offset:8448
    ds_read_b64_tr_b16 a[48:49], v56 offset:0
    ds_read_b64_tr_b16 a[50:51], v56 offset:256
    ds_read_b64_tr_b16 a[52:53], v56 offset:8192
    ds_read_b64_tr_b16 a[54:55], v56 offset:8448
    s_waitcnt lgkmcnt(0)
    s_mov_b64 s[8:9], s[52:53]
    s_xor_b32 s40, s93, 0
    s_add_u32 s40, s40, s66
    s_add_u32 m0, s40, 0
    s_add_u32 s41, s67, 0
    buffer_load_dwordx4 v48, s[8:11], s41 offen lds
    s_add_u32 m0, s40, 4096
    s_add_u32 s41, s67, 131072
    buffer_load_dwordx4 v48, s[8:11], s41 offen lds
    s_add_u32 m0, s40, 8192
    s_add_u32 s41, s67, 262144
    buffer_load_dwordx4 v48, s[8:11], s41 offen lds
    s_add_u32 m0, s40, 12288
    s_add_u32 s41, s67, 393216
    buffer_load_dwordx4 v48, s[8:11], s41 offen lds
    s_xor_b32 s40, s93, 16384
    s_add_u32 s40, s40, s66
    s_add_u32 m0, s40, 0
    s_add_u32 s41, s67, 524288
    buffer_load_dwordx4 v48, s[8:11], s41 offen lds
    s_add_u32 m0, s40, 4096
    s_add_u32 s41, s67, 655360
    buffer_load_dwordx4 v48, s[8:11], s41 offen lds
    s_add_u32 m0, s40, 8192
    s_add_u32 s41, s67, 786432
    buffer_load_dwordx4 v48, s[8:11], s41 offen lds
    s_add_u32 m0, s40, 12288
    s_add_u32 s41, s67, 917504
    buffer_load_dwordx4 v48, s[8:11], s41 offen lds
    s_xor_b32 s40, s93, 32768
    s_add_u32 s40, s40, s66
    s_add_u32 m0, s40, 0
    s_add_u32 s41, s67, 1048576
    buffer_load_dwordx4 v48, s[8:11], s41 offen lds
    s_add_u32 m0, s40, 4096
    s_add_u32 s41, s67, 1179648
    buffer_load_dwordx4 v48, s[8:11], s41 offen lds
    s_add_u32 m0, s40, 8192
    s_add_u32 s41, s67, 1310720
    buffer_load_dwordx4 v48, s[8:11], s41 offen lds
    s_add_u32 m0, s40, 12288
    s_add_u32 s41, s67, 1441792
    buffer_load_dwordx4 v48, s[8:11], s41 offen lds
    s_xor_b32 s40, s93, 49152
    s_add_u32 s40, s40, s66
    s_add_u32 m0, s40, 0
    s_add_u32 s41, s67, 1572864
    buffer_load_dwordx4 v48, s[8:11], s41 offen lds
    s_add_u32 m0, s40, 4096
    s_add_u32 s41, s67, 1703936
    buffer_load_dwordx4 v48, s[8:11], s41 offen lds
    s_add_u32 m0, s40, 8192
    s_add_u32 s41, s67, 1835008
    buffer_load_dwordx4 v48, s[8:11], s41 offen lds
    s_add_u32 m0, s40, 12288
    s_add_u32 s41, s67, 1966080
    buffer_load_dwordx4 v48, s[8:11], s41 offen lds
    s_waitcnt vmcnt(28)
    v_add_u32 v55, 131072, v52
    ds_read_b64_tr_b16 v[176:177], v55 offset:0
    ds_read_b64_tr_b16 v[178:179], v55 offset:256
    ds_read_b64_tr_b16 v[180:181], v55 offset:4096
    ds_read_b64_tr_b16 v[182:183], v55 offset:4352
    ds_read_b64_tr_b16 v[208:209], v55 offset:64
    ds_read_b64_tr_b16 v[210:211], v55 offset:320
    ds_read_b64_tr_b16 v[212:213], v55 offset:4160
    ds_read_b64_tr_b16 v[214:215], v55 offset:4416
    s_waitcnt lgkmcnt(0)
    s_mov_b64 s[8:9], s[56:57]
    s_xor_b32 s94, s13, 3
    s_mul_i32 s94, s94, 36864
    s_add_u32 s94, s94, s92
    s_lshl_b32 s40, s13, 7
    s_add_u32 s94, s94, s40
    s_add_u32 m0, s66, 122880
    s_add_u32 s41, s94, 512
    buffer_load_dwordx4 v49, s[8:11], s41 offen lds
    s_add_u32 m0, s66, 126976
    s_add_u32 s41, s94, 9728
    buffer_load_dwordx4 v49, s[8:11], s41 offen lds
    s_add_u32 m0, s66, 131072
    s_add_u32 s41, s94, 18944
    buffer_load_dwordx4 v49, s[8:11], s41 offen lds
    s_add_u32 m0, s66, 135168
    s_add_u32 s41, s94, 28160
    buffer_load_dwordx4 v49, s[8:11], s41 offen lds
    s_xor_b32 s94, s13, 0
    s_mul_i32 s94, s94, 36864
    s_add_u32 s94, s94, s92
    s_lshr_b32 s40, s13, 1
    s_lshl_b32 s40, s40, 6
    s_add_u32 s94, s94, s40
    s_add_u32 m0, s66, 139264
    s_add_u32 s41, s94, 1024
    buffer_load_dwordx4 v50, s[8:11], s41 offen lds
    s_add_u32 m0, s66, 143360
    s_add_u32 s41, s94, 19456
    buffer_load_dwordx4 v50, s[8:11], s41 offen lds
    s_xor_b32 s94, s13, 2
    s_mul_i32 s94, s94, 36864
    s_add_u32 s94, s94, s92
    s_lshr_b32 s40, s13, 1
    s_lshl_b32 s40, s40, 6
    s_add_u32 s94, s94, s40
    s_add_u32 m0, s66, 147456
    s_add_u32 s41, s94, 1024
    buffer_load_dwordx4 v50, s[8:11], s41 offen lds
    s_add_u32 m0, s66, 151552
    s_add_u32 s41, s94, 19456
    buffer_load_dwordx4 v50, s[8:11], s41 offen lds
    s_waitcnt vmcnt(32)
    v_add_u32 v55, 65536, v52
    ds_read_b64_tr_b16 v[184:185], v55 offset:0
    ds_read_b64_tr_b16 v[186:187], v55 offset:256
    ds_read_b64_tr_b16 v[188:189], v55 offset:4096
    ds_read_b64_tr_b16 v[190:191], v55 offset:4352
    ds_read_b64_tr_b16 v[216:217], v55 offset:64
    ds_read_b64_tr_b16 v[218:219], v55 offset:320
    ds_read_b64_tr_b16 v[220:221], v55 offset:4160
    ds_read_b64_tr_b16 v[222:223], v55 offset:4416
    s_waitcnt lgkmcnt(0)
    s_xor_b32 s94, s13, 0
    s_mul_i32 s94, s94, 36864
    s_add_u32 s94, s94, s92
    s_lshl_b32 s40, s13, 7
    s_add_u32 s94, s94, s40
    s_add_u32 m0, s66, 65536
    s_add_u32 s41, s94, 512
    buffer_load_dwordx4 v49, s[8:11], s41 offen lds
    s_add_u32 m0, s66, 69632
    s_add_u32 s41, s94, 9728
    buffer_load_dwordx4 v49, s[8:11], s41 offen lds
    s_add_u32 m0, s66, 73728
    s_add_u32 s41, s94, 18944
    buffer_load_dwordx4 v49, s[8:11], s41 offen lds
    s_add_u32 m0, s66, 77824
    s_add_u32 s41, s94, 28160
    buffer_load_dwordx4 v49, s[8:11], s41 offen lds
    s_waitcnt vmcnt(32)
    v_add_u32 v55, 81920, v52
    ds_read_b64_tr_b16 v[192:193], v55 offset:0
    ds_read_b64_tr_b16 v[194:195], v55 offset:256
    ds_read_b64_tr_b16 v[196:197], v55 offset:4096
    ds_read_b64_tr_b16 v[198:199], v55 offset:4352
    ds_read_b64_tr_b16 v[224:225], v55 offset:64
    ds_read_b64_tr_b16 v[226:227], v55 offset:320
    ds_read_b64_tr_b16 v[228:229], v55 offset:4160
    ds_read_b64_tr_b16 v[230:231], v55 offset:4416
    s_waitcnt lgkmcnt(0)
    s_xor_b32 s94, s13, 2
    s_mul_i32 s94, s94, 36864
    s_add_u32 s94, s94, s92
    s_lshl_b32 s40, s13, 7
    s_add_u32 s94, s94, s40
    s_add_u32 m0, s66, 81920
    s_add_u32 s41, s94, 512
    buffer_load_dwordx4 v49, s[8:11], s41 offen lds
    s_add_u32 m0, s66, 86016
    s_add_u32 s41, s94, 9728
    buffer_load_dwordx4 v49, s[8:11], s41 offen lds
    s_add_u32 m0, s66, 90112
    s_add_u32 s41, s94, 18944
    buffer_load_dwordx4 v49, s[8:11], s41 offen lds
    s_add_u32 m0, s66, 94208
    s_add_u32 s41, s94, 28160
    buffer_load_dwordx4 v49, s[8:11], s41 offen lds
    s_waitcnt vmcnt(32)
    v_add_u32 v55, 98304, v52
    ds_read_b64_tr_b16 v[200:201], v55 offset:0
    ds_read_b64_tr_b16 v[202:203], v55 offset:256
    ds_read_b64_tr_b16 v[204:205], v55 offset:4096
    ds_read_b64_tr_b16 v[206:207], v55 offset:4352
    ds_read_b64_tr_b16 v[232:233], v55 offset:64
    ds_read_b64_tr_b16 v[234:235], v55 offset:320
    ds_read_b64_tr_b16 v[236:237], v55 offset:4160
    ds_read_b64_tr_b16 v[238:239], v55 offset:4416
    s_waitcnt lgkmcnt(0)
    s_xor_b32 s94, s13, 1
    s_mul_i32 s94, s94, 36864
    s_add_u32 s94, s94, s92
    s_lshl_b32 s40, s13, 7
    s_add_u32 s94, s94, s40
    s_add_u32 m0, s66, 98304
    s_add_u32 s41, s94, 512
    buffer_load_dwordx4 v49, s[8:11], s41 offen lds
    s_add_u32 m0, s66, 102400
    s_add_u32 s41, s94, 9728
    buffer_load_dwordx4 v49, s[8:11], s41 offen lds
    s_add_u32 m0, s66, 106496
    s_add_u32 s41, s94, 18944
    buffer_load_dwordx4 v49, s[8:11], s41 offen lds
    s_add_u32 m0, s66, 110592
    s_add_u32 s41, s94, 28160
    buffer_load_dwordx4 v49, s[8:11], s41 offen lds
    s_waitcnt vmcnt(20)
    v_add_u32 v55, 0, v51
    v_xor_b32 v56, 32, v55
    ds_read_b64_tr_b16 v[0:1], v55 offset:0
    ds_read_b64_tr_b16 v[2:3], v55 offset:256
    ds_read_b64_tr_b16 v[4:5], v55 offset:8192
    ds_read_b64_tr_b16 v[6:7], v55 offset:8448
    ds_read_b64_tr_b16 v[8:9], v56 offset:0
    ds_read_b64_tr_b16 v[10:11], v56 offset:256
    ds_read_b64_tr_b16 v[12:13], v56 offset:8192
    ds_read_b64_tr_b16 v[14:15], v56 offset:8448
    s_waitcnt lgkmcnt(0)
    ds_write_b128 v61, v[0:3] offset:0
    ds_write_b128 v61, v[4:7] offset:4096
    ds_write_b128 v61, v[8:11] offset:8192
    ds_write_b128 v61, v[12:15] offset:12288
    s_waitcnt lgkmcnt(0)
    v_add_u32 v55, 16384, v51
    v_xor_b32 v56, 32, v55
    ds_read_b64_tr_b16 v[0:1], v55 offset:0
    ds_read_b64_tr_b16 v[2:3], v55 offset:256
    ds_read_b64_tr_b16 v[4:5], v55 offset:8192
    ds_read_b64_tr_b16 v[6:7], v55 offset:8448
    ds_read_b64_tr_b16 v[8:9], v56 offset:0
    ds_read_b64_tr_b16 v[10:11], v56 offset:256
    ds_read_b64_tr_b16 v[12:13], v56 offset:8192
    ds_read_b64_tr_b16 v[14:15], v56 offset:8448
    s_waitcnt lgkmcnt(0)
    ds_write_b128 v61, v[0:3] offset:16384
    ds_write_b128 v61, v[4:7] offset:20480
    ds_write_b128 v61, v[8:11] offset:24576
    ds_write_b128 v61, v[12:15] offset:28672
    s_waitcnt lgkmcnt(0)
    v_add_u32 v55, 32768, v51
    v_xor_b32 v56, 32, v55
    ds_read_b64_tr_b16 v[0:1], v55 offset:0
    ds_read_b64_tr_b16 v[2:3], v55 offset:256
    ds_read_b64_tr_b16 v[4:5], v55 offset:8192
    ds_read_b64_tr_b16 v[6:7], v55 offset:8448
    ds_read_b64_tr_b16 v[8:9], v56 offset:0
    ds_read_b64_tr_b16 v[10:11], v56 offset:256
    ds_read_b64_tr_b16 v[12:13], v56 offset:8192
    ds_read_b64_tr_b16 v[14:15], v56 offset:8448
    s_waitcnt lgkmcnt(0)
    ds_write_b128 v61, v[0:3] offset:32768
    ds_write_b128 v61, v[4:7] offset:36864
    ds_write_b128 v61, v[8:11] offset:40960
    ds_write_b128 v61, v[12:15] offset:45056
    s_waitcnt lgkmcnt(0)
    v_add_u32 v55, 49152, v51
    v_xor_b32 v56, 32, v55
    ds_read_b64_tr_b16 v[0:1], v55 offset:0
    ds_read_b64_tr_b16 v[2:3], v55 offset:256
    ds_read_b64_tr_b16 v[4:5], v55 offset:8192
    ds_read_b64_tr_b16 v[6:7], v55 offset:8448
    ds_read_b64_tr_b16 v[8:9], v56 offset:0
    ds_read_b64_tr_b16 v[10:11], v56 offset:256
    ds_read_b64_tr_b16 v[12:13], v56 offset:8192
    ds_read_b64_tr_b16 v[14:15], v56 offset:8448
    s_waitcnt lgkmcnt(0)
    ds_write_b128 v61, v[0:3] offset:49152
    ds_write_b128 v61, v[4:7] offset:53248
    ds_write_b128 v61, v[8:11] offset:57344
    ds_write_b128 v61, v[12:15] offset:61440
    s_waitcnt lgkmcnt(0)
    s_waitcnt vmcnt(16)
    v_add_u32 v55, 122880, v52
    ds_read_b64_tr_b16 v[0:1], v55 offset:0
    ds_read_b64_tr_b16 v[2:3], v55 offset:256
    ds_read_b64_tr_b16 v[4:5], v55 offset:4096
    ds_read_b64_tr_b16 v[6:7], v55 offset:4352
    ds_read_b64_tr_b16 v[8:9], v55 offset:64
    ds_read_b64_tr_b16 v[10:11], v55 offset:320
    ds_read_b64_tr_b16 v[12:13], v55 offset:4160
    ds_read_b64_tr_b16 v[14:15], v55 offset:4416
    s_waitcnt lgkmcnt(0)
    s_barrier
    ds_write_b128 v63, v[0:3] offset:24576
    ds_write_b128 v63, v[4:7] offset:28672
    s_barrier
    ds_write_b128 v63, v[8:11] offset:32768
    ds_write_b128 v63, v[12:15] offset:36864
    s_waitcnt lgkmcnt(0)
    s_waitcnt vmcnt(12)
    v_add_u32 v55, 139264, v53
    ds_read_b64_tr_b16 v[0:1], v55 offset:0
    ds_read_b64_tr_b16 v[2:3], v55 offset:128
    ds_read_b64_tr_b16 v[4:5], v55 offset:512
    ds_read_b64_tr_b16 v[6:7], v55 offset:640
    ds_read_b64_tr_b16 v[8:9], v55 offset:8192
    ds_read_b64_tr_b16 v[10:11], v55 offset:8320
    ds_read_b64_tr_b16 v[12:13], v55 offset:8704
    ds_read_b64_tr_b16 v[14:15], v55 offset:8832
    s_waitcnt lgkmcnt(0)
    s_barrier
    ds_write_b128 v63, v[0:3] offset:40960
    ds_write_b128 v63, v[4:7] offset:45056
    s_barrier
    ds_write_b128 v63, v[8:11] offset:49152
    ds_write_b128 v63, v[12:15] offset:53248
    s_waitcnt lgkmcnt(0)
    s_waitcnt vmcnt(8)
    v_add_u32 v55, 65536, v52
    ds_read_b64_tr_b16 v[0:1], v55 offset:0
    ds_read_b64_tr_b16 v[2:3], v55 offset:256
    ds_read_b64_tr_b16 v[4:5], v55 offset:4096
    ds_read_b64_tr_b16 v[6:7], v55 offset:4352
    ds_read_b64_tr_b16 v[8:9], v55 offset:64
    ds_read_b64_tr_b16 v[10:11], v55 offset:320
    ds_read_b64_tr_b16 v[12:13], v55 offset:4160
    ds_read_b64_tr_b16 v[14:15], v55 offset:4416
    s_waitcnt lgkmcnt(0)
    ds_write_b128 v62, v[0:3] offset:8192
    ds_write_b128 v62, v[4:7] offset:12288
    ds_write_b128 v62, v[8:11] offset:16384
    ds_write_b128 v62, v[12:15] offset:20480
    s_waitcnt lgkmcnt(0)
    s_waitcnt vmcnt(4)
    v_add_u32 v55, 81920, v52
    ds_read_b64_tr_b16 v[0:1], v55 offset:0
    ds_read_b64_tr_b16 v[2:3], v55 offset:256
    ds_read_b64_tr_b16 v[4:5], v55 offset:4096
    ds_read_b64_tr_b16 v[6:7], v55 offset:4352
    ds_read_b64_tr_b16 v[8:9], v55 offset:64
    ds_read_b64_tr_b16 v[10:11], v55 offset:320
    ds_read_b64_tr_b16 v[12:13], v55 offset:4160
    ds_read_b64_tr_b16 v[14:15], v55 offset:4416
    s_waitcnt lgkmcnt(0)
    ds_write_b128 v62, v[0:3] offset:24576
    ds_write_b128 v62, v[4:7] offset:28672
    ds_write_b128 v62, v[8:11] offset:32768
    ds_write_b128 v62, v[12:15] offset:36864
    s_waitcnt lgkmcnt(0)
    s_waitcnt vmcnt(0)
    v_add_u32 v55, 98304, v52
    ds_read_b64_tr_b16 v[240:241], v55 offset:0
    ds_read_b64_tr_b16 v[242:243], v55 offset:256
    ds_read_b64_tr_b16 v[244:245], v55 offset:4096
    ds_read_b64_tr_b16 v[246:247], v55 offset:4352
    ds_read_b64_tr_b16 v[248:249], v55 offset:64
    ds_read_b64_tr_b16 v[250:251], v55 offset:320
    ds_read_b64_tr_b16 v[252:253], v55 offset:4160
    ds_read_b64_tr_b16 v[254:255], v55 offset:4416
    s_waitcnt lgkmcnt(0)
    s_barrier
    v_bfe_u32 v40, v61, 4, 4
    v_bfe_u32 v41, v61, 8, 1
    v_lshlrev_b32 v41, 2, v41
    v_sub_u32 v41, v40, v41
    v_mov_b32 v42, 0x3f80
    v_mov_b32 v43, 0x3f800000
    v_cmp_eq_u32 vcc, 0, v41
    s_nop 1
    v_cndmask_b32 v32, 0, v42, vcc
    v_cmp_eq_u32 vcc, 1, v41
    s_nop 1
    v_cndmask_b32 v32, v32, v43, vcc
    v_cmp_eq_u32 vcc, 0, v40
    s_nop 1
    v_cndmask_b32 v36, 0, v42, vcc
    v_cmp_eq_u32 vcc, 1, v40
    s_nop 1
    v_cndmask_b32 v36, v36, v43, vcc
    v_cmp_eq_u32 vcc, 2, v41
    s_nop 1
    v_cndmask_b32 v33, 0, v42, vcc
    v_cmp_eq_u32 vcc, 3, v41
    s_nop 1
    v_cndmask_b32 v33, v33, v43, vcc
    v_cmp_eq_u32 vcc, 2, v40
    s_nop 1
    v_cndmask_b32 v37, 0, v42, vcc
    v_cmp_eq_u32 vcc, 3, v40
    s_nop 1
    v_cndmask_b32 v37, v37, v43, vcc
    v_cmp_eq_u32 vcc, 8, v41
    s_nop 1
    v_cndmask_b32 v34, 0, v42, vcc
    v_cmp_eq_u32 vcc, 9, v41
    s_nop 1
    v_cndmask_b32 v34, v34, v43, vcc
    v_cmp_eq_u32 vcc, 4, v40
    s_nop 1
    v_cndmask_b32 v38, 0, v42, vcc
    v_cmp_eq_u32 vcc, 5, v40
    s_nop 1
    v_cndmask_b32 v38, v38, v43, vcc
    v_cmp_eq_u32 vcc, 10, v41
    s_nop 1
    v_cndmask_b32 v35, 0, v42, vcc
    v_cmp_eq_u32 vcc, 11, v41
    s_nop 1
    v_cndmask_b32 v35, v35, v43, vcc
    v_cmp_eq_u32 vcc, 6, v40
    s_nop 1
    v_cndmask_b32 v39, 0, v42, vcc
    v_cmp_eq_u32 vcc, 7, v40
    s_nop 1
    v_cndmask_b32 v39, v39, v43, vcc
    ds_write_b128 v65, v[32:35] offset:9216
    ds_write_b128 v65, v[36:39] offset:10240
    v_mov_b32 v44, s95
    v_mov_b32 v45, s95
    v_mov_b32 v46, s95
    v_mov_b32 v47, s95
    v_mov_b32 v48, 118784
    ds_write_b128 v48, v[44:47]
    s_waitcnt vmcnt(0) lgkmcnt(0)
    s_barrier
    v_mov_b32 v2, 1
    s_cmp_lg_u32 s13, 0
    s_cbranch_scc1 cs_noarr
    s_mov_b64 exec, 1
    buffer_atomic_add v2, off, s[96:99], 0 offset:212
    s_mov_b32 s40, 16777216
    s_mov_b32 s42, 2
cs_startpoll:
    buffer_load_dword v3, off, s[96:99], 0 offset:212 sc1
    s_sub_u32 s40, s40, 1
    s_cbranch_scc1 cs_decide
    s_waitcnt vmcnt(0)
    v_readfirstlane_b32 s41, v3
    s_nop 1
    s_cmp_lt_u32 s41, 32
    s_cbranch_scc1 cs_startpoll
    s_mov_b32 s42, 1
cs_decide:
    s_mov_b64 exec, -1
cs_noarr:
    s_barrier
    s_lshr_b32 s92, s12, 1
    s_lshl_b32 s92, s92, 8
    s_add_u32 s92, s92, 125829120
    s_add_u32 s93, s95, 4
    v_bfe_u32 v2, v61, 4, 6
    v_min_u32 v2, 11, v2
    v_lshlrev_b32 v2, 2, v2
    s_mov_b32 s94, 4194304
cs_kv0:
    buffer_load_dword v3, v2, s[4:7], s92 offen sc1
    s_sub_u32 s94, s94, 1
    s_cbranch_scc1 cs_kv0_go
    s_waitcnt vmcnt(0)
    v_subrev_u32 v3, s93, v3
    v_cmp_lt_u32 vcc, 64, v3
    s_cbranch_vccz cs_kv0_go
    s_sleep 2
    s_branch cs_kv0
cs_kv0_go:
    s_mov_b32 s44, 0x3e0293ee
    s_mov_b32 s45, s44
    s_or_b32 s46, s44, 0x80000000
    s_mov_b32 s47, 128
    s_mov_b32 s60, 0x3f803f80
    s_mov_b32 s61, s60
    s_mov_b32 s62, 0x3e803e80
    s_mov_b32 s63, s62
    s_mov_b32 s28, 0
    s_mov_b32 s14, 68157440
    s_lshl_b32 s24, s12, 14
    s_add_u32 s24, s24, 0
    s_mul_i32 s40, s13, 3072
    s_add_u32 s23, s24, s40
    s_lshl_b32 s20, s12, 7
    s_add_u32 s20, s20, 68222976
    s_add_u32 s21, s20, 65536
    s_add_u32 s38, s20, 4096
    s_add_u32 s39, s21, 4096
    s_lshl_b32 s22, s12, 7
    s_add_u32 s22, s22, 68231168
    s_lshl_b32 s40, s12, 12
    s_add_u32 s25, s40, 79560704
    s_add_u32 s26, s40, 88997888
    s_lshl_b32 s65, s12, 9
    s_add_u32 s65, s65, 90177536
    s_lshl_b32 s40, s13, 5
    s_or_b32 s40, s40, s12
    s_cmp_lt_u32 s40, 24
    s_cselect_b32 s36, 0x1ffffff, 0
    s_mov_b32 s37, 0
    s_lshl_b32 s27, s12, 7
    s_add_u32 s27, s27, 125845504
    s_lshl_b32 s40, s13, 2
    s_add_u32 s27, s27, s40
    s_mov_b32 m0, 111616
    v_lshlrev_b32 v56, 2, v61
    buffer_load_dword v56, s[4:7], s24 offen sc1 lds
    s_add_u32 s24, s24, 524288
    buffer_load_dword v56, s[4:7], s24 offen sc1 lds
    s_add_u32 s24, s24, 524288
    s_add_u32 s15, s14, 4096
    s_add_u32 s16, s14, 8192
    ds_read_b128 v[32:35], v63 offset:57344
    ds_read_b128 v[36:39], v63 offset:61440
    ds_read_b128 v[40:43], v61 offset:0
    ds_read_b128 v[44:47], v61 offset:4096
    ds_read_b128 v[48:51], v61 offset:8192
    ds_read_b128 v[52:55], v61 offset:12288
    s_mov_b32 s29, 1048576
    buffer_load_dwordx4 v[24:27], v61, s[4:7], s14 offen sc1
.p2align 6
cs_loop:
    v_mov_b64 v[0:1], 0
    v_mov_b64 v[2:3], 0
    v_mov_b64 v[4:5], 0
    v_mov_b64 v[6:7], 0
    v_mov_b64 v[8:9], 0
    v_mov_b64 v[10:11], 0
    v_mov_b64 v[12:13], 0
    v_mov_b64 v[14:15], 0
    v_mov_b64 v[16:17], 0
    v_mov_b64 v[18:19], 0
cs_loop2:
    v_mov_b64 v[20:21], 0
    v_mov_b64 v[22:23], 0
    v_lshrrev_b32 v56, 2, v61
    v_add_u32 v58, 106496, v56
    s_mov_b32 s29, 1048576
    s_waitcnt lgkmcnt(0)
cs_chk0:
    s_waitcnt vmcnt(0)
    v_max3_u32 v57, v24, v25, v26
    v_max_u32 v57, v57, v27
    v_cmp_eq_u32 vcc, -1, v57
    ds_write_b128 v62, v[24:27] offset:40960
    s_cbranch_vccnz cs_spin0
    v_smfmac_f32_16x16x64_bf16 v[8:11], v[24:27], v[32:39], v60
    buffer_load_dwordx4 v[28:31], v61, s[4:7], s15 offen sc1
    buffer_load_dword v59, v56, s[4:7], s16 offen sc1
    v_smfmac_f32_16x16x64_bf16 v[4:7], v[24:27], v[40:47], v60
    ds_read_b128 v[32:35], v61 offset:16384
    v_smfmac_f32_16x16x64_bf16 v[12:15], v[24:27], v[48:55], v60
    ds_read_b128 v[36:39], v61 offset:20480
    s_waitcnt lgkmcnt(2)
    s_barrier
    ds_read_b128 v[48:51], v63 offset:0
    v_smfmac_f32_16x16x64_bf16 v[0:3], v[24:27], a[0:7], v60
    ds_read_b128 v[40:43], v61 offset:24576
    v_smfmac_f32_16x16x64_bf16 v[16:19], v[24:27], a[216:223], v60
    ds_read_b128 v[44:47], v61 offset:28672
    v_smfmac_f32_16x16x64_bf16 v[20:23], v[24:27], a[224:231], v60
    ds_read_b128 v[52:55], v64 offset:0
    s_waitcnt lgkmcnt(3)
    v_smfmac_f32_16x16x64_bf16 v[4:7], v[48:51], v[32:39], v60
    ds_read_b128 v[32:35], v61 offset:32768
    v_smfmac_f32_16x16x64_bf16 v[0:3], v[48:51], a[8:15], v60
    ds_read_b128 v[36:39], v61 offset:36864
    v_smfmac_f32_16x16x64_bf16 v[8:11], v[48:51], a[16:23], v60
    s_add_u32 s18, s14, s31
    s_add_u32 s41, s14, 16384
    s_waitcnt lgkmcnt(3)
    v_smfmac_f32_16x16x64_bf16 v[12:15], v[48:51], v[40:47], v60
    ds_read_b128 v[40:43], v61 offset:40960
    s_waitcnt lgkmcnt(3)
    v_smfmac_f32_16x16x64_bf16 v[0:3], v[52:55], a[24:31], v60
    ds_read_b128 v[44:47], v61 offset:45056
    v_smfmac_f32_16x16x64_bf16 v[8:11], v[52:55], a[32:39], v60
    ds_read_b128 v[48:51], v71 offset:0
    s_waitcnt lgkmcnt(3)
    v_smfmac_f32_16x16x64_bf16 v[4:7], v[52:55], v[32:39], v60
    ds_read_b128 v[32:35], v61 offset:49152
    s_waitcnt vmcnt(0)
    v_max3_u32 v57, v28, v29, v30
    ds_write_b128 v62, v[28:31] offset:45056
    v_max3_u32 v57, v57, v31, v59
    s_waitcnt lgkmcnt(3)
    v_smfmac_f32_16x16x64_bf16 v[12:15], v[52:55], v[40:47], v60
    ds_write_b32 v58, v59
    v_cmp_eq_u32 vcc, -1, v57
    s_waitcnt lgkmcnt(3)
    v_smfmac_f32_16x16x64_bf16 v[0:3], v[48:51], a[40:47], v60
    ds_read_b128 v[36:39], v61 offset:53248
    v_smfmac_f32_16x16x64_bf16 v[8:11], v[48:51], a[48:55], v60
    ds_read_b128 v[40:43], v61 offset:57344
    s_cbranch_vccnz cs_spin1
cs_go1:
    v_smfmac_f32_16x16x64_bf16 v[0:3], v[28:31], a[56:63], v60
    ds_read_b128 v[44:47], v61 offset:61440
    v_smfmac_f32_16x16x64_bf16 v[8:11], v[28:31], a[64:71], v60
    s_and_b32 s41, s41, 65535
    s_add_u32 s41, s41, 68157440
    v_smfmac_f32_16x16x64_bf16 v[4:7], v[28:31], a[136:143], v60
    s_waitcnt lgkmcnt(3)
    s_barrier
    ds_read_b128 v[52:55], v63 offset:4096
    s_waitcnt lgkmcnt(3)
    v_smfmac_f32_16x16x64_bf16 v[4:7], v[48:51], v[32:39], v60
    ds_read_b128 v[56:59], v71 offset:4096
    v_smfmac_f32_16x16x64_bf16 v[12:15], v[28:31], a[144:151], v60
    buffer_load_dwordx4 v[32:35], v61, s[4:7], s23 offen offset:0 sc1
    s_waitcnt lgkmcnt(2)
    v_smfmac_f32_16x16x64_bf16 v[12:15], v[48:51], v[40:47], v60
    ds_read_b128 v[24:27], v65 offset:8192
    v_smfmac_f32_16x16x64_bf16 v[16:19], v[28:31], v[96:103], v60
    ds_read_b128 v[48:51], v64 offset:4096
    v_smfmac_f32_16x16x64_bf16 v[20:23], v[28:31], v[104:111], v60
    buffer_load_dwordx4 v[36:39], v61, s[4:7], s23 offen offset:1024 sc1
    s_waitcnt lgkmcnt(3)
    v_smfmac_f32_16x16x64_bf16 v[0:3], v[52:55], a[72:79], v60
    v_lshlrev_b32 v28, 2, v61
    v_smfmac_f32_16x16x64_bf16 v[4:7], v[52:55], a[152:159], v60
    s_add_u32 s17, s41, s31
    s_and_b32 s30, s28, 1
    s_waitcnt lgkmcnt(2)
    v_smfmac_f32_16x16x64_bf16 v[0:3], v[56:59], a[104:111], v60
    buffer_load_dwordx4 v[40:43], v61, s[4:7], s23 offen offset:2048 sc1
    v_smfmac_f32_16x16x64_bf16 v[4:7], v[56:59], a[184:191], v60
    s_waitcnt lgkmcnt(1)
    v_smfmac_f32_16x16x64_bf16 v[0:3], v[24:27], a[120:127], v60
    v_smfmac_f32_16x16x64_bf16 v[4:7], v[24:27], a[200:207], v60
    buffer_load_dwordx4 v[44:47], v61, s[4:7], s23 offen offset:3072 sc1
    s_waitcnt lgkmcnt(0)
    v_smfmac_f32_16x16x64_bf16 v[0:3], v[48:51], a[88:95], v60
    v_smfmac_f32_16x16x64_bf16 v[4:7], v[48:51], a[168:175], v60
    s_barrier
    v_smfmac_f32_16x16x64_bf16 v[8:11], v[52:55], a[80:87], v60
    buffer_load_dword v28, s[4:7], s24 offen sc1 lds
    v_smfmac_f32_16x16x64_bf16 v[12:15], v[52:55], a[160:167], v60
    ds_read_b128 v[28:31], v65 offset:9216
    v_smfmac_f32_16x16x64_bf16 v[8:11], v[56:59], a[112:119], v60
    v_cvt_pk_bf16_f32 v0, v0, v1
    v_smfmac_f32_16x16x64_bf16 v[12:15], v[56:59], a[192:199], v60
    v_cvt_pk_bf16_f32 v1, v2, v3
    v_smfmac_f32_16x16x64_bf16 v[8:11], v[24:27], a[128:135], v60
    v_cvt_pk_bf16_f32 v2, v4, v5
    v_smfmac_f32_16x16x64_bf16 v[8:11], v[48:51], a[96:103], v60
    v_cvt_pk_bf16_f32 v3, v6, v7
    v_smfmac_f32_16x16x64_bf16 v[12:15], v[24:27], a[208:215], v60
    s_cmp_eq_u32 s28, 63
    v_smfmac_f32_16x16x64_bf16 v[12:15], v[48:51], a[176:183], v60
    s_waitcnt lgkmcnt(0)
    v_cvt_pk_bf16_f32 v8, v8, v9
    v_mfma_f32_16x16x32_bf16 v[4:7], v[0:3], v[28:31], 0
    v_cvt_pk_bf16_f32 v9, v10, v11
    s_waitcnt vmcnt(3)
    s_nop 1
    v_cvt_pk_bf16_f32 v10, v12, v13
    v_cvt_pk_bf16_f32 v11, v14, v15
    s_nop 1
    v_mfma_f32_16x16x32_bf16 v[12:15], v[8:11], v[28:31], 0
    v_cvt_pk_bf16_f32 v0, v4, v5
    v_cvt_pk_bf16_f32 v1, v6, v7
    v_smfmac_f32_16x16x64_bf16 v[16:19], v[24:27], v[160:167], v60
    s_mov_b64 exec, s[36:37]
    ds_read_b128 v[28:31], v69
    s_mov_b64 exec, -1
    s_nop 0
    v_cvt_pk_bf16_f32 v2, v12, v13
    v_cvt_pk_bf16_f32 v3, v14, v15
    s_cbranch_scc1 cs_last
    s_nop 0
    v_mfma_f32_16x16x32_bf16 v[8:11], v[0:3], v[0:3], 0
    v_mfma_f32_16x16x32_bf16 v[4:7], v[36:39], v[0:3], 0
    ds_read_b128 v[36:39], v64 offset:0
    v_mfma_f32_16x16x32_bf16 v[12:15], v[32:35], v[0:3], 0
    ds_read_b128 v[32:35], v63 offset:0
    v_mov_b32_dpp v8, v10 row_ror:8 row_mask:0xf bank_mask:0xc
    v_mov_b32_dpp v9, v11 row_ror:8 row_mask:0xf bank_mask:0xc
    ds_write_b64 v70, v[8:9]
    s_nop 3
    v_mov_b32_dpp v12, v4 row_ror:8 row_mask:0xf bank_mask:0xc
    v_mov_b32_dpp v13, v5 row_ror:8 row_mask:0xf bank_mask:0xc
    v_mov_b32_dpp v14, v6 row_ror:8 row_mask:0xf bank_mask:0xc
    v_mov_b32_dpp v15, v7 row_ror:8 row_mask:0xf bank_mask:0xc
    ds_write_b128 v62, v[12:15] offset:55296
    v_smfmac_f32_16x16x64_bf16 v[20:23], v[24:27], v[168:175], v60
    v_smfmac_f32_16x16x64_bf16 v[16:19], v[56:59], v[144:151], v60
    v_or_b32 v27, 512, v65
    v_smfmac_f32_16x16x64_bf16 v[20:23], v[56:59], v[152:159], v60
    s_waitcnt vmcnt(1)
    s_waitcnt lgkmcnt(4)
    s_mov_b64 exec, s[36:37]
    s_cbranch_execz cs_np3696
    buffer_store_dwordx4 v[28:31], v61, s[4:7], s65 offen sc1
cs_np3696:
    s_mov_b64 exec, -1
    v_smfmac_f32_16x16x64_bf16 v[16:19], v[48:51], v[128:135], v60
    s_waitcnt lgkmcnt(0)
    s_barrier
    ds_read_b128 v[4:7], v63 offset:14336
    ds_read_b128 v[8:11], v64 offset:14336
    ds_read_b128 v[0:3], v71 offset:14336
    v_smfmac_f32_16x16x64_bf16 v[20:23], v[48:51], v[136:143], v60
    ds_read_b128 v[56:59], v27 offset:10752
    v_smfmac_f32_16x16x64_bf16 v[16:19], v[52:55], v[112:119], v60
    ds_read_b128 v[24:27], v27 offset:11264
    v_smfmac_f32_16x16x64_bf16 v[20:23], v[52:55], v[120:127], v60
    ds_read_b128 v[28:31], v71 offset:0
    v_smfmac_f32_16x16x64_bf16 v[16:19], v[32:35], a[232:239], v60
    v_smfmac_f32_16x16x64_bf16 v[20:23], v[32:35], a[240:247], v60
    s_waitcnt lgkmcnt(5)
    v_add_f32 v12, v12, v4
    v_smfmac_f32_16x16x64_bf16 v[16:19], v[36:39], a[248:255], v60
    v_add_f32 v13, v13, v5
    v_smfmac_f32_16x16x64_bf16 v[20:23], v[36:39], v[72:79], v60
    v_add_f32 v14, v14, v6
    s_waitcnt lgkmcnt(0)
    v_smfmac_f32_16x16x64_bf16 v[16:19], v[28:31], v[80:87], v60
    v_add_f32 v15, v15, v7
    v_smfmac_f32_16x16x64_bf16 v[20:23], v[28:31], v[88:95], v60
    v_add_f32 v8, v8, v0
    v_add_f32 v9, v9, v1
    v_add_f32 v10, v10, v2
    v_add_f32 v11, v11, v3
    v_pk_add_f32 v[56:57], v[56:57], v[58:59]
    v_pk_add_f32 v[24:25], v[24:25], v[26:27]
    v_pk_add_f32 v[12:13], v[12:13], v[8:9]
    v_pk_add_f32 v[14:15], v[14:15], v[10:11]
    v_pk_add_f32 v[56:57], v[56:57], v[24:25]
    v_max3_f32 v4, v12, v13, v14
    v_max3_f32 v5, v15, v56, v57
    v_max_f32 v4, v4, v5
    v_cvt_pk_bf16_f32 v16, v16, v17
    v_cvt_pk_bf16_f32 v17, v18, v19
    v_max_f32_dpp v4, v4, v4 row_ror:8 row_mask:0xf bank_mask:0xf
    v_mov_b32 v5, v4
    v_cvt_pk_bf16_f32 v18, v20, v21
    v_cvt_pk_bf16_f32 v19, v22, v23
    v_permlane32_swap_b32 v4, v5
    v_max_f32 v4, v4, v5
    v_mov_b32 v5, v4
    v_mov_b64 v[24:25], s[62:63]
    v_mov_b64 v[26:27], s[60:61]
    v_permlane16_swap_b32 v4, v5
    v_max_f32 v4, v4, v5
    v_mul_f32 v4, s46, v4
    v_pk_fma_f32 v[12:13], v[12:13], s[44:45], v[4:5] op_sel_hi:[1,1,0]
    v_pk_fma_f32 v[14:15], v[14:15], s[44:45], v[4:5] op_sel_hi:[1,1,0]
    v_pk_fma_f32 v[56:57], v[56:57], s[44:45], v[4:5] op_sel_hi:[1,1,0]
    v_exp_f32 v12, v12
    v_exp_f32 v13, v13
    v_exp_f32 v14, v14
    v_cvt_pk_bf16_f32 v8, v12, v13
    v_exp_f32 v15, v15
    v_exp_f32 v56, v56
    v_cvt_pk_bf16_f32 v9, v14, v15
    v_mov_b32_dpp v10, v8 row_ror:8 row_mask:0xf bank_mask:0xf
    v_exp_f32 v57, v57
    v_mov_b32_dpp v11, v9 row_ror:8 row_mask:0xf bank_mask:0xf
    v_cvt_pk_bf16_f32 v6, v56, v57
    s_nop 0
    v_mfma_f32_16x16x32_bf16 v[56:59], v[40:43], v[8:11], 0
    ds_read_b128 v[48:51], v62 offset:8192
    v_mov_b32_dpp v7, v6 row_ror:8 row_mask:0xf bank_mask:0xf
    v_mfma_f32_16x16x32_bf16 v[20:23], v[44:47], v[8:11], 0
    ds_read_b128 v[52:55], v62 offset:12288
    v_bfe_u32 v4, v61, 7, 1
    v_mfma_f32_16x16x32_bf16 v[28:31], v[24:27], v[6:9], 0
    v_lshl_add_u32 v4, v4, 3, v68
    v_mov_b64 v[32:33], 0
    v_mfma_f32_16x16x16_bf16 v[56:59], v[16:17], v[6:7], v[56:59]
    v_mov_b64 v[34:35], 0
    v_mov_b64 v[36:37], 0
    v_mfma_f32_16x16x16_bf16 v[20:23], v[18:19], v[6:7], v[20:23]
    v_add_f32_dpp v28, v28, v28 row_ror:8 row_mask:0xf bank_mask:0xf
    v_rcp_f32 v28, v28
    v_mov_b64 v[38:39], 0
    s_nop 0
    v_mul_f32 v56, v56, v28
    v_mul_f32 v57, v57, v28
    v_mul_f32 v58, v58, v28
    v_mul_f32 v59, v59, v28
    v_mul_f32_dpp v56, v20, v28 row_ror:8 row_mask:0xf bank_mask:0xc
    v_mul_f32_dpp v57, v21, v28 row_ror:8 row_mask:0xf bank_mask:0xc
    v_mul_f32_dpp v58, v22, v28 row_ror:8 row_mask:0xf bank_mask:0xc
    v_mul_f32_dpp v59, v23, v28 row_ror:8 row_mask:0xf bank_mask:0xc
    v_cvt_pk_bf16_f32 v56, v56, v57
    v_cvt_pk_bf16_f32 v57, v58, v59
    ds_write_b64 v4, v[56:57]
    ds_read_b128 v[0:3], v68
    ds_read_b128 v[40:43], v62 offset:16384
    ds_read_b128 v[44:47], v62 offset:20480
    v_xor_b32 v24, 512, v68
    v_xor_b32 v28, 1024, v68
    v_xor_b32 v58, 1536, v68
    v_mov_b64 v[8:9], 0
    v_mov_b64 v[10:11], 0
    v_mov_b64 v[12:13], 0
    v_mov_b64 v[14:15], 0
    s_waitcnt lgkmcnt(3)
    s_barrier
    ds_read_b128 v[24:27], v24
    ds_read_b128 v[28:31], v28
    s_waitcnt lgkmcnt(4)
    v_smfmac_f32_16x16x64_bf16 v[32:35], v[0:3], v[176:183], v60
    ds_read_b128 v[56:59], v58
    v_smfmac_f32_16x16x64_bf16 v[36:39], v[0:3], v[208:215], v60
    v_mov_b64 v[20:21], 0
    v_smfmac_f32_16x16x64_bf16 v[8:11], v[0:3], v[48:55], v60
    ds_read_b128 v[48:51], v63 offset:40960
    v_mov_b64 v[22:23], 0
    s_waitcnt lgkmcnt(3)
    v_smfmac_f32_16x16x64_bf16 v[32:35], v[24:27], v[184:191], v60
    ds_read_b128 v[52:55], v63 offset:45056
    s_waitcnt lgkmcnt(3)
    v_smfmac_f32_16x16x64_bf16 v[32:35], v[28:31], v[192:199], v60
    s_waitcnt lgkmcnt(2)
    v_smfmac_f32_16x16x64_bf16 v[32:35], v[56:59], v[200:207], v60
    v_smfmac_f32_16x16x64_bf16 v[36:39], v[24:27], v[216:223], v60
    v_smfmac_f32_16x16x64_bf16 v[36:39], v[28:31], v[224:231], v60
    v_cvt_pk_bf16_f32 v32, v32, v33
    v_smfmac_f32_16x16x64_bf16 v[36:39], v[56:59], v[232:239], v60
    v_cvt_pk_bf16_f32 v33, v34, v35
    v_smfmac_f32_16x16x64_bf16 v[12:15], v[0:3], v[40:47], v60
    ds_read_b128 v[40:43], v63 offset:49152
    v_and_or_b32 v32, v32, -2, s30
    s_waitcnt lgkmcnt(1)
    v_smfmac_f32_16x16x64_bf16 v[20:23], v[0:3], v[48:55], v60
    buffer_store_dwordx2 v[32:33], v66, s[4:7], s20 offen sc1
    v_cvt_pk_bf16_f32 v36, v36, v37
    ds_read_b128 v[44:47], v63 offset:53248
    v_smfmac_f32_16x16x64_bf16 v[8:11], v[24:27], v[240:247], v60
    ds_read_b128 v[48:51], v62 offset:24576
    v_cvt_pk_bf16_f32 v37, v38, v39
    v_and_or_b32 v36, v36, -2, s30
    v_smfmac_f32_16x16x64_bf16 v[12:15], v[24:27], v[248:255], v60
    buffer_store_dwordx2 v[36:37], v66, s[4:7], s21 offen sc1
    ds_read_b128 v[52:55], v62 offset:28672
    ds_read_b128 v[0:3], v63 offset:24576
    ds_read_b128 v[4:7], v63 offset:28672
    s_waitcnt lgkmcnt(4)
    v_smfmac_f32_16x16x64_bf16 v[20:23], v[28:31], v[40:47], v60
    ds_read_b128 v[32:35], v63 offset:32768
    ds_read_b128 v[36:39], v63 offset:36864
    ds_read_b128 v[40:43], v62 offset:32768
    ds_read_b128 v[44:47], v62 offset:36864
    s_waitcnt lgkmcnt(6)
    v_smfmac_f32_16x16x64_bf16 v[8:11], v[28:31], v[48:55], v60
    s_nop 1
    v_cvt_pk_bf16_f32 v20, v20, v21
    v_cvt_pk_bf16_f32 v21, v22, v23
    s_waitcnt lgkmcnt(4)
    v_smfmac_f32_16x16x64_bf16 v[8:11], v[56:59], v[0:7], v60
    v_and_or_b32 v20, v20, -2, s30
    buffer_store_dwordx2 v[20:21], v67, s[4:7], s22 offen sc1
    s_waitcnt lgkmcnt(2)
    v_smfmac_f32_16x16x64_bf16 v[12:15], v[56:59], v[32:39], v60
    s_cmp_lg_u32 s13, 2
    s_waitcnt lgkmcnt(0)
    v_smfmac_f32_16x16x64_bf16 v[12:15], v[28:31], v[40:47], v60
    v_cvt_pk_bf16_f32 v8, v8, v9
    v_cvt_pk_bf16_f32 v9, v10, v11
    v_and_or_b32 v8, v8, -2, s30
    buffer_store_dwordx2 v[8:9], v66, s[4:7], s38 offen sc1
    s_nop 3
    v_cvt_pk_bf16_f32 v12, v12, v13
    v_cvt_pk_bf16_f32 v13, v14, v15
    v_and_or_b32 v12, v12, -2, s30
    buffer_store_dwordx2 v[12:13], v66, s[4:7], s39 offen sc1
    s_cbranch_scc1 cs_w013
    s_nop 15
    s_nop 15
    s_nop 15
    s_nop 15
    s_nop 15
    s_nop 15
    s_nop 15
    s_nop 15
    s_nop 15
    s_nop 15
    s_nop 15
    s_nop 15
    s_nop 7
    buffer_load_dwordx4 v[40:43], v65, s[4:7], s19 offen offset:0 sc1
    buffer_load_dwordx4 v[44:47], v65, s[4:7], s19 offen offset:1024 sc1
    buffer_load_dwordx4 v[48:51], v65, s[4:7], s19 offen offset:2048 sc1
    buffer_load_dwordx4 v[52:55], v65, s[4:7], s19 offen offset:3072 sc1
    ds_read_b128 v[56:59], v65 offset:10240
    s_add_u32 s28, s28, 1
    s_mov_b32 s14, s41
    s_add_u32 s23, s23, 524288
    s_add_u32 s24, s24, 524288
    s_add_u32 s15, s14, 4096
    s_add_u32 s16, s14, 8192
    v_mov_b32 v21, -1
    s_add_u32 s65, s65, 12288
    s_mov_b32 s40, 1
    v_mov_b64 v[0:1], 0
    v_mov_b64 v[2:3], 0
    v_mov_b64 v[4:5], 0
    v_mov_b64 v[6:7], 0
    v_mov_b64 v[8:9], 0
    v_mov_b64 v[10:11], 0
    v_mov_b64 v[12:13], 0
    v_mov_b64 v[14:15], 0
    v_mov_b64 v[16:17], 0
    v_mov_b64 v[18:19], 0
cs_chkF:
    v_mov_b32 v20, 0
    s_waitcnt vmcnt(3)
    s_waitcnt lgkmcnt(0)
    v_mfma_f32_16x16x32_bf16 v[28:31], v[40:43], v[56:59], 0
    v_bitop3_b32 v20, v20, v40, s30 bitop3:0xf6
    v_bitop3_b32 v20, v20, v42, s30 bitop3:0xf6
    s_waitcnt vmcnt(2)
    v_mfma_f32_16x16x32_bf16 v[28:31], v[44:47], v[56:59], v[28:31]
    v_bitop3_b32 v20, v20, v44, s30 bitop3:0xf6
    v_bitop3_b32 v20, v20, v46, s30 bitop3:0xf6
    s_waitcnt vmcnt(1)
    v_mfma_f32_16x16x32_bf16 v[28:31], v[48:51], v[56:59], v[28:31]
    v_bitop3_b32 v20, v20, v48, s30 bitop3:0xf6
    v_bitop3_b32 v20, v20, v50, s30 bitop3:0xf6
    s_waitcnt vmcnt(0)
    v_mfma_f32_16x16x32_bf16 v[28:31], v[52:55], v[56:59], v[28:31]
    v_bitop3_b32 v20, v20, v52, s30 bitop3:0xf6
    v_bitop3_b32 v20, v20, v54, s30 bitop3:0xf6
    v_and_b32 v20, s40, v20
    v_cmp_ne_u32 vcc, 0, v20
    s_cbranch_vccnz cs_spinF
    v_permlane32_swap_b32 v28, v30
    v_permlane32_swap_b32 v29, v31
    v_add_f32 v28, v28, v30
    v_add_f32 v30, v29, v31
    v_cvt_pk_bf16_f32 v28, v28, v30
    s_mov_b64 exec, s[32:33]
    buffer_store_dword v28, v69, s[4:7], s17 offen sc1
    buffer_store_dword v21, v69, s[4:7], s18 offen sc1
    s_mov_b64 exec, -1
    ds_read_b128 v[32:35], v63 offset:57344
    ds_read_b128 v[36:39], v63 offset:61440
    ds_read_b128 v[40:43], v61 offset:0
    ds_read_b128 v[44:47], v61 offset:4096
    ds_read_b128 v[48:51], v61 offset:8192
    ds_read_b128 v[52:55], v61 offset:12288
    s_nop 15
    s_nop 15
    s_nop 15
    s_nop 15
    s_nop 15
    s_nop 15
    s_nop 3
    buffer_load_dwordx4 v[24:27], v61, s[4:7], s14 offen sc1
    s_branch cs_loop2
cs_w013:
    ds_read_b128 v[56:59], v65 offset:10240
    ds_read_b128 v[32:35], v63 offset:57344
    ds_read_b128 v[36:39], v63 offset:61440
    ds_read_b128 v[40:43], v61 offset:0
    ds_read_b128 v[44:47], v61 offset:4096
    ds_read_b128 v[48:51], v61 offset:8192
    ds_read_b128 v[52:55], v61 offset:12288
    s_add_u32 s28, s28, 1
    s_mov_b32 s14, s41
    s_add_u32 s23, s23, 524288
    s_add_u32 s24, s24, 524288
    s_add_u32 s15, s14, 4096
    s_add_u32 s16, s14, 8192
    v_mov_b32 v21, -1
    s_add_u32 s65, s65, 12288
    s_mov_b32 s40, 1
    s_cmp_eq_u32 s64, 0
    s_cbranch_scc1 cs_w0
    s_nop 15
    s_nop 15
    s_nop 15
    s_nop 15
    s_nop 15
    s_nop 15
    s_nop 15
    s_nop 15
    s_nop 15
    s_nop 15
    s_nop 15
    s_nop 15
    s_nop 7
    buffer_load_dwordx4 v[0:3], v65, s[4:7], s19 offen offset:0 sc1
    buffer_load_dwordx4 v[4:7], v65, s[4:7], s19 offen offset:1024 sc1
    buffer_load_dwordx4 v[8:11], v65, s[4:7], s19 offen offset:2048 sc1
    buffer_load_dwordx4 v[12:15], v65, s[4:7], s19 offen offset:3072 sc1
cs_chkG:
    v_mov_b32 v20, 0
    s_waitcnt vmcnt(3)
    s_waitcnt lgkmcnt(6)
    v_mfma_f32_16x16x32_bf16 v[28:31], v[0:3], v[56:59], 0
    v_bitop3_b32 v20, v20, v0, s30 bitop3:0xf6
    v_bitop3_b32 v20, v20, v2, s30 bitop3:0xf6
    s_waitcnt vmcnt(2)
    v_mfma_f32_16x16x32_bf16 v[28:31], v[4:7], v[56:59], v[28:31]
    v_bitop3_b32 v20, v20, v4, s30 bitop3:0xf6
    v_bitop3_b32 v20, v20, v6, s30 bitop3:0xf6
    s_waitcnt vmcnt(1)
    v_mfma_f32_16x16x32_bf16 v[28:31], v[8:11], v[56:59], v[28:31]
    v_bitop3_b32 v20, v20, v8, s30 bitop3:0xf6
    v_bitop3_b32 v20, v20, v10, s30 bitop3:0xf6
    s_waitcnt vmcnt(0)
    v_mfma_f32_16x16x32_bf16 v[28:31], v[12:15], v[56:59], v[28:31]
    v_bitop3_b32 v20, v20, v12, s30 bitop3:0xf6
    v_bitop3_b32 v20, v20, v14, s30 bitop3:0xf6
    v_and_b32 v20, s40, v20
    v_cmp_ne_u32 vcc, 0, v20
    s_cbranch_vccnz cs_spinG
    v_permlane32_swap_b32 v28, v30
    v_permlane32_swap_b32 v29, v31
    v_add_f32 v28, v28, v30
    v_add_f32 v30, v29, v31
    s_cmp_eq_u32 s13, 3
    s_cbranch_scc1 cs_w3
    v_mov_b32 v29, v28
    v_mov_b32 v31, v30
    s_nop 0
    v_permlane16_swap_b32 v28, v29
    v_permlane16_swap_b32 v30, v31
    v_add_f32 v28, v28, v29
    v_add_f32 v30, v30, v31
cs_w3:
    v_cvt_pk_bf16_f32 v28, v28, v30
    s_mov_b64 exec, s[32:33]
    buffer_store_dword v28, v69, s[4:7], s17 offen sc1
    buffer_store_dword v21, v69, s[4:7], s18 offen sc1
    s_mov_b64 exec, -1
    buffer_load_dwordx4 v[24:27], v61, s[4:7], s14 offen sc1
    s_branch cs_loop
cs_w0:
    v_mov_b64 v[0:1], 0
    v_mov_b64 v[2:3], 0
    v_mov_b64 v[4:5], 0
    v_mov_b64 v[6:7], 0
    v_mov_b64 v[8:9], 0
    v_mov_b64 v[10:11], 0
    v_mov_b64 v[12:13], 0
    v_mov_b64 v[14:15], 0
    v_mov_b64 v[16:17], 0
    v_mov_b64 v[18:19], 0
    s_cmp_lg_u32 s28, 22
    s_cbranch_scc1 cs_nokv
    s_lshr_b32 s92, s12, 1
    s_lshl_b32 s92, s92, 8
    s_add_u32 s92, s92, 125829120
    s_add_u32 s93, s95, 63
    v_bfe_u32 v28, v61, 4, 6
    v_min_u32 v28, 11, v28
    v_lshlrev_b32 v28, 2, v28
    s_mov_b32 s94, 4194304
cs_kv1:
    buffer_load_dword v29, v28, s[4:7], s92 offen sc1
    s_sub_u32 s94, s94, 1
    s_cbranch_scc1 cs_kv1_go
    s_waitcnt vmcnt(0)
    v_subrev_u32 v29, s93, v29
    v_cmp_lt_u32 vcc, 64, v29
    s_cbranch_vccz cs_kv1_go
    s_sleep 2
    s_branch cs_kv1
cs_kv1_go:
cs_nokv:
    s_nop 15
    s_nop 15
    s_nop 15
    s_nop 15
    s_nop 15
    s_nop 15
    s_nop 15
    s_nop 15
    s_nop 15
    s_nop 15
    s_nop 15
    s_nop 15
    s_nop 15
    s_nop 15
    s_nop 15
    s_nop 15
    s_nop 15
    s_nop 15
    s_nop 15
    s_nop 15
    s_nop 15
    s_nop 15
    s_nop 15
    s_nop 15
    s_nop 15
    buffer_load_dwordx4 v[24:27], v61, s[4:7], s14 offen sc1
    s_branch cs_loop2
cs_spinF:
    buffer_load_dwordx4 v[40:43], v65, s[4:7], s19 offen offset:0 sc1
    buffer_load_dwordx4 v[44:47], v65, s[4:7], s19 offen offset:1024 sc1
    buffer_load_dwordx4 v[48:51], v65, s[4:7], s19 offen offset:2048 sc1
    buffer_load_dwordx4 v[52:55], v65, s[4:7], s19 offen offset:3072 sc1
    s_sub_u32 s29, s29, 1
    s_cmp_lt_i32 s29, 0
    s_cselect_b32 s40, 0, 1
    s_branch cs_chkF
cs_spinG:
    buffer_load_dwordx4 v[0:3], v65, s[4:7], s19 offen offset:0 sc1
    buffer_load_dwordx4 v[4:7], v65, s[4:7], s19 offen offset:1024 sc1
    buffer_load_dwordx4 v[8:11], v65, s[4:7], s19 offen offset:2048 sc1
    buffer_load_dwordx4 v[12:15], v65, s[4:7], s19 offen offset:3072 sc1
    s_sub_u32 s29, s29, 1
    s_cmp_lt_i32 s29, 0
    s_cselect_b32 s40, 0, 1
    s_branch cs_chkG
cs_spin0:
    buffer_load_dwordx4 v[24:27], v61, s[4:7], s14 offen sc1
    s_sub_u32 s29, s29, 1
    s_cmp_lt_i32 s29, 0
    s_cbranch_scc0 cs_chk0
    s_waitcnt vmcnt(0)
    v_min_u32 v24, -2, v24
    v_min_u32 v25, -2, v25
    v_min_u32 v26, -2, v26
    v_min_u32 v27, -2, v27
    s_branch cs_chk0
cs_spin1:
    buffer_load_dwordx4 v[28:31], v61, s[4:7], s15 offen sc1
    buffer_load_dword v59, v56, s[4:7], s16 offen sc1
    s_sub_u32 s29, s29, 1
    s_cmp_lt_i32 s29, 0
    s_waitcnt vmcnt(0)
    v_max3_u32 v57, v28, v29, v30
    v_max3_u32 v57, v57, v31, v59
    v_cmp_eq_u32 vcc, -1, v57
    ds_write_b128 v62, v[28:31] offset:45056
    ds_write_b32 v58, v59
    s_waitcnt lgkmcnt(0)
    s_cbranch_scc1 cs_go1
    s_cbranch_vccnz cs_spin1
    s_branch cs_go1
cs_last:
    s_nop 1
    s_waitcnt vmcnt(0) lgkmcnt(0)
    s_mov_b64 exec, s[36:37]
    ds_read_b128 v[40:43], v69
    s_mov_b64 exec, -1
    s_mov_b64 exec, s[34:35]
    buffer_store_dwordx4 v[0:3], v61, s[4:7], s25 offen sc1
    s_mov_b64 exec, -1
    ds_read_b128 v[32:35], v63 offset:0
    ds_read_b128 v[36:39], v64 offset:0
    ds_read_b128 v[28:31], v71 offset:0
    s_waitcnt lgkmcnt(3)
    s_mov_b64 exec, s[36:37]
    s_cbranch_execz cs_np4154
    buffer_store_dwordx4 v[40:43], v61, s[4:7], s65 offen sc1
cs_np4154:
    s_mov_b64 exec, -1
    v_smfmac_f32_16x16x64_bf16 v[20:23], v[24:27], v[168:175], v60
    v_smfmac_f32_16x16x64_bf16 v[16:19], v[56:59], v[144:151], v60
    v_smfmac_f32_16x16x64_bf16 v[20:23], v[56:59], v[152:159], v60
    v_smfmac_f32_16x16x64_bf16 v[16:19], v[48:51], v[128:135], v60
    v_smfmac_f32_16x16x64_bf16 v[20:23], v[48:51], v[136:143], v60
    v_smfmac_f32_16x16x64_bf16 v[16:19], v[52:55], v[112:119], v60
    v_smfmac_f32_16x16x64_bf16 v[20:23], v[52:55], v[120:127], v60
    s_waitcnt lgkmcnt(2)
    v_smfmac_f32_16x16x64_bf16 v[16:19], v[32:35], a[232:239], v60
    v_smfmac_f32_16x16x64_bf16 v[20:23], v[32:35], a[240:247], v60
    s_waitcnt lgkmcnt(1)
    v_smfmac_f32_16x16x64_bf16 v[16:19], v[36:39], a[248:255], v60
    v_smfmac_f32_16x16x64_bf16 v[20:23], v[36:39], v[72:79], v60
    s_waitcnt lgkmcnt(0)
    v_smfmac_f32_16x16x64_bf16 v[16:19], v[28:31], v[80:87], v60
    v_smfmac_f32_16x16x64_bf16 v[20:23], v[28:31], v[88:95], v60
    s_nop 3
    v_cvt_pk_bf16_f32 v16, v16, v17
    v_cvt_pk_bf16_f32 v17, v18, v19
    s_nop 1
    v_cvt_pk_bf16_f32 v18, v20, v21
    v_cvt_pk_bf16_f32 v19, v22, v23
    buffer_store_dwordx4 v[16:19], v61, s[4:7], s26 offen sc1
    v_mov_b32 v32, s95
    s_waitcnt vmcnt(0)
    s_mov_b64 exec, 1
    buffer_store_dword v32, off, s[4:7], s27 sc1
    s_mov_b64 exec, -1
    s_endpgm
L_helper:
L_qkv_next:
    s_mov_b32 s37, 4
    v_mov_b32 v250, 1
    v_mov_b32 v251, 163832
    v_cmp_eq_u32 vcc, 0, v0
    s_nop 0
    s_and_saveexec_b64 s[38:39], vcc
    s_cbranch_execz tk3
    buffer_atomic_add v250, off, s[96:99], s37 sc0
    s_waitcnt vmcnt(0)
    ds_write_b32 v251, v250
    s_waitcnt lgkmcnt(0)
tk3:
    s_mov_b64 exec, -1
    s_barrier
    ds_read_b32 v252, v251
    s_waitcnt lgkmcnt(0)
    v_readfirstlane_b32 s36, v252
    s_barrier
    s_nop 3
L_helper1:
    s_load_dwordx16 s[64:79], s[0:1], 64
    s_waitcnt lgkmcnt(0)
    s_cmp_ge_u32 s36, 320
    s_cbranch_scc1 L_ssm_next
    s_and_b32 s17, s36, 15
    s_lshl_b32 s17, s17, 1
    s_bfe_u32 s16, s36, 0x10004
    s_lshr_b32 s19, s36, 5
    s_mul_i32 s33, s16, 6
    s_add_u32 s33, s33, s19
    s_add_u32 s16, s16, 1
    s_lshr_b32 s37, s36, 4
    s_sub_u32 s38, s37, 12
    s_cmp_ge_u32 s36, 192
    s_cselect_b32 s16, 0, s16
    s_cselect_b32 s19, s38, s19
    s_cselect_b32 s33, s37, s33
    s_cselect_b32 s20, 8, 6
    v_lshrrev_b32 v4, 6, v0
    s_nop 0
    v_readfirstlane_b32 s18, v4
    v_lshlrev_b32 v7, 4, v0
    v_and_b32 v4, 63, v0
    v_lshrrev_b32 v6, 2, v4
    v_lshlrev_b32 v6, 13, v6
    v_lshrrev_b32 v5, 4, v4
    v_and_b32 v5, 2, v5
    v_xor_b32 v5, v5, v4
    v_and_b32 v5, 3, v5
    v_lshl_add_u32 v6, v5, 4, v6
    v_lshrrev_b32 v24, 4, v4
    v_lshlrev_b32 v24, 9, v24
    v_bfe_u32 v5, v4, 2, 2
    v_lshl_add_u32 v24, v5, 6, v24
    v_bfe_u32 v5, v4, 4, 1
    v_lshl_add_u32 v24, v5, 5, v24
    v_and_b32 v5, 3, v4
    v_lshl_add_u32 v24, v5, 3, v24
    s_lshl_b32 s31, s18, 12
    v_add_u32 v24, s31, v24
    s_cmp_eq_u32 s16, 1
    s_cselect_b64 s[12:13], s[54:55], s[52:53]
    s_cmp_eq_u32 s16, 2
    s_cselect_b64 s[12:13], s[56:57], s[12:13]
    s_mov_b32 s14, 4718592
    s_mov_b32 s15, 0x20000
    s_lshl_b32 s28, s17, 8
    s_lshl_b32 s21, s18, 6
    s_add_u32 s28, s28, s21
    s_add_u32 s21, s28, 0
    s_add_u32 m0, s31, 40960
    s_nop 0
    buffer_load_dwordx4 v6, s[12:15], s21 offen lds
    s_add_u32 m0, s31, 41984
    s_add_u32 s21, s21, 131072
    buffer_load_dwordx4 v6, s[12:15], s21 offen lds
    s_add_u32 m0, s31, 43008
    s_add_u32 s21, s21, 131072
    buffer_load_dwordx4 v6, s[12:15], s21 offen lds
    s_add_u32 m0, s31, 44032
    s_add_u32 s21, s21, 131072
    buffer_load_dwordx4 v6, s[12:15], s21 offen lds
    s_add_u32 s21, s28, 256
    s_add_u32 m0, s31, 57344
    s_nop 0
    buffer_load_dwordx4 v6, s[12:15], s21 offen lds
    s_add_u32 m0, s31, 58368
    s_add_u32 s21, s21, 131072
    buffer_load_dwordx4 v6, s[12:15], s21 offen lds
    s_add_u32 m0, s31, 59392
    s_add_u32 s21, s21, 131072
    buffer_load_dwordx4 v6, s[12:15], s21 offen lds
    s_add_u32 m0, s31, 60416
    s_add_u32 s21, s21, 131072
    buffer_load_dwordx4 v6, s[12:15], s21 offen lds
    s_add_u32 s21, s28, 524288
    s_add_u32 m0, s31, 73728
    s_nop 0
    buffer_load_dwordx4 v6, s[12:15], s21 offen lds
    s_add_u32 m0, s31, 74752
    s_add_u32 s21, s21, 131072
    buffer_load_dwordx4 v6, s[12:15], s21 offen lds
    s_add_u32 m0, s31, 75776
    s_add_u32 s21, s21, 131072
    buffer_load_dwordx4 v6, s[12:15], s21 offen lds
    s_add_u32 m0, s31, 76800
    s_add_u32 s21, s21, 131072
    buffer_load_dwordx4 v6, s[12:15], s21 offen lds
    s_add_u32 s21, s28, 524544
    s_add_u32 m0, s31, 90112
    s_nop 0
    buffer_load_dwordx4 v6, s[12:15], s21 offen lds
    s_add_u32 m0, s31, 91136
    s_add_u32 s21, s21, 131072
    buffer_load_dwordx4 v6, s[12:15], s21 offen lds
    s_add_u32 m0, s31, 92160
    s_add_u32 s21, s21, 131072
    buffer_load_dwordx4 v6, s[12:15], s21 offen lds
    s_add_u32 m0, s31, 93184
    s_add_u32 s21, s21, 131072
    buffer_load_dwordx4 v6, s[12:15], s21 offen lds
    s_add_u32 s21, s28, 1048576
    s_add_u32 m0, s31, 106496
    s_nop 0
    buffer_load_dwordx4 v6, s[12:15], s21 offen lds
    s_add_u32 m0, s31, 107520
    s_add_u32 s21, s21, 131072
    buffer_load_dwordx4 v6, s[12:15], s21 offen lds
    s_add_u32 m0, s31, 108544
    s_add_u32 s21, s21, 131072
    buffer_load_dwordx4 v6, s[12:15], s21 offen lds
    s_add_u32 m0, s31, 109568
    s_add_u32 s21, s21, 131072
    buffer_load_dwordx4 v6, s[12:15], s21 offen lds
    s_add_u32 s21, s28, 1048832
    s_add_u32 m0, s31, 122880
    s_nop 0
    buffer_load_dwordx4 v6, s[12:15], s21 offen lds
    s_add_u32 m0, s31, 123904
    s_add_u32 s21, s21, 131072
    buffer_load_dwordx4 v6, s[12:15], s21 offen lds
    s_add_u32 m0, s31, 124928
    s_add_u32 s21, s21, 131072
    buffer_load_dwordx4 v6, s[12:15], s21 offen lds
    s_add_u32 m0, s31, 125952
    s_add_u32 s21, s21, 131072
    buffer_load_dwordx4 v6, s[12:15], s21 offen lds
    s_add_u32 s21, s28, 1572864
    s_add_u32 m0, s31, 139264
    s_nop 0
    buffer_load_dwordx4 v6, s[12:15], s21 offen lds
    s_add_u32 m0, s31, 140288
    s_add_u32 s21, s21, 131072
    buffer_load_dwordx4 v6, s[12:15], s21 offen lds
    s_add_u32 m0, s31, 141312
    s_add_u32 s21, s21, 131072
    buffer_load_dwordx4 v6, s[12:15], s21 offen lds
    s_add_u32 m0, s31, 142336
    s_add_u32 s21, s21, 131072
    buffer_load_dwordx4 v6, s[12:15], s21 offen lds
    v_and_b32 v5, 15, v4
    v_lshrrev_b32 v3, 4, v4
    v_lshrrev_b32 v2, 2, v5
    v_xor_b32 v3, v3, v2
    v_lshl_add_u32 v3, v5, 2, v3
    v_lshlrev_b32 v1, 4, v3
    v_lshrrev_b32 v5, 2, v4
    v_lshrrev_b32 v3, 4, v4
    v_and_b32 v4, 3, v4
    v_xor_b32 v4, v4, v3
    v_lshlrev_b32 v3, 3, v3
    v_and_b32 v5, 3, v5
    v_add_u32 v3, v3, v5
    v_mul_u32_u24 v2, 1152, v3
    v_lshl_add_u32 v2, v4, 4, v2
    s_mov_b32 s8, s48
    s_mov_b32 s9, s49
    s_mov_b32 s10, 2359296
    s_mov_b32 s11, 0x20000
    s_lshr_b32 s22, s18, 1
    s_mul_i32 s24, s22, 4608
    s_and_b32 s22, s18, 1
    s_mul_i32 s23, s22, 576
    s_add_u32 s24, s24, s23
    s_mul_i32 s25, s18, 9216
    s_mul_i32 s22, s19, 36864
    s_add_u32 s24, s24, s22
    s_mul_i32 s42, s20, 36864
    s_mov_b32 s27, 0
    s_add_u32 s23, s27, s25
    s_add_u32 m0, s23, 0
    s_nop 0
    buffer_load_dwordx4 v2, s[8:11], s24 offen offset:0 lds
    s_add_u32 m0, s23, 960
    s_nop 0
    buffer_load_dwordx4 v2, s[8:11], s24 offen offset:64 lds
    s_add_u32 m0, s23, 1920
    s_nop 0
    buffer_load_dwordx4 v2, s[8:11], s24 offen offset:128 lds
    s_add_u32 m0, s23, 2880
    s_nop 0
    buffer_load_dwordx4 v2, s[8:11], s24 offen offset:192 lds
    s_add_u32 m0, s23, 3840
    s_nop 0
    buffer_load_dwordx4 v2, s[8:11], s24 offen offset:256 lds
    s_add_u32 m0, s23, 4800
    s_nop 0
    buffer_load_dwordx4 v2, s[8:11], s24 offen offset:320 lds
    s_add_u32 m0, s23, 5760
    s_nop 0
    buffer_load_dwordx4 v2, s[8:11], s24 offen offset:384 lds
    s_add_u32 m0, s23, 6720
    s_nop 0
    buffer_load_dwordx4 v2, s[8:11], s24 offen offset:448 lds
    s_add_u32 m0, s23, 7680
    s_nop 0
    buffer_load_dwordx4 v2, s[8:11], s24 offen offset:512 lds
    s_add_u32 s24, s24, s42
    s_lshl_b32 s22, s19, 5
    s_add_u32 s22, s22, s17
    s_lshl_b32 s26, s22, 14
    s_mul_i32 s23, s18, 3072
    s_add_u32 s26, s26, s23
    s_lshl_b32 s23, s16, 11
    s_add_u32 s26, s26, s23
    s_add_u32 s26, s26, -2048
    s_lshl_b32 s22, s22, 13
    s_add_u32 s22, s22, 33554432
    s_cmp_eq_u32 s16, 0
    s_cselect_b32 s26, s22, s26
    s_cselect_b32 s40, 4, 1
    s_cselect_b32 s43, 1, 2
    s_lshl_b32 s40, s40, 10
    s_lshl_b32 s43, s43, 13
    s_lshl_b32 s41, s43, 5
    s_mul_i32 s41, s41, s20
    s_lshl_b32 s29, s17, 7
    s_lshl_b32 s22, s33, 2
    s_add_u32 s29, s29, s22
    s_add_u32 s29, s29, 125829120
    v_add_u32 v25, 40960, v24
    v_xor_b32 v26, 32, v25
    s_waitcnt vmcnt(33)
    ds_read_b64_tr_b16 v[64:65], v25 offset:0
    ds_read_b64_tr_b16 v[66:67], v25 offset:256
    ds_read_b64_tr_b16 v[136:137], v26 offset:0
    ds_read_b64_tr_b16 v[138:139], v26 offset:256
    ds_read_b64_tr_b16 v[68:69], v25 offset:2048
    ds_read_b64_tr_b16 v[70:71], v25 offset:2304
    ds_read_b64_tr_b16 v[140:141], v26 offset:2048
    ds_read_b64_tr_b16 v[142:143], v26 offset:2304
    s_waitcnt lgkmcnt(0)
    s_add_u32 s21, s28, 1573120
    s_add_u32 m0, s31, 40960
    s_nop 0
    buffer_load_dwordx4 v6, s[12:15], s21 offen lds
    s_add_u32 m0, s31, 41984
    s_add_u32 s21, s21, 131072
    buffer_load_dwordx4 v6, s[12:15], s21 offen lds
    s_add_u32 m0, s31, 43008
    s_add_u32 s21, s21, 131072
    buffer_load_dwordx4 v6, s[12:15], s21 offen lds
    s_add_u32 m0, s31, 44032
    s_add_u32 s21, s21, 131072
    buffer_load_dwordx4 v6, s[12:15], s21 offen lds
    v_add_u32 v25, 57344, v24
    v_xor_b32 v26, 32, v25
    s_waitcnt vmcnt(33)
    ds_read_b64_tr_b16 a[0:1], v25 offset:0
    ds_read_b64_tr_b16 a[2:3], v25 offset:256
    ds_read_b64_tr_b16 a[72:73], v26 offset:0
    ds_read_b64_tr_b16 a[74:75], v26 offset:256
    ds_read_b64_tr_b16 a[4:5], v25 offset:2048
    ds_read_b64_tr_b16 a[6:7], v25 offset:2304
    ds_read_b64_tr_b16 a[76:77], v26 offset:2048
    ds_read_b64_tr_b16 a[78:79], v26 offset:2304
    s_waitcnt lgkmcnt(0)
    s_add_u32 s21, s28, 2097152
    s_add_u32 m0, s31, 57344
    s_nop 0
    buffer_load_dwordx4 v6, s[12:15], s21 offen lds
    s_add_u32 m0, s31, 58368
    s_add_u32 s21, s21, 131072
    buffer_load_dwordx4 v6, s[12:15], s21 offen lds
    s_add_u32 m0, s31, 59392
    s_add_u32 s21, s21, 131072
    buffer_load_dwordx4 v6, s[12:15], s21 offen lds
    s_add_u32 m0, s31, 60416
    s_add_u32 s21, s21, 131072
    buffer_load_dwordx4 v6, s[12:15], s21 offen lds
    v_add_u32 v25, 73728, v24
    v_xor_b32 v26, 32, v25
    s_waitcnt vmcnt(33)
    ds_read_b64_tr_b16 v[72:73], v25 offset:0
    ds_read_b64_tr_b16 v[74:75], v25 offset:256
    ds_read_b64_tr_b16 v[144:145], v26 offset:0
    ds_read_b64_tr_b16 v[146:147], v26 offset:256
    ds_read_b64_tr_b16 v[76:77], v25 offset:2048
    ds_read_b64_tr_b16 v[78:79], v25 offset:2304
    ds_read_b64_tr_b16 v[148:149], v26 offset:2048
    ds_read_b64_tr_b16 v[150:151], v26 offset:2304
    s_waitcnt lgkmcnt(0)
    s_add_u32 s21, s28, 2097408
    s_add_u32 m0, s31, 73728
    s_nop 0
    buffer_load_dwordx4 v6, s[12:15], s21 offen lds
    s_add_u32 m0, s31, 74752
    s_add_u32 s21, s21, 131072
    buffer_load_dwordx4 v6, s[12:15], s21 offen lds
    s_add_u32 m0, s31, 75776
    s_add_u32 s21, s21, 131072
    buffer_load_dwordx4 v6, s[12:15], s21 offen lds
    s_add_u32 m0, s31, 76800
    s_add_u32 s21, s21, 131072
    buffer_load_dwordx4 v6, s[12:15], s21 offen lds
    v_add_u32 v25, 90112, v24
    v_xor_b32 v26, 32, v25
    s_waitcnt vmcnt(33)
    ds_read_b64_tr_b16 a[8:9], v25 offset:0
    ds_read_b64_tr_b16 a[10:11], v25 offset:256
    ds_read_b64_tr_b16 a[80:81], v26 offset:0
    ds_read_b64_tr_b16 a[82:83], v26 offset:256
    ds_read_b64_tr_b16 a[12:13], v25 offset:2048
    ds_read_b64_tr_b16 a[14:15], v25 offset:2304
    ds_read_b64_tr_b16 a[84:85], v26 offset:2048
    ds_read_b64_tr_b16 a[86:87], v26 offset:2304
    s_waitcnt lgkmcnt(0)
    s_add_u32 s21, s28, 2621440
    s_add_u32 m0, s31, 90112
    s_nop 0
    buffer_load_dwordx4 v6, s[12:15], s21 offen lds
    s_add_u32 m0, s31, 91136
    s_add_u32 s21, s21, 131072
    buffer_load_dwordx4 v6, s[12:15], s21 offen lds
    s_add_u32 m0, s31, 92160
    s_add_u32 s21, s21, 131072
    buffer_load_dwordx4 v6, s[12:15], s21 offen lds
    s_add_u32 m0, s31, 93184
    s_add_u32 s21, s21, 131072
    buffer_load_dwordx4 v6, s[12:15], s21 offen lds
    v_add_u32 v25, 106496, v24
    v_xor_b32 v26, 32, v25
    s_waitcnt vmcnt(33)
    ds_read_b64_tr_b16 v[80:81], v25 offset:0
    ds_read_b64_tr_b16 v[82:83], v25 offset:256
    ds_read_b64_tr_b16 v[152:153], v26 offset:0
    ds_read_b64_tr_b16 v[154:155], v26 offset:256
    ds_read_b64_tr_b16 v[84:85], v25 offset:2048
    ds_read_b64_tr_b16 v[86:87], v25 offset:2304
    ds_read_b64_tr_b16 v[156:157], v26 offset:2048
    ds_read_b64_tr_b16 v[158:159], v26 offset:2304
    s_waitcnt lgkmcnt(0)
    s_add_u32 s21, s28, 2621696
    s_add_u32 m0, s31, 106496
    s_nop 0
    buffer_load_dwordx4 v6, s[12:15], s21 offen lds
    s_add_u32 m0, s31, 107520
    s_add_u32 s21, s21, 131072
    buffer_load_dwordx4 v6, s[12:15], s21 offen lds
    s_add_u32 m0, s31, 108544
    s_add_u32 s21, s21, 131072
    buffer_load_dwordx4 v6, s[12:15], s21 offen lds
    s_add_u32 m0, s31, 109568
    s_add_u32 s21, s21, 131072
    buffer_load_dwordx4 v6, s[12:15], s21 offen lds
    v_add_u32 v25, 122880, v24
    v_xor_b32 v26, 32, v25
    s_waitcnt vmcnt(33)
    ds_read_b64_tr_b16 a[16:17], v25 offset:0
    ds_read_b64_tr_b16 a[18:19], v25 offset:256
    ds_read_b64_tr_b16 a[88:89], v26 offset:0
    ds_read_b64_tr_b16 a[90:91], v26 offset:256
    ds_read_b64_tr_b16 a[20:21], v25 offset:2048
    ds_read_b64_tr_b16 a[22:23], v25 offset:2304
    ds_read_b64_tr_b16 a[92:93], v26 offset:2048
    ds_read_b64_tr_b16 a[94:95], v26 offset:2304
    s_waitcnt lgkmcnt(0)
    s_add_u32 s21, s28, 3145728
    s_add_u32 m0, s31, 122880
    s_nop 0
    buffer_load_dwordx4 v6, s[12:15], s21 offen lds
    s_add_u32 m0, s31, 123904
    s_add_u32 s21, s21, 131072
    buffer_load_dwordx4 v6, s[12:15], s21 offen lds
    s_add_u32 m0, s31, 124928
    s_add_u32 s21, s21, 131072
    buffer_load_dwordx4 v6, s[12:15], s21 offen lds
    s_add_u32 m0, s31, 125952
    s_add_u32 s21, s21, 131072
    buffer_load_dwordx4 v6, s[12:15], s21 offen lds
    v_add_u32 v25, 139264, v24
    v_xor_b32 v26, 32, v25
    s_waitcnt vmcnt(33)
    ds_read_b64_tr_b16 v[88:89], v25 offset:0
    ds_read_b64_tr_b16 v[90:91], v25 offset:256
    ds_read_b64_tr_b16 v[160:161], v26 offset:0
    ds_read_b64_tr_b16 v[162:163], v26 offset:256
    ds_read_b64_tr_b16 v[92:93], v25 offset:2048
    ds_read_b64_tr_b16 v[94:95], v25 offset:2304
    ds_read_b64_tr_b16 v[164:165], v26 offset:2048
    ds_read_b64_tr_b16 v[166:167], v26 offset:2304
    s_waitcnt lgkmcnt(0)
    s_add_u32 s21, s28, 3145984
    s_add_u32 m0, s31, 139264
    s_nop 0
    buffer_load_dwordx4 v6, s[12:15], s21 offen lds
    s_add_u32 m0, s31, 140288
    s_add_u32 s21, s21, 131072
    buffer_load_dwordx4 v6, s[12:15], s21 offen lds
    s_add_u32 m0, s31, 141312
    s_add_u32 s21, s21, 131072
    buffer_load_dwordx4 v6, s[12:15], s21 offen lds
    s_add_u32 m0, s31, 142336
    s_add_u32 s21, s21, 131072
    buffer_load_dwordx4 v6, s[12:15], s21 offen lds
    v_add_u32 v25, 40960, v24
    v_xor_b32 v26, 32, v25
    s_waitcnt vmcnt(24)
    ds_read_b64_tr_b16 a[24:25], v25 offset:0
    ds_read_b64_tr_b16 a[26:27], v25 offset:256
    ds_read_b64_tr_b16 a[96:97], v26 offset:0
    ds_read_b64_tr_b16 a[98:99], v26 offset:256
    ds_read_b64_tr_b16 a[28:29], v25 offset:2048
    ds_read_b64_tr_b16 a[30:31], v25 offset:2304
    ds_read_b64_tr_b16 a[100:101], v26 offset:2048
    ds_read_b64_tr_b16 a[102:103], v26 offset:2304
    s_waitcnt lgkmcnt(0)
    s_add_u32 s21, s28, 3670016
    s_add_u32 m0, s31, 40960
    s_nop 0
    buffer_load_dwordx4 v6, s[12:15], s21 offen lds
    s_add_u32 m0, s31, 41984
    s_add_u32 s21, s21, 131072
    buffer_load_dwordx4 v6, s[12:15], s21 offen lds
    s_add_u32 m0, s31, 43008
    s_add_u32 s21, s21, 131072
    buffer_load_dwordx4 v6, s[12:15], s21 offen lds
    s_add_u32 m0, s31, 44032
    s_add_u32 s21, s21, 131072
    buffer_load_dwordx4 v6, s[12:15], s21 offen lds
    v_add_u32 v25, 57344, v24
    v_xor_b32 v26, 32, v25
    s_waitcnt vmcnt(24)
    ds_read_b64_tr_b16 v[96:97], v25 offset:0
    ds_read_b64_tr_b16 v[98:99], v25 offset:256
    ds_read_b64_tr_b16 v[168:169], v26 offset:0
    ds_read_b64_tr_b16 v[170:171], v26 offset:256
    ds_read_b64_tr_b16 v[100:101], v25 offset:2048
    ds_read_b64_tr_b16 v[102:103], v25 offset:2304
    ds_read_b64_tr_b16 v[172:173], v26 offset:2048
    ds_read_b64_tr_b16 v[174:175], v26 offset:2304
    s_waitcnt lgkmcnt(0)
    s_add_u32 s21, s28, 3670272
    s_add_u32 m0, s31, 57344
    s_nop 0
    buffer_load_dwordx4 v6, s[12:15], s21 offen lds
    s_add_u32 m0, s31, 58368
    s_add_u32 s21, s21, 131072
    buffer_load_dwordx4 v6, s[12:15], s21 offen lds
    s_add_u32 m0, s31, 59392
    s_add_u32 s21, s21, 131072
    buffer_load_dwordx4 v6, s[12:15], s21 offen lds
    s_add_u32 m0, s31, 60416
    s_add_u32 s21, s21, 131072
    buffer_load_dwordx4 v6, s[12:15], s21 offen lds
    v_add_u32 v25, 73728, v24
    v_xor_b32 v26, 32, v25
    s_waitcnt vmcnt(24)
    ds_read_b64_tr_b16 a[32:33], v25 offset:0
    ds_read_b64_tr_b16 a[34:35], v25 offset:256
    ds_read_b64_tr_b16 a[104:105], v26 offset:0
    ds_read_b64_tr_b16 a[106:107], v26 offset:256
    ds_read_b64_tr_b16 a[36:37], v25 offset:2048
    ds_read_b64_tr_b16 a[38:39], v25 offset:2304
    ds_read_b64_tr_b16 a[108:109], v26 offset:2048
    ds_read_b64_tr_b16 a[110:111], v26 offset:2304
    s_waitcnt lgkmcnt(0)
    s_add_u32 s21, s28, 4194304
    s_add_u32 m0, s31, 73728
    s_nop 0
    buffer_load_dwordx4 v6, s[12:15], s21 offen lds
    s_add_u32 m0, s31, 74752
    s_add_u32 s21, s21, 131072
    buffer_load_dwordx4 v6, s[12:15], s21 offen lds
    s_add_u32 m0, s31, 75776
    s_add_u32 s21, s21, 131072
    buffer_load_dwordx4 v6, s[12:15], s21 offen lds
    s_add_u32 m0, s31, 76800
    s_add_u32 s21, s21, 131072
    buffer_load_dwordx4 v6, s[12:15], s21 offen lds
    v_add_u32 v25, 90112, v24
    v_xor_b32 v26, 32, v25
    s_waitcnt vmcnt(24)
    ds_read_b64_tr_b16 v[104:105], v25 offset:0
    ds_read_b64_tr_b16 v[106:107], v25 offset:256
    ds_read_b64_tr_b16 v[176:177], v26 offset:0
    ds_read_b64_tr_b16 v[178:179], v26 offset:256
    ds_read_b64_tr_b16 v[108:109], v25 offset:2048
    ds_read_b64_tr_b16 v[110:111], v25 offset:2304
    ds_read_b64_tr_b16 v[180:181], v26 offset:2048
    ds_read_b64_tr_b16 v[182:183], v26 offset:2304
    s_waitcnt lgkmcnt(0)
    s_add_u32 s21, s28, 4194560
    s_add_u32 m0, s31, 90112
    s_nop 0
    buffer_load_dwordx4 v6, s[12:15], s21 offen lds
    s_add_u32 m0, s31, 91136
    s_add_u32 s21, s21, 131072
    buffer_load_dwordx4 v6, s[12:15], s21 offen lds
    s_add_u32 m0, s31, 92160
    s_add_u32 s21, s21, 131072
    buffer_load_dwordx4 v6, s[12:15], s21 offen lds
    s_add_u32 m0, s31, 93184
    s_add_u32 s21, s21, 131072
    buffer_load_dwordx4 v6, s[12:15], s21 offen lds
    v_add_u32 v25, 106496, v24
    v_xor_b32 v26, 32, v25
    s_waitcnt vmcnt(24)
    ds_read_b64_tr_b16 a[40:41], v25 offset:0
    ds_read_b64_tr_b16 a[42:43], v25 offset:256
    ds_read_b64_tr_b16 a[112:113], v26 offset:0
    ds_read_b64_tr_b16 a[114:115], v26 offset:256
    ds_read_b64_tr_b16 a[44:45], v25 offset:2048
    ds_read_b64_tr_b16 a[46:47], v25 offset:2304
    ds_read_b64_tr_b16 a[116:117], v26 offset:2048
    ds_read_b64_tr_b16 a[118:119], v26 offset:2304
    s_waitcnt lgkmcnt(0)
    v_add_u32 v25, 122880, v24
    v_xor_b32 v26, 32, v25
    s_waitcnt vmcnt(20)
    ds_read_b64_tr_b16 v[112:113], v25 offset:0
    ds_read_b64_tr_b16 v[114:115], v25 offset:256
    ds_read_b64_tr_b16 v[184:185], v26 offset:0
    ds_read_b64_tr_b16 v[186:187], v26 offset:256
    ds_read_b64_tr_b16 v[116:117], v25 offset:2048
    ds_read_b64_tr_b16 v[118:119], v25 offset:2304
    ds_read_b64_tr_b16 v[188:189], v26 offset:2048
    ds_read_b64_tr_b16 v[190:191], v26 offset:2304
    s_waitcnt lgkmcnt(0)
    v_add_u32 v25, 139264, v24
    v_xor_b32 v26, 32, v25
    s_waitcnt vmcnt(16)
    ds_read_b64_tr_b16 a[48:49], v25 offset:0
    ds_read_b64_tr_b16 a[50:51], v25 offset:256
    ds_read_b64_tr_b16 a[120:121], v26 offset:0
    ds_read_b64_tr_b16 a[122:123], v26 offset:256
    ds_read_b64_tr_b16 a[52:53], v25 offset:2048
    ds_read_b64_tr_b16 a[54:55], v25 offset:2304
    ds_read_b64_tr_b16 a[124:125], v26 offset:2048
    ds_read_b64_tr_b16 a[126:127], v26 offset:2304
    s_waitcnt lgkmcnt(0)
    v_add_u32 v25, 40960, v24
    v_xor_b32 v26, 32, v25
    s_waitcnt vmcnt(12)
    ds_read_b64_tr_b16 v[120:121], v25 offset:0
    ds_read_b64_tr_b16 v[122:123], v25 offset:256
    ds_read_b64_tr_b16 v[192:193], v26 offset:0
    ds_read_b64_tr_b16 v[194:195], v26 offset:256
    ds_read_b64_tr_b16 v[124:125], v25 offset:2048
    ds_read_b64_tr_b16 v[126:127], v25 offset:2304
    ds_read_b64_tr_b16 v[196:197], v26 offset:2048
    ds_read_b64_tr_b16 v[198:199], v26 offset:2304
    s_waitcnt lgkmcnt(0)
    v_add_u32 v25, 57344, v24
    v_xor_b32 v26, 32, v25
    s_waitcnt vmcnt(8)
    ds_read_b64_tr_b16 a[56:57], v25 offset:0
    ds_read_b64_tr_b16 a[58:59], v25 offset:256
    ds_read_b64_tr_b16 a[128:129], v26 offset:0
    ds_read_b64_tr_b16 a[130:131], v26 offset:256
    ds_read_b64_tr_b16 a[60:61], v25 offset:2048
    ds_read_b64_tr_b16 a[62:63], v25 offset:2304
    ds_read_b64_tr_b16 a[132:133], v26 offset:2048
    ds_read_b64_tr_b16 a[134:135], v26 offset:2304
    s_waitcnt lgkmcnt(0)
    v_add_u32 v25, 73728, v24
    v_xor_b32 v26, 32, v25
    s_waitcnt vmcnt(4)
    ds_read_b64_tr_b16 v[128:129], v25 offset:0
    ds_read_b64_tr_b16 v[130:131], v25 offset:256
    ds_read_b64_tr_b16 v[200:201], v26 offset:0
    ds_read_b64_tr_b16 v[202:203], v26 offset:256
    ds_read_b64_tr_b16 v[132:133], v25 offset:2048
    ds_read_b64_tr_b16 v[134:135], v25 offset:2304
    ds_read_b64_tr_b16 v[204:205], v26 offset:2048
    ds_read_b64_tr_b16 v[206:207], v26 offset:2304
    s_waitcnt lgkmcnt(0)
    v_add_u32 v25, 90112, v24
    v_xor_b32 v26, 32, v25
    s_waitcnt vmcnt(0)
    ds_read_b64_tr_b16 a[64:65], v25 offset:0
    ds_read_b64_tr_b16 a[66:67], v25 offset:256
    ds_read_b64_tr_b16 a[136:137], v26 offset:0
    ds_read_b64_tr_b16 a[138:139], v26 offset:256
    ds_read_b64_tr_b16 a[68:69], v25 offset:2048
    ds_read_b64_tr_b16 a[70:71], v25 offset:2304
    ds_read_b64_tr_b16 a[140:141], v26 offset:2048
    ds_read_b64_tr_b16 a[142:143], v26 offset:2304
    s_waitcnt lgkmcnt(0)
    s_barrier
    s_mov_b32 s27, 36864
    s_add_u32 s23, s27, s25
    s_add_u32 m0, s23, 0
    s_nop 0
    buffer_load_dwordx4 v2, s[8:11], s24 offen offset:0 lds
    s_add_u32 m0, s23, 960
    s_nop 0
    buffer_load_dwordx4 v2, s[8:11], s24 offen offset:64 lds
    s_add_u32 m0, s23, 1920
    s_nop 0
    buffer_load_dwordx4 v2, s[8:11], s24 offen offset:128 lds
    s_add_u32 m0, s23, 2880
    s_nop 0
    buffer_load_dwordx4 v2, s[8:11], s24 offen offset:192 lds
    s_add_u32 m0, s23, 3840
    s_nop 0
    buffer_load_dwordx4 v2, s[8:11], s24 offen offset:256 lds
    s_add_u32 m0, s23, 4800
    s_nop 0
    buffer_load_dwordx4 v2, s[8:11], s24 offen offset:320 lds
    s_add_u32 m0, s23, 5760
    s_nop 0
    buffer_load_dwordx4 v2, s[8:11], s24 offen offset:384 lds
    s_add_u32 m0, s23, 6720
    s_nop 0
    buffer_load_dwordx4 v2, s[8:11], s24 offen offset:448 lds
    s_add_u32 m0, s23, 7680
    s_nop 0
    buffer_load_dwordx4 v2, s[8:11], s24 offen offset:512 lds
    s_add_u32 s24, s24, s42
    s_mov_b32 s27, 0
    s_mov_b32 s30, s95
    s_cmp_eq_u32 s18, 0
    s_cselect_b32 s34, 1, 0
    s_mov_b32 s35, 0
    s_cmp_eq_u32 s16, 2
    s_cbranch_scc1 qk_vloop
qk_loop:
    s_barrier
    v_add_u32 v3, s27, v1
    ds_read_b128 v[32:35], v3 offset:0
    ds_read_b128 v[36:39], v3 offset:18432
    ds_read_b128 v[40:43], v3 offset:1024
    ds_read_b128 v[44:47], v3 offset:19456
    ds_read_b128 v[48:51], v3 offset:2048
    ds_read_b128 v[52:55], v3 offset:20480
    s_sub_u32 s22, s30, 1
    v_mov_b32 v4, s22
    s_mov_b64 exec, s[34:35]
    buffer_store_dword v4, off, s[4:7], s29 sc1
    s_mov_b64 exec, -1
    s_add_u32 s22, s27, 73728
    s_sub_u32 s21, s22, 110592
    s_cselect_b32 s22, s22, s21
    ds_read_b128 v[56:59], v3 offset:3072
    ds_read_b128 v[60:63], v3 offset:21504
    s_add_u32 s23, s22, s25
    s_add_u32 m0, s23, 0
    s_nop 0
    buffer_load_dwordx4 v2, s[8:11], s24 offen offset:0 lds
    s_waitcnt lgkmcnt(6)
    v_mfma_f32_16x16x32_bf16 v[208:211], v[64:67], v[32:35], 0
    v_mfma_f32_16x16x32_bf16 v[212:215], v[136:139], v[32:35], 0
    v_mfma_f32_16x16x32_bf16 v[216:219], v[64:67], v[36:39], 0
    v_mfma_f32_16x16x32_bf16 v[220:223], v[136:139], v[36:39], 0
    v_mfma_f32_16x16x32_bf16 v[224:227], a[0:3], v[32:35], 0
    v_mfma_f32_16x16x32_bf16 v[228:231], a[72:75], v[32:35], 0
    v_mfma_f32_16x16x32_bf16 v[232:235], a[0:3], v[36:39], 0
    v_mfma_f32_16x16x32_bf16 v[236:239], a[72:75], v[36:39], 0
    ds_read_b128 v[32:35], v3 offset:4096
    ds_read_b128 v[36:39], v3 offset:22528
    s_add_u32 m0, s23, 960
    s_nop 0
    buffer_load_dwordx4 v2, s[8:11], s24 offen offset:64 lds
    s_waitcnt lgkmcnt(6)
    v_mfma_f32_16x16x32_bf16 v[208:211], v[68:71], v[40:43], v[208:211]
    v_mfma_f32_16x16x32_bf16 v[212:215], v[140:143], v[40:43], v[212:215]
    v_mfma_f32_16x16x32_bf16 v[216:219], v[68:71], v[44:47], v[216:219]
    v_mfma_f32_16x16x32_bf16 v[220:223], v[140:143], v[44:47], v[220:223]
    v_mfma_f32_16x16x32_bf16 v[224:227], a[4:7], v[40:43], v[224:227]
    v_mfma_f32_16x16x32_bf16 v[228:231], a[76:79], v[40:43], v[228:231]
    v_mfma_f32_16x16x32_bf16 v[232:235], a[4:7], v[44:47], v[232:235]
    v_mfma_f32_16x16x32_bf16 v[236:239], a[76:79], v[44:47], v[236:239]
    ds_read_b128 v[40:43], v3 offset:5120
    ds_read_b128 v[44:47], v3 offset:23552
    s_add_u32 m0, s23, 1920
    s_nop 0
    buffer_load_dwordx4 v2, s[8:11], s24 offen offset:128 lds
    s_waitcnt lgkmcnt(6)
    v_mfma_f32_16x16x32_bf16 v[208:211], v[72:75], v[48:51], v[208:211]
    v_mfma_f32_16x16x32_bf16 v[212:215], v[144:147], v[48:51], v[212:215]
    v_mfma_f32_16x16x32_bf16 v[216:219], v[72:75], v[52:55], v[216:219]
    v_mfma_f32_16x16x32_bf16 v[220:223], v[144:147], v[52:55], v[220:223]
    v_mfma_f32_16x16x32_bf16 v[224:227], a[8:11], v[48:51], v[224:227]
    v_mfma_f32_16x16x32_bf16 v[228:231], a[80:83], v[48:51], v[228:231]
    v_mfma_f32_16x16x32_bf16 v[232:235], a[8:11], v[52:55], v[232:235]
    v_mfma_f32_16x16x32_bf16 v[236:239], a[80:83], v[52:55], v[236:239]
    ds_read_b128 v[48:51], v3 offset:6144
    ds_read_b128 v[52:55], v3 offset:24576
    s_add_u32 m0, s23, 2880
    s_nop 0
    buffer_load_dwordx4 v2, s[8:11], s24 offen offset:192 lds
    s_waitcnt lgkmcnt(6)
    v_mfma_f32_16x16x32_bf16 v[208:211], v[76:79], v[56:59], v[208:211]
    v_mfma_f32_16x16x32_bf16 v[212:215], v[148:151], v[56:59], v[212:215]
    v_mfma_f32_16x16x32_bf16 v[216:219], v[76:79], v[60:63], v[216:219]
    v_mfma_f32_16x16x32_bf16 v[220:223], v[148:151], v[60:63], v[220:223]
    v_mfma_f32_16x16x32_bf16 v[224:227], a[12:15], v[56:59], v[224:227]
    v_mfma_f32_16x16x32_bf16 v[228:231], a[84:87], v[56:59], v[228:231]
    v_mfma_f32_16x16x32_bf16 v[232:235], a[12:15], v[60:63], v[232:235]
    v_mfma_f32_16x16x32_bf16 v[236:239], a[84:87], v[60:63], v[236:239]
    ds_read_b128 v[56:59], v3 offset:7168
    ds_read_b128 v[60:63], v3 offset:25600
    s_add_u32 m0, s23, 3840
    s_nop 0
    buffer_load_dwordx4 v2, s[8:11], s24 offen offset:256 lds
    s_waitcnt lgkmcnt(6)
    v_mfma_f32_16x16x32_bf16 v[208:211], v[80:83], v[32:35], v[208:211]
    v_mfma_f32_16x16x32_bf16 v[212:215], v[152:155], v[32:35], v[212:215]
    v_mfma_f32_16x16x32_bf16 v[216:219], v[80:83], v[36:39], v[216:219]
    v_mfma_f32_16x16x32_bf16 v[220:223], v[152:155], v[36:39], v[220:223]
    v_mfma_f32_16x16x32_bf16 v[224:227], a[16:19], v[32:35], v[224:227]
    v_mfma_f32_16x16x32_bf16 v[228:231], a[88:91], v[32:35], v[228:231]
    v_mfma_f32_16x16x32_bf16 v[232:235], a[16:19], v[36:39], v[232:235]
    v_mfma_f32_16x16x32_bf16 v[236:239], a[88:91], v[36:39], v[236:239]
    ds_read_b128 v[32:35], v3 offset:8192
    ds_read_b128 v[36:39], v3 offset:26624
    s_add_u32 m0, s23, 4800
    s_nop 0
    buffer_load_dwordx4 v2, s[8:11], s24 offen offset:320 lds
    s_waitcnt lgkmcnt(6)
    v_mfma_f32_16x16x32_bf16 v[208:211], v[84:87], v[40:43], v[208:211]
    v_mfma_f32_16x16x32_bf16 v[212:215], v[156:159], v[40:43], v[212:215]
    v_mfma_f32_16x16x32_bf16 v[216:219], v[84:87], v[44:47], v[216:219]
    v_mfma_f32_16x16x32_bf16 v[220:223], v[156:159], v[44:47], v[220:223]
    v_mfma_f32_16x16x32_bf16 v[224:227], a[20:23], v[40:43], v[224:227]
    v_mfma_f32_16x16x32_bf16 v[228:231], a[92:95], v[40:43], v[228:231]
    v_mfma_f32_16x16x32_bf16 v[232:235], a[20:23], v[44:47], v[232:235]
    v_mfma_f32_16x16x32_bf16 v[236:239], a[92:95], v[44:47], v[236:239]
    ds_read_b128 v[40:43], v3 offset:9216
    ds_read_b128 v[44:47], v3 offset:27648
    s_add_u32 m0, s23, 5760
    s_nop 0
    buffer_load_dwordx4 v2, s[8:11], s24 offen offset:384 lds
    s_waitcnt lgkmcnt(6)
    v_mfma_f32_16x16x32_bf16 v[208:211], v[88:91], v[48:51], v[208:211]
    v_mfma_f32_16x16x32_bf16 v[212:215], v[160:163], v[48:51], v[212:215]
    v_mfma_f32_16x16x32_bf16 v[216:219], v[88:91], v[52:55], v[216:219]
    v_mfma_f32_16x16x32_bf16 v[220:223], v[160:163], v[52:55], v[220:223]
    v_mfma_f32_16x16x32_bf16 v[224:227], a[24:27], v[48:51], v[224:227]
    v_mfma_f32_16x16x32_bf16 v[228:231], a[96:99], v[48:51], v[228:231]
    v_mfma_f32_16x16x32_bf16 v[232:235], a[24:27], v[52:55], v[232:235]
    v_mfma_f32_16x16x32_bf16 v[236:239], a[96:99], v[52:55], v[236:239]
    ds_read_b128 v[48:51], v3 offset:10240
    ds_read_b128 v[52:55], v3 offset:28672
    s_add_u32 m0, s23, 6720
    s_nop 0
    buffer_load_dwordx4 v2, s[8:11], s24 offen offset:448 lds
    s_waitcnt lgkmcnt(6)
    v_mfma_f32_16x16x32_bf16 v[208:211], v[92:95], v[56:59], v[208:211]
    v_mfma_f32_16x16x32_bf16 v[212:215], v[164:167], v[56:59], v[212:215]
    v_mfma_f32_16x16x32_bf16 v[216:219], v[92:95], v[60:63], v[216:219]
    v_mfma_f32_16x16x32_bf16 v[220:223], v[164:167], v[60:63], v[220:223]
    v_mfma_f32_16x16x32_bf16 v[224:227], a[28:31], v[56:59], v[224:227]
    v_mfma_f32_16x16x32_bf16 v[228:231], a[100:103], v[56:59], v[228:231]
    v_mfma_f32_16x16x32_bf16 v[232:235], a[28:31], v[60:63], v[232:235]
    v_mfma_f32_16x16x32_bf16 v[236:239], a[100:103], v[60:63], v[236:239]
    ds_read_b128 v[56:59], v3 offset:11264
    ds_read_b128 v[60:63], v3 offset:29696
    s_add_u32 m0, s23, 7680
    s_nop 0
    buffer_load_dwordx4 v2, s[8:11], s24 offen offset:512 lds
    s_add_u32 s24, s24, s42
    s_waitcnt lgkmcnt(6)
    v_mfma_f32_16x16x32_bf16 v[208:211], v[96:99], v[32:35], v[208:211]
    v_mfma_f32_16x16x32_bf16 v[212:215], v[168:171], v[32:35], v[212:215]
    v_mfma_f32_16x16x32_bf16 v[216:219], v[96:99], v[36:39], v[216:219]
    v_mfma_f32_16x16x32_bf16 v[220:223], v[168:171], v[36:39], v[220:223]
    v_mfma_f32_16x16x32_bf16 v[224:227], a[32:35], v[32:35], v[224:227]
    v_mfma_f32_16x16x32_bf16 v[228:231], a[104:107], v[32:35], v[228:231]
    v_mfma_f32_16x16x32_bf16 v[232:235], a[32:35], v[36:39], v[232:235]
    v_mfma_f32_16x16x32_bf16 v[236:239], a[104:107], v[36:39], v[236:239]
    ds_read_b128 v[32:35], v3 offset:12288
    ds_read_b128 v[36:39], v3 offset:30720
    s_waitcnt lgkmcnt(6)
    v_mfma_f32_16x16x32_bf16 v[208:211], v[100:103], v[40:43], v[208:211]
    v_mfma_f32_16x16x32_bf16 v[212:215], v[172:175], v[40:43], v[212:215]
    v_mfma_f32_16x16x32_bf16 v[216:219], v[100:103], v[44:47], v[216:219]
    v_mfma_f32_16x16x32_bf16 v[220:223], v[172:175], v[44:47], v[220:223]
    v_mfma_f32_16x16x32_bf16 v[224:227], a[36:39], v[40:43], v[224:227]
    v_mfma_f32_16x16x32_bf16 v[228:231], a[108:111], v[40:43], v[228:231]
    v_mfma_f32_16x16x32_bf16 v[232:235], a[36:39], v[44:47], v[232:235]
    v_mfma_f32_16x16x32_bf16 v[236:239], a[108:111], v[44:47], v[236:239]
    ds_read_b128 v[40:43], v3 offset:13312
    ds_read_b128 v[44:47], v3 offset:31744
    s_waitcnt lgkmcnt(6)
    v_mfma_f32_16x16x32_bf16 v[208:211], v[104:107], v[48:51], v[208:211]
    v_mfma_f32_16x16x32_bf16 v[212:215], v[176:179], v[48:51], v[212:215]
    v_mfma_f32_16x16x32_bf16 v[216:219], v[104:107], v[52:55], v[216:219]
    v_mfma_f32_16x16x32_bf16 v[220:223], v[176:179], v[52:55], v[220:223]
    v_mfma_f32_16x16x32_bf16 v[224:227], a[40:43], v[48:51], v[224:227]
    v_mfma_f32_16x16x32_bf16 v[228:231], a[112:115], v[48:51], v[228:231]
    v_mfma_f32_16x16x32_bf16 v[232:235], a[40:43], v[52:55], v[232:235]
    v_mfma_f32_16x16x32_bf16 v[236:239], a[112:115], v[52:55], v[236:239]
    ds_read_b128 v[48:51], v3 offset:14336
    ds_read_b128 v[52:55], v3 offset:32768
    s_waitcnt lgkmcnt(6)
    v_mfma_f32_16x16x32_bf16 v[208:211], v[108:111], v[56:59], v[208:211]
    v_mfma_f32_16x16x32_bf16 v[212:215], v[180:183], v[56:59], v[212:215]
    v_mfma_f32_16x16x32_bf16 v[216:219], v[108:111], v[60:63], v[216:219]
    v_mfma_f32_16x16x32_bf16 v[220:223], v[180:183], v[60:63], v[220:223]
    v_mfma_f32_16x16x32_bf16 v[224:227], a[44:47], v[56:59], v[224:227]
    v_mfma_f32_16x16x32_bf16 v[228:231], a[116:119], v[56:59], v[228:231]
    v_mfma_f32_16x16x32_bf16 v[232:235], a[44:47], v[60:63], v[232:235]
    v_mfma_f32_16x16x32_bf16 v[236:239], a[116:119], v[60:63], v[236:239]
    ds_read_b128 v[56:59], v3 offset:15360
    ds_read_b128 v[60:63], v3 offset:33792
    s_waitcnt lgkmcnt(6)
    v_mfma_f32_16x16x32_bf16 v[208:211], v[112:115], v[32:35], v[208:211]
    v_mfma_f32_16x16x32_bf16 v[212:215], v[184:187], v[32:35], v[212:215]
    v_mfma_f32_16x16x32_bf16 v[216:219], v[112:115], v[36:39], v[216:219]
    v_mfma_f32_16x16x32_bf16 v[220:223], v[184:187], v[36:39], v[220:223]
    v_mfma_f32_16x16x32_bf16 v[224:227], a[48:51], v[32:35], v[224:227]
    v_mfma_f32_16x16x32_bf16 v[228:231], a[120:123], v[32:35], v[228:231]
    v_mfma_f32_16x16x32_bf16 v[232:235], a[48:51], v[36:39], v[232:235]
    v_mfma_f32_16x16x32_bf16 v[236:239], a[120:123], v[36:39], v[236:239]
    ds_read_b128 v[32:35], v3 offset:16384
    ds_read_b128 v[36:39], v3 offset:34816
    s_waitcnt lgkmcnt(6)
    v_mfma_f32_16x16x32_bf16 v[208:211], v[116:119], v[40:43], v[208:211]
    v_mfma_f32_16x16x32_bf16 v[212:215], v[188:191], v[40:43], v[212:215]
    v_mfma_f32_16x16x32_bf16 v[216:219], v[116:119], v[44:47], v[216:219]
    v_mfma_f32_16x16x32_bf16 v[220:223], v[188:191], v[44:47], v[220:223]
    v_mfma_f32_16x16x32_bf16 v[224:227], a[52:55], v[40:43], v[224:227]
    v_mfma_f32_16x16x32_bf16 v[228:231], a[124:127], v[40:43], v[228:231]
    v_mfma_f32_16x16x32_bf16 v[232:235], a[52:55], v[44:47], v[232:235]
    v_mfma_f32_16x16x32_bf16 v[236:239], a[124:127], v[44:47], v[236:239]
    ds_read_b128 v[40:43], v3 offset:17408
    ds_read_b128 v[44:47], v3 offset:35840
    s_waitcnt lgkmcnt(6)
    v_mfma_f32_16x16x32_bf16 v[208:211], v[120:123], v[48:51], v[208:211]
    v_mfma_f32_16x16x32_bf16 v[212:215], v[192:195], v[48:51], v[212:215]
    v_mfma_f32_16x16x32_bf16 v[216:219], v[120:123], v[52:55], v[216:219]
    v_mfma_f32_16x16x32_bf16 v[220:223], v[192:195], v[52:55], v[220:223]
    v_mfma_f32_16x16x32_bf16 v[224:227], a[56:59], v[48:51], v[224:227]
    v_mfma_f32_16x16x32_bf16 v[228:231], a[128:131], v[48:51], v[228:231]
    v_mfma_f32_16x16x32_bf16 v[232:235], a[56:59], v[52:55], v[232:235]
    v_mfma_f32_16x16x32_bf16 v[236:239], a[128:131], v[52:55], v[236:239]
    s_waitcnt lgkmcnt(4)
    v_mfma_f32_16x16x32_bf16 v[208:211], v[124:127], v[56:59], v[208:211]
    v_mfma_f32_16x16x32_bf16 v[212:215], v[196:199], v[56:59], v[212:215]
    v_mfma_f32_16x16x32_bf16 v[216:219], v[124:127], v[60:63], v[216:219]
    v_mfma_f32_16x16x32_bf16 v[220:223], v[196:199], v[60:63], v[220:223]
    v_mfma_f32_16x16x32_bf16 v[224:227], a[60:63], v[56:59], v[224:227]
    v_mfma_f32_16x16x32_bf16 v[228:231], a[132:135], v[56:59], v[228:231]
    v_mfma_f32_16x16x32_bf16 v[232:235], a[60:63], v[60:63], v[232:235]
    v_mfma_f32_16x16x32_bf16 v[236:239], a[132:135], v[60:63], v[236:239]
    s_waitcnt lgkmcnt(2)
    v_mfma_f32_16x16x32_bf16 v[208:211], v[128:131], v[32:35], v[208:211]
    v_mfma_f32_16x16x32_bf16 v[212:215], v[200:203], v[32:35], v[212:215]
    v_mfma_f32_16x16x32_bf16 v[216:219], v[128:131], v[36:39], v[216:219]
    v_mfma_f32_16x16x32_bf16 v[220:223], v[200:203], v[36:39], v[220:223]
    v_mfma_f32_16x16x32_bf16 v[224:227], a[64:67], v[32:35], v[224:227]
    v_mfma_f32_16x16x32_bf16 v[228:231], a[136:139], v[32:35], v[228:231]
    v_mfma_f32_16x16x32_bf16 v[232:235], a[64:67], v[36:39], v[232:235]
    v_mfma_f32_16x16x32_bf16 v[236:239], a[136:139], v[36:39], v[236:239]
    s_waitcnt lgkmcnt(0)
    v_mfma_f32_16x16x32_bf16 v[208:211], v[132:135], v[40:43], v[208:211]
    v_mfma_f32_16x16x32_bf16 v[212:215], v[204:207], v[40:43], v[212:215]
    v_mfma_f32_16x16x32_bf16 v[216:219], v[132:135], v[44:47], v[216:219]
    v_mfma_f32_16x16x32_bf16 v[220:223], v[204:207], v[44:47], v[220:223]
    v_mfma_f32_16x16x32_bf16 v[224:227], a[68:71], v[40:43], v[224:227]
    v_mfma_f32_16x16x32_bf16 v[228:231], a[140:143], v[40:43], v[228:231]
    v_mfma_f32_16x16x32_bf16 v[232:235], a[68:71], v[44:47], v[232:235]
    v_mfma_f32_16x16x32_bf16 v[236:239], a[140:143], v[44:47], v[236:239]
    s_waitcnt vmcnt(0)
    v_cvt_pk_bf16_f32 v8, v208, v209
    v_cvt_pk_bf16_f32 v9, v210, v211
    v_cvt_pk_bf16_f32 v10, v212, v213
    v_cvt_pk_bf16_f32 v11, v214, v215
    s_mov_b32 s28, s26
    buffer_store_dwordx4 v[8:11], v7, s[4:7], s28 offen sc1
    v_cvt_pk_bf16_f32 v12, v216, v217
    v_cvt_pk_bf16_f32 v13, v218, v219
    v_cvt_pk_bf16_f32 v14, v220, v221
    v_cvt_pk_bf16_f32 v15, v222, v223
    s_add_u32 s28, s28, s40
    buffer_store_dwordx4 v[12:15], v7, s[4:7], s28 offen sc1
    v_cvt_pk_bf16_f32 v16, v224, v225
    v_cvt_pk_bf16_f32 v17, v226, v227
    v_cvt_pk_bf16_f32 v18, v228, v229
    v_cvt_pk_bf16_f32 v19, v230, v231
    s_add_u32 s28, s26, s43
    buffer_store_dwordx4 v[16:19], v7, s[4:7], s28 offen sc1
    v_cvt_pk_bf16_f32 v20, v232, v233
    v_cvt_pk_bf16_f32 v21, v234, v235
    v_cvt_pk_bf16_f32 v22, v236, v237
    v_cvt_pk_bf16_f32 v23, v238, v239
    s_add_u32 s28, s28, s40
    buffer_store_dwordx4 v[20:23], v7, s[4:7], s28 offen sc1
    s_add_u32 s26, s26, s41
    s_add_u32 s27, s27, 36864
    s_cmp_eq_u32 s27, 110592
    s_cselect_b32 s27, 0, s27
    s_add_u32 s30, s30, 1
    s_add_u32 s19, s19, s20
    s_cmp_lt_u32 s19, 64
    s_cbranch_scc1 qk_loop
    s_branch qk_done
qk_vloop:
    s_barrier
    v_add_u32 v3, s27, v1
    ds_read_b128 v[32:35], v3 offset:0
    ds_read_b128 v[36:39], v3 offset:18432
    ds_read_b128 v[40:43], v3 offset:1024
    ds_read_b128 v[44:47], v3 offset:19456
    ds_read_b128 v[48:51], v3 offset:2048
    ds_read_b128 v[52:55], v3 offset:20480
    s_sub_u32 s22, s30, 1
    v_mov_b32 v4, s22
    s_mov_b64 exec, s[34:35]
    buffer_store_dword v4, off, s[4:7], s29 sc1
    s_mov_b64 exec, -1
    s_add_u32 s22, s27, 73728
    s_sub_u32 s21, s22, 110592
    s_cselect_b32 s22, s22, s21
    ds_read_b128 v[56:59], v3 offset:3072
    ds_read_b128 v[60:63], v3 offset:21504
    s_add_u32 s23, s22, s25
    s_add_u32 m0, s23, 0
    s_nop 0
    buffer_load_dwordx4 v2, s[8:11], s24 offen offset:0 lds
    s_waitcnt lgkmcnt(6)
    v_mfma_f32_16x16x32_bf16 v[208:211], v[32:35], v[64:67], 0
    v_mfma_f32_16x16x32_bf16 v[212:215], v[32:35], v[136:139], 0
    v_mfma_f32_16x16x32_bf16 v[216:219], v[36:39], v[64:67], 0
    v_mfma_f32_16x16x32_bf16 v[220:223], v[36:39], v[136:139], 0
    v_mfma_f32_16x16x32_bf16 v[224:227], v[32:35], a[0:3], 0
    v_mfma_f32_16x16x32_bf16 v[228:231], v[32:35], a[72:75], 0
    v_mfma_f32_16x16x32_bf16 v[232:235], v[36:39], a[0:3], 0
    v_mfma_f32_16x16x32_bf16 v[236:239], v[36:39], a[72:75], 0
    ds_read_b128 v[32:35], v3 offset:4096
    ds_read_b128 v[36:39], v3 offset:22528
    s_add_u32 m0, s23, 960
    s_nop 0
    buffer_load_dwordx4 v2, s[8:11], s24 offen offset:64 lds
    s_waitcnt lgkmcnt(6)
    v_mfma_f32_16x16x32_bf16 v[208:211], v[40:43], v[68:71], v[208:211]
    v_mfma_f32_16x16x32_bf16 v[212:215], v[40:43], v[140:143], v[212:215]
    v_mfma_f32_16x16x32_bf16 v[216:219], v[44:47], v[68:71], v[216:219]
    v_mfma_f32_16x16x32_bf16 v[220:223], v[44:47], v[140:143], v[220:223]
    v_mfma_f32_16x16x32_bf16 v[224:227], v[40:43], a[4:7], v[224:227]
    v_mfma_f32_16x16x32_bf16 v[228:231], v[40:43], a[76:79], v[228:231]
    v_mfma_f32_16x16x32_bf16 v[232:235], v[44:47], a[4:7], v[232:235]
    v_mfma_f32_16x16x32_bf16 v[236:239], v[44:47], a[76:79], v[236:239]
    ds_read_b128 v[40:43], v3 offset:5120
    ds_read_b128 v[44:47], v3 offset:23552
    s_add_u32 m0, s23, 1920
    s_nop 0
    buffer_load_dwordx4 v2, s[8:11], s24 offen offset:128 lds
    s_waitcnt lgkmcnt(6)
    v_mfma_f32_16x16x32_bf16 v[208:211], v[48:51], v[72:75], v[208:211]
    v_mfma_f32_16x16x32_bf16 v[212:215], v[48:51], v[144:147], v[212:215]
    v_mfma_f32_16x16x32_bf16 v[216:219], v[52:55], v[72:75], v[216:219]
    v_mfma_f32_16x16x32_bf16 v[220:223], v[52:55], v[144:147], v[220:223]
    v_mfma_f32_16x16x32_bf16 v[224:227], v[48:51], a[8:11], v[224:227]
    v_mfma_f32_16x16x32_bf16 v[228:231], v[48:51], a[80:83], v[228:231]
    v_mfma_f32_16x16x32_bf16 v[232:235], v[52:55], a[8:11], v[232:235]
    v_mfma_f32_16x16x32_bf16 v[236:239], v[52:55], a[80:83], v[236:239]
    ds_read_b128 v[48:51], v3 offset:6144
    ds_read_b128 v[52:55], v3 offset:24576
    s_add_u32 m0, s23, 2880
    s_nop 0
    buffer_load_dwordx4 v2, s[8:11], s24 offen offset:192 lds
    s_waitcnt lgkmcnt(6)
    v_mfma_f32_16x16x32_bf16 v[208:211], v[56:59], v[76:79], v[208:211]
    v_mfma_f32_16x16x32_bf16 v[212:215], v[56:59], v[148:151], v[212:215]
    v_mfma_f32_16x16x32_bf16 v[216:219], v[60:63], v[76:79], v[216:219]
    v_mfma_f32_16x16x32_bf16 v[220:223], v[60:63], v[148:151], v[220:223]
    v_mfma_f32_16x16x32_bf16 v[224:227], v[56:59], a[12:15], v[224:227]
    v_mfma_f32_16x16x32_bf16 v[228:231], v[56:59], a[84:87], v[228:231]
    v_mfma_f32_16x16x32_bf16 v[232:235], v[60:63], a[12:15], v[232:235]
    v_mfma_f32_16x16x32_bf16 v[236:239], v[60:63], a[84:87], v[236:239]
    ds_read_b128 v[56:59], v3 offset:7168
    ds_read_b128 v[60:63], v3 offset:25600
    s_add_u32 m0, s23, 3840
    s_nop 0
    buffer_load_dwordx4 v2, s[8:11], s24 offen offset:256 lds
    s_waitcnt lgkmcnt(6)
    v_mfma_f32_16x16x32_bf16 v[208:211], v[32:35], v[80:83], v[208:211]
    v_mfma_f32_16x16x32_bf16 v[212:215], v[32:35], v[152:155], v[212:215]
    v_mfma_f32_16x16x32_bf16 v[216:219], v[36:39], v[80:83], v[216:219]
    v_mfma_f32_16x16x32_bf16 v[220:223], v[36:39], v[152:155], v[220:223]
    v_mfma_f32_16x16x32_bf16 v[224:227], v[32:35], a[16:19], v[224:227]
    v_mfma_f32_16x16x32_bf16 v[228:231], v[32:35], a[88:91], v[228:231]
    v_mfma_f32_16x16x32_bf16 v[232:235], v[36:39], a[16:19], v[232:235]
    v_mfma_f32_16x16x32_bf16 v[236:239], v[36:39], a[88:91], v[236:239]
    ds_read_b128 v[32:35], v3 offset:8192
    ds_read_b128 v[36:39], v3 offset:26624
    s_add_u32 m0, s23, 4800
    s_nop 0
    buffer_load_dwordx4 v2, s[8:11], s24 offen offset:320 lds
    s_waitcnt lgkmcnt(6)
    v_mfma_f32_16x16x32_bf16 v[208:211], v[40:43], v[84:87], v[208:211]
    v_mfma_f32_16x16x32_bf16 v[212:215], v[40:43], v[156:159], v[212:215]
    v_mfma_f32_16x16x32_bf16 v[216:219], v[44:47], v[84:87], v[216:219]
    v_mfma_f32_16x16x32_bf16 v[220:223], v[44:47], v[156:159], v[220:223]
    v_mfma_f32_16x16x32_bf16 v[224:227], v[40:43], a[20:23], v[224:227]
    v_mfma_f32_16x16x32_bf16 v[228:231], v[40:43], a[92:95], v[228:231]
    v_mfma_f32_16x16x32_bf16 v[232:235], v[44:47], a[20:23], v[232:235]
    v_mfma_f32_16x16x32_bf16 v[236:239], v[44:47], a[92:95], v[236:239]
    ds_read_b128 v[40:43], v3 offset:9216
    ds_read_b128 v[44:47], v3 offset:27648
    s_add_u32 m0, s23, 5760
    s_nop 0
    buffer_load_dwordx4 v2, s[8:11], s24 offen offset:384 lds
    s_waitcnt lgkmcnt(6)
    v_mfma_f32_16x16x32_bf16 v[208:211], v[48:51], v[88:91], v[208:211]
    v_mfma_f32_16x16x32_bf16 v[212:215], v[48:51], v[160:163], v[212:215]
    v_mfma_f32_16x16x32_bf16 v[216:219], v[52:55], v[88:91], v[216:219]
    v_mfma_f32_16x16x32_bf16 v[220:223], v[52:55], v[160:163], v[220:223]
    v_mfma_f32_16x16x32_bf16 v[224:227], v[48:51], a[24:27], v[224:227]
    v_mfma_f32_16x16x32_bf16 v[228:231], v[48:51], a[96:99], v[228:231]
    v_mfma_f32_16x16x32_bf16 v[232:235], v[52:55], a[24:27], v[232:235]
    v_mfma_f32_16x16x32_bf16 v[236:239], v[52:55], a[96:99], v[236:239]
    ds_read_b128 v[48:51], v3 offset:10240
    ds_read_b128 v[52:55], v3 offset:28672
    s_add_u32 m0, s23, 6720
    s_nop 0
    buffer_load_dwordx4 v2, s[8:11], s24 offen offset:448 lds
    s_waitcnt lgkmcnt(6)
    v_mfma_f32_16x16x32_bf16 v[208:211], v[56:59], v[92:95], v[208:211]
    v_mfma_f32_16x16x32_bf16 v[212:215], v[56:59], v[164:167], v[212:215]
    v_mfma_f32_16x16x32_bf16 v[216:219], v[60:63], v[92:95], v[216:219]
    v_mfma_f32_16x16x32_bf16 v[220:223], v[60:63], v[164:167], v[220:223]
    v_mfma_f32_16x16x32_bf16 v[224:227], v[56:59], a[28:31], v[224:227]
    v_mfma_f32_16x16x32_bf16 v[228:231], v[56:59], a[100:103], v[228:231]
    v_mfma_f32_16x16x32_bf16 v[232:235], v[60:63], a[28:31], v[232:235]
    v_mfma_f32_16x16x32_bf16 v[236:239], v[60:63], a[100:103], v[236:239]
    ds_read_b128 v[56:59], v3 offset:11264
    ds_read_b128 v[60:63], v3 offset:29696
    s_add_u32 m0, s23, 7680
    s_nop 0
    buffer_load_dwordx4 v2, s[8:11], s24 offen offset:512 lds
    s_add_u32 s24, s24, s42
    s_waitcnt lgkmcnt(6)
    v_mfma_f32_16x16x32_bf16 v[208:211], v[32:35], v[96:99], v[208:211]
    v_mfma_f32_16x16x32_bf16 v[212:215], v[32:35], v[168:171], v[212:215]
    v_mfma_f32_16x16x32_bf16 v[216:219], v[36:39], v[96:99], v[216:219]
    v_mfma_f32_16x16x32_bf16 v[220:223], v[36:39], v[168:171], v[220:223]
    v_mfma_f32_16x16x32_bf16 v[224:227], v[32:35], a[32:35], v[224:227]
    v_mfma_f32_16x16x32_bf16 v[228:231], v[32:35], a[104:107], v[228:231]
    v_mfma_f32_16x16x32_bf16 v[232:235], v[36:39], a[32:35], v[232:235]
    v_mfma_f32_16x16x32_bf16 v[236:239], v[36:39], a[104:107], v[236:239]
    ds_read_b128 v[32:35], v3 offset:12288
    ds_read_b128 v[36:39], v3 offset:30720
    s_waitcnt lgkmcnt(6)
    v_mfma_f32_16x16x32_bf16 v[208:211], v[40:43], v[100:103], v[208:211]
    v_mfma_f32_16x16x32_bf16 v[212:215], v[40:43], v[172:175], v[212:215]
    v_mfma_f32_16x16x32_bf16 v[216:219], v[44:47], v[100:103], v[216:219]
    v_mfma_f32_16x16x32_bf16 v[220:223], v[44:47], v[172:175], v[220:223]
    v_mfma_f32_16x16x32_bf16 v[224:227], v[40:43], a[36:39], v[224:227]
    v_mfma_f32_16x16x32_bf16 v[228:231], v[40:43], a[108:111], v[228:231]
    v_mfma_f32_16x16x32_bf16 v[232:235], v[44:47], a[36:39], v[232:235]
    v_mfma_f32_16x16x32_bf16 v[236:239], v[44:47], a[108:111], v[236:239]
    ds_read_b128 v[40:43], v3 offset:13312
    ds_read_b128 v[44:47], v3 offset:31744
    s_waitcnt lgkmcnt(6)
    v_mfma_f32_16x16x32_bf16 v[208:211], v[48:51], v[104:107], v[208:211]
    v_mfma_f32_16x16x32_bf16 v[212:215], v[48:51], v[176:179], v[212:215]
    v_mfma_f32_16x16x32_bf16 v[216:219], v[52:55], v[104:107], v[216:219]
    v_mfma_f32_16x16x32_bf16 v[220:223], v[52:55], v[176:179], v[220:223]
    v_mfma_f32_16x16x32_bf16 v[224:227], v[48:51], a[40:43], v[224:227]
    v_mfma_f32_16x16x32_bf16 v[228:231], v[48:51], a[112:115], v[228:231]
    v_mfma_f32_16x16x32_bf16 v[232:235], v[52:55], a[40:43], v[232:235]
    v_mfma_f32_16x16x32_bf16 v[236:239], v[52:55], a[112:115], v[236:239]
    ds_read_b128 v[48:51], v3 offset:14336
    ds_read_b128 v[52:55], v3 offset:32768
    s_waitcnt lgkmcnt(6)
    v_mfma_f32_16x16x32_bf16 v[208:211], v[56:59], v[108:111], v[208:211]
    v_mfma_f32_16x16x32_bf16 v[212:215], v[56:59], v[180:183], v[212:215]
    v_mfma_f32_16x16x32_bf16 v[216:219], v[60:63], v[108:111], v[216:219]
    v_mfma_f32_16x16x32_bf16 v[220:223], v[60:63], v[180:183], v[220:223]
    v_mfma_f32_16x16x32_bf16 v[224:227], v[56:59], a[44:47], v[224:227]
    v_mfma_f32_16x16x32_bf16 v[228:231], v[56:59], a[116:119], v[228:231]
    v_mfma_f32_16x16x32_bf16 v[232:235], v[60:63], a[44:47], v[232:235]
    v_mfma_f32_16x16x32_bf16 v[236:239], v[60:63], a[116:119], v[236:239]
    ds_read_b128 v[56:59], v3 offset:15360
    ds_read_b128 v[60:63], v3 offset:33792
    s_waitcnt lgkmcnt(6)
    v_mfma_f32_16x16x32_bf16 v[208:211], v[32:35], v[112:115], v[208:211]
    v_mfma_f32_16x16x32_bf16 v[212:215], v[32:35], v[184:187], v[212:215]
    v_mfma_f32_16x16x32_bf16 v[216:219], v[36:39], v[112:115], v[216:219]
    v_mfma_f32_16x16x32_bf16 v[220:223], v[36:39], v[184:187], v[220:223]
    v_mfma_f32_16x16x32_bf16 v[224:227], v[32:35], a[48:51], v[224:227]
    v_mfma_f32_16x16x32_bf16 v[228:231], v[32:35], a[120:123], v[228:231]
    v_mfma_f32_16x16x32_bf16 v[232:235], v[36:39], a[48:51], v[232:235]
    v_mfma_f32_16x16x32_bf16 v[236:239], v[36:39], a[120:123], v[236:239]
    ds_read_b128 v[32:35], v3 offset:16384
    ds_read_b128 v[36:39], v3 offset:34816
    s_waitcnt lgkmcnt(6)
    v_mfma_f32_16x16x32_bf16 v[208:211], v[40:43], v[116:119], v[208:211]
    v_mfma_f32_16x16x32_bf16 v[212:215], v[40:43], v[188:191], v[212:215]
    v_mfma_f32_16x16x32_bf16 v[216:219], v[44:47], v[116:119], v[216:219]
    v_mfma_f32_16x16x32_bf16 v[220:223], v[44:47], v[188:191], v[220:223]
    v_mfma_f32_16x16x32_bf16 v[224:227], v[40:43], a[52:55], v[224:227]
    v_mfma_f32_16x16x32_bf16 v[228:231], v[40:43], a[124:127], v[228:231]
    v_mfma_f32_16x16x32_bf16 v[232:235], v[44:47], a[52:55], v[232:235]
    v_mfma_f32_16x16x32_bf16 v[236:239], v[44:47], a[124:127], v[236:239]
    ds_read_b128 v[40:43], v3 offset:17408
    ds_read_b128 v[44:47], v3 offset:35840
    s_waitcnt lgkmcnt(6)
    v_mfma_f32_16x16x32_bf16 v[208:211], v[48:51], v[120:123], v[208:211]
    v_mfma_f32_16x16x32_bf16 v[212:215], v[48:51], v[192:195], v[212:215]
    v_mfma_f32_16x16x32_bf16 v[216:219], v[52:55], v[120:123], v[216:219]
    v_mfma_f32_16x16x32_bf16 v[220:223], v[52:55], v[192:195], v[220:223]
    v_mfma_f32_16x16x32_bf16 v[224:227], v[48:51], a[56:59], v[224:227]
    v_mfma_f32_16x16x32_bf16 v[228:231], v[48:51], a[128:131], v[228:231]
    v_mfma_f32_16x16x32_bf16 v[232:235], v[52:55], a[56:59], v[232:235]
    v_mfma_f32_16x16x32_bf16 v[236:239], v[52:55], a[128:131], v[236:239]
    s_waitcnt lgkmcnt(4)
    v_mfma_f32_16x16x32_bf16 v[208:211], v[56:59], v[124:127], v[208:211]
    v_mfma_f32_16x16x32_bf16 v[212:215], v[56:59], v[196:199], v[212:215]
    v_mfma_f32_16x16x32_bf16 v[216:219], v[60:63], v[124:127], v[216:219]
    v_mfma_f32_16x16x32_bf16 v[220:223], v[60:63], v[196:199], v[220:223]
    v_mfma_f32_16x16x32_bf16 v[224:227], v[56:59], a[60:63], v[224:227]
    v_mfma_f32_16x16x32_bf16 v[228:231], v[56:59], a[132:135], v[228:231]
    v_mfma_f32_16x16x32_bf16 v[232:235], v[60:63], a[60:63], v[232:235]
    v_mfma_f32_16x16x32_bf16 v[236:239], v[60:63], a[132:135], v[236:239]
    s_waitcnt lgkmcnt(2)
    v_mfma_f32_16x16x32_bf16 v[208:211], v[32:35], v[128:131], v[208:211]
    v_mfma_f32_16x16x32_bf16 v[212:215], v[32:35], v[200:203], v[212:215]
    v_mfma_f32_16x16x32_bf16 v[216:219], v[36:39], v[128:131], v[216:219]
    v_mfma_f32_16x16x32_bf16 v[220:223], v[36:39], v[200:203], v[220:223]
    v_mfma_f32_16x16x32_bf16 v[224:227], v[32:35], a[64:67], v[224:227]
    v_mfma_f32_16x16x32_bf16 v[228:231], v[32:35], a[136:139], v[228:231]
    v_mfma_f32_16x16x32_bf16 v[232:235], v[36:39], a[64:67], v[232:235]
    v_mfma_f32_16x16x32_bf16 v[236:239], v[36:39], a[136:139], v[236:239]
    s_waitcnt lgkmcnt(0)
    v_mfma_f32_16x16x32_bf16 v[208:211], v[40:43], v[132:135], v[208:211]
    v_mfma_f32_16x16x32_bf16 v[212:215], v[40:43], v[204:207], v[212:215]
    v_mfma_f32_16x16x32_bf16 v[216:219], v[44:47], v[132:135], v[216:219]
    v_mfma_f32_16x16x32_bf16 v[220:223], v[44:47], v[204:207], v[220:223]
    v_mfma_f32_16x16x32_bf16 v[224:227], v[40:43], a[68:71], v[224:227]
    v_mfma_f32_16x16x32_bf16 v[228:231], v[40:43], a[140:143], v[228:231]
    v_mfma_f32_16x16x32_bf16 v[232:235], v[44:47], a[68:71], v[232:235]
    v_mfma_f32_16x16x32_bf16 v[236:239], v[44:47], a[140:143], v[236:239]
    s_waitcnt vmcnt(0)
    v_cvt_pk_bf16_f32 v8, v208, v209
    v_cvt_pk_bf16_f32 v9, v210, v211
    v_cvt_pk_bf16_f32 v10, v216, v217
    v_cvt_pk_bf16_f32 v11, v218, v219
    s_mov_b32 s28, s26
    buffer_store_dwordx4 v[8:11], v7, s[4:7], s28 offen sc1
    v_cvt_pk_bf16_f32 v12, v212, v213
    v_cvt_pk_bf16_f32 v13, v214, v215
    v_cvt_pk_bf16_f32 v14, v220, v221
    v_cvt_pk_bf16_f32 v15, v222, v223
    s_add_u32 s28, s28, s40
    buffer_store_dwordx4 v[12:15], v7, s[4:7], s28 offen sc1
    v_cvt_pk_bf16_f32 v16, v224, v225
    v_cvt_pk_bf16_f32 v17, v226, v227
    v_cvt_pk_bf16_f32 v18, v232, v233
    v_cvt_pk_bf16_f32 v19, v234, v235
    s_add_u32 s28, s26, s43
    buffer_store_dwordx4 v[16:19], v7, s[4:7], s28 offen sc1
    v_cvt_pk_bf16_f32 v20, v228, v229
    v_cvt_pk_bf16_f32 v21, v230, v231
    v_cvt_pk_bf16_f32 v22, v236, v237
    v_cvt_pk_bf16_f32 v23, v238, v239
    s_add_u32 s28, s28, s40
    buffer_store_dwordx4 v[20:23], v7, s[4:7], s28 offen sc1
    s_add_u32 s26, s26, s41
    s_add_u32 s27, s27, 36864
    s_cmp_eq_u32 s27, 110592
    s_cselect_b32 s27, 0, s27
    s_add_u32 s30, s30, 1
    s_add_u32 s19, s19, s20
    s_cmp_lt_u32 s19, 64
    s_cbranch_scc1 qk_vloop
qk_done:
    s_waitcnt vmcnt(0)
    s_barrier
    s_add_u32 s22, s95, 63
    v_mov_b32 v4, s22
    s_mov_b64 exec, s[34:35]
    buffer_store_dword v4, off, s[4:7], s29 sc1
    s_mov_b64 exec, -1
    s_cmp_ge_u32 s36, 64
    s_cbranch_scc1 L_qkv_next
    s_lshr_b32 s33, s36, 5
    v_and_b32 v4, 63, v0
    v_lshrrev_b32 v5, 4, v4
    v_add_u32 v1, 0, v5
    v_mul_u32_u24 v6, 11, v1
    v_lshrrev_b32 v6, 5, v6
    v_add_u32 v1, v1, v6
    v_lshlrev_b32 v1, 7, v1
    v_and_b32 v6, 7, v4
    v_lshl_add_u32 v1, v6, 4, v1
    v_add_u32 v2, 4, v5
    v_mul_u32_u24 v6, 11, v2
    v_lshrrev_b32 v6, 5, v6
    v_add_u32 v2, v2, v6
    v_lshlrev_b32 v2, 7, v2
    v_and_b32 v6, 7, v4
    v_lshl_add_u32 v2, v6, 4, v2
    v_add_u32 v3, 8, v5
    v_mul_u32_u24 v6, 11, v3
    v_lshrrev_b32 v6, 5, v6
    v_add_u32 v3, v3, v6
    v_lshlrev_b32 v3, 7, v3
    v_and_b32 v6, 7, v4
    v_lshl_add_u32 v3, v6, 4, v3
    v_min_u32 v6, 23, v4
    v_lshlrev_b32 v6, 9, v6
    s_mov_b32 s19, s33
    s_mul_i32 s24, s19, 12288
    s_add_u32 s24, s24, 90177536
    s_lshl_b32 s26, s19, 5
    s_add_u32 s26, s26, s17
    s_lshl_b32 s26, s26, 12
    s_mov_b32 s21, 71303168
    s_cmp_eq_u32 s16, 2
    s_cselect_b32 s21, 80740352, s21
    s_add_u32 s26, s26, s21
    s_lshl_b32 s29, s17, 7
    s_lshl_b32 s21, s16, 1
    s_add_u32 s21, s21, s33
    s_lshl_b32 s21, s21, 2
    s_add_u32 s29, s29, s21
    s_add_u32 s29, s29, 125829240
mk_loop:
    s_cmp_lg_u32 s18, 0
    s_cbranch_scc1 mk_go
    s_add_u32 s23, s24, 12288
    s_mov_b32 s21, 4194304
mk_wait:
    buffer_load_dword v4, v6, s[4:7], s23 offen offset:384 sc1
    s_sub_u32 s21, s21, 1
    s_cbranch_scc1 mk_go
    s_waitcnt vmcnt(0)
    v_cmp_ne_u32 vcc, s95, v4
    s_cbranch_vccz mk_go
    s_sleep 4
    s_branch mk_wait
mk_go:
    s_barrier
    s_add_u32 s23, s24, 0
    buffer_load_dwordx4 v[24:27], v1, s[4:7], s23 offen offset:0 sc1
    buffer_load_dwordx4 v[28:31], v2, s[4:7], s23 offen offset:0 sc1
    buffer_load_dwordx4 v[32:35], v3, s[4:7], s23 offen offset:0 sc1
    buffer_load_dwordx4 v[36:39], v1, s[4:7], s23 offen offset:2048 sc1
    buffer_load_dwordx4 v[40:43], v2, s[4:7], s23 offen offset:2048 sc1
    buffer_load_dwordx4 v[44:47], v3, s[4:7], s23 offen offset:2048 sc1
    s_add_u32 s23, s24, 4096
    buffer_load_dwordx4 v[48:51], v1, s[4:7], s23 offen offset:0 sc1
    buffer_load_dwordx4 v[52:55], v2, s[4:7], s23 offen offset:0 sc1
    buffer_load_dwordx4 v[56:59], v3, s[4:7], s23 offen offset:0 sc1
    buffer_load_dwordx4 v[60:63], v1, s[4:7], s23 offen offset:2048 sc1
    buffer_load_dwordx4 v[208:211], v2, s[4:7], s23 offen offset:2048 sc1
    buffer_load_dwordx4 v[212:215], v3, s[4:7], s23 offen offset:2048 sc1
    s_add_u32 s23, s24, 8192
    buffer_load_dwordx4 v[216:219], v1, s[4:7], s23 offen offset:0 sc1
    buffer_load_dwordx4 v[220:223], v2, s[4:7], s23 offen offset:0 sc1
    buffer_load_dwordx4 v[224:227], v3, s[4:7], s23 offen offset:0 sc1
    buffer_load_dwordx4 v[228:231], v1, s[4:7], s23 offen offset:2048 sc1
    buffer_load_dwordx4 v[232:235], v2, s[4:7], s23 offen offset:2048 sc1
    buffer_load_dwordx4 v[236:239], v3, s[4:7], s23 offen offset:2048 sc1
    s_add_u32 s24, s24, 24576
    s_add_u32 s22, s19, s95
    s_add_u32 s22, s22, 1
    s_cmp_eq_u32 s16, 2
    s_cbranch_scc1 mk_v
    s_waitcnt vmcnt(17)
    v_mfma_f32_16x16x32_bf16 v[8:11], v[64:67], v[24:27], 0
    v_mfma_f32_16x16x32_bf16 v[12:15], v[136:139], v[24:27], 0
    v_mfma_f32_16x16x32_bf16 v[16:19], a[0:3], v[24:27], 0
    v_mfma_f32_16x16x32_bf16 v[20:23], a[72:75], v[24:27], 0
    s_waitcnt vmcnt(16)
    v_mfma_f32_16x16x32_bf16 v[8:11], v[68:71], v[28:31], v[8:11]
    v_mfma_f32_16x16x32_bf16 v[12:15], v[140:143], v[28:31], v[12:15]
    v_mfma_f32_16x16x32_bf16 v[16:19], a[4:7], v[28:31], v[16:19]
    v_mfma_f32_16x16x32_bf16 v[20:23], a[76:79], v[28:31], v[20:23]
    s_waitcnt vmcnt(15)
    v_mfma_f32_16x16x32_bf16 v[8:11], v[72:75], v[32:35], v[8:11]
    v_mfma_f32_16x16x32_bf16 v[12:15], v[144:147], v[32:35], v[12:15]
    v_mfma_f32_16x16x32_bf16 v[16:19], a[8:11], v[32:35], v[16:19]
    v_mfma_f32_16x16x32_bf16 v[20:23], a[80:83], v[32:35], v[20:23]
    s_waitcnt vmcnt(14)
    v_mfma_f32_16x16x32_bf16 v[8:11], v[76:79], v[36:39], v[8:11]
    v_mfma_f32_16x16x32_bf16 v[12:15], v[148:151], v[36:39], v[12:15]
    v_mfma_f32_16x16x32_bf16 v[16:19], a[12:15], v[36:39], v[16:19]
    v_mfma_f32_16x16x32_bf16 v[20:23], a[84:87], v[36:39], v[20:23]
    s_waitcnt vmcnt(13)
    v_mfma_f32_16x16x32_bf16 v[8:11], v[80:83], v[40:43], v[8:11]
    v_mfma_f32_16x16x32_bf16 v[12:15], v[152:155], v[40:43], v[12:15]
    v_mfma_f32_16x16x32_bf16 v[16:19], a[16:19], v[40:43], v[16:19]
    v_mfma_f32_16x16x32_bf16 v[20:23], a[88:91], v[40:43], v[20:23]
    s_waitcnt vmcnt(12)
    v_mfma_f32_16x16x32_bf16 v[8:11], v[84:87], v[44:47], v[8:11]
    v_mfma_f32_16x16x32_bf16 v[12:15], v[156:159], v[44:47], v[12:15]
    v_mfma_f32_16x16x32_bf16 v[16:19], a[20:23], v[44:47], v[16:19]
    v_mfma_f32_16x16x32_bf16 v[20:23], a[92:95], v[44:47], v[20:23]
    s_waitcnt vmcnt(11)
    v_mfma_f32_16x16x32_bf16 v[8:11], v[88:91], v[48:51], v[8:11]
    v_mfma_f32_16x16x32_bf16 v[12:15], v[160:163], v[48:51], v[12:15]
    v_mfma_f32_16x16x32_bf16 v[16:19], a[24:27], v[48:51], v[16:19]
    v_mfma_f32_16x16x32_bf16 v[20:23], a[96:99], v[48:51], v[20:23]
    s_waitcnt vmcnt(10)
    v_mfma_f32_16x16x32_bf16 v[8:11], v[92:95], v[52:55], v[8:11]
    v_mfma_f32_16x16x32_bf16 v[12:15], v[164:167], v[52:55], v[12:15]
    v_mfma_f32_16x16x32_bf16 v[16:19], a[28:31], v[52:55], v[16:19]
    v_mfma_f32_16x16x32_bf16 v[20:23], a[100:103], v[52:55], v[20:23]
    s_waitcnt vmcnt(9)
    v_mfma_f32_16x16x32_bf16 v[8:11], v[96:99], v[56:59], v[8:11]
    v_mfma_f32_16x16x32_bf16 v[12:15], v[168:171], v[56:59], v[12:15]
    v_mfma_f32_16x16x32_bf16 v[16:19], a[32:35], v[56:59], v[16:19]
    v_mfma_f32_16x16x32_bf16 v[20:23], a[104:107], v[56:59], v[20:23]
    s_waitcnt vmcnt(8)
    v_mfma_f32_16x16x32_bf16 v[8:11], v[100:103], v[60:63], v[8:11]
    v_mfma_f32_16x16x32_bf16 v[12:15], v[172:175], v[60:63], v[12:15]
    v_mfma_f32_16x16x32_bf16 v[16:19], a[36:39], v[60:63], v[16:19]
    v_mfma_f32_16x16x32_bf16 v[20:23], a[108:111], v[60:63], v[20:23]
    s_waitcnt vmcnt(7)
    v_mfma_f32_16x16x32_bf16 v[8:11], v[104:107], v[208:211], v[8:11]
    v_mfma_f32_16x16x32_bf16 v[12:15], v[176:179], v[208:211], v[12:15]
    v_mfma_f32_16x16x32_bf16 v[16:19], a[40:43], v[208:211], v[16:19]
    v_mfma_f32_16x16x32_bf16 v[20:23], a[112:115], v[208:211], v[20:23]
    s_waitcnt vmcnt(6)
    v_mfma_f32_16x16x32_bf16 v[8:11], v[108:111], v[212:215], v[8:11]
    v_mfma_f32_16x16x32_bf16 v[12:15], v[180:183], v[212:215], v[12:15]
    v_mfma_f32_16x16x32_bf16 v[16:19], a[44:47], v[212:215], v[16:19]
    v_mfma_f32_16x16x32_bf16 v[20:23], a[116:119], v[212:215], v[20:23]
    s_waitcnt vmcnt(5)
    v_mfma_f32_16x16x32_bf16 v[8:11], v[112:115], v[216:219], v[8:11]
    v_mfma_f32_16x16x32_bf16 v[12:15], v[184:187], v[216:219], v[12:15]
    v_mfma_f32_16x16x32_bf16 v[16:19], a[48:51], v[216:219], v[16:19]
    v_mfma_f32_16x16x32_bf16 v[20:23], a[120:123], v[216:219], v[20:23]
    s_waitcnt vmcnt(4)
    v_mfma_f32_16x16x32_bf16 v[8:11], v[116:119], v[220:223], v[8:11]
    v_mfma_f32_16x16x32_bf16 v[12:15], v[188:191], v[220:223], v[12:15]
    v_mfma_f32_16x16x32_bf16 v[16:19], a[52:55], v[220:223], v[16:19]
    v_mfma_f32_16x16x32_bf16 v[20:23], a[124:127], v[220:223], v[20:23]
    s_waitcnt vmcnt(3)
    v_mfma_f32_16x16x32_bf16 v[8:11], v[120:123], v[224:227], v[8:11]
    v_mfma_f32_16x16x32_bf16 v[12:15], v[192:195], v[224:227], v[12:15]
    v_mfma_f32_16x16x32_bf16 v[16:19], a[56:59], v[224:227], v[16:19]
    v_mfma_f32_16x16x32_bf16 v[20:23], a[128:131], v[224:227], v[20:23]
    s_waitcnt vmcnt(2)
    v_mfma_f32_16x16x32_bf16 v[8:11], v[124:127], v[228:231], v[8:11]
    v_mfma_f32_16x16x32_bf16 v[12:15], v[196:199], v[228:231], v[12:15]
    v_mfma_f32_16x16x32_bf16 v[16:19], a[60:63], v[228:231], v[16:19]
    v_mfma_f32_16x16x32_bf16 v[20:23], a[132:135], v[228:231], v[20:23]
    s_waitcnt vmcnt(1)
    v_mfma_f32_16x16x32_bf16 v[8:11], v[128:131], v[232:235], v[8:11]
    v_mfma_f32_16x16x32_bf16 v[12:15], v[200:203], v[232:235], v[12:15]
    v_mfma_f32_16x16x32_bf16 v[16:19], a[64:67], v[232:235], v[16:19]
    v_mfma_f32_16x16x32_bf16 v[20:23], a[136:139], v[232:235], v[20:23]
    s_waitcnt vmcnt(0)
    v_mfma_f32_16x16x32_bf16 v[8:11], v[132:135], v[236:239], v[8:11]
    v_mfma_f32_16x16x32_bf16 v[12:15], v[204:207], v[236:239], v[12:15]
    v_mfma_f32_16x16x32_bf16 v[16:19], a[68:71], v[236:239], v[16:19]
    v_mfma_f32_16x16x32_bf16 v[20:23], a[140:143], v[236:239], v[20:23]
    s_nop 7
    s_branch mk_st
mk_v:
    s_waitcnt vmcnt(17)
    v_mfma_f32_16x16x32_bf16 v[8:11], v[24:27], v[64:67], 0
    v_mfma_f32_16x16x32_bf16 v[12:15], v[24:27], v[136:139], 0
    v_mfma_f32_16x16x32_bf16 v[16:19], v[24:27], a[0:3], 0
    v_mfma_f32_16x16x32_bf16 v[20:23], v[24:27], a[72:75], 0
    s_waitcnt vmcnt(16)
    v_mfma_f32_16x16x32_bf16 v[8:11], v[28:31], v[68:71], v[8:11]
    v_mfma_f32_16x16x32_bf16 v[12:15], v[28:31], v[140:143], v[12:15]
    v_mfma_f32_16x16x32_bf16 v[16:19], v[28:31], a[4:7], v[16:19]
    v_mfma_f32_16x16x32_bf16 v[20:23], v[28:31], a[76:79], v[20:23]
    s_waitcnt vmcnt(15)
    v_mfma_f32_16x16x32_bf16 v[8:11], v[32:35], v[72:75], v[8:11]
    v_mfma_f32_16x16x32_bf16 v[12:15], v[32:35], v[144:147], v[12:15]
    v_mfma_f32_16x16x32_bf16 v[16:19], v[32:35], a[8:11], v[16:19]
    v_mfma_f32_16x16x32_bf16 v[20:23], v[32:35], a[80:83], v[20:23]
    s_waitcnt vmcnt(14)
    v_mfma_f32_16x16x32_bf16 v[8:11], v[36:39], v[76:79], v[8:11]
    v_mfma_f32_16x16x32_bf16 v[12:15], v[36:39], v[148:151], v[12:15]
    v_mfma_f32_16x16x32_bf16 v[16:19], v[36:39], a[12:15], v[16:19]
    v_mfma_f32_16x16x32_bf16 v[20:23], v[36:39], a[84:87], v[20:23]
    s_waitcnt vmcnt(13)
    v_mfma_f32_16x16x32_bf16 v[8:11], v[40:43], v[80:83], v[8:11]
    v_mfma_f32_16x16x32_bf16 v[12:15], v[40:43], v[152:155], v[12:15]
    v_mfma_f32_16x16x32_bf16 v[16:19], v[40:43], a[16:19], v[16:19]
    v_mfma_f32_16x16x32_bf16 v[20:23], v[40:43], a[88:91], v[20:23]
    s_waitcnt vmcnt(12)
    v_mfma_f32_16x16x32_bf16 v[8:11], v[44:47], v[84:87], v[8:11]
    v_mfma_f32_16x16x32_bf16 v[12:15], v[44:47], v[156:159], v[12:15]
    v_mfma_f32_16x16x32_bf16 v[16:19], v[44:47], a[20:23], v[16:19]
    v_mfma_f32_16x16x32_bf16 v[20:23], v[44:47], a[92:95], v[20:23]
    s_waitcnt vmcnt(11)
    v_mfma_f32_16x16x32_bf16 v[8:11], v[48:51], v[88:91], v[8:11]
    v_mfma_f32_16x16x32_bf16 v[12:15], v[48:51], v[160:163], v[12:15]
    v_mfma_f32_16x16x32_bf16 v[16:19], v[48:51], a[24:27], v[16:19]
    v_mfma_f32_16x16x32_bf16 v[20:23], v[48:51], a[96:99], v[20:23]
    s_waitcnt vmcnt(10)
    v_mfma_f32_16x16x32_bf16 v[8:11], v[52:55], v[92:95], v[8:11]
    v_mfma_f32_16x16x32_bf16 v[12:15], v[52:55], v[164:167], v[12:15]
    v_mfma_f32_16x16x32_bf16 v[16:19], v[52:55], a[28:31], v[16:19]
    v_mfma_f32_16x16x32_bf16 v[20:23], v[52:55], a[100:103], v[20:23]
    s_waitcnt vmcnt(9)
    v_mfma_f32_16x16x32_bf16 v[8:11], v[56:59], v[96:99], v[8:11]
    v_mfma_f32_16x16x32_bf16 v[12:15], v[56:59], v[168:171], v[12:15]
    v_mfma_f32_16x16x32_bf16 v[16:19], v[56:59], a[32:35], v[16:19]
    v_mfma_f32_16x16x32_bf16 v[20:23], v[56:59], a[104:107], v[20:23]
    s_waitcnt vmcnt(8)
    v_mfma_f32_16x16x32_bf16 v[8:11], v[60:63], v[100:103], v[8:11]
    v_mfma_f32_16x16x32_bf16 v[12:15], v[60:63], v[172:175], v[12:15]
    v_mfma_f32_16x16x32_bf16 v[16:19], v[60:63], a[36:39], v[16:19]
    v_mfma_f32_16x16x32_bf16 v[20:23], v[60:63], a[108:111], v[20:23]
    s_waitcnt vmcnt(7)
    v_mfma_f32_16x16x32_bf16 v[8:11], v[208:211], v[104:107], v[8:11]
    v_mfma_f32_16x16x32_bf16 v[12:15], v[208:211], v[176:179], v[12:15]
    v_mfma_f32_16x16x32_bf16 v[16:19], v[208:211], a[40:43], v[16:19]
    v_mfma_f32_16x16x32_bf16 v[20:23], v[208:211], a[112:115], v[20:23]
    s_waitcnt vmcnt(6)
    v_mfma_f32_16x16x32_bf16 v[8:11], v[212:215], v[108:111], v[8:11]
    v_mfma_f32_16x16x32_bf16 v[12:15], v[212:215], v[180:183], v[12:15]
    v_mfma_f32_16x16x32_bf16 v[16:19], v[212:215], a[44:47], v[16:19]
    v_mfma_f32_16x16x32_bf16 v[20:23], v[212:215], a[116:119], v[20:23]
    s_waitcnt vmcnt(5)
    v_mfma_f32_16x16x32_bf16 v[8:11], v[216:219], v[112:115], v[8:11]
    v_mfma_f32_16x16x32_bf16 v[12:15], v[216:219], v[184:187], v[12:15]
    v_mfma_f32_16x16x32_bf16 v[16:19], v[216:219], a[48:51], v[16:19]
    v_mfma_f32_16x16x32_bf16 v[20:23], v[216:219], a[120:123], v[20:23]
    s_waitcnt vmcnt(4)
    v_mfma_f32_16x16x32_bf16 v[8:11], v[220:223], v[116:119], v[8:11]
    v_mfma_f32_16x16x32_bf16 v[12:15], v[220:223], v[188:191], v[12:15]
    v_mfma_f32_16x16x32_bf16 v[16:19], v[220:223], a[52:55], v[16:19]
    v_mfma_f32_16x16x32_bf16 v[20:23], v[220:223], a[124:127], v[20:23]
    s_waitcnt vmcnt(3)
    v_mfma_f32_16x16x32_bf16 v[8:11], v[224:227], v[120:123], v[8:11]
    v_mfma_f32_16x16x32_bf16 v[12:15], v[224:227], v[192:195], v[12:15]
    v_mfma_f32_16x16x32_bf16 v[16:19], v[224:227], a[56:59], v[16:19]
    v_mfma_f32_16x16x32_bf16 v[20:23], v[224:227], a[128:131], v[20:23]
    s_waitcnt vmcnt(2)
    v_mfma_f32_16x16x32_bf16 v[8:11], v[228:231], v[124:127], v[8:11]
    v_mfma_f32_16x16x32_bf16 v[12:15], v[228:231], v[196:199], v[12:15]
    v_mfma_f32_16x16x32_bf16 v[16:19], v[228:231], a[60:63], v[16:19]
    v_mfma_f32_16x16x32_bf16 v[20:23], v[228:231], a[132:135], v[20:23]
    s_waitcnt vmcnt(1)
    v_mfma_f32_16x16x32_bf16 v[8:11], v[232:235], v[128:131], v[8:11]
    v_mfma_f32_16x16x32_bf16 v[12:15], v[232:235], v[200:203], v[12:15]
    v_mfma_f32_16x16x32_bf16 v[16:19], v[232:235], a[64:67], v[16:19]
    v_mfma_f32_16x16x32_bf16 v[20:23], v[232:235], a[136:139], v[20:23]
    s_waitcnt vmcnt(0)
    v_mfma_f32_16x16x32_bf16 v[8:11], v[236:239], v[132:135], v[8:11]
    v_mfma_f32_16x16x32_bf16 v[12:15], v[236:239], v[204:207], v[12:15]
    v_mfma_f32_16x16x32_bf16 v[16:19], v[236:239], a[68:71], v[16:19]
    v_mfma_f32_16x16x32_bf16 v[20:23], v[236:239], a[140:143], v[20:23]
    v_pk_mul_f32 v[8:9], v[8:9], 0.5 op_sel_hi:[1,0]
    v_pk_mul_f32 v[10:11], v[10:11], 0.5 op_sel_hi:[1,0]
    v_pk_mul_f32 v[12:13], v[12:13], 0.5 op_sel_hi:[1,0]
    v_pk_mul_f32 v[14:15], v[14:15], 0.5 op_sel_hi:[1,0]
    v_pk_mul_f32 v[16:17], v[16:17], 0.5 op_sel_hi:[1,0]
    v_pk_mul_f32 v[18:19], v[18:19], 0.5 op_sel_hi:[1,0]
    s_nop 1
    v_pk_mul_f32 v[20:21], v[20:21], 0.5 op_sel_hi:[1,0]
    v_pk_mul_f32 v[22:23], v[22:23], 0.5 op_sel_hi:[1,0]
    s_nop 1
mk_st:
    v_cvt_pk_bf16_f32 v24, v8, v9
    v_cvt_pk_bf16_f32 v25, v10, v11
    v_cvt_pk_bf16_f32 v26, v12, v13
    v_cvt_pk_bf16_f32 v27, v14, v15
    v_cvt_pk_bf16_f32 v28, v16, v17
    v_cvt_pk_bf16_f32 v29, v18, v19
    v_cvt_pk_bf16_f32 v30, v20, v21
    v_cvt_pk_bf16_f32 v31, v22, v23
    s_add_u32 s21, s26, 4096
    buffer_store_dwordx4 v[24:27], v7, s[4:7], s26 offen sc1
    buffer_store_dwordx4 v[28:31], v7, s[4:7], s21 offen sc1
    s_waitcnt vmcnt(0)
    s_barrier
    v_mov_b32 v4, s22
    s_mov_b64 exec, s[34:35]
    buffer_store_dword v4, off, s[4:7], s29 sc1
    s_mov_b64 exec, -1
    s_add_u32 s19, s19, 2
    s_add_u32 s26, s26, 262144
    s_cmp_lt_u32 s19, 63
    s_cbranch_scc1 mk_loop
    s_endpgm
L_ssm_next:
    s_mov_b32 s37, 8
    v_mov_b32 v250, 1
    v_mov_b32 v251, 163832
    v_cmp_eq_u32 vcc, 0, v0
    s_nop 0
    s_and_saveexec_b64 s[38:39], vcc
    s_cbranch_execz tk4
    buffer_atomic_add v250, off, s[96:99], s37 sc0
    s_waitcnt vmcnt(0)
    ds_write_b32 v251, v250
    s_waitcnt lgkmcnt(0)
tk4:
    s_mov_b64 exec, -1
    s_barrier
    ds_read_b32 v252, v251
    s_waitcnt lgkmcnt(0)
    v_readfirstlane_b32 s20, v252
    s_barrier
    s_nop 3
    s_cmp_ge_u32 s20, 144
    s_cbranch_scc1 L_phase2
    s_lshl_b32 s20, s20, 2
    v_lshrrev_b32 v5, 6, v0
    s_nop 0
    v_readfirstlane_b32 s21, v5
    v_and_b32 v1, 63, v0
    v_and_b32 v2, 15, v1
    v_lshrrev_b32 v3, 4, v1
    v_lshlrev_b32 v4, 14, v5
    s_mov_b32 s8, s62
    s_mov_b32 s9, s63
    s_mov_b32 s10, 2359296
    s_mov_b32 s11, 0x20000
    s_mov_b32 s16, s76
    s_mov_b32 s17, s77
    s_mov_b32 s18, 4718592
    s_mov_b32 s19, 0x20000
    v_mul_u32_u24 v5, 9216, v0
    s_lshl_b32 s22, s20, 1
    s_add_u32 s23, s22, 0
    buffer_load_dwordx2 v[8:9], v5, s[8:11], s23 offen
    s_add_u32 s23, s22, 1152
    buffer_load_dwordx2 v[10:11], v5, s[8:11], s23 offen
    s_add_u32 s23, s22, 2304
    buffer_load_dwordx2 v[12:13], v5, s[8:11], s23 offen
    s_add_u32 s23, s22, 3456
    buffer_load_dwordx2 v[14:15], v5, s[8:11], s23 offen
    s_add_u32 s23, s22, 4608
    buffer_load_dwordx2 v[16:17], v5, s[8:11], s23 offen
    s_add_u32 s23, s22, 5760
    buffer_load_dwordx2 v[18:19], v5, s[8:11], s23 offen
    s_add_u32 s23, s22, 6912
    buffer_load_dwordx2 v[20:21], v5, s[8:11], s23 offen
    s_add_u32 s23, s22, 8064
    buffer_load_dwordx2 v[22:23], v5, s[8:11], s23 offen
    s_add_u32 s22, s20, s21
    s_lshl_b32 s23, s22, 8
    v_lshlrev_b32 v6, 3, v2
    v_lshl_add_u32 v6, v3, 1, v6
    s_mov_b32 s12, s64
    s_mov_b32 s13, s65
    s_mov_b32 s14, 147456
    s_mov_b32 s15, 0x20000
    buffer_load_ushort v24, v6, s[12:15], s23 offen offset:0
    buffer_load_ushort v28, v6, s[12:15], s23 offen offset:128
    s_mov_b32 s12, s66
    s_mov_b32 s13, s67
    s_mov_b32 s14, 147456
    s_mov_b32 s15, 0x20000
    buffer_load_ushort v25, v6, s[12:15], s23 offen offset:0
    buffer_load_ushort v29, v6, s[12:15], s23 offen offset:128
    s_mov_b32 s12, s68
    s_mov_b32 s13, s69
    s_mov_b32 s14, 147456
    s_mov_b32 s15, 0x20000
    buffer_load_ushort v26, v6, s[12:15], s23 offen offset:0
    buffer_load_ushort v30, v6, s[12:15], s23 offen offset:128
    s_mov_b32 s12, s70
    s_mov_b32 s13, s71
    s_mov_b32 s14, 147456
    s_mov_b32 s15, 0x20000
    buffer_load_ushort v27, v6, s[12:15], s23 offen offset:0
    buffer_load_ushort v31, v6, s[12:15], s23 offen offset:128
    s_mov_b32 s12, s72
    s_mov_b32 s13, s73
    s_mov_b32 s14, 1152
    s_mov_b32 s15, 0x20000
    s_lshl_b32 s23, s22, 1
    buffer_load_ushort v32, off, s[12:15], s23
    s_mov_b32 s26, 0x3fb8aa3b
    s_mov_b32 s27, 0x3e22f983
    v_mov_b32 v34, 0
    v_mov_b32 v35, 0
    v_lshl_add_u32 v6, v1, 3, v4
    ds_write_b64 v6, v[34:35] offset:0
    s_waitcnt vmcnt(0)
    v_mov_b32 v36, 0x05040100
    v_mov_b32 v37, 0x07060302
    v_lshlrev_b32 v6, 4, v0
    v_perm_b32 v40, v10, v8, v36
    v_perm_b32 v41, v14, v12, v36
    v_perm_b32 v42, v18, v16, v36
    v_perm_b32 v43, v22, v20, v36
    ds_write_b128 v6, v[40:43] offset:512
    s_nop 1
    v_perm_b32 v40, v10, v8, v37
    v_perm_b32 v41, v14, v12, v37
    v_perm_b32 v42, v18, v16, v37
    v_perm_b32 v43, v22, v20, v37
    ds_write_b128 v6, v[40:43] offset:16896
    s_nop 1
    v_perm_b32 v40, v11, v9, v36
    v_perm_b32 v41, v15, v13, v36
    v_perm_b32 v42, v19, v17, v36
    v_perm_b32 v43, v23, v21, v36
    ds_write_b128 v6, v[40:43] offset:33280
    s_nop 1
    v_perm_b32 v40, v11, v9, v37
    v_perm_b32 v41, v15, v13, v37
    v_perm_b32 v42, v19, v17, v37
    v_perm_b32 v43, v23, v21, v37
    ds_write_b128 v6, v[40:43] offset:49664
    s_nop 1
    v_lshlrev_b32 v32, 16, v32
    v_mul_f32 v32, s26, v32
    v_exp_f32 v32, v32
    s_nop 0
    v_cvt_pk_bf16_f32 v32, v32, v32
    v_and_b32 v32, 0xffff0000, v32
    v_add_f32 v33, v32, v32
    v_lshlrev_b32 v24, 16, v24
    v_mul_f32 v24, s26, v24
    v_exp_f32 v24, v24
    s_nop 0
    v_cvt_pk_bf16_f32 v24, v24, v24
    v_and_b32 v24, 0xffff0000, v24
    v_mul_f32 v24, v24, v32
    v_mul_f32 v24, s26, v24
    v_sub_f32 v24, 0, v24
    v_lshlrev_b32 v25, 16, v25
    v_mul_f32 v25, v25, v32
    v_mul_f32 v25, s27, v25
    v_lshlrev_b32 v26, 16, v26
    v_mul_f32 v26, v26, v33
    v_lshlrev_b32 v27, 16, v27
    v_mul_f32 v27, v27, v33
    v_lshlrev_b32 v28, 16, v28
    v_mul_f32 v28, s26, v28
    v_exp_f32 v28, v28
    s_nop 0
    v_cvt_pk_bf16_f32 v28, v28, v28
    v_and_b32 v28, 0xffff0000, v28
    v_mul_f32 v28, v28, v32
    v_mul_f32 v28, s26, v28
    v_sub_f32 v28, 0, v28
    v_lshlrev_b32 v29, 16, v29
    v_mul_f32 v29, v29, v32
    v_mul_f32 v29, s27, v29
    v_lshlrev_b32 v30, 16, v30
    v_mul_f32 v30, v30, v33
    v_lshlrev_b32 v31, 16, v31
    v_mul_f32 v31, v31, v33
    v_cvt_f32_u32 v47, v2
    v_mul_f32 v44, 0x41800000, v47
    v_and_b32 v5, 7, v2
    v_add_u32 v5, 8, v5
    v_cvt_f32_u32 v5, v5
    v_mul_f32 v45, 0x42000000, v5
    v_mul_f32 v6, 0x42800000, v5
    v_cmp_lt_u32 vcc, 7, v2
    s_nop 1
    v_cndmask_b32 v45, v45, v6, vcc
    v_add_f32 v5, 0x41000000, v47
    v_mul_f32 v46, 0x43000000, v5
    v_mov_b32 v48, 0
    v_mov_b32 v49, 0
    v_mov_b32 v50, 0
    v_mov_b32 v51, 0
    v_mov_b32 v52, 0
    v_mov_b32 v53, 0
    v_mov_b32 v54, 0
    v_mov_b32 v55, 0
    v_mov_b32 v56, 0
    v_mov_b32 v57, 0
    v_mov_b32 v58, 0
    v_mov_b32 v59, 0
    v_mov_b32 v60, 0
    v_mov_b32 v61, 0
    v_mov_b32 v62, 0
    v_mov_b32 v63, 0
    v_mov_b32_dpp v64, v24 row_newbcast:0 row_mask:0xf bank_mask:0xf
    v_mov_b32_dpp v65, v25 row_newbcast:0 row_mask:0xf bank_mask:0xf
    v_mov_b32_dpp v66, v26 row_newbcast:0 row_mask:0xf bank_mask:0xf
    v_mov_b32_dpp v67, v27 row_newbcast:0 row_mask:0xf bank_mask:0xf
    v_mul_f32 v82, v64, v47
    v_mul_f32 v83, v65, v47
    v_exp_f32 v82, v82
    v_fract_f32 v83, v83
    v_cos_f32 v74, v83
    v_sin_f32 v75, v83
    v_mul_f32 v74, v74, v82
    v_mul_f32 v75, v75, v82
    v_mul_f32 v84, v75, v75
    v_add_f32 v85, v74, v74
    v_fma_f32 v76, v74, v74, -v84
    v_mul_f32 v77, v85, v75
    v_mul_f32 v84, v77, v77
    v_add_f32 v85, v76, v76
    v_fma_f32 v78, v76, v76, -v84
    v_mul_f32 v79, v85, v77
    v_mul_f32 v84, v79, v79
    v_add_f32 v85, v78, v78
    v_fma_f32 v80, v78, v78, -v84
    v_mul_f32 v81, v85, v79
    v_mul_f32 v82, v64, v44
    v_mul_f32 v83, v65, v44
    v_exp_f32 v82, v82
    v_fract_f32 v83, v83
    v_cos_f32 v68, v83
    v_sin_f32 v69, v83
    v_mul_f32 v68, v68, v82
    v_mul_f32 v69, v69, v82
    v_mul_f32 v84, v67, v69
    v_mul_f32 v85, v67, v68
    v_fma_f32 v68, v66, v68, -v84
    v_fma_f32 v69, -v66, v69, -v85
    v_mul_f32 v82, v64, v45
    v_mul_f32 v83, v65, v45
    v_exp_f32 v82, v82
    v_fract_f32 v83, v83
    v_cos_f32 v70, v83
    v_sin_f32 v71, v83
    v_mul_f32 v70, v70, v82
    v_mul_f32 v71, v71, v82
    v_mul_f32 v84, v67, v71
    v_mul_f32 v85, v67, v70
    v_fma_f32 v70, v66, v70, -v84
    v_fma_f32 v71, -v66, v71, -v85
    v_mul_f32 v82, v64, v46
    v_mul_f32 v83, v65, v46
    v_exp_f32 v82, v82
    v_fract_f32 v83, v83
    v_cos_f32 v72, v83
    v_sin_f32 v73, v83
    v_mul_f32 v72, v72, v82
    v_mul_f32 v73, v73, v82
    v_mul_f32 v84, v67, v73
    v_mul_f32 v85, v67, v72
    v_fma_f32 v72, v66, v72, -v84
    v_fma_f32 v73, -v66, v73, -v85
    v_mfma_f32_16x16x4_f32 v[48:51], v68, v74, v[48:51]
    v_mfma_f32_16x16x4_f32 v[52:55], v70, v76, v[52:55]
    v_mfma_f32_16x16x4_f32 v[56:59], v70, v78, v[56:59]
    v_mfma_f32_16x16x4_f32 v[60:63], v72, v80, v[60:63]
    v_mfma_f32_16x16x4_f32 v[48:51], v69, v75, v[48:51]
    v_mfma_f32_16x16x4_f32 v[52:55], v71, v77, v[52:55]
    v_mfma_f32_16x16x4_f32 v[56:59], v71, v79, v[56:59]
    v_mfma_f32_16x16x4_f32 v[60:63], v73, v81, v[60:63]
    v_mov_b32_dpp v64, v24 row_newbcast:1 row_mask:0xf bank_mask:0xf
    v_mov_b32_dpp v65, v25 row_newbcast:1 row_mask:0xf bank_mask:0xf
    v_mov_b32_dpp v66, v26 row_newbcast:1 row_mask:0xf bank_mask:0xf
    v_mov_b32_dpp v67, v27 row_newbcast:1 row_mask:0xf bank_mask:0xf
    v_mul_f32 v82, v64, v47
    v_mul_f32 v83, v65, v47
    v_exp_f32 v82, v82
    v_fract_f32 v83, v83
    v_cos_f32 v74, v83
    v_sin_f32 v75, v83
    v_mul_f32 v74, v74, v82
    v_mul_f32 v75, v75, v82
    v_mul_f32 v84, v75, v75
    v_add_f32 v85, v74, v74
    v_fma_f32 v76, v74, v74, -v84
    v_mul_f32 v77, v85, v75
    v_mul_f32 v84, v77, v77
    v_add_f32 v85, v76, v76
    v_fma_f32 v78, v76, v76, -v84
    v_mul_f32 v79, v85, v77
    v_mul_f32 v84, v79, v79
    v_add_f32 v85, v78, v78
    v_fma_f32 v80, v78, v78, -v84
    v_mul_f32 v81, v85, v79
    v_mul_f32 v82, v64, v44
    v_mul_f32 v83, v65, v44
    v_exp_f32 v82, v82
    v_fract_f32 v83, v83
    v_cos_f32 v68, v83
    v_sin_f32 v69, v83
    v_mul_f32 v68, v68, v82
    v_mul_f32 v69, v69, v82
    v_mul_f32 v84, v67, v69
    v_mul_f32 v85, v67, v68
    v_fma_f32 v68, v66, v68, -v84
    v_fma_f32 v69, -v66, v69, -v85
    v_mul_f32 v82, v64, v45
    v_mul_f32 v83, v65, v45
    v_exp_f32 v82, v82
    v_fract_f32 v83, v83
    v_cos_f32 v70, v83
    v_sin_f32 v71, v83
    v_mul_f32 v70, v70, v82
    v_mul_f32 v71, v71, v82
    v_mul_f32 v84, v67, v71
    v_mul_f32 v85, v67, v70
    v_fma_f32 v70, v66, v70, -v84
    v_fma_f32 v71, -v66, v71, -v85
    v_mul_f32 v82, v64, v46
    v_mul_f32 v83, v65, v46
    v_exp_f32 v82, v82
    v_fract_f32 v83, v83
    v_cos_f32 v72, v83
    v_sin_f32 v73, v83
    v_mul_f32 v72, v72, v82
    v_mul_f32 v73, v73, v82
    v_mul_f32 v84, v67, v73
    v_mul_f32 v85, v67, v72
    v_fma_f32 v72, v66, v72, -v84
    v_fma_f32 v73, -v66, v73, -v85
    v_mfma_f32_16x16x4_f32 v[48:51], v68, v74, v[48:51]
    v_mfma_f32_16x16x4_f32 v[52:55], v70, v76, v[52:55]
    v_mfma_f32_16x16x4_f32 v[56:59], v70, v78, v[56:59]
    v_mfma_f32_16x16x4_f32 v[60:63], v72, v80, v[60:63]
    v_mfma_f32_16x16x4_f32 v[48:51], v69, v75, v[48:51]
    v_mfma_f32_16x16x4_f32 v[52:55], v71, v77, v[52:55]
    v_mfma_f32_16x16x4_f32 v[56:59], v71, v79, v[56:59]
    v_mfma_f32_16x16x4_f32 v[60:63], v73, v81, v[60:63]
    v_mov_b32_dpp v64, v24 row_newbcast:2 row_mask:0xf bank_mask:0xf
    v_mov_b32_dpp v65, v25 row_newbcast:2 row_mask:0xf bank_mask:0xf
    v_mov_b32_dpp v66, v26 row_newbcast:2 row_mask:0xf bank_mask:0xf
    v_mov_b32_dpp v67, v27 row_newbcast:2 row_mask:0xf bank_mask:0xf
    v_mul_f32 v82, v64, v47
    v_mul_f32 v83, v65, v47
    v_exp_f32 v82, v82
    v_fract_f32 v83, v83
    v_cos_f32 v74, v83
    v_sin_f32 v75, v83
    v_mul_f32 v74, v74, v82
    v_mul_f32 v75, v75, v82
    v_mul_f32 v84, v75, v75
    v_add_f32 v85, v74, v74
    v_fma_f32 v76, v74, v74, -v84
    v_mul_f32 v77, v85, v75
    v_mul_f32 v84, v77, v77
    v_add_f32 v85, v76, v76
    v_fma_f32 v78, v76, v76, -v84
    v_mul_f32 v79, v85, v77
    v_mul_f32 v84, v79, v79
    v_add_f32 v85, v78, v78
    v_fma_f32 v80, v78, v78, -v84
    v_mul_f32 v81, v85, v79
    v_mul_f32 v82, v64, v44
    v_mul_f32 v83, v65, v44
    v_exp_f32 v82, v82
    v_fract_f32 v83, v83
    v_cos_f32 v68, v83
    v_sin_f32 v69, v83
    v_mul_f32 v68, v68, v82
    v_mul_f32 v69, v69, v82
    v_mul_f32 v84, v67, v69
    v_mul_f32 v85, v67, v68
    v_fma_f32 v68, v66, v68, -v84
    v_fma_f32 v69, -v66, v69, -v85
    v_mul_f32 v82, v64, v45
    v_mul_f32 v83, v65, v45
    v_exp_f32 v82, v82
    v_fract_f32 v83, v83
    v_cos_f32 v70, v83
    v_sin_f32 v71, v83
    v_mul_f32 v70, v70, v82
    v_mul_f32 v71, v71, v82
    v_mul_f32 v84, v67, v71
    v_mul_f32 v85, v67, v70
    v_fma_f32 v70, v66, v70, -v84
    v_fma_f32 v71, -v66, v71, -v85
    v_mul_f32 v82, v64, v46
    v_mul_f32 v83, v65, v46
    v_exp_f32 v82, v82
    v_fract_f32 v83, v83
    v_cos_f32 v72, v83
    v_sin_f32 v73, v83
    v_mul_f32 v72, v72, v82
    v_mul_f32 v73, v73, v82
    v_mul_f32 v84, v67, v73
    v_mul_f32 v85, v67, v72
    v_fma_f32 v72, v66, v72, -v84
    v_fma_f32 v73, -v66, v73, -v85
    v_mfma_f32_16x16x4_f32 v[48:51], v68, v74, v[48:51]
    v_mfma_f32_16x16x4_f32 v[52:55], v70, v76, v[52:55]
    v_mfma_f32_16x16x4_f32 v[56:59], v70, v78, v[56:59]
    v_mfma_f32_16x16x4_f32 v[60:63], v72, v80, v[60:63]
    v_mfma_f32_16x16x4_f32 v[48:51], v69, v75, v[48:51]
    v_mfma_f32_16x16x4_f32 v[52:55], v71, v77, v[52:55]
    v_mfma_f32_16x16x4_f32 v[56:59], v71, v79, v[56:59]
    v_mfma_f32_16x16x4_f32 v[60:63], v73, v81, v[60:63]
    v_mov_b32_dpp v64, v24 row_newbcast:3 row_mask:0xf bank_mask:0xf
    v_mov_b32_dpp v65, v25 row_newbcast:3 row_mask:0xf bank_mask:0xf
    v_mov_b32_dpp v66, v26 row_newbcast:3 row_mask:0xf bank_mask:0xf
    v_mov_b32_dpp v67, v27 row_newbcast:3 row_mask:0xf bank_mask:0xf
    v_mul_f32 v82, v64, v47
    v_mul_f32 v83, v65, v47
    v_exp_f32 v82, v82
    v_fract_f32 v83, v83
    v_cos_f32 v74, v83
    v_sin_f32 v75, v83
    v_mul_f32 v74, v74, v82
    v_mul_f32 v75, v75, v82
    v_mul_f32 v84, v75, v75
    v_add_f32 v85, v74, v74
    v_fma_f32 v76, v74, v74, -v84
    v_mul_f32 v77, v85, v75
    v_mul_f32 v84, v77, v77
    v_add_f32 v85, v76, v76
    v_fma_f32 v78, v76, v76, -v84
    v_mul_f32 v79, v85, v77
    v_mul_f32 v84, v79, v79
    v_add_f32 v85, v78, v78
    v_fma_f32 v80, v78, v78, -v84
    v_mul_f32 v81, v85, v79
    v_mul_f32 v82, v64, v44
    v_mul_f32 v83, v65, v44
    v_exp_f32 v82, v82
    v_fract_f32 v83, v83
    v_cos_f32 v68, v83
    v_sin_f32 v69, v83
    v_mul_f32 v68, v68, v82
    v_mul_f32 v69, v69, v82
    v_mul_f32 v84, v67, v69
    v_mul_f32 v85, v67, v68
    v_fma_f32 v68, v66, v68, -v84
    v_fma_f32 v69, -v66, v69, -v85
    v_mul_f32 v82, v64, v45
    v_mul_f32 v83, v65, v45
    v_exp_f32 v82, v82
    v_fract_f32 v83, v83
    v_cos_f32 v70, v83
    v_sin_f32 v71, v83
    v_mul_f32 v70, v70, v82
    v_mul_f32 v71, v71, v82
    v_mul_f32 v84, v67, v71
    v_mul_f32 v85, v67, v70
    v_fma_f32 v70, v66, v70, -v84
    v_fma_f32 v71, -v66, v71, -v85
    v_mul_f32 v82, v64, v46
    v_mul_f32 v83, v65, v46
    v_exp_f32 v82, v82
    v_fract_f32 v83, v83
    v_cos_f32 v72, v83
    v_sin_f32 v73, v83
    v_mul_f32 v72, v72, v82
    v_mul_f32 v73, v73, v82
    v_mul_f32 v84, v67, v73
    v_mul_f32 v85, v67, v72
    v_fma_f32 v72, v66, v72, -v84
    v_fma_f32 v73, -v66, v73, -v85
    v_mfma_f32_16x16x4_f32 v[48:51], v68, v74, v[48:51]
    v_mfma_f32_16x16x4_f32 v[52:55], v70, v76, v[52:55]
    v_mfma_f32_16x16x4_f32 v[56:59], v70, v78, v[56:59]
    v_mfma_f32_16x16x4_f32 v[60:63], v72, v80, v[60:63]
    v_mfma_f32_16x16x4_f32 v[48:51], v69, v75, v[48:51]
    v_mfma_f32_16x16x4_f32 v[52:55], v71, v77, v[52:55]
    v_mfma_f32_16x16x4_f32 v[56:59], v71, v79, v[56:59]
    v_mfma_f32_16x16x4_f32 v[60:63], v73, v81, v[60:63]
    v_mov_b32_dpp v64, v24 row_newbcast:4 row_mask:0xf bank_mask:0xf
    v_mov_b32_dpp v65, v25 row_newbcast:4 row_mask:0xf bank_mask:0xf
    v_mov_b32_dpp v66, v26 row_newbcast:4 row_mask:0xf bank_mask:0xf
    v_mov_b32_dpp v67, v27 row_newbcast:4 row_mask:0xf bank_mask:0xf
    v_mul_f32 v82, v64, v47
    v_mul_f32 v83, v65, v47
    v_exp_f32 v82, v82
    v_fract_f32 v83, v83
    v_cos_f32 v74, v83
    v_sin_f32 v75, v83
    v_mul_f32 v74, v74, v82
    v_mul_f32 v75, v75, v82
    v_mul_f32 v84, v75, v75
    v_add_f32 v85, v74, v74
    v_fma_f32 v76, v74, v74, -v84
    v_mul_f32 v77, v85, v75
    v_mul_f32 v84, v77, v77
    v_add_f32 v85, v76, v76
    v_fma_f32 v78, v76, v76, -v84
    v_mul_f32 v79, v85, v77
    v_mul_f32 v84, v79, v79
    v_add_f32 v85, v78, v78
    v_fma_f32 v80, v78, v78, -v84
    v_mul_f32 v81, v85, v79
    v_mul_f32 v82, v64, v44
    v_mul_f32 v83, v65, v44
    v_exp_f32 v82, v82
    v_fract_f32 v83, v83
    v_cos_f32 v68, v83
    v_sin_f32 v69, v83
    v_mul_f32 v68, v68, v82
    v_mul_f32 v69, v69, v82
    v_mul_f32 v84, v67, v69
    v_mul_f32 v85, v67, v68
    v_fma_f32 v68, v66, v68, -v84
    v_fma_f32 v69, -v66, v69, -v85
    v_mul_f32 v82, v64, v45
    v_mul_f32 v83, v65, v45
    v_exp_f32 v82, v82
    v_fract_f32 v83, v83
    v_cos_f32 v70, v83
    v_sin_f32 v71, v83
    v_mul_f32 v70, v70, v82
    v_mul_f32 v71, v71, v82
    v_mul_f32 v84, v67, v71
    v_mul_f32 v85, v67, v70
    v_fma_f32 v70, v66, v70, -v84
    v_fma_f32 v71, -v66, v71, -v85
    v_mul_f32 v82, v64, v46
    v_mul_f32 v83, v65, v46
    v_exp_f32 v82, v82
    v_fract_f32 v83, v83
    v_cos_f32 v72, v83
    v_sin_f32 v73, v83
    v_mul_f32 v72, v72, v82
    v_mul_f32 v73, v73, v82
    v_mul_f32 v84, v67, v73
    v_mul_f32 v85, v67, v72
    v_fma_f32 v72, v66, v72, -v84
    v_fma_f32 v73, -v66, v73, -v85
    v_mfma_f32_16x16x4_f32 v[48:51], v68, v74, v[48:51]
    v_mfma_f32_16x16x4_f32 v[52:55], v70, v76, v[52:55]
    v_mfma_f32_16x16x4_f32 v[56:59], v70, v78, v[56:59]
    v_mfma_f32_16x16x4_f32 v[60:63], v72, v80, v[60:63]
    v_mfma_f32_16x16x4_f32 v[48:51], v69, v75, v[48:51]
    v_mfma_f32_16x16x4_f32 v[52:55], v71, v77, v[52:55]
    v_mfma_f32_16x16x4_f32 v[56:59], v71, v79, v[56:59]
    v_mfma_f32_16x16x4_f32 v[60:63], v73, v81, v[60:63]
    v_mov_b32_dpp v64, v24 row_newbcast:5 row_mask:0xf bank_mask:0xf
    v_mov_b32_dpp v65, v25 row_newbcast:5 row_mask:0xf bank_mask:0xf
    v_mov_b32_dpp v66, v26 row_newbcast:5 row_mask:0xf bank_mask:0xf
    v_mov_b32_dpp v67, v27 row_newbcast:5 row_mask:0xf bank_mask:0xf
    v_mul_f32 v82, v64, v47
    v_mul_f32 v83, v65, v47
    v_exp_f32 v82, v82
    v_fract_f32 v83, v83
    v_cos_f32 v74, v83
    v_sin_f32 v75, v83
    v_mul_f32 v74, v74, v82
    v_mul_f32 v75, v75, v82
    v_mul_f32 v84, v75, v75
    v_add_f32 v85, v74, v74
    v_fma_f32 v76, v74, v74, -v84
    v_mul_f32 v77, v85, v75
    v_mul_f32 v84, v77, v77
    v_add_f32 v85, v76, v76
    v_fma_f32 v78, v76, v76, -v84
    v_mul_f32 v79, v85, v77
    v_mul_f32 v84, v79, v79
    v_add_f32 v85, v78, v78
    v_fma_f32 v80, v78, v78, -v84
    v_mul_f32 v81, v85, v79
    v_mul_f32 v82, v64, v44
    v_mul_f32 v83, v65, v44
    v_exp_f32 v82, v82
    v_fract_f32 v83, v83
    v_cos_f32 v68, v83
    v_sin_f32 v69, v83
    v_mul_f32 v68, v68, v82
    v_mul_f32 v69, v69, v82
    v_mul_f32 v84, v67, v69
    v_mul_f32 v85, v67, v68
    v_fma_f32 v68, v66, v68, -v84
    v_fma_f32 v69, -v66, v69, -v85
    v_mul_f32 v82, v64, v45
    v_mul_f32 v83, v65, v45
    v_exp_f32 v82, v82
    v_fract_f32 v83, v83
    v_cos_f32 v70, v83
    v_sin_f32 v71, v83
    v_mul_f32 v70, v70, v82
    v_mul_f32 v71, v71, v82
    v_mul_f32 v84, v67, v71
    v_mul_f32 v85, v67, v70
    v_fma_f32 v70, v66, v70, -v84
    v_fma_f32 v71, -v66, v71, -v85
    v_mul_f32 v82, v64, v46
    v_mul_f32 v83, v65, v46
    v_exp_f32 v82, v82
    v_fract_f32 v83, v83
    v_cos_f32 v72, v83
    v_sin_f32 v73, v83
    v_mul_f32 v72, v72, v82
    v_mul_f32 v73, v73, v82
    v_mul_f32 v84, v67, v73
    v_mul_f32 v85, v67, v72
    v_fma_f32 v72, v66, v72, -v84
    v_fma_f32 v73, -v66, v73, -v85
    v_mfma_f32_16x16x4_f32 v[48:51], v68, v74, v[48:51]
    v_mfma_f32_16x16x4_f32 v[52:55], v70, v76, v[52:55]
    v_mfma_f32_16x16x4_f32 v[56:59], v70, v78, v[56:59]
    v_mfma_f32_16x16x4_f32 v[60:63], v72, v80, v[60:63]
    v_mfma_f32_16x16x4_f32 v[48:51], v69, v75, v[48:51]
    v_mfma_f32_16x16x4_f32 v[52:55], v71, v77, v[52:55]
    v_mfma_f32_16x16x4_f32 v[56:59], v71, v79, v[56:59]
    v_mfma_f32_16x16x4_f32 v[60:63], v73, v81, v[60:63]
    v_mov_b32_dpp v64, v24 row_newbcast:6 row_mask:0xf bank_mask:0xf
    v_mov_b32_dpp v65, v25 row_newbcast:6 row_mask:0xf bank_mask:0xf
    v_mov_b32_dpp v66, v26 row_newbcast:6 row_mask:0xf bank_mask:0xf
    v_mov_b32_dpp v67, v27 row_newbcast:6 row_mask:0xf bank_mask:0xf
    v_mul_f32 v82, v64, v47
    v_mul_f32 v83, v65, v47
    v_exp_f32 v82, v82
    v_fract_f32 v83, v83
    v_cos_f32 v74, v83
    v_sin_f32 v75, v83
    v_mul_f32 v74, v74, v82
    v_mul_f32 v75, v75, v82
    v_mul_f32 v84, v75, v75
    v_add_f32 v85, v74, v74
    v_fma_f32 v76, v74, v74, -v84
    v_mul_f32 v77, v85, v75
    v_mul_f32 v84, v77, v77
    v_add_f32 v85, v76, v76
    v_fma_f32 v78, v76, v76, -v84
    v_mul_f32 v79, v85, v77
    v_mul_f32 v84, v79, v79
    v_add_f32 v85, v78, v78
    v_fma_f32 v80, v78, v78, -v84
    v_mul_f32 v81, v85, v79
    v_mul_f32 v82, v64, v44
    v_mul_f32 v83, v65, v44
    v_exp_f32 v82, v82
    v_fract_f32 v83, v83
    v_cos_f32 v68, v83
    v_sin_f32 v69, v83
    v_mul_f32 v68, v68, v82
    v_mul_f32 v69, v69, v82
    v_mul_f32 v84, v67, v69
    v_mul_f32 v85, v67, v68
    v_fma_f32 v68, v66, v68, -v84
    v_fma_f32 v69, -v66, v69, -v85
    v_mul_f32 v82, v64, v45
    v_mul_f32 v83, v65, v45
    v_exp_f32 v82, v82
    v_fract_f32 v83, v83
    v_cos_f32 v70, v83
    v_sin_f32 v71, v83
    v_mul_f32 v70, v70, v82
    v_mul_f32 v71, v71, v82
    v_mul_f32 v84, v67, v71
    v_mul_f32 v85, v67, v70
    v_fma_f32 v70, v66, v70, -v84
    v_fma_f32 v71, -v66, v71, -v85
    v_mul_f32 v82, v64, v46
    v_mul_f32 v83, v65, v46
    v_exp_f32 v82, v82
    v_fract_f32 v83, v83
    v_cos_f32 v72, v83
    v_sin_f32 v73, v83
    v_mul_f32 v72, v72, v82
    v_mul_f32 v73, v73, v82
    v_mul_f32 v84, v67, v73
    v_mul_f32 v85, v67, v72
    v_fma_f32 v72, v66, v72, -v84
    v_fma_f32 v73, -v66, v73, -v85
    v_mfma_f32_16x16x4_f32 v[48:51], v68, v74, v[48:51]
    v_mfma_f32_16x16x4_f32 v[52:55], v70, v76, v[52:55]
    v_mfma_f32_16x16x4_f32 v[56:59], v70, v78, v[56:59]
    v_mfma_f32_16x16x4_f32 v[60:63], v72, v80, v[60:63]
    v_mfma_f32_16x16x4_f32 v[48:51], v69, v75, v[48:51]
    v_mfma_f32_16x16x4_f32 v[52:55], v71, v77, v[52:55]
    v_mfma_f32_16x16x4_f32 v[56:59], v71, v79, v[56:59]
    v_mfma_f32_16x16x4_f32 v[60:63], v73, v81, v[60:63]
    v_mov_b32_dpp v64, v24 row_newbcast:7 row_mask:0xf bank_mask:0xf
    v_mov_b32_dpp v65, v25 row_newbcast:7 row_mask:0xf bank_mask:0xf
    v_mov_b32_dpp v66, v26 row_newbcast:7 row_mask:0xf bank_mask:0xf
    v_mov_b32_dpp v67, v27 row_newbcast:7 row_mask:0xf bank_mask:0xf
    v_mul_f32 v82, v64, v47
    v_mul_f32 v83, v65, v47
    v_exp_f32 v82, v82
    v_fract_f32 v83, v83
    v_cos_f32 v74, v83
    v_sin_f32 v75, v83
    v_mul_f32 v74, v74, v82
    v_mul_f32 v75, v75, v82
    v_mul_f32 v84, v75, v75
    v_add_f32 v85, v74, v74
    v_fma_f32 v76, v74, v74, -v84
    v_mul_f32 v77, v85, v75
    v_mul_f32 v84, v77, v77
    v_add_f32 v85, v76, v76
    v_fma_f32 v78, v76, v76, -v84
    v_mul_f32 v79, v85, v77
    v_mul_f32 v84, v79, v79
    v_add_f32 v85, v78, v78
    v_fma_f32 v80, v78, v78, -v84
    v_mul_f32 v81, v85, v79
    v_mul_f32 v82, v64, v44
    v_mul_f32 v83, v65, v44
    v_exp_f32 v82, v82
    v_fract_f32 v83, v83
    v_cos_f32 v68, v83
    v_sin_f32 v69, v83
    v_mul_f32 v68, v68, v82
    v_mul_f32 v69, v69, v82
    v_mul_f32 v84, v67, v69
    v_mul_f32 v85, v67, v68
    v_fma_f32 v68, v66, v68, -v84
    v_fma_f32 v69, -v66, v69, -v85
    v_mul_f32 v82, v64, v45
    v_mul_f32 v83, v65, v45
    v_exp_f32 v82, v82
    v_fract_f32 v83, v83
    v_cos_f32 v70, v83
    v_sin_f32 v71, v83
    v_mul_f32 v70, v70, v82
    v_mul_f32 v71, v71, v82
    v_mul_f32 v84, v67, v71
    v_mul_f32 v85, v67, v70
    v_fma_f32 v70, v66, v70, -v84
    v_fma_f32 v71, -v66, v71, -v85
    v_mul_f32 v82, v64, v46
    v_mul_f32 v83, v65, v46
    v_exp_f32 v82, v82
    v_fract_f32 v83, v83
    v_cos_f32 v72, v83
    v_sin_f32 v73, v83
    v_mul_f32 v72, v72, v82
    v_mul_f32 v73, v73, v82
    v_mul_f32 v84, v67, v73
    v_mul_f32 v85, v67, v72
    v_fma_f32 v72, v66, v72, -v84
    v_fma_f32 v73, -v66, v73, -v85
    v_mfma_f32_16x16x4_f32 v[48:51], v68, v74, v[48:51]
    v_mfma_f32_16x16x4_f32 v[52:55], v70, v76, v[52:55]
    v_mfma_f32_16x16x4_f32 v[56:59], v70, v78, v[56:59]
    v_mfma_f32_16x16x4_f32 v[60:63], v72, v80, v[60:63]
    v_mfma_f32_16x16x4_f32 v[48:51], v69, v75, v[48:51]
    v_mfma_f32_16x16x4_f32 v[52:55], v71, v77, v[52:55]
    v_mfma_f32_16x16x4_f32 v[56:59], v71, v79, v[56:59]
    v_mfma_f32_16x16x4_f32 v[60:63], v73, v81, v[60:63]
    v_mov_b32_dpp v64, v24 row_newbcast:8 row_mask:0xf bank_mask:0xf
    v_mov_b32_dpp v65, v25 row_newbcast:8 row_mask:0xf bank_mask:0xf
    v_mov_b32_dpp v66, v26 row_newbcast:8 row_mask:0xf bank_mask:0xf
    v_mov_b32_dpp v67, v27 row_newbcast:8 row_mask:0xf bank_mask:0xf
    v_mul_f32 v82, v64, v47
    v_mul_f32 v83, v65, v47
    v_exp_f32 v82, v82
    v_fract_f32 v83, v83
    v_cos_f32 v74, v83
    v_sin_f32 v75, v83
    v_mul_f32 v74, v74, v82
    v_mul_f32 v75, v75, v82
    v_mul_f32 v84, v75, v75
    v_add_f32 v85, v74, v74
    v_fma_f32 v76, v74, v74, -v84
    v_mul_f32 v77, v85, v75
    v_mul_f32 v84, v77, v77
    v_add_f32 v85, v76, v76
    v_fma_f32 v78, v76, v76, -v84
    v_mul_f32 v79, v85, v77
    v_mul_f32 v84, v79, v79
    v_add_f32 v85, v78, v78
    v_fma_f32 v80, v78, v78, -v84
    v_mul_f32 v81, v85, v79
    v_mul_f32 v82, v64, v44
    v_mul_f32 v83, v65, v44
    v_exp_f32 v82, v82
    v_fract_f32 v83, v83
    v_cos_f32 v68, v83
    v_sin_f32 v69, v83
    v_mul_f32 v68, v68, v82
    v_mul_f32 v69, v69, v82
    v_mul_f32 v84, v67, v69
    v_mul_f32 v85, v67, v68
    v_fma_f32 v68, v66, v68, -v84
    v_fma_f32 v69, -v66, v69, -v85
    v_mul_f32 v82, v64, v45
    v_mul_f32 v83, v65, v45
    v_exp_f32 v82, v82
    v_fract_f32 v83, v83
    v_cos_f32 v70, v83
    v_sin_f32 v71, v83
    v_mul_f32 v70, v70, v82
    v_mul_f32 v71, v71, v82
    v_mul_f32 v84, v67, v71
    v_mul_f32 v85, v67, v70
    v_fma_f32 v70, v66, v70, -v84
    v_fma_f32 v71, -v66, v71, -v85
    v_mul_f32 v82, v64, v46
    v_mul_f32 v83, v65, v46
    v_exp_f32 v82, v82
    v_fract_f32 v83, v83
    v_cos_f32 v72, v83
    v_sin_f32 v73, v83
    v_mul_f32 v72, v72, v82
    v_mul_f32 v73, v73, v82
    v_mul_f32 v84, v67, v73
    v_mul_f32 v85, v67, v72
    v_fma_f32 v72, v66, v72, -v84
    v_fma_f32 v73, -v66, v73, -v85
    v_mfma_f32_16x16x4_f32 v[48:51], v68, v74, v[48:51]
    v_mfma_f32_16x16x4_f32 v[52:55], v70, v76, v[52:55]
    v_mfma_f32_16x16x4_f32 v[56:59], v70, v78, v[56:59]
    v_mfma_f32_16x16x4_f32 v[60:63], v72, v80, v[60:63]
    v_mfma_f32_16x16x4_f32 v[48:51], v69, v75, v[48:51]
    v_mfma_f32_16x16x4_f32 v[52:55], v71, v77, v[52:55]
    v_mfma_f32_16x16x4_f32 v[56:59], v71, v79, v[56:59]
    v_mfma_f32_16x16x4_f32 v[60:63], v73, v81, v[60:63]
    v_mov_b32_dpp v64, v24 row_newbcast:9 row_mask:0xf bank_mask:0xf
    v_mov_b32_dpp v65, v25 row_newbcast:9 row_mask:0xf bank_mask:0xf
    v_mov_b32_dpp v66, v26 row_newbcast:9 row_mask:0xf bank_mask:0xf
    v_mov_b32_dpp v67, v27 row_newbcast:9 row_mask:0xf bank_mask:0xf
    v_mul_f32 v82, v64, v47
    v_mul_f32 v83, v65, v47
    v_exp_f32 v82, v82
    v_fract_f32 v83, v83
    v_cos_f32 v74, v83
    v_sin_f32 v75, v83
    v_mul_f32 v74, v74, v82
    v_mul_f32 v75, v75, v82
    v_mul_f32 v84, v75, v75
    v_add_f32 v85, v74, v74
    v_fma_f32 v76, v74, v74, -v84
    v_mul_f32 v77, v85, v75
    v_mul_f32 v84, v77, v77
    v_add_f32 v85, v76, v76
    v_fma_f32 v78, v76, v76, -v84
    v_mul_f32 v79, v85, v77
    v_mul_f32 v84, v79, v79
    v_add_f32 v85, v78, v78
    v_fma_f32 v80, v78, v78, -v84
    v_mul_f32 v81, v85, v79
    v_mul_f32 v82, v64, v44
    v_mul_f32 v83, v65, v44
    v_exp_f32 v82, v82
    v_fract_f32 v83, v83
    v_cos_f32 v68, v83
    v_sin_f32 v69, v83
    v_mul_f32 v68, v68, v82
    v_mul_f32 v69, v69, v82
    v_mul_f32 v84, v67, v69
    v_mul_f32 v85, v67, v68
    v_fma_f32 v68, v66, v68, -v84
    v_fma_f32 v69, -v66, v69, -v85
    v_mul_f32 v82, v64, v45
    v_mul_f32 v83, v65, v45
    v_exp_f32 v82, v82
    v_fract_f32 v83, v83
    v_cos_f32 v70, v83
    v_sin_f32 v71, v83
    v_mul_f32 v70, v70, v82
    v_mul_f32 v71, v71, v82
    v_mul_f32 v84, v67, v71
    v_mul_f32 v85, v67, v70
    v_fma_f32 v70, v66, v70, -v84
    v_fma_f32 v71, -v66, v71, -v85
    v_mul_f32 v82, v64, v46
    v_mul_f32 v83, v65, v46
    v_exp_f32 v82, v82
    v_fract_f32 v83, v83
    v_cos_f32 v72, v83
    v_sin_f32 v73, v83
    v_mul_f32 v72, v72, v82
    v_mul_f32 v73, v73, v82
    v_mul_f32 v84, v67, v73
    v_mul_f32 v85, v67, v72
    v_fma_f32 v72, v66, v72, -v84
    v_fma_f32 v73, -v66, v73, -v85
    v_mfma_f32_16x16x4_f32 v[48:51], v68, v74, v[48:51]
    v_mfma_f32_16x16x4_f32 v[52:55], v70, v76, v[52:55]
    v_mfma_f32_16x16x4_f32 v[56:59], v70, v78, v[56:59]
    v_mfma_f32_16x16x4_f32 v[60:63], v72, v80, v[60:63]
    v_mfma_f32_16x16x4_f32 v[48:51], v69, v75, v[48:51]
    v_mfma_f32_16x16x4_f32 v[52:55], v71, v77, v[52:55]
    v_mfma_f32_16x16x4_f32 v[56:59], v71, v79, v[56:59]
    v_mfma_f32_16x16x4_f32 v[60:63], v73, v81, v[60:63]
    v_mov_b32_dpp v64, v24 row_newbcast:10 row_mask:0xf bank_mask:0xf
    v_mov_b32_dpp v65, v25 row_newbcast:10 row_mask:0xf bank_mask:0xf
    v_mov_b32_dpp v66, v26 row_newbcast:10 row_mask:0xf bank_mask:0xf
    v_mov_b32_dpp v67, v27 row_newbcast:10 row_mask:0xf bank_mask:0xf
    v_mul_f32 v82, v64, v47
    v_mul_f32 v83, v65, v47
    v_exp_f32 v82, v82
    v_fract_f32 v83, v83
    v_cos_f32 v74, v83
    v_sin_f32 v75, v83
    v_mul_f32 v74, v74, v82
    v_mul_f32 v75, v75, v82
    v_mul_f32 v84, v75, v75
    v_add_f32 v85, v74, v74
    v_fma_f32 v76, v74, v74, -v84
    v_mul_f32 v77, v85, v75
    v_mul_f32 v84, v77, v77
    v_add_f32 v85, v76, v76
    v_fma_f32 v78, v76, v76, -v84
    v_mul_f32 v79, v85, v77
    v_mul_f32 v84, v79, v79
    v_add_f32 v85, v78, v78
    v_fma_f32 v80, v78, v78, -v84
    v_mul_f32 v81, v85, v79
    v_mul_f32 v82, v64, v44
    v_mul_f32 v83, v65, v44
    v_exp_f32 v82, v82
    v_fract_f32 v83, v83
    v_cos_f32 v68, v83
    v_sin_f32 v69, v83
    v_mul_f32 v68, v68, v82
    v_mul_f32 v69, v69, v82
    v_mul_f32 v84, v67, v69
    v_mul_f32 v85, v67, v68
    v_fma_f32 v68, v66, v68, -v84
    v_fma_f32 v69, -v66, v69, -v85
    v_mul_f32 v82, v64, v45
    v_mul_f32 v83, v65, v45
    v_exp_f32 v82, v82
    v_fract_f32 v83, v83
    v_cos_f32 v70, v83
    v_sin_f32 v71, v83
    v_mul_f32 v70, v70, v82
    v_mul_f32 v71, v71, v82
    v_mul_f32 v84, v67, v71
    v_mul_f32 v85, v67, v70
    v_fma_f32 v70, v66, v70, -v84
    v_fma_f32 v71, -v66, v71, -v85
    v_mul_f32 v82, v64, v46
    v_mul_f32 v83, v65, v46
    v_exp_f32 v82, v82
    v_fract_f32 v83, v83
    v_cos_f32 v72, v83
    v_sin_f32 v73, v83
    v_mul_f32 v72, v72, v82
    v_mul_f32 v73, v73, v82
    v_mul_f32 v84, v67, v73
    v_mul_f32 v85, v67, v72
    v_fma_f32 v72, v66, v72, -v84
    v_fma_f32 v73, -v66, v73, -v85
    v_mfma_f32_16x16x4_f32 v[48:51], v68, v74, v[48:51]
    v_mfma_f32_16x16x4_f32 v[52:55], v70, v76, v[52:55]
    v_mfma_f32_16x16x4_f32 v[56:59], v70, v78, v[56:59]
    v_mfma_f32_16x16x4_f32 v[60:63], v72, v80, v[60:63]
    v_mfma_f32_16x16x4_f32 v[48:51], v69, v75, v[48:51]
    v_mfma_f32_16x16x4_f32 v[52:55], v71, v77, v[52:55]
    v_mfma_f32_16x16x4_f32 v[56:59], v71, v79, v[56:59]
    v_mfma_f32_16x16x4_f32 v[60:63], v73, v81, v[60:63]
    v_mov_b32_dpp v64, v24 row_newbcast:11 row_mask:0xf bank_mask:0xf
    v_mov_b32_dpp v65, v25 row_newbcast:11 row_mask:0xf bank_mask:0xf
    v_mov_b32_dpp v66, v26 row_newbcast:11 row_mask:0xf bank_mask:0xf
    v_mov_b32_dpp v67, v27 row_newbcast:11 row_mask:0xf bank_mask:0xf
    v_mul_f32 v82, v64, v47
    v_mul_f32 v83, v65, v47
    v_exp_f32 v82, v82
    v_fract_f32 v83, v83
    v_cos_f32 v74, v83
    v_sin_f32 v75, v83
    v_mul_f32 v74, v74, v82
    v_mul_f32 v75, v75, v82
    v_mul_f32 v84, v75, v75
    v_add_f32 v85, v74, v74
    v_fma_f32 v76, v74, v74, -v84
    v_mul_f32 v77, v85, v75
    v_mul_f32 v84, v77, v77
    v_add_f32 v85, v76, v76
    v_fma_f32 v78, v76, v76, -v84
    v_mul_f32 v79, v85, v77
    v_mul_f32 v84, v79, v79
    v_add_f32 v85, v78, v78
    v_fma_f32 v80, v78, v78, -v84
    v_mul_f32 v81, v85, v79
    v_mul_f32 v82, v64, v44
    v_mul_f32 v83, v65, v44
    v_exp_f32 v82, v82
    v_fract_f32 v83, v83
    v_cos_f32 v68, v83
    v_sin_f32 v69, v83
    v_mul_f32 v68, v68, v82
    v_mul_f32 v69, v69, v82
    v_mul_f32 v84, v67, v69
    v_mul_f32 v85, v67, v68
    v_fma_f32 v68, v66, v68, -v84
    v_fma_f32 v69, -v66, v69, -v85
    v_mul_f32 v82, v64, v45
    v_mul_f32 v83, v65, v45
    v_exp_f32 v82, v82
    v_fract_f32 v83, v83
    v_cos_f32 v70, v83
    v_sin_f32 v71, v83
    v_mul_f32 v70, v70, v82
    v_mul_f32 v71, v71, v82
    v_mul_f32 v84, v67, v71
    v_mul_f32 v85, v67, v70
    v_fma_f32 v70, v66, v70, -v84
    v_fma_f32 v71, -v66, v71, -v85
    v_mul_f32 v82, v64, v46
    v_mul_f32 v83, v65, v46
    v_exp_f32 v82, v82
    v_fract_f32 v83, v83
    v_cos_f32 v72, v83
    v_sin_f32 v73, v83
    v_mul_f32 v72, v72, v82
    v_mul_f32 v73, v73, v82
    v_mul_f32 v84, v67, v73
    v_mul_f32 v85, v67, v72
    v_fma_f32 v72, v66, v72, -v84
    v_fma_f32 v73, -v66, v73, -v85
    v_mfma_f32_16x16x4_f32 v[48:51], v68, v74, v[48:51]
    v_mfma_f32_16x16x4_f32 v[52:55], v70, v76, v[52:55]
    v_mfma_f32_16x16x4_f32 v[56:59], v70, v78, v[56:59]
    v_mfma_f32_16x16x4_f32 v[60:63], v72, v80, v[60:63]
    v_mfma_f32_16x16x4_f32 v[48:51], v69, v75, v[48:51]
    v_mfma_f32_16x16x4_f32 v[52:55], v71, v77, v[52:55]
    v_mfma_f32_16x16x4_f32 v[56:59], v71, v79, v[56:59]
    v_mfma_f32_16x16x4_f32 v[60:63], v73, v81, v[60:63]
    v_mov_b32_dpp v64, v24 row_newbcast:12 row_mask:0xf bank_mask:0xf
    v_mov_b32_dpp v65, v25 row_newbcast:12 row_mask:0xf bank_mask:0xf
    v_mov_b32_dpp v66, v26 row_newbcast:12 row_mask:0xf bank_mask:0xf
    v_mov_b32_dpp v67, v27 row_newbcast:12 row_mask:0xf bank_mask:0xf
    v_mul_f32 v82, v64, v47
    v_mul_f32 v83, v65, v47
    v_exp_f32 v82, v82
    v_fract_f32 v83, v83
    v_cos_f32 v74, v83
    v_sin_f32 v75, v83
    v_mul_f32 v74, v74, v82
    v_mul_f32 v75, v75, v82
    v_mul_f32 v84, v75, v75
    v_add_f32 v85, v74, v74
    v_fma_f32 v76, v74, v74, -v84
    v_mul_f32 v77, v85, v75
    v_mul_f32 v84, v77, v77
    v_add_f32 v85, v76, v76
    v_fma_f32 v78, v76, v76, -v84
    v_mul_f32 v79, v85, v77
    v_mul_f32 v84, v79, v79
    v_add_f32 v85, v78, v78
    v_fma_f32 v80, v78, v78, -v84
    v_mul_f32 v81, v85, v79
    v_mul_f32 v82, v64, v44
    v_mul_f32 v83, v65, v44
    v_exp_f32 v82, v82
    v_fract_f32 v83, v83
    v_cos_f32 v68, v83
    v_sin_f32 v69, v83
    v_mul_f32 v68, v68, v82
    v_mul_f32 v69, v69, v82
    v_mul_f32 v84, v67, v69
    v_mul_f32 v85, v67, v68
    v_fma_f32 v68, v66, v68, -v84
    v_fma_f32 v69, -v66, v69, -v85
    v_mul_f32 v82, v64, v45
    v_mul_f32 v83, v65, v45
    v_exp_f32 v82, v82
    v_fract_f32 v83, v83
    v_cos_f32 v70, v83
    v_sin_f32 v71, v83
    v_mul_f32 v70, v70, v82
    v_mul_f32 v71, v71, v82
    v_mul_f32 v84, v67, v71
    v_mul_f32 v85, v67, v70
    v_fma_f32 v70, v66, v70, -v84
    v_fma_f32 v71, -v66, v71, -v85
    v_mul_f32 v82, v64, v46
    v_mul_f32 v83, v65, v46
    v_exp_f32 v82, v82
    v_fract_f32 v83, v83
    v_cos_f32 v72, v83
    v_sin_f32 v73, v83
    v_mul_f32 v72, v72, v82
    v_mul_f32 v73, v73, v82
    v_mul_f32 v84, v67, v73
    v_mul_f32 v85, v67, v72
    v_fma_f32 v72, v66, v72, -v84
    v_fma_f32 v73, -v66, v73, -v85
    v_mfma_f32_16x16x4_f32 v[48:51], v68, v74, v[48:51]
    v_mfma_f32_16x16x4_f32 v[52:55], v70, v76, v[52:55]
    v_mfma_f32_16x16x4_f32 v[56:59], v70, v78, v[56:59]
    v_mfma_f32_16x16x4_f32 v[60:63], v72, v80, v[60:63]
    v_mfma_f32_16x16x4_f32 v[48:51], v69, v75, v[48:51]
    v_mfma_f32_16x16x4_f32 v[52:55], v71, v77, v[52:55]
    v_mfma_f32_16x16x4_f32 v[56:59], v71, v79, v[56:59]
    v_mfma_f32_16x16x4_f32 v[60:63], v73, v81, v[60:63]
    v_mov_b32_dpp v64, v24 row_newbcast:13 row_mask:0xf bank_mask:0xf
    v_mov_b32_dpp v65, v25 row_newbcast:13 row_mask:0xf bank_mask:0xf
    v_mov_b32_dpp v66, v26 row_newbcast:13 row_mask:0xf bank_mask:0xf
    v_mov_b32_dpp v67, v27 row_newbcast:13 row_mask:0xf bank_mask:0xf
    v_mul_f32 v82, v64, v47
    v_mul_f32 v83, v65, v47
    v_exp_f32 v82, v82
    v_fract_f32 v83, v83
    v_cos_f32 v74, v83
    v_sin_f32 v75, v83
    v_mul_f32 v74, v74, v82
    v_mul_f32 v75, v75, v82
    v_mul_f32 v84, v75, v75
    v_add_f32 v85, v74, v74
    v_fma_f32 v76, v74, v74, -v84
    v_mul_f32 v77, v85, v75
    v_mul_f32 v84, v77, v77
    v_add_f32 v85, v76, v76
    v_fma_f32 v78, v76, v76, -v84
    v_mul_f32 v79, v85, v77
    v_mul_f32 v84, v79, v79
    v_add_f32 v85, v78, v78
    v_fma_f32 v80, v78, v78, -v84
    v_mul_f32 v81, v85, v79
    v_mul_f32 v82, v64, v44
    v_mul_f32 v83, v65, v44
    v_exp_f32 v82, v82
    v_fract_f32 v83, v83
    v_cos_f32 v68, v83
    v_sin_f32 v69, v83
    v_mul_f32 v68, v68, v82
    v_mul_f32 v69, v69, v82
    v_mul_f32 v84, v67, v69
    v_mul_f32 v85, v67, v68
    v_fma_f32 v68, v66, v68, -v84
    v_fma_f32 v69, -v66, v69, -v85
    v_mul_f32 v82, v64, v45
    v_mul_f32 v83, v65, v45
    v_exp_f32 v82, v82
    v_fract_f32 v83, v83
    v_cos_f32 v70, v83
    v_sin_f32 v71, v83
    v_mul_f32 v70, v70, v82
    v_mul_f32 v71, v71, v82
    v_mul_f32 v84, v67, v71
    v_mul_f32 v85, v67, v70
    v_fma_f32 v70, v66, v70, -v84
    v_fma_f32 v71, -v66, v71, -v85
    v_mul_f32 v82, v64, v46
    v_mul_f32 v83, v65, v46
    v_exp_f32 v82, v82
    v_fract_f32 v83, v83
    v_cos_f32 v72, v83
    v_sin_f32 v73, v83
    v_mul_f32 v72, v72, v82
    v_mul_f32 v73, v73, v82
    v_mul_f32 v84, v67, v73
    v_mul_f32 v85, v67, v72
    v_fma_f32 v72, v66, v72, -v84
    v_fma_f32 v73, -v66, v73, -v85
    v_mfma_f32_16x16x4_f32 v[48:51], v68, v74, v[48:51]
    v_mfma_f32_16x16x4_f32 v[52:55], v70, v76, v[52:55]
    v_mfma_f32_16x16x4_f32 v[56:59], v70, v78, v[56:59]
    v_mfma_f32_16x16x4_f32 v[60:63], v72, v80, v[60:63]
    v_mfma_f32_16x16x4_f32 v[48:51], v69, v75, v[48:51]
    v_mfma_f32_16x16x4_f32 v[52:55], v71, v77, v[52:55]
    v_mfma_f32_16x16x4_f32 v[56:59], v71, v79, v[56:59]
    v_mfma_f32_16x16x4_f32 v[60:63], v73, v81, v[60:63]
    v_mov_b32_dpp v64, v24 row_newbcast:14 row_mask:0xf bank_mask:0xf
    v_mov_b32_dpp v65, v25 row_newbcast:14 row_mask:0xf bank_mask:0xf
    v_mov_b32_dpp v66, v26 row_newbcast:14 row_mask:0xf bank_mask:0xf
    v_mov_b32_dpp v67, v27 row_newbcast:14 row_mask:0xf bank_mask:0xf
    v_mul_f32 v82, v64, v47
    v_mul_f32 v83, v65, v47
    v_exp_f32 v82, v82
    v_fract_f32 v83, v83
    v_cos_f32 v74, v83
    v_sin_f32 v75, v83
    v_mul_f32 v74, v74, v82
    v_mul_f32 v75, v75, v82
    v_mul_f32 v84, v75, v75
    v_add_f32 v85, v74, v74
    v_fma_f32 v76, v74, v74, -v84
    v_mul_f32 v77, v85, v75
    v_mul_f32 v84, v77, v77
    v_add_f32 v85, v76, v76
    v_fma_f32 v78, v76, v76, -v84
    v_mul_f32 v79, v85, v77
    v_mul_f32 v84, v79, v79
    v_add_f32 v85, v78, v78
    v_fma_f32 v80, v78, v78, -v84
    v_mul_f32 v81, v85, v79
    v_mul_f32 v82, v64, v44
    v_mul_f32 v83, v65, v44
    v_exp_f32 v82, v82
    v_fract_f32 v83, v83
    v_cos_f32 v68, v83
    v_sin_f32 v69, v83
    v_mul_f32 v68, v68, v82
    v_mul_f32 v69, v69, v82
    v_mul_f32 v84, v67, v69
    v_mul_f32 v85, v67, v68
    v_fma_f32 v68, v66, v68, -v84
    v_fma_f32 v69, -v66, v69, -v85
    v_mul_f32 v82, v64, v45
    v_mul_f32 v83, v65, v45
    v_exp_f32 v82, v82
    v_fract_f32 v83, v83
    v_cos_f32 v70, v83
    v_sin_f32 v71, v83
    v_mul_f32 v70, v70, v82
    v_mul_f32 v71, v71, v82
    v_mul_f32 v84, v67, v71
    v_mul_f32 v85, v67, v70
    v_fma_f32 v70, v66, v70, -v84
    v_fma_f32 v71, -v66, v71, -v85
    v_mul_f32 v82, v64, v46
    v_mul_f32 v83, v65, v46
    v_exp_f32 v82, v82
    v_fract_f32 v83, v83
    v_cos_f32 v72, v83
    v_sin_f32 v73, v83
    v_mul_f32 v72, v72, v82
    v_mul_f32 v73, v73, v82
    v_mul_f32 v84, v67, v73
    v_mul_f32 v85, v67, v72
    v_fma_f32 v72, v66, v72, -v84
    v_fma_f32 v73, -v66, v73, -v85
    v_mfma_f32_16x16x4_f32 v[48:51], v68, v74, v[48:51]
    v_mfma_f32_16x16x4_f32 v[52:55], v70, v76, v[52:55]
    v_mfma_f32_16x16x4_f32 v[56:59], v70, v78, v[56:59]
    v_mfma_f32_16x16x4_f32 v[60:63], v72, v80, v[60:63]
    v_mfma_f32_16x16x4_f32 v[48:51], v69, v75, v[48:51]
    v_mfma_f32_16x16x4_f32 v[52:55], v71, v77, v[52:55]
    v_mfma_f32_16x16x4_f32 v[56:59], v71, v79, v[56:59]
    v_mfma_f32_16x16x4_f32 v[60:63], v73, v81, v[60:63]
    v_mov_b32_dpp v64, v24 row_newbcast:15 row_mask:0xf bank_mask:0xf
    v_mov_b32_dpp v65, v25 row_newbcast:15 row_mask:0xf bank_mask:0xf
    v_mov_b32_dpp v66, v26 row_newbcast:15 row_mask:0xf bank_mask:0xf
    v_mov_b32_dpp v67, v27 row_newbcast:15 row_mask:0xf bank_mask:0xf
    v_mul_f32 v82, v64, v47
    v_mul_f32 v83, v65, v47
    v_exp_f32 v82, v82
    v_fract_f32 v83, v83
    v_cos_f32 v74, v83
    v_sin_f32 v75, v83
    v_mul_f32 v74, v74, v82
    v_mul_f32 v75, v75, v82
    v_mul_f32 v84, v75, v75
    v_add_f32 v85, v74, v74
    v_fma_f32 v76, v74, v74, -v84
    v_mul_f32 v77, v85, v75
    v_mul_f32 v84, v77, v77
    v_add_f32 v85, v76, v76
    v_fma_f32 v78, v76, v76, -v84
    v_mul_f32 v79, v85, v77
    v_mul_f32 v84, v79, v79
    v_add_f32 v85, v78, v78
    v_fma_f32 v80, v78, v78, -v84
    v_mul_f32 v81, v85, v79
    v_mul_f32 v82, v64, v44
    v_mul_f32 v83, v65, v44
    v_exp_f32 v82, v82
    v_fract_f32 v83, v83
    v_cos_f32 v68, v83
    v_sin_f32 v69, v83
    v_mul_f32 v68, v68, v82
    v_mul_f32 v69, v69, v82
    v_mul_f32 v84, v67, v69
    v_mul_f32 v85, v67, v68
    v_fma_f32 v68, v66, v68, -v84
    v_fma_f32 v69, -v66, v69, -v85
    v_mul_f32 v82, v64, v45
    v_mul_f32 v83, v65, v45
    v_exp_f32 v82, v82
    v_fract_f32 v83, v83
    v_cos_f32 v70, v83
    v_sin_f32 v71, v83
    v_mul_f32 v70, v70, v82
    v_mul_f32 v71, v71, v82
    v_mul_f32 v84, v67, v71
    v_mul_f32 v85, v67, v70
    v_fma_f32 v70, v66, v70, -v84
    v_fma_f32 v71, -v66, v71, -v85
    v_mul_f32 v82, v64, v46
    v_mul_f32 v83, v65, v46
    v_exp_f32 v82, v82
    v_fract_f32 v83, v83
    v_cos_f32 v72, v83
    v_sin_f32 v73, v83
    v_mul_f32 v72, v72, v82
    v_mul_f32 v73, v73, v82
    v_mul_f32 v84, v67, v73
    v_mul_f32 v85, v67, v72
    v_fma_f32 v72, v66, v72, -v84
    v_fma_f32 v73, -v66, v73, -v85
    v_mfma_f32_16x16x4_f32 v[48:51], v68, v74, v[48:51]
    v_mfma_f32_16x16x4_f32 v[52:55], v70, v76, v[52:55]
    v_mfma_f32_16x16x4_f32 v[56:59], v70, v78, v[56:59]
    v_mfma_f32_16x16x4_f32 v[60:63], v72, v80, v[60:63]
    v_mfma_f32_16x16x4_f32 v[48:51], v69, v75, v[48:51]
    v_mfma_f32_16x16x4_f32 v[52:55], v71, v77, v[52:55]
    v_mfma_f32_16x16x4_f32 v[56:59], v71, v79, v[56:59]
    v_mfma_f32_16x16x4_f32 v[60:63], v73, v81, v[60:63]
    v_mov_b32_dpp v64, v28 row_newbcast:0 row_mask:0xf bank_mask:0xf
    v_mov_b32_dpp v65, v29 row_newbcast:0 row_mask:0xf bank_mask:0xf
    v_mov_b32_dpp v66, v30 row_newbcast:0 row_mask:0xf bank_mask:0xf
    v_mov_b32_dpp v67, v31 row_newbcast:0 row_mask:0xf bank_mask:0xf
    v_mul_f32 v82, v64, v47
    v_mul_f32 v83, v65, v47
    v_exp_f32 v82, v82
    v_fract_f32 v83, v83
    v_cos_f32 v74, v83
    v_sin_f32 v75, v83
    v_mul_f32 v74, v74, v82
    v_mul_f32 v75, v75, v82
    v_mul_f32 v84, v75, v75
    v_add_f32 v85, v74, v74
    v_fma_f32 v76, v74, v74, -v84
    v_mul_f32 v77, v85, v75
    v_mul_f32 v84, v77, v77
    v_add_f32 v85, v76, v76
    v_fma_f32 v78, v76, v76, -v84
    v_mul_f32 v79, v85, v77
    v_mul_f32 v84, v79, v79
    v_add_f32 v85, v78, v78
    v_fma_f32 v80, v78, v78, -v84
    v_mul_f32 v81, v85, v79
    v_mul_f32 v82, v64, v44
    v_mul_f32 v83, v65, v44
    v_exp_f32 v82, v82
    v_fract_f32 v83, v83
    v_cos_f32 v68, v83
    v_sin_f32 v69, v83
    v_mul_f32 v68, v68, v82
    v_mul_f32 v69, v69, v82
    v_mul_f32 v84, v67, v69
    v_mul_f32 v85, v67, v68
    v_fma_f32 v68, v66, v68, -v84
    v_fma_f32 v69, -v66, v69, -v85
    v_mul_f32 v82, v64, v45
    v_mul_f32 v83, v65, v45
    v_exp_f32 v82, v82
    v_fract_f32 v83, v83
    v_cos_f32 v70, v83
    v_sin_f32 v71, v83
    v_mul_f32 v70, v70, v82
    v_mul_f32 v71, v71, v82
    v_mul_f32 v84, v67, v71
    v_mul_f32 v85, v67, v70
    v_fma_f32 v70, v66, v70, -v84
    v_fma_f32 v71, -v66, v71, -v85
    v_mul_f32 v82, v64, v46
    v_mul_f32 v83, v65, v46
    v_exp_f32 v82, v82
    v_fract_f32 v83, v83
    v_cos_f32 v72, v83
    v_sin_f32 v73, v83
    v_mul_f32 v72, v72, v82
    v_mul_f32 v73, v73, v82
    v_mul_f32 v84, v67, v73
    v_mul_f32 v85, v67, v72
    v_fma_f32 v72, v66, v72, -v84
    v_fma_f32 v73, -v66, v73, -v85
    v_mfma_f32_16x16x4_f32 v[48:51], v68, v74, v[48:51]
    v_mfma_f32_16x16x4_f32 v[52:55], v70, v76, v[52:55]
    v_mfma_f32_16x16x4_f32 v[56:59], v70, v78, v[56:59]
    v_mfma_f32_16x16x4_f32 v[60:63], v72, v80, v[60:63]
    v_mfma_f32_16x16x4_f32 v[48:51], v69, v75, v[48:51]
    v_mfma_f32_16x16x4_f32 v[52:55], v71, v77, v[52:55]
    v_mfma_f32_16x16x4_f32 v[56:59], v71, v79, v[56:59]
    v_mfma_f32_16x16x4_f32 v[60:63], v73, v81, v[60:63]
    v_mov_b32_dpp v64, v28 row_newbcast:1 row_mask:0xf bank_mask:0xf
    v_mov_b32_dpp v65, v29 row_newbcast:1 row_mask:0xf bank_mask:0xf
    v_mov_b32_dpp v66, v30 row_newbcast:1 row_mask:0xf bank_mask:0xf
    v_mov_b32_dpp v67, v31 row_newbcast:1 row_mask:0xf bank_mask:0xf
    v_mul_f32 v82, v64, v47
    v_mul_f32 v83, v65, v47
    v_exp_f32 v82, v82
    v_fract_f32 v83, v83
    v_cos_f32 v74, v83
    v_sin_f32 v75, v83
    v_mul_f32 v74, v74, v82
    v_mul_f32 v75, v75, v82
    v_mul_f32 v84, v75, v75
    v_add_f32 v85, v74, v74
    v_fma_f32 v76, v74, v74, -v84
    v_mul_f32 v77, v85, v75
    v_mul_f32 v84, v77, v77
    v_add_f32 v85, v76, v76
    v_fma_f32 v78, v76, v76, -v84
    v_mul_f32 v79, v85, v77
    v_mul_f32 v84, v79, v79
    v_add_f32 v85, v78, v78
    v_fma_f32 v80, v78, v78, -v84
    v_mul_f32 v81, v85, v79
    v_mul_f32 v82, v64, v44
    v_mul_f32 v83, v65, v44
    v_exp_f32 v82, v82
    v_fract_f32 v83, v83
    v_cos_f32 v68, v83
    v_sin_f32 v69, v83
    v_mul_f32 v68, v68, v82
    v_mul_f32 v69, v69, v82
    v_mul_f32 v84, v67, v69
    v_mul_f32 v85, v67, v68
    v_fma_f32 v68, v66, v68, -v84
    v_fma_f32 v69, -v66, v69, -v85
    v_mul_f32 v82, v64, v45
    v_mul_f32 v83, v65, v45
    v_exp_f32 v82, v82
    v_fract_f32 v83, v83
    v_cos_f32 v70, v83
    v_sin_f32 v71, v83
    v_mul_f32 v70, v70, v82
    v_mul_f32 v71, v71, v82
    v_mul_f32 v84, v67, v71
    v_mul_f32 v85, v67, v70
    v_fma_f32 v70, v66, v70, -v84
    v_fma_f32 v71, -v66, v71, -v85
    v_mul_f32 v82, v64, v46
    v_mul_f32 v83, v65, v46
    v_exp_f32 v82, v82
    v_fract_f32 v83, v83
    v_cos_f32 v72, v83
    v_sin_f32 v73, v83
    v_mul_f32 v72, v72, v82
    v_mul_f32 v73, v73, v82
    v_mul_f32 v84, v67, v73
    v_mul_f32 v85, v67, v72
    v_fma_f32 v72, v66, v72, -v84
    v_fma_f32 v73, -v66, v73, -v85
    v_mfma_f32_16x16x4_f32 v[48:51], v68, v74, v[48:51]
    v_mfma_f32_16x16x4_f32 v[52:55], v70, v76, v[52:55]
    v_mfma_f32_16x16x4_f32 v[56:59], v70, v78, v[56:59]
    v_mfma_f32_16x16x4_f32 v[60:63], v72, v80, v[60:63]
    v_mfma_f32_16x16x4_f32 v[48:51], v69, v75, v[48:51]
    v_mfma_f32_16x16x4_f32 v[52:55], v71, v77, v[52:55]
    v_mfma_f32_16x16x4_f32 v[56:59], v71, v79, v[56:59]
    v_mfma_f32_16x16x4_f32 v[60:63], v73, v81, v[60:63]
    v_mov_b32_dpp v64, v28 row_newbcast:2 row_mask:0xf bank_mask:0xf
    v_mov_b32_dpp v65, v29 row_newbcast:2 row_mask:0xf bank_mask:0xf
    v_mov_b32_dpp v66, v30 row_newbcast:2 row_mask:0xf bank_mask:0xf
    v_mov_b32_dpp v67, v31 row_newbcast:2 row_mask:0xf bank_mask:0xf
    v_mul_f32 v82, v64, v47
    v_mul_f32 v83, v65, v47
    v_exp_f32 v82, v82
    v_fract_f32 v83, v83
    v_cos_f32 v74, v83
    v_sin_f32 v75, v83
    v_mul_f32 v74, v74, v82
    v_mul_f32 v75, v75, v82
    v_mul_f32 v84, v75, v75
    v_add_f32 v85, v74, v74
    v_fma_f32 v76, v74, v74, -v84
    v_mul_f32 v77, v85, v75
    v_mul_f32 v84, v77, v77
    v_add_f32 v85, v76, v76
    v_fma_f32 v78, v76, v76, -v84
    v_mul_f32 v79, v85, v77
    v_mul_f32 v84, v79, v79
    v_add_f32 v85, v78, v78
    v_fma_f32 v80, v78, v78, -v84
    v_mul_f32 v81, v85, v79
    v_mul_f32 v82, v64, v44
    v_mul_f32 v83, v65, v44
    v_exp_f32 v82, v82
    v_fract_f32 v83, v83
    v_cos_f32 v68, v83
    v_sin_f32 v69, v83
    v_mul_f32 v68, v68, v82
    v_mul_f32 v69, v69, v82
    v_mul_f32 v84, v67, v69
    v_mul_f32 v85, v67, v68
    v_fma_f32 v68, v66, v68, -v84
    v_fma_f32 v69, -v66, v69, -v85
    v_mul_f32 v82, v64, v45
    v_mul_f32 v83, v65, v45
    v_exp_f32 v82, v82
    v_fract_f32 v83, v83
    v_cos_f32 v70, v83
    v_sin_f32 v71, v83
    v_mul_f32 v70, v70, v82
    v_mul_f32 v71, v71, v82
    v_mul_f32 v84, v67, v71
    v_mul_f32 v85, v67, v70
    v_fma_f32 v70, v66, v70, -v84
    v_fma_f32 v71, -v66, v71, -v85
    v_mul_f32 v82, v64, v46
    v_mul_f32 v83, v65, v46
    v_exp_f32 v82, v82
    v_fract_f32 v83, v83
    v_cos_f32 v72, v83
    v_sin_f32 v73, v83
    v_mul_f32 v72, v72, v82
    v_mul_f32 v73, v73, v82
    v_mul_f32 v84, v67, v73
    v_mul_f32 v85, v67, v72
    v_fma_f32 v72, v66, v72, -v84
    v_fma_f32 v73, -v66, v73, -v85
    v_mfma_f32_16x16x4_f32 v[48:51], v68, v74, v[48:51]
    v_mfma_f32_16x16x4_f32 v[52:55], v70, v76, v[52:55]
    v_mfma_f32_16x16x4_f32 v[56:59], v70, v78, v[56:59]
    v_mfma_f32_16x16x4_f32 v[60:63], v72, v80, v[60:63]
    v_mfma_f32_16x16x4_f32 v[48:51], v69, v75, v[48:51]
    v_mfma_f32_16x16x4_f32 v[52:55], v71, v77, v[52:55]
    v_mfma_f32_16x16x4_f32 v[56:59], v71, v79, v[56:59]
    v_mfma_f32_16x16x4_f32 v[60:63], v73, v81, v[60:63]
    v_mov_b32_dpp v64, v28 row_newbcast:3 row_mask:0xf bank_mask:0xf
    v_mov_b32_dpp v65, v29 row_newbcast:3 row_mask:0xf bank_mask:0xf
    v_mov_b32_dpp v66, v30 row_newbcast:3 row_mask:0xf bank_mask:0xf
    v_mov_b32_dpp v67, v31 row_newbcast:3 row_mask:0xf bank_mask:0xf
    v_mul_f32 v82, v64, v47
    v_mul_f32 v83, v65, v47
    v_exp_f32 v82, v82
    v_fract_f32 v83, v83
    v_cos_f32 v74, v83
    v_sin_f32 v75, v83
    v_mul_f32 v74, v74, v82
    v_mul_f32 v75, v75, v82
    v_mul_f32 v84, v75, v75
    v_add_f32 v85, v74, v74
    v_fma_f32 v76, v74, v74, -v84
    v_mul_f32 v77, v85, v75
    v_mul_f32 v84, v77, v77
    v_add_f32 v85, v76, v76
    v_fma_f32 v78, v76, v76, -v84
    v_mul_f32 v79, v85, v77
    v_mul_f32 v84, v79, v79
    v_add_f32 v85, v78, v78
    v_fma_f32 v80, v78, v78, -v84
    v_mul_f32 v81, v85, v79
    v_mul_f32 v82, v64, v44
    v_mul_f32 v83, v65, v44
    v_exp_f32 v82, v82
    v_fract_f32 v83, v83
    v_cos_f32 v68, v83
    v_sin_f32 v69, v83
    v_mul_f32 v68, v68, v82
    v_mul_f32 v69, v69, v82
    v_mul_f32 v84, v67, v69
    v_mul_f32 v85, v67, v68
    v_fma_f32 v68, v66, v68, -v84
    v_fma_f32 v69, -v66, v69, -v85
    v_mul_f32 v82, v64, v45
    v_mul_f32 v83, v65, v45
    v_exp_f32 v82, v82
    v_fract_f32 v83, v83
    v_cos_f32 v70, v83
    v_sin_f32 v71, v83
    v_mul_f32 v70, v70, v82
    v_mul_f32 v71, v71, v82
    v_mul_f32 v84, v67, v71
    v_mul_f32 v85, v67, v70
    v_fma_f32 v70, v66, v70, -v84
    v_fma_f32 v71, -v66, v71, -v85
    v_mul_f32 v82, v64, v46
    v_mul_f32 v83, v65, v46
    v_exp_f32 v82, v82
    v_fract_f32 v83, v83
    v_cos_f32 v72, v83
    v_sin_f32 v73, v83
    v_mul_f32 v72, v72, v82
    v_mul_f32 v73, v73, v82
    v_mul_f32 v84, v67, v73
    v_mul_f32 v85, v67, v72
    v_fma_f32 v72, v66, v72, -v84
    v_fma_f32 v73, -v66, v73, -v85
    v_mfma_f32_16x16x4_f32 v[48:51], v68, v74, v[48:51]
    v_mfma_f32_16x16x4_f32 v[52:55], v70, v76, v[52:55]
    v_mfma_f32_16x16x4_f32 v[56:59], v70, v78, v[56:59]
    v_mfma_f32_16x16x4_f32 v[60:63], v72, v80, v[60:63]
    v_mfma_f32_16x16x4_f32 v[48:51], v69, v75, v[48:51]
    v_mfma_f32_16x16x4_f32 v[52:55], v71, v77, v[52:55]
    v_mfma_f32_16x16x4_f32 v[56:59], v71, v79, v[56:59]
    v_mfma_f32_16x16x4_f32 v[60:63], v73, v81, v[60:63]
    v_mov_b32_dpp v64, v28 row_newbcast:4 row_mask:0xf bank_mask:0xf
    v_mov_b32_dpp v65, v29 row_newbcast:4 row_mask:0xf bank_mask:0xf
    v_mov_b32_dpp v66, v30 row_newbcast:4 row_mask:0xf bank_mask:0xf
    v_mov_b32_dpp v67, v31 row_newbcast:4 row_mask:0xf bank_mask:0xf
    v_mul_f32 v82, v64, v47
    v_mul_f32 v83, v65, v47
    v_exp_f32 v82, v82
    v_fract_f32 v83, v83
    v_cos_f32 v74, v83
    v_sin_f32 v75, v83
    v_mul_f32 v74, v74, v82
    v_mul_f32 v75, v75, v82
    v_mul_f32 v84, v75, v75
    v_add_f32 v85, v74, v74
    v_fma_f32 v76, v74, v74, -v84
    v_mul_f32 v77, v85, v75
    v_mul_f32 v84, v77, v77
    v_add_f32 v85, v76, v76
    v_fma_f32 v78, v76, v76, -v84
    v_mul_f32 v79, v85, v77
    v_mul_f32 v84, v79, v79
    v_add_f32 v85, v78, v78
    v_fma_f32 v80, v78, v78, -v84
    v_mul_f32 v81, v85, v79
    v_mul_f32 v82, v64, v44
    v_mul_f32 v83, v65, v44
    v_exp_f32 v82, v82
    v_fract_f32 v83, v83
    v_cos_f32 v68, v83
    v_sin_f32 v69, v83
    v_mul_f32 v68, v68, v82
    v_mul_f32 v69, v69, v82
    v_mul_f32 v84, v67, v69
    v_mul_f32 v85, v67, v68
    v_fma_f32 v68, v66, v68, -v84
    v_fma_f32 v69, -v66, v69, -v85
    v_mul_f32 v82, v64, v45
    v_mul_f32 v83, v65, v45
    v_exp_f32 v82, v82
    v_fract_f32 v83, v83
    v_cos_f32 v70, v83
    v_sin_f32 v71, v83
    v_mul_f32 v70, v70, v82
    v_mul_f32 v71, v71, v82
    v_mul_f32 v84, v67, v71
    v_mul_f32 v85, v67, v70
    v_fma_f32 v70, v66, v70, -v84
    v_fma_f32 v71, -v66, v71, -v85
    v_mul_f32 v82, v64, v46
    v_mul_f32 v83, v65, v46
    v_exp_f32 v82, v82
    v_fract_f32 v83, v83
    v_cos_f32 v72, v83
    v_sin_f32 v73, v83
    v_mul_f32 v72, v72, v82
    v_mul_f32 v73, v73, v82
    v_mul_f32 v84, v67, v73
    v_mul_f32 v85, v67, v72
    v_fma_f32 v72, v66, v72, -v84
    v_fma_f32 v73, -v66, v73, -v85
    v_mfma_f32_16x16x4_f32 v[48:51], v68, v74, v[48:51]
    v_mfma_f32_16x16x4_f32 v[52:55], v70, v76, v[52:55]
    v_mfma_f32_16x16x4_f32 v[56:59], v70, v78, v[56:59]
    v_mfma_f32_16x16x4_f32 v[60:63], v72, v80, v[60:63]
    v_mfma_f32_16x16x4_f32 v[48:51], v69, v75, v[48:51]
    v_mfma_f32_16x16x4_f32 v[52:55], v71, v77, v[52:55]
    v_mfma_f32_16x16x4_f32 v[56:59], v71, v79, v[56:59]
    v_mfma_f32_16x16x4_f32 v[60:63], v73, v81, v[60:63]
    v_mov_b32_dpp v64, v28 row_newbcast:5 row_mask:0xf bank_mask:0xf
    v_mov_b32_dpp v65, v29 row_newbcast:5 row_mask:0xf bank_mask:0xf
    v_mov_b32_dpp v66, v30 row_newbcast:5 row_mask:0xf bank_mask:0xf
    v_mov_b32_dpp v67, v31 row_newbcast:5 row_mask:0xf bank_mask:0xf
    v_mul_f32 v82, v64, v47
    v_mul_f32 v83, v65, v47
    v_exp_f32 v82, v82
    v_fract_f32 v83, v83
    v_cos_f32 v74, v83
    v_sin_f32 v75, v83
    v_mul_f32 v74, v74, v82
    v_mul_f32 v75, v75, v82
    v_mul_f32 v84, v75, v75
    v_add_f32 v85, v74, v74
    v_fma_f32 v76, v74, v74, -v84
    v_mul_f32 v77, v85, v75
    v_mul_f32 v84, v77, v77
    v_add_f32 v85, v76, v76
    v_fma_f32 v78, v76, v76, -v84
    v_mul_f32 v79, v85, v77
    v_mul_f32 v84, v79, v79
    v_add_f32 v85, v78, v78
    v_fma_f32 v80, v78, v78, -v84
    v_mul_f32 v81, v85, v79
    v_mul_f32 v82, v64, v44
    v_mul_f32 v83, v65, v44
    v_exp_f32 v82, v82
    v_fract_f32 v83, v83
    v_cos_f32 v68, v83
    v_sin_f32 v69, v83
    v_mul_f32 v68, v68, v82
    v_mul_f32 v69, v69, v82
    v_mul_f32 v84, v67, v69
    v_mul_f32 v85, v67, v68
    v_fma_f32 v68, v66, v68, -v84
    v_fma_f32 v69, -v66, v69, -v85
    v_mul_f32 v82, v64, v45
    v_mul_f32 v83, v65, v45
    v_exp_f32 v82, v82
    v_fract_f32 v83, v83
    v_cos_f32 v70, v83
    v_sin_f32 v71, v83
    v_mul_f32 v70, v70, v82
    v_mul_f32 v71, v71, v82
    v_mul_f32 v84, v67, v71
    v_mul_f32 v85, v67, v70
    v_fma_f32 v70, v66, v70, -v84
    v_fma_f32 v71, -v66, v71, -v85
    v_mul_f32 v82, v64, v46
    v_mul_f32 v83, v65, v46
    v_exp_f32 v82, v82
    v_fract_f32 v83, v83
    v_cos_f32 v72, v83
    v_sin_f32 v73, v83
    v_mul_f32 v72, v72, v82
    v_mul_f32 v73, v73, v82
    v_mul_f32 v84, v67, v73
    v_mul_f32 v85, v67, v72
    v_fma_f32 v72, v66, v72, -v84
    v_fma_f32 v73, -v66, v73, -v85
    v_mfma_f32_16x16x4_f32 v[48:51], v68, v74, v[48:51]
    v_mfma_f32_16x16x4_f32 v[52:55], v70, v76, v[52:55]
    v_mfma_f32_16x16x4_f32 v[56:59], v70, v78, v[56:59]
    v_mfma_f32_16x16x4_f32 v[60:63], v72, v80, v[60:63]
    v_mfma_f32_16x16x4_f32 v[48:51], v69, v75, v[48:51]
    v_mfma_f32_16x16x4_f32 v[52:55], v71, v77, v[52:55]
    v_mfma_f32_16x16x4_f32 v[56:59], v71, v79, v[56:59]
    v_mfma_f32_16x16x4_f32 v[60:63], v73, v81, v[60:63]
    v_mov_b32_dpp v64, v28 row_newbcast:6 row_mask:0xf bank_mask:0xf
    v_mov_b32_dpp v65, v29 row_newbcast:6 row_mask:0xf bank_mask:0xf
    v_mov_b32_dpp v66, v30 row_newbcast:6 row_mask:0xf bank_mask:0xf
    v_mov_b32_dpp v67, v31 row_newbcast:6 row_mask:0xf bank_mask:0xf
    v_mul_f32 v82, v64, v47
    v_mul_f32 v83, v65, v47
    v_exp_f32 v82, v82
    v_fract_f32 v83, v83
    v_cos_f32 v74, v83
    v_sin_f32 v75, v83
    v_mul_f32 v74, v74, v82
    v_mul_f32 v75, v75, v82
    v_mul_f32 v84, v75, v75
    v_add_f32 v85, v74, v74
    v_fma_f32 v76, v74, v74, -v84
    v_mul_f32 v77, v85, v75
    v_mul_f32 v84, v77, v77
    v_add_f32 v85, v76, v76
    v_fma_f32 v78, v76, v76, -v84
    v_mul_f32 v79, v85, v77
    v_mul_f32 v84, v79, v79
    v_add_f32 v85, v78, v78
    v_fma_f32 v80, v78, v78, -v84
    v_mul_f32 v81, v85, v79
    v_mul_f32 v82, v64, v44
    v_mul_f32 v83, v65, v44
    v_exp_f32 v82, v82
    v_fract_f32 v83, v83
    v_cos_f32 v68, v83
    v_sin_f32 v69, v83
    v_mul_f32 v68, v68, v82
    v_mul_f32 v69, v69, v82
    v_mul_f32 v84, v67, v69
    v_mul_f32 v85, v67, v68
    v_fma_f32 v68, v66, v68, -v84
    v_fma_f32 v69, -v66, v69, -v85
    v_mul_f32 v82, v64, v45
    v_mul_f32 v83, v65, v45
    v_exp_f32 v82, v82
    v_fract_f32 v83, v83
    v_cos_f32 v70, v83
    v_sin_f32 v71, v83
    v_mul_f32 v70, v70, v82
    v_mul_f32 v71, v71, v82
    v_mul_f32 v84, v67, v71
    v_mul_f32 v85, v67, v70
    v_fma_f32 v70, v66, v70, -v84
    v_fma_f32 v71, -v66, v71, -v85
    v_mul_f32 v82, v64, v46
    v_mul_f32 v83, v65, v46
    v_exp_f32 v82, v82
    v_fract_f32 v83, v83
    v_cos_f32 v72, v83
    v_sin_f32 v73, v83
    v_mul_f32 v72, v72, v82
    v_mul_f32 v73, v73, v82
    v_mul_f32 v84, v67, v73
    v_mul_f32 v85, v67, v72
    v_fma_f32 v72, v66, v72, -v84
    v_fma_f32 v73, -v66, v73, -v85
    v_mfma_f32_16x16x4_f32 v[48:51], v68, v74, v[48:51]
    v_mfma_f32_16x16x4_f32 v[52:55], v70, v76, v[52:55]
    v_mfma_f32_16x16x4_f32 v[56:59], v70, v78, v[56:59]
    v_mfma_f32_16x16x4_f32 v[60:63], v72, v80, v[60:63]
    v_mfma_f32_16x16x4_f32 v[48:51], v69, v75, v[48:51]
    v_mfma_f32_16x16x4_f32 v[52:55], v71, v77, v[52:55]
    v_mfma_f32_16x16x4_f32 v[56:59], v71, v79, v[56:59]
    v_mfma_f32_16x16x4_f32 v[60:63], v73, v81, v[60:63]
    v_mov_b32_dpp v64, v28 row_newbcast:7 row_mask:0xf bank_mask:0xf
    v_mov_b32_dpp v65, v29 row_newbcast:7 row_mask:0xf bank_mask:0xf
    v_mov_b32_dpp v66, v30 row_newbcast:7 row_mask:0xf bank_mask:0xf
    v_mov_b32_dpp v67, v31 row_newbcast:7 row_mask:0xf bank_mask:0xf
    v_mul_f32 v82, v64, v47
    v_mul_f32 v83, v65, v47
    v_exp_f32 v82, v82
    v_fract_f32 v83, v83
    v_cos_f32 v74, v83
    v_sin_f32 v75, v83
    v_mul_f32 v74, v74, v82
    v_mul_f32 v75, v75, v82
    v_mul_f32 v84, v75, v75
    v_add_f32 v85, v74, v74
    v_fma_f32 v76, v74, v74, -v84
    v_mul_f32 v77, v85, v75
    v_mul_f32 v84, v77, v77
    v_add_f32 v85, v76, v76
    v_fma_f32 v78, v76, v76, -v84
    v_mul_f32 v79, v85, v77
    v_mul_f32 v84, v79, v79
    v_add_f32 v85, v78, v78
    v_fma_f32 v80, v78, v78, -v84
    v_mul_f32 v81, v85, v79
    v_mul_f32 v82, v64, v44
    v_mul_f32 v83, v65, v44
    v_exp_f32 v82, v82
    v_fract_f32 v83, v83
    v_cos_f32 v68, v83
    v_sin_f32 v69, v83
    v_mul_f32 v68, v68, v82
    v_mul_f32 v69, v69, v82
    v_mul_f32 v84, v67, v69
    v_mul_f32 v85, v67, v68
    v_fma_f32 v68, v66, v68, -v84
    v_fma_f32 v69, -v66, v69, -v85
    v_mul_f32 v82, v64, v45
    v_mul_f32 v83, v65, v45
    v_exp_f32 v82, v82
    v_fract_f32 v83, v83
    v_cos_f32 v70, v83
    v_sin_f32 v71, v83
    v_mul_f32 v70, v70, v82
    v_mul_f32 v71, v71, v82
    v_mul_f32 v84, v67, v71
    v_mul_f32 v85, v67, v70
    v_fma_f32 v70, v66, v70, -v84
    v_fma_f32 v71, -v66, v71, -v85
    v_mul_f32 v82, v64, v46
    v_mul_f32 v83, v65, v46
    v_exp_f32 v82, v82
    v_fract_f32 v83, v83
    v_cos_f32 v72, v83
    v_sin_f32 v73, v83
    v_mul_f32 v72, v72, v82
    v_mul_f32 v73, v73, v82
    v_mul_f32 v84, v67, v73
    v_mul_f32 v85, v67, v72
    v_fma_f32 v72, v66, v72, -v84
    v_fma_f32 v73, -v66, v73, -v85
    v_mfma_f32_16x16x4_f32 v[48:51], v68, v74, v[48:51]
    v_mfma_f32_16x16x4_f32 v[52:55], v70, v76, v[52:55]
    v_mfma_f32_16x16x4_f32 v[56:59], v70, v78, v[56:59]
    v_mfma_f32_16x16x4_f32 v[60:63], v72, v80, v[60:63]
    v_mfma_f32_16x16x4_f32 v[48:51], v69, v75, v[48:51]
    v_mfma_f32_16x16x4_f32 v[52:55], v71, v77, v[52:55]
    v_mfma_f32_16x16x4_f32 v[56:59], v71, v79, v[56:59]
    v_mfma_f32_16x16x4_f32 v[60:63], v73, v81, v[60:63]
    v_mov_b32_dpp v64, v28 row_newbcast:8 row_mask:0xf bank_mask:0xf
    v_mov_b32_dpp v65, v29 row_newbcast:8 row_mask:0xf bank_mask:0xf
    v_mov_b32_dpp v66, v30 row_newbcast:8 row_mask:0xf bank_mask:0xf
    v_mov_b32_dpp v67, v31 row_newbcast:8 row_mask:0xf bank_mask:0xf
    v_mul_f32 v82, v64, v47
    v_mul_f32 v83, v65, v47
    v_exp_f32 v82, v82
    v_fract_f32 v83, v83
    v_cos_f32 v74, v83
    v_sin_f32 v75, v83
    v_mul_f32 v74, v74, v82
    v_mul_f32 v75, v75, v82
    v_mul_f32 v84, v75, v75
    v_add_f32 v85, v74, v74
    v_fma_f32 v76, v74, v74, -v84
    v_mul_f32 v77, v85, v75
    v_mul_f32 v84, v77, v77
    v_add_f32 v85, v76, v76
    v_fma_f32 v78, v76, v76, -v84
    v_mul_f32 v79, v85, v77
    v_mul_f32 v84, v79, v79
    v_add_f32 v85, v78, v78
    v_fma_f32 v80, v78, v78, -v84
    v_mul_f32 v81, v85, v79
    v_mul_f32 v82, v64, v44
    v_mul_f32 v83, v65, v44
    v_exp_f32 v82, v82
    v_fract_f32 v83, v83
    v_cos_f32 v68, v83
    v_sin_f32 v69, v83
    v_mul_f32 v68, v68, v82
    v_mul_f32 v69, v69, v82
    v_mul_f32 v84, v67, v69
    v_mul_f32 v85, v67, v68
    v_fma_f32 v68, v66, v68, -v84
    v_fma_f32 v69, -v66, v69, -v85
    v_mul_f32 v82, v64, v45
    v_mul_f32 v83, v65, v45
    v_exp_f32 v82, v82
    v_fract_f32 v83, v83
    v_cos_f32 v70, v83
    v_sin_f32 v71, v83
    v_mul_f32 v70, v70, v82
    v_mul_f32 v71, v71, v82
    v_mul_f32 v84, v67, v71
    v_mul_f32 v85, v67, v70
    v_fma_f32 v70, v66, v70, -v84
    v_fma_f32 v71, -v66, v71, -v85
    v_mul_f32 v82, v64, v46
    v_mul_f32 v83, v65, v46
    v_exp_f32 v82, v82
    v_fract_f32 v83, v83
    v_cos_f32 v72, v83
    v_sin_f32 v73, v83
    v_mul_f32 v72, v72, v82
    v_mul_f32 v73, v73, v82
    v_mul_f32 v84, v67, v73
    v_mul_f32 v85, v67, v72
    v_fma_f32 v72, v66, v72, -v84
    v_fma_f32 v73, -v66, v73, -v85
    v_mfma_f32_16x16x4_f32 v[48:51], v68, v74, v[48:51]
    v_mfma_f32_16x16x4_f32 v[52:55], v70, v76, v[52:55]
    v_mfma_f32_16x16x4_f32 v[56:59], v70, v78, v[56:59]
    v_mfma_f32_16x16x4_f32 v[60:63], v72, v80, v[60:63]
    v_mfma_f32_16x16x4_f32 v[48:51], v69, v75, v[48:51]
    v_mfma_f32_16x16x4_f32 v[52:55], v71, v77, v[52:55]
    v_mfma_f32_16x16x4_f32 v[56:59], v71, v79, v[56:59]
    v_mfma_f32_16x16x4_f32 v[60:63], v73, v81, v[60:63]
    v_mov_b32_dpp v64, v28 row_newbcast:9 row_mask:0xf bank_mask:0xf
    v_mov_b32_dpp v65, v29 row_newbcast:9 row_mask:0xf bank_mask:0xf
    v_mov_b32_dpp v66, v30 row_newbcast:9 row_mask:0xf bank_mask:0xf
    v_mov_b32_dpp v67, v31 row_newbcast:9 row_mask:0xf bank_mask:0xf
    v_mul_f32 v82, v64, v47
    v_mul_f32 v83, v65, v47
    v_exp_f32 v82, v82
    v_fract_f32 v83, v83
    v_cos_f32 v74, v83
    v_sin_f32 v75, v83
    v_mul_f32 v74, v74, v82
    v_mul_f32 v75, v75, v82
    v_mul_f32 v84, v75, v75
    v_add_f32 v85, v74, v74
    v_fma_f32 v76, v74, v74, -v84
    v_mul_f32 v77, v85, v75
    v_mul_f32 v84, v77, v77
    v_add_f32 v85, v76, v76
    v_fma_f32 v78, v76, v76, -v84
    v_mul_f32 v79, v85, v77
    v_mul_f32 v84, v79, v79
    v_add_f32 v85, v78, v78
    v_fma_f32 v80, v78, v78, -v84
    v_mul_f32 v81, v85, v79
    v_mul_f32 v82, v64, v44
    v_mul_f32 v83, v65, v44
    v_exp_f32 v82, v82
    v_fract_f32 v83, v83
    v_cos_f32 v68, v83
    v_sin_f32 v69, v83
    v_mul_f32 v68, v68, v82
    v_mul_f32 v69, v69, v82
    v_mul_f32 v84, v67, v69
    v_mul_f32 v85, v67, v68
    v_fma_f32 v68, v66, v68, -v84
    v_fma_f32 v69, -v66, v69, -v85
    v_mul_f32 v82, v64, v45
    v_mul_f32 v83, v65, v45
    v_exp_f32 v82, v82
    v_fract_f32 v83, v83
    v_cos_f32 v70, v83
    v_sin_f32 v71, v83
    v_mul_f32 v70, v70, v82
    v_mul_f32 v71, v71, v82
    v_mul_f32 v84, v67, v71
    v_mul_f32 v85, v67, v70
    v_fma_f32 v70, v66, v70, -v84
    v_fma_f32 v71, -v66, v71, -v85
    v_mul_f32 v82, v64, v46
    v_mul_f32 v83, v65, v46
    v_exp_f32 v82, v82
    v_fract_f32 v83, v83
    v_cos_f32 v72, v83
    v_sin_f32 v73, v83
    v_mul_f32 v72, v72, v82
    v_mul_f32 v73, v73, v82
    v_mul_f32 v84, v67, v73
    v_mul_f32 v85, v67, v72
    v_fma_f32 v72, v66, v72, -v84
    v_fma_f32 v73, -v66, v73, -v85
    v_mfma_f32_16x16x4_f32 v[48:51], v68, v74, v[48:51]
    v_mfma_f32_16x16x4_f32 v[52:55], v70, v76, v[52:55]
    v_mfma_f32_16x16x4_f32 v[56:59], v70, v78, v[56:59]
    v_mfma_f32_16x16x4_f32 v[60:63], v72, v80, v[60:63]
    v_mfma_f32_16x16x4_f32 v[48:51], v69, v75, v[48:51]
    v_mfma_f32_16x16x4_f32 v[52:55], v71, v77, v[52:55]
    v_mfma_f32_16x16x4_f32 v[56:59], v71, v79, v[56:59]
    v_mfma_f32_16x16x4_f32 v[60:63], v73, v81, v[60:63]
    v_mov_b32_dpp v64, v28 row_newbcast:10 row_mask:0xf bank_mask:0xf
    v_mov_b32_dpp v65, v29 row_newbcast:10 row_mask:0xf bank_mask:0xf
    v_mov_b32_dpp v66, v30 row_newbcast:10 row_mask:0xf bank_mask:0xf
    v_mov_b32_dpp v67, v31 row_newbcast:10 row_mask:0xf bank_mask:0xf
    v_mul_f32 v82, v64, v47
    v_mul_f32 v83, v65, v47
    v_exp_f32 v82, v82
    v_fract_f32 v83, v83
    v_cos_f32 v74, v83
    v_sin_f32 v75, v83
    v_mul_f32 v74, v74, v82
    v_mul_f32 v75, v75, v82
    v_mul_f32 v84, v75, v75
    v_add_f32 v85, v74, v74
    v_fma_f32 v76, v74, v74, -v84
    v_mul_f32 v77, v85, v75
    v_mul_f32 v84, v77, v77
    v_add_f32 v85, v76, v76
    v_fma_f32 v78, v76, v76, -v84
    v_mul_f32 v79, v85, v77
    v_mul_f32 v84, v79, v79
    v_add_f32 v85, v78, v78
    v_fma_f32 v80, v78, v78, -v84
    v_mul_f32 v81, v85, v79
    v_mul_f32 v82, v64, v44
    v_mul_f32 v83, v65, v44
    v_exp_f32 v82, v82
    v_fract_f32 v83, v83
    v_cos_f32 v68, v83
    v_sin_f32 v69, v83
    v_mul_f32 v68, v68, v82
    v_mul_f32 v69, v69, v82
    v_mul_f32 v84, v67, v69
    v_mul_f32 v85, v67, v68
    v_fma_f32 v68, v66, v68, -v84
    v_fma_f32 v69, -v66, v69, -v85
    v_mul_f32 v82, v64, v45
    v_mul_f32 v83, v65, v45
    v_exp_f32 v82, v82
    v_fract_f32 v83, v83
    v_cos_f32 v70, v83
    v_sin_f32 v71, v83
    v_mul_f32 v70, v70, v82
    v_mul_f32 v71, v71, v82
    v_mul_f32 v84, v67, v71
    v_mul_f32 v85, v67, v70
    v_fma_f32 v70, v66, v70, -v84
    v_fma_f32 v71, -v66, v71, -v85
    v_mul_f32 v82, v64, v46
    v_mul_f32 v83, v65, v46
    v_exp_f32 v82, v82
    v_fract_f32 v83, v83
    v_cos_f32 v72, v83
    v_sin_f32 v73, v83
    v_mul_f32 v72, v72, v82
    v_mul_f32 v73, v73, v82
    v_mul_f32 v84, v67, v73
    v_mul_f32 v85, v67, v72
    v_fma_f32 v72, v66, v72, -v84
    v_fma_f32 v73, -v66, v73, -v85
    v_mfma_f32_16x16x4_f32 v[48:51], v68, v74, v[48:51]
    v_mfma_f32_16x16x4_f32 v[52:55], v70, v76, v[52:55]
    v_mfma_f32_16x16x4_f32 v[56:59], v70, v78, v[56:59]
    v_mfma_f32_16x16x4_f32 v[60:63], v72, v80, v[60:63]
    v_mfma_f32_16x16x4_f32 v[48:51], v69, v75, v[48:51]
    v_mfma_f32_16x16x4_f32 v[52:55], v71, v77, v[52:55]
    v_mfma_f32_16x16x4_f32 v[56:59], v71, v79, v[56:59]
    v_mfma_f32_16x16x4_f32 v[60:63], v73, v81, v[60:63]
    v_mov_b32_dpp v64, v28 row_newbcast:11 row_mask:0xf bank_mask:0xf
    v_mov_b32_dpp v65, v29 row_newbcast:11 row_mask:0xf bank_mask:0xf
    v_mov_b32_dpp v66, v30 row_newbcast:11 row_mask:0xf bank_mask:0xf
    v_mov_b32_dpp v67, v31 row_newbcast:11 row_mask:0xf bank_mask:0xf
    v_mul_f32 v82, v64, v47
    v_mul_f32 v83, v65, v47
    v_exp_f32 v82, v82
    v_fract_f32 v83, v83
    v_cos_f32 v74, v83
    v_sin_f32 v75, v83
    v_mul_f32 v74, v74, v82
    v_mul_f32 v75, v75, v82
    v_mul_f32 v84, v75, v75
    v_add_f32 v85, v74, v74
    v_fma_f32 v76, v74, v74, -v84
    v_mul_f32 v77, v85, v75
    v_mul_f32 v84, v77, v77
    v_add_f32 v85, v76, v76
    v_fma_f32 v78, v76, v76, -v84
    v_mul_f32 v79, v85, v77
    v_mul_f32 v84, v79, v79
    v_add_f32 v85, v78, v78
    v_fma_f32 v80, v78, v78, -v84
    v_mul_f32 v81, v85, v79
    v_mul_f32 v82, v64, v44
    v_mul_f32 v83, v65, v44
    v_exp_f32 v82, v82
    v_fract_f32 v83, v83
    v_cos_f32 v68, v83
    v_sin_f32 v69, v83
    v_mul_f32 v68, v68, v82
    v_mul_f32 v69, v69, v82
    v_mul_f32 v84, v67, v69
    v_mul_f32 v85, v67, v68
    v_fma_f32 v68, v66, v68, -v84
    v_fma_f32 v69, -v66, v69, -v85
    v_mul_f32 v82, v64, v45
    v_mul_f32 v83, v65, v45
    v_exp_f32 v82, v82
    v_fract_f32 v83, v83
    v_cos_f32 v70, v83
    v_sin_f32 v71, v83
    v_mul_f32 v70, v70, v82
    v_mul_f32 v71, v71, v82
    v_mul_f32 v84, v67, v71
    v_mul_f32 v85, v67, v70
    v_fma_f32 v70, v66, v70, -v84
    v_fma_f32 v71, -v66, v71, -v85
    v_mul_f32 v82, v64, v46
    v_mul_f32 v83, v65, v46
    v_exp_f32 v82, v82
    v_fract_f32 v83, v83
    v_cos_f32 v72, v83
    v_sin_f32 v73, v83
    v_mul_f32 v72, v72, v82
    v_mul_f32 v73, v73, v82
    v_mul_f32 v84, v67, v73
    v_mul_f32 v85, v67, v72
    v_fma_f32 v72, v66, v72, -v84
    v_fma_f32 v73, -v66, v73, -v85
    v_mfma_f32_16x16x4_f32 v[48:51], v68, v74, v[48:51]
    v_mfma_f32_16x16x4_f32 v[52:55], v70, v76, v[52:55]
    v_mfma_f32_16x16x4_f32 v[56:59], v70, v78, v[56:59]
    v_mfma_f32_16x16x4_f32 v[60:63], v72, v80, v[60:63]
    v_mfma_f32_16x16x4_f32 v[48:51], v69, v75, v[48:51]
    v_mfma_f32_16x16x4_f32 v[52:55], v71, v77, v[52:55]
    v_mfma_f32_16x16x4_f32 v[56:59], v71, v79, v[56:59]
    v_mfma_f32_16x16x4_f32 v[60:63], v73, v81, v[60:63]
    v_mov_b32_dpp v64, v28 row_newbcast:12 row_mask:0xf bank_mask:0xf
    v_mov_b32_dpp v65, v29 row_newbcast:12 row_mask:0xf bank_mask:0xf
    v_mov_b32_dpp v66, v30 row_newbcast:12 row_mask:0xf bank_mask:0xf
    v_mov_b32_dpp v67, v31 row_newbcast:12 row_mask:0xf bank_mask:0xf
    v_mul_f32 v82, v64, v47
    v_mul_f32 v83, v65, v47
    v_exp_f32 v82, v82
    v_fract_f32 v83, v83
    v_cos_f32 v74, v83
    v_sin_f32 v75, v83
    v_mul_f32 v74, v74, v82
    v_mul_f32 v75, v75, v82
    v_mul_f32 v84, v75, v75
    v_add_f32 v85, v74, v74
    v_fma_f32 v76, v74, v74, -v84
    v_mul_f32 v77, v85, v75
    v_mul_f32 v84, v77, v77
    v_add_f32 v85, v76, v76
    v_fma_f32 v78, v76, v76, -v84
    v_mul_f32 v79, v85, v77
    v_mul_f32 v84, v79, v79
    v_add_f32 v85, v78, v78
    v_fma_f32 v80, v78, v78, -v84
    v_mul_f32 v81, v85, v79
    v_mul_f32 v82, v64, v44
    v_mul_f32 v83, v65, v44
    v_exp_f32 v82, v82
    v_fract_f32 v83, v83
    v_cos_f32 v68, v83
    v_sin_f32 v69, v83
    v_mul_f32 v68, v68, v82
    v_mul_f32 v69, v69, v82
    v_mul_f32 v84, v67, v69
    v_mul_f32 v85, v67, v68
    v_fma_f32 v68, v66, v68, -v84
    v_fma_f32 v69, -v66, v69, -v85
    v_mul_f32 v82, v64, v45
    v_mul_f32 v83, v65, v45
    v_exp_f32 v82, v82
    v_fract_f32 v83, v83
    v_cos_f32 v70, v83
    v_sin_f32 v71, v83
    v_mul_f32 v70, v70, v82
    v_mul_f32 v71, v71, v82
    v_mul_f32 v84, v67, v71
    v_mul_f32 v85, v67, v70
    v_fma_f32 v70, v66, v70, -v84
    v_fma_f32 v71, -v66, v71, -v85
    v_mul_f32 v82, v64, v46
    v_mul_f32 v83, v65, v46
    v_exp_f32 v82, v82
    v_fract_f32 v83, v83
    v_cos_f32 v72, v83
    v_sin_f32 v73, v83
    v_mul_f32 v72, v72, v82
    v_mul_f32 v73, v73, v82
    v_mul_f32 v84, v67, v73
    v_mul_f32 v85, v67, v72
    v_fma_f32 v72, v66, v72, -v84
    v_fma_f32 v73, -v66, v73, -v85
    v_mfma_f32_16x16x4_f32 v[48:51], v68, v74, v[48:51]
    v_mfma_f32_16x16x4_f32 v[52:55], v70, v76, v[52:55]
    v_mfma_f32_16x16x4_f32 v[56:59], v70, v78, v[56:59]
    v_mfma_f32_16x16x4_f32 v[60:63], v72, v80, v[60:63]
    v_mfma_f32_16x16x4_f32 v[48:51], v69, v75, v[48:51]
    v_mfma_f32_16x16x4_f32 v[52:55], v71, v77, v[52:55]
    v_mfma_f32_16x16x4_f32 v[56:59], v71, v79, v[56:59]
    v_mfma_f32_16x16x4_f32 v[60:63], v73, v81, v[60:63]
    v_mov_b32_dpp v64, v28 row_newbcast:13 row_mask:0xf bank_mask:0xf
    v_mov_b32_dpp v65, v29 row_newbcast:13 row_mask:0xf bank_mask:0xf
    v_mov_b32_dpp v66, v30 row_newbcast:13 row_mask:0xf bank_mask:0xf
    v_mov_b32_dpp v67, v31 row_newbcast:13 row_mask:0xf bank_mask:0xf
    v_mul_f32 v82, v64, v47
    v_mul_f32 v83, v65, v47
    v_exp_f32 v82, v82
    v_fract_f32 v83, v83
    v_cos_f32 v74, v83
    v_sin_f32 v75, v83
    v_mul_f32 v74, v74, v82
    v_mul_f32 v75, v75, v82
    v_mul_f32 v84, v75, v75
    v_add_f32 v85, v74, v74
    v_fma_f32 v76, v74, v74, -v84
    v_mul_f32 v77, v85, v75
    v_mul_f32 v84, v77, v77
    v_add_f32 v85, v76, v76
    v_fma_f32 v78, v76, v76, -v84
    v_mul_f32 v79, v85, v77
    v_mul_f32 v84, v79, v79
    v_add_f32 v85, v78, v78
    v_fma_f32 v80, v78, v78, -v84
    v_mul_f32 v81, v85, v79
    v_mul_f32 v82, v64, v44
    v_mul_f32 v83, v65, v44
    v_exp_f32 v82, v82
    v_fract_f32 v83, v83
    v_cos_f32 v68, v83
    v_sin_f32 v69, v83
    v_mul_f32 v68, v68, v82
    v_mul_f32 v69, v69, v82
    v_mul_f32 v84, v67, v69
    v_mul_f32 v85, v67, v68
    v_fma_f32 v68, v66, v68, -v84
    v_fma_f32 v69, -v66, v69, -v85
    v_mul_f32 v82, v64, v45
    v_mul_f32 v83, v65, v45
    v_exp_f32 v82, v82
    v_fract_f32 v83, v83
    v_cos_f32 v70, v83
    v_sin_f32 v71, v83
    v_mul_f32 v70, v70, v82
    v_mul_f32 v71, v71, v82
    v_mul_f32 v84, v67, v71
    v_mul_f32 v85, v67, v70
    v_fma_f32 v70, v66, v70, -v84
    v_fma_f32 v71, -v66, v71, -v85
    v_mul_f32 v82, v64, v46
    v_mul_f32 v83, v65, v46
    v_exp_f32 v82, v82
    v_fract_f32 v83, v83
    v_cos_f32 v72, v83
    v_sin_f32 v73, v83
    v_mul_f32 v72, v72, v82
    v_mul_f32 v73, v73, v82
    v_mul_f32 v84, v67, v73
    v_mul_f32 v85, v67, v72
    v_fma_f32 v72, v66, v72, -v84
    v_fma_f32 v73, -v66, v73, -v85
    v_mfma_f32_16x16x4_f32 v[48:51], v68, v74, v[48:51]
    v_mfma_f32_16x16x4_f32 v[52:55], v70, v76, v[52:55]
    v_mfma_f32_16x16x4_f32 v[56:59], v70, v78, v[56:59]
    v_mfma_f32_16x16x4_f32 v[60:63], v72, v80, v[60:63]
    v_mfma_f32_16x16x4_f32 v[48:51], v69, v75, v[48:51]
    v_mfma_f32_16x16x4_f32 v[52:55], v71, v77, v[52:55]
    v_mfma_f32_16x16x4_f32 v[56:59], v71, v79, v[56:59]
    v_mfma_f32_16x16x4_f32 v[60:63], v73, v81, v[60:63]
    v_mov_b32_dpp v64, v28 row_newbcast:14 row_mask:0xf bank_mask:0xf
    v_mov_b32_dpp v65, v29 row_newbcast:14 row_mask:0xf bank_mask:0xf
    v_mov_b32_dpp v66, v30 row_newbcast:14 row_mask:0xf bank_mask:0xf
    v_mov_b32_dpp v67, v31 row_newbcast:14 row_mask:0xf bank_mask:0xf
    v_mul_f32 v82, v64, v47
    v_mul_f32 v83, v65, v47
    v_exp_f32 v82, v82
    v_fract_f32 v83, v83
    v_cos_f32 v74, v83
    v_sin_f32 v75, v83
    v_mul_f32 v74, v74, v82
    v_mul_f32 v75, v75, v82
    v_mul_f32 v84, v75, v75
    v_add_f32 v85, v74, v74
    v_fma_f32 v76, v74, v74, -v84
    v_mul_f32 v77, v85, v75
    v_mul_f32 v84, v77, v77
    v_add_f32 v85, v76, v76
    v_fma_f32 v78, v76, v76, -v84
    v_mul_f32 v79, v85, v77
    v_mul_f32 v84, v79, v79
    v_add_f32 v85, v78, v78
    v_fma_f32 v80, v78, v78, -v84
    v_mul_f32 v81, v85, v79
    v_mul_f32 v82, v64, v44
    v_mul_f32 v83, v65, v44
    v_exp_f32 v82, v82
    v_fract_f32 v83, v83
    v_cos_f32 v68, v83
    v_sin_f32 v69, v83
    v_mul_f32 v68, v68, v82
    v_mul_f32 v69, v69, v82
    v_mul_f32 v84, v67, v69
    v_mul_f32 v85, v67, v68
    v_fma_f32 v68, v66, v68, -v84
    v_fma_f32 v69, -v66, v69, -v85
    v_mul_f32 v82, v64, v45
    v_mul_f32 v83, v65, v45
    v_exp_f32 v82, v82
    v_fract_f32 v83, v83
    v_cos_f32 v70, v83
    v_sin_f32 v71, v83
    v_mul_f32 v70, v70, v82
    v_mul_f32 v71, v71, v82
    v_mul_f32 v84, v67, v71
    v_mul_f32 v85, v67, v70
    v_fma_f32 v70, v66, v70, -v84
    v_fma_f32 v71, -v66, v71, -v85
    v_mul_f32 v82, v64, v46
    v_mul_f32 v83, v65, v46
    v_exp_f32 v82, v82
    v_fract_f32 v83, v83
    v_cos_f32 v72, v83
    v_sin_f32 v73, v83
    v_mul_f32 v72, v72, v82
    v_mul_f32 v73, v73, v82
    v_mul_f32 v84, v67, v73
    v_mul_f32 v85, v67, v72
    v_fma_f32 v72, v66, v72, -v84
    v_fma_f32 v73, -v66, v73, -v85
    v_mfma_f32_16x16x4_f32 v[48:51], v68, v74, v[48:51]
    v_mfma_f32_16x16x4_f32 v[52:55], v70, v76, v[52:55]
    v_mfma_f32_16x16x4_f32 v[56:59], v70, v78, v[56:59]
    v_mfma_f32_16x16x4_f32 v[60:63], v72, v80, v[60:63]
    v_mfma_f32_16x16x4_f32 v[48:51], v69, v75, v[48:51]
    v_mfma_f32_16x16x4_f32 v[52:55], v71, v77, v[52:55]
    v_mfma_f32_16x16x4_f32 v[56:59], v71, v79, v[56:59]
    v_mfma_f32_16x16x4_f32 v[60:63], v73, v81, v[60:63]
    v_mov_b32_dpp v64, v28 row_newbcast:15 row_mask:0xf bank_mask:0xf
    v_mov_b32_dpp v65, v29 row_newbcast:15 row_mask:0xf bank_mask:0xf
    v_mov_b32_dpp v66, v30 row_newbcast:15 row_mask:0xf bank_mask:0xf
    v_mov_b32_dpp v67, v31 row_newbcast:15 row_mask:0xf bank_mask:0xf
    v_mul_f32 v82, v64, v47
    v_mul_f32 v83, v65, v47
    v_exp_f32 v82, v82
    v_fract_f32 v83, v83
    v_cos_f32 v74, v83
    v_sin_f32 v75, v83
    v_mul_f32 v74, v74, v82
    v_mul_f32 v75, v75, v82
    v_mul_f32 v84, v75, v75
    v_add_f32 v85, v74, v74
    v_fma_f32 v76, v74, v74, -v84
    v_mul_f32 v77, v85, v75
    v_mul_f32 v84, v77, v77
    v_add_f32 v85, v76, v76
    v_fma_f32 v78, v76, v76, -v84
    v_mul_f32 v79, v85, v77
    v_mul_f32 v84, v79, v79
    v_add_f32 v85, v78, v78
    v_fma_f32 v80, v78, v78, -v84
    v_mul_f32 v81, v85, v79
    v_mul_f32 v82, v64, v44
    v_mul_f32 v83, v65, v44
    v_exp_f32 v82, v82
    v_fract_f32 v83, v83
    v_cos_f32 v68, v83
    v_sin_f32 v69, v83
    v_mul_f32 v68, v68, v82
    v_mul_f32 v69, v69, v82
    v_mul_f32 v84, v67, v69
    v_mul_f32 v85, v67, v68
    v_fma_f32 v68, v66, v68, -v84
    v_fma_f32 v69, -v66, v69, -v85
    v_mul_f32 v82, v64, v45
    v_mul_f32 v83, v65, v45
    v_exp_f32 v82, v82
    v_fract_f32 v83, v83
    v_cos_f32 v70, v83
    v_sin_f32 v71, v83
    v_mul_f32 v70, v70, v82
    v_mul_f32 v71, v71, v82
    v_mul_f32 v84, v67, v71
    v_mul_f32 v85, v67, v70
    v_fma_f32 v70, v66, v70, -v84
    v_fma_f32 v71, -v66, v71, -v85
    v_mul_f32 v82, v64, v46
    v_mul_f32 v83, v65, v46
    v_exp_f32 v82, v82
    v_fract_f32 v83, v83
    v_cos_f32 v72, v83
    v_sin_f32 v73, v83
    v_mul_f32 v72, v72, v82
    v_mul_f32 v73, v73, v82
    v_mul_f32 v84, v67, v73
    v_mul_f32 v85, v67, v72
    v_fma_f32 v72, v66, v72, -v84
    v_fma_f32 v73, -v66, v73, -v85
    v_mfma_f32_16x16x4_f32 v[48:51], v68, v74, v[48:51]
    v_mfma_f32_16x16x4_f32 v[52:55], v70, v76, v[52:55]
    v_mfma_f32_16x16x4_f32 v[56:59], v70, v78, v[56:59]
    v_mfma_f32_16x16x4_f32 v[60:63], v72, v80, v[60:63]
    v_mfma_f32_16x16x4_f32 v[48:51], v69, v75, v[48:51]
    v_mfma_f32_16x16x4_f32 v[52:55], v71, v77, v[52:55]
    v_mfma_f32_16x16x4_f32 v[56:59], v71, v79, v[56:59]
    v_mfma_f32_16x16x4_f32 v[60:63], v73, v81, v[60:63]
    v_lshlrev_b32 v5, 8, v3
    v_lshl_add_u32 v5, v2, 2, v5
    v_add_u32 v5, v5, v4
    ds_write_b32 v5, v48 offset:4608
    ds_write_b32 v5, v49 offset:4672
    ds_write_b32 v5, v50 offset:4736
    ds_write_b32 v5, v51 offset:4800
    v_cmp_gt_u32 vcc, 2, v3
    s_nop 0
    s_mov_b64 exec, vcc
    ds_write_b32 v5, v52 offset:5632
    ds_write_b32 v5, v53 offset:5696
    ds_write_b32 v5, v54 offset:5760
    ds_write_b32 v5, v55 offset:5824
    ds_write_b32 v5, v60 offset:6656
    ds_write_b32 v5, v61 offset:6720
    ds_write_b32 v5, v62 offset:6784
    ds_write_b32 v5, v63 offset:6848
    s_not_b64 exec, exec
    ds_write_b32 v5, v56 offset:5632
    ds_write_b32 v5, v57 offset:5696
    ds_write_b32 v5, v58 offset:5760
    ds_write_b32 v5, v59 offset:5824
    s_mov_b32 exec_lo, 0
    s_mov_b32 exec_hi, 3
    v_cmp_eq_u32 vcc, 0, v2
    s_nop 1
    v_cndmask_b32 v6, 0, v60, vcc
    ds_write_b32 v5, v6 offset:6656
    s_mov_b64 exec, -1
    s_waitcnt lgkmcnt(0)
    v_lshlrev_b32 v7, 1, v1
    v_sub_u32 v7, 2065, v7
    v_lshl_add_u32 v64, v1, 2, v4
    v_mov_b32 v65, 641
    s_mov_b32 s25, 17
ss_exp:
    v_subrev_u32 v66, 0, v7
    v_cvt_f32_u32 v70, v66
    v_cvt_pk_bf16_f32 v70, v70, v70
    v_and_b32 v70, 0xffff, v70
    v_subrev_u32 v70, 0x4280, v70
    v_cmp_gt_u32 vcc, 256, v66
    s_nop 1
    v_cndmask_b32 v70, v70, v66, vcc
    v_cmp_gt_u32 vcc, 2048, v66
    s_nop 1
    v_cndmask_b32 v70, v65, v70, vcc
    v_lshl_add_u32 v70, v70, 2, v4
    ds_read_b32 v74, v70 offset:4608
    v_subrev_u32 v67, 1, v7
    v_cvt_f32_u32 v71, v67
    v_cvt_pk_bf16_f32 v71, v71, v71
    v_and_b32 v71, 0xffff, v71
    v_subrev_u32 v71, 0x4280, v71
    v_cmp_gt_u32 vcc, 256, v67
    s_nop 1
    v_cndmask_b32 v71, v71, v67, vcc
    v_cmp_gt_u32 vcc, 2048, v67
    s_nop 1
    v_cndmask_b32 v71, v65, v71, vcc
    v_lshl_add_u32 v71, v71, 2, v4
    ds_read_b32 v75, v71 offset:4608
    v_subrev_u32 v68, 2, v7
    v_cvt_f32_u32 v72, v68
    v_cvt_pk_bf16_f32 v72, v72, v72
    v_and_b32 v72, 0xffff, v72
    v_subrev_u32 v72, 0x4280, v72
    v_cmp_gt_u32 vcc, 256, v68
    s_nop 1
    v_cndmask_b32 v72, v72, v68, vcc
    v_cmp_gt_u32 vcc, 2048, v68
    s_nop 1
    v_cndmask_b32 v72, v65, v72, vcc
    v_lshl_add_u32 v72, v72, 2, v4
    ds_read_b32 v76, v72 offset:4608
    s_waitcnt lgkmcnt(0)
    v_cvt_pk_bf16_f32 v78, v75, v76
    v_cvt_pk_bf16_f32 v79, v74, v75
    ds_write_b32 v64, v78 offset:7424
    ds_write_b32 v64, v79 offset:11776
    v_subrev_u32 v7, 128, v7
    v_add_u32 v64, 256, v64
    s_sub_u32 s25, s25, 1
    s_cmp_lg_u32 s25, 0
    s_cbranch_scc1 ss_exp
    s_waitcnt lgkmcnt(0)
    s_barrier
    v_and_b32 v5, 1, v2
    v_mul_u32_u24 v64, 4352, v5
    v_sub_u32 v5, v5, v2
    v_lshl_add_u32 v5, v3, 3, v5
    v_lshl_add_u32 v64, v5, 1, v64
    v_add_u32 v64, 11520, v64
    v_add_u32 v64, v64, v4
    v_lshlrev_b32 v65, 5, v2
    v_lshl_add_u32 v65, v3, 4, v65
    v_add_u32 v65, 480, v65
    v_add_u32 v65, v65, v4
    v_mov_b32 v96, 0
    v_mov_b32 v97, 0
    v_mov_b32 v98, 0
    v_mov_b32 v99, 0
    v_mov_b32 v100, 0
    v_mov_b32 v101, 0
    v_mov_b32 v102, 0
    v_mov_b32 v103, 0
    v_mov_b32 v104, 0
    v_mov_b32 v105, 0
    v_mov_b32 v106, 0
    v_mov_b32 v107, 0
    v_mov_b32 v108, 0
    v_mov_b32 v109, 0
    v_mov_b32 v110, 0
    v_mov_b32 v111, 0
    v_mov_b32 v112, 0
    v_mov_b32 v113, 0
    v_mov_b32 v114, 0
    v_mov_b32 v115, 0
    v_mov_b32 v116, 0
    v_mov_b32 v117, 0
    v_mov_b32 v118, 0
    v_mov_b32 v119, 0
    v_mov_b32 v120, 0
    v_mov_b32 v121, 0
    v_mov_b32 v122, 0
    v_mov_b32 v123, 0
    v_mov_b32 v124, 0
    v_mov_b32 v125, 0
    v_mov_b32 v126, 0
    v_mov_b32 v127, 0
    s_mov_b32 s25, 8
ss_cv0:
    ds_read2_b32 v[68:69], v64 offset0:0 offset1:1
    ds_read2_b32 v[70:71], v64 offset0:2 offset1:3
    ds_read_b128 v[128:131], v65 offset:0
    ds_read_b128 v[132:135], v65 offset:512
    ds_read_b128 v[136:139], v65 offset:1024
    ds_read_b128 v[140:143], v65 offset:1536
    ds_read_b128 v[144:147], v65 offset:2048
    ds_read_b128 v[148:151], v65 offset:2560
    ds_read_b128 v[152:155], v65 offset:3072
    ds_read_b128 v[156:159], v65 offset:3584
    v_subrev_u32 v64, 64, v64
    v_subrev_u32 v65, 64, v65
    s_waitcnt lgkmcnt(7)
    v_mfma_f32_16x16x32_bf16 v[96:99], v[68:71], v[128:131], v[96:99]
    s_waitcnt lgkmcnt(6)
    v_mfma_f32_16x16x32_bf16 v[100:103], v[68:71], v[132:135], v[100:103]
    s_waitcnt lgkmcnt(5)
    v_mfma_f32_16x16x32_bf16 v[104:107], v[68:71], v[136:139], v[104:107]
    s_waitcnt lgkmcnt(4)
    v_mfma_f32_16x16x32_bf16 v[108:111], v[68:71], v[140:143], v[108:111]
    s_waitcnt lgkmcnt(3)
    v_mfma_f32_16x16x32_bf16 v[112:115], v[68:71], v[144:147], v[112:115]
    s_waitcnt lgkmcnt(2)
    v_mfma_f32_16x16x32_bf16 v[116:119], v[68:71], v[148:151], v[116:119]
    s_waitcnt lgkmcnt(1)
    v_mfma_f32_16x16x32_bf16 v[120:123], v[68:71], v[152:155], v[120:123]
    s_waitcnt lgkmcnt(0)
    v_mfma_f32_16x16x32_bf16 v[124:127], v[68:71], v[156:159], v[124:127]
    s_sub_u32 s25, s25, 1
    s_cmp_lg_u32 s25, 0
    s_cbranch_scc1 ss_cv0
    v_add_u32 v65, 512, v65
    s_mov_b32 s25, 8
ss_cv1:
    ds_read2_b32 v[68:69], v64 offset0:0 offset1:1
    ds_read2_b32 v[70:71], v64 offset0:2 offset1:3
    ds_read_b128 v[132:135], v65 offset:0
    ds_read_b128 v[136:139], v65 offset:512
    ds_read_b128 v[140:143], v65 offset:1024
    ds_read_b128 v[144:147], v65 offset:1536
    ds_read_b128 v[148:151], v65 offset:2048
    ds_read_b128 v[152:155], v65 offset:2560
    ds_read_b128 v[156:159], v65 offset:3072
    v_subrev_u32 v64, 64, v64
    v_subrev_u32 v65, 64, v65
    s_waitcnt lgkmcnt(6)
    v_mfma_f32_16x16x32_bf16 v[100:103], v[68:71], v[132:135], v[100:103]
    s_waitcnt lgkmcnt(5)
    v_mfma_f32_16x16x32_bf16 v[104:107], v[68:71], v[136:139], v[104:107]
    s_waitcnt lgkmcnt(4)
    v_mfma_f32_16x16x32_bf16 v[108:111], v[68:71], v[140:143], v[108:111]
    s_waitcnt lgkmcnt(3)
    v_mfma_f32_16x16x32_bf16 v[112:115], v[68:71], v[144:147], v[112:115]
    s_waitcnt lgkmcnt(2)
    v_mfma_f32_16x16x32_bf16 v[116:119], v[68:71], v[148:151], v[116:119]
    s_waitcnt lgkmcnt(1)
    v_mfma_f32_16x16x32_bf16 v[120:123], v[68:71], v[152:155], v[120:123]
    s_waitcnt lgkmcnt(0)
    v_mfma_f32_16x16x32_bf16 v[124:127], v[68:71], v[156:159], v[124:127]
    s_sub_u32 s25, s25, 1
    s_cmp_lg_u32 s25, 0
    s_cbranch_scc1 ss_cv1
    v_add_u32 v65, 512, v65
    s_mov_b32 s25, 8
ss_cv2:
    ds_read2_b32 v[68:69], v64 offset0:0 offset1:1
    ds_read2_b32 v[70:71], v64 offset0:2 offset1:3
    ds_read_b128 v[136:139], v65 offset:0
    ds_read_b128 v[140:143], v65 offset:512
    ds_read_b128 v[144:147], v65 offset:1024
    ds_read_b128 v[148:151], v65 offset:1536
    ds_read_b128 v[152:155], v65 offset:2048
    ds_read_b128 v[156:159], v65 offset:2560
    v_subrev_u32 v64, 64, v64
    v_subrev_u32 v65, 64, v65
    s_waitcnt lgkmcnt(5)
    v_mfma_f32_16x16x32_bf16 v[104:107], v[68:71], v[136:139], v[104:107]
    s_waitcnt lgkmcnt(4)
    v_mfma_f32_16x16x32_bf16 v[108:111], v[68:71], v[140:143], v[108:111]
    s_waitcnt lgkmcnt(3)
    v_mfma_f32_16x16x32_bf16 v[112:115], v[68:71], v[144:147], v[112:115]
    s_waitcnt lgkmcnt(2)
    v_mfma_f32_16x16x32_bf16 v[116:119], v[68:71], v[148:151], v[116:119]
    s_waitcnt lgkmcnt(1)
    v_mfma_f32_16x16x32_bf16 v[120:123], v[68:71], v[152:155], v[120:123]
    s_waitcnt lgkmcnt(0)
    v_mfma_f32_16x16x32_bf16 v[124:127], v[68:71], v[156:159], v[124:127]
    s_sub_u32 s25, s25, 1
    s_cmp_lg_u32 s25, 0
    s_cbranch_scc1 ss_cv2
    v_add_u32 v65, 512, v65
    s_mov_b32 s25, 8
ss_cv3:
    ds_read2_b32 v[68:69], v64 offset0:0 offset1:1
    ds_read2_b32 v[70:71], v64 offset0:2 offset1:3
    ds_read_b128 v[140:143], v65 offset:0
    ds_read_b128 v[144:147], v65 offset:512
    ds_read_b128 v[148:151], v65 offset:1024
    ds_read_b128 v[152:155], v65 offset:1536
    ds_read_b128 v[156:159], v65 offset:2048
    v_subrev_u32 v64, 64, v64
    v_subrev_u32 v65, 64, v65
    s_waitcnt lgkmcnt(4)
    v_mfma_f32_16x16x32_bf16 v[108:111], v[68:71], v[140:143], v[108:111]
    s_waitcnt lgkmcnt(3)
    v_mfma_f32_16x16x32_bf16 v[112:115], v[68:71], v[144:147], v[112:115]
    s_waitcnt lgkmcnt(2)
    v_mfma_f32_16x16x32_bf16 v[116:119], v[68:71], v[148:151], v[116:119]
    s_waitcnt lgkmcnt(1)
    v_mfma_f32_16x16x32_bf16 v[120:123], v[68:71], v[152:155], v[120:123]
    s_waitcnt lgkmcnt(0)
    v_mfma_f32_16x16x32_bf16 v[124:127], v[68:71], v[156:159], v[124:127]
    s_sub_u32 s25, s25, 1
    s_cmp_lg_u32 s25, 0
    s_cbranch_scc1 ss_cv3
    v_add_u32 v65, 512, v65
    s_mov_b32 s25, 8
ss_cv4:
    ds_read2_b32 v[68:69], v64 offset0:0 offset1:1
    ds_read2_b32 v[70:71], v64 offset0:2 offset1:3
    ds_read_b128 v[144:147], v65 offset:0
    ds_read_b128 v[148:151], v65 offset:512
    ds_read_b128 v[152:155], v65 offset:1024
    ds_read_b128 v[156:159], v65 offset:1536
    v_subrev_u32 v64, 64, v64
    v_subrev_u32 v65, 64, v65
    s_waitcnt lgkmcnt(3)
    v_mfma_f32_16x16x32_bf16 v[112:115], v[68:71], v[144:147], v[112:115]
    s_waitcnt lgkmcnt(2)
    v_mfma_f32_16x16x32_bf16 v[116:119], v[68:71], v[148:151], v[116:119]
    s_waitcnt lgkmcnt(1)
    v_mfma_f32_16x16x32_bf16 v[120:123], v[68:71], v[152:155], v[120:123]
    s_waitcnt lgkmcnt(0)
    v_mfma_f32_16x16x32_bf16 v[124:127], v[68:71], v[156:159], v[124:127]
    s_sub_u32 s25, s25, 1
    s_cmp_lg_u32 s25, 0
    s_cbranch_scc1 ss_cv4
    v_add_u32 v65, 512, v65
    s_mov_b32 s25, 8
ss_cv5:
    ds_read2_b32 v[68:69], v64 offset0:0 offset1:1
    ds_read2_b32 v[70:71], v64 offset0:2 offset1:3
    ds_read_b128 v[148:151], v65 offset:0
    ds_read_b128 v[152:155], v65 offset:512
    ds_read_b128 v[156:159], v65 offset:1024
    v_subrev_u32 v64, 64, v64
    v_subrev_u32 v65, 64, v65
    s_waitcnt lgkmcnt(2)
    v_mfma_f32_16x16x32_bf16 v[116:119], v[68:71], v[148:151], v[116:119]
    s_waitcnt lgkmcnt(1)
    v_mfma_f32_16x16x32_bf16 v[120:123], v[68:71], v[152:155], v[120:123]
    s_waitcnt lgkmcnt(0)
    v_mfma_f32_16x16x32_bf16 v[124:127], v[68:71], v[156:159], v[124:127]
    s_sub_u32 s25, s25, 1
    s_cmp_lg_u32 s25, 0
    s_cbranch_scc1 ss_cv5
    v_add_u32 v65, 512, v65
    s_mov_b32 s25, 8
ss_cv6:
    ds_read2_b32 v[68:69], v64 offset0:0 offset1:1
    ds_read2_b32 v[70:71], v64 offset0:2 offset1:3
    ds_read_b128 v[152:155], v65 offset:0
    ds_read_b128 v[156:159], v65 offset:512
    v_subrev_u32 v64, 64, v64
    v_subrev_u32 v65, 64, v65
    s_waitcnt lgkmcnt(1)
    v_mfma_f32_16x16x32_bf16 v[120:123], v[68:71], v[152:155], v[120:123]
    s_waitcnt lgkmcnt(0)
    v_mfma_f32_16x16x32_bf16 v[124:127], v[68:71], v[156:159], v[124:127]
    s_sub_u32 s25, s25, 1
    s_cmp_lg_u32 s25, 0
    s_cbranch_scc1 ss_cv6
    v_add_u32 v65, 512, v65
    s_mov_b32 s25, 8
ss_cv7:
    ds_read2_b32 v[68:69], v64 offset0:0 offset1:1
    ds_read2_b32 v[70:71], v64 offset0:2 offset1:3
    ds_read_b128 v[156:159], v65 offset:0
    v_subrev_u32 v64, 64, v64
    v_subrev_u32 v65, 64, v65
    s_waitcnt lgkmcnt(0)
    v_mfma_f32_16x16x32_bf16 v[124:127], v[68:71], v[156:159], v[124:127]
    s_sub_u32 s25, s25, 1
    s_cmp_lg_u32 s25, 0
    s_cbranch_scc1 ss_cv7
    v_add_u32 v65, 512, v65
    s_nop 3
    v_lshlrev_b32 v5, 6, v2
    v_lshl_add_u32 v5, v3, 4, v5
    v_add_u32 v5, v5, v4
    ds_write_b128 v5, v[96:99] offset:7424
    ds_write_b128 v5, v[100:103] offset:8448
    ds_write_b128 v5, v[104:107] offset:9472
    ds_write_b128 v5, v[108:111] offset:10496
    ds_write_b128 v5, v[112:115] offset:11520
    ds_write_b128 v5, v[116:119] offset:12544
    ds_write_b128 v5, v[120:123] offset:13568
    ds_write_b128 v5, v[124:127] offset:14592
    s_mov_b32 s12, s74
    s_mov_b32 s13, s75
    s_mov_b32 s14, 1152
    s_mov_b32 s15, 0x20000
    s_lshl_b32 s23, s20, 1
    buffer_load_dwordx2 v[24:25], off, s[12:15], s23
    s_waitcnt vmcnt(0) lgkmcnt(0)
    s_barrier
    v_lshlrev_b32 v26, 16, v24
    v_and_b32 v27, 0xffff0000, v24
    v_lshlrev_b32 v28, 16, v25
    v_and_b32 v29, 0xffff0000, v25
    v_lshlrev_b32 v5, 5, v0
    ds_read_b128 v[64:67], v5 offset:7424
    ds_read_b128 v[68:71], v5 offset:7440
    ds_read_b128 v[72:75], v5 offset:23808
    ds_read_b128 v[76:79], v5 offset:23824
    ds_read_b128 v[80:83], v5 offset:40192
    ds_read_b128 v[84:87], v5 offset:40208
    ds_read_b128 v[88:91], v5 offset:56576
    ds_read_b128 v[92:95], v5 offset:56592
    s_waitcnt lgkmcnt(0)
    v_mul_u32_u24 v5, 18432, v0
    s_lshl_b32 s22, s20, 1
    s_add_u32 s22, s22, 1152
    v_lshlrev_b32 v6, 16, v8
    v_fmac_f32 v64, v6, v26
    v_and_b32 v6, 0xffff0000, v8
    v_fmac_f32 v72, v6, v27
    v_lshlrev_b32 v6, 16, v9
    v_fmac_f32 v80, v6, v28
    v_and_b32 v6, 0xffff0000, v9
    v_fmac_f32 v88, v6, v29
    v_cvt_pk_bf16_f32 v8, v64, v72
    v_cvt_pk_bf16_f32 v9, v80, v88
    s_add_u32 s23, s22, 0
    buffer_store_dwordx2 v[8:9], v5, s[16:19], s23 offen
    v_lshlrev_b32 v6, 16, v10
    v_fmac_f32 v65, v6, v26
    v_and_b32 v6, 0xffff0000, v10
    v_fmac_f32 v73, v6, v27
    v_lshlrev_b32 v6, 16, v11
    v_fmac_f32 v81, v6, v28
    v_and_b32 v6, 0xffff0000, v11
    v_fmac_f32 v89, v6, v29
    v_cvt_pk_bf16_f32 v10, v65, v73
    v_cvt_pk_bf16_f32 v11, v81, v89
    s_add_u32 s23, s22, 2304
    buffer_store_dwordx2 v[10:11], v5, s[16:19], s23 offen
    v_lshlrev_b32 v6, 16, v12
    v_fmac_f32 v66, v6, v26
    v_and_b32 v6, 0xffff0000, v12
    v_fmac_f32 v74, v6, v27
    v_lshlrev_b32 v6, 16, v13
    v_fmac_f32 v82, v6, v28
    v_and_b32 v6, 0xffff0000, v13
    v_fmac_f32 v90, v6, v29
    v_cvt_pk_bf16_f32 v12, v66, v74
    v_cvt_pk_bf16_f32 v13, v82, v90
    s_add_u32 s23, s22, 4608
    buffer_store_dwordx2 v[12:13], v5, s[16:19], s23 offen
    v_lshlrev_b32 v6, 16, v14
    v_fmac_f32 v67, v6, v26
    v_and_b32 v6, 0xffff0000, v14
    v_fmac_f32 v75, v6, v27
    v_lshlrev_b32 v6, 16, v15
    v_fmac_f32 v83, v6, v28
    v_and_b32 v6, 0xffff0000, v15
    v_fmac_f32 v91, v6, v29
    v_cvt_pk_bf16_f32 v14, v67, v75
    v_cvt_pk_bf16_f32 v15, v83, v91
    s_add_u32 s23, s22, 6912
    buffer_store_dwordx2 v[14:15], v5, s[16:19], s23 offen
    v_lshlrev_b32 v6, 16, v16
    v_fmac_f32 v68, v6, v26
    v_and_b32 v6, 0xffff0000, v16
    v_fmac_f32 v76, v6, v27
    v_lshlrev_b32 v6, 16, v17
    v_fmac_f32 v84, v6, v28
    v_and_b32 v6, 0xffff0000, v17
    v_fmac_f32 v92, v6, v29
    v_cvt_pk_bf16_f32 v16, v68, v76
    v_cvt_pk_bf16_f32 v17, v84, v92
    s_add_u32 s23, s22, 9216
    buffer_store_dwordx2 v[16:17], v5, s[16:19], s23 offen
    v_lshlrev_b32 v6, 16, v18
    v_fmac_f32 v69, v6, v26
    v_and_b32 v6, 0xffff0000, v18
    v_fmac_f32 v77, v6, v27
    v_lshlrev_b32 v6, 16, v19
    v_fmac_f32 v85, v6, v28
    v_and_b32 v6, 0xffff0000, v19
    v_fmac_f32 v93, v6, v29
    v_cvt_pk_bf16_f32 v18, v69, v77
    v_cvt_pk_bf16_f32 v19, v85, v93
    s_add_u32 s23, s22, 11520
    buffer_store_dwordx2 v[18:19], v5, s[16:19], s23 offen
    v_lshlrev_b32 v6, 16, v20
    v_fmac_f32 v70, v6, v26
    v_and_b32 v6, 0xffff0000, v20
    v_fmac_f32 v78, v6, v27
    v_lshlrev_b32 v6, 16, v21
    v_fmac_f32 v86, v6, v28
    v_and_b32 v6, 0xffff0000, v21
    v_fmac_f32 v94, v6, v29
    v_cvt_pk_bf16_f32 v20, v70, v78
    v_cvt_pk_bf16_f32 v21, v86, v94
    s_add_u32 s23, s22, 13824
    buffer_store_dwordx2 v[20:21], v5, s[16:19], s23 offen
    v_lshlrev_b32 v6, 16, v22
    v_fmac_f32 v71, v6, v26
    v_and_b32 v6, 0xffff0000, v22
    v_fmac_f32 v79, v6, v27
    v_lshlrev_b32 v6, 16, v23
    v_fmac_f32 v87, v6, v28
    v_and_b32 v6, 0xffff0000, v23
    v_fmac_f32 v95, v6, v29
    v_cvt_pk_bf16_f32 v22, v71, v79
    v_cvt_pk_bf16_f32 v23, v87, v95
    s_add_u32 s23, s22, 16128
    buffer_store_dwordx2 v[22:23], v5, s[16:19], s23 offen
    s_branch L_ssm_next
L_phase2:
    s_mov_b32 s40, 524288
mc2_w:
    buffer_load_dword v250, off, s[96:99], 0 offset:28 sc1
    s_waitcnt vmcnt(0)
    v_readfirstlane_b32 s41, v250
    s_nop 0
    s_cmp_lg_u32 s41, 0
    s_cbranch_scc1 mc2_known
    s_sub_u32 s40, s40, 1
    s_cbranch_scc1 mc2_force
    s_sleep 2
    s_branch mc2_w
mc2_force:
    v_mov_b32 v250, 2
    v_mov_b32 v251, 0
    s_mov_b64 exec, 1
    buffer_atomic_cmpswap v[250:251], off, s[96:99], 0 offset:28
    s_mov_b64 exec, -1
    s_waitcnt vmcnt(0)
    s_mov_b32 s40, 524288
    s_branch mc2_w
mc2_known:
    s_cmp_eq_u32 s41, 1
    s_cbranch_scc1 L_phase2b
    s_mov_b32 s37, 208
    v_mov_b32 v250, 1
    v_mov_b32 v251, 163832
    v_cmp_eq_u32 vcc, 0, v0
    s_nop 0
    s_and_saveexec_b64 s[38:39], vcc
    s_cbranch_execz tk5
    buffer_atomic_add v250, off, s[96:99], s37 sc0
    s_waitcnt vmcnt(0)
    ds_write_b32 v251, v250
    s_waitcnt lgkmcnt(0)
tk5:
    s_mov_b64 exec, -1
    s_barrier
    ds_read_b32 v252, v251
    s_waitcnt lgkmcnt(0)
    v_readfirstlane_b32 s12, v252
    s_barrier
    s_nop 3
    s_cmp_lt_u32 s12, 32
    s_cbranch_scc1 L_chain_safe
L_phase2b:
    s_mov_b32 s8, s76
    s_mov_b32 s9, s77
    s_mov_b32 s10, 4718592
    s_mov_b32 s11, 0x20000
    s_mov_b32 s37, 12
    v_mov_b32 v250, 1
    v_mov_b32 v251, 163832
    v_cmp_eq_u32 vcc, 0, v0
    s_nop 0
    s_and_saveexec_b64 s[38:39], vcc
    s_cbranch_execz tk6
    buffer_atomic_add v250, off, s[96:99], s37 sc0
    s_waitcnt vmcnt(0)
    ds_write_b32 v251, v250
    s_waitcnt lgkmcnt(0)
tk6:
    s_mov_b64 exec, -1
    s_barrier
    ds_read_b32 v252, v251
    s_waitcnt lgkmcnt(0)
    v_readfirstlane_b32 s36, v252
    s_barrier
    s_nop 3
    s_mul_hi_u32 s37, s36, 0x55555556
    s_mul_i32 s40, s37, 3
    s_sub_u32 s33, s36, s37
    s_mul_hi_u32 s41, s33, 0x0e38e38f
    s_mul_i32 s41, s41, 18
    s_sub_u32 s33, s33, s41
    s_cmp_lg_u32 s40, s36
    s_cbranch_scc1 L_op_start
L_att_next:
    s_mov_b32 s37, 16
    v_mov_b32 v250, 1
    v_mov_b32 v251, 163832
    v_cmp_eq_u32 vcc, 0, v0
    s_nop 0
    s_and_saveexec_b64 s[38:39], vcc
    s_cbranch_execz tk7
    buffer_atomic_add v250, off, s[96:99], s37 sc0
    s_waitcnt vmcnt(0)
    ds_write_b32 v251, v250
    s_waitcnt lgkmcnt(0)
tk7:
    s_mov_b64 exec, -1
    s_barrier
    ds_read_b32 v252, v251
    s_waitcnt lgkmcnt(0)
    v_readfirstlane_b32 s34, v252
    s_barrier
    s_nop 3
    s_cmp_ge_u32 s34, 512
    s_cbranch_scc1 L_op_start
    s_lshr_b32 s16, s34, 3
    s_and_b32 s17, s34, 7
    s_lshl_b32 s17, s17, 2
    s_add_u32 s17, s17, s32
    s_lshr_b32 s36, s17, 1
    s_lshl_b32 s36, s36, 8
    s_add_u32 s36, s36, 125829120
    s_mul_i32 s37, s16, 43
    s_lshr_b32 s37, s37, 8
    s_mul_i32 s41, s37, 6
    s_sub_u32 s41, s16, s41
    v_and_b32 v1, 63, v0
    v_mul_u32_u24 v2, 6, v1
    v_add_u32 v2, s41, v2
    v_mov_b32 v4, s37
    s_and_b32 s41, s16, 7
    s_add_u32 s41, s41, 12
    s_lshr_b32 s37, s16, 3
    v_mov_b32 v5, s41
    v_mov_b32 v6, s37
    v_cmp_lt_u32 vcc, 1, v1
    s_nop 1
    v_cndmask_b32 v2, v2, v5, vcc
    v_cndmask_b32 v4, v4, v6, vcc
    v_lshlrev_b32 v2, 2, v2
    v_add3_u32 v4, v4, s95, 1
    s_mov_b32 s40, 4194304
L_aw1:
    buffer_load_dword v3, v2, s[4:7], s36 offen sc1
    s_sub_u32 s40, s40, 1
    s_cbranch_scc1 L_aw1_go
    s_waitcnt vmcnt(0)
    v_subrev_u32 v3, v4, v3
    v_cmp_lt_u32 vcc, 64, v3
    s_cbranch_vccz L_aw1_go
    s_sleep 4
    s_branch L_aw1
L_aw1_go:
    v_and_b32 v5, 63, v0
    v_lshlrev_b32 v1, 4, v5
    v_or_b32 v3, 128, v1
    v_lshrrev_b32 v4, 4, v5
    v_bfe_u32 v6, v5, 2, 2
    v_sub_u32 v4, v6, v4
    v_lshlrev_b32 v4, 3, v4
    v_and_b32 v6, 3, v5
    v_add_u32 v4, v4, v6
    v_mov_b32 v6, 0xf149f2ca
    s_mov_b32 s22, 0x3e0293ee
    s_lshl_b32 s18, s16, 5
    s_add_u32 s18, s18, s17
    s_lshl_b32 s19, s18, 13
    s_add_u32 s20, s19, 33554432
    buffer_load_dwordx4 v[8:11], v1, s[4:7], s20 offen offset:0 sc1
    s_add_u32 s20, s19, 33554432
    buffer_load_dwordx4 v[12:15], v1, s[4:7], s20 offen offset:1024 sc1
    s_add_u32 s20, s19, 33554432
    buffer_load_dwordx4 v[16:19], v1, s[4:7], s20 offen offset:2048 sc1
    s_add_u32 s20, s19, 33554432
    buffer_load_dwordx4 v[20:23], v1, s[4:7], s20 offen offset:3072 sc1
    s_add_u32 s20, s19, 33558528
    buffer_load_dwordx4 v[24:27], v1, s[4:7], s20 offen offset:0 sc1
    s_add_u32 s20, s19, 33558528
    buffer_load_dwordx4 v[28:31], v1, s[4:7], s20 offen offset:1024 sc1
    s_add_u32 s20, s19, 33558528
    buffer_load_dwordx4 v[32:35], v1, s[4:7], s20 offen offset:2048 sc1
    s_add_u32 s20, s19, 33558528
    buffer_load_dwordx4 v[36:39], v1, s[4:7], s20 offen offset:3072 sc1
    s_lshl_b32 s21, s18, 14
    s_add_u32 s20, s21, 0
    buffer_load_dwordx4 v[40:43], v1, s[4:7], s20 offen offset:0 sc1
    s_add_u32 s20, s21, 4096
    buffer_load_dwordx4 v[44:47], v1, s[4:7], s20 offen offset:0 sc1
    s_add_u32 s20, s21, 8192
    buffer_load_dwordx4 v[48:51], v1, s[4:7], s20 offen offset:0 sc1
    s_add_u32 s20, s21, 12288
    buffer_load_dwordx4 v[52:55], v1, s[4:7], s20 offen offset:0 sc1
    s_add_u32 s20, s21, 0
    buffer_load_dwordx4 v[56:59], v1, s[4:7], s20 offen offset:1024 sc1
    s_add_u32 s20, s21, 4096
    buffer_load_dwordx4 v[60:63], v1, s[4:7], s20 offen offset:1024 sc1
    s_add_u32 s20, s21, 8192
    buffer_load_dwordx4 v[64:67], v1, s[4:7], s20 offen offset:1024 sc1
    s_add_u32 s20, s21, 12288
    buffer_load_dwordx4 v[68:71], v1, s[4:7], s20 offen offset:1024 sc1
    s_add_u32 s20, s21, 0
    buffer_load_dwordx4 v[88:91], v1, s[4:7], s20 offen offset:2048 sc1
    s_add_u32 s20, s21, 4096
    buffer_load_dwordx4 v[92:95], v1, s[4:7], s20 offen offset:2048 sc1
    s_add_u32 s20, s21, 8192
    buffer_load_dwordx4 v[96:99], v1, s[4:7], s20 offen offset:2048 sc1
    s_add_u32 s20, s21, 12288
    buffer_load_dwordx4 v[100:103], v1, s[4:7], s20 offen offset:2048 sc1
    s_add_u32 s20, s21, 0
    buffer_load_dwordx4 v[104:107], v1, s[4:7], s20 offen offset:3072 sc1
    s_add_u32 s20, s21, 4096
    buffer_load_dwordx4 v[108:111], v1, s[4:7], s20 offen offset:3072 sc1
    s_add_u32 s20, s21, 8192
    buffer_load_dwordx4 v[112:115], v1, s[4:7], s20 offen offset:3072 sc1
    s_add_u32 s20, s21, 12288
    buffer_load_dwordx4 v[116:119], v1, s[4:7], s20 offen offset:3072 sc1
    v_mov_b32 v172, 0x3f803f80
    v_mov_b32 v173, 0x3f803f80
    v_mov_b32 v174, 0x3f803f80
    v_mov_b32 v175, 0x3f803f80
    v_mov_b32 v176, 0x3f003f00
    v_mov_b32 v177, 0x3f003f00
    s_waitcnt vmcnt(8)
    v_mfma_f32_16x16x32_bf16 v[136:139], v[40:43], v[8:11], 0
    v_mfma_f32_16x16x32_bf16 v[140:143], v[56:59], v[8:11], 0
    v_mfma_f32_16x16x32_bf16 v[148:151], v[40:43], v[24:27], 0
    v_mfma_f32_16x16x32_bf16 v[152:155], v[56:59], v[24:27], 0
    v_mfma_f32_16x16x32_bf16 v[136:139], v[44:47], v[12:15], v[136:139]
    v_mfma_f32_16x16x32_bf16 v[140:143], v[60:63], v[12:15], v[140:143]
    v_mfma_f32_16x16x32_bf16 v[148:151], v[44:47], v[28:31], v[148:151]
    v_mfma_f32_16x16x32_bf16 v[152:155], v[60:63], v[28:31], v[152:155]
    v_mfma_f32_16x16x32_bf16 v[136:139], v[48:51], v[16:19], v[136:139]
    v_mfma_f32_16x16x32_bf16 v[140:143], v[64:67], v[16:19], v[140:143]
    v_mfma_f32_16x16x32_bf16 v[148:151], v[48:51], v[32:35], v[148:151]
    v_mfma_f32_16x16x32_bf16 v[152:155], v[64:67], v[32:35], v[152:155]
    v_mfma_f32_16x16x32_bf16 v[136:139], v[52:55], v[20:23], v[136:139]
    v_mfma_f32_16x16x32_bf16 v[140:143], v[68:71], v[20:23], v[140:143]
    v_mfma_f32_16x16x32_bf16 v[148:151], v[52:55], v[36:39], v[148:151]
    v_mfma_f32_16x16x32_bf16 v[152:155], v[68:71], v[36:39], v[152:155]
    v_cmp_le_i32 vcc, 0, v4
    s_nop 1
    v_cndmask_b32 v136, v6, v136, vcc
    v_cmp_le_i32 vcc, 1, v4
    s_nop 1
    v_cndmask_b32 v137, v6, v137, vcc
    v_cmp_le_i32 vcc, 2, v4
    s_nop 1
    v_cndmask_b32 v138, v6, v138, vcc
    v_cmp_le_i32 vcc, 3, v4
    s_nop 1
    v_cndmask_b32 v139, v6, v139, vcc
    v_cmp_le_i32 vcc, 4, v4
    s_nop 1
    v_cndmask_b32 v140, v6, v140, vcc
    v_cmp_le_i32 vcc, 5, v4
    s_nop 1
    v_cndmask_b32 v141, v6, v141, vcc
    v_cmp_le_i32 vcc, 6, v4
    s_nop 1
    v_cndmask_b32 v142, v6, v142, vcc
    v_cmp_le_i32 vcc, 7, v4
    s_nop 1
    v_cndmask_b32 v143, v6, v143, vcc
    v_cmp_le_i32 vcc, -4, v4
    s_nop 1
    v_cndmask_b32 v148, v6, v148, vcc
    v_cmp_le_i32 vcc, -3, v4
    s_nop 1
    v_cndmask_b32 v149, v6, v149, vcc
    v_cmp_le_i32 vcc, -2, v4
    s_nop 1
    v_cndmask_b32 v150, v6, v150, vcc
    v_cmp_le_i32 vcc, -1, v4
    s_nop 1
    v_cndmask_b32 v151, v6, v151, vcc
    v_cmp_le_i32 vcc, 0, v4
    s_nop 1
    v_cndmask_b32 v152, v6, v152, vcc
    v_cmp_le_i32 vcc, 1, v4
    s_nop 1
    v_cndmask_b32 v153, v6, v153, vcc
    v_cmp_le_i32 vcc, 2, v4
    s_nop 1
    v_cndmask_b32 v154, v6, v154, vcc
    v_cmp_le_i32 vcc, 3, v4
    s_nop 1
    v_cndmask_b32 v155, v6, v155, vcc
    s_nop 1
    s_mov_b32 s88, 65536
cw8:
    buffer_load_dword v199, off, s[4:7], s36 offset:128 sc1
    s_waitcnt vmcnt(0)
    v_readfirstlane_b32 s42, v199
    s_nop 0
    s_sub_u32 s42, s42, s95
    s_cmp_gt_u32 s42, 64
    s_cselect_b32 s42, 0, s42
    s_add_u32 s42, s42, 2
    s_cmp_ge_u32 s42, s16
    s_cbranch_scc1 cw8x
    s_sub_u32 s88, s88, 1
    s_cbranch_scc1 cw8x
    s_sub_u32 s42, s16, s42
    s_min_u32 s42, s42, 6
cw8s:
    s_sleep 24
    s_sub_u32 s42, s42, 1
    s_cmp_lg_u32 s42, 0
    s_cbranch_scc1 cw8s
    s_branch cw8
cw8x:
    s_and_b32 s37, s16, 1
    s_lshl_b32 s37, s37, 2
    s_add_u32 s37, s37, s36
    s_add_u32 s37, s37, 128
    s_add_u32 s41, s16, s95
    s_add_u32 s41, s41, 1
    s_lshl_b32 s42, s17, 7
    s_add_u32 s42, s42, 125845504
    s_cmp_eq_u32 s16, 63
    s_cselect_b32 s37, s42, s37
    s_cselect_b32 s41, s95, s41
    s_cselect_b32 s42, 12, 8
    v_lshlrev_b32 v198, 2, v0
    v_and_b32 v198, s42, v198
    s_mov_b32 s40, 4194304
L_aw2:
    buffer_load_dword v199, v198, s[4:7], s37 offen sc1
    s_sub_u32 s40, s40, 1
    s_cbranch_scc1 L_aw2_go
    s_waitcnt vmcnt(0)
    v_subrev_u32 v199, s41, v199
    v_cmp_lt_u32 vcc, 64, v199
    s_cbranch_vccz L_aw2_go
    s_sleep 4
    s_branch L_aw2
L_aw2_go:
    s_lshl_b32 s20, s18, 12
    s_add_u32 s20, s20, 71303168
    buffer_load_dwordx4 v[72:75], v3, s[4:7], s20 offen offset:0 sc1
    buffer_load_dwordx4 v[76:79], v3, s[4:7], s20 offen offset:1024 sc1
    buffer_load_dwordx4 v[80:83], v3, s[4:7], s20 offen offset:2048 sc1
    buffer_load_dwordx4 v[84:87], v3, s[4:7], s20 offen offset:3072 sc1
    s_lshl_b32 s20, s18, 12
    s_add_u32 s20, s20, 80740352
    buffer_load_dwordx4 v[120:123], v1, s[4:7], s20 offen offset:0 sc1
    buffer_load_dwordx4 v[124:127], v1, s[4:7], s20 offen offset:1024 sc1
    buffer_load_dwordx4 v[128:131], v1, s[4:7], s20 offen offset:2048 sc1
    buffer_load_dwordx4 v[132:135], v1, s[4:7], s20 offen offset:3072 sc1
    s_waitcnt vmcnt(4)
    v_mfma_f32_16x16x32_bf16 v[144:147], v[72:75], v[8:11], 0
    v_mfma_f32_16x16x32_bf16 v[156:159], v[72:75], v[24:27], 0
    v_mfma_f32_16x16x32_bf16 v[144:147], v[76:79], v[12:15], v[144:147]
    v_mfma_f32_16x16x32_bf16 v[156:159], v[76:79], v[28:31], v[156:159]
    v_mfma_f32_16x16x32_bf16 v[144:147], v[80:83], v[16:19], v[144:147]
    v_mfma_f32_16x16x32_bf16 v[156:159], v[80:83], v[32:35], v[156:159]
    v_mfma_f32_16x16x32_bf16 v[144:147], v[84:87], v[20:23], v[144:147]
    v_mfma_f32_16x16x32_bf16 v[156:159], v[84:87], v[36:39], v[156:159]
    v_max3_f32 v196, v136, v137, v138
    v_max3_f32 v197, v139, v140, v141
    v_max3_f32 v196, v196, v142, v143
    s_nop 0
    v_max3_f32 v197, v197, v144, v145
    v_max3_f32 v196, v196, v146, v147
    v_max_f32 v196, v196, v197
    v_mov_b32 v197, v196
    s_nop 1
    v_permlane32_swap_b32 v196, v197
    v_max_f32 v196, v196, v197
    v_mov_b32 v197, v196
    s_nop 1
    v_permlane16_swap_b32 v196, v197
    v_max_f32 v196, v196, v197
    v_mul_f32 v196, s22, v196
    v_sub_f32 v196, 0, v196
    v_fma_f32 v136, v136, s22, v196
    v_fma_f32 v137, v137, s22, v196
    v_fma_f32 v138, v138, s22, v196
    v_fma_f32 v139, v139, s22, v196
    v_fma_f32 v140, v140, s22, v196
    v_fma_f32 v141, v141, s22, v196
    v_fma_f32 v142, v142, s22, v196
    v_fma_f32 v143, v143, s22, v196
    v_fma_f32 v144, v144, s22, v196
    v_fma_f32 v145, v145, s22, v196
    v_fma_f32 v146, v146, s22, v196
    v_fma_f32 v147, v147, s22, v196
    v_exp_f32 v136, v136
    v_exp_f32 v137, v137
    v_exp_f32 v138, v138
    v_exp_f32 v139, v139
    v_exp_f32 v140, v140
    v_exp_f32 v141, v141
    v_exp_f32 v142, v142
    v_exp_f32 v143, v143
    v_exp_f32 v144, v144
    v_exp_f32 v145, v145
    v_exp_f32 v146, v146
    v_exp_f32 v147, v147
    v_cvt_pk_bf16_f32 v160, v136, v137
    v_cvt_pk_bf16_f32 v161, v138, v139
    v_cvt_pk_bf16_f32 v162, v140, v141
    v_cvt_pk_bf16_f32 v163, v142, v143
    v_cvt_pk_bf16_f32 v164, v144, v145
    v_cvt_pk_bf16_f32 v165, v146, v147
    v_max3_f32 v196, v148, v149, v150
    v_max3_f32 v197, v151, v152, v153
    v_max3_f32 v196, v196, v154, v155
    v_max3_f32 v197, v197, v156, v157
    v_max3_f32 v196, v196, v158, v159
    v_max_f32 v196, v196, v197
    v_mov_b32 v197, v196
    s_nop 1
    v_permlane32_swap_b32 v196, v197
    v_max_f32 v196, v196, v197
    v_mov_b32 v197, v196
    s_nop 1
    v_permlane16_swap_b32 v196, v197
    v_max_f32 v196, v196, v197
    v_mul_f32 v196, s22, v196
    v_sub_f32 v196, 0, v196
    v_fma_f32 v148, v148, s22, v196
    v_fma_f32 v149, v149, s22, v196
    v_fma_f32 v150, v150, s22, v196
    v_fma_f32 v151, v151, s22, v196
    v_fma_f32 v152, v152, s22, v196
    v_fma_f32 v153, v153, s22, v196
    v_fma_f32 v154, v154, s22, v196
    v_fma_f32 v155, v155, s22, v196
    v_fma_f32 v156, v156, s22, v196
    v_fma_f32 v157, v157, s22, v196
    v_fma_f32 v158, v158, s22, v196
    v_fma_f32 v159, v159, s22, v196
    v_exp_f32 v148, v148
    v_exp_f32 v149, v149
    v_exp_f32 v150, v150
    v_exp_f32 v151, v151
    v_exp_f32 v152, v152
    v_exp_f32 v153, v153
    v_exp_f32 v154, v154
    v_exp_f32 v155, v155
    v_exp_f32 v156, v156
    v_exp_f32 v157, v157
    v_exp_f32 v158, v158
    v_exp_f32 v159, v159
    v_cvt_pk_bf16_f32 v166, v148, v149
    v_cvt_pk_bf16_f32 v167, v150, v151
    v_cvt_pk_bf16_f32 v168, v152, v153
    v_cvt_pk_bf16_f32 v169, v154, v155
    v_cvt_pk_bf16_f32 v170, v156, v157
    v_cvt_pk_bf16_f32 v171, v158, v159
    v_mfma_f32_16x16x32_bf16 v[180:183], v[172:175], v[160:163], 0
    v_mfma_f32_16x16x32_bf16 v[184:187], v[172:175], v[166:169], 0
    v_mfma_f32_16x16x16_bf16 v[180:183], v[176:177], v[164:165], v[180:183]
    v_mfma_f32_16x16x16_bf16 v[184:187], v[176:177], v[170:171], v[184:187]
    s_nop 3
    v_rcp_f32 v180, v180
    s_nop 2
    v_rcp_f32 v184, v184
    s_waitcnt vmcnt(0)
    s_lshl_b32 s18, s16, 18
    s_lshl_b32 s19, s17, 12
    s_add_u32 s18, s18, s19
    s_add_u32 s18, s18, 50331648
    s_add_u32 s19, s18, 131072
    v_mfma_f32_16x16x32_bf16 v[8:11], v[88:91], v[160:163], 0
    v_mfma_f32_16x16x32_bf16 v[12:15], v[104:107], v[160:163], 0
    v_mfma_f32_16x16x32_bf16 v[16:19], v[88:91], v[166:169], 0
    v_mfma_f32_16x16x32_bf16 v[20:23], v[104:107], v[166:169], 0
    v_mfma_f32_16x16x32_bf16 v[24:27], v[92:95], v[160:163], 0
    v_mfma_f32_16x16x32_bf16 v[28:31], v[108:111], v[160:163], 0
    v_mfma_f32_16x16x32_bf16 v[32:35], v[92:95], v[166:169], 0
    v_mfma_f32_16x16x32_bf16 v[36:39], v[108:111], v[166:169], 0
    v_mfma_f32_16x16x32_bf16 v[40:43], v[96:99], v[160:163], 0
    v_mfma_f32_16x16x32_bf16 v[44:47], v[112:115], v[160:163], 0
    v_mfma_f32_16x16x32_bf16 v[48:51], v[96:99], v[166:169], 0
    v_mfma_f32_16x16x32_bf16 v[52:55], v[112:115], v[166:169], 0
    v_mfma_f32_16x16x32_bf16 v[56:59], v[100:103], v[160:163], 0
    v_mfma_f32_16x16x32_bf16 v[60:63], v[116:119], v[160:163], 0
    v_mfma_f32_16x16x32_bf16 v[64:67], v[100:103], v[166:169], 0
    v_mfma_f32_16x16x32_bf16 v[68:71], v[116:119], v[166:169], 0
    v_mfma_f32_16x16x16_bf16 v[8:11], v[120:121], v[164:165], v[8:11]
    v_mfma_f32_16x16x16_bf16 v[12:15], v[122:123], v[164:165], v[12:15]
    v_mfma_f32_16x16x16_bf16 v[16:19], v[120:121], v[170:171], v[16:19]
    v_mfma_f32_16x16x16_bf16 v[20:23], v[122:123], v[170:171], v[20:23]
    v_mfma_f32_16x16x16_bf16 v[24:27], v[124:125], v[164:165], v[24:27]
    v_mfma_f32_16x16x16_bf16 v[28:31], v[126:127], v[164:165], v[28:31]
    v_mfma_f32_16x16x16_bf16 v[32:35], v[124:125], v[170:171], v[32:35]
    v_mfma_f32_16x16x16_bf16 v[36:39], v[126:127], v[170:171], v[36:39]
    v_mfma_f32_16x16x16_bf16 v[40:43], v[128:129], v[164:165], v[40:43]
    v_mfma_f32_16x16x16_bf16 v[44:47], v[130:131], v[164:165], v[44:47]
    v_mfma_f32_16x16x16_bf16 v[48:51], v[128:129], v[170:171], v[48:51]
    v_mfma_f32_16x16x16_bf16 v[52:55], v[130:131], v[170:171], v[52:55]
    v_mfma_f32_16x16x16_bf16 v[56:59], v[132:133], v[164:165], v[56:59]
    v_mfma_f32_16x16x16_bf16 v[60:63], v[134:135], v[164:165], v[60:63]
    v_mfma_f32_16x16x16_bf16 v[64:67], v[132:133], v[170:171], v[64:67]
    v_mfma_f32_16x16x16_bf16 v[68:71], v[134:135], v[170:171], v[68:71]
    v_mul_f32 v8, v8, v180
    v_mul_f32 v12, v12, v180
    v_mul_f32 v9, v9, v180
    v_mul_f32 v13, v13, v180
    v_mul_f32 v10, v10, v180
    v_mul_f32 v14, v14, v180
    v_mul_f32 v11, v11, v180
    v_mul_f32 v15, v15, v180
    v_cvt_pk_bf16_f32 v8, v8, v9
    v_cvt_pk_bf16_f32 v9, v10, v11
    v_cvt_pk_bf16_f32 v10, v12, v13
    v_cvt_pk_bf16_f32 v11, v14, v15
    buffer_store_dwordx4 v[8:11], v1, s[4:7], s18 offen offset:0 sc1
    v_mul_f32 v16, v16, v184
    v_mul_f32 v20, v20, v184
    v_mul_f32 v17, v17, v184
    v_mul_f32 v21, v21, v184
    v_mul_f32 v18, v18, v184
    v_mul_f32 v22, v22, v184
    v_mul_f32 v19, v19, v184
    v_mul_f32 v23, v23, v184
    v_cvt_pk_bf16_f32 v16, v16, v17
    v_cvt_pk_bf16_f32 v17, v18, v19
    v_cvt_pk_bf16_f32 v18, v20, v21
    v_cvt_pk_bf16_f32 v19, v22, v23
    buffer_store_dwordx4 v[16:19], v1, s[4:7], s19 offen offset:0 sc1
    v_mul_f32 v24, v24, v180
    v_mul_f32 v28, v28, v180
    v_mul_f32 v25, v25, v180
    v_mul_f32 v29, v29, v180
    v_mul_f32 v26, v26, v180
    v_mul_f32 v30, v30, v180
    v_mul_f32 v27, v27, v180
    v_mul_f32 v31, v31, v180
    v_cvt_pk_bf16_f32 v24, v24, v25
    v_cvt_pk_bf16_f32 v25, v26, v27
    v_cvt_pk_bf16_f32 v26, v28, v29
    v_cvt_pk_bf16_f32 v27, v30, v31
    buffer_store_dwordx4 v[24:27], v1, s[4:7], s18 offen offset:1024 sc1
    v_mul_f32 v32, v32, v184
    v_mul_f32 v36, v36, v184
    v_mul_f32 v33, v33, v184
    v_mul_f32 v37, v37, v184
    v_mul_f32 v34, v34, v184
    v_mul_f32 v38, v38, v184
    v_mul_f32 v35, v35, v184
    v_mul_f32 v39, v39, v184
    v_cvt_pk_bf16_f32 v32, v32, v33
    v_cvt_pk_bf16_f32 v33, v34, v35
    v_cvt_pk_bf16_f32 v34, v36, v37
    v_cvt_pk_bf16_f32 v35, v38, v39
    buffer_store_dwordx4 v[32:35], v1, s[4:7], s19 offen offset:1024 sc1
    v_mul_f32 v40, v40, v180
    v_mul_f32 v44, v44, v180
    v_mul_f32 v41, v41, v180
    v_mul_f32 v45, v45, v180
    v_mul_f32 v42, v42, v180
    v_mul_f32 v46, v46, v180
    v_mul_f32 v43, v43, v180
    v_mul_f32 v47, v47, v180
    v_cvt_pk_bf16_f32 v40, v40, v41
    v_cvt_pk_bf16_f32 v41, v42, v43
    v_cvt_pk_bf16_f32 v42, v44, v45
    v_cvt_pk_bf16_f32 v43, v46, v47
    buffer_store_dwordx4 v[40:43], v1, s[4:7], s18 offen offset:2048 sc1
    v_mul_f32 v48, v48, v184
    v_mul_f32 v52, v52, v184
    v_mul_f32 v49, v49, v184
    v_mul_f32 v53, v53, v184
    v_mul_f32 v50, v50, v184
    v_mul_f32 v54, v54, v184
    v_mul_f32 v51, v51, v184
    v_mul_f32 v55, v55, v184
    v_cvt_pk_bf16_f32 v48, v48, v49
    v_cvt_pk_bf16_f32 v49, v50, v51
    v_cvt_pk_bf16_f32 v50, v52, v53
    v_cvt_pk_bf16_f32 v51, v54, v55
    buffer_store_dwordx4 v[48:51], v1, s[4:7], s19 offen offset:2048 sc1
    v_mul_f32 v56, v56, v180
    v_mul_f32 v60, v60, v180
    v_mul_f32 v57, v57, v180
    v_mul_f32 v61, v61, v180
    v_mul_f32 v58, v58, v180
    v_mul_f32 v62, v62, v180
    v_mul_f32 v59, v59, v180
    v_mul_f32 v63, v63, v180
    v_cvt_pk_bf16_f32 v56, v56, v57
    v_cvt_pk_bf16_f32 v57, v58, v59
    v_cvt_pk_bf16_f32 v58, v60, v61
    v_cvt_pk_bf16_f32 v59, v62, v63
    buffer_store_dwordx4 v[56:59], v1, s[4:7], s18 offen offset:3072 sc1
    v_mul_f32 v64, v64, v184
    v_mul_f32 v68, v68, v184
    v_mul_f32 v65, v65, v184
    v_mul_f32 v69, v69, v184
    v_mul_f32 v66, v66, v184
    v_mul_f32 v70, v70, v184
    v_mul_f32 v67, v67, v184
    v_mul_f32 v71, v71, v184
    v_cvt_pk_bf16_f32 v64, v64, v65
    v_cvt_pk_bf16_f32 v65, v66, v67
    v_cvt_pk_bf16_f32 v66, v68, v69
    v_cvt_pk_bf16_f32 v67, v70, v71
    buffer_store_dwordx4 v[64:67], v1, s[4:7], s19 offen offset:3072 sc1
    s_lshr_b32 s40, s34, 1
    s_lshl_b32 s40, s40, 7
    s_and_b32 s41, s34, 1
    s_lshl_b32 s41, s41, 2
    s_add_u32 s40, s40, s41
    s_add_u32 s40, s40, 125894656
    s_waitcnt vmcnt(0)
    s_barrier
    v_mov_b32 v250, s95
    v_cmp_eq_u32 vcc, 0, v0
    s_nop 0
    s_and_saveexec_b64 s[38:39], vcc
    s_cbranch_execz fs9
    buffer_store_dword v250, off, s[4:7], s40 sc1
fs9:
    s_mov_b64 exec, -1
    s_branch L_att_next
L_op_start:
    s_lshl_b32 s35, s33, 2
    s_add_u32 s35, s35, 136
    s_mov_b32 s37, s35
    v_mov_b32 v250, 1
    v_mov_b32 v251, 163832
    v_cmp_eq_u32 vcc, 0, v0
    s_nop 0
    s_and_saveexec_b64 s[38:39], vcc
    s_cbranch_execz tk10
    buffer_atomic_add v250, off, s[96:99], s37 sc0
    s_waitcnt vmcnt(0)
    ds_write_b32 v251, v250
    s_waitcnt lgkmcnt(0)
tk10:
    s_mov_b64 exec, -1
    s_barrier
    ds_read_b32 v252, v251
    s_waitcnt lgkmcnt(0)
    v_readfirstlane_b32 s16, v252
    s_barrier
    s_nop 3
    s_cmp_ge_u32 s16, 128
    s_cbranch_scc1 L_op_nextcb
    v_and_b32 v2, 63, v0
    v_lshlrev_b32 v1, 4, v2
    v_lshrrev_b32 v5, 2, v2
    v_mul_u32_u24 v3, 1152, v5
    v_and_b32 v5, 3, v2
    v_lshl_add_u32 v3, v5, 4, v3
    s_lshl_b32 s21, s32, 12
    v_add_u32 v4, s21, v1
    s_mov_b64 s[12:13], s[58:59]
    s_mov_b32 s14, 4718592
    s_mov_b32 s15, 0x20000
    s_mul_i32 s19, s32, 1179648
    s_lshl_b32 s18, s33, 6
    s_add_u32 s19, s19, s18
    s_add_u32 s18, s19, 0
    s_add_u32 m0, s21, 0
    s_nop 0
    buffer_load_dwordx4 v3, s[12:15], s18 offen lds
    s_add_u32 m0, s21, 1024
    s_add_u32 s18, s18, 18432
    buffer_load_dwordx4 v3, s[12:15], s18 offen lds
    s_add_u32 m0, s21, 2048
    s_add_u32 s18, s18, 18432
    buffer_load_dwordx4 v3, s[12:15], s18 offen lds
    s_add_u32 m0, s21, 3072
    s_add_u32 s18, s18, 18432
    buffer_load_dwordx4 v3, s[12:15], s18 offen lds
    s_add_u32 s18, s19, 73728
    s_add_u32 m0, s21, 16384
    s_nop 0
    buffer_load_dwordx4 v3, s[12:15], s18 offen lds
    s_add_u32 m0, s21, 17408
    s_add_u32 s18, s18, 18432
    buffer_load_dwordx4 v3, s[12:15], s18 offen lds
    s_add_u32 m0, s21, 18432
    s_add_u32 s18, s18, 18432
    buffer_load_dwordx4 v3, s[12:15], s18 offen lds
    s_add_u32 m0, s21, 19456
    s_add_u32 s18, s18, 18432
    buffer_load_dwordx4 v3, s[12:15], s18 offen lds
    s_add_u32 s18, s19, 147456
    s_add_u32 m0, s21, 32768
    s_nop 0
    buffer_load_dwordx4 v3, s[12:15], s18 offen lds
    s_add_u32 m0, s21, 33792
    s_add_u32 s18, s18, 18432
    buffer_load_dwordx4 v3, s[12:15], s18 offen lds
    s_add_u32 m0, s21, 34816
    s_add_u32 s18, s18, 18432
    buffer_load_dwordx4 v3, s[12:15], s18 offen lds
    s_add_u32 m0, s21, 35840
    s_add_u32 s18, s18, 18432
    buffer_load_dwordx4 v3, s[12:15], s18 offen lds
    s_add_u32 s18, s19, 221184
    s_add_u32 m0, s21, 49152
    s_nop 0
    buffer_load_dwordx4 v3, s[12:15], s18 offen lds
    s_add_u32 m0, s21, 50176
    s_add_u32 s18, s18, 18432
    buffer_load_dwordx4 v3, s[12:15], s18 offen lds
    s_add_u32 m0, s21, 51200
    s_add_u32 s18, s18, 18432
    buffer_load_dwordx4 v3, s[12:15], s18 offen lds
    s_add_u32 m0, s21, 52224
    s_add_u32 s18, s18, 18432
    buffer_load_dwordx4 v3, s[12:15], s18 offen lds
    s_add_u32 s18, s19, 294912
    s_add_u32 m0, s21, 65536
    s_nop 0
    buffer_load_dwordx4 v3, s[12:15], s18 offen lds
    s_add_u32 m0, s21, 66560
    s_add_u32 s18, s18, 18432
    buffer_load_dwordx4 v3, s[12:15], s18 offen lds
    s_add_u32 m0, s21, 67584
    s_add_u32 s18, s18, 18432
    buffer_load_dwordx4 v3, s[12:15], s18 offen lds
    s_add_u32 m0, s21, 68608
    s_add_u32 s18, s18, 18432
    buffer_load_dwordx4 v3, s[12:15], s18 offen lds
    s_add_u32 s18, s19, 368640
    s_add_u32 m0, s21, 81920
    s_nop 0
    buffer_load_dwordx4 v3, s[12:15], s18 offen lds
    s_add_u32 m0, s21, 82944
    s_add_u32 s18, s18, 18432
    buffer_load_dwordx4 v3, s[12:15], s18 offen lds
    s_add_u32 m0, s21, 83968
    s_add_u32 s18, s18, 18432
    buffer_load_dwordx4 v3, s[12:15], s18 offen lds
    s_add_u32 m0, s21, 84992
    s_add_u32 s18, s18, 18432
    buffer_load_dwordx4 v3, s[12:15], s18 offen lds
    s_add_u32 s18, s19, 442368
    s_add_u32 m0, s21, 98304
    s_nop 0
    buffer_load_dwordx4 v3, s[12:15], s18 offen lds
    s_add_u32 m0, s21, 99328
    s_add_u32 s18, s18, 18432
    buffer_load_dwordx4 v3, s[12:15], s18 offen lds
    s_add_u32 m0, s21, 100352
    s_add_u32 s18, s18, 18432
    buffer_load_dwordx4 v3, s[12:15], s18 offen lds
    s_add_u32 m0, s21, 101376
    s_add_u32 s18, s18, 18432
    buffer_load_dwordx4 v3, s[12:15], s18 offen lds
    s_add_u32 s18, s19, 516096
    s_add_u32 m0, s21, 114688
    s_nop 0
    buffer_load_dwordx4 v3, s[12:15], s18 offen lds
    s_add_u32 m0, s21, 115712
    s_add_u32 s18, s18, 18432
    buffer_load_dwordx4 v3, s[12:15], s18 offen lds
    s_add_u32 m0, s21, 116736
    s_add_u32 s18, s18, 18432
    buffer_load_dwordx4 v3, s[12:15], s18 offen lds
    s_add_u32 m0, s21, 117760
    s_add_u32 s18, s18, 18432
    buffer_load_dwordx4 v3, s[12:15], s18 offen lds
    s_add_u32 s18, s19, 589824
    s_add_u32 m0, s21, 131072
    s_nop 0
    buffer_load_dwordx4 v3, s[12:15], s18 offen lds
    s_add_u32 m0, s21, 132096
    s_add_u32 s18, s18, 18432
    buffer_load_dwordx4 v3, s[12:15], s18 offen lds
    s_add_u32 m0, s21, 133120
    s_add_u32 s18, s18, 18432
    buffer_load_dwordx4 v3, s[12:15], s18 offen lds
    s_add_u32 m0, s21, 134144
    s_add_u32 s18, s18, 18432
    buffer_load_dwordx4 v3, s[12:15], s18 offen lds
    v_add_u32 v6, 0, v4
    v_xor_b32 v7, 32, v6
    s_waitcnt vmcnt(32)
    ds_read_b64_tr_b16 a[0:1], v6 offset:0
    ds_read_b64_tr_b16 a[2:3], v6 offset:1024
    ds_read_b64_tr_b16 a[4:5], v6 offset:8
    ds_read_b64_tr_b16 a[6:7], v6 offset:1032
    ds_read_b64_tr_b16 a[8:9], v6 offset:2048
    ds_read_b64_tr_b16 a[10:11], v6 offset:3072
    ds_read_b64_tr_b16 a[12:13], v6 offset:2056
    ds_read_b64_tr_b16 a[14:15], v6 offset:3080
    s_waitcnt lgkmcnt(0)
    s_add_u32 s18, s19, 663552
    s_add_u32 m0, s21, 0
    s_nop 0
    buffer_load_dwordx4 v3, s[12:15], s18 offen lds
    s_add_u32 m0, s21, 1024
    s_add_u32 s18, s18, 18432
    buffer_load_dwordx4 v3, s[12:15], s18 offen lds
    s_add_u32 m0, s21, 2048
    s_add_u32 s18, s18, 18432
    buffer_load_dwordx4 v3, s[12:15], s18 offen lds
    s_add_u32 m0, s21, 3072
    s_add_u32 s18, s18, 18432
    buffer_load_dwordx4 v3, s[12:15], s18 offen lds
    v_add_u32 v6, 16384, v4
    v_xor_b32 v7, 32, v6
    s_waitcnt vmcnt(32)
    ds_read_b64_tr_b16 a[16:17], v6 offset:0
    ds_read_b64_tr_b16 a[18:19], v6 offset:1024
    ds_read_b64_tr_b16 a[20:21], v6 offset:8
    ds_read_b64_tr_b16 a[22:23], v6 offset:1032
    ds_read_b64_tr_b16 a[24:25], v6 offset:2048
    ds_read_b64_tr_b16 a[26:27], v6 offset:3072
    ds_read_b64_tr_b16 a[28:29], v6 offset:2056
    ds_read_b64_tr_b16 a[30:31], v6 offset:3080
    s_waitcnt lgkmcnt(0)
    s_add_u32 s18, s19, 737280
    s_add_u32 m0, s21, 16384
    s_nop 0
    buffer_load_dwordx4 v3, s[12:15], s18 offen lds
    s_add_u32 m0, s21, 17408
    s_add_u32 s18, s18, 18432
    buffer_load_dwordx4 v3, s[12:15], s18 offen lds
    s_add_u32 m0, s21, 18432
    s_add_u32 s18, s18, 18432
    buffer_load_dwordx4 v3, s[12:15], s18 offen lds
    s_add_u32 m0, s21, 19456
    s_add_u32 s18, s18, 18432
    buffer_load_dwordx4 v3, s[12:15], s18 offen lds
    v_add_u32 v6, 32768, v4
    v_xor_b32 v7, 32, v6
    s_waitcnt vmcnt(32)
    ds_read_b64_tr_b16 a[32:33], v6 offset:0
    ds_read_b64_tr_b16 a[34:35], v6 offset:1024
    ds_read_b64_tr_b16 a[36:37], v6 offset:8
    ds_read_b64_tr_b16 a[38:39], v6 offset:1032
    ds_read_b64_tr_b16 a[40:41], v6 offset:2048
    ds_read_b64_tr_b16 a[42:43], v6 offset:3072
    ds_read_b64_tr_b16 a[44:45], v6 offset:2056
    ds_read_b64_tr_b16 a[46:47], v6 offset:3080
    s_waitcnt lgkmcnt(0)
    s_add_u32 s18, s19, 811008
    s_add_u32 m0, s21, 32768
    s_nop 0
    buffer_load_dwordx4 v3, s[12:15], s18 offen lds
    s_add_u32 m0, s21, 33792
    s_add_u32 s18, s18, 18432
    buffer_load_dwordx4 v3, s[12:15], s18 offen lds
    s_add_u32 m0, s21, 34816
    s_add_u32 s18, s18, 18432
    buffer_load_dwordx4 v3, s[12:15], s18 offen lds
    s_add_u32 m0, s21, 35840
    s_add_u32 s18, s18, 18432
    buffer_load_dwordx4 v3, s[12:15], s18 offen lds
    v_add_u32 v6, 49152, v4
    v_xor_b32 v7, 32, v6
    s_waitcnt vmcnt(32)
    ds_read_b64_tr_b16 a[48:49], v6 offset:0
    ds_read_b64_tr_b16 a[50:51], v6 offset:1024
    ds_read_b64_tr_b16 a[52:53], v6 offset:8
    ds_read_b64_tr_b16 a[54:55], v6 offset:1032
    ds_read_b64_tr_b16 a[56:57], v6 offset:2048
    ds_read_b64_tr_b16 a[58:59], v6 offset:3072
    ds_read_b64_tr_b16 a[60:61], v6 offset:2056
    ds_read_b64_tr_b16 a[62:63], v6 offset:3080
    s_waitcnt lgkmcnt(0)
    s_add_u32 s18, s19, 884736
    s_add_u32 m0, s21, 49152
    s_nop 0
    buffer_load_dwordx4 v3, s[12:15], s18 offen lds
    s_add_u32 m0, s21, 50176
    s_add_u32 s18, s18, 18432
    buffer_load_dwordx4 v3, s[12:15], s18 offen lds
    s_add_u32 m0, s21, 51200
    s_add_u32 s18, s18, 18432
    buffer_load_dwordx4 v3, s[12:15], s18 offen lds
    s_add_u32 m0, s21, 52224
    s_add_u32 s18, s18, 18432
    buffer_load_dwordx4 v3, s[12:15], s18 offen lds
    v_add_u32 v6, 65536, v4
    v_xor_b32 v7, 32, v6
    s_waitcnt vmcnt(32)
    ds_read_b64_tr_b16 a[64:65], v6 offset:0
    ds_read_b64_tr_b16 a[66:67], v6 offset:1024
    ds_read_b64_tr_b16 a[68:69], v6 offset:8
    ds_read_b64_tr_b16 a[70:71], v6 offset:1032
    ds_read_b64_tr_b16 a[72:73], v6 offset:2048
    ds_read_b64_tr_b16 a[74:75], v6 offset:3072
    ds_read_b64_tr_b16 a[76:77], v6 offset:2056
    ds_read_b64_tr_b16 a[78:79], v6 offset:3080
    s_waitcnt lgkmcnt(0)
    s_add_u32 s18, s19, 958464
    s_add_u32 m0, s21, 65536
    s_nop 0
    buffer_load_dwordx4 v3, s[12:15], s18 offen lds
    s_add_u32 m0, s21, 66560
    s_add_u32 s18, s18, 18432
    buffer_load_dwordx4 v3, s[12:15], s18 offen lds
    s_add_u32 m0, s21, 67584
    s_add_u32 s18, s18, 18432
    buffer_load_dwordx4 v3, s[12:15], s18 offen lds
    s_add_u32 m0, s21, 68608
    s_add_u32 s18, s18, 18432
    buffer_load_dwordx4 v3, s[12:15], s18 offen lds
    v_add_u32 v6, 81920, v4
    v_xor_b32 v7, 32, v6
    s_waitcnt vmcnt(32)
    ds_read_b64_tr_b16 a[80:81], v6 offset:0
    ds_read_b64_tr_b16 a[82:83], v6 offset:1024
    ds_read_b64_tr_b16 a[84:85], v6 offset:8
    ds_read_b64_tr_b16 a[86:87], v6 offset:1032
    ds_read_b64_tr_b16 a[88:89], v6 offset:2048
    ds_read_b64_tr_b16 a[90:91], v6 offset:3072
    ds_read_b64_tr_b16 a[92:93], v6 offset:2056
    ds_read_b64_tr_b16 a[94:95], v6 offset:3080
    s_waitcnt lgkmcnt(0)
    s_add_u32 s18, s19, 1032192
    s_add_u32 m0, s21, 81920
    s_nop 0
    buffer_load_dwordx4 v3, s[12:15], s18 offen lds
    s_add_u32 m0, s21, 82944
    s_add_u32 s18, s18, 18432
    buffer_load_dwordx4 v3, s[12:15], s18 offen lds
    s_add_u32 m0, s21, 83968
    s_add_u32 s18, s18, 18432
    buffer_load_dwordx4 v3, s[12:15], s18 offen lds
    s_add_u32 m0, s21, 84992
    s_add_u32 s18, s18, 18432
    buffer_load_dwordx4 v3, s[12:15], s18 offen lds
    v_add_u32 v6, 98304, v4
    v_xor_b32 v7, 32, v6
    s_waitcnt vmcnt(32)
    ds_read_b64_tr_b16 a[96:97], v6 offset:0
    ds_read_b64_tr_b16 a[98:99], v6 offset:1024
    ds_read_b64_tr_b16 a[100:101], v6 offset:8
    ds_read_b64_tr_b16 a[102:103], v6 offset:1032
    ds_read_b64_tr_b16 a[104:105], v6 offset:2048
    ds_read_b64_tr_b16 a[106:107], v6 offset:3072
    ds_read_b64_tr_b16 a[108:109], v6 offset:2056
    ds_read_b64_tr_b16 a[110:111], v6 offset:3080
    s_waitcnt lgkmcnt(0)
    s_add_u32 s18, s19, 1105920
    s_add_u32 m0, s21, 98304
    s_nop 0
    buffer_load_dwordx4 v3, s[12:15], s18 offen lds
    s_add_u32 m0, s21, 99328
    s_add_u32 s18, s18, 18432
    buffer_load_dwordx4 v3, s[12:15], s18 offen lds
    s_add_u32 m0, s21, 100352
    s_add_u32 s18, s18, 18432
    buffer_load_dwordx4 v3, s[12:15], s18 offen lds
    s_add_u32 m0, s21, 101376
    s_add_u32 s18, s18, 18432
    buffer_load_dwordx4 v3, s[12:15], s18 offen lds
    v_add_u32 v6, 114688, v4
    v_xor_b32 v7, 32, v6
    s_waitcnt vmcnt(32)
    ds_read_b64_tr_b16 a[112:113], v6 offset:0
    ds_read_b64_tr_b16 a[114:115], v6 offset:1024
    ds_read_b64_tr_b16 a[116:117], v6 offset:8
    ds_read_b64_tr_b16 a[118:119], v6 offset:1032
    ds_read_b64_tr_b16 a[120:121], v6 offset:2048
    ds_read_b64_tr_b16 a[122:123], v6 offset:3072
    ds_read_b64_tr_b16 a[124:125], v6 offset:2056
    ds_read_b64_tr_b16 a[126:127], v6 offset:3080
    s_waitcnt lgkmcnt(0)
    v_add_u32 v6, 131072, v4
    v_xor_b32 v7, 32, v6
    s_waitcnt vmcnt(28)
    ds_read_b64_tr_b16 a[128:129], v6 offset:0
    ds_read_b64_tr_b16 a[130:131], v6 offset:1024
    ds_read_b64_tr_b16 a[132:133], v6 offset:8
    ds_read_b64_tr_b16 a[134:135], v6 offset:1032
    ds_read_b64_tr_b16 a[136:137], v6 offset:2048
    ds_read_b64_tr_b16 a[138:139], v6 offset:3072
    ds_read_b64_tr_b16 a[140:141], v6 offset:2056
    ds_read_b64_tr_b16 a[142:143], v6 offset:3080
    s_waitcnt lgkmcnt(0)
    v_add_u32 v6, 0, v4
    v_xor_b32 v7, 32, v6
    s_waitcnt vmcnt(24)
    ds_read_b64_tr_b16 a[144:145], v6 offset:0
    ds_read_b64_tr_b16 a[146:147], v6 offset:1024
    ds_read_b64_tr_b16 a[148:149], v6 offset:8
    ds_read_b64_tr_b16 a[150:151], v6 offset:1032
    ds_read_b64_tr_b16 a[152:153], v6 offset:2048
    ds_read_b64_tr_b16 a[154:155], v6 offset:3072
    ds_read_b64_tr_b16 a[156:157], v6 offset:2056
    ds_read_b64_tr_b16 a[158:159], v6 offset:3080
    s_waitcnt lgkmcnt(0)
    v_add_u32 v6, 16384, v4
    v_xor_b32 v7, 32, v6
    s_waitcnt vmcnt(20)
    ds_read_b64_tr_b16 a[160:161], v6 offset:0
    ds_read_b64_tr_b16 a[162:163], v6 offset:1024
    ds_read_b64_tr_b16 a[164:165], v6 offset:8
    ds_read_b64_tr_b16 a[166:167], v6 offset:1032
    ds_read_b64_tr_b16 a[168:169], v6 offset:2048
    ds_read_b64_tr_b16 a[170:171], v6 offset:3072
    ds_read_b64_tr_b16 a[172:173], v6 offset:2056
    ds_read_b64_tr_b16 a[174:175], v6 offset:3080
    s_waitcnt lgkmcnt(0)
    v_add_u32 v6, 32768, v4
    v_xor_b32 v7, 32, v6
    s_waitcnt vmcnt(16)
    ds_read_b64_tr_b16 a[176:177], v6 offset:0
    ds_read_b64_tr_b16 a[178:179], v6 offset:1024
    ds_read_b64_tr_b16 a[180:181], v6 offset:8
    ds_read_b64_tr_b16 a[182:183], v6 offset:1032
    ds_read_b64_tr_b16 a[184:185], v6 offset:2048
    ds_read_b64_tr_b16 a[186:187], v6 offset:3072
    ds_read_b64_tr_b16 a[188:189], v6 offset:2056
    ds_read_b64_tr_b16 a[190:191], v6 offset:3080
    s_waitcnt lgkmcnt(0)
    v_add_u32 v6, 49152, v4
    v_xor_b32 v7, 32, v6
    s_waitcnt vmcnt(12)
    ds_read_b64_tr_b16 a[192:193], v6 offset:0
    ds_read_b64_tr_b16 a[194:195], v6 offset:1024
    ds_read_b64_tr_b16 a[196:197], v6 offset:8
    ds_read_b64_tr_b16 a[198:199], v6 offset:1032
    ds_read_b64_tr_b16 a[200:201], v6 offset:2048
    ds_read_b64_tr_b16 a[202:203], v6 offset:3072
    ds_read_b64_tr_b16 a[204:205], v6 offset:2056
    ds_read_b64_tr_b16 a[206:207], v6 offset:3080
    s_waitcnt lgkmcnt(0)
    v_add_u32 v6, 65536, v4
    v_xor_b32 v7, 32, v6
    s_waitcnt vmcnt(8)
    ds_read_b64_tr_b16 a[208:209], v6 offset:0
    ds_read_b64_tr_b16 a[210:211], v6 offset:1024
    ds_read_b64_tr_b16 a[212:213], v6 offset:8
    ds_read_b64_tr_b16 a[214:215], v6 offset:1032
    ds_read_b64_tr_b16 a[216:217], v6 offset:2048
    ds_read_b64_tr_b16 a[218:219], v6 offset:3072
    ds_read_b64_tr_b16 a[220:221], v6 offset:2056
    ds_read_b64_tr_b16 a[222:223], v6 offset:3080
    s_waitcnt lgkmcnt(0)
    v_add_u32 v6, 81920, v4
    v_xor_b32 v7, 32, v6
    s_waitcnt vmcnt(4)
    ds_read_b64_tr_b16 a[224:225], v6 offset:0
    ds_read_b64_tr_b16 a[226:227], v6 offset:1024
    ds_read_b64_tr_b16 a[228:229], v6 offset:8
    ds_read_b64_tr_b16 a[230:231], v6 offset:1032
    ds_read_b64_tr_b16 a[232:233], v6 offset:2048
    ds_read_b64_tr_b16 a[234:235], v6 offset:3072
    ds_read_b64_tr_b16 a[236:237], v6 offset:2056
    ds_read_b64_tr_b16 a[238:239], v6 offset:3080
    s_waitcnt lgkmcnt(0)
    v_add_u32 v6, 98304, v4
    v_xor_b32 v7, 32, v6
    s_waitcnt vmcnt(0)
    ds_read_b64_tr_b16 a[240:241], v6 offset:0
    ds_read_b64_tr_b16 a[242:243], v6 offset:1024
    ds_read_b64_tr_b16 a[244:245], v6 offset:8
    ds_read_b64_tr_b16 a[246:247], v6 offset:1032
    ds_read_b64_tr_b16 a[248:249], v6 offset:2048
    ds_read_b64_tr_b16 a[250:251], v6 offset:3072
    ds_read_b64_tr_b16 a[252:253], v6 offset:2056
    ds_read_b64_tr_b16 a[254:255], v6 offset:3080
    s_waitcnt lgkmcnt(0)
    s_barrier
L_op_seg:
    s_lshr_b32 s43, s16, 1
    s_add_u32 s43, s43, 1
    s_and_b32 s36, s33, 15
    s_lshl_b32 s36, s36, 8
    s_add_u32 s36, s36, 125829120
    s_lshl_b32 s94, s33, 7
    s_add_u32 s94, s94, s16
    s_mov_b32 s88, 65536
cw11:
    buffer_load_dword v3, off, s[4:7], s36 offset:128 sc1
    s_waitcnt vmcnt(0)
    v_readfirstlane_b32 s42, v3
    s_nop 0
    s_sub_u32 s42, s42, s95
    s_cmp_gt_u32 s42, 64
    s_cselect_b32 s42, 0, s42
    s_add_u32 s42, s42, 2
    s_cmp_ge_u32 s42, s43
    s_cbranch_scc1 cw11x
    s_sub_u32 s88, s88, 1
    s_cbranch_scc1 cw11x
    s_sub_u32 s42, s43, s42
    s_min_u32 s42, s42, 6
cw11s:
    s_sleep 24
    s_sub_u32 s42, s42, 1
    s_cmp_lg_u32 s42, 0
    s_cbranch_scc1 cw11s
    s_branch cw11
cw11x:
    s_lshr_b32 s89, s16, 1
    s_lshl_b32 s89, s89, 2
    s_add_u32 s89, s89, s32
    s_lshl_b32 s89, s89, 7
    s_add_u32 s89, s89, 125894656
    v_mbcnt_lo_u32_b32 v2, -1, 0
    v_mbcnt_hi_u32_b32 v2, -1, v2
    v_min_u32 v2, 1, v2
    v_lshlrev_b32 v2, 2, v2
    s_mov_b32 s88, 4194304
fw12:
    buffer_load_dword v3, v2, s[4:7], s89 offen offset:0 sc1
    s_sub_u32 s88, s88, 1
    s_cbranch_scc1 fw12x
    s_waitcnt vmcnt(0)
    v_cmp_ne_u32 vcc, s95, v3
    s_cbranch_vccz fw12x
    s_sleep 6
    s_branch fw12
fw12x:
    s_lshl_b32 s18, s16, 17
    s_lshl_b32 s19, s32, 15
    s_add_u32 s18, s18, s19
    s_add_u32 s18, s18, 50331648
    buffer_load_dwordx4 v[32:35], v1, s[4:7], s18 offen offset:0 sc1
    buffer_load_dwordx4 v[36:39], v1, s[4:7], s18 offen offset:1024 sc1
    buffer_load_dwordx4 v[40:43], v1, s[4:7], s18 offen offset:2048 sc1
    buffer_load_dwordx4 v[44:47], v1, s[4:7], s18 offen offset:3072 sc1
    s_add_u32 s18, s18, 4096
    buffer_load_dwordx4 v[48:51], v1, s[4:7], s18 offen offset:0 sc1
    buffer_load_dwordx4 v[52:55], v1, s[4:7], s18 offen offset:1024 sc1
    buffer_load_dwordx4 v[56:59], v1, s[4:7], s18 offen offset:2048 sc1
    buffer_load_dwordx4 v[60:63], v1, s[4:7], s18 offen offset:3072 sc1
    s_add_u32 s18, s18, 4096
    buffer_load_dwordx4 v[64:67], v1, s[4:7], s18 offen offset:0 sc1
    buffer_load_dwordx4 v[68:71], v1, s[4:7], s18 offen offset:1024 sc1
    buffer_load_dwordx4 v[72:75], v1, s[4:7], s18 offen offset:2048 sc1
    buffer_load_dwordx4 v[76:79], v1, s[4:7], s18 offen offset:3072 sc1
    s_add_u32 s18, s18, 4096
    buffer_load_dwordx4 v[80:83], v1, s[4:7], s18 offen offset:0 sc1
    buffer_load_dwordx4 v[84:87], v1, s[4:7], s18 offen offset:1024 sc1
    buffer_load_dwordx4 v[88:91], v1, s[4:7], s18 offen offset:2048 sc1
    buffer_load_dwordx4 v[92:95], v1, s[4:7], s18 offen offset:3072 sc1
    s_add_u32 s18, s18, 4096
    buffer_load_dwordx4 v[96:99], v1, s[4:7], s18 offen offset:0 sc1
    buffer_load_dwordx4 v[100:103], v1, s[4:7], s18 offen offset:1024 sc1
    buffer_load_dwordx4 v[104:107], v1, s[4:7], s18 offen offset:2048 sc1
    buffer_load_dwordx4 v[108:111], v1, s[4:7], s18 offen offset:3072 sc1
    s_add_u32 s18, s18, 4096
    buffer_load_dwordx4 v[112:115], v1, s[4:7], s18 offen offset:0 sc1
    buffer_load_dwordx4 v[116:119], v1, s[4:7], s18 offen offset:1024 sc1
    buffer_load_dwordx4 v[120:123], v1, s[4:7], s18 offen offset:2048 sc1
    buffer_load_dwordx4 v[124:127], v1, s[4:7], s18 offen offset:3072 sc1
    s_add_u32 s18, s18, 4096
    buffer_load_dwordx4 v[128:131], v1, s[4:7], s18 offen offset:0 sc1
    buffer_load_dwordx4 v[132:135], v1, s[4:7], s18 offen offset:1024 sc1
    buffer_load_dwordx4 v[136:139], v1, s[4:7], s18 offen offset:2048 sc1
    buffer_load_dwordx4 v[140:143], v1, s[4:7], s18 offen offset:3072 sc1
    s_add_u32 s18, s18, 4096
    buffer_load_dwordx4 v[144:147], v1, s[4:7], s18 offen offset:0 sc1
    buffer_load_dwordx4 v[148:151], v1, s[4:7], s18 offen offset:1024 sc1
    buffer_load_dwordx4 v[152:155], v1, s[4:7], s18 offen offset:2048 sc1
    buffer_load_dwordx4 v[156:159], v1, s[4:7], s18 offen offset:3072 sc1
    v_lshlrev_b32 v2, 4, v0
    v_and_b32 v3, 3072, v2
    v_lshl_add_u32 v2, v3, 1, v1
    s_waitcnt vmcnt(31)
    v_mfma_f32_16x16x32_bf16 v[8:11], a[0:3], v[32:35], 0
    v_mfma_f32_16x16x32_bf16 v[12:15], a[4:7], v[32:35], 0
    s_waitcnt vmcnt(30)
    v_mfma_f32_16x16x32_bf16 v[8:11], a[8:11], v[36:39], v[8:11]
    v_mfma_f32_16x16x32_bf16 v[12:15], a[12:15], v[36:39], v[12:15]
    s_waitcnt vmcnt(29)
    v_mfma_f32_16x16x32_bf16 v[8:11], a[16:19], v[40:43], v[8:11]
    v_mfma_f32_16x16x32_bf16 v[12:15], a[20:23], v[40:43], v[12:15]
    s_waitcnt vmcnt(28)
    v_mfma_f32_16x16x32_bf16 v[8:11], a[24:27], v[44:47], v[8:11]
    v_mfma_f32_16x16x32_bf16 v[12:15], a[28:31], v[44:47], v[12:15]
    s_waitcnt vmcnt(27)
    v_mfma_f32_16x16x32_bf16 v[8:11], a[32:35], v[48:51], v[8:11]
    v_mfma_f32_16x16x32_bf16 v[12:15], a[36:39], v[48:51], v[12:15]
    s_waitcnt vmcnt(26)
    v_mfma_f32_16x16x32_bf16 v[8:11], a[40:43], v[52:55], v[8:11]
    v_mfma_f32_16x16x32_bf16 v[12:15], a[44:47], v[52:55], v[12:15]
    s_waitcnt vmcnt(25)
    v_mfma_f32_16x16x32_bf16 v[8:11], a[48:51], v[56:59], v[8:11]
    v_mfma_f32_16x16x32_bf16 v[12:15], a[52:55], v[56:59], v[12:15]
    s_waitcnt vmcnt(24)
    v_mfma_f32_16x16x32_bf16 v[8:11], a[56:59], v[60:63], v[8:11]
    v_mfma_f32_16x16x32_bf16 v[12:15], a[60:63], v[60:63], v[12:15]
    s_waitcnt vmcnt(23)
    v_mfma_f32_16x16x32_bf16 v[8:11], a[64:67], v[64:67], v[8:11]
    v_mfma_f32_16x16x32_bf16 v[12:15], a[68:71], v[64:67], v[12:15]
    s_waitcnt vmcnt(22)
    v_mfma_f32_16x16x32_bf16 v[8:11], a[72:75], v[68:71], v[8:11]
    v_mfma_f32_16x16x32_bf16 v[12:15], a[76:79], v[68:71], v[12:15]
    s_waitcnt vmcnt(21)
    v_mfma_f32_16x16x32_bf16 v[8:11], a[80:83], v[72:75], v[8:11]
    v_mfma_f32_16x16x32_bf16 v[12:15], a[84:87], v[72:75], v[12:15]
    s_waitcnt vmcnt(20)
    v_mfma_f32_16x16x32_bf16 v[8:11], a[88:91], v[76:79], v[8:11]
    v_mfma_f32_16x16x32_bf16 v[12:15], a[92:95], v[76:79], v[12:15]
    s_waitcnt vmcnt(19)
    v_mfma_f32_16x16x32_bf16 v[8:11], a[96:99], v[80:83], v[8:11]
    v_mfma_f32_16x16x32_bf16 v[12:15], a[100:103], v[80:83], v[12:15]
    s_waitcnt vmcnt(18)
    v_mfma_f32_16x16x32_bf16 v[8:11], a[104:107], v[84:87], v[8:11]
    v_mfma_f32_16x16x32_bf16 v[12:15], a[108:111], v[84:87], v[12:15]
    s_waitcnt vmcnt(17)
    v_mfma_f32_16x16x32_bf16 v[8:11], a[112:115], v[88:91], v[8:11]
    v_mfma_f32_16x16x32_bf16 v[12:15], a[116:119], v[88:91], v[12:15]
    s_waitcnt vmcnt(16)
    v_mfma_f32_16x16x32_bf16 v[8:11], a[120:123], v[92:95], v[8:11]
    v_mfma_f32_16x16x32_bf16 v[12:15], a[124:127], v[92:95], v[12:15]
    s_waitcnt vmcnt(15)
    v_mfma_f32_16x16x32_bf16 v[8:11], a[128:131], v[96:99], v[8:11]
    v_mfma_f32_16x16x32_bf16 v[12:15], a[132:135], v[96:99], v[12:15]
    s_waitcnt vmcnt(14)
    v_mfma_f32_16x16x32_bf16 v[8:11], a[136:139], v[100:103], v[8:11]
    v_mfma_f32_16x16x32_bf16 v[12:15], a[140:143], v[100:103], v[12:15]
    s_waitcnt vmcnt(13)
    v_mfma_f32_16x16x32_bf16 v[8:11], a[144:147], v[104:107], v[8:11]
    v_mfma_f32_16x16x32_bf16 v[12:15], a[148:151], v[104:107], v[12:15]
    s_waitcnt vmcnt(12)
    v_mfma_f32_16x16x32_bf16 v[8:11], a[152:155], v[108:111], v[8:11]
    v_mfma_f32_16x16x32_bf16 v[12:15], a[156:159], v[108:111], v[12:15]
    s_waitcnt vmcnt(11)
    v_mfma_f32_16x16x32_bf16 v[8:11], a[160:163], v[112:115], v[8:11]
    v_mfma_f32_16x16x32_bf16 v[12:15], a[164:167], v[112:115], v[12:15]
    s_waitcnt vmcnt(10)
    v_mfma_f32_16x16x32_bf16 v[8:11], a[168:171], v[116:119], v[8:11]
    v_mfma_f32_16x16x32_bf16 v[12:15], a[172:175], v[116:119], v[12:15]
    s_waitcnt vmcnt(9)
    v_mfma_f32_16x16x32_bf16 v[8:11], a[176:179], v[120:123], v[8:11]
    v_mfma_f32_16x16x32_bf16 v[12:15], a[180:183], v[120:123], v[12:15]
    s_waitcnt vmcnt(8)
    v_mfma_f32_16x16x32_bf16 v[8:11], a[184:187], v[124:127], v[8:11]
    v_mfma_f32_16x16x32_bf16 v[12:15], a[188:191], v[124:127], v[12:15]
    s_waitcnt vmcnt(7)
    v_mfma_f32_16x16x32_bf16 v[8:11], a[192:195], v[128:131], v[8:11]
    v_mfma_f32_16x16x32_bf16 v[12:15], a[196:199], v[128:131], v[12:15]
    s_waitcnt vmcnt(6)
    v_mfma_f32_16x16x32_bf16 v[8:11], a[200:203], v[132:135], v[8:11]
    v_mfma_f32_16x16x32_bf16 v[12:15], a[204:207], v[132:135], v[12:15]
    s_waitcnt vmcnt(5)
    v_mfma_f32_16x16x32_bf16 v[8:11], a[208:211], v[136:139], v[8:11]
    v_mfma_f32_16x16x32_bf16 v[12:15], a[212:215], v[136:139], v[12:15]
    s_waitcnt vmcnt(4)
    v_mfma_f32_16x16x32_bf16 v[8:11], a[216:219], v[140:143], v[8:11]
    v_mfma_f32_16x16x32_bf16 v[12:15], a[220:223], v[140:143], v[12:15]
    s_waitcnt vmcnt(3)
    v_mfma_f32_16x16x32_bf16 v[8:11], a[224:227], v[144:147], v[8:11]
    v_mfma_f32_16x16x32_bf16 v[12:15], a[228:231], v[144:147], v[12:15]
    s_waitcnt vmcnt(2)
    v_mfma_f32_16x16x32_bf16 v[8:11], a[232:235], v[148:151], v[8:11]
    v_mfma_f32_16x16x32_bf16 v[12:15], a[236:239], v[148:151], v[12:15]
    s_waitcnt vmcnt(1)
    v_mfma_f32_16x16x32_bf16 v[8:11], a[240:243], v[152:155], v[8:11]
    v_mfma_f32_16x16x32_bf16 v[12:15], a[244:247], v[152:155], v[12:15]
    s_waitcnt vmcnt(0)
    v_mfma_f32_16x16x32_bf16 v[8:11], a[248:251], v[156:159], v[8:11]
    v_mfma_f32_16x16x32_bf16 v[12:15], a[252:255], v[156:159], v[12:15]
    s_nop 3
    ds_write_b128 v2, v[8:11] offset:0
    s_nop 2
    ds_write_b128 v2, v[12:15] offset:1024
    s_waitcnt lgkmcnt(0)
    s_barrier
    s_cmp_lg_u32 s32, 0
    s_cbranch_scc1 os_skip
    ds_read_b128 v[40:43], v1 offset:2048
    ds_read_b128 v[44:47], v1 offset:3072
    ds_read_b128 v[48:51], v1 offset:4096
    ds_read_b128 v[52:55], v1 offset:5120
    ds_read_b128 v[56:59], v1 offset:6144
    ds_read_b128 v[60:63], v1 offset:7168
    v_lshrrev_b32 v3, 4, v1
    v_bfe_u32 v4, v3, 2, 2
    v_lshlrev_b32 v4, 3, v4
    v_and_b32 v2, 3, v3
    v_add_u32 v4, v4, v2
    v_mul_u32_u24 v4, 2304, v4
    v_lshrrev_b32 v3, 4, v3
    v_lshl_add_u32 v4, v3, 4, v4
    s_lshr_b32 s18, s16, 1
    s_lshl_b32 s18, s18, 3
    s_and_b32 s19, s16, 1
    s_add_u32 s18, s18, s19
    s_mul_i32 s18, s18, 9216
    s_lshl_b32 s19, s33, 6
    s_add_u32 s18, s18, s19
    s_waitcnt lgkmcnt(0)
    v_pk_add_f32 v[8:9], v[8:9], v[40:41]
    v_pk_add_f32 v[48:49], v[48:49], v[56:57]
    v_pk_add_f32 v[8:9], v[8:9], v[48:49]
    v_pk_add_f32 v[10:11], v[10:11], v[42:43]
    v_pk_add_f32 v[50:51], v[50:51], v[58:59]
    v_pk_add_f32 v[10:11], v[10:11], v[50:51]
    v_pk_add_f32 v[12:13], v[12:13], v[44:45]
    v_pk_add_f32 v[52:53], v[52:53], v[60:61]
    v_pk_add_f32 v[12:13], v[12:13], v[52:53]
    v_pk_add_f32 v[14:15], v[14:15], v[46:47]
    v_pk_add_f32 v[54:55], v[54:55], v[62:63]
    v_pk_add_f32 v[14:15], v[14:15], v[54:55]
    v_cvt_pk_bf16_f32 v32, v8, v9
    v_cvt_pk_bf16_f32 v33, v10, v11
    v_cvt_pk_bf16_f32 v34, v12, v13
    v_cvt_pk_bf16_f32 v35, v14, v15
    buffer_store_dwordx4 v[32:35], v4, s[8:11], s18 offen
os_skip:
    s_nop 1
    s_cmp_ge_u32 s16, 124
    s_cbranch_scc1 L_op_nextcb
    s_mov_b32 s37, s35
    v_mov_b32 v250, 1
    v_mov_b32 v251, 163832
    v_cmp_eq_u32 vcc, 0, v0
    s_nop 0
    s_and_saveexec_b64 s[38:39], vcc
    s_cbranch_execz tk13
    buffer_atomic_add v250, off, s[96:99], s37 sc0
    s_waitcnt vmcnt(0)
    ds_write_b32 v251, v250
    s_waitcnt lgkmcnt(0)
tk13:
    s_mov_b64 exec, -1
    s_barrier
    ds_read_b32 v252, v251
    s_waitcnt lgkmcnt(0)
    v_readfirstlane_b32 s16, v252
    s_barrier
    s_nop 3
    s_cmp_lt_u32 s16, 128
    s_cbranch_scc1 L_op_seg
L_op_nextcb:
    v_and_b32 v1, 63, v0
    v_min_u32 v1, 17, v1
    v_lshlrev_b32 v2, 2, v1
    buffer_load_dword v3, v2, s[96:99], 0 offen offset:136 sc1
    s_waitcnt vmcnt(0)
    v_cmp_gt_u32 vcc, 128, v3
    s_nop 0
    s_ff1_i32_b64 s40, vcc
    v_mov_b32 v250, s40
    v_mov_b32 v251, 163832
    s_cmp_lg_u32 s32, 0
    s_cbranch_scc1 L_op_nw
    ds_write_b32 v251, v250
    s_waitcnt lgkmcnt(0)
L_op_nw:
    s_barrier
    ds_read_b32 v252, v251
    s_waitcnt lgkmcnt(0)
    v_readfirstlane_b32 s33, v252
    s_barrier
    s_nop 1
    s_cmp_lt_u32 s33, 18
    s_cbranch_scc1 L_op_start
L_exit:
    s_endpgm
.section .rodata,"a"
.p2align 6
.amdhsa_kernel concat_heads__memory_aug_recurrent_mem_tr__ssm_conv_s4d__prompt_kernel
  .amdhsa_next_free_vgpr 512
  .amdhsa_next_free_sgpr 102
  .amdhsa_accum_offset 256
  .amdhsa_group_segment_fixed_size 0
  .amdhsa_kernarg_size 136
  .amdhsa_user_sgpr_count 2
  .amdhsa_user_sgpr_kernarg_segment_ptr 1
  .amdhsa_system_sgpr_workgroup_id_x 1
.end_amdhsa_kernel
.text
```

```asm
; @launch grid=(256,1,1) block=(256,1,1) lds=163840
.amdgcn_target "amdgcn-amd-amdhsa--gfx950"
.text
.globl concat_heads__memory_aug_recurrent_mem_tr__ssm_conv_s4d__prompt_kernel
.p2align 8
.type concat_heads__memory_aug_recurrent_mem_tr__ssm_conv_s4d__prompt_kernel,@function
concat_heads__memory_aug_recurrent_mem_tr__ssm_conv_s4d__prompt_kernel:
    s_cmp_ge_u32 s2, 256
    s_cbranch_scc1 L_exit
    s_load_dwordx4 s[84:87], s[0:1], 120
    s_load_dwordx16 s[48:63], s[0:1], 0
    v_lshrrev_b32 v1, 6, v0
    s_nop 0
    v_readfirstlane_b32 s32, v1
    s_getreg_b32 s3, hwreg(HW_REG_XCC_ID)
    s_and_b32 s3, s3, 15
    s_cmp_lg_u32 s32, 3
    s_cbranch_scc1 L_nowarm
    s_getpc_b64 s[44:45]
L_pcw:
    v_and_b32 v1, 63, v0
    v_lshlrev_b32 v1, 7, v1
    s_cmp_lg_u32 s3, 0
    s_cselect_b32 s33, L_helper-L_pcw, 0
    v_add_u32 v1, s33, v1
    v_min_u32 v2, L_exit-L_pcw, v1
    global_load_dword v240, v2, s[44:45]
    v_add_u32 v1, 8192, v1
    v_min_u32 v2, L_exit-L_pcw, v1
    global_load_dword v241, v2, s[44:45]
    v_add_u32 v1, 8192, v1
    s_cbranch_scc0 L_nowarm
    v_min_u32 v2, L_exit-L_pcw, v1
    global_load_dword v242, v2, s[44:45]
    v_add_u32 v1, 8192, v1
    v_min_u32 v2, L_exit-L_pcw, v1
    global_load_dword v243, v2, s[44:45]
    v_add_u32 v1, 8192, v1
    v_min_u32 v2, L_exit-L_pcw, v1
    global_load_dword v244, v2, s[44:45]
    v_add_u32 v1, 8192, v1
L_nowarm:
    s_waitcnt lgkmcnt(0)
    s_mov_b32 s4, s86
    s_mov_b32 s5, s87
    s_mov_b32 s6, 268435456
    s_mov_b32 s7, 0x20000
    s_mov_b32 s96, s84
    s_mov_b32 s97, s85
    s_mov_b32 s98, 256
    s_mov_b32 s99, 0x20000
    s_mov_b32 s95, 0
    s_cmp_lg_u32 s3, 0
    s_cbranch_scc1 L_helper
    s_mov_b32 s37, 128
    v_mov_b32 v250, 1
    v_mov_b32 v251, 163832
    v_cmp_eq_u32 vcc, 0, v0
    s_nop 0
    s_and_saveexec_b64 s[38:39], vcc
    s_cbranch_execz tk1m
    buffer_atomic_add v250, off, s[96:99], s37 sc0
tk1m:
    s_mov_b64 s[38:39], exec
    s_mov_b64 exec, -1
    v_lshrrev_b32 v54, 6, v0
    s_nop 0
    v_readfirstlane_b32 s13, v54
    v_and_b32 v57, 63, v0
    v_bfe_u32 v54, v57, 2, 1
    v_lshlrev_b32 v48, 13, v54
    v_bfe_u32 v54, v57, 3, 1
    v_lshl_add_u32 v48, v54, 15, v48
    v_bfe_u32 v54, v57, 4, 1
    v_lshl_add_u32 v48, v54, 14, v48
    v_bfe_u32 v54, v57, 5, 1
    v_lshl_add_u32 v48, v54, 16, v48
    v_lshrrev_b32 v55, 4, v57
    v_and_b32 v55, 2, v55
    v_xor_b32 v55, v55, v57
    v_and_b32 v55, 3, v55
    v_lshl_add_u32 v48, v55, 4, v48
    v_bfe_u32 v54, v57, 2, 1
    v_lshlrev_b32 v51, 6, v54
    v_bfe_u32 v54, v57, 3, 1
    v_lshl_add_u32 v51, v54, 9, v51
    v_bfe_u32 v54, v57, 4, 1
    v_lshl_add_u32 v51, v54, 7, v51
    v_bfe_u32 v54, v57, 5, 1
    v_lshl_add_u32 v51, v54, 12, v51
    v_bfe_u32 v54, v57, 0, 1
    v_lshl_add_u32 v51, v54, 3, v51
    v_bfe_u32 v54, v57, 1, 1
    v_lshl_add_u32 v51, v54, 4, v51
    v_bfe_u32 v54, v57, 3, 1
    v_lshl_add_u32 v51, v54, 5, v51
    v_lshrrev_b32 v55, 3, v57
    v_mul_u32_u24 v49, 1152, v55
    v_and_b32 v55, 7, v57
    v_lshl_add_u32 v49, v55, 4, v49
    v_bfe_u32 v54, v57, 4, 1
    v_lshlrev_b32 v52, 13, v54
    v_bfe_u32 v54, v57, 5, 1
    v_lshl_add_u32 v52, v54, 9, v52
    v_bfe_u32 v54, v57, 2, 1
    v_lshl_add_u32 v52, v54, 7, v52
    v_bfe_u32 v54, v57, 3, 1
    v_lshl_add_u32 v52, v54, 5, v52
    v_and_b32 v55, 3, v57
    v_lshl_add_u32 v52, v55, 3, v52
    v_lshrrev_b32 v55, 2, v57
    v_mul_u32_u24 v50, 1152, v55
    v_and_b32 v55, 3, v57
    v_lshl_add_u32 v50, v55, 4, v50
    v_bfe_u32 v54, v57, 4, 1
    v_lshlrev_b32 v53, 12, v54
    v_bfe_u32 v54, v57, 5, 1
    v_lshl_add_u32 v53, v54, 8, v53
    v_bfe_u32 v54, v57, 2, 1
    v_lshl_add_u32 v53, v54, 6, v53
    v_bfe_u32 v54, v57, 3, 1
    v_lshl_add_u32 v53, v54, 5, v53
    v_and_b32 v55, 3, v57
    v_lshl_add_u32 v53, v55, 3, v53
    s_lshl_b32 s66, s13, 10
    s_and_b32 s93, s13, 1
    s_lshl_b32 s93, s93, 14
    s_and_b32 s75, s13, 2
    s_lshl_b32 s75, s75, 19
    v_add_u32 v51, s66, v51
    v_add_u32 v52, s66, v52
    v_add_u32 v53, s66, v53
    v_mov_b32 v58, v48
    s_mov_b32 s10, 4718592
    s_mov_b32 s11, 0x20000
    s_mov_b64 exec, s[38:39]
    s_cbranch_execz tk1
    s_waitcnt vmcnt(0)
    ds_write_b32 v251, v250
    s_waitcnt lgkmcnt(0)
tk1:
    s_mov_b64 exec, -1
    s_barrier
    ds_read_b32 v252, v251
    s_waitcnt lgkmcnt(0)
    v_readfirstlane_b32 s12, v252
    s_barrier
    s_nop 3
    s_cmp_ge_u32 s12, 32
    s_cbranch_scc1 L_helper
L_chain:
    s_mov_b64 s[48:49], s[50:51]
    s_mov_b64 s[50:51], s[52:53]
    s_mov_b64 s[52:53], s[54:55]
    s_mov_b64 s[54:55], s[56:57]
    s_mov_b64 s[56:57], s[58:59]
    s_lshl_b32 s67, s12, 8
    s_lshl_b32 s40, s13, 6
    s_add_u32 s67, s67, s40
    s_mul_i32 s92, s12, 147456
    s_xor_b32 s94, s13, 0
    s_mul_i32 s94, s94, 36864
    s_add_u32 s94, s94, s92
    s_lshl_b32 s74, s13, 7
    s_add_u32 s94, s94, s74
    s_add_u32 s78, s94, 0
    s_mov_b64 s[8:9], s[56:57]
    v_mov_b32 v58, v49
    s_mov_b32 s79, 9216
    s_mov_b32 s81, 0
    s_add_u32 s80, s66, 0
    s_mov_b32 s76, 0
    s_mov_b32 s77, 8192
    s_call_b64 s[82:83], cf_dma
    s_mov_b32 s77, 16384
    s_call_b64 s[82:83], cf_dma
    s_xor_b32 s94, s13, 1
    s_mul_i32 s94, s94, 36864
    s_add_u32 s94, s94, s92
    s_lshl_b32 s74, s13, 7
    s_add_u32 s94, s94, s74
    s_add_u32 s78, s94, 0
    s_add_u32 s80, s66, 16384
    s_mov_b32 s76, 0
    s_mov_b32 s77, 8192
    s_call_b64 s[82:83], cf_dma
    s_mov_b32 s77, 16384
    s_call_b64 s[82:83], cf_dma
    s_xor_b32 s94, s13, 2
    s_mul_i32 s94, s94, 36864
    s_add_u32 s94, s94, s92
    s_lshl_b32 s74, s13, 7
    s_add_u32 s94, s94, s74
    s_add_u32 s78, s94, 0
    s_add_u32 s80, s66, 32768
    s_mov_b32 s76, 0
    s_mov_b32 s77, 8192
    s_call_b64 s[82:83], cf_dma
    v_lshrrev_b32 v24, 6, v0
    v_lshlrev_b32 v61, 4, v0
    v_add_u32 v62, 57344, v61
    v_xor_b32 v63, 1024, v61
    v_add_u32 v63, 98304, v63
    v_xor_b32 v64, 2048, v61
    v_add_u32 v64, 98304, v64
    v_and_b32 v65, 1023, v61
    v_add_u32 v65, 98304, v65
    v_and_b32 v26, 15, v0
    v_bfe_u32 v27, v0, 4, 2
    v_mov_b32 v60, 0x4444
    v_mov_b32 v25, 0xeeee
    v_cmp_lt_u32 vcc, 7, v26
    s_nop 1
    v_cndmask_b32 v60, v60, v25, vcc
    s_mov_b32 s77, 16384
    s_call_b64 s[82:83], cf_dma
    v_and_b32 v67, 12, v26
    v_lshlrev_b32 v67, 3, v67
    v_and_b32 v25, 1, v26
    v_lshl_add_u32 v67, v25, 4, v67
    v_bfe_u32 v25, v26, 1, 1
    v_lshl_add_u32 v67, v25, 3, v67
    v_lshl_add_u32 v66, v27, 14, v67
    v_lshl_add_u32 v66, v24, 17, v66
    s_xor_b32 s94, s13, 3
    s_mul_i32 s94, s94, 36864
    s_add_u32 s94, s94, s92
    s_lshl_b32 s74, s13, 7
    s_add_u32 s94, s94, s74
    s_add_u32 s78, s94, 0
    s_add_u32 s80, s66, 49152
    s_mov_b32 s76, 0
    s_mov_b32 s77, 8192
    s_call_b64 s[82:83], cf_dma
    v_and_b32 v67, 63, v67
    v_lshrrev_b32 v25, 1, v24
    v_lshl_add_u32 v67, v25, 18, v67
    v_lshl_add_u32 v67, v27, 16, v67
    v_lshrrev_b32 v25, 3, v26
    v_lshl_add_u32 v67, v25, 15, v67
    v_and_b32 v25, 1, v24
    v_lshl_add_u32 v67, v25, 6, v67
    s_mov_b32 s77, 16384
    s_call_b64 s[82:83], cf_dma
    v_and_b32 v25, 31, v0
    v_lshlrev_b32 v70, 4, v25
    v_lshlrev_b32 v28, 3, v25
    v_lshl_add_u32 v28, v24, 8, v28
    v_add_u32 v28, 110592, v28
    v_lshrrev_b32 v25, 1, v24
    v_lshl_add_u32 v70, v25, 9, v70
    v_and_b32 v25, 1, v24
    v_lshl_add_u32 v70, v25, 3, v70
    v_add_u32 v70, 109568, v70
    v_cmp_gt_u32 vcc, 2, v27
    s_nop 1
    v_cndmask_b32 v70, v70, v28, vcc
    v_xor_b32 v71, 2048, v63
    v_lshrrev_b32 v68, 4, v0
    v_lshlrev_b32 v68, 7, v68
    v_and_b32 v25, 7, v26
    v_lshl_add_u32 v68, v25, 4, v68
    v_add_u32 v68, 116736, v68
    v_and_b32 v25, 1, v27
    v_lshlrev_b32 v69, 7, v25
    v_lshrrev_b32 v25, 1, v27
    v_lshl_add_u32 v69, v25, 3, v69
    v_and_b32 v25, 3, v26
    v_lshl_add_u32 v69, v25, 4, v69
    v_bfe_u32 v25, v26, 2, 1
    v_lshl_add_u32 v69, v25, 2, v69
    s_mov_b32 s32, 0x00ff00ff
    s_mov_b32 s33, 0x00ff00ff
    s_not_b64 s[34:35], s[32:33]
    s_lshr_b32 s31, s12, 1
    s_lshl_b32 s31, s31, 8
    s_and_b32 s40, s12, 1
    s_lshl_b32 s40, s40, 6
    s_add_u32 s31, s31, s40
    s_and_b32 s40, s13, 1
    s_lshl_b32 s40, s40, 12
    s_add_u32 s31, s31, s40
    s_lshl_b32 s19, s12, 14
    s_add_u32 s19, s19, 67076096
    s_add_u32 s41, s19, 8192
    s_add_u32 s19, s19, s40
    s_and_b32 s40, s12, 1
    s_lshl_b32 s40, s40, 2
    s_or_b32 s40, s40, s13
    s_cmp_eq_u32 s40, 5
    s_cselect_b32 s64, 0, s13
    s_cmp_lg_u32 s13, 1
    s_cbranch_scc1 cf_notx
    s_mov_b32 s32, 0xff
    s_mov_b32 s33, 0xff
    s_mov_b32 s19, s41
    s_lshr_b32 s31, s12, 3
    s_lshl_b32 s31, s31, 8
    s_and_b32 s40, s12, 2
    s_lshl_b32 s40, s40, 6
    s_add_u32 s31, s31, s40
    s_and_b32 s40, s12, 4
    s_lshl_b32 s40, s40, 4
    s_add_u32 s31, s31, s40
    s_add_u32 s31, s31, 8192
cf_notx:
    s_cmp_lg_u32 s13, 0
    s_cbranch_scc1 cf_notp
    s_min_u32 s40, s12, 23
    s_mul_i32 s40, s40, 384
    s_add_u32 s40, s40, 98304
    v_add_u32 v69, s40, v61
    v_mov_b32 v25, 118784
    v_cmp_lt_u32 vcc, 23, v0
    s_nop 1
    v_cndmask_b32 v69, v69, v25, vcc
cf_notp:
    s_nop 1
    v_mov_b32 v28, 1
    v_mov_b32 v29, 1
    v_mov_b32 v30, 1
    v_mov_b32 v31, 1
    s_lshl_b32 s40, s12, 14
    s_add_u32 s40, s40, 67174400
    s_add_u32 s41, s40, 0
    buffer_store_dwordx4 v[28:31], v61, s[4:7], s41 offen
    s_add_u32 s41, s40, 4096
    buffer_store_dwordx4 v[28:31], v61, s[4:7], s41 offen
    s_add_u32 s41, s40, 8192
    buffer_store_dwordx4 v[28:31], v61, s[4:7], s41 offen
    s_cmp_eq_u32 s64, 0
    s_cselect_b64 exec, 0, s[32:33]
    v_mov_b32 v27, -1
    s_add_u32 s41, s31, 67108864
    buffer_store_dword v27, v69, s[4:7], s41 offen
    s_add_u32 s41, s31, 67125248
    buffer_store_dword v27, v69, s[4:7], s41 offen
    s_add_u32 s41, s31, 67141632
    buffer_store_dword v27, v69, s[4:7], s41 offen
    s_add_u32 s41, s31, 67158016
    buffer_store_dword v27, v69, s[4:7], s41 offen
    s_mov_b64 exec, -1
    s_mov_b64 s[68:69], s[48:49]
    s_mov_b32 s70, 9216
    s_mov_b32 s71, 0x20000
    v_and_b32 v25, 7, v0
    v_mul_u32_u24 v25, 1152, v25
    v_lshrrev_b32 v26, 3, v0
    v_lshl_add_u32 v25, v26, 4, v25
    buffer_load_dwordx4 v[36:39], v25, s[68:71], 0 offen
    buffer_load_dwordx4 v[40:43], v25, s[68:71], 0 offen offset:512
    v_bfe_u32 v25, v0, 2, 3
    v_mul_u32_u24 v25, 1152, v25
    v_lshrrev_b32 v26, 5, v0
    v_lshl_add_u32 v25, v26, 4, v25
    v_and_b32 v26, 3, v0
    v_lshl_add_u32 v25, v26, 2, v25
    buffer_load_dword v44, v25, s[68:71], 0 offen offset:1024
    s_waitcnt vmcnt(15)
    v_add_u32 v55, 0, v52
    ds_read_b64_tr_b16 v[176:177], v55 offset:0
    ds_read_b64_tr_b16 v[178:179], v55 offset:256
    ds_read_b64_tr_b16 v[180:181], v55 offset:4096
    ds_read_b64_tr_b16 v[182:183], v55 offset:4352
    s_xor_b32 s94, s13, 1
    s_mul_i32 s94, s94, 36864
    s_add_u32 s94, s94, s92
    s_lshl_b32 s74, s13, 7
    s_add_u32 s94, s94, s74
    s_add_u32 s78, s94, 512
    s_add_u32 s80, s66, 65536
    s_mov_b32 s76, 0
    s_mov_b32 s77, 8192
    s_call_b64 s[82:83], cf_dma
    ds_read_b64_tr_b16 v[208:209], v55 offset:64
    ds_read_b64_tr_b16 v[210:211], v55 offset:320
    ds_read_b64_tr_b16 v[212:213], v55 offset:4160
    ds_read_b64_tr_b16 v[214:215], v55 offset:4416
    s_mov_b32 s77, 16384
    s_call_b64 s[82:83], cf_dma
    s_waitcnt lgkmcnt(0)
    s_waitcnt vmcnt(15)
    v_add_u32 v55, 16384, v52
    ds_read_b64_tr_b16 v[184:185], v55 offset:0
    ds_read_b64_tr_b16 v[186:187], v55 offset:256
    ds_read_b64_tr_b16 v[188:189], v55 offset:4096
    ds_read_b64_tr_b16 v[190:191], v55 offset:4352
    s_xor_b32 s78, s75, 0
    s_add_u32 s78, s78, s67
    s_mov_b64 s[8:9], s[54:55]
    v_mov_b32 v58, v48
    s_mov_b32 s79, 131072
    s_mov_b32 s81, s93
    s_add_u32 s80, s66, 81920
    s_mov_b32 s76, 0
    s_mov_b32 s77, 8192
    s_call_b64 s[82:83], cf_dma
    ds_read_b64_tr_b16 v[216:217], v55 offset:64
    ds_read_b64_tr_b16 v[218:219], v55 offset:320
    ds_read_b64_tr_b16 v[220:221], v55 offset:4160
    ds_read_b64_tr_b16 v[222:223], v55 offset:4416
    s_mov_b32 s77, 16384
    s_call_b64 s[82:83], cf_dma
    s_waitcnt lgkmcnt(0)
    s_waitcnt vmcnt(15)
    v_add_u32 v55, 32768, v52
    ds_read_b64_tr_b16 v[192:193], v55 offset:0
    ds_read_b64_tr_b16 v[194:195], v55 offset:256
    ds_read_b64_tr_b16 v[196:197], v55 offset:4096
    ds_read_b64_tr_b16 v[198:199], v55 offset:4352
    s_mov_b32 s77, 24576
    s_call_b64 s[82:83], cf_dma
    ds_read_b64_tr_b16 v[224:225], v55 offset:64
    ds_read_b64_tr_b16 v[226:227], v55 offset:320
    ds_read_b64_tr_b16 v[228:229], v55 offset:4160
    ds_read_b64_tr_b16 v[230:231], v55 offset:4416
    s_mov_b32 s77, 32768
    s_call_b64 s[82:83], cf_dma
    s_waitcnt lgkmcnt(0)
    s_waitcnt vmcnt(15)
    v_add_u32 v55, 49152, v52
    ds_read_b64_tr_b16 v[200:201], v55 offset:0
    ds_read_b64_tr_b16 v[202:203], v55 offset:256
    ds_read_b64_tr_b16 v[204:205], v55 offset:4096
    ds_read_b64_tr_b16 v[206:207], v55 offset:4352
    s_xor_b32 s78, s75, 1048576
    s_add_u32 s78, s78, s67
    s_add_u32 s80, s66, 0
    s_mov_b32 s76, 0
    s_mov_b32 s77, 8192
    s_call_b64 s[82:83], cf_dma
    ds_read_b64_tr_b16 v[232:233], v55 offset:64
    ds_read_b64_tr_b16 v[234:235], v55 offset:320
    ds_read_b64_tr_b16 v[236:237], v55 offset:4160
    ds_read_b64_tr_b16 v[238:239], v55 offset:4416
    s_mov_b32 s77, 16384
    s_call_b64 s[82:83], cf_dma
    s_waitcnt lgkmcnt(0)
    s_waitcnt vmcnt(12)
    v_add_u32 v55, 65536, v52
    ds_read_b64_tr_b16 v[240:241], v55 offset:0
    ds_read_b64_tr_b16 v[242:243], v55 offset:256
    ds_read_b64_tr_b16 v[244:245], v55 offset:4096
    ds_read_b64_tr_b16 v[246:247], v55 offset:4352
    s_mov_b32 s77, 24576
    s_call_b64 s[82:83], cf_dma
    ds_read_b64_tr_b16 v[248:249], v55 offset:64
    ds_read_b64_tr_b16 v[250:251], v55 offset:320
    ds_read_b64_tr_b16 v[252:253], v55 offset:4160
    ds_read_b64_tr_b16 v[254:255], v55 offset:4416
    s_mov_b32 s77, 32768
    s_call_b64 s[82:83], cf_dma
    s_waitcnt lgkmcnt(0)
    v_min_u32 v36, -2, v36
    v_min_u32 v37, -2, v37
    v_min_u32 v38, -2, v38
    v_min_u32 v39, -2, v39
    v_min_u32 v40, -2, v40
    v_min_u32 v41, -2, v41
    v_min_u32 v42, -2, v42
    v_min_u32 v43, -2, v43
    v_min_u32 v44, -2, v44
    s_lshl_b32 s14, s12, 16
    s_add_u32 s14, s14, 92274688
    s_add_u32 s41, s14, 4096
    s_add_u32 s42, s14, 8192
    v_lshrrev_b32 v45, 2, v61
    buffer_store_dwordx4 v[36:39], v61, s[4:7], s14 offen
    buffer_store_dwordx4 v[40:43], v61, s[4:7], s41 offen
    buffer_store_dword v44, v45, s[4:7], s42 offen
    v_mov_b32 v46, 1
    s_mov_b64 exec, 1
    buffer_atomic_add v46, off, s[96:99], 0 offset:132 sc0
    s_mov_b64 exec, -1
    s_waitcnt vmcnt(9)
    v_add_u32 v55, 81920, v51
    v_xor_b32 v56, 32, v55
    ds_read_b64_tr_b16 a[216:217], v55 offset:0
    ds_read_b64_tr_b16 a[218:219], v55 offset:256
    ds_read_b64_tr_b16 a[220:221], v55 offset:8192
    ds_read_b64_tr_b16 a[222:223], v55 offset:8448
    s_xor_b32 s78, s75, 2097152
    s_add_u32 s78, s78, s67
    s_add_u32 s80, s66, 32768
    s_mov_b32 s76, 0
    s_mov_b32 s77, 8192
    s_call_b64 s[82:83], cf_dma
    ds_read_b64_tr_b16 a[224:225], v56 offset:0
    ds_read_b64_tr_b16 a[226:227], v56 offset:256
    ds_read_b64_tr_b16 a[228:229], v56 offset:8192
    ds_read_b64_tr_b16 a[230:231], v56 offset:8448
    s_mov_b32 s77, 16384
    s_call_b64 s[82:83], cf_dma
    s_waitcnt lgkmcnt(0)
    v_add_u32 v55, 98304, v51
    v_xor_b32 v56, 32, v55
    ds_read_b64_tr_b16 a[232:233], v55 offset:0
    ds_read_b64_tr_b16 a[234:235], v55 offset:256
    ds_read_b64_tr_b16 a[236:237], v55 offset:8192
    ds_read_b64_tr_b16 a[238:239], v55 offset:8448
    s_mov_b32 s77, 24576
    s_call_b64 s[82:83], cf_dma
    ds_read_b64_tr_b16 a[240:241], v56 offset:0
    ds_read_b64_tr_b16 a[242:243], v56 offset:256
    ds_read_b64_tr_b16 a[244:245], v56 offset:8192
    ds_read_b64_tr_b16 a[246:247], v56 offset:8448
    s_mov_b32 s77, 32768
    s_call_b64 s[82:83], cf_dma
    s_waitcnt lgkmcnt(0)
    s_waitcnt vmcnt(9)
    v_add_u32 v55, 0, v51
    v_xor_b32 v56, 32, v55
    ds_read_b64_tr_b16 a[248:249], v55 offset:0
    ds_read_b64_tr_b16 a[250:251], v55 offset:256
    ds_read_b64_tr_b16 a[252:253], v55 offset:8192
    ds_read_b64_tr_b16 a[254:255], v55 offset:8448
    s_xor_b32 s78, s75, 3145728
    s_add_u32 s78, s78, s67
    s_add_u32 s80, s66, 65536
    s_mov_b32 s76, 0
    s_mov_b32 s77, 8192
    s_call_b64 s[82:83], cf_dma
    ds_read_b64_tr_b16 v[72:73], v56 offset:0
    ds_read_b64_tr_b16 v[74:75], v56 offset:256
    ds_read_b64_tr_b16 v[76:77], v56 offset:8192
    ds_read_b64_tr_b16 v[78:79], v56 offset:8448
    s_mov_b32 s77, 16384
    s_call_b64 s[82:83], cf_dma
    s_waitcnt lgkmcnt(0)
    v_add_u32 v55, 16384, v51
    v_xor_b32 v56, 32, v55
    ds_read_b64_tr_b16 v[80:81], v55 offset:0
    ds_read_b64_tr_b16 v[82:83], v55 offset:256
    ds_read_b64_tr_b16 v[84:85], v55 offset:8192
    ds_read_b64_tr_b16 v[86:87], v55 offset:8448
    s_mov_b32 s77, 24576
    s_call_b64 s[82:83], cf_dma
    ds_read_b64_tr_b16 v[88:89], v56 offset:0
    ds_read_b64_tr_b16 v[90:91], v56 offset:256
    ds_read_b64_tr_b16 v[92:93], v56 offset:8192
    ds_read_b64_tr_b16 v[94:95], v56 offset:8448
    s_mov_b32 s77, 32768
    s_call_b64 s[82:83], cf_dma
    s_waitcnt lgkmcnt(0)
    s_waitcnt vmcnt(8)
    v_add_u32 v55, 32768, v51
    v_xor_b32 v56, 32, v55
    ds_read_b64_tr_b16 v[96:97], v55 offset:0
    ds_read_b64_tr_b16 v[98:99], v55 offset:256
    ds_read_b64_tr_b16 v[100:101], v55 offset:8192
    ds_read_b64_tr_b16 v[102:103], v55 offset:8448
    s_add_u32 s78, s67, 4194304
    s_mov_b32 s81, 0
    s_add_u32 s80, s66, 0
    s_mov_b32 s76, 0
    s_mov_b32 s77, 8192
    s_call_b64 s[82:83], cf_dma
    ds_read_b64_tr_b16 v[104:105], v56 offset:0
    ds_read_b64_tr_b16 v[106:107], v56 offset:256
    ds_read_b64_tr_b16 v[108:109], v56 offset:8192
    ds_read_b64_tr_b16 v[110:111], v56 offset:8448
    s_mov_b32 s77, 16384
    s_call_b64 s[82:83], cf_dma
    s_waitcnt lgkmcnt(0)
    v_add_u32 v55, 49152, v51
    v_xor_b32 v56, 32, v55
    ds_read_b64_tr_b16 v[112:113], v55 offset:0
    ds_read_b64_tr_b16 v[114:115], v55 offset:256
    ds_read_b64_tr_b16 v[116:117], v55 offset:8192
    ds_read_b64_tr_b16 v[118:119], v55 offset:8448
    s_xor_b32 s78, s75, 2097152
    s_add_u32 s78, s78, s67
    s_mov_b64 s[8:9], s[52:53]
    s_mov_b32 s81, s93
    s_add_u32 s80, s66, 98304
    s_mov_b32 s76, 0
    s_mov_b32 s77, 8192
    s_call_b64 s[82:83], cf_dma
    ds_read_b64_tr_b16 v[120:121], v56 offset:0
    ds_read_b64_tr_b16 v[122:123], v56 offset:256
    ds_read_b64_tr_b16 v[124:125], v56 offset:8192
    ds_read_b64_tr_b16 v[126:127], v56 offset:8448
    s_mov_b32 s77, 16384
    s_call_b64 s[82:83], cf_dma
    s_waitcnt lgkmcnt(0)
    v_readfirstlane_b32 s41, v46
    v_mov_b32 v36, 1
    v_mov_b32 v37, 0
    s_cmp_eq_u32 s41, 127
    s_cselect_b64 exec, 1, 0
    buffer_atomic_cmpswap v[36:37], off, s[96:99], 0 offset:140
    s_mov_b64 exec, -1
    s_waitcnt vmcnt(8)
    v_add_u32 v55, 65536, v51
    v_xor_b32 v56, 32, v55
    ds_read_b64_tr_b16 v[128:129], v55 offset:0
    ds_read_b64_tr_b16 v[130:131], v55 offset:256
    ds_read_b64_tr_b16 v[132:133], v55 offset:8192
    ds_read_b64_tr_b16 v[134:135], v55 offset:8448
    s_mov_b32 s77, 24576
    s_call_b64 s[82:83], cf_dma
    ds_read_b64_tr_b16 v[136:137], v56 offset:0
    ds_read_b64_tr_b16 v[138:139], v56 offset:256
    ds_read_b64_tr_b16 v[140:141], v56 offset:8192
    ds_read_b64_tr_b16 v[142:143], v56 offset:8448
    s_mov_b32 s77, 32768
    s_call_b64 s[82:83], cf_dma
    s_waitcnt lgkmcnt(0)
    v_add_u32 v55, 81920, v51
    v_xor_b32 v56, 32, v55
    ds_read_b64_tr_b16 v[144:145], v55 offset:0
    ds_read_b64_tr_b16 v[146:147], v55 offset:256
    ds_read_b64_tr_b16 v[148:149], v55 offset:8192
    ds_read_b64_tr_b16 v[150:151], v55 offset:8448
    s_xor_b32 s78, s75, 3145728
    s_add_u32 s78, s78, s67
    s_add_u32 s80, s66, 16384
    s_mov_b32 s76, 0
    s_mov_b32 s77, 8192
    s_call_b64 s[82:83], cf_dma
    ds_read_b64_tr_b16 v[152:153], v56 offset:0
    ds_read_b64_tr_b16 v[154:155], v56 offset:256
    ds_read_b64_tr_b16 v[156:157], v56 offset:8192
    ds_read_b64_tr_b16 v[158:159], v56 offset:8448
    s_mov_b32 s77, 16384
    s_call_b64 s[82:83], cf_dma
    s_waitcnt lgkmcnt(0)
    s_waitcnt vmcnt(12)
    v_add_u32 v55, 0, v51
    v_xor_b32 v56, 32, v55
    ds_read_b64_tr_b16 v[160:161], v55 offset:0
    ds_read_b64_tr_b16 v[162:163], v55 offset:256
    ds_read_b64_tr_b16 v[164:165], v55 offset:8192
    ds_read_b64_tr_b16 v[166:167], v55 offset:8448
    s_mov_b32 s77, 24576
    s_call_b64 s[82:83], cf_dma
    ds_read_b64_tr_b16 v[168:169], v56 offset:0
    ds_read_b64_tr_b16 v[170:171], v56 offset:256
    ds_read_b64_tr_b16 v[172:173], v56 offset:8192
    ds_read_b64_tr_b16 v[174:175], v56 offset:8448
    s_mov_b32 s77, 32768
    s_call_b64 s[82:83], cf_dma
    s_waitcnt lgkmcnt(0)
    s_waitcnt vmcnt(8)
    v_add_u32 v55, 98304, v51
    v_xor_b32 v56, 32, v55
    ds_read_b64_tr_b16 a[136:137], v55 offset:0
    ds_read_b64_tr_b16 a[138:139], v55 offset:256
    ds_read_b64_tr_b16 a[140:141], v55 offset:8192
    ds_read_b64_tr_b16 a[142:143], v55 offset:8448
    s_add_u32 s78, s67, 4194304
    s_mov_b32 s81, 0
    s_add_u32 s80, s66, 0
    s_mov_b32 s76, 0
    s_mov_b32 s77, 8192
    s_call_b64 s[82:83], cf_dma
    ds_read_b64_tr_b16 a[144:145], v56 offset:0
    ds_read_b64_tr_b16 a[146:147], v56 offset:256
    ds_read_b64_tr_b16 a[148:149], v56 offset:8192
    ds_read_b64_tr_b16 a[150:151], v56 offset:8448
    s_mov_b32 s77, 16384
    s_call_b64 s[82:83], cf_dma
    s_waitcnt lgkmcnt(0)
    v_add_u32 v55, 114688, v51
    v_xor_b32 v56, 32, v55
    ds_read_b64_tr_b16 a[152:153], v55 offset:0
    ds_read_b64_tr_b16 a[154:155], v55 offset:256
    ds_read_b64_tr_b16 a[156:157], v55 offset:8192
    ds_read_b64_tr_b16 a[158:159], v55 offset:8448
    s_xor_b32 s78, s75, 2097152
    s_add_u32 s78, s78, s67
    s_mov_b64 s[8:9], s[50:51]
    s_mov_b32 s81, s93
    s_add_u32 s80, s66, 49152
    s_mov_b32 s76, 0
    s_mov_b32 s77, 8192
    s_call_b64 s[82:83], cf_dma
    ds_read_b64_tr_b16 a[160:161], v56 offset:0
    ds_read_b64_tr_b16 a[162:163], v56 offset:256
    ds_read_b64_tr_b16 a[164:165], v56 offset:8192
    ds_read_b64_tr_b16 a[166:167], v56 offset:8448
    s_mov_b32 s77, 16384
    s_call_b64 s[82:83], cf_dma
    s_waitcnt lgkmcnt(0)
    s_waitcnt vmcnt(8)
    v_add_u32 v55, 16384, v51
    v_xor_b32 v56, 32, v55
    ds_read_b64_tr_b16 a[168:169], v55 offset:0
    ds_read_b64_tr_b16 a[170:171], v55 offset:256
    ds_read_b64_tr_b16 a[172:173], v55 offset:8192
    ds_read_b64_tr_b16 a[174:175], v55 offset:8448
    s_mov_b32 s77, 24576
    s_call_b64 s[82:83], cf_dma
    ds_read_b64_tr_b16 a[176:177], v56 offset:0
    ds_read_b64_tr_b16 a[178:179], v56 offset:256
    ds_read_b64_tr_b16 a[180:181], v56 offset:8192
    ds_read_b64_tr_b16 a[182:183], v56 offset:8448
    s_mov_b32 s77, 32768
    s_call_b64 s[82:83], cf_dma
    s_waitcnt lgkmcnt(0)
    v_add_u32 v55, 32768, v51
    v_xor_b32 v56, 32, v55
    ds_read_b64_tr_b16 a[184:185], v55 offset:0
    ds_read_b64_tr_b16 a[186:187], v55 offset:256
    ds_read_b64_tr_b16 a[188:189], v55 offset:8192
    ds_read_b64_tr_b16 a[190:191], v55 offset:8448
    s_xor_b32 s78, s75, 3145728
    s_add_u32 s78, s78, s67
    s_add_u32 s80, s66, 81920
    s_mov_b32 s76, 0
    s_mov_b32 s77, 8192
    s_call_b64 s[82:83], cf_dma
    ds_read_b64_tr_b16 a[192:193], v56 offset:0
    ds_read_b64_tr_b16 a[194:195], v56 offset:256
    ds_read_b64_tr_b16 a[196:197], v56 offset:8192
    ds_read_b64_tr_b16 a[198:199], v56 offset:8448
    s_mov_b32 s77, 16384
    s_call_b64 s[82:83], cf_dma
    s_waitcnt lgkmcnt(0)
    s_waitcnt vmcnt(12)
    v_add_u32 v55, 0, v51
    v_xor_b32 v56, 32, v55
    ds_read_b64_tr_b16 a[200:201], v55 offset:0
    ds_read_b64_tr_b16 a[202:203], v55 offset:256
    ds_read_b64_tr_b16 a[204:205], v55 offset:8192
    ds_read_b64_tr_b16 a[206:207], v55 offset:8448
    s_mov_b32 s77, 24576
    s_call_b64 s[82:83], cf_dma
    ds_read_b64_tr_b16 a[208:209], v56 offset:0
    ds_read_b64_tr_b16 a[210:211], v56 offset:256
    ds_read_b64_tr_b16 a[212:213], v56 offset:8192
    ds_read_b64_tr_b16 a[214:215], v56 offset:8448
    s_mov_b32 s77, 32768
    s_call_b64 s[82:83], cf_dma
    s_waitcnt lgkmcnt(0)
    s_waitcnt vmcnt(8)
    v_add_u32 v55, 49152, v51
    v_xor_b32 v56, 32, v55
    ds_read_b64_tr_b16 a[56:57], v55 offset:0
    ds_read_b64_tr_b16 a[58:59], v55 offset:256
    ds_read_b64_tr_b16 a[60:61], v55 offset:8192
    ds_read_b64_tr_b16 a[62:63], v55 offset:8448
    s_add_u32 s78, s67, 4194304
    s_mov_b32 s81, 0
    s_add_u32 s80, s66, 114688
    s_mov_b32 s76, 0
    s_mov_b32 s77, 8192
    s_call_b64 s[82:83], cf_dma
    ds_read_b64_tr_b16 a[64:65], v56 offset:0
    ds_read_b64_tr_b16 a[66:67], v56 offset:256
    ds_read_b64_tr_b16 a[68:69], v56 offset:8192
    ds_read_b64_tr_b16 a[70:71], v56 offset:8448
    s_mov_b32 s77, 16384
    s_call_b64 s[82:83], cf_dma
    s_waitcnt lgkmcnt(0)
    v_add_u32 v55, 65536, v51
    v_xor_b32 v56, 32, v55
    ds_read_b64_tr_b16 a[72:73], v55 offset:0
    ds_read_b64_tr_b16 a[74:75], v55 offset:256
    ds_read_b64_tr_b16 a[76:77], v55 offset:8192
    ds_read_b64_tr_b16 a[78:79], v55 offset:8448
    s_xor_b32 s78, s75, 1048576
    s_add_u32 s78, s78, s67
    s_mov_b32 s81, s93
    s_add_u32 s80, s66, 131072
    s_mov_b32 s76, 0
    s_mov_b32 s77, 8192
    s_call_b64 s[82:83], cf_dma
    ds_read_b64_tr_b16 a[80:81], v56 offset:0
    ds_read_b64_tr_b16 a[82:83], v56 offset:256
    ds_read_b64_tr_b16 a[84:85], v56 offset:8192
    ds_read_b64_tr_b16 a[86:87], v56 offset:8448
    s_mov_b32 s77, 16384
    s_call_b64 s[82:83], cf_dma
    s_waitcnt lgkmcnt(0)
    s_waitcnt vmcnt(8)
    v_add_u32 v55, 81920, v51
    v_xor_b32 v56, 32, v55
    ds_read_b64_tr_b16 a[88:89], v55 offset:0
    ds_read_b64_tr_b16 a[90:91], v55 offset:256
    ds_read_b64_tr_b16 a[92:93], v55 offset:8192
    ds_read_b64_tr_b16 a[94:95], v55 offset:8448
    s_mov_b32 s77, 24576
    s_call_b64 s[82:83], cf_dma
    ds_read_b64_tr_b16 a[96:97], v56 offset:0
    ds_read_b64_tr_b16 a[98:99], v56 offset:256
    ds_read_b64_tr_b16 a[100:101], v56 offset:8192
    ds_read_b64_tr_b16 a[102:103], v56 offset:8448
    s_mov_b32 s77, 32768
    s_call_b64 s[82:83], cf_dma
    s_waitcnt lgkmcnt(0)
    v_add_u32 v55, 98304, v51
    v_xor_b32 v56, 32, v55
    ds_read_b64_tr_b16 a[104:105], v55 offset:0
    ds_read_b64_tr_b16 a[106:107], v55 offset:256
    ds_read_b64_tr_b16 a[108:109], v55 offset:8192
    ds_read_b64_tr_b16 a[110:111], v55 offset:8448
    s_xor_b32 s78, s75, 0
    s_add_u32 s78, s78, s67
    s_add_u32 s80, s66, 32768
    s_mov_b32 s76, 0
    s_mov_b32 s77, 8192
    s_call_b64 s[82:83], cf_dma
    ds_read_b64_tr_b16 a[112:113], v56 offset:0
    ds_read_b64_tr_b16 a[114:115], v56 offset:256
    ds_read_b64_tr_b16 a[116:117], v56 offset:8192
    ds_read_b64_tr_b16 a[118:119], v56 offset:8448
    s_mov_b32 s77, 16384
    s_call_b64 s[82:83], cf_dma
    s_waitcnt lgkmcnt(0)
    s_waitcnt vmcnt(12)
    v_add_u32 v55, 114688, v51
    v_xor_b32 v56, 32, v55
    ds_read_b64_tr_b16 a[120:121], v55 offset:0
    ds_read_b64_tr_b16 a[122:123], v55 offset:256
    ds_read_b64_tr_b16 a[124:125], v55 offset:8192
    ds_read_b64_tr_b16 a[126:127], v55 offset:8448
    s_mov_b32 s77, 24576
    s_call_b64 s[82:83], cf_dma
    ds_read_b64_tr_b16 a[128:129], v56 offset:0
    ds_read_b64_tr_b16 a[130:131], v56 offset:256
    ds_read_b64_tr_b16 a[132:133], v56 offset:8192
    ds_read_b64_tr_b16 a[134:135], v56 offset:8448
    s_mov_b32 s77, 32768
    s_call_b64 s[82:83], cf_dma
    s_waitcnt lgkmcnt(0)
    s_waitcnt vmcnt(8)
    v_add_u32 v55, 131072, v51
    v_xor_b32 v56, 32, v55
    ds_read_b64_tr_b16 a[24:25], v55 offset:0
    ds_read_b64_tr_b16 a[26:27], v55 offset:256
    ds_read_b64_tr_b16 a[28:29], v55 offset:8192
    ds_read_b64_tr_b16 a[30:31], v55 offset:8448
    s_xor_b32 s78, s75, 0
    s_add_u32 s78, s78, s67
    s_mov_b64 s[8:9], s[52:53]
    s_add_u32 s80, s66, 0
    s_mov_b32 s76, 0
    s_mov_b32 s77, 8192
    s_call_b64 s[82:83], cf_dma
    ds_read_b64_tr_b16 a[32:33], v56 offset:0
    ds_read_b64_tr_b16 a[34:35], v56 offset:256
    ds_read_b64_tr_b16 a[36:37], v56 offset:8192
    ds_read_b64_tr_b16 a[38:39], v56 offset:8448
    s_mov_b32 s77, 16384
    s_call_b64 s[82:83], cf_dma
    s_waitcnt lgkmcnt(0)
    v_add_u32 v55, 147456, v51
    v_xor_b32 v56, 32, v55
    ds_read_b64_tr_b16 a[40:41], v55 offset:0
    ds_read_b64_tr_b16 a[42:43], v55 offset:256
    ds_read_b64_tr_b16 a[44:45], v55 offset:8192
    ds_read_b64_tr_b16 a[46:47], v55 offset:8448
    s_mov_b32 s77, 24576
    s_call_b64 s[82:83], cf_dma
    ds_read_b64_tr_b16 a[48:49], v56 offset:0
    ds_read_b64_tr_b16 a[50:51], v56 offset:256
    ds_read_b64_tr_b16 a[52:53], v56 offset:8192
    ds_read_b64_tr_b16 a[54:55], v56 offset:8448
    s_mov_b32 s77, 32768
    s_call_b64 s[82:83], cf_dma
    s_waitcnt lgkmcnt(0)
    s_waitcnt vmcnt(8)
    v_add_u32 v55, 32768, v51
    v_xor_b32 v56, 32, v55
    ds_read_b64_tr_b16 a[0:1], v55 offset:0
    ds_read_b64_tr_b16 a[2:3], v55 offset:256
    ds_read_b64_tr_b16 a[4:5], v55 offset:8192
    ds_read_b64_tr_b16 a[6:7], v55 offset:8448
    ds_read_b64_tr_b16 v[8:9], v56 offset:0
    ds_read_b64_tr_b16 v[10:11], v56 offset:256
    ds_read_b64_tr_b16 v[12:13], v56 offset:8192
    ds_read_b64_tr_b16 v[14:15], v56 offset:8448
    s_waitcnt lgkmcnt(0)
    s_barrier
    ds_write_b128 v63, v[8:11] offset:57344
    ds_write_b128 v63, v[12:15] offset:61440
    s_waitcnt lgkmcnt(0)
    v_add_u32 v55, 49152, v51
    v_xor_b32 v56, 32, v55
    ds_read_b64_tr_b16 a[8:9], v55 offset:0
    ds_read_b64_tr_b16 a[10:11], v55 offset:256
    ds_read_b64_tr_b16 a[12:13], v55 offset:8192
    ds_read_b64_tr_b16 a[14:15], v55 offset:8448
    ds_read_b64_tr_b16 a[16:17], v56 offset:0
    ds_read_b64_tr_b16 a[18:19], v56 offset:256
    ds_read_b64_tr_b16 a[20:21], v56 offset:8192
    ds_read_b64_tr_b16 a[22:23], v56 offset:8448
    s_waitcnt lgkmcnt(0)
    s_xor_b32 s78, s75, 1048576
    s_add_u32 s78, s78, s67
    s_add_u32 s80, s66, 32768
    s_mov_b32 s76, 0
    s_mov_b32 s77, 8192
    s_call_b64 s[82:83], cf_dma
    s_mov_b32 s77, 16384
    s_call_b64 s[82:83], cf_dma
    s_mov_b32 s77, 24576
    s_call_b64 s[82:83], cf_dma
    s_mov_b32 s77, 32768
    s_call_b64 s[82:83], cf_dma
    s_waitcnt vmcnt(8)
    v_add_u32 v55, 0, v51
    v_xor_b32 v56, 32, v55
    ds_read_b64_tr_b16 v[0:1], v55 offset:0
    ds_read_b64_tr_b16 v[2:3], v55 offset:256
    ds_read_b64_tr_b16 v[4:5], v55 offset:8192
    ds_read_b64_tr_b16 v[6:7], v55 offset:8448
    s_xor_b32 s94, s13, 0
    s_mul_i32 s94, s94, 36864
    s_add_u32 s94, s94, s92
    s_lshl_b32 s74, s13, 7
    s_add_u32 s94, s94, s74
    s_add_u32 s78, s94, 512
    s_mov_b64 s[8:9], s[56:57]
    v_mov_b32 v58, v49
    s_mov_b32 s79, 9216
    s_mov_b32 s81, 0
    s_add_u32 s80, s66, 65536
    s_mov_b32 s76, 0
    s_mov_b32 s77, 8192
    s_call_b64 s[82:83], cf_dma
    ds_read_b64_tr_b16 v[8:9], v56 offset:0
    ds_read_b64_tr_b16 v[10:11], v56 offset:256
    ds_read_b64_tr_b16 v[12:13], v56 offset:8192
    ds_read_b64_tr_b16 v[14:15], v56 offset:8448
    s_mov_b32 s77, 16384
    s_call_b64 s[82:83], cf_dma
    s_waitcnt lgkmcnt(0)
    ds_write_b128 v61, v[0:3] offset:0
    ds_write_b128 v61, v[4:7] offset:4096
    ds_write_b128 v61, v[8:11] offset:8192
    ds_write_b128 v61, v[12:15] offset:12288
    s_waitcnt lgkmcnt(0)
    v_add_u32 v55, 16384, v51
    v_xor_b32 v56, 32, v55
    ds_read_b64_tr_b16 v[0:1], v55 offset:0
    ds_read_b64_tr_b16 v[2:3], v55 offset:256
    ds_read_b64_tr_b16 v[4:5], v55 offset:8192
    ds_read_b64_tr_b16 v[6:7], v55 offset:8448
    s_xor_b32 s94, s13, 2
    s_mul_i32 s94, s94, 36864
    s_add_u32 s94, s94, s92
    s_lshl_b32 s74, s13, 7
    s_add_u32 s94, s94, s74
    s_add_u32 s78, s94, 512
    s_add_u32 s80, s66, 81920
    s_mov_b32 s76, 0
    s_mov_b32 s77, 8192
    s_call_b64 s[82:83], cf_dma
    ds_read_b64_tr_b16 v[8:9], v56 offset:0
    ds_read_b64_tr_b16 v[10:11], v56 offset:256
    ds_read_b64_tr_b16 v[12:13], v56 offset:8192
    ds_read_b64_tr_b16 v[14:15], v56 offset:8448
    s_mov_b32 s77, 16384
    s_call_b64 s[82:83], cf_dma
    s_waitcnt lgkmcnt(0)
    ds_write_b128 v61, v[0:3] offset:16384
    ds_write_b128 v61, v[4:7] offset:20480
    ds_write_b128 v61, v[8:11] offset:24576
    ds_write_b128 v61, v[12:15] offset:28672
    s_waitcnt lgkmcnt(0)
    s_waitcnt vmcnt(8)
    v_add_u32 v55, 32768, v51
    v_xor_b32 v56, 32, v55
    ds_read_b64_tr_b16 v[0:1], v55 offset:0
    ds_read_b64_tr_b16 v[2:3], v55 offset:256
    ds_read_b64_tr_b16 v[4:5], v55 offset:8192
    ds_read_b64_tr_b16 v[6:7], v55 offset:8448
    s_xor_b32 s94, s13, 3
    s_mul_i32 s94, s94, 36864
    s_add_u32 s94, s94, s92
    s_lshl_b32 s74, s13, 7
    s_add_u32 s94, s94, s74
    s_add_u32 s78, s94, 512
    s_add_u32 s80, s66, 122880
    s_mov_b32 s76, 0
    s_mov_b32 s77, 8192
    s_call_b64 s[82:83], cf_dma
    ds_read_b64_tr_b16 v[8:9], v56 offset:0
    ds_read_b64_tr_b16 v[10:11], v56 offset:256
    ds_read_b64_tr_b16 v[12:13], v56 offset:8192
    ds_read_b64_tr_b16 v[14:15], v56 offset:8448
    s_mov_b32 s77, 16384
    s_call_b64 s[82:83], cf_dma
    s_waitcnt lgkmcnt(0)
    ds_write_b128 v61, v[0:3] offset:32768
    ds_write_b128 v61, v[4:7] offset:36864
    ds_write_b128 v61, v[8:11] offset:40960
    ds_write_b128 v61, v[12:15] offset:45056
    s_waitcnt lgkmcnt(0)
    v_add_u32 v55, 49152, v51
    v_xor_b32 v56, 32, v55
    ds_read_b64_tr_b16 v[0:1], v55 offset:0
    ds_read_b64_tr_b16 v[2:3], v55 offset:256
    ds_read_b64_tr_b16 v[4:5], v55 offset:8192
    ds_read_b64_tr_b16 v[6:7], v55 offset:8448
    s_xor_b32 s94, s13, 0
    s_mul_i32 s94, s94, 36864
    s_add_u32 s94, s94, s92
    s_lshr_b32 s74, s13, 1
    s_lshl_b32 s74, s74, 6
    s_add_u32 s94, s94, s74
    s_add_u32 s78, s94, 1024
    v_mov_b32 v58, v50
    s_mov_b32 s79, 18432
    s_add_u32 s80, s66, 139264
    s_mov_b32 s76, 0
    s_mov_b32 s77, 8192
    s_call_b64 s[82:83], cf_dma
    ds_read_b64_tr_b16 v[8:9], v56 offset:0
    ds_read_b64_tr_b16 v[10:11], v56 offset:256
    ds_read_b64_tr_b16 v[12:13], v56 offset:8192
    ds_read_b64_tr_b16 v[14:15], v56 offset:8448
    s_xor_b32 s94, s13, 2
    s_mul_i32 s94, s94, 36864
    s_add_u32 s94, s94, s92
    s_lshr_b32 s74, s13, 1
    s_lshl_b32 s74, s74, 6
    s_add_u32 s94, s94, s74
    s_add_u32 s78, s94, 1024
    s_mov_b32 s77, 16384
    s_call_b64 s[82:83], cf_dma
    s_waitcnt lgkmcnt(0)
    ds_write_b128 v61, v[0:3] offset:49152
    ds_write_b128 v61, v[4:7] offset:53248
    ds_write_b128 v61, v[8:11] offset:57344
    ds_write_b128 v61, v[12:15] offset:61440
    s_waitcnt lgkmcnt(0)
    buffer_load_dword v38, off, s[96:99], 0 offset:140 sc1
    buffer_load_dword v39, off, s[96:99], 0 offset:144 sc1
    s_lshr_b32 s84, s12, 1
    s_lshl_b32 s84, s84, 8
    s_add_u32 s84, s84, 125829120
    v_bfe_u32 v40, v61, 4, 6
    v_min_u32 v40, 11, v40
    v_lshlrev_b32 v40, 2, v40
    buffer_load_dword v41, v40, s[4:7], s84 offen sc1
    s_waitcnt vmcnt(15)
    v_add_u32 v55, 65536, v52
    ds_read_b64_tr_b16 v[0:1], v55 offset:0
    ds_read_b64_tr_b16 v[2:3], v55 offset:256
    ds_read_b64_tr_b16 v[4:5], v55 offset:4096
    ds_read_b64_tr_b16 v[6:7], v55 offset:4352
    ds_read_b64_tr_b16 v[8:9], v55 offset:64
    ds_read_b64_tr_b16 v[10:11], v55 offset:320
    ds_read_b64_tr_b16 v[12:13], v55 offset:4160
    ds_read_b64_tr_b16 v[14:15], v55 offset:4416
    s_waitcnt lgkmcnt(0)
    ds_write_b128 v62, v[0:3] offset:8192
    ds_write_b128 v62, v[4:7] offset:12288
    ds_write_b128 v62, v[8:11] offset:16384
    ds_write_b128 v62, v[12:15] offset:20480
    s_waitcnt lgkmcnt(0)
    s_waitcnt vmcnt(11)
    v_add_u32 v55, 81920, v52
    ds_read_b64_tr_b16 v[0:1], v55 offset:0
    ds_read_b64_tr_b16 v[2:3], v55 offset:256
    ds_read_b64_tr_b16 v[4:5], v55 offset:4096
    ds_read_b64_tr_b16 v[6:7], v55 offset:4352
    ds_read_b64_tr_b16 v[8:9], v55 offset:64
    ds_read_b64_tr_b16 v[10:11], v55 offset:320
    ds_read_b64_tr_b16 v[12:13], v55 offset:4160
    ds_read_b64_tr_b16 v[14:15], v55 offset:4416
    s_waitcnt lgkmcnt(0)
    ds_write_b128 v62, v[0:3] offset:24576
    ds_write_b128 v62, v[4:7] offset:28672
    ds_write_b128 v62, v[8:11] offset:32768
    ds_write_b128 v62, v[12:15] offset:36864
    s_waitcnt lgkmcnt(0)
    s_waitcnt vmcnt(7)
    v_add_u32 v55, 122880, v52
    ds_read_b64_tr_b16 v[0:1], v55 offset:0
    ds_read_b64_tr_b16 v[2:3], v55 offset:256
    ds_read_b64_tr_b16 v[4:5], v55 offset:4096
    ds_read_b64_tr_b16 v[6:7], v55 offset:4352
    ds_read_b64_tr_b16 v[8:9], v55 offset:64
    ds_read_b64_tr_b16 v[10:11], v55 offset:320
    ds_read_b64_tr_b16 v[12:13], v55 offset:4160
    ds_read_b64_tr_b16 v[14:15], v55 offset:4416
    s_waitcnt lgkmcnt(0)
    s_barrier
    ds_write_b128 v63, v[0:3] offset:24576
    ds_write_b128 v63, v[4:7] offset:28672
    s_barrier
    ds_write_b128 v63, v[8:11] offset:32768
    ds_write_b128 v63, v[12:15] offset:36864
    s_waitcnt lgkmcnt(0)
    s_waitcnt vmcnt(3)
    v_add_u32 v55, 139264, v53
    ds_read_b64_tr_b16 v[0:1], v55 offset:0
    ds_read_b64_tr_b16 v[2:3], v55 offset:128
    ds_read_b64_tr_b16 v[4:5], v55 offset:512
    ds_read_b64_tr_b16 v[6:7], v55 offset:640
    ds_read_b64_tr_b16 v[8:9], v55 offset:8192
    ds_read_b64_tr_b16 v[10:11], v55 offset:8320
    ds_read_b64_tr_b16 v[12:13], v55 offset:8704
    ds_read_b64_tr_b16 v[14:15], v55 offset:8832
    s_waitcnt lgkmcnt(0)
    s_barrier
    ds_write_b128 v63, v[0:3] offset:40960
    ds_write_b128 v63, v[4:7] offset:45056
    s_barrier
    ds_write_b128 v63, v[8:11] offset:49152
    ds_write_b128 v63, v[12:15] offset:53248
    s_waitcnt lgkmcnt(0)
    s_barrier
    s_waitcnt vmcnt(0)
    v_readfirstlane_b32 s95, v39
    v_readfirstlane_b32 s85, v38
    s_nop 4
    s_mov_b32 s88, 4194304
gn2:
    s_cmp_lg_u32 s95, 0
    s_cbranch_scc1 gn2x
    buffer_load_dword v24, off, s[96:99], 0 offset:144 sc1
    s_sub_u32 s88, s88, 1
    s_cbranch_scc1 gn2x
    s_waitcnt vmcnt(0)
    v_readfirstlane_b32 s95, v24
    s_nop 1
    s_branch gn2
gn2x:
    s_add_u32 s93, s95, 2
    v_subrev_u32 v41, s93, v41
    v_cmp_lt_u32 s[86:87], 64, v41
    v_bfe_u32 v40, v61, 4, 4
    v_bfe_u32 v41, v61, 8, 1
    v_lshlrev_b32 v41, 2, v41
    v_sub_u32 v41, v40, v41
    v_mov_b32 v42, 0x3f80
    v_mov_b32 v43, 0x3f800000
    v_cmp_eq_u32 vcc, 0, v41
    s_nop 1
    v_cndmask_b32 v32, 0, v42, vcc
    v_cmp_eq_u32 vcc, 1, v41
    s_nop 1
    v_cndmask_b32 v32, v32, v43, vcc
    v_cmp_eq_u32 vcc, 0, v40
    s_nop 1
    v_cndmask_b32 v36, 0, v42, vcc
    v_cmp_eq_u32 vcc, 1, v40
    s_nop 1
    v_cndmask_b32 v36, v36, v43, vcc
    v_cmp_eq_u32 vcc, 2, v41
    s_nop 1
    v_cndmask_b32 v33, 0, v42, vcc
    v_cmp_eq_u32 vcc, 3, v41
    s_nop 1
    v_cndmask_b32 v33, v33, v43, vcc
    v_cmp_eq_u32 vcc, 2, v40
    s_nop 1
    v_cndmask_b32 v37, 0, v42, vcc
    v_cmp_eq_u32 vcc, 3, v40
    s_nop 1
    v_cndmask_b32 v37, v37, v43, vcc
    v_cmp_eq_u32 vcc, 8, v41
    s_nop 1
    v_cndmask_b32 v34, 0, v42, vcc
    v_cmp_eq_u32 vcc, 9, v41
    s_nop 1
    v_cndmask_b32 v34, v34, v43, vcc
    v_cmp_eq_u32 vcc, 4, v40
    s_nop 1
    v_cndmask_b32 v38, 0, v42, vcc
    v_cmp_eq_u32 vcc, 5, v40
    s_nop 1
    v_cndmask_b32 v38, v38, v43, vcc
    v_cmp_eq_u32 vcc, 10, v41
    s_nop 1
    v_cndmask_b32 v35, 0, v42, vcc
    v_cmp_eq_u32 vcc, 11, v41
    s_nop 1
    v_cndmask_b32 v35, v35, v43, vcc
    v_cmp_eq_u32 vcc, 6, v40
    s_nop 1
    v_cndmask_b32 v39, 0, v42, vcc
    v_cmp_eq_u32 vcc, 7, v40
    s_nop 1
    v_cndmask_b32 v39, v39, v43, vcc
    ds_write_b128 v65, v[32:35] offset:9216
    ds_write_b128 v65, v[36:39] offset:10240
    v_mov_b32 v44, s95
    v_mov_b32 v45, s95
    v_mov_b32 v46, s95
    v_mov_b32 v47, s95
    v_mov_b32 v48, 118784
    ds_write_b128 v48, v[44:47]
    s_waitcnt vmcnt(0) lgkmcnt(0)
    s_cmp_eq_u32 s85, 1
    s_cbranch_scc1 cf_run
    s_mov_b32 s40, 131072
cf_startpoll:
    buffer_load_dword v3, off, s[96:99], 0 offset:140 sc1
    s_waitcnt vmcnt(0)
    v_readfirstlane_b32 s85, v3
    s_nop 0
    s_cmp_eq_u32 s85, 1
    s_cbranch_scc1 cf_run
    s_cmp_eq_u32 s85, 2
    s_cbranch_scc1 cf_leave
    s_sleep 1
    s_sub_u32 s40, s40, 1
    s_cbranch_scc0 cf_startpoll
    v_mov_b32 v4, 2
    v_mov_b32 v5, 0
    s_mov_b64 exec, 1
    buffer_atomic_cmpswap v[4:5], off, s[96:99], 0 offset:140
    s_mov_b64 exec, -1
    s_mov_b32 s40, 1048576
    s_branch cf_startpoll
cf_leave:
    v_lshrrev_b32 v0, 4, v61
    s_mov_b32 s32, s13
    s_load_dwordx16 s[48:63], s[0:1], 0
    s_waitcnt lgkmcnt(0)
    s_branch L_helper
cf_run:
    s_cmp_eq_u64 s[86:87], 0
    s_cbranch_scc1 cf_kv0_go
    s_lshr_b32 s92, s12, 1
    s_lshl_b32 s92, s92, 8
    s_add_u32 s92, s92, 125829120
    v_bfe_u32 v2, v61, 4, 6
    v_min_u32 v2, 11, v2
    v_lshlrev_b32 v2, 2, v2
    s_add_u32 s93, s95, 2
    s_mov_b32 s94, 4194304
cf_kv0:
    buffer_load_dword v3, v2, s[4:7], s92 offen sc1
    s_sub_u32 s94, s94, 1
    s_cbranch_scc1 cf_kv0_go
    s_waitcnt vmcnt(0)
    v_subrev_u32 v3, s93, v3
    v_cmp_lt_u32 vcc, 64, v3
    s_cbranch_vccz cf_kv0_go
    s_sleep 2
    s_branch cf_kv0
cf_kv0_go:
    s_mov_b32 s44, 0x3e0293ee
    s_mov_b32 s45, s44
    s_or_b32 s46, s44, 0x80000000
    s_mov_b32 s47, 128
    s_mov_b32 s60, 0x3f803f80
    s_mov_b32 s61, s60
    s_mov_b32 s62, 0x3e803e80
    s_mov_b32 s63, s62
    s_mov_b32 s28, 0
    s_lshl_b32 s24, s12, 14
    s_add_u32 s24, s24, 0
    s_add_u32 s66, s24, 33030144
    s_mul_i32 s40, s13, 3072
    s_add_u32 s23, s24, s40
    s_lshl_b32 s20, s12, 7
    s_add_u32 s20, s20, 67174400
    s_add_u32 s21, s20, 65536
    s_add_u32 s38, s20, 4096
    s_add_u32 s39, s21, 4096
    s_lshl_b32 s22, s12, 7
    s_add_u32 s22, s22, 67182592
    s_lshl_b32 s40, s12, 12
    s_add_u32 s25, s40, 79429632
    s_add_u32 s26, s40, 88866816
    s_lshl_b32 s65, s12, 9
    s_add_u32 s65, s65, 90177536
    s_lshl_b32 s40, s13, 5
    s_or_b32 s40, s40, s12
    s_cmp_lt_u32 s40, 24
    s_cselect_b32 s36, 0x1ffffff, 0
    s_mov_b32 s37, 0
    s_lshl_b32 s27, s12, 7
    s_add_u32 s27, s27, 125845504
    s_lshl_b32 s40, s13, 2
    s_add_u32 s27, s27, s40
    s_mov_b32 m0, 111616
    v_lshlrev_b32 v56, 2, v61
    buffer_load_dword v56, s[4:7], s24 offen sc1 lds
    s_add_u32 s24, s24, 524288
    buffer_load_dword v56, s[4:7], s24 offen sc1 lds
    s_add_u32 s24, s24, 524288
    s_add_u32 s15, s14, 4096
    s_add_u32 s16, s14, 8192
    ds_read_b128 v[32:35], v63 offset:57344
    ds_read_b128 v[36:39], v63 offset:61440
    ds_read_b128 v[40:43], v61 offset:0
    ds_read_b128 v[44:47], v61 offset:4096
    ds_read_b128 v[48:51], v61 offset:8192
    ds_read_b128 v[52:55], v61 offset:12288
    s_mov_b32 s29, 1048576
    buffer_load_dwordx4 v[24:27], v61, s[4:7], s14 offen nt
.p2align 6
cf_loop:
    v_mov_b64 v[0:1], 0
    v_mov_b64 v[2:3], 0
    v_mov_b64 v[4:5], 0
    v_mov_b64 v[6:7], 0
    v_mov_b64 v[8:9], 0
    v_mov_b64 v[10:11], 0
    v_mov_b64 v[12:13], 0
    v_mov_b64 v[14:15], 0
    v_mov_b64 v[16:17], 0
    v_mov_b64 v[18:19], 0
cf_loop2:
    v_mov_b64 v[20:21], 0
    v_mov_b64 v[22:23], 0
    v_lshrrev_b32 v56, 2, v61
    v_add_u32 v58, 106496, v56
    s_mov_b32 s29, 1048576
    s_nop 15
    s_nop 3
    buffer_load_dwordx4 v[24:27], v61, s[4:7], s14 offen nt
    s_waitcnt lgkmcnt(0)
cf_chk0:
    s_waitcnt vmcnt(1)
    v_max3_u32 v57, v24, v25, v26
    v_max_u32 v57, v57, v27
    v_cmp_eq_u32 vcc, -1, v57
    ds_write_b128 v62, v[24:27] offset:40960
    s_cbranch_vccnz cf_spin0
    v_smfmac_f32_16x16x64_bf16 v[8:11], v[24:27], v[32:39], v60
    buffer_load_dwordx4 v[28:31], v61, s[4:7], s15 offen nt
    buffer_load_dword v59, v56, s[4:7], s16 offen nt
    v_smfmac_f32_16x16x64_bf16 v[4:7], v[24:27], v[40:47], v60
    ds_read_b128 v[32:35], v61 offset:16384
    v_smfmac_f32_16x16x64_bf16 v[12:15], v[24:27], v[48:55], v60
    ds_read_b128 v[36:39], v61 offset:20480
    s_waitcnt lgkmcnt(2)
    s_barrier
    ds_read_b128 v[48:51], v63 offset:0
    v_smfmac_f32_16x16x64_bf16 v[0:3], v[24:27], a[0:7], v60
    ds_read_b128 v[40:43], v61 offset:24576
    v_smfmac_f32_16x16x64_bf16 v[16:19], v[24:27], a[216:223], v60
    ds_read_b128 v[44:47], v61 offset:28672
    v_smfmac_f32_16x16x64_bf16 v[20:23], v[24:27], a[224:231], v60
    ds_read_b128 v[52:55], v64 offset:0
    s_waitcnt lgkmcnt(3)
    v_smfmac_f32_16x16x64_bf16 v[4:7], v[48:51], v[32:39], v60
    ds_read_b128 v[32:35], v61 offset:32768
    v_smfmac_f32_16x16x64_bf16 v[0:3], v[48:51], a[8:15], v60
    ds_read_b128 v[36:39], v61 offset:36864
    v_smfmac_f32_16x16x64_bf16 v[8:11], v[48:51], a[16:23], v60
    s_add_u32 s18, s14, s31
    s_add_u32 s41, s14, 16384
    s_waitcnt lgkmcnt(3)
    v_smfmac_f32_16x16x64_bf16 v[12:15], v[48:51], v[40:47], v60
    ds_read_b128 v[40:43], v61 offset:40960
    s_waitcnt lgkmcnt(3)
    v_smfmac_f32_16x16x64_bf16 v[0:3], v[52:55], a[24:31], v60
    ds_read_b128 v[44:47], v61 offset:45056
    v_smfmac_f32_16x16x64_bf16 v[8:11], v[52:55], a[32:39], v60
    ds_read_b128 v[48:51], v71 offset:0
    s_waitcnt lgkmcnt(3)
    v_smfmac_f32_16x16x64_bf16 v[4:7], v[52:55], v[32:39], v60
    ds_read_b128 v[32:35], v61 offset:49152
    s_waitcnt vmcnt(0)
    v_max3_u32 v57, v28, v29, v30
    ds_write_b128 v62, v[28:31] offset:45056
    v_max3_u32 v57, v57, v31, v59
    s_waitcnt lgkmcnt(3)
    v_smfmac_f32_16x16x64_bf16 v[12:15], v[52:55], v[40:47], v60
    ds_write_b32 v58, v59
    v_cmp_eq_u32 vcc, -1, v57
    s_waitcnt lgkmcnt(3)
    v_smfmac_f32_16x16x64_bf16 v[0:3], v[48:51], a[40:47], v60
    ds_read_b128 v[36:39], v61 offset:53248
    v_smfmac_f32_16x16x64_bf16 v[8:11], v[48:51], a[48:55], v60
    ds_read_b128 v[40:43], v61 offset:57344
    s_cbranch_vccnz cf_spin1
cf_go1:
    v_smfmac_f32_16x16x64_bf16 v[0:3], v[28:31], a[56:63], v60
    ds_read_b128 v[44:47], v61 offset:61440
    v_smfmac_f32_16x16x64_bf16 v[8:11], v[28:31], a[64:71], v60
    s_and_b32 s41, s41, 65535
    s_add_u32 s41, s41, 67108864
    v_smfmac_f32_16x16x64_bf16 v[4:7], v[28:31], a[136:143], v60
    s_waitcnt lgkmcnt(3)
    s_barrier
    ds_read_b128 v[52:55], v63 offset:4096
    s_waitcnt lgkmcnt(3)
    v_smfmac_f32_16x16x64_bf16 v[4:7], v[48:51], v[32:39], v60
    ds_read_b128 v[56:59], v71 offset:4096
    v_smfmac_f32_16x16x64_bf16 v[12:15], v[28:31], a[144:151], v60
    buffer_load_dwordx4 v[32:35], v61, s[4:7], s23 offen offset:0 sc1
    s_waitcnt lgkmcnt(2)
    v_smfmac_f32_16x16x64_bf16 v[12:15], v[48:51], v[40:47], v60
    ds_read_b128 v[24:27], v65 offset:8192
    v_smfmac_f32_16x16x64_bf16 v[16:19], v[28:31], v[96:103], v60
    ds_read_b128 v[48:51], v64 offset:4096
    v_smfmac_f32_16x16x64_bf16 v[20:23], v[28:31], v[104:111], v60
    buffer_load_dwordx4 v[36:39], v61, s[4:7], s23 offen offset:1024 sc1
    s_waitcnt lgkmcnt(3)
    v_smfmac_f32_16x16x64_bf16 v[0:3], v[52:55], a[72:79], v60
    v_lshlrev_b32 v28, 2, v61
    v_smfmac_f32_16x16x64_bf16 v[4:7], v[52:55], a[152:159], v60
    s_add_u32 s17, s41, s31
    s_and_b32 s30, s28, 1
    s_waitcnt lgkmcnt(2)
    v_smfmac_f32_16x16x64_bf16 v[0:3], v[56:59], a[104:111], v60
    buffer_load_dwordx4 v[40:43], v61, s[4:7], s23 offen offset:2048 sc1
    v_smfmac_f32_16x16x64_bf16 v[4:7], v[56:59], a[184:191], v60
    s_waitcnt lgkmcnt(1)
    v_smfmac_f32_16x16x64_bf16 v[0:3], v[24:27], a[120:127], v60
    v_smfmac_f32_16x16x64_bf16 v[4:7], v[24:27], a[200:207], v60
    buffer_load_dwordx4 v[44:47], v61, s[4:7], s23 offen offset:3072 sc1
    s_waitcnt lgkmcnt(0)
    v_smfmac_f32_16x16x64_bf16 v[0:3], v[48:51], a[88:95], v60
    v_smfmac_f32_16x16x64_bf16 v[4:7], v[48:51], a[168:175], v60
    s_barrier
    v_smfmac_f32_16x16x64_bf16 v[8:11], v[52:55], a[80:87], v60
    buffer_load_dword v28, s[4:7], s24 offen sc1 lds
    v_smfmac_f32_16x16x64_bf16 v[12:15], v[52:55], a[160:167], v60
    ds_read_b128 v[28:31], v65 offset:9216
    v_smfmac_f32_16x16x64_bf16 v[8:11], v[56:59], a[112:119], v60
    v_cvt_pk_bf16_f32 v0, v0, v1
    v_smfmac_f32_16x16x64_bf16 v[12:15], v[56:59], a[192:199], v60
    v_cvt_pk_bf16_f32 v1, v2, v3
    v_smfmac_f32_16x16x64_bf16 v[8:11], v[24:27], a[128:135], v60
    v_cvt_pk_bf16_f32 v2, v4, v5
    v_smfmac_f32_16x16x64_bf16 v[8:11], v[48:51], a[96:103], v60
    v_cvt_pk_bf16_f32 v3, v6, v7
    v_smfmac_f32_16x16x64_bf16 v[12:15], v[24:27], a[208:215], v60
    s_cmp_ge_u32 s28, 62
    v_smfmac_f32_16x16x64_bf16 v[12:15], v[48:51], a[176:183], v60
    s_waitcnt lgkmcnt(0)
    v_cvt_pk_bf16_f32 v8, v8, v9
    v_mfma_f32_16x16x32_bf16 v[4:7], v[0:3], v[28:31], 0
    v_cvt_pk_bf16_f32 v9, v10, v11
    s_waitcnt vmcnt(3)
    s_nop 1
    v_cvt_pk_bf16_f32 v10, v12, v13
    v_cvt_pk_bf16_f32 v11, v14, v15
    s_nop 1
    v_mfma_f32_16x16x32_bf16 v[12:15], v[8:11], v[28:31], 0
    v_cvt_pk_bf16_f32 v0, v4, v5
    v_cvt_pk_bf16_f32 v1, v6, v7
    v_smfmac_f32_16x16x64_bf16 v[16:19], v[24:27], v[160:167], v60
    s_mov_b64 exec, s[36:37]
    ds_read_b128 v[28:31], v69
    s_mov_b64 exec, -1
    s_nop 0
    v_cvt_pk_bf16_f32 v2, v12, v13
    v_cvt_pk_bf16_f32 v3, v14, v15
    s_cbranch_scc1 cf_last
cf_back:
    s_nop 0
    v_mfma_f32_16x16x32_bf16 v[8:11], v[0:3], v[0:3], 0
    v_mfma_f32_16x16x32_bf16 v[4:7], v[36:39], v[0:3], 0
    ds_read_b128 v[36:39], v64 offset:0
    v_mfma_f32_16x16x32_bf16 v[12:15], v[32:35], v[0:3], 0
    ds_read_b128 v[32:35], v63 offset:0
    v_mov_b32_dpp v8, v10 row_ror:8 row_mask:0xf bank_mask:0xc
    v_mov_b32_dpp v9, v11 row_ror:8 row_mask:0xf bank_mask:0xc
    ds_write_b64 v70, v[8:9]
    s_nop 3
    v_mov_b32_dpp v12, v4 row_ror:8 row_mask:0xf bank_mask:0xc
    v_mov_b32_dpp v13, v5 row_ror:8 row_mask:0xf bank_mask:0xc
    v_mov_b32_dpp v14, v6 row_ror:8 row_mask:0xf bank_mask:0xc
    v_mov_b32_dpp v15, v7 row_ror:8 row_mask:0xf bank_mask:0xc
    ds_write_b128 v62, v[12:15] offset:55296
    v_smfmac_f32_16x16x64_bf16 v[20:23], v[24:27], v[168:175], v60
    v_smfmac_f32_16x16x64_bf16 v[16:19], v[56:59], v[144:151], v60
    v_or_b32 v27, 512, v65
    v_smfmac_f32_16x16x64_bf16 v[20:23], v[56:59], v[152:159], v60
    s_waitcnt vmcnt(1)
    s_waitcnt lgkmcnt(4)
    s_mov_b64 exec, s[36:37]
    buffer_store_dwordx4 v[28:31], v61, s[4:7], s65 offen sc1
    s_mov_b64 exec, -1
    v_smfmac_f32_16x16x64_bf16 v[16:19], v[48:51], v[128:135], v60
    s_waitcnt lgkmcnt(0)
    s_barrier
    ds_read_b128 v[4:7], v63 offset:14336
    ds_read_b128 v[8:11], v64 offset:14336
    ds_read_b128 v[0:3], v71 offset:14336
    v_smfmac_f32_16x16x64_bf16 v[20:23], v[48:51], v[136:143], v60
    ds_read_b128 v[56:59], v27 offset:10752
    v_smfmac_f32_16x16x64_bf16 v[16:19], v[52:55], v[112:119], v60
    ds_read_b128 v[24:27], v27 offset:11264
    v_smfmac_f32_16x16x64_bf16 v[20:23], v[52:55], v[120:127], v60
    ds_read_b128 v[28:31], v71 offset:0
    v_smfmac_f32_16x16x64_bf16 v[16:19], v[32:35], a[232:239], v60
    v_smfmac_f32_16x16x64_bf16 v[20:23], v[32:35], a[240:247], v60
    s_waitcnt lgkmcnt(5)
    v_add_f32 v12, v12, v4
    v_smfmac_f32_16x16x64_bf16 v[16:19], v[36:39], a[248:255], v60
    v_add_f32 v13, v13, v5
    v_smfmac_f32_16x16x64_bf16 v[20:23], v[36:39], v[72:79], v60
    v_add_f32 v14, v14, v6
    s_waitcnt lgkmcnt(0)
    v_smfmac_f32_16x16x64_bf16 v[16:19], v[28:31], v[80:87], v60
    v_add_f32 v15, v15, v7
    v_smfmac_f32_16x16x64_bf16 v[20:23], v[28:31], v[88:95], v60
    v_add_f32 v8, v8, v0
    v_add_f32 v9, v9, v1
    v_add_f32 v10, v10, v2
    v_add_f32 v11, v11, v3
    v_pk_add_f32 v[56:57], v[56:57], v[58:59]
    v_pk_add_f32 v[24:25], v[24:25], v[26:27]
    v_pk_add_f32 v[12:13], v[12:13], v[8:9]
    v_pk_add_f32 v[14:15], v[14:15], v[10:11]
    v_pk_add_f32 v[56:57], v[56:57], v[24:25]
    v_max3_f32 v4, v12, v13, v14
    v_max3_f32 v5, v15, v56, v57
    v_max_f32 v4, v4, v5
    v_cvt_pk_bf16_f32 v16, v16, v17
    v_cvt_pk_bf16_f32 v17, v18, v19
    v_max_f32_dpp v4, v4, v4 row_ror:8 row_mask:0xf bank_mask:0xf
    v_mov_b32 v5, v4
    v_cvt_pk_bf16_f32 v18, v20, v21
    v_cvt_pk_bf16_f32 v19, v22, v23
    v_permlane32_swap_b32 v4, v5
    v_max_f32 v4, v4, v5
    v_mov_b32 v5, v4
    v_mov_b64 v[24:25], s[62:63]
    v_mov_b64 v[26:27], s[60:61]
    v_permlane16_swap_b32 v4, v5
    v_max_f32 v4, v4, v5
    v_mul_f32 v4, s46, v4
    v_pk_fma_f32 v[12:13], v[12:13], s[44:45], v[4:5] op_sel_hi:[1,1,0]
    v_pk_fma_f32 v[14:15], v[14:15], s[44:45], v[4:5] op_sel_hi:[1,1,0]
    v_pk_fma_f32 v[56:57], v[56:57], s[44:45], v[4:5] op_sel_hi:[1,1,0]
    v_exp_f32 v12, v12
    v_exp_f32 v13, v13
    v_exp_f32 v14, v14
    v_cvt_pk_bf16_f32 v8, v12, v13
    v_exp_f32 v15, v15
    v_exp_f32 v56, v56
    v_cvt_pk_bf16_f32 v9, v14, v15
    v_mov_b32_dpp v10, v8 row_ror:8 row_mask:0xf bank_mask:0xf
    v_exp_f32 v57, v57
    v_mov_b32_dpp v11, v9 row_ror:8 row_mask:0xf bank_mask:0xf
    v_cvt_pk_bf16_f32 v6, v56, v57
    s_nop 0
    v_mfma_f32_16x16x32_bf16 v[56:59], v[40:43], v[8:11], 0
    ds_read_b128 v[48:51], v62 offset:8192
    v_mov_b32_dpp v7, v6 row_ror:8 row_mask:0xf bank_mask:0xf
    v_mfma_f32_16x16x32_bf16 v[20:23], v[44:47], v[8:11], 0
    ds_read_b128 v[52:55], v62 offset:12288
    v_bfe_u32 v4, v61, 7, 1
    v_mfma_f32_16x16x32_bf16 v[28:31], v[24:27], v[6:9], 0
    v_lshl_add_u32 v4, v4, 3, v68
    v_mov_b64 v[32:33], 0
    v_mfma_f32_16x16x16_bf16 v[56:59], v[16:17], v[6:7], v[56:59]
    v_mov_b64 v[34:35], 0
    v_mov_b64 v[36:37], 0
    v_mfma_f32_16x16x16_bf16 v[20:23], v[18:19], v[6:7], v[20:23]
    v_add_f32_dpp v28, v28, v28 row_ror:8 row_mask:0xf bank_mask:0xf
    v_rcp_f32 v28, v28
    v_mov_b64 v[38:39], 0
    s_nop 0
    v_mul_f32 v56, v56, v28
    v_mul_f32 v57, v57, v28
    v_mul_f32 v58, v58, v28
    v_mul_f32 v59, v59, v28
    v_mul_f32_dpp v56, v20, v28 row_ror:8 row_mask:0xf bank_mask:0xc
    v_mul_f32_dpp v57, v21, v28 row_ror:8 row_mask:0xf bank_mask:0xc
    v_mul_f32_dpp v58, v22, v28 row_ror:8 row_mask:0xf bank_mask:0xc
    v_mul_f32_dpp v59, v23, v28 row_ror:8 row_mask:0xf bank_mask:0xc
    v_cvt_pk_bf16_f32 v56, v56, v57
    v_cvt_pk_bf16_f32 v57, v58, v59
    ds_write_b64 v4, v[56:57]
    ds_read_b128 v[0:3], v68
    ds_read_b128 v[40:43], v62 offset:16384
    ds_read_b128 v[44:47], v62 offset:20480
    v_xor_b32 v24, 512, v68
    v_xor_b32 v28, 1024, v68
    v_xor_b32 v58, 1536, v68
    v_mov_b64 v[8:9], 0
    v_mov_b64 v[10:11], 0
    v_mov_b64 v[12:13], 0
    v_mov_b64 v[14:15], 0
    s_waitcnt lgkmcnt(3)
    s_barrier
    ds_read_b128 v[24:27], v24
    ds_read_b128 v[28:31], v28
    s_waitcnt lgkmcnt(4)
    v_smfmac_f32_16x16x64_bf16 v[32:35], v[0:3], v[176:183], v60
    ds_read_b128 v[56:59], v58
    v_smfmac_f32_16x16x64_bf16 v[36:39], v[0:3], v[208:215], v60
    v_mov_b64 v[20:21], 0
    v_smfmac_f32_16x16x64_bf16 v[8:11], v[0:3], v[48:55], v60
    ds_read_b128 v[48:51], v63 offset:40960
    v_mov_b64 v[22:23], 0
    s_waitcnt lgkmcnt(3)
    v_smfmac_f32_16x16x64_bf16 v[32:35], v[24:27], v[184:191], v60
    ds_read_b128 v[52:55], v63 offset:45056
    s_waitcnt lgkmcnt(3)
    v_smfmac_f32_16x16x64_bf16 v[32:35], v[28:31], v[192:199], v60
    s_waitcnt lgkmcnt(2)
    v_smfmac_f32_16x16x64_bf16 v[32:35], v[56:59], v[200:207], v60
    v_smfmac_f32_16x16x64_bf16 v[36:39], v[24:27], v[216:223], v60
    v_smfmac_f32_16x16x64_bf16 v[36:39], v[28:31], v[224:231], v60
    v_cvt_pk_bf16_f32 v32, v32, v33
    v_smfmac_f32_16x16x64_bf16 v[36:39], v[56:59], v[232:239], v60
    v_cvt_pk_bf16_f32 v33, v34, v35
    v_smfmac_f32_16x16x64_bf16 v[12:15], v[0:3], v[40:47], v60
    ds_read_b128 v[40:43], v63 offset:49152
    v_and_or_b32 v32, v32, -2, s30
    s_waitcnt lgkmcnt(1)
    v_smfmac_f32_16x16x64_bf16 v[20:23], v[0:3], v[48:55], v60
    buffer_store_dwordx2 v[32:33], v66, s[4:7], s20 offen
    v_cvt_pk_bf16_f32 v36, v36, v37
    ds_read_b128 v[44:47], v63 offset:53248
    v_smfmac_f32_16x16x64_bf16 v[8:11], v[24:27], v[240:247], v60
    ds_read_b128 v[48:51], v62 offset:24576
    v_cvt_pk_bf16_f32 v37, v38, v39
    v_and_or_b32 v36, v36, -2, s30
    v_smfmac_f32_16x16x64_bf16 v[12:15], v[24:27], v[248:255], v60
    buffer_store_dwordx2 v[36:37], v66, s[4:7], s21 offen
    ds_read_b128 v[52:55], v62 offset:28672
    ds_read_b128 v[0:3], v63 offset:24576
    ds_read_b128 v[4:7], v63 offset:28672
    s_waitcnt lgkmcnt(4)
    v_smfmac_f32_16x16x64_bf16 v[20:23], v[28:31], v[40:47], v60
    ds_read_b128 v[32:35], v63 offset:32768
    ds_read_b128 v[36:39], v63 offset:36864
    ds_read_b128 v[40:43], v62 offset:32768
    ds_read_b128 v[44:47], v62 offset:36864
    s_waitcnt lgkmcnt(6)
    v_smfmac_f32_16x16x64_bf16 v[8:11], v[28:31], v[48:55], v60
    s_nop 1
    v_cvt_pk_bf16_f32 v20, v20, v21
    v_cvt_pk_bf16_f32 v21, v22, v23
    s_waitcnt lgkmcnt(4)
    v_smfmac_f32_16x16x64_bf16 v[8:11], v[56:59], v[0:7], v60
    v_and_or_b32 v20, v20, -2, s30
    buffer_store_dwordx2 v[20:21], v67, s[4:7], s22 offen
    s_waitcnt lgkmcnt(2)
    v_smfmac_f32_16x16x64_bf16 v[12:15], v[56:59], v[32:39], v60
    s_cmp_lg_u32 s13, 2
    s_waitcnt lgkmcnt(0)
    v_smfmac_f32_16x16x64_bf16 v[12:15], v[28:31], v[40:47], v60
    v_cvt_pk_bf16_f32 v8, v8, v9
    v_cvt_pk_bf16_f32 v9, v10, v11
    v_and_or_b32 v8, v8, -2, s30
    buffer_store_dwordx2 v[8:9], v66, s[4:7], s38 offen
    s_nop 3
    v_cvt_pk_bf16_f32 v12, v12, v13
    v_cvt_pk_bf16_f32 v13, v14, v15
    v_and_or_b32 v12, v12, -2, s30
    buffer_store_dwordx2 v[12:13], v66, s[4:7], s39 offen
    s_cbranch_scc1 cf_w013
    s_nop 15
    s_nop 15
    s_nop 15
    s_nop 6
    buffer_load_dwordx4 v[40:43], v65, s[4:7], s19 offen offset:0 nt
    buffer_load_dwordx4 v[44:47], v65, s[4:7], s19 offen offset:1024 nt
    buffer_load_dwordx4 v[48:51], v65, s[4:7], s19 offen offset:2048 nt
    buffer_load_dwordx4 v[52:55], v65, s[4:7], s19 offen offset:3072 nt
    ds_read_b128 v[56:59], v65 offset:10240
    s_add_u32 s28, s28, 1
    s_mov_b32 s14, s41
    s_add_u32 s23, s23, 524288
    s_add_u32 s24, s24, 524288
    s_min_u32 s24, s24, s66
    s_add_u32 s15, s14, 4096
    s_add_u32 s16, s14, 8192
    v_mov_b32 v21, -1
    s_add_u32 s65, s65, 12288
    s_mov_b32 s40, 1
    s_cmp_lg_u32 s28, 63
    s_cbranch_scc1 cf_nv1658
    ds_write_b128 v62, v[16:19] offset:55296
    s_waitcnt lgkmcnt(0)
cf_nv1658:
    v_mov_b64 v[0:1], 0
    v_mov_b64 v[2:3], 0
    v_mov_b64 v[4:5], 0
    v_mov_b64 v[6:7], 0
    v_mov_b64 v[8:9], 0
    v_mov_b64 v[10:11], 0
    v_mov_b64 v[12:13], 0
    v_mov_b64 v[14:15], 0
    v_mov_b64 v[16:17], 0
    v_mov_b64 v[18:19], 0
cf_chkF:
    v_mov_b32 v20, 0
    s_waitcnt vmcnt(3)
    v_mfma_f32_16x16x32_bf16 v[28:31], v[40:43], v[56:59], 0
    v_bitop3_b32 v20, v20, v40, s30 bitop3:0xf6
    v_bitop3_b32 v20, v20, v42, s30 bitop3:0xf6
    s_waitcnt vmcnt(2)
    v_mfma_f32_16x16x32_bf16 v[28:31], v[44:47], v[56:59], v[28:31]
    v_bitop3_b32 v20, v20, v44, s30 bitop3:0xf6
    v_bitop3_b32 v20, v20, v46, s30 bitop3:0xf6
    s_waitcnt vmcnt(1)
    v_mfma_f32_16x16x32_bf16 v[28:31], v[48:51], v[56:59], v[28:31]
    v_bitop3_b32 v20, v20, v48, s30 bitop3:0xf6
    v_bitop3_b32 v20, v20, v50, s30 bitop3:0xf6
    s_waitcnt vmcnt(0)
    v_mfma_f32_16x16x32_bf16 v[28:31], v[52:55], v[56:59], v[28:31]
    v_bitop3_b32 v20, v20, v52, s30 bitop3:0xf6
    v_bitop3_b32 v20, v20, v54, s30 bitop3:0xf6
    v_and_b32 v20, s40, v20
    v_cmp_ne_u32 vcc, 0, v20
    s_cbranch_vccnz cf_spinF
    v_permlane32_swap_b32 v28, v30
    v_permlane32_swap_b32 v29, v31
    v_add_f32 v28, v28, v30
    v_add_f32 v30, v29, v31
    v_cvt_pk_bf16_f32 v28, v28, v30
    s_mov_b64 exec, s[32:33]
    buffer_store_dword v28, v69, s[4:7], s17 offen
    buffer_store_dword v21, v69, s[4:7], s18 offen
    s_mov_b64 exec, -1
    ds_read_b128 v[32:35], v63 offset:57344
    ds_read_b128 v[36:39], v63 offset:61440
    ds_read_b128 v[40:43], v61 offset:0
    ds_read_b128 v[44:47], v61 offset:4096
    ds_read_b128 v[48:51], v61 offset:8192
    ds_read_b128 v[52:55], v61 offset:12288
    s_nop 14
    buffer_load_dwordx4 v[24:27], v61, s[4:7], s14 offen nt
    s_branch cf_loop2
cf_w013:
    ds_read_b128 v[56:59], v65 offset:10240
    ds_read_b128 v[32:35], v63 offset:57344
    ds_read_b128 v[36:39], v63 offset:61440
    ds_read_b128 v[40:43], v61 offset:0
    ds_read_b128 v[44:47], v61 offset:4096
    ds_read_b128 v[48:51], v61 offset:8192
    ds_read_b128 v[52:55], v61 offset:12288
    s_add_u32 s28, s28, 1
    s_mov_b32 s14, s41
    s_add_u32 s23, s23, 524288
    s_add_u32 s24, s24, 524288
    s_min_u32 s24, s24, s66
    s_add_u32 s15, s14, 4096
    s_add_u32 s16, s14, 8192
    v_mov_b32 v21, -1
    s_add_u32 s65, s65, 12288
    s_mov_b32 s40, 1
    s_cmp_lg_u32 s28, 63
    s_cbranch_scc1 cf_nv1730
    ds_write_b128 v62, v[16:19] offset:55296
    s_waitcnt lgkmcnt(0)
cf_nv1730:
    s_cmp_eq_u32 s64, 0
    s_cbranch_scc1 cf_w0
    s_nop 15
    s_nop 15
    s_nop 12
    buffer_load_dwordx4 v[0:3], v65, s[4:7], s19 offen offset:0 nt
    buffer_load_dwordx4 v[4:7], v65, s[4:7], s19 offen offset:1024 nt
    buffer_load_dwordx4 v[8:11], v65, s[4:7], s19 offen offset:2048 nt
    buffer_load_dwordx4 v[12:15], v65, s[4:7], s19 offen offset:3072 nt
cf_chkG:
    v_mov_b32 v20, 0
    s_waitcnt vmcnt(3)
    v_mfma_f32_16x16x32_bf16 v[28:31], v[0:3], v[56:59], 0
    v_bitop3_b32 v20, v20, v0, s30 bitop3:0xf6
    v_bitop3_b32 v20, v20, v2, s30 bitop3:0xf6
    s_waitcnt vmcnt(2)
    v_mfma_f32_16x16x32_bf16 v[28:31], v[4:7], v[56:59], v[28:31]
    v_bitop3_b32 v20, v20, v4, s30 bitop3:0xf6
    v_bitop3_b32 v20, v20, v6, s30 bitop3:0xf6
    s_waitcnt vmcnt(1)
    v_mfma_f32_16x16x32_bf16 v[28:31], v[8:11], v[56:59], v[28:31]
    v_bitop3_b32 v20, v20, v8, s30 bitop3:0xf6
    v_bitop3_b32 v20, v20, v10, s30 bitop3:0xf6
    s_waitcnt vmcnt(0)
    v_mfma_f32_16x16x32_bf16 v[28:31], v[12:15], v[56:59], v[28:31]
    v_bitop3_b32 v20, v20, v12, s30 bitop3:0xf6
    v_bitop3_b32 v20, v20, v14, s30 bitop3:0xf6
    v_and_b32 v20, s40, v20
    v_cmp_ne_u32 vcc, 0, v20
    s_cbranch_vccnz cf_spinG
    v_permlane32_swap_b32 v28, v30
    v_permlane32_swap_b32 v29, v31
    v_add_f32 v28, v28, v30
    v_add_f32 v30, v29, v31
    s_cmp_eq_u32 s13, 3
    s_cbranch_scc1 cf_w3
    v_mov_b32 v29, v28
    v_mov_b32 v31, v30
    s_nop 0
    v_permlane16_swap_b32 v28, v29
    v_permlane16_swap_b32 v30, v31
    v_add_f32 v28, v28, v29
    v_add_f32 v30, v30, v31
cf_w3:
    v_cvt_pk_bf16_f32 v28, v28, v30
    s_mov_b64 exec, s[32:33]
    buffer_store_dword v28, v69, s[4:7], s17 offen
    buffer_store_dword v21, v69, s[4:7], s18 offen
    s_mov_b64 exec, -1
    buffer_load_dwordx4 v[24:27], v61, s[4:7], s14 offen nt
    s_branch cf_loop
cf_w0:
    v_mov_b64 v[0:1], 0
    v_mov_b64 v[2:3], 0
    v_mov_b64 v[4:5], 0
    v_mov_b64 v[6:7], 0
    v_mov_b64 v[8:9], 0
    v_mov_b64 v[10:11], 0
    v_mov_b64 v[12:13], 0
    v_mov_b64 v[14:15], 0
    v_mov_b64 v[16:17], 0
    v_mov_b64 v[18:19], 0
    s_cmp_lg_u32 s28, 10
    s_cbranch_scc1 cf_nokv
    s_lshr_b32 s92, s12, 1
    s_lshl_b32 s92, s92, 8
    s_add_u32 s92, s92, 125829120
    v_bfe_u32 v28, v61, 4, 6
    v_min_u32 v28, 11, v28
    v_lshlrev_b32 v28, 2, v28
    s_add_u32 s93, s95, 63
    s_mov_b32 s94, 4194304
cf_kv1:
    buffer_load_dword v29, v28, s[4:7], s92 offen sc1
    s_sub_u32 s94, s94, 1
    s_cbranch_scc1 cf_kv1_go
    s_waitcnt vmcnt(0)
    v_subrev_u32 v29, s93, v29
    v_cmp_lt_u32 vcc, 64, v29
    s_cbranch_vccz cf_kv1_go
    s_sleep 2
    s_branch cf_kv1
cf_kv1_go:
cf_nokv:
    s_nop 15
    s_nop 15
    s_nop 15
    s_nop 15
    s_nop 15
    s_nop 15
    s_nop 15
    s_nop 7
    buffer_load_dwordx4 v[24:27], v61, s[4:7], s14 offen nt
    s_branch cf_loop2
cf_spinF:
    buffer_load_dwordx4 v[40:43], v65, s[4:7], s19 offen offset:0 nt
    buffer_load_dwordx4 v[44:47], v65, s[4:7], s19 offen offset:1024 nt
    buffer_load_dwordx4 v[48:51], v65, s[4:7], s19 offen offset:2048 nt
    buffer_load_dwordx4 v[52:55], v65, s[4:7], s19 offen offset:3072 nt
    s_sub_u32 s29, s29, 1
    s_cmp_lt_i32 s29, 0
    s_cselect_b32 s40, 0, 1
    s_branch cf_chkF
cf_spinG:
    buffer_load_dwordx4 v[0:3], v65, s[4:7], s19 offen offset:0 nt
    buffer_load_dwordx4 v[4:7], v65, s[4:7], s19 offen offset:1024 nt
    buffer_load_dwordx4 v[8:11], v65, s[4:7], s19 offen offset:2048 nt
    buffer_load_dwordx4 v[12:15], v65, s[4:7], s19 offen offset:3072 nt
    s_sub_u32 s29, s29, 1
    s_cmp_lt_i32 s29, 0
    s_cselect_b32 s40, 0, 1
    s_branch cf_chkG
cf_spin0:
    buffer_load_dwordx4 v[24:27], v61, s[4:7], s14 offen nt
    s_sub_u32 s29, s29, 1
    s_cmp_lt_i32 s29, 0
    s_cbranch_scc0 cf_chk0
    s_waitcnt vmcnt(0)
    v_min_u32 v24, -2, v24
    v_min_u32 v25, -2, v25
    v_min_u32 v26, -2, v26
    v_min_u32 v27, -2, v27
    s_branch cf_chk0
cf_spin1:
    buffer_load_dwordx4 v[28:31], v61, s[4:7], s15 offen nt
    buffer_load_dword v59, v56, s[4:7], s16 offen nt
    s_sub_u32 s29, s29, 1
    s_cmp_lt_i32 s29, 0
    s_waitcnt vmcnt(0)
    v_max3_u32 v57, v28, v29, v30
    v_max3_u32 v57, v57, v31, v59
    v_cmp_eq_u32 vcc, -1, v57
    ds_write_b128 v62, v[28:31] offset:45056
    ds_write_b32 v58, v59
    s_waitcnt lgkmcnt(0)
    s_cbranch_scc1 cf_go1
    s_cbranch_vccnz cf_spin1
    s_branch cf_go1
cf_last:
    s_nop 1
    s_cmp_eq_u32 s28, 63
    s_waitcnt vmcnt(1)
    s_cbranch_scc1 cf_last2
    s_waitcnt vmcnt(0)
    s_mov_b64 exec, s[34:35]
    buffer_store_dwordx4 v[0:3], v61, s[4:7], s25 offen sc1
    s_mov_b64 exec, -1
    s_add_u32 s25, s25, 131072
    s_branch cf_back
cf_last2:
    ds_read_b128 v[40:43], v62 offset:55296
    s_waitcnt lgkmcnt(0)
    buffer_store_dwordx4 v[40:43], v61, s[4:7], s26 offen sc1
    s_add_u32 s26, s26, 131072
    s_add_u32 s40, s95, 63
    v_mov_b32 v44, s40
    ds_read_b128 v[32:35], v63 offset:0
    ds_read_b128 v[36:39], v64 offset:0
    ds_read_b128 v[28:31], v71 offset:0
    v_smfmac_f32_16x16x64_bf16 v[20:23], v[24:27], v[168:175], v60
    v_smfmac_f32_16x16x64_bf16 v[16:19], v[56:59], v[144:151], v60
    v_smfmac_f32_16x16x64_bf16 v[20:23], v[56:59], v[152:159], v60
    v_smfmac_f32_16x16x64_bf16 v[16:19], v[48:51], v[128:135], v60
    v_smfmac_f32_16x16x64_bf16 v[20:23], v[48:51], v[136:143], v60
    v_smfmac_f32_16x16x64_bf16 v[16:19], v[52:55], v[112:119], v60
    v_smfmac_f32_16x16x64_bf16 v[20:23], v[52:55], v[120:127], v60
    s_waitcnt lgkmcnt(2)
    v_smfmac_f32_16x16x64_bf16 v[16:19], v[32:35], a[232:239], v60
    v_smfmac_f32_16x16x64_bf16 v[20:23], v[32:35], a[240:247], v60
    s_waitcnt lgkmcnt(1)
    v_smfmac_f32_16x16x64_bf16 v[16:19], v[36:39], a[248:255], v60
    v_smfmac_f32_16x16x64_bf16 v[20:23], v[36:39], v[72:79], v60
    s_waitcnt lgkmcnt(0)
    v_smfmac_f32_16x16x64_bf16 v[16:19], v[28:31], v[80:87], v60
    v_smfmac_f32_16x16x64_bf16 v[20:23], v[28:31], v[88:95], v60
    s_nop 3
    v_cvt_pk_bf16_f32 v16, v16, v17
    v_cvt_pk_bf16_f32 v17, v18, v19
    s_nop 1
    v_cvt_pk_bf16_f32 v18, v20, v21
    v_cvt_pk_bf16_f32 v19, v22, v23
    s_mov_b64 exec, s[34:35]
    buffer_store_dwordx4 v[0:3], v61, s[4:7], s25 offen sc1
    s_mov_b64 exec, -1
    buffer_store_dwordx4 v[16:19], v61, s[4:7], s26 offen sc1
    v_add_u32 v32, 1, v44
    s_waitcnt vmcnt(0)
    s_mov_b64 exec, 1
    buffer_store_dword v32, off, s[4:7], s27 sc1
    s_mov_b64 exec, -1
    s_endpgm
cf_dma:
    s_xor_b32 s74, s76, s81
    s_add_u32 m0, s74, s80
    s_add_u32 s76, s76, 4096
    buffer_load_dwordx4 v58, s[8:11], s78 offen lds
    s_add_u32 s78, s78, s79
    s_cmp_lt_u32 s76, s77
    s_cbranch_scc1 cf_dma
    s_setpc_b64 s[82:83]
L_chain_safe:
    s_mov_b64 s[48:49], s[50:51]
    s_mov_b64 s[50:51], s[52:53]
    s_mov_b64 s[52:53], s[54:55]
    s_mov_b64 s[54:55], s[56:57]
    s_mov_b64 s[56:57], s[58:59]
    v_lshrrev_b32 v54, 6, v0
    s_nop 0
    v_readfirstlane_b32 s13, v54
    v_and_b32 v57, 63, v0
    v_bfe_u32 v54, v57, 2, 1
    v_lshlrev_b32 v48, 13, v54
    v_bfe_u32 v54, v57, 3, 1
    v_lshl_add_u32 v48, v54, 15, v48
    v_bfe_u32 v54, v57, 4, 1
    v_lshl_add_u32 v48, v54, 14, v48
    v_bfe_u32 v54, v57, 5, 1
    v_lshl_add_u32 v48, v54, 16, v48
    v_lshrrev_b32 v55, 4, v57
    v_and_b32 v55, 2, v55
    v_xor_b32 v55, v55, v57
    v_and_b32 v55, 3, v55
    v_lshl_add_u32 v48, v55, 4, v48
    v_bfe_u32 v54, v57, 2, 1
    v_lshlrev_b32 v51, 6, v54
    v_bfe_u32 v54, v57, 3, 1
    v_lshl_add_u32 v51, v54, 9, v51
    v_bfe_u32 v54, v57, 4, 1
    v_lshl_add_u32 v51, v54, 7, v51
    v_bfe_u32 v54, v57, 5, 1
    v_lshl_add_u32 v51, v54, 12, v51
    v_bfe_u32 v54, v57, 0, 1
    v_lshl_add_u32 v51, v54, 3, v51
    v_bfe_u32 v54, v57, 1, 1
    v_lshl_add_u32 v51, v54, 4, v51
    v_bfe_u32 v54, v57, 3, 1
    v_lshl_add_u32 v51, v54, 5, v51
    v_lshrrev_b32 v55, 3, v57
    v_mul_u32_u24 v49, 1152, v55
    v_and_b32 v55, 7, v57
    v_lshl_add_u32 v49, v55, 4, v49
    v_bfe_u32 v54, v57, 4, 1
    v_lshlrev_b32 v52, 13, v54
    v_bfe_u32 v54, v57, 5, 1
    v_lshl_add_u32 v52, v54, 9, v52
    v_bfe_u32 v54, v57, 2, 1
    v_lshl_add_u32 v52, v54, 7, v52
    v_bfe_u32 v54, v57, 3, 1
    v_lshl_add_u32 v52, v54, 5, v52
    v_and_b32 v55, 3, v57
    v_lshl_add_u32 v52, v55, 3, v52
    v_lshrrev_b32 v55, 2, v57
    v_mul_u32_u24 v50, 1152, v55
    v_and_b32 v55, 3, v57
    v_lshl_add_u32 v50, v55, 4, v50
    v_bfe_u32 v54, v57, 4, 1
    v_lshlrev_b32 v53, 12, v54
    v_bfe_u32 v54, v57, 5, 1
    v_lshl_add_u32 v53, v54, 8, v53
    v_bfe_u32 v54, v57, 2, 1
    v_lshl_add_u32 v53, v54, 6, v53
    v_bfe_u32 v54, v57, 3, 1
    v_lshl_add_u32 v53, v54, 5, v53
    v_and_b32 v55, 3, v57
    v_lshl_add_u32 v53, v55, 3, v53
    s_lshl_b32 s66, s13, 10
    s_and_b32 s93, s13, 1
    s_lshl_b32 s93, s93, 14
    s_and_b32 s75, s13, 2
    s_lshl_b32 s75, s75, 19
    v_add_u32 v51, s66, v51
    v_add_u32 v52, s66, v52
    v_add_u32 v53, s66, v53
    v_mov_b32 v58, v48
    s_mov_b32 s10, 4718592
    s_mov_b32 s11, 0x20000
    s_lshl_b32 s67, s12, 8
    s_lshl_b32 s40, s13, 6
    s_add_u32 s67, s67, s40
    s_mul_i32 s92, s12, 147456
    s_xor_b32 s94, s13, 0
    s_mul_i32 s94, s94, 36864
    s_add_u32 s94, s94, s92
    s_lshl_b32 s74, s13, 7
    s_add_u32 s94, s94, s74
    s_add_u32 s78, s94, 0
    s_mov_b64 s[8:9], s[56:57]
    v_mov_b32 v58, v49
    s_mov_b32 s79, 9216
    s_mov_b32 s81, 0
    s_add_u32 s80, s66, 0
    s_mov_b32 s76, 0
    s_mov_b32 s77, 8192
    s_call_b64 s[82:83], cs_dma
    s_mov_b32 s77, 16384
    s_call_b64 s[82:83], cs_dma
    s_xor_b32 s94, s13, 1
    s_mul_i32 s94, s94, 36864
    s_add_u32 s94, s94, s92
    s_lshl_b32 s74, s13, 7
    s_add_u32 s94, s94, s74
    s_add_u32 s78, s94, 0
    s_add_u32 s80, s66, 16384
    s_mov_b32 s76, 0
    s_mov_b32 s77, 8192
    s_call_b64 s[82:83], cs_dma
    s_mov_b32 s77, 16384
    s_call_b64 s[82:83], cs_dma
    s_xor_b32 s94, s13, 2
    s_mul_i32 s94, s94, 36864
    s_add_u32 s94, s94, s92
    s_lshl_b32 s74, s13, 7
    s_add_u32 s94, s94, s74
    s_add_u32 s78, s94, 0
    s_add_u32 s80, s66, 32768
    s_mov_b32 s76, 0
    s_mov_b32 s77, 8192
    s_call_b64 s[82:83], cs_dma
    v_lshrrev_b32 v24, 6, v0
    v_lshlrev_b32 v61, 4, v0
    v_add_u32 v62, 57344, v61
    v_xor_b32 v63, 1024, v61
    v_add_u32 v63, 98304, v63
    v_xor_b32 v64, 2048, v61
    v_add_u32 v64, 98304, v64
    v_and_b32 v65, 1023, v61
    v_add_u32 v65, 98304, v65
    v_and_b32 v26, 15, v0
    v_bfe_u32 v27, v0, 4, 2
    v_mov_b32 v60, 0x4444
    v_mov_b32 v25, 0xeeee
    v_cmp_lt_u32 vcc, 7, v26
    s_nop 1
    v_cndmask_b32 v60, v60, v25, vcc
    s_mov_b32 s77, 16384
    s_call_b64 s[82:83], cs_dma
    v_and_b32 v67, 12, v26
    v_lshlrev_b32 v67, 3, v67
    v_and_b32 v25, 1, v26
    v_lshl_add_u32 v67, v25, 4, v67
    v_bfe_u32 v25, v26, 1, 1
    v_lshl_add_u32 v67, v25, 3, v67
    v_lshl_add_u32 v66, v27, 14, v67
    v_lshl_add_u32 v66, v24, 17, v66
    s_xor_b32 s94, s13, 3
    s_mul_i32 s94, s94, 36864
    s_add_u32 s94, s94, s92
    s_lshl_b32 s74, s13, 7
    s_add_u32 s94, s94, s74
    s_add_u32 s78, s94, 0
    s_add_u32 s80, s66, 49152
    s_mov_b32 s76, 0
    s_mov_b32 s77, 8192
    s_call_b64 s[82:83], cs_dma
    v_and_b32 v67, 63, v67
    v_lshrrev_b32 v25, 1, v24
    v_lshl_add_u32 v67, v25, 18, v67
    v_lshl_add_u32 v67, v27, 16, v67
    v_lshrrev_b32 v25, 3, v26
    v_lshl_add_u32 v67, v25, 15, v67
    v_and_b32 v25, 1, v24
    v_lshl_add_u32 v67, v25, 6, v67
    s_mov_b32 s77, 16384
    s_call_b64 s[82:83], cs_dma
    v_and_b32 v25, 31, v0
    v_lshlrev_b32 v70, 4, v25
    v_lshlrev_b32 v28, 3, v25
    v_lshl_add_u32 v28, v24, 8, v28
    v_add_u32 v28, 110592, v28
    v_lshrrev_b32 v25, 1, v24
    v_lshl_add_u32 v70, v25, 9, v70
    v_and_b32 v25, 1, v24
    v_lshl_add_u32 v70, v25, 3, v70
    v_add_u32 v70, 109568, v70
    v_cmp_gt_u32 vcc, 2, v27
    s_nop 1
    v_cndmask_b32 v70, v70, v28, vcc
    v_xor_b32 v71, 2048, v63
    v_lshrrev_b32 v68, 4, v0
    v_lshlrev_b32 v68, 7, v68
    v_and_b32 v25, 7, v26
    v_lshl_add_u32 v68, v25, 4, v68
    v_add_u32 v68, 116736, v68
    v_and_b32 v25, 1, v27
    v_lshlrev_b32 v69, 7, v25
    v_lshrrev_b32 v25, 1, v27
    v_lshl_add_u32 v69, v25, 3, v69
    v_and_b32 v25, 3, v26
    v_lshl_add_u32 v69, v25, 4, v69
    v_bfe_u32 v25, v26, 2, 1
    v_lshl_add_u32 v69, v25, 2, v69
    s_mov_b32 s32, 0x00ff00ff
    s_mov_b32 s33, 0x00ff00ff
    s_not_b64 s[34:35], s[32:33]
    s_lshr_b32 s31, s12, 1
    s_lshl_b32 s31, s31, 8
    s_and_b32 s40, s12, 1
    s_lshl_b32 s40, s40, 6
    s_add_u32 s31, s31, s40
    s_and_b32 s40, s13, 1
    s_lshl_b32 s40, s40, 12
    s_add_u32 s31, s31, s40
    s_lshl_b32 s19, s12, 14
    s_add_u32 s19, s19, 68124672
    s_add_u32 s41, s19, 8192
    s_add_u32 s19, s19, s40
    s_and_b32 s40, s12, 1
    s_lshl_b32 s40, s40, 2
    s_or_b32 s40, s40, s13
    s_cmp_eq_u32 s40, 5
    s_cselect_b32 s64, 0, s13
    s_cmp_lg_u32 s13, 1
    s_cbranch_scc1 cs_notx
    s_mov_b32 s32, 0xff
    s_mov_b32 s33, 0xff
    s_mov_b32 s19, s41
    s_lshr_b32 s31, s12, 3
    s_lshl_b32 s31, s31, 8
    s_and_b32 s40, s12, 2
    s_lshl_b32 s40, s40, 6
    s_add_u32 s31, s31, s40
    s_and_b32 s40, s12, 4
    s_lshl_b32 s40, s40, 4
    s_add_u32 s31, s31, s40
    s_add_u32 s31, s31, 8192
cs_notx:
    s_cmp_lg_u32 s13, 0
    s_cbranch_scc1 cs_notp
    s_min_u32 s40, s12, 23
    s_mul_i32 s40, s40, 384
    s_add_u32 s40, s40, 98304
    v_add_u32 v69, s40, v61
    v_mov_b32 v25, 118784
    v_cmp_lt_u32 vcc, 23, v0
    s_nop 1
    v_cndmask_b32 v69, v69, v25, vcc
cs_notp:
    s_nop 1
    v_mov_b32 v28, 1
    v_mov_b32 v29, 1
    v_mov_b32 v30, 1
    v_mov_b32 v31, 1
    s_lshl_b32 s40, s12, 14
    s_add_u32 s40, s40, 68222976
    s_add_u32 s41, s40, 0
    buffer_store_dwordx4 v[28:31], v61, s[4:7], s41 offen sc1
    s_add_u32 s41, s40, 4096
    buffer_store_dwordx4 v[28:31], v61, s[4:7], s41 offen sc1
    s_add_u32 s41, s40, 8192
    buffer_store_dwordx4 v[28:31], v61, s[4:7], s41 offen sc1
    s_cmp_eq_u32 s64, 0
    s_cselect_b64 exec, 0, s[32:33]
    v_mov_b32 v27, -1
    s_add_u32 s41, s31, 68157440
    buffer_store_dword v27, v69, s[4:7], s41 offen sc1
    s_add_u32 s41, s31, 68173824
    buffer_store_dword v27, v69, s[4:7], s41 offen sc1
    s_add_u32 s41, s31, 68190208
    buffer_store_dword v27, v69, s[4:7], s41 offen sc1
    s_add_u32 s41, s31, 68206592
    buffer_store_dword v27, v69, s[4:7], s41 offen sc1
    s_mov_b64 exec, -1
    s_mov_b64 s[68:69], s[48:49]
    s_mov_b32 s70, 9216
    s_mov_b32 s71, 0x20000
    v_and_b32 v25, 7, v0
    v_mul_u32_u24 v25, 1152, v25
    v_lshrrev_b32 v26, 3, v0
    v_lshl_add_u32 v25, v26, 4, v25
    buffer_load_dwordx4 v[36:39], v25, s[68:71], 0 offen
    buffer_load_dwordx4 v[40:43], v25, s[68:71], 0 offen offset:512
    v_bfe_u32 v25, v0, 2, 3
    v_mul_u32_u24 v25, 1152, v25
    v_lshrrev_b32 v26, 5, v0
    v_lshl_add_u32 v25, v26, 4, v25
    v_and_b32 v26, 3, v0
    v_lshl_add_u32 v25, v26, 2, v25
    buffer_load_dword v44, v25, s[68:71], 0 offen offset:1024
    s_waitcnt vmcnt(15)
    v_add_u32 v55, 0, v52
    ds_read_b64_tr_b16 v[176:177], v55 offset:0
    ds_read_b64_tr_b16 v[178:179], v55 offset:256
    ds_read_b64_tr_b16 v[180:181], v55 offset:4096
    ds_read_b64_tr_b16 v[182:183], v55 offset:4352
    s_xor_b32 s94, s13, 1
    s_mul_i32 s94, s94, 36864
    s_add_u32 s94, s94, s92
    s_lshl_b32 s74, s13, 7
    s_add_u32 s94, s94, s74
    s_add_u32 s78, s94, 512
    s_add_u32 s80, s66, 65536
    s_mov_b32 s76, 0
    s_mov_b32 s77, 8192
    s_call_b64 s[82:83], cs_dma
    ds_read_b64_tr_b16 v[208:209], v55 offset:64
    ds_read_b64_tr_b16 v[210:211], v55 offset:320
    ds_read_b64_tr_b16 v[212:213], v55 offset:4160
    ds_read_b64_tr_b16 v[214:215], v55 offset:4416
    s_mov_b32 s77, 16384
    s_call_b64 s[82:83], cs_dma
    s_waitcnt lgkmcnt(0)
    s_waitcnt vmcnt(15)
    v_add_u32 v55, 16384, v52
    ds_read_b64_tr_b16 v[184:185], v55 offset:0
    ds_read_b64_tr_b16 v[186:187], v55 offset:256
    ds_read_b64_tr_b16 v[188:189], v55 offset:4096
    ds_read_b64_tr_b16 v[190:191], v55 offset:4352
    s_xor_b32 s78, s75, 0
    s_add_u32 s78, s78, s67
    s_mov_b64 s[8:9], s[54:55]
    v_mov_b32 v58, v48
    s_mov_b32 s79, 131072
    s_mov_b32 s81, s93
    s_add_u32 s80, s66, 81920
    s_mov_b32 s76, 0
    s_mov_b32 s77, 8192
    s_call_b64 s[82:83], cs_dma
    ds_read_b64_tr_b16 v[216:217], v55 offset:64
    ds_read_b64_tr_b16 v[218:219], v55 offset:320
    ds_read_b64_tr_b16 v[220:221], v55 offset:4160
    ds_read_b64_tr_b16 v[222:223], v55 offset:4416
    s_mov_b32 s77, 16384
    s_call_b64 s[82:83], cs_dma
    s_waitcnt lgkmcnt(0)
    s_waitcnt vmcnt(15)
    v_add_u32 v55, 32768, v52
    ds_read_b64_tr_b16 v[192:193], v55 offset:0
    ds_read_b64_tr_b16 v[194:195], v55 offset:256
    ds_read_b64_tr_b16 v[196:197], v55 offset:4096
    ds_read_b64_tr_b16 v[198:199], v55 offset:4352
    s_mov_b32 s77, 24576
    s_call_b64 s[82:83], cs_dma
    ds_read_b64_tr_b16 v[224:225], v55 offset:64
    ds_read_b64_tr_b16 v[226:227], v55 offset:320
    ds_read_b64_tr_b16 v[228:229], v55 offset:4160
    ds_read_b64_tr_b16 v[230:231], v55 offset:4416
    s_mov_b32 s77, 32768
    s_call_b64 s[82:83], cs_dma
    s_waitcnt lgkmcnt(0)
    s_waitcnt vmcnt(15)
    v_add_u32 v55, 49152, v52
    ds_read_b64_tr_b16 v[200:201], v55 offset:0
    ds_read_b64_tr_b16 v[202:203], v55 offset:256
    ds_read_b64_tr_b16 v[204:205], v55 offset:4096
    ds_read_b64_tr_b16 v[206:207], v55 offset:4352
    s_xor_b32 s78, s75, 1048576
    s_add_u32 s78, s78, s67
    s_add_u32 s80, s66, 0
    s_mov_b32 s76, 0
    s_mov_b32 s77, 8192
    s_call_b64 s[82:83], cs_dma
    ds_read_b64_tr_b16 v[232:233], v55 offset:64
    ds_read_b64_tr_b16 v[234:235], v55 offset:320
    ds_read_b64_tr_b16 v[236:237], v55 offset:4160
    ds_read_b64_tr_b16 v[238:239], v55 offset:4416
    s_mov_b32 s77, 16384
    s_call_b64 s[82:83], cs_dma
    s_waitcnt lgkmcnt(0)
    s_waitcnt vmcnt(12)
    v_add_u32 v55, 65536, v52
    ds_read_b64_tr_b16 v[240:241], v55 offset:0
    ds_read_b64_tr_b16 v[242:243], v55 offset:256
    ds_read_b64_tr_b16 v[244:245], v55 offset:4096
    ds_read_b64_tr_b16 v[246:247], v55 offset:4352
    s_mov_b32 s77, 24576
    s_call_b64 s[82:83], cs_dma
    ds_read_b64_tr_b16 v[248:249], v55 offset:64
    ds_read_b64_tr_b16 v[250:251], v55 offset:320
    ds_read_b64_tr_b16 v[252:253], v55 offset:4160
    ds_read_b64_tr_b16 v[254:255], v55 offset:4416
    s_mov_b32 s77, 32768
    s_call_b64 s[82:83], cs_dma
    s_waitcnt lgkmcnt(0)
    v_min_u32 v36, -2, v36
    v_min_u32 v37, -2, v37
    v_min_u32 v38, -2, v38
    v_min_u32 v39, -2, v39
    v_min_u32 v40, -2, v40
    v_min_u32 v41, -2, v41
    v_min_u32 v42, -2, v42
    v_min_u32 v43, -2, v43
    v_min_u32 v44, -2, v44
    s_lshl_b32 s14, s12, 16
    s_add_u32 s14, s14, 92274688
    s_add_u32 s41, s14, 4096
    s_add_u32 s42, s14, 8192
    v_lshrrev_b32 v45, 2, v61
    buffer_store_dwordx4 v[36:39], v61, s[4:7], s14 offen sc1
    buffer_store_dwordx4 v[40:43], v61, s[4:7], s41 offen sc1
    buffer_store_dword v44, v45, s[4:7], s42 offen sc1
    v_mov_b32 v46, 1
    s_mov_b64 exec, 1
    buffer_atomic_add v46, off, s[96:99], 0 offset:212 sc0
    s_mov_b64 exec, -1
    s_waitcnt vmcnt(9)
    v_add_u32 v55, 81920, v51
    v_xor_b32 v56, 32, v55
    ds_read_b64_tr_b16 a[216:217], v55 offset:0
    ds_read_b64_tr_b16 a[218:219], v55 offset:256
    ds_read_b64_tr_b16 a[220:221], v55 offset:8192
    ds_read_b64_tr_b16 a[222:223], v55 offset:8448
    s_xor_b32 s78, s75, 2097152
    s_add_u32 s78, s78, s67
    s_add_u32 s80, s66, 32768
    s_mov_b32 s76, 0
    s_mov_b32 s77, 8192
    s_call_b64 s[82:83], cs_dma
    ds_read_b64_tr_b16 a[224:225], v56 offset:0
    ds_read_b64_tr_b16 a[226:227], v56 offset:256
    ds_read_b64_tr_b16 a[228:229], v56 offset:8192
    ds_read_b64_tr_b16 a[230:231], v56 offset:8448
    s_mov_b32 s77, 16384
    s_call_b64 s[82:83], cs_dma
    s_waitcnt lgkmcnt(0)
    v_add_u32 v55, 98304, v51
    v_xor_b32 v56, 32, v55
    ds_read_b64_tr_b16 a[232:233], v55 offset:0
    ds_read_b64_tr_b16 a[234:235], v55 offset:256
    ds_read_b64_tr_b16 a[236:237], v55 offset:8192
    ds_read_b64_tr_b16 a[238:239], v55 offset:8448
    s_mov_b32 s77, 24576
    s_call_b64 s[82:83], cs_dma
    ds_read_b64_tr_b16 a[240:241], v56 offset:0
    ds_read_b64_tr_b16 a[242:243], v56 offset:256
    ds_read_b64_tr_b16 a[244:245], v56 offset:8192
    ds_read_b64_tr_b16 a[246:247], v56 offset:8448
    s_mov_b32 s77, 32768
    s_call_b64 s[82:83], cs_dma
    s_waitcnt lgkmcnt(0)
    s_waitcnt vmcnt(9)
    v_add_u32 v55, 0, v51
    v_xor_b32 v56, 32, v55
    ds_read_b64_tr_b16 a[248:249], v55 offset:0
    ds_read_b64_tr_b16 a[250:251], v55 offset:256
    ds_read_b64_tr_b16 a[252:253], v55 offset:8192
    ds_read_b64_tr_b16 a[254:255], v55 offset:8448
    s_xor_b32 s78, s75, 3145728
    s_add_u32 s78, s78, s67
    s_add_u32 s80, s66, 65536
    s_mov_b32 s76, 0
    s_mov_b32 s77, 8192
    s_call_b64 s[82:83], cs_dma
    ds_read_b64_tr_b16 v[72:73], v56 offset:0
    ds_read_b64_tr_b16 v[74:75], v56 offset:256
    ds_read_b64_tr_b16 v[76:77], v56 offset:8192
    ds_read_b64_tr_b16 v[78:79], v56 offset:8448
    s_mov_b32 s77, 16384
    s_call_b64 s[82:83], cs_dma
    s_waitcnt lgkmcnt(0)
    v_add_u32 v55, 16384, v51
    v_xor_b32 v56, 32, v55
    ds_read_b64_tr_b16 v[80:81], v55 offset:0
    ds_read_b64_tr_b16 v[82:83], v55 offset:256
    ds_read_b64_tr_b16 v[84:85], v55 offset:8192
    ds_read_b64_tr_b16 v[86:87], v55 offset:8448
    s_mov_b32 s77, 24576
    s_call_b64 s[82:83], cs_dma
    ds_read_b64_tr_b16 v[88:89], v56 offset:0
    ds_read_b64_tr_b16 v[90:91], v56 offset:256
    ds_read_b64_tr_b16 v[92:93], v56 offset:8192
    ds_read_b64_tr_b16 v[94:95], v56 offset:8448
    s_mov_b32 s77, 32768
    s_call_b64 s[82:83], cs_dma
    s_waitcnt lgkmcnt(0)
    s_waitcnt vmcnt(8)
    v_add_u32 v55, 32768, v51
    v_xor_b32 v56, 32, v55
    ds_read_b64_tr_b16 v[96:97], v55 offset:0
    ds_read_b64_tr_b16 v[98:99], v55 offset:256
    ds_read_b64_tr_b16 v[100:101], v55 offset:8192
    ds_read_b64_tr_b16 v[102:103], v55 offset:8448
    s_add_u32 s78, s67, 4194304
    s_mov_b32 s81, 0
    s_add_u32 s80, s66, 0
    s_mov_b32 s76, 0
    s_mov_b32 s77, 8192
    s_call_b64 s[82:83], cs_dma
    ds_read_b64_tr_b16 v[104:105], v56 offset:0
    ds_read_b64_tr_b16 v[106:107], v56 offset:256
    ds_read_b64_tr_b16 v[108:109], v56 offset:8192
    ds_read_b64_tr_b16 v[110:111], v56 offset:8448
    s_mov_b32 s77, 16384
    s_call_b64 s[82:83], cs_dma
    s_waitcnt lgkmcnt(0)
    v_add_u32 v55, 49152, v51
    v_xor_b32 v56, 32, v55
    ds_read_b64_tr_b16 v[112:113], v55 offset:0
    ds_read_b64_tr_b16 v[114:115], v55 offset:256
    ds_read_b64_tr_b16 v[116:117], v55 offset:8192
    ds_read_b64_tr_b16 v[118:119], v55 offset:8448
    s_xor_b32 s78, s75, 2097152
    s_add_u32 s78, s78, s67
    s_mov_b64 s[8:9], s[52:53]
    s_mov_b32 s81, s93
    s_add_u32 s80, s66, 98304
    s_mov_b32 s76, 0
    s_mov_b32 s77, 8192
    s_call_b64 s[82:83], cs_dma
    ds_read_b64_tr_b16 v[120:121], v56 offset:0
    ds_read_b64_tr_b16 v[122:123], v56 offset:256
    ds_read_b64_tr_b16 v[124:125], v56 offset:8192
    ds_read_b64_tr_b16 v[126:127], v56 offset:8448
    s_mov_b32 s77, 16384
    s_call_b64 s[82:83], cs_dma
    s_waitcnt lgkmcnt(0)
    v_readfirstlane_b32 s41, v46
    v_mov_b32 v36, 1
    v_mov_b32 v37, 0
    s_cmp_eq_u32 s41, 127
    s_cselect_b64 exec, 1, 0
    buffer_atomic_cmpswap v[36:37], off, s[96:99], 0 offset:216
    s_mov_b64 exec, -1
    s_waitcnt vmcnt(8)
    v_add_u32 v55, 65536, v51
    v_xor_b32 v56, 32, v55
    ds_read_b64_tr_b16 v[128:129], v55 offset:0
    ds_read_b64_tr_b16 v[130:131], v55 offset:256
    ds_read_b64_tr_b16 v[132:133], v55 offset:8192
    ds_read_b64_tr_b16 v[134:135], v55 offset:8448
    s_mov_b32 s77, 24576
    s_call_b64 s[82:83], cs_dma
    ds_read_b64_tr_b16 v[136:137], v56 offset:0
    ds_read_b64_tr_b16 v[138:139], v56 offset:256
    ds_read_b64_tr_b16 v[140:141], v56 offset:8192
    ds_read_b64_tr_b16 v[142:143], v56 offset:8448
    s_mov_b32 s77, 32768
    s_call_b64 s[82:83], cs_dma
    s_waitcnt lgkmcnt(0)
    v_add_u32 v55, 81920, v51
    v_xor_b32 v56, 32, v55
    ds_read_b64_tr_b16 v[144:145], v55 offset:0
    ds_read_b64_tr_b16 v[146:147], v55 offset:256
    ds_read_b64_tr_b16 v[148:149], v55 offset:8192
    ds_read_b64_tr_b16 v[150:151], v55 offset:8448
    s_xor_b32 s78, s75, 3145728
    s_add_u32 s78, s78, s67
    s_add_u32 s80, s66, 16384
    s_mov_b32 s76, 0
    s_mov_b32 s77, 8192
    s_call_b64 s[82:83], cs_dma
    ds_read_b64_tr_b16 v[152:153], v56 offset:0
    ds_read_b64_tr_b16 v[154:155], v56 offset:256
    ds_read_b64_tr_b16 v[156:157], v56 offset:8192
    ds_read_b64_tr_b16 v[158:159], v56 offset:8448
    s_mov_b32 s77, 16384
    s_call_b64 s[82:83], cs_dma
    s_waitcnt lgkmcnt(0)
    s_waitcnt vmcnt(12)
    v_add_u32 v55, 0, v51
    v_xor_b32 v56, 32, v55
    ds_read_b64_tr_b16 v[160:161], v55 offset:0
    ds_read_b64_tr_b16 v[162:163], v55 offset:256
    ds_read_b64_tr_b16 v[164:165], v55 offset:8192
    ds_read_b64_tr_b16 v[166:167], v55 offset:8448
    s_mov_b32 s77, 24576
    s_call_b64 s[82:83], cs_dma
    ds_read_b64_tr_b16 v[168:169], v56 offset:0
    ds_read_b64_tr_b16 v[170:171], v56 offset:256
    ds_read_b64_tr_b16 v[172:173], v56 offset:8192
    ds_read_b64_tr_b16 v[174:175], v56 offset:8448
    s_mov_b32 s77, 32768
    s_call_b64 s[82:83], cs_dma
    s_waitcnt lgkmcnt(0)
    s_waitcnt vmcnt(8)
    v_add_u32 v55, 98304, v51
    v_xor_b32 v56, 32, v55
    ds_read_b64_tr_b16 a[136:137], v55 offset:0
    ds_read_b64_tr_b16 a[138:139], v55 offset:256
    ds_read_b64_tr_b16 a[140:141], v55 offset:8192
    ds_read_b64_tr_b16 a[142:143], v55 offset:8448
    s_add_u32 s78, s67, 4194304
    s_mov_b32 s81, 0
    s_add_u32 s80, s66, 0
    s_mov_b32 s76, 0
    s_mov_b32 s77, 8192
    s_call_b64 s[82:83], cs_dma
    ds_read_b64_tr_b16 a[144:145], v56 offset:0
    ds_read_b64_tr_b16 a[146:147], v56 offset:256
    ds_read_b64_tr_b16 a[148:149], v56 offset:8192
    ds_read_b64_tr_b16 a[150:151], v56 offset:8448
    s_mov_b32 s77, 16384
    s_call_b64 s[82:83], cs_dma
    s_waitcnt lgkmcnt(0)
    v_add_u32 v55, 114688, v51
    v_xor_b32 v56, 32, v55
    ds_read_b64_tr_b16 a[152:153], v55 offset:0
    ds_read_b64_tr_b16 a[154:155], v55 offset:256
    ds_read_b64_tr_b16 a[156:157], v55 offset:8192
    ds_read_b64_tr_b16 a[158:159], v55 offset:8448
    s_xor_b32 s78, s75, 2097152
    s_add_u32 s78, s78, s67
    s_mov_b64 s[8:9], s[50:51]
    s_mov_b32 s81, s93
    s_add_u32 s80, s66, 49152
    s_mov_b32 s76, 0
    s_mov_b32 s77, 8192
    s_call_b64 s[82:83], cs_dma
    ds_read_b64_tr_b16 a[160:161], v56 offset:0
    ds_read_b64_tr_b16 a[162:163], v56 offset:256
    ds_read_b64_tr_b16 a[164:165], v56 offset:8192
    ds_read_b64_tr_b16 a[166:167], v56 offset:8448
    s_mov_b32 s77, 16384
    s_call_b64 s[82:83], cs_dma
    s_waitcnt lgkmcnt(0)
    s_waitcnt vmcnt(8)
    v_add_u32 v55, 16384, v51
    v_xor_b32 v56, 32, v55
    ds_read_b64_tr_b16 a[168:169], v55 offset:0
    ds_read_b64_tr_b16 a[170:171], v55 offset:256
    ds_read_b64_tr_b16 a[172:173], v55 offset:8192
    ds_read_b64_tr_b16 a[174:175], v55 offset:8448
    s_mov_b32 s77, 24576
    s_call_b64 s[82:83], cs_dma
    ds_read_b64_tr_b16 a[176:177], v56 offset:0
    ds_read_b64_tr_b16 a[178:179], v56 offset:256
    ds_read_b64_tr_b16 a[180:181], v56 offset:8192
    ds_read_b64_tr_b16 a[182:183], v56 offset:8448
    s_mov_b32 s77, 32768
    s_call_b64 s[82:83], cs_dma
    s_waitcnt lgkmcnt(0)
    v_add_u32 v55, 32768, v51
    v_xor_b32 v56, 32, v55
    ds_read_b64_tr_b16 a[184:185], v55 offset:0
    ds_read_b64_tr_b16 a[186:187], v55 offset:256
    ds_read_b64_tr_b16 a[188:189], v55 offset:8192
    ds_read_b64_tr_b16 a[190:191], v55 offset:8448
    s_xor_b32 s78, s75, 3145728
    s_add_u32 s78, s78, s67
    s_add_u32 s80, s66, 81920
    s_mov_b32 s76, 0
    s_mov_b32 s77, 8192
    s_call_b64 s[82:83], cs_dma
    ds_read_b64_tr_b16 a[192:193], v56 offset:0
    ds_read_b64_tr_b16 a[194:195], v56 offset:256
    ds_read_b64_tr_b16 a[196:197], v56 offset:8192
    ds_read_b64_tr_b16 a[198:199], v56 offset:8448
    s_mov_b32 s77, 16384
    s_call_b64 s[82:83], cs_dma
    s_waitcnt lgkmcnt(0)
    s_waitcnt vmcnt(12)
    v_add_u32 v55, 0, v51
    v_xor_b32 v56, 32, v55
    ds_read_b64_tr_b16 a[200:201], v55 offset:0
    ds_read_b64_tr_b16 a[202:203], v55 offset:256
    ds_read_b64_tr_b16 a[204:205], v55 offset:8192
    ds_read_b64_tr_b16 a[206:207], v55 offset:8448
    s_mov_b32 s77, 24576
    s_call_b64 s[82:83], cs_dma
    ds_read_b64_tr_b16 a[208:209], v56 offset:0
    ds_read_b64_tr_b16 a[210:211], v56 offset:256
    ds_read_b64_tr_b16 a[212:213], v56 offset:8192
    ds_read_b64_tr_b16 a[214:215], v56 offset:8448
    s_mov_b32 s77, 32768
    s_call_b64 s[82:83], cs_dma
    s_waitcnt lgkmcnt(0)
    s_waitcnt vmcnt(8)
    v_add_u32 v55, 49152, v51
    v_xor_b32 v56, 32, v55
    ds_read_b64_tr_b16 a[56:57], v55 offset:0
    ds_read_b64_tr_b16 a[58:59], v55 offset:256
    ds_read_b64_tr_b16 a[60:61], v55 offset:8192
    ds_read_b64_tr_b16 a[62:63], v55 offset:8448
    s_add_u32 s78, s67, 4194304
    s_mov_b32 s81, 0
    s_add_u32 s80, s66, 114688
    s_mov_b32 s76, 0
    s_mov_b32 s77, 8192
    s_call_b64 s[82:83], cs_dma
    ds_read_b64_tr_b16 a[64:65], v56 offset:0
    ds_read_b64_tr_b16 a[66:67], v56 offset:256
    ds_read_b64_tr_b16 a[68:69], v56 offset:8192
    ds_read_b64_tr_b16 a[70:71], v56 offset:8448
    s_mov_b32 s77, 16384
    s_call_b64 s[82:83], cs_dma
    s_waitcnt lgkmcnt(0)
    v_add_u32 v55, 65536, v51
    v_xor_b32 v56, 32, v55
    ds_read_b64_tr_b16 a[72:73], v55 offset:0
    ds_read_b64_tr_b16 a[74:75], v55 offset:256
    ds_read_b64_tr_b16 a[76:77], v55 offset:8192
    ds_read_b64_tr_b16 a[78:79], v55 offset:8448
    s_xor_b32 s78, s75, 1048576
    s_add_u32 s78, s78, s67
    s_mov_b32 s81, s93
    s_add_u32 s80, s66, 131072
    s_mov_b32 s76, 0
    s_mov_b32 s77, 8192
    s_call_b64 s[82:83], cs_dma
    ds_read_b64_tr_b16 a[80:81], v56 offset:0
    ds_read_b64_tr_b16 a[82:83], v56 offset:256
    ds_read_b64_tr_b16 a[84:85], v56 offset:8192
    ds_read_b64_tr_b16 a[86:87], v56 offset:8448
    s_mov_b32 s77, 16384
    s_call_b64 s[82:83], cs_dma
    s_waitcnt lgkmcnt(0)
    s_waitcnt vmcnt(8)
    v_add_u32 v55, 81920, v51
    v_xor_b32 v56, 32, v55
    ds_read_b64_tr_b16 a[88:89], v55 offset:0
    ds_read_b64_tr_b16 a[90:91], v55 offset:256
    ds_read_b64_tr_b16 a[92:93], v55 offset:8192
    ds_read_b64_tr_b16 a[94:95], v55 offset:8448
    s_mov_b32 s77, 24576
    s_call_b64 s[82:83], cs_dma
    ds_read_b64_tr_b16 a[96:97], v56 offset:0
    ds_read_b64_tr_b16 a[98:99], v56 offset:256
    ds_read_b64_tr_b16 a[100:101], v56 offset:8192
    ds_read_b64_tr_b16 a[102:103], v56 offset:8448
    s_mov_b32 s77, 32768
    s_call_b64 s[82:83], cs_dma
    s_waitcnt lgkmcnt(0)
    v_add_u32 v55, 98304, v51
    v_xor_b32 v56, 32, v55
    ds_read_b64_tr_b16 a[104:105], v55 offset:0
    ds_read_b64_tr_b16 a[106:107], v55 offset:256
    ds_read_b64_tr_b16 a[108:109], v55 offset:8192
    ds_read_b64_tr_b16 a[110:111], v55 offset:8448
    s_xor_b32 s78, s75, 0
    s_add_u32 s78, s78, s67
    s_add_u32 s80, s66, 32768
    s_mov_b32 s76, 0
    s_mov_b32 s77, 8192
    s_call_b64 s[82:83], cs_dma
    ds_read_b64_tr_b16 a[112:113], v56 offset:0
    ds_read_b64_tr_b16 a[114:115], v56 offset:256
    ds_read_b64_tr_b16 a[116:117], v56 offset:8192
    ds_read_b64_tr_b16 a[118:119], v56 offset:8448
    s_mov_b32 s77, 16384
    s_call_b64 s[82:83], cs_dma
    s_waitcnt lgkmcnt(0)
    s_waitcnt vmcnt(12)
    v_add_u32 v55, 114688, v51
    v_xor_b32 v56, 32, v55
    ds_read_b64_tr_b16 a[120:121], v55 offset:0
    ds_read_b64_tr_b16 a[122:123], v55 offset:256
    ds_read_b64_tr_b16 a[124:125], v55 offset:8192
    ds_read_b64_tr_b16 a[126:127], v55 offset:8448
    s_mov_b32 s77, 24576
    s_call_b64 s[82:83], cs_dma
    ds_read_b64_tr_b16 a[128:129], v56 offset:0
    ds_read_b64_tr_b16 a[130:131], v56 offset:256
    ds_read_b64_tr_b16 a[132:133], v56 offset:8192
    ds_read_b64_tr_b16 a[134:135], v56 offset:8448
    s_mov_b32 s77, 32768
    s_call_b64 s[82:83], cs_dma
    s_waitcnt lgkmcnt(0)
    s_waitcnt vmcnt(8)
    v_add_u32 v55, 131072, v51
    v_xor_b32 v56, 32, v55
    ds_read_b64_tr_b16 a[24:25], v55 offset:0
    ds_read_b64_tr_b16 a[26:27], v55 offset:256
    ds_read_b64_tr_b16 a[28:29], v55 offset:8192
    ds_read_b64_tr_b16 a[30:31], v55 offset:8448
    s_xor_b32 s78, s75, 0
    s_add_u32 s78, s78, s67
    s_mov_b64 s[8:9], s[52:53]
    s_add_u32 s80, s66, 0
    s_mov_b32 s76, 0
    s_mov_b32 s77, 8192
    s_call_b64 s[82:83], cs_dma
    ds_read_b64_tr_b16 a[32:33], v56 offset:0
    ds_read_b64_tr_b16 a[34:35], v56 offset:256
    ds_read_b64_tr_b16 a[36:37], v56 offset:8192
    ds_read_b64_tr_b16 a[38:39], v56 offset:8448
    s_mov_b32 s77, 16384
    s_call_b64 s[82:83], cs_dma
    s_waitcnt lgkmcnt(0)
    v_add_u32 v55, 147456, v51
    v_xor_b32 v56, 32, v55
    ds_read_b64_tr_b16 a[40:41], v55 offset:0
    ds_read_b64_tr_b16 a[42:43], v55 offset:256
    ds_read_b64_tr_b16 a[44:45], v55 offset:8192
    ds_read_b64_tr_b16 a[46:47], v55 offset:8448
    s_mov_b32 s77, 24576
    s_call_b64 s[82:83], cs_dma
    ds_read_b64_tr_b16 a[48:49], v56 offset:0
    ds_read_b64_tr_b16 a[50:51], v56 offset:256
    ds_read_b64_tr_b16 a[52:53], v56 offset:8192
    ds_read_b64_tr_b16 a[54:55], v56 offset:8448
    s_mov_b32 s77, 32768
    s_call_b64 s[82:83], cs_dma
    s_waitcnt lgkmcnt(0)
    s_waitcnt vmcnt(8)
    v_add_u32 v55, 32768, v51
    v_xor_b32 v56, 32, v55
    ds_read_b64_tr_b16 a[0:1], v55 offset:0
    ds_read_b64_tr_b16 a[2:3], v55 offset:256
    ds_read_b64_tr_b16 a[4:5], v55 offset:8192
    ds_read_b64_tr_b16 a[6:7], v55 offset:8448
    ds_read_b64_tr_b16 v[8:9], v56 offset:0
    ds_read_b64_tr_b16 v[10:11], v56 offset:256
    ds_read_b64_tr_b16 v[12:13], v56 offset:8192
    ds_read_b64_tr_b16 v[14:15], v56 offset:8448
    s_waitcnt lgkmcnt(0)
    s_barrier
    ds_write_b128 v63, v[8:11] offset:57344
    ds_write_b128 v63, v[12:15] offset:61440
    s_waitcnt lgkmcnt(0)
    v_add_u32 v55, 49152, v51
    v_xor_b32 v56, 32, v55
    ds_read_b64_tr_b16 a[8:9], v55 offset:0
    ds_read_b64_tr_b16 a[10:11], v55 offset:256
    ds_read_b64_tr_b16 a[12:13], v55 offset:8192
    ds_read_b64_tr_b16 a[14:15], v55 offset:8448
    ds_read_b64_tr_b16 a[16:17], v56 offset:0
    ds_read_b64_tr_b16 a[18:19], v56 offset:256
    ds_read_b64_tr_b16 a[20:21], v56 offset:8192
    ds_read_b64_tr_b16 a[22:23], v56 offset:8448
    s_waitcnt lgkmcnt(0)
    s_xor_b32 s78, s75, 1048576
    s_add_u32 s78, s78, s67
    s_add_u32 s80, s66, 32768
    s_mov_b32 s76, 0
    s_mov_b32 s77, 8192
    s_call_b64 s[82:83], cs_dma
    s_mov_b32 s77, 16384
    s_call_b64 s[82:83], cs_dma
    s_mov_b32 s77, 24576
    s_call_b64 s[82:83], cs_dma
    s_mov_b32 s77, 32768
    s_call_b64 s[82:83], cs_dma
    s_waitcnt vmcnt(8)
    v_add_u32 v55, 0, v51
    v_xor_b32 v56, 32, v55
    ds_read_b64_tr_b16 v[0:1], v55 offset:0
    ds_read_b64_tr_b16 v[2:3], v55 offset:256
    ds_read_b64_tr_b16 v[4:5], v55 offset:8192
    ds_read_b64_tr_b16 v[6:7], v55 offset:8448
    s_xor_b32 s94, s13, 0
    s_mul_i32 s94, s94, 36864
    s_add_u32 s94, s94, s92
    s_lshl_b32 s74, s13, 7
    s_add_u32 s94, s94, s74
    s_add_u32 s78, s94, 512
    s_mov_b64 s[8:9], s[56:57]
    v_mov_b32 v58, v49
    s_mov_b32 s79, 9216
    s_mov_b32 s81, 0
    s_add_u32 s80, s66, 65536
    s_mov_b32 s76, 0
    s_mov_b32 s77, 8192
    s_call_b64 s[82:83], cs_dma
    ds_read_b64_tr_b16 v[8:9], v56 offset:0
    ds_read_b64_tr_b16 v[10:11], v56 offset:256
    ds_read_b64_tr_b16 v[12:13], v56 offset:8192
    ds_read_b64_tr_b16 v[14:15], v56 offset:8448
    s_mov_b32 s77, 16384
    s_call_b64 s[82:83], cs_dma
    s_waitcnt lgkmcnt(0)
    ds_write_b128 v61, v[0:3] offset:0
    ds_write_b128 v61, v[4:7] offset:4096
    ds_write_b128 v61, v[8:11] offset:8192
    ds_write_b128 v61, v[12:15] offset:12288
    s_waitcnt lgkmcnt(0)
    v_add_u32 v55, 16384, v51
    v_xor_b32 v56, 32, v55
    ds_read_b64_tr_b16 v[0:1], v55 offset:0
    ds_read_b64_tr_b16 v[2:3], v55 offset:256
    ds_read_b64_tr_b16 v[4:5], v55 offset:8192
    ds_read_b64_tr_b16 v[6:7], v55 offset:8448
    s_xor_b32 s94, s13, 2
    s_mul_i32 s94, s94, 36864
    s_add_u32 s94, s94, s92
    s_lshl_b32 s74, s13, 7
    s_add_u32 s94, s94, s74
    s_add_u32 s78, s94, 512
    s_add_u32 s80, s66, 81920
    s_mov_b32 s76, 0
    s_mov_b32 s77, 8192
    s_call_b64 s[82:83], cs_dma
    ds_read_b64_tr_b16 v[8:9], v56 offset:0
    ds_read_b64_tr_b16 v[10:11], v56 offset:256
    ds_read_b64_tr_b16 v[12:13], v56 offset:8192
    ds_read_b64_tr_b16 v[14:15], v56 offset:8448
    s_mov_b32 s77, 16384
    s_call_b64 s[82:83], cs_dma
    s_waitcnt lgkmcnt(0)
    ds_write_b128 v61, v[0:3] offset:16384
    ds_write_b128 v61, v[4:7] offset:20480
    ds_write_b128 v61, v[8:11] offset:24576
    ds_write_b128 v61, v[12:15] offset:28672
    s_waitcnt lgkmcnt(0)
    s_waitcnt vmcnt(8)
    v_add_u32 v55, 32768, v51
    v_xor_b32 v56, 32, v55
    ds_read_b64_tr_b16 v[0:1], v55 offset:0
    ds_read_b64_tr_b16 v[2:3], v55 offset:256
    ds_read_b64_tr_b16 v[4:5], v55 offset:8192
    ds_read_b64_tr_b16 v[6:7], v55 offset:8448
    s_xor_b32 s94, s13, 3
    s_mul_i32 s94, s94, 36864
    s_add_u32 s94, s94, s92
    s_lshl_b32 s74, s13, 7
    s_add_u32 s94, s94, s74
    s_add_u32 s78, s94, 512
    s_add_u32 s80, s66, 122880
    s_mov_b32 s76, 0
    s_mov_b32 s77, 8192
    s_call_b64 s[82:83], cs_dma
    ds_read_b64_tr_b16 v[8:9], v56 offset:0
    ds_read_b64_tr_b16 v[10:11], v56 offset:256
    ds_read_b64_tr_b16 v[12:13], v56 offset:8192
    ds_read_b64_tr_b16 v[14:15], v56 offset:8448
    s_mov_b32 s77, 16384
    s_call_b64 s[82:83], cs_dma
    s_waitcnt lgkmcnt(0)
    ds_write_b128 v61, v[0:3] offset:32768
    ds_write_b128 v61, v[4:7] offset:36864
    ds_write_b128 v61, v[8:11] offset:40960
    ds_write_b128 v61, v[12:15] offset:45056
    s_waitcnt lgkmcnt(0)
    v_add_u32 v55, 49152, v51
    v_xor_b32 v56, 32, v55
    ds_read_b64_tr_b16 v[0:1], v55 offset:0
    ds_read_b64_tr_b16 v[2:3], v55 offset:256
    ds_read_b64_tr_b16 v[4:5], v55 offset:8192
    ds_read_b64_tr_b16 v[6:7], v55 offset:8448
    s_xor_b32 s94, s13, 0
    s_mul_i32 s94, s94, 36864
    s_add_u32 s94, s94, s92
    s_lshr_b32 s74, s13, 1
    s_lshl_b32 s74, s74, 6
    s_add_u32 s94, s94, s74
    s_add_u32 s78, s94, 1024
    v_mov_b32 v58, v50
    s_mov_b32 s79, 18432
    s_add_u32 s80, s66, 139264
    s_mov_b32 s76, 0
    s_mov_b32 s77, 8192
    s_call_b64 s[82:83], cs_dma
    ds_read_b64_tr_b16 v[8:9], v56 offset:0
    ds_read_b64_tr_b16 v[10:11], v56 offset:256
    ds_read_b64_tr_b16 v[12:13], v56 offset:8192
    ds_read_b64_tr_b16 v[14:15], v56 offset:8448
    s_xor_b32 s94, s13, 2
    s_mul_i32 s94, s94, 36864
    s_add_u32 s94, s94, s92
    s_lshr_b32 s74, s13, 1
    s_lshl_b32 s74, s74, 6
    s_add_u32 s94, s94, s74
    s_add_u32 s78, s94, 1024
    s_mov_b32 s77, 16384
    s_call_b64 s[82:83], cs_dma
    s_waitcnt lgkmcnt(0)
    ds_write_b128 v61, v[0:3] offset:49152
    ds_write_b128 v61, v[4:7] offset:53248
    ds_write_b128 v61, v[8:11] offset:57344
    ds_write_b128 v61, v[12:15] offset:61440
    s_waitcnt lgkmcnt(0)
    buffer_load_dword v38, off, s[96:99], 0 offset:216 sc1
    buffer_load_dword v39, off, s[96:99], 0 offset:144 sc1
    s_lshr_b32 s84, s12, 1
    s_lshl_b32 s84, s84, 8
    s_add_u32 s84, s84, 125829120
    v_bfe_u32 v40, v61, 4, 6
    v_min_u32 v40, 11, v40
    v_lshlrev_b32 v40, 2, v40
    buffer_load_dword v41, v40, s[4:7], s84 offen sc1
    s_waitcnt vmcnt(15)
    v_add_u32 v55, 65536, v52
    ds_read_b64_tr_b16 v[0:1], v55 offset:0
    ds_read_b64_tr_b16 v[2:3], v55 offset:256
    ds_read_b64_tr_b16 v[4:5], v55 offset:4096
    ds_read_b64_tr_b16 v[6:7], v55 offset:4352
    ds_read_b64_tr_b16 v[8:9], v55 offset:64
    ds_read_b64_tr_b16 v[10:11], v55 offset:320
    ds_read_b64_tr_b16 v[12:13], v55 offset:4160
    ds_read_b64_tr_b16 v[14:15], v55 offset:4416
    s_waitcnt lgkmcnt(0)
    ds_write_b128 v62, v[0:3] offset:8192
    ds_write_b128 v62, v[4:7] offset:12288
    ds_write_b128 v62, v[8:11] offset:16384
    ds_write_b128 v62, v[12:15] offset:20480
    s_waitcnt lgkmcnt(0)
    s_waitcnt vmcnt(11)
    v_add_u32 v55, 81920, v52
    ds_read_b64_tr_b16 v[0:1], v55 offset:0
    ds_read_b64_tr_b16 v[2:3], v55 offset:256
    ds_read_b64_tr_b16 v[4:5], v55 offset:4096
    ds_read_b64_tr_b16 v[6:7], v55 offset:4352
    ds_read_b64_tr_b16 v[8:9], v55 offset:64
    ds_read_b64_tr_b16 v[10:11], v55 offset:320
    ds_read_b64_tr_b16 v[12:13], v55 offset:4160
    ds_read_b64_tr_b16 v[14:15], v55 offset:4416
    s_waitcnt lgkmcnt(0)
    ds_write_b128 v62, v[0:3] offset:24576
    ds_write_b128 v62, v[4:7] offset:28672
    ds_write_b128 v62, v[8:11] offset:32768
    ds_write_b128 v62, v[12:15] offset:36864
    s_waitcnt lgkmcnt(0)
    s_waitcnt vmcnt(7)
    v_add_u32 v55, 122880, v52
    ds_read_b64_tr_b16 v[0:1], v55 offset:0
    ds_read_b64_tr_b16 v[2:3], v55 offset:256
    ds_read_b64_tr_b16 v[4:5], v55 offset:4096
    ds_read_b64_tr_b16 v[6:7], v55 offset:4352
    ds_read_b64_tr_b16 v[8:9], v55 offset:64
    ds_read_b64_tr_b16 v[10:11], v55 offset:320
    ds_read_b64_tr_b16 v[12:13], v55 offset:4160
    ds_read_b64_tr_b16 v[14:15], v55 offset:4416
    s_waitcnt lgkmcnt(0)
    s_barrier
    ds_write_b128 v63, v[0:3] offset:24576
    ds_write_b128 v63, v[4:7] offset:28672
    s_barrier
    ds_write_b128 v63, v[8:11] offset:32768
    ds_write_b128 v63, v[12:15] offset:36864
    s_waitcnt lgkmcnt(0)
    s_waitcnt vmcnt(3)
    v_add_u32 v55, 139264, v53
    ds_read_b64_tr_b16 v[0:1], v55 offset:0
    ds_read_b64_tr_b16 v[2:3], v55 offset:128
    ds_read_b64_tr_b16 v[4:5], v55 offset:512
    ds_read_b64_tr_b16 v[6:7], v55 offset:640
    ds_read_b64_tr_b16 v[8:9], v55 offset:8192
    ds_read_b64_tr_b16 v[10:11], v55 offset:8320
    ds_read_b64_tr_b16 v[12:13], v55 offset:8704
    ds_read_b64_tr_b16 v[14:15], v55 offset:8832
    s_waitcnt lgkmcnt(0)
    s_barrier
    ds_write_b128 v63, v[0:3] offset:40960
    ds_write_b128 v63, v[4:7] offset:45056
    s_barrier
    ds_write_b128 v63, v[8:11] offset:49152
    ds_write_b128 v63, v[12:15] offset:53248
    s_waitcnt lgkmcnt(0)
    s_barrier
    s_waitcnt vmcnt(0)
    v_readfirstlane_b32 s95, v39
    v_readfirstlane_b32 s85, v38
    s_nop 4
    s_mov_b32 s88, 4194304
gn3:
    s_cmp_lg_u32 s95, 0
    s_cbranch_scc1 gn3x
    buffer_load_dword v24, off, s[96:99], 0 offset:144 sc1
    s_sub_u32 s88, s88, 1
    s_cbranch_scc1 gn3x
    s_waitcnt vmcnt(0)
    v_readfirstlane_b32 s95, v24
    s_nop 1
    s_branch gn3
gn3x:
    s_add_u32 s93, s95, 2
    v_subrev_u32 v41, s93, v41
    v_cmp_lt_u32 s[86:87], 64, v41
    v_bfe_u32 v40, v61, 4, 4
    v_bfe_u32 v41, v61, 8, 1
    v_lshlrev_b32 v41, 2, v41
    v_sub_u32 v41, v40, v41
    v_mov_b32 v42, 0x3f80
    v_mov_b32 v43, 0x3f800000
    v_cmp_eq_u32 vcc, 0, v41
    s_nop 1
    v_cndmask_b32 v32, 0, v42, vcc
    v_cmp_eq_u32 vcc, 1, v41
    s_nop 1
    v_cndmask_b32 v32, v32, v43, vcc
    v_cmp_eq_u32 vcc, 0, v40
    s_nop 1
    v_cndmask_b32 v36, 0, v42, vcc
    v_cmp_eq_u32 vcc, 1, v40
    s_nop 1
    v_cndmask_b32 v36, v36, v43, vcc
    v_cmp_eq_u32 vcc, 2, v41
    s_nop 1
    v_cndmask_b32 v33, 0, v42, vcc
    v_cmp_eq_u32 vcc, 3, v41
    s_nop 1
    v_cndmask_b32 v33, v33, v43, vcc
    v_cmp_eq_u32 vcc, 2, v40
    s_nop 1
    v_cndmask_b32 v37, 0, v42, vcc
    v_cmp_eq_u32 vcc, 3, v40
    s_nop 1
    v_cndmask_b32 v37, v37, v43, vcc
    v_cmp_eq_u32 vcc, 8, v41
    s_nop 1
    v_cndmask_b32 v34, 0, v42, vcc
    v_cmp_eq_u32 vcc, 9, v41
    s_nop 1
    v_cndmask_b32 v34, v34, v43, vcc
    v_cmp_eq_u32 vcc, 4, v40
    s_nop 1
    v_cndmask_b32 v38, 0, v42, vcc
    v_cmp_eq_u32 vcc, 5, v40
    s_nop 1
    v_cndmask_b32 v38, v38, v43, vcc
    v_cmp_eq_u32 vcc, 10, v41
    s_nop 1
    v_cndmask_b32 v35, 0, v42, vcc
    v_cmp_eq_u32 vcc, 11, v41
    s_nop 1
    v_cndmask_b32 v35, v35, v43, vcc
    v_cmp_eq_u32 vcc, 6, v40
    s_nop 1
    v_cndmask_b32 v39, 0, v42, vcc
    v_cmp_eq_u32 vcc, 7, v40
    s_nop 1
    v_cndmask_b32 v39, v39, v43, vcc
    ds_write_b128 v65, v[32:35] offset:9216
    ds_write_b128 v65, v[36:39] offset:10240
    v_mov_b32 v44, s95
    v_mov_b32 v45, s95
    v_mov_b32 v46, s95
    v_mov_b32 v47, s95
    v_mov_b32 v48, 118784
    ds_write_b128 v48, v[44:47]
    s_waitcnt vmcnt(0) lgkmcnt(0)
    s_cmp_eq_u32 s85, 1
    s_cbranch_scc1 cs_run
    s_mov_b32 s40, 16777216
cs_startpoll:
    buffer_load_dword v3, off, s[96:99], 0 offset:216 sc1
    s_waitcnt vmcnt(0)
    v_readfirstlane_b32 s85, v3
    s_nop 0
    s_cmp_eq_u32 s85, 1
    s_cbranch_scc1 cs_run
    s_sleep 1
    s_sub_u32 s40, s40, 1
    s_cbranch_scc0 cs_startpoll
    s_endpgm
cs_run:
    s_cmp_eq_u64 s[86:87], 0
    s_cbranch_scc1 cs_kv0_go
    s_lshr_b32 s92, s12, 1
    s_lshl_b32 s92, s92, 8
    s_add_u32 s92, s92, 125829120
    v_bfe_u32 v2, v61, 4, 6
    v_min_u32 v2, 11, v2
    v_lshlrev_b32 v2, 2, v2
    s_add_u32 s93, s95, 2
    s_mov_b32 s94, 4194304
cs_kv0:
    buffer_load_dword v3, v2, s[4:7], s92 offen sc1
    s_sub_u32 s94, s94, 1
    s_cbranch_scc1 cs_kv0_go
    s_waitcnt vmcnt(0)
    v_subrev_u32 v3, s93, v3
    v_cmp_lt_u32 vcc, 64, v3
    s_cbranch_vccz cs_kv0_go
    s_sleep 2
    s_branch cs_kv0
cs_kv0_go:
    s_mov_b32 s44, 0x3e0293ee
    s_mov_b32 s45, s44
    s_or_b32 s46, s44, 0x80000000
    s_mov_b32 s47, 128
    s_mov_b32 s60, 0x3f803f80
    s_mov_b32 s61, s60
    s_mov_b32 s62, 0x3e803e80
    s_mov_b32 s63, s62
    s_mov_b32 s28, 0
    s_lshl_b32 s24, s12, 14
    s_add_u32 s24, s24, 0
    s_add_u32 s66, s24, 33030144
    s_mul_i32 s40, s13, 3072
    s_add_u32 s23, s24, s40
    s_lshl_b32 s20, s12, 7
    s_add_u32 s20, s20, 68222976
    s_add_u32 s21, s20, 65536
    s_add_u32 s38, s20, 4096
    s_add_u32 s39, s21, 4096
    s_lshl_b32 s22, s12, 7
    s_add_u32 s22, s22, 68231168
    s_lshl_b32 s40, s12, 12
    s_add_u32 s25, s40, 79429632
    s_add_u32 s26, s40, 88866816
    s_lshl_b32 s65, s12, 9
    s_add_u32 s65, s65, 90177536
    s_lshl_b32 s40, s13, 5
    s_or_b32 s40, s40, s12
    s_cmp_lt_u32 s40, 24
    s_cselect_b32 s36, 0x1ffffff, 0
    s_mov_b32 s37, 0
    s_lshl_b32 s27, s12, 7
    s_add_u32 s27, s27, 125845504
    s_lshl_b32 s40, s13, 2
    s_add_u32 s27, s27, s40
    s_mov_b32 m0, 111616
    v_lshlrev_b32 v56, 2, v61
    buffer_load_dword v56, s[4:7], s24 offen sc1 lds
    s_add_u32 s24, s24, 524288
    buffer_load_dword v56, s[4:7], s24 offen sc1 lds
    s_add_u32 s24, s24, 524288
    s_add_u32 s15, s14, 4096
    s_add_u32 s16, s14, 8192
    ds_read_b128 v[32:35], v63 offset:57344
    ds_read_b128 v[36:39], v63 offset:61440
    ds_read_b128 v[40:43], v61 offset:0
    ds_read_b128 v[44:47], v61 offset:4096
    ds_read_b128 v[48:51], v61 offset:8192
    ds_read_b128 v[52:55], v61 offset:12288
    s_mov_b32 s29, 1048576
    buffer_load_dwordx4 v[24:27], v61, s[4:7], s14 offen sc1
.p2align 6
cs_loop:
    v_mov_b64 v[0:1], 0
    v_mov_b64 v[2:3], 0
    v_mov_b64 v[4:5], 0
    v_mov_b64 v[6:7], 0
    v_mov_b64 v[8:9], 0
    v_mov_b64 v[10:11], 0
    v_mov_b64 v[12:13], 0
    v_mov_b64 v[14:15], 0
    v_mov_b64 v[16:17], 0
    v_mov_b64 v[18:19], 0
cs_loop2:
    v_mov_b64 v[20:21], 0
    v_mov_b64 v[22:23], 0
    v_lshrrev_b32 v56, 2, v61
    v_add_u32 v58, 106496, v56
    s_mov_b32 s29, 1048576
    s_waitcnt lgkmcnt(0)
cs_chk0:
    s_waitcnt vmcnt(0)
    v_max3_u32 v57, v24, v25, v26
    v_max_u32 v57, v57, v27
    v_cmp_eq_u32 vcc, -1, v57
    ds_write_b128 v62, v[24:27] offset:40960
    s_cbranch_vccnz cs_spin0
    v_smfmac_f32_16x16x64_bf16 v[8:11], v[24:27], v[32:39], v60
    buffer_load_dwordx4 v[28:31], v61, s[4:7], s15 offen sc1
    buffer_load_dword v59, v56, s[4:7], s16 offen sc1
    v_smfmac_f32_16x16x64_bf16 v[4:7], v[24:27], v[40:47], v60
    ds_read_b128 v[32:35], v61 offset:16384
    v_smfmac_f32_16x16x64_bf16 v[12:15], v[24:27], v[48:55], v60
    ds_read_b128 v[36:39], v61 offset:20480
    s_waitcnt lgkmcnt(2)
    s_barrier
    ds_read_b128 v[48:51], v63 offset:0
    v_smfmac_f32_16x16x64_bf16 v[0:3], v[24:27], a[0:7], v60
    ds_read_b128 v[40:43], v61 offset:24576
    v_smfmac_f32_16x16x64_bf16 v[16:19], v[24:27], a[216:223], v60
    ds_read_b128 v[44:47], v61 offset:28672
    v_smfmac_f32_16x16x64_bf16 v[20:23], v[24:27], a[224:231], v60
    ds_read_b128 v[52:55], v64 offset:0
    s_waitcnt lgkmcnt(3)
    v_smfmac_f32_16x16x64_bf16 v[4:7], v[48:51], v[32:39], v60
    ds_read_b128 v[32:35], v61 offset:32768
    v_smfmac_f32_16x16x64_bf16 v[0:3], v[48:51], a[8:15], v60
    ds_read_b128 v[36:39], v61 offset:36864
    v_smfmac_f32_16x16x64_bf16 v[8:11], v[48:51], a[16:23], v60
    s_add_u32 s18, s14, s31
    s_add_u32 s41, s14, 16384
    s_waitcnt lgkmcnt(3)
    v_smfmac_f32_16x16x64_bf16 v[12:15], v[48:51], v[40:47], v60
    ds_read_b128 v[40:43], v61 offset:40960
    s_waitcnt lgkmcnt(3)
    v_smfmac_f32_16x16x64_bf16 v[0:3], v[52:55], a[24:31], v60
    ds_read_b128 v[44:47], v61 offset:45056
    v_smfmac_f32_16x16x64_bf16 v[8:11], v[52:55], a[32:39], v60
    ds_read_b128 v[48:51], v71 offset:0
    s_waitcnt lgkmcnt(3)
    v_smfmac_f32_16x16x64_bf16 v[4:7], v[52:55], v[32:39], v60
    ds_read_b128 v[32:35], v61 offset:49152
    s_waitcnt vmcnt(0)
    v_max3_u32 v57, v28, v29, v30
    ds_write_b128 v62, v[28:31] offset:45056
    v_max3_u32 v57, v57, v31, v59
    s_waitcnt lgkmcnt(3)
    v_smfmac_f32_16x16x64_bf16 v[12:15], v[52:55], v[40:47], v60
    ds_write_b32 v58, v59
    v_cmp_eq_u32 vcc, -1, v57
    s_waitcnt lgkmcnt(3)
    v_smfmac_f32_16x16x64_bf16 v[0:3], v[48:51], a[40:47], v60
    ds_read_b128 v[36:39], v61 offset:53248
    v_smfmac_f32_16x16x64_bf16 v[8:11], v[48:51], a[48:55], v60
    ds_read_b128 v[40:43], v61 offset:57344
    s_cbranch_vccnz cs_spin1
cs_go1:
    v_smfmac_f32_16x16x64_bf16 v[0:3], v[28:31], a[56:63], v60
    ds_read_b128 v[44:47], v61 offset:61440
    v_smfmac_f32_16x16x64_bf16 v[8:11], v[28:31], a[64:71], v60
    s_and_b32 s41, s41, 65535
    s_add_u32 s41, s41, 68157440
    v_smfmac_f32_16x16x64_bf16 v[4:7], v[28:31], a[136:143], v60
    s_waitcnt lgkmcnt(3)
    s_barrier
    ds_read_b128 v[52:55], v63 offset:4096
    s_waitcnt lgkmcnt(3)
    v_smfmac_f32_16x16x64_bf16 v[4:7], v[48:51], v[32:39], v60
    ds_read_b128 v[56:59], v71 offset:4096
    v_smfmac_f32_16x16x64_bf16 v[12:15], v[28:31], a[144:151], v60
    buffer_load_dwordx4 v[32:35], v61, s[4:7], s23 offen offset:0 sc1
    s_waitcnt lgkmcnt(2)
    v_smfmac_f32_16x16x64_bf16 v[12:15], v[48:51], v[40:47], v60
    ds_read_b128 v[24:27], v65 offset:8192
    v_smfmac_f32_16x16x64_bf16 v[16:19], v[28:31], v[96:103], v60
    ds_read_b128 v[48:51], v64 offset:4096
    v_smfmac_f32_16x16x64_bf16 v[20:23], v[28:31], v[104:111], v60
    buffer_load_dwordx4 v[36:39], v61, s[4:7], s23 offen offset:1024 sc1
    s_waitcnt lgkmcnt(3)
    v_smfmac_f32_16x16x64_bf16 v[0:3], v[52:55], a[72:79], v60
    v_lshlrev_b32 v28, 2, v61
    v_smfmac_f32_16x16x64_bf16 v[4:7], v[52:55], a[152:159], v60
    s_add_u32 s17, s41, s31
    s_and_b32 s30, s28, 1
    s_waitcnt lgkmcnt(2)
    v_smfmac_f32_16x16x64_bf16 v[0:3], v[56:59], a[104:111], v60
    buffer_load_dwordx4 v[40:43], v61, s[4:7], s23 offen offset:2048 sc1
    v_smfmac_f32_16x16x64_bf16 v[4:7], v[56:59], a[184:191], v60
    s_waitcnt lgkmcnt(1)
    v_smfmac_f32_16x16x64_bf16 v[0:3], v[24:27], a[120:127], v60
    v_smfmac_f32_16x16x64_bf16 v[4:7], v[24:27], a[200:207], v60
    buffer_load_dwordx4 v[44:47], v61, s[4:7], s23 offen offset:3072 sc1
    s_waitcnt lgkmcnt(0)
    v_smfmac_f32_16x16x64_bf16 v[0:3], v[48:51], a[88:95], v60
    v_smfmac_f32_16x16x64_bf16 v[4:7], v[48:51], a[168:175], v60
    s_barrier
    v_smfmac_f32_16x16x64_bf16 v[8:11], v[52:55], a[80:87], v60
    buffer_load_dword v28, s[4:7], s24 offen sc1 lds
    v_smfmac_f32_16x16x64_bf16 v[12:15], v[52:55], a[160:167], v60
    ds_read_b128 v[28:31], v65 offset:9216
    v_smfmac_f32_16x16x64_bf16 v[8:11], v[56:59], a[112:119], v60
    v_cvt_pk_bf16_f32 v0, v0, v1
    v_smfmac_f32_16x16x64_bf16 v[12:15], v[56:59], a[192:199], v60
    v_cvt_pk_bf16_f32 v1, v2, v3
    v_smfmac_f32_16x16x64_bf16 v[8:11], v[24:27], a[128:135], v60
    v_cvt_pk_bf16_f32 v2, v4, v5
    v_smfmac_f32_16x16x64_bf16 v[8:11], v[48:51], a[96:103], v60
    v_cvt_pk_bf16_f32 v3, v6, v7
    v_smfmac_f32_16x16x64_bf16 v[12:15], v[24:27], a[208:215], v60
    s_cmp_ge_u32 s28, 62
    v_smfmac_f32_16x16x64_bf16 v[12:15], v[48:51], a[176:183], v60
    s_waitcnt lgkmcnt(0)
    v_cvt_pk_bf16_f32 v8, v8, v9
    v_mfma_f32_16x16x32_bf16 v[4:7], v[0:3], v[28:31], 0
    v_cvt_pk_bf16_f32 v9, v10, v11
    s_waitcnt vmcnt(3)
    s_nop 1
    v_cvt_pk_bf16_f32 v10, v12, v13
    v_cvt_pk_bf16_f32 v11, v14, v15
    s_nop 1
    v_mfma_f32_16x16x32_bf16 v[12:15], v[8:11], v[28:31], 0
    v_cvt_pk_bf16_f32 v0, v4, v5
    v_cvt_pk_bf16_f32 v1, v6, v7
    v_smfmac_f32_16x16x64_bf16 v[16:19], v[24:27], v[160:167], v60
    s_mov_b64 exec, s[36:37]
    ds_read_b128 v[28:31], v69
    s_mov_b64 exec, -1
    s_nop 0
    v_cvt_pk_bf16_f32 v2, v12, v13
    v_cvt_pk_bf16_f32 v3, v14, v15
    s_cbranch_scc1 cs_last
cs_back:
    s_nop 0
    v_mfma_f32_16x16x32_bf16 v[8:11], v[0:3], v[0:3], 0
    v_mfma_f32_16x16x32_bf16 v[4:7], v[36:39], v[0:3], 0
    ds_read_b128 v[36:39], v64 offset:0
    v_mfma_f32_16x16x32_bf16 v[12:15], v[32:35], v[0:3], 0
    ds_read_b128 v[32:35], v63 offset:0
    v_mov_b32_dpp v8, v10 row_ror:8 row_mask:0xf bank_mask:0xc
    v_mov_b32_dpp v9, v11 row_ror:8 row_mask:0xf bank_mask:0xc
    ds_write_b64 v70, v[8:9]
    s_nop 3
    v_mov_b32_dpp v12, v4 row_ror:8 row_mask:0xf bank_mask:0xc
    v_mov_b32_dpp v13, v5 row_ror:8 row_mask:0xf bank_mask:0xc
    v_mov_b32_dpp v14, v6 row_ror:8 row_mask:0xf bank_mask:0xc
    v_mov_b32_dpp v15, v7 row_ror:8 row_mask:0xf bank_mask:0xc
    ds_write_b128 v62, v[12:15] offset:55296
    v_smfmac_f32_16x16x64_bf16 v[20:23], v[24:27], v[168:175], v60
    v_smfmac_f32_16x16x64_bf16 v[16:19], v[56:59], v[144:151], v60
    v_or_b32 v27, 512, v65
    v_smfmac_f32_16x16x64_bf16 v[20:23], v[56:59], v[152:159], v60
    s_waitcnt vmcnt(1)
    s_waitcnt lgkmcnt(4)
    s_mov_b64 exec, s[36:37]
    s_cbranch_execz cs_np3303
    buffer_store_dwordx4 v[28:31], v61, s[4:7], s65 offen sc1
cs_np3303:
    s_mov_b64 exec, -1
    v_smfmac_f32_16x16x64_bf16 v[16:19], v[48:51], v[128:135], v60
    s_waitcnt lgkmcnt(0)
    s_barrier
    ds_read_b128 v[4:7], v63 offset:14336
    ds_read_b128 v[8:11], v64 offset:14336
    ds_read_b128 v[0:3], v71 offset:14336
    v_smfmac_f32_16x16x64_bf16 v[20:23], v[48:51], v[136:143], v60
    ds_read_b128 v[56:59], v27 offset:10752
    v_smfmac_f32_16x16x64_bf16 v[16:19], v[52:55], v[112:119], v60
    ds_read_b128 v[24:27], v27 offset:11264
    v_smfmac_f32_16x16x64_bf16 v[20:23], v[52:55], v[120:127], v60
    ds_read_b128 v[28:31], v71 offset:0
    v_smfmac_f32_16x16x64_bf16 v[16:19], v[32:35], a[232:239], v60
    v_smfmac_f32_16x16x64_bf16 v[20:23], v[32:35], a[240:247], v60
    s_waitcnt lgkmcnt(5)
    v_add_f32 v12, v12, v4
    v_smfmac_f32_16x16x64_bf16 v[16:19], v[36:39], a[248:255], v60
    v_add_f32 v13, v13, v5
    v_smfmac_f32_16x16x64_bf16 v[20:23], v[36:39], v[72:79], v60
    v_add_f32 v14, v14, v6
    s_waitcnt lgkmcnt(0)
    v_smfmac_f32_16x16x64_bf16 v[16:19], v[28:31], v[80:87], v60
    v_add_f32 v15, v15, v7
    v_smfmac_f32_16x16x64_bf16 v[20:23], v[28:31], v[88:95], v60
    v_add_f32 v8, v8, v0
    v_add_f32 v9, v9, v1
    v_add_f32 v10, v10, v2
    v_add_f32 v11, v11, v3
    v_pk_add_f32 v[56:57], v[56:57], v[58:59]
    v_pk_add_f32 v[24:25], v[24:25], v[26:27]
    v_pk_add_f32 v[12:13], v[12:13], v[8:9]
    v_pk_add_f32 v[14:15], v[14:15], v[10:11]
    v_pk_add_f32 v[56:57], v[56:57], v[24:25]
    v_max3_f32 v4, v12, v13, v14
    v_max3_f32 v5, v15, v56, v57
    v_max_f32 v4, v4, v5
    v_cvt_pk_bf16_f32 v16, v16, v17
    v_cvt_pk_bf16_f32 v17, v18, v19
    v_max_f32_dpp v4, v4, v4 row_ror:8 row_mask:0xf bank_mask:0xf
    v_mov_b32 v5, v4
    v_cvt_pk_bf16_f32 v18, v20, v21
    v_cvt_pk_bf16_f32 v19, v22, v23
    v_permlane32_swap_b32 v4, v5
    v_max_f32 v4, v4, v5
    v_mov_b32 v5, v4
    v_mov_b64 v[24:25], s[62:63]
    v_mov_b64 v[26:27], s[60:61]
    v_permlane16_swap_b32 v4, v5
    v_max_f32 v4, v4, v5
    v_mul_f32 v4, s46, v4
    v_pk_fma_f32 v[12:13], v[12:13], s[44:45], v[4:5] op_sel_hi:[1,1,0]
    v_pk_fma_f32 v[14:15], v[14:15], s[44:45], v[4:5] op_sel_hi:[1,1,0]
    v_pk_fma_f32 v[56:57], v[56:57], s[44:45], v[4:5] op_sel_hi:[1,1,0]
    v_exp_f32 v12, v12
    v_exp_f32 v13, v13
    v_exp_f32 v14, v14
    v_cvt_pk_bf16_f32 v8, v12, v13
    v_exp_f32 v15, v15
    v_exp_f32 v56, v56
    v_cvt_pk_bf16_f32 v9, v14, v15
    v_mov_b32_dpp v10, v8 row_ror:8 row_mask:0xf bank_mask:0xf
    v_exp_f32 v57, v57
    v_mov_b32_dpp v11, v9 row_ror:8 row_mask:0xf bank_mask:0xf
    v_cvt_pk_bf16_f32 v6, v56, v57
    s_nop 0
    v_mfma_f32_16x16x32_bf16 v[56:59], v[40:43], v[8:11], 0
    ds_read_b128 v[48:51], v62 offset:8192
    v_mov_b32_dpp v7, v6 row_ror:8 row_mask:0xf bank_mask:0xf
    v_mfma_f32_16x16x32_bf16 v[20:23], v[44:47], v[8:11], 0
    ds_read_b128 v[52:55], v62 offset:12288
    v_bfe_u32 v4, v61, 7, 1
    v_mfma_f32_16x16x32_bf16 v[28:31], v[24:27], v[6:9], 0
    v_lshl_add_u32 v4, v4, 3, v68
    v_mov_b64 v[32:33], 0
    v_mfma_f32_16x16x16_bf16 v[56:59], v[16:17], v[6:7], v[56:59]
    v_mov_b64 v[34:35], 0
    v_mov_b64 v[36:37], 0
    v_mfma_f32_16x16x16_bf16 v[20:23], v[18:19], v[6:7], v[20:23]
    v_add_f32_dpp v28, v28, v28 row_ror:8 row_mask:0xf bank_mask:0xf
    v_rcp_f32 v28, v28
    v_mov_b64 v[38:39], 0
    s_nop 0
    v_mul_f32 v56, v56, v28
    v_mul_f32 v57, v57, v28
    v_mul_f32 v58, v58, v28
    v_mul_f32 v59, v59, v28
    v_mul_f32_dpp v56, v20, v28 row_ror:8 row_mask:0xf bank_mask:0xc
    v_mul_f32_dpp v57, v21, v28 row_ror:8 row_mask:0xf bank_mask:0xc
    v_mul_f32_dpp v58, v22, v28 row_ror:8 row_mask:0xf bank_mask:0xc
    v_mul_f32_dpp v59, v23, v28 row_ror:8 row_mask:0xf bank_mask:0xc
    v_cvt_pk_bf16_f32 v56, v56, v57
    v_cvt_pk_bf16_f32 v57, v58, v59
    ds_write_b64 v4, v[56:57]
    ds_read_b128 v[0:3], v68
    ds_read_b128 v[40:43], v62 offset:16384
    ds_read_b128 v[44:47], v62 offset:20480
    v_xor_b32 v24, 512, v68
    v_xor_b32 v28, 1024, v68
    v_xor_b32 v58, 1536, v68
    v_mov_b64 v[8:9], 0
    v_mov_b64 v[10:11], 0
    v_mov_b64 v[12:13], 0
    v_mov_b64 v[14:15], 0
    s_waitcnt lgkmcnt(3)
    s_barrier
    ds_read_b128 v[24:27], v24
    ds_read_b128 v[28:31], v28
    s_waitcnt lgkmcnt(4)
    v_smfmac_f32_16x16x64_bf16 v[32:35], v[0:3], v[176:183], v60
    ds_read_b128 v[56:59], v58
    v_smfmac_f32_16x16x64_bf16 v[36:39], v[0:3], v[208:215], v60
    v_mov_b64 v[20:21], 0
    v_smfmac_f32_16x16x64_bf16 v[8:11], v[0:3], v[48:55], v60
    ds_read_b128 v[48:51], v63 offset:40960
    v_mov_b64 v[22:23], 0
    s_waitcnt lgkmcnt(3)
    v_smfmac_f32_16x16x64_bf16 v[32:35], v[24:27], v[184:191], v60
    ds_read_b128 v[52:55], v63 offset:45056
    s_waitcnt lgkmcnt(3)
    v_smfmac_f32_16x16x64_bf16 v[32:35], v[28:31], v[192:199], v60
    s_waitcnt lgkmcnt(2)
    v_smfmac_f32_16x16x64_bf16 v[32:35], v[56:59], v[200:207], v60
    v_smfmac_f32_16x16x64_bf16 v[36:39], v[24:27], v[216:223], v60
    v_smfmac_f32_16x16x64_bf16 v[36:39], v[28:31], v[224:231], v60
    v_cvt_pk_bf16_f32 v32, v32, v33
    v_smfmac_f32_16x16x64_bf16 v[36:39], v[56:59], v[232:239], v60
    v_cvt_pk_bf16_f32 v33, v34, v35
    v_smfmac_f32_16x16x64_bf16 v[12:15], v[0:3], v[40:47], v60
    ds_read_b128 v[40:43], v63 offset:49152
    v_and_or_b32 v32, v32, -2, s30
    s_waitcnt lgkmcnt(1)
    v_smfmac_f32_16x16x64_bf16 v[20:23], v[0:3], v[48:55], v60
    buffer_store_dwordx2 v[32:33], v66, s[4:7], s20 offen sc1
    v_cvt_pk_bf16_f32 v36, v36, v37
    ds_read_b128 v[44:47], v63 offset:53248
    v_smfmac_f32_16x16x64_bf16 v[8:11], v[24:27], v[240:247], v60
    ds_read_b128 v[48:51], v62 offset:24576
    v_cvt_pk_bf16_f32 v37, v38, v39
    v_and_or_b32 v36, v36, -2, s30
    v_smfmac_f32_16x16x64_bf16 v[12:15], v[24:27], v[248:255], v60
    buffer_store_dwordx2 v[36:37], v66, s[4:7], s21 offen sc1
    ds_read_b128 v[52:55], v62 offset:28672
    ds_read_b128 v[0:3], v63 offset:24576
    ds_read_b128 v[4:7], v63 offset:28672
    s_waitcnt lgkmcnt(4)
    v_smfmac_f32_16x16x64_bf16 v[20:23], v[28:31], v[40:47], v60
    ds_read_b128 v[32:35], v63 offset:32768
    ds_read_b128 v[36:39], v63 offset:36864
    ds_read_b128 v[40:43], v62 offset:32768
    ds_read_b128 v[44:47], v62 offset:36864
    s_waitcnt lgkmcnt(6)
    v_smfmac_f32_16x16x64_bf16 v[8:11], v[28:31], v[48:55], v60
    s_nop 1
    v_cvt_pk_bf16_f32 v20, v20, v21
    v_cvt_pk_bf16_f32 v21, v22, v23
    s_waitcnt lgkmcnt(4)
    v_smfmac_f32_16x16x64_bf16 v[8:11], v[56:59], v[0:7], v60
    v_and_or_b32 v20, v20, -2, s30
    buffer_store_dwordx2 v[20:21], v67, s[4:7], s22 offen sc1
    s_waitcnt lgkmcnt(2)
    v_smfmac_f32_16x16x64_bf16 v[12:15], v[56:59], v[32:39], v60
    s_cmp_lg_u32 s13, 2
    s_waitcnt lgkmcnt(0)
    v_smfmac_f32_16x16x64_bf16 v[12:15], v[28:31], v[40:47], v60
    v_cvt_pk_bf16_f32 v8, v8, v9
    v_cvt_pk_bf16_f32 v9, v10, v11
    v_and_or_b32 v8, v8, -2, s30
    buffer_store_dwordx2 v[8:9], v66, s[4:7], s38 offen sc1
    s_nop 3
    v_cvt_pk_bf16_f32 v12, v12, v13
    v_cvt_pk_bf16_f32 v13, v14, v15
    v_and_or_b32 v12, v12, -2, s30
    buffer_store_dwordx2 v[12:13], v66, s[4:7], s39 offen sc1
    s_cbranch_scc1 cs_w013
    s_nop 15
    s_nop 15
    s_nop 15
    s_nop 15
    s_nop 15
    s_nop 15
    s_nop 15
    s_nop 15
    s_nop 15
    s_nop 15
    s_nop 15
    s_nop 15
    s_nop 7
    buffer_load_dwordx4 v[40:43], v65, s[4:7], s19 offen offset:0 sc1
    buffer_load_dwordx4 v[44:47], v65, s[4:7], s19 offen offset:1024 sc1
    buffer_load_dwordx4 v[48:51], v65, s[4:7], s19 offen offset:2048 sc1
    buffer_load_dwordx4 v[52:55], v65, s[4:7], s19 offen offset:3072 sc1
    ds_read_b128 v[56:59], v65 offset:10240
    s_add_u32 s28, s28, 1
    s_mov_b32 s14, s41
    s_add_u32 s23, s23, 524288
    s_add_u32 s24, s24, 524288
    s_min_u32 s24, s24, s66
    s_add_u32 s15, s14, 4096
    s_add_u32 s16, s14, 8192
    v_mov_b32 v21, -1
    s_add_u32 s65, s65, 12288
    s_mov_b32 s40, 1
    s_cmp_lg_u32 s28, 63
    s_cbranch_scc1 cs_nv3510
    ds_write_b128 v62, v[16:19] offset:55296
    s_waitcnt lgkmcnt(0)
cs_nv3510:
    v_mov_b64 v[0:1], 0
    v_mov_b64 v[2:3], 0
    v_mov_b64 v[4:5], 0
    v_mov_b64 v[6:7], 0
    v_mov_b64 v[8:9], 0
    v_mov_b64 v[10:11], 0
    v_mov_b64 v[12:13], 0
    v_mov_b64 v[14:15], 0
    v_mov_b64 v[16:17], 0
    v_mov_b64 v[18:19], 0
cs_chkF:
    v_mov_b32 v20, 0
    s_waitcnt vmcnt(3)
    v_mfma_f32_16x16x32_bf16 v[28:31], v[40:43], v[56:59], 0
    v_bitop3_b32 v20, v20, v40, s30 bitop3:0xf6
    v_bitop3_b32 v20, v20, v42, s30 bitop3:0xf6
    s_waitcnt vmcnt(2)
    v_mfma_f32_16x16x32_bf16 v[28:31], v[44:47], v[56:59], v[28:31]
    v_bitop3_b32 v20, v20, v44, s30 bitop3:0xf6
    v_bitop3_b32 v20, v20, v46, s30 bitop3:0xf6
    s_waitcnt vmcnt(1)
    v_mfma_f32_16x16x32_bf16 v[28:31], v[48:51], v[56:59], v[28:31]
    v_bitop3_b32 v20, v20, v48, s30 bitop3:0xf6
    v_bitop3_b32 v20, v20, v50, s30 bitop3:0xf6
    s_waitcnt vmcnt(0)
    v_mfma_f32_16x16x32_bf16 v[28:31], v[52:55], v[56:59], v[28:31]
    v_bitop3_b32 v20, v20, v52, s30 bitop3:0xf6
    v_bitop3_b32 v20, v20, v54, s30 bitop3:0xf6
    v_and_b32 v20, s40, v20
    v_cmp_ne_u32 vcc, 0, v20
    s_cbranch_vccnz cs_spinF
    v_permlane32_swap_b32 v28, v30
    v_permlane32_swap_b32 v29, v31
    v_add_f32 v28, v28, v30
    v_add_f32 v30, v29, v31
    v_cvt_pk_bf16_f32 v28, v28, v30
    s_mov_b64 exec, s[32:33]
    buffer_store_dword v28, v69, s[4:7], s17 offen sc1
    buffer_store_dword v21, v69, s[4:7], s18 offen sc1
    s_mov_b64 exec, -1
    ds_read_b128 v[32:35], v63 offset:57344
    ds_read_b128 v[36:39], v63 offset:61440
    ds_read_b128 v[40:43], v61 offset:0
    ds_read_b128 v[44:47], v61 offset:4096
    ds_read_b128 v[48:51], v61 offset:8192
    ds_read_b128 v[52:55], v61 offset:12288
    s_nop 15
    s_nop 15
    s_nop 15
    s_nop 15
    s_nop 15
    s_nop 15
    s_nop 3
    buffer_load_dwordx4 v[24:27], v61, s[4:7], s14 offen sc1
    s_branch cs_loop2
cs_w013:
    ds_read_b128 v[56:59], v65 offset:10240
    ds_read_b128 v[32:35], v63 offset:57344
    ds_read_b128 v[36:39], v63 offset:61440
    ds_read_b128 v[40:43], v61 offset:0
    ds_read_b128 v[44:47], v61 offset:4096
    ds_read_b128 v[48:51], v61 offset:8192
    ds_read_b128 v[52:55], v61 offset:12288
    s_add_u32 s28, s28, 1
    s_mov_b32 s14, s41
    s_add_u32 s23, s23, 524288
    s_add_u32 s24, s24, 524288
    s_min_u32 s24, s24, s66
    s_add_u32 s15, s14, 4096
    s_add_u32 s16, s14, 8192
    v_mov_b32 v21, -1
    s_add_u32 s65, s65, 12288
    s_mov_b32 s40, 1
    s_cmp_lg_u32 s28, 63
    s_cbranch_scc1 cs_nv3588
    ds_write_b128 v62, v[16:19] offset:55296
    s_waitcnt lgkmcnt(0)
cs_nv3588:
    s_cmp_eq_u32 s64, 0
    s_cbranch_scc1 cs_w0
    s_nop 15
    s_nop 15
    s_nop 15
    s_nop 15
    s_nop 15
    s_nop 15
    s_nop 15
    s_nop 15
    s_nop 15
    s_nop 15
    s_nop 15
    s_nop 15
    s_nop 7
    buffer_load_dwordx4 v[0:3], v65, s[4:7], s19 offen offset:0 sc1
    buffer_load_dwordx4 v[4:7], v65, s[4:7], s19 offen offset:1024 sc1
    buffer_load_dwordx4 v[8:11], v65, s[4:7], s19 offen offset:2048 sc1
    buffer_load_dwordx4 v[12:15], v65, s[4:7], s19 offen offset:3072 sc1
cs_chkG:
    v_mov_b32 v20, 0
    s_waitcnt vmcnt(3)
    v_mfma_f32_16x16x32_bf16 v[28:31], v[0:3], v[56:59], 0
    v_bitop3_b32 v20, v20, v0, s30 bitop3:0xf6
    v_bitop3_b32 v20, v20, v2, s30 bitop3:0xf6
    s_waitcnt vmcnt(2)
    v_mfma_f32_16x16x32_bf16 v[28:31], v[4:7], v[56:59], v[28:31]
    v_bitop3_b32 v20, v20, v4, s30 bitop3:0xf6
    v_bitop3_b32 v20, v20, v6, s30 bitop3:0xf6
    s_waitcnt vmcnt(1)
    v_mfma_f32_16x16x32_bf16 v[28:31], v[8:11], v[56:59], v[28:31]
    v_bitop3_b32 v20, v20, v8, s30 bitop3:0xf6
    v_bitop3_b32 v20, v20, v10, s30 bitop3:0xf6
    s_waitcnt vmcnt(0)
    v_mfma_f32_16x16x32_bf16 v[28:31], v[12:15], v[56:59], v[28:31]
    v_bitop3_b32 v20, v20, v12, s30 bitop3:0xf6
    v_bitop3_b32 v20, v20, v14, s30 bitop3:0xf6
    v_and_b32 v20, s40, v20
    v_cmp_ne_u32 vcc, 0, v20
    s_cbranch_vccnz cs_spinG
    v_permlane32_swap_b32 v28, v30
    v_permlane32_swap_b32 v29, v31
    v_add_f32 v28, v28, v30
    v_add_f32 v30, v29, v31
    s_cmp_eq_u32 s13, 3
    s_cbranch_scc1 cs_w3
    v_mov_b32 v29, v28
    v_mov_b32 v31, v30
    s_nop 0
    v_permlane16_swap_b32 v28, v29
    v_permlane16_swap_b32 v30, v31
    v_add_f32 v28, v28, v29
    v_add_f32 v30, v30, v31
cs_w3:
    v_cvt_pk_bf16_f32 v28, v28, v30
    s_mov_b64 exec, s[32:33]
    buffer_store_dword v28, v69, s[4:7], s17 offen sc1
    buffer_store_dword v21, v69, s[4:7], s18 offen sc1
    s_mov_b64 exec, -1
    buffer_load_dwordx4 v[24:27], v61, s[4:7], s14 offen sc1
    s_branch cs_loop
cs_w0:
    v_mov_b64 v[0:1], 0
    v_mov_b64 v[2:3], 0
    v_mov_b64 v[4:5], 0
    v_mov_b64 v[6:7], 0
    v_mov_b64 v[8:9], 0
    v_mov_b64 v[10:11], 0
    v_mov_b64 v[12:13], 0
    v_mov_b64 v[14:15], 0
    v_mov_b64 v[16:17], 0
    v_mov_b64 v[18:19], 0
    s_cmp_lg_u32 s28, 10
    s_cbranch_scc1 cs_nokv
    s_lshr_b32 s92, s12, 1
    s_lshl_b32 s92, s92, 8
    s_add_u32 s92, s92, 125829120
    v_bfe_u32 v28, v61, 4, 6
    v_min_u32 v28, 11, v28
    v_lshlrev_b32 v28, 2, v28
    s_add_u32 s93, s95, 63
    s_mov_b32 s94, 4194304
cs_kv1:
    buffer_load_dword v29, v28, s[4:7], s92 offen sc1
    s_sub_u32 s94, s94, 1
    s_cbranch_scc1 cs_kv1_go
    s_waitcnt vmcnt(0)
    v_subrev_u32 v29, s93, v29
    v_cmp_lt_u32 vcc, 64, v29
    s_cbranch_vccz cs_kv1_go
    s_sleep 2
    s_branch cs_kv1
cs_kv1_go:
cs_nokv:
    s_nop 15
    s_nop 15
    s_nop 15
    s_nop 15
    s_nop 15
    s_nop 15
    s_nop 15
    s_nop 15
    s_nop 15
    s_nop 15
    s_nop 15
    s_nop 15
    s_nop 15
    s_nop 15
    s_nop 15
    s_nop 15
    s_nop 15
    s_nop 15
    s_nop 15
    s_nop 15
    s_nop 15
    s_nop 15
    s_nop 15
    s_nop 15
    s_nop 15
    buffer_load_dwordx4 v[24:27], v61, s[4:7], s14 offen sc1
    s_branch cs_loop2
cs_spinF:
    buffer_load_dwordx4 v[40:43], v65, s[4:7], s19 offen offset:0 sc1
    buffer_load_dwordx4 v[44:47], v65, s[4:7], s19 offen offset:1024 sc1
    buffer_load_dwordx4 v[48:51], v65, s[4:7], s19 offen offset:2048 sc1
    buffer_load_dwordx4 v[52:55], v65, s[4:7], s19 offen offset:3072 sc1
    s_sub_u32 s29, s29, 1
    s_cmp_lt_i32 s29, 0
    s_cselect_b32 s40, 0, 1
    s_branch cs_chkF
cs_spinG:
    buffer_load_dwordx4 v[0:3], v65, s[4:7], s19 offen offset:0 sc1
    buffer_load_dwordx4 v[4:7], v65, s[4:7], s19 offen offset:1024 sc1
    buffer_load_dwordx4 v[8:11], v65, s[4:7], s19 offen offset:2048 sc1
    buffer_load_dwordx4 v[12:15], v65, s[4:7], s19 offen offset:3072 sc1
    s_sub_u32 s29, s29, 1
    s_cmp_lt_i32 s29, 0
    s_cselect_b32 s40, 0, 1
    s_branch cs_chkG
cs_spin0:
    buffer_load_dwordx4 v[24:27], v61, s[4:7], s14 offen sc1
    s_sub_u32 s29, s29, 1
    s_cmp_lt_i32 s29, 0
    s_cbranch_scc0 cs_chk0
    s_waitcnt vmcnt(0)
    v_min_u32 v24, -2, v24
    v_min_u32 v25, -2, v25
    v_min_u32 v26, -2, v26
    v_min_u32 v27, -2, v27
    s_branch cs_chk0
cs_spin1:
    buffer_load_dwordx4 v[28:31], v61, s[4:7], s15 offen sc1
    buffer_load_dword v59, v56, s[4:7], s16 offen sc1
    s_sub_u32 s29, s29, 1
    s_cmp_lt_i32 s29, 0
    s_waitcnt vmcnt(0)
    v_max3_u32 v57, v28, v29, v30
    v_max3_u32 v57, v57, v31, v59
    v_cmp_eq_u32 vcc, -1, v57
    ds_write_b128 v62, v[28:31] offset:45056
    ds_write_b32 v58, v59
    s_waitcnt lgkmcnt(0)
    s_cbranch_scc1 cs_go1
    s_cbranch_vccnz cs_spin1
    s_branch cs_go1
cs_last:
    s_nop 1
    s_cmp_eq_u32 s28, 63
    s_waitcnt vmcnt(1)
    s_cbranch_scc1 cs_last2
    s_waitcnt vmcnt(0)
    s_mov_b64 exec, s[34:35]
    buffer_store_dwordx4 v[0:3], v61, s[4:7], s25 offen sc1
    s_mov_b64 exec, -1
    s_add_u32 s25, s25, 131072
    s_branch cs_back
cs_last2:
    ds_read_b128 v[40:43], v62 offset:55296
    s_waitcnt lgkmcnt(0)
    buffer_store_dwordx4 v[40:43], v61, s[4:7], s26 offen sc1
    s_add_u32 s26, s26, 131072
    s_add_u32 s40, s95, 63
    v_mov_b32 v44, s40
    ds_read_b128 v[32:35], v63 offset:0
    ds_read_b128 v[36:39], v64 offset:0
    ds_read_b128 v[28:31], v71 offset:0
    v_smfmac_f32_16x16x64_bf16 v[20:23], v[24:27], v[168:175], v60
    v_smfmac_f32_16x16x64_bf16 v[16:19], v[56:59], v[144:151], v60
    v_smfmac_f32_16x16x64_bf16 v[20:23], v[56:59], v[152:159], v60
    v_smfmac_f32_16x16x64_bf16 v[16:19], v[48:51], v[128:135], v60
    v_smfmac_f32_16x16x64_bf16 v[20:23], v[48:51], v[136:143], v60
    v_smfmac_f32_16x16x64_bf16 v[16:19], v[52:55], v[112:119], v60
    v_smfmac_f32_16x16x64_bf16 v[20:23], v[52:55], v[120:127], v60
    s_waitcnt lgkmcnt(2)
    v_smfmac_f32_16x16x64_bf16 v[16:19], v[32:35], a[232:239], v60
    v_smfmac_f32_16x16x64_bf16 v[20:23], v[32:35], a[240:247], v60
    s_waitcnt lgkmcnt(1)
    v_smfmac_f32_16x16x64_bf16 v[16:19], v[36:39], a[248:255], v60
    v_smfmac_f32_16x16x64_bf16 v[20:23], v[36:39], v[72:79], v60
    s_waitcnt lgkmcnt(0)
    v_smfmac_f32_16x16x64_bf16 v[16:19], v[28:31], v[80:87], v60
    v_smfmac_f32_16x16x64_bf16 v[20:23], v[28:31], v[88:95], v60
    s_nop 3
    v_cvt_pk_bf16_f32 v16, v16, v17
    v_cvt_pk_bf16_f32 v17, v18, v19
    s_nop 1
    v_cvt_pk_bf16_f32 v18, v20, v21
    v_cvt_pk_bf16_f32 v19, v22, v23
    s_mov_b64 exec, s[34:35]
    buffer_store_dwordx4 v[0:3], v61, s[4:7], s25 offen sc1
    s_mov_b64 exec, -1
    buffer_store_dwordx4 v[16:19], v61, s[4:7], s26 offen sc1
    v_add_u32 v32, 1, v44
    s_waitcnt vmcnt(0)
    s_mov_b64 exec, 1
    buffer_store_dword v32, off, s[4:7], s27 sc1
    s_mov_b64 exec, -1
    s_endpgm
cs_dma:
    s_xor_b32 s74, s76, s81
    s_add_u32 m0, s74, s80
    s_add_u32 s76, s76, 4096
    buffer_load_dwordx4 v58, s[8:11], s78 offen lds
    s_add_u32 s78, s78, s79
    s_cmp_lt_u32 s76, s77
    s_cbranch_scc1 cs_dma
    s_setpc_b64 s[82:83]
L_helper:
    s_load_dwordx16 s[64:79], s[0:1], 64
    s_sub_u32 s33, s3, 1
    s_and_b32 s33, s33, 7
L_pool:
    s_lshl_b32 s35, s33, 2
    s_add_u32 s35, s35, 32
    s_mov_b32 s37, s35
    v_mov_b32 v250, 1
    v_mov_b32 v251, 163832
    v_cmp_eq_u32 vcc, 0, v0
    s_nop 0
    s_and_saveexec_b64 s[38:39], vcc
    s_cbranch_execz tk4
    buffer_atomic_add v250, off, s[96:99], s37 sc0
    s_waitcnt vmcnt(0)
    ds_write_b32 v251, v250
    s_waitcnt lgkmcnt(0)
tk4:
    s_mov_b64 exec, -1
    s_barrier
    ds_read_b32 v252, v251
    s_waitcnt lgkmcnt(0)
    v_readfirstlane_b32 s34, v252
    s_barrier
    s_nop 3
    s_mul_i32 s36, s33, 30
    s_add_u32 s36, s36, s34
    s_or_b32 s33, s34, s32
    s_cmp_lg_u32 s33, 0
    s_cbranch_scc1 L_helper1
    s_memrealtime s[90:91]
    s_waitcnt lgkmcnt(0)
    s_lshl_b32 s90, s90, 8
    s_or_b32 s90, s90, 1
    v_mov_b32 v250, s90
    v_mov_b32 v251, 0
    s_mov_b64 exec, 1
    buffer_atomic_cmpswap v[250:251], off, s[96:99], 0 offset:144
    s_mov_b64 exec, -1
L_helper1:
    s_cmp_ge_u32 s34, 30
    s_cbranch_scc1 L_qkv_next
    s_cmp_ge_u32 s36, 192
    s_cbranch_scc1 L_qkv_next
    s_mul_i32 s37, s36, 171
    s_lshr_b32 s37, s37, 10
    s_mul_i32 s38, s37, 6
    s_sub_u32 s36, s36, s38
    s_lshl_b32 s36, s36, 5
    s_add_u32 s36, s36, s37
    s_branch L_job
L_qkv_next:
    s_mov_b32 s37, 4
    v_mov_b32 v250, 1
    v_mov_b32 v251, 163832
    v_cmp_eq_u32 vcc, 0, v0
    s_nop 0
    s_and_saveexec_b64 s[38:39], vcc
    s_cbranch_execz tk5
    buffer_atomic_add v250, off, s[96:99], s37 sc0
    s_waitcnt vmcnt(0)
    ds_write_b32 v251, v250
    s_waitcnt lgkmcnt(0)
tk5:
    s_mov_b64 exec, -1
    s_barrier
    ds_read_b32 v252, v251
    s_waitcnt lgkmcnt(0)
    v_readfirstlane_b32 s36, v252
    s_barrier
    s_nop 3
    s_add_u32 s36, s36, 192
    s_cmp_ge_u32 s36, 320
    s_cbranch_scc1 L_ssm_next
L_job:
    s_and_b32 s17, s36, 15
    s_lshl_b32 s17, s17, 1
    s_bfe_u32 s16, s36, 0x10004
    s_lshr_b32 s19, s36, 5
    s_mul_i32 s33, s16, 6
    s_add_u32 s33, s33, s19
    s_add_u32 s16, s16, 1
    s_lshr_b32 s37, s36, 4
    s_sub_u32 s38, s37, 12
    s_cmp_ge_u32 s36, 192
    s_cselect_b32 s16, 0, s16
    s_cselect_b32 s19, s38, s19
    s_cselect_b32 s33, s37, s33
    s_cselect_b32 s20, 8, 6
    v_lshrrev_b32 v4, 6, v0
    s_nop 0
    v_readfirstlane_b32 s18, v4
    v_lshlrev_b32 v7, 4, v0
    v_and_b32 v4, 63, v0
    v_lshrrev_b32 v6, 2, v4
    v_lshlrev_b32 v6, 13, v6
    v_lshrrev_b32 v5, 4, v4
    v_and_b32 v5, 2, v5
    v_xor_b32 v5, v5, v4
    v_and_b32 v5, 3, v5
    v_lshl_add_u32 v6, v5, 4, v6
    v_lshrrev_b32 v24, 4, v4
    v_lshlrev_b32 v24, 9, v24
    v_bfe_u32 v5, v4, 2, 2
    v_lshl_add_u32 v24, v5, 6, v24
    v_bfe_u32 v5, v4, 4, 1
    v_lshl_add_u32 v24, v5, 5, v24
    v_and_b32 v5, 3, v4
    v_lshl_add_u32 v24, v5, 3, v24
    s_lshl_b32 s31, s18, 12
    v_add_u32 v24, s31, v24
    s_cmp_eq_u32 s16, 1
    s_cselect_b64 s[12:13], s[54:55], s[52:53]
    s_cmp_eq_u32 s16, 2
    s_cselect_b64 s[12:13], s[56:57], s[12:13]
    s_mov_b32 s14, 4718592
    s_mov_b32 s15, 0x20000
    s_lshl_b32 s28, s17, 8
    s_lshl_b32 s21, s18, 6
    s_add_u32 s28, s28, s21
    s_add_u32 s21, s28, 0
    s_add_u32 m0, s31, 40960
    s_nop 0
    buffer_load_dwordx4 v6, s[12:15], s21 offen lds
    s_add_u32 m0, s31, 41984
    s_add_u32 s21, s21, 131072
    buffer_load_dwordx4 v6, s[12:15], s21 offen lds
    s_add_u32 m0, s31, 43008
    s_add_u32 s21, s21, 131072
    buffer_load_dwordx4 v6, s[12:15], s21 offen lds
    s_add_u32 m0, s31, 44032
    s_add_u32 s21, s21, 131072
    buffer_load_dwordx4 v6, s[12:15], s21 offen lds
    s_add_u32 s21, s28, 256
    s_add_u32 m0, s31, 57344
    s_nop 0
    buffer_load_dwordx4 v6, s[12:15], s21 offen lds
    s_add_u32 m0, s31, 58368
    s_add_u32 s21, s21, 131072
    buffer_load_dwordx4 v6, s[12:15], s21 offen lds
    s_add_u32 m0, s31, 59392
    s_add_u32 s21, s21, 131072
    buffer_load_dwordx4 v6, s[12:15], s21 offen lds
    s_add_u32 m0, s31, 60416
    s_add_u32 s21, s21, 131072
    buffer_load_dwordx4 v6, s[12:15], s21 offen lds
    s_add_u32 s21, s28, 524288
    s_add_u32 m0, s31, 73728
    s_nop 0
    buffer_load_dwordx4 v6, s[12:15], s21 offen lds
    s_add_u32 m0, s31, 74752
    s_add_u32 s21, s21, 131072
    buffer_load_dwordx4 v6, s[12:15], s21 offen lds
    s_add_u32 m0, s31, 75776
    s_add_u32 s21, s21, 131072
    buffer_load_dwordx4 v6, s[12:15], s21 offen lds
    s_add_u32 m0, s31, 76800
    s_add_u32 s21, s21, 131072
    buffer_load_dwordx4 v6, s[12:15], s21 offen lds
    s_add_u32 s21, s28, 524544
    s_add_u32 m0, s31, 90112
    s_nop 0
    buffer_load_dwordx4 v6, s[12:15], s21 offen lds
    s_add_u32 m0, s31, 91136
    s_add_u32 s21, s21, 131072
    buffer_load_dwordx4 v6, s[12:15], s21 offen lds
    s_add_u32 m0, s31, 92160
    s_add_u32 s21, s21, 131072
    buffer_load_dwordx4 v6, s[12:15], s21 offen lds
    s_add_u32 m0, s31, 93184
    s_add_u32 s21, s21, 131072
    buffer_load_dwordx4 v6, s[12:15], s21 offen lds
    s_add_u32 s21, s28, 1048576
    s_add_u32 m0, s31, 106496
    s_nop 0
    buffer_load_dwordx4 v6, s[12:15], s21 offen lds
    s_add_u32 m0, s31, 107520
    s_add_u32 s21, s21, 131072
    buffer_load_dwordx4 v6, s[12:15], s21 offen lds
    s_add_u32 m0, s31, 108544
    s_add_u32 s21, s21, 131072
    buffer_load_dwordx4 v6, s[12:15], s21 offen lds
    s_add_u32 m0, s31, 109568
    s_add_u32 s21, s21, 131072
    buffer_load_dwordx4 v6, s[12:15], s21 offen lds
    s_add_u32 s21, s28, 1048832
    s_add_u32 m0, s31, 122880
    s_nop 0
    buffer_load_dwordx4 v6, s[12:15], s21 offen lds
    s_add_u32 m0, s31, 123904
    s_add_u32 s21, s21, 131072
    buffer_load_dwordx4 v6, s[12:15], s21 offen lds
    s_add_u32 m0, s31, 124928
    s_add_u32 s21, s21, 131072
    buffer_load_dwordx4 v6, s[12:15], s21 offen lds
    s_add_u32 m0, s31, 125952
    s_add_u32 s21, s21, 131072
    buffer_load_dwordx4 v6, s[12:15], s21 offen lds
    s_add_u32 s21, s28, 1572864
    s_add_u32 m0, s31, 139264
    s_nop 0
    buffer_load_dwordx4 v6, s[12:15], s21 offen lds
    s_add_u32 m0, s31, 140288
    s_add_u32 s21, s21, 131072
    buffer_load_dwordx4 v6, s[12:15], s21 offen lds
    s_add_u32 m0, s31, 141312
    s_add_u32 s21, s21, 131072
    buffer_load_dwordx4 v6, s[12:15], s21 offen lds
    s_add_u32 m0, s31, 142336
    s_add_u32 s21, s21, 131072
    buffer_load_dwordx4 v6, s[12:15], s21 offen lds
    v_and_b32 v5, 15, v4
    v_lshrrev_b32 v3, 4, v4
    v_lshrrev_b32 v2, 2, v5
    v_xor_b32 v3, v3, v2
    v_lshl_add_u32 v3, v5, 2, v3
    v_lshlrev_b32 v1, 4, v3
    v_lshrrev_b32 v5, 2, v4
    v_lshrrev_b32 v3, 4, v4
    v_and_b32 v4, 3, v4
    v_xor_b32 v4, v4, v3
    v_lshlrev_b32 v3, 3, v3
    v_and_b32 v5, 3, v5
    v_add_u32 v3, v3, v5
    v_mul_u32_u24 v2, 1152, v3
    v_lshl_add_u32 v2, v4, 4, v2
    s_mov_b32 s8, s48
    s_mov_b32 s9, s49
    s_mov_b32 s10, 2359296
    s_mov_b32 s11, 0x20000
    s_lshr_b32 s22, s18, 1
    s_mul_i32 s24, s22, 4608
    s_and_b32 s22, s18, 1
    s_mul_i32 s23, s22, 576
    s_add_u32 s24, s24, s23
    s_mul_i32 s25, s18, 9216
    s_mul_i32 s22, s19, 36864
    s_add_u32 s24, s24, s22
    s_mul_i32 s42, s20, 36864
    s_mov_b32 s27, 0
    s_add_u32 s23, s27, s25
    s_add_u32 m0, s23, 0
    s_nop 0
    buffer_load_dwordx4 v2, s[8:11], s24 offen offset:0 lds
    s_add_u32 m0, s23, 960
    s_nop 0
    buffer_load_dwordx4 v2, s[8:11], s24 offen offset:64 lds
    s_add_u32 m0, s23, 1920
    s_nop 0
    buffer_load_dwordx4 v2, s[8:11], s24 offen offset:128 lds
    s_add_u32 m0, s23, 2880
    s_nop 0
    buffer_load_dwordx4 v2, s[8:11], s24 offen offset:192 lds
    s_add_u32 m0, s23, 3840
    s_nop 0
    buffer_load_dwordx4 v2, s[8:11], s24 offen offset:256 lds
    s_add_u32 m0, s23, 4800
    s_nop 0
    buffer_load_dwordx4 v2, s[8:11], s24 offen offset:320 lds
    s_add_u32 m0, s23, 5760
    s_nop 0
    buffer_load_dwordx4 v2, s[8:11], s24 offen offset:384 lds
    s_add_u32 m0, s23, 6720
    s_nop 0
    buffer_load_dwordx4 v2, s[8:11], s24 offen offset:448 lds
    s_add_u32 m0, s23, 7680
    s_nop 0
    buffer_load_dwordx4 v2, s[8:11], s24 offen offset:512 lds
    s_add_u32 s24, s24, s42
    s_lshl_b32 s22, s19, 5
    s_add_u32 s22, s22, s17
    s_lshl_b32 s26, s22, 14
    s_mul_i32 s23, s18, 3072
    s_add_u32 s26, s26, s23
    s_lshl_b32 s23, s16, 11
    s_add_u32 s26, s26, s23
    s_add_u32 s26, s26, -2048
    s_lshl_b32 s22, s22, 13
    s_add_u32 s22, s22, 33554432
    s_cmp_eq_u32 s16, 0
    s_cselect_b32 s26, s22, s26
    s_cselect_b32 s40, 4, 1
    s_cselect_b32 s43, 1, 2
    s_lshl_b32 s40, s40, 10
    s_lshl_b32 s43, s43, 13
    s_lshl_b32 s41, s43, 5
    s_mul_i32 s41, s41, s20
    s_lshl_b32 s29, s17, 7
    s_lshl_b32 s22, s33, 2
    s_add_u32 s29, s29, s22
    s_add_u32 s29, s29, 125829120
    v_add_u32 v25, 40960, v24
    v_xor_b32 v26, 32, v25
    s_waitcnt vmcnt(33)
    ds_read_b64_tr_b16 v[64:65], v25 offset:0
    ds_read_b64_tr_b16 v[66:67], v25 offset:256
    ds_read_b64_tr_b16 v[136:137], v26 offset:0
    ds_read_b64_tr_b16 v[138:139], v26 offset:256
    ds_read_b64_tr_b16 v[68:69], v25 offset:2048
    ds_read_b64_tr_b16 v[70:71], v25 offset:2304
    ds_read_b64_tr_b16 v[140:141], v26 offset:2048
    ds_read_b64_tr_b16 v[142:143], v26 offset:2304
    s_waitcnt lgkmcnt(0)
    s_add_u32 s21, s28, 1573120
    s_add_u32 m0, s31, 40960
    s_nop 0
    buffer_load_dwordx4 v6, s[12:15], s21 offen lds
    s_add_u32 m0, s31, 41984
    s_add_u32 s21, s21, 131072
    buffer_load_dwordx4 v6, s[12:15], s21 offen lds
    s_add_u32 m0, s31, 43008
    s_add_u32 s21, s21, 131072
    buffer_load_dwordx4 v6, s[12:15], s21 offen lds
    s_add_u32 m0, s31, 44032
    s_add_u32 s21, s21, 131072
    buffer_load_dwordx4 v6, s[12:15], s21 offen lds
    v_add_u32 v25, 57344, v24
    v_xor_b32 v26, 32, v25
    s_waitcnt vmcnt(33)
    ds_read_b64_tr_b16 a[0:1], v25 offset:0
    ds_read_b64_tr_b16 a[2:3], v25 offset:256
    ds_read_b64_tr_b16 a[72:73], v26 offset:0
    ds_read_b64_tr_b16 a[74:75], v26 offset:256
    ds_read_b64_tr_b16 a[4:5], v25 offset:2048
    ds_read_b64_tr_b16 a[6:7], v25 offset:2304
    ds_read_b64_tr_b16 a[76:77], v26 offset:2048
    ds_read_b64_tr_b16 a[78:79], v26 offset:2304
    s_waitcnt lgkmcnt(0)
    s_add_u32 s21, s28, 2097152
    s_add_u32 m0, s31, 57344
    s_nop 0
    buffer_load_dwordx4 v6, s[12:15], s21 offen lds
    s_add_u32 m0, s31, 58368
    s_add_u32 s21, s21, 131072
    buffer_load_dwordx4 v6, s[12:15], s21 offen lds
    s_add_u32 m0, s31, 59392
    s_add_u32 s21, s21, 131072
    buffer_load_dwordx4 v6, s[12:15], s21 offen lds
    s_add_u32 m0, s31, 60416
    s_add_u32 s21, s21, 131072
    buffer_load_dwordx4 v6, s[12:15], s21 offen lds
    v_add_u32 v25, 73728, v24
    v_xor_b32 v26, 32, v25
    s_waitcnt vmcnt(33)
    ds_read_b64_tr_b16 v[72:73], v25 offset:0
    ds_read_b64_tr_b16 v[74:75], v25 offset:256
    ds_read_b64_tr_b16 v[144:145], v26 offset:0
    ds_read_b64_tr_b16 v[146:147], v26 offset:256
    ds_read_b64_tr_b16 v[76:77], v25 offset:2048
    ds_read_b64_tr_b16 v[78:79], v25 offset:2304
    ds_read_b64_tr_b16 v[148:149], v26 offset:2048
    ds_read_b64_tr_b16 v[150:151], v26 offset:2304
    s_waitcnt lgkmcnt(0)
    s_add_u32 s21, s28, 2097408
    s_add_u32 m0, s31, 73728
    s_nop 0
    buffer_load_dwordx4 v6, s[12:15], s21 offen lds
    s_add_u32 m0, s31, 74752
    s_add_u32 s21, s21, 131072
    buffer_load_dwordx4 v6, s[12:15], s21 offen lds
    s_add_u32 m0, s31, 75776
    s_add_u32 s21, s21, 131072
    buffer_load_dwordx4 v6, s[12:15], s21 offen lds
    s_add_u32 m0, s31, 76800
    s_add_u32 s21, s21, 131072
    buffer_load_dwordx4 v6, s[12:15], s21 offen lds
    v_add_u32 v25, 90112, v24
    v_xor_b32 v26, 32, v25
    s_waitcnt vmcnt(33)
    ds_read_b64_tr_b16 a[8:9], v25 offset:0
    ds_read_b64_tr_b16 a[10:11], v25 offset:256
    ds_read_b64_tr_b16 a[80:81], v26 offset:0
    ds_read_b64_tr_b16 a[82:83], v26 offset:256
    ds_read_b64_tr_b16 a[12:13], v25 offset:2048
    ds_read_b64_tr_b16 a[14:15], v25 offset:2304
    ds_read_b64_tr_b16 a[84:85], v26 offset:2048
    ds_read_b64_tr_b16 a[86:87], v26 offset:2304
    s_waitcnt lgkmcnt(0)
    s_add_u32 s21, s28, 2621440
    s_add_u32 m0, s31, 90112
    s_nop 0
    buffer_load_dwordx4 v6, s[12:15], s21 offen lds
    s_add_u32 m0, s31, 91136
    s_add_u32 s21, s21, 131072
    buffer_load_dwordx4 v6, s[12:15], s21 offen lds
    s_add_u32 m0, s31, 92160
    s_add_u32 s21, s21, 131072
    buffer_load_dwordx4 v6, s[12:15], s21 offen lds
    s_add_u32 m0, s31, 93184
    s_add_u32 s21, s21, 131072
    buffer_load_dwordx4 v6, s[12:15], s21 offen lds
    v_add_u32 v25, 106496, v24
    v_xor_b32 v26, 32, v25
    s_waitcnt vmcnt(33)
    ds_read_b64_tr_b16 v[80:81], v25 offset:0
    ds_read_b64_tr_b16 v[82:83], v25 offset:256
    ds_read_b64_tr_b16 v[152:153], v26 offset:0
    ds_read_b64_tr_b16 v[154:155], v26 offset:256
    ds_read_b64_tr_b16 v[84:85], v25 offset:2048
    ds_read_b64_tr_b16 v[86:87], v25 offset:2304
    ds_read_b64_tr_b16 v[156:157], v26 offset:2048
    ds_read_b64_tr_b16 v[158:159], v26 offset:2304
    s_waitcnt lgkmcnt(0)
    s_add_u32 s21, s28, 2621696
    s_add_u32 m0, s31, 106496
    s_nop 0
    buffer_load_dwordx4 v6, s[12:15], s21 offen lds
    s_add_u32 m0, s31, 107520
    s_add_u32 s21, s21, 131072
    buffer_load_dwordx4 v6, s[12:15], s21 offen lds
    s_add_u32 m0, s31, 108544
    s_add_u32 s21, s21, 131072
    buffer_load_dwordx4 v6, s[12:15], s21 offen lds
    s_add_u32 m0, s31, 109568
    s_add_u32 s21, s21, 131072
    buffer_load_dwordx4 v6, s[12:15], s21 offen lds
    v_add_u32 v25, 122880, v24
    v_xor_b32 v26, 32, v25
    s_waitcnt vmcnt(33)
    ds_read_b64_tr_b16 a[16:17], v25 offset:0
    ds_read_b64_tr_b16 a[18:19], v25 offset:256
    ds_read_b64_tr_b16 a[88:89], v26 offset:0
    ds_read_b64_tr_b16 a[90:91], v26 offset:256
    ds_read_b64_tr_b16 a[20:21], v25 offset:2048
    ds_read_b64_tr_b16 a[22:23], v25 offset:2304
    ds_read_b64_tr_b16 a[92:93], v26 offset:2048
    ds_read_b64_tr_b16 a[94:95], v26 offset:2304
    s_waitcnt lgkmcnt(0)
    s_add_u32 s21, s28, 3145728
    s_add_u32 m0, s31, 122880
    s_nop 0
    buffer_load_dwordx4 v6, s[12:15], s21 offen lds
    s_add_u32 m0, s31, 123904
    s_add_u32 s21, s21, 131072
    buffer_load_dwordx4 v6, s[12:15], s21 offen lds
    s_add_u32 m0, s31, 124928
    s_add_u32 s21, s21, 131072
    buffer_load_dwordx4 v6, s[12:15], s21 offen lds
    s_add_u32 m0, s31, 125952
    s_add_u32 s21, s21, 131072
    buffer_load_dwordx4 v6, s[12:15], s21 offen lds
    v_add_u32 v25, 139264, v24
    v_xor_b32 v26, 32, v25
    s_waitcnt vmcnt(33)
    ds_read_b64_tr_b16 v[88:89], v25 offset:0
    ds_read_b64_tr_b16 v[90:91], v25 offset:256
    ds_read_b64_tr_b16 v[160:161], v26 offset:0
    ds_read_b64_tr_b16 v[162:163], v26 offset:256
    ds_read_b64_tr_b16 v[92:93], v25 offset:2048
    ds_read_b64_tr_b16 v[94:95], v25 offset:2304
    ds_read_b64_tr_b16 v[164:165], v26 offset:2048
    ds_read_b64_tr_b16 v[166:167], v26 offset:2304
    s_waitcnt lgkmcnt(0)
    s_add_u32 s21, s28, 3145984
    s_add_u32 m0, s31, 139264
    s_nop 0
    buffer_load_dwordx4 v6, s[12:15], s21 offen lds
    s_add_u32 m0, s31, 140288
    s_add_u32 s21, s21, 131072
    buffer_load_dwordx4 v6, s[12:15], s21 offen lds
    s_add_u32 m0, s31, 141312
    s_add_u32 s21, s21, 131072
    buffer_load_dwordx4 v6, s[12:15], s21 offen lds
    s_add_u32 m0, s31, 142336
    s_add_u32 s21, s21, 131072
    buffer_load_dwordx4 v6, s[12:15], s21 offen lds
    v_add_u32 v25, 40960, v24
    v_xor_b32 v26, 32, v25
    s_waitcnt vmcnt(24)
    ds_read_b64_tr_b16 a[24:25], v25 offset:0
    ds_read_b64_tr_b16 a[26:27], v25 offset:256
    ds_read_b64_tr_b16 a[96:97], v26 offset:0
    ds_read_b64_tr_b16 a[98:99], v26 offset:256
    ds_read_b64_tr_b16 a[28:29], v25 offset:2048
    ds_read_b64_tr_b16 a[30:31], v25 offset:2304
    ds_read_b64_tr_b16 a[100:101], v26 offset:2048
    ds_read_b64_tr_b16 a[102:103], v26 offset:2304
    s_waitcnt lgkmcnt(0)
    s_add_u32 s21, s28, 3670016
    s_add_u32 m0, s31, 40960
    s_nop 0
    buffer_load_dwordx4 v6, s[12:15], s21 offen lds
    s_add_u32 m0, s31, 41984
    s_add_u32 s21, s21, 131072
    buffer_load_dwordx4 v6, s[12:15], s21 offen lds
    s_add_u32 m0, s31, 43008
    s_add_u32 s21, s21, 131072
    buffer_load_dwordx4 v6, s[12:15], s21 offen lds
    s_add_u32 m0, s31, 44032
    s_add_u32 s21, s21, 131072
    buffer_load_dwordx4 v6, s[12:15], s21 offen lds
    v_add_u32 v25, 57344, v24
    v_xor_b32 v26, 32, v25
    s_waitcnt vmcnt(24)
    ds_read_b64_tr_b16 v[96:97], v25 offset:0
    ds_read_b64_tr_b16 v[98:99], v25 offset:256
    ds_read_b64_tr_b16 v[168:169], v26 offset:0
    ds_read_b64_tr_b16 v[170:171], v26 offset:256
    ds_read_b64_tr_b16 v[100:101], v25 offset:2048
    ds_read_b64_tr_b16 v[102:103], v25 offset:2304
    ds_read_b64_tr_b16 v[172:173], v26 offset:2048
    ds_read_b64_tr_b16 v[174:175], v26 offset:2304
    s_waitcnt lgkmcnt(0)
    s_add_u32 s21, s28, 3670272
    s_add_u32 m0, s31, 57344
    s_nop 0
    buffer_load_dwordx4 v6, s[12:15], s21 offen lds
    s_add_u32 m0, s31, 58368
    s_add_u32 s21, s21, 131072
    buffer_load_dwordx4 v6, s[12:15], s21 offen lds
    s_add_u32 m0, s31, 59392
    s_add_u32 s21, s21, 131072
    buffer_load_dwordx4 v6, s[12:15], s21 offen lds
    s_add_u32 m0, s31, 60416
    s_add_u32 s21, s21, 131072
    buffer_load_dwordx4 v6, s[12:15], s21 offen lds
    v_add_u32 v25, 73728, v24
    v_xor_b32 v26, 32, v25
    s_waitcnt vmcnt(24)
    ds_read_b64_tr_b16 a[32:33], v25 offset:0
    ds_read_b64_tr_b16 a[34:35], v25 offset:256
    ds_read_b64_tr_b16 a[104:105], v26 offset:0
    ds_read_b64_tr_b16 a[106:107], v26 offset:256
    ds_read_b64_tr_b16 a[36:37], v25 offset:2048
    ds_read_b64_tr_b16 a[38:39], v25 offset:2304
    ds_read_b64_tr_b16 a[108:109], v26 offset:2048
    ds_read_b64_tr_b16 a[110:111], v26 offset:2304
    s_waitcnt lgkmcnt(0)
    s_add_u32 s21, s28, 4194304
    s_add_u32 m0, s31, 73728
    s_nop 0
    buffer_load_dwordx4 v6, s[12:15], s21 offen lds
    s_add_u32 m0, s31, 74752
    s_add_u32 s21, s21, 131072
    buffer_load_dwordx4 v6, s[12:15], s21 offen lds
    s_add_u32 m0, s31, 75776
    s_add_u32 s21, s21, 131072
    buffer_load_dwordx4 v6, s[12:15], s21 offen lds
    s_add_u32 m0, s31, 76800
    s_add_u32 s21, s21, 131072
    buffer_load_dwordx4 v6, s[12:15], s21 offen lds
    v_add_u32 v25, 90112, v24
    v_xor_b32 v26, 32, v25
    s_waitcnt vmcnt(24)
    ds_read_b64_tr_b16 v[104:105], v25 offset:0
    ds_read_b64_tr_b16 v[106:107], v25 offset:256
    ds_read_b64_tr_b16 v[176:177], v26 offset:0
    ds_read_b64_tr_b16 v[178:179], v26 offset:256
    ds_read_b64_tr_b16 v[108:109], v25 offset:2048
    ds_read_b64_tr_b16 v[110:111], v25 offset:2304
    ds_read_b64_tr_b16 v[180:181], v26 offset:2048
    ds_read_b64_tr_b16 v[182:183], v26 offset:2304
    s_waitcnt lgkmcnt(0)
    s_add_u32 s21, s28, 4194560
    s_add_u32 m0, s31, 90112
    s_nop 0
    buffer_load_dwordx4 v6, s[12:15], s21 offen lds
    s_add_u32 m0, s31, 91136
    s_add_u32 s21, s21, 131072
    buffer_load_dwordx4 v6, s[12:15], s21 offen lds
    s_add_u32 m0, s31, 92160
    s_add_u32 s21, s21, 131072
    buffer_load_dwordx4 v6, s[12:15], s21 offen lds
    s_add_u32 m0, s31, 93184
    s_add_u32 s21, s21, 131072
    buffer_load_dwordx4 v6, s[12:15], s21 offen lds
    v_add_u32 v25, 106496, v24
    v_xor_b32 v26, 32, v25
    s_waitcnt vmcnt(24)
    ds_read_b64_tr_b16 a[40:41], v25 offset:0
    ds_read_b64_tr_b16 a[42:43], v25 offset:256
    ds_read_b64_tr_b16 a[112:113], v26 offset:0
    ds_read_b64_tr_b16 a[114:115], v26 offset:256
    ds_read_b64_tr_b16 a[44:45], v25 offset:2048
    ds_read_b64_tr_b16 a[46:47], v25 offset:2304
    ds_read_b64_tr_b16 a[116:117], v26 offset:2048
    ds_read_b64_tr_b16 a[118:119], v26 offset:2304
    s_waitcnt lgkmcnt(0)
    v_add_u32 v25, 122880, v24
    v_xor_b32 v26, 32, v25
    s_waitcnt vmcnt(20)
    ds_read_b64_tr_b16 v[112:113], v25 offset:0
    ds_read_b64_tr_b16 v[114:115], v25 offset:256
    ds_read_b64_tr_b16 v[184:185], v26 offset:0
    ds_read_b64_tr_b16 v[186:187], v26 offset:256
    ds_read_b64_tr_b16 v[116:117], v25 offset:2048
    ds_read_b64_tr_b16 v[118:119], v25 offset:2304
    ds_read_b64_tr_b16 v[188:189], v26 offset:2048
    ds_read_b64_tr_b16 v[190:191], v26 offset:2304
    s_waitcnt lgkmcnt(0)
    v_add_u32 v25, 139264, v24
    v_xor_b32 v26, 32, v25
    s_waitcnt vmcnt(16)
    ds_read_b64_tr_b16 a[48:49], v25 offset:0
    ds_read_b64_tr_b16 a[50:51], v25 offset:256
    ds_read_b64_tr_b16 a[120:121], v26 offset:0
    ds_read_b64_tr_b16 a[122:123], v26 offset:256
    ds_read_b64_tr_b16 a[52:53], v25 offset:2048
    ds_read_b64_tr_b16 a[54:55], v25 offset:2304
    ds_read_b64_tr_b16 a[124:125], v26 offset:2048
    ds_read_b64_tr_b16 a[126:127], v26 offset:2304
    s_waitcnt lgkmcnt(0)
    v_add_u32 v25, 40960, v24
    v_xor_b32 v26, 32, v25
    s_waitcnt vmcnt(12)
    ds_read_b64_tr_b16 v[120:121], v25 offset:0
    ds_read_b64_tr_b16 v[122:123], v25 offset:256
    ds_read_b64_tr_b16 v[192:193], v26 offset:0
    ds_read_b64_tr_b16 v[194:195], v26 offset:256
    ds_read_b64_tr_b16 v[124:125], v25 offset:2048
    ds_read_b64_tr_b16 v[126:127], v25 offset:2304
    ds_read_b64_tr_b16 v[196:197], v26 offset:2048
    ds_read_b64_tr_b16 v[198:199], v26 offset:2304
    s_waitcnt lgkmcnt(0)
    v_add_u32 v25, 57344, v24
    v_xor_b32 v26, 32, v25
    s_waitcnt vmcnt(8)
    ds_read_b64_tr_b16 a[56:57], v25 offset:0
    ds_read_b64_tr_b16 a[58:59], v25 offset:256
    ds_read_b64_tr_b16 a[128:129], v26 offset:0
    ds_read_b64_tr_b16 a[130:131], v26 offset:256
    ds_read_b64_tr_b16 a[60:61], v25 offset:2048
    ds_read_b64_tr_b16 a[62:63], v25 offset:2304
    ds_read_b64_tr_b16 a[132:133], v26 offset:2048
    ds_read_b64_tr_b16 a[134:135], v26 offset:2304
    s_waitcnt lgkmcnt(0)
    v_add_u32 v25, 73728, v24
    v_xor_b32 v26, 32, v25
    s_waitcnt vmcnt(4)
    ds_read_b64_tr_b16 v[128:129], v25 offset:0
    ds_read_b64_tr_b16 v[130:131], v25 offset:256
    ds_read_b64_tr_b16 v[200:201], v26 offset:0
    ds_read_b64_tr_b16 v[202:203], v26 offset:256
    ds_read_b64_tr_b16 v[132:133], v25 offset:2048
    ds_read_b64_tr_b16 v[134:135], v25 offset:2304
    ds_read_b64_tr_b16 v[204:205], v26 offset:2048
    ds_read_b64_tr_b16 v[206:207], v26 offset:2304
    s_waitcnt lgkmcnt(0)
    v_add_u32 v25, 90112, v24
    v_xor_b32 v26, 32, v25
    s_waitcnt vmcnt(0)
    ds_read_b64_tr_b16 a[64:65], v25 offset:0
    ds_read_b64_tr_b16 a[66:67], v25 offset:256
    ds_read_b64_tr_b16 a[136:137], v26 offset:0
    ds_read_b64_tr_b16 a[138:139], v26 offset:256
    ds_read_b64_tr_b16 a[68:69], v25 offset:2048
    ds_read_b64_tr_b16 a[70:71], v25 offset:2304
    ds_read_b64_tr_b16 a[140:141], v26 offset:2048
    ds_read_b64_tr_b16 a[142:143], v26 offset:2304
    s_waitcnt lgkmcnt(0)
    s_mov_b32 s88, 4194304
gn6:
    s_cmp_lg_u32 s95, 0
    s_cbranch_scc1 gn6x
    buffer_load_dword v25, off, s[96:99], 0 offset:144 sc1
    s_sub_u32 s88, s88, 1
    s_cbranch_scc1 gn6x
    s_waitcnt vmcnt(0)
    v_readfirstlane_b32 s95, v25
    s_nop 1
    s_branch gn6
gn6x:
    s_barrier
    s_mov_b32 s27, 36864
    s_add_u32 s23, s27, s25
    s_add_u32 m0, s23, 0
    s_nop 0
    buffer_load_dwordx4 v2, s[8:11], s24 offen offset:0 lds
    s_add_u32 m0, s23, 960
    s_nop 0
    buffer_load_dwordx4 v2, s[8:11], s24 offen offset:64 lds
    s_add_u32 m0, s23, 1920
    s_nop 0
    buffer_load_dwordx4 v2, s[8:11], s24 offen offset:128 lds
    s_add_u32 m0, s23, 2880
    s_nop 0
    buffer_load_dwordx4 v2, s[8:11], s24 offen offset:192 lds
    s_add_u32 m0, s23, 3840
    s_nop 0
    buffer_load_dwordx4 v2, s[8:11], s24 offen offset:256 lds
    s_add_u32 m0, s23, 4800
    s_nop 0
    buffer_load_dwordx4 v2, s[8:11], s24 offen offset:320 lds
    s_add_u32 m0, s23, 5760
    s_nop 0
    buffer_load_dwordx4 v2, s[8:11], s24 offen offset:384 lds
    s_add_u32 m0, s23, 6720
    s_nop 0
    buffer_load_dwordx4 v2, s[8:11], s24 offen offset:448 lds
    s_add_u32 m0, s23, 7680
    s_nop 0
    buffer_load_dwordx4 v2, s[8:11], s24 offen offset:512 lds
    s_add_u32 s24, s24, s42
    s_mov_b32 s27, 0
    s_mov_b32 s30, s95
    s_cmp_eq_u32 s18, 0
    s_cselect_b32 s34, 1, 0
    s_mov_b32 s35, 0
    s_cmp_eq_u32 s16, 2
    s_cbranch_scc1 qk_vloop
qk_loop:
    s_barrier
    v_add_u32 v3, s27, v1
    ds_read_b128 v[32:35], v3 offset:0
    ds_read_b128 v[36:39], v3 offset:18432
    ds_read_b128 v[40:43], v3 offset:1024
    ds_read_b128 v[44:47], v3 offset:19456
    ds_read_b128 v[48:51], v3 offset:2048
    ds_read_b128 v[52:55], v3 offset:20480
    s_sub_u32 s22, s30, 1
    v_mov_b32 v4, s22
    s_mov_b64 exec, s[34:35]
    buffer_store_dword v4, off, s[4:7], s29 sc1
    s_mov_b64 exec, -1
    s_add_u32 s22, s27, 73728
    s_sub_u32 s21, s22, 110592
    s_cselect_b32 s22, s22, s21
    ds_read_b128 v[56:59], v3 offset:3072
    ds_read_b128 v[60:63], v3 offset:21504
    s_add_u32 s23, s22, s25
    s_add_u32 m0, s23, 0
    s_nop 0
    buffer_load_dwordx4 v2, s[8:11], s24 offen offset:0 lds
    s_waitcnt lgkmcnt(6)
    v_mfma_f32_16x16x32_bf16 v[208:211], v[64:67], v[32:35], 0
    v_mfma_f32_16x16x32_bf16 v[212:215], v[136:139], v[32:35], 0
    v_mfma_f32_16x16x32_bf16 v[216:219], v[64:67], v[36:39], 0
    v_mfma_f32_16x16x32_bf16 v[220:223], v[136:139], v[36:39], 0
    v_mfma_f32_16x16x32_bf16 v[224:227], a[0:3], v[32:35], 0
    v_mfma_f32_16x16x32_bf16 v[228:231], a[72:75], v[32:35], 0
    v_mfma_f32_16x16x32_bf16 v[232:235], a[0:3], v[36:39], 0
    v_mfma_f32_16x16x32_bf16 v[236:239], a[72:75], v[36:39], 0
    ds_read_b128 v[32:35], v3 offset:4096
    ds_read_b128 v[36:39], v3 offset:22528
    s_add_u32 m0, s23, 960
    s_nop 0
    buffer_load_dwordx4 v2, s[8:11], s24 offen offset:64 lds
    s_waitcnt lgkmcnt(6)
    v_mfma_f32_16x16x32_bf16 v[208:211], v[68:71], v[40:43], v[208:211]
    v_mfma_f32_16x16x32_bf16 v[212:215], v[140:143], v[40:43], v[212:215]
    v_mfma_f32_16x16x32_bf16 v[216:219], v[68:71], v[44:47], v[216:219]
    v_mfma_f32_16x16x32_bf16 v[220:223], v[140:143], v[44:47], v[220:223]
    v_mfma_f32_16x16x32_bf16 v[224:227], a[4:7], v[40:43], v[224:227]
    v_mfma_f32_16x16x32_bf16 v[228:231], a[76:79], v[40:43], v[228:231]
    v_mfma_f32_16x16x32_bf16 v[232:235], a[4:7], v[44:47], v[232:235]
    v_mfma_f32_16x16x32_bf16 v[236:239], a[76:79], v[44:47], v[236:239]
    ds_read_b128 v[40:43], v3 offset:5120
    ds_read_b128 v[44:47], v3 offset:23552
    s_add_u32 m0, s23, 1920
    s_nop 0
    buffer_load_dwordx4 v2, s[8:11], s24 offen offset:128 lds
    s_waitcnt lgkmcnt(6)
    v_mfma_f32_16x16x32_bf16 v[208:211], v[72:75], v[48:51], v[208:211]
    v_mfma_f32_16x16x32_bf16 v[212:215], v[144:147], v[48:51], v[212:215]
    v_mfma_f32_16x16x32_bf16 v[216:219], v[72:75], v[52:55], v[216:219]
    v_mfma_f32_16x16x32_bf16 v[220:223], v[144:147], v[52:55], v[220:223]
    v_mfma_f32_16x16x32_bf16 v[224:227], a[8:11], v[48:51], v[224:227]
    v_mfma_f32_16x16x32_bf16 v[228:231], a[80:83], v[48:51], v[228:231]
    v_mfma_f32_16x16x32_bf16 v[232:235], a[8:11], v[52:55], v[232:235]
    v_mfma_f32_16x16x32_bf16 v[236:239], a[80:83], v[52:55], v[236:239]
    ds_read_b128 v[48:51], v3 offset:6144
    ds_read_b128 v[52:55], v3 offset:24576
    s_add_u32 m0, s23, 2880
    s_nop 0
    buffer_load_dwordx4 v2, s[8:11], s24 offen offset:192 lds
    s_waitcnt lgkmcnt(6)
    v_mfma_f32_16x16x32_bf16 v[208:211], v[76:79], v[56:59], v[208:211]
    v_mfma_f32_16x16x32_bf16 v[212:215], v[148:151], v[56:59], v[212:215]
    v_mfma_f32_16x16x32_bf16 v[216:219], v[76:79], v[60:63], v[216:219]
    v_mfma_f32_16x16x32_bf16 v[220:223], v[148:151], v[60:63], v[220:223]
    v_mfma_f32_16x16x32_bf16 v[224:227], a[12:15], v[56:59], v[224:227]
    v_mfma_f32_16x16x32_bf16 v[228:231], a[84:87], v[56:59], v[228:231]
    v_mfma_f32_16x16x32_bf16 v[232:235], a[12:15], v[60:63], v[232:235]
    v_mfma_f32_16x16x32_bf16 v[236:239], a[84:87], v[60:63], v[236:239]
    ds_read_b128 v[56:59], v3 offset:7168
    ds_read_b128 v[60:63], v3 offset:25600
    s_add_u32 m0, s23, 3840
    s_nop 0
    buffer_load_dwordx4 v2, s[8:11], s24 offen offset:256 lds
    s_waitcnt lgkmcnt(6)
    v_mfma_f32_16x16x32_bf16 v[208:211], v[80:83], v[32:35], v[208:211]
    v_mfma_f32_16x16x32_bf16 v[212:215], v[152:155], v[32:35], v[212:215]
    v_mfma_f32_16x16x32_bf16 v[216:219], v[80:83], v[36:39], v[216:219]
    v_mfma_f32_16x16x32_bf16 v[220:223], v[152:155], v[36:39], v[220:223]
    v_mfma_f32_16x16x32_bf16 v[224:227], a[16:19], v[32:35], v[224:227]
    v_mfma_f32_16x16x32_bf16 v[228:231], a[88:91], v[32:35], v[228:231]
    v_mfma_f32_16x16x32_bf16 v[232:235], a[16:19], v[36:39], v[232:235]
    v_mfma_f32_16x16x32_bf16 v[236:239], a[88:91], v[36:39], v[236:239]
    ds_read_b128 v[32:35], v3 offset:8192
    ds_read_b128 v[36:39], v3 offset:26624
    s_add_u32 m0, s23, 4800
    s_nop 0
    buffer_load_dwordx4 v2, s[8:11], s24 offen offset:320 lds
    s_waitcnt lgkmcnt(6)
    v_mfma_f32_16x16x32_bf16 v[208:211], v[84:87], v[40:43], v[208:211]
    v_mfma_f32_16x16x32_bf16 v[212:215], v[156:159], v[40:43], v[212:215]
    v_mfma_f32_16x16x32_bf16 v[216:219], v[84:87], v[44:47], v[216:219]
    v_mfma_f32_16x16x32_bf16 v[220:223], v[156:159], v[44:47], v[220:223]
    v_mfma_f32_16x16x32_bf16 v[224:227], a[20:23], v[40:43], v[224:227]
    v_mfma_f32_16x16x32_bf16 v[228:231], a[92:95], v[40:43], v[228:231]
    v_mfma_f32_16x16x32_bf16 v[232:235], a[20:23], v[44:47], v[232:235]
    v_mfma_f32_16x16x32_bf16 v[236:239], a[92:95], v[44:47], v[236:239]
    ds_read_b128 v[40:43], v3 offset:9216
    ds_read_b128 v[44:47], v3 offset:27648
    s_add_u32 m0, s23, 5760
    s_nop 0
    buffer_load_dwordx4 v2, s[8:11], s24 offen offset:384 lds
    s_waitcnt lgkmcnt(6)
    v_mfma_f32_16x16x32_bf16 v[208:211], v[88:91], v[48:51], v[208:211]
    v_mfma_f32_16x16x32_bf16 v[212:215], v[160:163], v[48:51], v[212:215]
    v_mfma_f32_16x16x32_bf16 v[216:219], v[88:91], v[52:55], v[216:219]
    v_mfma_f32_16x16x32_bf16 v[220:223], v[160:163], v[52:55], v[220:223]
    v_mfma_f32_16x16x32_bf16 v[224:227], a[24:27], v[48:51], v[224:227]
    v_mfma_f32_16x16x32_bf16 v[228:231], a[96:99], v[48:51], v[228:231]
    v_mfma_f32_16x16x32_bf16 v[232:235], a[24:27], v[52:55], v[232:235]
    v_mfma_f32_16x16x32_bf16 v[236:239], a[96:99], v[52:55], v[236:239]
    ds_read_b128 v[48:51], v3 offset:10240
    ds_read_b128 v[52:55], v3 offset:28672
    s_add_u32 m0, s23, 6720
    s_nop 0
    buffer_load_dwordx4 v2, s[8:11], s24 offen offset:448 lds
    s_waitcnt lgkmcnt(6)
    v_mfma_f32_16x16x32_bf16 v[208:211], v[92:95], v[56:59], v[208:211]
    v_mfma_f32_16x16x32_bf16 v[212:215], v[164:167], v[56:59], v[212:215]
    v_mfma_f32_16x16x32_bf16 v[216:219], v[92:95], v[60:63], v[216:219]
    v_mfma_f32_16x16x32_bf16 v[220:223], v[164:167], v[60:63], v[220:223]
    v_mfma_f32_16x16x32_bf16 v[224:227], a[28:31], v[56:59], v[224:227]
    v_mfma_f32_16x16x32_bf16 v[228:231], a[100:103], v[56:59], v[228:231]
    v_mfma_f32_16x16x32_bf16 v[232:235], a[28:31], v[60:63], v[232:235]
    v_mfma_f32_16x16x32_bf16 v[236:239], a[100:103], v[60:63], v[236:239]
    ds_read_b128 v[56:59], v3 offset:11264
    ds_read_b128 v[60:63], v3 offset:29696
    s_add_u32 m0, s23, 7680
    s_nop 0
    buffer_load_dwordx4 v2, s[8:11], s24 offen offset:512 lds
    s_add_u32 s24, s24, s42
    s_waitcnt lgkmcnt(6)
    v_mfma_f32_16x16x32_bf16 v[208:211], v[96:99], v[32:35], v[208:211]
    v_mfma_f32_16x16x32_bf16 v[212:215], v[168:171], v[32:35], v[212:215]
    v_mfma_f32_16x16x32_bf16 v[216:219], v[96:99], v[36:39], v[216:219]
    v_mfma_f32_16x16x32_bf16 v[220:223], v[168:171], v[36:39], v[220:223]
    v_mfma_f32_16x16x32_bf16 v[224:227], a[32:35], v[32:35], v[224:227]
    v_mfma_f32_16x16x32_bf16 v[228:231], a[104:107], v[32:35], v[228:231]
    v_mfma_f32_16x16x32_bf16 v[232:235], a[32:35], v[36:39], v[232:235]
    v_mfma_f32_16x16x32_bf16 v[236:239], a[104:107], v[36:39], v[236:239]
    ds_read_b128 v[32:35], v3 offset:12288
    ds_read_b128 v[36:39], v3 offset:30720
    s_waitcnt lgkmcnt(6)
    v_mfma_f32_16x16x32_bf16 v[208:211], v[100:103], v[40:43], v[208:211]
    v_mfma_f32_16x16x32_bf16 v[212:215], v[172:175], v[40:43], v[212:215]
    v_mfma_f32_16x16x32_bf16 v[216:219], v[100:103], v[44:47], v[216:219]
    v_mfma_f32_16x16x32_bf16 v[220:223], v[172:175], v[44:47], v[220:223]
    v_mfma_f32_16x16x32_bf16 v[224:227], a[36:39], v[40:43], v[224:227]
    v_mfma_f32_16x16x32_bf16 v[228:231], a[108:111], v[40:43], v[228:231]
    v_mfma_f32_16x16x32_bf16 v[232:235], a[36:39], v[44:47], v[232:235]
    v_mfma_f32_16x16x32_bf16 v[236:239], a[108:111], v[44:47], v[236:239]
    ds_read_b128 v[40:43], v3 offset:13312
    ds_read_b128 v[44:47], v3 offset:31744
    s_waitcnt lgkmcnt(6)
    v_mfma_f32_16x16x32_bf16 v[208:211], v[104:107], v[48:51], v[208:211]
    v_mfma_f32_16x16x32_bf16 v[212:215], v[176:179], v[48:51], v[212:215]
    v_mfma_f32_16x16x32_bf16 v[216:219], v[104:107], v[52:55], v[216:219]
    v_mfma_f32_16x16x32_bf16 v[220:223], v[176:179], v[52:55], v[220:223]
    v_mfma_f32_16x16x32_bf16 v[224:227], a[40:43], v[48:51], v[224:227]
    v_mfma_f32_16x16x32_bf16 v[228:231], a[112:115], v[48:51], v[228:231]
    v_mfma_f32_16x16x32_bf16 v[232:235], a[40:43], v[52:55], v[232:235]
    v_mfma_f32_16x16x32_bf16 v[236:239], a[112:115], v[52:55], v[236:239]
    ds_read_b128 v[48:51], v3 offset:14336
    ds_read_b128 v[52:55], v3 offset:32768
    s_waitcnt lgkmcnt(6)
    v_mfma_f32_16x16x32_bf16 v[208:211], v[108:111], v[56:59], v[208:211]
    v_mfma_f32_16x16x32_bf16 v[212:215], v[180:183], v[56:59], v[212:215]
    v_mfma_f32_16x16x32_bf16 v[216:219], v[108:111], v[60:63], v[216:219]
    v_mfma_f32_16x16x32_bf16 v[220:223], v[180:183], v[60:63], v[220:223]
    v_mfma_f32_16x16x32_bf16 v[224:227], a[44:47], v[56:59], v[224:227]
    v_mfma_f32_16x16x32_bf16 v[228:231], a[116:119], v[56:59], v[228:231]
    v_mfma_f32_16x16x32_bf16 v[232:235], a[44:47], v[60:63], v[232:235]
    v_mfma_f32_16x16x32_bf16 v[236:239], a[116:119], v[60:63], v[236:239]
    ds_read_b128 v[56:59], v3 offset:15360
    ds_read_b128 v[60:63], v3 offset:33792
    s_waitcnt lgkmcnt(6)
    v_mfma_f32_16x16x32_bf16 v[208:211], v[112:115], v[32:35], v[208:211]
    v_mfma_f32_16x16x32_bf16 v[212:215], v[184:187], v[32:35], v[212:215]
    v_mfma_f32_16x16x32_bf16 v[216:219], v[112:115], v[36:39], v[216:219]
    v_mfma_f32_16x16x32_bf16 v[220:223], v[184:187], v[36:39], v[220:223]
    v_mfma_f32_16x16x32_bf16 v[224:227], a[48:51], v[32:35], v[224:227]
    v_mfma_f32_16x16x32_bf16 v[228:231], a[120:123], v[32:35], v[228:231]
    v_mfma_f32_16x16x32_bf16 v[232:235], a[48:51], v[36:39], v[232:235]
    v_mfma_f32_16x16x32_bf16 v[236:239], a[120:123], v[36:39], v[236:239]
    ds_read_b128 v[32:35], v3 offset:16384
    ds_read_b128 v[36:39], v3 offset:34816
    s_waitcnt lgkmcnt(6)
    v_mfma_f32_16x16x32_bf16 v[208:211], v[116:119], v[40:43], v[208:211]
    v_mfma_f32_16x16x32_bf16 v[212:215], v[188:191], v[40:43], v[212:215]
    v_mfma_f32_16x16x32_bf16 v[216:219], v[116:119], v[44:47], v[216:219]
    v_mfma_f32_16x16x32_bf16 v[220:223], v[188:191], v[44:47], v[220:223]
    v_mfma_f32_16x16x32_bf16 v[224:227], a[52:55], v[40:43], v[224:227]
    v_mfma_f32_16x16x32_bf16 v[228:231], a[124:127], v[40:43], v[228:231]
    v_mfma_f32_16x16x32_bf16 v[232:235], a[52:55], v[44:47], v[232:235]
    v_mfma_f32_16x16x32_bf16 v[236:239], a[124:127], v[44:47], v[236:239]
    ds_read_b128 v[40:43], v3 offset:17408
    ds_read_b128 v[44:47], v3 offset:35840
    s_waitcnt lgkmcnt(6)
    v_mfma_f32_16x16x32_bf16 v[208:211], v[120:123], v[48:51], v[208:211]
    v_mfma_f32_16x16x32_bf16 v[212:215], v[192:195], v[48:51], v[212:215]
    v_mfma_f32_16x16x32_bf16 v[216:219], v[120:123], v[52:55], v[216:219]
    v_mfma_f32_16x16x32_bf16 v[220:223], v[192:195], v[52:55], v[220:223]
    v_mfma_f32_16x16x32_bf16 v[224:227], a[56:59], v[48:51], v[224:227]
    v_mfma_f32_16x16x32_bf16 v[228:231], a[128:131], v[48:51], v[228:231]
    v_mfma_f32_16x16x32_bf16 v[232:235], a[56:59], v[52:55], v[232:235]
    v_mfma_f32_16x16x32_bf16 v[236:239], a[128:131], v[52:55], v[236:239]
    s_waitcnt lgkmcnt(4)
    v_mfma_f32_16x16x32_bf16 v[208:211], v[124:127], v[56:59], v[208:211]
    v_mfma_f32_16x16x32_bf16 v[212:215], v[196:199], v[56:59], v[212:215]
    v_mfma_f32_16x16x32_bf16 v[216:219], v[124:127], v[60:63], v[216:219]
    v_mfma_f32_16x16x32_bf16 v[220:223], v[196:199], v[60:63], v[220:223]
    v_mfma_f32_16x16x32_bf16 v[224:227], a[60:63], v[56:59], v[224:227]
    v_mfma_f32_16x16x32_bf16 v[228:231], a[132:135], v[56:59], v[228:231]
    v_mfma_f32_16x16x32_bf16 v[232:235], a[60:63], v[60:63], v[232:235]
    v_mfma_f32_16x16x32_bf16 v[236:239], a[132:135], v[60:63], v[236:239]
    s_waitcnt lgkmcnt(2)
    v_mfma_f32_16x16x32_bf16 v[208:211], v[128:131], v[32:35], v[208:211]
    v_mfma_f32_16x16x32_bf16 v[212:215], v[200:203], v[32:35], v[212:215]
    v_mfma_f32_16x16x32_bf16 v[216:219], v[128:131], v[36:39], v[216:219]
    v_mfma_f32_16x16x32_bf16 v[220:223], v[200:203], v[36:39], v[220:223]
    v_mfma_f32_16x16x32_bf16 v[224:227], a[64:67], v[32:35], v[224:227]
    v_mfma_f32_16x16x32_bf16 v[228:231], a[136:139], v[32:35], v[228:231]
    v_mfma_f32_16x16x32_bf16 v[232:235], a[64:67], v[36:39], v[232:235]
    v_mfma_f32_16x16x32_bf16 v[236:239], a[136:139], v[36:39], v[236:239]
    s_waitcnt lgkmcnt(0)
    v_mfma_f32_16x16x32_bf16 v[208:211], v[132:135], v[40:43], v[208:211]
    v_mfma_f32_16x16x32_bf16 v[212:215], v[204:207], v[40:43], v[212:215]
    v_mfma_f32_16x16x32_bf16 v[216:219], v[132:135], v[44:47], v[216:219]
    v_mfma_f32_16x16x32_bf16 v[220:223], v[204:207], v[44:47], v[220:223]
    v_mfma_f32_16x16x32_bf16 v[224:227], a[68:71], v[40:43], v[224:227]
    v_mfma_f32_16x16x32_bf16 v[228:231], a[140:143], v[40:43], v[228:231]
    v_mfma_f32_16x16x32_bf16 v[232:235], a[68:71], v[44:47], v[232:235]
    v_mfma_f32_16x16x32_bf16 v[236:239], a[140:143], v[44:47], v[236:239]
    s_waitcnt vmcnt(0)
    v_cvt_pk_bf16_f32 v8, v208, v209
    v_cvt_pk_bf16_f32 v9, v210, v211
    v_cvt_pk_bf16_f32 v10, v212, v213
    v_cvt_pk_bf16_f32 v11, v214, v215
    s_mov_b32 s28, s26
    buffer_store_dwordx4 v[8:11], v7, s[4:7], s28 offen sc1
    v_cvt_pk_bf16_f32 v12, v216, v217
    v_cvt_pk_bf16_f32 v13, v218, v219
    v_cvt_pk_bf16_f32 v14, v220, v221
    v_cvt_pk_bf16_f32 v15, v222, v223
    s_add_u32 s28, s28, s40
    buffer_store_dwordx4 v[12:15], v7, s[4:7], s28 offen sc1
    v_cvt_pk_bf16_f32 v16, v224, v225
    v_cvt_pk_bf16_f32 v17, v226, v227
    v_cvt_pk_bf16_f32 v18, v228, v229
    v_cvt_pk_bf16_f32 v19, v230, v231
    s_add_u32 s28, s26, s43
    buffer_store_dwordx4 v[16:19], v7, s[4:7], s28 offen sc1
    v_cvt_pk_bf16_f32 v20, v232, v233
    v_cvt_pk_bf16_f32 v21, v234, v235
    v_cvt_pk_bf16_f32 v22, v236, v237
    v_cvt_pk_bf16_f32 v23, v238, v239
    s_add_u32 s28, s28, s40
    buffer_store_dwordx4 v[20:23], v7, s[4:7], s28 offen sc1
    s_add_u32 s26, s26, s41
    s_add_u32 s27, s27, 36864
    s_cmp_eq_u32 s27, 110592
    s_cselect_b32 s27, 0, s27
    s_add_u32 s30, s30, 1
    s_add_u32 s19, s19, s20
    s_cmp_lt_u32 s19, 64
    s_cbranch_scc1 qk_loop
    s_branch qk_done
qk_vloop:
    s_barrier
    v_add_u32 v3, s27, v1
    ds_read_b128 v[32:35], v3 offset:0
    ds_read_b128 v[36:39], v3 offset:18432
    ds_read_b128 v[40:43], v3 offset:1024
    ds_read_b128 v[44:47], v3 offset:19456
    ds_read_b128 v[48:51], v3 offset:2048
    ds_read_b128 v[52:55], v3 offset:20480
    s_sub_u32 s22, s30, 1
    v_mov_b32 v4, s22
    s_mov_b64 exec, s[34:35]
    buffer_store_dword v4, off, s[4:7], s29 sc1
    s_mov_b64 exec, -1
    s_add_u32 s22, s27, 73728
    s_sub_u32 s21, s22, 110592
    s_cselect_b32 s22, s22, s21
    ds_read_b128 v[56:59], v3 offset:3072
    ds_read_b128 v[60:63], v3 offset:21504
    s_add_u32 s23, s22, s25
    s_add_u32 m0, s23, 0
    s_nop 0
    buffer_load_dwordx4 v2, s[8:11], s24 offen offset:0 lds
    s_waitcnt lgkmcnt(6)
    v_mfma_f32_16x16x32_bf16 v[208:211], v[32:35], v[64:67], 0
    v_mfma_f32_16x16x32_bf16 v[212:215], v[32:35], v[136:139], 0
    v_mfma_f32_16x16x32_bf16 v[216:219], v[36:39], v[64:67], 0
    v_mfma_f32_16x16x32_bf16 v[220:223], v[36:39], v[136:139], 0
    v_mfma_f32_16x16x32_bf16 v[224:227], v[32:35], a[0:3], 0
    v_mfma_f32_16x16x32_bf16 v[228:231], v[32:35], a[72:75], 0
    v_mfma_f32_16x16x32_bf16 v[232:235], v[36:39], a[0:3], 0
    v_mfma_f32_16x16x32_bf16 v[236:239], v[36:39], a[72:75], 0
    ds_read_b128 v[32:35], v3 offset:4096
    ds_read_b128 v[36:39], v3 offset:22528
    s_add_u32 m0, s23, 960
    s_nop 0
    buffer_load_dwordx4 v2, s[8:11], s24 offen offset:64 lds
    s_waitcnt lgkmcnt(6)
    v_mfma_f32_16x16x32_bf16 v[208:211], v[40:43], v[68:71], v[208:211]
    v_mfma_f32_16x16x32_bf16 v[212:215], v[40:43], v[140:143], v[212:215]
    v_mfma_f32_16x16x32_bf16 v[216:219], v[44:47], v[68:71], v[216:219]
    v_mfma_f32_16x16x32_bf16 v[220:223], v[44:47], v[140:143], v[220:223]
    v_mfma_f32_16x16x32_bf16 v[224:227], v[40:43], a[4:7], v[224:227]
    v_mfma_f32_16x16x32_bf16 v[228:231], v[40:43], a[76:79], v[228:231]
    v_mfma_f32_16x16x32_bf16 v[232:235], v[44:47], a[4:7], v[232:235]
    v_mfma_f32_16x16x32_bf16 v[236:239], v[44:47], a[76:79], v[236:239]
    ds_read_b128 v[40:43], v3 offset:5120
    ds_read_b128 v[44:47], v3 offset:23552
    s_add_u32 m0, s23, 1920
    s_nop 0
    buffer_load_dwordx4 v2, s[8:11], s24 offen offset:128 lds
    s_waitcnt lgkmcnt(6)
    v_mfma_f32_16x16x32_bf16 v[208:211], v[48:51], v[72:75], v[208:211]
    v_mfma_f32_16x16x32_bf16 v[212:215], v[48:51], v[144:147], v[212:215]
    v_mfma_f32_16x16x32_bf16 v[216:219], v[52:55], v[72:75], v[216:219]
    v_mfma_f32_16x16x32_bf16 v[220:223], v[52:55], v[144:147], v[220:223]
    v_mfma_f32_16x16x32_bf16 v[224:227], v[48:51], a[8:11], v[224:227]
    v_mfma_f32_16x16x32_bf16 v[228:231], v[48:51], a[80:83], v[228:231]
    v_mfma_f32_16x16x32_bf16 v[232:235], v[52:55], a[8:11], v[232:235]
    v_mfma_f32_16x16x32_bf16 v[236:239], v[52:55], a[80:83], v[236:239]
    ds_read_b128 v[48:51], v3 offset:6144
    ds_read_b128 v[52:55], v3 offset:24576
    s_add_u32 m0, s23, 2880
    s_nop 0
    buffer_load_dwordx4 v2, s[8:11], s24 offen offset:192 lds
    s_waitcnt lgkmcnt(6)
    v_mfma_f32_16x16x32_bf16 v[208:211], v[56:59], v[76:79], v[208:211]
    v_mfma_f32_16x16x32_bf16 v[212:215], v[56:59], v[148:151], v[212:215]
    v_mfma_f32_16x16x32_bf16 v[216:219], v[60:63], v[76:79], v[216:219]
    v_mfma_f32_16x16x32_bf16 v[220:223], v[60:63], v[148:151], v[220:223]
    v_mfma_f32_16x16x32_bf16 v[224:227], v[56:59], a[12:15], v[224:227]
    v_mfma_f32_16x16x32_bf16 v[228:231], v[56:59], a[84:87], v[228:231]
    v_mfma_f32_16x16x32_bf16 v[232:235], v[60:63], a[12:15], v[232:235]
    v_mfma_f32_16x16x32_bf16 v[236:239], v[60:63], a[84:87], v[236:239]
    ds_read_b128 v[56:59], v3 offset:7168
    ds_read_b128 v[60:63], v3 offset:25600
    s_add_u32 m0, s23, 3840
    s_nop 0
    buffer_load_dwordx4 v2, s[8:11], s24 offen offset:256 lds
    s_waitcnt lgkmcnt(6)
    v_mfma_f32_16x16x32_bf16 v[208:211], v[32:35], v[80:83], v[208:211]
    v_mfma_f32_16x16x32_bf16 v[212:215], v[32:35], v[152:155], v[212:215]
    v_mfma_f32_16x16x32_bf16 v[216:219], v[36:39], v[80:83], v[216:219]
    v_mfma_f32_16x16x32_bf16 v[220:223], v[36:39], v[152:155], v[220:223]
    v_mfma_f32_16x16x32_bf16 v[224:227], v[32:35], a[16:19], v[224:227]
    v_mfma_f32_16x16x32_bf16 v[228:231], v[32:35], a[88:91], v[228:231]
    v_mfma_f32_16x16x32_bf16 v[232:235], v[36:39], a[16:19], v[232:235]
    v_mfma_f32_16x16x32_bf16 v[236:239], v[36:39], a[88:91], v[236:239]
    ds_read_b128 v[32:35], v3 offset:8192
    ds_read_b128 v[36:39], v3 offset:26624
    s_add_u32 m0, s23, 4800
    s_nop 0
    buffer_load_dwordx4 v2, s[8:11], s24 offen offset:320 lds
    s_waitcnt lgkmcnt(6)
    v_mfma_f32_16x16x32_bf16 v[208:211], v[40:43], v[84:87], v[208:211]
    v_mfma_f32_16x16x32_bf16 v[212:215], v[40:43], v[156:159], v[212:215]
    v_mfma_f32_16x16x32_bf16 v[216:219], v[44:47], v[84:87], v[216:219]
    v_mfma_f32_16x16x32_bf16 v[220:223], v[44:47], v[156:159], v[220:223]
    v_mfma_f32_16x16x32_bf16 v[224:227], v[40:43], a[20:23], v[224:227]
    v_mfma_f32_16x16x32_bf16 v[228:231], v[40:43], a[92:95], v[228:231]
    v_mfma_f32_16x16x32_bf16 v[232:235], v[44:47], a[20:23], v[232:235]
    v_mfma_f32_16x16x32_bf16 v[236:239], v[44:47], a[92:95], v[236:239]
    ds_read_b128 v[40:43], v3 offset:9216
    ds_read_b128 v[44:47], v3 offset:27648
    s_add_u32 m0, s23, 5760
    s_nop 0
    buffer_load_dwordx4 v2, s[8:11], s24 offen offset:384 lds
    s_waitcnt lgkmcnt(6)
    v_mfma_f32_16x16x32_bf16 v[208:211], v[48:51], v[88:91], v[208:211]
    v_mfma_f32_16x16x32_bf16 v[212:215], v[48:51], v[160:163], v[212:215]
    v_mfma_f32_16x16x32_bf16 v[216:219], v[52:55], v[88:91], v[216:219]
    v_mfma_f32_16x16x32_bf16 v[220:223], v[52:55], v[160:163], v[220:223]
    v_mfma_f32_16x16x32_bf16 v[224:227], v[48:51], a[24:27], v[224:227]
    v_mfma_f32_16x16x32_bf16 v[228:231], v[48:51], a[96:99], v[228:231]
    v_mfma_f32_16x16x32_bf16 v[232:235], v[52:55], a[24:27], v[232:235]
    v_mfma_f32_16x16x32_bf16 v[236:239], v[52:55], a[96:99], v[236:239]
    ds_read_b128 v[48:51], v3 offset:10240
    ds_read_b128 v[52:55], v3 offset:28672
    s_add_u32 m0, s23, 6720
    s_nop 0
    buffer_load_dwordx4 v2, s[8:11], s24 offen offset:448 lds
    s_waitcnt lgkmcnt(6)
    v_mfma_f32_16x16x32_bf16 v[208:211], v[56:59], v[92:95], v[208:211]
    v_mfma_f32_16x16x32_bf16 v[212:215], v[56:59], v[164:167], v[212:215]
    v_mfma_f32_16x16x32_bf16 v[216:219], v[60:63], v[92:95], v[216:219]
    v_mfma_f32_16x16x32_bf16 v[220:223], v[60:63], v[164:167], v[220:223]
    v_mfma_f32_16x16x32_bf16 v[224:227], v[56:59], a[28:31], v[224:227]
    v_mfma_f32_16x16x32_bf16 v[228:231], v[56:59], a[100:103], v[228:231]
    v_mfma_f32_16x16x32_bf16 v[232:235], v[60:63], a[28:31], v[232:235]
    v_mfma_f32_16x16x32_bf16 v[236:239], v[60:63], a[100:103], v[236:239]
    ds_read_b128 v[56:59], v3 offset:11264
    ds_read_b128 v[60:63], v3 offset:29696
    s_add_u32 m0, s23, 7680
    s_nop 0
    buffer_load_dwordx4 v2, s[8:11], s24 offen offset:512 lds
    s_add_u32 s24, s24, s42
    s_waitcnt lgkmcnt(6)
    v_mfma_f32_16x16x32_bf16 v[208:211], v[32:35], v[96:99], v[208:211]
    v_mfma_f32_16x16x32_bf16 v[212:215], v[32:35], v[168:171], v[212:215]
    v_mfma_f32_16x16x32_bf16 v[216:219], v[36:39], v[96:99], v[216:219]
    v_mfma_f32_16x16x32_bf16 v[220:223], v[36:39], v[168:171], v[220:223]
    v_mfma_f32_16x16x32_bf16 v[224:227], v[32:35], a[32:35], v[224:227]
    v_mfma_f32_16x16x32_bf16 v[228:231], v[32:35], a[104:107], v[228:231]
    v_mfma_f32_16x16x32_bf16 v[232:235], v[36:39], a[32:35], v[232:235]
    v_mfma_f32_16x16x32_bf16 v[236:239], v[36:39], a[104:107], v[236:239]
    ds_read_b128 v[32:35], v3 offset:12288
    ds_read_b128 v[36:39], v3 offset:30720
    s_waitcnt lgkmcnt(6)
    v_mfma_f32_16x16x32_bf16 v[208:211], v[40:43], v[100:103], v[208:211]
    v_mfma_f32_16x16x32_bf16 v[212:215], v[40:43], v[172:175], v[212:215]
    v_mfma_f32_16x16x32_bf16 v[216:219], v[44:47], v[100:103], v[216:219]
    v_mfma_f32_16x16x32_bf16 v[220:223], v[44:47], v[172:175], v[220:223]
    v_mfma_f32_16x16x32_bf16 v[224:227], v[40:43], a[36:39], v[224:227]
    v_mfma_f32_16x16x32_bf16 v[228:231], v[40:43], a[108:111], v[228:231]
    v_mfma_f32_16x16x32_bf16 v[232:235], v[44:47], a[36:39], v[232:235]
    v_mfma_f32_16x16x32_bf16 v[236:239], v[44:47], a[108:111], v[236:239]
    ds_read_b128 v[40:43], v3 offset:13312
    ds_read_b128 v[44:47], v3 offset:31744
    s_waitcnt lgkmcnt(6)
    v_mfma_f32_16x16x32_bf16 v[208:211], v[48:51], v[104:107], v[208:211]
    v_mfma_f32_16x16x32_bf16 v[212:215], v[48:51], v[176:179], v[212:215]
    v_mfma_f32_16x16x32_bf16 v[216:219], v[52:55], v[104:107], v[216:219]
    v_mfma_f32_16x16x32_bf16 v[220:223], v[52:55], v[176:179], v[220:223]
    v_mfma_f32_16x16x32_bf16 v[224:227], v[48:51], a[40:43], v[224:227]
    v_mfma_f32_16x16x32_bf16 v[228:231], v[48:51], a[112:115], v[228:231]
    v_mfma_f32_16x16x32_bf16 v[232:235], v[52:55], a[40:43], v[232:235]
    v_mfma_f32_16x16x32_bf16 v[236:239], v[52:55], a[112:115], v[236:239]
    ds_read_b128 v[48:51], v3 offset:14336
    ds_read_b128 v[52:55], v3 offset:32768
    s_waitcnt lgkmcnt(6)
    v_mfma_f32_16x16x32_bf16 v[208:211], v[56:59], v[108:111], v[208:211]
    v_mfma_f32_16x16x32_bf16 v[212:215], v[56:59], v[180:183], v[212:215]
    v_mfma_f32_16x16x32_bf16 v[216:219], v[60:63], v[108:111], v[216:219]
    v_mfma_f32_16x16x32_bf16 v[220:223], v[60:63], v[180:183], v[220:223]
    v_mfma_f32_16x16x32_bf16 v[224:227], v[56:59], a[44:47], v[224:227]
    v_mfma_f32_16x16x32_bf16 v[228:231], v[56:59], a[116:119], v[228:231]
    v_mfma_f32_16x16x32_bf16 v[232:235], v[60:63], a[44:47], v[232:235]
    v_mfma_f32_16x16x32_bf16 v[236:239], v[60:63], a[116:119], v[236:239]
    ds_read_b128 v[56:59], v3 offset:15360
    ds_read_b128 v[60:63], v3 offset:33792
    s_waitcnt lgkmcnt(6)
    v_mfma_f32_16x16x32_bf16 v[208:211], v[32:35], v[112:115], v[208:211]
    v_mfma_f32_16x16x32_bf16 v[212:215], v[32:35], v[184:187], v[212:215]
    v_mfma_f32_16x16x32_bf16 v[216:219], v[36:39], v[112:115], v[216:219]
    v_mfma_f32_16x16x32_bf16 v[220:223], v[36:39], v[184:187], v[220:223]
    v_mfma_f32_16x16x32_bf16 v[224:227], v[32:35], a[48:51], v[224:227]
    v_mfma_f32_16x16x32_bf16 v[228:231], v[32:35], a[120:123], v[228:231]
    v_mfma_f32_16x16x32_bf16 v[232:235], v[36:39], a[48:51], v[232:235]
    v_mfma_f32_16x16x32_bf16 v[236:239], v[36:39], a[120:123], v[236:239]
    ds_read_b128 v[32:35], v3 offset:16384
    ds_read_b128 v[36:39], v3 offset:34816
    s_waitcnt lgkmcnt(6)
    v_mfma_f32_16x16x32_bf16 v[208:211], v[40:43], v[116:119], v[208:211]
    v_mfma_f32_16x16x32_bf16 v[212:215], v[40:43], v[188:191], v[212:215]
    v_mfma_f32_16x16x32_bf16 v[216:219], v[44:47], v[116:119], v[216:219]
    v_mfma_f32_16x16x32_bf16 v[220:223], v[44:47], v[188:191], v[220:223]
    v_mfma_f32_16x16x32_bf16 v[224:227], v[40:43], a[52:55], v[224:227]
    v_mfma_f32_16x16x32_bf16 v[228:231], v[40:43], a[124:127], v[228:231]
    v_mfma_f32_16x16x32_bf16 v[232:235], v[44:47], a[52:55], v[232:235]
    v_mfma_f32_16x16x32_bf16 v[236:239], v[44:47], a[124:127], v[236:239]
    ds_read_b128 v[40:43], v3 offset:17408
    ds_read_b128 v[44:47], v3 offset:35840
    s_waitcnt lgkmcnt(6)
    v_mfma_f32_16x16x32_bf16 v[208:211], v[48:51], v[120:123], v[208:211]
    v_mfma_f32_16x16x32_bf16 v[212:215], v[48:51], v[192:195], v[212:215]
    v_mfma_f32_16x16x32_bf16 v[216:219], v[52:55], v[120:123], v[216:219]
    v_mfma_f32_16x16x32_bf16 v[220:223], v[52:55], v[192:195], v[220:223]
    v_mfma_f32_16x16x32_bf16 v[224:227], v[48:51], a[56:59], v[224:227]
    v_mfma_f32_16x16x32_bf16 v[228:231], v[48:51], a[128:131], v[228:231]
    v_mfma_f32_16x16x32_bf16 v[232:235], v[52:55], a[56:59], v[232:235]
    v_mfma_f32_16x16x32_bf16 v[236:239], v[52:55], a[128:131], v[236:239]
    s_waitcnt lgkmcnt(4)
    v_mfma_f32_16x16x32_bf16 v[208:211], v[56:59], v[124:127], v[208:211]
    v_mfma_f32_16x16x32_bf16 v[212:215], v[56:59], v[196:199], v[212:215]
    v_mfma_f32_16x16x32_bf16 v[216:219], v[60:63], v[124:127], v[216:219]
    v_mfma_f32_16x16x32_bf16 v[220:223], v[60:63], v[196:199], v[220:223]
    v_mfma_f32_16x16x32_bf16 v[224:227], v[56:59], a[60:63], v[224:227]
    v_mfma_f32_16x16x32_bf16 v[228:231], v[56:59], a[132:135], v[228:231]
    v_mfma_f32_16x16x32_bf16 v[232:235], v[60:63], a[60:63], v[232:235]
    v_mfma_f32_16x16x32_bf16 v[236:239], v[60:63], a[132:135], v[236:239]
    s_waitcnt lgkmcnt(2)
    v_mfma_f32_16x16x32_bf16 v[208:211], v[32:35], v[128:131], v[208:211]
    v_mfma_f32_16x16x32_bf16 v[212:215], v[32:35], v[200:203], v[212:215]
    v_mfma_f32_16x16x32_bf16 v[216:219], v[36:39], v[128:131], v[216:219]
    v_mfma_f32_16x16x32_bf16 v[220:223], v[36:39], v[200:203], v[220:223]
    v_mfma_f32_16x16x32_bf16 v[224:227], v[32:35], a[64:67], v[224:227]
    v_mfma_f32_16x16x32_bf16 v[228:231], v[32:35], a[136:139], v[228:231]
    v_mfma_f32_16x16x32_bf16 v[232:235], v[36:39], a[64:67], v[232:235]
    v_mfma_f32_16x16x32_bf16 v[236:239], v[36:39], a[136:139], v[236:239]
    s_waitcnt lgkmcnt(0)
    v_mfma_f32_16x16x32_bf16 v[208:211], v[40:43], v[132:135], v[208:211]
    v_mfma_f32_16x16x32_bf16 v[212:215], v[40:43], v[204:207], v[212:215]
    v_mfma_f32_16x16x32_bf16 v[216:219], v[44:47], v[132:135], v[216:219]
    v_mfma_f32_16x16x32_bf16 v[220:223], v[44:47], v[204:207], v[220:223]
    v_mfma_f32_16x16x32_bf16 v[224:227], v[40:43], a[68:71], v[224:227]
    v_mfma_f32_16x16x32_bf16 v[228:231], v[40:43], a[140:143], v[228:231]
    v_mfma_f32_16x16x32_bf16 v[232:235], v[44:47], a[68:71], v[232:235]
    v_mfma_f32_16x16x32_bf16 v[236:239], v[44:47], a[140:143], v[236:239]
    s_waitcnt vmcnt(0)
    v_cvt_pk_bf16_f32 v8, v208, v209
    v_cvt_pk_bf16_f32 v9, v210, v211
    v_cvt_pk_bf16_f32 v10, v216, v217
    v_cvt_pk_bf16_f32 v11, v218, v219
    s_mov_b32 s28, s26
    buffer_store_dwordx4 v[8:11], v7, s[4:7], s28 offen sc1
    v_cvt_pk_bf16_f32 v12, v212, v213
    v_cvt_pk_bf16_f32 v13, v214, v215
    v_cvt_pk_bf16_f32 v14, v220, v221
    v_cvt_pk_bf16_f32 v15, v222, v223
    s_add_u32 s28, s28, s40
    buffer_store_dwordx4 v[12:15], v7, s[4:7], s28 offen sc1
    v_cvt_pk_bf16_f32 v16, v224, v225
    v_cvt_pk_bf16_f32 v17, v226, v227
    v_cvt_pk_bf16_f32 v18, v232, v233
    v_cvt_pk_bf16_f32 v19, v234, v235
    s_add_u32 s28, s26, s43
    buffer_store_dwordx4 v[16:19], v7, s[4:7], s28 offen sc1
    v_cvt_pk_bf16_f32 v20, v228, v229
    v_cvt_pk_bf16_f32 v21, v230, v231
    v_cvt_pk_bf16_f32 v22, v236, v237
    v_cvt_pk_bf16_f32 v23, v238, v239
    s_add_u32 s28, s28, s40
    buffer_store_dwordx4 v[20:23], v7, s[4:7], s28 offen sc1
    s_add_u32 s26, s26, s41
    s_add_u32 s27, s27, 36864
    s_cmp_eq_u32 s27, 110592
    s_cselect_b32 s27, 0, s27
    s_add_u32 s30, s30, 1
    s_add_u32 s19, s19, s20
    s_cmp_lt_u32 s19, 64
    s_cbranch_scc1 qk_vloop
qk_done:
    s_waitcnt vmcnt(0)
    s_barrier
    s_add_u32 s22, s95, 63
    v_mov_b32 v4, s22
    s_mov_b64 exec, s[34:35]
    buffer_store_dword v4, off, s[4:7], s29 sc1
    s_mov_b64 exec, -1
    s_cmp_ge_u32 s36, 64
    s_cbranch_scc1 L_qkv_next
    s_lshr_b32 s33, s36, 5
    v_and_b32 v4, 63, v0
    v_lshrrev_b32 v5, 4, v4
    v_add_u32 v1, 0, v5
    v_mul_u32_u24 v6, 11, v1
    v_lshrrev_b32 v6, 5, v6
    v_add_u32 v1, v1, v6
    v_lshlrev_b32 v1, 7, v1
    v_and_b32 v6, 7, v4
    v_lshl_add_u32 v1, v6, 4, v1
    v_add_u32 v2, 4, v5
    v_mul_u32_u24 v6, 11, v2
    v_lshrrev_b32 v6, 5, v6
    v_add_u32 v2, v2, v6
    v_lshlrev_b32 v2, 7, v2
    v_and_b32 v6, 7, v4
    v_lshl_add_u32 v2, v6, 4, v2
    v_add_u32 v3, 8, v5
    v_mul_u32_u24 v6, 11, v3
    v_lshrrev_b32 v6, 5, v6
    v_add_u32 v3, v3, v6
    v_lshlrev_b32 v3, 7, v3
    v_and_b32 v6, 7, v4
    v_lshl_add_u32 v3, v6, 4, v3
    v_min_u32 v6, 23, v4
    v_lshlrev_b32 v6, 9, v6
    s_mov_b32 s19, s33
    s_mul_i32 s24, s19, 12288
    s_add_u32 s24, s24, 90177536
    s_lshl_b32 s26, s19, 5
    s_add_u32 s26, s26, s17
    s_lshl_b32 s26, s26, 12
    s_mov_b32 s21, 71303168
    s_cmp_eq_u32 s16, 2
    s_cselect_b32 s21, 80740352, s21
    s_add_u32 s26, s26, s21
    s_lshl_b32 s29, s17, 7
    s_lshl_b32 s21, s16, 1
    s_add_u32 s21, s21, s33
    s_lshl_b32 s21, s21, 2
    s_add_u32 s29, s29, s21
    s_add_u32 s29, s29, 125829240
mk_loop:
    s_cmp_lg_u32 s18, 0
    s_cbranch_scc1 mk_go
    s_add_u32 s23, s24, 12288
    s_mov_b32 s21, 4194304
mk_wait:
    buffer_load_dword v4, v6, s[4:7], s23 offen offset:384 sc1
    s_sub_u32 s21, s21, 1
    s_cbranch_scc1 mk_go
    s_waitcnt vmcnt(0)
    v_cmp_ne_u32 vcc, s95, v4
    s_cbranch_vccz mk_go
    s_sleep 4
    s_branch mk_wait
mk_go:
    s_barrier
    s_add_u32 s23, s24, 0
    buffer_load_dwordx4 v[24:27], v1, s[4:7], s23 offen offset:0 sc1
    buffer_load_dwordx4 v[28:31], v2, s[4:7], s23 offen offset:0 sc1
    buffer_load_dwordx4 v[32:35], v3, s[4:7], s23 offen offset:0 sc1
    buffer_load_dwordx4 v[36:39], v1, s[4:7], s23 offen offset:2048 sc1
    buffer_load_dwordx4 v[40:43], v2, s[4:7], s23 offen offset:2048 sc1
    buffer_load_dwordx4 v[44:47], v3, s[4:7], s23 offen offset:2048 sc1
    s_add_u32 s23, s24, 4096
    buffer_load_dwordx4 v[48:51], v1, s[4:7], s23 offen offset:0 sc1
    buffer_load_dwordx4 v[52:55], v2, s[4:7], s23 offen offset:0 sc1
    buffer_load_dwordx4 v[56:59], v3, s[4:7], s23 offen offset:0 sc1
    buffer_load_dwordx4 v[60:63], v1, s[4:7], s23 offen offset:2048 sc1
    buffer_load_dwordx4 v[208:211], v2, s[4:7], s23 offen offset:2048 sc1
    buffer_load_dwordx4 v[212:215], v3, s[4:7], s23 offen offset:2048 sc1
    s_add_u32 s23, s24, 8192
    buffer_load_dwordx4 v[216:219], v1, s[4:7], s23 offen offset:0 sc1
    buffer_load_dwordx4 v[220:223], v2, s[4:7], s23 offen offset:0 sc1
    buffer_load_dwordx4 v[224:227], v3, s[4:7], s23 offen offset:0 sc1
    buffer_load_dwordx4 v[228:231], v1, s[4:7], s23 offen offset:2048 sc1
    buffer_load_dwordx4 v[232:235], v2, s[4:7], s23 offen offset:2048 sc1
    buffer_load_dwordx4 v[236:239], v3, s[4:7], s23 offen offset:2048 sc1
    s_add_u32 s24, s24, 24576
    s_add_u32 s22, s19, s95
    s_add_u32 s22, s22, 1
    s_cmp_eq_u32 s16, 2
    s_cbranch_scc1 mk_v
    s_waitcnt vmcnt(17)
    v_mfma_f32_16x16x32_bf16 v[8:11], v[64:67], v[24:27], 0
    v_mfma_f32_16x16x32_bf16 v[12:15], v[136:139], v[24:27], 0
    v_mfma_f32_16x16x32_bf16 v[16:19], a[0:3], v[24:27], 0
    v_mfma_f32_16x16x32_bf16 v[20:23], a[72:75], v[24:27], 0
    s_waitcnt vmcnt(16)
    v_mfma_f32_16x16x32_bf16 v[8:11], v[68:71], v[28:31], v[8:11]
    v_mfma_f32_16x16x32_bf16 v[12:15], v[140:143], v[28:31], v[12:15]
    v_mfma_f32_16x16x32_bf16 v[16:19], a[4:7], v[28:31], v[16:19]
    v_mfma_f32_16x16x32_bf16 v[20:23], a[76:79], v[28:31], v[20:23]
    s_waitcnt vmcnt(15)
    v_mfma_f32_16x16x32_bf16 v[8:11], v[72:75], v[32:35], v[8:11]
    v_mfma_f32_16x16x32_bf16 v[12:15], v[144:147], v[32:35], v[12:15]
    v_mfma_f32_16x16x32_bf16 v[16:19], a[8:11], v[32:35], v[16:19]
    v_mfma_f32_16x16x32_bf16 v[20:23], a[80:83], v[32:35], v[20:23]
    s_waitcnt vmcnt(14)
    v_mfma_f32_16x16x32_bf16 v[8:11], v[76:79], v[36:39], v[8:11]
    v_mfma_f32_16x16x32_bf16 v[12:15], v[148:151], v[36:39], v[12:15]
    v_mfma_f32_16x16x32_bf16 v[16:19], a[12:15], v[36:39], v[16:19]
    v_mfma_f32_16x16x32_bf16 v[20:23], a[84:87], v[36:39], v[20:23]
    s_waitcnt vmcnt(13)
    v_mfma_f32_16x16x32_bf16 v[8:11], v[80:83], v[40:43], v[8:11]
    v_mfma_f32_16x16x32_bf16 v[12:15], v[152:155], v[40:43], v[12:15]
    v_mfma_f32_16x16x32_bf16 v[16:19], a[16:19], v[40:43], v[16:19]
    v_mfma_f32_16x16x32_bf16 v[20:23], a[88:91], v[40:43], v[20:23]
    s_waitcnt vmcnt(12)
    v_mfma_f32_16x16x32_bf16 v[8:11], v[84:87], v[44:47], v[8:11]
    v_mfma_f32_16x16x32_bf16 v[12:15], v[156:159], v[44:47], v[12:15]
    v_mfma_f32_16x16x32_bf16 v[16:19], a[20:23], v[44:47], v[16:19]
    v_mfma_f32_16x16x32_bf16 v[20:23], a[92:95], v[44:47], v[20:23]
    s_waitcnt vmcnt(11)
    v_mfma_f32_16x16x32_bf16 v[8:11], v[88:91], v[48:51], v[8:11]
    v_mfma_f32_16x16x32_bf16 v[12:15], v[160:163], v[48:51], v[12:15]
    v_mfma_f32_16x16x32_bf16 v[16:19], a[24:27], v[48:51], v[16:19]
    v_mfma_f32_16x16x32_bf16 v[20:23], a[96:99], v[48:51], v[20:23]
    s_waitcnt vmcnt(10)
    v_mfma_f32_16x16x32_bf16 v[8:11], v[92:95], v[52:55], v[8:11]
    v_mfma_f32_16x16x32_bf16 v[12:15], v[164:167], v[52:55], v[12:15]
    v_mfma_f32_16x16x32_bf16 v[16:19], a[28:31], v[52:55], v[16:19]
    v_mfma_f32_16x16x32_bf16 v[20:23], a[100:103], v[52:55], v[20:23]
    s_waitcnt vmcnt(9)
    v_mfma_f32_16x16x32_bf16 v[8:11], v[96:99], v[56:59], v[8:11]
    v_mfma_f32_16x16x32_bf16 v[12:15], v[168:171], v[56:59], v[12:15]
    v_mfma_f32_16x16x32_bf16 v[16:19], a[32:35], v[56:59], v[16:19]
    v_mfma_f32_16x16x32_bf16 v[20:23], a[104:107], v[56:59], v[20:23]
    s_waitcnt vmcnt(8)
    v_mfma_f32_16x16x32_bf16 v[8:11], v[100:103], v[60:63], v[8:11]
    v_mfma_f32_16x16x32_bf16 v[12:15], v[172:175], v[60:63], v[12:15]
    v_mfma_f32_16x16x32_bf16 v[16:19], a[36:39], v[60:63], v[16:19]
    v_mfma_f32_16x16x32_bf16 v[20:23], a[108:111], v[60:63], v[20:23]
    s_waitcnt vmcnt(7)
    v_mfma_f32_16x16x32_bf16 v[8:11], v[104:107], v[208:211], v[8:11]
    v_mfma_f32_16x16x32_bf16 v[12:15], v[176:179], v[208:211], v[12:15]
    v_mfma_f32_16x16x32_bf16 v[16:19], a[40:43], v[208:211], v[16:19]
    v_mfma_f32_16x16x32_bf16 v[20:23], a[112:115], v[208:211], v[20:23]
    s_waitcnt vmcnt(6)
    v_mfma_f32_16x16x32_bf16 v[8:11], v[108:111], v[212:215], v[8:11]
    v_mfma_f32_16x16x32_bf16 v[12:15], v[180:183], v[212:215], v[12:15]
    v_mfma_f32_16x16x32_bf16 v[16:19], a[44:47], v[212:215], v[16:19]
    v_mfma_f32_16x16x32_bf16 v[20:23], a[116:119], v[212:215], v[20:23]
    s_waitcnt vmcnt(5)
    v_mfma_f32_16x16x32_bf16 v[8:11], v[112:115], v[216:219], v[8:11]
    v_mfma_f32_16x16x32_bf16 v[12:15], v[184:187], v[216:219], v[12:15]
    v_mfma_f32_16x16x32_bf16 v[16:19], a[48:51], v[216:219], v[16:19]
    v_mfma_f32_16x16x32_bf16 v[20:23], a[120:123], v[216:219], v[20:23]
    s_waitcnt vmcnt(4)
    v_mfma_f32_16x16x32_bf16 v[8:11], v[116:119], v[220:223], v[8:11]
    v_mfma_f32_16x16x32_bf16 v[12:15], v[188:191], v[220:223], v[12:15]
    v_mfma_f32_16x16x32_bf16 v[16:19], a[52:55], v[220:223], v[16:19]
    v_mfma_f32_16x16x32_bf16 v[20:23], a[124:127], v[220:223], v[20:23]
    s_waitcnt vmcnt(3)
    v_mfma_f32_16x16x32_bf16 v[8:11], v[120:123], v[224:227], v[8:11]
    v_mfma_f32_16x16x32_bf16 v[12:15], v[192:195], v[224:227], v[12:15]
    v_mfma_f32_16x16x32_bf16 v[16:19], a[56:59], v[224:227], v[16:19]
    v_mfma_f32_16x16x32_bf16 v[20:23], a[128:131], v[224:227], v[20:23]
    s_waitcnt vmcnt(2)
    v_mfma_f32_16x16x32_bf16 v[8:11], v[124:127], v[228:231], v[8:11]
    v_mfma_f32_16x16x32_bf16 v[12:15], v[196:199], v[228:231], v[12:15]
    v_mfma_f32_16x16x32_bf16 v[16:19], a[60:63], v[228:231], v[16:19]
    v_mfma_f32_16x16x32_bf16 v[20:23], a[132:135], v[228:231], v[20:23]
    s_waitcnt vmcnt(1)
    v_mfma_f32_16x16x32_bf16 v[8:11], v[128:131], v[232:235], v[8:11]
    v_mfma_f32_16x16x32_bf16 v[12:15], v[200:203], v[232:235], v[12:15]
    v_mfma_f32_16x16x32_bf16 v[16:19], a[64:67], v[232:235], v[16:19]
    v_mfma_f32_16x16x32_bf16 v[20:23], a[136:139], v[232:235], v[20:23]
    s_waitcnt vmcnt(0)
    v_mfma_f32_16x16x32_bf16 v[8:11], v[132:135], v[236:239], v[8:11]
    v_mfma_f32_16x16x32_bf16 v[12:15], v[204:207], v[236:239], v[12:15]
    v_mfma_f32_16x16x32_bf16 v[16:19], a[68:71], v[236:239], v[16:19]
    v_mfma_f32_16x16x32_bf16 v[20:23], a[140:143], v[236:239], v[20:23]
    s_nop 7
    s_branch mk_st
mk_v:
    s_waitcnt vmcnt(17)
    v_mfma_f32_16x16x32_bf16 v[8:11], v[24:27], v[64:67], 0
    v_mfma_f32_16x16x32_bf16 v[12:15], v[24:27], v[136:139], 0
    v_mfma_f32_16x16x32_bf16 v[16:19], v[24:27], a[0:3], 0
    v_mfma_f32_16x16x32_bf16 v[20:23], v[24:27], a[72:75], 0
    s_waitcnt vmcnt(16)
    v_mfma_f32_16x16x32_bf16 v[8:11], v[28:31], v[68:71], v[8:11]
    v_mfma_f32_16x16x32_bf16 v[12:15], v[28:31], v[140:143], v[12:15]
    v_mfma_f32_16x16x32_bf16 v[16:19], v[28:31], a[4:7], v[16:19]
    v_mfma_f32_16x16x32_bf16 v[20:23], v[28:31], a[76:79], v[20:23]
    s_waitcnt vmcnt(15)
    v_mfma_f32_16x16x32_bf16 v[8:11], v[32:35], v[72:75], v[8:11]
    v_mfma_f32_16x16x32_bf16 v[12:15], v[32:35], v[144:147], v[12:15]
    v_mfma_f32_16x16x32_bf16 v[16:19], v[32:35], a[8:11], v[16:19]
    v_mfma_f32_16x16x32_bf16 v[20:23], v[32:35], a[80:83], v[20:23]
    s_waitcnt vmcnt(14)
    v_mfma_f32_16x16x32_bf16 v[8:11], v[36:39], v[76:79], v[8:11]
    v_mfma_f32_16x16x32_bf16 v[12:15], v[36:39], v[148:151], v[12:15]
    v_mfma_f32_16x16x32_bf16 v[16:19], v[36:39], a[12:15], v[16:19]
    v_mfma_f32_16x16x32_bf16 v[20:23], v[36:39], a[84:87], v[20:23]
    s_waitcnt vmcnt(13)
    v_mfma_f32_16x16x32_bf16 v[8:11], v[40:43], v[80:83], v[8:11]
    v_mfma_f32_16x16x32_bf16 v[12:15], v[40:43], v[152:155], v[12:15]
    v_mfma_f32_16x16x32_bf16 v[16:19], v[40:43], a[16:19], v[16:19]
    v_mfma_f32_16x16x32_bf16 v[20:23], v[40:43], a[88:91], v[20:23]
    s_waitcnt vmcnt(12)
    v_mfma_f32_16x16x32_bf16 v[8:11], v[44:47], v[84:87], v[8:11]
    v_mfma_f32_16x16x32_bf16 v[12:15], v[44:47], v[156:159], v[12:15]
    v_mfma_f32_16x16x32_bf16 v[16:19], v[44:47], a[20:23], v[16:19]
    v_mfma_f32_16x16x32_bf16 v[20:23], v[44:47], a[92:95], v[20:23]
    s_waitcnt vmcnt(11)
    v_mfma_f32_16x16x32_bf16 v[8:11], v[48:51], v[88:91], v[8:11]
    v_mfma_f32_16x16x32_bf16 v[12:15], v[48:51], v[160:163], v[12:15]
    v_mfma_f32_16x16x32_bf16 v[16:19], v[48:51], a[24:27], v[16:19]
    v_mfma_f32_16x16x32_bf16 v[20:23], v[48:51], a[96:99], v[20:23]
    s_waitcnt vmcnt(10)
    v_mfma_f32_16x16x32_bf16 v[8:11], v[52:55], v[92:95], v[8:11]
    v_mfma_f32_16x16x32_bf16 v[12:15], v[52:55], v[164:167], v[12:15]
    v_mfma_f32_16x16x32_bf16 v[16:19], v[52:55], a[28:31], v[16:19]
    v_mfma_f32_16x16x32_bf16 v[20:23], v[52:55], a[100:103], v[20:23]
    s_waitcnt vmcnt(9)
    v_mfma_f32_16x16x32_bf16 v[8:11], v[56:59], v[96:99], v[8:11]
    v_mfma_f32_16x16x32_bf16 v[12:15], v[56:59], v[168:171], v[12:15]
    v_mfma_f32_16x16x32_bf16 v[16:19], v[56:59], a[32:35], v[16:19]
    v_mfma_f32_16x16x32_bf16 v[20:23], v[56:59], a[104:107], v[20:23]
    s_waitcnt vmcnt(8)
    v_mfma_f32_16x16x32_bf16 v[8:11], v[60:63], v[100:103], v[8:11]
    v_mfma_f32_16x16x32_bf16 v[12:15], v[60:63], v[172:175], v[12:15]
    v_mfma_f32_16x16x32_bf16 v[16:19], v[60:63], a[36:39], v[16:19]
    v_mfma_f32_16x16x32_bf16 v[20:23], v[60:63], a[108:111], v[20:23]
    s_waitcnt vmcnt(7)
    v_mfma_f32_16x16x32_bf16 v[8:11], v[208:211], v[104:107], v[8:11]
    v_mfma_f32_16x16x32_bf16 v[12:15], v[208:211], v[176:179], v[12:15]
    v_mfma_f32_16x16x32_bf16 v[16:19], v[208:211], a[40:43], v[16:19]
    v_mfma_f32_16x16x32_bf16 v[20:23], v[208:211], a[112:115], v[20:23]
    s_waitcnt vmcnt(6)
    v_mfma_f32_16x16x32_bf16 v[8:11], v[212:215], v[108:111], v[8:11]
    v_mfma_f32_16x16x32_bf16 v[12:15], v[212:215], v[180:183], v[12:15]
    v_mfma_f32_16x16x32_bf16 v[16:19], v[212:215], a[44:47], v[16:19]
    v_mfma_f32_16x16x32_bf16 v[20:23], v[212:215], a[116:119], v[20:23]
    s_waitcnt vmcnt(5)
    v_mfma_f32_16x16x32_bf16 v[8:11], v[216:219], v[112:115], v[8:11]
    v_mfma_f32_16x16x32_bf16 v[12:15], v[216:219], v[184:187], v[12:15]
    v_mfma_f32_16x16x32_bf16 v[16:19], v[216:219], a[48:51], v[16:19]
    v_mfma_f32_16x16x32_bf16 v[20:23], v[216:219], a[120:123], v[20:23]
    s_waitcnt vmcnt(4)
    v_mfma_f32_16x16x32_bf16 v[8:11], v[220:223], v[116:119], v[8:11]
    v_mfma_f32_16x16x32_bf16 v[12:15], v[220:223], v[188:191], v[12:15]
    v_mfma_f32_16x16x32_bf16 v[16:19], v[220:223], a[52:55], v[16:19]
    v_mfma_f32_16x16x32_bf16 v[20:23], v[220:223], a[124:127], v[20:23]
    s_waitcnt vmcnt(3)
    v_mfma_f32_16x16x32_bf16 v[8:11], v[224:227], v[120:123], v[8:11]
    v_mfma_f32_16x16x32_bf16 v[12:15], v[224:227], v[192:195], v[12:15]
    v_mfma_f32_16x16x32_bf16 v[16:19], v[224:227], a[56:59], v[16:19]
    v_mfma_f32_16x16x32_bf16 v[20:23], v[224:227], a[128:131], v[20:23]
    s_waitcnt vmcnt(2)
    v_mfma_f32_16x16x32_bf16 v[8:11], v[228:231], v[124:127], v[8:11]
    v_mfma_f32_16x16x32_bf16 v[12:15], v[228:231], v[196:199], v[12:15]
    v_mfma_f32_16x16x32_bf16 v[16:19], v[228:231], a[60:63], v[16:19]
    v_mfma_f32_16x16x32_bf16 v[20:23], v[228:231], a[132:135], v[20:23]
    s_waitcnt vmcnt(1)
    v_mfma_f32_16x16x32_bf16 v[8:11], v[232:235], v[128:131], v[8:11]
    v_mfma_f32_16x16x32_bf16 v[12:15], v[232:235], v[200:203], v[12:15]
    v_mfma_f32_16x16x32_bf16 v[16:19], v[232:235], a[64:67], v[16:19]
    v_mfma_f32_16x16x32_bf16 v[20:23], v[232:235], a[136:139], v[20:23]
    s_waitcnt vmcnt(0)
    v_mfma_f32_16x16x32_bf16 v[8:11], v[236:239], v[132:135], v[8:11]
    v_mfma_f32_16x16x32_bf16 v[12:15], v[236:239], v[204:207], v[12:15]
    v_mfma_f32_16x16x32_bf16 v[16:19], v[236:239], a[68:71], v[16:19]
    v_mfma_f32_16x16x32_bf16 v[20:23], v[236:239], a[140:143], v[20:23]
    v_pk_mul_f32 v[8:9], v[8:9], 0.5 op_sel_hi:[1,0]
    v_pk_mul_f32 v[10:11], v[10:11], 0.5 op_sel_hi:[1,0]
    v_pk_mul_f32 v[12:13], v[12:13], 0.5 op_sel_hi:[1,0]
    v_pk_mul_f32 v[14:15], v[14:15], 0.5 op_sel_hi:[1,0]
    v_pk_mul_f32 v[16:17], v[16:17], 0.5 op_sel_hi:[1,0]
    v_pk_mul_f32 v[18:19], v[18:19], 0.5 op_sel_hi:[1,0]
    s_nop 1
    v_pk_mul_f32 v[20:21], v[20:21], 0.5 op_sel_hi:[1,0]
    v_pk_mul_f32 v[22:23], v[22:23], 0.5 op_sel_hi:[1,0]
    s_nop 1
mk_st:
    v_cvt_pk_bf16_f32 v24, v8, v9
    v_cvt_pk_bf16_f32 v25, v10, v11
    v_cvt_pk_bf16_f32 v26, v12, v13
    v_cvt_pk_bf16_f32 v27, v14, v15
    v_cvt_pk_bf16_f32 v28, v16, v17
    v_cvt_pk_bf16_f32 v29, v18, v19
    v_cvt_pk_bf16_f32 v30, v20, v21
    v_cvt_pk_bf16_f32 v31, v22, v23
    s_add_u32 s21, s26, 4096
    buffer_store_dwordx4 v[24:27], v7, s[4:7], s26 offen sc1
    buffer_store_dwordx4 v[28:31], v7, s[4:7], s21 offen sc1
    s_waitcnt vmcnt(0)
    s_barrier
    v_mov_b32 v4, s22
    s_mov_b64 exec, s[34:35]
    buffer_store_dword v4, off, s[4:7], s29 sc1
    s_mov_b64 exec, -1
    s_add_u32 s19, s19, 2
    s_add_u32 s26, s26, 262144
    s_cmp_lt_u32 s19, 62
    s_cbranch_scc1 mk_loop
    s_endpgm
L_ssm_next:
    s_mov_b32 s37, 8
    v_mov_b32 v250, 1
    v_mov_b32 v251, 163832
    v_cmp_eq_u32 vcc, 0, v0
    s_nop 0
    s_and_saveexec_b64 s[38:39], vcc
    s_cbranch_execz tk7
    buffer_atomic_add v250, off, s[96:99], s37 sc0
    s_waitcnt vmcnt(0)
    ds_write_b32 v251, v250
    s_waitcnt lgkmcnt(0)
tk7:
    s_mov_b64 exec, -1
    s_barrier
    ds_read_b32 v252, v251
    s_waitcnt lgkmcnt(0)
    v_readfirstlane_b32 s20, v252
    s_barrier
    s_nop 3
    s_cmp_ge_u32 s20, 144
    s_cbranch_scc1 L_phase2
    s_lshl_b32 s20, s20, 2
    v_lshrrev_b32 v5, 6, v0
    s_nop 0
    v_readfirstlane_b32 s21, v5
    v_and_b32 v1, 63, v0
    v_and_b32 v2, 15, v1
    v_lshrrev_b32 v3, 4, v1
    v_lshlrev_b32 v4, 14, v5
    s_mov_b32 s8, s62
    s_mov_b32 s9, s63
    s_mov_b32 s10, 2359296
    s_mov_b32 s11, 0x20000
    s_mov_b32 s16, s76
    s_mov_b32 s17, s77
    s_mov_b32 s18, 4718592
    s_mov_b32 s19, 0x20000
    v_mul_u32_u24 v5, 9216, v0
    s_lshl_b32 s22, s20, 1
    s_add_u32 s23, s22, 0
    buffer_load_dwordx2 v[8:9], v5, s[8:11], s23 offen
    s_add_u32 s23, s22, 1152
    buffer_load_dwordx2 v[10:11], v5, s[8:11], s23 offen
    s_add_u32 s23, s22, 2304
    buffer_load_dwordx2 v[12:13], v5, s[8:11], s23 offen
    s_add_u32 s23, s22, 3456
    buffer_load_dwordx2 v[14:15], v5, s[8:11], s23 offen
    s_add_u32 s23, s22, 4608
    buffer_load_dwordx2 v[16:17], v5, s[8:11], s23 offen
    s_add_u32 s23, s22, 5760
    buffer_load_dwordx2 v[18:19], v5, s[8:11], s23 offen
    s_add_u32 s23, s22, 6912
    buffer_load_dwordx2 v[20:21], v5, s[8:11], s23 offen
    s_add_u32 s23, s22, 8064
    buffer_load_dwordx2 v[22:23], v5, s[8:11], s23 offen
    s_add_u32 s22, s20, s21
    s_lshl_b32 s23, s22, 8
    v_lshlrev_b32 v6, 3, v2
    v_lshl_add_u32 v6, v3, 1, v6
    s_mov_b32 s12, s64
    s_mov_b32 s13, s65
    s_mov_b32 s14, 147456
    s_mov_b32 s15, 0x20000
    buffer_load_ushort v24, v6, s[12:15], s23 offen offset:0
    buffer_load_ushort v28, v6, s[12:15], s23 offen offset:128
    s_mov_b32 s12, s66
    s_mov_b32 s13, s67
    s_mov_b32 s14, 147456
    s_mov_b32 s15, 0x20000
    buffer_load_ushort v25, v6, s[12:15], s23 offen offset:0
    buffer_load_ushort v29, v6, s[12:15], s23 offen offset:128
    s_mov_b32 s12, s68
    s_mov_b32 s13, s69
    s_mov_b32 s14, 147456
    s_mov_b32 s15, 0x20000
    buffer_load_ushort v26, v6, s[12:15], s23 offen offset:0
    buffer_load_ushort v30, v6, s[12:15], s23 offen offset:128
    s_mov_b32 s12, s70
    s_mov_b32 s13, s71
    s_mov_b32 s14, 147456
    s_mov_b32 s15, 0x20000
    buffer_load_ushort v27, v6, s[12:15], s23 offen offset:0
    buffer_load_ushort v31, v6, s[12:15], s23 offen offset:128
    s_mov_b32 s12, s72
    s_mov_b32 s13, s73
    s_mov_b32 s14, 1152
    s_mov_b32 s15, 0x20000
    s_lshl_b32 s23, s22, 1
    buffer_load_ushort v32, off, s[12:15], s23
    s_mov_b32 s26, 0x3fb8aa3b
    s_mov_b32 s27, 0x3e22f983
    v_mov_b32 v34, 0
    v_mov_b32 v35, 0
    v_lshl_add_u32 v6, v1, 3, v4
    ds_write_b64 v6, v[34:35] offset:0
    s_waitcnt vmcnt(0)
    v_mov_b32 v36, 0x05040100
    v_mov_b32 v37, 0x07060302
    v_lshlrev_b32 v6, 4, v0
    v_perm_b32 v40, v10, v8, v36
    v_perm_b32 v41, v14, v12, v36
    v_perm_b32 v42, v18, v16, v36
    v_perm_b32 v43, v22, v20, v36
    ds_write_b128 v6, v[40:43] offset:512
    s_nop 1
    v_perm_b32 v40, v10, v8, v37
    v_perm_b32 v41, v14, v12, v37
    v_perm_b32 v42, v18, v16, v37
    v_perm_b32 v43, v22, v20, v37
    ds_write_b128 v6, v[40:43] offset:16896
    s_nop 1
    v_perm_b32 v40, v11, v9, v36
    v_perm_b32 v41, v15, v13, v36
    v_perm_b32 v42, v19, v17, v36
    v_perm_b32 v43, v23, v21, v36
    ds_write_b128 v6, v[40:43] offset:33280
    s_nop 1
    v_perm_b32 v40, v11, v9, v37
    v_perm_b32 v41, v15, v13, v37
    v_perm_b32 v42, v19, v17, v37
    v_perm_b32 v43, v23, v21, v37
    ds_write_b128 v6, v[40:43] offset:49664
    s_nop 1
    v_lshlrev_b32 v32, 16, v32
    v_mul_f32 v32, s26, v32
    v_exp_f32 v32, v32
    s_nop 0
    v_cvt_pk_bf16_f32 v32, v32, v32
    v_and_b32 v32, 0xffff0000, v32
    v_add_f32 v33, v32, v32
    v_lshlrev_b32 v24, 16, v24
    v_mul_f32 v24, s26, v24
    v_exp_f32 v24, v24
    s_nop 0
    v_cvt_pk_bf16_f32 v24, v24, v24
    v_and_b32 v24, 0xffff0000, v24
    v_mul_f32 v24, v24, v32
    v_mul_f32 v24, s26, v24
    v_sub_f32 v24, 0, v24
    v_lshlrev_b32 v25, 16, v25
    v_mul_f32 v25, v25, v32
    v_mul_f32 v25, s27, v25
    v_lshlrev_b32 v26, 16, v26
    v_mul_f32 v26, v26, v33
    v_lshlrev_b32 v27, 16, v27
    v_mul_f32 v27, v27, v33
    v_lshlrev_b32 v28, 16, v28
    v_mul_f32 v28, s26, v28
    v_exp_f32 v28, v28
    s_nop 0
    v_cvt_pk_bf16_f32 v28, v28, v28
    v_and_b32 v28, 0xffff0000, v28
    v_mul_f32 v28, v28, v32
    v_mul_f32 v28, s26, v28
    v_sub_f32 v28, 0, v28
    v_lshlrev_b32 v29, 16, v29
    v_mul_f32 v29, v29, v32
    v_mul_f32 v29, s27, v29
    v_lshlrev_b32 v30, 16, v30
    v_mul_f32 v30, v30, v33
    v_lshlrev_b32 v31, 16, v31
    v_mul_f32 v31, v31, v33
    v_cvt_f32_u32 v47, v2
    v_mul_f32 v44, 0x41800000, v47
    v_and_b32 v5, 7, v2
    v_add_u32 v5, 8, v5
    v_cvt_f32_u32 v5, v5
    v_mul_f32 v45, 0x42000000, v5
    v_mul_f32 v6, 0x42800000, v5
    v_cmp_lt_u32 vcc, 7, v2
    s_nop 1
    v_cndmask_b32 v45, v45, v6, vcc
    v_add_f32 v5, 0x41000000, v47
    v_mul_f32 v46, 0x43000000, v5
    v_mov_b32 v48, 0
    v_mov_b32 v49, 0
    v_mov_b32 v50, 0
    v_mov_b32 v51, 0
    v_mov_b32 v52, 0
    v_mov_b32 v53, 0
    v_mov_b32 v54, 0
    v_mov_b32 v55, 0
    v_mov_b32 v56, 0
    v_mov_b32 v57, 0
    v_mov_b32 v58, 0
    v_mov_b32 v59, 0
    v_mov_b32 v60, 0
    v_mov_b32 v61, 0
    v_mov_b32 v62, 0
    v_mov_b32 v63, 0
    v_mov_b32_dpp v64, v24 row_newbcast:0 row_mask:0xf bank_mask:0xf
    v_mov_b32_dpp v65, v25 row_newbcast:0 row_mask:0xf bank_mask:0xf
    v_mov_b32_dpp v66, v26 row_newbcast:0 row_mask:0xf bank_mask:0xf
    v_mov_b32_dpp v67, v27 row_newbcast:0 row_mask:0xf bank_mask:0xf
    v_mul_f32 v82, v64, v47
    v_mul_f32 v83, v65, v47
    v_exp_f32 v82, v82
    v_fract_f32 v83, v83
    v_cos_f32 v74, v83
    v_sin_f32 v75, v83
    v_mul_f32 v74, v74, v82
    v_mul_f32 v75, v75, v82
    v_mul_f32 v84, v75, v75
    v_add_f32 v85, v74, v74
    v_fma_f32 v76, v74, v74, -v84
    v_mul_f32 v77, v85, v75
    v_mul_f32 v84, v77, v77
    v_add_f32 v85, v76, v76
    v_fma_f32 v78, v76, v76, -v84
    v_mul_f32 v79, v85, v77
    v_mul_f32 v84, v79, v79
    v_add_f32 v85, v78, v78
    v_fma_f32 v80, v78, v78, -v84
    v_mul_f32 v81, v85, v79
    v_mul_f32 v82, v64, v44
    v_mul_f32 v83, v65, v44
    v_exp_f32 v82, v82
    v_fract_f32 v83, v83
    v_cos_f32 v68, v83
    v_sin_f32 v69, v83
    v_mul_f32 v68, v68, v82
    v_mul_f32 v69, v69, v82
    v_mul_f32 v84, v67, v69
    v_mul_f32 v85, v67, v68
    v_fma_f32 v68, v66, v68, -v84
    v_fma_f32 v69, -v66, v69, -v85
    v_mul_f32 v82, v64, v45
    v_mul_f32 v83, v65, v45
    v_exp_f32 v82, v82
    v_fract_f32 v83, v83
    v_cos_f32 v70, v83
    v_sin_f32 v71, v83
    v_mul_f32 v70, v70, v82
    v_mul_f32 v71, v71, v82
    v_mul_f32 v84, v67, v71
    v_mul_f32 v85, v67, v70
    v_fma_f32 v70, v66, v70, -v84
    v_fma_f32 v71, -v66, v71, -v85
    v_mul_f32 v82, v64, v46
    v_mul_f32 v83, v65, v46
    v_exp_f32 v82, v82
    v_fract_f32 v83, v83
    v_cos_f32 v72, v83
    v_sin_f32 v73, v83
    v_mul_f32 v72, v72, v82
    v_mul_f32 v73, v73, v82
    v_mul_f32 v84, v67, v73
    v_mul_f32 v85, v67, v72
    v_fma_f32 v72, v66, v72, -v84
    v_fma_f32 v73, -v66, v73, -v85
    v_mfma_f32_16x16x4_f32 v[48:51], v68, v74, v[48:51]
    v_mfma_f32_16x16x4_f32 v[52:55], v70, v76, v[52:55]
    v_mfma_f32_16x16x4_f32 v[56:59], v70, v78, v[56:59]
    v_mfma_f32_16x16x4_f32 v[60:63], v72, v80, v[60:63]
    v_mfma_f32_16x16x4_f32 v[48:51], v69, v75, v[48:51]
    v_mfma_f32_16x16x4_f32 v[52:55], v71, v77, v[52:55]
    v_mfma_f32_16x16x4_f32 v[56:59], v71, v79, v[56:59]
    v_mfma_f32_16x16x4_f32 v[60:63], v73, v81, v[60:63]
    v_mov_b32_dpp v64, v24 row_newbcast:1 row_mask:0xf bank_mask:0xf
    v_mov_b32_dpp v65, v25 row_newbcast:1 row_mask:0xf bank_mask:0xf
    v_mov_b32_dpp v66, v26 row_newbcast:1 row_mask:0xf bank_mask:0xf
    v_mov_b32_dpp v67, v27 row_newbcast:1 row_mask:0xf bank_mask:0xf
    v_mul_f32 v82, v64, v47
    v_mul_f32 v83, v65, v47
    v_exp_f32 v82, v82
    v_fract_f32 v83, v83
    v_cos_f32 v74, v83
    v_sin_f32 v75, v83
    v_mul_f32 v74, v74, v82
    v_mul_f32 v75, v75, v82
    v_mul_f32 v84, v75, v75
    v_add_f32 v85, v74, v74
    v_fma_f32 v76, v74, v74, -v84
    v_mul_f32 v77, v85, v75
    v_mul_f32 v84, v77, v77
    v_add_f32 v85, v76, v76
    v_fma_f32 v78, v76, v76, -v84
    v_mul_f32 v79, v85, v77
    v_mul_f32 v84, v79, v79
    v_add_f32 v85, v78, v78
    v_fma_f32 v80, v78, v78, -v84
    v_mul_f32 v81, v85, v79
    v_mul_f32 v82, v64, v44
    v_mul_f32 v83, v65, v44
    v_exp_f32 v82, v82
    v_fract_f32 v83, v83
    v_cos_f32 v68, v83
    v_sin_f32 v69, v83
    v_mul_f32 v68, v68, v82
    v_mul_f32 v69, v69, v82
    v_mul_f32 v84, v67, v69
    v_mul_f32 v85, v67, v68
    v_fma_f32 v68, v66, v68, -v84
    v_fma_f32 v69, -v66, v69, -v85
    v_mul_f32 v82, v64, v45
    v_mul_f32 v83, v65, v45
    v_exp_f32 v82, v82
    v_fract_f32 v83, v83
    v_cos_f32 v70, v83
    v_sin_f32 v71, v83
    v_mul_f32 v70, v70, v82
    v_mul_f32 v71, v71, v82
    v_mul_f32 v84, v67, v71
    v_mul_f32 v85, v67, v70
    v_fma_f32 v70, v66, v70, -v84
    v_fma_f32 v71, -v66, v71, -v85
    v_mul_f32 v82, v64, v46
    v_mul_f32 v83, v65, v46
    v_exp_f32 v82, v82
    v_fract_f32 v83, v83
    v_cos_f32 v72, v83
    v_sin_f32 v73, v83
    v_mul_f32 v72, v72, v82
    v_mul_f32 v73, v73, v82
    v_mul_f32 v84, v67, v73
    v_mul_f32 v85, v67, v72
    v_fma_f32 v72, v66, v72, -v84
    v_fma_f32 v73, -v66, v73, -v85
    v_mfma_f32_16x16x4_f32 v[48:51], v68, v74, v[48:51]
    v_mfma_f32_16x16x4_f32 v[52:55], v70, v76, v[52:55]
    v_mfma_f32_16x16x4_f32 v[56:59], v70, v78, v[56:59]
    v_mfma_f32_16x16x4_f32 v[60:63], v72, v80, v[60:63]
    v_mfma_f32_16x16x4_f32 v[48:51], v69, v75, v[48:51]
    v_mfma_f32_16x16x4_f32 v[52:55], v71, v77, v[52:55]
    v_mfma_f32_16x16x4_f32 v[56:59], v71, v79, v[56:59]
    v_mfma_f32_16x16x4_f32 v[60:63], v73, v81, v[60:63]
    v_mov_b32_dpp v64, v24 row_newbcast:2 row_mask:0xf bank_mask:0xf
    v_mov_b32_dpp v65, v25 row_newbcast:2 row_mask:0xf bank_mask:0xf
    v_mov_b32_dpp v66, v26 row_newbcast:2 row_mask:0xf bank_mask:0xf
    v_mov_b32_dpp v67, v27 row_newbcast:2 row_mask:0xf bank_mask:0xf
    v_mul_f32 v82, v64, v47
    v_mul_f32 v83, v65, v47
    v_exp_f32 v82, v82
    v_fract_f32 v83, v83
    v_cos_f32 v74, v83
    v_sin_f32 v75, v83
    v_mul_f32 v74, v74, v82
    v_mul_f32 v75, v75, v82
    v_mul_f32 v84, v75, v75
    v_add_f32 v85, v74, v74
    v_fma_f32 v76, v74, v74, -v84
    v_mul_f32 v77, v85, v75
    v_mul_f32 v84, v77, v77
    v_add_f32 v85, v76, v76
    v_fma_f32 v78, v76, v76, -v84
    v_mul_f32 v79, v85, v77
    v_mul_f32 v84, v79, v79
    v_add_f32 v85, v78, v78
    v_fma_f32 v80, v78, v78, -v84
    v_mul_f32 v81, v85, v79
    v_mul_f32 v82, v64, v44
    v_mul_f32 v83, v65, v44
    v_exp_f32 v82, v82
    v_fract_f32 v83, v83
    v_cos_f32 v68, v83
    v_sin_f32 v69, v83
    v_mul_f32 v68, v68, v82
    v_mul_f32 v69, v69, v82
    v_mul_f32 v84, v67, v69
    v_mul_f32 v85, v67, v68
    v_fma_f32 v68, v66, v68, -v84
    v_fma_f32 v69, -v66, v69, -v85
    v_mul_f32 v82, v64, v45
    v_mul_f32 v83, v65, v45
    v_exp_f32 v82, v82
    v_fract_f32 v83, v83
    v_cos_f32 v70, v83
    v_sin_f32 v71, v83
    v_mul_f32 v70, v70, v82
    v_mul_f32 v71, v71, v82
    v_mul_f32 v84, v67, v71
    v_mul_f32 v85, v67, v70
    v_fma_f32 v70, v66, v70, -v84
    v_fma_f32 v71, -v66, v71, -v85
    v_mul_f32 v82, v64, v46
    v_mul_f32 v83, v65, v46
    v_exp_f32 v82, v82
    v_fract_f32 v83, v83
    v_cos_f32 v72, v83
    v_sin_f32 v73, v83
    v_mul_f32 v72, v72, v82
    v_mul_f32 v73, v73, v82
    v_mul_f32 v84, v67, v73
    v_mul_f32 v85, v67, v72
    v_fma_f32 v72, v66, v72, -v84
    v_fma_f32 v73, -v66, v73, -v85
    v_mfma_f32_16x16x4_f32 v[48:51], v68, v74, v[48:51]
    v_mfma_f32_16x16x4_f32 v[52:55], v70, v76, v[52:55]
    v_mfma_f32_16x16x4_f32 v[56:59], v70, v78, v[56:59]
    v_mfma_f32_16x16x4_f32 v[60:63], v72, v80, v[60:63]
    v_mfma_f32_16x16x4_f32 v[48:51], v69, v75, v[48:51]
    v_mfma_f32_16x16x4_f32 v[52:55], v71, v77, v[52:55]
    v_mfma_f32_16x16x4_f32 v[56:59], v71, v79, v[56:59]
    v_mfma_f32_16x16x4_f32 v[60:63], v73, v81, v[60:63]
    v_mov_b32_dpp v64, v24 row_newbcast:3 row_mask:0xf bank_mask:0xf
    v_mov_b32_dpp v65, v25 row_newbcast:3 row_mask:0xf bank_mask:0xf
    v_mov_b32_dpp v66, v26 row_newbcast:3 row_mask:0xf bank_mask:0xf
    v_mov_b32_dpp v67, v27 row_newbcast:3 row_mask:0xf bank_mask:0xf
    v_mul_f32 v82, v64, v47
    v_mul_f32 v83, v65, v47
    v_exp_f32 v82, v82
    v_fract_f32 v83, v83
    v_cos_f32 v74, v83
    v_sin_f32 v75, v83
    v_mul_f32 v74, v74, v82
    v_mul_f32 v75, v75, v82
    v_mul_f32 v84, v75, v75
    v_add_f32 v85, v74, v74
    v_fma_f32 v76, v74, v74, -v84
    v_mul_f32 v77, v85, v75
    v_mul_f32 v84, v77, v77
    v_add_f32 v85, v76, v76
    v_fma_f32 v78, v76, v76, -v84
    v_mul_f32 v79, v85, v77
    v_mul_f32 v84, v79, v79
    v_add_f32 v85, v78, v78
    v_fma_f32 v80, v78, v78, -v84
    v_mul_f32 v81, v85, v79
    v_mul_f32 v82, v64, v44
    v_mul_f32 v83, v65, v44
    v_exp_f32 v82, v82
    v_fract_f32 v83, v83
    v_cos_f32 v68, v83
    v_sin_f32 v69, v83
    v_mul_f32 v68, v68, v82
    v_mul_f32 v69, v69, v82
    v_mul_f32 v84, v67, v69
    v_mul_f32 v85, v67, v68
    v_fma_f32 v68, v66, v68, -v84
    v_fma_f32 v69, -v66, v69, -v85
    v_mul_f32 v82, v64, v45
    v_mul_f32 v83, v65, v45
    v_exp_f32 v82, v82
    v_fract_f32 v83, v83
    v_cos_f32 v70, v83
    v_sin_f32 v71, v83
    v_mul_f32 v70, v70, v82
    v_mul_f32 v71, v71, v82
    v_mul_f32 v84, v67, v71
    v_mul_f32 v85, v67, v70
    v_fma_f32 v70, v66, v70, -v84
    v_fma_f32 v71, -v66, v71, -v85
    v_mul_f32 v82, v64, v46
    v_mul_f32 v83, v65, v46
    v_exp_f32 v82, v82
    v_fract_f32 v83, v83
    v_cos_f32 v72, v83
    v_sin_f32 v73, v83
    v_mul_f32 v72, v72, v82
    v_mul_f32 v73, v73, v82
    v_mul_f32 v84, v67, v73
    v_mul_f32 v85, v67, v72
    v_fma_f32 v72, v66, v72, -v84
    v_fma_f32 v73, -v66, v73, -v85
    v_mfma_f32_16x16x4_f32 v[48:51], v68, v74, v[48:51]
    v_mfma_f32_16x16x4_f32 v[52:55], v70, v76, v[52:55]
    v_mfma_f32_16x16x4_f32 v[56:59], v70, v78, v[56:59]
    v_mfma_f32_16x16x4_f32 v[60:63], v72, v80, v[60:63]
    v_mfma_f32_16x16x4_f32 v[48:51], v69, v75, v[48:51]
    v_mfma_f32_16x16x4_f32 v[52:55], v71, v77, v[52:55]
    v_mfma_f32_16x16x4_f32 v[56:59], v71, v79, v[56:59]
    v_mfma_f32_16x16x4_f32 v[60:63], v73, v81, v[60:63]
    v_mov_b32_dpp v64, v24 row_newbcast:4 row_mask:0xf bank_mask:0xf
    v_mov_b32_dpp v65, v25 row_newbcast:4 row_mask:0xf bank_mask:0xf
    v_mov_b32_dpp v66, v26 row_newbcast:4 row_mask:0xf bank_mask:0xf
    v_mov_b32_dpp v67, v27 row_newbcast:4 row_mask:0xf bank_mask:0xf
    v_mul_f32 v82, v64, v47
    v_mul_f32 v83, v65, v47
    v_exp_f32 v82, v82
    v_fract_f32 v83, v83
    v_cos_f32 v74, v83
    v_sin_f32 v75, v83
    v_mul_f32 v74, v74, v82
    v_mul_f32 v75, v75, v82
    v_mul_f32 v84, v75, v75
    v_add_f32 v85, v74, v74
    v_fma_f32 v76, v74, v74, -v84
    v_mul_f32 v77, v85, v75
    v_mul_f32 v84, v77, v77
    v_add_f32 v85, v76, v76
    v_fma_f32 v78, v76, v76, -v84
    v_mul_f32 v79, v85, v77
    v_mul_f32 v84, v79, v79
    v_add_f32 v85, v78, v78
    v_fma_f32 v80, v78, v78, -v84
    v_mul_f32 v81, v85, v79
    v_mul_f32 v82, v64, v44
    v_mul_f32 v83, v65, v44
    v_exp_f32 v82, v82
    v_fract_f32 v83, v83
    v_cos_f32 v68, v83
    v_sin_f32 v69, v83
    v_mul_f32 v68, v68, v82
    v_mul_f32 v69, v69, v82
    v_mul_f32 v84, v67, v69
    v_mul_f32 v85, v67, v68
    v_fma_f32 v68, v66, v68, -v84
    v_fma_f32 v69, -v66, v69, -v85
    v_mul_f32 v82, v64, v45
    v_mul_f32 v83, v65, v45
    v_exp_f32 v82, v82
    v_fract_f32 v83, v83
    v_cos_f32 v70, v83
    v_sin_f32 v71, v83
    v_mul_f32 v70, v70, v82
    v_mul_f32 v71, v71, v82
    v_mul_f32 v84, v67, v71
    v_mul_f32 v85, v67, v70
    v_fma_f32 v70, v66, v70, -v84
    v_fma_f32 v71, -v66, v71, -v85
    v_mul_f32 v82, v64, v46
    v_mul_f32 v83, v65, v46
    v_exp_f32 v82, v82
    v_fract_f32 v83, v83
    v_cos_f32 v72, v83
    v_sin_f32 v73, v83
    v_mul_f32 v72, v72, v82
    v_mul_f32 v73, v73, v82
    v_mul_f32 v84, v67, v73
    v_mul_f32 v85, v67, v72
    v_fma_f32 v72, v66, v72, -v84
    v_fma_f32 v73, -v66, v73, -v85
    v_mfma_f32_16x16x4_f32 v[48:51], v68, v74, v[48:51]
    v_mfma_f32_16x16x4_f32 v[52:55], v70, v76, v[52:55]
    v_mfma_f32_16x16x4_f32 v[56:59], v70, v78, v[56:59]
    v_mfma_f32_16x16x4_f32 v[60:63], v72, v80, v[60:63]
    v_mfma_f32_16x16x4_f32 v[48:51], v69, v75, v[48:51]
    v_mfma_f32_16x16x4_f32 v[52:55], v71, v77, v[52:55]
    v_mfma_f32_16x16x4_f32 v[56:59], v71, v79, v[56:59]
    v_mfma_f32_16x16x4_f32 v[60:63], v73, v81, v[60:63]
    v_mov_b32_dpp v64, v24 row_newbcast:5 row_mask:0xf bank_mask:0xf
    v_mov_b32_dpp v65, v25 row_newbcast:5 row_mask:0xf bank_mask:0xf
    v_mov_b32_dpp v66, v26 row_newbcast:5 row_mask:0xf bank_mask:0xf
    v_mov_b32_dpp v67, v27 row_newbcast:5 row_mask:0xf bank_mask:0xf
    v_mul_f32 v82, v64, v47
    v_mul_f32 v83, v65, v47
    v_exp_f32 v82, v82
    v_fract_f32 v83, v83
    v_cos_f32 v74, v83
    v_sin_f32 v75, v83
    v_mul_f32 v74, v74, v82
    v_mul_f32 v75, v75, v82
    v_mul_f32 v84, v75, v75
    v_add_f32 v85, v74, v74
    v_fma_f32 v76, v74, v74, -v84
    v_mul_f32 v77, v85, v75
    v_mul_f32 v84, v77, v77
    v_add_f32 v85, v76, v76
    v_fma_f32 v78, v76, v76, -v84
    v_mul_f32 v79, v85, v77
    v_mul_f32 v84, v79, v79
    v_add_f32 v85, v78, v78
    v_fma_f32 v80, v78, v78, -v84
    v_mul_f32 v81, v85, v79
    v_mul_f32 v82, v64, v44
    v_mul_f32 v83, v65, v44
    v_exp_f32 v82, v82
    v_fract_f32 v83, v83
    v_cos_f32 v68, v83
    v_sin_f32 v69, v83
    v_mul_f32 v68, v68, v82
    v_mul_f32 v69, v69, v82
    v_mul_f32 v84, v67, v69
    v_mul_f32 v85, v67, v68
    v_fma_f32 v68, v66, v68, -v84
    v_fma_f32 v69, -v66, v69, -v85
    v_mul_f32 v82, v64, v45
    v_mul_f32 v83, v65, v45
    v_exp_f32 v82, v82
    v_fract_f32 v83, v83
    v_cos_f32 v70, v83
    v_sin_f32 v71, v83
    v_mul_f32 v70, v70, v82
    v_mul_f32 v71, v71, v82
    v_mul_f32 v84, v67, v71
    v_mul_f32 v85, v67, v70
    v_fma_f32 v70, v66, v70, -v84
    v_fma_f32 v71, -v66, v71, -v85
    v_mul_f32 v82, v64, v46
    v_mul_f32 v83, v65, v46
    v_exp_f32 v82, v82
    v_fract_f32 v83, v83
    v_cos_f32 v72, v83
    v_sin_f32 v73, v83
    v_mul_f32 v72, v72, v82
    v_mul_f32 v73, v73, v82
    v_mul_f32 v84, v67, v73
    v_mul_f32 v85, v67, v72
    v_fma_f32 v72, v66, v72, -v84
    v_fma_f32 v73, -v66, v73, -v85
    v_mfma_f32_16x16x4_f32 v[48:51], v68, v74, v[48:51]
    v_mfma_f32_16x16x4_f32 v[52:55], v70, v76, v[52:55]
    v_mfma_f32_16x16x4_f32 v[56:59], v70, v78, v[56:59]
    v_mfma_f32_16x16x4_f32 v[60:63], v72, v80, v[60:63]
    v_mfma_f32_16x16x4_f32 v[48:51], v69, v75, v[48:51]
    v_mfma_f32_16x16x4_f32 v[52:55], v71, v77, v[52:55]
    v_mfma_f32_16x16x4_f32 v[56:59], v71, v79, v[56:59]
    v_mfma_f32_16x16x4_f32 v[60:63], v73, v81, v[60:63]
    v_mov_b32_dpp v64, v24 row_newbcast:6 row_mask:0xf bank_mask:0xf
    v_mov_b32_dpp v65, v25 row_newbcast:6 row_mask:0xf bank_mask:0xf
    v_mov_b32_dpp v66, v26 row_newbcast:6 row_mask:0xf bank_mask:0xf
    v_mov_b32_dpp v67, v27 row_newbcast:6 row_mask:0xf bank_mask:0xf
    v_mul_f32 v82, v64, v47
    v_mul_f32 v83, v65, v47
    v_exp_f32 v82, v82
    v_fract_f32 v83, v83
    v_cos_f32 v74, v83
    v_sin_f32 v75, v83
    v_mul_f32 v74, v74, v82
    v_mul_f32 v75, v75, v82
    v_mul_f32 v84, v75, v75
    v_add_f32 v85, v74, v74
    v_fma_f32 v76, v74, v74, -v84
    v_mul_f32 v77, v85, v75
    v_mul_f32 v84, v77, v77
    v_add_f32 v85, v76, v76
    v_fma_f32 v78, v76, v76, -v84
    v_mul_f32 v79, v85, v77
    v_mul_f32 v84, v79, v79
    v_add_f32 v85, v78, v78
    v_fma_f32 v80, v78, v78, -v84
    v_mul_f32 v81, v85, v79
    v_mul_f32 v82, v64, v44
    v_mul_f32 v83, v65, v44
    v_exp_f32 v82, v82
    v_fract_f32 v83, v83
    v_cos_f32 v68, v83
    v_sin_f32 v69, v83
    v_mul_f32 v68, v68, v82
    v_mul_f32 v69, v69, v82
    v_mul_f32 v84, v67, v69
    v_mul_f32 v85, v67, v68
    v_fma_f32 v68, v66, v68, -v84
    v_fma_f32 v69, -v66, v69, -v85
    v_mul_f32 v82, v64, v45
    v_mul_f32 v83, v65, v45
    v_exp_f32 v82, v82
    v_fract_f32 v83, v83
    v_cos_f32 v70, v83
    v_sin_f32 v71, v83
    v_mul_f32 v70, v70, v82
    v_mul_f32 v71, v71, v82
    v_mul_f32 v84, v67, v71
    v_mul_f32 v85, v67, v70
    v_fma_f32 v70, v66, v70, -v84
    v_fma_f32 v71, -v66, v71, -v85
    v_mul_f32 v82, v64, v46
    v_mul_f32 v83, v65, v46
    v_exp_f32 v82, v82
    v_fract_f32 v83, v83
    v_cos_f32 v72, v83
    v_sin_f32 v73, v83
    v_mul_f32 v72, v72, v82
    v_mul_f32 v73, v73, v82
    v_mul_f32 v84, v67, v73
    v_mul_f32 v85, v67, v72
    v_fma_f32 v72, v66, v72, -v84
    v_fma_f32 v73, -v66, v73, -v85
    v_mfma_f32_16x16x4_f32 v[48:51], v68, v74, v[48:51]
    v_mfma_f32_16x16x4_f32 v[52:55], v70, v76, v[52:55]
    v_mfma_f32_16x16x4_f32 v[56:59], v70, v78, v[56:59]
    v_mfma_f32_16x16x4_f32 v[60:63], v72, v80, v[60:63]
    v_mfma_f32_16x16x4_f32 v[48:51], v69, v75, v[48:51]
    v_mfma_f32_16x16x4_f32 v[52:55], v71, v77, v[52:55]
    v_mfma_f32_16x16x4_f32 v[56:59], v71, v79, v[56:59]
    v_mfma_f32_16x16x4_f32 v[60:63], v73, v81, v[60:63]
    v_mov_b32_dpp v64, v24 row_newbcast:7 row_mask:0xf bank_mask:0xf
    v_mov_b32_dpp v65, v25 row_newbcast:7 row_mask:0xf bank_mask:0xf
    v_mov_b32_dpp v66, v26 row_newbcast:7 row_mask:0xf bank_mask:0xf
    v_mov_b32_dpp v67, v27 row_newbcast:7 row_mask:0xf bank_mask:0xf
    v_mul_f32 v82, v64, v47
    v_mul_f32 v83, v65, v47
    v_exp_f32 v82, v82
    v_fract_f32 v83, v83
    v_cos_f32 v74, v83
    v_sin_f32 v75, v83
    v_mul_f32 v74, v74, v82
    v_mul_f32 v75, v75, v82
    v_mul_f32 v84, v75, v75
    v_add_f32 v85, v74, v74
    v_fma_f32 v76, v74, v74, -v84
    v_mul_f32 v77, v85, v75
    v_mul_f32 v84, v77, v77
    v_add_f32 v85, v76, v76
    v_fma_f32 v78, v76, v76, -v84
    v_mul_f32 v79, v85, v77
    v_mul_f32 v84, v79, v79
    v_add_f32 v85, v78, v78
    v_fma_f32 v80, v78, v78, -v84
    v_mul_f32 v81, v85, v79
    v_mul_f32 v82, v64, v44
    v_mul_f32 v83, v65, v44
    v_exp_f32 v82, v82
    v_fract_f32 v83, v83
    v_cos_f32 v68, v83
    v_sin_f32 v69, v83
    v_mul_f32 v68, v68, v82
    v_mul_f32 v69, v69, v82
    v_mul_f32 v84, v67, v69
    v_mul_f32 v85, v67, v68
    v_fma_f32 v68, v66, v68, -v84
    v_fma_f32 v69, -v66, v69, -v85
    v_mul_f32 v82, v64, v45
    v_mul_f32 v83, v65, v45
    v_exp_f32 v82, v82
    v_fract_f32 v83, v83
    v_cos_f32 v70, v83
    v_sin_f32 v71, v83
    v_mul_f32 v70, v70, v82
    v_mul_f32 v71, v71, v82
    v_mul_f32 v84, v67, v71
    v_mul_f32 v85, v67, v70
    v_fma_f32 v70, v66, v70, -v84
    v_fma_f32 v71, -v66, v71, -v85
    v_mul_f32 v82, v64, v46
    v_mul_f32 v83, v65, v46
    v_exp_f32 v82, v82
    v_fract_f32 v83, v83
    v_cos_f32 v72, v83
    v_sin_f32 v73, v83
    v_mul_f32 v72, v72, v82
    v_mul_f32 v73, v73, v82
    v_mul_f32 v84, v67, v73
    v_mul_f32 v85, v67, v72
    v_fma_f32 v72, v66, v72, -v84
    v_fma_f32 v73, -v66, v73, -v85
    v_mfma_f32_16x16x4_f32 v[48:51], v68, v74, v[48:51]
    v_mfma_f32_16x16x4_f32 v[52:55], v70, v76, v[52:55]
    v_mfma_f32_16x16x4_f32 v[56:59], v70, v78, v[56:59]
    v_mfma_f32_16x16x4_f32 v[60:63], v72, v80, v[60:63]
    v_mfma_f32_16x16x4_f32 v[48:51], v69, v75, v[48:51]
    v_mfma_f32_16x16x4_f32 v[52:55], v71, v77, v[52:55]
    v_mfma_f32_16x16x4_f32 v[56:59], v71, v79, v[56:59]
    v_mfma_f32_16x16x4_f32 v[60:63], v73, v81, v[60:63]
    v_mov_b32_dpp v64, v24 row_newbcast:8 row_mask:0xf bank_mask:0xf
    v_mov_b32_dpp v65, v25 row_newbcast:8 row_mask:0xf bank_mask:0xf
    v_mov_b32_dpp v66, v26 row_newbcast:8 row_mask:0xf bank_mask:0xf
    v_mov_b32_dpp v67, v27 row_newbcast:8 row_mask:0xf bank_mask:0xf
    v_mul_f32 v82, v64, v47
    v_mul_f32 v83, v65, v47
    v_exp_f32 v82, v82
    v_fract_f32 v83, v83
    v_cos_f32 v74, v83
    v_sin_f32 v75, v83
    v_mul_f32 v74, v74, v82
    v_mul_f32 v75, v75, v82
    v_mul_f32 v84, v75, v75
    v_add_f32 v85, v74, v74
    v_fma_f32 v76, v74, v74, -v84
    v_mul_f32 v77, v85, v75
    v_mul_f32 v84, v77, v77
    v_add_f32 v85, v76, v76
    v_fma_f32 v78, v76, v76, -v84
    v_mul_f32 v79, v85, v77
    v_mul_f32 v84, v79, v79
    v_add_f32 v85, v78, v78
    v_fma_f32 v80, v78, v78, -v84
    v_mul_f32 v81, v85, v79
    v_mul_f32 v82, v64, v44
    v_mul_f32 v83, v65, v44
    v_exp_f32 v82, v82
    v_fract_f32 v83, v83
    v_cos_f32 v68, v83
    v_sin_f32 v69, v83
    v_mul_f32 v68, v68, v82
    v_mul_f32 v69, v69, v82
    v_mul_f32 v84, v67, v69
    v_mul_f32 v85, v67, v68
    v_fma_f32 v68, v66, v68, -v84
    v_fma_f32 v69, -v66, v69, -v85
    v_mul_f32 v82, v64, v45
    v_mul_f32 v83, v65, v45
    v_exp_f32 v82, v82
    v_fract_f32 v83, v83
    v_cos_f32 v70, v83
    v_sin_f32 v71, v83
    v_mul_f32 v70, v70, v82
    v_mul_f32 v71, v71, v82
    v_mul_f32 v84, v67, v71
    v_mul_f32 v85, v67, v70
    v_fma_f32 v70, v66, v70, -v84
    v_fma_f32 v71, -v66, v71, -v85
    v_mul_f32 v82, v64, v46
    v_mul_f32 v83, v65, v46
    v_exp_f32 v82, v82
    v_fract_f32 v83, v83
    v_cos_f32 v72, v83
    v_sin_f32 v73, v83
    v_mul_f32 v72, v72, v82
    v_mul_f32 v73, v73, v82
    v_mul_f32 v84, v67, v73
    v_mul_f32 v85, v67, v72
    v_fma_f32 v72, v66, v72, -v84
    v_fma_f32 v73, -v66, v73, -v85
    v_mfma_f32_16x16x4_f32 v[48:51], v68, v74, v[48:51]
    v_mfma_f32_16x16x4_f32 v[52:55], v70, v76, v[52:55]
    v_mfma_f32_16x16x4_f32 v[56:59], v70, v78, v[56:59]
    v_mfma_f32_16x16x4_f32 v[60:63], v72, v80, v[60:63]
    v_mfma_f32_16x16x4_f32 v[48:51], v69, v75, v[48:51]
    v_mfma_f32_16x16x4_f32 v[52:55], v71, v77, v[52:55]
    v_mfma_f32_16x16x4_f32 v[56:59], v71, v79, v[56:59]
    v_mfma_f32_16x16x4_f32 v[60:63], v73, v81, v[60:63]
    v_mov_b32_dpp v64, v24 row_newbcast:9 row_mask:0xf bank_mask:0xf
    v_mov_b32_dpp v65, v25 row_newbcast:9 row_mask:0xf bank_mask:0xf
    v_mov_b32_dpp v66, v26 row_newbcast:9 row_mask:0xf bank_mask:0xf
    v_mov_b32_dpp v67, v27 row_newbcast:9 row_mask:0xf bank_mask:0xf
    v_mul_f32 v82, v64, v47
    v_mul_f32 v83, v65, v47
    v_exp_f32 v82, v82
    v_fract_f32 v83, v83
    v_cos_f32 v74, v83
    v_sin_f32 v75, v83
    v_mul_f32 v74, v74, v82
    v_mul_f32 v75, v75, v82
    v_mul_f32 v84, v75, v75
    v_add_f32 v85, v74, v74
    v_fma_f32 v76, v74, v74, -v84
    v_mul_f32 v77, v85, v75
    v_mul_f32 v84, v77, v77
    v_add_f32 v85, v76, v76
    v_fma_f32 v78, v76, v76, -v84
    v_mul_f32 v79, v85, v77
    v_mul_f32 v84, v79, v79
    v_add_f32 v85, v78, v78
    v_fma_f32 v80, v78, v78, -v84
    v_mul_f32 v81, v85, v79
    v_mul_f32 v82, v64, v44
    v_mul_f32 v83, v65, v44
    v_exp_f32 v82, v82
    v_fract_f32 v83, v83
    v_cos_f32 v68, v83
    v_sin_f32 v69, v83
    v_mul_f32 v68, v68, v82
    v_mul_f32 v69, v69, v82
    v_mul_f32 v84, v67, v69
    v_mul_f32 v85, v67, v68
    v_fma_f32 v68, v66, v68, -v84
    v_fma_f32 v69, -v66, v69, -v85
    v_mul_f32 v82, v64, v45
    v_mul_f32 v83, v65, v45
    v_exp_f32 v82, v82
    v_fract_f32 v83, v83
    v_cos_f32 v70, v83
    v_sin_f32 v71, v83
    v_mul_f32 v70, v70, v82
    v_mul_f32 v71, v71, v82
    v_mul_f32 v84, v67, v71
    v_mul_f32 v85, v67, v70
    v_fma_f32 v70, v66, v70, -v84
    v_fma_f32 v71, -v66, v71, -v85
    v_mul_f32 v82, v64, v46
    v_mul_f32 v83, v65, v46
    v_exp_f32 v82, v82
    v_fract_f32 v83, v83
    v_cos_f32 v72, v83
    v_sin_f32 v73, v83
    v_mul_f32 v72, v72, v82
    v_mul_f32 v73, v73, v82
    v_mul_f32 v84, v67, v73
    v_mul_f32 v85, v67, v72
    v_fma_f32 v72, v66, v72, -v84
    v_fma_f32 v73, -v66, v73, -v85
    v_mfma_f32_16x16x4_f32 v[48:51], v68, v74, v[48:51]
    v_mfma_f32_16x16x4_f32 v[52:55], v70, v76, v[52:55]
    v_mfma_f32_16x16x4_f32 v[56:59], v70, v78, v[56:59]
    v_mfma_f32_16x16x4_f32 v[60:63], v72, v80, v[60:63]
    v_mfma_f32_16x16x4_f32 v[48:51], v69, v75, v[48:51]
    v_mfma_f32_16x16x4_f32 v[52:55], v71, v77, v[52:55]
    v_mfma_f32_16x16x4_f32 v[56:59], v71, v79, v[56:59]
    v_mfma_f32_16x16x4_f32 v[60:63], v73, v81, v[60:63]
    v_mov_b32_dpp v64, v24 row_newbcast:10 row_mask:0xf bank_mask:0xf
    v_mov_b32_dpp v65, v25 row_newbcast:10 row_mask:0xf bank_mask:0xf
    v_mov_b32_dpp v66, v26 row_newbcast:10 row_mask:0xf bank_mask:0xf
    v_mov_b32_dpp v67, v27 row_newbcast:10 row_mask:0xf bank_mask:0xf
    v_mul_f32 v82, v64, v47
    v_mul_f32 v83, v65, v47
    v_exp_f32 v82, v82
    v_fract_f32 v83, v83
    v_cos_f32 v74, v83
    v_sin_f32 v75, v83
    v_mul_f32 v74, v74, v82
    v_mul_f32 v75, v75, v82
    v_mul_f32 v84, v75, v75
    v_add_f32 v85, v74, v74
    v_fma_f32 v76, v74, v74, -v84
    v_mul_f32 v77, v85, v75
    v_mul_f32 v84, v77, v77
    v_add_f32 v85, v76, v76
    v_fma_f32 v78, v76, v76, -v84
    v_mul_f32 v79, v85, v77
    v_mul_f32 v84, v79, v79
    v_add_f32 v85, v78, v78
    v_fma_f32 v80, v78, v78, -v84
    v_mul_f32 v81, v85, v79
    v_mul_f32 v82, v64, v44
    v_mul_f32 v83, v65, v44
    v_exp_f32 v82, v82
    v_fract_f32 v83, v83
    v_cos_f32 v68, v83
    v_sin_f32 v69, v83
    v_mul_f32 v68, v68, v82
    v_mul_f32 v69, v69, v82
    v_mul_f32 v84, v67, v69
    v_mul_f32 v85, v67, v68
    v_fma_f32 v68, v66, v68, -v84
    v_fma_f32 v69, -v66, v69, -v85
    v_mul_f32 v82, v64, v45
    v_mul_f32 v83, v65, v45
    v_exp_f32 v82, v82
    v_fract_f32 v83, v83
    v_cos_f32 v70, v83
    v_sin_f32 v71, v83
    v_mul_f32 v70, v70, v82
    v_mul_f32 v71, v71, v82
    v_mul_f32 v84, v67, v71
    v_mul_f32 v85, v67, v70
    v_fma_f32 v70, v66, v70, -v84
    v_fma_f32 v71, -v66, v71, -v85
    v_mul_f32 v82, v64, v46
    v_mul_f32 v83, v65, v46
    v_exp_f32 v82, v82
    v_fract_f32 v83, v83
    v_cos_f32 v72, v83
    v_sin_f32 v73, v83
    v_mul_f32 v72, v72, v82
    v_mul_f32 v73, v73, v82
    v_mul_f32 v84, v67, v73
    v_mul_f32 v85, v67, v72
    v_fma_f32 v72, v66, v72, -v84
    v_fma_f32 v73, -v66, v73, -v85
    v_mfma_f32_16x16x4_f32 v[48:51], v68, v74, v[48:51]
    v_mfma_f32_16x16x4_f32 v[52:55], v70, v76, v[52:55]
    v_mfma_f32_16x16x4_f32 v[56:59], v70, v78, v[56:59]
    v_mfma_f32_16x16x4_f32 v[60:63], v72, v80, v[60:63]
    v_mfma_f32_16x16x4_f32 v[48:51], v69, v75, v[48:51]
    v_mfma_f32_16x16x4_f32 v[52:55], v71, v77, v[52:55]
    v_mfma_f32_16x16x4_f32 v[56:59], v71, v79, v[56:59]
    v_mfma_f32_16x16x4_f32 v[60:63], v73, v81, v[60:63]
    v_mov_b32_dpp v64, v24 row_newbcast:11 row_mask:0xf bank_mask:0xf
    v_mov_b32_dpp v65, v25 row_newbcast:11 row_mask:0xf bank_mask:0xf
    v_mov_b32_dpp v66, v26 row_newbcast:11 row_mask:0xf bank_mask:0xf
    v_mov_b32_dpp v67, v27 row_newbcast:11 row_mask:0xf bank_mask:0xf
    v_mul_f32 v82, v64, v47
    v_mul_f32 v83, v65, v47
    v_exp_f32 v82, v82
    v_fract_f32 v83, v83
    v_cos_f32 v74, v83
    v_sin_f32 v75, v83
    v_mul_f32 v74, v74, v82
    v_mul_f32 v75, v75, v82
    v_mul_f32 v84, v75, v75
    v_add_f32 v85, v74, v74
    v_fma_f32 v76, v74, v74, -v84
    v_mul_f32 v77, v85, v75
    v_mul_f32 v84, v77, v77
    v_add_f32 v85, v76, v76
    v_fma_f32 v78, v76, v76, -v84
    v_mul_f32 v79, v85, v77
    v_mul_f32 v84, v79, v79
    v_add_f32 v85, v78, v78
    v_fma_f32 v80, v78, v78, -v84
    v_mul_f32 v81, v85, v79
    v_mul_f32 v82, v64, v44
    v_mul_f32 v83, v65, v44
    v_exp_f32 v82, v82
    v_fract_f32 v83, v83
    v_cos_f32 v68, v83
    v_sin_f32 v69, v83
    v_mul_f32 v68, v68, v82
    v_mul_f32 v69, v69, v82
    v_mul_f32 v84, v67, v69
    v_mul_f32 v85, v67, v68
    v_fma_f32 v68, v66, v68, -v84
    v_fma_f32 v69, -v66, v69, -v85
    v_mul_f32 v82, v64, v45
    v_mul_f32 v83, v65, v45
    v_exp_f32 v82, v82
    v_fract_f32 v83, v83
    v_cos_f32 v70, v83
    v_sin_f32 v71, v83
    v_mul_f32 v70, v70, v82
    v_mul_f32 v71, v71, v82
    v_mul_f32 v84, v67, v71
    v_mul_f32 v85, v67, v70
    v_fma_f32 v70, v66, v70, -v84
    v_fma_f32 v71, -v66, v71, -v85
    v_mul_f32 v82, v64, v46
    v_mul_f32 v83, v65, v46
    v_exp_f32 v82, v82
    v_fract_f32 v83, v83
    v_cos_f32 v72, v83
    v_sin_f32 v73, v83
    v_mul_f32 v72, v72, v82
    v_mul_f32 v73, v73, v82
    v_mul_f32 v84, v67, v73
    v_mul_f32 v85, v67, v72
    v_fma_f32 v72, v66, v72, -v84
    v_fma_f32 v73, -v66, v73, -v85
    v_mfma_f32_16x16x4_f32 v[48:51], v68, v74, v[48:51]
    v_mfma_f32_16x16x4_f32 v[52:55], v70, v76, v[52:55]
    v_mfma_f32_16x16x4_f32 v[56:59], v70, v78, v[56:59]
    v_mfma_f32_16x16x4_f32 v[60:63], v72, v80, v[60:63]
    v_mfma_f32_16x16x4_f32 v[48:51], v69, v75, v[48:51]
    v_mfma_f32_16x16x4_f32 v[52:55], v71, v77, v[52:55]
    v_mfma_f32_16x16x4_f32 v[56:59], v71, v79, v[56:59]
    v_mfma_f32_16x16x4_f32 v[60:63], v73, v81, v[60:63]
    v_mov_b32_dpp v64, v24 row_newbcast:12 row_mask:0xf bank_mask:0xf
    v_mov_b32_dpp v65, v25 row_newbcast:12 row_mask:0xf bank_mask:0xf
    v_mov_b32_dpp v66, v26 row_newbcast:12 row_mask:0xf bank_mask:0xf
    v_mov_b32_dpp v67, v27 row_newbcast:12 row_mask:0xf bank_mask:0xf
    v_mul_f32 v82, v64, v47
    v_mul_f32 v83, v65, v47
    v_exp_f32 v82, v82
    v_fract_f32 v83, v83
    v_cos_f32 v74, v83
    v_sin_f32 v75, v83
    v_mul_f32 v74, v74, v82
    v_mul_f32 v75, v75, v82
    v_mul_f32 v84, v75, v75
    v_add_f32 v85, v74, v74
    v_fma_f32 v76, v74, v74, -v84
    v_mul_f32 v77, v85, v75
    v_mul_f32 v84, v77, v77
    v_add_f32 v85, v76, v76
    v_fma_f32 v78, v76, v76, -v84
    v_mul_f32 v79, v85, v77
    v_mul_f32 v84, v79, v79
    v_add_f32 v85, v78, v78
    v_fma_f32 v80, v78, v78, -v84
    v_mul_f32 v81, v85, v79
    v_mul_f32 v82, v64, v44
    v_mul_f32 v83, v65, v44
    v_exp_f32 v82, v82
    v_fract_f32 v83, v83
    v_cos_f32 v68, v83
    v_sin_f32 v69, v83
    v_mul_f32 v68, v68, v82
    v_mul_f32 v69, v69, v82
    v_mul_f32 v84, v67, v69
    v_mul_f32 v85, v67, v68
    v_fma_f32 v68, v66, v68, -v84
    v_fma_f32 v69, -v66, v69, -v85
    v_mul_f32 v82, v64, v45
    v_mul_f32 v83, v65, v45
    v_exp_f32 v82, v82
    v_fract_f32 v83, v83
    v_cos_f32 v70, v83
    v_sin_f32 v71, v83
    v_mul_f32 v70, v70, v82
    v_mul_f32 v71, v71, v82
    v_mul_f32 v84, v67, v71
    v_mul_f32 v85, v67, v70
    v_fma_f32 v70, v66, v70, -v84
    v_fma_f32 v71, -v66, v71, -v85
    v_mul_f32 v82, v64, v46
    v_mul_f32 v83, v65, v46
    v_exp_f32 v82, v82
    v_fract_f32 v83, v83
    v_cos_f32 v72, v83
    v_sin_f32 v73, v83
    v_mul_f32 v72, v72, v82
    v_mul_f32 v73, v73, v82
    v_mul_f32 v84, v67, v73
    v_mul_f32 v85, v67, v72
    v_fma_f32 v72, v66, v72, -v84
    v_fma_f32 v73, -v66, v73, -v85
    v_mfma_f32_16x16x4_f32 v[48:51], v68, v74, v[48:51]
    v_mfma_f32_16x16x4_f32 v[52:55], v70, v76, v[52:55]
    v_mfma_f32_16x16x4_f32 v[56:59], v70, v78, v[56:59]
    v_mfma_f32_16x16x4_f32 v[60:63], v72, v80, v[60:63]
    v_mfma_f32_16x16x4_f32 v[48:51], v69, v75, v[48:51]
    v_mfma_f32_16x16x4_f32 v[52:55], v71, v77, v[52:55]
    v_mfma_f32_16x16x4_f32 v[56:59], v71, v79, v[56:59]
    v_mfma_f32_16x16x4_f32 v[60:63], v73, v81, v[60:63]
    v_mov_b32_dpp v64, v24 row_newbcast:13 row_mask:0xf bank_mask:0xf
    v_mov_b32_dpp v65, v25 row_newbcast:13 row_mask:0xf bank_mask:0xf
    v_mov_b32_dpp v66, v26 row_newbcast:13 row_mask:0xf bank_mask:0xf
    v_mov_b32_dpp v67, v27 row_newbcast:13 row_mask:0xf bank_mask:0xf
    v_mul_f32 v82, v64, v47
    v_mul_f32 v83, v65, v47
    v_exp_f32 v82, v82
    v_fract_f32 v83, v83
    v_cos_f32 v74, v83
    v_sin_f32 v75, v83
    v_mul_f32 v74, v74, v82
    v_mul_f32 v75, v75, v82
    v_mul_f32 v84, v75, v75
    v_add_f32 v85, v74, v74
    v_fma_f32 v76, v74, v74, -v84
    v_mul_f32 v77, v85, v75
    v_mul_f32 v84, v77, v77
    v_add_f32 v85, v76, v76
    v_fma_f32 v78, v76, v76, -v84
    v_mul_f32 v79, v85, v77
    v_mul_f32 v84, v79, v79
    v_add_f32 v85, v78, v78
    v_fma_f32 v80, v78, v78, -v84
    v_mul_f32 v81, v85, v79
    v_mul_f32 v82, v64, v44
    v_mul_f32 v83, v65, v44
    v_exp_f32 v82, v82
    v_fract_f32 v83, v83
    v_cos_f32 v68, v83
    v_sin_f32 v69, v83
    v_mul_f32 v68, v68, v82
    v_mul_f32 v69, v69, v82
    v_mul_f32 v84, v67, v69
    v_mul_f32 v85, v67, v68
    v_fma_f32 v68, v66, v68, -v84
    v_fma_f32 v69, -v66, v69, -v85
    v_mul_f32 v82, v64, v45
    v_mul_f32 v83, v65, v45
    v_exp_f32 v82, v82
    v_fract_f32 v83, v83
    v_cos_f32 v70, v83
    v_sin_f32 v71, v83
    v_mul_f32 v70, v70, v82
    v_mul_f32 v71, v71, v82
    v_mul_f32 v84, v67, v71
    v_mul_f32 v85, v67, v70
    v_fma_f32 v70, v66, v70, -v84
    v_fma_f32 v71, -v66, v71, -v85
    v_mul_f32 v82, v64, v46
    v_mul_f32 v83, v65, v46
    v_exp_f32 v82, v82
    v_fract_f32 v83, v83
    v_cos_f32 v72, v83
    v_sin_f32 v73, v83
    v_mul_f32 v72, v72, v82
    v_mul_f32 v73, v73, v82
    v_mul_f32 v84, v67, v73
    v_mul_f32 v85, v67, v72
    v_fma_f32 v72, v66, v72, -v84
    v_fma_f32 v73, -v66, v73, -v85
    v_mfma_f32_16x16x4_f32 v[48:51], v68, v74, v[48:51]
    v_mfma_f32_16x16x4_f32 v[52:55], v70, v76, v[52:55]
    v_mfma_f32_16x16x4_f32 v[56:59], v70, v78, v[56:59]
    v_mfma_f32_16x16x4_f32 v[60:63], v72, v80, v[60:63]
    v_mfma_f32_16x16x4_f32 v[48:51], v69, v75, v[48:51]
    v_mfma_f32_16x16x4_f32 v[52:55], v71, v77, v[52:55]
    v_mfma_f32_16x16x4_f32 v[56:59], v71, v79, v[56:59]
    v_mfma_f32_16x16x4_f32 v[60:63], v73, v81, v[60:63]
    v_mov_b32_dpp v64, v24 row_newbcast:14 row_mask:0xf bank_mask:0xf
    v_mov_b32_dpp v65, v25 row_newbcast:14 row_mask:0xf bank_mask:0xf
    v_mov_b32_dpp v66, v26 row_newbcast:14 row_mask:0xf bank_mask:0xf
    v_mov_b32_dpp v67, v27 row_newbcast:14 row_mask:0xf bank_mask:0xf
    v_mul_f32 v82, v64, v47
    v_mul_f32 v83, v65, v47
    v_exp_f32 v82, v82
    v_fract_f32 v83, v83
    v_cos_f32 v74, v83
    v_sin_f32 v75, v83
    v_mul_f32 v74, v74, v82
    v_mul_f32 v75, v75, v82
    v_mul_f32 v84, v75, v75
    v_add_f32 v85, v74, v74
    v_fma_f32 v76, v74, v74, -v84
    v_mul_f32 v77, v85, v75
    v_mul_f32 v84, v77, v77
    v_add_f32 v85, v76, v76
    v_fma_f32 v78, v76, v76, -v84
    v_mul_f32 v79, v85, v77
    v_mul_f32 v84, v79, v79
    v_add_f32 v85, v78, v78
    v_fma_f32 v80, v78, v78, -v84
    v_mul_f32 v81, v85, v79
    v_mul_f32 v82, v64, v44
    v_mul_f32 v83, v65, v44
    v_exp_f32 v82, v82
    v_fract_f32 v83, v83
    v_cos_f32 v68, v83
    v_sin_f32 v69, v83
    v_mul_f32 v68, v68, v82
    v_mul_f32 v69, v69, v82
    v_mul_f32 v84, v67, v69
    v_mul_f32 v85, v67, v68
    v_fma_f32 v68, v66, v68, -v84
    v_fma_f32 v69, -v66, v69, -v85
    v_mul_f32 v82, v64, v45
    v_mul_f32 v83, v65, v45
    v_exp_f32 v82, v82
    v_fract_f32 v83, v83
    v_cos_f32 v70, v83
    v_sin_f32 v71, v83
    v_mul_f32 v70, v70, v82
    v_mul_f32 v71, v71, v82
    v_mul_f32 v84, v67, v71
    v_mul_f32 v85, v67, v70
    v_fma_f32 v70, v66, v70, -v84
    v_fma_f32 v71, -v66, v71, -v85
    v_mul_f32 v82, v64, v46
    v_mul_f32 v83, v65, v46
    v_exp_f32 v82, v82
    v_fract_f32 v83, v83
    v_cos_f32 v72, v83
    v_sin_f32 v73, v83
    v_mul_f32 v72, v72, v82
    v_mul_f32 v73, v73, v82
    v_mul_f32 v84, v67, v73
    v_mul_f32 v85, v67, v72
    v_fma_f32 v72, v66, v72, -v84
    v_fma_f32 v73, -v66, v73, -v85
    v_mfma_f32_16x16x4_f32 v[48:51], v68, v74, v[48:51]
    v_mfma_f32_16x16x4_f32 v[52:55], v70, v76, v[52:55]
    v_mfma_f32_16x16x4_f32 v[56:59], v70, v78, v[56:59]
    v_mfma_f32_16x16x4_f32 v[60:63], v72, v80, v[60:63]
    v_mfma_f32_16x16x4_f32 v[48:51], v69, v75, v[48:51]
    v_mfma_f32_16x16x4_f32 v[52:55], v71, v77, v[52:55]
    v_mfma_f32_16x16x4_f32 v[56:59], v71, v79, v[56:59]
    v_mfma_f32_16x16x4_f32 v[60:63], v73, v81, v[60:63]
    v_mov_b32_dpp v64, v24 row_newbcast:15 row_mask:0xf bank_mask:0xf
    v_mov_b32_dpp v65, v25 row_newbcast:15 row_mask:0xf bank_mask:0xf
    v_mov_b32_dpp v66, v26 row_newbcast:15 row_mask:0xf bank_mask:0xf
    v_mov_b32_dpp v67, v27 row_newbcast:15 row_mask:0xf bank_mask:0xf
    v_mul_f32 v82, v64, v47
    v_mul_f32 v83, v65, v47
    v_exp_f32 v82, v82
    v_fract_f32 v83, v83
    v_cos_f32 v74, v83
    v_sin_f32 v75, v83
    v_mul_f32 v74, v74, v82
    v_mul_f32 v75, v75, v82
    v_mul_f32 v84, v75, v75
    v_add_f32 v85, v74, v74
    v_fma_f32 v76, v74, v74, -v84
    v_mul_f32 v77, v85, v75
    v_mul_f32 v84, v77, v77
    v_add_f32 v85, v76, v76
    v_fma_f32 v78, v76, v76, -v84
    v_mul_f32 v79, v85, v77
    v_mul_f32 v84, v79, v79
    v_add_f32 v85, v78, v78
    v_fma_f32 v80, v78, v78, -v84
    v_mul_f32 v81, v85, v79
    v_mul_f32 v82, v64, v44
    v_mul_f32 v83, v65, v44
    v_exp_f32 v82, v82
    v_fract_f32 v83, v83
    v_cos_f32 v68, v83
    v_sin_f32 v69, v83
    v_mul_f32 v68, v68, v82
    v_mul_f32 v69, v69, v82
    v_mul_f32 v84, v67, v69
    v_mul_f32 v85, v67, v68
    v_fma_f32 v68, v66, v68, -v84
    v_fma_f32 v69, -v66, v69, -v85
    v_mul_f32 v82, v64, v45
    v_mul_f32 v83, v65, v45
    v_exp_f32 v82, v82
    v_fract_f32 v83, v83
    v_cos_f32 v70, v83
    v_sin_f32 v71, v83
    v_mul_f32 v70, v70, v82
    v_mul_f32 v71, v71, v82
    v_mul_f32 v84, v67, v71
    v_mul_f32 v85, v67, v70
    v_fma_f32 v70, v66, v70, -v84
    v_fma_f32 v71, -v66, v71, -v85
    v_mul_f32 v82, v64, v46
    v_mul_f32 v83, v65, v46
    v_exp_f32 v82, v82
    v_fract_f32 v83, v83
    v_cos_f32 v72, v83
    v_sin_f32 v73, v83
    v_mul_f32 v72, v72, v82
    v_mul_f32 v73, v73, v82
    v_mul_f32 v84, v67, v73
    v_mul_f32 v85, v67, v72
    v_fma_f32 v72, v66, v72, -v84
    v_fma_f32 v73, -v66, v73, -v85
    v_mfma_f32_16x16x4_f32 v[48:51], v68, v74, v[48:51]
    v_mfma_f32_16x16x4_f32 v[52:55], v70, v76, v[52:55]
    v_mfma_f32_16x16x4_f32 v[56:59], v70, v78, v[56:59]
    v_mfma_f32_16x16x4_f32 v[60:63], v72, v80, v[60:63]
    v_mfma_f32_16x16x4_f32 v[48:51], v69, v75, v[48:51]
    v_mfma_f32_16x16x4_f32 v[52:55], v71, v77, v[52:55]
    v_mfma_f32_16x16x4_f32 v[56:59], v71, v79, v[56:59]
    v_mfma_f32_16x16x4_f32 v[60:63], v73, v81, v[60:63]
    v_mov_b32_dpp v64, v28 row_newbcast:0 row_mask:0xf bank_mask:0xf
    v_mov_b32_dpp v65, v29 row_newbcast:0 row_mask:0xf bank_mask:0xf
    v_mov_b32_dpp v66, v30 row_newbcast:0 row_mask:0xf bank_mask:0xf
    v_mov_b32_dpp v67, v31 row_newbcast:0 row_mask:0xf bank_mask:0xf
    v_mul_f32 v82, v64, v47
    v_mul_f32 v83, v65, v47
    v_exp_f32 v82, v82
    v_fract_f32 v83, v83
    v_cos_f32 v74, v83
    v_sin_f32 v75, v83
    v_mul_f32 v74, v74, v82
    v_mul_f32 v75, v75, v82
    v_mul_f32 v84, v75, v75
    v_add_f32 v85, v74, v74
    v_fma_f32 v76, v74, v74, -v84
    v_mul_f32 v77, v85, v75
    v_mul_f32 v84, v77, v77
    v_add_f32 v85, v76, v76
    v_fma_f32 v78, v76, v76, -v84
    v_mul_f32 v79, v85, v77
    v_mul_f32 v84, v79, v79
    v_add_f32 v85, v78, v78
    v_fma_f32 v80, v78, v78, -v84
    v_mul_f32 v81, v85, v79
    v_mul_f32 v82, v64, v44
    v_mul_f32 v83, v65, v44
    v_exp_f32 v82, v82
    v_fract_f32 v83, v83
    v_cos_f32 v68, v83
    v_sin_f32 v69, v83
    v_mul_f32 v68, v68, v82
    v_mul_f32 v69, v69, v82
    v_mul_f32 v84, v67, v69
    v_mul_f32 v85, v67, v68
    v_fma_f32 v68, v66, v68, -v84
    v_fma_f32 v69, -v66, v69, -v85
    v_mul_f32 v82, v64, v45
    v_mul_f32 v83, v65, v45
    v_exp_f32 v82, v82
    v_fract_f32 v83, v83
    v_cos_f32 v70, v83
    v_sin_f32 v71, v83
    v_mul_f32 v70, v70, v82
    v_mul_f32 v71, v71, v82
    v_mul_f32 v84, v67, v71
    v_mul_f32 v85, v67, v70
    v_fma_f32 v70, v66, v70, -v84
    v_fma_f32 v71, -v66, v71, -v85
    v_mul_f32 v82, v64, v46
    v_mul_f32 v83, v65, v46
    v_exp_f32 v82, v82
    v_fract_f32 v83, v83
    v_cos_f32 v72, v83
    v_sin_f32 v73, v83
    v_mul_f32 v72, v72, v82
    v_mul_f32 v73, v73, v82
    v_mul_f32 v84, v67, v73
    v_mul_f32 v85, v67, v72
    v_fma_f32 v72, v66, v72, -v84
    v_fma_f32 v73, -v66, v73, -v85
    v_mfma_f32_16x16x4_f32 v[48:51], v68, v74, v[48:51]
    v_mfma_f32_16x16x4_f32 v[52:55], v70, v76, v[52:55]
    v_mfma_f32_16x16x4_f32 v[56:59], v70, v78, v[56:59]
    v_mfma_f32_16x16x4_f32 v[60:63], v72, v80, v[60:63]
    v_mfma_f32_16x16x4_f32 v[48:51], v69, v75, v[48:51]
    v_mfma_f32_16x16x4_f32 v[52:55], v71, v77, v[52:55]
    v_mfma_f32_16x16x4_f32 v[56:59], v71, v79, v[56:59]
    v_mfma_f32_16x16x4_f32 v[60:63], v73, v81, v[60:63]
    v_mov_b32_dpp v64, v28 row_newbcast:1 row_mask:0xf bank_mask:0xf
    v_mov_b32_dpp v65, v29 row_newbcast:1 row_mask:0xf bank_mask:0xf
    v_mov_b32_dpp v66, v30 row_newbcast:1 row_mask:0xf bank_mask:0xf
    v_mov_b32_dpp v67, v31 row_newbcast:1 row_mask:0xf bank_mask:0xf
    v_mul_f32 v82, v64, v47
    v_mul_f32 v83, v65, v47
    v_exp_f32 v82, v82
    v_fract_f32 v83, v83
    v_cos_f32 v74, v83
    v_sin_f32 v75, v83
    v_mul_f32 v74, v74, v82
    v_mul_f32 v75, v75, v82
    v_mul_f32 v84, v75, v75
    v_add_f32 v85, v74, v74
    v_fma_f32 v76, v74, v74, -v84
    v_mul_f32 v77, v85, v75
    v_mul_f32 v84, v77, v77
    v_add_f32 v85, v76, v76
    v_fma_f32 v78, v76, v76, -v84
    v_mul_f32 v79, v85, v77
    v_mul_f32 v84, v79, v79
    v_add_f32 v85, v78, v78
    v_fma_f32 v80, v78, v78, -v84
    v_mul_f32 v81, v85, v79
    v_mul_f32 v82, v64, v44
    v_mul_f32 v83, v65, v44
    v_exp_f32 v82, v82
    v_fract_f32 v83, v83
    v_cos_f32 v68, v83
    v_sin_f32 v69, v83
    v_mul_f32 v68, v68, v82
    v_mul_f32 v69, v69, v82
    v_mul_f32 v84, v67, v69
    v_mul_f32 v85, v67, v68
    v_fma_f32 v68, v66, v68, -v84
    v_fma_f32 v69, -v66, v69, -v85
    v_mul_f32 v82, v64, v45
    v_mul_f32 v83, v65, v45
    v_exp_f32 v82, v82
    v_fract_f32 v83, v83
    v_cos_f32 v70, v83
    v_sin_f32 v71, v83
    v_mul_f32 v70, v70, v82
    v_mul_f32 v71, v71, v82
    v_mul_f32 v84, v67, v71
    v_mul_f32 v85, v67, v70
    v_fma_f32 v70, v66, v70, -v84
    v_fma_f32 v71, -v66, v71, -v85
    v_mul_f32 v82, v64, v46
    v_mul_f32 v83, v65, v46
    v_exp_f32 v82, v82
    v_fract_f32 v83, v83
    v_cos_f32 v72, v83
    v_sin_f32 v73, v83
    v_mul_f32 v72, v72, v82
    v_mul_f32 v73, v73, v82
    v_mul_f32 v84, v67, v73
    v_mul_f32 v85, v67, v72
    v_fma_f32 v72, v66, v72, -v84
    v_fma_f32 v73, -v66, v73, -v85
    v_mfma_f32_16x16x4_f32 v[48:51], v68, v74, v[48:51]
    v_mfma_f32_16x16x4_f32 v[52:55], v70, v76, v[52:55]
    v_mfma_f32_16x16x4_f32 v[56:59], v70, v78, v[56:59]
    v_mfma_f32_16x16x4_f32 v[60:63], v72, v80, v[60:63]
    v_mfma_f32_16x16x4_f32 v[48:51], v69, v75, v[48:51]
    v_mfma_f32_16x16x4_f32 v[52:55], v71, v77, v[52:55]
    v_mfma_f32_16x16x4_f32 v[56:59], v71, v79, v[56:59]
    v_mfma_f32_16x16x4_f32 v[60:63], v73, v81, v[60:63]
    v_mov_b32_dpp v64, v28 row_newbcast:2 row_mask:0xf bank_mask:0xf
    v_mov_b32_dpp v65, v29 row_newbcast:2 row_mask:0xf bank_mask:0xf
    v_mov_b32_dpp v66, v30 row_newbcast:2 row_mask:0xf bank_mask:0xf
    v_mov_b32_dpp v67, v31 row_newbcast:2 row_mask:0xf bank_mask:0xf
    v_mul_f32 v82, v64, v47
    v_mul_f32 v83, v65, v47
    v_exp_f32 v82, v82
    v_fract_f32 v83, v83
    v_cos_f32 v74, v83
    v_sin_f32 v75, v83
    v_mul_f32 v74, v74, v82
    v_mul_f32 v75, v75, v82
    v_mul_f32 v84, v75, v75
    v_add_f32 v85, v74, v74
    v_fma_f32 v76, v74, v74, -v84
    v_mul_f32 v77, v85, v75
    v_mul_f32 v84, v77, v77
    v_add_f32 v85, v76, v76
    v_fma_f32 v78, v76, v76, -v84
    v_mul_f32 v79, v85, v77
    v_mul_f32 v84, v79, v79
    v_add_f32 v85, v78, v78
    v_fma_f32 v80, v78, v78, -v84
    v_mul_f32 v81, v85, v79
    v_mul_f32 v82, v64, v44
    v_mul_f32 v83, v65, v44
    v_exp_f32 v82, v82
    v_fract_f32 v83, v83
    v_cos_f32 v68, v83
    v_sin_f32 v69, v83
    v_mul_f32 v68, v68, v82
    v_mul_f32 v69, v69, v82
    v_mul_f32 v84, v67, v69
    v_mul_f32 v85, v67, v68
    v_fma_f32 v68, v66, v68, -v84
    v_fma_f32 v69, -v66, v69, -v85
    v_mul_f32 v82, v64, v45
    v_mul_f32 v83, v65, v45
    v_exp_f32 v82, v82
    v_fract_f32 v83, v83
    v_cos_f32 v70, v83
    v_sin_f32 v71, v83
    v_mul_f32 v70, v70, v82
    v_mul_f32 v71, v71, v82
    v_mul_f32 v84, v67, v71
    v_mul_f32 v85, v67, v70
    v_fma_f32 v70, v66, v70, -v84
    v_fma_f32 v71, -v66, v71, -v85
    v_mul_f32 v82, v64, v46
    v_mul_f32 v83, v65, v46
    v_exp_f32 v82, v82
    v_fract_f32 v83, v83
    v_cos_f32 v72, v83
    v_sin_f32 v73, v83
    v_mul_f32 v72, v72, v82
    v_mul_f32 v73, v73, v82
    v_mul_f32 v84, v67, v73
    v_mul_f32 v85, v67, v72
    v_fma_f32 v72, v66, v72, -v84
    v_fma_f32 v73, -v66, v73, -v85
    v_mfma_f32_16x16x4_f32 v[48:51], v68, v74, v[48:51]
    v_mfma_f32_16x16x4_f32 v[52:55], v70, v76, v[52:55]
    v_mfma_f32_16x16x4_f32 v[56:59], v70, v78, v[56:59]
    v_mfma_f32_16x16x4_f32 v[60:63], v72, v80, v[60:63]
    v_mfma_f32_16x16x4_f32 v[48:51], v69, v75, v[48:51]
    v_mfma_f32_16x16x4_f32 v[52:55], v71, v77, v[52:55]
    v_mfma_f32_16x16x4_f32 v[56:59], v71, v79, v[56:59]
    v_mfma_f32_16x16x4_f32 v[60:63], v73, v81, v[60:63]
    v_mov_b32_dpp v64, v28 row_newbcast:3 row_mask:0xf bank_mask:0xf
    v_mov_b32_dpp v65, v29 row_newbcast:3 row_mask:0xf bank_mask:0xf
    v_mov_b32_dpp v66, v30 row_newbcast:3 row_mask:0xf bank_mask:0xf
    v_mov_b32_dpp v67, v31 row_newbcast:3 row_mask:0xf bank_mask:0xf
    v_mul_f32 v82, v64, v47
    v_mul_f32 v83, v65, v47
    v_exp_f32 v82, v82
    v_fract_f32 v83, v83
    v_cos_f32 v74, v83
    v_sin_f32 v75, v83
    v_mul_f32 v74, v74, v82
    v_mul_f32 v75, v75, v82
    v_mul_f32 v84, v75, v75
    v_add_f32 v85, v74, v74
    v_fma_f32 v76, v74, v74, -v84
    v_mul_f32 v77, v85, v75
    v_mul_f32 v84, v77, v77
    v_add_f32 v85, v76, v76
    v_fma_f32 v78, v76, v76, -v84
    v_mul_f32 v79, v85, v77
    v_mul_f32 v84, v79, v79
    v_add_f32 v85, v78, v78
    v_fma_f32 v80, v78, v78, -v84
    v_mul_f32 v81, v85, v79
    v_mul_f32 v82, v64, v44
    v_mul_f32 v83, v65, v44
    v_exp_f32 v82, v82
    v_fract_f32 v83, v83
    v_cos_f32 v68, v83
    v_sin_f32 v69, v83
    v_mul_f32 v68, v68, v82
    v_mul_f32 v69, v69, v82
    v_mul_f32 v84, v67, v69
    v_mul_f32 v85, v67, v68
    v_fma_f32 v68, v66, v68, -v84
    v_fma_f32 v69, -v66, v69, -v85
    v_mul_f32 v82, v64, v45
    v_mul_f32 v83, v65, v45
    v_exp_f32 v82, v82
    v_fract_f32 v83, v83
    v_cos_f32 v70, v83
    v_sin_f32 v71, v83
    v_mul_f32 v70, v70, v82
    v_mul_f32 v71, v71, v82
    v_mul_f32 v84, v67, v71
    v_mul_f32 v85, v67, v70
    v_fma_f32 v70, v66, v70, -v84
    v_fma_f32 v71, -v66, v71, -v85
    v_mul_f32 v82, v64, v46
    v_mul_f32 v83, v65, v46
    v_exp_f32 v82, v82
    v_fract_f32 v83, v83
    v_cos_f32 v72, v83
    v_sin_f32 v73, v83
    v_mul_f32 v72, v72, v82
    v_mul_f32 v73, v73, v82
    v_mul_f32 v84, v67, v73
    v_mul_f32 v85, v67, v72
    v_fma_f32 v72, v66, v72, -v84
    v_fma_f32 v73, -v66, v73, -v85
    v_mfma_f32_16x16x4_f32 v[48:51], v68, v74, v[48:51]
    v_mfma_f32_16x16x4_f32 v[52:55], v70, v76, v[52:55]
    v_mfma_f32_16x16x4_f32 v[56:59], v70, v78, v[56:59]
    v_mfma_f32_16x16x4_f32 v[60:63], v72, v80, v[60:63]
    v_mfma_f32_16x16x4_f32 v[48:51], v69, v75, v[48:51]
    v_mfma_f32_16x16x4_f32 v[52:55], v71, v77, v[52:55]
    v_mfma_f32_16x16x4_f32 v[56:59], v71, v79, v[56:59]
    v_mfma_f32_16x16x4_f32 v[60:63], v73, v81, v[60:63]
    v_mov_b32_dpp v64, v28 row_newbcast:4 row_mask:0xf bank_mask:0xf
    v_mov_b32_dpp v65, v29 row_newbcast:4 row_mask:0xf bank_mask:0xf
    v_mov_b32_dpp v66, v30 row_newbcast:4 row_mask:0xf bank_mask:0xf
    v_mov_b32_dpp v67, v31 row_newbcast:4 row_mask:0xf bank_mask:0xf
    v_mul_f32 v82, v64, v47
    v_mul_f32 v83, v65, v47
    v_exp_f32 v82, v82
    v_fract_f32 v83, v83
    v_cos_f32 v74, v83
    v_sin_f32 v75, v83
    v_mul_f32 v74, v74, v82
    v_mul_f32 v75, v75, v82
    v_mul_f32 v84, v75, v75
    v_add_f32 v85, v74, v74
    v_fma_f32 v76, v74, v74, -v84
    v_mul_f32 v77, v85, v75
    v_mul_f32 v84, v77, v77
    v_add_f32 v85, v76, v76
    v_fma_f32 v78, v76, v76, -v84
    v_mul_f32 v79, v85, v77
    v_mul_f32 v84, v79, v79
    v_add_f32 v85, v78, v78
    v_fma_f32 v80, v78, v78, -v84
    v_mul_f32 v81, v85, v79
    v_mul_f32 v82, v64, v44
    v_mul_f32 v83, v65, v44
    v_exp_f32 v82, v82
    v_fract_f32 v83, v83
    v_cos_f32 v68, v83
    v_sin_f32 v69, v83
    v_mul_f32 v68, v68, v82
    v_mul_f32 v69, v69, v82
    v_mul_f32 v84, v67, v69
    v_mul_f32 v85, v67, v68
    v_fma_f32 v68, v66, v68, -v84
    v_fma_f32 v69, -v66, v69, -v85
    v_mul_f32 v82, v64, v45
    v_mul_f32 v83, v65, v45
    v_exp_f32 v82, v82
    v_fract_f32 v83, v83
    v_cos_f32 v70, v83
    v_sin_f32 v71, v83
    v_mul_f32 v70, v70, v82
    v_mul_f32 v71, v71, v82
    v_mul_f32 v84, v67, v71
    v_mul_f32 v85, v67, v70
    v_fma_f32 v70, v66, v70, -v84
    v_fma_f32 v71, -v66, v71, -v85
    v_mul_f32 v82, v64, v46
    v_mul_f32 v83, v65, v46
    v_exp_f32 v82, v82
    v_fract_f32 v83, v83
    v_cos_f32 v72, v83
    v_sin_f32 v73, v83
    v_mul_f32 v72, v72, v82
    v_mul_f32 v73, v73, v82
    v_mul_f32 v84, v67, v73
    v_mul_f32 v85, v67, v72
    v_fma_f32 v72, v66, v72, -v84
    v_fma_f32 v73, -v66, v73, -v85
    v_mfma_f32_16x16x4_f32 v[48:51], v68, v74, v[48:51]
    v_mfma_f32_16x16x4_f32 v[52:55], v70, v76, v[52:55]
    v_mfma_f32_16x16x4_f32 v[56:59], v70, v78, v[56:59]
    v_mfma_f32_16x16x4_f32 v[60:63], v72, v80, v[60:63]
    v_mfma_f32_16x16x4_f32 v[48:51], v69, v75, v[48:51]
    v_mfma_f32_16x16x4_f32 v[52:55], v71, v77, v[52:55]
    v_mfma_f32_16x16x4_f32 v[56:59], v71, v79, v[56:59]
    v_mfma_f32_16x16x4_f32 v[60:63], v73, v81, v[60:63]
    v_mov_b32_dpp v64, v28 row_newbcast:5 row_mask:0xf bank_mask:0xf
    v_mov_b32_dpp v65, v29 row_newbcast:5 row_mask:0xf bank_mask:0xf
    v_mov_b32_dpp v66, v30 row_newbcast:5 row_mask:0xf bank_mask:0xf
    v_mov_b32_dpp v67, v31 row_newbcast:5 row_mask:0xf bank_mask:0xf
    v_mul_f32 v82, v64, v47
    v_mul_f32 v83, v65, v47
    v_exp_f32 v82, v82
    v_fract_f32 v83, v83
    v_cos_f32 v74, v83
    v_sin_f32 v75, v83
    v_mul_f32 v74, v74, v82
    v_mul_f32 v75, v75, v82
    v_mul_f32 v84, v75, v75
    v_add_f32 v85, v74, v74
    v_fma_f32 v76, v74, v74, -v84
    v_mul_f32 v77, v85, v75
    v_mul_f32 v84, v77, v77
    v_add_f32 v85, v76, v76
    v_fma_f32 v78, v76, v76, -v84
    v_mul_f32 v79, v85, v77
    v_mul_f32 v84, v79, v79
    v_add_f32 v85, v78, v78
    v_fma_f32 v80, v78, v78, -v84
    v_mul_f32 v81, v85, v79
    v_mul_f32 v82, v64, v44
    v_mul_f32 v83, v65, v44
    v_exp_f32 v82, v82
    v_fract_f32 v83, v83
    v_cos_f32 v68, v83
    v_sin_f32 v69, v83
    v_mul_f32 v68, v68, v82
    v_mul_f32 v69, v69, v82
    v_mul_f32 v84, v67, v69
    v_mul_f32 v85, v67, v68
    v_fma_f32 v68, v66, v68, -v84
    v_fma_f32 v69, -v66, v69, -v85
    v_mul_f32 v82, v64, v45
    v_mul_f32 v83, v65, v45
    v_exp_f32 v82, v82
    v_fract_f32 v83, v83
    v_cos_f32 v70, v83
    v_sin_f32 v71, v83
    v_mul_f32 v70, v70, v82
    v_mul_f32 v71, v71, v82
    v_mul_f32 v84, v67, v71
    v_mul_f32 v85, v67, v70
    v_fma_f32 v70, v66, v70, -v84
    v_fma_f32 v71, -v66, v71, -v85
    v_mul_f32 v82, v64, v46
    v_mul_f32 v83, v65, v46
    v_exp_f32 v82, v82
    v_fract_f32 v83, v83
    v_cos_f32 v72, v83
    v_sin_f32 v73, v83
    v_mul_f32 v72, v72, v82
    v_mul_f32 v73, v73, v82
    v_mul_f32 v84, v67, v73
    v_mul_f32 v85, v67, v72
    v_fma_f32 v72, v66, v72, -v84
    v_fma_f32 v73, -v66, v73, -v85
    v_mfma_f32_16x16x4_f32 v[48:51], v68, v74, v[48:51]
    v_mfma_f32_16x16x4_f32 v[52:55], v70, v76, v[52:55]
    v_mfma_f32_16x16x4_f32 v[56:59], v70, v78, v[56:59]
    v_mfma_f32_16x16x4_f32 v[60:63], v72, v80, v[60:63]
    v_mfma_f32_16x16x4_f32 v[48:51], v69, v75, v[48:51]
    v_mfma_f32_16x16x4_f32 v[52:55], v71, v77, v[52:55]
    v_mfma_f32_16x16x4_f32 v[56:59], v71, v79, v[56:59]
    v_mfma_f32_16x16x4_f32 v[60:63], v73, v81, v[60:63]
    v_mov_b32_dpp v64, v28 row_newbcast:6 row_mask:0xf bank_mask:0xf
    v_mov_b32_dpp v65, v29 row_newbcast:6 row_mask:0xf bank_mask:0xf
    v_mov_b32_dpp v66, v30 row_newbcast:6 row_mask:0xf bank_mask:0xf
    v_mov_b32_dpp v67, v31 row_newbcast:6 row_mask:0xf bank_mask:0xf
    v_mul_f32 v82, v64, v47
    v_mul_f32 v83, v65, v47
    v_exp_f32 v82, v82
    v_fract_f32 v83, v83
    v_cos_f32 v74, v83
    v_sin_f32 v75, v83
    v_mul_f32 v74, v74, v82
    v_mul_f32 v75, v75, v82
    v_mul_f32 v84, v75, v75
    v_add_f32 v85, v74, v74
    v_fma_f32 v76, v74, v74, -v84
    v_mul_f32 v77, v85, v75
    v_mul_f32 v84, v77, v77
    v_add_f32 v85, v76, v76
    v_fma_f32 v78, v76, v76, -v84
    v_mul_f32 v79, v85, v77
    v_mul_f32 v84, v79, v79
    v_add_f32 v85, v78, v78
    v_fma_f32 v80, v78, v78, -v84
    v_mul_f32 v81, v85, v79
    v_mul_f32 v82, v64, v44
    v_mul_f32 v83, v65, v44
    v_exp_f32 v82, v82
    v_fract_f32 v83, v83
    v_cos_f32 v68, v83
    v_sin_f32 v69, v83
    v_mul_f32 v68, v68, v82
    v_mul_f32 v69, v69, v82
    v_mul_f32 v84, v67, v69
    v_mul_f32 v85, v67, v68
    v_fma_f32 v68, v66, v68, -v84
    v_fma_f32 v69, -v66, v69, -v85
    v_mul_f32 v82, v64, v45
    v_mul_f32 v83, v65, v45
    v_exp_f32 v82, v82
    v_fract_f32 v83, v83
    v_cos_f32 v70, v83
    v_sin_f32 v71, v83
    v_mul_f32 v70, v70, v82
    v_mul_f32 v71, v71, v82
    v_mul_f32 v84, v67, v71
    v_mul_f32 v85, v67, v70
    v_fma_f32 v70, v66, v70, -v84
    v_fma_f32 v71, -v66, v71, -v85
    v_mul_f32 v82, v64, v46
    v_mul_f32 v83, v65, v46
    v_exp_f32 v82, v82
    v_fract_f32 v83, v83
    v_cos_f32 v72, v83
    v_sin_f32 v73, v83
    v_mul_f32 v72, v72, v82
    v_mul_f32 v73, v73, v82
    v_mul_f32 v84, v67, v73
    v_mul_f32 v85, v67, v72
    v_fma_f32 v72, v66, v72, -v84
    v_fma_f32 v73, -v66, v73, -v85
    v_mfma_f32_16x16x4_f32 v[48:51], v68, v74, v[48:51]
    v_mfma_f32_16x16x4_f32 v[52:55], v70, v76, v[52:55]
    v_mfma_f32_16x16x4_f32 v[56:59], v70, v78, v[56:59]
    v_mfma_f32_16x16x4_f32 v[60:63], v72, v80, v[60:63]
    v_mfma_f32_16x16x4_f32 v[48:51], v69, v75, v[48:51]
    v_mfma_f32_16x16x4_f32 v[52:55], v71, v77, v[52:55]
    v_mfma_f32_16x16x4_f32 v[56:59], v71, v79, v[56:59]
    v_mfma_f32_16x16x4_f32 v[60:63], v73, v81, v[60:63]
    v_mov_b32_dpp v64, v28 row_newbcast:7 row_mask:0xf bank_mask:0xf
    v_mov_b32_dpp v65, v29 row_newbcast:7 row_mask:0xf bank_mask:0xf
    v_mov_b32_dpp v66, v30 row_newbcast:7 row_mask:0xf bank_mask:0xf
    v_mov_b32_dpp v67, v31 row_newbcast:7 row_mask:0xf bank_mask:0xf
    v_mul_f32 v82, v64, v47
    v_mul_f32 v83, v65, v47
    v_exp_f32 v82, v82
    v_fract_f32 v83, v83
    v_cos_f32 v74, v83
    v_sin_f32 v75, v83
    v_mul_f32 v74, v74, v82
    v_mul_f32 v75, v75, v82
    v_mul_f32 v84, v75, v75
    v_add_f32 v85, v74, v74
    v_fma_f32 v76, v74, v74, -v84
    v_mul_f32 v77, v85, v75
    v_mul_f32 v84, v77, v77
    v_add_f32 v85, v76, v76
    v_fma_f32 v78, v76, v76, -v84
    v_mul_f32 v79, v85, v77
    v_mul_f32 v84, v79, v79
    v_add_f32 v85, v78, v78
    v_fma_f32 v80, v78, v78, -v84
    v_mul_f32 v81, v85, v79
    v_mul_f32 v82, v64, v44
    v_mul_f32 v83, v65, v44
    v_exp_f32 v82, v82
    v_fract_f32 v83, v83
    v_cos_f32 v68, v83
    v_sin_f32 v69, v83
    v_mul_f32 v68, v68, v82
    v_mul_f32 v69, v69, v82
    v_mul_f32 v84, v67, v69
    v_mul_f32 v85, v67, v68
    v_fma_f32 v68, v66, v68, -v84
    v_fma_f32 v69, -v66, v69, -v85
    v_mul_f32 v82, v64, v45
    v_mul_f32 v83, v65, v45
    v_exp_f32 v82, v82
    v_fract_f32 v83, v83
    v_cos_f32 v70, v83
    v_sin_f32 v71, v83
    v_mul_f32 v70, v70, v82
    v_mul_f32 v71, v71, v82
    v_mul_f32 v84, v67, v71
    v_mul_f32 v85, v67, v70
    v_fma_f32 v70, v66, v70, -v84
    v_fma_f32 v71, -v66, v71, -v85
    v_mul_f32 v82, v64, v46
    v_mul_f32 v83, v65, v46
    v_exp_f32 v82, v82
    v_fract_f32 v83, v83
    v_cos_f32 v72, v83
    v_sin_f32 v73, v83
    v_mul_f32 v72, v72, v82
    v_mul_f32 v73, v73, v82
    v_mul_f32 v84, v67, v73
    v_mul_f32 v85, v67, v72
    v_fma_f32 v72, v66, v72, -v84
    v_fma_f32 v73, -v66, v73, -v85
    v_mfma_f32_16x16x4_f32 v[48:51], v68, v74, v[48:51]
    v_mfma_f32_16x16x4_f32 v[52:55], v70, v76, v[52:55]
    v_mfma_f32_16x16x4_f32 v[56:59], v70, v78, v[56:59]
    v_mfma_f32_16x16x4_f32 v[60:63], v72, v80, v[60:63]
    v_mfma_f32_16x16x4_f32 v[48:51], v69, v75, v[48:51]
    v_mfma_f32_16x16x4_f32 v[52:55], v71, v77, v[52:55]
    v_mfma_f32_16x16x4_f32 v[56:59], v71, v79, v[56:59]
    v_mfma_f32_16x16x4_f32 v[60:63], v73, v81, v[60:63]
    v_mov_b32_dpp v64, v28 row_newbcast:8 row_mask:0xf bank_mask:0xf
    v_mov_b32_dpp v65, v29 row_newbcast:8 row_mask:0xf bank_mask:0xf
    v_mov_b32_dpp v66, v30 row_newbcast:8 row_mask:0xf bank_mask:0xf
    v_mov_b32_dpp v67, v31 row_newbcast:8 row_mask:0xf bank_mask:0xf
    v_mul_f32 v82, v64, v47
    v_mul_f32 v83, v65, v47
    v_exp_f32 v82, v82
    v_fract_f32 v83, v83
    v_cos_f32 v74, v83
    v_sin_f32 v75, v83
    v_mul_f32 v74, v74, v82
    v_mul_f32 v75, v75, v82
    v_mul_f32 v84, v75, v75
    v_add_f32 v85, v74, v74
    v_fma_f32 v76, v74, v74, -v84
    v_mul_f32 v77, v85, v75
    v_mul_f32 v84, v77, v77
    v_add_f32 v85, v76, v76
    v_fma_f32 v78, v76, v76, -v84
    v_mul_f32 v79, v85, v77
    v_mul_f32 v84, v79, v79
    v_add_f32 v85, v78, v78
    v_fma_f32 v80, v78, v78, -v84
    v_mul_f32 v81, v85, v79
    v_mul_f32 v82, v64, v44
    v_mul_f32 v83, v65, v44
    v_exp_f32 v82, v82
    v_fract_f32 v83, v83
    v_cos_f32 v68, v83
    v_sin_f32 v69, v83
    v_mul_f32 v68, v68, v82
    v_mul_f32 v69, v69, v82
    v_mul_f32 v84, v67, v69
    v_mul_f32 v85, v67, v68
    v_fma_f32 v68, v66, v68, -v84
    v_fma_f32 v69, -v66, v69, -v85
    v_mul_f32 v82, v64, v45
    v_mul_f32 v83, v65, v45
    v_exp_f32 v82, v82
    v_fract_f32 v83, v83
    v_cos_f32 v70, v83
    v_sin_f32 v71, v83
    v_mul_f32 v70, v70, v82
    v_mul_f32 v71, v71, v82
    v_mul_f32 v84, v67, v71
    v_mul_f32 v85, v67, v70
    v_fma_f32 v70, v66, v70, -v84
    v_fma_f32 v71, -v66, v71, -v85
    v_mul_f32 v82, v64, v46
    v_mul_f32 v83, v65, v46
    v_exp_f32 v82, v82
    v_fract_f32 v83, v83
    v_cos_f32 v72, v83
    v_sin_f32 v73, v83
    v_mul_f32 v72, v72, v82
    v_mul_f32 v73, v73, v82
    v_mul_f32 v84, v67, v73
    v_mul_f32 v85, v67, v72
    v_fma_f32 v72, v66, v72, -v84
    v_fma_f32 v73, -v66, v73, -v85
    v_mfma_f32_16x16x4_f32 v[48:51], v68, v74, v[48:51]
    v_mfma_f32_16x16x4_f32 v[52:55], v70, v76, v[52:55]
    v_mfma_f32_16x16x4_f32 v[56:59], v70, v78, v[56:59]
    v_mfma_f32_16x16x4_f32 v[60:63], v72, v80, v[60:63]
    v_mfma_f32_16x16x4_f32 v[48:51], v69, v75, v[48:51]
    v_mfma_f32_16x16x4_f32 v[52:55], v71, v77, v[52:55]
    v_mfma_f32_16x16x4_f32 v[56:59], v71, v79, v[56:59]
    v_mfma_f32_16x16x4_f32 v[60:63], v73, v81, v[60:63]
    v_mov_b32_dpp v64, v28 row_newbcast:9 row_mask:0xf bank_mask:0xf
    v_mov_b32_dpp v65, v29 row_newbcast:9 row_mask:0xf bank_mask:0xf
    v_mov_b32_dpp v66, v30 row_newbcast:9 row_mask:0xf bank_mask:0xf
    v_mov_b32_dpp v67, v31 row_newbcast:9 row_mask:0xf bank_mask:0xf
    v_mul_f32 v82, v64, v47
    v_mul_f32 v83, v65, v47
    v_exp_f32 v82, v82
    v_fract_f32 v83, v83
    v_cos_f32 v74, v83
    v_sin_f32 v75, v83
    v_mul_f32 v74, v74, v82
    v_mul_f32 v75, v75, v82
    v_mul_f32 v84, v75, v75
    v_add_f32 v85, v74, v74
    v_fma_f32 v76, v74, v74, -v84
    v_mul_f32 v77, v85, v75
    v_mul_f32 v84, v77, v77
    v_add_f32 v85, v76, v76
    v_fma_f32 v78, v76, v76, -v84
    v_mul_f32 v79, v85, v77
    v_mul_f32 v84, v79, v79
    v_add_f32 v85, v78, v78
    v_fma_f32 v80, v78, v78, -v84
    v_mul_f32 v81, v85, v79
    v_mul_f32 v82, v64, v44
    v_mul_f32 v83, v65, v44
    v_exp_f32 v82, v82
    v_fract_f32 v83, v83
    v_cos_f32 v68, v83
    v_sin_f32 v69, v83
    v_mul_f32 v68, v68, v82
    v_mul_f32 v69, v69, v82
    v_mul_f32 v84, v67, v69
    v_mul_f32 v85, v67, v68
    v_fma_f32 v68, v66, v68, -v84
    v_fma_f32 v69, -v66, v69, -v85
    v_mul_f32 v82, v64, v45
    v_mul_f32 v83, v65, v45
    v_exp_f32 v82, v82
    v_fract_f32 v83, v83
    v_cos_f32 v70, v83
    v_sin_f32 v71, v83
    v_mul_f32 v70, v70, v82
    v_mul_f32 v71, v71, v82
    v_mul_f32 v84, v67, v71
    v_mul_f32 v85, v67, v70
    v_fma_f32 v70, v66, v70, -v84
    v_fma_f32 v71, -v66, v71, -v85
    v_mul_f32 v82, v64, v46
    v_mul_f32 v83, v65, v46
    v_exp_f32 v82, v82
    v_fract_f32 v83, v83
    v_cos_f32 v72, v83
    v_sin_f32 v73, v83
    v_mul_f32 v72, v72, v82
    v_mul_f32 v73, v73, v82
    v_mul_f32 v84, v67, v73
    v_mul_f32 v85, v67, v72
    v_fma_f32 v72, v66, v72, -v84
    v_fma_f32 v73, -v66, v73, -v85
    v_mfma_f32_16x16x4_f32 v[48:51], v68, v74, v[48:51]
    v_mfma_f32_16x16x4_f32 v[52:55], v70, v76, v[52:55]
    v_mfma_f32_16x16x4_f32 v[56:59], v70, v78, v[56:59]
    v_mfma_f32_16x16x4_f32 v[60:63], v72, v80, v[60:63]
    v_mfma_f32_16x16x4_f32 v[48:51], v69, v75, v[48:51]
    v_mfma_f32_16x16x4_f32 v[52:55], v71, v77, v[52:55]
    v_mfma_f32_16x16x4_f32 v[56:59], v71, v79, v[56:59]
    v_mfma_f32_16x16x4_f32 v[60:63], v73, v81, v[60:63]
    v_mov_b32_dpp v64, v28 row_newbcast:10 row_mask:0xf bank_mask:0xf
    v_mov_b32_dpp v65, v29 row_newbcast:10 row_mask:0xf bank_mask:0xf
    v_mov_b32_dpp v66, v30 row_newbcast:10 row_mask:0xf bank_mask:0xf
    v_mov_b32_dpp v67, v31 row_newbcast:10 row_mask:0xf bank_mask:0xf
    v_mul_f32 v82, v64, v47
    v_mul_f32 v83, v65, v47
    v_exp_f32 v82, v82
    v_fract_f32 v83, v83
    v_cos_f32 v74, v83
    v_sin_f32 v75, v83
    v_mul_f32 v74, v74, v82
    v_mul_f32 v75, v75, v82
    v_mul_f32 v84, v75, v75
    v_add_f32 v85, v74, v74
    v_fma_f32 v76, v74, v74, -v84
    v_mul_f32 v77, v85, v75
    v_mul_f32 v84, v77, v77
    v_add_f32 v85, v76, v76
    v_fma_f32 v78, v76, v76, -v84
    v_mul_f32 v79, v85, v77
    v_mul_f32 v84, v79, v79
    v_add_f32 v85, v78, v78
    v_fma_f32 v80, v78, v78, -v84
    v_mul_f32 v81, v85, v79
    v_mul_f32 v82, v64, v44
    v_mul_f32 v83, v65, v44
    v_exp_f32 v82, v82
    v_fract_f32 v83, v83
    v_cos_f32 v68, v83
    v_sin_f32 v69, v83
    v_mul_f32 v68, v68, v82
    v_mul_f32 v69, v69, v82
    v_mul_f32 v84, v67, v69
    v_mul_f32 v85, v67, v68
    v_fma_f32 v68, v66, v68, -v84
    v_fma_f32 v69, -v66, v69, -v85
    v_mul_f32 v82, v64, v45
    v_mul_f32 v83, v65, v45
    v_exp_f32 v82, v82
    v_fract_f32 v83, v83
    v_cos_f32 v70, v83
    v_sin_f32 v71, v83
    v_mul_f32 v70, v70, v82
    v_mul_f32 v71, v71, v82
    v_mul_f32 v84, v67, v71
    v_mul_f32 v85, v67, v70
    v_fma_f32 v70, v66, v70, -v84
    v_fma_f32 v71, -v66, v71, -v85
    v_mul_f32 v82, v64, v46
    v_mul_f32 v83, v65, v46
    v_exp_f32 v82, v82
    v_fract_f32 v83, v83
    v_cos_f32 v72, v83
    v_sin_f32 v73, v83
    v_mul_f32 v72, v72, v82
    v_mul_f32 v73, v73, v82
    v_mul_f32 v84, v67, v73
    v_mul_f32 v85, v67, v72
    v_fma_f32 v72, v66, v72, -v84
    v_fma_f32 v73, -v66, v73, -v85
    v_mfma_f32_16x16x4_f32 v[48:51], v68, v74, v[48:51]
    v_mfma_f32_16x16x4_f32 v[52:55], v70, v76, v[52:55]
    v_mfma_f32_16x16x4_f32 v[56:59], v70, v78, v[56:59]
    v_mfma_f32_16x16x4_f32 v[60:63], v72, v80, v[60:63]
    v_mfma_f32_16x16x4_f32 v[48:51], v69, v75, v[48:51]
    v_mfma_f32_16x16x4_f32 v[52:55], v71, v77, v[52:55]
    v_mfma_f32_16x16x4_f32 v[56:59], v71, v79, v[56:59]
    v_mfma_f32_16x16x4_f32 v[60:63], v73, v81, v[60:63]
    v_mov_b32_dpp v64, v28 row_newbcast:11 row_mask:0xf bank_mask:0xf
    v_mov_b32_dpp v65, v29 row_newbcast:11 row_mask:0xf bank_mask:0xf
    v_mov_b32_dpp v66, v30 row_newbcast:11 row_mask:0xf bank_mask:0xf
    v_mov_b32_dpp v67, v31 row_newbcast:11 row_mask:0xf bank_mask:0xf
    v_mul_f32 v82, v64, v47
    v_mul_f32 v83, v65, v47
    v_exp_f32 v82, v82
    v_fract_f32 v83, v83
    v_cos_f32 v74, v83
    v_sin_f32 v75, v83
    v_mul_f32 v74, v74, v82
    v_mul_f32 v75, v75, v82
    v_mul_f32 v84, v75, v75
    v_add_f32 v85, v74, v74
    v_fma_f32 v76, v74, v74, -v84
    v_mul_f32 v77, v85, v75
    v_mul_f32 v84, v77, v77
    v_add_f32 v85, v76, v76
    v_fma_f32 v78, v76, v76, -v84
    v_mul_f32 v79, v85, v77
    v_mul_f32 v84, v79, v79
    v_add_f32 v85, v78, v78
    v_fma_f32 v80, v78, v78, -v84
    v_mul_f32 v81, v85, v79
    v_mul_f32 v82, v64, v44
    v_mul_f32 v83, v65, v44
    v_exp_f32 v82, v82
    v_fract_f32 v83, v83
    v_cos_f32 v68, v83
    v_sin_f32 v69, v83
    v_mul_f32 v68, v68, v82
    v_mul_f32 v69, v69, v82
    v_mul_f32 v84, v67, v69
    v_mul_f32 v85, v67, v68
    v_fma_f32 v68, v66, v68, -v84
    v_fma_f32 v69, -v66, v69, -v85
    v_mul_f32 v82, v64, v45
    v_mul_f32 v83, v65, v45
    v_exp_f32 v82, v82
    v_fract_f32 v83, v83
    v_cos_f32 v70, v83
    v_sin_f32 v71, v83
    v_mul_f32 v70, v70, v82
    v_mul_f32 v71, v71, v82
    v_mul_f32 v84, v67, v71
    v_mul_f32 v85, v67, v70
    v_fma_f32 v70, v66, v70, -v84
    v_fma_f32 v71, -v66, v71, -v85
    v_mul_f32 v82, v64, v46
    v_mul_f32 v83, v65, v46
    v_exp_f32 v82, v82
    v_fract_f32 v83, v83
    v_cos_f32 v72, v83
    v_sin_f32 v73, v83
    v_mul_f32 v72, v72, v82
    v_mul_f32 v73, v73, v82
    v_mul_f32 v84, v67, v73
    v_mul_f32 v85, v67, v72
    v_fma_f32 v72, v66, v72, -v84
    v_fma_f32 v73, -v66, v73, -v85
    v_mfma_f32_16x16x4_f32 v[48:51], v68, v74, v[48:51]
    v_mfma_f32_16x16x4_f32 v[52:55], v70, v76, v[52:55]
    v_mfma_f32_16x16x4_f32 v[56:59], v70, v78, v[56:59]
    v_mfma_f32_16x16x4_f32 v[60:63], v72, v80, v[60:63]
    v_mfma_f32_16x16x4_f32 v[48:51], v69, v75, v[48:51]
    v_mfma_f32_16x16x4_f32 v[52:55], v71, v77, v[52:55]
    v_mfma_f32_16x16x4_f32 v[56:59], v71, v79, v[56:59]
    v_mfma_f32_16x16x4_f32 v[60:63], v73, v81, v[60:63]
    v_mov_b32_dpp v64, v28 row_newbcast:12 row_mask:0xf bank_mask:0xf
    v_mov_b32_dpp v65, v29 row_newbcast:12 row_mask:0xf bank_mask:0xf
    v_mov_b32_dpp v66, v30 row_newbcast:12 row_mask:0xf bank_mask:0xf
    v_mov_b32_dpp v67, v31 row_newbcast:12 row_mask:0xf bank_mask:0xf
    v_mul_f32 v82, v64, v47
    v_mul_f32 v83, v65, v47
    v_exp_f32 v82, v82
    v_fract_f32 v83, v83
    v_cos_f32 v74, v83
    v_sin_f32 v75, v83
    v_mul_f32 v74, v74, v82
    v_mul_f32 v75, v75, v82
    v_mul_f32 v84, v75, v75
    v_add_f32 v85, v74, v74
    v_fma_f32 v76, v74, v74, -v84
    v_mul_f32 v77, v85, v75
    v_mul_f32 v84, v77, v77
    v_add_f32 v85, v76, v76
    v_fma_f32 v78, v76, v76, -v84
    v_mul_f32 v79, v85, v77
    v_mul_f32 v84, v79, v79
    v_add_f32 v85, v78, v78
    v_fma_f32 v80, v78, v78, -v84
    v_mul_f32 v81, v85, v79
    v_mul_f32 v82, v64, v44
    v_mul_f32 v83, v65, v44
    v_exp_f32 v82, v82
    v_fract_f32 v83, v83
    v_cos_f32 v68, v83
    v_sin_f32 v69, v83
    v_mul_f32 v68, v68, v82
    v_mul_f32 v69, v69, v82
    v_mul_f32 v84, v67, v69
    v_mul_f32 v85, v67, v68
    v_fma_f32 v68, v66, v68, -v84
    v_fma_f32 v69, -v66, v69, -v85
    v_mul_f32 v82, v64, v45
    v_mul_f32 v83, v65, v45
    v_exp_f32 v82, v82
    v_fract_f32 v83, v83
    v_cos_f32 v70, v83
    v_sin_f32 v71, v83
    v_mul_f32 v70, v70, v82
    v_mul_f32 v71, v71, v82
    v_mul_f32 v84, v67, v71
    v_mul_f32 v85, v67, v70
    v_fma_f32 v70, v66, v70, -v84
    v_fma_f32 v71, -v66, v71, -v85
    v_mul_f32 v82, v64, v46
    v_mul_f32 v83, v65, v46
    v_exp_f32 v82, v82
    v_fract_f32 v83, v83
    v_cos_f32 v72, v83
    v_sin_f32 v73, v83
    v_mul_f32 v72, v72, v82
    v_mul_f32 v73, v73, v82
    v_mul_f32 v84, v67, v73
    v_mul_f32 v85, v67, v72
    v_fma_f32 v72, v66, v72, -v84
    v_fma_f32 v73, -v66, v73, -v85
    v_mfma_f32_16x16x4_f32 v[48:51], v68, v74, v[48:51]
    v_mfma_f32_16x16x4_f32 v[52:55], v70, v76, v[52:55]
    v_mfma_f32_16x16x4_f32 v[56:59], v70, v78, v[56:59]
    v_mfma_f32_16x16x4_f32 v[60:63], v72, v80, v[60:63]
    v_mfma_f32_16x16x4_f32 v[48:51], v69, v75, v[48:51]
    v_mfma_f32_16x16x4_f32 v[52:55], v71, v77, v[52:55]
    v_mfma_f32_16x16x4_f32 v[56:59], v71, v79, v[56:59]
    v_mfma_f32_16x16x4_f32 v[60:63], v73, v81, v[60:63]
    v_mov_b32_dpp v64, v28 row_newbcast:13 row_mask:0xf bank_mask:0xf
    v_mov_b32_dpp v65, v29 row_newbcast:13 row_mask:0xf bank_mask:0xf
    v_mov_b32_dpp v66, v30 row_newbcast:13 row_mask:0xf bank_mask:0xf
    v_mov_b32_dpp v67, v31 row_newbcast:13 row_mask:0xf bank_mask:0xf
    v_mul_f32 v82, v64, v47
    v_mul_f32 v83, v65, v47
    v_exp_f32 v82, v82
    v_fract_f32 v83, v83
    v_cos_f32 v74, v83
    v_sin_f32 v75, v83
    v_mul_f32 v74, v74, v82
    v_mul_f32 v75, v75, v82
    v_mul_f32 v84, v75, v75
    v_add_f32 v85, v74, v74
    v_fma_f32 v76, v74, v74, -v84
    v_mul_f32 v77, v85, v75
    v_mul_f32 v84, v77, v77
    v_add_f32 v85, v76, v76
    v_fma_f32 v78, v76, v76, -v84
    v_mul_f32 v79, v85, v77
    v_mul_f32 v84, v79, v79
    v_add_f32 v85, v78, v78
    v_fma_f32 v80, v78, v78, -v84
    v_mul_f32 v81, v85, v79
    v_mul_f32 v82, v64, v44
    v_mul_f32 v83, v65, v44
    v_exp_f32 v82, v82
    v_fract_f32 v83, v83
    v_cos_f32 v68, v83
    v_sin_f32 v69, v83
    v_mul_f32 v68, v68, v82
    v_mul_f32 v69, v69, v82
    v_mul_f32 v84, v67, v69
    v_mul_f32 v85, v67, v68
    v_fma_f32 v68, v66, v68, -v84
    v_fma_f32 v69, -v66, v69, -v85
    v_mul_f32 v82, v64, v45
    v_mul_f32 v83, v65, v45
    v_exp_f32 v82, v82
    v_fract_f32 v83, v83
    v_cos_f32 v70, v83
    v_sin_f32 v71, v83
    v_mul_f32 v70, v70, v82
    v_mul_f32 v71, v71, v82
    v_mul_f32 v84, v67, v71
    v_mul_f32 v85, v67, v70
    v_fma_f32 v70, v66, v70, -v84
    v_fma_f32 v71, -v66, v71, -v85
    v_mul_f32 v82, v64, v46
    v_mul_f32 v83, v65, v46
    v_exp_f32 v82, v82
    v_fract_f32 v83, v83
    v_cos_f32 v72, v83
    v_sin_f32 v73, v83
    v_mul_f32 v72, v72, v82
    v_mul_f32 v73, v73, v82
    v_mul_f32 v84, v67, v73
    v_mul_f32 v85, v67, v72
    v_fma_f32 v72, v66, v72, -v84
    v_fma_f32 v73, -v66, v73, -v85
    v_mfma_f32_16x16x4_f32 v[48:51], v68, v74, v[48:51]
    v_mfma_f32_16x16x4_f32 v[52:55], v70, v76, v[52:55]
    v_mfma_f32_16x16x4_f32 v[56:59], v70, v78, v[56:59]
    v_mfma_f32_16x16x4_f32 v[60:63], v72, v80, v[60:63]
    v_mfma_f32_16x16x4_f32 v[48:51], v69, v75, v[48:51]
    v_mfma_f32_16x16x4_f32 v[52:55], v71, v77, v[52:55]
    v_mfma_f32_16x16x4_f32 v[56:59], v71, v79, v[56:59]
    v_mfma_f32_16x16x4_f32 v[60:63], v73, v81, v[60:63]
    v_mov_b32_dpp v64, v28 row_newbcast:14 row_mask:0xf bank_mask:0xf
    v_mov_b32_dpp v65, v29 row_newbcast:14 row_mask:0xf bank_mask:0xf
    v_mov_b32_dpp v66, v30 row_newbcast:14 row_mask:0xf bank_mask:0xf
    v_mov_b32_dpp v67, v31 row_newbcast:14 row_mask:0xf bank_mask:0xf
    v_mul_f32 v82, v64, v47
    v_mul_f32 v83, v65, v47
    v_exp_f32 v82, v82
    v_fract_f32 v83, v83
    v_cos_f32 v74, v83
    v_sin_f32 v75, v83
    v_mul_f32 v74, v74, v82
    v_mul_f32 v75, v75, v82
    v_mul_f32 v84, v75, v75
    v_add_f32 v85, v74, v74
    v_fma_f32 v76, v74, v74, -v84
    v_mul_f32 v77, v85, v75
    v_mul_f32 v84, v77, v77
    v_add_f32 v85, v76, v76
    v_fma_f32 v78, v76, v76, -v84
    v_mul_f32 v79, v85, v77
    v_mul_f32 v84, v79, v79
    v_add_f32 v85, v78, v78
    v_fma_f32 v80, v78, v78, -v84
    v_mul_f32 v81, v85, v79
    v_mul_f32 v82, v64, v44
    v_mul_f32 v83, v65, v44
    v_exp_f32 v82, v82
    v_fract_f32 v83, v83
    v_cos_f32 v68, v83
    v_sin_f32 v69, v83
    v_mul_f32 v68, v68, v82
    v_mul_f32 v69, v69, v82
    v_mul_f32 v84, v67, v69
    v_mul_f32 v85, v67, v68
    v_fma_f32 v68, v66, v68, -v84
    v_fma_f32 v69, -v66, v69, -v85
    v_mul_f32 v82, v64, v45
    v_mul_f32 v83, v65, v45
    v_exp_f32 v82, v82
    v_fract_f32 v83, v83
    v_cos_f32 v70, v83
    v_sin_f32 v71, v83
    v_mul_f32 v70, v70, v82
    v_mul_f32 v71, v71, v82
    v_mul_f32 v84, v67, v71
    v_mul_f32 v85, v67, v70
    v_fma_f32 v70, v66, v70, -v84
    v_fma_f32 v71, -v66, v71, -v85
    v_mul_f32 v82, v64, v46
    v_mul_f32 v83, v65, v46
    v_exp_f32 v82, v82
    v_fract_f32 v83, v83
    v_cos_f32 v72, v83
    v_sin_f32 v73, v83
    v_mul_f32 v72, v72, v82
    v_mul_f32 v73, v73, v82
    v_mul_f32 v84, v67, v73
    v_mul_f32 v85, v67, v72
    v_fma_f32 v72, v66, v72, -v84
    v_fma_f32 v73, -v66, v73, -v85
    v_mfma_f32_16x16x4_f32 v[48:51], v68, v74, v[48:51]
    v_mfma_f32_16x16x4_f32 v[52:55], v70, v76, v[52:55]
    v_mfma_f32_16x16x4_f32 v[56:59], v70, v78, v[56:59]
    v_mfma_f32_16x16x4_f32 v[60:63], v72, v80, v[60:63]
    v_mfma_f32_16x16x4_f32 v[48:51], v69, v75, v[48:51]
    v_mfma_f32_16x16x4_f32 v[52:55], v71, v77, v[52:55]
    v_mfma_f32_16x16x4_f32 v[56:59], v71, v79, v[56:59]
    v_mfma_f32_16x16x4_f32 v[60:63], v73, v81, v[60:63]
    v_mov_b32_dpp v64, v28 row_newbcast:15 row_mask:0xf bank_mask:0xf
    v_mov_b32_dpp v65, v29 row_newbcast:15 row_mask:0xf bank_mask:0xf
    v_mov_b32_dpp v66, v30 row_newbcast:15 row_mask:0xf bank_mask:0xf
    v_mov_b32_dpp v67, v31 row_newbcast:15 row_mask:0xf bank_mask:0xf
    v_mul_f32 v82, v64, v47
    v_mul_f32 v83, v65, v47
    v_exp_f32 v82, v82
    v_fract_f32 v83, v83
    v_cos_f32 v74, v83
    v_sin_f32 v75, v83
    v_mul_f32 v74, v74, v82
    v_mul_f32 v75, v75, v82
    v_mul_f32 v84, v75, v75
    v_add_f32 v85, v74, v74
    v_fma_f32 v76, v74, v74, -v84
    v_mul_f32 v77, v85, v75
    v_mul_f32 v84, v77, v77
    v_add_f32 v85, v76, v76
    v_fma_f32 v78, v76, v76, -v84
    v_mul_f32 v79, v85, v77
    v_mul_f32 v84, v79, v79
    v_add_f32 v85, v78, v78
    v_fma_f32 v80, v78, v78, -v84
    v_mul_f32 v81, v85, v79
    v_mul_f32 v82, v64, v44
    v_mul_f32 v83, v65, v44
    v_exp_f32 v82, v82
    v_fract_f32 v83, v83
    v_cos_f32 v68, v83
    v_sin_f32 v69, v83
    v_mul_f32 v68, v68, v82
    v_mul_f32 v69, v69, v82
    v_mul_f32 v84, v67, v69
    v_mul_f32 v85, v67, v68
    v_fma_f32 v68, v66, v68, -v84
    v_fma_f32 v69, -v66, v69, -v85
    v_mul_f32 v82, v64, v45
    v_mul_f32 v83, v65, v45
    v_exp_f32 v82, v82
    v_fract_f32 v83, v83
    v_cos_f32 v70, v83
    v_sin_f32 v71, v83
    v_mul_f32 v70, v70, v82
    v_mul_f32 v71, v71, v82
    v_mul_f32 v84, v67, v71
    v_mul_f32 v85, v67, v70
    v_fma_f32 v70, v66, v70, -v84
    v_fma_f32 v71, -v66, v71, -v85
    v_mul_f32 v82, v64, v46
    v_mul_f32 v83, v65, v46
    v_exp_f32 v82, v82
    v_fract_f32 v83, v83
    v_cos_f32 v72, v83
    v_sin_f32 v73, v83
    v_mul_f32 v72, v72, v82
    v_mul_f32 v73, v73, v82
    v_mul_f32 v84, v67, v73
    v_mul_f32 v85, v67, v72
    v_fma_f32 v72, v66, v72, -v84
    v_fma_f32 v73, -v66, v73, -v85
    v_mfma_f32_16x16x4_f32 v[48:51], v68, v74, v[48:51]
    v_mfma_f32_16x16x4_f32 v[52:55], v70, v76, v[52:55]
    v_mfma_f32_16x16x4_f32 v[56:59], v70, v78, v[56:59]
    v_mfma_f32_16x16x4_f32 v[60:63], v72, v80, v[60:63]
    v_mfma_f32_16x16x4_f32 v[48:51], v69, v75, v[48:51]
    v_mfma_f32_16x16x4_f32 v[52:55], v71, v77, v[52:55]
    v_mfma_f32_16x16x4_f32 v[56:59], v71, v79, v[56:59]
    v_mfma_f32_16x16x4_f32 v[60:63], v73, v81, v[60:63]
    v_lshlrev_b32 v5, 8, v3
    v_lshl_add_u32 v5, v2, 2, v5
    v_add_u32 v5, v5, v4
    ds_write_b32 v5, v48 offset:4608
    ds_write_b32 v5, v49 offset:4672
    ds_write_b32 v5, v50 offset:4736
    ds_write_b32 v5, v51 offset:4800
    v_cmp_gt_u32 vcc, 2, v3
    s_nop 0
    s_mov_b64 exec, vcc
    ds_write_b32 v5, v52 offset:5632
    ds_write_b32 v5, v53 offset:5696
    ds_write_b32 v5, v54 offset:5760
    ds_write_b32 v5, v55 offset:5824
    ds_write_b32 v5, v60 offset:6656
    ds_write_b32 v5, v61 offset:6720
    ds_write_b32 v5, v62 offset:6784
    ds_write_b32 v5, v63 offset:6848
    s_not_b64 exec, exec
    ds_write_b32 v5, v56 offset:5632
    ds_write_b32 v5, v57 offset:5696
    ds_write_b32 v5, v58 offset:5760
    ds_write_b32 v5, v59 offset:5824
    s_mov_b32 exec_lo, 0
    s_mov_b32 exec_hi, 3
    v_cmp_eq_u32 vcc, 0, v2
    s_nop 1
    v_cndmask_b32 v6, 0, v60, vcc
    ds_write_b32 v5, v6 offset:6656
    s_mov_b64 exec, -1
    s_waitcnt lgkmcnt(0)
    v_lshlrev_b32 v7, 1, v1
    v_sub_u32 v7, 2065, v7
    v_lshl_add_u32 v64, v1, 2, v4
    v_mov_b32 v65, 641
    s_mov_b32 s25, 17
ss_exp:
    v_subrev_u32 v66, 0, v7
    v_cvt_f32_u32 v70, v66
    v_cvt_pk_bf16_f32 v70, v70, v70
    v_and_b32 v70, 0xffff, v70
    v_subrev_u32 v70, 0x4280, v70
    v_cmp_gt_u32 vcc, 256, v66
    s_nop 1
    v_cndmask_b32 v70, v70, v66, vcc
    v_cmp_gt_u32 vcc, 2048, v66
    s_nop 1
    v_cndmask_b32 v70, v65, v70, vcc
    v_lshl_add_u32 v70, v70, 2, v4
    ds_read_b32 v74, v70 offset:4608
    v_subrev_u32 v67, 1, v7
    v_cvt_f32_u32 v71, v67
    v_cvt_pk_bf16_f32 v71, v71, v71
    v_and_b32 v71, 0xffff, v71
    v_subrev_u32 v71, 0x4280, v71
    v_cmp_gt_u32 vcc, 256, v67
    s_nop 1
    v_cndmask_b32 v71, v71, v67, vcc
    v_cmp_gt_u32 vcc, 2048, v67
    s_nop 1
    v_cndmask_b32 v71, v65, v71, vcc
    v_lshl_add_u32 v71, v71, 2, v4
    ds_read_b32 v75, v71 offset:4608
    v_subrev_u32 v68, 2, v7
    v_cvt_f32_u32 v72, v68
    v_cvt_pk_bf16_f32 v72, v72, v72
    v_and_b32 v72, 0xffff, v72
    v_subrev_u32 v72, 0x4280, v72
    v_cmp_gt_u32 vcc, 256, v68
    s_nop 1
    v_cndmask_b32 v72, v72, v68, vcc
    v_cmp_gt_u32 vcc, 2048, v68
    s_nop 1
    v_cndmask_b32 v72, v65, v72, vcc
    v_lshl_add_u32 v72, v72, 2, v4
    ds_read_b32 v76, v72 offset:4608
    s_waitcnt lgkmcnt(0)
    v_cvt_pk_bf16_f32 v78, v75, v76
    v_cvt_pk_bf16_f32 v79, v74, v75
    ds_write_b32 v64, v78 offset:7424
    ds_write_b32 v64, v79 offset:11776
    v_subrev_u32 v7, 128, v7
    v_add_u32 v64, 256, v64
    s_sub_u32 s25, s25, 1
    s_cmp_lg_u32 s25, 0
    s_cbranch_scc1 ss_exp
    s_waitcnt lgkmcnt(0)
    s_barrier
    v_and_b32 v5, 1, v2
    v_mul_u32_u24 v64, 4352, v5
    v_sub_u32 v5, v5, v2
    v_lshl_add_u32 v5, v3, 3, v5
    v_lshl_add_u32 v64, v5, 1, v64
    v_add_u32 v64, 11520, v64
    v_add_u32 v64, v64, v4
    v_lshlrev_b32 v65, 5, v2
    v_lshl_add_u32 v65, v3, 4, v65
    v_add_u32 v65, 480, v65
    v_add_u32 v65, v65, v4
    v_mov_b32 v96, 0
    v_mov_b32 v97, 0
    v_mov_b32 v98, 0
    v_mov_b32 v99, 0
    v_mov_b32 v100, 0
    v_mov_b32 v101, 0
    v_mov_b32 v102, 0
    v_mov_b32 v103, 0
    v_mov_b32 v104, 0
    v_mov_b32 v105, 0
    v_mov_b32 v106, 0
    v_mov_b32 v107, 0
    v_mov_b32 v108, 0
    v_mov_b32 v109, 0
    v_mov_b32 v110, 0
    v_mov_b32 v111, 0
    v_mov_b32 v112, 0
    v_mov_b32 v113, 0
    v_mov_b32 v114, 0
    v_mov_b32 v115, 0
    v_mov_b32 v116, 0
    v_mov_b32 v117, 0
    v_mov_b32 v118, 0
    v_mov_b32 v119, 0
    v_mov_b32 v120, 0
    v_mov_b32 v121, 0
    v_mov_b32 v122, 0
    v_mov_b32 v123, 0
    v_mov_b32 v124, 0
    v_mov_b32 v125, 0
    v_mov_b32 v126, 0
    v_mov_b32 v127, 0
    s_mov_b32 s25, 8
ss_cv0:
    ds_read2_b32 v[68:69], v64 offset0:0 offset1:1
    ds_read2_b32 v[70:71], v64 offset0:2 offset1:3
    ds_read_b128 v[128:131], v65 offset:0
    ds_read_b128 v[132:135], v65 offset:512
    ds_read_b128 v[136:139], v65 offset:1024
    ds_read_b128 v[140:143], v65 offset:1536
    ds_read_b128 v[144:147], v65 offset:2048
    ds_read_b128 v[148:151], v65 offset:2560
    ds_read_b128 v[152:155], v65 offset:3072
    ds_read_b128 v[156:159], v65 offset:3584
    v_subrev_u32 v64, 64, v64
    v_subrev_u32 v65, 64, v65
    s_waitcnt lgkmcnt(7)
    v_mfma_f32_16x16x32_bf16 v[96:99], v[68:71], v[128:131], v[96:99]
    s_waitcnt lgkmcnt(6)
    v_mfma_f32_16x16x32_bf16 v[100:103], v[68:71], v[132:135], v[100:103]
    s_waitcnt lgkmcnt(5)
    v_mfma_f32_16x16x32_bf16 v[104:107], v[68:71], v[136:139], v[104:107]
    s_waitcnt lgkmcnt(4)
    v_mfma_f32_16x16x32_bf16 v[108:111], v[68:71], v[140:143], v[108:111]
    s_waitcnt lgkmcnt(3)
    v_mfma_f32_16x16x32_bf16 v[112:115], v[68:71], v[144:147], v[112:115]
    s_waitcnt lgkmcnt(2)
    v_mfma_f32_16x16x32_bf16 v[116:119], v[68:71], v[148:151], v[116:119]
    s_waitcnt lgkmcnt(1)
    v_mfma_f32_16x16x32_bf16 v[120:123], v[68:71], v[152:155], v[120:123]
    s_waitcnt lgkmcnt(0)
    v_mfma_f32_16x16x32_bf16 v[124:127], v[68:71], v[156:159], v[124:127]
    s_sub_u32 s25, s25, 1
    s_cmp_lg_u32 s25, 0
    s_cbranch_scc1 ss_cv0
    v_add_u32 v65, 512, v65
    s_mov_b32 s25, 8
ss_cv1:
    ds_read2_b32 v[68:69], v64 offset0:0 offset1:1
    ds_read2_b32 v[70:71], v64 offset0:2 offset1:3
    ds_read_b128 v[132:135], v65 offset:0
    ds_read_b128 v[136:139], v65 offset:512
    ds_read_b128 v[140:143], v65 offset:1024
    ds_read_b128 v[144:147], v65 offset:1536
    ds_read_b128 v[148:151], v65 offset:2048
    ds_read_b128 v[152:155], v65 offset:2560
    ds_read_b128 v[156:159], v65 offset:3072
    v_subrev_u32 v64, 64, v64
    v_subrev_u32 v65, 64, v65
    s_waitcnt lgkmcnt(6)
    v_mfma_f32_16x16x32_bf16 v[100:103], v[68:71], v[132:135], v[100:103]
    s_waitcnt lgkmcnt(5)
    v_mfma_f32_16x16x32_bf16 v[104:107], v[68:71], v[136:139], v[104:107]
    s_waitcnt lgkmcnt(4)
    v_mfma_f32_16x16x32_bf16 v[108:111], v[68:71], v[140:143], v[108:111]
    s_waitcnt lgkmcnt(3)
    v_mfma_f32_16x16x32_bf16 v[112:115], v[68:71], v[144:147], v[112:115]
    s_waitcnt lgkmcnt(2)
    v_mfma_f32_16x16x32_bf16 v[116:119], v[68:71], v[148:151], v[116:119]
    s_waitcnt lgkmcnt(1)
    v_mfma_f32_16x16x32_bf16 v[120:123], v[68:71], v[152:155], v[120:123]
    s_waitcnt lgkmcnt(0)
    v_mfma_f32_16x16x32_bf16 v[124:127], v[68:71], v[156:159], v[124:127]
    s_sub_u32 s25, s25, 1
    s_cmp_lg_u32 s25, 0
    s_cbranch_scc1 ss_cv1
    v_add_u32 v65, 512, v65
    s_mov_b32 s25, 8
ss_cv2:
    ds_read2_b32 v[68:69], v64 offset0:0 offset1:1
    ds_read2_b32 v[70:71], v64 offset0:2 offset1:3
    ds_read_b128 v[136:139], v65 offset:0
    ds_read_b128 v[140:143], v65 offset:512
    ds_read_b128 v[144:147], v65 offset:1024
    ds_read_b128 v[148:151], v65 offset:1536
    ds_read_b128 v[152:155], v65 offset:2048
    ds_read_b128 v[156:159], v65 offset:2560
    v_subrev_u32 v64, 64, v64
    v_subrev_u32 v65, 64, v65
    s_waitcnt lgkmcnt(5)
    v_mfma_f32_16x16x32_bf16 v[104:107], v[68:71], v[136:139], v[104:107]
    s_waitcnt lgkmcnt(4)
    v_mfma_f32_16x16x32_bf16 v[108:111], v[68:71], v[140:143], v[108:111]
    s_waitcnt lgkmcnt(3)
    v_mfma_f32_16x16x32_bf16 v[112:115], v[68:71], v[144:147], v[112:115]
    s_waitcnt lgkmcnt(2)
    v_mfma_f32_16x16x32_bf16 v[116:119], v[68:71], v[148:151], v[116:119]
    s_waitcnt lgkmcnt(1)
    v_mfma_f32_16x16x32_bf16 v[120:123], v[68:71], v[152:155], v[120:123]
    s_waitcnt lgkmcnt(0)
    v_mfma_f32_16x16x32_bf16 v[124:127], v[68:71], v[156:159], v[124:127]
    s_sub_u32 s25, s25, 1
    s_cmp_lg_u32 s25, 0
    s_cbranch_scc1 ss_cv2
    v_add_u32 v65, 512, v65
    s_mov_b32 s25, 8
ss_cv3:
    ds_read2_b32 v[68:69], v64 offset0:0 offset1:1
    ds_read2_b32 v[70:71], v64 offset0:2 offset1:3
    ds_read_b128 v[140:143], v65 offset:0
    ds_read_b128 v[144:147], v65 offset:512
    ds_read_b128 v[148:151], v65 offset:1024
    ds_read_b128 v[152:155], v65 offset:1536
    ds_read_b128 v[156:159], v65 offset:2048
    v_subrev_u32 v64, 64, v64
    v_subrev_u32 v65, 64, v65
    s_waitcnt lgkmcnt(4)
    v_mfma_f32_16x16x32_bf16 v[108:111], v[68:71], v[140:143], v[108:111]
    s_waitcnt lgkmcnt(3)
    v_mfma_f32_16x16x32_bf16 v[112:115], v[68:71], v[144:147], v[112:115]
    s_waitcnt lgkmcnt(2)
    v_mfma_f32_16x16x32_bf16 v[116:119], v[68:71], v[148:151], v[116:119]
    s_waitcnt lgkmcnt(1)
    v_mfma_f32_16x16x32_bf16 v[120:123], v[68:71], v[152:155], v[120:123]
    s_waitcnt lgkmcnt(0)
    v_mfma_f32_16x16x32_bf16 v[124:127], v[68:71], v[156:159], v[124:127]
    s_sub_u32 s25, s25, 1
    s_cmp_lg_u32 s25, 0
    s_cbranch_scc1 ss_cv3
    v_add_u32 v65, 512, v65
    s_mov_b32 s25, 8
ss_cv4:
    ds_read2_b32 v[68:69], v64 offset0:0 offset1:1
    ds_read2_b32 v[70:71], v64 offset0:2 offset1:3
    ds_read_b128 v[144:147], v65 offset:0
    ds_read_b128 v[148:151], v65 offset:512
    ds_read_b128 v[152:155], v65 offset:1024
    ds_read_b128 v[156:159], v65 offset:1536
    v_subrev_u32 v64, 64, v64
    v_subrev_u32 v65, 64, v65
    s_waitcnt lgkmcnt(3)
    v_mfma_f32_16x16x32_bf16 v[112:115], v[68:71], v[144:147], v[112:115]
    s_waitcnt lgkmcnt(2)
    v_mfma_f32_16x16x32_bf16 v[116:119], v[68:71], v[148:151], v[116:119]
    s_waitcnt lgkmcnt(1)
    v_mfma_f32_16x16x32_bf16 v[120:123], v[68:71], v[152:155], v[120:123]
    s_waitcnt lgkmcnt(0)
    v_mfma_f32_16x16x32_bf16 v[124:127], v[68:71], v[156:159], v[124:127]
    s_sub_u32 s25, s25, 1
    s_cmp_lg_u32 s25, 0
    s_cbranch_scc1 ss_cv4
    v_add_u32 v65, 512, v65
    s_mov_b32 s25, 8
ss_cv5:
    ds_read2_b32 v[68:69], v64 offset0:0 offset1:1
    ds_read2_b32 v[70:71], v64 offset0:2 offset1:3
    ds_read_b128 v[148:151], v65 offset:0
    ds_read_b128 v[152:155], v65 offset:512
    ds_read_b128 v[156:159], v65 offset:1024
    v_subrev_u32 v64, 64, v64
    v_subrev_u32 v65, 64, v65
    s_waitcnt lgkmcnt(2)
    v_mfma_f32_16x16x32_bf16 v[116:119], v[68:71], v[148:151], v[116:119]
    s_waitcnt lgkmcnt(1)
    v_mfma_f32_16x16x32_bf16 v[120:123], v[68:71], v[152:155], v[120:123]
    s_waitcnt lgkmcnt(0)
    v_mfma_f32_16x16x32_bf16 v[124:127], v[68:71], v[156:159], v[124:127]
    s_sub_u32 s25, s25, 1
    s_cmp_lg_u32 s25, 0
    s_cbranch_scc1 ss_cv5
    v_add_u32 v65, 512, v65
    s_mov_b32 s25, 8
ss_cv6:
    ds_read2_b32 v[68:69], v64 offset0:0 offset1:1
    ds_read2_b32 v[70:71], v64 offset0:2 offset1:3
    ds_read_b128 v[152:155], v65 offset:0
    ds_read_b128 v[156:159], v65 offset:512
    v_subrev_u32 v64, 64, v64
    v_subrev_u32 v65, 64, v65
    s_waitcnt lgkmcnt(1)
    v_mfma_f32_16x16x32_bf16 v[120:123], v[68:71], v[152:155], v[120:123]
    s_waitcnt lgkmcnt(0)
    v_mfma_f32_16x16x32_bf16 v[124:127], v[68:71], v[156:159], v[124:127]
    s_sub_u32 s25, s25, 1
    s_cmp_lg_u32 s25, 0
    s_cbranch_scc1 ss_cv6
    v_add_u32 v65, 512, v65
    s_mov_b32 s25, 8
ss_cv7:
    ds_read2_b32 v[68:69], v64 offset0:0 offset1:1
    ds_read2_b32 v[70:71], v64 offset0:2 offset1:3
    ds_read_b128 v[156:159], v65 offset:0
    v_subrev_u32 v64, 64, v64
    v_subrev_u32 v65, 64, v65
    s_waitcnt lgkmcnt(0)
    v_mfma_f32_16x16x32_bf16 v[124:127], v[68:71], v[156:159], v[124:127]
    s_sub_u32 s25, s25, 1
    s_cmp_lg_u32 s25, 0
    s_cbranch_scc1 ss_cv7
    v_add_u32 v65, 512, v65
    s_nop 3
    v_lshlrev_b32 v5, 6, v2
    v_lshl_add_u32 v5, v3, 4, v5
    v_add_u32 v5, v5, v4
    ds_write_b128 v5, v[96:99] offset:7424
    ds_write_b128 v5, v[100:103] offset:8448
    ds_write_b128 v5, v[104:107] offset:9472
    ds_write_b128 v5, v[108:111] offset:10496
    ds_write_b128 v5, v[112:115] offset:11520
    ds_write_b128 v5, v[116:119] offset:12544
    ds_write_b128 v5, v[120:123] offset:13568
    ds_write_b128 v5, v[124:127] offset:14592
    s_mov_b32 s12, s74
    s_mov_b32 s13, s75
    s_mov_b32 s14, 1152
    s_mov_b32 s15, 0x20000
    s_lshl_b32 s23, s20, 1
    buffer_load_dwordx2 v[24:25], off, s[12:15], s23
    s_waitcnt vmcnt(0) lgkmcnt(0)
    s_barrier
    v_lshlrev_b32 v26, 16, v24
    v_and_b32 v27, 0xffff0000, v24
    v_lshlrev_b32 v28, 16, v25
    v_and_b32 v29, 0xffff0000, v25
    v_lshlrev_b32 v5, 5, v0
    ds_read_b128 v[64:67], v5 offset:7424
    ds_read_b128 v[68:71], v5 offset:7440
    ds_read_b128 v[72:75], v5 offset:23808
    ds_read_b128 v[76:79], v5 offset:23824
    ds_read_b128 v[80:83], v5 offset:40192
    ds_read_b128 v[84:87], v5 offset:40208
    ds_read_b128 v[88:91], v5 offset:56576
    ds_read_b128 v[92:95], v5 offset:56592
    s_waitcnt lgkmcnt(0)
    v_mul_u32_u24 v5, 18432, v0
    s_lshl_b32 s22, s20, 1
    s_add_u32 s22, s22, 1152
    v_lshlrev_b32 v6, 16, v8
    v_fmac_f32 v64, v6, v26
    v_and_b32 v6, 0xffff0000, v8
    v_fmac_f32 v72, v6, v27
    v_lshlrev_b32 v6, 16, v9
    v_fmac_f32 v80, v6, v28
    v_and_b32 v6, 0xffff0000, v9
    v_fmac_f32 v88, v6, v29
    v_cvt_pk_bf16_f32 v8, v64, v72
    v_cvt_pk_bf16_f32 v9, v80, v88
    s_add_u32 s23, s22, 0
    buffer_store_dwordx2 v[8:9], v5, s[16:19], s23 offen
    v_lshlrev_b32 v6, 16, v10
    v_fmac_f32 v65, v6, v26
    v_and_b32 v6, 0xffff0000, v10
    v_fmac_f32 v73, v6, v27
    v_lshlrev_b32 v6, 16, v11
    v_fmac_f32 v81, v6, v28
    v_and_b32 v6, 0xffff0000, v11
    v_fmac_f32 v89, v6, v29
    v_cvt_pk_bf16_f32 v10, v65, v73
    v_cvt_pk_bf16_f32 v11, v81, v89
    s_add_u32 s23, s22, 2304
    buffer_store_dwordx2 v[10:11], v5, s[16:19], s23 offen
    v_lshlrev_b32 v6, 16, v12
    v_fmac_f32 v66, v6, v26
    v_and_b32 v6, 0xffff0000, v12
    v_fmac_f32 v74, v6, v27
    v_lshlrev_b32 v6, 16, v13
    v_fmac_f32 v82, v6, v28
    v_and_b32 v6, 0xffff0000, v13
    v_fmac_f32 v90, v6, v29
    v_cvt_pk_bf16_f32 v12, v66, v74
    v_cvt_pk_bf16_f32 v13, v82, v90
    s_add_u32 s23, s22, 4608
    buffer_store_dwordx2 v[12:13], v5, s[16:19], s23 offen
    v_lshlrev_b32 v6, 16, v14
    v_fmac_f32 v67, v6, v26
    v_and_b32 v6, 0xffff0000, v14
    v_fmac_f32 v75, v6, v27
    v_lshlrev_b32 v6, 16, v15
    v_fmac_f32 v83, v6, v28
    v_and_b32 v6, 0xffff0000, v15
    v_fmac_f32 v91, v6, v29
    v_cvt_pk_bf16_f32 v14, v67, v75
    v_cvt_pk_bf16_f32 v15, v83, v91
    s_add_u32 s23, s22, 6912
    buffer_store_dwordx2 v[14:15], v5, s[16:19], s23 offen
    v_lshlrev_b32 v6, 16, v16
    v_fmac_f32 v68, v6, v26
    v_and_b32 v6, 0xffff0000, v16
    v_fmac_f32 v76, v6, v27
    v_lshlrev_b32 v6, 16, v17
    v_fmac_f32 v84, v6, v28
    v_and_b32 v6, 0xffff0000, v17
    v_fmac_f32 v92, v6, v29
    v_cvt_pk_bf16_f32 v16, v68, v76
    v_cvt_pk_bf16_f32 v17, v84, v92
    s_add_u32 s23, s22, 9216
    buffer_store_dwordx2 v[16:17], v5, s[16:19], s23 offen
    v_lshlrev_b32 v6, 16, v18
    v_fmac_f32 v69, v6, v26
    v_and_b32 v6, 0xffff0000, v18
    v_fmac_f32 v77, v6, v27
    v_lshlrev_b32 v6, 16, v19
    v_fmac_f32 v85, v6, v28
    v_and_b32 v6, 0xffff0000, v19
    v_fmac_f32 v93, v6, v29
    v_cvt_pk_bf16_f32 v18, v69, v77
    v_cvt_pk_bf16_f32 v19, v85, v93
    s_add_u32 s23, s22, 11520
    buffer_store_dwordx2 v[18:19], v5, s[16:19], s23 offen
    v_lshlrev_b32 v6, 16, v20
    v_fmac_f32 v70, v6, v26
    v_and_b32 v6, 0xffff0000, v20
    v_fmac_f32 v78, v6, v27
    v_lshlrev_b32 v6, 16, v21
    v_fmac_f32 v86, v6, v28
    v_and_b32 v6, 0xffff0000, v21
    v_fmac_f32 v94, v6, v29
    v_cvt_pk_bf16_f32 v20, v70, v78
    v_cvt_pk_bf16_f32 v21, v86, v94
    s_add_u32 s23, s22, 13824
    buffer_store_dwordx2 v[20:21], v5, s[16:19], s23 offen
    v_lshlrev_b32 v6, 16, v22
    v_fmac_f32 v71, v6, v26
    v_and_b32 v6, 0xffff0000, v22
    v_fmac_f32 v79, v6, v27
    v_lshlrev_b32 v6, 16, v23
    v_fmac_f32 v87, v6, v28
    v_and_b32 v6, 0xffff0000, v23
    v_fmac_f32 v95, v6, v29
    v_cvt_pk_bf16_f32 v22, v71, v79
    v_cvt_pk_bf16_f32 v23, v87, v95
    s_add_u32 s23, s22, 16128
    buffer_store_dwordx2 v[22:23], v5, s[16:19], s23 offen
    s_branch L_ssm_next
L_phase2:
    v_and_b32 v1, 63, v0
    v_min_u32 v1, 6, v1
    v_lshlrev_b32 v2, 2, v1
    buffer_load_dword v3, v2, s[96:99], 0 offen offset:32 sc1
    v_mov_b32 v4, 30
    v_cmp_eq_u32 vcc, 6, v1
    s_nop 1
    v_cndmask_b32 v4, v4, 12, vcc
    s_waitcnt vmcnt(0)
    v_cmp_lt_u32 vcc, v3, v4
    s_nop 0
    s_ff1_i32_b64 s40, vcc
    v_mov_b32 v250, s40
    v_mov_b32 v251, 163832
    s_cmp_lg_u32 s32, 0
    s_cbranch_scc1 L_sw_nw
    ds_write_b32 v251, v250
    s_waitcnt lgkmcnt(0)
L_sw_nw:
    s_barrier
    ds_read_b32 v252, v251
    s_waitcnt lgkmcnt(0)
    v_readfirstlane_b32 s33, v252
    s_barrier
    s_nop 1
    s_cmp_lt_u32 s33, 7
    s_cbranch_scc1 L_pool
    s_mov_b32 s88, 4194304
gn8:
    s_cmp_lg_u32 s95, 0
    s_cbranch_scc1 gn8x
    buffer_load_dword v250, off, s[96:99], 0 offset:144 sc1
    s_sub_u32 s88, s88, 1
    s_cbranch_scc1 gn8x
    s_waitcnt vmcnt(0)
    v_readfirstlane_b32 s95, v250
    s_nop 1
    s_branch gn8
gn8x:
    s_mov_b32 s40, 524288
mc2_w:
    buffer_load_dword v250, off, s[96:99], 0 offset:140 sc1
    s_waitcnt vmcnt(0)
    v_readfirstlane_b32 s41, v250
    s_nop 0
    s_cmp_lg_u32 s41, 0
    s_cbranch_scc1 mc2_known
    s_sub_u32 s40, s40, 1
    s_cbranch_scc1 mc2_force
    s_sleep 2
    s_branch mc2_w
mc2_force:
    v_mov_b32 v250, 2
    v_mov_b32 v251, 0
    s_mov_b64 exec, 1
    buffer_atomic_cmpswap v[250:251], off, s[96:99], 0 offset:140
    s_mov_b64 exec, -1
    s_waitcnt vmcnt(0)
    s_mov_b32 s40, 524288
    s_branch mc2_w
mc2_known:
    s_cmp_eq_u32 s41, 1
    s_cbranch_scc1 L_phase2b
    s_mov_b32 s37, 208
    v_mov_b32 v250, 1
    v_mov_b32 v251, 163832
    v_cmp_eq_u32 vcc, 0, v0
    s_nop 0
    s_and_saveexec_b64 s[38:39], vcc
    s_cbranch_execz tk9
    buffer_atomic_add v250, off, s[96:99], s37 sc0
    s_waitcnt vmcnt(0)
    ds_write_b32 v251, v250
    s_waitcnt lgkmcnt(0)
tk9:
    s_mov_b64 exec, -1
    s_barrier
    ds_read_b32 v252, v251
    s_waitcnt lgkmcnt(0)
    v_readfirstlane_b32 s12, v252
    s_barrier
    s_nop 3
    s_cmp_lt_u32 s12, 32
    s_cbranch_scc1 L_chain_safe
L_phase2b:
    s_mov_b32 s8, s76
    s_mov_b32 s9, s77
    s_mov_b32 s10, 4718592
    s_mov_b32 s11, 0x20000
    s_mov_b32 s37, 12
    v_mov_b32 v250, 1
    v_mov_b32 v251, 163832
    v_cmp_eq_u32 vcc, 0, v0
    s_nop 0
    s_and_saveexec_b64 s[38:39], vcc
    s_cbranch_execz tk10
    buffer_atomic_add v250, off, s[96:99], s37 sc0
    s_waitcnt vmcnt(0)
    ds_write_b32 v251, v250
    s_waitcnt lgkmcnt(0)
tk10:
    s_mov_b64 exec, -1
    s_barrier
    ds_read_b32 v252, v251
    s_waitcnt lgkmcnt(0)
    v_readfirstlane_b32 s34, v252
    s_barrier
    s_nop 3
    s_cmp_ge_u32 s34, 156
    s_cbranch_scc1 L_done
    s_cmp_ge_u32 s34, 48
    s_cbranch_scc1 L_op_start
L_att_next:
    s_lshr_b32 s16, s34, 3
    s_and_b32 s17, s34, 7
    s_lshl_b32 s17, s17, 2
    s_add_u32 s17, s17, s32
    s_lshr_b32 s36, s17, 1
    s_lshl_b32 s36, s36, 8
    s_add_u32 s36, s36, 125829120
    s_mul_i32 s37, s16, 43
    s_lshr_b32 s37, s37, 8
    s_mul_i32 s41, s37, 6
    s_sub_u32 s41, s16, s41
    v_and_b32 v1, 63, v0
    v_mul_u32_u24 v2, 6, v1
    v_add_u32 v2, s41, v2
    v_mov_b32 v4, s37
    s_and_b32 s41, s16, 7
    s_add_u32 s41, s41, 12
    s_lshr_b32 s37, s16, 3
    v_mov_b32 v5, s41
    v_mov_b32 v6, s37
    v_cmp_lt_u32 vcc, 1, v1
    s_nop 1
    v_cndmask_b32 v2, v2, v5, vcc
    v_cndmask_b32 v4, v4, v6, vcc
    v_lshlrev_b32 v2, 2, v2
    v_add3_u32 v4, v4, s95, 1
    s_mov_b32 s40, 4194304
L_aw1:
    buffer_load_dword v3, v2, s[4:7], s36 offen sc1
    s_sub_u32 s40, s40, 1
    s_cbranch_scc1 L_aw1_go
    s_waitcnt vmcnt(0)
    v_subrev_u32 v3, v4, v3
    v_cmp_lt_u32 vcc, 64, v3
    s_cbranch_vccz L_aw1_go
    s_sleep 4
    s_branch L_aw1
L_aw1_go:
    v_and_b32 v5, 63, v0
    v_lshlrev_b32 v1, 4, v5
    v_or_b32 v3, 128, v1
    v_lshrrev_b32 v4, 4, v5
    v_bfe_u32 v6, v5, 2, 2
    v_sub_u32 v4, v6, v4
    v_lshlrev_b32 v4, 3, v4
    v_and_b32 v6, 3, v5
    v_add_u32 v4, v4, v6
    v_mov_b32 v6, 0xf149f2ca
    s_mov_b32 s22, 0x3e0293ee
    s_lshl_b32 s18, s16, 5
    s_add_u32 s18, s18, s17
    s_lshl_b32 s19, s18, 13
    s_add_u32 s20, s19, 33554432
    buffer_load_dwordx4 v[8:11], v1, s[4:7], s20 offen offset:0 sc1
    s_add_u32 s20, s19, 33554432
    buffer_load_dwordx4 v[12:15], v1, s[4:7], s20 offen offset:1024 sc1
    s_add_u32 s20, s19, 33554432
    buffer_load_dwordx4 v[16:19], v1, s[4:7], s20 offen offset:2048 sc1
    s_add_u32 s20, s19, 33554432
    buffer_load_dwordx4 v[20:23], v1, s[4:7], s20 offen offset:3072 sc1
    s_add_u32 s20, s19, 33558528
    buffer_load_dwordx4 v[24:27], v1, s[4:7], s20 offen offset:0 sc1
    s_add_u32 s20, s19, 33558528
    buffer_load_dwordx4 v[28:31], v1, s[4:7], s20 offen offset:1024 sc1
    s_add_u32 s20, s19, 33558528
    buffer_load_dwordx4 v[32:35], v1, s[4:7], s20 offen offset:2048 sc1
    s_add_u32 s20, s19, 33558528
    buffer_load_dwordx4 v[36:39], v1, s[4:7], s20 offen offset:3072 sc1
    s_lshl_b32 s21, s18, 14
    s_add_u32 s20, s21, 0
    buffer_load_dwordx4 v[40:43], v1, s[4:7], s20 offen offset:0 sc1
    s_add_u32 s20, s21, 4096
    buffer_load_dwordx4 v[44:47], v1, s[4:7], s20 offen offset:0 sc1
    s_add_u32 s20, s21, 8192
    buffer_load_dwordx4 v[48:51], v1, s[4:7], s20 offen offset:0 sc1
    s_add_u32 s20, s21, 12288
    buffer_load_dwordx4 v[52:55], v1, s[4:7], s20 offen offset:0 sc1
    s_add_u32 s20, s21, 0
    buffer_load_dwordx4 v[56:59], v1, s[4:7], s20 offen offset:1024 sc1
    s_add_u32 s20, s21, 4096
    buffer_load_dwordx4 v[60:63], v1, s[4:7], s20 offen offset:1024 sc1
    s_add_u32 s20, s21, 8192
    buffer_load_dwordx4 v[64:67], v1, s[4:7], s20 offen offset:1024 sc1
    s_add_u32 s20, s21, 12288
    buffer_load_dwordx4 v[68:71], v1, s[4:7], s20 offen offset:1024 sc1
    s_add_u32 s20, s21, 0
    buffer_load_dwordx4 v[88:91], v1, s[4:7], s20 offen offset:2048 sc1
    s_add_u32 s20, s21, 4096
    buffer_load_dwordx4 v[92:95], v1, s[4:7], s20 offen offset:2048 sc1
    s_add_u32 s20, s21, 8192
    buffer_load_dwordx4 v[96:99], v1, s[4:7], s20 offen offset:2048 sc1
    s_add_u32 s20, s21, 12288
    buffer_load_dwordx4 v[100:103], v1, s[4:7], s20 offen offset:2048 sc1
    s_add_u32 s20, s21, 0
    buffer_load_dwordx4 v[104:107], v1, s[4:7], s20 offen offset:3072 sc1
    s_add_u32 s20, s21, 4096
    buffer_load_dwordx4 v[108:111], v1, s[4:7], s20 offen offset:3072 sc1
    s_add_u32 s20, s21, 8192
    buffer_load_dwordx4 v[112:115], v1, s[4:7], s20 offen offset:3072 sc1
    s_add_u32 s20, s21, 12288
    buffer_load_dwordx4 v[116:119], v1, s[4:7], s20 offen offset:3072 sc1
    v_mov_b32 v172, 0x3f803f80
    v_mov_b32 v173, 0x3f803f80
    v_mov_b32 v174, 0x3f803f80
    v_mov_b32 v175, 0x3f803f80
    v_mov_b32 v176, 0x3f003f00
    v_mov_b32 v177, 0x3f003f00
    s_waitcnt vmcnt(8)
    v_mfma_f32_16x16x32_bf16 v[136:139], v[40:43], v[8:11], 0
    v_mfma_f32_16x16x32_bf16 v[140:143], v[56:59], v[8:11], 0
    v_mfma_f32_16x16x32_bf16 v[148:151], v[40:43], v[24:27], 0
    v_mfma_f32_16x16x32_bf16 v[152:155], v[56:59], v[24:27], 0
    v_mfma_f32_16x16x32_bf16 v[136:139], v[44:47], v[12:15], v[136:139]
    v_mfma_f32_16x16x32_bf16 v[140:143], v[60:63], v[12:15], v[140:143]
    v_mfma_f32_16x16x32_bf16 v[148:151], v[44:47], v[28:31], v[148:151]
    v_mfma_f32_16x16x32_bf16 v[152:155], v[60:63], v[28:31], v[152:155]
    v_mfma_f32_16x16x32_bf16 v[136:139], v[48:51], v[16:19], v[136:139]
    v_mfma_f32_16x16x32_bf16 v[140:143], v[64:67], v[16:19], v[140:143]
    v_mfma_f32_16x16x32_bf16 v[148:151], v[48:51], v[32:35], v[148:151]
    v_mfma_f32_16x16x32_bf16 v[152:155], v[64:67], v[32:35], v[152:155]
    v_mfma_f32_16x16x32_bf16 v[136:139], v[52:55], v[20:23], v[136:139]
    v_mfma_f32_16x16x32_bf16 v[140:143], v[68:71], v[20:23], v[140:143]
    v_mfma_f32_16x16x32_bf16 v[148:151], v[52:55], v[36:39], v[148:151]
    v_mfma_f32_16x16x32_bf16 v[152:155], v[68:71], v[36:39], v[152:155]
    v_cmp_le_i32 vcc, 0, v4
    s_nop 1
    v_cndmask_b32 v136, v6, v136, vcc
    v_cmp_le_i32 vcc, 1, v4
    s_nop 1
    v_cndmask_b32 v137, v6, v137, vcc
    v_cmp_le_i32 vcc, 2, v4
    s_nop 1
    v_cndmask_b32 v138, v6, v138, vcc
    v_cmp_le_i32 vcc, 3, v4
    s_nop 1
    v_cndmask_b32 v139, v6, v139, vcc
    v_cmp_le_i32 vcc, 4, v4
    s_nop 1
    v_cndmask_b32 v140, v6, v140, vcc
    v_cmp_le_i32 vcc, 5, v4
    s_nop 1
    v_cndmask_b32 v141, v6, v141, vcc
    v_cmp_le_i32 vcc, 6, v4
    s_nop 1
    v_cndmask_b32 v142, v6, v142, vcc
    v_cmp_le_i32 vcc, 7, v4
    s_nop 1
    v_cndmask_b32 v143, v6, v143, vcc
    v_cmp_le_i32 vcc, -4, v4
    s_nop 1
    v_cndmask_b32 v148, v6, v148, vcc
    v_cmp_le_i32 vcc, -3, v4
    s_nop 1
    v_cndmask_b32 v149, v6, v149, vcc
    v_cmp_le_i32 vcc, -2, v4
    s_nop 1
    v_cndmask_b32 v150, v6, v150, vcc
    v_cmp_le_i32 vcc, -1, v4
    s_nop 1
    v_cndmask_b32 v151, v6, v151, vcc
    v_cmp_le_i32 vcc, 0, v4
    s_nop 1
    v_cndmask_b32 v152, v6, v152, vcc
    v_cmp_le_i32 vcc, 1, v4
    s_nop 1
    v_cndmask_b32 v153, v6, v153, vcc
    v_cmp_le_i32 vcc, 2, v4
    s_nop 1
    v_cndmask_b32 v154, v6, v154, vcc
    v_cmp_le_i32 vcc, 3, v4
    s_nop 1
    v_cndmask_b32 v155, v6, v155, vcc
    s_nop 1
    s_mov_b32 s88, 65536
cw11:
    buffer_load_dword v199, off, s[4:7], s36 offset:128 sc1
    s_waitcnt vmcnt(0)
    v_readfirstlane_b32 s42, v199
    s_nop 0
    s_sub_u32 s42, s42, s95
    s_cmp_gt_u32 s42, 64
    s_cselect_b32 s42, 0, s42
    s_add_u32 s42, s42, 2
    s_cmp_ge_u32 s42, s16
    s_cbranch_scc1 cw11x
    s_sub_u32 s88, s88, 1
    s_cbranch_scc1 cw11x
    s_sub_u32 s42, s16, s42
    s_min_u32 s42, s42, 6
cw11s:
    s_sleep 24
    s_sub_u32 s42, s42, 1
    s_cmp_lg_u32 s42, 0
    s_cbranch_scc1 cw11s
    s_branch cw11
cw11x:
    s_and_b32 s37, s16, 1
    s_lshl_b32 s37, s37, 2
    s_add_u32 s37, s37, s36
    s_add_u32 s37, s37, 128
    s_add_u32 s41, s16, s95
    s_add_u32 s41, s41, 1
    s_lshl_b32 s42, s17, 7
    s_add_u32 s42, s42, 125845504
    s_cmp_ge_u32 s16, 62
    s_cselect_b32 s37, s42, s37
    s_cselect_b32 s42, 12, 8
    v_lshlrev_b32 v198, 2, v0
    v_and_b32 v198, s42, v198
    s_mov_b32 s40, 4194304
L_aw2:
    buffer_load_dword v199, v198, s[4:7], s37 offen sc1
    s_sub_u32 s40, s40, 1
    s_cbranch_scc1 L_aw2_go
    s_waitcnt vmcnt(0)
    v_subrev_u32 v199, s41, v199
    v_cmp_lt_u32 vcc, 64, v199
    s_cbranch_vccz L_aw2_go
    s_sleep 3
    s_branch L_aw2
L_aw2_go:
    s_lshl_b32 s20, s18, 12
    s_add_u32 s20, s20, 71303168
    buffer_load_dwordx4 v[72:75], v3, s[4:7], s20 offen offset:0 sc1
    buffer_load_dwordx4 v[76:79], v3, s[4:7], s20 offen offset:1024 sc1
    buffer_load_dwordx4 v[80:83], v3, s[4:7], s20 offen offset:2048 sc1
    buffer_load_dwordx4 v[84:87], v3, s[4:7], s20 offen offset:3072 sc1
    s_lshl_b32 s20, s18, 12
    s_add_u32 s20, s20, 80740352
    buffer_load_dwordx4 v[120:123], v1, s[4:7], s20 offen offset:0 sc1
    buffer_load_dwordx4 v[124:127], v1, s[4:7], s20 offen offset:1024 sc1
    buffer_load_dwordx4 v[128:131], v1, s[4:7], s20 offen offset:2048 sc1
    buffer_load_dwordx4 v[132:135], v1, s[4:7], s20 offen offset:3072 sc1
    s_waitcnt vmcnt(4)
    v_mfma_f32_16x16x32_bf16 v[144:147], v[72:75], v[8:11], 0
    v_mfma_f32_16x16x32_bf16 v[156:159], v[72:75], v[24:27], 0
    v_mfma_f32_16x16x32_bf16 v[144:147], v[76:79], v[12:15], v[144:147]
    v_mfma_f32_16x16x32_bf16 v[156:159], v[76:79], v[28:31], v[156:159]
    v_mfma_f32_16x16x32_bf16 v[144:147], v[80:83], v[16:19], v[144:147]
    v_mfma_f32_16x16x32_bf16 v[156:159], v[80:83], v[32:35], v[156:159]
    v_mfma_f32_16x16x32_bf16 v[144:147], v[84:87], v[20:23], v[144:147]
    v_mfma_f32_16x16x32_bf16 v[156:159], v[84:87], v[36:39], v[156:159]
    v_max3_f32 v196, v136, v137, v138
    v_max3_f32 v197, v139, v140, v141
    v_max3_f32 v196, v196, v142, v143
    s_nop 0
    v_max3_f32 v197, v197, v144, v145
    v_max3_f32 v196, v196, v146, v147
    v_max_f32 v196, v196, v197
    v_mov_b32 v197, v196
    s_nop 1
    v_permlane32_swap_b32 v196, v197
    v_max_f32 v196, v196, v197
    v_mov_b32 v197, v196
    s_nop 1
    v_permlane16_swap_b32 v196, v197
    v_max_f32 v196, v196, v197
    v_mul_f32 v196, s22, v196
    v_sub_f32 v196, 0, v196
    v_fma_f32 v136, v136, s22, v196
    v_fma_f32 v137, v137, s22, v196
    v_fma_f32 v138, v138, s22, v196
    v_fma_f32 v139, v139, s22, v196
    v_fma_f32 v140, v140, s22, v196
    v_fma_f32 v141, v141, s22, v196
    v_fma_f32 v142, v142, s22, v196
    v_fma_f32 v143, v143, s22, v196
    v_fma_f32 v144, v144, s22, v196
    v_fma_f32 v145, v145, s22, v196
    v_fma_f32 v146, v146, s22, v196
    v_fma_f32 v147, v147, s22, v196
    v_exp_f32 v136, v136
    v_exp_f32 v137, v137
    v_exp_f32 v138, v138
    v_exp_f32 v139, v139
    v_exp_f32 v140, v140
    v_exp_f32 v141, v141
    v_exp_f32 v142, v142
    v_exp_f32 v143, v143
    v_exp_f32 v144, v144
    v_exp_f32 v145, v145
    v_exp_f32 v146, v146
    v_exp_f32 v147, v147
    v_cvt_pk_bf16_f32 v160, v136, v137
    v_cvt_pk_bf16_f32 v161, v138, v139
    v_cvt_pk_bf16_f32 v162, v140, v141
    v_cvt_pk_bf16_f32 v163, v142, v143
    v_cvt_pk_bf16_f32 v164, v144, v145
    v_cvt_pk_bf16_f32 v165, v146, v147
    v_max3_f32 v196, v148, v149, v150
    v_max3_f32 v197, v151, v152, v153
    v_max3_f32 v196, v196, v154, v155
    v_max3_f32 v197, v197, v156, v157
    v_max3_f32 v196, v196, v158, v159
    v_max_f32 v196, v196, v197
    v_mov_b32 v197, v196
    s_nop 1
    v_permlane32_swap_b32 v196, v197
    v_max_f32 v196, v196, v197
    v_mov_b32 v197, v196
    s_nop 1
    v_permlane16_swap_b32 v196, v197
    v_max_f32 v196, v196, v197
    v_mul_f32 v196, s22, v196
    v_sub_f32 v196, 0, v196
    v_fma_f32 v148, v148, s22, v196
    v_fma_f32 v149, v149, s22, v196
    v_fma_f32 v150, v150, s22, v196
    v_fma_f32 v151, v151, s22, v196
    v_fma_f32 v152, v152, s22, v196
    v_fma_f32 v153, v153, s22, v196
    v_fma_f32 v154, v154, s22, v196
    v_fma_f32 v155, v155, s22, v196
    v_fma_f32 v156, v156, s22, v196
    v_fma_f32 v157, v157, s22, v196
    v_fma_f32 v158, v158, s22, v196
    v_fma_f32 v159, v159, s22, v196
    v_exp_f32 v148, v148
    v_exp_f32 v149, v149
    v_exp_f32 v150, v150
    v_exp_f32 v151, v151
    v_exp_f32 v152, v152
    v_exp_f32 v153, v153
    v_exp_f32 v154, v154
    v_exp_f32 v155, v155
    v_exp_f32 v156, v156
    v_exp_f32 v157, v157
    v_exp_f32 v158, v158
    v_exp_f32 v159, v159
    v_cvt_pk_bf16_f32 v166, v148, v149
    v_cvt_pk_bf16_f32 v167, v150, v151
    v_cvt_pk_bf16_f32 v168, v152, v153
    v_cvt_pk_bf16_f32 v169, v154, v155
    v_cvt_pk_bf16_f32 v170, v156, v157
    v_cvt_pk_bf16_f32 v171, v158, v159
    v_mfma_f32_16x16x32_bf16 v[180:183], v[172:175], v[160:163], 0
    v_mfma_f32_16x16x32_bf16 v[184:187], v[172:175], v[166:169], 0
    v_mfma_f32_16x16x16_bf16 v[180:183], v[176:177], v[164:165], v[180:183]
    v_mfma_f32_16x16x16_bf16 v[184:187], v[176:177], v[170:171], v[184:187]
    s_nop 3
    v_rcp_f32 v180, v180
    s_nop 2
    v_rcp_f32 v184, v184
    s_waitcnt vmcnt(0)
    s_lshl_b32 s18, s16, 18
    s_lshl_b32 s19, s17, 12
    s_add_u32 s18, s18, s19
    s_add_u32 s18, s18, 50331648
    s_add_u32 s19, s18, 131072
    v_mfma_f32_16x16x32_bf16 v[8:11], v[88:91], v[160:163], 0
    v_mfma_f32_16x16x32_bf16 v[12:15], v[104:107], v[160:163], 0
    v_mfma_f32_16x16x32_bf16 v[16:19], v[88:91], v[166:169], 0
    v_mfma_f32_16x16x32_bf16 v[20:23], v[104:107], v[166:169], 0
    v_mfma_f32_16x16x32_bf16 v[24:27], v[92:95], v[160:163], 0
    v_mfma_f32_16x16x32_bf16 v[28:31], v[108:111], v[160:163], 0
    v_mfma_f32_16x16x32_bf16 v[32:35], v[92:95], v[166:169], 0
    v_mfma_f32_16x16x32_bf16 v[36:39], v[108:111], v[166:169], 0
    v_mfma_f32_16x16x32_bf16 v[40:43], v[96:99], v[160:163], 0
    v_mfma_f32_16x16x32_bf16 v[44:47], v[112:115], v[160:163], 0
    v_mfma_f32_16x16x32_bf16 v[48:51], v[96:99], v[166:169], 0
    v_mfma_f32_16x16x32_bf16 v[52:55], v[112:115], v[166:169], 0
    v_mfma_f32_16x16x32_bf16 v[56:59], v[100:103], v[160:163], 0
    v_mfma_f32_16x16x32_bf16 v[60:63], v[116:119], v[160:163], 0
    v_mfma_f32_16x16x32_bf16 v[64:67], v[100:103], v[166:169], 0
    v_mfma_f32_16x16x32_bf16 v[68:71], v[116:119], v[166:169], 0
    v_mfma_f32_16x16x16_bf16 v[8:11], v[120:121], v[164:165], v[8:11]
    v_mfma_f32_16x16x16_bf16 v[12:15], v[122:123], v[164:165], v[12:15]
    v_mfma_f32_16x16x16_bf16 v[16:19], v[120:121], v[170:171], v[16:19]
    v_mfma_f32_16x16x16_bf16 v[20:23], v[122:123], v[170:171], v[20:23]
    v_mfma_f32_16x16x16_bf16 v[24:27], v[124:125], v[164:165], v[24:27]
    v_mfma_f32_16x16x16_bf16 v[28:31], v[126:127], v[164:165], v[28:31]
    v_mfma_f32_16x16x16_bf16 v[32:35], v[124:125], v[170:171], v[32:35]
    v_mfma_f32_16x16x16_bf16 v[36:39], v[126:127], v[170:171], v[36:39]
    v_mfma_f32_16x16x16_bf16 v[40:43], v[128:129], v[164:165], v[40:43]
    v_mfma_f32_16x16x16_bf16 v[44:47], v[130:131], v[164:165], v[44:47]
    v_mfma_f32_16x16x16_bf16 v[48:51], v[128:129], v[170:171], v[48:51]
    v_mfma_f32_16x16x16_bf16 v[52:55], v[130:131], v[170:171], v[52:55]
    v_mfma_f32_16x16x16_bf16 v[56:59], v[132:133], v[164:165], v[56:59]
    v_mfma_f32_16x16x16_bf16 v[60:63], v[134:135], v[164:165], v[60:63]
    v_mfma_f32_16x16x16_bf16 v[64:67], v[132:133], v[170:171], v[64:67]
    v_mfma_f32_16x16x16_bf16 v[68:71], v[134:135], v[170:171], v[68:71]
    v_mul_f32 v8, v8, v180
    v_mul_f32 v12, v12, v180
    v_mul_f32 v9, v9, v180
    v_mul_f32 v13, v13, v180
    v_mul_f32 v10, v10, v180
    v_mul_f32 v14, v14, v180
    v_mul_f32 v11, v11, v180
    v_mul_f32 v15, v15, v180
    v_cvt_pk_bf16_f32 v8, v8, v9
    v_cvt_pk_bf16_f32 v9, v10, v11
    v_cvt_pk_bf16_f32 v10, v12, v13
    v_cvt_pk_bf16_f32 v11, v14, v15
    buffer_store_dwordx4 v[8:11], v1, s[4:7], s18 offen offset:0 sc1
    v_mul_f32 v16, v16, v184
    v_mul_f32 v20, v20, v184
    v_mul_f32 v17, v17, v184
    v_mul_f32 v21, v21, v184
    v_mul_f32 v18, v18, v184
    v_mul_f32 v22, v22, v184
    v_mul_f32 v19, v19, v184
    v_mul_f32 v23, v23, v184
    v_cvt_pk_bf16_f32 v16, v16, v17
    v_cvt_pk_bf16_f32 v17, v18, v19
    v_cvt_pk_bf16_f32 v18, v20, v21
    v_cvt_pk_bf16_f32 v19, v22, v23
    buffer_store_dwordx4 v[16:19], v1, s[4:7], s19 offen offset:0 sc1
    v_mul_f32 v24, v24, v180
    v_mul_f32 v28, v28, v180
    v_mul_f32 v25, v25, v180
    v_mul_f32 v29, v29, v180
    v_mul_f32 v26, v26, v180
    v_mul_f32 v30, v30, v180
    v_mul_f32 v27, v27, v180
    v_mul_f32 v31, v31, v180
    v_cvt_pk_bf16_f32 v24, v24, v25
    v_cvt_pk_bf16_f32 v25, v26, v27
    v_cvt_pk_bf16_f32 v26, v28, v29
    v_cvt_pk_bf16_f32 v27, v30, v31
    buffer_store_dwordx4 v[24:27], v1, s[4:7], s18 offen offset:1024 sc1
    v_mul_f32 v32, v32, v184
    v_mul_f32 v36, v36, v184
    v_mul_f32 v33, v33, v184
    v_mul_f32 v37, v37, v184
    v_mul_f32 v34, v34, v184
    v_mul_f32 v38, v38, v184
    v_mul_f32 v35, v35, v184
    v_mul_f32 v39, v39, v184
    v_cvt_pk_bf16_f32 v32, v32, v33
    v_cvt_pk_bf16_f32 v33, v34, v35
    v_cvt_pk_bf16_f32 v34, v36, v37
    v_cvt_pk_bf16_f32 v35, v38, v39
    buffer_store_dwordx4 v[32:35], v1, s[4:7], s19 offen offset:1024 sc1
    v_mul_f32 v40, v40, v180
    v_mul_f32 v44, v44, v180
    v_mul_f32 v41, v41, v180
    v_mul_f32 v45, v45, v180
    v_mul_f32 v42, v42, v180
    v_mul_f32 v46, v46, v180
    v_mul_f32 v43, v43, v180
    v_mul_f32 v47, v47, v180
    v_cvt_pk_bf16_f32 v40, v40, v41
    v_cvt_pk_bf16_f32 v41, v42, v43
    v_cvt_pk_bf16_f32 v42, v44, v45
    v_cvt_pk_bf16_f32 v43, v46, v47
    buffer_store_dwordx4 v[40:43], v1, s[4:7], s18 offen offset:2048 sc1
    v_mul_f32 v48, v48, v184
    v_mul_f32 v52, v52, v184
    v_mul_f32 v49, v49, v184
    v_mul_f32 v53, v53, v184
    v_mul_f32 v50, v50, v184
    v_mul_f32 v54, v54, v184
    v_mul_f32 v51, v51, v184
    v_mul_f32 v55, v55, v184
    v_cvt_pk_bf16_f32 v48, v48, v49
    v_cvt_pk_bf16_f32 v49, v50, v51
    v_cvt_pk_bf16_f32 v50, v52, v53
    v_cvt_pk_bf16_f32 v51, v54, v55
    buffer_store_dwordx4 v[48:51], v1, s[4:7], s19 offen offset:2048 sc1
    v_mul_f32 v56, v56, v180
    v_mul_f32 v60, v60, v180
    v_mul_f32 v57, v57, v180
    v_mul_f32 v61, v61, v180
    v_mul_f32 v58, v58, v180
    v_mul_f32 v62, v62, v180
    v_mul_f32 v59, v59, v180
    v_mul_f32 v63, v63, v180
    v_cvt_pk_bf16_f32 v56, v56, v57
    v_cvt_pk_bf16_f32 v57, v58, v59
    v_cvt_pk_bf16_f32 v58, v60, v61
    v_cvt_pk_bf16_f32 v59, v62, v63
    buffer_store_dwordx4 v[56:59], v1, s[4:7], s18 offen offset:3072 sc1
    v_mul_f32 v64, v64, v184
    v_mul_f32 v68, v68, v184
    v_mul_f32 v65, v65, v184
    v_mul_f32 v69, v69, v184
    v_mul_f32 v66, v66, v184
    v_mul_f32 v70, v70, v184
    v_mul_f32 v67, v67, v184
    v_mul_f32 v71, v71, v184
    v_cvt_pk_bf16_f32 v64, v64, v65
    v_cvt_pk_bf16_f32 v65, v66, v67
    v_cvt_pk_bf16_f32 v66, v68, v69
    v_cvt_pk_bf16_f32 v67, v70, v71
    buffer_store_dwordx4 v[64:67], v1, s[4:7], s19 offen offset:3072 sc1
    s_lshr_b32 s40, s34, 1
    s_lshl_b32 s40, s40, 7
    s_and_b32 s41, s17, 7
    s_lshl_b32 s41, s41, 2
    s_add_u32 s40, s40, s41
    s_add_u32 s40, s40, 125894656
    v_mov_b32 v250, s95
    s_waitcnt vmcnt(0)
    s_mov_b64 exec, 1
    buffer_store_dword v250, off, s[4:7], s40 sc1
    s_mov_b64 exec, -1
    s_add_u32 s34, s34, 48
    s_cmp_lt_u32 s34, 512
    s_cbranch_scc1 L_att_next
    s_branch L_done
L_op_start:
    s_sub_u32 s34, s34, 48
    s_mul_hi_u32 s16, s34, 0x0e38e38f
    s_mul_i32 s41, s16, 18
    s_sub_u32 s33, s34, s41
    v_and_b32 v2, 63, v0
    v_lshlrev_b32 v1, 4, v2
    v_lshrrev_b32 v5, 2, v2
    v_mul_u32_u24 v3, 1152, v5
    v_and_b32 v5, 3, v2
    v_lshl_add_u32 v3, v5, 4, v3
    s_lshl_b32 s21, s32, 12
    v_add_u32 v4, s21, v1
    s_mov_b64 s[12:13], s[58:59]
    s_mov_b32 s14, 4718592
    s_mov_b32 s15, 0x20000
    s_mul_i32 s19, s32, 1179648
    s_lshl_b32 s18, s33, 6
    s_add_u32 s19, s19, s18
    s_add_u32 s18, s19, 0
    s_add_u32 m0, s21, 0
    s_nop 0
    buffer_load_dwordx4 v3, s[12:15], s18 offen lds
    s_add_u32 m0, s21, 1024
    s_add_u32 s18, s18, 18432
    buffer_load_dwordx4 v3, s[12:15], s18 offen lds
    s_add_u32 m0, s21, 2048
    s_add_u32 s18, s18, 18432
    buffer_load_dwordx4 v3, s[12:15], s18 offen lds
    s_add_u32 m0, s21, 3072
    s_add_u32 s18, s18, 18432
    buffer_load_dwordx4 v3, s[12:15], s18 offen lds
    s_add_u32 s18, s19, 73728
    s_add_u32 m0, s21, 16384
    s_nop 0
    buffer_load_dwordx4 v3, s[12:15], s18 offen lds
    s_add_u32 m0, s21, 17408
    s_add_u32 s18, s18, 18432
    buffer_load_dwordx4 v3, s[12:15], s18 offen lds
    s_add_u32 m0, s21, 18432
    s_add_u32 s18, s18, 18432
    buffer_load_dwordx4 v3, s[12:15], s18 offen lds
    s_add_u32 m0, s21, 19456
    s_add_u32 s18, s18, 18432
    buffer_load_dwordx4 v3, s[12:15], s18 offen lds
    s_add_u32 s18, s19, 147456
    s_add_u32 m0, s21, 32768
    s_nop 0
    buffer_load_dwordx4 v3, s[12:15], s18 offen lds
    s_add_u32 m0, s21, 33792
    s_add_u32 s18, s18, 18432
    buffer_load_dwordx4 v3, s[12:15], s18 offen lds
    s_add_u32 m0, s21, 34816
    s_add_u32 s18, s18, 18432
    buffer_load_dwordx4 v3, s[12:15], s18 offen lds
    s_add_u32 m0, s21, 35840
    s_add_u32 s18, s18, 18432
    buffer_load_dwordx4 v3, s[12:15], s18 offen lds
    s_add_u32 s18, s19, 221184
    s_add_u32 m0, s21, 49152
    s_nop 0
    buffer_load_dwordx4 v3, s[12:15], s18 offen lds
    s_add_u32 m0, s21, 50176
    s_add_u32 s18, s18, 18432
    buffer_load_dwordx4 v3, s[12:15], s18 offen lds
    s_add_u32 m0, s21, 51200
    s_add_u32 s18, s18, 18432
    buffer_load_dwordx4 v3, s[12:15], s18 offen lds
    s_add_u32 m0, s21, 52224
    s_add_u32 s18, s18, 18432
    buffer_load_dwordx4 v3, s[12:15], s18 offen lds
    s_add_u32 s18, s19, 294912
    s_add_u32 m0, s21, 65536
    s_nop 0
    buffer_load_dwordx4 v3, s[12:15], s18 offen lds
    s_add_u32 m0, s21, 66560
    s_add_u32 s18, s18, 18432
    buffer_load_dwordx4 v3, s[12:15], s18 offen lds
    s_add_u32 m0, s21, 67584
    s_add_u32 s18, s18, 18432
    buffer_load_dwordx4 v3, s[12:15], s18 offen lds
    s_add_u32 m0, s21, 68608
    s_add_u32 s18, s18, 18432
    buffer_load_dwordx4 v3, s[12:15], s18 offen lds
    s_add_u32 s18, s19, 368640
    s_add_u32 m0, s21, 81920
    s_nop 0
    buffer_load_dwordx4 v3, s[12:15], s18 offen lds
    s_add_u32 m0, s21, 82944
    s_add_u32 s18, s18, 18432
    buffer_load_dwordx4 v3, s[12:15], s18 offen lds
    s_add_u32 m0, s21, 83968
    s_add_u32 s18, s18, 18432
    buffer_load_dwordx4 v3, s[12:15], s18 offen lds
    s_add_u32 m0, s21, 84992
    s_add_u32 s18, s18, 18432
    buffer_load_dwordx4 v3, s[12:15], s18 offen lds
    s_add_u32 s18, s19, 442368
    s_add_u32 m0, s21, 98304
    s_nop 0
    buffer_load_dwordx4 v3, s[12:15], s18 offen lds
    s_add_u32 m0, s21, 99328
    s_add_u32 s18, s18, 18432
    buffer_load_dwordx4 v3, s[12:15], s18 offen lds
    s_add_u32 m0, s21, 100352
    s_add_u32 s18, s18, 18432
    buffer_load_dwordx4 v3, s[12:15], s18 offen lds
    s_add_u32 m0, s21, 101376
    s_add_u32 s18, s18, 18432
    buffer_load_dwordx4 v3, s[12:15], s18 offen lds
    s_add_u32 s18, s19, 516096
    s_add_u32 m0, s21, 114688
    s_nop 0
    buffer_load_dwordx4 v3, s[12:15], s18 offen lds
    s_add_u32 m0, s21, 115712
    s_add_u32 s18, s18, 18432
    buffer_load_dwordx4 v3, s[12:15], s18 offen lds
    s_add_u32 m0, s21, 116736
    s_add_u32 s18, s18, 18432
    buffer_load_dwordx4 v3, s[12:15], s18 offen lds
    s_add_u32 m0, s21, 117760
    s_add_u32 s18, s18, 18432
    buffer_load_dwordx4 v3, s[12:15], s18 offen lds
    s_add_u32 s18, s19, 589824
    s_add_u32 m0, s21, 131072
    s_nop 0
    buffer_load_dwordx4 v3, s[12:15], s18 offen lds
    s_add_u32 m0, s21, 132096
    s_add_u32 s18, s18, 18432
    buffer_load_dwordx4 v3, s[12:15], s18 offen lds
    s_add_u32 m0, s21, 133120
    s_add_u32 s18, s18, 18432
    buffer_load_dwordx4 v3, s[12:15], s18 offen lds
    s_add_u32 m0, s21, 134144
    s_add_u32 s18, s18, 18432
    buffer_load_dwordx4 v3, s[12:15], s18 offen lds
    v_add_u32 v6, 0, v4
    v_xor_b32 v7, 32, v6
    s_waitcnt vmcnt(32)
    ds_read_b64_tr_b16 a[0:1], v6 offset:0
    ds_read_b64_tr_b16 a[2:3], v6 offset:1024
    ds_read_b64_tr_b16 a[4:5], v6 offset:8
    ds_read_b64_tr_b16 a[6:7], v6 offset:1032
    ds_read_b64_tr_b16 a[8:9], v6 offset:2048
    ds_read_b64_tr_b16 a[10:11], v6 offset:3072
    ds_read_b64_tr_b16 a[12:13], v6 offset:2056
    ds_read_b64_tr_b16 a[14:15], v6 offset:3080
    s_waitcnt lgkmcnt(0)
    s_add_u32 s18, s19, 663552
    s_add_u32 m0, s21, 0
    s_nop 0
    buffer_load_dwordx4 v3, s[12:15], s18 offen lds
    s_add_u32 m0, s21, 1024
    s_add_u32 s18, s18, 18432
    buffer_load_dwordx4 v3, s[12:15], s18 offen lds
    s_add_u32 m0, s21, 2048
    s_add_u32 s18, s18, 18432
    buffer_load_dwordx4 v3, s[12:15], s18 offen lds
    s_add_u32 m0, s21, 3072
    s_add_u32 s18, s18, 18432
    buffer_load_dwordx4 v3, s[12:15], s18 offen lds
    v_add_u32 v6, 16384, v4
    v_xor_b32 v7, 32, v6
    s_waitcnt vmcnt(32)
    ds_read_b64_tr_b16 a[16:17], v6 offset:0
    ds_read_b64_tr_b16 a[18:19], v6 offset:1024
    ds_read_b64_tr_b16 a[20:21], v6 offset:8
    ds_read_b64_tr_b16 a[22:23], v6 offset:1032
    ds_read_b64_tr_b16 a[24:25], v6 offset:2048
    ds_read_b64_tr_b16 a[26:27], v6 offset:3072
    ds_read_b64_tr_b16 a[28:29], v6 offset:2056
    ds_read_b64_tr_b16 a[30:31], v6 offset:3080
    s_waitcnt lgkmcnt(0)
    s_add_u32 s18, s19, 737280
    s_add_u32 m0, s21, 16384
    s_nop 0
    buffer_load_dwordx4 v3, s[12:15], s18 offen lds
    s_add_u32 m0, s21, 17408
    s_add_u32 s18, s18, 18432
    buffer_load_dwordx4 v3, s[12:15], s18 offen lds
    s_add_u32 m0, s21, 18432
    s_add_u32 s18, s18, 18432
    buffer_load_dwordx4 v3, s[12:15], s18 offen lds
    s_add_u32 m0, s21, 19456
    s_add_u32 s18, s18, 18432
    buffer_load_dwordx4 v3, s[12:15], s18 offen lds
    v_add_u32 v6, 32768, v4
    v_xor_b32 v7, 32, v6
    s_waitcnt vmcnt(32)
    ds_read_b64_tr_b16 a[32:33], v6 offset:0
    ds_read_b64_tr_b16 a[34:35], v6 offset:1024
    ds_read_b64_tr_b16 a[36:37], v6 offset:8
    ds_read_b64_tr_b16 a[38:39], v6 offset:1032
    ds_read_b64_tr_b16 a[40:41], v6 offset:2048
    ds_read_b64_tr_b16 a[42:43], v6 offset:3072
    ds_read_b64_tr_b16 a[44:45], v6 offset:2056
    ds_read_b64_tr_b16 a[46:47], v6 offset:3080
    s_waitcnt lgkmcnt(0)
    s_add_u32 s18, s19, 811008
    s_add_u32 m0, s21, 32768
    s_nop 0
    buffer_load_dwordx4 v3, s[12:15], s18 offen lds
    s_add_u32 m0, s21, 33792
    s_add_u32 s18, s18, 18432
    buffer_load_dwordx4 v3, s[12:15], s18 offen lds
    s_add_u32 m0, s21, 34816
    s_add_u32 s18, s18, 18432
    buffer_load_dwordx4 v3, s[12:15], s18 offen lds
    s_add_u32 m0, s21, 35840
    s_add_u32 s18, s18, 18432
    buffer_load_dwordx4 v3, s[12:15], s18 offen lds
    v_add_u32 v6, 49152, v4
    v_xor_b32 v7, 32, v6
    s_waitcnt vmcnt(32)
    ds_read_b64_tr_b16 a[48:49], v6 offset:0
    ds_read_b64_tr_b16 a[50:51], v6 offset:1024
    ds_read_b64_tr_b16 a[52:53], v6 offset:8
    ds_read_b64_tr_b16 a[54:55], v6 offset:1032
    ds_read_b64_tr_b16 a[56:57], v6 offset:2048
    ds_read_b64_tr_b16 a[58:59], v6 offset:3072
    ds_read_b64_tr_b16 a[60:61], v6 offset:2056
    ds_read_b64_tr_b16 a[62:63], v6 offset:3080
    s_waitcnt lgkmcnt(0)
    s_add_u32 s18, s19, 884736
    s_add_u32 m0, s21, 49152
    s_nop 0
    buffer_load_dwordx4 v3, s[12:15], s18 offen lds
    s_add_u32 m0, s21, 50176
    s_add_u32 s18, s18, 18432
    buffer_load_dwordx4 v3, s[12:15], s18 offen lds
    s_add_u32 m0, s21, 51200
    s_add_u32 s18, s18, 18432
    buffer_load_dwordx4 v3, s[12:15], s18 offen lds
    s_add_u32 m0, s21, 52224
    s_add_u32 s18, s18, 18432
    buffer_load_dwordx4 v3, s[12:15], s18 offen lds
    v_add_u32 v6, 65536, v4
    v_xor_b32 v7, 32, v6
    s_waitcnt vmcnt(32)
    ds_read_b64_tr_b16 a[64:65], v6 offset:0
    ds_read_b64_tr_b16 a[66:67], v6 offset:1024
    ds_read_b64_tr_b16 a[68:69], v6 offset:8
    ds_read_b64_tr_b16 a[70:71], v6 offset:1032
    ds_read_b64_tr_b16 a[72:73], v6 offset:2048
    ds_read_b64_tr_b16 a[74:75], v6 offset:3072
    ds_read_b64_tr_b16 a[76:77], v6 offset:2056
    ds_read_b64_tr_b16 a[78:79], v6 offset:3080
    s_waitcnt lgkmcnt(0)
    s_add_u32 s18, s19, 958464
    s_add_u32 m0, s21, 65536
    s_nop 0
    buffer_load_dwordx4 v3, s[12:15], s18 offen lds
    s_add_u32 m0, s21, 66560
    s_add_u32 s18, s18, 18432
    buffer_load_dwordx4 v3, s[12:15], s18 offen lds
    s_add_u32 m0, s21, 67584
    s_add_u32 s18, s18, 18432
    buffer_load_dwordx4 v3, s[12:15], s18 offen lds
    s_add_u32 m0, s21, 68608
    s_add_u32 s18, s18, 18432
    buffer_load_dwordx4 v3, s[12:15], s18 offen lds
    v_add_u32 v6, 81920, v4
    v_xor_b32 v7, 32, v6
    s_waitcnt vmcnt(32)
    ds_read_b64_tr_b16 a[80:81], v6 offset:0
    ds_read_b64_tr_b16 a[82:83], v6 offset:1024
    ds_read_b64_tr_b16 a[84:85], v6 offset:8
    ds_read_b64_tr_b16 a[86:87], v6 offset:1032
    ds_read_b64_tr_b16 a[88:89], v6 offset:2048
    ds_read_b64_tr_b16 a[90:91], v6 offset:3072
    ds_read_b64_tr_b16 a[92:93], v6 offset:2056
    ds_read_b64_tr_b16 a[94:95], v6 offset:3080
    s_waitcnt lgkmcnt(0)
    s_add_u32 s18, s19, 1032192
    s_add_u32 m0, s21, 81920
    s_nop 0
    buffer_load_dwordx4 v3, s[12:15], s18 offen lds
    s_add_u32 m0, s21, 82944
    s_add_u32 s18, s18, 18432
    buffer_load_dwordx4 v3, s[12:15], s18 offen lds
    s_add_u32 m0, s21, 83968
    s_add_u32 s18, s18, 18432
    buffer_load_dwordx4 v3, s[12:15], s18 offen lds
    s_add_u32 m0, s21, 84992
    s_add_u32 s18, s18, 18432
    buffer_load_dwordx4 v3, s[12:15], s18 offen lds
    v_add_u32 v6, 98304, v4
    v_xor_b32 v7, 32, v6
    s_waitcnt vmcnt(32)
    ds_read_b64_tr_b16 a[96:97], v6 offset:0
    ds_read_b64_tr_b16 a[98:99], v6 offset:1024
    ds_read_b64_tr_b16 a[100:101], v6 offset:8
    ds_read_b64_tr_b16 a[102:103], v6 offset:1032
    ds_read_b64_tr_b16 a[104:105], v6 offset:2048
    ds_read_b64_tr_b16 a[106:107], v6 offset:3072
    ds_read_b64_tr_b16 a[108:109], v6 offset:2056
    ds_read_b64_tr_b16 a[110:111], v6 offset:3080
    s_waitcnt lgkmcnt(0)
    s_add_u32 s18, s19, 1105920
    s_add_u32 m0, s21, 98304
    s_nop 0
    buffer_load_dwordx4 v3, s[12:15], s18 offen lds
    s_add_u32 m0, s21, 99328
    s_add_u32 s18, s18, 18432
    buffer_load_dwordx4 v3, s[12:15], s18 offen lds
    s_add_u32 m0, s21, 100352
    s_add_u32 s18, s18, 18432
    buffer_load_dwordx4 v3, s[12:15], s18 offen lds
    s_add_u32 m0, s21, 101376
    s_add_u32 s18, s18, 18432
    buffer_load_dwordx4 v3, s[12:15], s18 offen lds
    v_add_u32 v6, 114688, v4
    v_xor_b32 v7, 32, v6
    s_waitcnt vmcnt(32)
    ds_read_b64_tr_b16 a[112:113], v6 offset:0
    ds_read_b64_tr_b16 a[114:115], v6 offset:1024
    ds_read_b64_tr_b16 a[116:117], v6 offset:8
    ds_read_b64_tr_b16 a[118:119], v6 offset:1032
    ds_read_b64_tr_b16 a[120:121], v6 offset:2048
    ds_read_b64_tr_b16 a[122:123], v6 offset:3072
    ds_read_b64_tr_b16 a[124:125], v6 offset:2056
    ds_read_b64_tr_b16 a[126:127], v6 offset:3080
    s_waitcnt lgkmcnt(0)
    v_add_u32 v6, 131072, v4
    v_xor_b32 v7, 32, v6
    s_waitcnt vmcnt(28)
    ds_read_b64_tr_b16 a[128:129], v6 offset:0
    ds_read_b64_tr_b16 a[130:131], v6 offset:1024
    ds_read_b64_tr_b16 a[132:133], v6 offset:8
    ds_read_b64_tr_b16 a[134:135], v6 offset:1032
    ds_read_b64_tr_b16 a[136:137], v6 offset:2048
    ds_read_b64_tr_b16 a[138:139], v6 offset:3072
    ds_read_b64_tr_b16 a[140:141], v6 offset:2056
    ds_read_b64_tr_b16 a[142:143], v6 offset:3080
    s_waitcnt lgkmcnt(0)
    v_add_u32 v6, 0, v4
    v_xor_b32 v7, 32, v6
    s_waitcnt vmcnt(24)
    ds_read_b64_tr_b16 a[144:145], v6 offset:0
    ds_read_b64_tr_b16 a[146:147], v6 offset:1024
    ds_read_b64_tr_b16 a[148:149], v6 offset:8
    ds_read_b64_tr_b16 a[150:151], v6 offset:1032
    ds_read_b64_tr_b16 a[152:153], v6 offset:2048
    ds_read_b64_tr_b16 a[154:155], v6 offset:3072
    ds_read_b64_tr_b16 a[156:157], v6 offset:2056
    ds_read_b64_tr_b16 a[158:159], v6 offset:3080
    s_waitcnt lgkmcnt(0)
    v_add_u32 v6, 16384, v4
    v_xor_b32 v7, 32, v6
    s_waitcnt vmcnt(20)
    ds_read_b64_tr_b16 a[160:161], v6 offset:0
    ds_read_b64_tr_b16 a[162:163], v6 offset:1024
    ds_read_b64_tr_b16 a[164:165], v6 offset:8
    ds_read_b64_tr_b16 a[166:167], v6 offset:1032
    ds_read_b64_tr_b16 a[168:169], v6 offset:2048
    ds_read_b64_tr_b16 a[170:171], v6 offset:3072
    ds_read_b64_tr_b16 a[172:173], v6 offset:2056
    ds_read_b64_tr_b16 a[174:175], v6 offset:3080
    s_waitcnt lgkmcnt(0)
    v_add_u32 v6, 32768, v4
    v_xor_b32 v7, 32, v6
    s_waitcnt vmcnt(16)
    ds_read_b64_tr_b16 a[176:177], v6 offset:0
    ds_read_b64_tr_b16 a[178:179], v6 offset:1024
    ds_read_b64_tr_b16 a[180:181], v6 offset:8
    ds_read_b64_tr_b16 a[182:183], v6 offset:1032
    ds_read_b64_tr_b16 a[184:185], v6 offset:2048
    ds_read_b64_tr_b16 a[186:187], v6 offset:3072
    ds_read_b64_tr_b16 a[188:189], v6 offset:2056
    ds_read_b64_tr_b16 a[190:191], v6 offset:3080
    s_waitcnt lgkmcnt(0)
    v_add_u32 v6, 49152, v4
    v_xor_b32 v7, 32, v6
    s_waitcnt vmcnt(12)
    ds_read_b64_tr_b16 a[192:193], v6 offset:0
    ds_read_b64_tr_b16 a[194:195], v6 offset:1024
    ds_read_b64_tr_b16 a[196:197], v6 offset:8
    ds_read_b64_tr_b16 a[198:199], v6 offset:1032
    ds_read_b64_tr_b16 a[200:201], v6 offset:2048
    ds_read_b64_tr_b16 a[202:203], v6 offset:3072
    ds_read_b64_tr_b16 a[204:205], v6 offset:2056
    ds_read_b64_tr_b16 a[206:207], v6 offset:3080
    s_waitcnt lgkmcnt(0)
    v_add_u32 v6, 65536, v4
    v_xor_b32 v7, 32, v6
    s_waitcnt vmcnt(8)
    ds_read_b64_tr_b16 a[208:209], v6 offset:0
    ds_read_b64_tr_b16 a[210:211], v6 offset:1024
    ds_read_b64_tr_b16 a[212:213], v6 offset:8
    ds_read_b64_tr_b16 a[214:215], v6 offset:1032
    ds_read_b64_tr_b16 a[216:217], v6 offset:2048
    ds_read_b64_tr_b16 a[218:219], v6 offset:3072
    ds_read_b64_tr_b16 a[220:221], v6 offset:2056
    ds_read_b64_tr_b16 a[222:223], v6 offset:3080
    s_waitcnt lgkmcnt(0)
    v_add_u32 v6, 81920, v4
    v_xor_b32 v7, 32, v6
    s_waitcnt vmcnt(4)
    ds_read_b64_tr_b16 a[224:225], v6 offset:0
    ds_read_b64_tr_b16 a[226:227], v6 offset:1024
    ds_read_b64_tr_b16 a[228:229], v6 offset:8
    ds_read_b64_tr_b16 a[230:231], v6 offset:1032
    ds_read_b64_tr_b16 a[232:233], v6 offset:2048
    ds_read_b64_tr_b16 a[234:235], v6 offset:3072
    ds_read_b64_tr_b16 a[236:237], v6 offset:2056
    ds_read_b64_tr_b16 a[238:239], v6 offset:3080
    s_waitcnt lgkmcnt(0)
    v_add_u32 v6, 98304, v4
    v_xor_b32 v7, 32, v6
    s_waitcnt vmcnt(0)
    ds_read_b64_tr_b16 a[240:241], v6 offset:0
    ds_read_b64_tr_b16 a[242:243], v6 offset:1024
    ds_read_b64_tr_b16 a[244:245], v6 offset:8
    ds_read_b64_tr_b16 a[246:247], v6 offset:1032
    ds_read_b64_tr_b16 a[248:249], v6 offset:2048
    ds_read_b64_tr_b16 a[250:251], v6 offset:3072
    ds_read_b64_tr_b16 a[252:253], v6 offset:2056
    ds_read_b64_tr_b16 a[254:255], v6 offset:3080
    s_waitcnt lgkmcnt(0)
    s_barrier
L_op_seg:
    s_lshr_b32 s43, s16, 1
    s_add_u32 s43, s43, 1
    s_min_u32 s43, s43, 63
    s_and_b32 s36, s33, 15
    s_lshl_b32 s36, s36, 8
    s_add_u32 s36, s36, 125829120
    s_lshl_b32 s94, s33, 7
    s_add_u32 s94, s94, s16
    s_mov_b32 s88, 65536
cw12:
    buffer_load_dword v3, off, s[4:7], s36 offset:128 sc1
    s_waitcnt vmcnt(0)
    v_readfirstlane_b32 s42, v3
    s_nop 0
    s_sub_u32 s42, s42, s95
    s_cmp_gt_u32 s42, 64
    s_cselect_b32 s42, 0, s42
    s_add_u32 s42, s42, 2
    s_cmp_ge_u32 s42, s43
    s_cbranch_scc1 cw12x
    s_sub_u32 s88, s88, 1
    s_cbranch_scc1 cw12x
    s_sub_u32 s42, s43, s42
    s_min_u32 s42, s42, 6
cw12s:
    s_sleep 24
    s_sub_u32 s42, s42, 1
    s_cmp_lg_u32 s42, 0
    s_cbranch_scc1 cw12s
    s_branch cw12
cw12x:
    s_lshr_b32 s89, s16, 1
    s_lshl_b32 s89, s89, 2
    s_add_u32 s89, s89, s32
    s_lshl_b32 s89, s89, 7
    s_add_u32 s89, s89, 125894656
    v_mbcnt_lo_u32_b32 v2, -1, 0
    v_mbcnt_hi_u32_b32 v2, -1, v2
    v_min_u32 v2, 7, v2
    v_lshlrev_b32 v2, 2, v2
    s_mov_b32 s88, 4194304
fw13:
    buffer_load_dword v3, v2, s[4:7], s89 offen offset:0 sc1
    s_sub_u32 s88, s88, 1
    s_cbranch_scc1 fw13x
    s_waitcnt vmcnt(0)
    v_cmp_ne_u32 vcc, s95, v3
    s_cbranch_vccz fw13x
    s_sleep 4
    s_cmp_gt_u32 s88, 4194280
    s_cbranch_scc1 fw13
    s_sleep 40
    s_branch fw13
fw13x:
    s_lshl_b32 s18, s16, 17
    s_lshl_b32 s19, s32, 15
    s_add_u32 s18, s18, s19
    s_add_u32 s18, s18, 50331648
    buffer_load_dwordx4 v[32:35], v1, s[4:7], s18 offen offset:0 sc1
    buffer_load_dwordx4 v[36:39], v1, s[4:7], s18 offen offset:1024 sc1
    buffer_load_dwordx4 v[40:43], v1, s[4:7], s18 offen offset:2048 sc1
    buffer_load_dwordx4 v[44:47], v1, s[4:7], s18 offen offset:3072 sc1
    s_add_u32 s18, s18, 4096
    buffer_load_dwordx4 v[48:51], v1, s[4:7], s18 offen offset:0 sc1
    buffer_load_dwordx4 v[52:55], v1, s[4:7], s18 offen offset:1024 sc1
    buffer_load_dwordx4 v[56:59], v1, s[4:7], s18 offen offset:2048 sc1
    buffer_load_dwordx4 v[60:63], v1, s[4:7], s18 offen offset:3072 sc1
    s_add_u32 s18, s18, 4096
    buffer_load_dwordx4 v[64:67], v1, s[4:7], s18 offen offset:0 sc1
    buffer_load_dwordx4 v[68:71], v1, s[4:7], s18 offen offset:1024 sc1
    buffer_load_dwordx4 v[72:75], v1, s[4:7], s18 offen offset:2048 sc1
    buffer_load_dwordx4 v[76:79], v1, s[4:7], s18 offen offset:3072 sc1
    s_add_u32 s18, s18, 4096
    buffer_load_dwordx4 v[80:83], v1, s[4:7], s18 offen offset:0 sc1
    buffer_load_dwordx4 v[84:87], v1, s[4:7], s18 offen offset:1024 sc1
    buffer_load_dwordx4 v[88:91], v1, s[4:7], s18 offen offset:2048 sc1
    buffer_load_dwordx4 v[92:95], v1, s[4:7], s18 offen offset:3072 sc1
    s_add_u32 s18, s18, 4096
    buffer_load_dwordx4 v[96:99], v1, s[4:7], s18 offen offset:0 sc1
    buffer_load_dwordx4 v[100:103], v1, s[4:7], s18 offen offset:1024 sc1
    buffer_load_dwordx4 v[104:107], v1, s[4:7], s18 offen offset:2048 sc1
    buffer_load_dwordx4 v[108:111], v1, s[4:7], s18 offen offset:3072 sc1
    s_add_u32 s18, s18, 4096
    buffer_load_dwordx4 v[112:115], v1, s[4:7], s18 offen offset:0 sc1
    buffer_load_dwordx4 v[116:119], v1, s[4:7], s18 offen offset:1024 sc1
    buffer_load_dwordx4 v[120:123], v1, s[4:7], s18 offen offset:2048 sc1
    buffer_load_dwordx4 v[124:127], v1, s[4:7], s18 offen offset:3072 sc1
    s_add_u32 s18, s18, 4096
    buffer_load_dwordx4 v[128:131], v1, s[4:7], s18 offen offset:0 sc1
    buffer_load_dwordx4 v[132:135], v1, s[4:7], s18 offen offset:1024 sc1
    buffer_load_dwordx4 v[136:139], v1, s[4:7], s18 offen offset:2048 sc1
    buffer_load_dwordx4 v[140:143], v1, s[4:7], s18 offen offset:3072 sc1
    s_add_u32 s18, s18, 4096
    buffer_load_dwordx4 v[144:147], v1, s[4:7], s18 offen offset:0 sc1
    buffer_load_dwordx4 v[148:151], v1, s[4:7], s18 offen offset:1024 sc1
    buffer_load_dwordx4 v[152:155], v1, s[4:7], s18 offen offset:2048 sc1
    buffer_load_dwordx4 v[156:159], v1, s[4:7], s18 offen offset:3072 sc1
    v_lshlrev_b32 v2, 4, v0
    v_and_b32 v3, 3072, v2
    v_lshl_add_u32 v2, v3, 1, v1
    s_waitcnt vmcnt(31)
    v_mfma_f32_16x16x32_bf16 v[8:11], a[0:3], v[32:35], 0
    v_mfma_f32_16x16x32_bf16 v[12:15], a[4:7], v[32:35], 0
    s_waitcnt vmcnt(30)
    v_mfma_f32_16x16x32_bf16 v[8:11], a[8:11], v[36:39], v[8:11]
    v_mfma_f32_16x16x32_bf16 v[12:15], a[12:15], v[36:39], v[12:15]
    s_waitcnt vmcnt(29)
    v_mfma_f32_16x16x32_bf16 v[8:11], a[16:19], v[40:43], v[8:11]
    v_mfma_f32_16x16x32_bf16 v[12:15], a[20:23], v[40:43], v[12:15]
    s_waitcnt vmcnt(28)
    v_mfma_f32_16x16x32_bf16 v[8:11], a[24:27], v[44:47], v[8:11]
    v_mfma_f32_16x16x32_bf16 v[12:15], a[28:31], v[44:47], v[12:15]
    s_waitcnt vmcnt(27)
    v_mfma_f32_16x16x32_bf16 v[8:11], a[32:35], v[48:51], v[8:11]
    v_mfma_f32_16x16x32_bf16 v[12:15], a[36:39], v[48:51], v[12:15]
    s_waitcnt vmcnt(26)
    v_mfma_f32_16x16x32_bf16 v[8:11], a[40:43], v[52:55], v[8:11]
    v_mfma_f32_16x16x32_bf16 v[12:15], a[44:47], v[52:55], v[12:15]
    s_waitcnt vmcnt(25)
    v_mfma_f32_16x16x32_bf16 v[8:11], a[48:51], v[56:59], v[8:11]
    v_mfma_f32_16x16x32_bf16 v[12:15], a[52:55], v[56:59], v[12:15]
    s_waitcnt vmcnt(24)
    v_mfma_f32_16x16x32_bf16 v[8:11], a[56:59], v[60:63], v[8:11]
    v_mfma_f32_16x16x32_bf16 v[12:15], a[60:63], v[60:63], v[12:15]
    s_waitcnt vmcnt(23)
    v_mfma_f32_16x16x32_bf16 v[8:11], a[64:67], v[64:67], v[8:11]
    v_mfma_f32_16x16x32_bf16 v[12:15], a[68:71], v[64:67], v[12:15]
    s_waitcnt vmcnt(22)
    v_mfma_f32_16x16x32_bf16 v[8:11], a[72:75], v[68:71], v[8:11]
    v_mfma_f32_16x16x32_bf16 v[12:15], a[76:79], v[68:71], v[12:15]
    s_waitcnt vmcnt(21)
    v_mfma_f32_16x16x32_bf16 v[8:11], a[80:83], v[72:75], v[8:11]
    v_mfma_f32_16x16x32_bf16 v[12:15], a[84:87], v[72:75], v[12:15]
    s_waitcnt vmcnt(20)
    v_mfma_f32_16x16x32_bf16 v[8:11], a[88:91], v[76:79], v[8:11]
    v_mfma_f32_16x16x32_bf16 v[12:15], a[92:95], v[76:79], v[12:15]
    s_waitcnt vmcnt(19)
    v_mfma_f32_16x16x32_bf16 v[8:11], a[96:99], v[80:83], v[8:11]
    v_mfma_f32_16x16x32_bf16 v[12:15], a[100:103], v[80:83], v[12:15]
    s_waitcnt vmcnt(18)
    v_mfma_f32_16x16x32_bf16 v[8:11], a[104:107], v[84:87], v[8:11]
    v_mfma_f32_16x16x32_bf16 v[12:15], a[108:111], v[84:87], v[12:15]
    s_waitcnt vmcnt(17)
    v_mfma_f32_16x16x32_bf16 v[8:11], a[112:115], v[88:91], v[8:11]
    v_mfma_f32_16x16x32_bf16 v[12:15], a[116:119], v[88:91], v[12:15]
    s_waitcnt vmcnt(16)
    v_mfma_f32_16x16x32_bf16 v[8:11], a[120:123], v[92:95], v[8:11]
    v_mfma_f32_16x16x32_bf16 v[12:15], a[124:127], v[92:95], v[12:15]
    s_waitcnt vmcnt(15)
    v_mfma_f32_16x16x32_bf16 v[8:11], a[128:131], v[96:99], v[8:11]
    v_mfma_f32_16x16x32_bf16 v[12:15], a[132:135], v[96:99], v[12:15]
    s_waitcnt vmcnt(14)
    v_mfma_f32_16x16x32_bf16 v[8:11], a[136:139], v[100:103], v[8:11]
    v_mfma_f32_16x16x32_bf16 v[12:15], a[140:143], v[100:103], v[12:15]
    s_waitcnt vmcnt(13)
    v_mfma_f32_16x16x32_bf16 v[8:11], a[144:147], v[104:107], v[8:11]
    v_mfma_f32_16x16x32_bf16 v[12:15], a[148:151], v[104:107], v[12:15]
    s_waitcnt vmcnt(12)
    v_mfma_f32_16x16x32_bf16 v[8:11], a[152:155], v[108:111], v[8:11]
    v_mfma_f32_16x16x32_bf16 v[12:15], a[156:159], v[108:111], v[12:15]
    s_waitcnt vmcnt(11)
    v_mfma_f32_16x16x32_bf16 v[8:11], a[160:163], v[112:115], v[8:11]
    v_mfma_f32_16x16x32_bf16 v[12:15], a[164:167], v[112:115], v[12:15]
    s_waitcnt vmcnt(10)
    v_mfma_f32_16x16x32_bf16 v[8:11], a[168:171], v[116:119], v[8:11]
    v_mfma_f32_16x16x32_bf16 v[12:15], a[172:175], v[116:119], v[12:15]
    s_waitcnt vmcnt(9)
    v_mfma_f32_16x16x32_bf16 v[8:11], a[176:179], v[120:123], v[8:11]
    v_mfma_f32_16x16x32_bf16 v[12:15], a[180:183], v[120:123], v[12:15]
    s_waitcnt vmcnt(8)
    v_mfma_f32_16x16x32_bf16 v[8:11], a[184:187], v[124:127], v[8:11]
    v_mfma_f32_16x16x32_bf16 v[12:15], a[188:191], v[124:127], v[12:15]
    s_waitcnt vmcnt(7)
    v_mfma_f32_16x16x32_bf16 v[8:11], a[192:195], v[128:131], v[8:11]
    v_mfma_f32_16x16x32_bf16 v[12:15], a[196:199], v[128:131], v[12:15]
    s_waitcnt vmcnt(6)
    v_mfma_f32_16x16x32_bf16 v[8:11], a[200:203], v[132:135], v[8:11]
    v_mfma_f32_16x16x32_bf16 v[12:15], a[204:207], v[132:135], v[12:15]
    s_waitcnt vmcnt(5)
    v_mfma_f32_16x16x32_bf16 v[8:11], a[208:211], v[136:139], v[8:11]
    v_mfma_f32_16x16x32_bf16 v[12:15], a[212:215], v[136:139], v[12:15]
    s_waitcnt vmcnt(4)
    v_mfma_f32_16x16x32_bf16 v[8:11], a[216:219], v[140:143], v[8:11]
    v_mfma_f32_16x16x32_bf16 v[12:15], a[220:223], v[140:143], v[12:15]
    s_waitcnt vmcnt(3)
    v_mfma_f32_16x16x32_bf16 v[8:11], a[224:227], v[144:147], v[8:11]
    v_mfma_f32_16x16x32_bf16 v[12:15], a[228:231], v[144:147], v[12:15]
    s_waitcnt vmcnt(2)
    v_mfma_f32_16x16x32_bf16 v[8:11], a[232:235], v[148:151], v[8:11]
    v_mfma_f32_16x16x32_bf16 v[12:15], a[236:239], v[148:151], v[12:15]
    s_waitcnt vmcnt(1)
    v_mfma_f32_16x16x32_bf16 v[8:11], a[240:243], v[152:155], v[8:11]
    v_mfma_f32_16x16x32_bf16 v[12:15], a[244:247], v[152:155], v[12:15]
    s_waitcnt vmcnt(0)
    v_mfma_f32_16x16x32_bf16 v[8:11], a[248:251], v[156:159], v[8:11]
    v_mfma_f32_16x16x32_bf16 v[12:15], a[252:255], v[156:159], v[12:15]
    s_nop 3
    ds_write_b128 v2, v[8:11] offset:0
    s_nop 2
    ds_write_b128 v2, v[12:15] offset:1024
    s_waitcnt lgkmcnt(0)
    s_barrier
    s_cmp_lg_u32 s32, 0
    s_cbranch_scc1 os_skip
    ds_read_b128 v[40:43], v1 offset:2048
    ds_read_b128 v[44:47], v1 offset:3072
    ds_read_b128 v[48:51], v1 offset:4096
    ds_read_b128 v[52:55], v1 offset:5120
    ds_read_b128 v[56:59], v1 offset:6144
    ds_read_b128 v[60:63], v1 offset:7168
    v_lshrrev_b32 v3, 4, v1
    v_bfe_u32 v4, v3, 2, 2
    v_lshlrev_b32 v4, 3, v4
    v_and_b32 v2, 3, v3
    v_add_u32 v4, v4, v2
    v_mul_u32_u24 v4, 2304, v4
    v_lshrrev_b32 v3, 4, v3
    v_lshl_add_u32 v4, v3, 4, v4
    s_lshr_b32 s18, s16, 1
    s_lshl_b32 s18, s18, 3
    s_and_b32 s19, s16, 1
    s_add_u32 s18, s18, s19
    s_mul_i32 s18, s18, 9216
    s_lshl_b32 s19, s33, 6
    s_add_u32 s18, s18, s19
    s_waitcnt lgkmcnt(0)
    v_pk_add_f32 v[8:9], v[8:9], v[40:41]
    v_pk_add_f32 v[48:49], v[48:49], v[56:57]
    v_pk_add_f32 v[8:9], v[8:9], v[48:49]
    v_pk_add_f32 v[10:11], v[10:11], v[42:43]
    v_pk_add_f32 v[50:51], v[50:51], v[58:59]
    v_pk_add_f32 v[10:11], v[10:11], v[50:51]
    v_pk_add_f32 v[12:13], v[12:13], v[44:45]
    v_pk_add_f32 v[52:53], v[52:53], v[60:61]
    v_pk_add_f32 v[12:13], v[12:13], v[52:53]
    v_pk_add_f32 v[14:15], v[14:15], v[46:47]
    v_pk_add_f32 v[54:55], v[54:55], v[62:63]
    v_pk_add_f32 v[14:15], v[14:15], v[54:55]
    v_cvt_pk_bf16_f32 v32, v8, v9
    v_cvt_pk_bf16_f32 v33, v10, v11
    v_cvt_pk_bf16_f32 v34, v12, v13
    v_cvt_pk_bf16_f32 v35, v14, v15
    buffer_store_dwordx4 v[32:35], v4, s[8:11], s18 offen
os_skip:
    s_nop 1
    s_add_u32 s16, s16, 6
    s_cmp_ge_u32 s16, 128
    s_cbranch_scc1 L_done
    s_barrier
    s_branch L_op_seg
L_done:
L_exit:
    s_endpgm
.section .rodata,"a"
.p2align 6
.amdhsa_kernel concat_heads__memory_aug_recurrent_mem_tr__ssm_conv_s4d__prompt_kernel
  .amdhsa_next_free_vgpr 512
  .amdhsa_next_free_sgpr 102
  .amdhsa_accum_offset 256
  .amdhsa_group_segment_fixed_size 0
  .amdhsa_kernarg_size 136
  .amdhsa_user_sgpr_count 2
  .amdhsa_user_sgpr_kernarg_segment_ptr 1
  .amdhsa_system_sgpr_workgroup_id_x 1
.end_amdhsa_kernel
.text
```

```asm
; @launch grid=(256,1,1) block=(256,1,1) lds=163840
.amdgcn_target "amdgcn-amd-amdhsa--gfx950"
.text
.globl concat_heads__memory_aug_recurrent_mem_tr__ssm_conv_s4d__prompt_kernel
.p2align 8
.type concat_heads__memory_aug_recurrent_mem_tr__ssm_conv_s4d__prompt_kernel,@function
concat_heads__memory_aug_recurrent_mem_tr__ssm_conv_s4d__prompt_kernel:
    s_cmp_ge_u32 s2, 256
    s_cbranch_scc1 L_exit
    s_load_dwordx4 s[84:87], s[0:1], 120
    s_load_dwordx16 s[48:63], s[0:1], 0
    v_lshrrev_b32 v1, 6, v0
    s_nop 0
    v_readfirstlane_b32 s32, v1
    s_getreg_b32 s3, hwreg(HW_REG_XCC_ID)
    s_and_b32 s3, s3, 15
    s_cmp_lg_u32 s32, 3
    s_cbranch_scc1 L_nowarm
    s_getpc_b64 s[44:45]
L_pcw:
    v_and_b32 v1, 63, v0
    v_lshlrev_b32 v1, 7, v1
    s_cmp_lg_u32 s3, 0
    s_cselect_b32 s33, L_helper-L_pcw, 0
    v_add_u32 v1, s33, v1
    v_min_u32 v2, L_exit-L_pcw, v1
    global_load_dword v240, v2, s[44:45]
    v_add_u32 v1, 8192, v1
    v_min_u32 v2, L_exit-L_pcw, v1
    global_load_dword v241, v2, s[44:45]
    v_add_u32 v1, 8192, v1
    s_cbranch_scc0 L_nowarm
    v_min_u32 v2, L_exit-L_pcw, v1
    global_load_dword v242, v2, s[44:45]
    v_add_u32 v1, 8192, v1
    v_min_u32 v2, L_exit-L_pcw, v1
    global_load_dword v243, v2, s[44:45]
    v_add_u32 v1, 8192, v1
    v_min_u32 v2, L_exit-L_pcw, v1
    global_load_dword v244, v2, s[44:45]
    v_add_u32 v1, 8192, v1
L_nowarm:
    s_waitcnt lgkmcnt(0)
    s_mov_b32 s4, s86
    s_mov_b32 s5, s87
    s_mov_b32 s6, 268435456
    s_mov_b32 s7, 0x20000
    s_mov_b32 s96, s84
    s_mov_b32 s97, s85
    s_mov_b32 s98, 256
    s_mov_b32 s99, 0x20000
    s_mov_b32 s95, 0
    s_cmp_lg_u32 s3, 0
    s_cbranch_scc1 L_helper
    s_mov_b32 s37, 128
    v_mov_b32 v250, 1
    v_mov_b32 v251, 163832
    v_cmp_eq_u32 vcc, 0, v0
    s_nop 0
    s_and_saveexec_b64 s[38:39], vcc
    s_cbranch_execz tk1m
    buffer_atomic_add v250, off, s[96:99], s37 sc0
tk1m:
    s_mov_b64 s[38:39], exec
    s_mov_b64 exec, -1
    v_lshrrev_b32 v54, 6, v0
    s_nop 0
    v_readfirstlane_b32 s13, v54
    v_and_b32 v57, 63, v0
    v_bfe_u32 v54, v57, 2, 1
    v_lshlrev_b32 v48, 13, v54
    v_bfe_u32 v54, v57, 3, 1
    v_lshl_add_u32 v48, v54, 15, v48
    v_bfe_u32 v54, v57, 4, 1
    v_lshl_add_u32 v48, v54, 14, v48
    v_bfe_u32 v54, v57, 5, 1
    v_lshl_add_u32 v48, v54, 16, v48
    v_lshrrev_b32 v55, 4, v57
    v_and_b32 v55, 2, v55
    v_xor_b32 v55, v55, v57
    v_and_b32 v55, 3, v55
    v_lshl_add_u32 v48, v55, 4, v48
    v_bfe_u32 v54, v57, 2, 1
    v_lshlrev_b32 v51, 6, v54
    v_bfe_u32 v54, v57, 3, 1
    v_lshl_add_u32 v51, v54, 9, v51
    v_bfe_u32 v54, v57, 4, 1
    v_lshl_add_u32 v51, v54, 7, v51
    v_bfe_u32 v54, v57, 5, 1
    v_lshl_add_u32 v51, v54, 12, v51
    v_bfe_u32 v54, v57, 0, 1
    v_lshl_add_u32 v51, v54, 3, v51
    v_bfe_u32 v54, v57, 1, 1
    v_lshl_add_u32 v51, v54, 4, v51
    v_bfe_u32 v54, v57, 3, 1
    v_lshl_add_u32 v51, v54, 5, v51
    v_lshrrev_b32 v55, 3, v57
    v_mul_u32_u24 v49, 1152, v55
    v_and_b32 v55, 7, v57
    v_lshl_add_u32 v49, v55, 4, v49
    v_bfe_u32 v54, v57, 4, 1
    v_lshlrev_b32 v52, 13, v54
    v_bfe_u32 v54, v57, 5, 1
    v_lshl_add_u32 v52, v54, 9, v52
    v_bfe_u32 v54, v57, 2, 1
    v_lshl_add_u32 v52, v54, 7, v52
    v_bfe_u32 v54, v57, 3, 1
    v_lshl_add_u32 v52, v54, 5, v52
    v_and_b32 v55, 3, v57
    v_lshl_add_u32 v52, v55, 3, v52
    v_lshrrev_b32 v55, 2, v57
    v_mul_u32_u24 v50, 1152, v55
    v_and_b32 v55, 3, v57
    v_lshl_add_u32 v50, v55, 4, v50
    v_bfe_u32 v54, v57, 4, 1
    v_lshlrev_b32 v53, 12, v54
    v_bfe_u32 v54, v57, 5, 1
    v_lshl_add_u32 v53, v54, 8, v53
    v_bfe_u32 v54, v57, 2, 1
    v_lshl_add_u32 v53, v54, 6, v53
    v_bfe_u32 v54, v57, 3, 1
    v_lshl_add_u32 v53, v54, 5, v53
    v_and_b32 v55, 3, v57
    v_lshl_add_u32 v53, v55, 3, v53
    s_lshl_b32 s66, s13, 10
    s_and_b32 s93, s13, 1
    s_lshl_b32 s93, s93, 14
    s_and_b32 s75, s13, 2
    s_lshl_b32 s75, s75, 19
    v_add_u32 v51, s66, v51
    v_add_u32 v52, s66, v52
    v_add_u32 v53, s66, v53
    v_mov_b32 v58, v48
    s_mov_b32 s10, 4718592
    s_mov_b32 s11, 0x20000
    s_mov_b64 exec, s[38:39]
    s_cbranch_execz tk1
    s_waitcnt vmcnt(0)
    ds_write_b32 v251, v250
    s_waitcnt lgkmcnt(0)
tk1:
    s_mov_b64 exec, -1
    s_barrier
    ds_read_b32 v252, v251
    s_waitcnt lgkmcnt(0)
    v_readfirstlane_b32 s12, v252
    s_barrier
    s_nop 3
    s_cmp_ge_u32 s12, 32
    s_cbranch_scc1 L_helper
L_chain:
    s_mov_b64 s[48:49], s[50:51]
    s_mov_b64 s[50:51], s[52:53]
    s_mov_b64 s[52:53], s[54:55]
    s_mov_b64 s[54:55], s[56:57]
    s_mov_b64 s[56:57], s[58:59]
    s_lshl_b32 s67, s12, 8
    s_lshl_b32 s40, s13, 6
    s_add_u32 s67, s67, s40
    s_mul_i32 s92, s12, 147456
    s_xor_b32 s94, s13, 0
    s_mul_i32 s94, s94, 36864
    s_add_u32 s94, s94, s92
    s_lshl_b32 s74, s13, 7
    s_add_u32 s94, s94, s74
    s_add_u32 s78, s94, 0
    s_mov_b64 s[8:9], s[56:57]
    v_mov_b32 v58, v49
    s_mov_b32 s79, 9216
    s_mov_b32 s81, 0
    s_add_u32 s80, s66, 0
    s_mov_b32 s76, 0
    s_mov_b32 s77, 8192
    s_call_b64 s[82:83], cf_dma
    s_mov_b32 s77, 16384
    s_call_b64 s[82:83], cf_dma
    s_xor_b32 s94, s13, 1
    s_mul_i32 s94, s94, 36864
    s_add_u32 s94, s94, s92
    s_lshl_b32 s74, s13, 7
    s_add_u32 s94, s94, s74
    s_add_u32 s78, s94, 0
    s_add_u32 s80, s66, 16384
    s_mov_b32 s76, 0
    s_mov_b32 s77, 8192
    s_call_b64 s[82:83], cf_dma
    s_mov_b32 s77, 16384
    s_call_b64 s[82:83], cf_dma
    s_xor_b32 s94, s13, 2
    s_mul_i32 s94, s94, 36864
    s_add_u32 s94, s94, s92
    s_lshl_b32 s74, s13, 7
    s_add_u32 s94, s94, s74
    s_add_u32 s78, s94, 0
    s_add_u32 s80, s66, 32768
    s_mov_b32 s76, 0
    s_mov_b32 s77, 8192
    s_call_b64 s[82:83], cf_dma
    v_lshrrev_b32 v24, 6, v0
    v_lshlrev_b32 v61, 4, v0
    v_add_u32 v62, 57344, v61
    v_xor_b32 v63, 1024, v61
    v_add_u32 v63, 98304, v63
    v_xor_b32 v64, 2048, v61
    v_add_u32 v64, 98304, v64
    v_and_b32 v65, 1023, v61
    v_add_u32 v65, 98304, v65
    v_and_b32 v26, 15, v0
    v_bfe_u32 v27, v0, 4, 2
    v_mov_b32 v60, 0x4444
    v_mov_b32 v25, 0xeeee
    v_cmp_lt_u32 vcc, 7, v26
    s_nop 1
    v_cndmask_b32 v60, v60, v25, vcc
    s_mov_b32 s77, 16384
    s_call_b64 s[82:83], cf_dma
    v_and_b32 v67, 12, v26
    v_lshlrev_b32 v67, 3, v67
    v_and_b32 v25, 1, v26
    v_lshl_add_u32 v67, v25, 4, v67
    v_bfe_u32 v25, v26, 1, 1
    v_lshl_add_u32 v67, v25, 3, v67
    v_lshl_add_u32 v66, v27, 14, v67
    v_lshl_add_u32 v66, v24, 17, v66
    s_xor_b32 s94, s13, 3
    s_mul_i32 s94, s94, 36864
    s_add_u32 s94, s94, s92
    s_lshl_b32 s74, s13, 7
    s_add_u32 s94, s94, s74
    s_add_u32 s78, s94, 0
    s_add_u32 s80, s66, 49152
    s_mov_b32 s76, 0
    s_mov_b32 s77, 8192
    s_call_b64 s[82:83], cf_dma
    v_and_b32 v67, 63, v67
    v_lshrrev_b32 v25, 1, v24
    v_lshl_add_u32 v67, v25, 18, v67
    v_lshl_add_u32 v67, v27, 16, v67
    v_lshrrev_b32 v25, 3, v26
    v_lshl_add_u32 v67, v25, 15, v67
    v_and_b32 v25, 1, v24
    v_lshl_add_u32 v67, v25, 6, v67
    s_mov_b32 s77, 16384
    s_call_b64 s[82:83], cf_dma
    v_and_b32 v25, 31, v0
    v_lshlrev_b32 v70, 4, v25
    v_lshlrev_b32 v28, 3, v25
    v_lshl_add_u32 v28, v24, 10, v28
    v_add_u32 v28, 110592, v28
    v_lshrrev_b32 v25, 1, v24
    v_lshl_add_u32 v70, v25, 9, v70
    v_and_b32 v25, 1, v24
    v_lshl_add_u32 v70, v25, 3, v70
    v_add_u32 v70, 109568, v70
    v_cmp_gt_u32 vcc, 2, v27
    s_nop 1
    v_cndmask_b32 v70, v70, v28, vcc
    v_xor_b32 v71, 2048, v63
    v_lshrrev_b32 v68, 4, v0
    v_lshlrev_b32 v68, 7, v68
    v_and_b32 v25, 7, v26
    v_lshl_add_u32 v68, v25, 4, v68
    v_add_u32 v68, 98304, v68
    v_xor_b32 v74, 512, v68
    v_xor_b32 v75, 1024, v68
    v_xor_b32 v76, 1536, v68
    v_lshrrev_b32 v25, 3, v26
    v_lshl_add_u32 v77, v25, 3, v68
    v_or_b32 v78, 512, v65
    v_lshlrev_b32 v79, 2, v61
    v_mov_b64 v[72:73], 0
    v_and_b32 v25, 1, v27
    v_lshlrev_b32 v69, 7, v25
    v_lshrrev_b32 v25, 1, v27
    v_lshl_add_u32 v69, v25, 3, v69
    v_and_b32 v25, 3, v26
    v_lshl_add_u32 v69, v25, 4, v69
    v_bfe_u32 v25, v26, 2, 1
    v_lshl_add_u32 v69, v25, 2, v69
    s_mov_b32 s32, 0x00ff00ff
    s_mov_b32 s33, 0x00ff00ff
    s_not_b64 s[34:35], s[32:33]
    s_lshr_b32 s31, s12, 1
    s_lshl_b32 s31, s31, 8
    s_and_b32 s40, s12, 1
    s_lshl_b32 s40, s40, 6
    s_add_u32 s31, s31, s40
    s_and_b32 s40, s13, 1
    s_lshl_b32 s40, s40, 12
    s_add_u32 s31, s31, s40
    s_lshl_b32 s19, s12, 14
    s_add_u32 s19, s19, 67076096
    s_add_u32 s41, s19, 8192
    s_add_u32 s19, s19, s40
    s_and_b32 s40, s12, 1
    s_lshl_b32 s40, s40, 2
    s_or_b32 s40, s40, s13
    s_cmp_eq_u32 s40, 5
    s_cselect_b32 s64, 0, s13
    s_cmp_lg_u32 s13, 1
    s_cbranch_scc1 cf_notx
    s_mov_b32 s32, 0xff
    s_mov_b32 s33, 0xff
    s_mov_b32 s19, s41
    s_lshr_b32 s31, s12, 3
    s_lshl_b32 s31, s31, 8
    s_and_b32 s40, s12, 2
    s_lshl_b32 s40, s40, 6
    s_add_u32 s31, s31, s40
    s_and_b32 s40, s12, 4
    s_lshl_b32 s40, s40, 4
    s_add_u32 s31, s31, s40
    s_add_u32 s31, s31, 8192
cf_notx:
    s_cmp_lg_u32 s13, 0
    s_cbranch_scc1 cf_notp
    s_min_u32 s40, s12, 23
    s_mul_i32 s40, s40, 384
    s_add_u32 s40, s40, 98304
    v_add_u32 v69, s40, v61
    v_mov_b32 v25, 108288
    v_cmp_lt_u32 vcc, 23, v0
    s_nop 1
    v_cndmask_b32 v69, v69, v25, vcc
cf_notp:
    s_nop 1
    v_mov_b32 v28, 1
    v_mov_b32 v29, 1
    v_mov_b32 v30, 1
    v_mov_b32 v31, 1
    s_lshl_b32 s40, s12, 14
    s_add_u32 s40, s40, 67174400
    s_add_u32 s41, s40, 0
    buffer_store_dwordx4 v[28:31], v61, s[4:7], s41 offen
    s_add_u32 s41, s40, 4096
    buffer_store_dwordx4 v[28:31], v61, s[4:7], s41 offen
    s_add_u32 s41, s40, 8192
    buffer_store_dwordx4 v[28:31], v61, s[4:7], s41 offen
    s_cmp_eq_u32 s64, 0
    s_cselect_b64 exec, 0, s[32:33]
    v_mov_b32 v27, -1
    s_add_u32 s41, s31, 67108864
    buffer_store_dword v27, v69, s[4:7], s41 offen
    s_add_u32 s41, s31, 67125248
    buffer_store_dword v27, v69, s[4:7], s41 offen
    s_add_u32 s41, s31, 67141632
    buffer_store_dword v27, v69, s[4:7], s41 offen
    s_add_u32 s41, s31, 67158016
    buffer_store_dword v27, v69, s[4:7], s41 offen
    s_mov_b64 exec, -1
    s_mov_b64 s[68:69], s[48:49]
    s_mov_b32 s70, 9216
    s_mov_b32 s71, 0x20000
    v_and_b32 v25, 7, v0
    v_mul_u32_u24 v25, 1152, v25
    v_lshrrev_b32 v26, 3, v0
    v_lshl_add_u32 v25, v26, 4, v25
    buffer_load_dwordx4 v[36:39], v25, s[68:71], 0 offen
    buffer_load_dwordx4 v[40:43], v25, s[68:71], 0 offen offset:512
    v_bfe_u32 v25, v0, 2, 3
    v_mul_u32_u24 v25, 1152, v25
    v_lshrrev_b32 v26, 5, v0
    v_lshl_add_u32 v25, v26, 4, v25
    v_and_b32 v26, 3, v0
    v_lshl_add_u32 v25, v26, 2, v25
    buffer_load_dword v44, v25, s[68:71], 0 offen offset:1024
    s_waitcnt vmcnt(15)
    v_add_u32 v55, 0, v52
    ds_read_b64_tr_b16 v[160:161], v55 offset:0
    ds_read_b64_tr_b16 v[162:163], v55 offset:256
    ds_read_b64_tr_b16 v[164:165], v55 offset:4096
    ds_read_b64_tr_b16 v[166:167], v55 offset:4352
    s_xor_b32 s94, s13, 0
    s_mul_i32 s94, s94, 36864
    s_add_u32 s94, s94, s92
    s_lshl_b32 s74, s13, 7
    s_add_u32 s94, s94, s74
    s_add_u32 s78, s94, 512
    s_add_u32 s80, s66, 65536
    s_mov_b32 s76, 0
    s_mov_b32 s77, 8192
    s_call_b64 s[82:83], cf_dma
    ds_read_b64_tr_b16 v[192:193], v55 offset:64
    ds_read_b64_tr_b16 v[194:195], v55 offset:320
    ds_read_b64_tr_b16 v[196:197], v55 offset:4160
    ds_read_b64_tr_b16 v[198:199], v55 offset:4416
    s_mov_b32 s77, 16384
    s_call_b64 s[82:83], cf_dma
    s_waitcnt lgkmcnt(0)
    s_waitcnt vmcnt(15)
    v_add_u32 v55, 16384, v52
    ds_read_b64_tr_b16 v[168:169], v55 offset:0
    ds_read_b64_tr_b16 v[170:171], v55 offset:256
    ds_read_b64_tr_b16 v[172:173], v55 offset:4096
    ds_read_b64_tr_b16 v[174:175], v55 offset:4352
    s_xor_b32 s94, s13, 1
    s_mul_i32 s94, s94, 36864
    s_add_u32 s94, s94, s92
    s_lshl_b32 s74, s13, 7
    s_add_u32 s94, s94, s74
    s_add_u32 s78, s94, 512
    s_add_u32 s80, s66, 0
    s_mov_b32 s76, 0
    s_mov_b32 s77, 8192
    s_call_b64 s[82:83], cf_dma
    ds_read_b64_tr_b16 v[200:201], v55 offset:64
    ds_read_b64_tr_b16 v[202:203], v55 offset:320
    ds_read_b64_tr_b16 v[204:205], v55 offset:4160
    ds_read_b64_tr_b16 v[206:207], v55 offset:4416
    s_mov_b32 s77, 16384
    s_call_b64 s[82:83], cf_dma
    s_waitcnt lgkmcnt(0)
    s_waitcnt vmcnt(15)
    v_add_u32 v55, 32768, v52
    ds_read_b64_tr_b16 v[176:177], v55 offset:0
    ds_read_b64_tr_b16 v[178:179], v55 offset:256
    ds_read_b64_tr_b16 v[180:181], v55 offset:4096
    ds_read_b64_tr_b16 v[182:183], v55 offset:4352
    s_xor_b32 s78, s75, 0
    s_add_u32 s78, s78, s67
    s_mov_b64 s[8:9], s[54:55]
    v_mov_b32 v58, v48
    s_mov_b32 s79, 131072
    s_mov_b32 s81, s93
    s_add_u32 s80, s66, 81920
    s_mov_b32 s76, 0
    s_mov_b32 s77, 8192
    s_call_b64 s[82:83], cf_dma
    ds_read_b64_tr_b16 v[208:209], v55 offset:64
    ds_read_b64_tr_b16 v[210:211], v55 offset:320
    ds_read_b64_tr_b16 v[212:213], v55 offset:4160
    ds_read_b64_tr_b16 v[214:215], v55 offset:4416
    s_mov_b32 s77, 16384
    s_call_b64 s[82:83], cf_dma
    s_waitcnt lgkmcnt(0)
    s_waitcnt vmcnt(15)
    v_add_u32 v55, 49152, v52
    ds_read_b64_tr_b16 v[184:185], v55 offset:0
    ds_read_b64_tr_b16 v[186:187], v55 offset:256
    ds_read_b64_tr_b16 v[188:189], v55 offset:4096
    ds_read_b64_tr_b16 v[190:191], v55 offset:4352
    s_mov_b32 s77, 24576
    s_call_b64 s[82:83], cf_dma
    ds_read_b64_tr_b16 v[216:217], v55 offset:64
    ds_read_b64_tr_b16 v[218:219], v55 offset:320
    ds_read_b64_tr_b16 v[220:221], v55 offset:4160
    ds_read_b64_tr_b16 v[222:223], v55 offset:4416
    s_mov_b32 s77, 32768
    s_call_b64 s[82:83], cf_dma
    s_waitcnt lgkmcnt(0)
    s_waitcnt vmcnt(12)
    v_add_u32 v55, 65536, v52
    ds_read_b64_tr_b16 v[224:225], v55 offset:0
    ds_read_b64_tr_b16 v[226:227], v55 offset:256
    ds_read_b64_tr_b16 v[228:229], v55 offset:4096
    ds_read_b64_tr_b16 v[230:231], v55 offset:4352
    s_xor_b32 s78, s75, 1048576
    s_add_u32 s78, s78, s67
    s_add_u32 s80, s66, 16384
    s_mov_b32 s76, 0
    s_mov_b32 s77, 8192
    s_call_b64 s[82:83], cf_dma
    ds_read_b64_tr_b16 v[240:241], v55 offset:64
    ds_read_b64_tr_b16 v[242:243], v55 offset:320
    ds_read_b64_tr_b16 v[244:245], v55 offset:4160
    ds_read_b64_tr_b16 v[246:247], v55 offset:4416
    s_mov_b32 s77, 16384
    s_call_b64 s[82:83], cf_dma
    s_waitcnt lgkmcnt(0)
    v_min_u32 v36, -2, v36
    v_min_u32 v37, -2, v37
    v_min_u32 v38, -2, v38
    v_min_u32 v39, -2, v39
    v_min_u32 v40, -2, v40
    v_min_u32 v41, -2, v41
    v_min_u32 v42, -2, v42
    v_min_u32 v43, -2, v43
    v_min_u32 v44, -2, v44
    s_lshl_b32 s14, s12, 16
    s_add_u32 s14, s14, 92274688
    s_add_u32 s41, s14, 4096
    s_add_u32 s42, s14, 8192
    v_lshrrev_b32 v45, 2, v61
    buffer_store_dwordx4 v[36:39], v61, s[4:7], s14 offen
    buffer_store_dwordx4 v[40:43], v61, s[4:7], s41 offen
    buffer_store_dword v44, v45, s[4:7], s42 offen
    v_mov_b32 v46, 1
    s_mov_b64 exec, 1
    buffer_atomic_add v46, off, s[96:99], 0 offset:132 sc0
    s_mov_b64 exec, -1
    s_waitcnt vmcnt(13)
    v_add_u32 v55, 0, v52
    ds_read_b64_tr_b16 v[232:233], v55 offset:0
    ds_read_b64_tr_b16 v[234:235], v55 offset:256
    ds_read_b64_tr_b16 v[236:237], v55 offset:4096
    ds_read_b64_tr_b16 v[238:239], v55 offset:4352
    s_mov_b32 s77, 24576
    s_call_b64 s[82:83], cf_dma
    ds_read_b64_tr_b16 v[248:249], v55 offset:64
    ds_read_b64_tr_b16 v[250:251], v55 offset:320
    ds_read_b64_tr_b16 v[252:253], v55 offset:4160
    ds_read_b64_tr_b16 v[254:255], v55 offset:4416
    s_mov_b32 s77, 32768
    s_call_b64 s[82:83], cf_dma
    s_waitcnt lgkmcnt(0)
    s_waitcnt vmcnt(9)
    v_add_u32 v55, 81920, v51
    v_xor_b32 v56, 32, v55
    ds_read_b64_tr_b16 a[192:193], v55 offset:0
    ds_read_b64_tr_b16 a[194:195], v55 offset:256
    ds_read_b64_tr_b16 a[196:197], v55 offset:8192
    ds_read_b64_tr_b16 a[198:199], v55 offset:8448
    s_xor_b32 s78, s75, 2097152
    s_add_u32 s78, s78, s67
    s_add_u32 s80, s66, 49152
    s_mov_b32 s76, 0
    s_mov_b32 s77, 8192
    s_call_b64 s[82:83], cf_dma
    ds_read_b64_tr_b16 a[200:201], v56 offset:0
    ds_read_b64_tr_b16 a[202:203], v56 offset:256
    ds_read_b64_tr_b16 a[204:205], v56 offset:8192
    ds_read_b64_tr_b16 a[206:207], v56 offset:8448
    s_mov_b32 s77, 16384
    s_call_b64 s[82:83], cf_dma
    s_waitcnt lgkmcnt(0)
    v_add_u32 v55, 98304, v51
    v_xor_b32 v56, 32, v55
    ds_read_b64_tr_b16 a[208:209], v55 offset:0
    ds_read_b64_tr_b16 a[210:211], v55 offset:256
    ds_read_b64_tr_b16 a[212:213], v55 offset:8192
    ds_read_b64_tr_b16 a[214:215], v55 offset:8448
    s_mov_b32 s77, 24576
    s_call_b64 s[82:83], cf_dma
    ds_read_b64_tr_b16 a[216:217], v56 offset:0
    ds_read_b64_tr_b16 a[218:219], v56 offset:256
    ds_read_b64_tr_b16 a[220:221], v56 offset:8192
    ds_read_b64_tr_b16 a[222:223], v56 offset:8448
    s_mov_b32 s77, 32768
    s_call_b64 s[82:83], cf_dma
    s_waitcnt lgkmcnt(0)
    s_waitcnt vmcnt(8)
    v_add_u32 v55, 16384, v51
    v_xor_b32 v56, 32, v55
    ds_read_b64_tr_b16 a[224:225], v55 offset:0
    ds_read_b64_tr_b16 a[226:227], v55 offset:256
    ds_read_b64_tr_b16 a[228:229], v55 offset:8192
    ds_read_b64_tr_b16 a[230:231], v55 offset:8448
    s_xor_b32 s78, s75, 3145728
    s_add_u32 s78, s78, s67
    s_add_u32 s80, s66, 81920
    s_mov_b32 s76, 0
    s_mov_b32 s77, 8192
    s_call_b64 s[82:83], cf_dma
    ds_read_b64_tr_b16 a[232:233], v56 offset:0
    ds_read_b64_tr_b16 a[234:235], v56 offset:256
    ds_read_b64_tr_b16 a[236:237], v56 offset:8192
    ds_read_b64_tr_b16 a[238:239], v56 offset:8448
    s_mov_b32 s77, 16384
    s_call_b64 s[82:83], cf_dma
    s_waitcnt lgkmcnt(0)
    v_add_u32 v55, 32768, v51
    v_xor_b32 v56, 32, v55
    ds_read_b64_tr_b16 a[240:241], v55 offset:0
    ds_read_b64_tr_b16 a[242:243], v55 offset:256
    ds_read_b64_tr_b16 a[244:245], v55 offset:8192
    ds_read_b64_tr_b16 a[246:247], v55 offset:8448
    s_mov_b32 s77, 24576
    s_call_b64 s[82:83], cf_dma
    ds_read_b64_tr_b16 a[248:249], v56 offset:0
    ds_read_b64_tr_b16 a[250:251], v56 offset:256
    ds_read_b64_tr_b16 a[252:253], v56 offset:8192
    ds_read_b64_tr_b16 a[254:255], v56 offset:8448
    s_mov_b32 s77, 32768
    s_call_b64 s[82:83], cf_dma
    s_waitcnt lgkmcnt(0)
    v_readfirstlane_b32 s41, v46
    v_mov_b32 v36, 1
    v_mov_b32 v37, 0
    s_cmp_eq_u32 s41, 127
    s_cselect_b64 exec, 1, 0
    buffer_atomic_cmpswap v[36:37], off, s[96:99], 0 offset:140
    s_mov_b64 exec, -1
    s_waitcnt vmcnt(8)
    v_add_u32 v55, 49152, v51
    v_xor_b32 v56, 32, v55
    ds_read_b64_tr_b16 v[80:81], v55 offset:0
    ds_read_b64_tr_b16 v[82:83], v55 offset:256
    ds_read_b64_tr_b16 v[84:85], v55 offset:8192
    ds_read_b64_tr_b16 v[86:87], v55 offset:8448
    s_add_u32 s78, s67, 4194304
    s_mov_b32 s81, 0
    s_add_u32 s80, s66, 0
    s_mov_b32 s76, 0
    s_mov_b32 s77, 8192
    s_call_b64 s[82:83], cf_dma
    ds_read_b64_tr_b16 v[88:89], v56 offset:0
    ds_read_b64_tr_b16 v[90:91], v56 offset:256
    ds_read_b64_tr_b16 v[92:93], v56 offset:8192
    ds_read_b64_tr_b16 v[94:95], v56 offset:8448
    s_mov_b32 s77, 16384
    s_call_b64 s[82:83], cf_dma
    s_waitcnt lgkmcnt(0)
    v_add_u32 v55, 65536, v51
    v_xor_b32 v56, 32, v55
    ds_read_b64_tr_b16 v[96:97], v55 offset:0
    ds_read_b64_tr_b16 v[98:99], v55 offset:256
    ds_read_b64_tr_b16 v[100:101], v55 offset:8192
    ds_read_b64_tr_b16 v[102:103], v55 offset:8448
    s_xor_b32 s78, s75, 2097152
    s_add_u32 s78, s78, s67
    s_mov_b64 s[8:9], s[52:53]
    s_mov_b32 s81, s93
    s_add_u32 s80, s66, 16384
    s_mov_b32 s76, 0
    s_mov_b32 s77, 8192
    s_call_b64 s[82:83], cf_dma
    ds_read_b64_tr_b16 v[104:105], v56 offset:0
    ds_read_b64_tr_b16 v[106:107], v56 offset:256
    ds_read_b64_tr_b16 v[108:109], v56 offset:8192
    ds_read_b64_tr_b16 v[110:111], v56 offset:8448
    s_mov_b32 s77, 16384
    s_call_b64 s[82:83], cf_dma
    s_waitcnt lgkmcnt(0)
    s_waitcnt vmcnt(8)
    v_add_u32 v55, 81920, v51
    v_xor_b32 v56, 32, v55
    ds_read_b64_tr_b16 v[112:113], v55 offset:0
    ds_read_b64_tr_b16 v[114:115], v55 offset:256
    ds_read_b64_tr_b16 v[116:117], v55 offset:8192
    ds_read_b64_tr_b16 v[118:119], v55 offset:8448
    s_mov_b32 s77, 24576
    s_call_b64 s[82:83], cf_dma
    ds_read_b64_tr_b16 v[120:121], v56 offset:0
    ds_read_b64_tr_b16 v[122:123], v56 offset:256
    ds_read_b64_tr_b16 v[124:125], v56 offset:8192
    ds_read_b64_tr_b16 v[126:127], v56 offset:8448
    s_mov_b32 s77, 32768
    s_call_b64 s[82:83], cf_dma
    s_waitcnt lgkmcnt(0)
    v_add_u32 v55, 98304, v51
    v_xor_b32 v56, 32, v55
    ds_read_b64_tr_b16 v[128:129], v55 offset:0
    ds_read_b64_tr_b16 v[130:131], v55 offset:256
    ds_read_b64_tr_b16 v[132:133], v55 offset:8192
    ds_read_b64_tr_b16 v[134:135], v55 offset:8448
    s_xor_b32 s78, s75, 3145728
    s_add_u32 s78, s78, s67
    s_add_u32 s80, s66, 114688
    s_mov_b32 s76, 0
    s_mov_b32 s77, 8192
    s_call_b64 s[82:83], cf_dma
    ds_read_b64_tr_b16 v[136:137], v56 offset:0
    ds_read_b64_tr_b16 v[138:139], v56 offset:256
    ds_read_b64_tr_b16 v[140:141], v56 offset:8192
    ds_read_b64_tr_b16 v[142:143], v56 offset:8448
    s_mov_b32 s77, 16384
    s_call_b64 s[82:83], cf_dma
    s_waitcnt lgkmcnt(0)
    s_waitcnt vmcnt(12)
    v_add_u32 v55, 0, v51
    v_xor_b32 v56, 32, v55
    ds_read_b64_tr_b16 v[144:145], v55 offset:0
    ds_read_b64_tr_b16 v[146:147], v55 offset:256
    ds_read_b64_tr_b16 v[148:149], v55 offset:8192
    ds_read_b64_tr_b16 v[150:151], v55 offset:8448
    s_mov_b32 s77, 24576
    s_call_b64 s[82:83], cf_dma
    ds_read_b64_tr_b16 v[152:153], v56 offset:0
    ds_read_b64_tr_b16 v[154:155], v56 offset:256
    ds_read_b64_tr_b16 v[156:157], v56 offset:8192
    ds_read_b64_tr_b16 v[158:159], v56 offset:8448
    s_mov_b32 s77, 32768
    s_call_b64 s[82:83], cf_dma
    s_waitcnt lgkmcnt(0)
    s_waitcnt vmcnt(8)
    v_add_u32 v55, 16384, v51
    v_xor_b32 v56, 32, v55
    ds_read_b64_tr_b16 a[128:129], v55 offset:0
    ds_read_b64_tr_b16 a[130:131], v55 offset:256
    ds_read_b64_tr_b16 a[132:133], v55 offset:8192
    ds_read_b64_tr_b16 a[134:135], v55 offset:8448
    s_xor_b32 s78, s75, 2097152
    s_add_u32 s78, s78, s67
    s_mov_b64 s[8:9], s[50:51]
    s_add_u32 s80, s66, 49152
    s_mov_b32 s76, 0
    s_mov_b32 s77, 8192
    s_call_b64 s[82:83], cf_dma
    ds_read_b64_tr_b16 a[136:137], v56 offset:0
    ds_read_b64_tr_b16 a[138:139], v56 offset:256
    ds_read_b64_tr_b16 a[140:141], v56 offset:8192
    ds_read_b64_tr_b16 a[142:143], v56 offset:8448
    s_mov_b32 s77, 16384
    s_call_b64 s[82:83], cf_dma
    s_waitcnt lgkmcnt(0)
    v_add_u32 v55, 32768, v51
    v_xor_b32 v56, 32, v55
    ds_read_b64_tr_b16 a[144:145], v55 offset:0
    ds_read_b64_tr_b16 a[146:147], v55 offset:256
    ds_read_b64_tr_b16 a[148:149], v55 offset:8192
    ds_read_b64_tr_b16 a[150:151], v55 offset:8448
    s_mov_b32 s77, 24576
    s_call_b64 s[82:83], cf_dma
    ds_read_b64_tr_b16 a[152:153], v56 offset:0
    ds_read_b64_tr_b16 a[154:155], v56 offset:256
    ds_read_b64_tr_b16 a[156:157], v56 offset:8192
    ds_read_b64_tr_b16 a[158:159], v56 offset:8448
    s_mov_b32 s77, 32768
    s_call_b64 s[82:83], cf_dma
    s_waitcnt lgkmcnt(0)
    s_waitcnt vmcnt(8)
    v_add_u32 v55, 114688, v51
    v_xor_b32 v56, 32, v55
    ds_read_b64_tr_b16 a[160:161], v55 offset:0
    ds_read_b64_tr_b16 a[162:163], v55 offset:256
    ds_read_b64_tr_b16 a[164:165], v55 offset:8192
    ds_read_b64_tr_b16 a[166:167], v55 offset:8448
    s_xor_b32 s78, s75, 3145728
    s_add_u32 s78, s78, s67
    s_add_u32 s80, s66, 0
    s_mov_b32 s76, 0
    s_mov_b32 s77, 8192
    s_call_b64 s[82:83], cf_dma
    ds_read_b64_tr_b16 a[168:169], v56 offset:0
    ds_read_b64_tr_b16 a[170:171], v56 offset:256
    ds_read_b64_tr_b16 a[172:173], v56 offset:8192
    ds_read_b64_tr_b16 a[174:175], v56 offset:8448
    s_mov_b32 s77, 16384
    s_call_b64 s[82:83], cf_dma
    s_waitcnt lgkmcnt(0)
    v_add_u32 v55, 131072, v51
    v_xor_b32 v56, 32, v55
    ds_read_b64_tr_b16 a[176:177], v55 offset:0
    ds_read_b64_tr_b16 a[178:179], v55 offset:256
    ds_read_b64_tr_b16 a[180:181], v55 offset:8192
    ds_read_b64_tr_b16 a[182:183], v55 offset:8448
    s_mov_b32 s77, 24576
    s_call_b64 s[82:83], cf_dma
    ds_read_b64_tr_b16 a[184:185], v56 offset:0
    ds_read_b64_tr_b16 a[186:187], v56 offset:256
    ds_read_b64_tr_b16 a[188:189], v56 offset:8192
    ds_read_b64_tr_b16 a[190:191], v56 offset:8448
    s_mov_b32 s77, 32768
    s_call_b64 s[82:83], cf_dma
    s_waitcnt lgkmcnt(0)
    s_waitcnt vmcnt(8)
    v_add_u32 v55, 49152, v51
    v_xor_b32 v56, 32, v55
    ds_read_b64_tr_b16 a[48:49], v55 offset:0
    ds_read_b64_tr_b16 a[50:51], v55 offset:256
    ds_read_b64_tr_b16 a[52:53], v55 offset:8192
    ds_read_b64_tr_b16 a[54:55], v55 offset:8448
    s_add_u32 s78, s67, 4194304
    s_mov_b32 s81, 0
    s_add_u32 s80, s66, 98304
    s_mov_b32 s76, 0
    s_mov_b32 s77, 8192
    s_call_b64 s[82:83], cf_dma
    ds_read_b64_tr_b16 a[56:57], v56 offset:0
    ds_read_b64_tr_b16 a[58:59], v56 offset:256
    ds_read_b64_tr_b16 a[60:61], v56 offset:8192
    ds_read_b64_tr_b16 a[62:63], v56 offset:8448
    s_mov_b32 s77, 16384
    s_call_b64 s[82:83], cf_dma
    s_waitcnt lgkmcnt(0)
    v_add_u32 v55, 65536, v51
    v_xor_b32 v56, 32, v55
    ds_read_b64_tr_b16 a[64:65], v55 offset:0
    ds_read_b64_tr_b16 a[66:67], v55 offset:256
    ds_read_b64_tr_b16 a[68:69], v55 offset:8192
    ds_read_b64_tr_b16 a[70:71], v55 offset:8448
    s_xor_b32 s78, s75, 1048576
    s_add_u32 s78, s78, s67
    s_mov_b32 s81, s93
    s_add_u32 s80, s66, 114688
    s_mov_b32 s76, 0
    s_mov_b32 s77, 8192
    s_call_b64 s[82:83], cf_dma
    ds_read_b64_tr_b16 a[72:73], v56 offset:0
    ds_read_b64_tr_b16 a[74:75], v56 offset:256
    ds_read_b64_tr_b16 a[76:77], v56 offset:8192
    ds_read_b64_tr_b16 a[78:79], v56 offset:8448
    s_mov_b32 s77, 16384
    s_call_b64 s[82:83], cf_dma
    s_waitcnt lgkmcnt(0)
    s_waitcnt vmcnt(8)
    v_add_u32 v55, 0, v51
    v_xor_b32 v56, 32, v55
    ds_read_b64_tr_b16 a[80:81], v55 offset:0
    ds_read_b64_tr_b16 a[82:83], v55 offset:256
    ds_read_b64_tr_b16 a[84:85], v55 offset:8192
    ds_read_b64_tr_b16 a[86:87], v55 offset:8448
    s_mov_b32 s77, 24576
    s_call_b64 s[82:83], cf_dma
    ds_read_b64_tr_b16 a[88:89], v56 offset:0
    ds_read_b64_tr_b16 a[90:91], v56 offset:256
    ds_read_b64_tr_b16 a[92:93], v56 offset:8192
    ds_read_b64_tr_b16 a[94:95], v56 offset:8448
    s_mov_b32 s77, 32768
    s_call_b64 s[82:83], cf_dma
    s_waitcnt lgkmcnt(0)
    v_add_u32 v55, 16384, v51
    v_xor_b32 v56, 32, v55
    ds_read_b64_tr_b16 a[96:97], v55 offset:0
    ds_read_b64_tr_b16 a[98:99], v55 offset:256
    ds_read_b64_tr_b16 a[100:101], v55 offset:8192
    ds_read_b64_tr_b16 a[102:103], v55 offset:8448
    s_xor_b32 s78, s75, 0
    s_add_u32 s78, s78, s67
    s_add_u32 s80, s66, 65536
    s_mov_b32 s76, 0
    s_mov_b32 s77, 8192
    s_call_b64 s[82:83], cf_dma
    ds_read_b64_tr_b16 a[104:105], v56 offset:0
    ds_read_b64_tr_b16 a[106:107], v56 offset:256
    ds_read_b64_tr_b16 a[108:109], v56 offset:8192
    ds_read_b64_tr_b16 a[110:111], v56 offset:8448
    s_mov_b32 s77, 16384
    s_call_b64 s[82:83], cf_dma
    s_waitcnt lgkmcnt(0)
    s_waitcnt vmcnt(12)
    v_add_u32 v55, 98304, v51
    v_xor_b32 v56, 32, v55
    ds_read_b64_tr_b16 a[112:113], v55 offset:0
    ds_read_b64_tr_b16 a[114:115], v55 offset:256
    ds_read_b64_tr_b16 a[116:117], v55 offset:8192
    ds_read_b64_tr_b16 a[118:119], v55 offset:8448
    s_mov_b32 s77, 24576
    s_call_b64 s[82:83], cf_dma
    ds_read_b64_tr_b16 a[120:121], v56 offset:0
    ds_read_b64_tr_b16 a[122:123], v56 offset:256
    ds_read_b64_tr_b16 a[124:125], v56 offset:8192
    ds_read_b64_tr_b16 a[126:127], v56 offset:8448
    s_mov_b32 s77, 32768
    s_call_b64 s[82:83], cf_dma
    s_waitcnt lgkmcnt(0)
    s_waitcnt vmcnt(8)
    v_add_u32 v55, 114688, v51
    v_xor_b32 v56, 32, v55
    ds_read_b64_tr_b16 a[16:17], v55 offset:0
    ds_read_b64_tr_b16 a[18:19], v55 offset:256
    ds_read_b64_tr_b16 a[20:21], v55 offset:8192
    ds_read_b64_tr_b16 a[22:23], v55 offset:8448
    s_xor_b32 s78, s75, 0
    s_add_u32 s78, s78, s67
    s_mov_b64 s[8:9], s[52:53]
    s_add_u32 s80, s66, 0
    s_mov_b32 s76, 0
    s_mov_b32 s77, 8192
    s_call_b64 s[82:83], cf_dma
    ds_read_b64_tr_b16 a[24:25], v56 offset:0
    ds_read_b64_tr_b16 a[26:27], v56 offset:256
    ds_read_b64_tr_b16 a[28:29], v56 offset:8192
    ds_read_b64_tr_b16 a[30:31], v56 offset:8448
    s_mov_b32 s77, 16384
    s_call_b64 s[82:83], cf_dma
    s_waitcnt lgkmcnt(0)
    v_add_u32 v55, 131072, v51
    v_xor_b32 v56, 32, v55
    ds_read_b64_tr_b16 a[32:33], v55 offset:0
    ds_read_b64_tr_b16 a[34:35], v55 offset:256
    ds_read_b64_tr_b16 a[36:37], v55 offset:8192
    ds_read_b64_tr_b16 a[38:39], v55 offset:8448
    s_mov_b32 s77, 24576
    s_call_b64 s[82:83], cf_dma
    ds_read_b64_tr_b16 a[40:41], v56 offset:0
    ds_read_b64_tr_b16 a[42:43], v56 offset:256
    ds_read_b64_tr_b16 a[44:45], v56 offset:8192
    ds_read_b64_tr_b16 a[46:47], v56 offset:8448
    s_mov_b32 s77, 32768
    s_call_b64 s[82:83], cf_dma
    s_waitcnt lgkmcnt(0)
    s_waitcnt vmcnt(8)
    v_add_u32 v55, 65536, v51
    v_xor_b32 v56, 32, v55
    ds_read_b64_tr_b16 v[0:1], v55 offset:0
    ds_read_b64_tr_b16 v[2:3], v55 offset:256
    ds_read_b64_tr_b16 v[4:5], v55 offset:8192
    ds_read_b64_tr_b16 v[6:7], v55 offset:8448
    s_xor_b32 s78, s75, 1048576
    s_add_u32 s78, s78, s67
    s_add_u32 s80, s66, 32768
    s_mov_b32 s76, 0
    s_mov_b32 s77, 8192
    s_call_b64 s[82:83], cf_dma
    ds_read_b64_tr_b16 v[8:9], v56 offset:0
    ds_read_b64_tr_b16 v[10:11], v56 offset:256
    ds_read_b64_tr_b16 v[12:13], v56 offset:8192
    ds_read_b64_tr_b16 v[14:15], v56 offset:8448
    s_mov_b32 s77, 16384
    s_call_b64 s[82:83], cf_dma
    s_waitcnt lgkmcnt(0)
    ds_write_b128 v62, v[0:3] offset:8192
    ds_write_b128 v62, v[4:7] offset:12288
    ds_write_b128 v62, v[8:11] offset:16384
    ds_write_b128 v62, v[12:15] offset:20480
    s_waitcnt lgkmcnt(0)
    v_add_u32 v55, 81920, v51
    v_xor_b32 v56, 32, v55
    ds_read_b64_tr_b16 a[0:1], v55 offset:0
    ds_read_b64_tr_b16 a[2:3], v55 offset:256
    ds_read_b64_tr_b16 a[4:5], v55 offset:8192
    ds_read_b64_tr_b16 a[6:7], v55 offset:8448
    s_mov_b32 s77, 24576
    s_call_b64 s[82:83], cf_dma
    ds_read_b64_tr_b16 a[8:9], v56 offset:0
    ds_read_b64_tr_b16 a[10:11], v56 offset:256
    ds_read_b64_tr_b16 a[12:13], v56 offset:8192
    ds_read_b64_tr_b16 a[14:15], v56 offset:8448
    s_mov_b32 s77, 32768
    s_call_b64 s[82:83], cf_dma
    s_waitcnt lgkmcnt(0)
    s_waitcnt vmcnt(8)
    v_add_u32 v55, 0, v51
    v_xor_b32 v56, 32, v55
    ds_read_b64_tr_b16 v[0:1], v55 offset:0
    ds_read_b64_tr_b16 v[2:3], v55 offset:256
    ds_read_b64_tr_b16 v[4:5], v55 offset:8192
    ds_read_b64_tr_b16 v[6:7], v55 offset:8448
    s_xor_b32 s94, s13, 0
    s_mul_i32 s94, s94, 36864
    s_add_u32 s94, s94, s92
    s_lshr_b32 s74, s13, 1
    s_lshl_b32 s74, s74, 6
    s_add_u32 s94, s94, s74
    s_add_u32 s78, s94, 1024
    s_mov_b64 s[8:9], s[56:57]
    v_mov_b32 v58, v50
    s_mov_b32 s79, 18432
    s_mov_b32 s81, 0
    s_add_u32 s80, s66, 147456
    s_mov_b32 s76, 0
    s_mov_b32 s77, 8192
    s_call_b64 s[82:83], cf_dma
    ds_read_b64_tr_b16 v[8:9], v56 offset:0
    ds_read_b64_tr_b16 v[10:11], v56 offset:256
    ds_read_b64_tr_b16 v[12:13], v56 offset:8192
    ds_read_b64_tr_b16 v[14:15], v56 offset:8448
    s_xor_b32 s94, s13, 2
    s_mul_i32 s94, s94, 36864
    s_add_u32 s94, s94, s92
    s_lshr_b32 s74, s13, 1
    s_lshl_b32 s74, s74, 6
    s_add_u32 s94, s94, s74
    s_add_u32 s78, s94, 1024
    s_mov_b32 s77, 16384
    s_call_b64 s[82:83], cf_dma
    s_waitcnt lgkmcnt(0)
    ds_write_b128 v61, v[0:3] offset:0
    ds_write_b128 v61, v[4:7] offset:4096
    ds_write_b128 v61, v[8:11] offset:8192
    ds_write_b128 v61, v[12:15] offset:12288
    s_waitcnt lgkmcnt(0)
    v_add_u32 v55, 16384, v51
    v_xor_b32 v56, 32, v55
    ds_read_b64_tr_b16 v[0:1], v55 offset:0
    ds_read_b64_tr_b16 v[2:3], v55 offset:256
    ds_read_b64_tr_b16 v[4:5], v55 offset:8192
    ds_read_b64_tr_b16 v[6:7], v55 offset:8448
    s_xor_b32 s94, s13, 3
    s_mul_i32 s94, s94, 36864
    s_add_u32 s94, s94, s92
    s_lshl_b32 s74, s13, 7
    s_add_u32 s94, s94, s74
    s_add_u32 s78, s94, 512
    v_mov_b32 v58, v49
    s_mov_b32 s79, 9216
    s_add_u32 s80, s66, 131072
    s_mov_b32 s76, 0
    s_mov_b32 s77, 8192
    s_call_b64 s[82:83], cf_dma
    ds_read_b64_tr_b16 v[8:9], v56 offset:0
    ds_read_b64_tr_b16 v[10:11], v56 offset:256
    ds_read_b64_tr_b16 v[12:13], v56 offset:8192
    ds_read_b64_tr_b16 v[14:15], v56 offset:8448
    s_mov_b32 s77, 16384
    s_call_b64 s[82:83], cf_dma
    s_waitcnt lgkmcnt(0)
    ds_write_b128 v61, v[0:3] offset:16384
    ds_write_b128 v61, v[4:7] offset:20480
    ds_write_b128 v61, v[8:11] offset:24576
    ds_write_b128 v61, v[12:15] offset:28672
    s_waitcnt lgkmcnt(0)
    s_waitcnt vmcnt(8)
    v_add_u32 v55, 32768, v51
    v_xor_b32 v56, 32, v55
    ds_read_b64_tr_b16 v[0:1], v55 offset:0
    ds_read_b64_tr_b16 v[2:3], v55 offset:256
    ds_read_b64_tr_b16 v[4:5], v55 offset:8192
    ds_read_b64_tr_b16 v[6:7], v55 offset:8448
    s_xor_b32 s94, s13, 2
    s_mul_i32 s94, s94, 36864
    s_add_u32 s94, s94, s92
    s_lshl_b32 s74, s13, 7
    s_add_u32 s94, s94, s74
    s_add_u32 s78, s94, 512
    s_add_u32 s80, s66, 114688
    s_mov_b32 s76, 0
    s_mov_b32 s77, 8192
    s_call_b64 s[82:83], cf_dma
    ds_read_b64_tr_b16 v[8:9], v56 offset:0
    ds_read_b64_tr_b16 v[10:11], v56 offset:256
    ds_read_b64_tr_b16 v[12:13], v56 offset:8192
    ds_read_b64_tr_b16 v[14:15], v56 offset:8448
    s_mov_b32 s77, 16384
    s_call_b64 s[82:83], cf_dma
    s_waitcnt lgkmcnt(0)
    ds_write_b128 v61, v[0:3] offset:32768
    ds_write_b128 v61, v[4:7] offset:36864
    ds_write_b128 v61, v[8:11] offset:40960
    ds_write_b128 v61, v[12:15] offset:45056
    s_waitcnt lgkmcnt(0)
    v_add_u32 v55, 49152, v51
    v_xor_b32 v56, 32, v55
    ds_read_b64_tr_b16 v[0:1], v55 offset:0
    ds_read_b64_tr_b16 v[2:3], v55 offset:256
    ds_read_b64_tr_b16 v[4:5], v55 offset:8192
    ds_read_b64_tr_b16 v[6:7], v55 offset:8448
    s_add_u32 s78, s67, 4194304
    s_mov_b64 s[8:9], s[52:53]
    v_mov_b32 v58, v48
    s_mov_b32 s79, 131072
    s_add_u32 s80, s66, 81920
    s_mov_b32 s76, 0
    s_mov_b32 s77, 8192
    s_call_b64 s[82:83], cf_dma
    ds_read_b64_tr_b16 v[8:9], v56 offset:0
    ds_read_b64_tr_b16 v[10:11], v56 offset:256
    ds_read_b64_tr_b16 v[12:13], v56 offset:8192
    ds_read_b64_tr_b16 v[14:15], v56 offset:8448
    s_mov_b32 s77, 16384
    s_call_b64 s[82:83], cf_dma
    s_waitcnt lgkmcnt(0)
    ds_write_b128 v61, v[0:3] offset:49152
    ds_write_b128 v61, v[4:7] offset:53248
    ds_write_b128 v61, v[8:11] offset:57344
    ds_write_b128 v61, v[12:15] offset:61440
    s_waitcnt lgkmcnt(0)
    buffer_load_dword v38, off, s[96:99], 0 offset:140 sc1
    buffer_load_dword v39, off, s[96:99], 0 offset:144 sc1
    s_lshr_b32 s84, s12, 1
    s_lshl_b32 s84, s84, 8
    s_add_u32 s84, s84, 125829120
    v_bfe_u32 v40, v61, 4, 6
    v_min_u32 v40, 11, v40
    v_lshlrev_b32 v40, 2, v40
    buffer_load_dword v41, v40, s[4:7], s84 offen sc1
    s_waitcnt vmcnt(15)
    v_add_u32 v55, 147456, v53
    ds_read_b64_tr_b16 v[0:1], v55 offset:0
    ds_read_b64_tr_b16 v[2:3], v55 offset:128
    ds_read_b64_tr_b16 v[4:5], v55 offset:512
    ds_read_b64_tr_b16 v[6:7], v55 offset:640
    ds_read_b64_tr_b16 v[8:9], v55 offset:8192
    ds_read_b64_tr_b16 v[10:11], v55 offset:8320
    ds_read_b64_tr_b16 v[12:13], v55 offset:8704
    ds_read_b64_tr_b16 v[14:15], v55 offset:8832
    s_waitcnt lgkmcnt(0)
    s_barrier
    ds_write_b128 v63, v[0:3] offset:49152
    ds_write_b128 v63, v[4:7] offset:53248
    s_barrier
    ds_write_b128 v63, v[8:11] offset:57344
    ds_write_b128 v63, v[12:15] offset:61440
    s_waitcnt lgkmcnt(0)
    s_waitcnt vmcnt(11)
    v_add_u32 v55, 131072, v52
    ds_read_b64_tr_b16 v[0:1], v55 offset:0
    ds_read_b64_tr_b16 v[2:3], v55 offset:256
    ds_read_b64_tr_b16 v[4:5], v55 offset:4096
    ds_read_b64_tr_b16 v[6:7], v55 offset:4352
    ds_read_b64_tr_b16 v[8:9], v55 offset:64
    ds_read_b64_tr_b16 v[10:11], v55 offset:320
    ds_read_b64_tr_b16 v[12:13], v55 offset:4160
    ds_read_b64_tr_b16 v[14:15], v55 offset:4416
    s_waitcnt lgkmcnt(0)
    s_barrier
    ds_write_b128 v63, v[0:3] offset:32768
    ds_write_b128 v63, v[4:7] offset:36864
    s_barrier
    ds_write_b128 v63, v[8:11] offset:40960
    ds_write_b128 v63, v[12:15] offset:45056
    s_waitcnt lgkmcnt(0)
    s_waitcnt vmcnt(7)
    v_add_u32 v55, 114688, v52
    ds_read_b64_tr_b16 v[0:1], v55 offset:0
    ds_read_b64_tr_b16 v[2:3], v55 offset:256
    ds_read_b64_tr_b16 v[4:5], v55 offset:4096
    ds_read_b64_tr_b16 v[6:7], v55 offset:4352
    ds_read_b64_tr_b16 v[8:9], v55 offset:64
    ds_read_b64_tr_b16 v[10:11], v55 offset:320
    ds_read_b64_tr_b16 v[12:13], v55 offset:4160
    ds_read_b64_tr_b16 v[14:15], v55 offset:4416
    s_waitcnt lgkmcnt(0)
    s_barrier
    ds_write_b128 v63, v[0:3] offset:16384
    ds_write_b128 v63, v[4:7] offset:20480
    s_barrier
    ds_write_b128 v63, v[8:11] offset:24576
    ds_write_b128 v63, v[12:15] offset:28672
    s_waitcnt lgkmcnt(0)
    s_waitcnt vmcnt(3)
    v_add_u32 v55, 81920, v51
    v_xor_b32 v56, 32, v55
    ds_read_b64_tr_b16 v[0:1], v55 offset:0
    ds_read_b64_tr_b16 v[2:3], v55 offset:256
    ds_read_b64_tr_b16 v[4:5], v55 offset:8192
    ds_read_b64_tr_b16 v[6:7], v55 offset:8448
    ds_read_b64_tr_b16 v[8:9], v56 offset:0
    ds_read_b64_tr_b16 v[10:11], v56 offset:256
    ds_read_b64_tr_b16 v[12:13], v56 offset:8192
    ds_read_b64_tr_b16 v[14:15], v56 offset:8448
    s_waitcnt lgkmcnt(0)
    ds_write_b128 v62, v[0:3] offset:24576
    ds_write_b128 v62, v[4:7] offset:28672
    ds_write_b128 v62, v[8:11] offset:32768
    ds_write_b128 v62, v[12:15] offset:36864
    s_waitcnt lgkmcnt(0)
    s_barrier
    s_waitcnt vmcnt(0)
    v_readfirstlane_b32 s95, v39
    v_readfirstlane_b32 s85, v38
    s_nop 4
    s_mov_b32 s88, 4194304
gn2:
    s_cmp_lg_u32 s95, 0
    s_cbranch_scc1 gn2x
    buffer_load_dword v24, off, s[96:99], 0 offset:144 sc1
    s_sub_u32 s88, s88, 1
    s_cbranch_scc1 gn2x
    s_waitcnt vmcnt(0)
    v_readfirstlane_b32 s95, v24
    s_nop 1
    s_branch gn2
gn2x:
    s_add_u32 s93, s95, 2
    v_subrev_u32 v41, s93, v41
    v_cmp_lt_u32 s[86:87], 64, v41
    v_bfe_u32 v40, v61, 4, 4
    v_bfe_u32 v41, v61, 8, 1
    v_lshlrev_b32 v41, 2, v41
    v_sub_u32 v41, v40, v41
    v_mov_b32 v42, 0x3f80
    v_mov_b32 v43, 0x3f800000
    v_cmp_eq_u32 vcc, 0, v41
    s_nop 1
    v_cndmask_b32 v32, 0, v42, vcc
    v_cmp_eq_u32 vcc, 1, v41
    s_nop 1
    v_cndmask_b32 v32, v32, v43, vcc
    v_cmp_eq_u32 vcc, 0, v40
    s_nop 1
    v_cndmask_b32 v36, 0, v42, vcc
    v_cmp_eq_u32 vcc, 1, v40
    s_nop 1
    v_cndmask_b32 v36, v36, v43, vcc
    v_cmp_eq_u32 vcc, 2, v41
    s_nop 1
    v_cndmask_b32 v33, 0, v42, vcc
    v_cmp_eq_u32 vcc, 3, v41
    s_nop 1
    v_cndmask_b32 v33, v33, v43, vcc
    v_cmp_eq_u32 vcc, 2, v40
    s_nop 1
    v_cndmask_b32 v37, 0, v42, vcc
    v_cmp_eq_u32 vcc, 3, v40
    s_nop 1
    v_cndmask_b32 v37, v37, v43, vcc
    v_cmp_eq_u32 vcc, 8, v41
    s_nop 1
    v_cndmask_b32 v34, 0, v42, vcc
    v_cmp_eq_u32 vcc, 9, v41
    s_nop 1
    v_cndmask_b32 v34, v34, v43, vcc
    v_cmp_eq_u32 vcc, 4, v40
    s_nop 1
    v_cndmask_b32 v38, 0, v42, vcc
    v_cmp_eq_u32 vcc, 5, v40
    s_nop 1
    v_cndmask_b32 v38, v38, v43, vcc
    v_cmp_eq_u32 vcc, 10, v41
    s_nop 1
    v_cndmask_b32 v35, 0, v42, vcc
    v_cmp_eq_u32 vcc, 11, v41
    s_nop 1
    v_cndmask_b32 v35, v35, v43, vcc
    v_cmp_eq_u32 vcc, 6, v40
    s_nop 1
    v_cndmask_b32 v39, 0, v42, vcc
    v_cmp_eq_u32 vcc, 7, v40
    s_nop 1
    v_cndmask_b32 v39, v39, v43, vcc
    ds_write_b128 v78, v[32:35] offset:8704
    ds_write_b128 v65, v[36:39] offset:10240
    v_mov_b32 v44, s95
    v_mov_b32 v45, s95
    v_mov_b32 v46, s95
    v_mov_b32 v47, s95
    v_mov_b32 v48, 108288
    ds_write_b128 v48, v[44:47]
    s_waitcnt vmcnt(0) lgkmcnt(0)
    s_cmp_eq_u32 s85, 1
    s_cbranch_scc1 cf_run
    s_mov_b32 s40, 131072
cf_startpoll:
    buffer_load_dword v3, off, s[96:99], 0 offset:140 sc1
    s_waitcnt vmcnt(0)
    v_readfirstlane_b32 s85, v3
    s_nop 0
    s_cmp_eq_u32 s85, 1
    s_cbranch_scc1 cf_run
    s_cmp_eq_u32 s85, 2
    s_cbranch_scc1 cf_leave
    s_sleep 1
    s_sub_u32 s40, s40, 1
    s_cbranch_scc0 cf_startpoll
    v_mov_b32 v4, 2
    v_mov_b32 v5, 0
    s_mov_b64 exec, 1
    buffer_atomic_cmpswap v[4:5], off, s[96:99], 0 offset:140
    s_mov_b64 exec, -1
    s_mov_b32 s40, 1048576
    s_branch cf_startpoll
cf_leave:
    v_lshrrev_b32 v0, 4, v61
    s_mov_b32 s32, s13
    s_load_dwordx16 s[48:63], s[0:1], 0
    s_waitcnt lgkmcnt(0)
    s_branch L_helper
cf_run:
    s_cmp_eq_u64 s[86:87], 0
    s_cbranch_scc1 cf_kv0_go
    s_lshr_b32 s92, s12, 1
    s_lshl_b32 s92, s92, 8
    s_add_u32 s92, s92, 125829120
    v_bfe_u32 v2, v61, 4, 6
    v_min_u32 v2, 11, v2
    v_lshlrev_b32 v2, 2, v2
    s_add_u32 s93, s95, 2
    s_mov_b32 s94, 4194304
cf_kv0:
    buffer_load_dword v3, v2, s[4:7], s92 offen sc1
    s_sub_u32 s94, s94, 1
    s_cbranch_scc1 cf_kv0_go
    s_waitcnt vmcnt(0)
    v_subrev_u32 v3, s93, v3
    v_cmp_lt_u32 vcc, 64, v3
    s_cbranch_vccz cf_kv0_go
    s_sleep 2
    s_branch cf_kv0
cf_kv0_go:
    s_mov_b32 s44, 0x3e0293ee
    s_mov_b32 s45, s44
    s_mov_b32 s46, 0x42000000
    s_mov_b32 s47, 128
    s_mov_b32 s60, 0x3f803f80
    s_mov_b32 s61, s60
    s_mov_b32 s62, 0x3e803e80
    s_mov_b32 s63, s62
    s_mov_b32 s28, 0
    s_lshl_b32 s24, s12, 14
    s_add_u32 s24, s24, 0
    s_add_u32 s66, s24, 33030144
    s_mul_i32 s40, s13, 3072
    s_add_u32 s23, s24, s40
    s_lshl_b32 s20, s12, 7
    s_add_u32 s20, s20, 67174400
    s_add_u32 s21, s20, 65536
    s_add_u32 s38, s20, 4096
    s_add_u32 s39, s21, 4096
    s_lshl_b32 s22, s12, 7
    s_add_u32 s22, s22, 67182592
    s_lshl_b32 s40, s12, 12
    s_add_u32 s25, s40, 79429632
    s_add_u32 s26, s40, 88866816
    s_lshl_b32 s65, s12, 9
    s_add_u32 s65, s65, 90177536
    s_lshl_b32 s40, s13, 5
    s_or_b32 s40, s40, s12
    s_cmp_lt_u32 s40, 24
    s_cselect_b32 s36, 0x1ffffff, 0
    s_mov_b32 s37, 0
    s_lshl_b32 s27, s12, 7
    s_add_u32 s27, s27, 125845504
    s_lshl_b32 s40, s13, 2
    s_add_u32 s27, s27, s40
    s_mov_b32 m0, 108032
    v_lshlrev_b32 v56, 2, v61
    buffer_load_dword v56, s[4:7], s24 offen sc1 lds
    s_add_u32 s24, s24, 524288
    buffer_load_dword v56, s[4:7], s24 offen sc1 lds
    s_add_u32 s24, s24, 524288
    v_lshlrev_b32 v56, 2, v61
    s_lshl_b32 s40, s12, 14
    s_add_u32 s40, s40, 67174400
    buffer_load_dword v56, s[4:7], s40 offen sc1 lds
    s_and_b32 s40, s12, 3
    s_lshl_b32 s40, s40, 14
    s_add_u32 s40, s40, 67108864
    buffer_load_dword v56, s[4:7], s40 offen sc1 lds
    s_add_u32 s15, s14, 4096
    s_add_u32 s16, s14, 8192
    ds_read_b128 v[32:35], v62 offset:16384
    ds_read_b128 v[36:39], v62 offset:20480
    ds_read_b128 v[40:43], v61 offset:0
    ds_read_b128 v[44:47], v61 offset:4096
    ds_read_b128 v[48:51], v61 offset:8192
    ds_read_b128 v[52:55], v61 offset:12288
    s_mov_b32 s29, 1048576
    buffer_load_dwordx4 v[24:27], v61, s[4:7], s14 offen nt
.p2align 6
cf_loop:
    v_mov_b64 v[0:1], 0
    v_mov_b64 v[2:3], 0
    v_mov_b64 v[4:5], 0
    v_mov_b64 v[6:7], 0
    v_mov_b64 v[8:9], 0
    v_mov_b64 v[10:11], 0
    v_mov_b64 v[12:13], 0
    v_mov_b64 v[14:15], 0
cf_loop2:
    ds_read_b128 v[16:19], v62 offset:8192
    ds_read_b128 v[20:23], v62 offset:12288
    v_lshrrev_b32 v56, 2, v61
    v_add_u32 v58, 106496, v56
    s_mov_b32 s29, 1048576
    s_nop 13
    buffer_load_dwordx4 v[24:27], v61, s[4:7], s14 offen nt
    s_waitcnt lgkmcnt(0)
cf_chk0:
    s_waitcnt vmcnt(1)
cf_chk0b:
    v_max3_u32 v57, v24, v25, v26
    v_max_u32 v57, v57, v27
    v_cmp_eq_u32 vcc, -1, v57
    ds_write_b128 v62, v[24:27] offset:40960
    s_cbranch_vccnz cf_spin0
    v_smfmac_f32_16x16x64_bf16 v[0:3], v[24:27], v[16:23], v60
    buffer_load_dwordx4 v[28:31], v61, s[4:7], s15 offen nt
    buffer_load_dword v59, v56, s[4:7], s16 offen nt
    v_smfmac_f32_16x16x64_bf16 v[8:11], v[24:27], v[32:39], v60
    v_mov_b64 v[16:17], 0
    v_smfmac_f32_16x16x64_bf16 v[12:15], v[24:27], v[48:55], v60
    ds_read_b128 v[32:35], v61 offset:16384
    v_mov_b64 v[18:19], 0
    s_waitcnt lgkmcnt(1)
    s_barrier
    ds_read_b128 v[48:51], v63 offset:0
    ds_read_b128 v[36:39], v61 offset:20480
    v_smfmac_f32_16x16x64_bf16 v[4:7], v[24:27], v[40:47], v60
    ds_read_b128 v[40:43], v61 offset:24576
    v_mov_b64 v[20:21], 0
    v_smfmac_f32_16x16x64_bf16 v[16:19], v[24:27], a[192:199], v60
    ds_read_b128 v[44:47], v61 offset:28672
    v_mov_b64 v[22:23], 0
    ds_read_b128 v[52:55], v64 offset:0
    s_nop 0
    v_smfmac_f32_16x16x64_bf16 v[20:23], v[24:27], a[200:207], v60
    s_waitcnt lgkmcnt(4)
    v_smfmac_f32_16x16x64_bf16 v[0:3], v[48:51], a[0:7], v60
    s_add_u32 s18, s14, s31
    s_add_u32 s41, s14, 16384
    s_waitcnt lgkmcnt(3)
    v_smfmac_f32_16x16x64_bf16 v[4:7], v[48:51], v[32:39], v60
    ds_read_b128 v[32:35], v61 offset:32768
    v_smfmac_f32_16x16x64_bf16 v[8:11], v[48:51], a[8:15], v60
    ds_read_b128 v[36:39], v61 offset:36864
    s_waitcnt lgkmcnt(3)
    v_smfmac_f32_16x16x64_bf16 v[12:15], v[48:51], v[40:47], v60
    ds_read_b128 v[40:43], v61 offset:40960
    s_waitcnt lgkmcnt(3)
    v_smfmac_f32_16x16x64_bf16 v[0:3], v[52:55], a[16:23], v60
    ds_read_b128 v[44:47], v61 offset:45056
    v_smfmac_f32_16x16x64_bf16 v[8:11], v[52:55], a[24:31], v60
    ds_read_b128 v[48:51], v71 offset:0
    s_waitcnt lgkmcnt(3)
    v_smfmac_f32_16x16x64_bf16 v[4:7], v[52:55], v[32:39], v60
    s_waitcnt vmcnt(0)
    ds_write_b128 v62, v[28:31] offset:45056
    s_waitcnt lgkmcnt(2)
    v_smfmac_f32_16x16x64_bf16 v[12:15], v[52:55], v[40:47], v60
    ds_write_b32 v58, v59
    v_max3_u32 v57, v28, v29, v30
    s_waitcnt lgkmcnt(2)
    v_smfmac_f32_16x16x64_bf16 v[0:3], v[48:51], a[32:39], v60
    ds_read_b128 v[32:35], v61 offset:49152
    v_max3_u32 v57, v57, v31, v59
    v_smfmac_f32_16x16x64_bf16 v[8:11], v[48:51], a[40:47], v60
    ds_read_b128 v[36:39], v61 offset:53248
    v_cmp_eq_u32 vcc, -1, v57
    v_smfmac_f32_16x16x64_bf16 v[16:19], v[52:55], a[224:231], v60
    ds_read_b128 v[40:43], v61 offset:57344
    v_smfmac_f32_16x16x64_bf16 v[20:23], v[52:55], a[232:239], v60
    ds_read_b128 v[44:47], v61 offset:61440
    s_cbranch_vccnz cf_spin1
cf_go1:
    v_smfmac_f32_16x16x64_bf16 v[0:3], v[28:31], a[48:55], v60
    s_waitcnt lgkmcnt(4)
    s_barrier
    ds_read_b128 v[52:55], v63 offset:4096
    s_waitcnt lgkmcnt(3)
    v_smfmac_f32_16x16x64_bf16 v[4:7], v[48:51], v[32:39], v60
    ds_read_b128 v[56:59], v71 offset:4096
    v_smfmac_f32_16x16x64_bf16 v[8:11], v[28:31], a[56:63], v60
    buffer_load_dwordx4 v[32:35], v61, s[4:7], s23 offen offset:0 sc1
    s_waitcnt lgkmcnt(2)
    v_smfmac_f32_16x16x64_bf16 v[12:15], v[48:51], v[40:47], v60
    ds_read_b128 v[48:51], v64 offset:4096
    v_smfmac_f32_16x16x64_bf16 v[4:7], v[28:31], a[128:135], v60
    ds_read_b128 v[24:27], v65 offset:8192
    v_smfmac_f32_16x16x64_bf16 v[12:15], v[28:31], a[136:143], v60
    s_and_b32 s41, s41, 65535
    s_add_u32 s41, s41, 67108864
    v_smfmac_f32_16x16x64_bf16 v[16:19], v[28:31], v[80:87], v60
    buffer_load_dwordx4 v[36:39], v61, s[4:7], s23 offen offset:1024 sc1
    v_smfmac_f32_16x16x64_bf16 v[20:23], v[28:31], v[88:95], v60
    s_add_u32 s17, s41, s31
    s_and_b32 s30, s28, 1
    s_waitcnt lgkmcnt(3)
    v_smfmac_f32_16x16x64_bf16 v[0:3], v[52:55], a[64:71], v60
    ds_read_b128 v[28:31], v78 offset:8704
    v_smfmac_f32_16x16x64_bf16 v[4:7], v[52:55], a[144:151], v60
    buffer_load_dwordx4 v[40:43], v61, s[4:7], s23 offen offset:2048 sc1
    v_smfmac_f32_16x16x64_bf16 v[8:11], v[52:55], a[72:79], v60
    v_smfmac_f32_16x16x64_bf16 v[12:15], v[52:55], a[152:159], v60
    v_smfmac_f32_16x16x64_bf16 v[16:19], v[52:55], v[96:103], v60
    buffer_load_dwordx4 v[44:47], v61, s[4:7], s23 offen offset:3072 sc1
    v_smfmac_f32_16x16x64_bf16 v[20:23], v[52:55], v[104:111], v60
    ds_read_b128 v[52:55], v62 offset:28672
    s_waitcnt lgkmcnt(3)
    v_smfmac_f32_16x16x64_bf16 v[0:3], v[48:51], a[80:87], v60
    v_smfmac_f32_16x16x64_bf16 v[4:7], v[48:51], a[160:167], v60
    v_smfmac_f32_16x16x64_bf16 v[8:11], v[48:51], a[88:95], v60
    v_smfmac_f32_16x16x64_bf16 v[12:15], v[48:51], a[168:175], v60
    v_smfmac_f32_16x16x64_bf16 v[16:19], v[48:51], v[112:119], v60
    buffer_load_dword v79, s[4:7], s24 offen sc1 lds
    v_smfmac_f32_16x16x64_bf16 v[20:23], v[48:51], v[120:127], v60
    ds_read_b128 v[48:51], v62 offset:24576
    v_smfmac_f32_16x16x64_bf16 v[0:3], v[56:59], a[96:103], v60
    v_smfmac_f32_16x16x64_bf16 v[4:7], v[56:59], a[176:183], v60
    s_waitcnt lgkmcnt(3)
    v_smfmac_f32_16x16x64_bf16 v[0:3], v[24:27], a[112:119], v60
    s_cmp_ge_u32 s28, 62
    v_smfmac_f32_16x16x64_bf16 v[8:11], v[56:59], a[104:111], v60
    s_waitcnt lgkmcnt(0)
    v_smfmac_f32_16x16x64_bf16 v[4:7], v[24:27], v[48:55], v60
    ds_read_b128 v[48:51], v62 offset:32768
    v_cvt_pk_bf16_f32 v0, v0, v1
    v_smfmac_f32_16x16x64_bf16 v[12:15], v[56:59], a[184:191], v60
    ds_read_b128 v[52:55], v62 offset:36864
    v_cvt_pk_bf16_f32 v1, v2, v3
    v_smfmac_f32_16x16x64_bf16 v[8:11], v[24:27], a[120:127], v60
    v_cvt_pk_bf16_f32 v2, v4, v5
    v_smfmac_f32_16x16x64_bf16 v[16:19], v[56:59], v[128:135], v60
    v_cvt_pk_bf16_f32 v3, v6, v7
    s_nop 1
    v_mfma_f32_16x16x32_bf16 v[4:7], v[0:3], v[28:31], 0
    v_cvt_pk_bf16_f32 v8, v8, v9
    s_waitcnt lgkmcnt(0)
    v_smfmac_f32_16x16x64_bf16 v[12:15], v[24:27], v[48:55], v60
    ds_read_b128 v[48:51], v63 offset:0
    v_cvt_pk_bf16_f32 v9, v10, v11
    v_smfmac_f32_16x16x64_bf16 v[20:23], v[56:59], v[136:143], v60
    ds_read_b128 v[52:55], v71 offset:0
    v_cvt_pk_bf16_f32 v0, v4, v5
    s_nop 0
    v_cvt_pk_bf16_f32 v10, v12, v13
    v_cvt_pk_bf16_f32 v11, v14, v15
    v_cvt_pk_bf16_f32 v1, v6, v7
    s_waitcnt vmcnt(1)
    v_mfma_f32_16x16x32_bf16 v[12:15], v[8:11], v[28:31], 0
    s_mov_b64 exec, s[36:37]
    ds_read_b128 v[56:59], v69
    s_mov_b64 exec, -1
    v_smfmac_f32_16x16x64_bf16 v[16:19], v[24:27], v[144:151], v60
    s_nop 3
    v_cvt_pk_bf16_f32 v2, v12, v13
    v_cvt_pk_bf16_f32 v3, v14, v15
    s_nop 1
    v_mfma_f32_16x16x32_bf16 v[8:11], v[0:3], v[0:3], 0
    s_cbranch_scc1 cf_last
cf_back:
    v_mfma_f32_16x16x32_bf16 v[4:7], v[36:39], v[0:3], 0
    ds_read_b128 v[36:39], v63 offset:53248
    v_mfma_f32_16x16x32_bf16 v[12:15], v[32:35], v[0:3], 0
    ds_read_b128 v[32:35], v63 offset:49152
    v_mov_b32_dpp v8, v10 row_ror:8 row_mask:0xf bank_mask:0xc
    v_mov_b32_dpp v9, v11 row_ror:8 row_mask:0xf bank_mask:0xc
    ds_write_b64 v70, v[8:9]
    s_nop 1
    v_mov_b32_dpp v12, v4 row_ror:8 row_mask:0xf bank_mask:0xc
    v_mov_b32_dpp v13, v5 row_ror:8 row_mask:0xf bank_mask:0xc
    v_mov_b32_dpp v14, v6 row_ror:8 row_mask:0xf bank_mask:0xc
    v_mov_b32_dpp v15, v7 row_ror:8 row_mask:0xf bank_mask:0xc
    ds_write_b128 v62, v[12:15] offset:53248
    v_smfmac_f32_16x16x64_bf16 v[20:23], v[24:27], v[152:159], v60
    s_waitcnt lgkmcnt(4)
    s_mov_b64 exec, s[36:37]
    buffer_store_dwordx4 v[56:59], v61, s[4:7], s65 offen sc1
    s_mov_b64 exec, -1
    v_smfmac_f32_16x16x64_bf16 v[16:19], v[48:51], a[208:215], v60
    v_smfmac_f32_16x16x64_bf16 v[20:23], v[48:51], a[216:223], v60
    s_waitcnt lgkmcnt(0)
    s_barrier
    ds_read_b128 v[56:59], v78 offset:10752
    ds_read_b128 v[28:31], v78 offset:11264
    v_smfmac_f32_16x16x64_bf16 v[16:19], v[52:55], a[240:247], v60
    ds_read_b128 v[4:7], v63 offset:12288
    ds_read_b128 v[8:11], v64 offset:12288
    v_smfmac_f32_16x16x64_bf16 v[20:23], v[52:55], a[248:255], v60
    ds_read_b128 v[0:3], v71 offset:12288
    ds_read_b128 v[48:51], v63 offset:57344
    ds_read_b128 v[52:55], v63 offset:61440
    v_mul_f32 v12, s44, v12
    v_mul_f32 v13, s44, v13
    v_mul_f32 v14, s44, v14
    v_mul_f32 v15, s44, v15
    v_mov_b64 v[24:25], s[62:63]
    v_cvt_pk_bf16_f32 v16, v16, v17
    s_waitcnt lgkmcnt(5)
    v_pk_add_f32 v[56:57], v[56:57], v[58:59]
    v_pk_add_f32 v[28:29], v[28:29], v[30:31]
    v_pk_add_f32 v[56:57], v[56:57], v[28:29]
    v_pk_mul_f32 v[56:57], v[56:57], s[44:45]
    v_exp_f32 v58, v56
    v_exp_f32 v59, v57
    s_waitcnt lgkmcnt(4)
    v_pk_fma_f32 v[12:13], v[4:5], s[44:45], v[12:13]
    v_pk_fma_f32 v[14:15], v[6:7], s[44:45], v[14:15]
    v_cvt_pk_bf16_f32 v6, v58, v59
    v_cvt_pk_bf16_f32 v17, v18, v19
    s_waitcnt lgkmcnt(2)
    v_pk_fma_f32 v[12:13], v[8:9], s[44:45], v[12:13]
    v_pk_fma_f32 v[14:15], v[10:11], s[44:45], v[14:15]
    v_pk_fma_f32 v[12:13], v[0:1], s[44:45], v[12:13]
    v_mov_b32_dpp v7, v6 row_ror:8 row_mask:0xf bank_mask:0xf
    v_pk_fma_f32 v[14:15], v[2:3], s[44:45], v[14:15]
    v_exp_f32 v0, v12
    v_mfma_f32_16x16x16_bf16 v[28:31], v[16:17], v[6:7], 0
    v_exp_f32 v1, v13
    v_cvt_pk_bf16_f32 v18, v20, v21
    v_exp_f32 v2, v14
    v_cvt_pk_bf16_f32 v19, v22, v23
    v_cvt_pk_bf16_f32 v8, v0, v1
    v_exp_f32 v3, v15
    v_mfma_f32_16x16x16_bf16 v[20:23], v[18:19], v[6:7], 0
    v_mov_b64 v[26:27], s[60:61]
    v_cvt_pk_bf16_f32 v9, v2, v3
    v_mov_b32_dpp v10, v8 row_ror:8 row_mask:0xf bank_mask:0xf
    v_max3_f32 v4, |v12|, |v13|, |v14|
    v_mfma_f32_16x16x32_bf16 v[0:3], v[24:27], v[6:9], 0
    v_mov_b32_dpp v11, v9 row_ror:8 row_mask:0xf bank_mask:0xf
    v_max3_f32 v4, v4, |v15|, |v56|
    v_max_f32_e64 v4, v4, |v57|
    v_mfma_f32_16x16x32_bf16 v[28:31], v[40:43], v[8:11], v[28:31]
    v_cmp_nge_f32 vcc, s46, v4
    v_mfma_f32_16x16x32_bf16 v[20:23], v[44:47], v[8:11], v[20:23]
    s_cbranch_scc1 cf_stash
cf_back2:
    s_cbranch_vccnz cf_guard
cf_norm:
    v_add_f32_dpp v0, v0, v0 row_ror:8 row_mask:0xf bank_mask:0xf
    v_rcp_f32 v0, v0
    v_mfma_f32_16x16x16_bf16 v[12:15], v[72:73], v[72:73], 0
    v_mul_f32 v28, v28, v0
    v_mul_f32 v29, v29, v0
    v_mul_f32 v30, v30, v0
    v_mul_f32 v31, v31, v0
    v_mul_f32_dpp v28, v20, v0 row_ror:8 row_mask:0xf bank_mask:0xc
    v_mul_f32_dpp v29, v21, v0 row_ror:8 row_mask:0xf bank_mask:0xc
    v_mul_f32_dpp v30, v22, v0 row_ror:8 row_mask:0xf bank_mask:0xc
    v_mul_f32_dpp v31, v23, v0 row_ror:8 row_mask:0xf bank_mask:0xc
    v_cvt_pk_bf16_f32 v28, v28, v29
    v_cvt_pk_bf16_f32 v29, v30, v31
    v_mfma_f32_16x16x16_bf16 v[8:11], v[72:73], v[72:73], 0
    ds_write_b64 v77, v[28:29]
    v_mfma_f32_16x16x16_bf16 v[4:7], v[72:73], v[72:73], 0
    ds_read_b128 v[0:3], v68
    v_mfma_f32_16x16x16_bf16 v[16:19], v[72:73], v[72:73], 0
    ds_read_b128 v[40:43], v63 offset:16384
    v_mfma_f32_16x16x16_bf16 v[20:23], v[72:73], v[72:73], 0
    ds_read_b128 v[44:47], v63 offset:20480
    s_waitcnt lgkmcnt(3)
    s_barrier
    ds_read_b128 v[24:27], v74
    ds_read_b128 v[28:31], v75
    ds_read_b128 v[56:59], v76
    s_waitcnt lgkmcnt(5)
    v_smfmac_f32_16x16x64_bf16 v[12:15], v[0:3], v[160:167], v60
    v_smfmac_f32_16x16x64_bf16 v[8:11], v[0:3], v[192:199], v60
    v_smfmac_f32_16x16x64_bf16 v[4:7], v[0:3], v[32:39], v60
    ds_read_b128 v[32:35], v63 offset:32768
    v_smfmac_f32_16x16x64_bf16 v[16:19], v[0:3], v[224:231], v60
    ds_read_b128 v[36:39], v63 offset:36864
    s_waitcnt lgkmcnt(3)
    v_smfmac_f32_16x16x64_bf16 v[12:15], v[24:27], v[168:175], v60
    v_smfmac_f32_16x16x64_bf16 v[4:7], v[28:31], v[48:55], v60
    ds_read_b128 v[48:51], v63 offset:24576
    v_smfmac_f32_16x16x64_bf16 v[12:15], v[28:31], v[176:183], v60
    ds_read_b128 v[52:55], v63 offset:28672
    s_waitcnt lgkmcnt(4)
    v_smfmac_f32_16x16x64_bf16 v[12:15], v[56:59], v[184:191], v60
    v_cvt_pk_bf16_f32 v4, v4, v5
    v_smfmac_f32_16x16x64_bf16 v[16:19], v[28:31], v[40:47], v60
    ds_read_b128 v[40:43], v63 offset:40960
    v_and_or_b32 v4, v4, -2, s30
    v_smfmac_f32_16x16x64_bf16 v[8:11], v[24:27], v[200:207], v60
    ds_read_b128 v[44:47], v63 offset:45056
    v_cvt_pk_bf16_f32 v5, v6, v7
    v_smfmac_f32_16x16x64_bf16 v[8:11], v[28:31], v[208:215], v60
    buffer_store_dwordx2 v[4:5], v67, s[4:7], s22 offen
    v_cvt_pk_bf16_f32 v12, v12, v13
    v_smfmac_f32_16x16x64_bf16 v[8:11], v[56:59], v[216:223], v60
    v_and_or_b32 v12, v12, -2, s30
    v_smfmac_f32_16x16x64_bf16 v[16:19], v[24:27], v[232:239], v60
    v_cvt_pk_bf16_f32 v13, v14, v15
    s_waitcnt lgkmcnt(4)
    v_smfmac_f32_16x16x64_bf16 v[16:19], v[56:59], v[32:39], v60
    buffer_store_dwordx2 v[12:13], v66, s[4:7], s20 offen
    v_cvt_pk_bf16_f32 v8, v8, v9
    s_waitcnt lgkmcnt(0)
    v_smfmac_f32_16x16x64_bf16 v[20:23], v[0:3], v[240:247], v60
    v_and_or_b32 v8, v8, -2, s30
    v_smfmac_f32_16x16x64_bf16 v[20:23], v[24:27], v[248:255], v60
    v_cvt_pk_bf16_f32 v9, v10, v11
    v_smfmac_f32_16x16x64_bf16 v[20:23], v[28:31], v[48:55], v60
    buffer_store_dwordx2 v[8:9], v66, s[4:7], s21 offen
    v_cvt_pk_bf16_f32 v16, v16, v17
    v_smfmac_f32_16x16x64_bf16 v[20:23], v[56:59], v[40:47], v60
    v_and_or_b32 v16, v16, -2, s30
    v_cvt_pk_bf16_f32 v17, v18, v19
    buffer_store_dwordx2 v[16:17], v66, s[4:7], s38 offen
    s_cmp_lg_u32 s13, 2
    s_nop 1
    v_cvt_pk_bf16_f32 v20, v20, v21
    v_and_or_b32 v20, v20, -2, s30
    v_cvt_pk_bf16_f32 v21, v22, v23
    buffer_store_dwordx2 v[20:21], v66, s[4:7], s39 offen
    s_cbranch_scc1 cf_w013
    s_nop 15
    s_nop 15
    s_nop 15
    s_nop 15
    s_nop 7
    buffer_load_dwordx4 v[40:43], v65, s[4:7], s19 offen offset:0 nt
    buffer_load_dwordx4 v[44:47], v65, s[4:7], s19 offen offset:1024 nt
    buffer_load_dwordx4 v[48:51], v65, s[4:7], s19 offen offset:2048 nt
    buffer_load_dwordx4 v[52:55], v65, s[4:7], s19 offen offset:3072 nt
    ds_read_b128 v[56:59], v65 offset:10240
    s_add_u32 s28, s28, 1
    s_mov_b32 s14, s41
    s_add_u32 s23, s23, 524288
    s_add_u32 s24, s24, 524288
    s_min_u32 s24, s24, s66
    s_add_u32 s15, s14, 4096
    s_add_u32 s16, s14, 8192
    v_mov_b32 v21, -1
    s_add_u32 s65, s65, 12288
    s_mov_b32 s40, 1
    v_mov_b64 v[0:1], 0
    v_mov_b64 v[2:3], 0
    v_mov_b64 v[4:5], 0
    v_mov_b64 v[6:7], 0
    v_mov_b64 v[8:9], 0
    v_mov_b64 v[10:11], 0
    v_mov_b64 v[12:13], 0
    v_mov_b64 v[14:15], 0
cf_chkF:
    v_mov_b32 v20, 0
    s_waitcnt vmcnt(3)
    s_waitcnt lgkmcnt(0)
    v_mfma_f32_16x16x32_bf16 v[28:31], v[40:43], v[56:59], 0
    v_bitop3_b32 v20, v20, v40, s30 bitop3:0xf6
    v_bitop3_b32 v20, v20, v42, s30 bitop3:0xf6
    s_waitcnt vmcnt(2)
    v_mfma_f32_16x16x32_bf16 v[28:31], v[44:47], v[56:59], v[28:31]
    v_bitop3_b32 v20, v20, v44, s30 bitop3:0xf6
    v_bitop3_b32 v20, v20, v46, s30 bitop3:0xf6
    s_waitcnt vmcnt(1)
    v_mfma_f32_16x16x32_bf16 v[28:31], v[48:51], v[56:59], v[28:31]
    v_bitop3_b32 v20, v20, v48, s30 bitop3:0xf6
    v_bitop3_b32 v20, v20, v50, s30 bitop3:0xf6
    s_waitcnt vmcnt(0)
    v_mfma_f32_16x16x32_bf16 v[28:31], v[52:55], v[56:59], v[28:31]
    v_bitop3_b32 v20, v20, v52, s30 bitop3:0xf6
    v_bitop3_b32 v20, v20, v54, s30 bitop3:0xf6
    v_and_b32 v20, s40, v20
    v_cmp_ne_u32 vcc, 0, v20
    s_cbranch_vccnz cf_spinF
    v_permlane32_swap_b32 v28, v30
    v_permlane32_swap_b32 v29, v31
    v_add_f32 v28, v28, v30
    v_add_f32 v30, v29, v31
    v_cvt_pk_bf16_f32 v28, v28, v30
    s_mov_b64 exec, s[32:33]
    buffer_store_dword v28, v69, s[4:7], s17 offen
    buffer_store_dword v21, v69, s[4:7], s18 offen
    s_mov_b64 exec, -1
    ds_read_b128 v[32:35], v62 offset:16384
    ds_read_b128 v[36:39], v62 offset:20480
    ds_read_b128 v[40:43], v61 offset:0
    ds_read_b128 v[44:47], v61 offset:4096
    ds_read_b128 v[48:51], v61 offset:8192
    ds_read_b128 v[52:55], v61 offset:12288
    s_nop 14
    buffer_load_dwordx4 v[24:27], v61, s[4:7], s14 offen nt
    s_branch cf_loop2
cf_w013:
    ds_read_b128 v[56:59], v65 offset:10240
    ds_read_b128 v[32:35], v62 offset:16384
    ds_read_b128 v[36:39], v62 offset:20480
    ds_read_b128 v[40:43], v61 offset:0
    ds_read_b128 v[44:47], v61 offset:4096
    ds_read_b128 v[48:51], v61 offset:8192
    ds_read_b128 v[52:55], v61 offset:12288
    s_add_u32 s28, s28, 1
    s_mov_b32 s14, s41
    s_add_u32 s23, s23, 524288
    s_add_u32 s24, s24, 524288
    s_min_u32 s24, s24, s66
    s_add_u32 s15, s14, 4096
    s_add_u32 s16, s14, 8192
    v_mov_b32 v21, -1
    s_add_u32 s65, s65, 12288
    s_mov_b32 s40, 1
    s_cmp_eq_u32 s64, 0
    s_cbranch_scc1 cf_w0
    s_cmp_eq_u32 s13, 1
    s_nop 15
    s_nop 13
    s_cbranch_scc1 cf_sx
    s_nop 15
    s_nop 15
    s_nop 7
cf_sx:
    buffer_load_dwordx4 v[0:3], v65, s[4:7], s19 offen offset:0 nt
    buffer_load_dwordx4 v[4:7], v65, s[4:7], s19 offen offset:1024 nt
    buffer_load_dwordx4 v[8:11], v65, s[4:7], s19 offen offset:2048 nt
    buffer_load_dwordx4 v[12:15], v65, s[4:7], s19 offen offset:3072 nt
cf_chkG:
    v_mov_b32 v20, 0
    s_waitcnt vmcnt(3)
    s_waitcnt lgkmcnt(6)
    v_mfma_f32_16x16x32_bf16 v[28:31], v[0:3], v[56:59], 0
    v_bitop3_b32 v20, v20, v0, s30 bitop3:0xf6
    v_bitop3_b32 v20, v20, v2, s30 bitop3:0xf6
    s_waitcnt vmcnt(2)
    v_mfma_f32_16x16x32_bf16 v[28:31], v[4:7], v[56:59], v[28:31]
    v_bitop3_b32 v20, v20, v4, s30 bitop3:0xf6
    v_bitop3_b32 v20, v20, v6, s30 bitop3:0xf6
    s_waitcnt vmcnt(1)
    v_mfma_f32_16x16x32_bf16 v[28:31], v[8:11], v[56:59], v[28:31]
    v_bitop3_b32 v20, v20, v8, s30 bitop3:0xf6
    v_bitop3_b32 v20, v20, v10, s30 bitop3:0xf6
    s_waitcnt vmcnt(0)
    v_mfma_f32_16x16x32_bf16 v[28:31], v[12:15], v[56:59], v[28:31]
    v_bitop3_b32 v20, v20, v12, s30 bitop3:0xf6
    v_bitop3_b32 v20, v20, v14, s30 bitop3:0xf6
    v_and_b32 v20, s40, v20
    v_cmp_ne_u32 vcc, 0, v20
    s_cbranch_vccnz cf_spinG
    v_permlane32_swap_b32 v28, v30
    v_permlane32_swap_b32 v29, v31
    v_add_f32 v28, v28, v30
    v_add_f32 v30, v29, v31
    s_cmp_eq_u32 s13, 3
    s_cbranch_scc1 cf_w3
    v_mov_b32 v29, v28
    v_mov_b32 v31, v30
    s_nop 0
    v_permlane16_swap_b32 v28, v29
    v_permlane16_swap_b32 v30, v31
    v_add_f32 v28, v28, v29
    v_add_f32 v30, v30, v31
cf_w3:
    v_cvt_pk_bf16_f32 v28, v28, v30
    s_mov_b64 exec, s[32:33]
    buffer_store_dword v28, v69, s[4:7], s17 offen
    buffer_store_dword v21, v69, s[4:7], s18 offen
    s_mov_b64 exec, -1
    buffer_load_dwordx4 v[24:27], v61, s[4:7], s14 offen nt
    s_branch cf_loop
cf_w0:
    v_mov_b64 v[0:1], 0
    v_mov_b64 v[2:3], 0
    v_mov_b64 v[4:5], 0
    v_mov_b64 v[6:7], 0
    v_mov_b64 v[8:9], 0
    v_mov_b64 v[10:11], 0
    v_mov_b64 v[12:13], 0
    v_mov_b64 v[14:15], 0
    s_cmp_lg_u32 s28, 10
    s_cbranch_scc1 cf_nokv
    s_lshr_b32 s92, s12, 1
    s_lshl_b32 s92, s92, 8
    s_add_u32 s92, s92, 125829120
    v_bfe_u32 v28, v61, 4, 6
    v_min_u32 v28, 11, v28
    v_lshlrev_b32 v28, 2, v28
    s_add_u32 s93, s95, 63
    s_mov_b32 s94, 4194304
cf_kv1:
    buffer_load_dword v29, v28, s[4:7], s92 offen sc1
    s_sub_u32 s94, s94, 1
    s_cbranch_scc1 cf_kv1_go
    s_waitcnt vmcnt(0)
    v_subrev_u32 v29, s93, v29
    v_cmp_lt_u32 vcc, 64, v29
    s_cbranch_vccz cf_kv1_go
    s_sleep 2
    s_branch cf_kv1
cf_kv1_go:
cf_nokv:
    s_nop 15
    s_nop 15
    s_nop 15
    s_nop 15
    s_nop 15
    s_nop 15
    s_nop 15
    s_nop 15
    s_nop 15
    s_nop 15
    s_nop 7
    buffer_load_dwordx4 v[24:27], v61, s[4:7], s14 offen nt
    s_branch cf_loop2
cf_spinF:
    buffer_load_dwordx4 v[40:43], v65, s[4:7], s19 offen offset:0 nt
    buffer_load_dwordx4 v[44:47], v65, s[4:7], s19 offen offset:1024 nt
    buffer_load_dwordx4 v[48:51], v65, s[4:7], s19 offen offset:2048 nt
    buffer_load_dwordx4 v[52:55], v65, s[4:7], s19 offen offset:3072 nt
    s_sub_u32 s29, s29, 1
    s_cmp_lt_i32 s29, 0
    s_cselect_b32 s40, 0, 1
    s_branch cf_chkF
cf_spinG:
    buffer_load_dwordx4 v[0:3], v65, s[4:7], s19 offen offset:0 nt
    buffer_load_dwordx4 v[4:7], v65, s[4:7], s19 offen offset:1024 nt
    buffer_load_dwordx4 v[8:11], v65, s[4:7], s19 offen offset:2048 nt
    buffer_load_dwordx4 v[12:15], v65, s[4:7], s19 offen offset:3072 nt
    s_sub_u32 s29, s29, 1
    s_cmp_lt_i32 s29, 0
    s_cselect_b32 s40, 0, 1
    s_branch cf_chkG
cf_guard:
    s_nop 7
    v_max3_f32 v6, v12, v13, v14
    v_max3_f32 v7, v15, v56, v57
    v_max_f32 v6, v6, v7
    s_nop 1
    v_max_f32_dpp v6, v6, v6 row_ror:8 row_mask:0xf bank_mask:0xf
    v_mov_b32 v7, v6
    s_nop 1
    v_permlane32_swap_b32 v6, v7
    v_max_f32 v6, v6, v7
    v_mov_b32 v7, v6
    s_nop 1
    v_permlane16_swap_b32 v6, v7
    v_max_f32 v6, v6, v7
    v_sub_f32 v12, v12, v6
    v_sub_f32 v13, v13, v6
    v_sub_f32 v14, v14, v6
    v_sub_f32 v15, v15, v6
    v_sub_f32 v56, v56, v6
    v_sub_f32 v57, v57, v6
    v_exp_f32 v58, v56
    v_exp_f32 v59, v57
    s_nop 0
    v_cvt_pk_bf16_f32 v6, v58, v59
    s_nop 1
    v_mov_b32_dpp v7, v6 row_ror:8 row_mask:0xf bank_mask:0xf
    v_exp_f32 v0, v12
    s_nop 0
    v_mfma_f32_16x16x16_bf16 v[28:31], v[16:17], v[6:7], 0
    v_exp_f32 v1, v13
    v_exp_f32 v2, v14
    v_cvt_pk_bf16_f32 v8, v0, v1
    v_exp_f32 v3, v15
    v_mfma_f32_16x16x16_bf16 v[20:23], v[18:19], v[6:7], 0
    v_cvt_pk_bf16_f32 v9, v2, v3
    v_mov_b32_dpp v10, v8 row_ror:8 row_mask:0xf bank_mask:0xf
    v_max3_f32 v4, |v12|, |v13|, |v14|
    v_mfma_f32_16x16x32_bf16 v[0:3], v[24:27], v[6:9], 0
    v_mov_b32_dpp v11, v9 row_ror:8 row_mask:0xf bank_mask:0xf
    v_max3_f32 v4, v4, |v15|, |v56|
    v_max_f32_e64 v4, v4, |v57|
    v_mfma_f32_16x16x32_bf16 v[28:31], v[40:43], v[8:11], v[28:31]
    v_cmp_nge_f32 vcc, s46, v4
    v_mfma_f32_16x16x32_bf16 v[20:23], v[44:47], v[8:11], v[20:23]
    s_nop 7
    s_branch cf_norm
cf_stash:
    buffer_store_dwordx4 v[16:19], v61, s[4:7], s26 offen sc1
    s_add_u32 s26, s26, 131072
    s_nop 1
    s_branch cf_back2
cf_spin0:
    buffer_load_dwordx4 v[24:27], v61, s[4:7], s14 offen nt
    s_sub_u32 s29, s29, 1
    s_cmp_lt_i32 s29, 0
    s_cbranch_scc0 cf_chk0
    s_waitcnt vmcnt(0)
    v_min_u32 v24, -2, v24
    v_min_u32 v25, -2, v25
    v_min_u32 v26, -2, v26
    v_min_u32 v27, -2, v27
    s_branch cf_chk0
cf_spin1:
    buffer_load_dwordx4 v[28:31], v61, s[4:7], s15 offen nt
    buffer_load_dword v59, v56, s[4:7], s16 offen nt
    s_sub_u32 s29, s29, 1
    s_cmp_lt_i32 s29, 0
    s_waitcnt vmcnt(0)
    v_max3_u32 v57, v28, v29, v30
    v_max3_u32 v57, v57, v31, v59
    v_cmp_eq_u32 vcc, -1, v57
    ds_write_b128 v62, v[28:31] offset:45056
    ds_write_b32 v58, v59
    s_waitcnt lgkmcnt(0)
    s_cbranch_scc1 cf_go1
    s_cbranch_vccnz cf_spin1
    s_branch cf_go1
cf_last:
    s_nop 1
    s_cmp_eq_u32 s28, 63
    s_cbranch_scc1 cf_last2
    s_mov_b64 exec, s[34:35]
    buffer_store_dwordx4 v[0:3], v61, s[4:7], s25 offen sc1
    s_mov_b64 exec, -1
    s_add_u32 s25, s25, 131072
    s_cmp_eq_u32 0, 0
    s_branch cf_back
cf_last2:
    s_waitcnt lgkmcnt(0)
    s_mov_b64 exec, s[34:35]
    buffer_store_dwordx4 v[0:3], v61, s[4:7], s25 offen sc1
    s_mov_b64 exec, -1
    s_add_u32 s40, s95, 64
    v_mov_b32 v32, s40
    v_smfmac_f32_16x16x64_bf16 v[20:23], v[24:27], v[152:159], v60
    v_smfmac_f32_16x16x64_bf16 v[16:19], v[48:51], a[208:215], v60
    v_smfmac_f32_16x16x64_bf16 v[20:23], v[48:51], a[216:223], v60
    v_smfmac_f32_16x16x64_bf16 v[16:19], v[52:55], a[240:247], v60
    v_smfmac_f32_16x16x64_bf16 v[20:23], v[52:55], a[248:255], v60
    s_nop 3
    v_cvt_pk_bf16_f32 v16, v16, v17
    v_cvt_pk_bf16_f32 v17, v18, v19
    s_nop 1
    v_cvt_pk_bf16_f32 v18, v20, v21
    v_cvt_pk_bf16_f32 v19, v22, v23
    buffer_store_dwordx4 v[16:19], v61, s[4:7], s26 offen sc1
    s_waitcnt vmcnt(0)
    s_mov_b64 exec, 1
    buffer_store_dword v32, off, s[4:7], s27 sc1
    s_mov_b64 exec, -1
    s_endpgm
cf_dma:
    s_xor_b32 s74, s76, s81
    s_add_u32 m0, s74, s80
    s_add_u32 s76, s76, 4096
    buffer_load_dwordx4 v58, s[8:11], s78 offen lds
    s_add_u32 s78, s78, s79
    s_cmp_lt_u32 s76, s77
    s_cbranch_scc1 cf_dma
    s_setpc_b64 s[82:83]
L_chain_safe:
    s_mov_b64 s[48:49], s[50:51]
    s_mov_b64 s[50:51], s[52:53]
    s_mov_b64 s[52:53], s[54:55]
    s_mov_b64 s[54:55], s[56:57]
    s_mov_b64 s[56:57], s[58:59]
    v_lshrrev_b32 v54, 6, v0
    s_nop 0
    v_readfirstlane_b32 s13, v54
    v_and_b32 v57, 63, v0
    v_bfe_u32 v54, v57, 2, 1
    v_lshlrev_b32 v48, 13, v54
    v_bfe_u32 v54, v57, 3, 1
    v_lshl_add_u32 v48, v54, 15, v48
    v_bfe_u32 v54, v57, 4, 1
    v_lshl_add_u32 v48, v54, 14, v48
    v_bfe_u32 v54, v57, 5, 1
    v_lshl_add_u32 v48, v54, 16, v48
    v_lshrrev_b32 v55, 4, v57
    v_and_b32 v55, 2, v55
    v_xor_b32 v55, v55, v57
    v_and_b32 v55, 3, v55
    v_lshl_add_u32 v48, v55, 4, v48
    v_bfe_u32 v54, v57, 2, 1
    v_lshlrev_b32 v51, 6, v54
    v_bfe_u32 v54, v57, 3, 1
    v_lshl_add_u32 v51, v54, 9, v51
    v_bfe_u32 v54, v57, 4, 1
    v_lshl_add_u32 v51, v54, 7, v51
    v_bfe_u32 v54, v57, 5, 1
    v_lshl_add_u32 v51, v54, 12, v51
    v_bfe_u32 v54, v57, 0, 1
    v_lshl_add_u32 v51, v54, 3, v51
    v_bfe_u32 v54, v57, 1, 1
    v_lshl_add_u32 v51, v54, 4, v51
    v_bfe_u32 v54, v57, 3, 1
    v_lshl_add_u32 v51, v54, 5, v51
    v_lshrrev_b32 v55, 3, v57
    v_mul_u32_u24 v49, 1152, v55
    v_and_b32 v55, 7, v57
    v_lshl_add_u32 v49, v55, 4, v49
    v_bfe_u32 v54, v57, 4, 1
    v_lshlrev_b32 v52, 13, v54
    v_bfe_u32 v54, v57, 5, 1
    v_lshl_add_u32 v52, v54, 9, v52
    v_bfe_u32 v54, v57, 2, 1
    v_lshl_add_u32 v52, v54, 7, v52
    v_bfe_u32 v54, v57, 3, 1
    v_lshl_add_u32 v52, v54, 5, v52
    v_and_b32 v55, 3, v57
    v_lshl_add_u32 v52, v55, 3, v52
    v_lshrrev_b32 v55, 2, v57
    v_mul_u32_u24 v50, 1152, v55
    v_and_b32 v55, 3, v57
    v_lshl_add_u32 v50, v55, 4, v50
    v_bfe_u32 v54, v57, 4, 1
    v_lshlrev_b32 v53, 12, v54
    v_bfe_u32 v54, v57, 5, 1
    v_lshl_add_u32 v53, v54, 8, v53
    v_bfe_u32 v54, v57, 2, 1
    v_lshl_add_u32 v53, v54, 6, v53
    v_bfe_u32 v54, v57, 3, 1
    v_lshl_add_u32 v53, v54, 5, v53
    v_and_b32 v55, 3, v57
    v_lshl_add_u32 v53, v55, 3, v53
    s_lshl_b32 s66, s13, 10
    s_and_b32 s93, s13, 1
    s_lshl_b32 s93, s93, 14
    s_and_b32 s75, s13, 2
    s_lshl_b32 s75, s75, 19
    v_add_u32 v51, s66, v51
    v_add_u32 v52, s66, v52
    v_add_u32 v53, s66, v53
    v_mov_b32 v58, v48
    s_mov_b32 s10, 4718592
    s_mov_b32 s11, 0x20000
    s_lshl_b32 s67, s12, 8
    s_lshl_b32 s40, s13, 6
    s_add_u32 s67, s67, s40
    s_mul_i32 s92, s12, 147456
    s_xor_b32 s94, s13, 0
    s_mul_i32 s94, s94, 36864
    s_add_u32 s94, s94, s92
    s_lshl_b32 s74, s13, 7
    s_add_u32 s94, s94, s74
    s_add_u32 s78, s94, 0
    s_mov_b64 s[8:9], s[56:57]
    v_mov_b32 v58, v49
    s_mov_b32 s79, 9216
    s_mov_b32 s81, 0
    s_add_u32 s80, s66, 0
    s_mov_b32 s76, 0
    s_mov_b32 s77, 8192
    s_call_b64 s[82:83], cs_dma
    s_mov_b32 s77, 16384
    s_call_b64 s[82:83], cs_dma
    s_xor_b32 s94, s13, 1
    s_mul_i32 s94, s94, 36864
    s_add_u32 s94, s94, s92
    s_lshl_b32 s74, s13, 7
    s_add_u32 s94, s94, s74
    s_add_u32 s78, s94, 0
    s_add_u32 s80, s66, 16384
    s_mov_b32 s76, 0
    s_mov_b32 s77, 8192
    s_call_b64 s[82:83], cs_dma
    s_mov_b32 s77, 16384
    s_call_b64 s[82:83], cs_dma
    s_xor_b32 s94, s13, 2
    s_mul_i32 s94, s94, 36864
    s_add_u32 s94, s94, s92
    s_lshl_b32 s74, s13, 7
    s_add_u32 s94, s94, s74
    s_add_u32 s78, s94, 0
    s_add_u32 s80, s66, 32768
    s_mov_b32 s76, 0
    s_mov_b32 s77, 8192
    s_call_b64 s[82:83], cs_dma
    v_lshrrev_b32 v24, 6, v0
    v_lshlrev_b32 v61, 4, v0
    v_add_u32 v62, 57344, v61
    v_xor_b32 v63, 1024, v61
    v_add_u32 v63, 98304, v63
    v_xor_b32 v64, 2048, v61
    v_add_u32 v64, 98304, v64
    v_and_b32 v65, 1023, v61
    v_add_u32 v65, 98304, v65
    v_and_b32 v26, 15, v0
    v_bfe_u32 v27, v0, 4, 2
    v_mov_b32 v60, 0x4444
    v_mov_b32 v25, 0xeeee
    v_cmp_lt_u32 vcc, 7, v26
    s_nop 1
    v_cndmask_b32 v60, v60, v25, vcc
    s_mov_b32 s77, 16384
    s_call_b64 s[82:83], cs_dma
    v_and_b32 v67, 12, v26
    v_lshlrev_b32 v67, 3, v67
    v_and_b32 v25, 1, v26
    v_lshl_add_u32 v67, v25, 4, v67
    v_bfe_u32 v25, v26, 1, 1
    v_lshl_add_u32 v67, v25, 3, v67
    v_lshl_add_u32 v66, v27, 14, v67
    v_lshl_add_u32 v66, v24, 17, v66
    s_xor_b32 s94, s13, 3
    s_mul_i32 s94, s94, 36864
    s_add_u32 s94, s94, s92
    s_lshl_b32 s74, s13, 7
    s_add_u32 s94, s94, s74
    s_add_u32 s78, s94, 0
    s_add_u32 s80, s66, 49152
    s_mov_b32 s76, 0
    s_mov_b32 s77, 8192
    s_call_b64 s[82:83], cs_dma
    v_and_b32 v67, 63, v67
    v_lshrrev_b32 v25, 1, v24
    v_lshl_add_u32 v67, v25, 18, v67
    v_lshl_add_u32 v67, v27, 16, v67
    v_lshrrev_b32 v25, 3, v26
    v_lshl_add_u32 v67, v25, 15, v67
    v_and_b32 v25, 1, v24
    v_lshl_add_u32 v67, v25, 6, v67
    s_mov_b32 s77, 16384
    s_call_b64 s[82:83], cs_dma
    v_and_b32 v25, 31, v0
    v_lshlrev_b32 v70, 4, v25
    v_lshlrev_b32 v28, 3, v25
    v_lshl_add_u32 v28, v24, 10, v28
    v_add_u32 v28, 110592, v28
    v_lshrrev_b32 v25, 1, v24
    v_lshl_add_u32 v70, v25, 9, v70
    v_and_b32 v25, 1, v24
    v_lshl_add_u32 v70, v25, 3, v70
    v_add_u32 v70, 109568, v70
    v_cmp_gt_u32 vcc, 2, v27
    s_nop 1
    v_cndmask_b32 v70, v70, v28, vcc
    v_xor_b32 v71, 2048, v63
    v_lshrrev_b32 v68, 4, v0
    v_lshlrev_b32 v68, 7, v68
    v_and_b32 v25, 7, v26
    v_lshl_add_u32 v68, v25, 4, v68
    v_add_u32 v68, 98304, v68
    v_xor_b32 v74, 512, v68
    v_xor_b32 v75, 1024, v68
    v_xor_b32 v76, 1536, v68
    v_lshrrev_b32 v25, 3, v26
    v_lshl_add_u32 v77, v25, 3, v68
    v_or_b32 v78, 512, v65
    v_lshlrev_b32 v79, 2, v61
    v_mov_b64 v[72:73], 0
    v_and_b32 v25, 1, v27
    v_lshlrev_b32 v69, 7, v25
    v_lshrrev_b32 v25, 1, v27
    v_lshl_add_u32 v69, v25, 3, v69
    v_and_b32 v25, 3, v26
    v_lshl_add_u32 v69, v25, 4, v69
    v_bfe_u32 v25, v26, 2, 1
    v_lshl_add_u32 v69, v25, 2, v69
    s_mov_b32 s32, 0x00ff00ff
    s_mov_b32 s33, 0x00ff00ff
    s_not_b64 s[34:35], s[32:33]
    s_lshr_b32 s31, s12, 1
    s_lshl_b32 s31, s31, 8
    s_and_b32 s40, s12, 1
    s_lshl_b32 s40, s40, 6
    s_add_u32 s31, s31, s40
    s_and_b32 s40, s13, 1
    s_lshl_b32 s40, s40, 12
    s_add_u32 s31, s31, s40
    s_lshl_b32 s19, s12, 14
    s_add_u32 s19, s19, 68124672
    s_add_u32 s41, s19, 8192
    s_add_u32 s19, s19, s40
    s_and_b32 s40, s12, 1
    s_lshl_b32 s40, s40, 2
    s_or_b32 s40, s40, s13
    s_cmp_eq_u32 s40, 5
    s_cselect_b32 s64, 0, s13
    s_cmp_lg_u32 s13, 1
    s_cbranch_scc1 cs_notx
    s_mov_b32 s32, 0xff
    s_mov_b32 s33, 0xff
    s_mov_b32 s19, s41
    s_lshr_b32 s31, s12, 3
    s_lshl_b32 s31, s31, 8
    s_and_b32 s40, s12, 2
    s_lshl_b32 s40, s40, 6
    s_add_u32 s31, s31, s40
    s_and_b32 s40, s12, 4
    s_lshl_b32 s40, s40, 4
    s_add_u32 s31, s31, s40
    s_add_u32 s31, s31, 8192
cs_notx:
    s_cmp_lg_u32 s13, 0
    s_cbranch_scc1 cs_notp
    s_min_u32 s40, s12, 23
    s_mul_i32 s40, s40, 384
    s_add_u32 s40, s40, 98304
    v_add_u32 v69, s40, v61
    v_mov_b32 v25, 108288
    v_cmp_lt_u32 vcc, 23, v0
    s_nop 1
    v_cndmask_b32 v69, v69, v25, vcc
cs_notp:
    s_nop 1
    v_mov_b32 v28, 1
    v_mov_b32 v29, 1
    v_mov_b32 v30, 1
    v_mov_b32 v31, 1
    s_lshl_b32 s40, s12, 14
    s_add_u32 s40, s40, 68222976
    s_add_u32 s41, s40, 0
    buffer_store_dwordx4 v[28:31], v61, s[4:7], s41 offen sc1
    s_add_u32 s41, s40, 4096
    buffer_store_dwordx4 v[28:31], v61, s[4:7], s41 offen sc1
    s_add_u32 s41, s40, 8192
    buffer_store_dwordx4 v[28:31], v61, s[4:7], s41 offen sc1
    s_cmp_eq_u32 s64, 0
    s_cselect_b64 exec, 0, s[32:33]
    v_mov_b32 v27, -1
    s_add_u32 s41, s31, 68157440
    buffer_store_dword v27, v69, s[4:7], s41 offen sc1
    s_add_u32 s41, s31, 68173824
    buffer_store_dword v27, v69, s[4:7], s41 offen sc1
    s_add_u32 s41, s31, 68190208
    buffer_store_dword v27, v69, s[4:7], s41 offen sc1
    s_add_u32 s41, s31, 68206592
    buffer_store_dword v27, v69, s[4:7], s41 offen sc1
    s_mov_b64 exec, -1
    s_mov_b64 s[68:69], s[48:49]
    s_mov_b32 s70, 9216
    s_mov_b32 s71, 0x20000
    v_and_b32 v25, 7, v0
    v_mul_u32_u24 v25, 1152, v25
    v_lshrrev_b32 v26, 3, v0
    v_lshl_add_u32 v25, v26, 4, v25
    buffer_load_dwordx4 v[36:39], v25, s[68:71], 0 offen
    buffer_load_dwordx4 v[40:43], v25, s[68:71], 0 offen offset:512
    v_bfe_u32 v25, v0, 2, 3
    v_mul_u32_u24 v25, 1152, v25
    v_lshrrev_b32 v26, 5, v0
    v_lshl_add_u32 v25, v26, 4, v25
    v_and_b32 v26, 3, v0
    v_lshl_add_u32 v25, v26, 2, v25
    buffer_load_dword v44, v25, s[68:71], 0 offen offset:1024
    s_waitcnt vmcnt(15)
    v_add_u32 v55, 0, v52
    ds_read_b64_tr_b16 v[160:161], v55 offset:0
    ds_read_b64_tr_b16 v[162:163], v55 offset:256
    ds_read_b64_tr_b16 v[164:165], v55 offset:4096
    ds_read_b64_tr_b16 v[166:167], v55 offset:4352
    s_xor_b32 s94, s13, 0
    s_mul_i32 s94, s94, 36864
    s_add_u32 s94, s94, s92
    s_lshl_b32 s74, s13, 7
    s_add_u32 s94, s94, s74
    s_add_u32 s78, s94, 512
    s_add_u32 s80, s66, 65536
    s_mov_b32 s76, 0
    s_mov_b32 s77, 8192
    s_call_b64 s[82:83], cs_dma
    ds_read_b64_tr_b16 v[192:193], v55 offset:64
    ds_read_b64_tr_b16 v[194:195], v55 offset:320
    ds_read_b64_tr_b16 v[196:197], v55 offset:4160
    ds_read_b64_tr_b16 v[198:199], v55 offset:4416
    s_mov_b32 s77, 16384
    s_call_b64 s[82:83], cs_dma
    s_waitcnt lgkmcnt(0)
    s_waitcnt vmcnt(15)
    v_add_u32 v55, 16384, v52
    ds_read_b64_tr_b16 v[168:169], v55 offset:0
    ds_read_b64_tr_b16 v[170:171], v55 offset:256
    ds_read_b64_tr_b16 v[172:173], v55 offset:4096
    ds_read_b64_tr_b16 v[174:175], v55 offset:4352
    s_xor_b32 s94, s13, 1
    s_mul_i32 s94, s94, 36864
    s_add_u32 s94, s94, s92
    s_lshl_b32 s74, s13, 7
    s_add_u32 s94, s94, s74
    s_add_u32 s78, s94, 512
    s_add_u32 s80, s66, 0
    s_mov_b32 s76, 0
    s_mov_b32 s77, 8192
    s_call_b64 s[82:83], cs_dma
    ds_read_b64_tr_b16 v[200:201], v55 offset:64
    ds_read_b64_tr_b16 v[202:203], v55 offset:320
    ds_read_b64_tr_b16 v[204:205], v55 offset:4160
    ds_read_b64_tr_b16 v[206:207], v55 offset:4416
    s_mov_b32 s77, 16384
    s_call_b64 s[82:83], cs_dma
    s_waitcnt lgkmcnt(0)
    s_waitcnt vmcnt(15)
    v_add_u32 v55, 32768, v52
    ds_read_b64_tr_b16 v[176:177], v55 offset:0
    ds_read_b64_tr_b16 v[178:179], v55 offset:256
    ds_read_b64_tr_b16 v[180:181], v55 offset:4096
    ds_read_b64_tr_b16 v[182:183], v55 offset:4352
    s_xor_b32 s78, s75, 0
    s_add_u32 s78, s78, s67
    s_mov_b64 s[8:9], s[54:55]
    v_mov_b32 v58, v48
    s_mov_b32 s79, 131072
    s_mov_b32 s81, s93
    s_add_u32 s80, s66, 81920
    s_mov_b32 s76, 0
    s_mov_b32 s77, 8192
    s_call_b64 s[82:83], cs_dma
    ds_read_b64_tr_b16 v[208:209], v55 offset:64
    ds_read_b64_tr_b16 v[210:211], v55 offset:320
    ds_read_b64_tr_b16 v[212:213], v55 offset:4160
    ds_read_b64_tr_b16 v[214:215], v55 offset:4416
    s_mov_b32 s77, 16384
    s_call_b64 s[82:83], cs_dma
    s_waitcnt lgkmcnt(0)
    s_waitcnt vmcnt(15)
    v_add_u32 v55, 49152, v52
    ds_read_b64_tr_b16 v[184:185], v55 offset:0
    ds_read_b64_tr_b16 v[186:187], v55 offset:256
    ds_read_b64_tr_b16 v[188:189], v55 offset:4096
    ds_read_b64_tr_b16 v[190:191], v55 offset:4352
    s_mov_b32 s77, 24576
    s_call_b64 s[82:83], cs_dma
    ds_read_b64_tr_b16 v[216:217], v55 offset:64
    ds_read_b64_tr_b16 v[218:219], v55 offset:320
    ds_read_b64_tr_b16 v[220:221], v55 offset:4160
    ds_read_b64_tr_b16 v[222:223], v55 offset:4416
    s_mov_b32 s77, 32768
    s_call_b64 s[82:83], cs_dma
    s_waitcnt lgkmcnt(0)
    s_waitcnt vmcnt(12)
    v_add_u32 v55, 65536, v52
    ds_read_b64_tr_b16 v[224:225], v55 offset:0
    ds_read_b64_tr_b16 v[226:227], v55 offset:256
    ds_read_b64_tr_b16 v[228:229], v55 offset:4096
    ds_read_b64_tr_b16 v[230:231], v55 offset:4352
    s_xor_b32 s78, s75, 1048576
    s_add_u32 s78, s78, s67
    s_add_u32 s80, s66, 16384
    s_mov_b32 s76, 0
    s_mov_b32 s77, 8192
    s_call_b64 s[82:83], cs_dma
    ds_read_b64_tr_b16 v[240:241], v55 offset:64
    ds_read_b64_tr_b16 v[242:243], v55 offset:320
    ds_read_b64_tr_b16 v[244:245], v55 offset:4160
    ds_read_b64_tr_b16 v[246:247], v55 offset:4416
    s_mov_b32 s77, 16384
    s_call_b64 s[82:83], cs_dma
    s_waitcnt lgkmcnt(0)
    v_min_u32 v36, -2, v36
    v_min_u32 v37, -2, v37
    v_min_u32 v38, -2, v38
    v_min_u32 v39, -2, v39
    v_min_u32 v40, -2, v40
    v_min_u32 v41, -2, v41
    v_min_u32 v42, -2, v42
    v_min_u32 v43, -2, v43
    v_min_u32 v44, -2, v44
    s_lshl_b32 s14, s12, 16
    s_add_u32 s14, s14, 92274688
    s_add_u32 s41, s14, 4096
    s_add_u32 s42, s14, 8192
    v_lshrrev_b32 v45, 2, v61
    buffer_store_dwordx4 v[36:39], v61, s[4:7], s14 offen sc1
    buffer_store_dwordx4 v[40:43], v61, s[4:7], s41 offen sc1
    buffer_store_dword v44, v45, s[4:7], s42 offen sc1
    v_mov_b32 v46, 1
    s_mov_b64 exec, 1
    buffer_atomic_add v46, off, s[96:99], 0 offset:212 sc0
    s_mov_b64 exec, -1
    s_waitcnt vmcnt(13)
    v_add_u32 v55, 0, v52
    ds_read_b64_tr_b16 v[232:233], v55 offset:0
    ds_read_b64_tr_b16 v[234:235], v55 offset:256
    ds_read_b64_tr_b16 v[236:237], v55 offset:4096
    ds_read_b64_tr_b16 v[238:239], v55 offset:4352
    s_mov_b32 s77, 24576
    s_call_b64 s[82:83], cs_dma
    ds_read_b64_tr_b16 v[248:249], v55 offset:64
    ds_read_b64_tr_b16 v[250:251], v55 offset:320
    ds_read_b64_tr_b16 v[252:253], v55 offset:4160
    ds_read_b64_tr_b16 v[254:255], v55 offset:4416
    s_mov_b32 s77, 32768
    s_call_b64 s[82:83], cs_dma
    s_waitcnt lgkmcnt(0)
    s_waitcnt vmcnt(9)
    v_add_u32 v55, 81920, v51
    v_xor_b32 v56, 32, v55
    ds_read_b64_tr_b16 a[192:193], v55 offset:0
    ds_read_b64_tr_b16 a[194:195], v55 offset:256
    ds_read_b64_tr_b16 a[196:197], v55 offset:8192
    ds_read_b64_tr_b16 a[198:199], v55 offset:8448
    s_xor_b32 s78, s75, 2097152
    s_add_u32 s78, s78, s67
    s_add_u32 s80, s66, 49152
    s_mov_b32 s76, 0
    s_mov_b32 s77, 8192
    s_call_b64 s[82:83], cs_dma
    ds_read_b64_tr_b16 a[200:201], v56 offset:0
    ds_read_b64_tr_b16 a[202:203], v56 offset:256
    ds_read_b64_tr_b16 a[204:205], v56 offset:8192
    ds_read_b64_tr_b16 a[206:207], v56 offset:8448
    s_mov_b32 s77, 16384
    s_call_b64 s[82:83], cs_dma
    s_waitcnt lgkmcnt(0)
    v_add_u32 v55, 98304, v51
    v_xor_b32 v56, 32, v55
    ds_read_b64_tr_b16 a[208:209], v55 offset:0
    ds_read_b64_tr_b16 a[210:211], v55 offset:256
    ds_read_b64_tr_b16 a[212:213], v55 offset:8192
    ds_read_b64_tr_b16 a[214:215], v55 offset:8448
    s_mov_b32 s77, 24576
    s_call_b64 s[82:83], cs_dma
    ds_read_b64_tr_b16 a[216:217], v56 offset:0
    ds_read_b64_tr_b16 a[218:219], v56 offset:256
    ds_read_b64_tr_b16 a[220:221], v56 offset:8192
    ds_read_b64_tr_b16 a[222:223], v56 offset:8448
    s_mov_b32 s77, 32768
    s_call_b64 s[82:83], cs_dma
    s_waitcnt lgkmcnt(0)
    s_waitcnt vmcnt(8)
    v_add_u32 v55, 16384, v51
    v_xor_b32 v56, 32, v55
    ds_read_b64_tr_b16 a[224:225], v55 offset:0
    ds_read_b64_tr_b16 a[226:227], v55 offset:256
    ds_read_b64_tr_b16 a[228:229], v55 offset:8192
    ds_read_b64_tr_b16 a[230:231], v55 offset:8448
    s_xor_b32 s78, s75, 3145728
    s_add_u32 s78, s78, s67
    s_add_u32 s80, s66, 81920
    s_mov_b32 s76, 0
    s_mov_b32 s77, 8192
    s_call_b64 s[82:83], cs_dma
    ds_read_b64_tr_b16 a[232:233], v56 offset:0
    ds_read_b64_tr_b16 a[234:235], v56 offset:256
    ds_read_b64_tr_b16 a[236:237], v56 offset:8192
    ds_read_b64_tr_b16 a[238:239], v56 offset:8448
    s_mov_b32 s77, 16384
    s_call_b64 s[82:83], cs_dma
    s_waitcnt lgkmcnt(0)
    v_add_u32 v55, 32768, v51
    v_xor_b32 v56, 32, v55
    ds_read_b64_tr_b16 a[240:241], v55 offset:0
    ds_read_b64_tr_b16 a[242:243], v55 offset:256
    ds_read_b64_tr_b16 a[244:245], v55 offset:8192
    ds_read_b64_tr_b16 a[246:247], v55 offset:8448
    s_mov_b32 s77, 24576
    s_call_b64 s[82:83], cs_dma
    ds_read_b64_tr_b16 a[248:249], v56 offset:0
    ds_read_b64_tr_b16 a[250:251], v56 offset:256
    ds_read_b64_tr_b16 a[252:253], v56 offset:8192
    ds_read_b64_tr_b16 a[254:255], v56 offset:8448
    s_mov_b32 s77, 32768
    s_call_b64 s[82:83], cs_dma
    s_waitcnt lgkmcnt(0)
    v_readfirstlane_b32 s41, v46
    v_mov_b32 v36, 1
    v_mov_b32 v37, 0
    s_cmp_eq_u32 s41, 127
    s_cselect_b64 exec, 1, 0
    buffer_atomic_cmpswap v[36:37], off, s[96:99], 0 offset:216
    s_mov_b64 exec, -1
    s_waitcnt vmcnt(8)
    v_add_u32 v55, 49152, v51
    v_xor_b32 v56, 32, v55
    ds_read_b64_tr_b16 v[80:81], v55 offset:0
    ds_read_b64_tr_b16 v[82:83], v55 offset:256
    ds_read_b64_tr_b16 v[84:85], v55 offset:8192
    ds_read_b64_tr_b16 v[86:87], v55 offset:8448
    s_add_u32 s78, s67, 4194304
    s_mov_b32 s81, 0
    s_add_u32 s80, s66, 0
    s_mov_b32 s76, 0
    s_mov_b32 s77, 8192
    s_call_b64 s[82:83], cs_dma
    ds_read_b64_tr_b16 v[88:89], v56 offset:0
    ds_read_b64_tr_b16 v[90:91], v56 offset:256
    ds_read_b64_tr_b16 v[92:93], v56 offset:8192
    ds_read_b64_tr_b16 v[94:95], v56 offset:8448
    s_mov_b32 s77, 16384
    s_call_b64 s[82:83], cs_dma
    s_waitcnt lgkmcnt(0)
    v_add_u32 v55, 65536, v51
    v_xor_b32 v56, 32, v55
    ds_read_b64_tr_b16 v[96:97], v55 offset:0
    ds_read_b64_tr_b16 v[98:99], v55 offset:256
    ds_read_b64_tr_b16 v[100:101], v55 offset:8192
    ds_read_b64_tr_b16 v[102:103], v55 offset:8448
    s_xor_b32 s78, s75, 2097152
    s_add_u32 s78, s78, s67
    s_mov_b64 s[8:9], s[52:53]
    s_mov_b32 s81, s93
    s_add_u32 s80, s66, 16384
    s_mov_b32 s76, 0
    s_mov_b32 s77, 8192
    s_call_b64 s[82:83], cs_dma
    ds_read_b64_tr_b16 v[104:105], v56 offset:0
    ds_read_b64_tr_b16 v[106:107], v56 offset:256
    ds_read_b64_tr_b16 v[108:109], v56 offset:8192
    ds_read_b64_tr_b16 v[110:111], v56 offset:8448
    s_mov_b32 s77, 16384
    s_call_b64 s[82:83], cs_dma
    s_waitcnt lgkmcnt(0)
    s_waitcnt vmcnt(8)
    v_add_u32 v55, 81920, v51
    v_xor_b32 v56, 32, v55
    ds_read_b64_tr_b16 v[112:113], v55 offset:0
    ds_read_b64_tr_b16 v[114:115], v55 offset:256
    ds_read_b64_tr_b16 v[116:117], v55 offset:8192
    ds_read_b64_tr_b16 v[118:119], v55 offset:8448
    s_mov_b32 s77, 24576
    s_call_b64 s[82:83], cs_dma
    ds_read_b64_tr_b16 v[120:121], v56 offset:0
    ds_read_b64_tr_b16 v[122:123], v56 offset:256
    ds_read_b64_tr_b16 v[124:125], v56 offset:8192
    ds_read_b64_tr_b16 v[126:127], v56 offset:8448
    s_mov_b32 s77, 32768
    s_call_b64 s[82:83], cs_dma
    s_waitcnt lgkmcnt(0)
    v_add_u32 v55, 98304, v51
    v_xor_b32 v56, 32, v55
    ds_read_b64_tr_b16 v[128:129], v55 offset:0
    ds_read_b64_tr_b16 v[130:131], v55 offset:256
    ds_read_b64_tr_b16 v[132:133], v55 offset:8192
    ds_read_b64_tr_b16 v[134:135], v55 offset:8448
    s_xor_b32 s78, s75, 3145728
    s_add_u32 s78, s78, s67
    s_add_u32 s80, s66, 114688
    s_mov_b32 s76, 0
    s_mov_b32 s77, 8192
    s_call_b64 s[82:83], cs_dma
    ds_read_b64_tr_b16 v[136:137], v56 offset:0
    ds_read_b64_tr_b16 v[138:139], v56 offset:256
    ds_read_b64_tr_b16 v[140:141], v56 offset:8192
    ds_read_b64_tr_b16 v[142:143], v56 offset:8448
    s_mov_b32 s77, 16384
    s_call_b64 s[82:83], cs_dma
    s_waitcnt lgkmcnt(0)
    s_waitcnt vmcnt(12)
    v_add_u32 v55, 0, v51
    v_xor_b32 v56, 32, v55
    ds_read_b64_tr_b16 v[144:145], v55 offset:0
    ds_read_b64_tr_b16 v[146:147], v55 offset:256
    ds_read_b64_tr_b16 v[148:149], v55 offset:8192
    ds_read_b64_tr_b16 v[150:151], v55 offset:8448
    s_mov_b32 s77, 24576
    s_call_b64 s[82:83], cs_dma
    ds_read_b64_tr_b16 v[152:153], v56 offset:0
    ds_read_b64_tr_b16 v[154:155], v56 offset:256
    ds_read_b64_tr_b16 v[156:157], v56 offset:8192
    ds_read_b64_tr_b16 v[158:159], v56 offset:8448
    s_mov_b32 s77, 32768
    s_call_b64 s[82:83], cs_dma
    s_waitcnt lgkmcnt(0)
    s_waitcnt vmcnt(8)
    v_add_u32 v55, 16384, v51
    v_xor_b32 v56, 32, v55
    ds_read_b64_tr_b16 a[128:129], v55 offset:0
    ds_read_b64_tr_b16 a[130:131], v55 offset:256
    ds_read_b64_tr_b16 a[132:133], v55 offset:8192
    ds_read_b64_tr_b16 a[134:135], v55 offset:8448
    s_xor_b32 s78, s75, 2097152
    s_add_u32 s78, s78, s67
    s_mov_b64 s[8:9], s[50:51]
    s_add_u32 s80, s66, 49152
    s_mov_b32 s76, 0
    s_mov_b32 s77, 8192
    s_call_b64 s[82:83], cs_dma
    ds_read_b64_tr_b16 a[136:137], v56 offset:0
    ds_read_b64_tr_b16 a[138:139], v56 offset:256
    ds_read_b64_tr_b16 a[140:141], v56 offset:8192
    ds_read_b64_tr_b16 a[142:143], v56 offset:8448
    s_mov_b32 s77, 16384
    s_call_b64 s[82:83], cs_dma
    s_waitcnt lgkmcnt(0)
    v_add_u32 v55, 32768, v51
    v_xor_b32 v56, 32, v55
    ds_read_b64_tr_b16 a[144:145], v55 offset:0
    ds_read_b64_tr_b16 a[146:147], v55 offset:256
    ds_read_b64_tr_b16 a[148:149], v55 offset:8192
    ds_read_b64_tr_b16 a[150:151], v55 offset:8448
    s_mov_b32 s77, 24576
    s_call_b64 s[82:83], cs_dma
    ds_read_b64_tr_b16 a[152:153], v56 offset:0
    ds_read_b64_tr_b16 a[154:155], v56 offset:256
    ds_read_b64_tr_b16 a[156:157], v56 offset:8192
    ds_read_b64_tr_b16 a[158:159], v56 offset:8448
    s_mov_b32 s77, 32768
    s_call_b64 s[82:83], cs_dma
    s_waitcnt lgkmcnt(0)
    s_waitcnt vmcnt(8)
    v_add_u32 v55, 114688, v51
    v_xor_b32 v56, 32, v55
    ds_read_b64_tr_b16 a[160:161], v55 offset:0
    ds_read_b64_tr_b16 a[162:163], v55 offset:256
    ds_read_b64_tr_b16 a[164:165], v55 offset:8192
    ds_read_b64_tr_b16 a[166:167], v55 offset:8448
    s_xor_b32 s78, s75, 3145728
    s_add_u32 s78, s78, s67
    s_add_u32 s80, s66, 0
    s_mov_b32 s76, 0
    s_mov_b32 s77, 8192
    s_call_b64 s[82:83], cs_dma
    ds_read_b64_tr_b16 a[168:169], v56 offset:0
    ds_read_b64_tr_b16 a[170:171], v56 offset:256
    ds_read_b64_tr_b16 a[172:173], v56 offset:8192
    ds_read_b64_tr_b16 a[174:175], v56 offset:8448
    s_mov_b32 s77, 16384
    s_call_b64 s[82:83], cs_dma
    s_waitcnt lgkmcnt(0)
    v_add_u32 v55, 131072, v51
    v_xor_b32 v56, 32, v55
    ds_read_b64_tr_b16 a[176:177], v55 offset:0
    ds_read_b64_tr_b16 a[178:179], v55 offset:256
    ds_read_b64_tr_b16 a[180:181], v55 offset:8192
    ds_read_b64_tr_b16 a[182:183], v55 offset:8448
    s_mov_b32 s77, 24576
    s_call_b64 s[82:83], cs_dma
    ds_read_b64_tr_b16 a[184:185], v56 offset:0
    ds_read_b64_tr_b16 a[186:187], v56 offset:256
    ds_read_b64_tr_b16 a[188:189], v56 offset:8192
    ds_read_b64_tr_b16 a[190:191], v56 offset:8448
    s_mov_b32 s77, 32768
    s_call_b64 s[82:83], cs_dma
    s_waitcnt lgkmcnt(0)
    s_waitcnt vmcnt(8)
    v_add_u32 v55, 49152, v51
    v_xor_b32 v56, 32, v55
    ds_read_b64_tr_b16 a[48:49], v55 offset:0
    ds_read_b64_tr_b16 a[50:51], v55 offset:256
    ds_read_b64_tr_b16 a[52:53], v55 offset:8192
    ds_read_b64_tr_b16 a[54:55], v55 offset:8448
    s_add_u32 s78, s67, 4194304
    s_mov_b32 s81, 0
    s_add_u32 s80, s66, 98304
    s_mov_b32 s76, 0
    s_mov_b32 s77, 8192
    s_call_b64 s[82:83], cs_dma
    ds_read_b64_tr_b16 a[56:57], v56 offset:0
    ds_read_b64_tr_b16 a[58:59], v56 offset:256
    ds_read_b64_tr_b16 a[60:61], v56 offset:8192
    ds_read_b64_tr_b16 a[62:63], v56 offset:8448
    s_mov_b32 s77, 16384
    s_call_b64 s[82:83], cs_dma
    s_waitcnt lgkmcnt(0)
    v_add_u32 v55, 65536, v51
    v_xor_b32 v56, 32, v55
    ds_read_b64_tr_b16 a[64:65], v55 offset:0
    ds_read_b64_tr_b16 a[66:67], v55 offset:256
    ds_read_b64_tr_b16 a[68:69], v55 offset:8192
    ds_read_b64_tr_b16 a[70:71], v55 offset:8448
    s_xor_b32 s78, s75, 1048576
    s_add_u32 s78, s78, s67
    s_mov_b32 s81, s93
    s_add_u32 s80, s66, 114688
    s_mov_b32 s76, 0
    s_mov_b32 s77, 8192
    s_call_b64 s[82:83], cs_dma
    ds_read_b64_tr_b16 a[72:73], v56 offset:0
    ds_read_b64_tr_b16 a[74:75], v56 offset:256
    ds_read_b64_tr_b16 a[76:77], v56 offset:8192
    ds_read_b64_tr_b16 a[78:79], v56 offset:8448
    s_mov_b32 s77, 16384
    s_call_b64 s[82:83], cs_dma
    s_waitcnt lgkmcnt(0)
    s_waitcnt vmcnt(8)
    v_add_u32 v55, 0, v51
    v_xor_b32 v56, 32, v55
    ds_read_b64_tr_b16 a[80:81], v55 offset:0
    ds_read_b64_tr_b16 a[82:83], v55 offset:256
    ds_read_b64_tr_b16 a[84:85], v55 offset:8192
    ds_read_b64_tr_b16 a[86:87], v55 offset:8448
    s_mov_b32 s77, 24576
    s_call_b64 s[82:83], cs_dma
    ds_read_b64_tr_b16 a[88:89], v56 offset:0
    ds_read_b64_tr_b16 a[90:91], v56 offset:256
    ds_read_b64_tr_b16 a[92:93], v56 offset:8192
    ds_read_b64_tr_b16 a[94:95], v56 offset:8448
    s_mov_b32 s77, 32768
    s_call_b64 s[82:83], cs_dma
    s_waitcnt lgkmcnt(0)
    v_add_u32 v55, 16384, v51
    v_xor_b32 v56, 32, v55
    ds_read_b64_tr_b16 a[96:97], v55 offset:0
    ds_read_b64_tr_b16 a[98:99], v55 offset:256
    ds_read_b64_tr_b16 a[100:101], v55 offset:8192
    ds_read_b64_tr_b16 a[102:103], v55 offset:8448
    s_xor_b32 s78, s75, 0
    s_add_u32 s78, s78, s67
    s_add_u32 s80, s66, 65536
    s_mov_b32 s76, 0
    s_mov_b32 s77, 8192
    s_call_b64 s[82:83], cs_dma
    ds_read_b64_tr_b16 a[104:105], v56 offset:0
    ds_read_b64_tr_b16 a[106:107], v56 offset:256
    ds_read_b64_tr_b16 a[108:109], v56 offset:8192
    ds_read_b64_tr_b16 a[110:111], v56 offset:8448
    s_mov_b32 s77, 16384
    s_call_b64 s[82:83], cs_dma
    s_waitcnt lgkmcnt(0)
    s_waitcnt vmcnt(12)
    v_add_u32 v55, 98304, v51
    v_xor_b32 v56, 32, v55
    ds_read_b64_tr_b16 a[112:113], v55 offset:0
    ds_read_b64_tr_b16 a[114:115], v55 offset:256
    ds_read_b64_tr_b16 a[116:117], v55 offset:8192
    ds_read_b64_tr_b16 a[118:119], v55 offset:8448
    s_mov_b32 s77, 24576
    s_call_b64 s[82:83], cs_dma
    ds_read_b64_tr_b16 a[120:121], v56 offset:0
    ds_read_b64_tr_b16 a[122:123], v56 offset:256
    ds_read_b64_tr_b16 a[124:125], v56 offset:8192
    ds_read_b64_tr_b16 a[126:127], v56 offset:8448
    s_mov_b32 s77, 32768
    s_call_b64 s[82:83], cs_dma
    s_waitcnt lgkmcnt(0)
    s_waitcnt vmcnt(8)
    v_add_u32 v55, 114688, v51
    v_xor_b32 v56, 32, v55
    ds_read_b64_tr_b16 a[16:17], v55 offset:0
    ds_read_b64_tr_b16 a[18:19], v55 offset:256
    ds_read_b64_tr_b16 a[20:21], v55 offset:8192
    ds_read_b64_tr_b16 a[22:23], v55 offset:8448
    s_xor_b32 s78, s75, 0
    s_add_u32 s78, s78, s67
    s_mov_b64 s[8:9], s[52:53]
    s_add_u32 s80, s66, 0
    s_mov_b32 s76, 0
    s_mov_b32 s77, 8192
    s_call_b64 s[82:83], cs_dma
    ds_read_b64_tr_b16 a[24:25], v56 offset:0
    ds_read_b64_tr_b16 a[26:27], v56 offset:256
    ds_read_b64_tr_b16 a[28:29], v56 offset:8192
    ds_read_b64_tr_b16 a[30:31], v56 offset:8448
    s_mov_b32 s77, 16384
    s_call_b64 s[82:83], cs_dma
    s_waitcnt lgkmcnt(0)
    v_add_u32 v55, 131072, v51
    v_xor_b32 v56, 32, v55
    ds_read_b64_tr_b16 a[32:33], v55 offset:0
    ds_read_b64_tr_b16 a[34:35], v55 offset:256
    ds_read_b64_tr_b16 a[36:37], v55 offset:8192
    ds_read_b64_tr_b16 a[38:39], v55 offset:8448
    s_mov_b32 s77, 24576
    s_call_b64 s[82:83], cs_dma
    ds_read_b64_tr_b16 a[40:41], v56 offset:0
    ds_read_b64_tr_b16 a[42:43], v56 offset:256
    ds_read_b64_tr_b16 a[44:45], v56 offset:8192
    ds_read_b64_tr_b16 a[46:47], v56 offset:8448
    s_mov_b32 s77, 32768
    s_call_b64 s[82:83], cs_dma
    s_waitcnt lgkmcnt(0)
    s_waitcnt vmcnt(8)
    v_add_u32 v55, 65536, v51
    v_xor_b32 v56, 32, v55
    ds_read_b64_tr_b16 v[0:1], v55 offset:0
    ds_read_b64_tr_b16 v[2:3], v55 offset:256
    ds_read_b64_tr_b16 v[4:5], v55 offset:8192
    ds_read_b64_tr_b16 v[6:7], v55 offset:8448
    s_xor_b32 s78, s75, 1048576
    s_add_u32 s78, s78, s67
    s_add_u32 s80, s66, 32768
    s_mov_b32 s76, 0
    s_mov_b32 s77, 8192
    s_call_b64 s[82:83], cs_dma
    ds_read_b64_tr_b16 v[8:9], v56 offset:0
    ds_read_b64_tr_b16 v[10:11], v56 offset:256
    ds_read_b64_tr_b16 v[12:13], v56 offset:8192
    ds_read_b64_tr_b16 v[14:15], v56 offset:8448
    s_mov_b32 s77, 16384
    s_call_b64 s[82:83], cs_dma
    s_waitcnt lgkmcnt(0)
    ds_write_b128 v62, v[0:3] offset:8192
    ds_write_b128 v62, v[4:7] offset:12288
    ds_write_b128 v62, v[8:11] offset:16384
    ds_write_b128 v62, v[12:15] offset:20480
    s_waitcnt lgkmcnt(0)
    v_add_u32 v55, 81920, v51
    v_xor_b32 v56, 32, v55
    ds_read_b64_tr_b16 a[0:1], v55 offset:0
    ds_read_b64_tr_b16 a[2:3], v55 offset:256
    ds_read_b64_tr_b16 a[4:5], v55 offset:8192
    ds_read_b64_tr_b16 a[6:7], v55 offset:8448
    s_mov_b32 s77, 24576
    s_call_b64 s[82:83], cs_dma
    ds_read_b64_tr_b16 a[8:9], v56 offset:0
    ds_read_b64_tr_b16 a[10:11], v56 offset:256
    ds_read_b64_tr_b16 a[12:13], v56 offset:8192
    ds_read_b64_tr_b16 a[14:15], v56 offset:8448
    s_mov_b32 s77, 32768
    s_call_b64 s[82:83], cs_dma
    s_waitcnt lgkmcnt(0)
    s_waitcnt vmcnt(8)
    v_add_u32 v55, 0, v51
    v_xor_b32 v56, 32, v55
    ds_read_b64_tr_b16 v[0:1], v55 offset:0
    ds_read_b64_tr_b16 v[2:3], v55 offset:256
    ds_read_b64_tr_b16 v[4:5], v55 offset:8192
    ds_read_b64_tr_b16 v[6:7], v55 offset:8448
    s_xor_b32 s94, s13, 0
    s_mul_i32 s94, s94, 36864
    s_add_u32 s94, s94, s92
    s_lshr_b32 s74, s13, 1
    s_lshl_b32 s74, s74, 6
    s_add_u32 s94, s94, s74
    s_add_u32 s78, s94, 1024
    s_mov_b64 s[8:9], s[56:57]
    v_mov_b32 v58, v50
    s_mov_b32 s79, 18432
    s_mov_b32 s81, 0
    s_add_u32 s80, s66, 147456
    s_mov_b32 s76, 0
    s_mov_b32 s77, 8192
    s_call_b64 s[82:83], cs_dma
    ds_read_b64_tr_b16 v[8:9], v56 offset:0
    ds_read_b64_tr_b16 v[10:11], v56 offset:256
    ds_read_b64_tr_b16 v[12:13], v56 offset:8192
    ds_read_b64_tr_b16 v[14:15], v56 offset:8448
    s_xor_b32 s94, s13, 2
    s_mul_i32 s94, s94, 36864
    s_add_u32 s94, s94, s92
    s_lshr_b32 s74, s13, 1
    s_lshl_b32 s74, s74, 6
    s_add_u32 s94, s94, s74
    s_add_u32 s78, s94, 1024
    s_mov_b32 s77, 16384
    s_call_b64 s[82:83], cs_dma
    s_waitcnt lgkmcnt(0)
    ds_write_b128 v61, v[0:3] offset:0
    ds_write_b128 v61, v[4:7] offset:4096
    ds_write_b128 v61, v[8:11] offset:8192
    ds_write_b128 v61, v[12:15] offset:12288
    s_waitcnt lgkmcnt(0)
    v_add_u32 v55, 16384, v51
    v_xor_b32 v56, 32, v55
    ds_read_b64_tr_b16 v[0:1], v55 offset:0
    ds_read_b64_tr_b16 v[2:3], v55 offset:256
    ds_read_b64_tr_b16 v[4:5], v55 offset:8192
    ds_read_b64_tr_b16 v[6:7], v55 offset:8448
    s_xor_b32 s94, s13, 3
    s_mul_i32 s94, s94, 36864
    s_add_u32 s94, s94, s92
    s_lshl_b32 s74, s13, 7
    s_add_u32 s94, s94, s74
    s_add_u32 s78, s94, 512
    v_mov_b32 v58, v49
    s_mov_b32 s79, 9216
    s_add_u32 s80, s66, 131072
    s_mov_b32 s76, 0
    s_mov_b32 s77, 8192
    s_call_b64 s[82:83], cs_dma
    ds_read_b64_tr_b16 v[8:9], v56 offset:0
    ds_read_b64_tr_b16 v[10:11], v56 offset:256
    ds_read_b64_tr_b16 v[12:13], v56 offset:8192
    ds_read_b64_tr_b16 v[14:15], v56 offset:8448
    s_mov_b32 s77, 16384
    s_call_b64 s[82:83], cs_dma
    s_waitcnt lgkmcnt(0)
    ds_write_b128 v61, v[0:3] offset:16384
    ds_write_b128 v61, v[4:7] offset:20480
    ds_write_b128 v61, v[8:11] offset:24576
    ds_write_b128 v61, v[12:15] offset:28672
    s_waitcnt lgkmcnt(0)
    s_waitcnt vmcnt(8)
    v_add_u32 v55, 32768, v51
    v_xor_b32 v56, 32, v55
    ds_read_b64_tr_b16 v[0:1], v55 offset:0
    ds_read_b64_tr_b16 v[2:3], v55 offset:256
    ds_read_b64_tr_b16 v[4:5], v55 offset:8192
    ds_read_b64_tr_b16 v[6:7], v55 offset:8448
    s_xor_b32 s94, s13, 2
    s_mul_i32 s94, s94, 36864
    s_add_u32 s94, s94, s92
    s_lshl_b32 s74, s13, 7
    s_add_u32 s94, s94, s74
    s_add_u32 s78, s94, 512
    s_add_u32 s80, s66, 114688
    s_mov_b32 s76, 0
    s_mov_b32 s77, 8192
    s_call_b64 s[82:83], cs_dma
    ds_read_b64_tr_b16 v[8:9], v56 offset:0
    ds_read_b64_tr_b16 v[10:11], v56 offset:256
    ds_read_b64_tr_b16 v[12:13], v56 offset:8192
    ds_read_b64_tr_b16 v[14:15], v56 offset:8448
    s_mov_b32 s77, 16384
    s_call_b64 s[82:83], cs_dma
    s_waitcnt lgkmcnt(0)
    ds_write_b128 v61, v[0:3] offset:32768
    ds_write_b128 v61, v[4:7] offset:36864
    ds_write_b128 v61, v[8:11] offset:40960
    ds_write_b128 v61, v[12:15] offset:45056
    s_waitcnt lgkmcnt(0)
    v_add_u32 v55, 49152, v51
    v_xor_b32 v56, 32, v55
    ds_read_b64_tr_b16 v[0:1], v55 offset:0
    ds_read_b64_tr_b16 v[2:3], v55 offset:256
    ds_read_b64_tr_b16 v[4:5], v55 offset:8192
    ds_read_b64_tr_b16 v[6:7], v55 offset:8448
    s_add_u32 s78, s67, 4194304
    s_mov_b64 s[8:9], s[52:53]
    v_mov_b32 v58, v48
    s_mov_b32 s79, 131072
    s_add_u32 s80, s66, 81920
    s_mov_b32 s76, 0
    s_mov_b32 s77, 8192
    s_call_b64 s[82:83], cs_dma
    ds_read_b64_tr_b16 v[8:9], v56 offset:0
    ds_read_b64_tr_b16 v[10:11], v56 offset:256
    ds_read_b64_tr_b16 v[12:13], v56 offset:8192
    ds_read_b64_tr_b16 v[14:15], v56 offset:8448
    s_mov_b32 s77, 16384
    s_call_b64 s[82:83], cs_dma
    s_waitcnt lgkmcnt(0)
    ds_write_b128 v61, v[0:3] offset:49152
    ds_write_b128 v61, v[4:7] offset:53248
    ds_write_b128 v61, v[8:11] offset:57344
    ds_write_b128 v61, v[12:15] offset:61440
    s_waitcnt lgkmcnt(0)
    buffer_load_dword v38, off, s[96:99], 0 offset:216 sc1
    buffer_load_dword v39, off, s[96:99], 0 offset:144 sc1
    s_lshr_b32 s84, s12, 1
    s_lshl_b32 s84, s84, 8
    s_add_u32 s84, s84, 125829120
    v_bfe_u32 v40, v61, 4, 6
    v_min_u32 v40, 11, v40
    v_lshlrev_b32 v40, 2, v40
    buffer_load_dword v41, v40, s[4:7], s84 offen sc1
    s_waitcnt vmcnt(15)
    v_add_u32 v55, 147456, v53
    ds_read_b64_tr_b16 v[0:1], v55 offset:0
    ds_read_b64_tr_b16 v[2:3], v55 offset:128
    ds_read_b64_tr_b16 v[4:5], v55 offset:512
    ds_read_b64_tr_b16 v[6:7], v55 offset:640
    ds_read_b64_tr_b16 v[8:9], v55 offset:8192
    ds_read_b64_tr_b16 v[10:11], v55 offset:8320
    ds_read_b64_tr_b16 v[12:13], v55 offset:8704
    ds_read_b64_tr_b16 v[14:15], v55 offset:8832
    s_waitcnt lgkmcnt(0)
    s_barrier
    ds_write_b128 v63, v[0:3] offset:49152
    ds_write_b128 v63, v[4:7] offset:53248
    s_barrier
    ds_write_b128 v63, v[8:11] offset:57344
    ds_write_b128 v63, v[12:15] offset:61440
    s_waitcnt lgkmcnt(0)
    s_waitcnt vmcnt(11)
    v_add_u32 v55, 131072, v52
    ds_read_b64_tr_b16 v[0:1], v55 offset:0
    ds_read_b64_tr_b16 v[2:3], v55 offset:256
    ds_read_b64_tr_b16 v[4:5], v55 offset:4096
    ds_read_b64_tr_b16 v[6:7], v55 offset:4352
    ds_read_b64_tr_b16 v[8:9], v55 offset:64
    ds_read_b64_tr_b16 v[10:11], v55 offset:320
    ds_read_b64_tr_b16 v[12:13], v55 offset:4160
    ds_read_b64_tr_b16 v[14:15], v55 offset:4416
    s_waitcnt lgkmcnt(0)
    s_barrier
    ds_write_b128 v63, v[0:3] offset:32768
    ds_write_b128 v63, v[4:7] offset:36864
    s_barrier
    ds_write_b128 v63, v[8:11] offset:40960
    ds_write_b128 v63, v[12:15] offset:45056
    s_waitcnt lgkmcnt(0)
    s_waitcnt vmcnt(7)
    v_add_u32 v55, 114688, v52
    ds_read_b64_tr_b16 v[0:1], v55 offset:0
    ds_read_b64_tr_b16 v[2:3], v55 offset:256
    ds_read_b64_tr_b16 v[4:5], v55 offset:4096
    ds_read_b64_tr_b16 v[6:7], v55 offset:4352
    ds_read_b64_tr_b16 v[8:9], v55 offset:64
    ds_read_b64_tr_b16 v[10:11], v55 offset:320
    ds_read_b64_tr_b16 v[12:13], v55 offset:4160
    ds_read_b64_tr_b16 v[14:15], v55 offset:4416
    s_waitcnt lgkmcnt(0)
    s_barrier
    ds_write_b128 v63, v[0:3] offset:16384
    ds_write_b128 v63, v[4:7] offset:20480
    s_barrier
    ds_write_b128 v63, v[8:11] offset:24576
    ds_write_b128 v63, v[12:15] offset:28672
    s_waitcnt lgkmcnt(0)
    s_waitcnt vmcnt(3)
    v_add_u32 v55, 81920, v51
    v_xor_b32 v56, 32, v55
    ds_read_b64_tr_b16 v[0:1], v55 offset:0
    ds_read_b64_tr_b16 v[2:3], v55 offset:256
    ds_read_b64_tr_b16 v[4:5], v55 offset:8192
    ds_read_b64_tr_b16 v[6:7], v55 offset:8448
    ds_read_b64_tr_b16 v[8:9], v56 offset:0
    ds_read_b64_tr_b16 v[10:11], v56 offset:256
    ds_read_b64_tr_b16 v[12:13], v56 offset:8192
    ds_read_b64_tr_b16 v[14:15], v56 offset:8448
    s_waitcnt lgkmcnt(0)
    ds_write_b128 v62, v[0:3] offset:24576
    ds_write_b128 v62, v[4:7] offset:28672
    ds_write_b128 v62, v[8:11] offset:32768
    ds_write_b128 v62, v[12:15] offset:36864
    s_waitcnt lgkmcnt(0)
    s_barrier
    s_waitcnt vmcnt(0)
    v_readfirstlane_b32 s95, v39
    v_readfirstlane_b32 s85, v38
    s_nop 4
    s_mov_b32 s88, 4194304
gn3:
    s_cmp_lg_u32 s95, 0
    s_cbranch_scc1 gn3x
    buffer_load_dword v24, off, s[96:99], 0 offset:144 sc1
    s_sub_u32 s88, s88, 1
    s_cbranch_scc1 gn3x
    s_waitcnt vmcnt(0)
    v_readfirstlane_b32 s95, v24
    s_nop 1
    s_branch gn3
gn3x:
    s_add_u32 s93, s95, 2
    v_subrev_u32 v41, s93, v41
    v_cmp_lt_u32 s[86:87], 64, v41
    v_bfe_u32 v40, v61, 4, 4
    v_bfe_u32 v41, v61, 8, 1
    v_lshlrev_b32 v41, 2, v41
    v_sub_u32 v41, v40, v41
    v_mov_b32 v42, 0x3f80
    v_mov_b32 v43, 0x3f800000
    v_cmp_eq_u32 vcc, 0, v41
    s_nop 1
    v_cndmask_b32 v32, 0, v42, vcc
    v_cmp_eq_u32 vcc, 1, v41
    s_nop 1
    v_cndmask_b32 v32, v32, v43, vcc
    v_cmp_eq_u32 vcc, 0, v40
    s_nop 1
    v_cndmask_b32 v36, 0, v42, vcc
    v_cmp_eq_u32 vcc, 1, v40
    s_nop 1
    v_cndmask_b32 v36, v36, v43, vcc
    v_cmp_eq_u32 vcc, 2, v41
    s_nop 1
    v_cndmask_b32 v33, 0, v42, vcc
    v_cmp_eq_u32 vcc, 3, v41
    s_nop 1
    v_cndmask_b32 v33, v33, v43, vcc
    v_cmp_eq_u32 vcc, 2, v40
    s_nop 1
    v_cndmask_b32 v37, 0, v42, vcc
    v_cmp_eq_u32 vcc, 3, v40
    s_nop 1
    v_cndmask_b32 v37, v37, v43, vcc
    v_cmp_eq_u32 vcc, 8, v41
    s_nop 1
    v_cndmask_b32 v34, 0, v42, vcc
    v_cmp_eq_u32 vcc, 9, v41
    s_nop 1
    v_cndmask_b32 v34, v34, v43, vcc
    v_cmp_eq_u32 vcc, 4, v40
    s_nop 1
    v_cndmask_b32 v38, 0, v42, vcc
    v_cmp_eq_u32 vcc, 5, v40
    s_nop 1
    v_cndmask_b32 v38, v38, v43, vcc
    v_cmp_eq_u32 vcc, 10, v41
    s_nop 1
    v_cndmask_b32 v35, 0, v42, vcc
    v_cmp_eq_u32 vcc, 11, v41
    s_nop 1
    v_cndmask_b32 v35, v35, v43, vcc
    v_cmp_eq_u32 vcc, 6, v40
    s_nop 1
    v_cndmask_b32 v39, 0, v42, vcc
    v_cmp_eq_u32 vcc, 7, v40
    s_nop 1
    v_cndmask_b32 v39, v39, v43, vcc
    ds_write_b128 v78, v[32:35] offset:8704
    ds_write_b128 v65, v[36:39] offset:10240
    v_mov_b32 v44, s95
    v_mov_b32 v45, s95
    v_mov_b32 v46, s95
    v_mov_b32 v47, s95
    v_mov_b32 v48, 108288
    ds_write_b128 v48, v[44:47]
    s_waitcnt vmcnt(0) lgkmcnt(0)
    s_cmp_eq_u32 s85, 1
    s_cbranch_scc1 cs_run
    s_mov_b32 s40, 16777216
cs_startpoll:
    buffer_load_dword v3, off, s[96:99], 0 offset:216 sc1
    s_waitcnt vmcnt(0)
    v_readfirstlane_b32 s85, v3
    s_nop 0
    s_cmp_eq_u32 s85, 1
    s_cbranch_scc1 cs_run
    s_sleep 1
    s_sub_u32 s40, s40, 1
    s_cbranch_scc0 cs_startpoll
    s_endpgm
cs_run:
    s_cmp_eq_u64 s[86:87], 0
    s_cbranch_scc1 cs_kv0_go
    s_lshr_b32 s92, s12, 1
    s_lshl_b32 s92, s92, 8
    s_add_u32 s92, s92, 125829120
    v_bfe_u32 v2, v61, 4, 6
    v_min_u32 v2, 11, v2
    v_lshlrev_b32 v2, 2, v2
    s_add_u32 s93, s95, 2
    s_mov_b32 s94, 4194304
cs_kv0:
    buffer_load_dword v3, v2, s[4:7], s92 offen sc1
    s_sub_u32 s94, s94, 1
    s_cbranch_scc1 cs_kv0_go
    s_waitcnt vmcnt(0)
    v_subrev_u32 v3, s93, v3
    v_cmp_lt_u32 vcc, 64, v3
    s_cbranch_vccz cs_kv0_go
    s_sleep 2
    s_branch cs_kv0
cs_kv0_go:
    s_mov_b32 s44, 0x3e0293ee
    s_mov_b32 s45, s44
    s_mov_b32 s46, 0x42000000
    s_mov_b32 s47, 128
    s_mov_b32 s60, 0x3f803f80
    s_mov_b32 s61, s60
    s_mov_b32 s62, 0x3e803e80
    s_mov_b32 s63, s62
    s_mov_b32 s28, 0
    s_lshl_b32 s24, s12, 14
    s_add_u32 s24, s24, 0
    s_add_u32 s66, s24, 33030144
    s_mul_i32 s40, s13, 3072
    s_add_u32 s23, s24, s40
    s_lshl_b32 s20, s12, 7
    s_add_u32 s20, s20, 68222976
    s_add_u32 s21, s20, 65536
    s_add_u32 s38, s20, 4096
    s_add_u32 s39, s21, 4096
    s_lshl_b32 s22, s12, 7
    s_add_u32 s22, s22, 68231168
    s_lshl_b32 s40, s12, 12
    s_add_u32 s25, s40, 79429632
    s_add_u32 s26, s40, 88866816
    s_lshl_b32 s65, s12, 9
    s_add_u32 s65, s65, 90177536
    s_lshl_b32 s40, s13, 5
    s_or_b32 s40, s40, s12
    s_cmp_lt_u32 s40, 24
    s_cselect_b32 s36, 0x1ffffff, 0
    s_mov_b32 s37, 0
    s_lshl_b32 s27, s12, 7
    s_add_u32 s27, s27, 125845504
    s_lshl_b32 s40, s13, 2
    s_add_u32 s27, s27, s40
    s_mov_b32 m0, 108032
    v_lshlrev_b32 v56, 2, v61
    buffer_load_dword v56, s[4:7], s24 offen sc1 lds
    s_add_u32 s24, s24, 524288
    buffer_load_dword v56, s[4:7], s24 offen sc1 lds
    s_add_u32 s24, s24, 524288
    v_lshlrev_b32 v56, 2, v61
    s_lshl_b32 s40, s12, 14
    s_add_u32 s40, s40, 68222976
    buffer_load_dword v56, s[4:7], s40 offen sc1 lds
    s_and_b32 s40, s12, 3
    s_lshl_b32 s40, s40, 14
    s_add_u32 s40, s40, 68157440
    buffer_load_dword v56, s[4:7], s40 offen sc1 lds
    s_add_u32 s15, s14, 4096
    s_add_u32 s16, s14, 8192
    ds_read_b128 v[32:35], v62 offset:16384
    ds_read_b128 v[36:39], v62 offset:20480
    ds_read_b128 v[40:43], v61 offset:0
    ds_read_b128 v[44:47], v61 offset:4096
    ds_read_b128 v[48:51], v61 offset:8192
    ds_read_b128 v[52:55], v61 offset:12288
    s_mov_b32 s29, 1048576
    buffer_load_dwordx4 v[24:27], v61, s[4:7], s14 offen sc1
.p2align 6
cs_loop:
    v_mov_b64 v[0:1], 0
    v_mov_b64 v[2:3], 0
    v_mov_b64 v[4:5], 0
    v_mov_b64 v[6:7], 0
    v_mov_b64 v[8:9], 0
    v_mov_b64 v[10:11], 0
    v_mov_b64 v[12:13], 0
    v_mov_b64 v[14:15], 0
cs_loop2:
    ds_read_b128 v[16:19], v62 offset:8192
    ds_read_b128 v[20:23], v62 offset:12288
    v_lshrrev_b32 v56, 2, v61
    v_add_u32 v58, 106496, v56
    s_mov_b32 s29, 1048576
    s_waitcnt lgkmcnt(0)
cs_chk0:
    s_waitcnt vmcnt(0)
cs_chk0b:
    v_max3_u32 v57, v24, v25, v26
    v_max_u32 v57, v57, v27
    v_cmp_eq_u32 vcc, -1, v57
    ds_write_b128 v62, v[24:27] offset:40960
    s_cbranch_vccnz cs_spin0
    v_smfmac_f32_16x16x64_bf16 v[0:3], v[24:27], v[16:23], v60
    buffer_load_dwordx4 v[28:31], v61, s[4:7], s15 offen sc1
    buffer_load_dword v59, v56, s[4:7], s16 offen sc1
    v_smfmac_f32_16x16x64_bf16 v[8:11], v[24:27], v[32:39], v60
    v_mov_b64 v[16:17], 0
    v_smfmac_f32_16x16x64_bf16 v[12:15], v[24:27], v[48:55], v60
    ds_read_b128 v[32:35], v61 offset:16384
    v_mov_b64 v[18:19], 0
    s_waitcnt lgkmcnt(1)
    s_barrier
    ds_read_b128 v[48:51], v63 offset:0
    ds_read_b128 v[36:39], v61 offset:20480
    v_smfmac_f32_16x16x64_bf16 v[4:7], v[24:27], v[40:47], v60
    ds_read_b128 v[40:43], v61 offset:24576
    v_mov_b64 v[20:21], 0
    v_smfmac_f32_16x16x64_bf16 v[16:19], v[24:27], a[192:199], v60
    ds_read_b128 v[44:47], v61 offset:28672
    v_mov_b64 v[22:23], 0
    ds_read_b128 v[52:55], v64 offset:0
    s_nop 0
    v_smfmac_f32_16x16x64_bf16 v[20:23], v[24:27], a[200:207], v60
    s_waitcnt lgkmcnt(4)
    v_smfmac_f32_16x16x64_bf16 v[0:3], v[48:51], a[0:7], v60
    s_add_u32 s18, s14, s31
    s_add_u32 s41, s14, 16384
    s_waitcnt lgkmcnt(3)
    v_smfmac_f32_16x16x64_bf16 v[4:7], v[48:51], v[32:39], v60
    ds_read_b128 v[32:35], v61 offset:32768
    v_smfmac_f32_16x16x64_bf16 v[8:11], v[48:51], a[8:15], v60
    ds_read_b128 v[36:39], v61 offset:36864
    s_waitcnt lgkmcnt(3)
    v_smfmac_f32_16x16x64_bf16 v[12:15], v[48:51], v[40:47], v60
    ds_read_b128 v[40:43], v61 offset:40960
    s_waitcnt lgkmcnt(3)
    v_smfmac_f32_16x16x64_bf16 v[0:3], v[52:55], a[16:23], v60
    ds_read_b128 v[44:47], v61 offset:45056
    v_smfmac_f32_16x16x64_bf16 v[8:11], v[52:55], a[24:31], v60
    ds_read_b128 v[48:51], v71 offset:0
    s_waitcnt lgkmcnt(3)
    v_smfmac_f32_16x16x64_bf16 v[4:7], v[52:55], v[32:39], v60
    s_waitcnt vmcnt(0)
    ds_write_b128 v62, v[28:31] offset:45056
    s_waitcnt lgkmcnt(2)
    v_smfmac_f32_16x16x64_bf16 v[12:15], v[52:55], v[40:47], v60
    ds_write_b32 v58, v59
    v_max3_u32 v57, v28, v29, v30
    s_waitcnt lgkmcnt(2)
    v_smfmac_f32_16x16x64_bf16 v[0:3], v[48:51], a[32:39], v60
    ds_read_b128 v[32:35], v61 offset:49152
    v_max3_u32 v57, v57, v31, v59
    v_smfmac_f32_16x16x64_bf16 v[8:11], v[48:51], a[40:47], v60
    ds_read_b128 v[36:39], v61 offset:53248
    v_cmp_eq_u32 vcc, -1, v57
    v_smfmac_f32_16x16x64_bf16 v[16:19], v[52:55], a[224:231], v60
    ds_read_b128 v[40:43], v61 offset:57344
    v_smfmac_f32_16x16x64_bf16 v[20:23], v[52:55], a[232:239], v60
    ds_read_b128 v[44:47], v61 offset:61440
    s_cbranch_vccnz cs_spin1
cs_go1:
    v_smfmac_f32_16x16x64_bf16 v[0:3], v[28:31], a[48:55], v60
    s_waitcnt lgkmcnt(4)
    s_barrier
    ds_read_b128 v[52:55], v63 offset:4096
    s_waitcnt lgkmcnt(3)
    v_smfmac_f32_16x16x64_bf16 v[4:7], v[48:51], v[32:39], v60
    ds_read_b128 v[56:59], v71 offset:4096
    v_smfmac_f32_16x16x64_bf16 v[8:11], v[28:31], a[56:63], v60
    buffer_load_dwordx4 v[32:35], v61, s[4:7], s23 offen offset:0 sc1
    s_waitcnt lgkmcnt(2)
    v_smfmac_f32_16x16x64_bf16 v[12:15], v[48:51], v[40:47], v60
    ds_read_b128 v[48:51], v64 offset:4096
    v_smfmac_f32_16x16x64_bf16 v[4:7], v[28:31], a[128:135], v60
    ds_read_b128 v[24:27], v65 offset:8192
    v_smfmac_f32_16x16x64_bf16 v[12:15], v[28:31], a[136:143], v60
    s_and_b32 s41, s41, 65535
    s_add_u32 s41, s41, 68157440
    v_smfmac_f32_16x16x64_bf16 v[16:19], v[28:31], v[80:87], v60
    buffer_load_dwordx4 v[36:39], v61, s[4:7], s23 offen offset:1024 sc1
    v_smfmac_f32_16x16x64_bf16 v[20:23], v[28:31], v[88:95], v60
    s_add_u32 s17, s41, s31
    s_and_b32 s30, s28, 1
    s_waitcnt lgkmcnt(3)
    v_smfmac_f32_16x16x64_bf16 v[0:3], v[52:55], a[64:71], v60
    ds_read_b128 v[28:31], v78 offset:8704
    v_smfmac_f32_16x16x64_bf16 v[4:7], v[52:55], a[144:151], v60
    buffer_load_dwordx4 v[40:43], v61, s[4:7], s23 offen offset:2048 sc1
    v_smfmac_f32_16x16x64_bf16 v[8:11], v[52:55], a[72:79], v60
    v_smfmac_f32_16x16x64_bf16 v[12:15], v[52:55], a[152:159], v60
    v_smfmac_f32_16x16x64_bf16 v[16:19], v[52:55], v[96:103], v60
    buffer_load_dwordx4 v[44:47], v61, s[4:7], s23 offen offset:3072 sc1
    v_smfmac_f32_16x16x64_bf16 v[20:23], v[52:55], v[104:111], v60
    ds_read_b128 v[52:55], v62 offset:28672
    s_waitcnt lgkmcnt(3)
    v_smfmac_f32_16x16x64_bf16 v[0:3], v[48:51], a[80:87], v60
    v_smfmac_f32_16x16x64_bf16 v[4:7], v[48:51], a[160:167], v60
    v_smfmac_f32_16x16x64_bf16 v[8:11], v[48:51], a[88:95], v60
    v_smfmac_f32_16x16x64_bf16 v[12:15], v[48:51], a[168:175], v60
    v_smfmac_f32_16x16x64_bf16 v[16:19], v[48:51], v[112:119], v60
    buffer_load_dword v79, s[4:7], s24 offen sc1 lds
    v_smfmac_f32_16x16x64_bf16 v[20:23], v[48:51], v[120:127], v60
    ds_read_b128 v[48:51], v62 offset:24576
    v_smfmac_f32_16x16x64_bf16 v[0:3], v[56:59], a[96:103], v60
    v_smfmac_f32_16x16x64_bf16 v[4:7], v[56:59], a[176:183], v60
    s_waitcnt lgkmcnt(3)
    v_smfmac_f32_16x16x64_bf16 v[0:3], v[24:27], a[112:119], v60
    s_cmp_ge_u32 s28, 62
    v_smfmac_f32_16x16x64_bf16 v[8:11], v[56:59], a[104:111], v60
    s_waitcnt lgkmcnt(0)
    v_smfmac_f32_16x16x64_bf16 v[4:7], v[24:27], v[48:55], v60
    ds_read_b128 v[48:51], v62 offset:32768
    v_cvt_pk_bf16_f32 v0, v0, v1
    v_smfmac_f32_16x16x64_bf16 v[12:15], v[56:59], a[184:191], v60
    ds_read_b128 v[52:55], v62 offset:36864
    v_cvt_pk_bf16_f32 v1, v2, v3
    v_smfmac_f32_16x16x64_bf16 v[8:11], v[24:27], a[120:127], v60
    v_cvt_pk_bf16_f32 v2, v4, v5
    v_smfmac_f32_16x16x64_bf16 v[16:19], v[56:59], v[128:135], v60
    v_cvt_pk_bf16_f32 v3, v6, v7
    s_nop 1
    v_mfma_f32_16x16x32_bf16 v[4:7], v[0:3], v[28:31], 0
    v_cvt_pk_bf16_f32 v8, v8, v9
    s_waitcnt lgkmcnt(0)
    v_smfmac_f32_16x16x64_bf16 v[12:15], v[24:27], v[48:55], v60
    ds_read_b128 v[48:51], v63 offset:0
    v_cvt_pk_bf16_f32 v9, v10, v11
    v_smfmac_f32_16x16x64_bf16 v[20:23], v[56:59], v[136:143], v60
    ds_read_b128 v[52:55], v71 offset:0
    v_cvt_pk_bf16_f32 v0, v4, v5
    s_nop 0
    v_cvt_pk_bf16_f32 v10, v12, v13
    v_cvt_pk_bf16_f32 v11, v14, v15
    v_cvt_pk_bf16_f32 v1, v6, v7
    s_waitcnt vmcnt(1)
    v_mfma_f32_16x16x32_bf16 v[12:15], v[8:11], v[28:31], 0
    s_mov_b64 exec, s[36:37]
    ds_read_b128 v[56:59], v69
    s_mov_b64 exec, -1
    v_smfmac_f32_16x16x64_bf16 v[16:19], v[24:27], v[144:151], v60
    s_nop 3
    v_cvt_pk_bf16_f32 v2, v12, v13
    v_cvt_pk_bf16_f32 v3, v14, v15
    s_nop 1
    v_mfma_f32_16x16x32_bf16 v[8:11], v[0:3], v[0:3], 0
    s_cbranch_scc1 cs_last
cs_back:
    v_mfma_f32_16x16x32_bf16 v[4:7], v[36:39], v[0:3], 0
    ds_read_b128 v[36:39], v63 offset:53248
    v_mfma_f32_16x16x32_bf16 v[12:15], v[32:35], v[0:3], 0
    ds_read_b128 v[32:35], v63 offset:49152
    v_mov_b32_dpp v8, v10 row_ror:8 row_mask:0xf bank_mask:0xc
    v_mov_b32_dpp v9, v11 row_ror:8 row_mask:0xf bank_mask:0xc
    ds_write_b64 v70, v[8:9]
    s_nop 1
    v_mov_b32_dpp v12, v4 row_ror:8 row_mask:0xf bank_mask:0xc
    v_mov_b32_dpp v13, v5 row_ror:8 row_mask:0xf bank_mask:0xc
    v_mov_b32_dpp v14, v6 row_ror:8 row_mask:0xf bank_mask:0xc
    v_mov_b32_dpp v15, v7 row_ror:8 row_mask:0xf bank_mask:0xc
    ds_write_b128 v62, v[12:15] offset:53248
    v_smfmac_f32_16x16x64_bf16 v[20:23], v[24:27], v[152:159], v60
    s_waitcnt lgkmcnt(4)
    s_mov_b64 exec, s[36:37]
    s_cbranch_execz cs_np3363
    buffer_store_dwordx4 v[56:59], v61, s[4:7], s65 offen sc1
cs_np3363:
    s_mov_b64 exec, -1
    v_smfmac_f32_16x16x64_bf16 v[16:19], v[48:51], a[208:215], v60
    v_smfmac_f32_16x16x64_bf16 v[20:23], v[48:51], a[216:223], v60
    s_waitcnt lgkmcnt(0)
    s_barrier
    ds_read_b128 v[56:59], v78 offset:10752
    ds_read_b128 v[28:31], v78 offset:11264
    v_smfmac_f32_16x16x64_bf16 v[16:19], v[52:55], a[240:247], v60
    ds_read_b128 v[4:7], v63 offset:12288
    ds_read_b128 v[8:11], v64 offset:12288
    v_smfmac_f32_16x16x64_bf16 v[20:23], v[52:55], a[248:255], v60
    ds_read_b128 v[0:3], v71 offset:12288
    ds_read_b128 v[48:51], v63 offset:57344
    ds_read_b128 v[52:55], v63 offset:61440
    v_mul_f32 v12, s44, v12
    v_mul_f32 v13, s44, v13
    v_mul_f32 v14, s44, v14
    v_mul_f32 v15, s44, v15
    v_mov_b64 v[24:25], s[62:63]
    v_cvt_pk_bf16_f32 v16, v16, v17
    s_waitcnt lgkmcnt(5)
    v_pk_add_f32 v[56:57], v[56:57], v[58:59]
    v_pk_add_f32 v[28:29], v[28:29], v[30:31]
    v_pk_add_f32 v[56:57], v[56:57], v[28:29]
    v_pk_mul_f32 v[56:57], v[56:57], s[44:45]
    v_exp_f32 v58, v56
    v_exp_f32 v59, v57
    s_waitcnt lgkmcnt(4)
    v_pk_fma_f32 v[12:13], v[4:5], s[44:45], v[12:13]
    v_pk_fma_f32 v[14:15], v[6:7], s[44:45], v[14:15]
    v_cvt_pk_bf16_f32 v6, v58, v59
    v_cvt_pk_bf16_f32 v17, v18, v19
    s_waitcnt lgkmcnt(2)
    v_pk_fma_f32 v[12:13], v[8:9], s[44:45], v[12:13]
    v_pk_fma_f32 v[14:15], v[10:11], s[44:45], v[14:15]
    v_pk_fma_f32 v[12:13], v[0:1], s[44:45], v[12:13]
    v_mov_b32_dpp v7, v6 row_ror:8 row_mask:0xf bank_mask:0xf
    v_pk_fma_f32 v[14:15], v[2:3], s[44:45], v[14:15]
    v_exp_f32 v0, v12
    v_mfma_f32_16x16x16_bf16 v[28:31], v[16:17], v[6:7], 0
    v_exp_f32 v1, v13
    v_cvt_pk_bf16_f32 v18, v20, v21
    v_exp_f32 v2, v14
    v_cvt_pk_bf16_f32 v19, v22, v23
    v_cvt_pk_bf16_f32 v8, v0, v1
    v_exp_f32 v3, v15
    v_mfma_f32_16x16x16_bf16 v[20:23], v[18:19], v[6:7], 0
    v_mov_b64 v[26:27], s[60:61]
    v_cvt_pk_bf16_f32 v9, v2, v3
    v_mov_b32_dpp v10, v8 row_ror:8 row_mask:0xf bank_mask:0xf
    v_max3_f32 v4, |v12|, |v13|, |v14|
    v_mfma_f32_16x16x32_bf16 v[0:3], v[24:27], v[6:9], 0
    v_mov_b32_dpp v11, v9 row_ror:8 row_mask:0xf bank_mask:0xf
    v_max3_f32 v4, v4, |v15|, |v56|
    v_max_f32_e64 v4, v4, |v57|
    v_mfma_f32_16x16x32_bf16 v[28:31], v[40:43], v[8:11], v[28:31]
    v_cmp_nge_f32 vcc, s46, v4
    v_mfma_f32_16x16x32_bf16 v[20:23], v[44:47], v[8:11], v[20:23]
    s_cbranch_scc1 cs_stash
cs_back2:
    s_cbranch_vccnz cs_guard
cs_norm:
    v_add_f32_dpp v0, v0, v0 row_ror:8 row_mask:0xf bank_mask:0xf
    v_rcp_f32 v0, v0
    v_mfma_f32_16x16x16_bf16 v[12:15], v[72:73], v[72:73], 0
    v_mul_f32 v28, v28, v0
    v_mul_f32 v29, v29, v0
    v_mul_f32 v30, v30, v0
    v_mul_f32 v31, v31, v0
    v_mul_f32_dpp v28, v20, v0 row_ror:8 row_mask:0xf bank_mask:0xc
    v_mul_f32_dpp v29, v21, v0 row_ror:8 row_mask:0xf bank_mask:0xc
    v_mul_f32_dpp v30, v22, v0 row_ror:8 row_mask:0xf bank_mask:0xc
    v_mul_f32_dpp v31, v23, v0 row_ror:8 row_mask:0xf bank_mask:0xc
    v_cvt_pk_bf16_f32 v28, v28, v29
    v_cvt_pk_bf16_f32 v29, v30, v31
    v_mfma_f32_16x16x16_bf16 v[8:11], v[72:73], v[72:73], 0
    ds_write_b64 v77, v[28:29]
    v_mfma_f32_16x16x16_bf16 v[4:7], v[72:73], v[72:73], 0
    ds_read_b128 v[0:3], v68
    v_mfma_f32_16x16x16_bf16 v[16:19], v[72:73], v[72:73], 0
    ds_read_b128 v[40:43], v63 offset:16384
    v_mfma_f32_16x16x16_bf16 v[20:23], v[72:73], v[72:73], 0
    ds_read_b128 v[44:47], v63 offset:20480
    s_waitcnt lgkmcnt(3)
    s_barrier
    ds_read_b128 v[24:27], v74
    ds_read_b128 v[28:31], v75
    ds_read_b128 v[56:59], v76
    s_waitcnt lgkmcnt(5)
    v_smfmac_f32_16x16x64_bf16 v[12:15], v[0:3], v[160:167], v60
    v_smfmac_f32_16x16x64_bf16 v[8:11], v[0:3], v[192:199], v60
    v_smfmac_f32_16x16x64_bf16 v[4:7], v[0:3], v[32:39], v60
    ds_read_b128 v[32:35], v63 offset:32768
    v_smfmac_f32_16x16x64_bf16 v[16:19], v[0:3], v[224:231], v60
    ds_read_b128 v[36:39], v63 offset:36864
    s_waitcnt lgkmcnt(3)
    v_smfmac_f32_16x16x64_bf16 v[12:15], v[24:27], v[168:175], v60
    v_smfmac_f32_16x16x64_bf16 v[4:7], v[28:31], v[48:55], v60
    ds_read_b128 v[48:51], v63 offset:24576
    v_smfmac_f32_16x16x64_bf16 v[12:15], v[28:31], v[176:183], v60
    ds_read_b128 v[52:55], v63 offset:28672
    s_waitcnt lgkmcnt(4)
    v_smfmac_f32_16x16x64_bf16 v[12:15], v[56:59], v[184:191], v60
    v_cvt_pk_bf16_f32 v4, v4, v5
    v_smfmac_f32_16x16x64_bf16 v[16:19], v[28:31], v[40:47], v60
    ds_read_b128 v[40:43], v63 offset:40960
    v_and_or_b32 v4, v4, -2, s30
    v_smfmac_f32_16x16x64_bf16 v[8:11], v[24:27], v[200:207], v60
    ds_read_b128 v[44:47], v63 offset:45056
    v_cvt_pk_bf16_f32 v5, v6, v7
    v_smfmac_f32_16x16x64_bf16 v[8:11], v[28:31], v[208:215], v60
    buffer_store_dwordx2 v[4:5], v67, s[4:7], s22 offen sc1
    v_cvt_pk_bf16_f32 v12, v12, v13
    v_smfmac_f32_16x16x64_bf16 v[8:11], v[56:59], v[216:223], v60
    v_and_or_b32 v12, v12, -2, s30
    v_smfmac_f32_16x16x64_bf16 v[16:19], v[24:27], v[232:239], v60
    v_cvt_pk_bf16_f32 v13, v14, v15
    s_waitcnt lgkmcnt(4)
    v_smfmac_f32_16x16x64_bf16 v[16:19], v[56:59], v[32:39], v60
    buffer_store_dwordx2 v[12:13], v66, s[4:7], s20 offen sc1
    v_cvt_pk_bf16_f32 v8, v8, v9
    s_waitcnt lgkmcnt(0)
    v_smfmac_f32_16x16x64_bf16 v[20:23], v[0:3], v[240:247], v60
    v_and_or_b32 v8, v8, -2, s30
    v_smfmac_f32_16x16x64_bf16 v[20:23], v[24:27], v[248:255], v60
    v_cvt_pk_bf16_f32 v9, v10, v11
    v_smfmac_f32_16x16x64_bf16 v[20:23], v[28:31], v[48:55], v60
    buffer_store_dwordx2 v[8:9], v66, s[4:7], s21 offen sc1
    v_cvt_pk_bf16_f32 v16, v16, v17
    v_smfmac_f32_16x16x64_bf16 v[20:23], v[56:59], v[40:47], v60
    v_and_or_b32 v16, v16, -2, s30
    v_cvt_pk_bf16_f32 v17, v18, v19
    buffer_store_dwordx2 v[16:17], v66, s[4:7], s38 offen sc1
    s_cmp_lg_u32 s13, 2
    s_nop 1
    v_cvt_pk_bf16_f32 v20, v20, v21
    v_and_or_b32 v20, v20, -2, s30
    v_cvt_pk_bf16_f32 v21, v22, v23
    buffer_store_dwordx2 v[20:21], v66, s[4:7], s39 offen sc1
    s_cbranch_scc1 cs_w013
    s_nop 15
    s_nop 15
    s_nop 15
    s_nop 15
    s_nop 15
    s_nop 15
    s_nop 15
    s_nop 15
    s_nop 15
    s_nop 15
    s_nop 15
    s_nop 15
    s_nop 7
    buffer_load_dwordx4 v[40:43], v65, s[4:7], s19 offen offset:0 sc1
    buffer_load_dwordx4 v[44:47], v65, s[4:7], s19 offen offset:1024 sc1
    buffer_load_dwordx4 v[48:51], v65, s[4:7], s19 offen offset:2048 sc1
    buffer_load_dwordx4 v[52:55], v65, s[4:7], s19 offen offset:3072 sc1
    ds_read_b128 v[56:59], v65 offset:10240
    s_add_u32 s28, s28, 1
    s_mov_b32 s14, s41
    s_add_u32 s23, s23, 524288
    s_add_u32 s24, s24, 524288
    s_min_u32 s24, s24, s66
    s_add_u32 s15, s14, 4096
    s_add_u32 s16, s14, 8192
    v_mov_b32 v21, -1
    s_add_u32 s65, s65, 12288
    s_mov_b32 s40, 1
    v_mov_b64 v[0:1], 0
    v_mov_b64 v[2:3], 0
    v_mov_b64 v[4:5], 0
    v_mov_b64 v[6:7], 0
    v_mov_b64 v[8:9], 0
    v_mov_b64 v[10:11], 0
    v_mov_b64 v[12:13], 0
    v_mov_b64 v[14:15], 0
cs_chkF:
    v_mov_b32 v20, 0
    s_waitcnt vmcnt(3)
    s_waitcnt lgkmcnt(0)
    v_mfma_f32_16x16x32_bf16 v[28:31], v[40:43], v[56:59], 0
    v_bitop3_b32 v20, v20, v40, s30 bitop3:0xf6
    v_bitop3_b32 v20, v20, v42, s30 bitop3:0xf6
    s_waitcnt vmcnt(2)
    v_mfma_f32_16x16x32_bf16 v[28:31], v[44:47], v[56:59], v[28:31]
    v_bitop3_b32 v20, v20, v44, s30 bitop3:0xf6
    v_bitop3_b32 v20, v20, v46, s30 bitop3:0xf6
    s_waitcnt vmcnt(1)
    v_mfma_f32_16x16x32_bf16 v[28:31], v[48:51], v[56:59], v[28:31]
    v_bitop3_b32 v20, v20, v48, s30 bitop3:0xf6
    v_bitop3_b32 v20, v20, v50, s30 bitop3:0xf6
    s_waitcnt vmcnt(0)
    v_mfma_f32_16x16x32_bf16 v[28:31], v[52:55], v[56:59], v[28:31]
    v_bitop3_b32 v20, v20, v52, s30 bitop3:0xf6
    v_bitop3_b32 v20, v20, v54, s30 bitop3:0xf6
    v_and_b32 v20, s40, v20
    v_cmp_ne_u32 vcc, 0, v20
    s_cbranch_vccnz cs_spinF
    v_permlane32_swap_b32 v28, v30
    v_permlane32_swap_b32 v29, v31
    v_add_f32 v28, v28, v30
    v_add_f32 v30, v29, v31
    v_cvt_pk_bf16_f32 v28, v28, v30
    s_mov_b64 exec, s[32:33]
    buffer_store_dword v28, v69, s[4:7], s17 offen sc1
    buffer_store_dword v21, v69, s[4:7], s18 offen sc1
    s_mov_b64 exec, -1
    ds_read_b128 v[32:35], v62 offset:16384
    ds_read_b128 v[36:39], v62 offset:20480
    ds_read_b128 v[40:43], v61 offset:0
    ds_read_b128 v[44:47], v61 offset:4096
    ds_read_b128 v[48:51], v61 offset:8192
    ds_read_b128 v[52:55], v61 offset:12288
    s_nop 15
    s_nop 15
    s_nop 15
    s_nop 15
    s_nop 15
    s_nop 15
    s_nop 3
    buffer_load_dwordx4 v[24:27], v61, s[4:7], s14 offen sc1
    s_branch cs_loop2
cs_w013:
    ds_read_b128 v[56:59], v65 offset:10240
    ds_read_b128 v[32:35], v62 offset:16384
    ds_read_b128 v[36:39], v62 offset:20480
    ds_read_b128 v[40:43], v61 offset:0
    ds_read_b128 v[44:47], v61 offset:4096
    ds_read_b128 v[48:51], v61 offset:8192
    ds_read_b128 v[52:55], v61 offset:12288
    s_add_u32 s28, s28, 1
    s_mov_b32 s14, s41
    s_add_u32 s23, s23, 524288
    s_add_u32 s24, s24, 524288
    s_min_u32 s24, s24, s66
    s_add_u32 s15, s14, 4096
    s_add_u32 s16, s14, 8192
    v_mov_b32 v21, -1
    s_add_u32 s65, s65, 12288
    s_mov_b32 s40, 1
    s_cmp_eq_u32 s64, 0
    s_cbranch_scc1 cs_w0
    s_cmp_eq_u32 s13, 1
    s_cbranch_scc1 cs_sx
    s_nop 15
    s_nop 15
    s_nop 15
    s_nop 15
    s_nop 15
    s_nop 15
    s_nop 15
    s_nop 15
    s_nop 15
    s_nop 15
    s_nop 15
    s_nop 15
    s_nop 7
cs_sx:
    buffer_load_dwordx4 v[0:3], v65, s[4:7], s19 offen offset:0 sc1
    buffer_load_dwordx4 v[4:7], v65, s[4:7], s19 offen offset:1024 sc1
    buffer_load_dwordx4 v[8:11], v65, s[4:7], s19 offen offset:2048 sc1
    buffer_load_dwordx4 v[12:15], v65, s[4:7], s19 offen offset:3072 sc1
cs_chkG:
    v_mov_b32 v20, 0
    s_waitcnt vmcnt(3)
    s_waitcnt lgkmcnt(6)
    v_mfma_f32_16x16x32_bf16 v[28:31], v[0:3], v[56:59], 0
    v_bitop3_b32 v20, v20, v0, s30 bitop3:0xf6
    v_bitop3_b32 v20, v20, v2, s30 bitop3:0xf6
    s_waitcnt vmcnt(2)
    v_mfma_f32_16x16x32_bf16 v[28:31], v[4:7], v[56:59], v[28:31]
    v_bitop3_b32 v20, v20, v4, s30 bitop3:0xf6
    v_bitop3_b32 v20, v20, v6, s30 bitop3:0xf6
    s_waitcnt vmcnt(1)
    v_mfma_f32_16x16x32_bf16 v[28:31], v[8:11], v[56:59], v[28:31]
    v_bitop3_b32 v20, v20, v8, s30 bitop3:0xf6
    v_bitop3_b32 v20, v20, v10, s30 bitop3:0xf6
    s_waitcnt vmcnt(0)
    v_mfma_f32_16x16x32_bf16 v[28:31], v[12:15], v[56:59], v[28:31]
    v_bitop3_b32 v20, v20, v12, s30 bitop3:0xf6
    v_bitop3_b32 v20, v20, v14, s30 bitop3:0xf6
    v_and_b32 v20, s40, v20
    v_cmp_ne_u32 vcc, 0, v20
    s_cbranch_vccnz cs_spinG
    v_permlane32_swap_b32 v28, v30
    v_permlane32_swap_b32 v29, v31
    v_add_f32 v28, v28, v30
    v_add_f32 v30, v29, v31
    s_cmp_eq_u32 s13, 3
    s_cbranch_scc1 cs_w3
    v_mov_b32 v29, v28
    v_mov_b32 v31, v30
    s_nop 0
    v_permlane16_swap_b32 v28, v29
    v_permlane16_swap_b32 v30, v31
    v_add_f32 v28, v28, v29
    v_add_f32 v30, v30, v31
cs_w3:
    v_cvt_pk_bf16_f32 v28, v28, v30
    s_mov_b64 exec, s[32:33]
    buffer_store_dword v28, v69, s[4:7], s17 offen sc1
    buffer_store_dword v21, v69, s[4:7], s18 offen sc1
    s_mov_b64 exec, -1
    buffer_load_dwordx4 v[24:27], v61, s[4:7], s14 offen sc1
    s_branch cs_loop
cs_w0:
    v_mov_b64 v[0:1], 0
    v_mov_b64 v[2:3], 0
    v_mov_b64 v[4:5], 0
    v_mov_b64 v[6:7], 0
    v_mov_b64 v[8:9], 0
    v_mov_b64 v[10:11], 0
    v_mov_b64 v[12:13], 0
    v_mov_b64 v[14:15], 0
    s_cmp_lg_u32 s28, 10
    s_cbranch_scc1 cs_nokv
    s_lshr_b32 s92, s12, 1
    s_lshl_b32 s92, s92, 8
    s_add_u32 s92, s92, 125829120
    v_bfe_u32 v28, v61, 4, 6
    v_min_u32 v28, 11, v28
    v_lshlrev_b32 v28, 2, v28
    s_add_u32 s93, s95, 63
    s_mov_b32 s94, 4194304
cs_kv1:
    buffer_load_dword v29, v28, s[4:7], s92 offen sc1
    s_sub_u32 s94, s94, 1
    s_cbranch_scc1 cs_kv1_go
    s_waitcnt vmcnt(0)
    v_subrev_u32 v29, s93, v29
    v_cmp_lt_u32 vcc, 64, v29
    s_cbranch_vccz cs_kv1_go
    s_sleep 2
    s_branch cs_kv1
cs_kv1_go:
cs_nokv:
    s_nop 15
    s_nop 15
    s_nop 15
    s_nop 15
    s_nop 15
    s_nop 15
    s_nop 15
    s_nop 15
    s_nop 15
    s_nop 15
    s_nop 15
    s_nop 15
    s_nop 15
    s_nop 15
    s_nop 15
    s_nop 15
    s_nop 15
    s_nop 15
    s_nop 15
    s_nop 15
    s_nop 15
    s_nop 15
    s_nop 15
    s_nop 15
    s_nop 15
    buffer_load_dwordx4 v[24:27], v61, s[4:7], s14 offen sc1
    s_branch cs_loop2
cs_spinF:
    buffer_load_dwordx4 v[40:43], v65, s[4:7], s19 offen offset:0 sc1
    buffer_load_dwordx4 v[44:47], v65, s[4:7], s19 offen offset:1024 sc1
    buffer_load_dwordx4 v[48:51], v65, s[4:7], s19 offen offset:2048 sc1
    buffer_load_dwordx4 v[52:55], v65, s[4:7], s19 offen offset:3072 sc1
    s_sub_u32 s29, s29, 1
    s_cmp_lt_i32 s29, 0
    s_cselect_b32 s40, 0, 1
    s_branch cs_chkF
cs_spinG:
    buffer_load_dwordx4 v[0:3], v65, s[4:7], s19 offen offset:0 sc1
    buffer_load_dwordx4 v[4:7], v65, s[4:7], s19 offen offset:1024 sc1
    buffer_load_dwordx4 v[8:11], v65, s[4:7], s19 offen offset:2048 sc1
    buffer_load_dwordx4 v[12:15], v65, s[4:7], s19 offen offset:3072 sc1
    s_sub_u32 s29, s29, 1
    s_cmp_lt_i32 s29, 0
    s_cselect_b32 s40, 0, 1
    s_branch cs_chkG
cs_guard:
    s_nop 7
    v_max3_f32 v6, v12, v13, v14
    v_max3_f32 v7, v15, v56, v57
    v_max_f32 v6, v6, v7
    s_nop 1
    v_max_f32_dpp v6, v6, v6 row_ror:8 row_mask:0xf bank_mask:0xf
    v_mov_b32 v7, v6
    s_nop 1
    v_permlane32_swap_b32 v6, v7
    v_max_f32 v6, v6, v7
    v_mov_b32 v7, v6
    s_nop 1
    v_permlane16_swap_b32 v6, v7
    v_max_f32 v6, v6, v7
    v_sub_f32 v12, v12, v6
    v_sub_f32 v13, v13, v6
    v_sub_f32 v14, v14, v6
    v_sub_f32 v15, v15, v6
    v_sub_f32 v56, v56, v6
    v_sub_f32 v57, v57, v6
    v_exp_f32 v58, v56
    v_exp_f32 v59, v57
    s_nop 0
    v_cvt_pk_bf16_f32 v6, v58, v59
    s_nop 1
    v_mov_b32_dpp v7, v6 row_ror:8 row_mask:0xf bank_mask:0xf
    v_exp_f32 v0, v12
    s_nop 0
    v_mfma_f32_16x16x16_bf16 v[28:31], v[16:17], v[6:7], 0
    v_exp_f32 v1, v13
    v_exp_f32 v2, v14
    v_cvt_pk_bf16_f32 v8, v0, v1
    v_exp_f32 v3, v15
    v_mfma_f32_16x16x16_bf16 v[20:23], v[18:19], v[6:7], 0
    v_cvt_pk_bf16_f32 v9, v2, v3
    v_mov_b32_dpp v10, v8 row_ror:8 row_mask:0xf bank_mask:0xf
    v_max3_f32 v4, |v12|, |v13|, |v14|
    v_mfma_f32_16x16x32_bf16 v[0:3], v[24:27], v[6:9], 0
    v_mov_b32_dpp v11, v9 row_ror:8 row_mask:0xf bank_mask:0xf
    v_max3_f32 v4, v4, |v15|, |v56|
    v_max_f32_e64 v4, v4, |v57|
    v_mfma_f32_16x16x32_bf16 v[28:31], v[40:43], v[8:11], v[28:31]
    v_cmp_nge_f32 vcc, s46, v4
    v_mfma_f32_16x16x32_bf16 v[20:23], v[44:47], v[8:11], v[20:23]
    s_nop 7
    s_branch cs_norm
cs_stash:
    buffer_store_dwordx4 v[16:19], v61, s[4:7], s26 offen sc1
    s_add_u32 s26, s26, 131072
    s_nop 1
    s_branch cs_back2
cs_spin0:
    buffer_load_dwordx4 v[24:27], v61, s[4:7], s14 offen sc1
    s_sub_u32 s29, s29, 1
    s_cmp_lt_i32 s29, 0
    s_cbranch_scc0 cs_chk0
    s_waitcnt vmcnt(0)
    v_min_u32 v24, -2, v24
    v_min_u32 v25, -2, v25
    v_min_u32 v26, -2, v26
    v_min_u32 v27, -2, v27
    s_branch cs_chk0
cs_spin1:
    buffer_load_dwordx4 v[28:31], v61, s[4:7], s15 offen sc1
    buffer_load_dword v59, v56, s[4:7], s16 offen sc1
    s_sub_u32 s29, s29, 1
    s_cmp_lt_i32 s29, 0
    s_waitcnt vmcnt(0)
    v_max3_u32 v57, v28, v29, v30
    v_max3_u32 v57, v57, v31, v59
    v_cmp_eq_u32 vcc, -1, v57
    ds_write_b128 v62, v[28:31] offset:45056
    ds_write_b32 v58, v59
    s_waitcnt lgkmcnt(0)
    s_cbranch_scc1 cs_go1
    s_cbranch_vccnz cs_spin1
    s_branch cs_go1
cs_last:
    s_nop 1
    s_cmp_eq_u32 s28, 63
    s_cbranch_scc1 cs_last2
    s_mov_b64 exec, s[34:35]
    buffer_store_dwordx4 v[0:3], v61, s[4:7], s25 offen sc1
    s_mov_b64 exec, -1
    s_add_u32 s25, s25, 131072
    s_cmp_eq_u32 0, 0
    s_branch cs_back
cs_last2:
    s_waitcnt lgkmcnt(0)
    s_mov_b64 exec, s[34:35]
    buffer_store_dwordx4 v[0:3], v61, s[4:7], s25 offen sc1
    s_mov_b64 exec, -1
    s_add_u32 s40, s95, 64
    v_mov_b32 v32, s40
    v_smfmac_f32_16x16x64_bf16 v[20:23], v[24:27], v[152:159], v60
    v_smfmac_f32_16x16x64_bf16 v[16:19], v[48:51], a[208:215], v60
    v_smfmac_f32_16x16x64_bf16 v[20:23], v[48:51], a[216:223], v60
    v_smfmac_f32_16x16x64_bf16 v[16:19], v[52:55], a[240:247], v60
    v_smfmac_f32_16x16x64_bf16 v[20:23], v[52:55], a[248:255], v60
    s_nop 3
    v_cvt_pk_bf16_f32 v16, v16, v17
    v_cvt_pk_bf16_f32 v17, v18, v19
    s_nop 1
    v_cvt_pk_bf16_f32 v18, v20, v21
    v_cvt_pk_bf16_f32 v19, v22, v23
    buffer_store_dwordx4 v[16:19], v61, s[4:7], s26 offen sc1
    s_waitcnt vmcnt(0)
    s_mov_b64 exec, 1
    buffer_store_dword v32, off, s[4:7], s27 sc1
    s_mov_b64 exec, -1
    s_endpgm
cs_dma:
    s_xor_b32 s74, s76, s81
    s_add_u32 m0, s74, s80
    s_add_u32 s76, s76, 4096
    buffer_load_dwordx4 v58, s[8:11], s78 offen lds
    s_add_u32 s78, s78, s79
    s_cmp_lt_u32 s76, s77
    s_cbranch_scc1 cs_dma
    s_setpc_b64 s[82:83]
L_helper:
    s_load_dwordx16 s[64:79], s[0:1], 64
    s_sub_u32 s33, s3, 1
    s_and_b32 s33, s33, 7
L_pool:
    s_lshl_b32 s35, s33, 2
    s_add_u32 s35, s35, 32
    s_mov_b32 s37, s35
    v_mov_b32 v250, 1
    v_mov_b32 v251, 163832
    v_cmp_eq_u32 vcc, 0, v0
    s_nop 0
    s_and_saveexec_b64 s[38:39], vcc
    s_cbranch_execz tk4
    buffer_atomic_add v250, off, s[96:99], s37 sc0
    s_waitcnt vmcnt(0)
    ds_write_b32 v251, v250
    s_waitcnt lgkmcnt(0)
tk4:
    s_mov_b64 exec, -1
    s_barrier
    ds_read_b32 v252, v251
    s_waitcnt lgkmcnt(0)
    v_readfirstlane_b32 s34, v252
    s_barrier
    s_nop 3
    s_mul_i32 s36, s33, 30
    s_add_u32 s36, s36, s34
    s_or_b32 s33, s34, s32
    s_cmp_lg_u32 s33, 0
    s_cbranch_scc1 L_helper1
    s_memrealtime s[90:91]
    s_waitcnt lgkmcnt(0)
    s_lshl_b32 s90, s90, 8
    s_or_b32 s90, s90, 1
    v_mov_b32 v250, s90
    v_mov_b32 v251, 0
    s_mov_b64 exec, 1
    buffer_atomic_cmpswap v[250:251], off, s[96:99], 0 offset:144
    s_mov_b64 exec, -1
L_helper1:
    s_cmp_ge_u32 s34, 30
    s_cbranch_scc1 L_qkv_next
    s_cmp_ge_u32 s36, 192
    s_cbranch_scc1 L_qkv_next
    s_mul_i32 s37, s36, 171
    s_lshr_b32 s37, s37, 10
    s_mul_i32 s38, s37, 6
    s_sub_u32 s36, s36, s38
    s_lshl_b32 s36, s36, 5
    s_add_u32 s36, s36, s37
    s_branch L_job
L_qkv_next:
    s_mov_b32 s37, 4
    v_mov_b32 v250, 1
    v_mov_b32 v251, 163832
    v_cmp_eq_u32 vcc, 0, v0
    s_nop 0
    s_and_saveexec_b64 s[38:39], vcc
    s_cbranch_execz tk5
    buffer_atomic_add v250, off, s[96:99], s37 sc0
    s_waitcnt vmcnt(0)
    ds_write_b32 v251, v250
    s_waitcnt lgkmcnt(0)
tk5:
    s_mov_b64 exec, -1
    s_barrier
    ds_read_b32 v252, v251
    s_waitcnt lgkmcnt(0)
    v_readfirstlane_b32 s36, v252
    s_barrier
    s_nop 3
    s_add_u32 s36, s36, 192
    s_cmp_ge_u32 s36, 320
    s_cbranch_scc1 L_ssm_next
L_job:
    s_and_b32 s17, s36, 15
    s_lshl_b32 s17, s17, 1
    s_bfe_u32 s16, s36, 0x10004
    s_lshr_b32 s19, s36, 5
    s_mul_i32 s33, s16, 6
    s_add_u32 s33, s33, s19
    s_add_u32 s16, s16, 1
    s_lshr_b32 s37, s36, 4
    s_sub_u32 s38, s37, 12
    s_cmp_ge_u32 s36, 192
    s_cselect_b32 s16, 0, s16
    s_cselect_b32 s19, s38, s19
    s_cselect_b32 s33, s37, s33
    s_cselect_b32 s20, 8, 6
    v_lshrrev_b32 v4, 6, v0
    s_nop 0
    v_readfirstlane_b32 s18, v4
    v_lshlrev_b32 v7, 4, v0
    v_and_b32 v4, 63, v0
    v_lshrrev_b32 v6, 2, v4
    v_lshlrev_b32 v6, 13, v6
    v_lshrrev_b32 v5, 4, v4
    v_and_b32 v5, 2, v5
    v_xor_b32 v5, v5, v4
    v_and_b32 v5, 3, v5
    v_lshl_add_u32 v6, v5, 4, v6
    v_lshrrev_b32 v24, 4, v4
    v_lshlrev_b32 v24, 9, v24
    v_bfe_u32 v5, v4, 2, 2
    v_lshl_add_u32 v24, v5, 6, v24
    v_bfe_u32 v5, v4, 4, 1
    v_lshl_add_u32 v24, v5, 5, v24
    v_and_b32 v5, 3, v4
    v_lshl_add_u32 v24, v5, 3, v24
    s_lshl_b32 s31, s18, 12
    v_add_u32 v24, s31, v24
    s_cmp_eq_u32 s16, 1
    s_cselect_b64 s[12:13], s[54:55], s[52:53]
    s_cmp_eq_u32 s16, 2
    s_cselect_b64 s[12:13], s[56:57], s[12:13]
    s_mov_b32 s14, 4718592
    s_mov_b32 s15, 0x20000
    s_lshl_b32 s28, s17, 8
    s_lshl_b32 s21, s18, 6
    s_add_u32 s28, s28, s21
    s_add_u32 s21, s28, 0
    s_add_u32 m0, s31, 40960
    s_nop 0
    buffer_load_dwordx4 v6, s[12:15], s21 offen lds
    s_add_u32 m0, s31, 41984
    s_add_u32 s21, s21, 131072
    buffer_load_dwordx4 v6, s[12:15], s21 offen lds
    s_add_u32 m0, s31, 43008
    s_add_u32 s21, s21, 131072
    buffer_load_dwordx4 v6, s[12:15], s21 offen lds
    s_add_u32 m0, s31, 44032
    s_add_u32 s21, s21, 131072
    buffer_load_dwordx4 v6, s[12:15], s21 offen lds
    s_add_u32 s21, s28, 256
    s_add_u32 m0, s31, 57344
    s_nop 0
    buffer_load_dwordx4 v6, s[12:15], s21 offen lds
    s_add_u32 m0, s31, 58368
    s_add_u32 s21, s21, 131072
    buffer_load_dwordx4 v6, s[12:15], s21 offen lds
    s_add_u32 m0, s31, 59392
    s_add_u32 s21, s21, 131072
    buffer_load_dwordx4 v6, s[12:15], s21 offen lds
    s_add_u32 m0, s31, 60416
    s_add_u32 s21, s21, 131072
    buffer_load_dwordx4 v6, s[12:15], s21 offen lds
    s_add_u32 s21, s28, 524288
    s_add_u32 m0, s31, 73728
    s_nop 0
    buffer_load_dwordx4 v6, s[12:15], s21 offen lds
    s_add_u32 m0, s31, 74752
    s_add_u32 s21, s21, 131072
    buffer_load_dwordx4 v6, s[12:15], s21 offen lds
    s_add_u32 m0, s31, 75776
    s_add_u32 s21, s21, 131072
    buffer_load_dwordx4 v6, s[12:15], s21 offen lds
    s_add_u32 m0, s31, 76800
    s_add_u32 s21, s21, 131072
    buffer_load_dwordx4 v6, s[12:15], s21 offen lds
    s_add_u32 s21, s28, 524544
    s_add_u32 m0, s31, 90112
    s_nop 0
    buffer_load_dwordx4 v6, s[12:15], s21 offen lds
    s_add_u32 m0, s31, 91136
    s_add_u32 s21, s21, 131072
    buffer_load_dwordx4 v6, s[12:15], s21 offen lds
    s_add_u32 m0, s31, 92160
    s_add_u32 s21, s21, 131072
    buffer_load_dwordx4 v6, s[12:15], s21 offen lds
    s_add_u32 m0, s31, 93184
    s_add_u32 s21, s21, 131072
    buffer_load_dwordx4 v6, s[12:15], s21 offen lds
    s_add_u32 s21, s28, 1048576
    s_add_u32 m0, s31, 106496
    s_nop 0
    buffer_load_dwordx4 v6, s[12:15], s21 offen lds
    s_add_u32 m0, s31, 107520
    s_add_u32 s21, s21, 131072
    buffer_load_dwordx4 v6, s[12:15], s21 offen lds
    s_add_u32 m0, s31, 108544
    s_add_u32 s21, s21, 131072
    buffer_load_dwordx4 v6, s[12:15], s21 offen lds
    s_add_u32 m0, s31, 109568
    s_add_u32 s21, s21, 131072
    buffer_load_dwordx4 v6, s[12:15], s21 offen lds
    s_add_u32 s21, s28, 1048832
    s_add_u32 m0, s31, 122880
    s_nop 0
    buffer_load_dwordx4 v6, s[12:15], s21 offen lds
    s_add_u32 m0, s31, 123904
    s_add_u32 s21, s21, 131072
    buffer_load_dwordx4 v6, s[12:15], s21 offen lds
    s_add_u32 m0, s31, 124928
    s_add_u32 s21, s21, 131072
    buffer_load_dwordx4 v6, s[12:15], s21 offen lds
    s_add_u32 m0, s31, 125952
    s_add_u32 s21, s21, 131072
    buffer_load_dwordx4 v6, s[12:15], s21 offen lds
    s_add_u32 s21, s28, 1572864
    s_add_u32 m0, s31, 139264
    s_nop 0
    buffer_load_dwordx4 v6, s[12:15], s21 offen lds
    s_add_u32 m0, s31, 140288
    s_add_u32 s21, s21, 131072
    buffer_load_dwordx4 v6, s[12:15], s21 offen lds
    s_add_u32 m0, s31, 141312
    s_add_u32 s21, s21, 131072
    buffer_load_dwordx4 v6, s[12:15], s21 offen lds
    s_add_u32 m0, s31, 142336
    s_add_u32 s21, s21, 131072
    buffer_load_dwordx4 v6, s[12:15], s21 offen lds
    v_and_b32 v5, 15, v4
    v_lshrrev_b32 v3, 4, v4
    v_lshrrev_b32 v2, 2, v5
    v_xor_b32 v3, v3, v2
    v_lshl_add_u32 v3, v5, 2, v3
    v_lshlrev_b32 v1, 4, v3
    v_lshrrev_b32 v5, 2, v4
    v_lshrrev_b32 v3, 4, v4
    v_and_b32 v4, 3, v4
    v_xor_b32 v4, v4, v3
    v_lshlrev_b32 v3, 3, v3
    v_and_b32 v5, 3, v5
    v_add_u32 v3, v3, v5
    v_mul_u32_u24 v2, 1152, v3
    v_lshl_add_u32 v2, v4, 4, v2
    s_mov_b32 s8, s48
    s_mov_b32 s9, s49
    s_mov_b32 s10, 2359296
    s_mov_b32 s11, 0x20000
    s_lshr_b32 s22, s18, 1
    s_mul_i32 s24, s22, 4608
    s_and_b32 s22, s18, 1
    s_mul_i32 s23, s22, 576
    s_add_u32 s24, s24, s23
    s_mul_i32 s25, s18, 9216
    s_mul_i32 s22, s19, 36864
    s_add_u32 s24, s24, s22
    s_mul_i32 s42, s20, 36864
    s_mov_b32 s27, 0
    s_add_u32 s23, s27, s25
    s_add_u32 m0, s23, 0
    s_nop 0
    buffer_load_dwordx4 v2, s[8:11], s24 offen offset:0 lds
    s_add_u32 m0, s23, 960
    s_nop 0
    buffer_load_dwordx4 v2, s[8:11], s24 offen offset:64 lds
    s_add_u32 m0, s23, 1920
    s_nop 0
    buffer_load_dwordx4 v2, s[8:11], s24 offen offset:128 lds
    s_add_u32 m0, s23, 2880
    s_nop 0
    buffer_load_dwordx4 v2, s[8:11], s24 offen offset:192 lds
    s_add_u32 m0, s23, 3840
    s_nop 0
    buffer_load_dwordx4 v2, s[8:11], s24 offen offset:256 lds
    s_add_u32 m0, s23, 4800
    s_nop 0
    buffer_load_dwordx4 v2, s[8:11], s24 offen offset:320 lds
    s_add_u32 m0, s23, 5760
    s_nop 0
    buffer_load_dwordx4 v2, s[8:11], s24 offen offset:384 lds
    s_add_u32 m0, s23, 6720
    s_nop 0
    buffer_load_dwordx4 v2, s[8:11], s24 offen offset:448 lds
    s_add_u32 m0, s23, 7680
    s_nop 0
    buffer_load_dwordx4 v2, s[8:11], s24 offen offset:512 lds
    s_add_u32 s24, s24, s42
    s_lshl_b32 s22, s19, 5
    s_add_u32 s22, s22, s17
    s_lshl_b32 s26, s22, 14
    s_mul_i32 s23, s18, 3072
    s_add_u32 s26, s26, s23
    s_lshl_b32 s23, s16, 11
    s_add_u32 s26, s26, s23
    s_add_u32 s26, s26, -2048
    s_lshl_b32 s22, s22, 13
    s_add_u32 s22, s22, 33554432
    s_cmp_eq_u32 s16, 0
    s_cselect_b32 s26, s22, s26
    s_cselect_b32 s40, 4, 1
    s_cselect_b32 s43, 1, 2
    s_lshl_b32 s40, s40, 10
    s_lshl_b32 s43, s43, 13
    s_lshl_b32 s41, s43, 5
    s_mul_i32 s41, s41, s20
    s_lshl_b32 s29, s17, 7
    s_lshl_b32 s22, s33, 2
    s_add_u32 s29, s29, s22
    s_add_u32 s29, s29, 125829120
    v_add_u32 v25, 40960, v24
    v_xor_b32 v26, 32, v25
    s_waitcnt vmcnt(33)
    ds_read_b64_tr_b16 v[64:65], v25 offset:0
    ds_read_b64_tr_b16 v[66:67], v25 offset:256
    ds_read_b64_tr_b16 v[136:137], v26 offset:0
    ds_read_b64_tr_b16 v[138:139], v26 offset:256
    ds_read_b64_tr_b16 v[68:69], v25 offset:2048
    ds_read_b64_tr_b16 v[70:71], v25 offset:2304
    ds_read_b64_tr_b16 v[140:141], v26 offset:2048
    ds_read_b64_tr_b16 v[142:143], v26 offset:2304
    s_waitcnt lgkmcnt(0)
    s_add_u32 s21, s28, 1573120
    s_add_u32 m0, s31, 40960
    s_nop 0
    buffer_load_dwordx4 v6, s[12:15], s21 offen lds
    s_add_u32 m0, s31, 41984
    s_add_u32 s21, s21, 131072
    buffer_load_dwordx4 v6, s[12:15], s21 offen lds
    s_add_u32 m0, s31, 43008
    s_add_u32 s21, s21, 131072
    buffer_load_dwordx4 v6, s[12:15], s21 offen lds
    s_add_u32 m0, s31, 44032
    s_add_u32 s21, s21, 131072
    buffer_load_dwordx4 v6, s[12:15], s21 offen lds
    v_add_u32 v25, 57344, v24
    v_xor_b32 v26, 32, v25
    s_waitcnt vmcnt(33)
    ds_read_b64_tr_b16 a[0:1], v25 offset:0
    ds_read_b64_tr_b16 a[2:3], v25 offset:256
    ds_read_b64_tr_b16 a[72:73], v26 offset:0
    ds_read_b64_tr_b16 a[74:75], v26 offset:256
    ds_read_b64_tr_b16 a[4:5], v25 offset:2048
    ds_read_b64_tr_b16 a[6:7], v25 offset:2304
    ds_read_b64_tr_b16 a[76:77], v26 offset:2048
    ds_read_b64_tr_b16 a[78:79], v26 offset:2304
    s_waitcnt lgkmcnt(0)
    s_add_u32 s21, s28, 2097152
    s_add_u32 m0, s31, 57344
    s_nop 0
    buffer_load_dwordx4 v6, s[12:15], s21 offen lds
    s_add_u32 m0, s31, 58368
    s_add_u32 s21, s21, 131072
    buffer_load_dwordx4 v6, s[12:15], s21 offen lds
    s_add_u32 m0, s31, 59392
    s_add_u32 s21, s21, 131072
    buffer_load_dwordx4 v6, s[12:15], s21 offen lds
    s_add_u32 m0, s31, 60416
    s_add_u32 s21, s21, 131072
    buffer_load_dwordx4 v6, s[12:15], s21 offen lds
    v_add_u32 v25, 73728, v24
    v_xor_b32 v26, 32, v25
    s_waitcnt vmcnt(33)
    ds_read_b64_tr_b16 v[72:73], v25 offset:0
    ds_read_b64_tr_b16 v[74:75], v25 offset:256
    ds_read_b64_tr_b16 v[144:145], v26 offset:0
    ds_read_b64_tr_b16 v[146:147], v26 offset:256
    ds_read_b64_tr_b16 v[76:77], v25 offset:2048
    ds_read_b64_tr_b16 v[78:79], v25 offset:2304
    ds_read_b64_tr_b16 v[148:149], v26 offset:2048
    ds_read_b64_tr_b16 v[150:151], v26 offset:2304
    s_waitcnt lgkmcnt(0)
    s_add_u32 s21, s28, 2097408
    s_add_u32 m0, s31, 73728
    s_nop 0
    buffer_load_dwordx4 v6, s[12:15], s21 offen lds
    s_add_u32 m0, s31, 74752
    s_add_u32 s21, s21, 131072
    buffer_load_dwordx4 v6, s[12:15], s21 offen lds
    s_add_u32 m0, s31, 75776
    s_add_u32 s21, s21, 131072
    buffer_load_dwordx4 v6, s[12:15], s21 offen lds
    s_add_u32 m0, s31, 76800
    s_add_u32 s21, s21, 131072
    buffer_load_dwordx4 v6, s[12:15], s21 offen lds
    v_add_u32 v25, 90112, v24
    v_xor_b32 v26, 32, v25
    s_waitcnt vmcnt(33)
    ds_read_b64_tr_b16 a[8:9], v25 offset:0
    ds_read_b64_tr_b16 a[10:11], v25 offset:256
    ds_read_b64_tr_b16 a[80:81], v26 offset:0
    ds_read_b64_tr_b16 a[82:83], v26 offset:256
    ds_read_b64_tr_b16 a[12:13], v25 offset:2048
    ds_read_b64_tr_b16 a[14:15], v25 offset:2304
    ds_read_b64_tr_b16 a[84:85], v26 offset:2048
    ds_read_b64_tr_b16 a[86:87], v26 offset:2304
    s_waitcnt lgkmcnt(0)
    s_add_u32 s21, s28, 2621440
    s_add_u32 m0, s31, 90112
    s_nop 0
    buffer_load_dwordx4 v6, s[12:15], s21 offen lds
    s_add_u32 m0, s31, 91136
    s_add_u32 s21, s21, 131072
    buffer_load_dwordx4 v6, s[12:15], s21 offen lds
    s_add_u32 m0, s31, 92160
    s_add_u32 s21, s21, 131072
    buffer_load_dwordx4 v6, s[12:15], s21 offen lds
    s_add_u32 m0, s31, 93184
    s_add_u32 s21, s21, 131072
    buffer_load_dwordx4 v6, s[12:15], s21 offen lds
    v_add_u32 v25, 106496, v24
    v_xor_b32 v26, 32, v25
    s_waitcnt vmcnt(33)
    ds_read_b64_tr_b16 v[80:81], v25 offset:0
    ds_read_b64_tr_b16 v[82:83], v25 offset:256
    ds_read_b64_tr_b16 v[152:153], v26 offset:0
    ds_read_b64_tr_b16 v[154:155], v26 offset:256
    ds_read_b64_tr_b16 v[84:85], v25 offset:2048
    ds_read_b64_tr_b16 v[86:87], v25 offset:2304
    ds_read_b64_tr_b16 v[156:157], v26 offset:2048
    ds_read_b64_tr_b16 v[158:159], v26 offset:2304
    s_waitcnt lgkmcnt(0)
    s_add_u32 s21, s28, 2621696
    s_add_u32 m0, s31, 106496
    s_nop 0
    buffer_load_dwordx4 v6, s[12:15], s21 offen lds
    s_add_u32 m0, s31, 107520
    s_add_u32 s21, s21, 131072
    buffer_load_dwordx4 v6, s[12:15], s21 offen lds
    s_add_u32 m0, s31, 108544
    s_add_u32 s21, s21, 131072
    buffer_load_dwordx4 v6, s[12:15], s21 offen lds
    s_add_u32 m0, s31, 109568
    s_add_u32 s21, s21, 131072
    buffer_load_dwordx4 v6, s[12:15], s21 offen lds
    v_add_u32 v25, 122880, v24
    v_xor_b32 v26, 32, v25
    s_waitcnt vmcnt(33)
    ds_read_b64_tr_b16 a[16:17], v25 offset:0
    ds_read_b64_tr_b16 a[18:19], v25 offset:256
    ds_read_b64_tr_b16 a[88:89], v26 offset:0
    ds_read_b64_tr_b16 a[90:91], v26 offset:256
    ds_read_b64_tr_b16 a[20:21], v25 offset:2048
    ds_read_b64_tr_b16 a[22:23], v25 offset:2304
    ds_read_b64_tr_b16 a[92:93], v26 offset:2048
    ds_read_b64_tr_b16 a[94:95], v26 offset:2304
    s_waitcnt lgkmcnt(0)
    s_add_u32 s21, s28, 3145728
    s_add_u32 m0, s31, 122880
    s_nop 0
    buffer_load_dwordx4 v6, s[12:15], s21 offen lds
    s_add_u32 m0, s31, 123904
    s_add_u32 s21, s21, 131072
    buffer_load_dwordx4 v6, s[12:15], s21 offen lds
    s_add_u32 m0, s31, 124928
    s_add_u32 s21, s21, 131072
    buffer_load_dwordx4 v6, s[12:15], s21 offen lds
    s_add_u32 m0, s31, 125952
    s_add_u32 s21, s21, 131072
    buffer_load_dwordx4 v6, s[12:15], s21 offen lds
    v_add_u32 v25, 139264, v24
    v_xor_b32 v26, 32, v25
    s_waitcnt vmcnt(33)
    ds_read_b64_tr_b16 v[88:89], v25 offset:0
    ds_read_b64_tr_b16 v[90:91], v25 offset:256
    ds_read_b64_tr_b16 v[160:161], v26 offset:0
    ds_read_b64_tr_b16 v[162:163], v26 offset:256
    ds_read_b64_tr_b16 v[92:93], v25 offset:2048
    ds_read_b64_tr_b16 v[94:95], v25 offset:2304
    ds_read_b64_tr_b16 v[164:165], v26 offset:2048
    ds_read_b64_tr_b16 v[166:167], v26 offset:2304
    s_waitcnt lgkmcnt(0)
    s_add_u32 s21, s28, 3145984
    s_add_u32 m0, s31, 139264
    s_nop 0
    buffer_load_dwordx4 v6, s[12:15], s21 offen lds
    s_add_u32 m0, s31, 140288
    s_add_u32 s21, s21, 131072
    buffer_load_dwordx4 v6, s[12:15], s21 offen lds
    s_add_u32 m0, s31, 141312
    s_add_u32 s21, s21, 131072
    buffer_load_dwordx4 v6, s[12:15], s21 offen lds
    s_add_u32 m0, s31, 142336
    s_add_u32 s21, s21, 131072
    buffer_load_dwordx4 v6, s[12:15], s21 offen lds
    v_add_u32 v25, 40960, v24
    v_xor_b32 v26, 32, v25
    s_waitcnt vmcnt(24)
    ds_read_b64_tr_b16 a[24:25], v25 offset:0
    ds_read_b64_tr_b16 a[26:27], v25 offset:256
    ds_read_b64_tr_b16 a[96:97], v26 offset:0
    ds_read_b64_tr_b16 a[98:99], v26 offset:256
    ds_read_b64_tr_b16 a[28:29], v25 offset:2048
    ds_read_b64_tr_b16 a[30:31], v25 offset:2304
    ds_read_b64_tr_b16 a[100:101], v26 offset:2048
    ds_read_b64_tr_b16 a[102:103], v26 offset:2304
    s_waitcnt lgkmcnt(0)
    s_add_u32 s21, s28, 3670016
    s_add_u32 m0, s31, 40960
    s_nop 0
    buffer_load_dwordx4 v6, s[12:15], s21 offen lds
    s_add_u32 m0, s31, 41984
    s_add_u32 s21, s21, 131072
    buffer_load_dwordx4 v6, s[12:15], s21 offen lds
    s_add_u32 m0, s31, 43008
    s_add_u32 s21, s21, 131072
    buffer_load_dwordx4 v6, s[12:15], s21 offen lds
    s_add_u32 m0, s31, 44032
    s_add_u32 s21, s21, 131072
    buffer_load_dwordx4 v6, s[12:15], s21 offen lds
    v_add_u32 v25, 57344, v24
    v_xor_b32 v26, 32, v25
    s_waitcnt vmcnt(24)
    ds_read_b64_tr_b16 v[96:97], v25 offset:0
    ds_read_b64_tr_b16 v[98:99], v25 offset:256
    ds_read_b64_tr_b16 v[168:169], v26 offset:0
    ds_read_b64_tr_b16 v[170:171], v26 offset:256
    ds_read_b64_tr_b16 v[100:101], v25 offset:2048
    ds_read_b64_tr_b16 v[102:103], v25 offset:2304
    ds_read_b64_tr_b16 v[172:173], v26 offset:2048
    ds_read_b64_tr_b16 v[174:175], v26 offset:2304
    s_waitcnt lgkmcnt(0)
    s_add_u32 s21, s28, 3670272
    s_add_u32 m0, s31, 57344
    s_nop 0
    buffer_load_dwordx4 v6, s[12:15], s21 offen lds
    s_add_u32 m0, s31, 58368
    s_add_u32 s21, s21, 131072
    buffer_load_dwordx4 v6, s[12:15], s21 offen lds
    s_add_u32 m0, s31, 59392
    s_add_u32 s21, s21, 131072
    buffer_load_dwordx4 v6, s[12:15], s21 offen lds
    s_add_u32 m0, s31, 60416
    s_add_u32 s21, s21, 131072
    buffer_load_dwordx4 v6, s[12:15], s21 offen lds
    v_add_u32 v25, 73728, v24
    v_xor_b32 v26, 32, v25
    s_waitcnt vmcnt(24)
    ds_read_b64_tr_b16 a[32:33], v25 offset:0
    ds_read_b64_tr_b16 a[34:35], v25 offset:256
    ds_read_b64_tr_b16 a[104:105], v26 offset:0
    ds_read_b64_tr_b16 a[106:107], v26 offset:256
    ds_read_b64_tr_b16 a[36:37], v25 offset:2048
    ds_read_b64_tr_b16 a[38:39], v25 offset:2304
    ds_read_b64_tr_b16 a[108:109], v26 offset:2048
    ds_read_b64_tr_b16 a[110:111], v26 offset:2304
    s_waitcnt lgkmcnt(0)
    s_add_u32 s21, s28, 4194304
    s_add_u32 m0, s31, 73728
    s_nop 0
    buffer_load_dwordx4 v6, s[12:15], s21 offen lds
    s_add_u32 m0, s31, 74752
    s_add_u32 s21, s21, 131072
    buffer_load_dwordx4 v6, s[12:15], s21 offen lds
    s_add_u32 m0, s31, 75776
    s_add_u32 s21, s21, 131072
    buffer_load_dwordx4 v6, s[12:15], s21 offen lds
    s_add_u32 m0, s31, 76800
    s_add_u32 s21, s21, 131072
    buffer_load_dwordx4 v6, s[12:15], s21 offen lds
    v_add_u32 v25, 90112, v24
    v_xor_b32 v26, 32, v25
    s_waitcnt vmcnt(24)
    ds_read_b64_tr_b16 v[104:105], v25 offset:0
    ds_read_b64_tr_b16 v[106:107], v25 offset:256
    ds_read_b64_tr_b16 v[176:177], v26 offset:0
    ds_read_b64_tr_b16 v[178:179], v26 offset:256
    ds_read_b64_tr_b16 v[108:109], v25 offset:2048
    ds_read_b64_tr_b16 v[110:111], v25 offset:2304
    ds_read_b64_tr_b16 v[180:181], v26 offset:2048
    ds_read_b64_tr_b16 v[182:183], v26 offset:2304
    s_waitcnt lgkmcnt(0)
    s_add_u32 s21, s28, 4194560
    s_add_u32 m0, s31, 90112
    s_nop 0
    buffer_load_dwordx4 v6, s[12:15], s21 offen lds
    s_add_u32 m0, s31, 91136
    s_add_u32 s21, s21, 131072
    buffer_load_dwordx4 v6, s[12:15], s21 offen lds
    s_add_u32 m0, s31, 92160
    s_add_u32 s21, s21, 131072
    buffer_load_dwordx4 v6, s[12:15], s21 offen lds
    s_add_u32 m0, s31, 93184
    s_add_u32 s21, s21, 131072
    buffer_load_dwordx4 v6, s[12:15], s21 offen lds
    v_add_u32 v25, 106496, v24
    v_xor_b32 v26, 32, v25
    s_waitcnt vmcnt(24)
    ds_read_b64_tr_b16 a[40:41], v25 offset:0
    ds_read_b64_tr_b16 a[42:43], v25 offset:256
    ds_read_b64_tr_b16 a[112:113], v26 offset:0
    ds_read_b64_tr_b16 a[114:115], v26 offset:256
    ds_read_b64_tr_b16 a[44:45], v25 offset:2048
    ds_read_b64_tr_b16 a[46:47], v25 offset:2304
    ds_read_b64_tr_b16 a[116:117], v26 offset:2048
    ds_read_b64_tr_b16 a[118:119], v26 offset:2304
    s_waitcnt lgkmcnt(0)
    v_add_u32 v25, 122880, v24
    v_xor_b32 v26, 32, v25
    s_waitcnt vmcnt(20)
    ds_read_b64_tr_b16 v[112:113], v25 offset:0
    ds_read_b64_tr_b16 v[114:115], v25 offset:256
    ds_read_b64_tr_b16 v[184:185], v26 offset:0
    ds_read_b64_tr_b16 v[186:187], v26 offset:256
    ds_read_b64_tr_b16 v[116:117], v25 offset:2048
    ds_read_b64_tr_b16 v[118:119], v25 offset:2304
    ds_read_b64_tr_b16 v[188:189], v26 offset:2048
    ds_read_b64_tr_b16 v[190:191], v26 offset:2304
    s_waitcnt lgkmcnt(0)
    v_add_u32 v25, 139264, v24
    v_xor_b32 v26, 32, v25
    s_waitcnt vmcnt(16)
    ds_read_b64_tr_b16 a[48:49], v25 offset:0
    ds_read_b64_tr_b16 a[50:51], v25 offset:256
    ds_read_b64_tr_b16 a[120:121], v26 offset:0
    ds_read_b64_tr_b16 a[122:123], v26 offset:256
    ds_read_b64_tr_b16 a[52:53], v25 offset:2048
    ds_read_b64_tr_b16 a[54:55], v25 offset:2304
    ds_read_b64_tr_b16 a[124:125], v26 offset:2048
    ds_read_b64_tr_b16 a[126:127], v26 offset:2304
    s_waitcnt lgkmcnt(0)
    v_add_u32 v25, 40960, v24
    v_xor_b32 v26, 32, v25
    s_waitcnt vmcnt(12)
    ds_read_b64_tr_b16 v[120:121], v25 offset:0
    ds_read_b64_tr_b16 v[122:123], v25 offset:256
    ds_read_b64_tr_b16 v[192:193], v26 offset:0
    ds_read_b64_tr_b16 v[194:195], v26 offset:256
    ds_read_b64_tr_b16 v[124:125], v25 offset:2048
    ds_read_b64_tr_b16 v[126:127], v25 offset:2304
    ds_read_b64_tr_b16 v[196:197], v26 offset:2048
    ds_read_b64_tr_b16 v[198:199], v26 offset:2304
    s_waitcnt lgkmcnt(0)
    v_add_u32 v25, 57344, v24
    v_xor_b32 v26, 32, v25
    s_waitcnt vmcnt(8)
    ds_read_b64_tr_b16 a[56:57], v25 offset:0
    ds_read_b64_tr_b16 a[58:59], v25 offset:256
    ds_read_b64_tr_b16 a[128:129], v26 offset:0
    ds_read_b64_tr_b16 a[130:131], v26 offset:256
    ds_read_b64_tr_b16 a[60:61], v25 offset:2048
    ds_read_b64_tr_b16 a[62:63], v25 offset:2304
    ds_read_b64_tr_b16 a[132:133], v26 offset:2048
    ds_read_b64_tr_b16 a[134:135], v26 offset:2304
    s_waitcnt lgkmcnt(0)
    v_add_u32 v25, 73728, v24
    v_xor_b32 v26, 32, v25
    s_waitcnt vmcnt(4)
    ds_read_b64_tr_b16 v[128:129], v25 offset:0
    ds_read_b64_tr_b16 v[130:131], v25 offset:256
    ds_read_b64_tr_b16 v[200:201], v26 offset:0
    ds_read_b64_tr_b16 v[202:203], v26 offset:256
    ds_read_b64_tr_b16 v[132:133], v25 offset:2048
    ds_read_b64_tr_b16 v[134:135], v25 offset:2304
    ds_read_b64_tr_b16 v[204:205], v26 offset:2048
    ds_read_b64_tr_b16 v[206:207], v26 offset:2304
    s_waitcnt lgkmcnt(0)
    v_add_u32 v25, 90112, v24
    v_xor_b32 v26, 32, v25
    s_waitcnt vmcnt(0)
    ds_read_b64_tr_b16 a[64:65], v25 offset:0
    ds_read_b64_tr_b16 a[66:67], v25 offset:256
    ds_read_b64_tr_b16 a[136:137], v26 offset:0
    ds_read_b64_tr_b16 a[138:139], v26 offset:256
    ds_read_b64_tr_b16 a[68:69], v25 offset:2048
    ds_read_b64_tr_b16 a[70:71], v25 offset:2304
    ds_read_b64_tr_b16 a[140:141], v26 offset:2048
    ds_read_b64_tr_b16 a[142:143], v26 offset:2304
    s_waitcnt lgkmcnt(0)
    s_mov_b32 s88, 4194304
gn6:
    s_cmp_lg_u32 s95, 0
    s_cbranch_scc1 gn6x
    buffer_load_dword v25, off, s[96:99], 0 offset:144 sc1
    s_sub_u32 s88, s88, 1
    s_cbranch_scc1 gn6x
    s_waitcnt vmcnt(0)
    v_readfirstlane_b32 s95, v25
    s_nop 1
    s_branch gn6
gn6x:
    s_barrier
    s_mov_b32 s27, 36864
    s_add_u32 s23, s27, s25
    s_add_u32 m0, s23, 0
    s_nop 0
    buffer_load_dwordx4 v2, s[8:11], s24 offen offset:0 lds
    s_add_u32 m0, s23, 960
    s_nop 0
    buffer_load_dwordx4 v2, s[8:11], s24 offen offset:64 lds
    s_add_u32 m0, s23, 1920
    s_nop 0
    buffer_load_dwordx4 v2, s[8:11], s24 offen offset:128 lds
    s_add_u32 m0, s23, 2880
    s_nop 0
    buffer_load_dwordx4 v2, s[8:11], s24 offen offset:192 lds
    s_add_u32 m0, s23, 3840
    s_nop 0
    buffer_load_dwordx4 v2, s[8:11], s24 offen offset:256 lds
    s_add_u32 m0, s23, 4800
    s_nop 0
    buffer_load_dwordx4 v2, s[8:11], s24 offen offset:320 lds
    s_add_u32 m0, s23, 5760
    s_nop 0
    buffer_load_dwordx4 v2, s[8:11], s24 offen offset:384 lds
    s_add_u32 m0, s23, 6720
    s_nop 0
    buffer_load_dwordx4 v2, s[8:11], s24 offen offset:448 lds
    s_add_u32 m0, s23, 7680
    s_nop 0
    buffer_load_dwordx4 v2, s[8:11], s24 offen offset:512 lds
    s_add_u32 s24, s24, s42
    s_mov_b32 s27, 0
    s_mov_b32 s30, s95
    s_cmp_eq_u32 s18, 0
    s_cselect_b32 s34, 1, 0
    s_mov_b32 s35, 0
    s_cmp_eq_u32 s16, 2
    s_cbranch_scc1 qk_vloop
qk_loop:
    s_barrier
    v_add_u32 v3, s27, v1
    ds_read_b128 v[32:35], v3 offset:0
    ds_read_b128 v[36:39], v3 offset:18432
    ds_read_b128 v[40:43], v3 offset:1024
    ds_read_b128 v[44:47], v3 offset:19456
    ds_read_b128 v[48:51], v3 offset:2048
    ds_read_b128 v[52:55], v3 offset:20480
    s_sub_u32 s22, s30, 1
    v_mov_b32 v4, s22
    s_mov_b64 exec, s[34:35]
    buffer_store_dword v4, off, s[4:7], s29 sc1
    s_mov_b64 exec, -1
    s_add_u32 s22, s27, 73728
    s_sub_u32 s21, s22, 110592
    s_cselect_b32 s22, s22, s21
    ds_read_b128 v[56:59], v3 offset:3072
    ds_read_b128 v[60:63], v3 offset:21504
    s_add_u32 s23, s22, s25
    s_add_u32 m0, s23, 0
    s_nop 0
    buffer_load_dwordx4 v2, s[8:11], s24 offen offset:0 lds
    s_waitcnt lgkmcnt(6)
    v_mfma_f32_16x16x32_bf16 v[208:211], v[64:67], v[32:35], 0
    v_mfma_f32_16x16x32_bf16 v[212:215], v[136:139], v[32:35], 0
    v_mfma_f32_16x16x32_bf16 v[216:219], v[64:67], v[36:39], 0
    v_mfma_f32_16x16x32_bf16 v[220:223], v[136:139], v[36:39], 0
    v_mfma_f32_16x16x32_bf16 v[224:227], a[0:3], v[32:35], 0
    v_mfma_f32_16x16x32_bf16 v[228:231], a[72:75], v[32:35], 0
    v_mfma_f32_16x16x32_bf16 v[232:235], a[0:3], v[36:39], 0
    v_mfma_f32_16x16x32_bf16 v[236:239], a[72:75], v[36:39], 0
    ds_read_b128 v[32:35], v3 offset:4096
    ds_read_b128 v[36:39], v3 offset:22528
    s_add_u32 m0, s23, 960
    s_nop 0
    buffer_load_dwordx4 v2, s[8:11], s24 offen offset:64 lds
    s_waitcnt lgkmcnt(6)
    v_mfma_f32_16x16x32_bf16 v[208:211], v[68:71], v[40:43], v[208:211]
    v_mfma_f32_16x16x32_bf16 v[212:215], v[140:143], v[40:43], v[212:215]
    v_mfma_f32_16x16x32_bf16 v[216:219], v[68:71], v[44:47], v[216:219]
    v_mfma_f32_16x16x32_bf16 v[220:223], v[140:143], v[44:47], v[220:223]
    v_mfma_f32_16x16x32_bf16 v[224:227], a[4:7], v[40:43], v[224:227]
    v_mfma_f32_16x16x32_bf16 v[228:231], a[76:79], v[40:43], v[228:231]
    v_mfma_f32_16x16x32_bf16 v[232:235], a[4:7], v[44:47], v[232:235]
    v_mfma_f32_16x16x32_bf16 v[236:239], a[76:79], v[44:47], v[236:239]
    ds_read_b128 v[40:43], v3 offset:5120
    ds_read_b128 v[44:47], v3 offset:23552
    s_add_u32 m0, s23, 1920
    s_nop 0
    buffer_load_dwordx4 v2, s[8:11], s24 offen offset:128 lds
    s_waitcnt lgkmcnt(6)
    v_mfma_f32_16x16x32_bf16 v[208:211], v[72:75], v[48:51], v[208:211]
    v_mfma_f32_16x16x32_bf16 v[212:215], v[144:147], v[48:51], v[212:215]
    v_mfma_f32_16x16x32_bf16 v[216:219], v[72:75], v[52:55], v[216:219]
    v_mfma_f32_16x16x32_bf16 v[220:223], v[144:147], v[52:55], v[220:223]
    v_mfma_f32_16x16x32_bf16 v[224:227], a[8:11], v[48:51], v[224:227]
    v_mfma_f32_16x16x32_bf16 v[228:231], a[80:83], v[48:51], v[228:231]
    v_mfma_f32_16x16x32_bf16 v[232:235], a[8:11], v[52:55], v[232:235]
    v_mfma_f32_16x16x32_bf16 v[236:239], a[80:83], v[52:55], v[236:239]
    ds_read_b128 v[48:51], v3 offset:6144
    ds_read_b128 v[52:55], v3 offset:24576
    s_add_u32 m0, s23, 2880
    s_nop 0
    buffer_load_dwordx4 v2, s[8:11], s24 offen offset:192 lds
    s_waitcnt lgkmcnt(6)
    v_mfma_f32_16x16x32_bf16 v[208:211], v[76:79], v[56:59], v[208:211]
    v_mfma_f32_16x16x32_bf16 v[212:215], v[148:151], v[56:59], v[212:215]
    v_mfma_f32_16x16x32_bf16 v[216:219], v[76:79], v[60:63], v[216:219]
    v_mfma_f32_16x16x32_bf16 v[220:223], v[148:151], v[60:63], v[220:223]
    v_mfma_f32_16x16x32_bf16 v[224:227], a[12:15], v[56:59], v[224:227]
    v_mfma_f32_16x16x32_bf16 v[228:231], a[84:87], v[56:59], v[228:231]
    v_mfma_f32_16x16x32_bf16 v[232:235], a[12:15], v[60:63], v[232:235]
    v_mfma_f32_16x16x32_bf16 v[236:239], a[84:87], v[60:63], v[236:239]
    ds_read_b128 v[56:59], v3 offset:7168
    ds_read_b128 v[60:63], v3 offset:25600
    s_add_u32 m0, s23, 3840
    s_nop 0
    buffer_load_dwordx4 v2, s[8:11], s24 offen offset:256 lds
    s_waitcnt lgkmcnt(6)
    v_mfma_f32_16x16x32_bf16 v[208:211], v[80:83], v[32:35], v[208:211]
    v_mfma_f32_16x16x32_bf16 v[212:215], v[152:155], v[32:35], v[212:215]
    v_mfma_f32_16x16x32_bf16 v[216:219], v[80:83], v[36:39], v[216:219]
    v_mfma_f32_16x16x32_bf16 v[220:223], v[152:155], v[36:39], v[220:223]
    v_mfma_f32_16x16x32_bf16 v[224:227], a[16:19], v[32:35], v[224:227]
    v_mfma_f32_16x16x32_bf16 v[228:231], a[88:91], v[32:35], v[228:231]
    v_mfma_f32_16x16x32_bf16 v[232:235], a[16:19], v[36:39], v[232:235]
    v_mfma_f32_16x16x32_bf16 v[236:239], a[88:91], v[36:39], v[236:239]
    ds_read_b128 v[32:35], v3 offset:8192
    ds_read_b128 v[36:39], v3 offset:26624
    s_add_u32 m0, s23, 4800
    s_nop 0
    buffer_load_dwordx4 v2, s[8:11], s24 offen offset:320 lds
    s_waitcnt lgkmcnt(6)
    v_mfma_f32_16x16x32_bf16 v[208:211], v[84:87], v[40:43], v[208:211]
    v_mfma_f32_16x16x32_bf16 v[212:215], v[156:159], v[40:43], v[212:215]
    v_mfma_f32_16x16x32_bf16 v[216:219], v[84:87], v[44:47], v[216:219]
    v_mfma_f32_16x16x32_bf16 v[220:223], v[156:159], v[44:47], v[220:223]
    v_mfma_f32_16x16x32_bf16 v[224:227], a[20:23], v[40:43], v[224:227]
    v_mfma_f32_16x16x32_bf16 v[228:231], a[92:95], v[40:43], v[228:231]
    v_mfma_f32_16x16x32_bf16 v[232:235], a[20:23], v[44:47], v[232:235]
    v_mfma_f32_16x16x32_bf16 v[236:239], a[92:95], v[44:47], v[236:239]
    ds_read_b128 v[40:43], v3 offset:9216
    ds_read_b128 v[44:47], v3 offset:27648
    s_add_u32 m0, s23, 5760
    s_nop 0
    buffer_load_dwordx4 v2, s[8:11], s24 offen offset:384 lds
    s_waitcnt lgkmcnt(6)
    v_mfma_f32_16x16x32_bf16 v[208:211], v[88:91], v[48:51], v[208:211]
    v_mfma_f32_16x16x32_bf16 v[212:215], v[160:163], v[48:51], v[212:215]
    v_mfma_f32_16x16x32_bf16 v[216:219], v[88:91], v[52:55], v[216:219]
    v_mfma_f32_16x16x32_bf16 v[220:223], v[160:163], v[52:55], v[220:223]
    v_mfma_f32_16x16x32_bf16 v[224:227], a[24:27], v[48:51], v[224:227]
    v_mfma_f32_16x16x32_bf16 v[228:231], a[96:99], v[48:51], v[228:231]
    v_mfma_f32_16x16x32_bf16 v[232:235], a[24:27], v[52:55], v[232:235]
    v_mfma_f32_16x16x32_bf16 v[236:239], a[96:99], v[52:55], v[236:239]
    ds_read_b128 v[48:51], v3 offset:10240
    ds_read_b128 v[52:55], v3 offset:28672
    s_add_u32 m0, s23, 6720
    s_nop 0
    buffer_load_dwordx4 v2, s[8:11], s24 offen offset:448 lds
    s_waitcnt lgkmcnt(6)
    v_mfma_f32_16x16x32_bf16 v[208:211], v[92:95], v[56:59], v[208:211]
    v_mfma_f32_16x16x32_bf16 v[212:215], v[164:167], v[56:59], v[212:215]
    v_mfma_f32_16x16x32_bf16 v[216:219], v[92:95], v[60:63], v[216:219]
    v_mfma_f32_16x16x32_bf16 v[220:223], v[164:167], v[60:63], v[220:223]
    v_mfma_f32_16x16x32_bf16 v[224:227], a[28:31], v[56:59], v[224:227]
    v_mfma_f32_16x16x32_bf16 v[228:231], a[100:103], v[56:59], v[228:231]
    v_mfma_f32_16x16x32_bf16 v[232:235], a[28:31], v[60:63], v[232:235]
    v_mfma_f32_16x16x32_bf16 v[236:239], a[100:103], v[60:63], v[236:239]
    ds_read_b128 v[56:59], v3 offset:11264
    ds_read_b128 v[60:63], v3 offset:29696
    s_add_u32 m0, s23, 7680
    s_nop 0
    buffer_load_dwordx4 v2, s[8:11], s24 offen offset:512 lds
    s_add_u32 s24, s24, s42
    s_waitcnt lgkmcnt(6)
    v_mfma_f32_16x16x32_bf16 v[208:211], v[96:99], v[32:35], v[208:211]
    v_mfma_f32_16x16x32_bf16 v[212:215], v[168:171], v[32:35], v[212:215]
    v_mfma_f32_16x16x32_bf16 v[216:219], v[96:99], v[36:39], v[216:219]
    v_mfma_f32_16x16x32_bf16 v[220:223], v[168:171], v[36:39], v[220:223]
    v_mfma_f32_16x16x32_bf16 v[224:227], a[32:35], v[32:35], v[224:227]
    v_mfma_f32_16x16x32_bf16 v[228:231], a[104:107], v[32:35], v[228:231]
    v_mfma_f32_16x16x32_bf16 v[232:235], a[32:35], v[36:39], v[232:235]
    v_mfma_f32_16x16x32_bf16 v[236:239], a[104:107], v[36:39], v[236:239]
    ds_read_b128 v[32:35], v3 offset:12288
    ds_read_b128 v[36:39], v3 offset:30720
    s_waitcnt lgkmcnt(6)
    v_mfma_f32_16x16x32_bf16 v[208:211], v[100:103], v[40:43], v[208:211]
    v_mfma_f32_16x16x32_bf16 v[212:215], v[172:175], v[40:43], v[212:215]
    v_mfma_f32_16x16x32_bf16 v[216:219], v[100:103], v[44:47], v[216:219]
    v_mfma_f32_16x16x32_bf16 v[220:223], v[172:175], v[44:47], v[220:223]
    v_mfma_f32_16x16x32_bf16 v[224:227], a[36:39], v[40:43], v[224:227]
    v_mfma_f32_16x16x32_bf16 v[228:231], a[108:111], v[40:43], v[228:231]
    v_mfma_f32_16x16x32_bf16 v[232:235], a[36:39], v[44:47], v[232:235]
    v_mfma_f32_16x16x32_bf16 v[236:239], a[108:111], v[44:47], v[236:239]
    ds_read_b128 v[40:43], v3 offset:13312
    ds_read_b128 v[44:47], v3 offset:31744
    s_waitcnt lgkmcnt(6)
    v_mfma_f32_16x16x32_bf16 v[208:211], v[104:107], v[48:51], v[208:211]
    v_mfma_f32_16x16x32_bf16 v[212:215], v[176:179], v[48:51], v[212:215]
    v_mfma_f32_16x16x32_bf16 v[216:219], v[104:107], v[52:55], v[216:219]
    v_mfma_f32_16x16x32_bf16 v[220:223], v[176:179], v[52:55], v[220:223]
    v_mfma_f32_16x16x32_bf16 v[224:227], a[40:43], v[48:51], v[224:227]
    v_mfma_f32_16x16x32_bf16 v[228:231], a[112:115], v[48:51], v[228:231]
    v_mfma_f32_16x16x32_bf16 v[232:235], a[40:43], v[52:55], v[232:235]
    v_mfma_f32_16x16x32_bf16 v[236:239], a[112:115], v[52:55], v[236:239]
    ds_read_b128 v[48:51], v3 offset:14336
    ds_read_b128 v[52:55], v3 offset:32768
    s_waitcnt lgkmcnt(6)
    v_mfma_f32_16x16x32_bf16 v[208:211], v[108:111], v[56:59], v[208:211]
    v_mfma_f32_16x16x32_bf16 v[212:215], v[180:183], v[56:59], v[212:215]
    v_mfma_f32_16x16x32_bf16 v[216:219], v[108:111], v[60:63], v[216:219]
    v_mfma_f32_16x16x32_bf16 v[220:223], v[180:183], v[60:63], v[220:223]
    v_mfma_f32_16x16x32_bf16 v[224:227], a[44:47], v[56:59], v[224:227]
    v_mfma_f32_16x16x32_bf16 v[228:231], a[116:119], v[56:59], v[228:231]
    v_mfma_f32_16x16x32_bf16 v[232:235], a[44:47], v[60:63], v[232:235]
    v_mfma_f32_16x16x32_bf16 v[236:239], a[116:119], v[60:63], v[236:239]
    ds_read_b128 v[56:59], v3 offset:15360
    ds_read_b128 v[60:63], v3 offset:33792
    s_waitcnt lgkmcnt(6)
    v_mfma_f32_16x16x32_bf16 v[208:211], v[112:115], v[32:35], v[208:211]
    v_mfma_f32_16x16x32_bf16 v[212:215], v[184:187], v[32:35], v[212:215]
    v_mfma_f32_16x16x32_bf16 v[216:219], v[112:115], v[36:39], v[216:219]
    v_mfma_f32_16x16x32_bf16 v[220:223], v[184:187], v[36:39], v[220:223]
    v_mfma_f32_16x16x32_bf16 v[224:227], a[48:51], v[32:35], v[224:227]
    v_mfma_f32_16x16x32_bf16 v[228:231], a[120:123], v[32:35], v[228:231]
    v_mfma_f32_16x16x32_bf16 v[232:235], a[48:51], v[36:39], v[232:235]
    v_mfma_f32_16x16x32_bf16 v[236:239], a[120:123], v[36:39], v[236:239]
    ds_read_b128 v[32:35], v3 offset:16384
    ds_read_b128 v[36:39], v3 offset:34816
    s_waitcnt lgkmcnt(6)
    v_mfma_f32_16x16x32_bf16 v[208:211], v[116:119], v[40:43], v[208:211]
    v_mfma_f32_16x16x32_bf16 v[212:215], v[188:191], v[40:43], v[212:215]
    v_mfma_f32_16x16x32_bf16 v[216:219], v[116:119], v[44:47], v[216:219]
    v_mfma_f32_16x16x32_bf16 v[220:223], v[188:191], v[44:47], v[220:223]
    v_mfma_f32_16x16x32_bf16 v[224:227], a[52:55], v[40:43], v[224:227]
    v_mfma_f32_16x16x32_bf16 v[228:231], a[124:127], v[40:43], v[228:231]
    v_mfma_f32_16x16x32_bf16 v[232:235], a[52:55], v[44:47], v[232:235]
    v_mfma_f32_16x16x32_bf16 v[236:239], a[124:127], v[44:47], v[236:239]
    ds_read_b128 v[40:43], v3 offset:17408
    ds_read_b128 v[44:47], v3 offset:35840
    s_waitcnt lgkmcnt(6)
    v_mfma_f32_16x16x32_bf16 v[208:211], v[120:123], v[48:51], v[208:211]
    v_mfma_f32_16x16x32_bf16 v[212:215], v[192:195], v[48:51], v[212:215]
    v_mfma_f32_16x16x32_bf16 v[216:219], v[120:123], v[52:55], v[216:219]
    v_mfma_f32_16x16x32_bf16 v[220:223], v[192:195], v[52:55], v[220:223]
    v_mfma_f32_16x16x32_bf16 v[224:227], a[56:59], v[48:51], v[224:227]
    v_mfma_f32_16x16x32_bf16 v[228:231], a[128:131], v[48:51], v[228:231]
    v_mfma_f32_16x16x32_bf16 v[232:235], a[56:59], v[52:55], v[232:235]
    v_mfma_f32_16x16x32_bf16 v[236:239], a[128:131], v[52:55], v[236:239]
    s_waitcnt lgkmcnt(4)
    v_mfma_f32_16x16x32_bf16 v[208:211], v[124:127], v[56:59], v[208:211]
    v_mfma_f32_16x16x32_bf16 v[212:215], v[196:199], v[56:59], v[212:215]
    v_mfma_f32_16x16x32_bf16 v[216:219], v[124:127], v[60:63], v[216:219]
    v_mfma_f32_16x16x32_bf16 v[220:223], v[196:199], v[60:63], v[220:223]
    v_mfma_f32_16x16x32_bf16 v[224:227], a[60:63], v[56:59], v[224:227]
    v_mfma_f32_16x16x32_bf16 v[228:231], a[132:135], v[56:59], v[228:231]
    v_mfma_f32_16x16x32_bf16 v[232:235], a[60:63], v[60:63], v[232:235]
    v_mfma_f32_16x16x32_bf16 v[236:239], a[132:135], v[60:63], v[236:239]
    s_waitcnt lgkmcnt(2)
    v_mfma_f32_16x16x32_bf16 v[208:211], v[128:131], v[32:35], v[208:211]
    v_mfma_f32_16x16x32_bf16 v[212:215], v[200:203], v[32:35], v[212:215]
    v_mfma_f32_16x16x32_bf16 v[216:219], v[128:131], v[36:39], v[216:219]
    v_mfma_f32_16x16x32_bf16 v[220:223], v[200:203], v[36:39], v[220:223]
    v_mfma_f32_16x16x32_bf16 v[224:227], a[64:67], v[32:35], v[224:227]
    v_mfma_f32_16x16x32_bf16 v[228:231], a[136:139], v[32:35], v[228:231]
    v_mfma_f32_16x16x32_bf16 v[232:235], a[64:67], v[36:39], v[232:235]
    v_mfma_f32_16x16x32_bf16 v[236:239], a[136:139], v[36:39], v[236:239]
    s_waitcnt lgkmcnt(0)
    v_mfma_f32_16x16x32_bf16 v[208:211], v[132:135], v[40:43], v[208:211]
    v_mfma_f32_16x16x32_bf16 v[212:215], v[204:207], v[40:43], v[212:215]
    v_mfma_f32_16x16x32_bf16 v[216:219], v[132:135], v[44:47], v[216:219]
    v_mfma_f32_16x16x32_bf16 v[220:223], v[204:207], v[44:47], v[220:223]
    v_mfma_f32_16x16x32_bf16 v[224:227], a[68:71], v[40:43], v[224:227]
    v_mfma_f32_16x16x32_bf16 v[228:231], a[140:143], v[40:43], v[228:231]
    v_mfma_f32_16x16x32_bf16 v[232:235], a[68:71], v[44:47], v[232:235]
    v_mfma_f32_16x16x32_bf16 v[236:239], a[140:143], v[44:47], v[236:239]
    s_waitcnt vmcnt(0)
    v_cvt_pk_bf16_f32 v8, v208, v209
    v_cvt_pk_bf16_f32 v9, v210, v211
    v_cvt_pk_bf16_f32 v10, v212, v213
    v_cvt_pk_bf16_f32 v11, v214, v215
    s_mov_b32 s28, s26
    buffer_store_dwordx4 v[8:11], v7, s[4:7], s28 offen sc1
    v_cvt_pk_bf16_f32 v12, v216, v217
    v_cvt_pk_bf16_f32 v13, v218, v219
    v_cvt_pk_bf16_f32 v14, v220, v221
    v_cvt_pk_bf16_f32 v15, v222, v223
    s_add_u32 s28, s28, s40
    buffer_store_dwordx4 v[12:15], v7, s[4:7], s28 offen sc1
    v_cvt_pk_bf16_f32 v16, v224, v225
    v_cvt_pk_bf16_f32 v17, v226, v227
    v_cvt_pk_bf16_f32 v18, v228, v229
    v_cvt_pk_bf16_f32 v19, v230, v231
    s_add_u32 s28, s26, s43
    buffer_store_dwordx4 v[16:19], v7, s[4:7], s28 offen sc1
    v_cvt_pk_bf16_f32 v20, v232, v233
    v_cvt_pk_bf16_f32 v21, v234, v235
    v_cvt_pk_bf16_f32 v22, v236, v237
    v_cvt_pk_bf16_f32 v23, v238, v239
    s_add_u32 s28, s28, s40
    buffer_store_dwordx4 v[20:23], v7, s[4:7], s28 offen sc1
    s_add_u32 s26, s26, s41
    s_add_u32 s27, s27, 36864
    s_cmp_eq_u32 s27, 110592
    s_cselect_b32 s27, 0, s27
    s_add_u32 s30, s30, 1
    s_add_u32 s19, s19, s20
    s_cmp_lt_u32 s19, 64
    s_cbranch_scc1 qk_loop
    s_branch qk_done
qk_vloop:
    s_barrier
    v_add_u32 v3, s27, v1
    ds_read_b128 v[32:35], v3 offset:0
    ds_read_b128 v[36:39], v3 offset:18432
    ds_read_b128 v[40:43], v3 offset:1024
    ds_read_b128 v[44:47], v3 offset:19456
    ds_read_b128 v[48:51], v3 offset:2048
    ds_read_b128 v[52:55], v3 offset:20480
    s_sub_u32 s22, s30, 1
    v_mov_b32 v4, s22
    s_mov_b64 exec, s[34:35]
    buffer_store_dword v4, off, s[4:7], s29 sc1
    s_mov_b64 exec, -1
    s_add_u32 s22, s27, 73728
    s_sub_u32 s21, s22, 110592
    s_cselect_b32 s22, s22, s21
    ds_read_b128 v[56:59], v3 offset:3072
    ds_read_b128 v[60:63], v3 offset:21504
    s_add_u32 s23, s22, s25
    s_add_u32 m0, s23, 0
    s_nop 0
    buffer_load_dwordx4 v2, s[8:11], s24 offen offset:0 lds
    s_waitcnt lgkmcnt(6)
    v_mfma_f32_16x16x32_bf16 v[208:211], v[32:35], v[64:67], 0
    v_mfma_f32_16x16x32_bf16 v[212:215], v[32:35], v[136:139], 0
    v_mfma_f32_16x16x32_bf16 v[216:219], v[36:39], v[64:67], 0
    v_mfma_f32_16x16x32_bf16 v[220:223], v[36:39], v[136:139], 0
    v_mfma_f32_16x16x32_bf16 v[224:227], v[32:35], a[0:3], 0
    v_mfma_f32_16x16x32_bf16 v[228:231], v[32:35], a[72:75], 0
    v_mfma_f32_16x16x32_bf16 v[232:235], v[36:39], a[0:3], 0
    v_mfma_f32_16x16x32_bf16 v[236:239], v[36:39], a[72:75], 0
    ds_read_b128 v[32:35], v3 offset:4096
    ds_read_b128 v[36:39], v3 offset:22528
    s_add_u32 m0, s23, 960
    s_nop 0
    buffer_load_dwordx4 v2, s[8:11], s24 offen offset:64 lds
    s_waitcnt lgkmcnt(6)
    v_mfma_f32_16x16x32_bf16 v[208:211], v[40:43], v[68:71], v[208:211]
    v_mfma_f32_16x16x32_bf16 v[212:215], v[40:43], v[140:143], v[212:215]
    v_mfma_f32_16x16x32_bf16 v[216:219], v[44:47], v[68:71], v[216:219]
    v_mfma_f32_16x16x32_bf16 v[220:223], v[44:47], v[140:143], v[220:223]
    v_mfma_f32_16x16x32_bf16 v[224:227], v[40:43], a[4:7], v[224:227]
    v_mfma_f32_16x16x32_bf16 v[228:231], v[40:43], a[76:79], v[228:231]
    v_mfma_f32_16x16x32_bf16 v[232:235], v[44:47], a[4:7], v[232:235]
    v_mfma_f32_16x16x32_bf16 v[236:239], v[44:47], a[76:79], v[236:239]
    ds_read_b128 v[40:43], v3 offset:5120
    ds_read_b128 v[44:47], v3 offset:23552
    s_add_u32 m0, s23, 1920
    s_nop 0
    buffer_load_dwordx4 v2, s[8:11], s24 offen offset:128 lds
    s_waitcnt lgkmcnt(6)
    v_mfma_f32_16x16x32_bf16 v[208:211], v[48:51], v[72:75], v[208:211]
    v_mfma_f32_16x16x32_bf16 v[212:215], v[48:51], v[144:147], v[212:215]
    v_mfma_f32_16x16x32_bf16 v[216:219], v[52:55], v[72:75], v[216:219]
    v_mfma_f32_16x16x32_bf16 v[220:223], v[52:55], v[144:147], v[220:223]
    v_mfma_f32_16x16x32_bf16 v[224:227], v[48:51], a[8:11], v[224:227]
    v_mfma_f32_16x16x32_bf16 v[228:231], v[48:51], a[80:83], v[228:231]
    v_mfma_f32_16x16x32_bf16 v[232:235], v[52:55], a[8:11], v[232:235]
    v_mfma_f32_16x16x32_bf16 v[236:239], v[52:55], a[80:83], v[236:239]
    ds_read_b128 v[48:51], v3 offset:6144
    ds_read_b128 v[52:55], v3 offset:24576
    s_add_u32 m0, s23, 2880
    s_nop 0
    buffer_load_dwordx4 v2, s[8:11], s24 offen offset:192 lds
    s_waitcnt lgkmcnt(6)
    v_mfma_f32_16x16x32_bf16 v[208:211], v[56:59], v[76:79], v[208:211]
    v_mfma_f32_16x16x32_bf16 v[212:215], v[56:59], v[148:151], v[212:215]
    v_mfma_f32_16x16x32_bf16 v[216:219], v[60:63], v[76:79], v[216:219]
    v_mfma_f32_16x16x32_bf16 v[220:223], v[60:63], v[148:151], v[220:223]
    v_mfma_f32_16x16x32_bf16 v[224:227], v[56:59], a[12:15], v[224:227]
    v_mfma_f32_16x16x32_bf16 v[228:231], v[56:59], a[84:87], v[228:231]
    v_mfma_f32_16x16x32_bf16 v[232:235], v[60:63], a[12:15], v[232:235]
    v_mfma_f32_16x16x32_bf16 v[236:239], v[60:63], a[84:87], v[236:239]
    ds_read_b128 v[56:59], v3 offset:7168
    ds_read_b128 v[60:63], v3 offset:25600
    s_add_u32 m0, s23, 3840
    s_nop 0
    buffer_load_dwordx4 v2, s[8:11], s24 offen offset:256 lds
    s_waitcnt lgkmcnt(6)
    v_mfma_f32_16x16x32_bf16 v[208:211], v[32:35], v[80:83], v[208:211]
    v_mfma_f32_16x16x32_bf16 v[212:215], v[32:35], v[152:155], v[212:215]
    v_mfma_f32_16x16x32_bf16 v[216:219], v[36:39], v[80:83], v[216:219]
    v_mfma_f32_16x16x32_bf16 v[220:223], v[36:39], v[152:155], v[220:223]
    v_mfma_f32_16x16x32_bf16 v[224:227], v[32:35], a[16:19], v[224:227]
    v_mfma_f32_16x16x32_bf16 v[228:231], v[32:35], a[88:91], v[228:231]
    v_mfma_f32_16x16x32_bf16 v[232:235], v[36:39], a[16:19], v[232:235]
    v_mfma_f32_16x16x32_bf16 v[236:239], v[36:39], a[88:91], v[236:239]
    ds_read_b128 v[32:35], v3 offset:8192
    ds_read_b128 v[36:39], v3 offset:26624
    s_add_u32 m0, s23, 4800
    s_nop 0
    buffer_load_dwordx4 v2, s[8:11], s24 offen offset:320 lds
    s_waitcnt lgkmcnt(6)
    v_mfma_f32_16x16x32_bf16 v[208:211], v[40:43], v[84:87], v[208:211]
    v_mfma_f32_16x16x32_bf16 v[212:215], v[40:43], v[156:159], v[212:215]
    v_mfma_f32_16x16x32_bf16 v[216:219], v[44:47], v[84:87], v[216:219]
    v_mfma_f32_16x16x32_bf16 v[220:223], v[44:47], v[156:159], v[220:223]
    v_mfma_f32_16x16x32_bf16 v[224:227], v[40:43], a[20:23], v[224:227]
    v_mfma_f32_16x16x32_bf16 v[228:231], v[40:43], a[92:95], v[228:231]
    v_mfma_f32_16x16x32_bf16 v[232:235], v[44:47], a[20:23], v[232:235]
    v_mfma_f32_16x16x32_bf16 v[236:239], v[44:47], a[92:95], v[236:239]
    ds_read_b128 v[40:43], v3 offset:9216
    ds_read_b128 v[44:47], v3 offset:27648
    s_add_u32 m0, s23, 5760
    s_nop 0
    buffer_load_dwordx4 v2, s[8:11], s24 offen offset:384 lds
    s_waitcnt lgkmcnt(6)
    v_mfma_f32_16x16x32_bf16 v[208:211], v[48:51], v[88:91], v[208:211]
    v_mfma_f32_16x16x32_bf16 v[212:215], v[48:51], v[160:163], v[212:215]
    v_mfma_f32_16x16x32_bf16 v[216:219], v[52:55], v[88:91], v[216:219]
    v_mfma_f32_16x16x32_bf16 v[220:223], v[52:55], v[160:163], v[220:223]
    v_mfma_f32_16x16x32_bf16 v[224:227], v[48:51], a[24:27], v[224:227]
    v_mfma_f32_16x16x32_bf16 v[228:231], v[48:51], a[96:99], v[228:231]
    v_mfma_f32_16x16x32_bf16 v[232:235], v[52:55], a[24:27], v[232:235]
    v_mfma_f32_16x16x32_bf16 v[236:239], v[52:55], a[96:99], v[236:239]
    ds_read_b128 v[48:51], v3 offset:10240
    ds_read_b128 v[52:55], v3 offset:28672
    s_add_u32 m0, s23, 6720
    s_nop 0
    buffer_load_dwordx4 v2, s[8:11], s24 offen offset:448 lds
    s_waitcnt lgkmcnt(6)
    v_mfma_f32_16x16x32_bf16 v[208:211], v[56:59], v[92:95], v[208:211]
    v_mfma_f32_16x16x32_bf16 v[212:215], v[56:59], v[164:167], v[212:215]
    v_mfma_f32_16x16x32_bf16 v[216:219], v[60:63], v[92:95], v[216:219]
    v_mfma_f32_16x16x32_bf16 v[220:223], v[60:63], v[164:167], v[220:223]
    v_mfma_f32_16x16x32_bf16 v[224:227], v[56:59], a[28:31], v[224:227]
    v_mfma_f32_16x16x32_bf16 v[228:231], v[56:59], a[100:103], v[228:231]
    v_mfma_f32_16x16x32_bf16 v[232:235], v[60:63], a[28:31], v[232:235]
    v_mfma_f32_16x16x32_bf16 v[236:239], v[60:63], a[100:103], v[236:239]
    ds_read_b128 v[56:59], v3 offset:11264
    ds_read_b128 v[60:63], v3 offset:29696
    s_add_u32 m0, s23, 7680
    s_nop 0
    buffer_load_dwordx4 v2, s[8:11], s24 offen offset:512 lds
    s_add_u32 s24, s24, s42
    s_waitcnt lgkmcnt(6)
    v_mfma_f32_16x16x32_bf16 v[208:211], v[32:35], v[96:99], v[208:211]
    v_mfma_f32_16x16x32_bf16 v[212:215], v[32:35], v[168:171], v[212:215]
    v_mfma_f32_16x16x32_bf16 v[216:219], v[36:39], v[96:99], v[216:219]
    v_mfma_f32_16x16x32_bf16 v[220:223], v[36:39], v[168:171], v[220:223]
    v_mfma_f32_16x16x32_bf16 v[224:227], v[32:35], a[32:35], v[224:227]
    v_mfma_f32_16x16x32_bf16 v[228:231], v[32:35], a[104:107], v[228:231]
    v_mfma_f32_16x16x32_bf16 v[232:235], v[36:39], a[32:35], v[232:235]
    v_mfma_f32_16x16x32_bf16 v[236:239], v[36:39], a[104:107], v[236:239]
    ds_read_b128 v[32:35], v3 offset:12288
    ds_read_b128 v[36:39], v3 offset:30720
    s_waitcnt lgkmcnt(6)
    v_mfma_f32_16x16x32_bf16 v[208:211], v[40:43], v[100:103], v[208:211]
    v_mfma_f32_16x16x32_bf16 v[212:215], v[40:43], v[172:175], v[212:215]
    v_mfma_f32_16x16x32_bf16 v[216:219], v[44:47], v[100:103], v[216:219]
    v_mfma_f32_16x16x32_bf16 v[220:223], v[44:47], v[172:175], v[220:223]
    v_mfma_f32_16x16x32_bf16 v[224:227], v[40:43], a[36:39], v[224:227]
    v_mfma_f32_16x16x32_bf16 v[228:231], v[40:43], a[108:111], v[228:231]
    v_mfma_f32_16x16x32_bf16 v[232:235], v[44:47], a[36:39], v[232:235]
    v_mfma_f32_16x16x32_bf16 v[236:239], v[44:47], a[108:111], v[236:239]
    ds_read_b128 v[40:43], v3 offset:13312
    ds_read_b128 v[44:47], v3 offset:31744
    s_waitcnt lgkmcnt(6)
    v_mfma_f32_16x16x32_bf16 v[208:211], v[48:51], v[104:107], v[208:211]
    v_mfma_f32_16x16x32_bf16 v[212:215], v[48:51], v[176:179], v[212:215]
    v_mfma_f32_16x16x32_bf16 v[216:219], v[52:55], v[104:107], v[216:219]
    v_mfma_f32_16x16x32_bf16 v[220:223], v[52:55], v[176:179], v[220:223]
    v_mfma_f32_16x16x32_bf16 v[224:227], v[48:51], a[40:43], v[224:227]
    v_mfma_f32_16x16x32_bf16 v[228:231], v[48:51], a[112:115], v[228:231]
    v_mfma_f32_16x16x32_bf16 v[232:235], v[52:55], a[40:43], v[232:235]
    v_mfma_f32_16x16x32_bf16 v[236:239], v[52:55], a[112:115], v[236:239]
    ds_read_b128 v[48:51], v3 offset:14336
    ds_read_b128 v[52:55], v3 offset:32768
    s_waitcnt lgkmcnt(6)
    v_mfma_f32_16x16x32_bf16 v[208:211], v[56:59], v[108:111], v[208:211]
    v_mfma_f32_16x16x32_bf16 v[212:215], v[56:59], v[180:183], v[212:215]
    v_mfma_f32_16x16x32_bf16 v[216:219], v[60:63], v[108:111], v[216:219]
    v_mfma_f32_16x16x32_bf16 v[220:223], v[60:63], v[180:183], v[220:223]
    v_mfma_f32_16x16x32_bf16 v[224:227], v[56:59], a[44:47], v[224:227]
    v_mfma_f32_16x16x32_bf16 v[228:231], v[56:59], a[116:119], v[228:231]
    v_mfma_f32_16x16x32_bf16 v[232:235], v[60:63], a[44:47], v[232:235]
    v_mfma_f32_16x16x32_bf16 v[236:239], v[60:63], a[116:119], v[236:239]
    ds_read_b128 v[56:59], v3 offset:15360
    ds_read_b128 v[60:63], v3 offset:33792
    s_waitcnt lgkmcnt(6)
    v_mfma_f32_16x16x32_bf16 v[208:211], v[32:35], v[112:115], v[208:211]
    v_mfma_f32_16x16x32_bf16 v[212:215], v[32:35], v[184:187], v[212:215]
    v_mfma_f32_16x16x32_bf16 v[216:219], v[36:39], v[112:115], v[216:219]
    v_mfma_f32_16x16x32_bf16 v[220:223], v[36:39], v[184:187], v[220:223]
    v_mfma_f32_16x16x32_bf16 v[224:227], v[32:35], a[48:51], v[224:227]
    v_mfma_f32_16x16x32_bf16 v[228:231], v[32:35], a[120:123], v[228:231]
    v_mfma_f32_16x16x32_bf16 v[232:235], v[36:39], a[48:51], v[232:235]
    v_mfma_f32_16x16x32_bf16 v[236:239], v[36:39], a[120:123], v[236:239]
    ds_read_b128 v[32:35], v3 offset:16384
    ds_read_b128 v[36:39], v3 offset:34816
    s_waitcnt lgkmcnt(6)
    v_mfma_f32_16x16x32_bf16 v[208:211], v[40:43], v[116:119], v[208:211]
    v_mfma_f32_16x16x32_bf16 v[212:215], v[40:43], v[188:191], v[212:215]
    v_mfma_f32_16x16x32_bf16 v[216:219], v[44:47], v[116:119], v[216:219]
    v_mfma_f32_16x16x32_bf16 v[220:223], v[44:47], v[188:191], v[220:223]
    v_mfma_f32_16x16x32_bf16 v[224:227], v[40:43], a[52:55], v[224:227]
    v_mfma_f32_16x16x32_bf16 v[228:231], v[40:43], a[124:127], v[228:231]
    v_mfma_f32_16x16x32_bf16 v[232:235], v[44:47], a[52:55], v[232:235]
    v_mfma_f32_16x16x32_bf16 v[236:239], v[44:47], a[124:127], v[236:239]
    ds_read_b128 v[40:43], v3 offset:17408
    ds_read_b128 v[44:47], v3 offset:35840
    s_waitcnt lgkmcnt(6)
    v_mfma_f32_16x16x32_bf16 v[208:211], v[48:51], v[120:123], v[208:211]
    v_mfma_f32_16x16x32_bf16 v[212:215], v[48:51], v[192:195], v[212:215]
    v_mfma_f32_16x16x32_bf16 v[216:219], v[52:55], v[120:123], v[216:219]
    v_mfma_f32_16x16x32_bf16 v[220:223], v[52:55], v[192:195], v[220:223]
    v_mfma_f32_16x16x32_bf16 v[224:227], v[48:51], a[56:59], v[224:227]
    v_mfma_f32_16x16x32_bf16 v[228:231], v[48:51], a[128:131], v[228:231]
    v_mfma_f32_16x16x32_bf16 v[232:235], v[52:55], a[56:59], v[232:235]
    v_mfma_f32_16x16x32_bf16 v[236:239], v[52:55], a[128:131], v[236:239]
    s_waitcnt lgkmcnt(4)
    v_mfma_f32_16x16x32_bf16 v[208:211], v[56:59], v[124:127], v[208:211]
    v_mfma_f32_16x16x32_bf16 v[212:215], v[56:59], v[196:199], v[212:215]
    v_mfma_f32_16x16x32_bf16 v[216:219], v[60:63], v[124:127], v[216:219]
    v_mfma_f32_16x16x32_bf16 v[220:223], v[60:63], v[196:199], v[220:223]
    v_mfma_f32_16x16x32_bf16 v[224:227], v[56:59], a[60:63], v[224:227]
    v_mfma_f32_16x16x32_bf16 v[228:231], v[56:59], a[132:135], v[228:231]
    v_mfma_f32_16x16x32_bf16 v[232:235], v[60:63], a[60:63], v[232:235]
    v_mfma_f32_16x16x32_bf16 v[236:239], v[60:63], a[132:135], v[236:239]
    s_waitcnt lgkmcnt(2)
    v_mfma_f32_16x16x32_bf16 v[208:211], v[32:35], v[128:131], v[208:211]
    v_mfma_f32_16x16x32_bf16 v[212:215], v[32:35], v[200:203], v[212:215]
    v_mfma_f32_16x16x32_bf16 v[216:219], v[36:39], v[128:131], v[216:219]
    v_mfma_f32_16x16x32_bf16 v[220:223], v[36:39], v[200:203], v[220:223]
    v_mfma_f32_16x16x32_bf16 v[224:227], v[32:35], a[64:67], v[224:227]
    v_mfma_f32_16x16x32_bf16 v[228:231], v[32:35], a[136:139], v[228:231]
    v_mfma_f32_16x16x32_bf16 v[232:235], v[36:39], a[64:67], v[232:235]
    v_mfma_f32_16x16x32_bf16 v[236:239], v[36:39], a[136:139], v[236:239]
    s_waitcnt lgkmcnt(0)
    v_mfma_f32_16x16x32_bf16 v[208:211], v[40:43], v[132:135], v[208:211]
    v_mfma_f32_16x16x32_bf16 v[212:215], v[40:43], v[204:207], v[212:215]
    v_mfma_f32_16x16x32_bf16 v[216:219], v[44:47], v[132:135], v[216:219]
    v_mfma_f32_16x16x32_bf16 v[220:223], v[44:47], v[204:207], v[220:223]
    v_mfma_f32_16x16x32_bf16 v[224:227], v[40:43], a[68:71], v[224:227]
    v_mfma_f32_16x16x32_bf16 v[228:231], v[40:43], a[140:143], v[228:231]
    v_mfma_f32_16x16x32_bf16 v[232:235], v[44:47], a[68:71], v[232:235]
    v_mfma_f32_16x16x32_bf16 v[236:239], v[44:47], a[140:143], v[236:239]
    s_waitcnt vmcnt(0)
    v_cvt_pk_bf16_f32 v8, v208, v209
    v_cvt_pk_bf16_f32 v9, v210, v211
    v_cvt_pk_bf16_f32 v10, v216, v217
    v_cvt_pk_bf16_f32 v11, v218, v219
    s_mov_b32 s28, s26
    buffer_store_dwordx4 v[8:11], v7, s[4:7], s28 offen sc1
    v_cvt_pk_bf16_f32 v12, v212, v213
    v_cvt_pk_bf16_f32 v13, v214, v215
    v_cvt_pk_bf16_f32 v14, v220, v221
    v_cvt_pk_bf16_f32 v15, v222, v223
    s_add_u32 s28, s28, s40
    buffer_store_dwordx4 v[12:15], v7, s[4:7], s28 offen sc1
    v_cvt_pk_bf16_f32 v16, v224, v225
    v_cvt_pk_bf16_f32 v17, v226, v227
    v_cvt_pk_bf16_f32 v18, v232, v233
    v_cvt_pk_bf16_f32 v19, v234, v235
    s_add_u32 s28, s26, s43
    buffer_store_dwordx4 v[16:19], v7, s[4:7], s28 offen sc1
    v_cvt_pk_bf16_f32 v20, v228, v229
    v_cvt_pk_bf16_f32 v21, v230, v231
    v_cvt_pk_bf16_f32 v22, v236, v237
    v_cvt_pk_bf16_f32 v23, v238, v239
    s_add_u32 s28, s28, s40
    buffer_store_dwordx4 v[20:23], v7, s[4:7], s28 offen sc1
    s_add_u32 s26, s26, s41
    s_add_u32 s27, s27, 36864
    s_cmp_eq_u32 s27, 110592
    s_cselect_b32 s27, 0, s27
    s_add_u32 s30, s30, 1
    s_add_u32 s19, s19, s20
    s_cmp_lt_u32 s19, 64
    s_cbranch_scc1 qk_vloop
qk_done:
    s_waitcnt vmcnt(0)
    s_barrier
    s_add_u32 s22, s95, 63
    v_mov_b32 v4, s22
    s_mov_b64 exec, s[34:35]
    buffer_store_dword v4, off, s[4:7], s29 sc1
    s_mov_b64 exec, -1
    s_cmp_ge_u32 s36, 64
    s_cbranch_scc1 L_qkv_next
    s_lshr_b32 s33, s36, 5
    v_and_b32 v4, 63, v0
    v_lshrrev_b32 v5, 4, v4
    v_add_u32 v1, 0, v5
    v_mul_u32_u24 v6, 11, v1
    v_lshrrev_b32 v6, 5, v6
    v_add_u32 v1, v1, v6
    v_lshlrev_b32 v1, 7, v1
    v_and_b32 v6, 7, v4
    v_lshl_add_u32 v1, v6, 4, v1
    v_add_u32 v2, 4, v5
    v_mul_u32_u24 v6, 11, v2
    v_lshrrev_b32 v6, 5, v6
    v_add_u32 v2, v2, v6
    v_lshlrev_b32 v2, 7, v2
    v_and_b32 v6, 7, v4
    v_lshl_add_u32 v2, v6, 4, v2
    v_add_u32 v3, 8, v5
    v_mul_u32_u24 v6, 11, v3
    v_lshrrev_b32 v6, 5, v6
    v_add_u32 v3, v3, v6
    v_lshlrev_b32 v3, 7, v3
    v_and_b32 v6, 7, v4
    v_lshl_add_u32 v3, v6, 4, v3
    v_min_u32 v6, 23, v4
    v_lshlrev_b32 v6, 9, v6
    s_mov_b32 s19, s33
    s_mul_i32 s24, s19, 12288
    s_add_u32 s24, s24, 90177536
    s_lshl_b32 s26, s19, 5
    s_add_u32 s26, s26, s17
    s_lshl_b32 s26, s26, 12
    s_mov_b32 s21, 71303168
    s_cmp_eq_u32 s16, 2
    s_cselect_b32 s21, 80740352, s21
    s_add_u32 s26, s26, s21
    s_lshl_b32 s29, s17, 7
    s_lshl_b32 s21, s16, 1
    s_add_u32 s21, s21, s33
    s_lshl_b32 s21, s21, 2
    s_add_u32 s29, s29, s21
    s_add_u32 s29, s29, 125829240
mk_loop:
    s_cmp_lg_u32 s18, 0
    s_cbranch_scc1 mk_go
    s_add_u32 s23, s24, 12288
    s_mov_b32 s21, 4194304
mk_wait:
    buffer_load_dword v4, v6, s[4:7], s23 offen offset:384 sc1
    s_sub_u32 s21, s21, 1
    s_cbranch_scc1 mk_go
    s_waitcnt vmcnt(0)
    v_cmp_ne_u32 vcc, s95, v4
    s_cbranch_vccz mk_go
    s_sleep 4
    s_branch mk_wait
mk_go:
    s_barrier
    s_add_u32 s23, s24, 0
    buffer_load_dwordx4 v[24:27], v1, s[4:7], s23 offen offset:0 sc1
    buffer_load_dwordx4 v[28:31], v2, s[4:7], s23 offen offset:0 sc1
    buffer_load_dwordx4 v[32:35], v3, s[4:7], s23 offen offset:0 sc1
    buffer_load_dwordx4 v[36:39], v1, s[4:7], s23 offen offset:2048 sc1
    buffer_load_dwordx4 v[40:43], v2, s[4:7], s23 offen offset:2048 sc1
    buffer_load_dwordx4 v[44:47], v3, s[4:7], s23 offen offset:2048 sc1
    s_add_u32 s23, s24, 4096
    buffer_load_dwordx4 v[48:51], v1, s[4:7], s23 offen offset:0 sc1
    buffer_load_dwordx4 v[52:55], v2, s[4:7], s23 offen offset:0 sc1
    buffer_load_dwordx4 v[56:59], v3, s[4:7], s23 offen offset:0 sc1
    buffer_load_dwordx4 v[60:63], v1, s[4:7], s23 offen offset:2048 sc1
    buffer_load_dwordx4 v[208:211], v2, s[4:7], s23 offen offset:2048 sc1
    buffer_load_dwordx4 v[212:215], v3, s[4:7], s23 offen offset:2048 sc1
    s_add_u32 s23, s24, 8192
    buffer_load_dwordx4 v[216:219], v1, s[4:7], s23 offen offset:0 sc1
    buffer_load_dwordx4 v[220:223], v2, s[4:7], s23 offen offset:0 sc1
    buffer_load_dwordx4 v[224:227], v3, s[4:7], s23 offen offset:0 sc1
    buffer_load_dwordx4 v[228:231], v1, s[4:7], s23 offen offset:2048 sc1
    buffer_load_dwordx4 v[232:235], v2, s[4:7], s23 offen offset:2048 sc1
    buffer_load_dwordx4 v[236:239], v3, s[4:7], s23 offen offset:2048 sc1
    s_add_u32 s24, s24, 24576
    s_add_u32 s22, s19, s95
    s_add_u32 s22, s22, 1
    s_cmp_eq_u32 s16, 2
    s_cbranch_scc1 mk_v
    s_waitcnt vmcnt(17)
    v_mfma_f32_16x16x32_bf16 v[8:11], v[64:67], v[24:27], 0
    v_mfma_f32_16x16x32_bf16 v[12:15], v[136:139], v[24:27], 0
    v_mfma_f32_16x16x32_bf16 v[16:19], a[0:3], v[24:27], 0
    v_mfma_f32_16x16x32_bf16 v[20:23], a[72:75], v[24:27], 0
    s_waitcnt vmcnt(16)
    v_mfma_f32_16x16x32_bf16 v[8:11], v[68:71], v[28:31], v[8:11]
    v_mfma_f32_16x16x32_bf16 v[12:15], v[140:143], v[28:31], v[12:15]
    v_mfma_f32_16x16x32_bf16 v[16:19], a[4:7], v[28:31], v[16:19]
    v_mfma_f32_16x16x32_bf16 v[20:23], a[76:79], v[28:31], v[20:23]
    s_waitcnt vmcnt(15)
    v_mfma_f32_16x16x32_bf16 v[8:11], v[72:75], v[32:35], v[8:11]
    v_mfma_f32_16x16x32_bf16 v[12:15], v[144:147], v[32:35], v[12:15]
    v_mfma_f32_16x16x32_bf16 v[16:19], a[8:11], v[32:35], v[16:19]
    v_mfma_f32_16x16x32_bf16 v[20:23], a[80:83], v[32:35], v[20:23]
    s_waitcnt vmcnt(14)
    v_mfma_f32_16x16x32_bf16 v[8:11], v[76:79], v[36:39], v[8:11]
    v_mfma_f32_16x16x32_bf16 v[12:15], v[148:151], v[36:39], v[12:15]
    v_mfma_f32_16x16x32_bf16 v[16:19], a[12:15], v[36:39], v[16:19]
    v_mfma_f32_16x16x32_bf16 v[20:23], a[84:87], v[36:39], v[20:23]
    s_waitcnt vmcnt(13)
    v_mfma_f32_16x16x32_bf16 v[8:11], v[80:83], v[40:43], v[8:11]
    v_mfma_f32_16x16x32_bf16 v[12:15], v[152:155], v[40:43], v[12:15]
    v_mfma_f32_16x16x32_bf16 v[16:19], a[16:19], v[40:43], v[16:19]
    v_mfma_f32_16x16x32_bf16 v[20:23], a[88:91], v[40:43], v[20:23]
    s_waitcnt vmcnt(12)
    v_mfma_f32_16x16x32_bf16 v[8:11], v[84:87], v[44:47], v[8:11]
    v_mfma_f32_16x16x32_bf16 v[12:15], v[156:159], v[44:47], v[12:15]
    v_mfma_f32_16x16x32_bf16 v[16:19], a[20:23], v[44:47], v[16:19]
    v_mfma_f32_16x16x32_bf16 v[20:23], a[92:95], v[44:47], v[20:23]
    s_waitcnt vmcnt(11)
    v_mfma_f32_16x16x32_bf16 v[8:11], v[88:91], v[48:51], v[8:11]
    v_mfma_f32_16x16x32_bf16 v[12:15], v[160:163], v[48:51], v[12:15]
    v_mfma_f32_16x16x32_bf16 v[16:19], a[24:27], v[48:51], v[16:19]
    v_mfma_f32_16x16x32_bf16 v[20:23], a[96:99], v[48:51], v[20:23]
    s_waitcnt vmcnt(10)
    v_mfma_f32_16x16x32_bf16 v[8:11], v[92:95], v[52:55], v[8:11]
    v_mfma_f32_16x16x32_bf16 v[12:15], v[164:167], v[52:55], v[12:15]
    v_mfma_f32_16x16x32_bf16 v[16:19], a[28:31], v[52:55], v[16:19]
    v_mfma_f32_16x16x32_bf16 v[20:23], a[100:103], v[52:55], v[20:23]
    s_waitcnt vmcnt(9)
    v_mfma_f32_16x16x32_bf16 v[8:11], v[96:99], v[56:59], v[8:11]
    v_mfma_f32_16x16x32_bf16 v[12:15], v[168:171], v[56:59], v[12:15]
    v_mfma_f32_16x16x32_bf16 v[16:19], a[32:35], v[56:59], v[16:19]
    v_mfma_f32_16x16x32_bf16 v[20:23], a[104:107], v[56:59], v[20:23]
    s_waitcnt vmcnt(8)
    v_mfma_f32_16x16x32_bf16 v[8:11], v[100:103], v[60:63], v[8:11]
    v_mfma_f32_16x16x32_bf16 v[12:15], v[172:175], v[60:63], v[12:15]
    v_mfma_f32_16x16x32_bf16 v[16:19], a[36:39], v[60:63], v[16:19]
    v_mfma_f32_16x16x32_bf16 v[20:23], a[108:111], v[60:63], v[20:23]
    s_waitcnt vmcnt(7)
    v_mfma_f32_16x16x32_bf16 v[8:11], v[104:107], v[208:211], v[8:11]
    v_mfma_f32_16x16x32_bf16 v[12:15], v[176:179], v[208:211], v[12:15]
    v_mfma_f32_16x16x32_bf16 v[16:19], a[40:43], v[208:211], v[16:19]
    v_mfma_f32_16x16x32_bf16 v[20:23], a[112:115], v[208:211], v[20:23]
    s_waitcnt vmcnt(6)
    v_mfma_f32_16x16x32_bf16 v[8:11], v[108:111], v[212:215], v[8:11]
    v_mfma_f32_16x16x32_bf16 v[12:15], v[180:183], v[212:215], v[12:15]
    v_mfma_f32_16x16x32_bf16 v[16:19], a[44:47], v[212:215], v[16:19]
    v_mfma_f32_16x16x32_bf16 v[20:23], a[116:119], v[212:215], v[20:23]
    s_waitcnt vmcnt(5)
    v_mfma_f32_16x16x32_bf16 v[8:11], v[112:115], v[216:219], v[8:11]
    v_mfma_f32_16x16x32_bf16 v[12:15], v[184:187], v[216:219], v[12:15]
    v_mfma_f32_16x16x32_bf16 v[16:19], a[48:51], v[216:219], v[16:19]
    v_mfma_f32_16x16x32_bf16 v[20:23], a[120:123], v[216:219], v[20:23]
    s_waitcnt vmcnt(4)
    v_mfma_f32_16x16x32_bf16 v[8:11], v[116:119], v[220:223], v[8:11]
    v_mfma_f32_16x16x32_bf16 v[12:15], v[188:191], v[220:223], v[12:15]
    v_mfma_f32_16x16x32_bf16 v[16:19], a[52:55], v[220:223], v[16:19]
    v_mfma_f32_16x16x32_bf16 v[20:23], a[124:127], v[220:223], v[20:23]
    s_waitcnt vmcnt(3)
    v_mfma_f32_16x16x32_bf16 v[8:11], v[120:123], v[224:227], v[8:11]
    v_mfma_f32_16x16x32_bf16 v[12:15], v[192:195], v[224:227], v[12:15]
    v_mfma_f32_16x16x32_bf16 v[16:19], a[56:59], v[224:227], v[16:19]
    v_mfma_f32_16x16x32_bf16 v[20:23], a[128:131], v[224:227], v[20:23]
    s_waitcnt vmcnt(2)
    v_mfma_f32_16x16x32_bf16 v[8:11], v[124:127], v[228:231], v[8:11]
    v_mfma_f32_16x16x32_bf16 v[12:15], v[196:199], v[228:231], v[12:15]
    v_mfma_f32_16x16x32_bf16 v[16:19], a[60:63], v[228:231], v[16:19]
    v_mfma_f32_16x16x32_bf16 v[20:23], a[132:135], v[228:231], v[20:23]
    s_waitcnt vmcnt(1)
    v_mfma_f32_16x16x32_bf16 v[8:11], v[128:131], v[232:235], v[8:11]
    v_mfma_f32_16x16x32_bf16 v[12:15], v[200:203], v[232:235], v[12:15]
    v_mfma_f32_16x16x32_bf16 v[16:19], a[64:67], v[232:235], v[16:19]
    v_mfma_f32_16x16x32_bf16 v[20:23], a[136:139], v[232:235], v[20:23]
    s_waitcnt vmcnt(0)
    v_mfma_f32_16x16x32_bf16 v[8:11], v[132:135], v[236:239], v[8:11]
    v_mfma_f32_16x16x32_bf16 v[12:15], v[204:207], v[236:239], v[12:15]
    v_mfma_f32_16x16x32_bf16 v[16:19], a[68:71], v[236:239], v[16:19]
    v_mfma_f32_16x16x32_bf16 v[20:23], a[140:143], v[236:239], v[20:23]
    s_nop 7
    s_branch mk_st
mk_v:
    s_waitcnt vmcnt(17)
    v_mfma_f32_16x16x32_bf16 v[8:11], v[24:27], v[64:67], 0
    v_mfma_f32_16x16x32_bf16 v[12:15], v[24:27], v[136:139], 0
    v_mfma_f32_16x16x32_bf16 v[16:19], v[24:27], a[0:3], 0
    v_mfma_f32_16x16x32_bf16 v[20:23], v[24:27], a[72:75], 0
    s_waitcnt vmcnt(16)
    v_mfma_f32_16x16x32_bf16 v[8:11], v[28:31], v[68:71], v[8:11]
    v_mfma_f32_16x16x32_bf16 v[12:15], v[28:31], v[140:143], v[12:15]
    v_mfma_f32_16x16x32_bf16 v[16:19], v[28:31], a[4:7], v[16:19]
    v_mfma_f32_16x16x32_bf16 v[20:23], v[28:31], a[76:79], v[20:23]
    s_waitcnt vmcnt(15)
    v_mfma_f32_16x16x32_bf16 v[8:11], v[32:35], v[72:75], v[8:11]
    v_mfma_f32_16x16x32_bf16 v[12:15], v[32:35], v[144:147], v[12:15]
    v_mfma_f32_16x16x32_bf16 v[16:19], v[32:35], a[8:11], v[16:19]
    v_mfma_f32_16x16x32_bf16 v[20:23], v[32:35], a[80:83], v[20:23]
    s_waitcnt vmcnt(14)
    v_mfma_f32_16x16x32_bf16 v[8:11], v[36:39], v[76:79], v[8:11]
    v_mfma_f32_16x16x32_bf16 v[12:15], v[36:39], v[148:151], v[12:15]
    v_mfma_f32_16x16x32_bf16 v[16:19], v[36:39], a[12:15], v[16:19]
    v_mfma_f32_16x16x32_bf16 v[20:23], v[36:39], a[84:87], v[20:23]
    s_waitcnt vmcnt(13)
    v_mfma_f32_16x16x32_bf16 v[8:11], v[40:43], v[80:83], v[8:11]
    v_mfma_f32_16x16x32_bf16 v[12:15], v[40:43], v[152:155], v[12:15]
    v_mfma_f32_16x16x32_bf16 v[16:19], v[40:43], a[16:19], v[16:19]
    v_mfma_f32_16x16x32_bf16 v[20:23], v[40:43], a[88:91], v[20:23]
    s_waitcnt vmcnt(12)
    v_mfma_f32_16x16x32_bf16 v[8:11], v[44:47], v[84:87], v[8:11]
    v_mfma_f32_16x16x32_bf16 v[12:15], v[44:47], v[156:159], v[12:15]
    v_mfma_f32_16x16x32_bf16 v[16:19], v[44:47], a[20:23], v[16:19]
    v_mfma_f32_16x16x32_bf16 v[20:23], v[44:47], a[92:95], v[20:23]
    s_waitcnt vmcnt(11)
    v_mfma_f32_16x16x32_bf16 v[8:11], v[48:51], v[88:91], v[8:11]
    v_mfma_f32_16x16x32_bf16 v[12:15], v[48:51], v[160:163], v[12:15]
    v_mfma_f32_16x16x32_bf16 v[16:19], v[48:51], a[24:27], v[16:19]
    v_mfma_f32_16x16x32_bf16 v[20:23], v[48:51], a[96:99], v[20:23]
    s_waitcnt vmcnt(10)
    v_mfma_f32_16x16x32_bf16 v[8:11], v[52:55], v[92:95], v[8:11]
    v_mfma_f32_16x16x32_bf16 v[12:15], v[52:55], v[164:167], v[12:15]
    v_mfma_f32_16x16x32_bf16 v[16:19], v[52:55], a[28:31], v[16:19]
    v_mfma_f32_16x16x32_bf16 v[20:23], v[52:55], a[100:103], v[20:23]
    s_waitcnt vmcnt(9)
    v_mfma_f32_16x16x32_bf16 v[8:11], v[56:59], v[96:99], v[8:11]
    v_mfma_f32_16x16x32_bf16 v[12:15], v[56:59], v[168:171], v[12:15]
    v_mfma_f32_16x16x32_bf16 v[16:19], v[56:59], a[32:35], v[16:19]
    v_mfma_f32_16x16x32_bf16 v[20:23], v[56:59], a[104:107], v[20:23]
    s_waitcnt vmcnt(8)
    v_mfma_f32_16x16x32_bf16 v[8:11], v[60:63], v[100:103], v[8:11]
    v_mfma_f32_16x16x32_bf16 v[12:15], v[60:63], v[172:175], v[12:15]
    v_mfma_f32_16x16x32_bf16 v[16:19], v[60:63], a[36:39], v[16:19]
    v_mfma_f32_16x16x32_bf16 v[20:23], v[60:63], a[108:111], v[20:23]
    s_waitcnt vmcnt(7)
    v_mfma_f32_16x16x32_bf16 v[8:11], v[208:211], v[104:107], v[8:11]
    v_mfma_f32_16x16x32_bf16 v[12:15], v[208:211], v[176:179], v[12:15]
    v_mfma_f32_16x16x32_bf16 v[16:19], v[208:211], a[40:43], v[16:19]
    v_mfma_f32_16x16x32_bf16 v[20:23], v[208:211], a[112:115], v[20:23]
    s_waitcnt vmcnt(6)
    v_mfma_f32_16x16x32_bf16 v[8:11], v[212:215], v[108:111], v[8:11]
    v_mfma_f32_16x16x32_bf16 v[12:15], v[212:215], v[180:183], v[12:15]
    v_mfma_f32_16x16x32_bf16 v[16:19], v[212:215], a[44:47], v[16:19]
    v_mfma_f32_16x16x32_bf16 v[20:23], v[212:215], a[116:119], v[20:23]
    s_waitcnt vmcnt(5)
    v_mfma_f32_16x16x32_bf16 v[8:11], v[216:219], v[112:115], v[8:11]
    v_mfma_f32_16x16x32_bf16 v[12:15], v[216:219], v[184:187], v[12:15]
    v_mfma_f32_16x16x32_bf16 v[16:19], v[216:219], a[48:51], v[16:19]
    v_mfma_f32_16x16x32_bf16 v[20:23], v[216:219], a[120:123], v[20:23]
    s_waitcnt vmcnt(4)
    v_mfma_f32_16x16x32_bf16 v[8:11], v[220:223], v[116:119], v[8:11]
    v_mfma_f32_16x16x32_bf16 v[12:15], v[220:223], v[188:191], v[12:15]
    v_mfma_f32_16x16x32_bf16 v[16:19], v[220:223], a[52:55], v[16:19]
    v_mfma_f32_16x16x32_bf16 v[20:23], v[220:223], a[124:127], v[20:23]
    s_waitcnt vmcnt(3)
    v_mfma_f32_16x16x32_bf16 v[8:11], v[224:227], v[120:123], v[8:11]
    v_mfma_f32_16x16x32_bf16 v[12:15], v[224:227], v[192:195], v[12:15]
    v_mfma_f32_16x16x32_bf16 v[16:19], v[224:227], a[56:59], v[16:19]
    v_mfma_f32_16x16x32_bf16 v[20:23], v[224:227], a[128:131], v[20:23]
    s_waitcnt vmcnt(2)
    v_mfma_f32_16x16x32_bf16 v[8:11], v[228:231], v[124:127], v[8:11]
    v_mfma_f32_16x16x32_bf16 v[12:15], v[228:231], v[196:199], v[12:15]
    v_mfma_f32_16x16x32_bf16 v[16:19], v[228:231], a[60:63], v[16:19]
    v_mfma_f32_16x16x32_bf16 v[20:23], v[228:231], a[132:135], v[20:23]
    s_waitcnt vmcnt(1)
    v_mfma_f32_16x16x32_bf16 v[8:11], v[232:235], v[128:131], v[8:11]
    v_mfma_f32_16x16x32_bf16 v[12:15], v[232:235], v[200:203], v[12:15]
    v_mfma_f32_16x16x32_bf16 v[16:19], v[232:235], a[64:67], v[16:19]
    v_mfma_f32_16x16x32_bf16 v[20:23], v[232:235], a[136:139], v[20:23]
    s_waitcnt vmcnt(0)
    v_mfma_f32_16x16x32_bf16 v[8:11], v[236:239], v[132:135], v[8:11]
    v_mfma_f32_16x16x32_bf16 v[12:15], v[236:239], v[204:207], v[12:15]
    v_mfma_f32_16x16x32_bf16 v[16:19], v[236:239], a[68:71], v[16:19]
    v_mfma_f32_16x16x32_bf16 v[20:23], v[236:239], a[140:143], v[20:23]
    v_pk_mul_f32 v[8:9], v[8:9], 0.5 op_sel_hi:[1,0]
    v_pk_mul_f32 v[10:11], v[10:11], 0.5 op_sel_hi:[1,0]
    v_pk_mul_f32 v[12:13], v[12:13], 0.5 op_sel_hi:[1,0]
    v_pk_mul_f32 v[14:15], v[14:15], 0.5 op_sel_hi:[1,0]
    v_pk_mul_f32 v[16:17], v[16:17], 0.5 op_sel_hi:[1,0]
    v_pk_mul_f32 v[18:19], v[18:19], 0.5 op_sel_hi:[1,0]
    s_nop 0
    v_pk_mul_f32 v[20:21], v[20:21], 0.5 op_sel_hi:[1,0]
    v_pk_mul_f32 v[22:23], v[22:23], 0.5 op_sel_hi:[1,0]
    s_nop 1
mk_st:
    v_cvt_pk_bf16_f32 v24, v8, v9
    v_cvt_pk_bf16_f32 v25, v10, v11
    v_cvt_pk_bf16_f32 v26, v12, v13
    v_cvt_pk_bf16_f32 v27, v14, v15
    v_cvt_pk_bf16_f32 v28, v16, v17
    v_cvt_pk_bf16_f32 v29, v18, v19
    v_cvt_pk_bf16_f32 v30, v20, v21
    v_cvt_pk_bf16_f32 v31, v22, v23
    s_add_u32 s21, s26, 4096
    buffer_store_dwordx4 v[24:27], v7, s[4:7], s26 offen sc1
    buffer_store_dwordx4 v[28:31], v7, s[4:7], s21 offen sc1
    s_waitcnt vmcnt(0)
    s_barrier
    v_mov_b32 v4, s22
    s_mov_b64 exec, s[34:35]
    buffer_store_dword v4, off, s[4:7], s29 sc1
    s_mov_b64 exec, -1
    s_add_u32 s19, s19, 2
    s_add_u32 s26, s26, 262144
    s_cmp_lt_u32 s19, 62
    s_cbranch_scc1 mk_loop
    s_endpgm
L_ssm_next:
    s_mov_b32 s37, 8
    v_mov_b32 v250, 1
    v_mov_b32 v251, 163832
    v_cmp_eq_u32 vcc, 0, v0
    s_nop 0
    s_and_saveexec_b64 s[38:39], vcc
    s_cbranch_execz tk7
    buffer_atomic_add v250, off, s[96:99], s37 sc0
    s_waitcnt vmcnt(0)
    ds_write_b32 v251, v250
    s_waitcnt lgkmcnt(0)
tk7:
    s_mov_b64 exec, -1
    s_barrier
    ds_read_b32 v252, v251
    s_waitcnt lgkmcnt(0)
    v_readfirstlane_b32 s20, v252
    s_barrier
    s_nop 3
    s_cmp_ge_u32 s20, 144
    s_cbranch_scc1 L_phase2
    s_lshl_b32 s20, s20, 2
    v_lshrrev_b32 v5, 6, v0
    s_nop 0
    v_readfirstlane_b32 s21, v5
    v_and_b32 v1, 63, v0
    v_and_b32 v2, 15, v1
    v_lshrrev_b32 v3, 4, v1
    v_lshlrev_b32 v4, 14, v5
    s_mov_b32 s8, s62
    s_mov_b32 s9, s63
    s_mov_b32 s10, 2359296
    s_mov_b32 s11, 0x20000
    s_mov_b32 s16, s76
    s_mov_b32 s17, s77
    s_mov_b32 s18, 4718592
    s_mov_b32 s19, 0x20000
    v_mul_u32_u24 v5, 9216, v0
    s_lshl_b32 s22, s20, 1
    s_add_u32 s23, s22, 0
    buffer_load_dwordx2 v[8:9], v5, s[8:11], s23 offen
    s_add_u32 s23, s22, 1152
    buffer_load_dwordx2 v[10:11], v5, s[8:11], s23 offen
    s_add_u32 s23, s22, 2304
    buffer_load_dwordx2 v[12:13], v5, s[8:11], s23 offen
    s_add_u32 s23, s22, 3456
    buffer_load_dwordx2 v[14:15], v5, s[8:11], s23 offen
    s_add_u32 s23, s22, 4608
    buffer_load_dwordx2 v[16:17], v5, s[8:11], s23 offen
    s_add_u32 s23, s22, 5760
    buffer_load_dwordx2 v[18:19], v5, s[8:11], s23 offen
    s_add_u32 s23, s22, 6912
    buffer_load_dwordx2 v[20:21], v5, s[8:11], s23 offen
    s_add_u32 s23, s22, 8064
    buffer_load_dwordx2 v[22:23], v5, s[8:11], s23 offen
    s_add_u32 s22, s20, s21
    s_lshl_b32 s23, s22, 8
    v_lshlrev_b32 v6, 3, v2
    v_lshl_add_u32 v6, v3, 1, v6
    s_mov_b32 s12, s64
    s_mov_b32 s13, s65
    s_mov_b32 s14, 147456
    s_mov_b32 s15, 0x20000
    buffer_load_ushort v24, v6, s[12:15], s23 offen offset:0
    buffer_load_ushort v28, v6, s[12:15], s23 offen offset:128
    s_mov_b32 s12, s66
    s_mov_b32 s13, s67
    s_mov_b32 s14, 147456
    s_mov_b32 s15, 0x20000
    buffer_load_ushort v25, v6, s[12:15], s23 offen offset:0
    buffer_load_ushort v29, v6, s[12:15], s23 offen offset:128
    s_mov_b32 s12, s68
    s_mov_b32 s13, s69
    s_mov_b32 s14, 147456
    s_mov_b32 s15, 0x20000
    buffer_load_ushort v26, v6, s[12:15], s23 offen offset:0
    buffer_load_ushort v30, v6, s[12:15], s23 offen offset:128
    s_mov_b32 s12, s70
    s_mov_b32 s13, s71
    s_mov_b32 s14, 147456
    s_mov_b32 s15, 0x20000
    buffer_load_ushort v27, v6, s[12:15], s23 offen offset:0
    buffer_load_ushort v31, v6, s[12:15], s23 offen offset:128
    s_mov_b32 s12, s72
    s_mov_b32 s13, s73
    s_mov_b32 s14, 1152
    s_mov_b32 s15, 0x20000
    s_lshl_b32 s23, s22, 1
    buffer_load_ushort v32, off, s[12:15], s23
    s_mov_b32 s26, 0x3fb8aa3b
    s_mov_b32 s27, 0x3e22f983
    v_mov_b32 v34, 0
    v_mov_b32 v35, 0
    v_lshl_add_u32 v6, v1, 3, v4
    ds_write_b64 v6, v[34:35] offset:0
    s_waitcnt vmcnt(0)
    v_mov_b32 v36, 0x05040100
    v_mov_b32 v37, 0x07060302
    v_lshlrev_b32 v6, 4, v0
    v_perm_b32 v40, v10, v8, v36
    v_perm_b32 v41, v14, v12, v36
    v_perm_b32 v42, v18, v16, v36
    v_perm_b32 v43, v22, v20, v36
    ds_write_b128 v6, v[40:43] offset:512
    s_nop 1
    v_perm_b32 v40, v10, v8, v37
    v_perm_b32 v41, v14, v12, v37
    v_perm_b32 v42, v18, v16, v37
    v_perm_b32 v43, v22, v20, v37
    ds_write_b128 v6, v[40:43] offset:16896
    s_nop 1
    v_perm_b32 v40, v11, v9, v36
    v_perm_b32 v41, v15, v13, v36
    v_perm_b32 v42, v19, v17, v36
    v_perm_b32 v43, v23, v21, v36
    ds_write_b128 v6, v[40:43] offset:33280
    s_nop 1
    v_perm_b32 v40, v11, v9, v37
    v_perm_b32 v41, v15, v13, v37
    v_perm_b32 v42, v19, v17, v37
    v_perm_b32 v43, v23, v21, v37
    ds_write_b128 v6, v[40:43] offset:49664
    s_nop 1
    v_lshlrev_b32 v32, 16, v32
    v_mul_f32 v32, s26, v32
    v_exp_f32 v32, v32
    s_nop 0
    v_cvt_pk_bf16_f32 v32, v32, v32
    v_and_b32 v32, 0xffff0000, v32
    v_add_f32 v33, v32, v32
    v_lshlrev_b32 v24, 16, v24
    v_mul_f32 v24, s26, v24
    v_exp_f32 v24, v24
    s_nop 0
    v_cvt_pk_bf16_f32 v24, v24, v24
    v_and_b32 v24, 0xffff0000, v24
    v_mul_f32 v24, v24, v32
    v_mul_f32 v24, s26, v24
    v_sub_f32 v24, 0, v24
    v_lshlrev_b32 v25, 16, v25
    v_mul_f32 v25, v25, v32
    v_mul_f32 v25, s27, v25
    v_lshlrev_b32 v26, 16, v26
    v_mul_f32 v26, v26, v33
    v_lshlrev_b32 v27, 16, v27
    v_mul_f32 v27, v27, v33
    v_lshlrev_b32 v28, 16, v28
    v_mul_f32 v28, s26, v28
    v_exp_f32 v28, v28
    s_nop 0
    v_cvt_pk_bf16_f32 v28, v28, v28
    v_and_b32 v28, 0xffff0000, v28
    v_mul_f32 v28, v28, v32
    v_mul_f32 v28, s26, v28
    v_sub_f32 v28, 0, v28
    v_lshlrev_b32 v29, 16, v29
    v_mul_f32 v29, v29, v32
    v_mul_f32 v29, s27, v29
    v_lshlrev_b32 v30, 16, v30
    v_mul_f32 v30, v30, v33
    v_lshlrev_b32 v31, 16, v31
    v_mul_f32 v31, v31, v33
    v_cvt_f32_u32 v47, v2
    v_mul_f32 v44, 0x41800000, v47
    v_and_b32 v5, 7, v2
    v_add_u32 v5, 8, v5
    v_cvt_f32_u32 v5, v5
    v_mul_f32 v45, 0x42000000, v5
    v_mul_f32 v6, 0x42800000, v5
    v_cmp_lt_u32 vcc, 7, v2
    s_nop 1
    v_cndmask_b32 v45, v45, v6, vcc
    v_add_f32 v5, 0x41000000, v47
    v_mul_f32 v46, 0x43000000, v5
    v_mov_b32 v48, 0
    v_mov_b32 v49, 0
    v_mov_b32 v50, 0
    v_mov_b32 v51, 0
    v_mov_b32 v52, 0
    v_mov_b32 v53, 0
    v_mov_b32 v54, 0
    v_mov_b32 v55, 0
    v_mov_b32 v56, 0
    v_mov_b32 v57, 0
    v_mov_b32 v58, 0
    v_mov_b32 v59, 0
    v_mov_b32 v60, 0
    v_mov_b32 v61, 0
    v_mov_b32 v62, 0
    v_mov_b32 v63, 0
    v_mov_b32_dpp v64, v24 row_newbcast:0 row_mask:0xf bank_mask:0xf
    v_mov_b32_dpp v65, v25 row_newbcast:0 row_mask:0xf bank_mask:0xf
    v_mov_b32_dpp v66, v26 row_newbcast:0 row_mask:0xf bank_mask:0xf
    v_mov_b32_dpp v67, v27 row_newbcast:0 row_mask:0xf bank_mask:0xf
    v_mul_f32 v82, v64, v47
    v_mul_f32 v83, v65, v47
    v_exp_f32 v82, v82
    v_fract_f32 v83, v83
    v_cos_f32 v74, v83
    v_sin_f32 v75, v83
    v_mul_f32 v74, v74, v82
    v_mul_f32 v75, v75, v82
    v_mul_f32 v84, v75, v75
    v_add_f32 v85, v74, v74
    v_fma_f32 v76, v74, v74, -v84
    v_mul_f32 v77, v85, v75
    v_mul_f32 v84, v77, v77
    v_add_f32 v85, v76, v76
    v_fma_f32 v78, v76, v76, -v84
    v_mul_f32 v79, v85, v77
    v_mul_f32 v84, v79, v79
    v_add_f32 v85, v78, v78
    v_fma_f32 v80, v78, v78, -v84
    v_mul_f32 v81, v85, v79
    v_mul_f32 v82, v64, v44
    v_mul_f32 v83, v65, v44
    v_exp_f32 v82, v82
    v_fract_f32 v83, v83
    v_cos_f32 v68, v83
    v_sin_f32 v69, v83
    v_mul_f32 v68, v68, v82
    v_mul_f32 v69, v69, v82
    v_mul_f32 v84, v67, v69
    v_mul_f32 v85, v67, v68
    v_fma_f32 v68, v66, v68, -v84
    v_fma_f32 v69, -v66, v69, -v85
    v_mul_f32 v82, v64, v45
    v_mul_f32 v83, v65, v45
    v_exp_f32 v82, v82
    v_fract_f32 v83, v83
    v_cos_f32 v70, v83
    v_sin_f32 v71, v83
    v_mul_f32 v70, v70, v82
    v_mul_f32 v71, v71, v82
    v_mul_f32 v84, v67, v71
    v_mul_f32 v85, v67, v70
    v_fma_f32 v70, v66, v70, -v84
    v_fma_f32 v71, -v66, v71, -v85
    v_mul_f32 v82, v64, v46
    v_mul_f32 v83, v65, v46
    v_exp_f32 v82, v82
    v_fract_f32 v83, v83
    v_cos_f32 v72, v83
    v_sin_f32 v73, v83
    v_mul_f32 v72, v72, v82
    v_mul_f32 v73, v73, v82
    v_mul_f32 v84, v67, v73
    v_mul_f32 v85, v67, v72
    v_fma_f32 v72, v66, v72, -v84
    v_fma_f32 v73, -v66, v73, -v85
    v_mfma_f32_16x16x4_f32 v[48:51], v68, v74, v[48:51]
    v_mfma_f32_16x16x4_f32 v[52:55], v70, v76, v[52:55]
    v_mfma_f32_16x16x4_f32 v[56:59], v70, v78, v[56:59]
    v_mfma_f32_16x16x4_f32 v[60:63], v72, v80, v[60:63]
    v_mfma_f32_16x16x4_f32 v[48:51], v69, v75, v[48:51]
    v_mfma_f32_16x16x4_f32 v[52:55], v71, v77, v[52:55]
    v_mfma_f32_16x16x4_f32 v[56:59], v71, v79, v[56:59]
    v_mfma_f32_16x16x4_f32 v[60:63], v73, v81, v[60:63]
    v_mov_b32_dpp v64, v24 row_newbcast:1 row_mask:0xf bank_mask:0xf
    v_mov_b32_dpp v65, v25 row_newbcast:1 row_mask:0xf bank_mask:0xf
    v_mov_b32_dpp v66, v26 row_newbcast:1 row_mask:0xf bank_mask:0xf
    v_mov_b32_dpp v67, v27 row_newbcast:1 row_mask:0xf bank_mask:0xf
    v_mul_f32 v82, v64, v47
    v_mul_f32 v83, v65, v47
    v_exp_f32 v82, v82
    v_fract_f32 v83, v83
    v_cos_f32 v74, v83
    v_sin_f32 v75, v83
    v_mul_f32 v74, v74, v82
    v_mul_f32 v75, v75, v82
    v_mul_f32 v84, v75, v75
    v_add_f32 v85, v74, v74
    v_fma_f32 v76, v74, v74, -v84
    v_mul_f32 v77, v85, v75
    v_mul_f32 v84, v77, v77
    v_add_f32 v85, v76, v76
    v_fma_f32 v78, v76, v76, -v84
    v_mul_f32 v79, v85, v77
    v_mul_f32 v84, v79, v79
    v_add_f32 v85, v78, v78
    v_fma_f32 v80, v78, v78, -v84
    v_mul_f32 v81, v85, v79
    v_mul_f32 v82, v64, v44
    v_mul_f32 v83, v65, v44
    v_exp_f32 v82, v82
    v_fract_f32 v83, v83
    v_cos_f32 v68, v83
    v_sin_f32 v69, v83
    v_mul_f32 v68, v68, v82
    v_mul_f32 v69, v69, v82
    v_mul_f32 v84, v67, v69
    v_mul_f32 v85, v67, v68
    v_fma_f32 v68, v66, v68, -v84
    v_fma_f32 v69, -v66, v69, -v85
    v_mul_f32 v82, v64, v45
    v_mul_f32 v83, v65, v45
    v_exp_f32 v82, v82
    v_fract_f32 v83, v83
    v_cos_f32 v70, v83
    v_sin_f32 v71, v83
    v_mul_f32 v70, v70, v82
    v_mul_f32 v71, v71, v82
    v_mul_f32 v84, v67, v71
    v_mul_f32 v85, v67, v70
    v_fma_f32 v70, v66, v70, -v84
    v_fma_f32 v71, -v66, v71, -v85
    v_mul_f32 v82, v64, v46
    v_mul_f32 v83, v65, v46
    v_exp_f32 v82, v82
    v_fract_f32 v83, v83
    v_cos_f32 v72, v83
    v_sin_f32 v73, v83
    v_mul_f32 v72, v72, v82
    v_mul_f32 v73, v73, v82
    v_mul_f32 v84, v67, v73
    v_mul_f32 v85, v67, v72
    v_fma_f32 v72, v66, v72, -v84
    v_fma_f32 v73, -v66, v73, -v85
    v_mfma_f32_16x16x4_f32 v[48:51], v68, v74, v[48:51]
    v_mfma_f32_16x16x4_f32 v[52:55], v70, v76, v[52:55]
    v_mfma_f32_16x16x4_f32 v[56:59], v70, v78, v[56:59]
    v_mfma_f32_16x16x4_f32 v[60:63], v72, v80, v[60:63]
    v_mfma_f32_16x16x4_f32 v[48:51], v69, v75, v[48:51]
    v_mfma_f32_16x16x4_f32 v[52:55], v71, v77, v[52:55]
    v_mfma_f32_16x16x4_f32 v[56:59], v71, v79, v[56:59]
    v_mfma_f32_16x16x4_f32 v[60:63], v73, v81, v[60:63]
    v_mov_b32_dpp v64, v24 row_newbcast:2 row_mask:0xf bank_mask:0xf
    v_mov_b32_dpp v65, v25 row_newbcast:2 row_mask:0xf bank_mask:0xf
    v_mov_b32_dpp v66, v26 row_newbcast:2 row_mask:0xf bank_mask:0xf
    v_mov_b32_dpp v67, v27 row_newbcast:2 row_mask:0xf bank_mask:0xf
    v_mul_f32 v82, v64, v47
    v_mul_f32 v83, v65, v47
    v_exp_f32 v82, v82
    v_fract_f32 v83, v83
    v_cos_f32 v74, v83
    v_sin_f32 v75, v83
    v_mul_f32 v74, v74, v82
    v_mul_f32 v75, v75, v82
    v_mul_f32 v84, v75, v75
    v_add_f32 v85, v74, v74
    v_fma_f32 v76, v74, v74, -v84
    v_mul_f32 v77, v85, v75
    v_mul_f32 v84, v77, v77
    v_add_f32 v85, v76, v76
    v_fma_f32 v78, v76, v76, -v84
    v_mul_f32 v79, v85, v77
    v_mul_f32 v84, v79, v79
    v_add_f32 v85, v78, v78
    v_fma_f32 v80, v78, v78, -v84
    v_mul_f32 v81, v85, v79
    v_mul_f32 v82, v64, v44
    v_mul_f32 v83, v65, v44
    v_exp_f32 v82, v82
    v_fract_f32 v83, v83
    v_cos_f32 v68, v83
    v_sin_f32 v69, v83
    v_mul_f32 v68, v68, v82
    v_mul_f32 v69, v69, v82
    v_mul_f32 v84, v67, v69
    v_mul_f32 v85, v67, v68
    v_fma_f32 v68, v66, v68, -v84
    v_fma_f32 v69, -v66, v69, -v85
    v_mul_f32 v82, v64, v45
    v_mul_f32 v83, v65, v45
    v_exp_f32 v82, v82
    v_fract_f32 v83, v83
    v_cos_f32 v70, v83
    v_sin_f32 v71, v83
    v_mul_f32 v70, v70, v82
    v_mul_f32 v71, v71, v82
    v_mul_f32 v84, v67, v71
    v_mul_f32 v85, v67, v70
    v_fma_f32 v70, v66, v70, -v84
    v_fma_f32 v71, -v66, v71, -v85
    v_mul_f32 v82, v64, v46
    v_mul_f32 v83, v65, v46
    v_exp_f32 v82, v82
    v_fract_f32 v83, v83
    v_cos_f32 v72, v83
    v_sin_f32 v73, v83
    v_mul_f32 v72, v72, v82
    v_mul_f32 v73, v73, v82
    v_mul_f32 v84, v67, v73
    v_mul_f32 v85, v67, v72
    v_fma_f32 v72, v66, v72, -v84
    v_fma_f32 v73, -v66, v73, -v85
    v_mfma_f32_16x16x4_f32 v[48:51], v68, v74, v[48:51]
    v_mfma_f32_16x16x4_f32 v[52:55], v70, v76, v[52:55]
    v_mfma_f32_16x16x4_f32 v[56:59], v70, v78, v[56:59]
    v_mfma_f32_16x16x4_f32 v[60:63], v72, v80, v[60:63]
    v_mfma_f32_16x16x4_f32 v[48:51], v69, v75, v[48:51]
    v_mfma_f32_16x16x4_f32 v[52:55], v71, v77, v[52:55]
    v_mfma_f32_16x16x4_f32 v[56:59], v71, v79, v[56:59]
    v_mfma_f32_16x16x4_f32 v[60:63], v73, v81, v[60:63]
    v_mov_b32_dpp v64, v24 row_newbcast:3 row_mask:0xf bank_mask:0xf
    v_mov_b32_dpp v65, v25 row_newbcast:3 row_mask:0xf bank_mask:0xf
    v_mov_b32_dpp v66, v26 row_newbcast:3 row_mask:0xf bank_mask:0xf
    v_mov_b32_dpp v67, v27 row_newbcast:3 row_mask:0xf bank_mask:0xf
    v_mul_f32 v82, v64, v47
    v_mul_f32 v83, v65, v47
    v_exp_f32 v82, v82
    v_fract_f32 v83, v83
    v_cos_f32 v74, v83
    v_sin_f32 v75, v83
    v_mul_f32 v74, v74, v82
    v_mul_f32 v75, v75, v82
    v_mul_f32 v84, v75, v75
    v_add_f32 v85, v74, v74
    v_fma_f32 v76, v74, v74, -v84
    v_mul_f32 v77, v85, v75
    v_mul_f32 v84, v77, v77
    v_add_f32 v85, v76, v76
    v_fma_f32 v78, v76, v76, -v84
    v_mul_f32 v79, v85, v77
    v_mul_f32 v84, v79, v79
    v_add_f32 v85, v78, v78
    v_fma_f32 v80, v78, v78, -v84
    v_mul_f32 v81, v85, v79
    v_mul_f32 v82, v64, v44
    v_mul_f32 v83, v65, v44
    v_exp_f32 v82, v82
    v_fract_f32 v83, v83
    v_cos_f32 v68, v83
    v_sin_f32 v69, v83
    v_mul_f32 v68, v68, v82
    v_mul_f32 v69, v69, v82
    v_mul_f32 v84, v67, v69
    v_mul_f32 v85, v67, v68
    v_fma_f32 v68, v66, v68, -v84
    v_fma_f32 v69, -v66, v69, -v85
    v_mul_f32 v82, v64, v45
    v_mul_f32 v83, v65, v45
    v_exp_f32 v82, v82
    v_fract_f32 v83, v83
    v_cos_f32 v70, v83
    v_sin_f32 v71, v83
    v_mul_f32 v70, v70, v82
    v_mul_f32 v71, v71, v82
    v_mul_f32 v84, v67, v71
    v_mul_f32 v85, v67, v70
    v_fma_f32 v70, v66, v70, -v84
    v_fma_f32 v71, -v66, v71, -v85
    v_mul_f32 v82, v64, v46
    v_mul_f32 v83, v65, v46
    v_exp_f32 v82, v82
    v_fract_f32 v83, v83
    v_cos_f32 v72, v83
    v_sin_f32 v73, v83
    v_mul_f32 v72, v72, v82
    v_mul_f32 v73, v73, v82
    v_mul_f32 v84, v67, v73
    v_mul_f32 v85, v67, v72
    v_fma_f32 v72, v66, v72, -v84
    v_fma_f32 v73, -v66, v73, -v85
    v_mfma_f32_16x16x4_f32 v[48:51], v68, v74, v[48:51]
    v_mfma_f32_16x16x4_f32 v[52:55], v70, v76, v[52:55]
    v_mfma_f32_16x16x4_f32 v[56:59], v70, v78, v[56:59]
    v_mfma_f32_16x16x4_f32 v[60:63], v72, v80, v[60:63]
    v_mfma_f32_16x16x4_f32 v[48:51], v69, v75, v[48:51]
    v_mfma_f32_16x16x4_f32 v[52:55], v71, v77, v[52:55]
    v_mfma_f32_16x16x4_f32 v[56:59], v71, v79, v[56:59]
    v_mfma_f32_16x16x4_f32 v[60:63], v73, v81, v[60:63]
    v_mov_b32_dpp v64, v24 row_newbcast:4 row_mask:0xf bank_mask:0xf
    v_mov_b32_dpp v65, v25 row_newbcast:4 row_mask:0xf bank_mask:0xf
    v_mov_b32_dpp v66, v26 row_newbcast:4 row_mask:0xf bank_mask:0xf
    v_mov_b32_dpp v67, v27 row_newbcast:4 row_mask:0xf bank_mask:0xf
    v_mul_f32 v82, v64, v47
    v_mul_f32 v83, v65, v47
    v_exp_f32 v82, v82
    v_fract_f32 v83, v83
    v_cos_f32 v74, v83
    v_sin_f32 v75, v83
    v_mul_f32 v74, v74, v82
    v_mul_f32 v75, v75, v82
    v_mul_f32 v84, v75, v75
    v_add_f32 v85, v74, v74
    v_fma_f32 v76, v74, v74, -v84
    v_mul_f32 v77, v85, v75
    v_mul_f32 v84, v77, v77
    v_add_f32 v85, v76, v76
    v_fma_f32 v78, v76, v76, -v84
    v_mul_f32 v79, v85, v77
    v_mul_f32 v84, v79, v79
    v_add_f32 v85, v78, v78
    v_fma_f32 v80, v78, v78, -v84
    v_mul_f32 v81, v85, v79
    v_mul_f32 v82, v64, v44
    v_mul_f32 v83, v65, v44
    v_exp_f32 v82, v82
    v_fract_f32 v83, v83
    v_cos_f32 v68, v83
    v_sin_f32 v69, v83
    v_mul_f32 v68, v68, v82
    v_mul_f32 v69, v69, v82
    v_mul_f32 v84, v67, v69
    v_mul_f32 v85, v67, v68
    v_fma_f32 v68, v66, v68, -v84
    v_fma_f32 v69, -v66, v69, -v85
    v_mul_f32 v82, v64, v45
    v_mul_f32 v83, v65, v45
    v_exp_f32 v82, v82
    v_fract_f32 v83, v83
    v_cos_f32 v70, v83
    v_sin_f32 v71, v83
    v_mul_f32 v70, v70, v82
    v_mul_f32 v71, v71, v82
    v_mul_f32 v84, v67, v71
    v_mul_f32 v85, v67, v70
    v_fma_f32 v70, v66, v70, -v84
    v_fma_f32 v71, -v66, v71, -v85
    v_mul_f32 v82, v64, v46
    v_mul_f32 v83, v65, v46
    v_exp_f32 v82, v82
    v_fract_f32 v83, v83
    v_cos_f32 v72, v83
    v_sin_f32 v73, v83
    v_mul_f32 v72, v72, v82
    v_mul_f32 v73, v73, v82
    v_mul_f32 v84, v67, v73
    v_mul_f32 v85, v67, v72
    v_fma_f32 v72, v66, v72, -v84
    v_fma_f32 v73, -v66, v73, -v85
    v_mfma_f32_16x16x4_f32 v[48:51], v68, v74, v[48:51]
    v_mfma_f32_16x16x4_f32 v[52:55], v70, v76, v[52:55]
    v_mfma_f32_16x16x4_f32 v[56:59], v70, v78, v[56:59]
    v_mfma_f32_16x16x4_f32 v[60:63], v72, v80, v[60:63]
    v_mfma_f32_16x16x4_f32 v[48:51], v69, v75, v[48:51]
    v_mfma_f32_16x16x4_f32 v[52:55], v71, v77, v[52:55]
    v_mfma_f32_16x16x4_f32 v[56:59], v71, v79, v[56:59]
    v_mfma_f32_16x16x4_f32 v[60:63], v73, v81, v[60:63]
    v_mov_b32_dpp v64, v24 row_newbcast:5 row_mask:0xf bank_mask:0xf
    v_mov_b32_dpp v65, v25 row_newbcast:5 row_mask:0xf bank_mask:0xf
    v_mov_b32_dpp v66, v26 row_newbcast:5 row_mask:0xf bank_mask:0xf
    v_mov_b32_dpp v67, v27 row_newbcast:5 row_mask:0xf bank_mask:0xf
    v_mul_f32 v82, v64, v47
    v_mul_f32 v83, v65, v47
    v_exp_f32 v82, v82
    v_fract_f32 v83, v83
    v_cos_f32 v74, v83
    v_sin_f32 v75, v83
    v_mul_f32 v74, v74, v82
    v_mul_f32 v75, v75, v82
    v_mul_f32 v84, v75, v75
    v_add_f32 v85, v74, v74
    v_fma_f32 v76, v74, v74, -v84
    v_mul_f32 v77, v85, v75
    v_mul_f32 v84, v77, v77
    v_add_f32 v85, v76, v76
    v_fma_f32 v78, v76, v76, -v84
    v_mul_f32 v79, v85, v77
    v_mul_f32 v84, v79, v79
    v_add_f32 v85, v78, v78
    v_fma_f32 v80, v78, v78, -v84
    v_mul_f32 v81, v85, v79
    v_mul_f32 v82, v64, v44
    v_mul_f32 v83, v65, v44
    v_exp_f32 v82, v82
    v_fract_f32 v83, v83
    v_cos_f32 v68, v83
    v_sin_f32 v69, v83
    v_mul_f32 v68, v68, v82
    v_mul_f32 v69, v69, v82
    v_mul_f32 v84, v67, v69
    v_mul_f32 v85, v67, v68
    v_fma_f32 v68, v66, v68, -v84
    v_fma_f32 v69, -v66, v69, -v85
    v_mul_f32 v82, v64, v45
    v_mul_f32 v83, v65, v45
    v_exp_f32 v82, v82
    v_fract_f32 v83, v83
    v_cos_f32 v70, v83
    v_sin_f32 v71, v83
    v_mul_f32 v70, v70, v82
    v_mul_f32 v71, v71, v82
    v_mul_f32 v84, v67, v71
    v_mul_f32 v85, v67, v70
    v_fma_f32 v70, v66, v70, -v84
    v_fma_f32 v71, -v66, v71, -v85
    v_mul_f32 v82, v64, v46
    v_mul_f32 v83, v65, v46
    v_exp_f32 v82, v82
    v_fract_f32 v83, v83
    v_cos_f32 v72, v83
    v_sin_f32 v73, v83
    v_mul_f32 v72, v72, v82
    v_mul_f32 v73, v73, v82
    v_mul_f32 v84, v67, v73
    v_mul_f32 v85, v67, v72
    v_fma_f32 v72, v66, v72, -v84
    v_fma_f32 v73, -v66, v73, -v85
    v_mfma_f32_16x16x4_f32 v[48:51], v68, v74, v[48:51]
    v_mfma_f32_16x16x4_f32 v[52:55], v70, v76, v[52:55]
    v_mfma_f32_16x16x4_f32 v[56:59], v70, v78, v[56:59]
    v_mfma_f32_16x16x4_f32 v[60:63], v72, v80, v[60:63]
    v_mfma_f32_16x16x4_f32 v[48:51], v69, v75, v[48:51]
    v_mfma_f32_16x16x4_f32 v[52:55], v71, v77, v[52:55]
    v_mfma_f32_16x16x4_f32 v[56:59], v71, v79, v[56:59]
    v_mfma_f32_16x16x4_f32 v[60:63], v73, v81, v[60:63]
    v_mov_b32_dpp v64, v24 row_newbcast:6 row_mask:0xf bank_mask:0xf
    v_mov_b32_dpp v65, v25 row_newbcast:6 row_mask:0xf bank_mask:0xf
    v_mov_b32_dpp v66, v26 row_newbcast:6 row_mask:0xf bank_mask:0xf
    v_mov_b32_dpp v67, v27 row_newbcast:6 row_mask:0xf bank_mask:0xf
    v_mul_f32 v82, v64, v47
    v_mul_f32 v83, v65, v47
    v_exp_f32 v82, v82
    v_fract_f32 v83, v83
    v_cos_f32 v74, v83
    v_sin_f32 v75, v83
    v_mul_f32 v74, v74, v82
    v_mul_f32 v75, v75, v82
    v_mul_f32 v84, v75, v75
    v_add_f32 v85, v74, v74
    v_fma_f32 v76, v74, v74, -v84
    v_mul_f32 v77, v85, v75
    v_mul_f32 v84, v77, v77
    v_add_f32 v85, v76, v76
    v_fma_f32 v78, v76, v76, -v84
    v_mul_f32 v79, v85, v77
    v_mul_f32 v84, v79, v79
    v_add_f32 v85, v78, v78
    v_fma_f32 v80, v78, v78, -v84
    v_mul_f32 v81, v85, v79
    v_mul_f32 v82, v64, v44
    v_mul_f32 v83, v65, v44
    v_exp_f32 v82, v82
    v_fract_f32 v83, v83
    v_cos_f32 v68, v83
    v_sin_f32 v69, v83
    v_mul_f32 v68, v68, v82
    v_mul_f32 v69, v69, v82
    v_mul_f32 v84, v67, v69
    v_mul_f32 v85, v67, v68
    v_fma_f32 v68, v66, v68, -v84
    v_fma_f32 v69, -v66, v69, -v85
    v_mul_f32 v82, v64, v45
    v_mul_f32 v83, v65, v45
    v_exp_f32 v82, v82
    v_fract_f32 v83, v83
    v_cos_f32 v70, v83
    v_sin_f32 v71, v83
    v_mul_f32 v70, v70, v82
    v_mul_f32 v71, v71, v82
    v_mul_f32 v84, v67, v71
    v_mul_f32 v85, v67, v70
    v_fma_f32 v70, v66, v70, -v84
    v_fma_f32 v71, -v66, v71, -v85
    v_mul_f32 v82, v64, v46
    v_mul_f32 v83, v65, v46
    v_exp_f32 v82, v82
    v_fract_f32 v83, v83
    v_cos_f32 v72, v83
    v_sin_f32 v73, v83
    v_mul_f32 v72, v72, v82
    v_mul_f32 v73, v73, v82
    v_mul_f32 v84, v67, v73
    v_mul_f32 v85, v67, v72
    v_fma_f32 v72, v66, v72, -v84
    v_fma_f32 v73, -v66, v73, -v85
    v_mfma_f32_16x16x4_f32 v[48:51], v68, v74, v[48:51]
    v_mfma_f32_16x16x4_f32 v[52:55], v70, v76, v[52:55]
    v_mfma_f32_16x16x4_f32 v[56:59], v70, v78, v[56:59]
    v_mfma_f32_16x16x4_f32 v[60:63], v72, v80, v[60:63]
    v_mfma_f32_16x16x4_f32 v[48:51], v69, v75, v[48:51]
    v_mfma_f32_16x16x4_f32 v[52:55], v71, v77, v[52:55]
    v_mfma_f32_16x16x4_f32 v[56:59], v71, v79, v[56:59]
    v_mfma_f32_16x16x4_f32 v[60:63], v73, v81, v[60:63]
    v_mov_b32_dpp v64, v24 row_newbcast:7 row_mask:0xf bank_mask:0xf
    v_mov_b32_dpp v65, v25 row_newbcast:7 row_mask:0xf bank_mask:0xf
    v_mov_b32_dpp v66, v26 row_newbcast:7 row_mask:0xf bank_mask:0xf
    v_mov_b32_dpp v67, v27 row_newbcast:7 row_mask:0xf bank_mask:0xf
    v_mul_f32 v82, v64, v47
    v_mul_f32 v83, v65, v47
    v_exp_f32 v82, v82
    v_fract_f32 v83, v83
    v_cos_f32 v74, v83
    v_sin_f32 v75, v83
    v_mul_f32 v74, v74, v82
    v_mul_f32 v75, v75, v82
    v_mul_f32 v84, v75, v75
    v_add_f32 v85, v74, v74
    v_fma_f32 v76, v74, v74, -v84
    v_mul_f32 v77, v85, v75
    v_mul_f32 v84, v77, v77
    v_add_f32 v85, v76, v76
    v_fma_f32 v78, v76, v76, -v84
    v_mul_f32 v79, v85, v77
    v_mul_f32 v84, v79, v79
    v_add_f32 v85, v78, v78
    v_fma_f32 v80, v78, v78, -v84
    v_mul_f32 v81, v85, v79
    v_mul_f32 v82, v64, v44
    v_mul_f32 v83, v65, v44
    v_exp_f32 v82, v82
    v_fract_f32 v83, v83
    v_cos_f32 v68, v83
    v_sin_f32 v69, v83
    v_mul_f32 v68, v68, v82
    v_mul_f32 v69, v69, v82
    v_mul_f32 v84, v67, v69
    v_mul_f32 v85, v67, v68
    v_fma_f32 v68, v66, v68, -v84
    v_fma_f32 v69, -v66, v69, -v85
    v_mul_f32 v82, v64, v45
    v_mul_f32 v83, v65, v45
    v_exp_f32 v82, v82
    v_fract_f32 v83, v83
    v_cos_f32 v70, v83
    v_sin_f32 v71, v83
    v_mul_f32 v70, v70, v82
    v_mul_f32 v71, v71, v82
    v_mul_f32 v84, v67, v71
    v_mul_f32 v85, v67, v70
    v_fma_f32 v70, v66, v70, -v84
    v_fma_f32 v71, -v66, v71, -v85
    v_mul_f32 v82, v64, v46
    v_mul_f32 v83, v65, v46
    v_exp_f32 v82, v82
    v_fract_f32 v83, v83
    v_cos_f32 v72, v83
    v_sin_f32 v73, v83
    v_mul_f32 v72, v72, v82
    v_mul_f32 v73, v73, v82
    v_mul_f32 v84, v67, v73
    v_mul_f32 v85, v67, v72
    v_fma_f32 v72, v66, v72, -v84
    v_fma_f32 v73, -v66, v73, -v85
    v_mfma_f32_16x16x4_f32 v[48:51], v68, v74, v[48:51]
    v_mfma_f32_16x16x4_f32 v[52:55], v70, v76, v[52:55]
    v_mfma_f32_16x16x4_f32 v[56:59], v70, v78, v[56:59]
    v_mfma_f32_16x16x4_f32 v[60:63], v72, v80, v[60:63]
    v_mfma_f32_16x16x4_f32 v[48:51], v69, v75, v[48:51]
    v_mfma_f32_16x16x4_f32 v[52:55], v71, v77, v[52:55]
    v_mfma_f32_16x16x4_f32 v[56:59], v71, v79, v[56:59]
    v_mfma_f32_16x16x4_f32 v[60:63], v73, v81, v[60:63]
    v_mov_b32_dpp v64, v24 row_newbcast:8 row_mask:0xf bank_mask:0xf
    v_mov_b32_dpp v65, v25 row_newbcast:8 row_mask:0xf bank_mask:0xf
    v_mov_b32_dpp v66, v26 row_newbcast:8 row_mask:0xf bank_mask:0xf
    v_mov_b32_dpp v67, v27 row_newbcast:8 row_mask:0xf bank_mask:0xf
    v_mul_f32 v82, v64, v47
    v_mul_f32 v83, v65, v47
    v_exp_f32 v82, v82
    v_fract_f32 v83, v83
    v_cos_f32 v74, v83
    v_sin_f32 v75, v83
    v_mul_f32 v74, v74, v82
    v_mul_f32 v75, v75, v82
    v_mul_f32 v84, v75, v75
    v_add_f32 v85, v74, v74
    v_fma_f32 v76, v74, v74, -v84
    v_mul_f32 v77, v85, v75
    v_mul_f32 v84, v77, v77
    v_add_f32 v85, v76, v76
    v_fma_f32 v78, v76, v76, -v84
    v_mul_f32 v79, v85, v77
    v_mul_f32 v84, v79, v79
    v_add_f32 v85, v78, v78
    v_fma_f32 v80, v78, v78, -v84
    v_mul_f32 v81, v85, v79
    v_mul_f32 v82, v64, v44
    v_mul_f32 v83, v65, v44
    v_exp_f32 v82, v82
    v_fract_f32 v83, v83
    v_cos_f32 v68, v83
    v_sin_f32 v69, v83
    v_mul_f32 v68, v68, v82
    v_mul_f32 v69, v69, v82
    v_mul_f32 v84, v67, v69
    v_mul_f32 v85, v67, v68
    v_fma_f32 v68, v66, v68, -v84
    v_fma_f32 v69, -v66, v69, -v85
    v_mul_f32 v82, v64, v45
    v_mul_f32 v83, v65, v45
    v_exp_f32 v82, v82
    v_fract_f32 v83, v83
    v_cos_f32 v70, v83
    v_sin_f32 v71, v83
    v_mul_f32 v70, v70, v82
    v_mul_f32 v71, v71, v82
    v_mul_f32 v84, v67, v71
    v_mul_f32 v85, v67, v70
    v_fma_f32 v70, v66, v70, -v84
    v_fma_f32 v71, -v66, v71, -v85
    v_mul_f32 v82, v64, v46
    v_mul_f32 v83, v65, v46
    v_exp_f32 v82, v82
    v_fract_f32 v83, v83
    v_cos_f32 v72, v83
    v_sin_f32 v73, v83
    v_mul_f32 v72, v72, v82
    v_mul_f32 v73, v73, v82
    v_mul_f32 v84, v67, v73
    v_mul_f32 v85, v67, v72
    v_fma_f32 v72, v66, v72, -v84
    v_fma_f32 v73, -v66, v73, -v85
    v_mfma_f32_16x16x4_f32 v[48:51], v68, v74, v[48:51]
    v_mfma_f32_16x16x4_f32 v[52:55], v70, v76, v[52:55]
    v_mfma_f32_16x16x4_f32 v[56:59], v70, v78, v[56:59]
    v_mfma_f32_16x16x4_f32 v[60:63], v72, v80, v[60:63]
    v_mfma_f32_16x16x4_f32 v[48:51], v69, v75, v[48:51]
    v_mfma_f32_16x16x4_f32 v[52:55], v71, v77, v[52:55]
    v_mfma_f32_16x16x4_f32 v[56:59], v71, v79, v[56:59]
    v_mfma_f32_16x16x4_f32 v[60:63], v73, v81, v[60:63]
    v_mov_b32_dpp v64, v24 row_newbcast:9 row_mask:0xf bank_mask:0xf
    v_mov_b32_dpp v65, v25 row_newbcast:9 row_mask:0xf bank_mask:0xf
    v_mov_b32_dpp v66, v26 row_newbcast:9 row_mask:0xf bank_mask:0xf
    v_mov_b32_dpp v67, v27 row_newbcast:9 row_mask:0xf bank_mask:0xf
    v_mul_f32 v82, v64, v47
    v_mul_f32 v83, v65, v47
    v_exp_f32 v82, v82
    v_fract_f32 v83, v83
    v_cos_f32 v74, v83
    v_sin_f32 v75, v83
    v_mul_f32 v74, v74, v82
    v_mul_f32 v75, v75, v82
    v_mul_f32 v84, v75, v75
    v_add_f32 v85, v74, v74
    v_fma_f32 v76, v74, v74, -v84
    v_mul_f32 v77, v85, v75
    v_mul_f32 v84, v77, v77
    v_add_f32 v85, v76, v76
    v_fma_f32 v78, v76, v76, -v84
    v_mul_f32 v79, v85, v77
    v_mul_f32 v84, v79, v79
    v_add_f32 v85, v78, v78
    v_fma_f32 v80, v78, v78, -v84
    v_mul_f32 v81, v85, v79
    v_mul_f32 v82, v64, v44
    v_mul_f32 v83, v65, v44
    v_exp_f32 v82, v82
    v_fract_f32 v83, v83
    v_cos_f32 v68, v83
    v_sin_f32 v69, v83
    v_mul_f32 v68, v68, v82
    v_mul_f32 v69, v69, v82
    v_mul_f32 v84, v67, v69
    v_mul_f32 v85, v67, v68
    v_fma_f32 v68, v66, v68, -v84
    v_fma_f32 v69, -v66, v69, -v85
    v_mul_f32 v82, v64, v45
    v_mul_f32 v83, v65, v45
    v_exp_f32 v82, v82
    v_fract_f32 v83, v83
    v_cos_f32 v70, v83
    v_sin_f32 v71, v83
    v_mul_f32 v70, v70, v82
    v_mul_f32 v71, v71, v82
    v_mul_f32 v84, v67, v71
    v_mul_f32 v85, v67, v70
    v_fma_f32 v70, v66, v70, -v84
    v_fma_f32 v71, -v66, v71, -v85
    v_mul_f32 v82, v64, v46
    v_mul_f32 v83, v65, v46
    v_exp_f32 v82, v82
    v_fract_f32 v83, v83
    v_cos_f32 v72, v83
    v_sin_f32 v73, v83
    v_mul_f32 v72, v72, v82
    v_mul_f32 v73, v73, v82
    v_mul_f32 v84, v67, v73
    v_mul_f32 v85, v67, v72
    v_fma_f32 v72, v66, v72, -v84
    v_fma_f32 v73, -v66, v73, -v85
    v_mfma_f32_16x16x4_f32 v[48:51], v68, v74, v[48:51]
    v_mfma_f32_16x16x4_f32 v[52:55], v70, v76, v[52:55]
    v_mfma_f32_16x16x4_f32 v[56:59], v70, v78, v[56:59]
    v_mfma_f32_16x16x4_f32 v[60:63], v72, v80, v[60:63]
    v_mfma_f32_16x16x4_f32 v[48:51], v69, v75, v[48:51]
    v_mfma_f32_16x16x4_f32 v[52:55], v71, v77, v[52:55]
    v_mfma_f32_16x16x4_f32 v[56:59], v71, v79, v[56:59]
    v_mfma_f32_16x16x4_f32 v[60:63], v73, v81, v[60:63]
    v_mov_b32_dpp v64, v24 row_newbcast:10 row_mask:0xf bank_mask:0xf
    v_mov_b32_dpp v65, v25 row_newbcast:10 row_mask:0xf bank_mask:0xf
    v_mov_b32_dpp v66, v26 row_newbcast:10 row_mask:0xf bank_mask:0xf
    v_mov_b32_dpp v67, v27 row_newbcast:10 row_mask:0xf bank_mask:0xf
    v_mul_f32 v82, v64, v47
    v_mul_f32 v83, v65, v47
    v_exp_f32 v82, v82
    v_fract_f32 v83, v83
    v_cos_f32 v74, v83
    v_sin_f32 v75, v83
    v_mul_f32 v74, v74, v82
    v_mul_f32 v75, v75, v82
    v_mul_f32 v84, v75, v75
    v_add_f32 v85, v74, v74
    v_fma_f32 v76, v74, v74, -v84
    v_mul_f32 v77, v85, v75
    v_mul_f32 v84, v77, v77
    v_add_f32 v85, v76, v76
    v_fma_f32 v78, v76, v76, -v84
    v_mul_f32 v79, v85, v77
    v_mul_f32 v84, v79, v79
    v_add_f32 v85, v78, v78
    v_fma_f32 v80, v78, v78, -v84
    v_mul_f32 v81, v85, v79
    v_mul_f32 v82, v64, v44
    v_mul_f32 v83, v65, v44
    v_exp_f32 v82, v82
    v_fract_f32 v83, v83
    v_cos_f32 v68, v83
    v_sin_f32 v69, v83
    v_mul_f32 v68, v68, v82
    v_mul_f32 v69, v69, v82
    v_mul_f32 v84, v67, v69
    v_mul_f32 v85, v67, v68
    v_fma_f32 v68, v66, v68, -v84
    v_fma_f32 v69, -v66, v69, -v85
    v_mul_f32 v82, v64, v45
    v_mul_f32 v83, v65, v45
    v_exp_f32 v82, v82
    v_fract_f32 v83, v83
    v_cos_f32 v70, v83
    v_sin_f32 v71, v83
    v_mul_f32 v70, v70, v82
    v_mul_f32 v71, v71, v82
    v_mul_f32 v84, v67, v71
    v_mul_f32 v85, v67, v70
    v_fma_f32 v70, v66, v70, -v84
    v_fma_f32 v71, -v66, v71, -v85
    v_mul_f32 v82, v64, v46
    v_mul_f32 v83, v65, v46
    v_exp_f32 v82, v82
    v_fract_f32 v83, v83
    v_cos_f32 v72, v83
    v_sin_f32 v73, v83
    v_mul_f32 v72, v72, v82
    v_mul_f32 v73, v73, v82
    v_mul_f32 v84, v67, v73
    v_mul_f32 v85, v67, v72
    v_fma_f32 v72, v66, v72, -v84
    v_fma_f32 v73, -v66, v73, -v85
    v_mfma_f32_16x16x4_f32 v[48:51], v68, v74, v[48:51]
    v_mfma_f32_16x16x4_f32 v[52:55], v70, v76, v[52:55]
    v_mfma_f32_16x16x4_f32 v[56:59], v70, v78, v[56:59]
    v_mfma_f32_16x16x4_f32 v[60:63], v72, v80, v[60:63]
    v_mfma_f32_16x16x4_f32 v[48:51], v69, v75, v[48:51]
    v_mfma_f32_16x16x4_f32 v[52:55], v71, v77, v[52:55]
    v_mfma_f32_16x16x4_f32 v[56:59], v71, v79, v[56:59]
    v_mfma_f32_16x16x4_f32 v[60:63], v73, v81, v[60:63]
    v_mov_b32_dpp v64, v24 row_newbcast:11 row_mask:0xf bank_mask:0xf
    v_mov_b32_dpp v65, v25 row_newbcast:11 row_mask:0xf bank_mask:0xf
    v_mov_b32_dpp v66, v26 row_newbcast:11 row_mask:0xf bank_mask:0xf
    v_mov_b32_dpp v67, v27 row_newbcast:11 row_mask:0xf bank_mask:0xf
    v_mul_f32 v82, v64, v47
    v_mul_f32 v83, v65, v47
    v_exp_f32 v82, v82
    v_fract_f32 v83, v83
    v_cos_f32 v74, v83
    v_sin_f32 v75, v83
    v_mul_f32 v74, v74, v82
    v_mul_f32 v75, v75, v82
    v_mul_f32 v84, v75, v75
    v_add_f32 v85, v74, v74
    v_fma_f32 v76, v74, v74, -v84
    v_mul_f32 v77, v85, v75
    v_mul_f32 v84, v77, v77
    v_add_f32 v85, v76, v76
    v_fma_f32 v78, v76, v76, -v84
    v_mul_f32 v79, v85, v77
    v_mul_f32 v84, v79, v79
    v_add_f32 v85, v78, v78
    v_fma_f32 v80, v78, v78, -v84
    v_mul_f32 v81, v85, v79
    v_mul_f32 v82, v64, v44
    v_mul_f32 v83, v65, v44
    v_exp_f32 v82, v82
    v_fract_f32 v83, v83
    v_cos_f32 v68, v83
    v_sin_f32 v69, v83
    v_mul_f32 v68, v68, v82
    v_mul_f32 v69, v69, v82
    v_mul_f32 v84, v67, v69
    v_mul_f32 v85, v67, v68
    v_fma_f32 v68, v66, v68, -v84
    v_fma_f32 v69, -v66, v69, -v85
    v_mul_f32 v82, v64, v45
    v_mul_f32 v83, v65, v45
    v_exp_f32 v82, v82
    v_fract_f32 v83, v83
    v_cos_f32 v70, v83
    v_sin_f32 v71, v83
    v_mul_f32 v70, v70, v82
    v_mul_f32 v71, v71, v82
    v_mul_f32 v84, v67, v71
    v_mul_f32 v85, v67, v70
    v_fma_f32 v70, v66, v70, -v84
    v_fma_f32 v71, -v66, v71, -v85
    v_mul_f32 v82, v64, v46
    v_mul_f32 v83, v65, v46
    v_exp_f32 v82, v82
    v_fract_f32 v83, v83
    v_cos_f32 v72, v83
    v_sin_f32 v73, v83
    v_mul_f32 v72, v72, v82
    v_mul_f32 v73, v73, v82
    v_mul_f32 v84, v67, v73
    v_mul_f32 v85, v67, v72
    v_fma_f32 v72, v66, v72, -v84
    v_fma_f32 v73, -v66, v73, -v85
    v_mfma_f32_16x16x4_f32 v[48:51], v68, v74, v[48:51]
    v_mfma_f32_16x16x4_f32 v[52:55], v70, v76, v[52:55]
    v_mfma_f32_16x16x4_f32 v[56:59], v70, v78, v[56:59]
    v_mfma_f32_16x16x4_f32 v[60:63], v72, v80, v[60:63]
    v_mfma_f32_16x16x4_f32 v[48:51], v69, v75, v[48:51]
    v_mfma_f32_16x16x4_f32 v[52:55], v71, v77, v[52:55]
    v_mfma_f32_16x16x4_f32 v[56:59], v71, v79, v[56:59]
    v_mfma_f32_16x16x4_f32 v[60:63], v73, v81, v[60:63]
    v_mov_b32_dpp v64, v24 row_newbcast:12 row_mask:0xf bank_mask:0xf
    v_mov_b32_dpp v65, v25 row_newbcast:12 row_mask:0xf bank_mask:0xf
    v_mov_b32_dpp v66, v26 row_newbcast:12 row_mask:0xf bank_mask:0xf
    v_mov_b32_dpp v67, v27 row_newbcast:12 row_mask:0xf bank_mask:0xf
    v_mul_f32 v82, v64, v47
    v_mul_f32 v83, v65, v47
    v_exp_f32 v82, v82
    v_fract_f32 v83, v83
    v_cos_f32 v74, v83
    v_sin_f32 v75, v83
    v_mul_f32 v74, v74, v82
    v_mul_f32 v75, v75, v82
    v_mul_f32 v84, v75, v75
    v_add_f32 v85, v74, v74
    v_fma_f32 v76, v74, v74, -v84
    v_mul_f32 v77, v85, v75
    v_mul_f32 v84, v77, v77
    v_add_f32 v85, v76, v76
    v_fma_f32 v78, v76, v76, -v84
    v_mul_f32 v79, v85, v77
    v_mul_f32 v84, v79, v79
    v_add_f32 v85, v78, v78
    v_fma_f32 v80, v78, v78, -v84
    v_mul_f32 v81, v85, v79
    v_mul_f32 v82, v64, v44
    v_mul_f32 v83, v65, v44
    v_exp_f32 v82, v82
    v_fract_f32 v83, v83
    v_cos_f32 v68, v83
    v_sin_f32 v69, v83
    v_mul_f32 v68, v68, v82
    v_mul_f32 v69, v69, v82
    v_mul_f32 v84, v67, v69
    v_mul_f32 v85, v67, v68
    v_fma_f32 v68, v66, v68, -v84
    v_fma_f32 v69, -v66, v69, -v85
    v_mul_f32 v82, v64, v45
    v_mul_f32 v83, v65, v45
    v_exp_f32 v82, v82
    v_fract_f32 v83, v83
    v_cos_f32 v70, v83
    v_sin_f32 v71, v83
    v_mul_f32 v70, v70, v82
    v_mul_f32 v71, v71, v82
    v_mul_f32 v84, v67, v71
    v_mul_f32 v85, v67, v70
    v_fma_f32 v70, v66, v70, -v84
    v_fma_f32 v71, -v66, v71, -v85
    v_mul_f32 v82, v64, v46
    v_mul_f32 v83, v65, v46
    v_exp_f32 v82, v82
    v_fract_f32 v83, v83
    v_cos_f32 v72, v83
    v_sin_f32 v73, v83
    v_mul_f32 v72, v72, v82
    v_mul_f32 v73, v73, v82
    v_mul_f32 v84, v67, v73
    v_mul_f32 v85, v67, v72
    v_fma_f32 v72, v66, v72, -v84
    v_fma_f32 v73, -v66, v73, -v85
    v_mfma_f32_16x16x4_f32 v[48:51], v68, v74, v[48:51]
    v_mfma_f32_16x16x4_f32 v[52:55], v70, v76, v[52:55]
    v_mfma_f32_16x16x4_f32 v[56:59], v70, v78, v[56:59]
    v_mfma_f32_16x16x4_f32 v[60:63], v72, v80, v[60:63]
    v_mfma_f32_16x16x4_f32 v[48:51], v69, v75, v[48:51]
    v_mfma_f32_16x16x4_f32 v[52:55], v71, v77, v[52:55]
    v_mfma_f32_16x16x4_f32 v[56:59], v71, v79, v[56:59]
    v_mfma_f32_16x16x4_f32 v[60:63], v73, v81, v[60:63]
    v_mov_b32_dpp v64, v24 row_newbcast:13 row_mask:0xf bank_mask:0xf
    v_mov_b32_dpp v65, v25 row_newbcast:13 row_mask:0xf bank_mask:0xf
    v_mov_b32_dpp v66, v26 row_newbcast:13 row_mask:0xf bank_mask:0xf
    v_mov_b32_dpp v67, v27 row_newbcast:13 row_mask:0xf bank_mask:0xf
    v_mul_f32 v82, v64, v47
    v_mul_f32 v83, v65, v47
    v_exp_f32 v82, v82
    v_fract_f32 v83, v83
    v_cos_f32 v74, v83
    v_sin_f32 v75, v83
    v_mul_f32 v74, v74, v82
    v_mul_f32 v75, v75, v82
    v_mul_f32 v84, v75, v75
    v_add_f32 v85, v74, v74
    v_fma_f32 v76, v74, v74, -v84
    v_mul_f32 v77, v85, v75
    v_mul_f32 v84, v77, v77
    v_add_f32 v85, v76, v76
    v_fma_f32 v78, v76, v76, -v84
    v_mul_f32 v79, v85, v77
    v_mul_f32 v84, v79, v79
    v_add_f32 v85, v78, v78
    v_fma_f32 v80, v78, v78, -v84
    v_mul_f32 v81, v85, v79
    v_mul_f32 v82, v64, v44
    v_mul_f32 v83, v65, v44
    v_exp_f32 v82, v82
    v_fract_f32 v83, v83
    v_cos_f32 v68, v83
    v_sin_f32 v69, v83
    v_mul_f32 v68, v68, v82
    v_mul_f32 v69, v69, v82
    v_mul_f32 v84, v67, v69
    v_mul_f32 v85, v67, v68
    v_fma_f32 v68, v66, v68, -v84
    v_fma_f32 v69, -v66, v69, -v85
    v_mul_f32 v82, v64, v45
    v_mul_f32 v83, v65, v45
    v_exp_f32 v82, v82
    v_fract_f32 v83, v83
    v_cos_f32 v70, v83
    v_sin_f32 v71, v83
    v_mul_f32 v70, v70, v82
    v_mul_f32 v71, v71, v82
    v_mul_f32 v84, v67, v71
    v_mul_f32 v85, v67, v70
    v_fma_f32 v70, v66, v70, -v84
    v_fma_f32 v71, -v66, v71, -v85
    v_mul_f32 v82, v64, v46
    v_mul_f32 v83, v65, v46
    v_exp_f32 v82, v82
    v_fract_f32 v83, v83
    v_cos_f32 v72, v83
    v_sin_f32 v73, v83
    v_mul_f32 v72, v72, v82
    v_mul_f32 v73, v73, v82
    v_mul_f32 v84, v67, v73
    v_mul_f32 v85, v67, v72
    v_fma_f32 v72, v66, v72, -v84
    v_fma_f32 v73, -v66, v73, -v85
    v_mfma_f32_16x16x4_f32 v[48:51], v68, v74, v[48:51]
    v_mfma_f32_16x16x4_f32 v[52:55], v70, v76, v[52:55]
    v_mfma_f32_16x16x4_f32 v[56:59], v70, v78, v[56:59]
    v_mfma_f32_16x16x4_f32 v[60:63], v72, v80, v[60:63]
    v_mfma_f32_16x16x4_f32 v[48:51], v69, v75, v[48:51]
    v_mfma_f32_16x16x4_f32 v[52:55], v71, v77, v[52:55]
    v_mfma_f32_16x16x4_f32 v[56:59], v71, v79, v[56:59]
    v_mfma_f32_16x16x4_f32 v[60:63], v73, v81, v[60:63]
    v_mov_b32_dpp v64, v24 row_newbcast:14 row_mask:0xf bank_mask:0xf
    v_mov_b32_dpp v65, v25 row_newbcast:14 row_mask:0xf bank_mask:0xf
    v_mov_b32_dpp v66, v26 row_newbcast:14 row_mask:0xf bank_mask:0xf
    v_mov_b32_dpp v67, v27 row_newbcast:14 row_mask:0xf bank_mask:0xf
    v_mul_f32 v82, v64, v47
    v_mul_f32 v83, v65, v47
    v_exp_f32 v82, v82
    v_fract_f32 v83, v83
    v_cos_f32 v74, v83
    v_sin_f32 v75, v83
    v_mul_f32 v74, v74, v82
    v_mul_f32 v75, v75, v82
    v_mul_f32 v84, v75, v75
    v_add_f32 v85, v74, v74
    v_fma_f32 v76, v74, v74, -v84
    v_mul_f32 v77, v85, v75
    v_mul_f32 v84, v77, v77
    v_add_f32 v85, v76, v76
    v_fma_f32 v78, v76, v76, -v84
    v_mul_f32 v79, v85, v77
    v_mul_f32 v84, v79, v79
    v_add_f32 v85, v78, v78
    v_fma_f32 v80, v78, v78, -v84
    v_mul_f32 v81, v85, v79
    v_mul_f32 v82, v64, v44
    v_mul_f32 v83, v65, v44
    v_exp_f32 v82, v82
    v_fract_f32 v83, v83
    v_cos_f32 v68, v83
    v_sin_f32 v69, v83
    v_mul_f32 v68, v68, v82
    v_mul_f32 v69, v69, v82
    v_mul_f32 v84, v67, v69
    v_mul_f32 v85, v67, v68
    v_fma_f32 v68, v66, v68, -v84
    v_fma_f32 v69, -v66, v69, -v85
    v_mul_f32 v82, v64, v45
    v_mul_f32 v83, v65, v45
    v_exp_f32 v82, v82
    v_fract_f32 v83, v83
    v_cos_f32 v70, v83
    v_sin_f32 v71, v83
    v_mul_f32 v70, v70, v82
    v_mul_f32 v71, v71, v82
    v_mul_f32 v84, v67, v71
    v_mul_f32 v85, v67, v70
    v_fma_f32 v70, v66, v70, -v84
    v_fma_f32 v71, -v66, v71, -v85
    v_mul_f32 v82, v64, v46
    v_mul_f32 v83, v65, v46
    v_exp_f32 v82, v82
    v_fract_f32 v83, v83
    v_cos_f32 v72, v83
    v_sin_f32 v73, v83
    v_mul_f32 v72, v72, v82
    v_mul_f32 v73, v73, v82
    v_mul_f32 v84, v67, v73
    v_mul_f32 v85, v67, v72
    v_fma_f32 v72, v66, v72, -v84
    v_fma_f32 v73, -v66, v73, -v85
    v_mfma_f32_16x16x4_f32 v[48:51], v68, v74, v[48:51]
    v_mfma_f32_16x16x4_f32 v[52:55], v70, v76, v[52:55]
    v_mfma_f32_16x16x4_f32 v[56:59], v70, v78, v[56:59]
    v_mfma_f32_16x16x4_f32 v[60:63], v72, v80, v[60:63]
    v_mfma_f32_16x16x4_f32 v[48:51], v69, v75, v[48:51]
    v_mfma_f32_16x16x4_f32 v[52:55], v71, v77, v[52:55]
    v_mfma_f32_16x16x4_f32 v[56:59], v71, v79, v[56:59]
    v_mfma_f32_16x16x4_f32 v[60:63], v73, v81, v[60:63]
    v_mov_b32_dpp v64, v24 row_newbcast:15 row_mask:0xf bank_mask:0xf
    v_mov_b32_dpp v65, v25 row_newbcast:15 row_mask:0xf bank_mask:0xf
    v_mov_b32_dpp v66, v26 row_newbcast:15 row_mask:0xf bank_mask:0xf
    v_mov_b32_dpp v67, v27 row_newbcast:15 row_mask:0xf bank_mask:0xf
    v_mul_f32 v82, v64, v47
    v_mul_f32 v83, v65, v47
    v_exp_f32 v82, v82
    v_fract_f32 v83, v83
    v_cos_f32 v74, v83
    v_sin_f32 v75, v83
    v_mul_f32 v74, v74, v82
    v_mul_f32 v75, v75, v82
    v_mul_f32 v84, v75, v75
    v_add_f32 v85, v74, v74
    v_fma_f32 v76, v74, v74, -v84
    v_mul_f32 v77, v85, v75
    v_mul_f32 v84, v77, v77
    v_add_f32 v85, v76, v76
    v_fma_f32 v78, v76, v76, -v84
    v_mul_f32 v79, v85, v77
    v_mul_f32 v84, v79, v79
    v_add_f32 v85, v78, v78
    v_fma_f32 v80, v78, v78, -v84
    v_mul_f32 v81, v85, v79
    v_mul_f32 v82, v64, v44
    v_mul_f32 v83, v65, v44
    v_exp_f32 v82, v82
    v_fract_f32 v83, v83
    v_cos_f32 v68, v83
    v_sin_f32 v69, v83
    v_mul_f32 v68, v68, v82
    v_mul_f32 v69, v69, v82
    v_mul_f32 v84, v67, v69
    v_mul_f32 v85, v67, v68
    v_fma_f32 v68, v66, v68, -v84
    v_fma_f32 v69, -v66, v69, -v85
    v_mul_f32 v82, v64, v45
    v_mul_f32 v83, v65, v45
    v_exp_f32 v82, v82
    v_fract_f32 v83, v83
    v_cos_f32 v70, v83
    v_sin_f32 v71, v83
    v_mul_f32 v70, v70, v82
    v_mul_f32 v71, v71, v82
    v_mul_f32 v84, v67, v71
    v_mul_f32 v85, v67, v70
    v_fma_f32 v70, v66, v70, -v84
    v_fma_f32 v71, -v66, v71, -v85
    v_mul_f32 v82, v64, v46
    v_mul_f32 v83, v65, v46
    v_exp_f32 v82, v82
    v_fract_f32 v83, v83
    v_cos_f32 v72, v83
    v_sin_f32 v73, v83
    v_mul_f32 v72, v72, v82
    v_mul_f32 v73, v73, v82
    v_mul_f32 v84, v67, v73
    v_mul_f32 v85, v67, v72
    v_fma_f32 v72, v66, v72, -v84
    v_fma_f32 v73, -v66, v73, -v85
    v_mfma_f32_16x16x4_f32 v[48:51], v68, v74, v[48:51]
    v_mfma_f32_16x16x4_f32 v[52:55], v70, v76, v[52:55]
    v_mfma_f32_16x16x4_f32 v[56:59], v70, v78, v[56:59]
    v_mfma_f32_16x16x4_f32 v[60:63], v72, v80, v[60:63]
    v_mfma_f32_16x16x4_f32 v[48:51], v69, v75, v[48:51]
    v_mfma_f32_16x16x4_f32 v[52:55], v71, v77, v[52:55]
    v_mfma_f32_16x16x4_f32 v[56:59], v71, v79, v[56:59]
    v_mfma_f32_16x16x4_f32 v[60:63], v73, v81, v[60:63]
    v_mov_b32_dpp v64, v28 row_newbcast:0 row_mask:0xf bank_mask:0xf
    v_mov_b32_dpp v65, v29 row_newbcast:0 row_mask:0xf bank_mask:0xf
    v_mov_b32_dpp v66, v30 row_newbcast:0 row_mask:0xf bank_mask:0xf
    v_mov_b32_dpp v67, v31 row_newbcast:0 row_mask:0xf bank_mask:0xf
    v_mul_f32 v82, v64, v47
    v_mul_f32 v83, v65, v47
    v_exp_f32 v82, v82
    v_fract_f32 v83, v83
    v_cos_f32 v74, v83
    v_sin_f32 v75, v83
    v_mul_f32 v74, v74, v82
    v_mul_f32 v75, v75, v82
    v_mul_f32 v84, v75, v75
    v_add_f32 v85, v74, v74
    v_fma_f32 v76, v74, v74, -v84
    v_mul_f32 v77, v85, v75
    v_mul_f32 v84, v77, v77
    v_add_f32 v85, v76, v76
    v_fma_f32 v78, v76, v76, -v84
    v_mul_f32 v79, v85, v77
    v_mul_f32 v84, v79, v79
    v_add_f32 v85, v78, v78
    v_fma_f32 v80, v78, v78, -v84
    v_mul_f32 v81, v85, v79
    v_mul_f32 v82, v64, v44
    v_mul_f32 v83, v65, v44
    v_exp_f32 v82, v82
    v_fract_f32 v83, v83
    v_cos_f32 v68, v83
    v_sin_f32 v69, v83
    v_mul_f32 v68, v68, v82
    v_mul_f32 v69, v69, v82
    v_mul_f32 v84, v67, v69
    v_mul_f32 v85, v67, v68
    v_fma_f32 v68, v66, v68, -v84
    v_fma_f32 v69, -v66, v69, -v85
    v_mul_f32 v82, v64, v45
    v_mul_f32 v83, v65, v45
    v_exp_f32 v82, v82
    v_fract_f32 v83, v83
    v_cos_f32 v70, v83
    v_sin_f32 v71, v83
    v_mul_f32 v70, v70, v82
    v_mul_f32 v71, v71, v82
    v_mul_f32 v84, v67, v71
    v_mul_f32 v85, v67, v70
    v_fma_f32 v70, v66, v70, -v84
    v_fma_f32 v71, -v66, v71, -v85
    v_mul_f32 v82, v64, v46
    v_mul_f32 v83, v65, v46
    v_exp_f32 v82, v82
    v_fract_f32 v83, v83
    v_cos_f32 v72, v83
    v_sin_f32 v73, v83
    v_mul_f32 v72, v72, v82
    v_mul_f32 v73, v73, v82
    v_mul_f32 v84, v67, v73
    v_mul_f32 v85, v67, v72
    v_fma_f32 v72, v66, v72, -v84
    v_fma_f32 v73, -v66, v73, -v85
    v_mfma_f32_16x16x4_f32 v[48:51], v68, v74, v[48:51]
    v_mfma_f32_16x16x4_f32 v[52:55], v70, v76, v[52:55]
    v_mfma_f32_16x16x4_f32 v[56:59], v70, v78, v[56:59]
    v_mfma_f32_16x16x4_f32 v[60:63], v72, v80, v[60:63]
    v_mfma_f32_16x16x4_f32 v[48:51], v69, v75, v[48:51]
    v_mfma_f32_16x16x4_f32 v[52:55], v71, v77, v[52:55]
    v_mfma_f32_16x16x4_f32 v[56:59], v71, v79, v[56:59]
    v_mfma_f32_16x16x4_f32 v[60:63], v73, v81, v[60:63]
    v_mov_b32_dpp v64, v28 row_newbcast:1 row_mask:0xf bank_mask:0xf
    v_mov_b32_dpp v65, v29 row_newbcast:1 row_mask:0xf bank_mask:0xf
    v_mov_b32_dpp v66, v30 row_newbcast:1 row_mask:0xf bank_mask:0xf
    v_mov_b32_dpp v67, v31 row_newbcast:1 row_mask:0xf bank_mask:0xf
    v_mul_f32 v82, v64, v47
    v_mul_f32 v83, v65, v47
    v_exp_f32 v82, v82
    v_fract_f32 v83, v83
    v_cos_f32 v74, v83
    v_sin_f32 v75, v83
    v_mul_f32 v74, v74, v82
    v_mul_f32 v75, v75, v82
    v_mul_f32 v84, v75, v75
    v_add_f32 v85, v74, v74
    v_fma_f32 v76, v74, v74, -v84
    v_mul_f32 v77, v85, v75
    v_mul_f32 v84, v77, v77
    v_add_f32 v85, v76, v76
    v_fma_f32 v78, v76, v76, -v84
    v_mul_f32 v79, v85, v77
    v_mul_f32 v84, v79, v79
    v_add_f32 v85, v78, v78
    v_fma_f32 v80, v78, v78, -v84
    v_mul_f32 v81, v85, v79
    v_mul_f32 v82, v64, v44
    v_mul_f32 v83, v65, v44
    v_exp_f32 v82, v82
    v_fract_f32 v83, v83
    v_cos_f32 v68, v83
    v_sin_f32 v69, v83
    v_mul_f32 v68, v68, v82
    v_mul_f32 v69, v69, v82
    v_mul_f32 v84, v67, v69
    v_mul_f32 v85, v67, v68
    v_fma_f32 v68, v66, v68, -v84
    v_fma_f32 v69, -v66, v69, -v85
    v_mul_f32 v82, v64, v45
    v_mul_f32 v83, v65, v45
    v_exp_f32 v82, v82
    v_fract_f32 v83, v83
    v_cos_f32 v70, v83
    v_sin_f32 v71, v83
    v_mul_f32 v70, v70, v82
    v_mul_f32 v71, v71, v82
    v_mul_f32 v84, v67, v71
    v_mul_f32 v85, v67, v70
    v_fma_f32 v70, v66, v70, -v84
    v_fma_f32 v71, -v66, v71, -v85
    v_mul_f32 v82, v64, v46
    v_mul_f32 v83, v65, v46
    v_exp_f32 v82, v82
    v_fract_f32 v83, v83
    v_cos_f32 v72, v83
    v_sin_f32 v73, v83
    v_mul_f32 v72, v72, v82
    v_mul_f32 v73, v73, v82
    v_mul_f32 v84, v67, v73
    v_mul_f32 v85, v67, v72
    v_fma_f32 v72, v66, v72, -v84
    v_fma_f32 v73, -v66, v73, -v85
    v_mfma_f32_16x16x4_f32 v[48:51], v68, v74, v[48:51]
    v_mfma_f32_16x16x4_f32 v[52:55], v70, v76, v[52:55]
    v_mfma_f32_16x16x4_f32 v[56:59], v70, v78, v[56:59]
    v_mfma_f32_16x16x4_f32 v[60:63], v72, v80, v[60:63]
    v_mfma_f32_16x16x4_f32 v[48:51], v69, v75, v[48:51]
    v_mfma_f32_16x16x4_f32 v[52:55], v71, v77, v[52:55]
    v_mfma_f32_16x16x4_f32 v[56:59], v71, v79, v[56:59]
    v_mfma_f32_16x16x4_f32 v[60:63], v73, v81, v[60:63]
    v_mov_b32_dpp v64, v28 row_newbcast:2 row_mask:0xf bank_mask:0xf
    v_mov_b32_dpp v65, v29 row_newbcast:2 row_mask:0xf bank_mask:0xf
    v_mov_b32_dpp v66, v30 row_newbcast:2 row_mask:0xf bank_mask:0xf
    v_mov_b32_dpp v67, v31 row_newbcast:2 row_mask:0xf bank_mask:0xf
    v_mul_f32 v82, v64, v47
    v_mul_f32 v83, v65, v47
    v_exp_f32 v82, v82
    v_fract_f32 v83, v83
    v_cos_f32 v74, v83
    v_sin_f32 v75, v83
    v_mul_f32 v74, v74, v82
    v_mul_f32 v75, v75, v82
    v_mul_f32 v84, v75, v75
    v_add_f32 v85, v74, v74
    v_fma_f32 v76, v74, v74, -v84
    v_mul_f32 v77, v85, v75
    v_mul_f32 v84, v77, v77
    v_add_f32 v85, v76, v76
    v_fma_f32 v78, v76, v76, -v84
    v_mul_f32 v79, v85, v77
    v_mul_f32 v84, v79, v79
    v_add_f32 v85, v78, v78
    v_fma_f32 v80, v78, v78, -v84
    v_mul_f32 v81, v85, v79
    v_mul_f32 v82, v64, v44
    v_mul_f32 v83, v65, v44
    v_exp_f32 v82, v82
    v_fract_f32 v83, v83
    v_cos_f32 v68, v83
    v_sin_f32 v69, v83
    v_mul_f32 v68, v68, v82
    v_mul_f32 v69, v69, v82
    v_mul_f32 v84, v67, v69
    v_mul_f32 v85, v67, v68
    v_fma_f32 v68, v66, v68, -v84
    v_fma_f32 v69, -v66, v69, -v85
    v_mul_f32 v82, v64, v45
    v_mul_f32 v83, v65, v45
    v_exp_f32 v82, v82
    v_fract_f32 v83, v83
    v_cos_f32 v70, v83
    v_sin_f32 v71, v83
    v_mul_f32 v70, v70, v82
    v_mul_f32 v71, v71, v82
    v_mul_f32 v84, v67, v71
    v_mul_f32 v85, v67, v70
    v_fma_f32 v70, v66, v70, -v84
    v_fma_f32 v71, -v66, v71, -v85
    v_mul_f32 v82, v64, v46
    v_mul_f32 v83, v65, v46
    v_exp_f32 v82, v82
    v_fract_f32 v83, v83
    v_cos_f32 v72, v83
    v_sin_f32 v73, v83
    v_mul_f32 v72, v72, v82
    v_mul_f32 v73, v73, v82
    v_mul_f32 v84, v67, v73
    v_mul_f32 v85, v67, v72
    v_fma_f32 v72, v66, v72, -v84
    v_fma_f32 v73, -v66, v73, -v85
    v_mfma_f32_16x16x4_f32 v[48:51], v68, v74, v[48:51]
    v_mfma_f32_16x16x4_f32 v[52:55], v70, v76, v[52:55]
    v_mfma_f32_16x16x4_f32 v[56:59], v70, v78, v[56:59]
    v_mfma_f32_16x16x4_f32 v[60:63], v72, v80, v[60:63]
    v_mfma_f32_16x16x4_f32 v[48:51], v69, v75, v[48:51]
    v_mfma_f32_16x16x4_f32 v[52:55], v71, v77, v[52:55]
    v_mfma_f32_16x16x4_f32 v[56:59], v71, v79, v[56:59]
    v_mfma_f32_16x16x4_f32 v[60:63], v73, v81, v[60:63]
    v_mov_b32_dpp v64, v28 row_newbcast:3 row_mask:0xf bank_mask:0xf
    v_mov_b32_dpp v65, v29 row_newbcast:3 row_mask:0xf bank_mask:0xf
    v_mov_b32_dpp v66, v30 row_newbcast:3 row_mask:0xf bank_mask:0xf
    v_mov_b32_dpp v67, v31 row_newbcast:3 row_mask:0xf bank_mask:0xf
    v_mul_f32 v82, v64, v47
    v_mul_f32 v83, v65, v47
    v_exp_f32 v82, v82
    v_fract_f32 v83, v83
    v_cos_f32 v74, v83
    v_sin_f32 v75, v83
    v_mul_f32 v74, v74, v82
    v_mul_f32 v75, v75, v82
    v_mul_f32 v84, v75, v75
    v_add_f32 v85, v74, v74
    v_fma_f32 v76, v74, v74, -v84
    v_mul_f32 v77, v85, v75
    v_mul_f32 v84, v77, v77
    v_add_f32 v85, v76, v76
    v_fma_f32 v78, v76, v76, -v84
    v_mul_f32 v79, v85, v77
    v_mul_f32 v84, v79, v79
    v_add_f32 v85, v78, v78
    v_fma_f32 v80, v78, v78, -v84
    v_mul_f32 v81, v85, v79
    v_mul_f32 v82, v64, v44
    v_mul_f32 v83, v65, v44
    v_exp_f32 v82, v82
    v_fract_f32 v83, v83
    v_cos_f32 v68, v83
    v_sin_f32 v69, v83
    v_mul_f32 v68, v68, v82
    v_mul_f32 v69, v69, v82
    v_mul_f32 v84, v67, v69
    v_mul_f32 v85, v67, v68
    v_fma_f32 v68, v66, v68, -v84
    v_fma_f32 v69, -v66, v69, -v85
    v_mul_f32 v82, v64, v45
    v_mul_f32 v83, v65, v45
    v_exp_f32 v82, v82
    v_fract_f32 v83, v83
    v_cos_f32 v70, v83
    v_sin_f32 v71, v83
    v_mul_f32 v70, v70, v82
    v_mul_f32 v71, v71, v82
    v_mul_f32 v84, v67, v71
    v_mul_f32 v85, v67, v70
    v_fma_f32 v70, v66, v70, -v84
    v_fma_f32 v71, -v66, v71, -v85
    v_mul_f32 v82, v64, v46
    v_mul_f32 v83, v65, v46
    v_exp_f32 v82, v82
    v_fract_f32 v83, v83
    v_cos_f32 v72, v83
    v_sin_f32 v73, v83
    v_mul_f32 v72, v72, v82
    v_mul_f32 v73, v73, v82
    v_mul_f32 v84, v67, v73
    v_mul_f32 v85, v67, v72
    v_fma_f32 v72, v66, v72, -v84
    v_fma_f32 v73, -v66, v73, -v85
    v_mfma_f32_16x16x4_f32 v[48:51], v68, v74, v[48:51]
    v_mfma_f32_16x16x4_f32 v[52:55], v70, v76, v[52:55]
    v_mfma_f32_16x16x4_f32 v[56:59], v70, v78, v[56:59]
    v_mfma_f32_16x16x4_f32 v[60:63], v72, v80, v[60:63]
    v_mfma_f32_16x16x4_f32 v[48:51], v69, v75, v[48:51]
    v_mfma_f32_16x16x4_f32 v[52:55], v71, v77, v[52:55]
    v_mfma_f32_16x16x4_f32 v[56:59], v71, v79, v[56:59]
    v_mfma_f32_16x16x4_f32 v[60:63], v73, v81, v[60:63]
    v_mov_b32_dpp v64, v28 row_newbcast:4 row_mask:0xf bank_mask:0xf
    v_mov_b32_dpp v65, v29 row_newbcast:4 row_mask:0xf bank_mask:0xf
    v_mov_b32_dpp v66, v30 row_newbcast:4 row_mask:0xf bank_mask:0xf
    v_mov_b32_dpp v67, v31 row_newbcast:4 row_mask:0xf bank_mask:0xf
    v_mul_f32 v82, v64, v47
    v_mul_f32 v83, v65, v47
    v_exp_f32 v82, v82
    v_fract_f32 v83, v83
    v_cos_f32 v74, v83
    v_sin_f32 v75, v83
    v_mul_f32 v74, v74, v82
    v_mul_f32 v75, v75, v82
    v_mul_f32 v84, v75, v75
    v_add_f32 v85, v74, v74
    v_fma_f32 v76, v74, v74, -v84
    v_mul_f32 v77, v85, v75
    v_mul_f32 v84, v77, v77
    v_add_f32 v85, v76, v76
    v_fma_f32 v78, v76, v76, -v84
    v_mul_f32 v79, v85, v77
    v_mul_f32 v84, v79, v79
    v_add_f32 v85, v78, v78
    v_fma_f32 v80, v78, v78, -v84
    v_mul_f32 v81, v85, v79
    v_mul_f32 v82, v64, v44
    v_mul_f32 v83, v65, v44
    v_exp_f32 v82, v82
    v_fract_f32 v83, v83
    v_cos_f32 v68, v83
    v_sin_f32 v69, v83
    v_mul_f32 v68, v68, v82
    v_mul_f32 v69, v69, v82
    v_mul_f32 v84, v67, v69
    v_mul_f32 v85, v67, v68
    v_fma_f32 v68, v66, v68, -v84
    v_fma_f32 v69, -v66, v69, -v85
    v_mul_f32 v82, v64, v45
    v_mul_f32 v83, v65, v45
    v_exp_f32 v82, v82
    v_fract_f32 v83, v83
    v_cos_f32 v70, v83
    v_sin_f32 v71, v83
    v_mul_f32 v70, v70, v82
    v_mul_f32 v71, v71, v82
    v_mul_f32 v84, v67, v71
    v_mul_f32 v85, v67, v70
    v_fma_f32 v70, v66, v70, -v84
    v_fma_f32 v71, -v66, v71, -v85
    v_mul_f32 v82, v64, v46
    v_mul_f32 v83, v65, v46
    v_exp_f32 v82, v82
    v_fract_f32 v83, v83
    v_cos_f32 v72, v83
    v_sin_f32 v73, v83
    v_mul_f32 v72, v72, v82
    v_mul_f32 v73, v73, v82
    v_mul_f32 v84, v67, v73
    v_mul_f32 v85, v67, v72
    v_fma_f32 v72, v66, v72, -v84
    v_fma_f32 v73, -v66, v73, -v85
    v_mfma_f32_16x16x4_f32 v[48:51], v68, v74, v[48:51]
    v_mfma_f32_16x16x4_f32 v[52:55], v70, v76, v[52:55]
    v_mfma_f32_16x16x4_f32 v[56:59], v70, v78, v[56:59]
    v_mfma_f32_16x16x4_f32 v[60:63], v72, v80, v[60:63]
    v_mfma_f32_16x16x4_f32 v[48:51], v69, v75, v[48:51]
    v_mfma_f32_16x16x4_f32 v[52:55], v71, v77, v[52:55]
    v_mfma_f32_16x16x4_f32 v[56:59], v71, v79, v[56:59]
    v_mfma_f32_16x16x4_f32 v[60:63], v73, v81, v[60:63]
    v_mov_b32_dpp v64, v28 row_newbcast:5 row_mask:0xf bank_mask:0xf
    v_mov_b32_dpp v65, v29 row_newbcast:5 row_mask:0xf bank_mask:0xf
    v_mov_b32_dpp v66, v30 row_newbcast:5 row_mask:0xf bank_mask:0xf
    v_mov_b32_dpp v67, v31 row_newbcast:5 row_mask:0xf bank_mask:0xf
    v_mul_f32 v82, v64, v47
    v_mul_f32 v83, v65, v47
    v_exp_f32 v82, v82
    v_fract_f32 v83, v83
    v_cos_f32 v74, v83
    v_sin_f32 v75, v83
    v_mul_f32 v74, v74, v82
    v_mul_f32 v75, v75, v82
    v_mul_f32 v84, v75, v75
    v_add_f32 v85, v74, v74
    v_fma_f32 v76, v74, v74, -v84
    v_mul_f32 v77, v85, v75
    v_mul_f32 v84, v77, v77
    v_add_f32 v85, v76, v76
    v_fma_f32 v78, v76, v76, -v84
    v_mul_f32 v79, v85, v77
    v_mul_f32 v84, v79, v79
    v_add_f32 v85, v78, v78
    v_fma_f32 v80, v78, v78, -v84
    v_mul_f32 v81, v85, v79
    v_mul_f32 v82, v64, v44
    v_mul_f32 v83, v65, v44
    v_exp_f32 v82, v82
    v_fract_f32 v83, v83
    v_cos_f32 v68, v83
    v_sin_f32 v69, v83
    v_mul_f32 v68, v68, v82
    v_mul_f32 v69, v69, v82
    v_mul_f32 v84, v67, v69
    v_mul_f32 v85, v67, v68
    v_fma_f32 v68, v66, v68, -v84
    v_fma_f32 v69, -v66, v69, -v85
    v_mul_f32 v82, v64, v45
    v_mul_f32 v83, v65, v45
    v_exp_f32 v82, v82
    v_fract_f32 v83, v83
    v_cos_f32 v70, v83
    v_sin_f32 v71, v83
    v_mul_f32 v70, v70, v82
    v_mul_f32 v71, v71, v82
    v_mul_f32 v84, v67, v71
    v_mul_f32 v85, v67, v70
    v_fma_f32 v70, v66, v70, -v84
    v_fma_f32 v71, -v66, v71, -v85
    v_mul_f32 v82, v64, v46
    v_mul_f32 v83, v65, v46
    v_exp_f32 v82, v82
    v_fract_f32 v83, v83
    v_cos_f32 v72, v83
    v_sin_f32 v73, v83
    v_mul_f32 v72, v72, v82
    v_mul_f32 v73, v73, v82
    v_mul_f32 v84, v67, v73
    v_mul_f32 v85, v67, v72
    v_fma_f32 v72, v66, v72, -v84
    v_fma_f32 v73, -v66, v73, -v85
    v_mfma_f32_16x16x4_f32 v[48:51], v68, v74, v[48:51]
    v_mfma_f32_16x16x4_f32 v[52:55], v70, v76, v[52:55]
    v_mfma_f32_16x16x4_f32 v[56:59], v70, v78, v[56:59]
    v_mfma_f32_16x16x4_f32 v[60:63], v72, v80, v[60:63]
    v_mfma_f32_16x16x4_f32 v[48:51], v69, v75, v[48:51]
    v_mfma_f32_16x16x4_f32 v[52:55], v71, v77, v[52:55]
    v_mfma_f32_16x16x4_f32 v[56:59], v71, v79, v[56:59]
    v_mfma_f32_16x16x4_f32 v[60:63], v73, v81, v[60:63]
    v_mov_b32_dpp v64, v28 row_newbcast:6 row_mask:0xf bank_mask:0xf
    v_mov_b32_dpp v65, v29 row_newbcast:6 row_mask:0xf bank_mask:0xf
    v_mov_b32_dpp v66, v30 row_newbcast:6 row_mask:0xf bank_mask:0xf
    v_mov_b32_dpp v67, v31 row_newbcast:6 row_mask:0xf bank_mask:0xf
    v_mul_f32 v82, v64, v47
    v_mul_f32 v83, v65, v47
    v_exp_f32 v82, v82
    v_fract_f32 v83, v83
    v_cos_f32 v74, v83
    v_sin_f32 v75, v83
    v_mul_f32 v74, v74, v82
    v_mul_f32 v75, v75, v82
    v_mul_f32 v84, v75, v75
    v_add_f32 v85, v74, v74
    v_fma_f32 v76, v74, v74, -v84
    v_mul_f32 v77, v85, v75
    v_mul_f32 v84, v77, v77
    v_add_f32 v85, v76, v76
    v_fma_f32 v78, v76, v76, -v84
    v_mul_f32 v79, v85, v77
    v_mul_f32 v84, v79, v79
    v_add_f32 v85, v78, v78
    v_fma_f32 v80, v78, v78, -v84
    v_mul_f32 v81, v85, v79
    v_mul_f32 v82, v64, v44
    v_mul_f32 v83, v65, v44
    v_exp_f32 v82, v82
    v_fract_f32 v83, v83
    v_cos_f32 v68, v83
    v_sin_f32 v69, v83
    v_mul_f32 v68, v68, v82
    v_mul_f32 v69, v69, v82
    v_mul_f32 v84, v67, v69
    v_mul_f32 v85, v67, v68
    v_fma_f32 v68, v66, v68, -v84
    v_fma_f32 v69, -v66, v69, -v85
    v_mul_f32 v82, v64, v45
    v_mul_f32 v83, v65, v45
    v_exp_f32 v82, v82
    v_fract_f32 v83, v83
    v_cos_f32 v70, v83
    v_sin_f32 v71, v83
    v_mul_f32 v70, v70, v82
    v_mul_f32 v71, v71, v82
    v_mul_f32 v84, v67, v71
    v_mul_f32 v85, v67, v70
    v_fma_f32 v70, v66, v70, -v84
    v_fma_f32 v71, -v66, v71, -v85
    v_mul_f32 v82, v64, v46
    v_mul_f32 v83, v65, v46
    v_exp_f32 v82, v82
    v_fract_f32 v83, v83
    v_cos_f32 v72, v83
    v_sin_f32 v73, v83
    v_mul_f32 v72, v72, v82
    v_mul_f32 v73, v73, v82
    v_mul_f32 v84, v67, v73
    v_mul_f32 v85, v67, v72
    v_fma_f32 v72, v66, v72, -v84
    v_fma_f32 v73, -v66, v73, -v85
    v_mfma_f32_16x16x4_f32 v[48:51], v68, v74, v[48:51]
    v_mfma_f32_16x16x4_f32 v[52:55], v70, v76, v[52:55]
    v_mfma_f32_16x16x4_f32 v[56:59], v70, v78, v[56:59]
    v_mfma_f32_16x16x4_f32 v[60:63], v72, v80, v[60:63]
    v_mfma_f32_16x16x4_f32 v[48:51], v69, v75, v[48:51]
    v_mfma_f32_16x16x4_f32 v[52:55], v71, v77, v[52:55]
    v_mfma_f32_16x16x4_f32 v[56:59], v71, v79, v[56:59]
    v_mfma_f32_16x16x4_f32 v[60:63], v73, v81, v[60:63]
    v_mov_b32_dpp v64, v28 row_newbcast:7 row_mask:0xf bank_mask:0xf
    v_mov_b32_dpp v65, v29 row_newbcast:7 row_mask:0xf bank_mask:0xf
    v_mov_b32_dpp v66, v30 row_newbcast:7 row_mask:0xf bank_mask:0xf
    v_mov_b32_dpp v67, v31 row_newbcast:7 row_mask:0xf bank_mask:0xf
    v_mul_f32 v82, v64, v47
    v_mul_f32 v83, v65, v47
    v_exp_f32 v82, v82
    v_fract_f32 v83, v83
    v_cos_f32 v74, v83
    v_sin_f32 v75, v83
    v_mul_f32 v74, v74, v82
    v_mul_f32 v75, v75, v82
    v_mul_f32 v84, v75, v75
    v_add_f32 v85, v74, v74
    v_fma_f32 v76, v74, v74, -v84
    v_mul_f32 v77, v85, v75
    v_mul_f32 v84, v77, v77
    v_add_f32 v85, v76, v76
    v_fma_f32 v78, v76, v76, -v84
    v_mul_f32 v79, v85, v77
    v_mul_f32 v84, v79, v79
    v_add_f32 v85, v78, v78
    v_fma_f32 v80, v78, v78, -v84
    v_mul_f32 v81, v85, v79
    v_mul_f32 v82, v64, v44
    v_mul_f32 v83, v65, v44
    v_exp_f32 v82, v82
    v_fract_f32 v83, v83
    v_cos_f32 v68, v83
    v_sin_f32 v69, v83
    v_mul_f32 v68, v68, v82
    v_mul_f32 v69, v69, v82
    v_mul_f32 v84, v67, v69
    v_mul_f32 v85, v67, v68
    v_fma_f32 v68, v66, v68, -v84
    v_fma_f32 v69, -v66, v69, -v85
    v_mul_f32 v82, v64, v45
    v_mul_f32 v83, v65, v45
    v_exp_f32 v82, v82
    v_fract_f32 v83, v83
    v_cos_f32 v70, v83
    v_sin_f32 v71, v83
    v_mul_f32 v70, v70, v82
    v_mul_f32 v71, v71, v82
    v_mul_f32 v84, v67, v71
    v_mul_f32 v85, v67, v70
    v_fma_f32 v70, v66, v70, -v84
    v_fma_f32 v71, -v66, v71, -v85
    v_mul_f32 v82, v64, v46
    v_mul_f32 v83, v65, v46
    v_exp_f32 v82, v82
    v_fract_f32 v83, v83
    v_cos_f32 v72, v83
    v_sin_f32 v73, v83
    v_mul_f32 v72, v72, v82
    v_mul_f32 v73, v73, v82
    v_mul_f32 v84, v67, v73
    v_mul_f32 v85, v67, v72
    v_fma_f32 v72, v66, v72, -v84
    v_fma_f32 v73, -v66, v73, -v85
    v_mfma_f32_16x16x4_f32 v[48:51], v68, v74, v[48:51]
    v_mfma_f32_16x16x4_f32 v[52:55], v70, v76, v[52:55]
    v_mfma_f32_16x16x4_f32 v[56:59], v70, v78, v[56:59]
    v_mfma_f32_16x16x4_f32 v[60:63], v72, v80, v[60:63]
    v_mfma_f32_16x16x4_f32 v[48:51], v69, v75, v[48:51]
    v_mfma_f32_16x16x4_f32 v[52:55], v71, v77, v[52:55]
    v_mfma_f32_16x16x4_f32 v[56:59], v71, v79, v[56:59]
    v_mfma_f32_16x16x4_f32 v[60:63], v73, v81, v[60:63]
    v_mov_b32_dpp v64, v28 row_newbcast:8 row_mask:0xf bank_mask:0xf
    v_mov_b32_dpp v65, v29 row_newbcast:8 row_mask:0xf bank_mask:0xf
    v_mov_b32_dpp v66, v30 row_newbcast:8 row_mask:0xf bank_mask:0xf
    v_mov_b32_dpp v67, v31 row_newbcast:8 row_mask:0xf bank_mask:0xf
    v_mul_f32 v82, v64, v47
    v_mul_f32 v83, v65, v47
    v_exp_f32 v82, v82
    v_fract_f32 v83, v83
    v_cos_f32 v74, v83
    v_sin_f32 v75, v83
    v_mul_f32 v74, v74, v82
    v_mul_f32 v75, v75, v82
    v_mul_f32 v84, v75, v75
    v_add_f32 v85, v74, v74
    v_fma_f32 v76, v74, v74, -v84
    v_mul_f32 v77, v85, v75
    v_mul_f32 v84, v77, v77
    v_add_f32 v85, v76, v76
    v_fma_f32 v78, v76, v76, -v84
    v_mul_f32 v79, v85, v77
    v_mul_f32 v84, v79, v79
    v_add_f32 v85, v78, v78
    v_fma_f32 v80, v78, v78, -v84
    v_mul_f32 v81, v85, v79
    v_mul_f32 v82, v64, v44
    v_mul_f32 v83, v65, v44
    v_exp_f32 v82, v82
    v_fract_f32 v83, v83
    v_cos_f32 v68, v83
    v_sin_f32 v69, v83
    v_mul_f32 v68, v68, v82
    v_mul_f32 v69, v69, v82
    v_mul_f32 v84, v67, v69
    v_mul_f32 v85, v67, v68
    v_fma_f32 v68, v66, v68, -v84
    v_fma_f32 v69, -v66, v69, -v85
    v_mul_f32 v82, v64, v45
    v_mul_f32 v83, v65, v45
    v_exp_f32 v82, v82
    v_fract_f32 v83, v83
    v_cos_f32 v70, v83
    v_sin_f32 v71, v83
    v_mul_f32 v70, v70, v82
    v_mul_f32 v71, v71, v82
    v_mul_f32 v84, v67, v71
    v_mul_f32 v85, v67, v70
    v_fma_f32 v70, v66, v70, -v84
    v_fma_f32 v71, -v66, v71, -v85
    v_mul_f32 v82, v64, v46
    v_mul_f32 v83, v65, v46
    v_exp_f32 v82, v82
    v_fract_f32 v83, v83
    v_cos_f32 v72, v83
    v_sin_f32 v73, v83
    v_mul_f32 v72, v72, v82
    v_mul_f32 v73, v73, v82
    v_mul_f32 v84, v67, v73
    v_mul_f32 v85, v67, v72
    v_fma_f32 v72, v66, v72, -v84
    v_fma_f32 v73, -v66, v73, -v85
    v_mfma_f32_16x16x4_f32 v[48:51], v68, v74, v[48:51]
    v_mfma_f32_16x16x4_f32 v[52:55], v70, v76, v[52:55]
    v_mfma_f32_16x16x4_f32 v[56:59], v70, v78, v[56:59]
    v_mfma_f32_16x16x4_f32 v[60:63], v72, v80, v[60:63]
    v_mfma_f32_16x16x4_f32 v[48:51], v69, v75, v[48:51]
    v_mfma_f32_16x16x4_f32 v[52:55], v71, v77, v[52:55]
    v_mfma_f32_16x16x4_f32 v[56:59], v71, v79, v[56:59]
    v_mfma_f32_16x16x4_f32 v[60:63], v73, v81, v[60:63]
    v_mov_b32_dpp v64, v28 row_newbcast:9 row_mask:0xf bank_mask:0xf
    v_mov_b32_dpp v65, v29 row_newbcast:9 row_mask:0xf bank_mask:0xf
    v_mov_b32_dpp v66, v30 row_newbcast:9 row_mask:0xf bank_mask:0xf
    v_mov_b32_dpp v67, v31 row_newbcast:9 row_mask:0xf bank_mask:0xf
    v_mul_f32 v82, v64, v47
    v_mul_f32 v83, v65, v47
    v_exp_f32 v82, v82
    v_fract_f32 v83, v83
    v_cos_f32 v74, v83
    v_sin_f32 v75, v83
    v_mul_f32 v74, v74, v82
    v_mul_f32 v75, v75, v82
    v_mul_f32 v84, v75, v75
    v_add_f32 v85, v74, v74
    v_fma_f32 v76, v74, v74, -v84
    v_mul_f32 v77, v85, v75
    v_mul_f32 v84, v77, v77
    v_add_f32 v85, v76, v76
    v_fma_f32 v78, v76, v76, -v84
    v_mul_f32 v79, v85, v77
    v_mul_f32 v84, v79, v79
    v_add_f32 v85, v78, v78
    v_fma_f32 v80, v78, v78, -v84
    v_mul_f32 v81, v85, v79
    v_mul_f32 v82, v64, v44
    v_mul_f32 v83, v65, v44
    v_exp_f32 v82, v82
    v_fract_f32 v83, v83
    v_cos_f32 v68, v83
    v_sin_f32 v69, v83
    v_mul_f32 v68, v68, v82
    v_mul_f32 v69, v69, v82
    v_mul_f32 v84, v67, v69
    v_mul_f32 v85, v67, v68
    v_fma_f32 v68, v66, v68, -v84
    v_fma_f32 v69, -v66, v69, -v85
    v_mul_f32 v82, v64, v45
    v_mul_f32 v83, v65, v45
    v_exp_f32 v82, v82
    v_fract_f32 v83, v83
    v_cos_f32 v70, v83
    v_sin_f32 v71, v83
    v_mul_f32 v70, v70, v82
    v_mul_f32 v71, v71, v82
    v_mul_f32 v84, v67, v71
    v_mul_f32 v85, v67, v70
    v_fma_f32 v70, v66, v70, -v84
    v_fma_f32 v71, -v66, v71, -v85
    v_mul_f32 v82, v64, v46
    v_mul_f32 v83, v65, v46
    v_exp_f32 v82, v82
    v_fract_f32 v83, v83
    v_cos_f32 v72, v83
    v_sin_f32 v73, v83
    v_mul_f32 v72, v72, v82
    v_mul_f32 v73, v73, v82
    v_mul_f32 v84, v67, v73
    v_mul_f32 v85, v67, v72
    v_fma_f32 v72, v66, v72, -v84
    v_fma_f32 v73, -v66, v73, -v85
    v_mfma_f32_16x16x4_f32 v[48:51], v68, v74, v[48:51]
    v_mfma_f32_16x16x4_f32 v[52:55], v70, v76, v[52:55]
    v_mfma_f32_16x16x4_f32 v[56:59], v70, v78, v[56:59]
    v_mfma_f32_16x16x4_f32 v[60:63], v72, v80, v[60:63]
    v_mfma_f32_16x16x4_f32 v[48:51], v69, v75, v[48:51]
    v_mfma_f32_16x16x4_f32 v[52:55], v71, v77, v[52:55]
    v_mfma_f32_16x16x4_f32 v[56:59], v71, v79, v[56:59]
    v_mfma_f32_16x16x4_f32 v[60:63], v73, v81, v[60:63]
    v_mov_b32_dpp v64, v28 row_newbcast:10 row_mask:0xf bank_mask:0xf
    v_mov_b32_dpp v65, v29 row_newbcast:10 row_mask:0xf bank_mask:0xf
    v_mov_b32_dpp v66, v30 row_newbcast:10 row_mask:0xf bank_mask:0xf
    v_mov_b32_dpp v67, v31 row_newbcast:10 row_mask:0xf bank_mask:0xf
    v_mul_f32 v82, v64, v47
    v_mul_f32 v83, v65, v47
    v_exp_f32 v82, v82
    v_fract_f32 v83, v83
    v_cos_f32 v74, v83
    v_sin_f32 v75, v83
    v_mul_f32 v74, v74, v82
    v_mul_f32 v75, v75, v82
    v_mul_f32 v84, v75, v75
    v_add_f32 v85, v74, v74
    v_fma_f32 v76, v74, v74, -v84
    v_mul_f32 v77, v85, v75
    v_mul_f32 v84, v77, v77
    v_add_f32 v85, v76, v76
    v_fma_f32 v78, v76, v76, -v84
    v_mul_f32 v79, v85, v77
    v_mul_f32 v84, v79, v79
    v_add_f32 v85, v78, v78
    v_fma_f32 v80, v78, v78, -v84
    v_mul_f32 v81, v85, v79
    v_mul_f32 v82, v64, v44
    v_mul_f32 v83, v65, v44
    v_exp_f32 v82, v82
    v_fract_f32 v83, v83
    v_cos_f32 v68, v83
    v_sin_f32 v69, v83
    v_mul_f32 v68, v68, v82
    v_mul_f32 v69, v69, v82
    v_mul_f32 v84, v67, v69
    v_mul_f32 v85, v67, v68
    v_fma_f32 v68, v66, v68, -v84
    v_fma_f32 v69, -v66, v69, -v85
    v_mul_f32 v82, v64, v45
    v_mul_f32 v83, v65, v45
    v_exp_f32 v82, v82
    v_fract_f32 v83, v83
    v_cos_f32 v70, v83
    v_sin_f32 v71, v83
    v_mul_f32 v70, v70, v82
    v_mul_f32 v71, v71, v82
    v_mul_f32 v84, v67, v71
    v_mul_f32 v85, v67, v70
    v_fma_f32 v70, v66, v70, -v84
    v_fma_f32 v71, -v66, v71, -v85
    v_mul_f32 v82, v64, v46
    v_mul_f32 v83, v65, v46
    v_exp_f32 v82, v82
    v_fract_f32 v83, v83
    v_cos_f32 v72, v83
    v_sin_f32 v73, v83
    v_mul_f32 v72, v72, v82
    v_mul_f32 v73, v73, v82
    v_mul_f32 v84, v67, v73
    v_mul_f32 v85, v67, v72
    v_fma_f32 v72, v66, v72, -v84
    v_fma_f32 v73, -v66, v73, -v85
    v_mfma_f32_16x16x4_f32 v[48:51], v68, v74, v[48:51]
    v_mfma_f32_16x16x4_f32 v[52:55], v70, v76, v[52:55]
    v_mfma_f32_16x16x4_f32 v[56:59], v70, v78, v[56:59]
    v_mfma_f32_16x16x4_f32 v[60:63], v72, v80, v[60:63]
    v_mfma_f32_16x16x4_f32 v[48:51], v69, v75, v[48:51]
    v_mfma_f32_16x16x4_f32 v[52:55], v71, v77, v[52:55]
    v_mfma_f32_16x16x4_f32 v[56:59], v71, v79, v[56:59]
    v_mfma_f32_16x16x4_f32 v[60:63], v73, v81, v[60:63]
    v_mov_b32_dpp v64, v28 row_newbcast:11 row_mask:0xf bank_mask:0xf
    v_mov_b32_dpp v65, v29 row_newbcast:11 row_mask:0xf bank_mask:0xf
    v_mov_b32_dpp v66, v30 row_newbcast:11 row_mask:0xf bank_mask:0xf
    v_mov_b32_dpp v67, v31 row_newbcast:11 row_mask:0xf bank_mask:0xf
    v_mul_f32 v82, v64, v47
    v_mul_f32 v83, v65, v47
    v_exp_f32 v82, v82
    v_fract_f32 v83, v83
    v_cos_f32 v74, v83
    v_sin_f32 v75, v83
    v_mul_f32 v74, v74, v82
    v_mul_f32 v75, v75, v82
    v_mul_f32 v84, v75, v75
    v_add_f32 v85, v74, v74
    v_fma_f32 v76, v74, v74, -v84
    v_mul_f32 v77, v85, v75
    v_mul_f32 v84, v77, v77
    v_add_f32 v85, v76, v76
    v_fma_f32 v78, v76, v76, -v84
    v_mul_f32 v79, v85, v77
    v_mul_f32 v84, v79, v79
    v_add_f32 v85, v78, v78
    v_fma_f32 v80, v78, v78, -v84
    v_mul_f32 v81, v85, v79
    v_mul_f32 v82, v64, v44
    v_mul_f32 v83, v65, v44
    v_exp_f32 v82, v82
    v_fract_f32 v83, v83
    v_cos_f32 v68, v83
    v_sin_f32 v69, v83
    v_mul_f32 v68, v68, v82
    v_mul_f32 v69, v69, v82
    v_mul_f32 v84, v67, v69
    v_mul_f32 v85, v67, v68
    v_fma_f32 v68, v66, v68, -v84
    v_fma_f32 v69, -v66, v69, -v85
    v_mul_f32 v82, v64, v45
    v_mul_f32 v83, v65, v45
    v_exp_f32 v82, v82
    v_fract_f32 v83, v83
    v_cos_f32 v70, v83
    v_sin_f32 v71, v83
    v_mul_f32 v70, v70, v82
    v_mul_f32 v71, v71, v82
    v_mul_f32 v84, v67, v71
    v_mul_f32 v85, v67, v70
    v_fma_f32 v70, v66, v70, -v84
    v_fma_f32 v71, -v66, v71, -v85
    v_mul_f32 v82, v64, v46
    v_mul_f32 v83, v65, v46
    v_exp_f32 v82, v82
    v_fract_f32 v83, v83
    v_cos_f32 v72, v83
    v_sin_f32 v73, v83
    v_mul_f32 v72, v72, v82
    v_mul_f32 v73, v73, v82
    v_mul_f32 v84, v67, v73
    v_mul_f32 v85, v67, v72
    v_fma_f32 v72, v66, v72, -v84
    v_fma_f32 v73, -v66, v73, -v85
    v_mfma_f32_16x16x4_f32 v[48:51], v68, v74, v[48:51]
    v_mfma_f32_16x16x4_f32 v[52:55], v70, v76, v[52:55]
    v_mfma_f32_16x16x4_f32 v[56:59], v70, v78, v[56:59]
    v_mfma_f32_16x16x4_f32 v[60:63], v72, v80, v[60:63]
    v_mfma_f32_16x16x4_f32 v[48:51], v69, v75, v[48:51]
    v_mfma_f32_16x16x4_f32 v[52:55], v71, v77, v[52:55]
    v_mfma_f32_16x16x4_f32 v[56:59], v71, v79, v[56:59]
    v_mfma_f32_16x16x4_f32 v[60:63], v73, v81, v[60:63]
    v_mov_b32_dpp v64, v28 row_newbcast:12 row_mask:0xf bank_mask:0xf
    v_mov_b32_dpp v65, v29 row_newbcast:12 row_mask:0xf bank_mask:0xf
    v_mov_b32_dpp v66, v30 row_newbcast:12 row_mask:0xf bank_mask:0xf
    v_mov_b32_dpp v67, v31 row_newbcast:12 row_mask:0xf bank_mask:0xf
    v_mul_f32 v82, v64, v47
    v_mul_f32 v83, v65, v47
    v_exp_f32 v82, v82
    v_fract_f32 v83, v83
    v_cos_f32 v74, v83
    v_sin_f32 v75, v83
    v_mul_f32 v74, v74, v82
    v_mul_f32 v75, v75, v82
    v_mul_f32 v84, v75, v75
    v_add_f32 v85, v74, v74
    v_fma_f32 v76, v74, v74, -v84
    v_mul_f32 v77, v85, v75
    v_mul_f32 v84, v77, v77
    v_add_f32 v85, v76, v76
    v_fma_f32 v78, v76, v76, -v84
    v_mul_f32 v79, v85, v77
    v_mul_f32 v84, v79, v79
    v_add_f32 v85, v78, v78
    v_fma_f32 v80, v78, v78, -v84
    v_mul_f32 v81, v85, v79
    v_mul_f32 v82, v64, v44
    v_mul_f32 v83, v65, v44
    v_exp_f32 v82, v82
    v_fract_f32 v83, v83
    v_cos_f32 v68, v83
    v_sin_f32 v69, v83
    v_mul_f32 v68, v68, v82
    v_mul_f32 v69, v69, v82
    v_mul_f32 v84, v67, v69
    v_mul_f32 v85, v67, v68
    v_fma_f32 v68, v66, v68, -v84
    v_fma_f32 v69, -v66, v69, -v85
    v_mul_f32 v82, v64, v45
    v_mul_f32 v83, v65, v45
    v_exp_f32 v82, v82
    v_fract_f32 v83, v83
    v_cos_f32 v70, v83
    v_sin_f32 v71, v83
    v_mul_f32 v70, v70, v82
    v_mul_f32 v71, v71, v82
    v_mul_f32 v84, v67, v71
    v_mul_f32 v85, v67, v70
    v_fma_f32 v70, v66, v70, -v84
    v_fma_f32 v71, -v66, v71, -v85
    v_mul_f32 v82, v64, v46
    v_mul_f32 v83, v65, v46
    v_exp_f32 v82, v82
    v_fract_f32 v83, v83
    v_cos_f32 v72, v83
    v_sin_f32 v73, v83
    v_mul_f32 v72, v72, v82
    v_mul_f32 v73, v73, v82
    v_mul_f32 v84, v67, v73
    v_mul_f32 v85, v67, v72
    v_fma_f32 v72, v66, v72, -v84
    v_fma_f32 v73, -v66, v73, -v85
    v_mfma_f32_16x16x4_f32 v[48:51], v68, v74, v[48:51]
    v_mfma_f32_16x16x4_f32 v[52:55], v70, v76, v[52:55]
    v_mfma_f32_16x16x4_f32 v[56:59], v70, v78, v[56:59]
    v_mfma_f32_16x16x4_f32 v[60:63], v72, v80, v[60:63]
    v_mfma_f32_16x16x4_f32 v[48:51], v69, v75, v[48:51]
    v_mfma_f32_16x16x4_f32 v[52:55], v71, v77, v[52:55]
    v_mfma_f32_16x16x4_f32 v[56:59], v71, v79, v[56:59]
    v_mfma_f32_16x16x4_f32 v[60:63], v73, v81, v[60:63]
    v_mov_b32_dpp v64, v28 row_newbcast:13 row_mask:0xf bank_mask:0xf
    v_mov_b32_dpp v65, v29 row_newbcast:13 row_mask:0xf bank_mask:0xf
    v_mov_b32_dpp v66, v30 row_newbcast:13 row_mask:0xf bank_mask:0xf
    v_mov_b32_dpp v67, v31 row_newbcast:13 row_mask:0xf bank_mask:0xf
    v_mul_f32 v82, v64, v47
    v_mul_f32 v83, v65, v47
    v_exp_f32 v82, v82
    v_fract_f32 v83, v83
    v_cos_f32 v74, v83
    v_sin_f32 v75, v83
    v_mul_f32 v74, v74, v82
    v_mul_f32 v75, v75, v82
    v_mul_f32 v84, v75, v75
    v_add_f32 v85, v74, v74
    v_fma_f32 v76, v74, v74, -v84
    v_mul_f32 v77, v85, v75
    v_mul_f32 v84, v77, v77
    v_add_f32 v85, v76, v76
    v_fma_f32 v78, v76, v76, -v84
    v_mul_f32 v79, v85, v77
    v_mul_f32 v84, v79, v79
    v_add_f32 v85, v78, v78
    v_fma_f32 v80, v78, v78, -v84
    v_mul_f32 v81, v85, v79
    v_mul_f32 v82, v64, v44
    v_mul_f32 v83, v65, v44
    v_exp_f32 v82, v82
    v_fract_f32 v83, v83
    v_cos_f32 v68, v83
    v_sin_f32 v69, v83
    v_mul_f32 v68, v68, v82
    v_mul_f32 v69, v69, v82
    v_mul_f32 v84, v67, v69
    v_mul_f32 v85, v67, v68
    v_fma_f32 v68, v66, v68, -v84
    v_fma_f32 v69, -v66, v69, -v85
    v_mul_f32 v82, v64, v45
    v_mul_f32 v83, v65, v45
    v_exp_f32 v82, v82
    v_fract_f32 v83, v83
    v_cos_f32 v70, v83
    v_sin_f32 v71, v83
    v_mul_f32 v70, v70, v82
    v_mul_f32 v71, v71, v82
    v_mul_f32 v84, v67, v71
    v_mul_f32 v85, v67, v70
    v_fma_f32 v70, v66, v70, -v84
    v_fma_f32 v71, -v66, v71, -v85
    v_mul_f32 v82, v64, v46
    v_mul_f32 v83, v65, v46
    v_exp_f32 v82, v82
    v_fract_f32 v83, v83
    v_cos_f32 v72, v83
    v_sin_f32 v73, v83
    v_mul_f32 v72, v72, v82
    v_mul_f32 v73, v73, v82
    v_mul_f32 v84, v67, v73
    v_mul_f32 v85, v67, v72
    v_fma_f32 v72, v66, v72, -v84
    v_fma_f32 v73, -v66, v73, -v85
    v_mfma_f32_16x16x4_f32 v[48:51], v68, v74, v[48:51]
    v_mfma_f32_16x16x4_f32 v[52:55], v70, v76, v[52:55]
    v_mfma_f32_16x16x4_f32 v[56:59], v70, v78, v[56:59]
    v_mfma_f32_16x16x4_f32 v[60:63], v72, v80, v[60:63]
    v_mfma_f32_16x16x4_f32 v[48:51], v69, v75, v[48:51]
    v_mfma_f32_16x16x4_f32 v[52:55], v71, v77, v[52:55]
    v_mfma_f32_16x16x4_f32 v[56:59], v71, v79, v[56:59]
    v_mfma_f32_16x16x4_f32 v[60:63], v73, v81, v[60:63]
    v_mov_b32_dpp v64, v28 row_newbcast:14 row_mask:0xf bank_mask:0xf
    v_mov_b32_dpp v65, v29 row_newbcast:14 row_mask:0xf bank_mask:0xf
    v_mov_b32_dpp v66, v30 row_newbcast:14 row_mask:0xf bank_mask:0xf
    v_mov_b32_dpp v67, v31 row_newbcast:14 row_mask:0xf bank_mask:0xf
    v_mul_f32 v82, v64, v47
    v_mul_f32 v83, v65, v47
    v_exp_f32 v82, v82
    v_fract_f32 v83, v83
    v_cos_f32 v74, v83
    v_sin_f32 v75, v83
    v_mul_f32 v74, v74, v82
    v_mul_f32 v75, v75, v82
    v_mul_f32 v84, v75, v75
    v_add_f32 v85, v74, v74
    v_fma_f32 v76, v74, v74, -v84
    v_mul_f32 v77, v85, v75
    v_mul_f32 v84, v77, v77
    v_add_f32 v85, v76, v76
    v_fma_f32 v78, v76, v76, -v84
    v_mul_f32 v79, v85, v77
    v_mul_f32 v84, v79, v79
    v_add_f32 v85, v78, v78
    v_fma_f32 v80, v78, v78, -v84
    v_mul_f32 v81, v85, v79
    v_mul_f32 v82, v64, v44
    v_mul_f32 v83, v65, v44
    v_exp_f32 v82, v82
    v_fract_f32 v83, v83
    v_cos_f32 v68, v83
    v_sin_f32 v69, v83
    v_mul_f32 v68, v68, v82
    v_mul_f32 v69, v69, v82
    v_mul_f32 v84, v67, v69
    v_mul_f32 v85, v67, v68
    v_fma_f32 v68, v66, v68, -v84
    v_fma_f32 v69, -v66, v69, -v85
    v_mul_f32 v82, v64, v45
    v_mul_f32 v83, v65, v45
    v_exp_f32 v82, v82
    v_fract_f32 v83, v83
    v_cos_f32 v70, v83
    v_sin_f32 v71, v83
    v_mul_f32 v70, v70, v82
    v_mul_f32 v71, v71, v82
    v_mul_f32 v84, v67, v71
    v_mul_f32 v85, v67, v70
    v_fma_f32 v70, v66, v70, -v84
    v_fma_f32 v71, -v66, v71, -v85
    v_mul_f32 v82, v64, v46
    v_mul_f32 v83, v65, v46
    v_exp_f32 v82, v82
    v_fract_f32 v83, v83
    v_cos_f32 v72, v83
    v_sin_f32 v73, v83
    v_mul_f32 v72, v72, v82
    v_mul_f32 v73, v73, v82
    v_mul_f32 v84, v67, v73
    v_mul_f32 v85, v67, v72
    v_fma_f32 v72, v66, v72, -v84
    v_fma_f32 v73, -v66, v73, -v85
    v_mfma_f32_16x16x4_f32 v[48:51], v68, v74, v[48:51]
    v_mfma_f32_16x16x4_f32 v[52:55], v70, v76, v[52:55]
    v_mfma_f32_16x16x4_f32 v[56:59], v70, v78, v[56:59]
    v_mfma_f32_16x16x4_f32 v[60:63], v72, v80, v[60:63]
    v_mfma_f32_16x16x4_f32 v[48:51], v69, v75, v[48:51]
    v_mfma_f32_16x16x4_f32 v[52:55], v71, v77, v[52:55]
    v_mfma_f32_16x16x4_f32 v[56:59], v71, v79, v[56:59]
    v_mfma_f32_16x16x4_f32 v[60:63], v73, v81, v[60:63]
    v_mov_b32_dpp v64, v28 row_newbcast:15 row_mask:0xf bank_mask:0xf
    v_mov_b32_dpp v65, v29 row_newbcast:15 row_mask:0xf bank_mask:0xf
    v_mov_b32_dpp v66, v30 row_newbcast:15 row_mask:0xf bank_mask:0xf
    v_mov_b32_dpp v67, v31 row_newbcast:15 row_mask:0xf bank_mask:0xf
    v_mul_f32 v82, v64, v47
    v_mul_f32 v83, v65, v47
    v_exp_f32 v82, v82
    v_fract_f32 v83, v83
    v_cos_f32 v74, v83
    v_sin_f32 v75, v83
    v_mul_f32 v74, v74, v82
    v_mul_f32 v75, v75, v82
    v_mul_f32 v84, v75, v75
    v_add_f32 v85, v74, v74
    v_fma_f32 v76, v74, v74, -v84
    v_mul_f32 v77, v85, v75
    v_mul_f32 v84, v77, v77
    v_add_f32 v85, v76, v76
    v_fma_f32 v78, v76, v76, -v84
    v_mul_f32 v79, v85, v77
    v_mul_f32 v84, v79, v79
    v_add_f32 v85, v78, v78
    v_fma_f32 v80, v78, v78, -v84
    v_mul_f32 v81, v85, v79
    v_mul_f32 v82, v64, v44
    v_mul_f32 v83, v65, v44
    v_exp_f32 v82, v82
    v_fract_f32 v83, v83
    v_cos_f32 v68, v83
    v_sin_f32 v69, v83
    v_mul_f32 v68, v68, v82
    v_mul_f32 v69, v69, v82
    v_mul_f32 v84, v67, v69
    v_mul_f32 v85, v67, v68
    v_fma_f32 v68, v66, v68, -v84
    v_fma_f32 v69, -v66, v69, -v85
    v_mul_f32 v82, v64, v45
    v_mul_f32 v83, v65, v45
    v_exp_f32 v82, v82
    v_fract_f32 v83, v83
    v_cos_f32 v70, v83
    v_sin_f32 v71, v83
    v_mul_f32 v70, v70, v82
    v_mul_f32 v71, v71, v82
    v_mul_f32 v84, v67, v71
    v_mul_f32 v85, v67, v70
    v_fma_f32 v70, v66, v70, -v84
    v_fma_f32 v71, -v66, v71, -v85
    v_mul_f32 v82, v64, v46
    v_mul_f32 v83, v65, v46
    v_exp_f32 v82, v82
    v_fract_f32 v83, v83
    v_cos_f32 v72, v83
    v_sin_f32 v73, v83
    v_mul_f32 v72, v72, v82
    v_mul_f32 v73, v73, v82
    v_mul_f32 v84, v67, v73
    v_mul_f32 v85, v67, v72
    v_fma_f32 v72, v66, v72, -v84
    v_fma_f32 v73, -v66, v73, -v85
    v_mfma_f32_16x16x4_f32 v[48:51], v68, v74, v[48:51]
    v_mfma_f32_16x16x4_f32 v[52:55], v70, v76, v[52:55]
    v_mfma_f32_16x16x4_f32 v[56:59], v70, v78, v[56:59]
    v_mfma_f32_16x16x4_f32 v[60:63], v72, v80, v[60:63]
    v_mfma_f32_16x16x4_f32 v[48:51], v69, v75, v[48:51]
    v_mfma_f32_16x16x4_f32 v[52:55], v71, v77, v[52:55]
    v_mfma_f32_16x16x4_f32 v[56:59], v71, v79, v[56:59]
    v_mfma_f32_16x16x4_f32 v[60:63], v73, v81, v[60:63]
    v_lshlrev_b32 v5, 8, v3
    v_lshl_add_u32 v5, v2, 2, v5
    v_add_u32 v5, v5, v4
    ds_write_b32 v5, v48 offset:4608
    ds_write_b32 v5, v49 offset:4672
    ds_write_b32 v5, v50 offset:4736
    ds_write_b32 v5, v51 offset:4800
    v_cmp_gt_u32 vcc, 2, v3
    s_nop 0
    s_mov_b64 exec, vcc
    ds_write_b32 v5, v52 offset:5632
    ds_write_b32 v5, v53 offset:5696
    ds_write_b32 v5, v54 offset:5760
    ds_write_b32 v5, v55 offset:5824
    ds_write_b32 v5, v60 offset:6656
    ds_write_b32 v5, v61 offset:6720
    ds_write_b32 v5, v62 offset:6784
    ds_write_b32 v5, v63 offset:6848
    s_not_b64 exec, exec
    ds_write_b32 v5, v56 offset:5632
    ds_write_b32 v5, v57 offset:5696
    ds_write_b32 v5, v58 offset:5760
    ds_write_b32 v5, v59 offset:5824
    s_mov_b32 exec_lo, 0
    s_mov_b32 exec_hi, 3
    v_cmp_eq_u32 vcc, 0, v2
    s_nop 1
    v_cndmask_b32 v6, 0, v60, vcc
    ds_write_b32 v5, v6 offset:6656
    s_mov_b64 exec, -1
    s_waitcnt lgkmcnt(0)
    v_lshlrev_b32 v7, 1, v1
    v_sub_u32 v7, 2065, v7
    v_lshl_add_u32 v64, v1, 2, v4
    v_mov_b32 v65, 641
    s_mov_b32 s25, 17
ss_exp:
    v_subrev_u32 v66, 0, v7
    v_cvt_f32_u32 v70, v66
    v_cvt_pk_bf16_f32 v70, v70, v70
    v_and_b32 v70, 0xffff, v70
    v_subrev_u32 v70, 0x4280, v70
    v_cmp_gt_u32 vcc, 256, v66
    s_nop 1
    v_cndmask_b32 v70, v70, v66, vcc
    v_cmp_gt_u32 vcc, 2048, v66
    s_nop 1
    v_cndmask_b32 v70, v65, v70, vcc
    v_lshl_add_u32 v70, v70, 2, v4
    ds_read_b32 v74, v70 offset:4608
    v_subrev_u32 v67, 1, v7
    v_cvt_f32_u32 v71, v67
    v_cvt_pk_bf16_f32 v71, v71, v71
    v_and_b32 v71, 0xffff, v71
    v_subrev_u32 v71, 0x4280, v71
    v_cmp_gt_u32 vcc, 256, v67
    s_nop 1
    v_cndmask_b32 v71, v71, v67, vcc
    v_cmp_gt_u32 vcc, 2048, v67
    s_nop 1
    v_cndmask_b32 v71, v65, v71, vcc
    v_lshl_add_u32 v71, v71, 2, v4
    ds_read_b32 v75, v71 offset:4608
    v_subrev_u32 v68, 2, v7
    v_cvt_f32_u32 v72, v68
    v_cvt_pk_bf16_f32 v72, v72, v72
    v_and_b32 v72, 0xffff, v72
    v_subrev_u32 v72, 0x4280, v72
    v_cmp_gt_u32 vcc, 256, v68
    s_nop 1
    v_cndmask_b32 v72, v72, v68, vcc
    v_cmp_gt_u32 vcc, 2048, v68
    s_nop 1
    v_cndmask_b32 v72, v65, v72, vcc
    v_lshl_add_u32 v72, v72, 2, v4
    ds_read_b32 v76, v72 offset:4608
    s_waitcnt lgkmcnt(0)
    v_cvt_pk_bf16_f32 v78, v75, v76
    v_cvt_pk_bf16_f32 v79, v74, v75
    ds_write_b32 v64, v78 offset:7424
    ds_write_b32 v64, v79 offset:11776
    v_subrev_u32 v7, 128, v7
    v_add_u32 v64, 256, v64
    s_sub_u32 s25, s25, 1
    s_cmp_lg_u32 s25, 0
    s_cbranch_scc1 ss_exp
    s_waitcnt lgkmcnt(0)
    s_barrier
    v_and_b32 v5, 1, v2
    v_mul_u32_u24 v64, 4352, v5
    v_sub_u32 v5, v5, v2
    v_lshl_add_u32 v5, v3, 3, v5
    v_lshl_add_u32 v64, v5, 1, v64
    v_add_u32 v64, 11520, v64
    v_add_u32 v64, v64, v4
    v_lshlrev_b32 v65, 5, v2
    v_lshl_add_u32 v65, v3, 4, v65
    v_add_u32 v65, 480, v65
    v_add_u32 v65, v65, v4
    v_mov_b32 v96, 0
    v_mov_b32 v97, 0
    v_mov_b32 v98, 0
    v_mov_b32 v99, 0
    v_mov_b32 v100, 0
    v_mov_b32 v101, 0
    v_mov_b32 v102, 0
    v_mov_b32 v103, 0
    v_mov_b32 v104, 0
    v_mov_b32 v105, 0
    v_mov_b32 v106, 0
    v_mov_b32 v107, 0
    v_mov_b32 v108, 0
    v_mov_b32 v109, 0
    v_mov_b32 v110, 0
    v_mov_b32 v111, 0
    v_mov_b32 v112, 0
    v_mov_b32 v113, 0
    v_mov_b32 v114, 0
    v_mov_b32 v115, 0
    v_mov_b32 v116, 0
    v_mov_b32 v117, 0
    v_mov_b32 v118, 0
    v_mov_b32 v119, 0
    v_mov_b32 v120, 0
    v_mov_b32 v121, 0
    v_mov_b32 v122, 0
    v_mov_b32 v123, 0
    v_mov_b32 v124, 0
    v_mov_b32 v125, 0
    v_mov_b32 v126, 0
    v_mov_b32 v127, 0
    s_mov_b32 s25, 8
ss_cv0:
    ds_read2_b32 v[68:69], v64 offset0:0 offset1:1
    ds_read2_b32 v[70:71], v64 offset0:2 offset1:3
    ds_read_b128 v[128:131], v65 offset:0
    ds_read_b128 v[132:135], v65 offset:512
    ds_read_b128 v[136:139], v65 offset:1024
    ds_read_b128 v[140:143], v65 offset:1536
    ds_read_b128 v[144:147], v65 offset:2048
    ds_read_b128 v[148:151], v65 offset:2560
    ds_read_b128 v[152:155], v65 offset:3072
    ds_read_b128 v[156:159], v65 offset:3584
    v_subrev_u32 v64, 64, v64
    v_subrev_u32 v65, 64, v65
    s_waitcnt lgkmcnt(7)
    v_mfma_f32_16x16x32_bf16 v[96:99], v[68:71], v[128:131], v[96:99]
    s_waitcnt lgkmcnt(6)
    v_mfma_f32_16x16x32_bf16 v[100:103], v[68:71], v[132:135], v[100:103]
    s_waitcnt lgkmcnt(5)
    v_mfma_f32_16x16x32_bf16 v[104:107], v[68:71], v[136:139], v[104:107]
    s_waitcnt lgkmcnt(4)
    v_mfma_f32_16x16x32_bf16 v[108:111], v[68:71], v[140:143], v[108:111]
    s_waitcnt lgkmcnt(3)
    v_mfma_f32_16x16x32_bf16 v[112:115], v[68:71], v[144:147], v[112:115]
    s_waitcnt lgkmcnt(2)
    v_mfma_f32_16x16x32_bf16 v[116:119], v[68:71], v[148:151], v[116:119]
    s_waitcnt lgkmcnt(1)
    v_mfma_f32_16x16x32_bf16 v[120:123], v[68:71], v[152:155], v[120:123]
    s_waitcnt lgkmcnt(0)
    v_mfma_f32_16x16x32_bf16 v[124:127], v[68:71], v[156:159], v[124:127]
    s_sub_u32 s25, s25, 1
    s_cmp_lg_u32 s25, 0
    s_cbranch_scc1 ss_cv0
    v_add_u32 v65, 512, v65
    s_mov_b32 s25, 8
ss_cv1:
    ds_read2_b32 v[68:69], v64 offset0:0 offset1:1
    ds_read2_b32 v[70:71], v64 offset0:2 offset1:3
    ds_read_b128 v[132:135], v65 offset:0
    ds_read_b128 v[136:139], v65 offset:512
    ds_read_b128 v[140:143], v65 offset:1024
    ds_read_b128 v[144:147], v65 offset:1536
    ds_read_b128 v[148:151], v65 offset:2048
    ds_read_b128 v[152:155], v65 offset:2560
    ds_read_b128 v[156:159], v65 offset:3072
    v_subrev_u32 v64, 64, v64
    v_subrev_u32 v65, 64, v65
    s_waitcnt lgkmcnt(6)
    v_mfma_f32_16x16x32_bf16 v[100:103], v[68:71], v[132:135], v[100:103]
    s_waitcnt lgkmcnt(5)
    v_mfma_f32_16x16x32_bf16 v[104:107], v[68:71], v[136:139], v[104:107]
    s_waitcnt lgkmcnt(4)
    v_mfma_f32_16x16x32_bf16 v[108:111], v[68:71], v[140:143], v[108:111]
    s_waitcnt lgkmcnt(3)
    v_mfma_f32_16x16x32_bf16 v[112:115], v[68:71], v[144:147], v[112:115]
    s_waitcnt lgkmcnt(2)
    v_mfma_f32_16x16x32_bf16 v[116:119], v[68:71], v[148:151], v[116:119]
    s_waitcnt lgkmcnt(1)
    v_mfma_f32_16x16x32_bf16 v[120:123], v[68:71], v[152:155], v[120:123]
    s_waitcnt lgkmcnt(0)
    v_mfma_f32_16x16x32_bf16 v[124:127], v[68:71], v[156:159], v[124:127]
    s_sub_u32 s25, s25, 1
    s_cmp_lg_u32 s25, 0
    s_cbranch_scc1 ss_cv1
    v_add_u32 v65, 512, v65
    s_mov_b32 s25, 8
ss_cv2:
    ds_read2_b32 v[68:69], v64 offset0:0 offset1:1
    ds_read2_b32 v[70:71], v64 offset0:2 offset1:3
    ds_read_b128 v[136:139], v65 offset:0
    ds_read_b128 v[140:143], v65 offset:512
    ds_read_b128 v[144:147], v65 offset:1024
    ds_read_b128 v[148:151], v65 offset:1536
    ds_read_b128 v[152:155], v65 offset:2048
    ds_read_b128 v[156:159], v65 offset:2560
    v_subrev_u32 v64, 64, v64
    v_subrev_u32 v65, 64, v65
    s_waitcnt lgkmcnt(5)
    v_mfma_f32_16x16x32_bf16 v[104:107], v[68:71], v[136:139], v[104:107]
    s_waitcnt lgkmcnt(4)
    v_mfma_f32_16x16x32_bf16 v[108:111], v[68:71], v[140:143], v[108:111]
    s_waitcnt lgkmcnt(3)
    v_mfma_f32_16x16x32_bf16 v[112:115], v[68:71], v[144:147], v[112:115]
    s_waitcnt lgkmcnt(2)
    v_mfma_f32_16x16x32_bf16 v[116:119], v[68:71], v[148:151], v[116:119]
    s_waitcnt lgkmcnt(1)
    v_mfma_f32_16x16x32_bf16 v[120:123], v[68:71], v[152:155], v[120:123]
    s_waitcnt lgkmcnt(0)
    v_mfma_f32_16x16x32_bf16 v[124:127], v[68:71], v[156:159], v[124:127]
    s_sub_u32 s25, s25, 1
    s_cmp_lg_u32 s25, 0
    s_cbranch_scc1 ss_cv2
    v_add_u32 v65, 512, v65
    s_mov_b32 s25, 8
ss_cv3:
    ds_read2_b32 v[68:69], v64 offset0:0 offset1:1
    ds_read2_b32 v[70:71], v64 offset0:2 offset1:3
    ds_read_b128 v[140:143], v65 offset:0
    ds_read_b128 v[144:147], v65 offset:512
    ds_read_b128 v[148:151], v65 offset:1024
    ds_read_b128 v[152:155], v65 offset:1536
    ds_read_b128 v[156:159], v65 offset:2048
    v_subrev_u32 v64, 64, v64
    v_subrev_u32 v65, 64, v65
    s_waitcnt lgkmcnt(4)
    v_mfma_f32_16x16x32_bf16 v[108:111], v[68:71], v[140:143], v[108:111]
    s_waitcnt lgkmcnt(3)
    v_mfma_f32_16x16x32_bf16 v[112:115], v[68:71], v[144:147], v[112:115]
    s_waitcnt lgkmcnt(2)
    v_mfma_f32_16x16x32_bf16 v[116:119], v[68:71], v[148:151], v[116:119]
    s_waitcnt lgkmcnt(1)
    v_mfma_f32_16x16x32_bf16 v[120:123], v[68:71], v[152:155], v[120:123]
    s_waitcnt lgkmcnt(0)
    v_mfma_f32_16x16x32_bf16 v[124:127], v[68:71], v[156:159], v[124:127]
    s_sub_u32 s25, s25, 1
    s_cmp_lg_u32 s25, 0
    s_cbranch_scc1 ss_cv3
    v_add_u32 v65, 512, v65
    s_mov_b32 s25, 8
ss_cv4:
    ds_read2_b32 v[68:69], v64 offset0:0 offset1:1
    ds_read2_b32 v[70:71], v64 offset0:2 offset1:3
    ds_read_b128 v[144:147], v65 offset:0
    ds_read_b128 v[148:151], v65 offset:512
    ds_read_b128 v[152:155], v65 offset:1024
    ds_read_b128 v[156:159], v65 offset:1536
    v_subrev_u32 v64, 64, v64
    v_subrev_u32 v65, 64, v65
    s_waitcnt lgkmcnt(3)
    v_mfma_f32_16x16x32_bf16 v[112:115], v[68:71], v[144:147], v[112:115]
    s_waitcnt lgkmcnt(2)
    v_mfma_f32_16x16x32_bf16 v[116:119], v[68:71], v[148:151], v[116:119]
    s_waitcnt lgkmcnt(1)
    v_mfma_f32_16x16x32_bf16 v[120:123], v[68:71], v[152:155], v[120:123]
    s_waitcnt lgkmcnt(0)
    v_mfma_f32_16x16x32_bf16 v[124:127], v[68:71], v[156:159], v[124:127]
    s_sub_u32 s25, s25, 1
    s_cmp_lg_u32 s25, 0
    s_cbranch_scc1 ss_cv4
    v_add_u32 v65, 512, v65
    s_mov_b32 s25, 8
ss_cv5:
    ds_read2_b32 v[68:69], v64 offset0:0 offset1:1
    ds_read2_b32 v[70:71], v64 offset0:2 offset1:3
    ds_read_b128 v[148:151], v65 offset:0
    ds_read_b128 v[152:155], v65 offset:512
    ds_read_b128 v[156:159], v65 offset:1024
    v_subrev_u32 v64, 64, v64
    v_subrev_u32 v65, 64, v65
    s_waitcnt lgkmcnt(2)
    v_mfma_f32_16x16x32_bf16 v[116:119], v[68:71], v[148:151], v[116:119]
    s_waitcnt lgkmcnt(1)
    v_mfma_f32_16x16x32_bf16 v[120:123], v[68:71], v[152:155], v[120:123]
    s_waitcnt lgkmcnt(0)
    v_mfma_f32_16x16x32_bf16 v[124:127], v[68:71], v[156:159], v[124:127]
    s_sub_u32 s25, s25, 1
    s_cmp_lg_u32 s25, 0
    s_cbranch_scc1 ss_cv5
    v_add_u32 v65, 512, v65
    s_mov_b32 s25, 8
ss_cv6:
    ds_read2_b32 v[68:69], v64 offset0:0 offset1:1
    ds_read2_b32 v[70:71], v64 offset0:2 offset1:3
    ds_read_b128 v[152:155], v65 offset:0
    ds_read_b128 v[156:159], v65 offset:512
    v_subrev_u32 v64, 64, v64
    v_subrev_u32 v65, 64, v65
    s_waitcnt lgkmcnt(1)
    v_mfma_f32_16x16x32_bf16 v[120:123], v[68:71], v[152:155], v[120:123]
    s_waitcnt lgkmcnt(0)
    v_mfma_f32_16x16x32_bf16 v[124:127], v[68:71], v[156:159], v[124:127]
    s_sub_u32 s25, s25, 1
    s_cmp_lg_u32 s25, 0
    s_cbranch_scc1 ss_cv6
    v_add_u32 v65, 512, v65
    s_mov_b32 s25, 8
ss_cv7:
    ds_read2_b32 v[68:69], v64 offset0:0 offset1:1
    ds_read2_b32 v[70:71], v64 offset0:2 offset1:3
    ds_read_b128 v[156:159], v65 offset:0
    v_subrev_u32 v64, 64, v64
    v_subrev_u32 v65, 64, v65
    s_waitcnt lgkmcnt(0)
    v_mfma_f32_16x16x32_bf16 v[124:127], v[68:71], v[156:159], v[124:127]
    s_sub_u32 s25, s25, 1
    s_cmp_lg_u32 s25, 0
    s_cbranch_scc1 ss_cv7
    v_add_u32 v65, 512, v65
    s_nop 3
    v_lshlrev_b32 v5, 6, v2
    v_lshl_add_u32 v5, v3, 4, v5
    v_add_u32 v5, v5, v4
    ds_write_b128 v5, v[96:99] offset:7424
    ds_write_b128 v5, v[100:103] offset:8448
    ds_write_b128 v5, v[104:107] offset:9472
    ds_write_b128 v5, v[108:111] offset:10496
    ds_write_b128 v5, v[112:115] offset:11520
    ds_write_b128 v5, v[116:119] offset:12544
    ds_write_b128 v5, v[120:123] offset:13568
    ds_write_b128 v5, v[124:127] offset:14592
    s_mov_b32 s12, s74
    s_mov_b32 s13, s75
    s_mov_b32 s14, 1152
    s_mov_b32 s15, 0x20000
    s_lshl_b32 s23, s20, 1
    buffer_load_dwordx2 v[24:25], off, s[12:15], s23
    s_waitcnt vmcnt(0) lgkmcnt(0)
    s_barrier
    v_lshlrev_b32 v26, 16, v24
    v_and_b32 v27, 0xffff0000, v24
    v_lshlrev_b32 v28, 16, v25
    v_and_b32 v29, 0xffff0000, v25
    v_lshlrev_b32 v5, 5, v0
    ds_read_b128 v[64:67], v5 offset:7424
    ds_read_b128 v[68:71], v5 offset:7440
    ds_read_b128 v[72:75], v5 offset:23808
    ds_read_b128 v[76:79], v5 offset:23824
    ds_read_b128 v[80:83], v5 offset:40192
    ds_read_b128 v[84:87], v5 offset:40208
    ds_read_b128 v[88:91], v5 offset:56576
    ds_read_b128 v[92:95], v5 offset:56592
    s_waitcnt lgkmcnt(0)
    v_mul_u32_u24 v5, 18432, v0
    s_lshl_b32 s22, s20, 1
    s_add_u32 s22, s22, 1152
    v_lshlrev_b32 v6, 16, v8
    v_fmac_f32 v64, v6, v26
    v_and_b32 v6, 0xffff0000, v8
    v_fmac_f32 v72, v6, v27
    v_lshlrev_b32 v6, 16, v9
    v_fmac_f32 v80, v6, v28
    v_and_b32 v6, 0xffff0000, v9
    v_fmac_f32 v88, v6, v29
    v_cvt_pk_bf16_f32 v8, v64, v72
    v_cvt_pk_bf16_f32 v9, v80, v88
    s_add_u32 s23, s22, 0
    buffer_store_dwordx2 v[8:9], v5, s[16:19], s23 offen
    v_lshlrev_b32 v6, 16, v10
    v_fmac_f32 v65, v6, v26
    v_and_b32 v6, 0xffff0000, v10
    v_fmac_f32 v73, v6, v27
    v_lshlrev_b32 v6, 16, v11
    v_fmac_f32 v81, v6, v28
    v_and_b32 v6, 0xffff0000, v11
    v_fmac_f32 v89, v6, v29
    v_cvt_pk_bf16_f32 v10, v65, v73
    v_cvt_pk_bf16_f32 v11, v81, v89
    s_add_u32 s23, s22, 2304
    buffer_store_dwordx2 v[10:11], v5, s[16:19], s23 offen
    v_lshlrev_b32 v6, 16, v12
    v_fmac_f32 v66, v6, v26
    v_and_b32 v6, 0xffff0000, v12
    v_fmac_f32 v74, v6, v27
    v_lshlrev_b32 v6, 16, v13
    v_fmac_f32 v82, v6, v28
    v_and_b32 v6, 0xffff0000, v13
    v_fmac_f32 v90, v6, v29
    v_cvt_pk_bf16_f32 v12, v66, v74
    v_cvt_pk_bf16_f32 v13, v82, v90
    s_add_u32 s23, s22, 4608
    buffer_store_dwordx2 v[12:13], v5, s[16:19], s23 offen
    v_lshlrev_b32 v6, 16, v14
    v_fmac_f32 v67, v6, v26
    v_and_b32 v6, 0xffff0000, v14
    v_fmac_f32 v75, v6, v27
    v_lshlrev_b32 v6, 16, v15
    v_fmac_f32 v83, v6, v28
    v_and_b32 v6, 0xffff0000, v15
    v_fmac_f32 v91, v6, v29
    v_cvt_pk_bf16_f32 v14, v67, v75
    v_cvt_pk_bf16_f32 v15, v83, v91
    s_add_u32 s23, s22, 6912
    buffer_store_dwordx2 v[14:15], v5, s[16:19], s23 offen
    v_lshlrev_b32 v6, 16, v16
    v_fmac_f32 v68, v6, v26
    v_and_b32 v6, 0xffff0000, v16
    v_fmac_f32 v76, v6, v27
    v_lshlrev_b32 v6, 16, v17
    v_fmac_f32 v84, v6, v28
    v_and_b32 v6, 0xffff0000, v17
    v_fmac_f32 v92, v6, v29
    v_cvt_pk_bf16_f32 v16, v68, v76
    v_cvt_pk_bf16_f32 v17, v84, v92
    s_add_u32 s23, s22, 9216
    buffer_store_dwordx2 v[16:17], v5, s[16:19], s23 offen
    v_lshlrev_b32 v6, 16, v18
    v_fmac_f32 v69, v6, v26
    v_and_b32 v6, 0xffff0000, v18
    v_fmac_f32 v77, v6, v27
    v_lshlrev_b32 v6, 16, v19
    v_fmac_f32 v85, v6, v28
    v_and_b32 v6, 0xffff0000, v19
    v_fmac_f32 v93, v6, v29
    v_cvt_pk_bf16_f32 v18, v69, v77
    v_cvt_pk_bf16_f32 v19, v85, v93
    s_add_u32 s23, s22, 11520
    buffer_store_dwordx2 v[18:19], v5, s[16:19], s23 offen
    v_lshlrev_b32 v6, 16, v20
    v_fmac_f32 v70, v6, v26
    v_and_b32 v6, 0xffff0000, v20
    v_fmac_f32 v78, v6, v27
    v_lshlrev_b32 v6, 16, v21
    v_fmac_f32 v86, v6, v28
    v_and_b32 v6, 0xffff0000, v21
    v_fmac_f32 v94, v6, v29
    v_cvt_pk_bf16_f32 v20, v70, v78
    v_cvt_pk_bf16_f32 v21, v86, v94
    s_add_u32 s23, s22, 13824
    buffer_store_dwordx2 v[20:21], v5, s[16:19], s23 offen
    v_lshlrev_b32 v6, 16, v22
    v_fmac_f32 v71, v6, v26
    v_and_b32 v6, 0xffff0000, v22
    v_fmac_f32 v79, v6, v27
    v_lshlrev_b32 v6, 16, v23
    v_fmac_f32 v87, v6, v28
    v_and_b32 v6, 0xffff0000, v23
    v_fmac_f32 v95, v6, v29
    v_cvt_pk_bf16_f32 v22, v71, v79
    v_cvt_pk_bf16_f32 v23, v87, v95
    s_add_u32 s23, s22, 16128
    buffer_store_dwordx2 v[22:23], v5, s[16:19], s23 offen
    s_branch L_ssm_next
L_phase2:
    v_and_b32 v1, 63, v0
    v_min_u32 v1, 6, v1
    v_lshlrev_b32 v2, 2, v1
    buffer_load_dword v3, v2, s[96:99], 0 offen offset:32 sc1
    v_mov_b32 v4, 30
    v_cmp_eq_u32 vcc, 6, v1
    s_nop 1
    v_cndmask_b32 v4, v4, 12, vcc
    s_waitcnt vmcnt(0)
    v_cmp_lt_u32 vcc, v3, v4
    s_nop 0
    s_ff1_i32_b64 s40, vcc
    v_mov_b32 v250, s40
    v_mov_b32 v251, 163832
    s_cmp_lg_u32 s32, 0
    s_cbranch_scc1 L_sw_nw
    ds_write_b32 v251, v250
    s_waitcnt lgkmcnt(0)
L_sw_nw:
    s_barrier
    ds_read_b32 v252, v251
    s_waitcnt lgkmcnt(0)
    v_readfirstlane_b32 s33, v252
    s_barrier
    s_nop 1
    s_cmp_lt_u32 s33, 7
    s_cbranch_scc1 L_pool
    s_mov_b32 s88, 4194304
gn8:
    s_cmp_lg_u32 s95, 0
    s_cbranch_scc1 gn8x
    buffer_load_dword v250, off, s[96:99], 0 offset:144 sc1
    s_sub_u32 s88, s88, 1
    s_cbranch_scc1 gn8x
    s_waitcnt vmcnt(0)
    v_readfirstlane_b32 s95, v250
    s_nop 1
    s_branch gn8
gn8x:
    s_mov_b32 s40, 524288
mc2_w:
    buffer_load_dword v250, off, s[96:99], 0 offset:140 sc1
    s_waitcnt vmcnt(0)
    v_readfirstlane_b32 s41, v250
    s_nop 0
    s_cmp_lg_u32 s41, 0
    s_cbranch_scc1 mc2_known
    s_sub_u32 s40, s40, 1
    s_cbranch_scc1 mc2_force
    s_sleep 2
    s_branch mc2_w
mc2_force:
    v_mov_b32 v250, 2
    v_mov_b32 v251, 0
    s_mov_b64 exec, 1
    buffer_atomic_cmpswap v[250:251], off, s[96:99], 0 offset:140
    s_mov_b64 exec, -1
    s_waitcnt vmcnt(0)
    s_mov_b32 s40, 524288
    s_branch mc2_w
mc2_known:
    s_cmp_eq_u32 s41, 1
    s_cbranch_scc1 L_phase2b
    s_mov_b32 s37, 208
    v_mov_b32 v250, 1
    v_mov_b32 v251, 163832
    v_cmp_eq_u32 vcc, 0, v0
    s_nop 0
    s_and_saveexec_b64 s[38:39], vcc
    s_cbranch_execz tk9
    buffer_atomic_add v250, off, s[96:99], s37 sc0
    s_waitcnt vmcnt(0)
    ds_write_b32 v251, v250
    s_waitcnt lgkmcnt(0)
tk9:
    s_mov_b64 exec, -1
    s_barrier
    ds_read_b32 v252, v251
    s_waitcnt lgkmcnt(0)
    v_readfirstlane_b32 s12, v252
    s_barrier
    s_nop 3
    s_cmp_lt_u32 s12, 32
    s_cbranch_scc1 L_chain_safe
L_phase2b:
    s_mov_b32 s8, s76
    s_mov_b32 s9, s77
    s_mov_b32 s10, 4718592
    s_mov_b32 s11, 0x20000
    s_mov_b32 s37, 12
    v_mov_b32 v250, 1
    v_mov_b32 v251, 163832
    v_cmp_eq_u32 vcc, 0, v0
    s_nop 0
    s_and_saveexec_b64 s[38:39], vcc
    s_cbranch_execz tk10
    buffer_atomic_add v250, off, s[96:99], s37 sc0
    s_waitcnt vmcnt(0)
    ds_write_b32 v251, v250
    s_waitcnt lgkmcnt(0)
tk10:
    s_mov_b64 exec, -1
    s_barrier
    ds_read_b32 v252, v251
    s_waitcnt lgkmcnt(0)
    v_readfirstlane_b32 s34, v252
    s_barrier
    s_nop 3
    s_cmp_ge_u32 s34, 156
    s_cbranch_scc1 L_done
    s_cmp_ge_u32 s34, 48
    s_cbranch_scc1 L_op_start
L_att_next:
    s_lshr_b32 s16, s34, 3
    s_and_b32 s17, s34, 7
    s_lshl_b32 s17, s17, 2
    s_add_u32 s17, s17, s32
    s_lshr_b32 s36, s17, 1
    s_lshl_b32 s36, s36, 8
    s_add_u32 s36, s36, 125829120
    s_mul_i32 s37, s16, 43
    s_lshr_b32 s37, s37, 8
    s_mul_i32 s41, s37, 6
    s_sub_u32 s41, s16, s41
    v_and_b32 v1, 63, v0
    v_mul_u32_u24 v2, 6, v1
    v_add_u32 v2, s41, v2
    v_mov_b32 v4, s37
    s_and_b32 s41, s16, 7
    s_add_u32 s41, s41, 12
    s_lshr_b32 s37, s16, 3
    v_mov_b32 v5, s41
    v_mov_b32 v6, s37
    v_cmp_lt_u32 vcc, 1, v1
    s_nop 1
    v_cndmask_b32 v2, v2, v5, vcc
    v_cndmask_b32 v4, v4, v6, vcc
    v_lshlrev_b32 v2, 2, v2
    v_add3_u32 v4, v4, s95, 1
    s_mov_b32 s40, 4194304
L_aw1:
    buffer_load_dword v3, v2, s[4:7], s36 offen sc1
    s_sub_u32 s40, s40, 1
    s_cbranch_scc1 L_aw1_go
    s_waitcnt vmcnt(0)
    v_subrev_u32 v3, v4, v3
    v_cmp_lt_u32 vcc, 64, v3
    s_cbranch_vccz L_aw1_go
    s_sleep 4
    s_branch L_aw1
L_aw1_go:
    v_and_b32 v5, 63, v0
    v_lshlrev_b32 v1, 4, v5
    v_or_b32 v3, 128, v1
    v_lshrrev_b32 v4, 4, v5
    v_bfe_u32 v6, v5, 2, 2
    v_sub_u32 v4, v6, v4
    v_lshlrev_b32 v4, 3, v4
    v_and_b32 v6, 3, v5
    v_add_u32 v4, v4, v6
    v_mov_b32 v6, 0xf149f2ca
    s_mov_b32 s22, 0x3e0293ee
    s_lshl_b32 s18, s16, 5
    s_add_u32 s18, s18, s17
    s_lshl_b32 s19, s18, 13
    s_add_u32 s20, s19, 33554432
    buffer_load_dwordx4 v[8:11], v1, s[4:7], s20 offen offset:0 sc1
    s_add_u32 s20, s19, 33554432
    buffer_load_dwordx4 v[12:15], v1, s[4:7], s20 offen offset:1024 sc1
    s_add_u32 s20, s19, 33554432
    buffer_load_dwordx4 v[16:19], v1, s[4:7], s20 offen offset:2048 sc1
    s_add_u32 s20, s19, 33554432
    buffer_load_dwordx4 v[20:23], v1, s[4:7], s20 offen offset:3072 sc1
    s_add_u32 s20, s19, 33558528
    buffer_load_dwordx4 v[24:27], v1, s[4:7], s20 offen offset:0 sc1
    s_add_u32 s20, s19, 33558528
    buffer_load_dwordx4 v[28:31], v1, s[4:7], s20 offen offset:1024 sc1
    s_add_u32 s20, s19, 33558528
    buffer_load_dwordx4 v[32:35], v1, s[4:7], s20 offen offset:2048 sc1
    s_add_u32 s20, s19, 33558528
    buffer_load_dwordx4 v[36:39], v1, s[4:7], s20 offen offset:3072 sc1
    s_lshl_b32 s21, s18, 14
    s_add_u32 s20, s21, 0
    buffer_load_dwordx4 v[40:43], v1, s[4:7], s20 offen offset:0 sc1
    s_add_u32 s20, s21, 4096
    buffer_load_dwordx4 v[44:47], v1, s[4:7], s20 offen offset:0 sc1
    s_add_u32 s20, s21, 8192
    buffer_load_dwordx4 v[48:51], v1, s[4:7], s20 offen offset:0 sc1
    s_add_u32 s20, s21, 12288
    buffer_load_dwordx4 v[52:55], v1, s[4:7], s20 offen offset:0 sc1
    s_add_u32 s20, s21, 0
    buffer_load_dwordx4 v[56:59], v1, s[4:7], s20 offen offset:1024 sc1
    s_add_u32 s20, s21, 4096
    buffer_load_dwordx4 v[60:63], v1, s[4:7], s20 offen offset:1024 sc1
    s_add_u32 s20, s21, 8192
    buffer_load_dwordx4 v[64:67], v1, s[4:7], s20 offen offset:1024 sc1
    s_add_u32 s20, s21, 12288
    buffer_load_dwordx4 v[68:71], v1, s[4:7], s20 offen offset:1024 sc1
    s_add_u32 s20, s21, 0
    buffer_load_dwordx4 v[88:91], v1, s[4:7], s20 offen offset:2048 sc1
    s_add_u32 s20, s21, 4096
    buffer_load_dwordx4 v[92:95], v1, s[4:7], s20 offen offset:2048 sc1
    s_add_u32 s20, s21, 8192
    buffer_load_dwordx4 v[96:99], v1, s[4:7], s20 offen offset:2048 sc1
    s_add_u32 s20, s21, 12288
    buffer_load_dwordx4 v[100:103], v1, s[4:7], s20 offen offset:2048 sc1
    s_add_u32 s20, s21, 0
    buffer_load_dwordx4 v[104:107], v1, s[4:7], s20 offen offset:3072 sc1
    s_add_u32 s20, s21, 4096
    buffer_load_dwordx4 v[108:111], v1, s[4:7], s20 offen offset:3072 sc1
    s_add_u32 s20, s21, 8192
    buffer_load_dwordx4 v[112:115], v1, s[4:7], s20 offen offset:3072 sc1
    s_add_u32 s20, s21, 12288
    buffer_load_dwordx4 v[116:119], v1, s[4:7], s20 offen offset:3072 sc1
    v_mov_b32 v172, 0x3f803f80
    v_mov_b32 v173, 0x3f803f80
    v_mov_b32 v174, 0x3f803f80
    v_mov_b32 v175, 0x3f803f80
    v_mov_b32 v176, 0x3f003f00
    v_mov_b32 v177, 0x3f003f00
    s_waitcnt vmcnt(8)
    v_mfma_f32_16x16x32_bf16 v[136:139], v[40:43], v[8:11], 0
    v_mfma_f32_16x16x32_bf16 v[140:143], v[56:59], v[8:11], 0
    v_mfma_f32_16x16x32_bf16 v[148:151], v[40:43], v[24:27], 0
    v_mfma_f32_16x16x32_bf16 v[152:155], v[56:59], v[24:27], 0
    v_mfma_f32_16x16x32_bf16 v[136:139], v[44:47], v[12:15], v[136:139]
    v_mfma_f32_16x16x32_bf16 v[140:143], v[60:63], v[12:15], v[140:143]
    v_mfma_f32_16x16x32_bf16 v[148:151], v[44:47], v[28:31], v[148:151]
    v_mfma_f32_16x16x32_bf16 v[152:155], v[60:63], v[28:31], v[152:155]
    v_mfma_f32_16x16x32_bf16 v[136:139], v[48:51], v[16:19], v[136:139]
    v_mfma_f32_16x16x32_bf16 v[140:143], v[64:67], v[16:19], v[140:143]
    v_mfma_f32_16x16x32_bf16 v[148:151], v[48:51], v[32:35], v[148:151]
    v_mfma_f32_16x16x32_bf16 v[152:155], v[64:67], v[32:35], v[152:155]
    v_mfma_f32_16x16x32_bf16 v[136:139], v[52:55], v[20:23], v[136:139]
    v_mfma_f32_16x16x32_bf16 v[140:143], v[68:71], v[20:23], v[140:143]
    v_mfma_f32_16x16x32_bf16 v[148:151], v[52:55], v[36:39], v[148:151]
    v_mfma_f32_16x16x32_bf16 v[152:155], v[68:71], v[36:39], v[152:155]
    v_cmp_le_i32 vcc, 0, v4
    s_nop 1
    v_cndmask_b32 v136, v6, v136, vcc
    v_cmp_le_i32 vcc, 1, v4
    s_nop 1
    v_cndmask_b32 v137, v6, v137, vcc
    v_cmp_le_i32 vcc, 2, v4
    s_nop 1
    v_cndmask_b32 v138, v6, v138, vcc
    v_cmp_le_i32 vcc, 3, v4
    s_nop 1
    v_cndmask_b32 v139, v6, v139, vcc
    v_cmp_le_i32 vcc, 4, v4
    s_nop 1
    v_cndmask_b32 v140, v6, v140, vcc
    v_cmp_le_i32 vcc, 5, v4
    s_nop 1
    v_cndmask_b32 v141, v6, v141, vcc
    v_cmp_le_i32 vcc, 6, v4
    s_nop 1
    v_cndmask_b32 v142, v6, v142, vcc
    v_cmp_le_i32 vcc, 7, v4
    s_nop 1
    v_cndmask_b32 v143, v6, v143, vcc
    v_cmp_le_i32 vcc, -4, v4
    s_nop 1
    v_cndmask_b32 v148, v6, v148, vcc
    v_cmp_le_i32 vcc, -3, v4
    s_nop 1
    v_cndmask_b32 v149, v6, v149, vcc
    v_cmp_le_i32 vcc, -2, v4
    s_nop 1
    v_cndmask_b32 v150, v6, v150, vcc
    v_cmp_le_i32 vcc, -1, v4
    s_nop 1
    v_cndmask_b32 v151, v6, v151, vcc
    v_cmp_le_i32 vcc, 0, v4
    s_nop 1
    v_cndmask_b32 v152, v6, v152, vcc
    v_cmp_le_i32 vcc, 1, v4
    s_nop 1
    v_cndmask_b32 v153, v6, v153, vcc
    v_cmp_le_i32 vcc, 2, v4
    s_nop 1
    v_cndmask_b32 v154, v6, v154, vcc
    v_cmp_le_i32 vcc, 3, v4
    s_nop 1
    v_cndmask_b32 v155, v6, v155, vcc
    s_nop 1
    s_mov_b32 s88, 65536
cw11:
    buffer_load_dword v199, off, s[4:7], s36 offset:128 sc1
    s_waitcnt vmcnt(0)
    v_readfirstlane_b32 s42, v199
    s_nop 0
    s_sub_u32 s42, s42, s95
    s_cmp_gt_u32 s42, 64
    s_cselect_b32 s42, 0, s42
    s_add_u32 s42, s42, 2
    s_cmp_ge_u32 s42, s16
    s_cbranch_scc1 cw11x
    s_sub_u32 s88, s88, 1
    s_cbranch_scc1 cw11x
    s_sub_u32 s42, s16, s42
    s_min_u32 s42, s42, 6
cw11s:
    s_sleep 24
    s_sub_u32 s42, s42, 1
    s_cmp_lg_u32 s42, 0
    s_cbranch_scc1 cw11s
    s_branch cw11
cw11x:
    s_and_b32 s37, s16, 1
    s_lshl_b32 s37, s37, 2
    s_add_u32 s37, s37, s36
    s_add_u32 s37, s37, 128
    s_add_u32 s41, s16, s95
    s_add_u32 s41, s41, 1
    s_lshl_b32 s42, s17, 7
    s_add_u32 s42, s42, 125845504
    s_cmp_ge_u32 s16, 62
    s_cselect_b32 s37, s42, s37
    s_cselect_b32 s42, 12, 8
    v_lshlrev_b32 v198, 2, v0
    v_and_b32 v198, s42, v198
    s_mov_b32 s40, 4194304
L_aw2:
    buffer_load_dword v199, v198, s[4:7], s37 offen sc1
    s_sub_u32 s40, s40, 1
    s_cbranch_scc1 L_aw2_go
    s_waitcnt vmcnt(0)
    v_subrev_u32 v199, s41, v199
    v_cmp_lt_u32 vcc, 64, v199
    s_cbranch_vccz L_aw2_go
    s_sleep 3
    s_branch L_aw2
L_aw2_go:
    s_lshl_b32 s20, s18, 12
    s_add_u32 s20, s20, 71303168
    buffer_load_dwordx4 v[72:75], v3, s[4:7], s20 offen offset:0 sc1
    buffer_load_dwordx4 v[76:79], v3, s[4:7], s20 offen offset:1024 sc1
    buffer_load_dwordx4 v[80:83], v3, s[4:7], s20 offen offset:2048 sc1
    buffer_load_dwordx4 v[84:87], v3, s[4:7], s20 offen offset:3072 sc1
    s_lshl_b32 s20, s18, 12
    s_add_u32 s20, s20, 80740352
    buffer_load_dwordx4 v[120:123], v1, s[4:7], s20 offen offset:0 sc1
    buffer_load_dwordx4 v[124:127], v1, s[4:7], s20 offen offset:1024 sc1
    buffer_load_dwordx4 v[128:131], v1, s[4:7], s20 offen offset:2048 sc1
    buffer_load_dwordx4 v[132:135], v1, s[4:7], s20 offen offset:3072 sc1
    s_waitcnt vmcnt(4)
    v_mfma_f32_16x16x32_bf16 v[144:147], v[72:75], v[8:11], 0
    v_mfma_f32_16x16x32_bf16 v[156:159], v[72:75], v[24:27], 0
    v_mfma_f32_16x16x32_bf16 v[144:147], v[76:79], v[12:15], v[144:147]
    v_mfma_f32_16x16x32_bf16 v[156:159], v[76:79], v[28:31], v[156:159]
    v_mfma_f32_16x16x32_bf16 v[144:147], v[80:83], v[16:19], v[144:147]
    v_mfma_f32_16x16x32_bf16 v[156:159], v[80:83], v[32:35], v[156:159]
    v_mfma_f32_16x16x32_bf16 v[144:147], v[84:87], v[20:23], v[144:147]
    v_mfma_f32_16x16x32_bf16 v[156:159], v[84:87], v[36:39], v[156:159]
    v_max3_f32 v196, v136, v137, v138
    v_max3_f32 v197, v139, v140, v141
    v_max3_f32 v196, v196, v142, v143
    v_max3_f32 v197, v197, v144, v145
    v_max3_f32 v196, v196, v146, v147
    v_max_f32 v196, v196, v197
    v_mov_b32 v197, v196
    s_nop 1
    v_permlane32_swap_b32 v196, v197
    v_max_f32 v196, v196, v197
    v_mov_b32 v197, v196
    s_nop 1
    v_permlane16_swap_b32 v196, v197
    v_max_f32 v196, v196, v197
    v_mul_f32 v196, s22, v196
    v_sub_f32 v196, 0, v196
    v_fma_f32 v136, v136, s22, v196
    v_fma_f32 v137, v137, s22, v196
    v_fma_f32 v138, v138, s22, v196
    v_fma_f32 v139, v139, s22, v196
    v_fma_f32 v140, v140, s22, v196
    v_fma_f32 v141, v141, s22, v196
    v_fma_f32 v142, v142, s22, v196
    v_fma_f32 v143, v143, s22, v196
    v_fma_f32 v144, v144, s22, v196
    v_fma_f32 v145, v145, s22, v196
    v_fma_f32 v146, v146, s22, v196
    v_fma_f32 v147, v147, s22, v196
    v_exp_f32 v136, v136
    v_exp_f32 v137, v137
    v_exp_f32 v138, v138
    v_exp_f32 v139, v139
    v_exp_f32 v140, v140
    v_exp_f32 v141, v141
    v_exp_f32 v142, v142
    v_exp_f32 v143, v143
    v_exp_f32 v144, v144
    v_exp_f32 v145, v145
    v_exp_f32 v146, v146
    v_exp_f32 v147, v147
    v_cvt_pk_bf16_f32 v160, v136, v137
    v_cvt_pk_bf16_f32 v161, v138, v139
    v_cvt_pk_bf16_f32 v162, v140, v141
    v_cvt_pk_bf16_f32 v163, v142, v143
    v_cvt_pk_bf16_f32 v164, v144, v145
    v_cvt_pk_bf16_f32 v165, v146, v147
    v_max3_f32 v196, v148, v149, v150
    v_max3_f32 v197, v151, v152, v153
    v_max3_f32 v196, v196, v154, v155
    v_max3_f32 v197, v197, v156, v157
    v_max3_f32 v196, v196, v158, v159
    v_max_f32 v196, v196, v197
    v_mov_b32 v197, v196
    s_nop 1
    v_permlane32_swap_b32 v196, v197
    v_max_f32 v196, v196, v197
    v_mov_b32 v197, v196
    s_nop 1
    v_permlane16_swap_b32 v196, v197
    v_max_f32 v196, v196, v197
    v_mul_f32 v196, s22, v196
    v_sub_f32 v196, 0, v196
    v_fma_f32 v148, v148, s22, v196
    v_fma_f32 v149, v149, s22, v196
    v_fma_f32 v150, v150, s22, v196
    v_fma_f32 v151, v151, s22, v196
    v_fma_f32 v152, v152, s22, v196
    v_fma_f32 v153, v153, s22, v196
    v_fma_f32 v154, v154, s22, v196
    v_fma_f32 v155, v155, s22, v196
    v_fma_f32 v156, v156, s22, v196
    v_fma_f32 v157, v157, s22, v196
    v_fma_f32 v158, v158, s22, v196
    v_fma_f32 v159, v159, s22, v196
    v_exp_f32 v148, v148
    v_exp_f32 v149, v149
    v_exp_f32 v150, v150
    v_exp_f32 v151, v151
    v_exp_f32 v152, v152
    v_exp_f32 v153, v153
    v_exp_f32 v154, v154
    v_exp_f32 v155, v155
    v_exp_f32 v156, v156
    v_exp_f32 v157, v157
    v_exp_f32 v158, v158
    v_exp_f32 v159, v159
    v_cvt_pk_bf16_f32 v166, v148, v149
    v_cvt_pk_bf16_f32 v167, v150, v151
    v_cvt_pk_bf16_f32 v168, v152, v153
    v_cvt_pk_bf16_f32 v169, v154, v155
    v_cvt_pk_bf16_f32 v170, v156, v157
    v_cvt_pk_bf16_f32 v171, v158, v159
    v_mfma_f32_16x16x32_bf16 v[180:183], v[172:175], v[160:163], 0
    v_mfma_f32_16x16x32_bf16 v[184:187], v[172:175], v[166:169], 0
    v_mfma_f32_16x16x16_bf16 v[180:183], v[176:177], v[164:165], v[180:183]
    v_mfma_f32_16x16x16_bf16 v[184:187], v[176:177], v[170:171], v[184:187]
    s_nop 3
    v_rcp_f32 v180, v180
    s_nop 2
    v_rcp_f32 v184, v184
    s_waitcnt vmcnt(0)
    s_lshl_b32 s18, s16, 18
    s_lshl_b32 s19, s17, 12
    s_add_u32 s18, s18, s19
    s_add_u32 s18, s18, 50331648
    s_add_u32 s19, s18, 131072
    v_mfma_f32_16x16x32_bf16 v[8:11], v[88:91], v[160:163], 0
    v_mfma_f32_16x16x32_bf16 v[12:15], v[104:107], v[160:163], 0
    v_mfma_f32_16x16x32_bf16 v[16:19], v[88:91], v[166:169], 0
    v_mfma_f32_16x16x32_bf16 v[20:23], v[104:107], v[166:169], 0
    v_mfma_f32_16x16x32_bf16 v[24:27], v[92:95], v[160:163], 0
    v_mfma_f32_16x16x32_bf16 v[28:31], v[108:111], v[160:163], 0
    v_mfma_f32_16x16x32_bf16 v[32:35], v[92:95], v[166:169], 0
    v_mfma_f32_16x16x32_bf16 v[36:39], v[108:111], v[166:169], 0
    v_mfma_f32_16x16x32_bf16 v[40:43], v[96:99], v[160:163], 0
    v_mfma_f32_16x16x32_bf16 v[44:47], v[112:115], v[160:163], 0
    v_mfma_f32_16x16x32_bf16 v[48:51], v[96:99], v[166:169], 0
    v_mfma_f32_16x16x32_bf16 v[52:55], v[112:115], v[166:169], 0
    v_mfma_f32_16x16x32_bf16 v[56:59], v[100:103], v[160:163], 0
    v_mfma_f32_16x16x32_bf16 v[60:63], v[116:119], v[160:163], 0
    v_mfma_f32_16x16x32_bf16 v[64:67], v[100:103], v[166:169], 0
    v_mfma_f32_16x16x32_bf16 v[68:71], v[116:119], v[166:169], 0
    v_mfma_f32_16x16x16_bf16 v[8:11], v[120:121], v[164:165], v[8:11]
    v_mfma_f32_16x16x16_bf16 v[12:15], v[122:123], v[164:165], v[12:15]
    v_mfma_f32_16x16x16_bf16 v[16:19], v[120:121], v[170:171], v[16:19]
    v_mfma_f32_16x16x16_bf16 v[20:23], v[122:123], v[170:171], v[20:23]
    v_mfma_f32_16x16x16_bf16 v[24:27], v[124:125], v[164:165], v[24:27]
    v_mfma_f32_16x16x16_bf16 v[28:31], v[126:127], v[164:165], v[28:31]
    v_mfma_f32_16x16x16_bf16 v[32:35], v[124:125], v[170:171], v[32:35]
    v_mfma_f32_16x16x16_bf16 v[36:39], v[126:127], v[170:171], v[36:39]
    v_mfma_f32_16x16x16_bf16 v[40:43], v[128:129], v[164:165], v[40:43]
    v_mfma_f32_16x16x16_bf16 v[44:47], v[130:131], v[164:165], v[44:47]
    v_mfma_f32_16x16x16_bf16 v[48:51], v[128:129], v[170:171], v[48:51]
    v_mfma_f32_16x16x16_bf16 v[52:55], v[130:131], v[170:171], v[52:55]
    v_mfma_f32_16x16x16_bf16 v[56:59], v[132:133], v[164:165], v[56:59]
    v_mfma_f32_16x16x16_bf16 v[60:63], v[134:135], v[164:165], v[60:63]
    v_mfma_f32_16x16x16_bf16 v[64:67], v[132:133], v[170:171], v[64:67]
    v_mfma_f32_16x16x16_bf16 v[68:71], v[134:135], v[170:171], v[68:71]
    v_mul_f32 v8, v8, v180
    v_mul_f32 v12, v12, v180
    v_mul_f32 v9, v9, v180
    v_mul_f32 v13, v13, v180
    v_mul_f32 v10, v10, v180
    v_mul_f32 v14, v14, v180
    v_mul_f32 v11, v11, v180
    v_mul_f32 v15, v15, v180
    v_cvt_pk_bf16_f32 v8, v8, v9
    v_cvt_pk_bf16_f32 v9, v10, v11
    v_cvt_pk_bf16_f32 v10, v12, v13
    v_cvt_pk_bf16_f32 v11, v14, v15
    buffer_store_dwordx4 v[8:11], v1, s[4:7], s18 offen offset:0 sc1
    v_mul_f32 v16, v16, v184
    v_mul_f32 v20, v20, v184
    v_mul_f32 v17, v17, v184
    v_mul_f32 v21, v21, v184
    v_mul_f32 v18, v18, v184
    v_mul_f32 v22, v22, v184
    v_mul_f32 v19, v19, v184
    v_mul_f32 v23, v23, v184
    v_cvt_pk_bf16_f32 v16, v16, v17
    v_cvt_pk_bf16_f32 v17, v18, v19
    v_cvt_pk_bf16_f32 v18, v20, v21
    v_cvt_pk_bf16_f32 v19, v22, v23
    buffer_store_dwordx4 v[16:19], v1, s[4:7], s19 offen offset:0 sc1
    v_mul_f32 v24, v24, v180
    v_mul_f32 v28, v28, v180
    v_mul_f32 v25, v25, v180
    v_mul_f32 v29, v29, v180
    v_mul_f32 v26, v26, v180
    v_mul_f32 v30, v30, v180
    v_mul_f32 v27, v27, v180
    v_mul_f32 v31, v31, v180
    v_cvt_pk_bf16_f32 v24, v24, v25
    v_cvt_pk_bf16_f32 v25, v26, v27
    v_cvt_pk_bf16_f32 v26, v28, v29
    v_cvt_pk_bf16_f32 v27, v30, v31
    buffer_store_dwordx4 v[24:27], v1, s[4:7], s18 offen offset:1024 sc1
    v_mul_f32 v32, v32, v184
    v_mul_f32 v36, v36, v184
    v_mul_f32 v33, v33, v184
    v_mul_f32 v37, v37, v184
    v_mul_f32 v34, v34, v184
    v_mul_f32 v38, v38, v184
    v_mul_f32 v35, v35, v184
    v_mul_f32 v39, v39, v184
    v_cvt_pk_bf16_f32 v32, v32, v33
    v_cvt_pk_bf16_f32 v33, v34, v35
    v_cvt_pk_bf16_f32 v34, v36, v37
    v_cvt_pk_bf16_f32 v35, v38, v39
    buffer_store_dwordx4 v[32:35], v1, s[4:7], s19 offen offset:1024 sc1
    v_mul_f32 v40, v40, v180
    v_mul_f32 v44, v44, v180
    v_mul_f32 v41, v41, v180
    v_mul_f32 v45, v45, v180
    v_mul_f32 v42, v42, v180
    v_mul_f32 v46, v46, v180
    v_mul_f32 v43, v43, v180
    v_mul_f32 v47, v47, v180
    v_cvt_pk_bf16_f32 v40, v40, v41
    v_cvt_pk_bf16_f32 v41, v42, v43
    v_cvt_pk_bf16_f32 v42, v44, v45
    v_cvt_pk_bf16_f32 v43, v46, v47
    buffer_store_dwordx4 v[40:43], v1, s[4:7], s18 offen offset:2048 sc1
    v_mul_f32 v48, v48, v184
    v_mul_f32 v52, v52, v184
    v_mul_f32 v49, v49, v184
    v_mul_f32 v53, v53, v184
    v_mul_f32 v50, v50, v184
    v_mul_f32 v54, v54, v184
    v_mul_f32 v51, v51, v184
    v_mul_f32 v55, v55, v184
    v_cvt_pk_bf16_f32 v48, v48, v49
    v_cvt_pk_bf16_f32 v49, v50, v51
    v_cvt_pk_bf16_f32 v50, v52, v53
    v_cvt_pk_bf16_f32 v51, v54, v55
    buffer_store_dwordx4 v[48:51], v1, s[4:7], s19 offen offset:2048 sc1
    v_mul_f32 v56, v56, v180
    v_mul_f32 v60, v60, v180
    v_mul_f32 v57, v57, v180
    v_mul_f32 v61, v61, v180
    v_mul_f32 v58, v58, v180
    v_mul_f32 v62, v62, v180
    v_mul_f32 v59, v59, v180
    v_mul_f32 v63, v63, v180
    v_cvt_pk_bf16_f32 v56, v56, v57
    v_cvt_pk_bf16_f32 v57, v58, v59
    v_cvt_pk_bf16_f32 v58, v60, v61
    v_cvt_pk_bf16_f32 v59, v62, v63
    buffer_store_dwordx4 v[56:59], v1, s[4:7], s18 offen offset:3072 sc1
    v_mul_f32 v64, v64, v184
    v_mul_f32 v68, v68, v184
    v_mul_f32 v65, v65, v184
    v_mul_f32 v69, v69, v184
    v_mul_f32 v66, v66, v184
    v_mul_f32 v70, v70, v184
    v_mul_f32 v67, v67, v184
    v_mul_f32 v71, v71, v184
    v_cvt_pk_bf16_f32 v64, v64, v65
    v_cvt_pk_bf16_f32 v65, v66, v67
    v_cvt_pk_bf16_f32 v66, v68, v69
    v_cvt_pk_bf16_f32 v67, v70, v71
    buffer_store_dwordx4 v[64:67], v1, s[4:7], s19 offen offset:3072 sc1
    s_lshr_b32 s40, s34, 1
    s_lshl_b32 s40, s40, 7
    s_and_b32 s41, s17, 7
    s_lshl_b32 s41, s41, 2
    s_add_u32 s40, s40, s41
    s_add_u32 s40, s40, 125894656
    v_mov_b32 v250, s95
    s_waitcnt vmcnt(0)
    s_mov_b64 exec, 1
    buffer_store_dword v250, off, s[4:7], s40 sc1
    s_mov_b64 exec, -1
    s_add_u32 s34, s34, 48
    s_cmp_lt_u32 s34, 512
    s_cbranch_scc1 L_att_next
    s_branch L_done
L_op_start:
    s_sub_u32 s34, s34, 48
    s_mul_hi_u32 s16, s34, 0x0e38e38f
    s_mul_i32 s41, s16, 18
    s_sub_u32 s33, s34, s41
    v_and_b32 v2, 63, v0
    v_lshlrev_b32 v1, 4, v2
    v_lshrrev_b32 v5, 2, v2
    v_mul_u32_u24 v3, 1152, v5
    v_and_b32 v5, 3, v2
    v_lshl_add_u32 v3, v5, 4, v3
    s_lshl_b32 s21, s32, 12
    v_add_u32 v4, s21, v1
    s_mov_b64 s[12:13], s[58:59]
    s_mov_b32 s14, 4718592
    s_mov_b32 s15, 0x20000
    s_mul_i32 s19, s32, 1179648
    s_lshl_b32 s18, s33, 6
    s_add_u32 s19, s19, s18
    s_add_u32 s18, s19, 0
    s_add_u32 m0, s21, 0
    s_nop 0
    buffer_load_dwordx4 v3, s[12:15], s18 offen lds
    s_add_u32 m0, s21, 1024
    s_add_u32 s18, s18, 18432
    buffer_load_dwordx4 v3, s[12:15], s18 offen lds
    s_add_u32 m0, s21, 2048
    s_add_u32 s18, s18, 18432
    buffer_load_dwordx4 v3, s[12:15], s18 offen lds
    s_add_u32 m0, s21, 3072
    s_add_u32 s18, s18, 18432
    buffer_load_dwordx4 v3, s[12:15], s18 offen lds
    s_add_u32 s18, s19, 73728
    s_add_u32 m0, s21, 16384
    s_nop 0
    buffer_load_dwordx4 v3, s[12:15], s18 offen lds
    s_add_u32 m0, s21, 17408
    s_add_u32 s18, s18, 18432
    buffer_load_dwordx4 v3, s[12:15], s18 offen lds
    s_add_u32 m0, s21, 18432
    s_add_u32 s18, s18, 18432
    buffer_load_dwordx4 v3, s[12:15], s18 offen lds
    s_add_u32 m0, s21, 19456
    s_add_u32 s18, s18, 18432
    buffer_load_dwordx4 v3, s[12:15], s18 offen lds
    s_add_u32 s18, s19, 147456
    s_add_u32 m0, s21, 32768
    s_nop 0
    buffer_load_dwordx4 v3, s[12:15], s18 offen lds
    s_add_u32 m0, s21, 33792
    s_add_u32 s18, s18, 18432
    buffer_load_dwordx4 v3, s[12:15], s18 offen lds
    s_add_u32 m0, s21, 34816
    s_add_u32 s18, s18, 18432
    buffer_load_dwordx4 v3, s[12:15], s18 offen lds
    s_add_u32 m0, s21, 35840
    s_add_u32 s18, s18, 18432
    buffer_load_dwordx4 v3, s[12:15], s18 offen lds
    s_add_u32 s18, s19, 221184
    s_add_u32 m0, s21, 49152
    s_nop 0
    buffer_load_dwordx4 v3, s[12:15], s18 offen lds
    s_add_u32 m0, s21, 50176
    s_add_u32 s18, s18, 18432
    buffer_load_dwordx4 v3, s[12:15], s18 offen lds
    s_add_u32 m0, s21, 51200
    s_add_u32 s18, s18, 18432
    buffer_load_dwordx4 v3, s[12:15], s18 offen lds
    s_add_u32 m0, s21, 52224
    s_add_u32 s18, s18, 18432
    buffer_load_dwordx4 v3, s[12:15], s18 offen lds
    s_add_u32 s18, s19, 294912
    s_add_u32 m0, s21, 65536
    s_nop 0
    buffer_load_dwordx4 v3, s[12:15], s18 offen lds
    s_add_u32 m0, s21, 66560
    s_add_u32 s18, s18, 18432
    buffer_load_dwordx4 v3, s[12:15], s18 offen lds
    s_add_u32 m0, s21, 67584
    s_add_u32 s18, s18, 18432
    buffer_load_dwordx4 v3, s[12:15], s18 offen lds
    s_add_u32 m0, s21, 68608
    s_add_u32 s18, s18, 18432
    buffer_load_dwordx4 v3, s[12:15], s18 offen lds
    s_add_u32 s18, s19, 368640
    s_add_u32 m0, s21, 81920
    s_nop 0
    buffer_load_dwordx4 v3, s[12:15], s18 offen lds
    s_add_u32 m0, s21, 82944
    s_add_u32 s18, s18, 18432
    buffer_load_dwordx4 v3, s[12:15], s18 offen lds
    s_add_u32 m0, s21, 83968
    s_add_u32 s18, s18, 18432
    buffer_load_dwordx4 v3, s[12:15], s18 offen lds
    s_add_u32 m0, s21, 84992
    s_add_u32 s18, s18, 18432
    buffer_load_dwordx4 v3, s[12:15], s18 offen lds
    s_add_u32 s18, s19, 442368
    s_add_u32 m0, s21, 98304
    s_nop 0
    buffer_load_dwordx4 v3, s[12:15], s18 offen lds
    s_add_u32 m0, s21, 99328
    s_add_u32 s18, s18, 18432
    buffer_load_dwordx4 v3, s[12:15], s18 offen lds
    s_add_u32 m0, s21, 100352
    s_add_u32 s18, s18, 18432
    buffer_load_dwordx4 v3, s[12:15], s18 offen lds
    s_add_u32 m0, s21, 101376
    s_add_u32 s18, s18, 18432
    buffer_load_dwordx4 v3, s[12:15], s18 offen lds
    s_add_u32 s18, s19, 516096
    s_add_u32 m0, s21, 114688
    s_nop 0
    buffer_load_dwordx4 v3, s[12:15], s18 offen lds
    s_add_u32 m0, s21, 115712
    s_add_u32 s18, s18, 18432
    buffer_load_dwordx4 v3, s[12:15], s18 offen lds
    s_add_u32 m0, s21, 116736
    s_add_u32 s18, s18, 18432
    buffer_load_dwordx4 v3, s[12:15], s18 offen lds
    s_add_u32 m0, s21, 117760
    s_add_u32 s18, s18, 18432
    buffer_load_dwordx4 v3, s[12:15], s18 offen lds
    s_add_u32 s18, s19, 589824
    s_add_u32 m0, s21, 131072
    s_nop 0
    buffer_load_dwordx4 v3, s[12:15], s18 offen lds
    s_add_u32 m0, s21, 132096
    s_add_u32 s18, s18, 18432
    buffer_load_dwordx4 v3, s[12:15], s18 offen lds
    s_add_u32 m0, s21, 133120
    s_add_u32 s18, s18, 18432
    buffer_load_dwordx4 v3, s[12:15], s18 offen lds
    s_add_u32 m0, s21, 134144
    s_add_u32 s18, s18, 18432
    buffer_load_dwordx4 v3, s[12:15], s18 offen lds
    v_add_u32 v6, 0, v4
    v_xor_b32 v7, 32, v6
    s_waitcnt vmcnt(32)
    ds_read_b64_tr_b16 a[0:1], v6 offset:0
    ds_read_b64_tr_b16 a[2:3], v6 offset:1024
    ds_read_b64_tr_b16 a[4:5], v6 offset:8
    ds_read_b64_tr_b16 a[6:7], v6 offset:1032
    ds_read_b64_tr_b16 a[8:9], v6 offset:2048
    ds_read_b64_tr_b16 a[10:11], v6 offset:3072
    ds_read_b64_tr_b16 a[12:13], v6 offset:2056
    ds_read_b64_tr_b16 a[14:15], v6 offset:3080
    s_waitcnt lgkmcnt(0)
    s_add_u32 s18, s19, 663552
    s_add_u32 m0, s21, 0
    s_nop 0
    buffer_load_dwordx4 v3, s[12:15], s18 offen lds
    s_add_u32 m0, s21, 1024
    s_add_u32 s18, s18, 18432
    buffer_load_dwordx4 v3, s[12:15], s18 offen lds
    s_add_u32 m0, s21, 2048
    s_add_u32 s18, s18, 18432
    buffer_load_dwordx4 v3, s[12:15], s18 offen lds
    s_add_u32 m0, s21, 3072
    s_add_u32 s18, s18, 18432
    buffer_load_dwordx4 v3, s[12:15], s18 offen lds
    v_add_u32 v6, 16384, v4
    v_xor_b32 v7, 32, v6
    s_waitcnt vmcnt(32)
    ds_read_b64_tr_b16 a[16:17], v6 offset:0
    ds_read_b64_tr_b16 a[18:19], v6 offset:1024
    ds_read_b64_tr_b16 a[20:21], v6 offset:8
    ds_read_b64_tr_b16 a[22:23], v6 offset:1032
    ds_read_b64_tr_b16 a[24:25], v6 offset:2048
    ds_read_b64_tr_b16 a[26:27], v6 offset:3072
    ds_read_b64_tr_b16 a[28:29], v6 offset:2056
    ds_read_b64_tr_b16 a[30:31], v6 offset:3080
    s_waitcnt lgkmcnt(0)
    s_add_u32 s18, s19, 737280
    s_add_u32 m0, s21, 16384
    s_nop 0
    buffer_load_dwordx4 v3, s[12:15], s18 offen lds
    s_add_u32 m0, s21, 17408
    s_add_u32 s18, s18, 18432
    buffer_load_dwordx4 v3, s[12:15], s18 offen lds
    s_add_u32 m0, s21, 18432
    s_add_u32 s18, s18, 18432
    buffer_load_dwordx4 v3, s[12:15], s18 offen lds
    s_add_u32 m0, s21, 19456
    s_add_u32 s18, s18, 18432
    buffer_load_dwordx4 v3, s[12:15], s18 offen lds
    v_add_u32 v6, 32768, v4
    v_xor_b32 v7, 32, v6
    s_waitcnt vmcnt(32)
    ds_read_b64_tr_b16 a[32:33], v6 offset:0
    ds_read_b64_tr_b16 a[34:35], v6 offset:1024
    ds_read_b64_tr_b16 a[36:37], v6 offset:8
    ds_read_b64_tr_b16 a[38:39], v6 offset:1032
    ds_read_b64_tr_b16 a[40:41], v6 offset:2048
    ds_read_b64_tr_b16 a[42:43], v6 offset:3072
    ds_read_b64_tr_b16 a[44:45], v6 offset:2056
    ds_read_b64_tr_b16 a[46:47], v6 offset:3080
    s_waitcnt lgkmcnt(0)
    s_add_u32 s18, s19, 811008
    s_add_u32 m0, s21, 32768
    s_nop 0
    buffer_load_dwordx4 v3, s[12:15], s18 offen lds
    s_add_u32 m0, s21, 33792
    s_add_u32 s18, s18, 18432
    buffer_load_dwordx4 v3, s[12:15], s18 offen lds
    s_add_u32 m0, s21, 34816
    s_add_u32 s18, s18, 18432
    buffer_load_dwordx4 v3, s[12:15], s18 offen lds
    s_add_u32 m0, s21, 35840
    s_add_u32 s18, s18, 18432
    buffer_load_dwordx4 v3, s[12:15], s18 offen lds
    v_add_u32 v6, 49152, v4
    v_xor_b32 v7, 32, v6
    s_waitcnt vmcnt(32)
    ds_read_b64_tr_b16 a[48:49], v6 offset:0
    ds_read_b64_tr_b16 a[50:51], v6 offset:1024
    ds_read_b64_tr_b16 a[52:53], v6 offset:8
    ds_read_b64_tr_b16 a[54:55], v6 offset:1032
    ds_read_b64_tr_b16 a[56:57], v6 offset:2048
    ds_read_b64_tr_b16 a[58:59], v6 offset:3072
    ds_read_b64_tr_b16 a[60:61], v6 offset:2056
    ds_read_b64_tr_b16 a[62:63], v6 offset:3080
    s_waitcnt lgkmcnt(0)
    s_add_u32 s18, s19, 884736
    s_add_u32 m0, s21, 49152
    s_nop 0
    buffer_load_dwordx4 v3, s[12:15], s18 offen lds
    s_add_u32 m0, s21, 50176
    s_add_u32 s18, s18, 18432
    buffer_load_dwordx4 v3, s[12:15], s18 offen lds
    s_add_u32 m0, s21, 51200
    s_add_u32 s18, s18, 18432
    buffer_load_dwordx4 v3, s[12:15], s18 offen lds
    s_add_u32 m0, s21, 52224
    s_add_u32 s18, s18, 18432
    buffer_load_dwordx4 v3, s[12:15], s18 offen lds
    v_add_u32 v6, 65536, v4
    v_xor_b32 v7, 32, v6
    s_waitcnt vmcnt(32)
    ds_read_b64_tr_b16 a[64:65], v6 offset:0
    ds_read_b64_tr_b16 a[66:67], v6 offset:1024
    ds_read_b64_tr_b16 a[68:69], v6 offset:8
    ds_read_b64_tr_b16 a[70:71], v6 offset:1032
    ds_read_b64_tr_b16 a[72:73], v6 offset:2048
    ds_read_b64_tr_b16 a[74:75], v6 offset:3072
    ds_read_b64_tr_b16 a[76:77], v6 offset:2056
    ds_read_b64_tr_b16 a[78:79], v6 offset:3080
    s_waitcnt lgkmcnt(0)
    s_add_u32 s18, s19, 958464
    s_add_u32 m0, s21, 65536
    s_nop 0
    buffer_load_dwordx4 v3, s[12:15], s18 offen lds
    s_add_u32 m0, s21, 66560
    s_add_u32 s18, s18, 18432
    buffer_load_dwordx4 v3, s[12:15], s18 offen lds
    s_add_u32 m0, s21, 67584
    s_add_u32 s18, s18, 18432
    buffer_load_dwordx4 v3, s[12:15], s18 offen lds
    s_add_u32 m0, s21, 68608
    s_add_u32 s18, s18, 18432
    buffer_load_dwordx4 v3, s[12:15], s18 offen lds
    v_add_u32 v6, 81920, v4
    v_xor_b32 v7, 32, v6
    s_waitcnt vmcnt(32)
    ds_read_b64_tr_b16 a[80:81], v6 offset:0
    ds_read_b64_tr_b16 a[82:83], v6 offset:1024
    ds_read_b64_tr_b16 a[84:85], v6 offset:8
    ds_read_b64_tr_b16 a[86:87], v6 offset:1032
    ds_read_b64_tr_b16 a[88:89], v6 offset:2048
    ds_read_b64_tr_b16 a[90:91], v6 offset:3072
    ds_read_b64_tr_b16 a[92:93], v6 offset:2056
    ds_read_b64_tr_b16 a[94:95], v6 offset:3080
    s_waitcnt lgkmcnt(0)
    s_add_u32 s18, s19, 1032192
    s_add_u32 m0, s21, 81920
    s_nop 0
    buffer_load_dwordx4 v3, s[12:15], s18 offen lds
    s_add_u32 m0, s21, 82944
    s_add_u32 s18, s18, 18432
    buffer_load_dwordx4 v3, s[12:15], s18 offen lds
    s_add_u32 m0, s21, 83968
    s_add_u32 s18, s18, 18432
    buffer_load_dwordx4 v3, s[12:15], s18 offen lds
    s_add_u32 m0, s21, 84992
    s_add_u32 s18, s18, 18432
    buffer_load_dwordx4 v3, s[12:15], s18 offen lds
    v_add_u32 v6, 98304, v4
    v_xor_b32 v7, 32, v6
    s_waitcnt vmcnt(32)
    ds_read_b64_tr_b16 a[96:97], v6 offset:0
    ds_read_b64_tr_b16 a[98:99], v6 offset:1024
    ds_read_b64_tr_b16 a[100:101], v6 offset:8
    ds_read_b64_tr_b16 a[102:103], v6 offset:1032
    ds_read_b64_tr_b16 a[104:105], v6 offset:2048
    ds_read_b64_tr_b16 a[106:107], v6 offset:3072
    ds_read_b64_tr_b16 a[108:109], v6 offset:2056
    ds_read_b64_tr_b16 a[110:111], v6 offset:3080
    s_waitcnt lgkmcnt(0)
    s_add_u32 s18, s19, 1105920
    s_add_u32 m0, s21, 98304
    s_nop 0
    buffer_load_dwordx4 v3, s[12:15], s18 offen lds
    s_add_u32 m0, s21, 99328
    s_add_u32 s18, s18, 18432
    buffer_load_dwordx4 v3, s[12:15], s18 offen lds
    s_add_u32 m0, s21, 100352
    s_add_u32 s18, s18, 18432
    buffer_load_dwordx4 v3, s[12:15], s18 offen lds
    s_add_u32 m0, s21, 101376
    s_add_u32 s18, s18, 18432
    buffer_load_dwordx4 v3, s[12:15], s18 offen lds
    v_add_u32 v6, 114688, v4
    v_xor_b32 v7, 32, v6
    s_waitcnt vmcnt(32)
    ds_read_b64_tr_b16 a[112:113], v6 offset:0
    ds_read_b64_tr_b16 a[114:115], v6 offset:1024
    ds_read_b64_tr_b16 a[116:117], v6 offset:8
    ds_read_b64_tr_b16 a[118:119], v6 offset:1032
    ds_read_b64_tr_b16 a[120:121], v6 offset:2048
    ds_read_b64_tr_b16 a[122:123], v6 offset:3072
    ds_read_b64_tr_b16 a[124:125], v6 offset:2056
    ds_read_b64_tr_b16 a[126:127], v6 offset:3080
    s_waitcnt lgkmcnt(0)
    v_add_u32 v6, 131072, v4
    v_xor_b32 v7, 32, v6
    s_waitcnt vmcnt(28)
    ds_read_b64_tr_b16 a[128:129], v6 offset:0
    ds_read_b64_tr_b16 a[130:131], v6 offset:1024
    ds_read_b64_tr_b16 a[132:133], v6 offset:8
    ds_read_b64_tr_b16 a[134:135], v6 offset:1032
    ds_read_b64_tr_b16 a[136:137], v6 offset:2048
    ds_read_b64_tr_b16 a[138:139], v6 offset:3072
    ds_read_b64_tr_b16 a[140:141], v6 offset:2056
    ds_read_b64_tr_b16 a[142:143], v6 offset:3080
    s_waitcnt lgkmcnt(0)
    v_add_u32 v6, 0, v4
    v_xor_b32 v7, 32, v6
    s_waitcnt vmcnt(24)
    ds_read_b64_tr_b16 a[144:145], v6 offset:0
    ds_read_b64_tr_b16 a[146:147], v6 offset:1024
    ds_read_b64_tr_b16 a[148:149], v6 offset:8
    ds_read_b64_tr_b16 a[150:151], v6 offset:1032
    ds_read_b64_tr_b16 a[152:153], v6 offset:2048
    ds_read_b64_tr_b16 a[154:155], v6 offset:3072
    ds_read_b64_tr_b16 a[156:157], v6 offset:2056
    ds_read_b64_tr_b16 a[158:159], v6 offset:3080
    s_waitcnt lgkmcnt(0)
    v_add_u32 v6, 16384, v4
    v_xor_b32 v7, 32, v6
    s_waitcnt vmcnt(20)
    ds_read_b64_tr_b16 a[160:161], v6 offset:0
    ds_read_b64_tr_b16 a[162:163], v6 offset:1024
    ds_read_b64_tr_b16 a[164:165], v6 offset:8
    ds_read_b64_tr_b16 a[166:167], v6 offset:1032
    ds_read_b64_tr_b16 a[168:169], v6 offset:2048
    ds_read_b64_tr_b16 a[170:171], v6 offset:3072
    ds_read_b64_tr_b16 a[172:173], v6 offset:2056
    ds_read_b64_tr_b16 a[174:175], v6 offset:3080
    s_waitcnt lgkmcnt(0)
    v_add_u32 v6, 32768, v4
    v_xor_b32 v7, 32, v6
    s_waitcnt vmcnt(16)
    ds_read_b64_tr_b16 a[176:177], v6 offset:0
    ds_read_b64_tr_b16 a[178:179], v6 offset:1024
    ds_read_b64_tr_b16 a[180:181], v6 offset:8
    ds_read_b64_tr_b16 a[182:183], v6 offset:1032
    ds_read_b64_tr_b16 a[184:185], v6 offset:2048
    ds_read_b64_tr_b16 a[186:187], v6 offset:3072
    ds_read_b64_tr_b16 a[188:189], v6 offset:2056
    ds_read_b64_tr_b16 a[190:191], v6 offset:3080
    s_waitcnt lgkmcnt(0)
    v_add_u32 v6, 49152, v4
    v_xor_b32 v7, 32, v6
    s_waitcnt vmcnt(12)
    ds_read_b64_tr_b16 a[192:193], v6 offset:0
    ds_read_b64_tr_b16 a[194:195], v6 offset:1024
    ds_read_b64_tr_b16 a[196:197], v6 offset:8
    ds_read_b64_tr_b16 a[198:199], v6 offset:1032
    ds_read_b64_tr_b16 a[200:201], v6 offset:2048
    ds_read_b64_tr_b16 a[202:203], v6 offset:3072
    ds_read_b64_tr_b16 a[204:205], v6 offset:2056
    ds_read_b64_tr_b16 a[206:207], v6 offset:3080
    s_waitcnt lgkmcnt(0)
    v_add_u32 v6, 65536, v4
    v_xor_b32 v7, 32, v6
    s_waitcnt vmcnt(8)
    ds_read_b64_tr_b16 a[208:209], v6 offset:0
    ds_read_b64_tr_b16 a[210:211], v6 offset:1024
    ds_read_b64_tr_b16 a[212:213], v6 offset:8
    ds_read_b64_tr_b16 a[214:215], v6 offset:1032
    ds_read_b64_tr_b16 a[216:217], v6 offset:2048
    ds_read_b64_tr_b16 a[218:219], v6 offset:3072
    ds_read_b64_tr_b16 a[220:221], v6 offset:2056
    ds_read_b64_tr_b16 a[222:223], v6 offset:3080
    s_waitcnt lgkmcnt(0)
    v_add_u32 v6, 81920, v4
    v_xor_b32 v7, 32, v6
    s_waitcnt vmcnt(4)
    ds_read_b64_tr_b16 a[224:225], v6 offset:0
    ds_read_b64_tr_b16 a[226:227], v6 offset:1024
    ds_read_b64_tr_b16 a[228:229], v6 offset:8
    ds_read_b64_tr_b16 a[230:231], v6 offset:1032
    ds_read_b64_tr_b16 a[232:233], v6 offset:2048
    ds_read_b64_tr_b16 a[234:235], v6 offset:3072
    ds_read_b64_tr_b16 a[236:237], v6 offset:2056
    ds_read_b64_tr_b16 a[238:239], v6 offset:3080
    s_waitcnt lgkmcnt(0)
    v_add_u32 v6, 98304, v4
    v_xor_b32 v7, 32, v6
    s_waitcnt vmcnt(0)
    ds_read_b64_tr_b16 a[240:241], v6 offset:0
    ds_read_b64_tr_b16 a[242:243], v6 offset:1024
    ds_read_b64_tr_b16 a[244:245], v6 offset:8
    ds_read_b64_tr_b16 a[246:247], v6 offset:1032
    ds_read_b64_tr_b16 a[248:249], v6 offset:2048
    ds_read_b64_tr_b16 a[250:251], v6 offset:3072
    ds_read_b64_tr_b16 a[252:253], v6 offset:2056
    ds_read_b64_tr_b16 a[254:255], v6 offset:3080
    s_waitcnt lgkmcnt(0)
    s_barrier
L_op_seg:
    s_lshr_b32 s43, s16, 1
    s_add_u32 s43, s43, 1
    s_min_u32 s43, s43, 63
    s_and_b32 s36, s33, 15
    s_lshl_b32 s36, s36, 8
    s_add_u32 s36, s36, 125829120
    s_lshl_b32 s94, s33, 7
    s_add_u32 s94, s94, s16
    s_mov_b32 s88, 65536
cw12:
    buffer_load_dword v3, off, s[4:7], s36 offset:128 sc1
    s_waitcnt vmcnt(0)
    v_readfirstlane_b32 s42, v3
    s_nop 0
    s_sub_u32 s42, s42, s95
    s_cmp_gt_u32 s42, 64
    s_cselect_b32 s42, 0, s42
    s_add_u32 s42, s42, 2
    s_cmp_ge_u32 s42, s43
    s_cbranch_scc1 cw12x
    s_sub_u32 s88, s88, 1
    s_cbranch_scc1 cw12x
    s_sub_u32 s42, s43, s42
    s_min_u32 s42, s42, 6
cw12s:
    s_sleep 24
    s_sub_u32 s42, s42, 1
    s_cmp_lg_u32 s42, 0
    s_cbranch_scc1 cw12s
    s_branch cw12
cw12x:
    s_lshr_b32 s89, s16, 1
    s_lshl_b32 s89, s89, 2
    s_add_u32 s89, s89, s32
    s_lshl_b32 s89, s89, 7
    s_add_u32 s89, s89, 125894656
    v_mbcnt_lo_u32_b32 v2, -1, 0
    v_mbcnt_hi_u32_b32 v2, -1, v2
    v_min_u32 v2, 7, v2
    v_lshlrev_b32 v2, 2, v2
    s_mov_b32 s88, 4194304
fw13:
    buffer_load_dword v3, v2, s[4:7], s89 offen offset:0 sc1
    s_sub_u32 s88, s88, 1
    s_cbranch_scc1 fw13x
    s_waitcnt vmcnt(0)
    v_cmp_ne_u32 vcc, s95, v3
    s_cbranch_vccz fw13x
    s_sleep 4
    s_cmp_gt_u32 s88, 4194280
    s_cbranch_scc1 fw13
    s_sleep 40
    s_branch fw13
fw13x:
    s_lshl_b32 s18, s16, 17
    s_lshl_b32 s19, s32, 15
    s_add_u32 s18, s18, s19
    s_add_u32 s18, s18, 50331648
    buffer_load_dwordx4 v[32:35], v1, s[4:7], s18 offen offset:0 sc1
    buffer_load_dwordx4 v[36:39], v1, s[4:7], s18 offen offset:1024 sc1
    buffer_load_dwordx4 v[40:43], v1, s[4:7], s18 offen offset:2048 sc1
    buffer_load_dwordx4 v[44:47], v1, s[4:7], s18 offen offset:3072 sc1
    s_add_u32 s18, s18, 4096
    buffer_load_dwordx4 v[48:51], v1, s[4:7], s18 offen offset:0 sc1
    buffer_load_dwordx4 v[52:55], v1, s[4:7], s18 offen offset:1024 sc1
    buffer_load_dwordx4 v[56:59], v1, s[4:7], s18 offen offset:2048 sc1
    buffer_load_dwordx4 v[60:63], v1, s[4:7], s18 offen offset:3072 sc1
    s_add_u32 s18, s18, 4096
    buffer_load_dwordx4 v[64:67], v1, s[4:7], s18 offen offset:0 sc1
    buffer_load_dwordx4 v[68:71], v1, s[4:7], s18 offen offset:1024 sc1
    buffer_load_dwordx4 v[72:75], v1, s[4:7], s18 offen offset:2048 sc1
    buffer_load_dwordx4 v[76:79], v1, s[4:7], s18 offen offset:3072 sc1
    s_add_u32 s18, s18, 4096
    buffer_load_dwordx4 v[80:83], v1, s[4:7], s18 offen offset:0 sc1
    buffer_load_dwordx4 v[84:87], v1, s[4:7], s18 offen offset:1024 sc1
    buffer_load_dwordx4 v[88:91], v1, s[4:7], s18 offen offset:2048 sc1
    buffer_load_dwordx4 v[92:95], v1, s[4:7], s18 offen offset:3072 sc1
    s_add_u32 s18, s18, 4096
    buffer_load_dwordx4 v[96:99], v1, s[4:7], s18 offen offset:0 sc1
    buffer_load_dwordx4 v[100:103], v1, s[4:7], s18 offen offset:1024 sc1
    buffer_load_dwordx4 v[104:107], v1, s[4:7], s18 offen offset:2048 sc1
    buffer_load_dwordx4 v[108:111], v1, s[4:7], s18 offen offset:3072 sc1
    s_add_u32 s18, s18, 4096
    buffer_load_dwordx4 v[112:115], v1, s[4:7], s18 offen offset:0 sc1
    buffer_load_dwordx4 v[116:119], v1, s[4:7], s18 offen offset:1024 sc1
    buffer_load_dwordx4 v[120:123], v1, s[4:7], s18 offen offset:2048 sc1
    buffer_load_dwordx4 v[124:127], v1, s[4:7], s18 offen offset:3072 sc1
    s_add_u32 s18, s18, 4096
    buffer_load_dwordx4 v[128:131], v1, s[4:7], s18 offen offset:0 sc1
    buffer_load_dwordx4 v[132:135], v1, s[4:7], s18 offen offset:1024 sc1
    buffer_load_dwordx4 v[136:139], v1, s[4:7], s18 offen offset:2048 sc1
    buffer_load_dwordx4 v[140:143], v1, s[4:7], s18 offen offset:3072 sc1
    s_add_u32 s18, s18, 4096
    buffer_load_dwordx4 v[144:147], v1, s[4:7], s18 offen offset:0 sc1
    buffer_load_dwordx4 v[148:151], v1, s[4:7], s18 offen offset:1024 sc1
    buffer_load_dwordx4 v[152:155], v1, s[4:7], s18 offen offset:2048 sc1
    buffer_load_dwordx4 v[156:159], v1, s[4:7], s18 offen offset:3072 sc1
    v_lshlrev_b32 v2, 4, v0
    v_and_b32 v3, 3072, v2
    v_lshl_add_u32 v2, v3, 1, v1
    s_waitcnt vmcnt(31)
    v_mfma_f32_16x16x32_bf16 v[8:11], a[0:3], v[32:35], 0
    v_mfma_f32_16x16x32_bf16 v[12:15], a[4:7], v[32:35], 0
    s_waitcnt vmcnt(30)
    v_mfma_f32_16x16x32_bf16 v[8:11], a[8:11], v[36:39], v[8:11]
    v_mfma_f32_16x16x32_bf16 v[12:15], a[12:15], v[36:39], v[12:15]
    s_waitcnt vmcnt(29)
    v_mfma_f32_16x16x32_bf16 v[8:11], a[16:19], v[40:43], v[8:11]
    v_mfma_f32_16x16x32_bf16 v[12:15], a[20:23], v[40:43], v[12:15]
    s_waitcnt vmcnt(28)
    v_mfma_f32_16x16x32_bf16 v[8:11], a[24:27], v[44:47], v[8:11]
    v_mfma_f32_16x16x32_bf16 v[12:15], a[28:31], v[44:47], v[12:15]
    s_waitcnt vmcnt(27)
    v_mfma_f32_16x16x32_bf16 v[8:11], a[32:35], v[48:51], v[8:11]
    v_mfma_f32_16x16x32_bf16 v[12:15], a[36:39], v[48:51], v[12:15]
    s_waitcnt vmcnt(26)
    v_mfma_f32_16x16x32_bf16 v[8:11], a[40:43], v[52:55], v[8:11]
    v_mfma_f32_16x16x32_bf16 v[12:15], a[44:47], v[52:55], v[12:15]
    s_waitcnt vmcnt(25)
    v_mfma_f32_16x16x32_bf16 v[8:11], a[48:51], v[56:59], v[8:11]
    v_mfma_f32_16x16x32_bf16 v[12:15], a[52:55], v[56:59], v[12:15]
    s_waitcnt vmcnt(24)
    v_mfma_f32_16x16x32_bf16 v[8:11], a[56:59], v[60:63], v[8:11]
    v_mfma_f32_16x16x32_bf16 v[12:15], a[60:63], v[60:63], v[12:15]
    s_waitcnt vmcnt(23)
    v_mfma_f32_16x16x32_bf16 v[8:11], a[64:67], v[64:67], v[8:11]
    v_mfma_f32_16x16x32_bf16 v[12:15], a[68:71], v[64:67], v[12:15]
    s_waitcnt vmcnt(22)
    v_mfma_f32_16x16x32_bf16 v[8:11], a[72:75], v[68:71], v[8:11]
    v_mfma_f32_16x16x32_bf16 v[12:15], a[76:79], v[68:71], v[12:15]
    s_waitcnt vmcnt(21)
    v_mfma_f32_16x16x32_bf16 v[8:11], a[80:83], v[72:75], v[8:11]
    v_mfma_f32_16x16x32_bf16 v[12:15], a[84:87], v[72:75], v[12:15]
    s_waitcnt vmcnt(20)
    v_mfma_f32_16x16x32_bf16 v[8:11], a[88:91], v[76:79], v[8:11]
    v_mfma_f32_16x16x32_bf16 v[12:15], a[92:95], v[76:79], v[12:15]
    s_waitcnt vmcnt(19)
    v_mfma_f32_16x16x32_bf16 v[8:11], a[96:99], v[80:83], v[8:11]
    v_mfma_f32_16x16x32_bf16 v[12:15], a[100:103], v[80:83], v[12:15]
    s_waitcnt vmcnt(18)
    v_mfma_f32_16x16x32_bf16 v[8:11], a[104:107], v[84:87], v[8:11]
    v_mfma_f32_16x16x32_bf16 v[12:15], a[108:111], v[84:87], v[12:15]
    s_waitcnt vmcnt(17)
    v_mfma_f32_16x16x32_bf16 v[8:11], a[112:115], v[88:91], v[8:11]
    v_mfma_f32_16x16x32_bf16 v[12:15], a[116:119], v[88:91], v[12:15]
    s_waitcnt vmcnt(16)
    v_mfma_f32_16x16x32_bf16 v[8:11], a[120:123], v[92:95], v[8:11]
    v_mfma_f32_16x16x32_bf16 v[12:15], a[124:127], v[92:95], v[12:15]
    s_waitcnt vmcnt(15)
    v_mfma_f32_16x16x32_bf16 v[8:11], a[128:131], v[96:99], v[8:11]
    v_mfma_f32_16x16x32_bf16 v[12:15], a[132:135], v[96:99], v[12:15]
    s_waitcnt vmcnt(14)
    v_mfma_f32_16x16x32_bf16 v[8:11], a[136:139], v[100:103], v[8:11]
    v_mfma_f32_16x16x32_bf16 v[12:15], a[140:143], v[100:103], v[12:15]
    s_waitcnt vmcnt(13)
    v_mfma_f32_16x16x32_bf16 v[8:11], a[144:147], v[104:107], v[8:11]
    v_mfma_f32_16x16x32_bf16 v[12:15], a[148:151], v[104:107], v[12:15]
    s_waitcnt vmcnt(12)
    v_mfma_f32_16x16x32_bf16 v[8:11], a[152:155], v[108:111], v[8:11]
    v_mfma_f32_16x16x32_bf16 v[12:15], a[156:159], v[108:111], v[12:15]
    s_waitcnt vmcnt(11)
    v_mfma_f32_16x16x32_bf16 v[8:11], a[160:163], v[112:115], v[8:11]
    v_mfma_f32_16x16x32_bf16 v[12:15], a[164:167], v[112:115], v[12:15]
    s_waitcnt vmcnt(10)
    v_mfma_f32_16x16x32_bf16 v[8:11], a[168:171], v[116:119], v[8:11]
    v_mfma_f32_16x16x32_bf16 v[12:15], a[172:175], v[116:119], v[12:15]
    s_waitcnt vmcnt(9)
    v_mfma_f32_16x16x32_bf16 v[8:11], a[176:179], v[120:123], v[8:11]
    v_mfma_f32_16x16x32_bf16 v[12:15], a[180:183], v[120:123], v[12:15]
    s_waitcnt vmcnt(8)
    v_mfma_f32_16x16x32_bf16 v[8:11], a[184:187], v[124:127], v[8:11]
    v_mfma_f32_16x16x32_bf16 v[12:15], a[188:191], v[124:127], v[12:15]
    s_waitcnt vmcnt(7)
    v_mfma_f32_16x16x32_bf16 v[8:11], a[192:195], v[128:131], v[8:11]
    v_mfma_f32_16x16x32_bf16 v[12:15], a[196:199], v[128:131], v[12:15]
    s_waitcnt vmcnt(6)
    v_mfma_f32_16x16x32_bf16 v[8:11], a[200:203], v[132:135], v[8:11]
    v_mfma_f32_16x16x32_bf16 v[12:15], a[204:207], v[132:135], v[12:15]
    s_waitcnt vmcnt(5)
    v_mfma_f32_16x16x32_bf16 v[8:11], a[208:211], v[136:139], v[8:11]
    v_mfma_f32_16x16x32_bf16 v[12:15], a[212:215], v[136:139], v[12:15]
    s_waitcnt vmcnt(4)
    v_mfma_f32_16x16x32_bf16 v[8:11], a[216:219], v[140:143], v[8:11]
    v_mfma_f32_16x16x32_bf16 v[12:15], a[220:223], v[140:143], v[12:15]
    s_waitcnt vmcnt(3)
    v_mfma_f32_16x16x32_bf16 v[8:11], a[224:227], v[144:147], v[8:11]
    v_mfma_f32_16x16x32_bf16 v[12:15], a[228:231], v[144:147], v[12:15]
    s_waitcnt vmcnt(2)
    v_mfma_f32_16x16x32_bf16 v[8:11], a[232:235], v[148:151], v[8:11]
    v_mfma_f32_16x16x32_bf16 v[12:15], a[236:239], v[148:151], v[12:15]
    s_waitcnt vmcnt(1)
    v_mfma_f32_16x16x32_bf16 v[8:11], a[240:243], v[152:155], v[8:11]
    v_mfma_f32_16x16x32_bf16 v[12:15], a[244:247], v[152:155], v[12:15]
    s_waitcnt vmcnt(0)
    v_mfma_f32_16x16x32_bf16 v[8:11], a[248:251], v[156:159], v[8:11]
    v_mfma_f32_16x16x32_bf16 v[12:15], a[252:255], v[156:159], v[12:15]
    s_nop 3
    ds_write_b128 v2, v[8:11] offset:0
    s_nop 2
    ds_write_b128 v2, v[12:15] offset:1024
    s_waitcnt lgkmcnt(0)
    s_barrier
    s_cmp_lg_u32 s32, 0
    s_cbranch_scc1 os_skip
    ds_read_b128 v[40:43], v1 offset:2048
    ds_read_b128 v[44:47], v1 offset:3072
    ds_read_b128 v[48:51], v1 offset:4096
    ds_read_b128 v[52:55], v1 offset:5120
    ds_read_b128 v[56:59], v1 offset:6144
    ds_read_b128 v[60:63], v1 offset:7168
    v_lshrrev_b32 v3, 4, v1
    v_bfe_u32 v4, v3, 2, 2
    v_lshlrev_b32 v4, 3, v4
    v_and_b32 v2, 3, v3
    v_add_u32 v4, v4, v2
    v_mul_u32_u24 v4, 2304, v4
    v_lshrrev_b32 v3, 4, v3
    v_lshl_add_u32 v4, v3, 4, v4
    s_lshr_b32 s18, s16, 1
    s_lshl_b32 s18, s18, 3
    s_and_b32 s19, s16, 1
    s_add_u32 s18, s18, s19
    s_mul_i32 s18, s18, 9216
    s_lshl_b32 s19, s33, 6
    s_add_u32 s18, s18, s19
    s_waitcnt lgkmcnt(0)
    v_pk_add_f32 v[8:9], v[8:9], v[40:41]
    v_pk_add_f32 v[48:49], v[48:49], v[56:57]
    v_pk_add_f32 v[8:9], v[8:9], v[48:49]
    v_pk_add_f32 v[10:11], v[10:11], v[42:43]
    v_pk_add_f32 v[50:51], v[50:51], v[58:59]
    v_pk_add_f32 v[10:11], v[10:11], v[50:51]
    v_pk_add_f32 v[12:13], v[12:13], v[44:45]
    v_pk_add_f32 v[52:53], v[52:53], v[60:61]
    v_pk_add_f32 v[12:13], v[12:13], v[52:53]
    v_pk_add_f32 v[14:15], v[14:15], v[46:47]
    v_pk_add_f32 v[54:55], v[54:55], v[62:63]
    v_pk_add_f32 v[14:15], v[14:15], v[54:55]
    v_cvt_pk_bf16_f32 v32, v8, v9
    v_cvt_pk_bf16_f32 v33, v10, v11
    v_cvt_pk_bf16_f32 v34, v12, v13
    v_cvt_pk_bf16_f32 v35, v14, v15
    buffer_store_dwordx4 v[32:35], v4, s[8:11], s18 offen
os_skip:
    s_nop 1
    s_add_u32 s16, s16, 6
    s_cmp_ge_u32 s16, 128
    s_cbranch_scc1 L_done
    s_barrier
    s_branch L_op_seg
L_done:
L_exit:
    s_endpgm
.section .rodata,"a"
.p2align 6
.amdhsa_kernel concat_heads__memory_aug_recurrent_mem_tr__ssm_conv_s4d__prompt_kernel
  .amdhsa_next_free_vgpr 512
  .amdhsa_next_free_sgpr 102
  .amdhsa_accum_offset 256
  .amdhsa_group_segment_fixed_size 0
  .amdhsa_kernarg_size 136
  .amdhsa_user_sgpr_count 2
  .amdhsa_user_sgpr_kernarg_segment_ptr 1
  .amdhsa_system_sgpr_workgroup_id_x 1
.end_amdhsa_kernel
.text
```

```asm
; @launch grid=(256,1,1) block=(256,1,1) lds=163840
.amdgcn_target "amdgcn-amd-amdhsa--gfx950"
.text
.globl concat_heads__memory_aug_recurrent_mem_tr__ssm_conv_s4d__prompt_kernel
.p2align 8
.type concat_heads__memory_aug_recurrent_mem_tr__ssm_conv_s4d__prompt_kernel,@function
concat_heads__memory_aug_recurrent_mem_tr__ssm_conv_s4d__prompt_kernel:
    s_cmp_ge_u32 s2, 256
    s_cbranch_scc1 L_exit
    s_load_dwordx4 s[84:87], s[0:1], 120
    s_load_dwordx16 s[48:63], s[0:1], 0
    v_lshrrev_b32 v1, 6, v0
    s_nop 0
    v_readfirstlane_b32 s32, v1
    s_getreg_b32 s3, hwreg(HW_REG_XCC_ID)
    s_and_b32 s3, s3, 15
    s_cmp_lg_u32 s32, 3
    s_cbranch_scc1 L_nowarm
    s_getpc_b64 s[44:45]
L_pcw:
    v_and_b32 v1, 63, v0
    v_lshlrev_b32 v1, 7, v1
    s_cmp_lg_u32 s3, 0
    s_cselect_b32 s33, L_helper-L_pcw, 0
    v_add_u32 v1, s33, v1
    v_min_u32 v2, L_exit-L_pcw, v1
    global_load_dword v240, v2, s[44:45]
    v_add_u32 v1, 8192, v1
    v_min_u32 v2, L_exit-L_pcw, v1
    global_load_dword v241, v2, s[44:45]
    v_add_u32 v1, 8192, v1
    s_cbranch_scc0 L_nowarm
    v_min_u32 v2, L_exit-L_pcw, v1
    global_load_dword v242, v2, s[44:45]
    v_add_u32 v1, 8192, v1
    v_min_u32 v2, L_exit-L_pcw, v1
    global_load_dword v243, v2, s[44:45]
    v_add_u32 v1, 8192, v1
    v_min_u32 v2, L_exit-L_pcw, v1
    global_load_dword v244, v2, s[44:45]
    v_add_u32 v1, 8192, v1
L_nowarm:
    s_waitcnt lgkmcnt(0)
    s_mov_b32 s4, s86
    s_mov_b32 s5, s87
    s_mov_b32 s6, 268435456
    s_mov_b32 s7, 0x20000
    s_mov_b32 s96, s84
    s_mov_b32 s97, s85
    s_mov_b32 s98, 256
    s_mov_b32 s99, 0x20000
    s_mov_b32 s95, 0
    s_cmp_lg_u32 s3, 0
    s_cbranch_scc1 L_helper
    s_mov_b32 s37, 128
    v_mov_b32 v250, 1
    v_mov_b32 v251, 163832
    v_cmp_eq_u32 vcc, 0, v0
    s_nop 0
    s_and_saveexec_b64 s[38:39], vcc
    s_cbranch_execz tk1m
    buffer_atomic_add v250, off, s[96:99], s37 sc0
tk1m:
    s_mov_b64 s[38:39], exec
    s_mov_b64 exec, -1
    v_lshrrev_b32 v54, 6, v0
    s_nop 0
    v_readfirstlane_b32 s13, v54
    v_and_b32 v57, 63, v0
    v_bfe_u32 v54, v57, 2, 1
    v_lshlrev_b32 v48, 13, v54
    v_bfe_u32 v54, v57, 3, 1
    v_lshl_add_u32 v48, v54, 15, v48
    v_bfe_u32 v54, v57, 4, 1
    v_lshl_add_u32 v48, v54, 14, v48
    v_bfe_u32 v54, v57, 5, 1
    v_lshl_add_u32 v48, v54, 16, v48
    v_lshrrev_b32 v55, 4, v57
    v_and_b32 v55, 2, v55
    v_xor_b32 v55, v55, v57
    v_and_b32 v55, 3, v55
    v_lshl_add_u32 v48, v55, 4, v48
    v_bfe_u32 v54, v57, 2, 1
    v_lshlrev_b32 v51, 6, v54
    v_bfe_u32 v54, v57, 3, 1
    v_lshl_add_u32 v51, v54, 9, v51
    v_bfe_u32 v54, v57, 4, 1
    v_lshl_add_u32 v51, v54, 7, v51
    v_bfe_u32 v54, v57, 5, 1
    v_lshl_add_u32 v51, v54, 12, v51
    v_bfe_u32 v54, v57, 0, 1
    v_lshl_add_u32 v51, v54, 3, v51
    v_bfe_u32 v54, v57, 1, 1
    v_lshl_add_u32 v51, v54, 4, v51
    v_bfe_u32 v54, v57, 3, 1
    v_lshl_add_u32 v51, v54, 5, v51
    v_lshrrev_b32 v55, 3, v57
    v_mul_u32_u24 v49, 1152, v55
    v_and_b32 v55, 7, v57
    v_lshl_add_u32 v49, v55, 4, v49
    v_bfe_u32 v54, v57, 4, 1
    v_lshlrev_b32 v52, 13, v54
    v_bfe_u32 v54, v57, 5, 1
    v_lshl_add_u32 v52, v54, 9, v52
    v_bfe_u32 v54, v57, 2, 1
    v_lshl_add_u32 v52, v54, 7, v52
    v_bfe_u32 v54, v57, 3, 1
    v_lshl_add_u32 v52, v54, 5, v52
    v_and_b32 v55, 3, v57
    v_lshl_add_u32 v52, v55, 3, v52
    v_lshrrev_b32 v55, 2, v57
    v_mul_u32_u24 v50, 1152, v55
    v_and_b32 v55, 3, v57
    v_lshl_add_u32 v50, v55, 4, v50
    v_bfe_u32 v54, v57, 4, 1
    v_lshlrev_b32 v53, 12, v54
    v_bfe_u32 v54, v57, 5, 1
    v_lshl_add_u32 v53, v54, 8, v53
    v_bfe_u32 v54, v57, 2, 1
    v_lshl_add_u32 v53, v54, 6, v53
    v_bfe_u32 v54, v57, 3, 1
    v_lshl_add_u32 v53, v54, 5, v53
    v_and_b32 v55, 3, v57
    v_lshl_add_u32 v53, v55, 3, v53
    s_lshl_b32 s66, s13, 10
    s_and_b32 s93, s13, 1
    s_lshl_b32 s93, s93, 14
    s_and_b32 s75, s13, 2
    s_lshl_b32 s75, s75, 19
    v_add_u32 v51, s66, v51
    v_add_u32 v52, s66, v52
    v_add_u32 v53, s66, v53
    v_mov_b32 v58, v48
    s_mov_b32 s10, 4718592
    s_mov_b32 s11, 0x20000
    s_mov_b64 exec, s[38:39]
    s_cbranch_execz tk1
    s_waitcnt vmcnt(0)
    ds_write_b32 v251, v250
    s_waitcnt lgkmcnt(0)
tk1:
    s_mov_b64 exec, -1
    s_barrier
    ds_read_b32 v252, v251
    s_waitcnt lgkmcnt(0)
    v_readfirstlane_b32 s12, v252
    s_barrier
    s_nop 3
    s_cmp_ge_u32 s12, 32
    s_cbranch_scc1 L_helper
L_chain:
    s_mov_b64 s[48:49], s[50:51]
    s_mov_b64 s[50:51], s[52:53]
    s_mov_b64 s[52:53], s[54:55]
    s_mov_b64 s[54:55], s[56:57]
    s_mov_b64 s[56:57], s[58:59]
    s_lshl_b32 s67, s12, 8
    s_lshl_b32 s40, s13, 6
    s_add_u32 s67, s67, s40
    s_mul_i32 s92, s12, 147456
    s_lshr_b32 s73, s50, 8
    s_add_u32 s73, s73, s12
    s_and_b32 s73, s73, 31
    s_bitcmp1_b32 0xa2222222, s73
    s_cselect_b32 s72, 5, 0
    s_add_u32 s73, s73, 1
    s_lshr_b32 s73, s73, 2
    s_xor_b32 s94, s13, 0
    s_mul_i32 s94, s94, 36864
    s_add_u32 s94, s94, s92
    s_lshl_b32 s74, s13, 7
    s_add_u32 s94, s94, s74
    s_add_u32 s78, s94, 0
    s_mov_b64 s[8:9], s[56:57]
    v_mov_b32 v58, v49
    s_mov_b32 s79, 9216
    s_mov_b32 s81, 0
    s_add_u32 s80, s66, 114688
    s_mov_b32 s76, 0
    s_mov_b32 s77, 8192
    s_call_b64 s[82:83], cf_dma
    s_mov_b32 s77, 16384
    s_call_b64 s[82:83], cf_dma
    s_xor_b32 s94, s13, 1
    s_mul_i32 s94, s94, 36864
    s_add_u32 s94, s94, s92
    s_lshl_b32 s74, s13, 7
    s_add_u32 s94, s94, s74
    s_add_u32 s78, s94, 0
    s_add_u32 s80, s66, 81920
    s_mov_b32 s76, 0
    s_mov_b32 s77, 8192
    s_call_b64 s[82:83], cf_dma
    s_mov_b32 s77, 16384
    s_call_b64 s[82:83], cf_dma
    s_xor_b32 s94, s13, 2
    s_mul_i32 s94, s94, 36864
    s_add_u32 s94, s94, s92
    s_lshl_b32 s74, s13, 7
    s_add_u32 s94, s94, s74
    s_add_u32 s78, s94, 0
    s_add_u32 s80, s66, 16384
    s_mov_b32 s76, 0
    s_mov_b32 s77, 8192
    s_call_b64 s[82:83], cf_dma
    v_lshrrev_b32 v24, 6, v0
    v_lshlrev_b32 v61, 4, v0
    v_add_u32 v62, 57344, v61
    v_xor_b32 v63, 1024, v61
    v_add_u32 v63, 98304, v63
    v_xor_b32 v64, 2048, v61
    v_add_u32 v64, 98304, v64
    v_and_b32 v65, 1023, v61
    v_add_u32 v65, 98304, v65
    v_and_b32 v26, 15, v0
    v_bfe_u32 v27, v0, 4, 2
    v_mov_b32 v60, 0x4444
    v_mov_b32 v25, 0xeeee
    v_cmp_lt_u32 vcc, 7, v26
    s_nop 1
    v_cndmask_b32 v60, v60, v25, vcc
    s_mov_b32 s77, 16384
    s_call_b64 s[82:83], cf_dma
    v_and_b32 v67, 12, v26
    v_lshlrev_b32 v67, 3, v67
    v_and_b32 v25, 1, v26
    v_lshl_add_u32 v67, v25, 4, v67
    v_bfe_u32 v25, v26, 1, 1
    v_lshl_add_u32 v67, v25, 3, v67
    v_lshl_add_u32 v66, v27, 14, v67
    v_lshl_add_u32 v66, v24, 17, v66
    s_xor_b32 s94, s13, 3
    s_mul_i32 s94, s94, 36864
    s_add_u32 s94, s94, s92
    s_lshl_b32 s74, s13, 7
    s_add_u32 s94, s94, s74
    s_add_u32 s78, s94, 0
    s_add_u32 s80, s66, 0
    s_mov_b32 s76, 0
    s_mov_b32 s77, 8192
    s_call_b64 s[82:83], cf_dma
    v_and_b32 v67, 63, v67
    v_lshrrev_b32 v25, 1, v24
    v_lshl_add_u32 v67, v25, 18, v67
    v_lshl_add_u32 v67, v27, 16, v67
    v_lshrrev_b32 v25, 3, v26
    v_lshl_add_u32 v67, v25, 15, v67
    v_and_b32 v25, 1, v24
    v_lshl_add_u32 v67, v25, 6, v67
    s_mov_b32 s77, 16384
    s_call_b64 s[82:83], cf_dma
    v_and_b32 v25, 31, v0
    v_lshlrev_b32 v70, 4, v25
    v_lshlrev_b32 v28, 3, v25
    v_lshl_add_u32 v28, v24, 10, v28
    v_add_u32 v28, 110592, v28
    v_lshrrev_b32 v25, 1, v24
    v_lshl_add_u32 v70, v25, 9, v70
    v_and_b32 v25, 1, v24
    v_lshl_add_u32 v70, v25, 3, v70
    v_add_u32 v70, 109568, v70
    v_cmp_gt_u32 vcc, 2, v27
    s_nop 1
    v_cndmask_b32 v70, v70, v28, vcc
    v_xor_b32 v71, 2048, v63
    v_lshrrev_b32 v68, 4, v0
    v_lshlrev_b32 v68, 7, v68
    v_and_b32 v25, 7, v26
    v_lshl_add_u32 v68, v25, 4, v68
    v_add_u32 v68, 98304, v68
    v_xor_b32 v74, 512, v68
    v_xor_b32 v75, 1024, v68
    v_xor_b32 v76, 1536, v68
    v_lshrrev_b32 v25, 3, v26
    v_lshl_add_u32 v77, v25, 3, v68
    v_or_b32 v78, 512, v65
    v_lshlrev_b32 v79, 2, v61
    v_mov_b64 v[72:73], 0
    v_and_b32 v25, 1, v27
    v_lshlrev_b32 v69, 7, v25
    v_lshrrev_b32 v25, 1, v27
    v_lshl_add_u32 v69, v25, 3, v69
    v_and_b32 v25, 3, v26
    v_lshl_add_u32 v69, v25, 4, v69
    v_bfe_u32 v25, v26, 2, 1
    v_lshl_add_u32 v69, v25, 2, v69
    s_mov_b32 s32, 0x00ff00ff
    s_mov_b32 s33, 0x00ff00ff
    s_not_b64 s[34:35], s[32:33]
    s_lshr_b32 s31, s12, 1
    s_lshl_b32 s31, s31, 8
    s_and_b32 s40, s12, 1
    s_lshl_b32 s40, s40, 6
    s_add_u32 s31, s31, s40
    s_and_b32 s40, s13, 1
    s_lshl_b32 s40, s40, 12
    s_add_u32 s31, s31, s40
    s_lshl_b32 s19, s12, 14
    s_add_u32 s19, s19, 67076096
    s_add_u32 s41, s19, 8192
    s_add_u32 s19, s19, s40
    s_and_b32 s40, s12, 1
    s_lshl_b32 s40, s40, 2
    s_or_b32 s40, s40, s13
    s_cmp_eq_u32 s40, 5
    s_cselect_b32 s64, 0, s13
    s_cmp_lg_u32 s13, 1
    s_cbranch_scc1 cf_notx
    s_mov_b32 s32, 0xff
    s_mov_b32 s33, 0xff
    s_mov_b32 s19, s41
    s_lshr_b32 s31, s12, 3
    s_lshl_b32 s31, s31, 8
    s_and_b32 s40, s12, 2
    s_lshl_b32 s40, s40, 6
    s_add_u32 s31, s31, s40
    s_and_b32 s40, s12, 4
    s_lshl_b32 s40, s40, 4
    s_add_u32 s31, s31, s40
    s_add_u32 s31, s31, 8192
cf_notx:
    s_cmp_lg_u32 s13, 0
    s_cbranch_scc1 cf_notp
    s_min_u32 s40, s12, 23
    s_mul_i32 s40, s40, 384
    s_add_u32 s40, s40, 98304
    v_add_u32 v69, s40, v61
    v_mov_b32 v25, 108288
    v_cmp_lt_u32 vcc, 23, v0
    s_nop 1
    v_cndmask_b32 v69, v69, v25, vcc
cf_notp:
    s_nop 1
    v_mov_b32 v28, 1
    v_mov_b32 v29, 1
    v_mov_b32 v30, 1
    v_mov_b32 v31, 1
    s_lshl_b32 s40, s12, 14
    s_add_u32 s40, s40, 67174400
    s_add_u32 s41, s40, 0
    buffer_store_dwordx4 v[28:31], v61, s[4:7], s41 offen
    s_add_u32 s41, s40, 4096
    buffer_store_dwordx4 v[28:31], v61, s[4:7], s41 offen
    s_add_u32 s41, s40, 8192
    buffer_store_dwordx4 v[28:31], v61, s[4:7], s41 offen
    s_cmp_eq_u32 s64, 0
    s_cselect_b64 exec, 0, s[32:33]
    v_mov_b32 v27, -1
    s_add_u32 s41, s31, 67108864
    buffer_store_dword v27, v69, s[4:7], s41 offen
    s_add_u32 s41, s31, 67125248
    buffer_store_dword v27, v69, s[4:7], s41 offen
    s_add_u32 s41, s31, 67141632
    buffer_store_dword v27, v69, s[4:7], s41 offen
    s_add_u32 s41, s31, 67158016
    buffer_store_dword v27, v69, s[4:7], s41 offen
    s_mov_b64 exec, -1
    s_mov_b64 s[68:69], s[48:49]
    s_mov_b32 s70, 9216
    s_mov_b32 s71, 0x20000
    v_and_b32 v25, 7, v0
    v_mul_u32_u24 v25, 1152, v25
    v_lshrrev_b32 v26, 3, v0
    v_lshl_add_u32 v25, v26, 4, v25
    buffer_load_dwordx4 v[36:39], v25, s[68:71], 0 offen
    buffer_load_dwordx4 v[40:43], v25, s[68:71], 0 offen offset:512
    v_bfe_u32 v25, v0, 2, 3
    v_mul_u32_u24 v25, 1152, v25
    v_lshrrev_b32 v26, 5, v0
    v_lshl_add_u32 v25, v26, 4, v25
    v_and_b32 v26, 3, v0
    v_lshl_add_u32 v25, v26, 2, v25
    buffer_load_dword v44, v25, s[68:71], 0 offen offset:1024
    s_waitcnt vmcnt(15)
    v_add_u32 v55, 114688, v52
    ds_read_b64_tr_b16 v[160:161], v55 offset:0
    ds_read_b64_tr_b16 v[162:163], v55 offset:256
    ds_read_b64_tr_b16 v[164:165], v55 offset:4096
    ds_read_b64_tr_b16 v[166:167], v55 offset:4352
    s_xor_b32 s94, s13, 0
    s_mul_i32 s94, s94, 36864
    s_add_u32 s94, s94, s92
    s_lshl_b32 s74, s13, 7
    s_add_u32 s94, s94, s74
    s_add_u32 s78, s94, 512
    s_add_u32 s80, s66, 147456
    s_mov_b32 s76, 0
    s_mov_b32 s77, 8192
    s_call_b64 s[82:83], cf_dma
    ds_read_b64_tr_b16 v[192:193], v55 offset:64
    ds_read_b64_tr_b16 v[194:195], v55 offset:320
    ds_read_b64_tr_b16 v[196:197], v55 offset:4160
    ds_read_b64_tr_b16 v[198:199], v55 offset:4416
    s_mov_b32 s77, 16384
    s_call_b64 s[82:83], cf_dma
    s_waitcnt lgkmcnt(0)
    s_waitcnt vmcnt(15)
    v_add_u32 v55, 81920, v52
    ds_read_b64_tr_b16 v[168:169], v55 offset:0
    ds_read_b64_tr_b16 v[170:171], v55 offset:256
    ds_read_b64_tr_b16 v[172:173], v55 offset:4096
    ds_read_b64_tr_b16 v[174:175], v55 offset:4352
    s_xor_b32 s94, s13, 1
    s_mul_i32 s94, s94, 36864
    s_add_u32 s94, s94, s92
    s_lshl_b32 s74, s13, 7
    s_add_u32 s94, s94, s74
    s_add_u32 s78, s94, 512
    s_add_u32 s80, s66, 98304
    s_mov_b32 s76, 0
    s_mov_b32 s77, 8192
    s_call_b64 s[82:83], cf_dma
    ds_read_b64_tr_b16 v[200:201], v55 offset:64
    ds_read_b64_tr_b16 v[202:203], v55 offset:320
    ds_read_b64_tr_b16 v[204:205], v55 offset:4160
    ds_read_b64_tr_b16 v[206:207], v55 offset:4416
    s_mov_b32 s77, 16384
    s_call_b64 s[82:83], cf_dma
    s_waitcnt lgkmcnt(0)
    s_waitcnt vmcnt(15)
    v_add_u32 v55, 16384, v52
    ds_read_b64_tr_b16 v[176:177], v55 offset:0
    ds_read_b64_tr_b16 v[178:179], v55 offset:256
    ds_read_b64_tr_b16 v[180:181], v55 offset:4096
    ds_read_b64_tr_b16 v[182:183], v55 offset:4352
    s_add_u32 s78, s67, 4194304
    s_mov_b64 s[8:9], s[54:55]
    v_mov_b32 v58, v48
    s_mov_b32 s79, 131072
    s_add_u32 s80, s66, 32768
    s_mov_b32 s76, 0
    s_mov_b32 s77, 8192
    s_call_b64 s[82:83], cf_dma
    ds_read_b64_tr_b16 v[208:209], v55 offset:64
    ds_read_b64_tr_b16 v[210:211], v55 offset:320
    ds_read_b64_tr_b16 v[212:213], v55 offset:4160
    ds_read_b64_tr_b16 v[214:215], v55 offset:4416
    s_mov_b32 s77, 16384
    s_call_b64 s[82:83], cf_dma
    s_waitcnt lgkmcnt(0)
    s_waitcnt vmcnt(15)
    v_add_u32 v55, 0, v52
    ds_read_b64_tr_b16 v[184:185], v55 offset:0
    ds_read_b64_tr_b16 v[186:187], v55 offset:256
    ds_read_b64_tr_b16 v[188:189], v55 offset:4096
    ds_read_b64_tr_b16 v[190:191], v55 offset:4352
    s_xor_b32 s78, s75, 0
    s_add_u32 s78, s78, s67
    s_mov_b32 s81, s93
    s_add_u32 s80, s66, 114688
    s_mov_b32 s76, 0
    s_mov_b32 s77, 8192
    s_call_b64 s[82:83], cf_dma
    ds_read_b64_tr_b16 v[216:217], v55 offset:64
    ds_read_b64_tr_b16 v[218:219], v55 offset:320
    ds_read_b64_tr_b16 v[220:221], v55 offset:4160
    ds_read_b64_tr_b16 v[222:223], v55 offset:4416
    s_mov_b32 s77, 16384
    s_call_b64 s[82:83], cf_dma
    s_waitcnt lgkmcnt(0)
    s_waitcnt vmcnt(12)
    v_add_u32 v55, 147456, v52
    ds_read_b64_tr_b16 v[224:225], v55 offset:0
    ds_read_b64_tr_b16 v[226:227], v55 offset:256
    ds_read_b64_tr_b16 v[228:229], v55 offset:4096
    ds_read_b64_tr_b16 v[230:231], v55 offset:4352
    s_mov_b32 s77, 24576
    s_call_b64 s[82:83], cf_dma
    ds_read_b64_tr_b16 v[240:241], v55 offset:64
    ds_read_b64_tr_b16 v[242:243], v55 offset:320
    ds_read_b64_tr_b16 v[244:245], v55 offset:4160
    ds_read_b64_tr_b16 v[246:247], v55 offset:4416
    s_mov_b32 s77, 32768
    s_call_b64 s[82:83], cf_dma
    s_waitcnt lgkmcnt(0)
    v_min_u32 v36, -2, v36
    v_min_u32 v37, -2, v37
    v_min_u32 v38, -2, v38
    v_min_u32 v39, -2, v39
    v_min_u32 v40, -2, v40
    v_min_u32 v41, -2, v41
    v_min_u32 v42, -2, v42
    v_min_u32 v43, -2, v43
    v_min_u32 v44, -2, v44
    s_lshl_b32 s14, s12, 16
    s_add_u32 s14, s14, 92274688
    s_add_u32 s41, s14, 4096
    s_add_u32 s42, s14, 8192
    v_lshrrev_b32 v45, 2, v61
    buffer_store_dwordx4 v[36:39], v61, s[4:7], s14 offen
    buffer_store_dwordx4 v[40:43], v61, s[4:7], s41 offen
    buffer_store_dword v44, v45, s[4:7], s42 offen
    v_mov_b32 v46, 1
    s_mov_b64 exec, 1
    buffer_atomic_add v46, off, s[96:99], 0 offset:132 sc0
    s_mov_b64 exec, -1
    s_waitcnt vmcnt(13)
    v_add_u32 v55, 98304, v52
    ds_read_b64_tr_b16 v[232:233], v55 offset:0
    ds_read_b64_tr_b16 v[234:235], v55 offset:256
    ds_read_b64_tr_b16 v[236:237], v55 offset:4096
    ds_read_b64_tr_b16 v[238:239], v55 offset:4352
    s_xor_b32 s78, s75, 1048576
    s_add_u32 s78, s78, s67
    s_add_u32 s80, s66, 65536
    s_mov_b32 s76, 0
    s_mov_b32 s77, 8192
    s_call_b64 s[82:83], cf_dma
    ds_read_b64_tr_b16 v[248:249], v55 offset:64
    ds_read_b64_tr_b16 v[250:251], v55 offset:320
    ds_read_b64_tr_b16 v[252:253], v55 offset:4160
    ds_read_b64_tr_b16 v[254:255], v55 offset:4416
    s_mov_b32 s77, 16384
    s_call_b64 s[82:83], cf_dma
    s_waitcnt lgkmcnt(0)
    s_waitcnt vmcnt(13)
    v_add_u32 v55, 32768, v51
    v_xor_b32 v56, 32, v55
    ds_read_b64_tr_b16 v[144:145], v55 offset:0
    ds_read_b64_tr_b16 v[146:147], v55 offset:256
    ds_read_b64_tr_b16 v[148:149], v55 offset:8192
    ds_read_b64_tr_b16 v[150:151], v55 offset:8448
    s_mov_b32 s77, 24576
    s_call_b64 s[82:83], cf_dma
    ds_read_b64_tr_b16 v[152:153], v56 offset:0
    ds_read_b64_tr_b16 v[154:155], v56 offset:256
    ds_read_b64_tr_b16 v[156:157], v56 offset:8192
    ds_read_b64_tr_b16 v[158:159], v56 offset:8448
    s_mov_b32 s77, 32768
    s_call_b64 s[82:83], cf_dma
    s_waitcnt lgkmcnt(0)
    s_waitcnt vmcnt(9)
    v_add_u32 v55, 114688, v51
    v_xor_b32 v56, 32, v55
    ds_read_b64_tr_b16 a[192:193], v55 offset:0
    ds_read_b64_tr_b16 a[194:195], v55 offset:256
    ds_read_b64_tr_b16 a[196:197], v55 offset:8192
    ds_read_b64_tr_b16 a[198:199], v55 offset:8448
    s_lshl_b32 s89, s73, 7
    s_add_u32 s89, s89, 125853696
    v_min_u32 v33, 7, v57
    v_lshlrev_b32 v33, 2, v33
    s_cmp_eq_u32 s72, 0
    s_cbranch_scc1 cf_cpe
    buffer_load_dword v34, off, s[96:99], 0 offset:64 sc1
    buffer_load_dword v35, v33, s[4:7], s89 offen sc1
cf_cpe:
    s_xor_b32 s78, s75, 2097152
    s_add_u32 s78, s78, s67
    s_add_u32 s80, s66, 0
    s_mov_b32 s76, 0
    s_mov_b32 s77, 8192
    s_call_b64 s[82:83], cf_dma
    ds_read_b64_tr_b16 a[200:201], v56 offset:0
    ds_read_b64_tr_b16 a[202:203], v56 offset:256
    ds_read_b64_tr_b16 a[204:205], v56 offset:8192
    ds_read_b64_tr_b16 a[206:207], v56 offset:8448
    s_mov_b32 s77, 16384
    s_call_b64 s[82:83], cf_dma
    s_waitcnt lgkmcnt(0)
    v_add_u32 v55, 131072, v51
    v_xor_b32 v56, 32, v55
    ds_read_b64_tr_b16 a[208:209], v55 offset:0
    ds_read_b64_tr_b16 a[210:211], v55 offset:256
    ds_read_b64_tr_b16 a[212:213], v55 offset:8192
    ds_read_b64_tr_b16 a[214:215], v55 offset:8448
    s_mov_b32 s77, 24576
    s_call_b64 s[82:83], cf_dma
    ds_read_b64_tr_b16 a[216:217], v56 offset:0
    ds_read_b64_tr_b16 a[218:219], v56 offset:256
    ds_read_b64_tr_b16 a[220:221], v56 offset:8192
    ds_read_b64_tr_b16 a[222:223], v56 offset:8448
    s_mov_b32 s77, 32768
    s_call_b64 s[82:83], cf_dma
    s_waitcnt lgkmcnt(0)
    s_waitcnt vmcnt(8)
    v_add_u32 v55, 65536, v51
    v_xor_b32 v56, 32, v55
    ds_read_b64_tr_b16 a[224:225], v55 offset:0
    ds_read_b64_tr_b16 a[226:227], v55 offset:256
    ds_read_b64_tr_b16 a[228:229], v55 offset:8192
    ds_read_b64_tr_b16 a[230:231], v55 offset:8448
    s_xor_b32 s78, s75, 3145728
    s_add_u32 s78, s78, s67
    s_add_u32 s80, s66, 32768
    s_mov_b32 s76, 0
    s_mov_b32 s77, 8192
    s_call_b64 s[82:83], cf_dma
    ds_read_b64_tr_b16 a[232:233], v56 offset:0
    ds_read_b64_tr_b16 a[234:235], v56 offset:256
    ds_read_b64_tr_b16 a[236:237], v56 offset:8192
    ds_read_b64_tr_b16 a[238:239], v56 offset:8448
    s_mov_b32 s77, 16384
    s_call_b64 s[82:83], cf_dma
    s_waitcnt lgkmcnt(0)
    v_add_u32 v55, 81920, v51
    v_xor_b32 v56, 32, v55
    ds_read_b64_tr_b16 a[240:241], v55 offset:0
    ds_read_b64_tr_b16 a[242:243], v55 offset:256
    ds_read_b64_tr_b16 a[244:245], v55 offset:8192
    ds_read_b64_tr_b16 a[246:247], v55 offset:8448
    s_mov_b32 s77, 24576
    s_call_b64 s[82:83], cf_dma
    ds_read_b64_tr_b16 a[248:249], v56 offset:0
    ds_read_b64_tr_b16 a[250:251], v56 offset:256
    ds_read_b64_tr_b16 a[252:253], v56 offset:8192
    ds_read_b64_tr_b16 a[254:255], v56 offset:8448
    s_mov_b32 s77, 32768
    s_call_b64 s[82:83], cf_dma
    s_waitcnt lgkmcnt(0)
    v_readfirstlane_b32 s41, v46
    v_mov_b32 v36, 1
    v_mov_b32 v37, 0
    s_cmp_eq_u32 s41, 127
    s_cselect_b64 exec, 1, 0
    buffer_atomic_cmpswap v[36:37], off, s[96:99], 0 offset:140
    s_mov_b64 exec, -1
    s_waitcnt vmcnt(8)
    v_add_u32 v55, 0, v51
    v_xor_b32 v56, 32, v55
    ds_read_b64_tr_b16 v[80:81], v55 offset:0
    ds_read_b64_tr_b16 v[82:83], v55 offset:256
    ds_read_b64_tr_b16 v[84:85], v55 offset:8192
    ds_read_b64_tr_b16 v[86:87], v55 offset:8448
    s_cmp_eq_u32 s72, 0
    s_cbranch_scc1 cf_ncp
    s_waitcnt vmcnt(16)
    v_readfirstlane_b32 s95, v34
    v_cmp_ne_u32 vcc, v34, v35
    s_cmp_eq_u32 s95, 0
    s_cbranch_scc1 cf_cps
    s_cbranch_vccz cf_cpo
cf_cps:
    s_nop 1
    s_mov_b32 s88, 4194304
gn2:
    s_cmp_lg_u32 s95, 0
    s_cbranch_scc1 gn2x
    buffer_load_dword v34, off, s[96:99], 0 offset:64 sc1
    s_sub_u32 s88, s88, 1
    s_cbranch_scc1 gn2x
    s_waitcnt vmcnt(0)
    v_readfirstlane_b32 s95, v34
    s_nop 1
    s_branch gn2
gn2x:
    s_nop 1
    v_mbcnt_lo_u32_b32 v33, -1, 0
    v_mbcnt_hi_u32_b32 v33, -1, v33
    v_min_u32 v33, 7, v33
    v_lshlrev_b32 v33, 2, v33
    s_mov_b32 s88, 4194304
fw3:
    buffer_load_dword v35, v33, s[4:7], s89 offen offset:0 sc1
    s_sub_u32 s88, s88, 1
    s_cbranch_scc1 fw3x
    s_waitcnt vmcnt(0)
    v_cmp_ne_u32 vcc, s95, v35
    s_cbranch_vccz fw3x
    s_sleep 1
    s_cmp_gt_u32 s88, 4194280
    s_cbranch_scc1 fw3
    s_sleep 40
    s_branch fw3
fw3x:
cf_cpo:
    s_mul_i32 s74, s73, 442368
    s_add_u32 s74, s74, 96468992
    s_add_u32 s50, s4, s74
    s_addc_u32 s51, s5, 0
    s_add_u32 s52, s50, 147456
    s_addc_u32 s53, s51, 0
    s_lshl_b32 s67, s13, 6
    v_and_b32 v54, 63, v48
    v_lshrrev_b32 v48, 13, v48
    v_lshl_add_u32 v48, v48, 8, v54
cf_ncp:
    s_xor_b32 s78, s75, 2097152
    s_lshr_b32 s78, s78, s72
    s_add_u32 s78, s78, s67
    s_mov_b64 s[8:9], s[52:53]
    v_mov_b32 v58, v48
    s_lshr_b32 s79, 131072, s72
    s_add_u32 s80, s66, 131072
    s_mov_b32 s76, 0
    s_mov_b32 s77, 8192
    s_call_b64 s[82:83], cf_dma
    ds_read_b64_tr_b16 v[88:89], v56 offset:0
    ds_read_b64_tr_b16 v[90:91], v56 offset:256
    ds_read_b64_tr_b16 v[92:93], v56 offset:8192
    ds_read_b64_tr_b16 v[94:95], v56 offset:8448
    s_mov_b32 s77, 16384
    s_call_b64 s[82:83], cf_dma
    s_waitcnt lgkmcnt(0)
    v_add_u32 v55, 16384, v51
    v_xor_b32 v56, 32, v55
    ds_read_b64_tr_b16 v[96:97], v55 offset:0
    ds_read_b64_tr_b16 v[98:99], v55 offset:256
    ds_read_b64_tr_b16 v[100:101], v55 offset:8192
    ds_read_b64_tr_b16 v[102:103], v55 offset:8448
    s_mov_b32 s77, 24576
    s_call_b64 s[82:83], cf_dma
    ds_read_b64_tr_b16 v[104:105], v56 offset:0
    ds_read_b64_tr_b16 v[106:107], v56 offset:256
    ds_read_b64_tr_b16 v[108:109], v56 offset:8192
    ds_read_b64_tr_b16 v[110:111], v56 offset:8448
    s_mov_b32 s77, 32768
    s_call_b64 s[82:83], cf_dma
    s_waitcnt lgkmcnt(0)
    s_waitcnt vmcnt(8)
    v_add_u32 v55, 32768, v51
    v_xor_b32 v56, 32, v55
    ds_read_b64_tr_b16 v[112:113], v55 offset:0
    ds_read_b64_tr_b16 v[114:115], v55 offset:256
    ds_read_b64_tr_b16 v[116:117], v55 offset:8192
    ds_read_b64_tr_b16 v[118:119], v55 offset:8448
    s_xor_b32 s78, s75, 3145728
    s_lshr_b32 s78, s78, s72
    s_add_u32 s78, s78, s67
    s_add_u32 s80, s66, 65536
    s_mov_b32 s76, 0
    s_mov_b32 s77, 8192
    s_call_b64 s[82:83], cf_dma
    ds_read_b64_tr_b16 v[120:121], v56 offset:0
    ds_read_b64_tr_b16 v[122:123], v56 offset:256
    ds_read_b64_tr_b16 v[124:125], v56 offset:8192
    ds_read_b64_tr_b16 v[126:127], v56 offset:8448
    s_mov_b32 s77, 16384
    s_call_b64 s[82:83], cf_dma
    s_waitcnt lgkmcnt(0)
    v_add_u32 v55, 49152, v51
    v_xor_b32 v56, 32, v55
    ds_read_b64_tr_b16 v[128:129], v55 offset:0
    ds_read_b64_tr_b16 v[130:131], v55 offset:256
    ds_read_b64_tr_b16 v[132:133], v55 offset:8192
    ds_read_b64_tr_b16 v[134:135], v55 offset:8448
    s_mov_b32 s77, 24576
    s_call_b64 s[82:83], cf_dma
    ds_read_b64_tr_b16 v[136:137], v56 offset:0
    ds_read_b64_tr_b16 v[138:139], v56 offset:256
    ds_read_b64_tr_b16 v[140:141], v56 offset:8192
    ds_read_b64_tr_b16 v[142:143], v56 offset:8448
    s_mov_b32 s77, 32768
    s_call_b64 s[82:83], cf_dma
    s_waitcnt lgkmcnt(0)
    s_waitcnt vmcnt(8)
    v_add_u32 v55, 131072, v51
    v_xor_b32 v56, 32, v55
    ds_read_b64_tr_b16 a[128:129], v55 offset:0
    ds_read_b64_tr_b16 a[130:131], v55 offset:256
    ds_read_b64_tr_b16 a[132:133], v55 offset:8192
    ds_read_b64_tr_b16 a[134:135], v55 offset:8448
    s_xor_b32 s78, s75, 2097152
    s_lshr_b32 s78, s78, s72
    s_add_u32 s78, s78, s67
    s_mov_b64 s[8:9], s[50:51]
    s_add_u32 s80, s66, 0
    s_mov_b32 s76, 0
    s_mov_b32 s77, 8192
    s_call_b64 s[82:83], cf_dma
    ds_read_b64_tr_b16 a[136:137], v56 offset:0
    ds_read_b64_tr_b16 a[138:139], v56 offset:256
    ds_read_b64_tr_b16 a[140:141], v56 offset:8192
    ds_read_b64_tr_b16 a[142:143], v56 offset:8448
    s_mov_b32 s77, 16384
    s_call_b64 s[82:83], cf_dma
    s_waitcnt lgkmcnt(0)
    v_add_u32 v55, 147456, v51
    v_xor_b32 v56, 32, v55
    ds_read_b64_tr_b16 a[144:145], v55 offset:0
    ds_read_b64_tr_b16 a[146:147], v55 offset:256
    ds_read_b64_tr_b16 a[148:149], v55 offset:8192
    ds_read_b64_tr_b16 a[150:151], v55 offset:8448
    s_mov_b32 s77, 24576
    s_call_b64 s[82:83], cf_dma
    ds_read_b64_tr_b16 a[152:153], v56 offset:0
    ds_read_b64_tr_b16 a[154:155], v56 offset:256
    ds_read_b64_tr_b16 a[156:157], v56 offset:8192
    ds_read_b64_tr_b16 a[158:159], v56 offset:8448
    s_mov_b32 s77, 32768
    s_call_b64 s[82:83], cf_dma
    s_waitcnt lgkmcnt(0)
    s_waitcnt vmcnt(8)
    v_add_u32 v55, 65536, v51
    v_xor_b32 v56, 32, v55
    ds_read_b64_tr_b16 a[160:161], v55 offset:0
    ds_read_b64_tr_b16 a[162:163], v55 offset:256
    ds_read_b64_tr_b16 a[164:165], v55 offset:8192
    ds_read_b64_tr_b16 a[166:167], v55 offset:8448
    s_xor_b32 s78, s75, 3145728
    s_lshr_b32 s78, s78, s72
    s_add_u32 s78, s78, s67
    s_add_u32 s80, s66, 32768
    s_mov_b32 s76, 0
    s_mov_b32 s77, 8192
    s_call_b64 s[82:83], cf_dma
    ds_read_b64_tr_b16 a[168:169], v56 offset:0
    ds_read_b64_tr_b16 a[170:171], v56 offset:256
    ds_read_b64_tr_b16 a[172:173], v56 offset:8192
    ds_read_b64_tr_b16 a[174:175], v56 offset:8448
    s_mov_b32 s77, 16384
    s_call_b64 s[82:83], cf_dma
    s_waitcnt lgkmcnt(0)
    v_add_u32 v55, 81920, v51
    v_xor_b32 v56, 32, v55
    ds_read_b64_tr_b16 a[176:177], v55 offset:0
    ds_read_b64_tr_b16 a[178:179], v55 offset:256
    ds_read_b64_tr_b16 a[180:181], v55 offset:8192
    ds_read_b64_tr_b16 a[182:183], v55 offset:8448
    s_mov_b32 s77, 24576
    s_call_b64 s[82:83], cf_dma
    ds_read_b64_tr_b16 a[184:185], v56 offset:0
    ds_read_b64_tr_b16 a[186:187], v56 offset:256
    ds_read_b64_tr_b16 a[188:189], v56 offset:8192
    ds_read_b64_tr_b16 a[190:191], v56 offset:8448
    s_mov_b32 s77, 32768
    s_call_b64 s[82:83], cf_dma
    s_waitcnt lgkmcnt(0)
    s_waitcnt vmcnt(8)
    v_add_u32 v55, 0, v51
    v_xor_b32 v56, 32, v55
    ds_read_b64_tr_b16 a[48:49], v55 offset:0
    ds_read_b64_tr_b16 a[50:51], v55 offset:256
    ds_read_b64_tr_b16 a[52:53], v55 offset:8192
    ds_read_b64_tr_b16 a[54:55], v55 offset:8448
    s_lshr_b32 s78, 4194304, s72
    s_add_u32 s78, s78, s67
    s_mov_b32 s81, 0
    s_add_u32 s80, s66, 98304
    s_mov_b32 s76, 0
    s_mov_b32 s77, 8192
    s_call_b64 s[82:83], cf_dma
    ds_read_b64_tr_b16 a[56:57], v56 offset:0
    ds_read_b64_tr_b16 a[58:59], v56 offset:256
    ds_read_b64_tr_b16 a[60:61], v56 offset:8192
    ds_read_b64_tr_b16 a[62:63], v56 offset:8448
    s_mov_b32 s77, 16384
    s_call_b64 s[82:83], cf_dma
    s_waitcnt lgkmcnt(0)
    v_add_u32 v55, 16384, v51
    v_xor_b32 v56, 32, v55
    ds_read_b64_tr_b16 a[64:65], v55 offset:0
    ds_read_b64_tr_b16 a[66:67], v55 offset:256
    ds_read_b64_tr_b16 a[68:69], v55 offset:8192
    ds_read_b64_tr_b16 a[70:71], v55 offset:8448
    s_xor_b32 s78, s75, 1048576
    s_lshr_b32 s78, s78, s72
    s_add_u32 s78, s78, s67
    s_mov_b32 s81, s93
    s_add_u32 s80, s66, 114688
    s_mov_b32 s76, 0
    s_mov_b32 s77, 8192
    s_call_b64 s[82:83], cf_dma
    ds_read_b64_tr_b16 a[72:73], v56 offset:0
    ds_read_b64_tr_b16 a[74:75], v56 offset:256
    ds_read_b64_tr_b16 a[76:77], v56 offset:8192
    ds_read_b64_tr_b16 a[78:79], v56 offset:8448
    s_mov_b32 s77, 16384
    s_call_b64 s[82:83], cf_dma
    s_waitcnt lgkmcnt(0)
    s_waitcnt vmcnt(8)
    v_add_u32 v55, 32768, v51
    v_xor_b32 v56, 32, v55
    ds_read_b64_tr_b16 a[80:81], v55 offset:0
    ds_read_b64_tr_b16 a[82:83], v55 offset:256
    ds_read_b64_tr_b16 a[84:85], v55 offset:8192
    ds_read_b64_tr_b16 a[86:87], v55 offset:8448
    s_mov_b32 s77, 24576
    s_call_b64 s[82:83], cf_dma
    ds_read_b64_tr_b16 a[88:89], v56 offset:0
    ds_read_b64_tr_b16 a[90:91], v56 offset:256
    ds_read_b64_tr_b16 a[92:93], v56 offset:8192
    ds_read_b64_tr_b16 a[94:95], v56 offset:8448
    s_mov_b32 s77, 32768
    s_call_b64 s[82:83], cf_dma
    s_waitcnt lgkmcnt(0)
    v_add_u32 v55, 49152, v51
    v_xor_b32 v56, 32, v55
    ds_read_b64_tr_b16 a[96:97], v55 offset:0
    ds_read_b64_tr_b16 a[98:99], v55 offset:256
    ds_read_b64_tr_b16 a[100:101], v55 offset:8192
    ds_read_b64_tr_b16 a[102:103], v55 offset:8448
    s_xor_b32 s78, s75, 0
    s_lshr_b32 s78, s78, s72
    s_add_u32 s78, s78, s67
    s_add_u32 s80, s66, 65536
    s_mov_b32 s76, 0
    s_mov_b32 s77, 8192
    s_call_b64 s[82:83], cf_dma
    ds_read_b64_tr_b16 a[104:105], v56 offset:0
    ds_read_b64_tr_b16 a[106:107], v56 offset:256
    ds_read_b64_tr_b16 a[108:109], v56 offset:8192
    ds_read_b64_tr_b16 a[110:111], v56 offset:8448
    s_mov_b32 s77, 16384
    s_call_b64 s[82:83], cf_dma
    s_waitcnt lgkmcnt(0)
    s_waitcnt vmcnt(12)
    v_add_u32 v55, 98304, v51
    v_xor_b32 v56, 32, v55
    ds_read_b64_tr_b16 a[112:113], v55 offset:0
    ds_read_b64_tr_b16 a[114:115], v55 offset:256
    ds_read_b64_tr_b16 a[116:117], v55 offset:8192
    ds_read_b64_tr_b16 a[118:119], v55 offset:8448
    s_mov_b32 s77, 24576
    s_call_b64 s[82:83], cf_dma
    ds_read_b64_tr_b16 a[120:121], v56 offset:0
    ds_read_b64_tr_b16 a[122:123], v56 offset:256
    ds_read_b64_tr_b16 a[124:125], v56 offset:8192
    ds_read_b64_tr_b16 a[126:127], v56 offset:8448
    s_mov_b32 s77, 32768
    s_call_b64 s[82:83], cf_dma
    s_waitcnt lgkmcnt(0)
    s_waitcnt vmcnt(8)
    v_add_u32 v55, 114688, v51
    v_xor_b32 v56, 32, v55
    ds_read_b64_tr_b16 a[16:17], v55 offset:0
    ds_read_b64_tr_b16 a[18:19], v55 offset:256
    ds_read_b64_tr_b16 a[20:21], v55 offset:8192
    ds_read_b64_tr_b16 a[22:23], v55 offset:8448
    s_xor_b32 s78, s75, 0
    s_lshr_b32 s78, s78, s72
    s_add_u32 s78, s78, s67
    s_mov_b64 s[8:9], s[52:53]
    s_add_u32 s80, s66, 0
    s_mov_b32 s76, 0
    s_mov_b32 s77, 8192
    s_call_b64 s[82:83], cf_dma
    ds_read_b64_tr_b16 a[24:25], v56 offset:0
    ds_read_b64_tr_b16 a[26:27], v56 offset:256
    ds_read_b64_tr_b16 a[28:29], v56 offset:8192
    ds_read_b64_tr_b16 a[30:31], v56 offset:8448
    s_mov_b32 s77, 16384
    s_call_b64 s[82:83], cf_dma
    s_waitcnt lgkmcnt(0)
    v_add_u32 v55, 131072, v51
    v_xor_b32 v56, 32, v55
    ds_read_b64_tr_b16 a[32:33], v55 offset:0
    ds_read_b64_tr_b16 a[34:35], v55 offset:256
    ds_read_b64_tr_b16 a[36:37], v55 offset:8192
    ds_read_b64_tr_b16 a[38:39], v55 offset:8448
    s_mov_b32 s77, 24576
    s_call_b64 s[82:83], cf_dma
    ds_read_b64_tr_b16 a[40:41], v56 offset:0
    ds_read_b64_tr_b16 a[42:43], v56 offset:256
    ds_read_b64_tr_b16 a[44:45], v56 offset:8192
    ds_read_b64_tr_b16 a[46:47], v56 offset:8448
    s_mov_b32 s77, 32768
    s_call_b64 s[82:83], cf_dma
    s_waitcnt lgkmcnt(0)
    s_waitcnt vmcnt(8)
    v_add_u32 v55, 65536, v51
    v_xor_b32 v56, 32, v55
    ds_read_b64_tr_b16 v[0:1], v55 offset:0
    ds_read_b64_tr_b16 v[2:3], v55 offset:256
    ds_read_b64_tr_b16 v[4:5], v55 offset:8192
    ds_read_b64_tr_b16 v[6:7], v55 offset:8448
    s_xor_b32 s78, s75, 1048576
    s_lshr_b32 s78, s78, s72
    s_add_u32 s78, s78, s67
    s_add_u32 s80, s66, 32768
    s_mov_b32 s76, 0
    s_mov_b32 s77, 8192
    s_call_b64 s[82:83], cf_dma
    ds_read_b64_tr_b16 v[8:9], v56 offset:0
    ds_read_b64_tr_b16 v[10:11], v56 offset:256
    ds_read_b64_tr_b16 v[12:13], v56 offset:8192
    ds_read_b64_tr_b16 v[14:15], v56 offset:8448
    s_mov_b32 s77, 16384
    s_call_b64 s[82:83], cf_dma
    s_waitcnt lgkmcnt(0)
    ds_write_b128 v62, v[0:3] offset:8192
    ds_write_b128 v62, v[4:7] offset:12288
    ds_write_b128 v62, v[8:11] offset:16384
    ds_write_b128 v62, v[12:15] offset:20480
    s_waitcnt lgkmcnt(0)
    v_add_u32 v55, 81920, v51
    v_xor_b32 v56, 32, v55
    ds_read_b64_tr_b16 a[0:1], v55 offset:0
    ds_read_b64_tr_b16 a[2:3], v55 offset:256
    ds_read_b64_tr_b16 a[4:5], v55 offset:8192
    ds_read_b64_tr_b16 a[6:7], v55 offset:8448
    s_mov_b32 s77, 24576
    s_call_b64 s[82:83], cf_dma
    ds_read_b64_tr_b16 a[8:9], v56 offset:0
    ds_read_b64_tr_b16 a[10:11], v56 offset:256
    ds_read_b64_tr_b16 a[12:13], v56 offset:8192
    ds_read_b64_tr_b16 a[14:15], v56 offset:8448
    s_mov_b32 s77, 32768
    s_call_b64 s[82:83], cf_dma
    s_waitcnt lgkmcnt(0)
    s_waitcnt vmcnt(8)
    v_add_u32 v55, 0, v51
    v_xor_b32 v56, 32, v55
    ds_read_b64_tr_b16 v[0:1], v55 offset:0
    ds_read_b64_tr_b16 v[2:3], v55 offset:256
    ds_read_b64_tr_b16 v[4:5], v55 offset:8192
    ds_read_b64_tr_b16 v[6:7], v55 offset:8448
    s_xor_b32 s94, s13, 0
    s_mul_i32 s94, s94, 36864
    s_add_u32 s94, s94, s92
    s_lshr_b32 s74, s13, 1
    s_lshl_b32 s74, s74, 6
    s_add_u32 s94, s94, s74
    s_add_u32 s78, s94, 1024
    s_mov_b64 s[8:9], s[56:57]
    v_mov_b32 v58, v50
    s_mov_b32 s79, 18432
    s_mov_b32 s81, 0
    s_add_u32 s80, s66, 147456
    s_mov_b32 s76, 0
    s_mov_b32 s77, 8192
    s_call_b64 s[82:83], cf_dma
    ds_read_b64_tr_b16 v[8:9], v56 offset:0
    ds_read_b64_tr_b16 v[10:11], v56 offset:256
    ds_read_b64_tr_b16 v[12:13], v56 offset:8192
    ds_read_b64_tr_b16 v[14:15], v56 offset:8448
    s_xor_b32 s94, s13, 2
    s_mul_i32 s94, s94, 36864
    s_add_u32 s94, s94, s92
    s_lshr_b32 s74, s13, 1
    s_lshl_b32 s74, s74, 6
    s_add_u32 s94, s94, s74
    s_add_u32 s78, s94, 1024
    s_mov_b32 s77, 16384
    s_call_b64 s[82:83], cf_dma
    s_waitcnt lgkmcnt(0)
    ds_write_b128 v61, v[0:3] offset:0
    ds_write_b128 v61, v[4:7] offset:4096
    ds_write_b128 v61, v[8:11] offset:8192
    ds_write_b128 v61, v[12:15] offset:12288
    s_waitcnt lgkmcnt(0)
    v_add_u32 v55, 16384, v51
    v_xor_b32 v56, 32, v55
    ds_read_b64_tr_b16 v[0:1], v55 offset:0
    ds_read_b64_tr_b16 v[2:3], v55 offset:256
    ds_read_b64_tr_b16 v[4:5], v55 offset:8192
    ds_read_b64_tr_b16 v[6:7], v55 offset:8448
    s_xor_b32 s94, s13, 3
    s_mul_i32 s94, s94, 36864
    s_add_u32 s94, s94, s92
    s_lshl_b32 s74, s13, 7
    s_add_u32 s94, s94, s74
    s_add_u32 s78, s94, 512
    v_mov_b32 v58, v49
    s_mov_b32 s79, 9216
    s_add_u32 s80, s66, 131072
    s_mov_b32 s76, 0
    s_mov_b32 s77, 8192
    s_call_b64 s[82:83], cf_dma
    ds_read_b64_tr_b16 v[8:9], v56 offset:0
    ds_read_b64_tr_b16 v[10:11], v56 offset:256
    ds_read_b64_tr_b16 v[12:13], v56 offset:8192
    ds_read_b64_tr_b16 v[14:15], v56 offset:8448
    s_mov_b32 s77, 16384
    s_call_b64 s[82:83], cf_dma
    s_waitcnt lgkmcnt(0)
    ds_write_b128 v61, v[0:3] offset:16384
    ds_write_b128 v61, v[4:7] offset:20480
    ds_write_b128 v61, v[8:11] offset:24576
    ds_write_b128 v61, v[12:15] offset:28672
    s_waitcnt lgkmcnt(0)
    s_waitcnt vmcnt(8)
    v_add_u32 v55, 32768, v51
    v_xor_b32 v56, 32, v55
    ds_read_b64_tr_b16 v[0:1], v55 offset:0
    ds_read_b64_tr_b16 v[2:3], v55 offset:256
    ds_read_b64_tr_b16 v[4:5], v55 offset:8192
    ds_read_b64_tr_b16 v[6:7], v55 offset:8448
    s_xor_b32 s94, s13, 2
    s_mul_i32 s94, s94, 36864
    s_add_u32 s94, s94, s92
    s_lshl_b32 s74, s13, 7
    s_add_u32 s94, s94, s74
    s_add_u32 s78, s94, 512
    s_add_u32 s80, s66, 114688
    s_mov_b32 s76, 0
    s_mov_b32 s77, 8192
    s_call_b64 s[82:83], cf_dma
    ds_read_b64_tr_b16 v[8:9], v56 offset:0
    ds_read_b64_tr_b16 v[10:11], v56 offset:256
    ds_read_b64_tr_b16 v[12:13], v56 offset:8192
    ds_read_b64_tr_b16 v[14:15], v56 offset:8448
    s_mov_b32 s77, 16384
    s_call_b64 s[82:83], cf_dma
    s_waitcnt lgkmcnt(0)
    ds_write_b128 v61, v[0:3] offset:32768
    ds_write_b128 v61, v[4:7] offset:36864
    ds_write_b128 v61, v[8:11] offset:40960
    ds_write_b128 v61, v[12:15] offset:45056
    s_waitcnt lgkmcnt(0)
    v_add_u32 v55, 49152, v51
    v_xor_b32 v56, 32, v55
    ds_read_b64_tr_b16 v[0:1], v55 offset:0
    ds_read_b64_tr_b16 v[2:3], v55 offset:256
    ds_read_b64_tr_b16 v[4:5], v55 offset:8192
    ds_read_b64_tr_b16 v[6:7], v55 offset:8448
    s_lshr_b32 s78, 4194304, s72
    s_add_u32 s78, s78, s67
    s_mov_b64 s[8:9], s[52:53]
    v_mov_b32 v58, v48
    s_lshr_b32 s79, 131072, s72
    s_add_u32 s80, s66, 81920
    s_mov_b32 s76, 0
    s_mov_b32 s77, 8192
    s_call_b64 s[82:83], cf_dma
    ds_read_b64_tr_b16 v[8:9], v56 offset:0
    ds_read_b64_tr_b16 v[10:11], v56 offset:256
    ds_read_b64_tr_b16 v[12:13], v56 offset:8192
    ds_read_b64_tr_b16 v[14:15], v56 offset:8448
    s_mov_b32 s77, 16384
    s_call_b64 s[82:83], cf_dma
    s_waitcnt lgkmcnt(0)
    ds_write_b128 v61, v[0:3] offset:49152
    ds_write_b128 v61, v[4:7] offset:53248
    ds_write_b128 v61, v[8:11] offset:57344
    ds_write_b128 v61, v[12:15] offset:61440
    s_waitcnt lgkmcnt(0)
    buffer_load_dword v38, off, s[96:99], 0 offset:140 sc1
    buffer_load_dword v39, off, s[96:99], 0 offset:64 sc1
    s_lshr_b32 s84, s12, 1
    s_lshl_b32 s84, s84, 8
    s_add_u32 s84, s84, 125829120
    v_bfe_u32 v40, v61, 4, 6
    v_min_u32 v40, 11, v40
    v_lshlrev_b32 v40, 2, v40
    buffer_load_dword v41, v40, s[4:7], s84 offen sc1
    s_waitcnt vmcnt(15)
    v_add_u32 v55, 147456, v53
    ds_read_b64_tr_b16 v[0:1], v55 offset:0
    ds_read_b64_tr_b16 v[2:3], v55 offset:128
    ds_read_b64_tr_b16 v[4:5], v55 offset:512
    ds_read_b64_tr_b16 v[6:7], v55 offset:640
    ds_read_b64_tr_b16 v[8:9], v55 offset:8192
    ds_read_b64_tr_b16 v[10:11], v55 offset:8320
    ds_read_b64_tr_b16 v[12:13], v55 offset:8704
    ds_read_b64_tr_b16 v[14:15], v55 offset:8832
    s_waitcnt lgkmcnt(0)
    s_barrier
    ds_write_b128 v63, v[0:3] offset:49152
    ds_write_b128 v63, v[4:7] offset:53248
    s_barrier
    ds_write_b128 v63, v[8:11] offset:57344
    ds_write_b128 v63, v[12:15] offset:61440
    s_waitcnt lgkmcnt(0)
    s_waitcnt vmcnt(11)
    v_add_u32 v55, 131072, v52
    ds_read_b64_tr_b16 v[0:1], v55 offset:0
    ds_read_b64_tr_b16 v[2:3], v55 offset:256
    ds_read_b64_tr_b16 v[4:5], v55 offset:4096
    ds_read_b64_tr_b16 v[6:7], v55 offset:4352
    ds_read_b64_tr_b16 v[8:9], v55 offset:64
    ds_read_b64_tr_b16 v[10:11], v55 offset:320
    ds_read_b64_tr_b16 v[12:13], v55 offset:4160
    ds_read_b64_tr_b16 v[14:15], v55 offset:4416
    s_waitcnt lgkmcnt(0)
    s_barrier
    ds_write_b128 v63, v[0:3] offset:32768
    ds_write_b128 v63, v[4:7] offset:36864
    s_barrier
    ds_write_b128 v63, v[8:11] offset:40960
    ds_write_b128 v63, v[12:15] offset:45056
    s_waitcnt lgkmcnt(0)
    s_waitcnt vmcnt(7)
    v_add_u32 v55, 114688, v52
    ds_read_b64_tr_b16 v[0:1], v55 offset:0
    ds_read_b64_tr_b16 v[2:3], v55 offset:256
    ds_read_b64_tr_b16 v[4:5], v55 offset:4096
    ds_read_b64_tr_b16 v[6:7], v55 offset:4352
    ds_read_b64_tr_b16 v[8:9], v55 offset:64
    ds_read_b64_tr_b16 v[10:11], v55 offset:320
    ds_read_b64_tr_b16 v[12:13], v55 offset:4160
    ds_read_b64_tr_b16 v[14:15], v55 offset:4416
    s_waitcnt lgkmcnt(0)
    s_barrier
    ds_write_b128 v63, v[0:3] offset:16384
    ds_write_b128 v63, v[4:7] offset:20480
    s_barrier
    ds_write_b128 v63, v[8:11] offset:24576
    ds_write_b128 v63, v[12:15] offset:28672
    s_waitcnt lgkmcnt(0)
    s_waitcnt vmcnt(3)
    v_add_u32 v55, 81920, v51
    v_xor_b32 v56, 32, v55
    ds_read_b64_tr_b16 v[0:1], v55 offset:0
    ds_read_b64_tr_b16 v[2:3], v55 offset:256
    ds_read_b64_tr_b16 v[4:5], v55 offset:8192
    ds_read_b64_tr_b16 v[6:7], v55 offset:8448
    ds_read_b64_tr_b16 v[8:9], v56 offset:0
    ds_read_b64_tr_b16 v[10:11], v56 offset:256
    ds_read_b64_tr_b16 v[12:13], v56 offset:8192
    ds_read_b64_tr_b16 v[14:15], v56 offset:8448
    s_waitcnt lgkmcnt(0)
    ds_write_b128 v62, v[0:3] offset:24576
    ds_write_b128 v62, v[4:7] offset:28672
    ds_write_b128 v62, v[8:11] offset:32768
    ds_write_b128 v62, v[12:15] offset:36864
    s_waitcnt lgkmcnt(0)
    s_barrier
    s_waitcnt vmcnt(0)
    v_readfirstlane_b32 s95, v39
    v_readfirstlane_b32 s85, v38
    s_nop 4
    s_mov_b32 s88, 4194304
gn4:
    s_cmp_lg_u32 s95, 0
    s_cbranch_scc1 gn4x
    buffer_load_dword v24, off, s[96:99], 0 offset:64 sc1
    s_sub_u32 s88, s88, 1
    s_cbranch_scc1 gn4x
    s_waitcnt vmcnt(0)
    v_readfirstlane_b32 s95, v24
    s_nop 1
    s_branch gn4
gn4x:
    s_add_u32 s93, s95, 2
    v_subrev_u32 v41, s93, v41
    v_cmp_lt_u32 s[86:87], 64, v41
    v_bfe_u32 v40, v61, 4, 4
    v_bfe_u32 v41, v61, 8, 1
    v_lshlrev_b32 v41, 2, v41
    v_sub_u32 v41, v40, v41
    v_mov_b32 v42, 0x3f80
    v_mov_b32 v43, 0x3f800000
    v_cmp_eq_u32 vcc, 0, v41
    s_nop 1
    v_cndmask_b32 v32, 0, v42, vcc
    v_cmp_eq_u32 vcc, 1, v41
    s_nop 1
    v_cndmask_b32 v32, v32, v43, vcc
    v_cmp_eq_u32 vcc, 0, v40
    s_nop 1
    v_cndmask_b32 v36, 0, v42, vcc
    v_cmp_eq_u32 vcc, 1, v40
    s_nop 1
    v_cndmask_b32 v36, v36, v43, vcc
    v_cmp_eq_u32 vcc, 2, v41
    s_nop 1
    v_cndmask_b32 v33, 0, v42, vcc
    v_cmp_eq_u32 vcc, 3, v41
    s_nop 1
    v_cndmask_b32 v33, v33, v43, vcc
    v_cmp_eq_u32 vcc, 2, v40
    s_nop 1
    v_cndmask_b32 v37, 0, v42, vcc
    v_cmp_eq_u32 vcc, 3, v40
    s_nop 1
    v_cndmask_b32 v37, v37, v43, vcc
    v_cmp_eq_u32 vcc, 8, v41
    s_nop 1
    v_cndmask_b32 v34, 0, v42, vcc
    v_cmp_eq_u32 vcc, 9, v41
    s_nop 1
    v_cndmask_b32 v34, v34, v43, vcc
    v_cmp_eq_u32 vcc, 4, v40
    s_nop 1
    v_cndmask_b32 v38, 0, v42, vcc
    v_cmp_eq_u32 vcc, 5, v40
    s_nop 1
    v_cndmask_b32 v38, v38, v43, vcc
    v_cmp_eq_u32 vcc, 10, v41
    s_nop 1
    v_cndmask_b32 v35, 0, v42, vcc
    v_cmp_eq_u32 vcc, 11, v41
    s_nop 1
    v_cndmask_b32 v35, v35, v43, vcc
    v_cmp_eq_u32 vcc, 6, v40
    s_nop 1
    v_cndmask_b32 v39, 0, v42, vcc
    v_cmp_eq_u32 vcc, 7, v40
    s_nop 1
    v_cndmask_b32 v39, v39, v43, vcc
    ds_write_b128 v78, v[32:35] offset:8704
    ds_write_b128 v65, v[36:39] offset:10240
    v_mov_b32 v44, s95
    v_mov_b32 v45, s95
    v_mov_b32 v46, s95
    v_mov_b32 v47, s95
    v_mov_b32 v48, 108288
    ds_write_b128 v48, v[44:47]
    s_waitcnt vmcnt(0) lgkmcnt(0)
    s_cmp_eq_u32 s85, 1
    s_cbranch_scc1 cf_run
    s_mov_b32 s40, 131072
cf_startpoll:
    buffer_load_dword v3, off, s[96:99], 0 offset:140 sc1
    s_waitcnt vmcnt(0)
    v_readfirstlane_b32 s85, v3
    s_nop 0
    s_cmp_eq_u32 s85, 1
    s_cbranch_scc1 cf_run
    s_cmp_eq_u32 s85, 2
    s_cbranch_scc1 cf_leave
    s_sleep 1
    s_sub_u32 s40, s40, 1
    s_cbranch_scc0 cf_startpoll
    v_mov_b32 v4, 2
    v_mov_b32 v5, 0
    s_mov_b64 exec, 1
    buffer_atomic_cmpswap v[4:5], off, s[96:99], 0 offset:140
    s_mov_b64 exec, -1
    s_mov_b32 s40, 1048576
    s_branch cf_startpoll
cf_leave:
    v_lshrrev_b32 v0, 4, v61
    s_mov_b32 s32, s13
    s_load_dwordx16 s[48:63], s[0:1], 0
    s_waitcnt lgkmcnt(0)
    s_branch L_helper
cf_run:
    s_cmp_eq_u64 s[86:87], 0
    s_cbranch_scc1 cf_kv0_go
    s_lshr_b32 s92, s12, 1
    s_lshl_b32 s92, s92, 8
    s_add_u32 s92, s92, 125829120
    v_bfe_u32 v2, v61, 4, 6
    v_min_u32 v2, 11, v2
    v_lshlrev_b32 v2, 2, v2
    s_add_u32 s93, s95, 2
    s_mov_b32 s94, 4194304
cf_kv0:
    buffer_load_dword v3, v2, s[4:7], s92 offen sc1
    s_sub_u32 s94, s94, 1
    s_cbranch_scc1 cf_kv0_go
    s_waitcnt vmcnt(0)
    v_subrev_u32 v3, s93, v3
    v_cmp_lt_u32 vcc, 64, v3
    s_cbranch_vccz cf_kv0_go
    s_sleep 2
    s_branch cf_kv0
cf_kv0_go:
    s_mov_b32 s44, 0x3e0293ee
    s_mov_b32 s45, s44
    s_mov_b32 s46, 0x42000000
    s_mov_b32 s47, 128
    s_mov_b32 s60, 0x3f803f80
    s_mov_b32 s61, s60
    s_mov_b32 s62, 0x3e803e80
    s_mov_b32 s63, s62
    s_mov_b32 s28, 0
    s_lshl_b32 s24, s12, 14
    s_add_u32 s24, s24, 0
    s_add_u32 s66, s24, 33030144
    s_mul_i32 s40, s13, 3072
    s_add_u32 s23, s24, s40
    s_lshl_b32 s20, s12, 7
    s_add_u32 s20, s20, 67174400
    s_add_u32 s21, s20, 65536
    s_add_u32 s38, s20, 4096
    s_add_u32 s39, s21, 4096
    s_lshl_b32 s22, s12, 7
    s_add_u32 s22, s22, 67182592
    s_lshl_b32 s40, s12, 12
    s_add_u32 s25, s40, 79429632
    s_add_u32 s26, s40, 88866816
    s_lshl_b32 s65, s12, 9
    s_add_u32 s65, s65, 90177536
    s_lshl_b32 s40, s13, 5
    s_or_b32 s40, s40, s12
    s_cmp_lt_u32 s40, 24
    s_cselect_b32 s36, 0x1ffffff, 0
    s_mov_b32 s37, 0
    s_lshl_b32 s27, s12, 7
    s_add_u32 s27, s27, 125845504
    s_lshl_b32 s40, s13, 2
    s_add_u32 s27, s27, s40
    s_mov_b32 m0, 108032
    v_lshlrev_b32 v56, 2, v61
    buffer_load_dword v56, s[4:7], s24 offen sc1 lds
    s_add_u32 s24, s24, 524288
    buffer_load_dword v56, s[4:7], s24 offen sc1 lds
    s_add_u32 s24, s24, 524288
    v_lshlrev_b32 v56, 2, v61
    s_lshl_b32 s40, s12, 14
    s_add_u32 s40, s40, 67174400
    buffer_load_dword v56, s[4:7], s40 offen sc1 lds
    s_and_b32 s40, s12, 3
    s_lshl_b32 s40, s40, 14
    s_add_u32 s40, s40, 67108864
    buffer_load_dword v56, s[4:7], s40 offen sc1 lds
    s_add_u32 s15, s14, 4096
    s_add_u32 s16, s14, 8192
    ds_read_b128 v[32:35], v62 offset:16384
    ds_read_b128 v[36:39], v62 offset:20480
    ds_read_b128 v[40:43], v61 offset:0
    ds_read_b128 v[44:47], v61 offset:4096
    ds_read_b128 v[48:51], v61 offset:8192
    ds_read_b128 v[52:55], v61 offset:12288
    s_mov_b32 s29, 1048576
    buffer_load_dwordx4 v[24:27], v61, s[4:7], s14 offen nt
.p2align 6
cf_loop:
    v_mov_b64 v[0:1], 0
    v_mov_b64 v[2:3], 0
    v_mov_b64 v[4:5], 0
    v_mov_b64 v[6:7], 0
    v_mov_b64 v[8:9], 0
    v_mov_b64 v[10:11], 0
    v_mov_b64 v[12:13], 0
    v_mov_b64 v[14:15], 0
cf_loop2:
    ds_read_b128 v[16:19], v62 offset:8192
    ds_read_b128 v[20:23], v62 offset:12288
    v_lshrrev_b32 v56, 2, v61
    v_add_u32 v58, 106496, v56
    s_mov_b32 s29, 1048576
    s_nop 13
    buffer_load_dwordx4 v[24:27], v61, s[4:7], s14 offen nt
    s_waitcnt lgkmcnt(0)
cf_chk0:
    s_waitcnt vmcnt(1)
cf_chk0b:
    v_max3_u32 v57, v24, v25, v26
    v_max_u32 v57, v57, v27
    v_cmp_eq_u32 vcc, -1, v57
    ds_write_b128 v62, v[24:27] offset:40960
    s_cbranch_vccnz cf_spin0
    v_smfmac_f32_16x16x64_bf16 v[0:3], v[24:27], v[16:23], v60
    buffer_load_dwordx4 v[28:31], v61, s[4:7], s15 offen nt
    buffer_load_dword v59, v56, s[4:7], s16 offen nt
    v_smfmac_f32_16x16x64_bf16 v[8:11], v[24:27], v[32:39], v60
    v_mov_b64 v[16:17], 0
    v_smfmac_f32_16x16x64_bf16 v[12:15], v[24:27], v[48:55], v60
    ds_read_b128 v[32:35], v61 offset:16384
    v_mov_b64 v[18:19], 0
    s_waitcnt lgkmcnt(1)
    s_barrier
    ds_read_b128 v[48:51], v63 offset:0
    ds_read_b128 v[36:39], v61 offset:20480
    v_smfmac_f32_16x16x64_bf16 v[4:7], v[24:27], v[40:47], v60
    ds_read_b128 v[40:43], v61 offset:24576
    v_mov_b64 v[20:21], 0
    v_smfmac_f32_16x16x64_bf16 v[16:19], v[24:27], a[192:199], v60
    ds_read_b128 v[44:47], v61 offset:28672
    v_mov_b64 v[22:23], 0
    ds_read_b128 v[52:55], v64 offset:0
    s_nop 0
    v_smfmac_f32_16x16x64_bf16 v[20:23], v[24:27], a[200:207], v60
    s_waitcnt lgkmcnt(4)
    v_smfmac_f32_16x16x64_bf16 v[0:3], v[48:51], a[0:7], v60
    s_add_u32 s18, s14, s31
    s_add_u32 s41, s14, 16384
    s_waitcnt lgkmcnt(3)
    v_smfmac_f32_16x16x64_bf16 v[4:7], v[48:51], v[32:39], v60
    ds_read_b128 v[32:35], v61 offset:32768
    v_smfmac_f32_16x16x64_bf16 v[8:11], v[48:51], a[8:15], v60
    ds_read_b128 v[36:39], v61 offset:36864
    s_waitcnt lgkmcnt(3)
    v_smfmac_f32_16x16x64_bf16 v[12:15], v[48:51], v[40:47], v60
    ds_read_b128 v[40:43], v61 offset:40960
    s_waitcnt lgkmcnt(3)
    v_smfmac_f32_16x16x64_bf16 v[0:3], v[52:55], a[16:23], v60
    ds_read_b128 v[44:47], v61 offset:45056
    v_smfmac_f32_16x16x64_bf16 v[8:11], v[52:55], a[24:31], v60
    ds_read_b128 v[48:51], v71 offset:0
    s_waitcnt lgkmcnt(3)
    v_smfmac_f32_16x16x64_bf16 v[4:7], v[52:55], v[32:39], v60
    s_waitcnt vmcnt(0)
    ds_write_b128 v62, v[28:31] offset:45056
    s_waitcnt lgkmcnt(2)
    v_smfmac_f32_16x16x64_bf16 v[12:15], v[52:55], v[40:47], v60
    ds_write_b32 v58, v59
    v_max3_u32 v57, v28, v29, v30
    s_waitcnt lgkmcnt(2)
    v_smfmac_f32_16x16x64_bf16 v[0:3], v[48:51], a[32:39], v60
    ds_read_b128 v[32:35], v61 offset:49152
    v_max3_u32 v57, v57, v31, v59
    v_smfmac_f32_16x16x64_bf16 v[8:11], v[48:51], a[40:47], v60
    ds_read_b128 v[36:39], v61 offset:53248
    v_cmp_eq_u32 vcc, -1, v57
    v_smfmac_f32_16x16x64_bf16 v[16:19], v[52:55], a[224:231], v60
    ds_read_b128 v[40:43], v61 offset:57344
    v_smfmac_f32_16x16x64_bf16 v[20:23], v[52:55], a[232:239], v60
    ds_read_b128 v[44:47], v61 offset:61440
    s_cbranch_vccnz cf_spin1
cf_go1:
    v_smfmac_f32_16x16x64_bf16 v[0:3], v[28:31], a[48:55], v60
    s_waitcnt lgkmcnt(4)
    s_barrier
    ds_read_b128 v[52:55], v63 offset:4096
    s_waitcnt lgkmcnt(3)
    v_smfmac_f32_16x16x64_bf16 v[4:7], v[48:51], v[32:39], v60
    ds_read_b128 v[56:59], v71 offset:4096
    v_smfmac_f32_16x16x64_bf16 v[8:11], v[28:31], a[56:63], v60
    buffer_load_dwordx4 v[32:35], v61, s[4:7], s23 offen offset:0 sc1
    s_waitcnt lgkmcnt(2)
    v_smfmac_f32_16x16x64_bf16 v[12:15], v[48:51], v[40:47], v60
    ds_read_b128 v[48:51], v64 offset:4096
    v_smfmac_f32_16x16x64_bf16 v[4:7], v[28:31], a[128:135], v60
    ds_read_b128 v[24:27], v65 offset:8192
    v_smfmac_f32_16x16x64_bf16 v[12:15], v[28:31], a[136:143], v60
    s_and_b32 s41, s41, 65535
    s_add_u32 s41, s41, 67108864
    v_smfmac_f32_16x16x64_bf16 v[16:19], v[28:31], v[80:87], v60
    buffer_load_dwordx4 v[36:39], v61, s[4:7], s23 offen offset:1024 sc1
    v_smfmac_f32_16x16x64_bf16 v[20:23], v[28:31], v[88:95], v60
    s_add_u32 s17, s41, s31
    s_and_b32 s30, s28, 1
    s_waitcnt lgkmcnt(3)
    v_smfmac_f32_16x16x64_bf16 v[0:3], v[52:55], a[64:71], v60
    ds_read_b128 v[28:31], v78 offset:8704
    v_smfmac_f32_16x16x64_bf16 v[4:7], v[52:55], a[144:151], v60
    buffer_load_dwordx4 v[40:43], v61, s[4:7], s23 offen offset:2048 sc1
    v_smfmac_f32_16x16x64_bf16 v[8:11], v[52:55], a[72:79], v60
    v_smfmac_f32_16x16x64_bf16 v[12:15], v[52:55], a[152:159], v60
    v_smfmac_f32_16x16x64_bf16 v[16:19], v[52:55], v[96:103], v60
    buffer_load_dwordx4 v[44:47], v61, s[4:7], s23 offen offset:3072 sc1
    v_smfmac_f32_16x16x64_bf16 v[20:23], v[52:55], v[104:111], v60
    ds_read_b128 v[52:55], v62 offset:28672
    s_waitcnt lgkmcnt(3)
    v_smfmac_f32_16x16x64_bf16 v[0:3], v[48:51], a[80:87], v60
    v_smfmac_f32_16x16x64_bf16 v[4:7], v[48:51], a[160:167], v60
    v_smfmac_f32_16x16x64_bf16 v[8:11], v[48:51], a[88:95], v60
    v_smfmac_f32_16x16x64_bf16 v[12:15], v[48:51], a[168:175], v60
    v_smfmac_f32_16x16x64_bf16 v[16:19], v[48:51], v[112:119], v60
    buffer_load_dword v79, s[4:7], s24 offen sc1 lds
    v_smfmac_f32_16x16x64_bf16 v[20:23], v[48:51], v[120:127], v60
    ds_read_b128 v[48:51], v62 offset:24576
    v_smfmac_f32_16x16x64_bf16 v[0:3], v[56:59], a[96:103], v60
    v_smfmac_f32_16x16x64_bf16 v[4:7], v[56:59], a[176:183], v60
    s_waitcnt lgkmcnt(3)
    v_smfmac_f32_16x16x64_bf16 v[0:3], v[24:27], a[112:119], v60
    s_cmp_ge_u32 s28, 62
    v_smfmac_f32_16x16x64_bf16 v[8:11], v[56:59], a[104:111], v60
    s_waitcnt lgkmcnt(0)
    v_smfmac_f32_16x16x64_bf16 v[4:7], v[24:27], v[48:55], v60
    ds_read_b128 v[48:51], v62 offset:32768
    v_cvt_pk_bf16_f32 v0, v0, v1
    v_smfmac_f32_16x16x64_bf16 v[12:15], v[56:59], a[184:191], v60
    ds_read_b128 v[52:55], v62 offset:36864
    v_cvt_pk_bf16_f32 v1, v2, v3
    v_smfmac_f32_16x16x64_bf16 v[8:11], v[24:27], a[120:127], v60
    v_cvt_pk_bf16_f32 v2, v4, v5
    v_smfmac_f32_16x16x64_bf16 v[16:19], v[56:59], v[128:135], v60
    v_cvt_pk_bf16_f32 v3, v6, v7
    s_nop 1
    v_mfma_f32_16x16x32_bf16 v[4:7], v[0:3], v[28:31], 0
    v_cvt_pk_bf16_f32 v8, v8, v9
    s_waitcnt lgkmcnt(0)
    v_smfmac_f32_16x16x64_bf16 v[12:15], v[24:27], v[48:55], v60
    ds_read_b128 v[48:51], v63 offset:0
    v_cvt_pk_bf16_f32 v9, v10, v11
    v_smfmac_f32_16x16x64_bf16 v[20:23], v[56:59], v[136:143], v60
    ds_read_b128 v[52:55], v71 offset:0
    v_cvt_pk_bf16_f32 v0, v4, v5
    s_nop 0
    v_cvt_pk_bf16_f32 v10, v12, v13
    v_cvt_pk_bf16_f32 v11, v14, v15
    v_cvt_pk_bf16_f32 v1, v6, v7
    s_waitcnt vmcnt(1)
    v_mfma_f32_16x16x32_bf16 v[12:15], v[8:11], v[28:31], 0
    s_mov_b64 exec, s[36:37]
    ds_read_b128 v[56:59], v69
    s_mov_b64 exec, -1
    v_smfmac_f32_16x16x64_bf16 v[16:19], v[24:27], v[144:151], v60
    s_nop 3
    v_cvt_pk_bf16_f32 v2, v12, v13
    v_cvt_pk_bf16_f32 v3, v14, v15
    s_nop 1
    v_mfma_f32_16x16x32_bf16 v[8:11], v[0:3], v[0:3], 0
    s_cbranch_scc1 cf_last
cf_back:
    v_mfma_f32_16x16x32_bf16 v[4:7], v[36:39], v[0:3], 0
    ds_read_b128 v[36:39], v63 offset:53248
    v_mfma_f32_16x16x32_bf16 v[12:15], v[32:35], v[0:3], 0
    ds_read_b128 v[32:35], v63 offset:49152
    v_mov_b32_dpp v8, v10 row_ror:8 row_mask:0xf bank_mask:0xc
    v_mov_b32_dpp v9, v11 row_ror:8 row_mask:0xf bank_mask:0xc
    ds_write_b64 v70, v[8:9]
    s_nop 1
    v_mov_b32_dpp v12, v4 row_ror:8 row_mask:0xf bank_mask:0xc
    v_mov_b32_dpp v13, v5 row_ror:8 row_mask:0xf bank_mask:0xc
    v_mov_b32_dpp v14, v6 row_ror:8 row_mask:0xf bank_mask:0xc
    v_mov_b32_dpp v15, v7 row_ror:8 row_mask:0xf bank_mask:0xc
    ds_write_b128 v62, v[12:15] offset:53248
    v_smfmac_f32_16x16x64_bf16 v[20:23], v[24:27], v[152:159], v60
    s_waitcnt lgkmcnt(4)
    s_mov_b64 exec, s[36:37]
    buffer_store_dwordx4 v[56:59], v61, s[4:7], s65 offen sc1
    s_mov_b64 exec, -1
    v_smfmac_f32_16x16x64_bf16 v[16:19], v[48:51], a[208:215], v60
    v_smfmac_f32_16x16x64_bf16 v[20:23], v[48:51], a[216:223], v60
    s_waitcnt lgkmcnt(0)
    s_barrier
    ds_read_b128 v[56:59], v78 offset:10752
    ds_read_b128 v[28:31], v78 offset:11264
    v_smfmac_f32_16x16x64_bf16 v[16:19], v[52:55], a[240:247], v60
    ds_read_b128 v[4:7], v63 offset:12288
    ds_read_b128 v[8:11], v64 offset:12288
    v_smfmac_f32_16x16x64_bf16 v[20:23], v[52:55], a[248:255], v60
    ds_read_b128 v[0:3], v71 offset:12288
    ds_read_b128 v[48:51], v63 offset:57344
    ds_read_b128 v[52:55], v63 offset:61440
    v_mul_f32 v12, s44, v12
    v_mul_f32 v13, s44, v13
    v_mul_f32 v14, s44, v14
    v_mul_f32 v15, s44, v15
    v_mov_b64 v[24:25], s[62:63]
    v_cvt_pk_bf16_f32 v16, v16, v17
    s_waitcnt lgkmcnt(5)
    v_pk_add_f32 v[56:57], v[56:57], v[58:59]
    v_pk_add_f32 v[28:29], v[28:29], v[30:31]
    v_pk_add_f32 v[56:57], v[56:57], v[28:29]
    v_pk_mul_f32 v[56:57], v[56:57], s[44:45]
    v_exp_f32 v58, v56
    v_exp_f32 v59, v57
    s_waitcnt lgkmcnt(4)
    v_pk_fma_f32 v[12:13], v[4:5], s[44:45], v[12:13]
    v_pk_fma_f32 v[14:15], v[6:7], s[44:45], v[14:15]
    v_cvt_pk_bf16_f32 v6, v58, v59
    v_cvt_pk_bf16_f32 v17, v18, v19
    s_waitcnt lgkmcnt(2)
    v_pk_fma_f32 v[12:13], v[8:9], s[44:45], v[12:13]
    v_pk_fma_f32 v[14:15], v[10:11], s[44:45], v[14:15]
    v_pk_fma_f32 v[12:13], v[0:1], s[44:45], v[12:13]
    v_mov_b32_dpp v7, v6 row_ror:8 row_mask:0xf bank_mask:0xf
    v_pk_fma_f32 v[14:15], v[2:3], s[44:45], v[14:15]
    v_exp_f32 v0, v12
    v_mfma_f32_16x16x16_bf16 v[28:31], v[16:17], v[6:7], 0
    v_exp_f32 v1, v13
    v_cvt_pk_bf16_f32 v18, v20, v21
    v_exp_f32 v2, v14
    v_cvt_pk_bf16_f32 v19, v22, v23
    v_cvt_pk_bf16_f32 v8, v0, v1
    v_exp_f32 v3, v15
    v_mfma_f32_16x16x16_bf16 v[20:23], v[18:19], v[6:7], 0
    v_mov_b64 v[26:27], s[60:61]
    v_cvt_pk_bf16_f32 v9, v2, v3
    v_mov_b32_dpp v10, v8 row_ror:8 row_mask:0xf bank_mask:0xf
    v_max3_f32 v4, |v12|, |v13|, |v14|
    v_mfma_f32_16x16x32_bf16 v[0:3], v[24:27], v[6:9], 0
    v_mov_b32_dpp v11, v9 row_ror:8 row_mask:0xf bank_mask:0xf
    v_max3_f32 v4, v4, |v15|, |v56|
    v_max_f32_e64 v4, v4, |v57|
    v_mfma_f32_16x16x32_bf16 v[28:31], v[40:43], v[8:11], v[28:31]
    v_cmp_nge_f32 vcc, s46, v4
    v_mfma_f32_16x16x32_bf16 v[20:23], v[44:47], v[8:11], v[20:23]
    s_cbranch_scc1 cf_stash
cf_back2:
    s_cbranch_vccnz cf_guard
cf_norm:
    v_add_f32_dpp v0, v0, v0 row_ror:8 row_mask:0xf bank_mask:0xf
    v_rcp_f32 v0, v0
    v_mfma_f32_16x16x16_bf16 v[12:15], v[72:73], v[72:73], 0
    v_mul_f32 v28, v28, v0
    v_mul_f32 v29, v29, v0
    v_mul_f32 v30, v30, v0
    v_mul_f32 v31, v31, v0
    v_mul_f32_dpp v28, v20, v0 row_ror:8 row_mask:0xf bank_mask:0xc
    v_mul_f32_dpp v29, v21, v0 row_ror:8 row_mask:0xf bank_mask:0xc
    v_mul_f32_dpp v30, v22, v0 row_ror:8 row_mask:0xf bank_mask:0xc
    v_mul_f32_dpp v31, v23, v0 row_ror:8 row_mask:0xf bank_mask:0xc
    v_cvt_pk_bf16_f32 v28, v28, v29
    v_cvt_pk_bf16_f32 v29, v30, v31
    v_mfma_f32_16x16x16_bf16 v[8:11], v[72:73], v[72:73], 0
    ds_write_b64 v77, v[28:29]
    v_mfma_f32_16x16x16_bf16 v[4:7], v[72:73], v[72:73], 0
    ds_read_b128 v[0:3], v68
    v_mfma_f32_16x16x16_bf16 v[16:19], v[72:73], v[72:73], 0
    ds_read_b128 v[40:43], v63 offset:16384
    v_mfma_f32_16x16x16_bf16 v[20:23], v[72:73], v[72:73], 0
    ds_read_b128 v[44:47], v63 offset:20480
    s_waitcnt lgkmcnt(3)
    s_barrier
    ds_read_b128 v[24:27], v74
    ds_read_b128 v[28:31], v75
    ds_read_b128 v[56:59], v76
    s_waitcnt lgkmcnt(5)
    v_smfmac_f32_16x16x64_bf16 v[12:15], v[0:3], v[160:167], v60
    v_smfmac_f32_16x16x64_bf16 v[8:11], v[0:3], v[192:199], v60
    v_smfmac_f32_16x16x64_bf16 v[4:7], v[0:3], v[32:39], v60
    ds_read_b128 v[32:35], v63 offset:32768
    v_smfmac_f32_16x16x64_bf16 v[16:19], v[0:3], v[224:231], v60
    ds_read_b128 v[36:39], v63 offset:36864
    s_waitcnt lgkmcnt(3)
    v_smfmac_f32_16x16x64_bf16 v[12:15], v[24:27], v[168:175], v60
    v_smfmac_f32_16x16x64_bf16 v[4:7], v[28:31], v[48:55], v60
    ds_read_b128 v[48:51], v63 offset:24576
    v_smfmac_f32_16x16x64_bf16 v[12:15], v[28:31], v[176:183], v60
    ds_read_b128 v[52:55], v63 offset:28672
    s_waitcnt lgkmcnt(4)
    v_smfmac_f32_16x16x64_bf16 v[12:15], v[56:59], v[184:191], v60
    v_cvt_pk_bf16_f32 v4, v4, v5
    v_smfmac_f32_16x16x64_bf16 v[16:19], v[28:31], v[40:47], v60
    ds_read_b128 v[40:43], v63 offset:40960
    v_and_or_b32 v4, v4, -2, s30
    v_smfmac_f32_16x16x64_bf16 v[8:11], v[24:27], v[200:207], v60
    ds_read_b128 v[44:47], v63 offset:45056
    v_cvt_pk_bf16_f32 v5, v6, v7
    v_smfmac_f32_16x16x64_bf16 v[8:11], v[28:31], v[208:215], v60
    buffer_store_dwordx2 v[4:5], v67, s[4:7], s22 offen
    v_cvt_pk_bf16_f32 v12, v12, v13
    v_smfmac_f32_16x16x64_bf16 v[8:11], v[56:59], v[216:223], v60
    v_and_or_b32 v12, v12, -2, s30
    v_smfmac_f32_16x16x64_bf16 v[16:19], v[24:27], v[232:239], v60
    v_cvt_pk_bf16_f32 v13, v14, v15
    s_waitcnt lgkmcnt(4)
    v_smfmac_f32_16x16x64_bf16 v[16:19], v[56:59], v[32:39], v60
    buffer_store_dwordx2 v[12:13], v66, s[4:7], s20 offen
    v_cvt_pk_bf16_f32 v8, v8, v9
    s_waitcnt lgkmcnt(0)
    v_smfmac_f32_16x16x64_bf16 v[20:23], v[0:3], v[240:247], v60
    v_and_or_b32 v8, v8, -2, s30
    v_smfmac_f32_16x16x64_bf16 v[20:23], v[24:27], v[248:255], v60
    v_cvt_pk_bf16_f32 v9, v10, v11
    v_smfmac_f32_16x16x64_bf16 v[20:23], v[28:31], v[48:55], v60
    buffer_store_dwordx2 v[8:9], v66, s[4:7], s21 offen
    v_cvt_pk_bf16_f32 v16, v16, v17
    v_smfmac_f32_16x16x64_bf16 v[20:23], v[56:59], v[40:47], v60
    v_and_or_b32 v16, v16, -2, s30
    v_cvt_pk_bf16_f32 v17, v18, v19
    buffer_store_dwordx2 v[16:17], v66, s[4:7], s38 offen
    s_cmp_lg_u32 s13, 2
    s_nop 1
    v_cvt_pk_bf16_f32 v20, v20, v21
    v_and_or_b32 v20, v20, -2, s30
    v_cvt_pk_bf16_f32 v21, v22, v23
    buffer_store_dwordx2 v[20:21], v66, s[4:7], s39 offen
    s_cbranch_scc1 cf_w013
    s_nop 15
    s_nop 15
    s_nop 15
    s_nop 15
    s_nop 7
    buffer_load_dwordx4 v[40:43], v65, s[4:7], s19 offen offset:0 nt
    buffer_load_dwordx4 v[44:47], v65, s[4:7], s19 offen offset:1024 nt
    buffer_load_dwordx4 v[48:51], v65, s[4:7], s19 offen offset:2048 nt
    buffer_load_dwordx4 v[52:55], v65, s[4:7], s19 offen offset:3072 nt
    ds_read_b128 v[56:59], v65 offset:10240
    s_add_u32 s28, s28, 1
    s_mov_b32 s14, s41
    s_add_u32 s23, s23, 524288
    s_add_u32 s24, s24, 524288
    s_min_u32 s24, s24, s66
    s_add_u32 s15, s14, 4096
    s_add_u32 s16, s14, 8192
    v_mov_b32 v21, -1
    s_add_u32 s65, s65, 12288
    s_mov_b32 s40, 1
    v_mov_b64 v[0:1], 0
    v_mov_b64 v[2:3], 0
    v_mov_b64 v[4:5], 0
    v_mov_b64 v[6:7], 0
    v_mov_b64 v[8:9], 0
    v_mov_b64 v[10:11], 0
    v_mov_b64 v[12:13], 0
    v_mov_b64 v[14:15], 0
cf_chkF:
    v_mov_b32 v20, 0
    s_waitcnt vmcnt(3)
    s_waitcnt lgkmcnt(0)
    v_mfma_f32_16x16x32_bf16 v[28:31], v[40:43], v[56:59], 0
    v_bitop3_b32 v20, v20, v40, s30 bitop3:0xf6
    v_bitop3_b32 v20, v20, v42, s30 bitop3:0xf6
    s_waitcnt vmcnt(2)
    v_mfma_f32_16x16x32_bf16 v[28:31], v[44:47], v[56:59], v[28:31]
    v_bitop3_b32 v20, v20, v44, s30 bitop3:0xf6
    v_bitop3_b32 v20, v20, v46, s30 bitop3:0xf6
    s_waitcnt vmcnt(1)
    v_mfma_f32_16x16x32_bf16 v[28:31], v[48:51], v[56:59], v[28:31]
    v_bitop3_b32 v20, v20, v48, s30 bitop3:0xf6
    v_bitop3_b32 v20, v20, v50, s30 bitop3:0xf6
    s_waitcnt vmcnt(0)
    v_mfma_f32_16x16x32_bf16 v[28:31], v[52:55], v[56:59], v[28:31]
    v_bitop3_b32 v20, v20, v52, s30 bitop3:0xf6
    v_bitop3_b32 v20, v20, v54, s30 bitop3:0xf6
    v_and_b32 v20, s40, v20
    v_cmp_ne_u32 vcc, 0, v20
    s_cbranch_vccnz cf_spinF
    v_permlane32_swap_b32 v28, v30
    v_permlane32_swap_b32 v29, v31
    v_add_f32 v28, v28, v30
    v_add_f32 v30, v29, v31
    v_cvt_pk_bf16_f32 v28, v28, v30
    s_mov_b64 exec, s[32:33]
    buffer_store_dword v28, v69, s[4:7], s17 offen
    buffer_store_dword v21, v69, s[4:7], s18 offen
    s_mov_b64 exec, -1
    ds_read_b128 v[32:35], v62 offset:16384
    ds_read_b128 v[36:39], v62 offset:20480
    ds_read_b128 v[40:43], v61 offset:0
    ds_read_b128 v[44:47], v61 offset:4096
    ds_read_b128 v[48:51], v61 offset:8192
    ds_read_b128 v[52:55], v61 offset:12288
    s_nop 14
    buffer_load_dwordx4 v[24:27], v61, s[4:7], s14 offen nt
    s_branch cf_loop2
cf_w013:
    ds_read_b128 v[56:59], v65 offset:10240
    ds_read_b128 v[32:35], v62 offset:16384
    ds_read_b128 v[36:39], v62 offset:20480
    ds_read_b128 v[40:43], v61 offset:0
    ds_read_b128 v[44:47], v61 offset:4096
    ds_read_b128 v[48:51], v61 offset:8192
    ds_read_b128 v[52:55], v61 offset:12288
    s_add_u32 s28, s28, 1
    s_mov_b32 s14, s41
    s_add_u32 s23, s23, 524288
    s_add_u32 s24, s24, 524288
    s_min_u32 s24, s24, s66
    s_add_u32 s15, s14, 4096
    s_add_u32 s16, s14, 8192
    v_mov_b32 v21, -1
    s_add_u32 s65, s65, 12288
    s_mov_b32 s40, 1
    s_cmp_eq_u32 s64, 0
    s_cbranch_scc1 cf_w0
    s_cmp_eq_u32 s13, 1
    s_nop 15
    s_nop 15
    s_nop 7
    s_cbranch_scc1 cf_sx
    s_nop 15
    s_nop 13
cf_sx:
    buffer_load_dwordx4 v[0:3], v65, s[4:7], s19 offen offset:0 nt
    buffer_load_dwordx4 v[4:7], v65, s[4:7], s19 offen offset:1024 nt
    buffer_load_dwordx4 v[8:11], v65, s[4:7], s19 offen offset:2048 nt
    buffer_load_dwordx4 v[12:15], v65, s[4:7], s19 offen offset:3072 nt
cf_chkG:
    v_mov_b32 v20, 0
    s_waitcnt vmcnt(3)
    s_waitcnt lgkmcnt(6)
    v_mfma_f32_16x16x32_bf16 v[28:31], v[0:3], v[56:59], 0
    v_bitop3_b32 v20, v20, v0, s30 bitop3:0xf6
    v_bitop3_b32 v20, v20, v2, s30 bitop3:0xf6
    s_waitcnt vmcnt(2)
    v_mfma_f32_16x16x32_bf16 v[28:31], v[4:7], v[56:59], v[28:31]
    v_bitop3_b32 v20, v20, v4, s30 bitop3:0xf6
    v_bitop3_b32 v20, v20, v6, s30 bitop3:0xf6
    s_waitcnt vmcnt(1)
    v_mfma_f32_16x16x32_bf16 v[28:31], v[8:11], v[56:59], v[28:31]
    v_bitop3_b32 v20, v20, v8, s30 bitop3:0xf6
    v_bitop3_b32 v20, v20, v10, s30 bitop3:0xf6
    s_waitcnt vmcnt(0)
    v_mfma_f32_16x16x32_bf16 v[28:31], v[12:15], v[56:59], v[28:31]
    v_bitop3_b32 v20, v20, v12, s30 bitop3:0xf6
    v_bitop3_b32 v20, v20, v14, s30 bitop3:0xf6
    v_and_b32 v20, s40, v20
    v_cmp_ne_u32 vcc, 0, v20
    s_cbranch_vccnz cf_spinG
    v_permlane32_swap_b32 v28, v30
    v_permlane32_swap_b32 v29, v31
    v_add_f32 v28, v28, v30
    v_add_f32 v30, v29, v31
    s_cmp_eq_u32 s13, 3
    s_cbranch_scc1 cf_w3
    v_mov_b32 v29, v28
    v_mov_b32 v31, v30
    s_nop 0
    v_permlane16_swap_b32 v28, v29
    v_permlane16_swap_b32 v30, v31
    v_add_f32 v28, v28, v29
    v_add_f32 v30, v30, v31
cf_w3:
    v_cvt_pk_bf16_f32 v28, v28, v30
    s_mov_b64 exec, s[32:33]
    buffer_store_dword v28, v69, s[4:7], s17 offen
    buffer_store_dword v21, v69, s[4:7], s18 offen
    s_mov_b64 exec, -1
    buffer_load_dwordx4 v[24:27], v61, s[4:7], s14 offen nt
    s_branch cf_loop
cf_w0:
    v_mov_b64 v[0:1], 0
    v_mov_b64 v[2:3], 0
    v_mov_b64 v[4:5], 0
    v_mov_b64 v[6:7], 0
    v_mov_b64 v[8:9], 0
    v_mov_b64 v[10:11], 0
    v_mov_b64 v[12:13], 0
    v_mov_b64 v[14:15], 0
    s_cmp_lg_u32 s28, 10
    s_cbranch_scc1 cf_nokv
    s_lshr_b32 s92, s12, 1
    s_lshl_b32 s92, s92, 8
    s_add_u32 s92, s92, 125829120
    v_bfe_u32 v28, v61, 4, 6
    v_min_u32 v28, 11, v28
    v_lshlrev_b32 v28, 2, v28
    s_add_u32 s93, s95, 63
    s_mov_b32 s94, 4194304
cf_kv1:
    buffer_load_dword v29, v28, s[4:7], s92 offen sc1
    s_sub_u32 s94, s94, 1
    s_cbranch_scc1 cf_kv1_go
    s_waitcnt vmcnt(0)
    v_subrev_u32 v29, s93, v29
    v_cmp_lt_u32 vcc, 64, v29
    s_cbranch_vccz cf_kv1_go
    s_sleep 2
    s_branch cf_kv1
cf_kv1_go:
cf_nokv:
    s_nop 15
    s_nop 15
    s_nop 15
    s_nop 15
    s_nop 15
    s_nop 15
    s_nop 15
    s_nop 15
    s_nop 15
    s_nop 15
    s_nop 7
    buffer_load_dwordx4 v[24:27], v61, s[4:7], s14 offen nt
    s_branch cf_loop2
cf_spinF:
    buffer_load_dwordx4 v[40:43], v65, s[4:7], s19 offen offset:0 nt
    buffer_load_dwordx4 v[44:47], v65, s[4:7], s19 offen offset:1024 nt
    buffer_load_dwordx4 v[48:51], v65, s[4:7], s19 offen offset:2048 nt
    buffer_load_dwordx4 v[52:55], v65, s[4:7], s19 offen offset:3072 nt
    s_sub_u32 s29, s29, 1
    s_cmp_lt_i32 s29, 0
    s_cselect_b32 s40, 0, 1
    s_branch cf_chkF
cf_spinG:
    buffer_load_dwordx4 v[0:3], v65, s[4:7], s19 offen offset:0 nt
    buffer_load_dwordx4 v[4:7], v65, s[4:7], s19 offen offset:1024 nt
    buffer_load_dwordx4 v[8:11], v65, s[4:7], s19 offen offset:2048 nt
    buffer_load_dwordx4 v[12:15], v65, s[4:7], s19 offen offset:3072 nt
    s_sub_u32 s29, s29, 1
    s_cmp_lt_i32 s29, 0
    s_cselect_b32 s40, 0, 1
    s_branch cf_chkG
cf_guard:
    s_nop 7
    v_max3_f32 v6, v12, v13, v14
    v_max3_f32 v7, v15, v56, v57
    v_max_f32 v6, v6, v7
    s_nop 1
    v_max_f32_dpp v6, v6, v6 row_ror:8 row_mask:0xf bank_mask:0xf
    v_mov_b32 v7, v6
    s_nop 1
    v_permlane32_swap_b32 v6, v7
    v_max_f32 v6, v6, v7
    v_mov_b32 v7, v6
    s_nop 1
    v_permlane16_swap_b32 v6, v7
    v_max_f32 v6, v6, v7
    v_sub_f32 v12, v12, v6
    v_sub_f32 v13, v13, v6
    v_sub_f32 v14, v14, v6
    v_sub_f32 v15, v15, v6
    v_sub_f32 v56, v56, v6
    v_sub_f32 v57, v57, v6
    v_exp_f32 v58, v56
    v_exp_f32 v59, v57
    s_nop 0
    v_cvt_pk_bf16_f32 v6, v58, v59
    s_nop 1
    v_mov_b32_dpp v7, v6 row_ror:8 row_mask:0xf bank_mask:0xf
    v_exp_f32 v0, v12
    s_nop 0
    v_mfma_f32_16x16x16_bf16 v[28:31], v[16:17], v[6:7], 0
    v_exp_f32 v1, v13
    v_exp_f32 v2, v14
    v_cvt_pk_bf16_f32 v8, v0, v1
    v_exp_f32 v3, v15
    v_mfma_f32_16x16x16_bf16 v[20:23], v[18:19], v[6:7], 0
    v_cvt_pk_bf16_f32 v9, v2, v3
    v_mov_b32_dpp v10, v8 row_ror:8 row_mask:0xf bank_mask:0xf
    v_max3_f32 v4, |v12|, |v13|, |v14|
    v_mfma_f32_16x16x32_bf16 v[0:3], v[24:27], v[6:9], 0
    v_mov_b32_dpp v11, v9 row_ror:8 row_mask:0xf bank_mask:0xf
    v_max3_f32 v4, v4, |v15|, |v56|
    v_max_f32_e64 v4, v4, |v57|
    v_mfma_f32_16x16x32_bf16 v[28:31], v[40:43], v[8:11], v[28:31]
    v_cmp_nge_f32 vcc, s46, v4
    v_mfma_f32_16x16x32_bf16 v[20:23], v[44:47], v[8:11], v[20:23]
    s_nop 7
    s_branch cf_norm
cf_stash:
    buffer_store_dwordx4 v[16:19], v61, s[4:7], s26 offen sc1
    s_add_u32 s26, s26, 131072
    s_nop 1
    s_branch cf_back2
cf_spin0:
    buffer_load_dwordx4 v[24:27], v61, s[4:7], s14 offen nt
    s_sub_u32 s29, s29, 1
    s_cmp_lt_i32 s29, 0
    s_cbranch_scc0 cf_chk0
    s_waitcnt vmcnt(0)
    v_min_u32 v24, -2, v24
    v_min_u32 v25, -2, v25
    v_min_u32 v26, -2, v26
    v_min_u32 v27, -2, v27
    s_branch cf_chk0
cf_spin1:
    buffer_load_dwordx4 v[28:31], v61, s[4:7], s15 offen nt
    buffer_load_dword v59, v56, s[4:7], s16 offen nt
    s_sub_u32 s29, s29, 1
    s_cmp_lt_i32 s29, 0
    s_waitcnt vmcnt(0)
    v_max3_u32 v57, v28, v29, v30
    v_max3_u32 v57, v57, v31, v59
    v_cmp_eq_u32 vcc, -1, v57
    ds_write_b128 v62, v[28:31] offset:45056
    ds_write_b32 v58, v59
    s_waitcnt lgkmcnt(0)
    s_cbranch_scc1 cf_go1
    s_cbranch_vccnz cf_spin1
    s_branch cf_go1
cf_last:
    s_nop 1
    s_cmp_eq_u32 s28, 63
    s_cbranch_scc1 cf_last2
    s_mov_b64 exec, s[34:35]
    buffer_store_dwordx4 v[0:3], v61, s[4:7], s25 offen sc1
    s_mov_b64 exec, -1
    s_add_u32 s25, s25, 131072
    s_cmp_eq_u32 0, 0
    s_branch cf_back
cf_last2:
    s_waitcnt lgkmcnt(0)
    s_mov_b64 exec, s[34:35]
    buffer_store_dwordx4 v[0:3], v61, s[4:7], s25 offen sc1
    s_mov_b64 exec, -1
    s_add_u32 s40, s95, 64
    v_mov_b32 v32, s40
    v_smfmac_f32_16x16x64_bf16 v[20:23], v[24:27], v[152:159], v60
    v_smfmac_f32_16x16x64_bf16 v[16:19], v[48:51], a[208:215], v60
    v_smfmac_f32_16x16x64_bf16 v[20:23], v[48:51], a[216:223], v60
    v_smfmac_f32_16x16x64_bf16 v[16:19], v[52:55], a[240:247], v60
    v_smfmac_f32_16x16x64_bf16 v[20:23], v[52:55], a[248:255], v60
    s_nop 3
    v_cvt_pk_bf16_f32 v16, v16, v17
    v_cvt_pk_bf16_f32 v17, v18, v19
    s_nop 1
    v_cvt_pk_bf16_f32 v18, v20, v21
    v_cvt_pk_bf16_f32 v19, v22, v23
    buffer_store_dwordx4 v[16:19], v61, s[4:7], s26 offen sc1
    s_waitcnt vmcnt(0)
    s_mov_b64 exec, 1
    buffer_store_dword v32, off, s[4:7], s27 sc1
    s_mov_b64 exec, -1
    s_endpgm
cf_dma:
    s_xor_b32 s74, s76, s81
    s_add_u32 m0, s74, s80
    s_add_u32 s76, s76, 4096
    buffer_load_dwordx4 v58, s[8:11], s78 offen lds
    s_add_u32 s78, s78, s79
    s_cmp_lt_u32 s76, s77
    s_cbranch_scc1 cf_dma
    s_setpc_b64 s[82:83]
L_chain_safe:
    s_mov_b64 s[48:49], s[50:51]
    s_mov_b64 s[50:51], s[52:53]
    s_mov_b64 s[52:53], s[54:55]
    s_mov_b64 s[54:55], s[56:57]
    s_mov_b64 s[56:57], s[58:59]
    v_lshrrev_b32 v54, 6, v0
    s_nop 0
    v_readfirstlane_b32 s13, v54
    v_and_b32 v57, 63, v0
    v_bfe_u32 v54, v57, 2, 1
    v_lshlrev_b32 v48, 13, v54
    v_bfe_u32 v54, v57, 3, 1
    v_lshl_add_u32 v48, v54, 15, v48
    v_bfe_u32 v54, v57, 4, 1
    v_lshl_add_u32 v48, v54, 14, v48
    v_bfe_u32 v54, v57, 5, 1
    v_lshl_add_u32 v48, v54, 16, v48
    v_lshrrev_b32 v55, 4, v57
    v_and_b32 v55, 2, v55
    v_xor_b32 v55, v55, v57
    v_and_b32 v55, 3, v55
    v_lshl_add_u32 v48, v55, 4, v48
    v_bfe_u32 v54, v57, 2, 1
    v_lshlrev_b32 v51, 6, v54
    v_bfe_u32 v54, v57, 3, 1
    v_lshl_add_u32 v51, v54, 9, v51
    v_bfe_u32 v54, v57, 4, 1
    v_lshl_add_u32 v51, v54, 7, v51
    v_bfe_u32 v54, v57, 5, 1
    v_lshl_add_u32 v51, v54, 12, v51
    v_bfe_u32 v54, v57, 0, 1
    v_lshl_add_u32 v51, v54, 3, v51
    v_bfe_u32 v54, v57, 1, 1
    v_lshl_add_u32 v51, v54, 4, v51
    v_bfe_u32 v54, v57, 3, 1
    v_lshl_add_u32 v51, v54, 5, v51
    v_lshrrev_b32 v55, 3, v57
    v_mul_u32_u24 v49, 1152, v55
    v_and_b32 v55, 7, v57
    v_lshl_add_u32 v49, v55, 4, v49
    v_bfe_u32 v54, v57, 4, 1
    v_lshlrev_b32 v52, 13, v54
    v_bfe_u32 v54, v57, 5, 1
    v_lshl_add_u32 v52, v54, 9, v52
    v_bfe_u32 v54, v57, 2, 1
    v_lshl_add_u32 v52, v54, 7, v52
    v_bfe_u32 v54, v57, 3, 1
    v_lshl_add_u32 v52, v54, 5, v52
    v_and_b32 v55, 3, v57
    v_lshl_add_u32 v52, v55, 3, v52
    v_lshrrev_b32 v55, 2, v57
    v_mul_u32_u24 v50, 1152, v55
    v_and_b32 v55, 3, v57
    v_lshl_add_u32 v50, v55, 4, v50
    v_bfe_u32 v54, v57, 4, 1
    v_lshlrev_b32 v53, 12, v54
    v_bfe_u32 v54, v57, 5, 1
    v_lshl_add_u32 v53, v54, 8, v53
    v_bfe_u32 v54, v57, 2, 1
    v_lshl_add_u32 v53, v54, 6, v53
    v_bfe_u32 v54, v57, 3, 1
    v_lshl_add_u32 v53, v54, 5, v53
    v_and_b32 v55, 3, v57
    v_lshl_add_u32 v53, v55, 3, v53
    s_lshl_b32 s66, s13, 10
    s_and_b32 s93, s13, 1
    s_lshl_b32 s93, s93, 14
    s_and_b32 s75, s13, 2
    s_lshl_b32 s75, s75, 19
    v_add_u32 v51, s66, v51
    v_add_u32 v52, s66, v52
    v_add_u32 v53, s66, v53
    v_mov_b32 v58, v48
    s_mov_b32 s10, 4718592
    s_mov_b32 s11, 0x20000
    s_lshl_b32 s67, s12, 8
    s_lshl_b32 s40, s13, 6
    s_add_u32 s67, s67, s40
    s_mul_i32 s92, s12, 147456
    s_lshr_b32 s73, s50, 8
    s_add_u32 s73, s73, s12
    s_and_b32 s73, s73, 31
    s_bitcmp1_b32 0xa2222222, s73
    s_cselect_b32 s72, 0, 0
    s_add_u32 s73, s73, 1
    s_lshr_b32 s73, s73, 2
    s_xor_b32 s94, s13, 0
    s_mul_i32 s94, s94, 36864
    s_add_u32 s94, s94, s92
    s_lshl_b32 s74, s13, 7
    s_add_u32 s94, s94, s74
    s_add_u32 s78, s94, 0
    s_mov_b64 s[8:9], s[56:57]
    v_mov_b32 v58, v49
    s_mov_b32 s79, 9216
    s_mov_b32 s81, 0
    s_add_u32 s80, s66, 114688
    s_mov_b32 s76, 0
    s_mov_b32 s77, 8192
    s_call_b64 s[82:83], cs_dma
    s_mov_b32 s77, 16384
    s_call_b64 s[82:83], cs_dma
    s_xor_b32 s94, s13, 1
    s_mul_i32 s94, s94, 36864
    s_add_u32 s94, s94, s92
    s_lshl_b32 s74, s13, 7
    s_add_u32 s94, s94, s74
    s_add_u32 s78, s94, 0
    s_add_u32 s80, s66, 81920
    s_mov_b32 s76, 0
    s_mov_b32 s77, 8192
    s_call_b64 s[82:83], cs_dma
    s_mov_b32 s77, 16384
    s_call_b64 s[82:83], cs_dma
    s_xor_b32 s94, s13, 2
    s_mul_i32 s94, s94, 36864
    s_add_u32 s94, s94, s92
    s_lshl_b32 s74, s13, 7
    s_add_u32 s94, s94, s74
    s_add_u32 s78, s94, 0
    s_add_u32 s80, s66, 16384
    s_mov_b32 s76, 0
    s_mov_b32 s77, 8192
    s_call_b64 s[82:83], cs_dma
    v_lshrrev_b32 v24, 6, v0
    v_lshlrev_b32 v61, 4, v0
    v_add_u32 v62, 57344, v61
    v_xor_b32 v63, 1024, v61
    v_add_u32 v63, 98304, v63
    v_xor_b32 v64, 2048, v61
    v_add_u32 v64, 98304, v64
    v_and_b32 v65, 1023, v61
    v_add_u32 v65, 98304, v65
    v_and_b32 v26, 15, v0
    v_bfe_u32 v27, v0, 4, 2
    v_mov_b32 v60, 0x4444
    v_mov_b32 v25, 0xeeee
    v_cmp_lt_u32 vcc, 7, v26
    s_nop 1
    v_cndmask_b32 v60, v60, v25, vcc
    s_mov_b32 s77, 16384
    s_call_b64 s[82:83], cs_dma
    v_and_b32 v67, 12, v26
    v_lshlrev_b32 v67, 3, v67
    v_and_b32 v25, 1, v26
    v_lshl_add_u32 v67, v25, 4, v67
    v_bfe_u32 v25, v26, 1, 1
    v_lshl_add_u32 v67, v25, 3, v67
    v_lshl_add_u32 v66, v27, 14, v67
    v_lshl_add_u32 v66, v24, 17, v66
    s_xor_b32 s94, s13, 3
    s_mul_i32 s94, s94, 36864
    s_add_u32 s94, s94, s92
    s_lshl_b32 s74, s13, 7
    s_add_u32 s94, s94, s74
    s_add_u32 s78, s94, 0
    s_add_u32 s80, s66, 0
    s_mov_b32 s76, 0
    s_mov_b32 s77, 8192
    s_call_b64 s[82:83], cs_dma
    v_and_b32 v67, 63, v67
    v_lshrrev_b32 v25, 1, v24
    v_lshl_add_u32 v67, v25, 18, v67
    v_lshl_add_u32 v67, v27, 16, v67
    v_lshrrev_b32 v25, 3, v26
    v_lshl_add_u32 v67, v25, 15, v67
    v_and_b32 v25, 1, v24
    v_lshl_add_u32 v67, v25, 6, v67
    s_mov_b32 s77, 16384
    s_call_b64 s[82:83], cs_dma
    v_and_b32 v25, 31, v0
    v_lshlrev_b32 v70, 4, v25
    v_lshlrev_b32 v28, 3, v25
    v_lshl_add_u32 v28, v24, 10, v28
    v_add_u32 v28, 110592, v28
    v_lshrrev_b32 v25, 1, v24
    v_lshl_add_u32 v70, v25, 9, v70
    v_and_b32 v25, 1, v24
    v_lshl_add_u32 v70, v25, 3, v70
    v_add_u32 v70, 109568, v70
    v_cmp_gt_u32 vcc, 2, v27
    s_nop 1
    v_cndmask_b32 v70, v70, v28, vcc
    v_xor_b32 v71, 2048, v63
    v_lshrrev_b32 v68, 4, v0
    v_lshlrev_b32 v68, 7, v68
    v_and_b32 v25, 7, v26
    v_lshl_add_u32 v68, v25, 4, v68
    v_add_u32 v68, 98304, v68
    v_xor_b32 v74, 512, v68
    v_xor_b32 v75, 1024, v68
    v_xor_b32 v76, 1536, v68
    v_lshrrev_b32 v25, 3, v26
    v_lshl_add_u32 v77, v25, 3, v68
    v_or_b32 v78, 512, v65
    v_lshlrev_b32 v79, 2, v61
    v_mov_b64 v[72:73], 0
    v_and_b32 v25, 1, v27
    v_lshlrev_b32 v69, 7, v25
    v_lshrrev_b32 v25, 1, v27
    v_lshl_add_u32 v69, v25, 3, v69
    v_and_b32 v25, 3, v26
    v_lshl_add_u32 v69, v25, 4, v69
    v_bfe_u32 v25, v26, 2, 1
    v_lshl_add_u32 v69, v25, 2, v69
    s_mov_b32 s32, 0x00ff00ff
    s_mov_b32 s33, 0x00ff00ff
    s_not_b64 s[34:35], s[32:33]
    s_lshr_b32 s31, s12, 1
    s_lshl_b32 s31, s31, 8
    s_and_b32 s40, s12, 1
    s_lshl_b32 s40, s40, 6
    s_add_u32 s31, s31, s40
    s_and_b32 s40, s13, 1
    s_lshl_b32 s40, s40, 12
    s_add_u32 s31, s31, s40
    s_lshl_b32 s19, s12, 14
    s_add_u32 s19, s19, 68124672
    s_add_u32 s41, s19, 8192
    s_add_u32 s19, s19, s40
    s_and_b32 s40, s12, 1
    s_lshl_b32 s40, s40, 2
    s_or_b32 s40, s40, s13
    s_cmp_eq_u32 s40, 5
    s_cselect_b32 s64, 0, s13
    s_cmp_lg_u32 s13, 1
    s_cbranch_scc1 cs_notx
    s_mov_b32 s32, 0xff
    s_mov_b32 s33, 0xff
    s_mov_b32 s19, s41
    s_lshr_b32 s31, s12, 3
    s_lshl_b32 s31, s31, 8
    s_and_b32 s40, s12, 2
    s_lshl_b32 s40, s40, 6
    s_add_u32 s31, s31, s40
    s_and_b32 s40, s12, 4
    s_lshl_b32 s40, s40, 4
    s_add_u32 s31, s31, s40
    s_add_u32 s31, s31, 8192
cs_notx:
    s_cmp_lg_u32 s13, 0
    s_cbranch_scc1 cs_notp
    s_min_u32 s40, s12, 23
    s_mul_i32 s40, s40, 384
    s_add_u32 s40, s40, 98304
    v_add_u32 v69, s40, v61
    v_mov_b32 v25, 108288
    v_cmp_lt_u32 vcc, 23, v0
    s_nop 1
    v_cndmask_b32 v69, v69, v25, vcc
cs_notp:
    s_nop 1
    v_mov_b32 v28, 1
    v_mov_b32 v29, 1
    v_mov_b32 v30, 1
    v_mov_b32 v31, 1
    s_lshl_b32 s40, s12, 14
    s_add_u32 s40, s40, 68222976
    s_add_u32 s41, s40, 0
    buffer_store_dwordx4 v[28:31], v61, s[4:7], s41 offen sc1
    s_add_u32 s41, s40, 4096
    buffer_store_dwordx4 v[28:31], v61, s[4:7], s41 offen sc1
    s_add_u32 s41, s40, 8192
    buffer_store_dwordx4 v[28:31], v61, s[4:7], s41 offen sc1
    s_cmp_eq_u32 s64, 0
    s_cselect_b64 exec, 0, s[32:33]
    v_mov_b32 v27, -1
    s_add_u32 s41, s31, 68157440
    buffer_store_dword v27, v69, s[4:7], s41 offen sc1
    s_add_u32 s41, s31, 68173824
    buffer_store_dword v27, v69, s[4:7], s41 offen sc1
    s_add_u32 s41, s31, 68190208
    buffer_store_dword v27, v69, s[4:7], s41 offen sc1
    s_add_u32 s41, s31, 68206592
    buffer_store_dword v27, v69, s[4:7], s41 offen sc1
    s_mov_b64 exec, -1
    s_mov_b64 s[68:69], s[48:49]
    s_mov_b32 s70, 9216
    s_mov_b32 s71, 0x20000
    v_and_b32 v25, 7, v0
    v_mul_u32_u24 v25, 1152, v25
    v_lshrrev_b32 v26, 3, v0
    v_lshl_add_u32 v25, v26, 4, v25
    buffer_load_dwordx4 v[36:39], v25, s[68:71], 0 offen
    buffer_load_dwordx4 v[40:43], v25, s[68:71], 0 offen offset:512
    v_bfe_u32 v25, v0, 2, 3
    v_mul_u32_u24 v25, 1152, v25
    v_lshrrev_b32 v26, 5, v0
    v_lshl_add_u32 v25, v26, 4, v25
    v_and_b32 v26, 3, v0
    v_lshl_add_u32 v25, v26, 2, v25
    buffer_load_dword v44, v25, s[68:71], 0 offen offset:1024
    s_waitcnt vmcnt(15)
    v_add_u32 v55, 114688, v52
    ds_read_b64_tr_b16 v[160:161], v55 offset:0
    ds_read_b64_tr_b16 v[162:163], v55 offset:256
    ds_read_b64_tr_b16 v[164:165], v55 offset:4096
    ds_read_b64_tr_b16 v[166:167], v55 offset:4352
    s_xor_b32 s94, s13, 0
    s_mul_i32 s94, s94, 36864
    s_add_u32 s94, s94, s92
    s_lshl_b32 s74, s13, 7
    s_add_u32 s94, s94, s74
    s_add_u32 s78, s94, 512
    s_add_u32 s80, s66, 147456
    s_mov_b32 s76, 0
    s_mov_b32 s77, 8192
    s_call_b64 s[82:83], cs_dma
    ds_read_b64_tr_b16 v[192:193], v55 offset:64
    ds_read_b64_tr_b16 v[194:195], v55 offset:320
    ds_read_b64_tr_b16 v[196:197], v55 offset:4160
    ds_read_b64_tr_b16 v[198:199], v55 offset:4416
    s_mov_b32 s77, 16384
    s_call_b64 s[82:83], cs_dma
    s_waitcnt lgkmcnt(0)
    s_waitcnt vmcnt(15)
    v_add_u32 v55, 81920, v52
    ds_read_b64_tr_b16 v[168:169], v55 offset:0
    ds_read_b64_tr_b16 v[170:171], v55 offset:256
    ds_read_b64_tr_b16 v[172:173], v55 offset:4096
    ds_read_b64_tr_b16 v[174:175], v55 offset:4352
    s_xor_b32 s94, s13, 1
    s_mul_i32 s94, s94, 36864
    s_add_u32 s94, s94, s92
    s_lshl_b32 s74, s13, 7
    s_add_u32 s94, s94, s74
    s_add_u32 s78, s94, 512
    s_add_u32 s80, s66, 98304
    s_mov_b32 s76, 0
    s_mov_b32 s77, 8192
    s_call_b64 s[82:83], cs_dma
    ds_read_b64_tr_b16 v[200:201], v55 offset:64
    ds_read_b64_tr_b16 v[202:203], v55 offset:320
    ds_read_b64_tr_b16 v[204:205], v55 offset:4160
    ds_read_b64_tr_b16 v[206:207], v55 offset:4416
    s_mov_b32 s77, 16384
    s_call_b64 s[82:83], cs_dma
    s_waitcnt lgkmcnt(0)
    s_waitcnt vmcnt(15)
    v_add_u32 v55, 16384, v52
    ds_read_b64_tr_b16 v[176:177], v55 offset:0
    ds_read_b64_tr_b16 v[178:179], v55 offset:256
    ds_read_b64_tr_b16 v[180:181], v55 offset:4096
    ds_read_b64_tr_b16 v[182:183], v55 offset:4352
    s_add_u32 s78, s67, 4194304
    s_mov_b64 s[8:9], s[54:55]
    v_mov_b32 v58, v48
    s_mov_b32 s79, 131072
    s_add_u32 s80, s66, 32768
    s_mov_b32 s76, 0
    s_mov_b32 s77, 8192
    s_call_b64 s[82:83], cs_dma
    ds_read_b64_tr_b16 v[208:209], v55 offset:64
    ds_read_b64_tr_b16 v[210:211], v55 offset:320
    ds_read_b64_tr_b16 v[212:213], v55 offset:4160
    ds_read_b64_tr_b16 v[214:215], v55 offset:4416
    s_mov_b32 s77, 16384
    s_call_b64 s[82:83], cs_dma
    s_waitcnt lgkmcnt(0)
    s_waitcnt vmcnt(15)
    v_add_u32 v55, 0, v52
    ds_read_b64_tr_b16 v[184:185], v55 offset:0
    ds_read_b64_tr_b16 v[186:187], v55 offset:256
    ds_read_b64_tr_b16 v[188:189], v55 offset:4096
    ds_read_b64_tr_b16 v[190:191], v55 offset:4352
    s_xor_b32 s78, s75, 0
    s_add_u32 s78, s78, s67
    s_mov_b32 s81, s93
    s_add_u32 s80, s66, 114688
    s_mov_b32 s76, 0
    s_mov_b32 s77, 8192
    s_call_b64 s[82:83], cs_dma
    ds_read_b64_tr_b16 v[216:217], v55 offset:64
    ds_read_b64_tr_b16 v[218:219], v55 offset:320
    ds_read_b64_tr_b16 v[220:221], v55 offset:4160
    ds_read_b64_tr_b16 v[222:223], v55 offset:4416
    s_mov_b32 s77, 16384
    s_call_b64 s[82:83], cs_dma
    s_waitcnt lgkmcnt(0)
    s_waitcnt vmcnt(12)
    v_add_u32 v55, 147456, v52
    ds_read_b64_tr_b16 v[224:225], v55 offset:0
    ds_read_b64_tr_b16 v[226:227], v55 offset:256
    ds_read_b64_tr_b16 v[228:229], v55 offset:4096
    ds_read_b64_tr_b16 v[230:231], v55 offset:4352
    s_mov_b32 s77, 24576
    s_call_b64 s[82:83], cs_dma
    ds_read_b64_tr_b16 v[240:241], v55 offset:64
    ds_read_b64_tr_b16 v[242:243], v55 offset:320
    ds_read_b64_tr_b16 v[244:245], v55 offset:4160
    ds_read_b64_tr_b16 v[246:247], v55 offset:4416
    s_mov_b32 s77, 32768
    s_call_b64 s[82:83], cs_dma
    s_waitcnt lgkmcnt(0)
    v_min_u32 v36, -2, v36
    v_min_u32 v37, -2, v37
    v_min_u32 v38, -2, v38
    v_min_u32 v39, -2, v39
    v_min_u32 v40, -2, v40
    v_min_u32 v41, -2, v41
    v_min_u32 v42, -2, v42
    v_min_u32 v43, -2, v43
    v_min_u32 v44, -2, v44
    s_lshl_b32 s14, s12, 16
    s_add_u32 s14, s14, 92274688
    s_add_u32 s41, s14, 4096
    s_add_u32 s42, s14, 8192
    v_lshrrev_b32 v45, 2, v61
    buffer_store_dwordx4 v[36:39], v61, s[4:7], s14 offen sc1
    buffer_store_dwordx4 v[40:43], v61, s[4:7], s41 offen sc1
    buffer_store_dword v44, v45, s[4:7], s42 offen sc1
    v_mov_b32 v46, 1
    s_mov_b64 exec, 1
    buffer_atomic_add v46, off, s[96:99], 0 offset:212 sc0
    s_mov_b64 exec, -1
    s_waitcnt vmcnt(13)
    v_add_u32 v55, 98304, v52
    ds_read_b64_tr_b16 v[232:233], v55 offset:0
    ds_read_b64_tr_b16 v[234:235], v55 offset:256
    ds_read_b64_tr_b16 v[236:237], v55 offset:4096
    ds_read_b64_tr_b16 v[238:239], v55 offset:4352
    s_xor_b32 s78, s75, 1048576
    s_add_u32 s78, s78, s67
    s_add_u32 s80, s66, 65536
    s_mov_b32 s76, 0
    s_mov_b32 s77, 8192
    s_call_b64 s[82:83], cs_dma
    ds_read_b64_tr_b16 v[248:249], v55 offset:64
    ds_read_b64_tr_b16 v[250:251], v55 offset:320
    ds_read_b64_tr_b16 v[252:253], v55 offset:4160
    ds_read_b64_tr_b16 v[254:255], v55 offset:4416
    s_mov_b32 s77, 16384
    s_call_b64 s[82:83], cs_dma
    s_waitcnt lgkmcnt(0)
    s_waitcnt vmcnt(13)
    v_add_u32 v55, 32768, v51
    v_xor_b32 v56, 32, v55
    ds_read_b64_tr_b16 v[144:145], v55 offset:0
    ds_read_b64_tr_b16 v[146:147], v55 offset:256
    ds_read_b64_tr_b16 v[148:149], v55 offset:8192
    ds_read_b64_tr_b16 v[150:151], v55 offset:8448
    s_mov_b32 s77, 24576
    s_call_b64 s[82:83], cs_dma
    ds_read_b64_tr_b16 v[152:153], v56 offset:0
    ds_read_b64_tr_b16 v[154:155], v56 offset:256
    ds_read_b64_tr_b16 v[156:157], v56 offset:8192
    ds_read_b64_tr_b16 v[158:159], v56 offset:8448
    s_mov_b32 s77, 32768
    s_call_b64 s[82:83], cs_dma
    s_waitcnt lgkmcnt(0)
    s_waitcnt vmcnt(9)
    v_add_u32 v55, 114688, v51
    v_xor_b32 v56, 32, v55
    ds_read_b64_tr_b16 a[192:193], v55 offset:0
    ds_read_b64_tr_b16 a[194:195], v55 offset:256
    ds_read_b64_tr_b16 a[196:197], v55 offset:8192
    ds_read_b64_tr_b16 a[198:199], v55 offset:8448
    s_xor_b32 s78, s75, 2097152
    s_add_u32 s78, s78, s67
    s_add_u32 s80, s66, 0
    s_mov_b32 s76, 0
    s_mov_b32 s77, 8192
    s_call_b64 s[82:83], cs_dma
    ds_read_b64_tr_b16 a[200:201], v56 offset:0
    ds_read_b64_tr_b16 a[202:203], v56 offset:256
    ds_read_b64_tr_b16 a[204:205], v56 offset:8192
    ds_read_b64_tr_b16 a[206:207], v56 offset:8448
    s_mov_b32 s77, 16384
    s_call_b64 s[82:83], cs_dma
    s_waitcnt lgkmcnt(0)
    v_add_u32 v55, 131072, v51
    v_xor_b32 v56, 32, v55
    ds_read_b64_tr_b16 a[208:209], v55 offset:0
    ds_read_b64_tr_b16 a[210:211], v55 offset:256
    ds_read_b64_tr_b16 a[212:213], v55 offset:8192
    ds_read_b64_tr_b16 a[214:215], v55 offset:8448
    s_mov_b32 s77, 24576
    s_call_b64 s[82:83], cs_dma
    ds_read_b64_tr_b16 a[216:217], v56 offset:0
    ds_read_b64_tr_b16 a[218:219], v56 offset:256
    ds_read_b64_tr_b16 a[220:221], v56 offset:8192
    ds_read_b64_tr_b16 a[222:223], v56 offset:8448
    s_mov_b32 s77, 32768
    s_call_b64 s[82:83], cs_dma
    s_waitcnt lgkmcnt(0)
    s_waitcnt vmcnt(8)
    v_add_u32 v55, 65536, v51
    v_xor_b32 v56, 32, v55
    ds_read_b64_tr_b16 a[224:225], v55 offset:0
    ds_read_b64_tr_b16 a[226:227], v55 offset:256
    ds_read_b64_tr_b16 a[228:229], v55 offset:8192
    ds_read_b64_tr_b16 a[230:231], v55 offset:8448
    s_xor_b32 s78, s75, 3145728
    s_add_u32 s78, s78, s67
    s_add_u32 s80, s66, 32768
    s_mov_b32 s76, 0
    s_mov_b32 s77, 8192
    s_call_b64 s[82:83], cs_dma
    ds_read_b64_tr_b16 a[232:233], v56 offset:0
    ds_read_b64_tr_b16 a[234:235], v56 offset:256
    ds_read_b64_tr_b16 a[236:237], v56 offset:8192
    ds_read_b64_tr_b16 a[238:239], v56 offset:8448
    s_mov_b32 s77, 16384
    s_call_b64 s[82:83], cs_dma
    s_waitcnt lgkmcnt(0)
    v_add_u32 v55, 81920, v51
    v_xor_b32 v56, 32, v55
    ds_read_b64_tr_b16 a[240:241], v55 offset:0
    ds_read_b64_tr_b16 a[242:243], v55 offset:256
    ds_read_b64_tr_b16 a[244:245], v55 offset:8192
    ds_read_b64_tr_b16 a[246:247], v55 offset:8448
    s_mov_b32 s77, 24576
    s_call_b64 s[82:83], cs_dma
    ds_read_b64_tr_b16 a[248:249], v56 offset:0
    ds_read_b64_tr_b16 a[250:251], v56 offset:256
    ds_read_b64_tr_b16 a[252:253], v56 offset:8192
    ds_read_b64_tr_b16 a[254:255], v56 offset:8448
    s_mov_b32 s77, 32768
    s_call_b64 s[82:83], cs_dma
    s_waitcnt lgkmcnt(0)
    v_readfirstlane_b32 s41, v46
    v_mov_b32 v36, 1
    v_mov_b32 v37, 0
    s_cmp_eq_u32 s41, 127
    s_cselect_b64 exec, 1, 0
    buffer_atomic_cmpswap v[36:37], off, s[96:99], 0 offset:216
    s_mov_b64 exec, -1
    s_waitcnt vmcnt(8)
    v_add_u32 v55, 0, v51
    v_xor_b32 v56, 32, v55
    ds_read_b64_tr_b16 v[80:81], v55 offset:0
    ds_read_b64_tr_b16 v[82:83], v55 offset:256
    ds_read_b64_tr_b16 v[84:85], v55 offset:8192
    ds_read_b64_tr_b16 v[86:87], v55 offset:8448
    s_xor_b32 s78, s75, 2097152
    s_add_u32 s78, s78, s67
    s_mov_b64 s[8:9], s[52:53]
    s_add_u32 s80, s66, 131072
    s_mov_b32 s76, 0
    s_mov_b32 s77, 8192
    s_call_b64 s[82:83], cs_dma
    ds_read_b64_tr_b16 v[88:89], v56 offset:0
    ds_read_b64_tr_b16 v[90:91], v56 offset:256
    ds_read_b64_tr_b16 v[92:93], v56 offset:8192
    ds_read_b64_tr_b16 v[94:95], v56 offset:8448
    s_mov_b32 s77, 16384
    s_call_b64 s[82:83], cs_dma
    s_waitcnt lgkmcnt(0)
    v_add_u32 v55, 16384, v51
    v_xor_b32 v56, 32, v55
    ds_read_b64_tr_b16 v[96:97], v55 offset:0
    ds_read_b64_tr_b16 v[98:99], v55 offset:256
    ds_read_b64_tr_b16 v[100:101], v55 offset:8192
    ds_read_b64_tr_b16 v[102:103], v55 offset:8448
    s_mov_b32 s77, 24576
    s_call_b64 s[82:83], cs_dma
    ds_read_b64_tr_b16 v[104:105], v56 offset:0
    ds_read_b64_tr_b16 v[106:107], v56 offset:256
    ds_read_b64_tr_b16 v[108:109], v56 offset:8192
    ds_read_b64_tr_b16 v[110:111], v56 offset:8448
    s_mov_b32 s77, 32768
    s_call_b64 s[82:83], cs_dma
    s_waitcnt lgkmcnt(0)
    s_waitcnt vmcnt(8)
    v_add_u32 v55, 32768, v51
    v_xor_b32 v56, 32, v55
    ds_read_b64_tr_b16 v[112:113], v55 offset:0
    ds_read_b64_tr_b16 v[114:115], v55 offset:256
    ds_read_b64_tr_b16 v[116:117], v55 offset:8192
    ds_read_b64_tr_b16 v[118:119], v55 offset:8448
    s_xor_b32 s78, s75, 3145728
    s_add_u32 s78, s78, s67
    s_add_u32 s80, s66, 65536
    s_mov_b32 s76, 0
    s_mov_b32 s77, 8192
    s_call_b64 s[82:83], cs_dma
    ds_read_b64_tr_b16 v[120:121], v56 offset:0
    ds_read_b64_tr_b16 v[122:123], v56 offset:256
    ds_read_b64_tr_b16 v[124:125], v56 offset:8192
    ds_read_b64_tr_b16 v[126:127], v56 offset:8448
    s_mov_b32 s77, 16384
    s_call_b64 s[82:83], cs_dma
    s_waitcnt lgkmcnt(0)
    v_add_u32 v55, 49152, v51
    v_xor_b32 v56, 32, v55
    ds_read_b64_tr_b16 v[128:129], v55 offset:0
    ds_read_b64_tr_b16 v[130:131], v55 offset:256
    ds_read_b64_tr_b16 v[132:133], v55 offset:8192
    ds_read_b64_tr_b16 v[134:135], v55 offset:8448
    s_mov_b32 s77, 24576
    s_call_b64 s[82:83], cs_dma
    ds_read_b64_tr_b16 v[136:137], v56 offset:0
    ds_read_b64_tr_b16 v[138:139], v56 offset:256
    ds_read_b64_tr_b16 v[140:141], v56 offset:8192
    ds_read_b64_tr_b16 v[142:143], v56 offset:8448
    s_mov_b32 s77, 32768
    s_call_b64 s[82:83], cs_dma
    s_waitcnt lgkmcnt(0)
    s_waitcnt vmcnt(8)
    v_add_u32 v55, 131072, v51
    v_xor_b32 v56, 32, v55
    ds_read_b64_tr_b16 a[128:129], v55 offset:0
    ds_read_b64_tr_b16 a[130:131], v55 offset:256
    ds_read_b64_tr_b16 a[132:133], v55 offset:8192
    ds_read_b64_tr_b16 a[134:135], v55 offset:8448
    s_xor_b32 s78, s75, 2097152
    s_add_u32 s78, s78, s67
    s_mov_b64 s[8:9], s[50:51]
    s_add_u32 s80, s66, 0
    s_mov_b32 s76, 0
    s_mov_b32 s77, 8192
    s_call_b64 s[82:83], cs_dma
    ds_read_b64_tr_b16 a[136:137], v56 offset:0
    ds_read_b64_tr_b16 a[138:139], v56 offset:256
    ds_read_b64_tr_b16 a[140:141], v56 offset:8192
    ds_read_b64_tr_b16 a[142:143], v56 offset:8448
    s_mov_b32 s77, 16384
    s_call_b64 s[82:83], cs_dma
    s_waitcnt lgkmcnt(0)
    v_add_u32 v55, 147456, v51
    v_xor_b32 v56, 32, v55
    ds_read_b64_tr_b16 a[144:145], v55 offset:0
    ds_read_b64_tr_b16 a[146:147], v55 offset:256
    ds_read_b64_tr_b16 a[148:149], v55 offset:8192
    ds_read_b64_tr_b16 a[150:151], v55 offset:8448
    s_mov_b32 s77, 24576
    s_call_b64 s[82:83], cs_dma
    ds_read_b64_tr_b16 a[152:153], v56 offset:0
    ds_read_b64_tr_b16 a[154:155], v56 offset:256
    ds_read_b64_tr_b16 a[156:157], v56 offset:8192
    ds_read_b64_tr_b16 a[158:159], v56 offset:8448
    s_mov_b32 s77, 32768
    s_call_b64 s[82:83], cs_dma
    s_waitcnt lgkmcnt(0)
    s_waitcnt vmcnt(8)
    v_add_u32 v55, 65536, v51
    v_xor_b32 v56, 32, v55
    ds_read_b64_tr_b16 a[160:161], v55 offset:0
    ds_read_b64_tr_b16 a[162:163], v55 offset:256
    ds_read_b64_tr_b16 a[164:165], v55 offset:8192
    ds_read_b64_tr_b16 a[166:167], v55 offset:8448
    s_xor_b32 s78, s75, 3145728
    s_add_u32 s78, s78, s67
    s_add_u32 s80, s66, 32768
    s_mov_b32 s76, 0
    s_mov_b32 s77, 8192
    s_call_b64 s[82:83], cs_dma
    ds_read_b64_tr_b16 a[168:169], v56 offset:0
    ds_read_b64_tr_b16 a[170:171], v56 offset:256
    ds_read_b64_tr_b16 a[172:173], v56 offset:8192
    ds_read_b64_tr_b16 a[174:175], v56 offset:8448
    s_mov_b32 s77, 16384
    s_call_b64 s[82:83], cs_dma
    s_waitcnt lgkmcnt(0)
    v_add_u32 v55, 81920, v51
    v_xor_b32 v56, 32, v55
    ds_read_b64_tr_b16 a[176:177], v55 offset:0
    ds_read_b64_tr_b16 a[178:179], v55 offset:256
    ds_read_b64_tr_b16 a[180:181], v55 offset:8192
    ds_read_b64_tr_b16 a[182:183], v55 offset:8448
    s_mov_b32 s77, 24576
    s_call_b64 s[82:83], cs_dma
    ds_read_b64_tr_b16 a[184:185], v56 offset:0
    ds_read_b64_tr_b16 a[186:187], v56 offset:256
    ds_read_b64_tr_b16 a[188:189], v56 offset:8192
    ds_read_b64_tr_b16 a[190:191], v56 offset:8448
    s_mov_b32 s77, 32768
    s_call_b64 s[82:83], cs_dma
    s_waitcnt lgkmcnt(0)
    s_waitcnt vmcnt(8)
    v_add_u32 v55, 0, v51
    v_xor_b32 v56, 32, v55
    ds_read_b64_tr_b16 a[48:49], v55 offset:0
    ds_read_b64_tr_b16 a[50:51], v55 offset:256
    ds_read_b64_tr_b16 a[52:53], v55 offset:8192
    ds_read_b64_tr_b16 a[54:55], v55 offset:8448
    s_add_u32 s78, s67, 4194304
    s_mov_b32 s81, 0
    s_add_u32 s80, s66, 98304
    s_mov_b32 s76, 0
    s_mov_b32 s77, 8192
    s_call_b64 s[82:83], cs_dma
    ds_read_b64_tr_b16 a[56:57], v56 offset:0
    ds_read_b64_tr_b16 a[58:59], v56 offset:256
    ds_read_b64_tr_b16 a[60:61], v56 offset:8192
    ds_read_b64_tr_b16 a[62:63], v56 offset:8448
    s_mov_b32 s77, 16384
    s_call_b64 s[82:83], cs_dma
    s_waitcnt lgkmcnt(0)
    v_add_u32 v55, 16384, v51
    v_xor_b32 v56, 32, v55
    ds_read_b64_tr_b16 a[64:65], v55 offset:0
    ds_read_b64_tr_b16 a[66:67], v55 offset:256
    ds_read_b64_tr_b16 a[68:69], v55 offset:8192
    ds_read_b64_tr_b16 a[70:71], v55 offset:8448
    s_xor_b32 s78, s75, 1048576
    s_add_u32 s78, s78, s67
    s_mov_b32 s81, s93
    s_add_u32 s80, s66, 114688
    s_mov_b32 s76, 0
    s_mov_b32 s77, 8192
    s_call_b64 s[82:83], cs_dma
    ds_read_b64_tr_b16 a[72:73], v56 offset:0
    ds_read_b64_tr_b16 a[74:75], v56 offset:256
    ds_read_b64_tr_b16 a[76:77], v56 offset:8192
    ds_read_b64_tr_b16 a[78:79], v56 offset:8448
    s_mov_b32 s77, 16384
    s_call_b64 s[82:83], cs_dma
    s_waitcnt lgkmcnt(0)
    s_waitcnt vmcnt(8)
    v_add_u32 v55, 32768, v51
    v_xor_b32 v56, 32, v55
    ds_read_b64_tr_b16 a[80:81], v55 offset:0
    ds_read_b64_tr_b16 a[82:83], v55 offset:256
    ds_read_b64_tr_b16 a[84:85], v55 offset:8192
    ds_read_b64_tr_b16 a[86:87], v55 offset:8448
    s_mov_b32 s77, 24576
    s_call_b64 s[82:83], cs_dma
    ds_read_b64_tr_b16 a[88:89], v56 offset:0
    ds_read_b64_tr_b16 a[90:91], v56 offset:256
    ds_read_b64_tr_b16 a[92:93], v56 offset:8192
    ds_read_b64_tr_b16 a[94:95], v56 offset:8448
    s_mov_b32 s77, 32768
    s_call_b64 s[82:83], cs_dma
    s_waitcnt lgkmcnt(0)
    v_add_u32 v55, 49152, v51
    v_xor_b32 v56, 32, v55
    ds_read_b64_tr_b16 a[96:97], v55 offset:0
    ds_read_b64_tr_b16 a[98:99], v55 offset:256
    ds_read_b64_tr_b16 a[100:101], v55 offset:8192
    ds_read_b64_tr_b16 a[102:103], v55 offset:8448
    s_xor_b32 s78, s75, 0
    s_add_u32 s78, s78, s67
    s_add_u32 s80, s66, 65536
    s_mov_b32 s76, 0
    s_mov_b32 s77, 8192
    s_call_b64 s[82:83], cs_dma
    ds_read_b64_tr_b16 a[104:105], v56 offset:0
    ds_read_b64_tr_b16 a[106:107], v56 offset:256
    ds_read_b64_tr_b16 a[108:109], v56 offset:8192
    ds_read_b64_tr_b16 a[110:111], v56 offset:8448
    s_mov_b32 s77, 16384
    s_call_b64 s[82:83], cs_dma
    s_waitcnt lgkmcnt(0)
    s_waitcnt vmcnt(12)
    v_add_u32 v55, 98304, v51
    v_xor_b32 v56, 32, v55
    ds_read_b64_tr_b16 a[112:113], v55 offset:0
    ds_read_b64_tr_b16 a[114:115], v55 offset:256
    ds_read_b64_tr_b16 a[116:117], v55 offset:8192
    ds_read_b64_tr_b16 a[118:119], v55 offset:8448
    s_mov_b32 s77, 24576
    s_call_b64 s[82:83], cs_dma
    ds_read_b64_tr_b16 a[120:121], v56 offset:0
    ds_read_b64_tr_b16 a[122:123], v56 offset:256
    ds_read_b64_tr_b16 a[124:125], v56 offset:8192
    ds_read_b64_tr_b16 a[126:127], v56 offset:8448
    s_mov_b32 s77, 32768
    s_call_b64 s[82:83], cs_dma
    s_waitcnt lgkmcnt(0)
    s_waitcnt vmcnt(8)
    v_add_u32 v55, 114688, v51
    v_xor_b32 v56, 32, v55
    ds_read_b64_tr_b16 a[16:17], v55 offset:0
    ds_read_b64_tr_b16 a[18:19], v55 offset:256
    ds_read_b64_tr_b16 a[20:21], v55 offset:8192
    ds_read_b64_tr_b16 a[22:23], v55 offset:8448
    s_xor_b32 s78, s75, 0
    s_add_u32 s78, s78, s67
    s_mov_b64 s[8:9], s[52:53]
    s_add_u32 s80, s66, 0
    s_mov_b32 s76, 0
    s_mov_b32 s77, 8192
    s_call_b64 s[82:83], cs_dma
    ds_read_b64_tr_b16 a[24:25], v56 offset:0
    ds_read_b64_tr_b16 a[26:27], v56 offset:256
    ds_read_b64_tr_b16 a[28:29], v56 offset:8192
    ds_read_b64_tr_b16 a[30:31], v56 offset:8448
    s_mov_b32 s77, 16384
    s_call_b64 s[82:83], cs_dma
    s_waitcnt lgkmcnt(0)
    v_add_u32 v55, 131072, v51
    v_xor_b32 v56, 32, v55
    ds_read_b64_tr_b16 a[32:33], v55 offset:0
    ds_read_b64_tr_b16 a[34:35], v55 offset:256
    ds_read_b64_tr_b16 a[36:37], v55 offset:8192
    ds_read_b64_tr_b16 a[38:39], v55 offset:8448
    s_mov_b32 s77, 24576
    s_call_b64 s[82:83], cs_dma
    ds_read_b64_tr_b16 a[40:41], v56 offset:0
    ds_read_b64_tr_b16 a[42:43], v56 offset:256
    ds_read_b64_tr_b16 a[44:45], v56 offset:8192
    ds_read_b64_tr_b16 a[46:47], v56 offset:8448
    s_mov_b32 s77, 32768
    s_call_b64 s[82:83], cs_dma
    s_waitcnt lgkmcnt(0)
    s_waitcnt vmcnt(8)
    v_add_u32 v55, 65536, v51
    v_xor_b32 v56, 32, v55
    ds_read_b64_tr_b16 v[0:1], v55 offset:0
    ds_read_b64_tr_b16 v[2:3], v55 offset:256
    ds_read_b64_tr_b16 v[4:5], v55 offset:8192
    ds_read_b64_tr_b16 v[6:7], v55 offset:8448
    s_xor_b32 s78, s75, 1048576
    s_add_u32 s78, s78, s67
    s_add_u32 s80, s66, 32768
    s_mov_b32 s76, 0
    s_mov_b32 s77, 8192
    s_call_b64 s[82:83], cs_dma
    ds_read_b64_tr_b16 v[8:9], v56 offset:0
    ds_read_b64_tr_b16 v[10:11], v56 offset:256
    ds_read_b64_tr_b16 v[12:13], v56 offset:8192
    ds_read_b64_tr_b16 v[14:15], v56 offset:8448
    s_mov_b32 s77, 16384
    s_call_b64 s[82:83], cs_dma
    s_waitcnt lgkmcnt(0)
    ds_write_b128 v62, v[0:3] offset:8192
    ds_write_b128 v62, v[4:7] offset:12288
    ds_write_b128 v62, v[8:11] offset:16384
    ds_write_b128 v62, v[12:15] offset:20480
    s_waitcnt lgkmcnt(0)
    v_add_u32 v55, 81920, v51
    v_xor_b32 v56, 32, v55
    ds_read_b64_tr_b16 a[0:1], v55 offset:0
    ds_read_b64_tr_b16 a[2:3], v55 offset:256
    ds_read_b64_tr_b16 a[4:5], v55 offset:8192
    ds_read_b64_tr_b16 a[6:7], v55 offset:8448
    s_mov_b32 s77, 24576
    s_call_b64 s[82:83], cs_dma
    ds_read_b64_tr_b16 a[8:9], v56 offset:0
    ds_read_b64_tr_b16 a[10:11], v56 offset:256
    ds_read_b64_tr_b16 a[12:13], v56 offset:8192
    ds_read_b64_tr_b16 a[14:15], v56 offset:8448
    s_mov_b32 s77, 32768
    s_call_b64 s[82:83], cs_dma
    s_waitcnt lgkmcnt(0)
    s_waitcnt vmcnt(8)
    v_add_u32 v55, 0, v51
    v_xor_b32 v56, 32, v55
    ds_read_b64_tr_b16 v[0:1], v55 offset:0
    ds_read_b64_tr_b16 v[2:3], v55 offset:256
    ds_read_b64_tr_b16 v[4:5], v55 offset:8192
    ds_read_b64_tr_b16 v[6:7], v55 offset:8448
    s_xor_b32 s94, s13, 0
    s_mul_i32 s94, s94, 36864
    s_add_u32 s94, s94, s92
    s_lshr_b32 s74, s13, 1
    s_lshl_b32 s74, s74, 6
    s_add_u32 s94, s94, s74
    s_add_u32 s78, s94, 1024
    s_mov_b64 s[8:9], s[56:57]
    v_mov_b32 v58, v50
    s_mov_b32 s79, 18432
    s_mov_b32 s81, 0
    s_add_u32 s80, s66, 147456
    s_mov_b32 s76, 0
    s_mov_b32 s77, 8192
    s_call_b64 s[82:83], cs_dma
    ds_read_b64_tr_b16 v[8:9], v56 offset:0
    ds_read_b64_tr_b16 v[10:11], v56 offset:256
    ds_read_b64_tr_b16 v[12:13], v56 offset:8192
    ds_read_b64_tr_b16 v[14:15], v56 offset:8448
    s_xor_b32 s94, s13, 2
    s_mul_i32 s94, s94, 36864
    s_add_u32 s94, s94, s92
    s_lshr_b32 s74, s13, 1
    s_lshl_b32 s74, s74, 6
    s_add_u32 s94, s94, s74
    s_add_u32 s78, s94, 1024
    s_mov_b32 s77, 16384
    s_call_b64 s[82:83], cs_dma
    s_waitcnt lgkmcnt(0)
    ds_write_b128 v61, v[0:3] offset:0
    ds_write_b128 v61, v[4:7] offset:4096
    ds_write_b128 v61, v[8:11] offset:8192
    ds_write_b128 v61, v[12:15] offset:12288
    s_waitcnt lgkmcnt(0)
    v_add_u32 v55, 16384, v51
    v_xor_b32 v56, 32, v55
    ds_read_b64_tr_b16 v[0:1], v55 offset:0
    ds_read_b64_tr_b16 v[2:3], v55 offset:256
    ds_read_b64_tr_b16 v[4:5], v55 offset:8192
    ds_read_b64_tr_b16 v[6:7], v55 offset:8448
    s_xor_b32 s94, s13, 3
    s_mul_i32 s94, s94, 36864
    s_add_u32 s94, s94, s92
    s_lshl_b32 s74, s13, 7
    s_add_u32 s94, s94, s74
    s_add_u32 s78, s94, 512
    v_mov_b32 v58, v49
    s_mov_b32 s79, 9216
    s_add_u32 s80, s66, 131072
    s_mov_b32 s76, 0
    s_mov_b32 s77, 8192
    s_call_b64 s[82:83], cs_dma
    ds_read_b64_tr_b16 v[8:9], v56 offset:0
    ds_read_b64_tr_b16 v[10:11], v56 offset:256
    ds_read_b64_tr_b16 v[12:13], v56 offset:8192
    ds_read_b64_tr_b16 v[14:15], v56 offset:8448
    s_mov_b32 s77, 16384
    s_call_b64 s[82:83], cs_dma
    s_waitcnt lgkmcnt(0)
    ds_write_b128 v61, v[0:3] offset:16384
    ds_write_b128 v61, v[4:7] offset:20480
    ds_write_b128 v61, v[8:11] offset:24576
    ds_write_b128 v61, v[12:15] offset:28672
    s_waitcnt lgkmcnt(0)
    s_waitcnt vmcnt(8)
    v_add_u32 v55, 32768, v51
    v_xor_b32 v56, 32, v55
    ds_read_b64_tr_b16 v[0:1], v55 offset:0
    ds_read_b64_tr_b16 v[2:3], v55 offset:256
    ds_read_b64_tr_b16 v[4:5], v55 offset:8192
    ds_read_b64_tr_b16 v[6:7], v55 offset:8448
    s_xor_b32 s94, s13, 2
    s_mul_i32 s94, s94, 36864
    s_add_u32 s94, s94, s92
    s_lshl_b32 s74, s13, 7
    s_add_u32 s94, s94, s74
    s_add_u32 s78, s94, 512
    s_add_u32 s80, s66, 114688
    s_mov_b32 s76, 0
    s_mov_b32 s77, 8192
    s_call_b64 s[82:83], cs_dma
    ds_read_b64_tr_b16 v[8:9], v56 offset:0
    ds_read_b64_tr_b16 v[10:11], v56 offset:256
    ds_read_b64_tr_b16 v[12:13], v56 offset:8192
    ds_read_b64_tr_b16 v[14:15], v56 offset:8448
    s_mov_b32 s77, 16384
    s_call_b64 s[82:83], cs_dma
    s_waitcnt lgkmcnt(0)
    ds_write_b128 v61, v[0:3] offset:32768
    ds_write_b128 v61, v[4:7] offset:36864
    ds_write_b128 v61, v[8:11] offset:40960
    ds_write_b128 v61, v[12:15] offset:45056
    s_waitcnt lgkmcnt(0)
    v_add_u32 v55, 49152, v51
    v_xor_b32 v56, 32, v55
    ds_read_b64_tr_b16 v[0:1], v55 offset:0
    ds_read_b64_tr_b16 v[2:3], v55 offset:256
    ds_read_b64_tr_b16 v[4:5], v55 offset:8192
    ds_read_b64_tr_b16 v[6:7], v55 offset:8448
    s_add_u32 s78, s67, 4194304
    s_mov_b64 s[8:9], s[52:53]
    v_mov_b32 v58, v48
    s_mov_b32 s79, 131072
    s_add_u32 s80, s66, 81920
    s_mov_b32 s76, 0
    s_mov_b32 s77, 8192
    s_call_b64 s[82:83], cs_dma
    ds_read_b64_tr_b16 v[8:9], v56 offset:0
    ds_read_b64_tr_b16 v[10:11], v56 offset:256
    ds_read_b64_tr_b16 v[12:13], v56 offset:8192
    ds_read_b64_tr_b16 v[14:15], v56 offset:8448
    s_mov_b32 s77, 16384
    s_call_b64 s[82:83], cs_dma
    s_waitcnt lgkmcnt(0)
    ds_write_b128 v61, v[0:3] offset:49152
    ds_write_b128 v61, v[4:7] offset:53248
    ds_write_b128 v61, v[8:11] offset:57344
    ds_write_b128 v61, v[12:15] offset:61440
    s_waitcnt lgkmcnt(0)
    buffer_load_dword v38, off, s[96:99], 0 offset:216 sc1
    buffer_load_dword v39, off, s[96:99], 0 offset:64 sc1
    s_lshr_b32 s84, s12, 1
    s_lshl_b32 s84, s84, 8
    s_add_u32 s84, s84, 125829120
    v_bfe_u32 v40, v61, 4, 6
    v_min_u32 v40, 11, v40
    v_lshlrev_b32 v40, 2, v40
    buffer_load_dword v41, v40, s[4:7], s84 offen sc1
    s_waitcnt vmcnt(15)
    v_add_u32 v55, 147456, v53
    ds_read_b64_tr_b16 v[0:1], v55 offset:0
    ds_read_b64_tr_b16 v[2:3], v55 offset:128
    ds_read_b64_tr_b16 v[4:5], v55 offset:512
    ds_read_b64_tr_b16 v[6:7], v55 offset:640
    ds_read_b64_tr_b16 v[8:9], v55 offset:8192
    ds_read_b64_tr_b16 v[10:11], v55 offset:8320
    ds_read_b64_tr_b16 v[12:13], v55 offset:8704
    ds_read_b64_tr_b16 v[14:15], v55 offset:8832
    s_waitcnt lgkmcnt(0)
    s_barrier
    ds_write_b128 v63, v[0:3] offset:49152
    ds_write_b128 v63, v[4:7] offset:53248
    s_barrier
    ds_write_b128 v63, v[8:11] offset:57344
    ds_write_b128 v63, v[12:15] offset:61440
    s_waitcnt lgkmcnt(0)
    s_waitcnt vmcnt(11)
    v_add_u32 v55, 131072, v52
    ds_read_b64_tr_b16 v[0:1], v55 offset:0
    ds_read_b64_tr_b16 v[2:3], v55 offset:256
    ds_read_b64_tr_b16 v[4:5], v55 offset:4096
    ds_read_b64_tr_b16 v[6:7], v55 offset:4352
    ds_read_b64_tr_b16 v[8:9], v55 offset:64
    ds_read_b64_tr_b16 v[10:11], v55 offset:320
    ds_read_b64_tr_b16 v[12:13], v55 offset:4160
    ds_read_b64_tr_b16 v[14:15], v55 offset:4416
    s_waitcnt lgkmcnt(0)
    s_barrier
    ds_write_b128 v63, v[0:3] offset:32768
    ds_write_b128 v63, v[4:7] offset:36864
    s_barrier
    ds_write_b128 v63, v[8:11] offset:40960
    ds_write_b128 v63, v[12:15] offset:45056
    s_waitcnt lgkmcnt(0)
    s_waitcnt vmcnt(7)
    v_add_u32 v55, 114688, v52
    ds_read_b64_tr_b16 v[0:1], v55 offset:0
    ds_read_b64_tr_b16 v[2:3], v55 offset:256
    ds_read_b64_tr_b16 v[4:5], v55 offset:4096
    ds_read_b64_tr_b16 v[6:7], v55 offset:4352
    ds_read_b64_tr_b16 v[8:9], v55 offset:64
    ds_read_b64_tr_b16 v[10:11], v55 offset:320
    ds_read_b64_tr_b16 v[12:13], v55 offset:4160
    ds_read_b64_tr_b16 v[14:15], v55 offset:4416
    s_waitcnt lgkmcnt(0)
    s_barrier
    ds_write_b128 v63, v[0:3] offset:16384
    ds_write_b128 v63, v[4:7] offset:20480
    s_barrier
    ds_write_b128 v63, v[8:11] offset:24576
    ds_write_b128 v63, v[12:15] offset:28672
    s_waitcnt lgkmcnt(0)
    s_waitcnt vmcnt(3)
    v_add_u32 v55, 81920, v51
    v_xor_b32 v56, 32, v55
    ds_read_b64_tr_b16 v[0:1], v55 offset:0
    ds_read_b64_tr_b16 v[2:3], v55 offset:256
    ds_read_b64_tr_b16 v[4:5], v55 offset:8192
    ds_read_b64_tr_b16 v[6:7], v55 offset:8448
    ds_read_b64_tr_b16 v[8:9], v56 offset:0
    ds_read_b64_tr_b16 v[10:11], v56 offset:256
    ds_read_b64_tr_b16 v[12:13], v56 offset:8192
    ds_read_b64_tr_b16 v[14:15], v56 offset:8448
    s_waitcnt lgkmcnt(0)
    ds_write_b128 v62, v[0:3] offset:24576
    ds_write_b128 v62, v[4:7] offset:28672
    ds_write_b128 v62, v[8:11] offset:32768
    ds_write_b128 v62, v[12:15] offset:36864
    s_waitcnt lgkmcnt(0)
    s_barrier
    s_waitcnt vmcnt(0)
    v_readfirstlane_b32 s95, v39
    v_readfirstlane_b32 s85, v38
    s_nop 4
    s_mov_b32 s88, 4194304
gn5:
    s_cmp_lg_u32 s95, 0
    s_cbranch_scc1 gn5x
    buffer_load_dword v24, off, s[96:99], 0 offset:64 sc1
    s_sub_u32 s88, s88, 1
    s_cbranch_scc1 gn5x
    s_waitcnt vmcnt(0)
    v_readfirstlane_b32 s95, v24
    s_nop 1
    s_branch gn5
gn5x:
    s_add_u32 s93, s95, 2
    v_subrev_u32 v41, s93, v41
    v_cmp_lt_u32 s[86:87], 64, v41
    v_bfe_u32 v40, v61, 4, 4
    v_bfe_u32 v41, v61, 8, 1
    v_lshlrev_b32 v41, 2, v41
    v_sub_u32 v41, v40, v41
    v_mov_b32 v42, 0x3f80
    v_mov_b32 v43, 0x3f800000
    v_cmp_eq_u32 vcc, 0, v41
    s_nop 1
    v_cndmask_b32 v32, 0, v42, vcc
    v_cmp_eq_u32 vcc, 1, v41
    s_nop 1
    v_cndmask_b32 v32, v32, v43, vcc
    v_cmp_eq_u32 vcc, 0, v40
    s_nop 1
    v_cndmask_b32 v36, 0, v42, vcc
    v_cmp_eq_u32 vcc, 1, v40
    s_nop 1
    v_cndmask_b32 v36, v36, v43, vcc
    v_cmp_eq_u32 vcc, 2, v41
    s_nop 1
    v_cndmask_b32 v33, 0, v42, vcc
    v_cmp_eq_u32 vcc, 3, v41
    s_nop 1
    v_cndmask_b32 v33, v33, v43, vcc
    v_cmp_eq_u32 vcc, 2, v40
    s_nop 1
    v_cndmask_b32 v37, 0, v42, vcc
    v_cmp_eq_u32 vcc, 3, v40
    s_nop 1
    v_cndmask_b32 v37, v37, v43, vcc
    v_cmp_eq_u32 vcc, 8, v41
    s_nop 1
    v_cndmask_b32 v34, 0, v42, vcc
    v_cmp_eq_u32 vcc, 9, v41
    s_nop 1
    v_cndmask_b32 v34, v34, v43, vcc
    v_cmp_eq_u32 vcc, 4, v40
    s_nop 1
    v_cndmask_b32 v38, 0, v42, vcc
    v_cmp_eq_u32 vcc, 5, v40
    s_nop 1
    v_cndmask_b32 v38, v38, v43, vcc
    v_cmp_eq_u32 vcc, 10, v41
    s_nop 1
    v_cndmask_b32 v35, 0, v42, vcc
    v_cmp_eq_u32 vcc, 11, v41
    s_nop 1
    v_cndmask_b32 v35, v35, v43, vcc
    v_cmp_eq_u32 vcc, 6, v40
    s_nop 1
    v_cndmask_b32 v39, 0, v42, vcc
    v_cmp_eq_u32 vcc, 7, v40
    s_nop 1
    v_cndmask_b32 v39, v39, v43, vcc
    ds_write_b128 v78, v[32:35] offset:8704
    ds_write_b128 v65, v[36:39] offset:10240
    v_mov_b32 v44, s95
    v_mov_b32 v45, s95
    v_mov_b32 v46, s95
    v_mov_b32 v47, s95
    v_mov_b32 v48, 108288
    ds_write_b128 v48, v[44:47]
    s_waitcnt vmcnt(0) lgkmcnt(0)
    s_cmp_eq_u32 s85, 1
    s_cbranch_scc1 cs_run
    s_mov_b32 s40, 16777216
cs_startpoll:
    buffer_load_dword v3, off, s[96:99], 0 offset:216 sc1
    s_waitcnt vmcnt(0)
    v_readfirstlane_b32 s85, v3
    s_nop 0
    s_cmp_eq_u32 s85, 1
    s_cbranch_scc1 cs_run
    s_sleep 1
    s_sub_u32 s40, s40, 1
    s_cbranch_scc0 cs_startpoll
    s_endpgm
cs_run:
    s_cmp_eq_u64 s[86:87], 0
    s_cbranch_scc1 cs_kv0_go
    s_lshr_b32 s92, s12, 1
    s_lshl_b32 s92, s92, 8
    s_add_u32 s92, s92, 125829120
    v_bfe_u32 v2, v61, 4, 6
    v_min_u32 v2, 11, v2
    v_lshlrev_b32 v2, 2, v2
    s_add_u32 s93, s95, 2
    s_mov_b32 s94, 4194304
cs_kv0:
    buffer_load_dword v3, v2, s[4:7], s92 offen sc1
    s_sub_u32 s94, s94, 1
    s_cbranch_scc1 cs_kv0_go
    s_waitcnt vmcnt(0)
    v_subrev_u32 v3, s93, v3
    v_cmp_lt_u32 vcc, 64, v3
    s_cbranch_vccz cs_kv0_go
    s_sleep 2
    s_branch cs_kv0
cs_kv0_go:
    s_mov_b32 s44, 0x3e0293ee
    s_mov_b32 s45, s44
    s_mov_b32 s46, 0x42000000
    s_mov_b32 s47, 128
    s_mov_b32 s60, 0x3f803f80
    s_mov_b32 s61, s60
    s_mov_b32 s62, 0x3e803e80
    s_mov_b32 s63, s62
    s_mov_b32 s28, 0
    s_lshl_b32 s24, s12, 14
    s_add_u32 s24, s24, 0
    s_add_u32 s66, s24, 33030144
    s_mul_i32 s40, s13, 3072
    s_add_u32 s23, s24, s40
    s_lshl_b32 s20, s12, 7
    s_add_u32 s20, s20, 68222976
    s_add_u32 s21, s20, 65536
    s_add_u32 s38, s20, 4096
    s_add_u32 s39, s21, 4096
    s_lshl_b32 s22, s12, 7
    s_add_u32 s22, s22, 68231168
    s_lshl_b32 s40, s12, 12
    s_add_u32 s25, s40, 79429632
    s_add_u32 s26, s40, 88866816
    s_lshl_b32 s65, s12, 9
    s_add_u32 s65, s65, 90177536
    s_lshl_b32 s40, s13, 5
    s_or_b32 s40, s40, s12
    s_cmp_lt_u32 s40, 24
    s_cselect_b32 s36, 0x1ffffff, 0
    s_mov_b32 s37, 0
    s_lshl_b32 s27, s12, 7
    s_add_u32 s27, s27, 125845504
    s_lshl_b32 s40, s13, 2
    s_add_u32 s27, s27, s40
    s_mov_b32 m0, 108032
    v_lshlrev_b32 v56, 2, v61
    buffer_load_dword v56, s[4:7], s24 offen sc1 lds
    s_add_u32 s24, s24, 524288
    buffer_load_dword v56, s[4:7], s24 offen sc1 lds
    s_add_u32 s24, s24, 524288
    v_lshlrev_b32 v56, 2, v61
    s_lshl_b32 s40, s12, 14
    s_add_u32 s40, s40, 68222976
    buffer_load_dword v56, s[4:7], s40 offen sc1 lds
    s_and_b32 s40, s12, 3
    s_lshl_b32 s40, s40, 14
    s_add_u32 s40, s40, 68157440
    buffer_load_dword v56, s[4:7], s40 offen sc1 lds
    s_add_u32 s15, s14, 4096
    s_add_u32 s16, s14, 8192
    ds_read_b128 v[32:35], v62 offset:16384
    ds_read_b128 v[36:39], v62 offset:20480
    ds_read_b128 v[40:43], v61 offset:0
    ds_read_b128 v[44:47], v61 offset:4096
    ds_read_b128 v[48:51], v61 offset:8192
    ds_read_b128 v[52:55], v61 offset:12288
    s_mov_b32 s29, 1048576
    buffer_load_dwordx4 v[24:27], v61, s[4:7], s14 offen sc1
.p2align 6
cs_loop:
    v_mov_b64 v[0:1], 0
    v_mov_b64 v[2:3], 0
    v_mov_b64 v[4:5], 0
    v_mov_b64 v[6:7], 0
    v_mov_b64 v[8:9], 0
    v_mov_b64 v[10:11], 0
    v_mov_b64 v[12:13], 0
    v_mov_b64 v[14:15], 0
cs_loop2:
    ds_read_b128 v[16:19], v62 offset:8192
    ds_read_b128 v[20:23], v62 offset:12288
    v_lshrrev_b32 v56, 2, v61
    v_add_u32 v58, 106496, v56
    s_mov_b32 s29, 1048576
    s_waitcnt lgkmcnt(0)
cs_chk0:
    s_waitcnt vmcnt(0)
cs_chk0b:
    v_max3_u32 v57, v24, v25, v26
    v_max_u32 v57, v57, v27
    v_cmp_eq_u32 vcc, -1, v57
    ds_write_b128 v62, v[24:27] offset:40960
    s_cbranch_vccnz cs_spin0
    v_smfmac_f32_16x16x64_bf16 v[0:3], v[24:27], v[16:23], v60
    buffer_load_dwordx4 v[28:31], v61, s[4:7], s15 offen sc1
    buffer_load_dword v59, v56, s[4:7], s16 offen sc1
    v_smfmac_f32_16x16x64_bf16 v[8:11], v[24:27], v[32:39], v60
    v_mov_b64 v[16:17], 0
    v_smfmac_f32_16x16x64_bf16 v[12:15], v[24:27], v[48:55], v60
    ds_read_b128 v[32:35], v61 offset:16384
    v_mov_b64 v[18:19], 0
    s_waitcnt lgkmcnt(1)
    s_barrier
    ds_read_b128 v[48:51], v63 offset:0
    ds_read_b128 v[36:39], v61 offset:20480
    v_smfmac_f32_16x16x64_bf16 v[4:7], v[24:27], v[40:47], v60
    ds_read_b128 v[40:43], v61 offset:24576
    v_mov_b64 v[20:21], 0
    v_smfmac_f32_16x16x64_bf16 v[16:19], v[24:27], a[192:199], v60
    ds_read_b128 v[44:47], v61 offset:28672
    v_mov_b64 v[22:23], 0
    ds_read_b128 v[52:55], v64 offset:0
    s_nop 0
    v_smfmac_f32_16x16x64_bf16 v[20:23], v[24:27], a[200:207], v60
    s_waitcnt lgkmcnt(4)
    v_smfmac_f32_16x16x64_bf16 v[0:3], v[48:51], a[0:7], v60
    s_add_u32 s18, s14, s31
    s_add_u32 s41, s14, 16384
    s_waitcnt lgkmcnt(3)
    v_smfmac_f32_16x16x64_bf16 v[4:7], v[48:51], v[32:39], v60
    ds_read_b128 v[32:35], v61 offset:32768
    v_smfmac_f32_16x16x64_bf16 v[8:11], v[48:51], a[8:15], v60
    ds_read_b128 v[36:39], v61 offset:36864
    s_waitcnt lgkmcnt(3)
    v_smfmac_f32_16x16x64_bf16 v[12:15], v[48:51], v[40:47], v60
    ds_read_b128 v[40:43], v61 offset:40960
    s_waitcnt lgkmcnt(3)
    v_smfmac_f32_16x16x64_bf16 v[0:3], v[52:55], a[16:23], v60
    ds_read_b128 v[44:47], v61 offset:45056
    v_smfmac_f32_16x16x64_bf16 v[8:11], v[52:55], a[24:31], v60
    ds_read_b128 v[48:51], v71 offset:0
    s_waitcnt lgkmcnt(3)
    v_smfmac_f32_16x16x64_bf16 v[4:7], v[52:55], v[32:39], v60
    s_waitcnt vmcnt(0)
    ds_write_b128 v62, v[28:31] offset:45056
    s_waitcnt lgkmcnt(2)
    v_smfmac_f32_16x16x64_bf16 v[12:15], v[52:55], v[40:47], v60
    ds_write_b32 v58, v59
    v_max3_u32 v57, v28, v29, v30
    s_waitcnt lgkmcnt(2)
    v_smfmac_f32_16x16x64_bf16 v[0:3], v[48:51], a[32:39], v60
    ds_read_b128 v[32:35], v61 offset:49152
    v_max3_u32 v57, v57, v31, v59
    v_smfmac_f32_16x16x64_bf16 v[8:11], v[48:51], a[40:47], v60
    ds_read_b128 v[36:39], v61 offset:53248
    v_cmp_eq_u32 vcc, -1, v57
    v_smfmac_f32_16x16x64_bf16 v[16:19], v[52:55], a[224:231], v60
    ds_read_b128 v[40:43], v61 offset:57344
    v_smfmac_f32_16x16x64_bf16 v[20:23], v[52:55], a[232:239], v60
    ds_read_b128 v[44:47], v61 offset:61440
    s_cbranch_vccnz cs_spin1
cs_go1:
    v_smfmac_f32_16x16x64_bf16 v[0:3], v[28:31], a[48:55], v60
    s_waitcnt lgkmcnt(4)
    s_barrier
    ds_read_b128 v[52:55], v63 offset:4096
    s_waitcnt lgkmcnt(3)
    v_smfmac_f32_16x16x64_bf16 v[4:7], v[48:51], v[32:39], v60
    ds_read_b128 v[56:59], v71 offset:4096
    v_smfmac_f32_16x16x64_bf16 v[8:11], v[28:31], a[56:63], v60
    buffer_load_dwordx4 v[32:35], v61, s[4:7], s23 offen offset:0 sc1
    s_waitcnt lgkmcnt(2)
    v_smfmac_f32_16x16x64_bf16 v[12:15], v[48:51], v[40:47], v60
    ds_read_b128 v[48:51], v64 offset:4096
    v_smfmac_f32_16x16x64_bf16 v[4:7], v[28:31], a[128:135], v60
    ds_read_b128 v[24:27], v65 offset:8192
    v_smfmac_f32_16x16x64_bf16 v[12:15], v[28:31], a[136:143], v60
    s_and_b32 s41, s41, 65535
    s_add_u32 s41, s41, 68157440
    v_smfmac_f32_16x16x64_bf16 v[16:19], v[28:31], v[80:87], v60
    buffer_load_dwordx4 v[36:39], v61, s[4:7], s23 offen offset:1024 sc1
    v_smfmac_f32_16x16x64_bf16 v[20:23], v[28:31], v[88:95], v60
    s_add_u32 s17, s41, s31
    s_and_b32 s30, s28, 1
    s_waitcnt lgkmcnt(3)
    v_smfmac_f32_16x16x64_bf16 v[0:3], v[52:55], a[64:71], v60
    ds_read_b128 v[28:31], v78 offset:8704
    v_smfmac_f32_16x16x64_bf16 v[4:7], v[52:55], a[144:151], v60
    buffer_load_dwordx4 v[40:43], v61, s[4:7], s23 offen offset:2048 sc1
    v_smfmac_f32_16x16x64_bf16 v[8:11], v[52:55], a[72:79], v60
    v_smfmac_f32_16x16x64_bf16 v[12:15], v[52:55], a[152:159], v60
    v_smfmac_f32_16x16x64_bf16 v[16:19], v[52:55], v[96:103], v60
    buffer_load_dwordx4 v[44:47], v61, s[4:7], s23 offen offset:3072 sc1
    v_smfmac_f32_16x16x64_bf16 v[20:23], v[52:55], v[104:111], v60
    ds_read_b128 v[52:55], v62 offset:28672
    s_waitcnt lgkmcnt(3)
    v_smfmac_f32_16x16x64_bf16 v[0:3], v[48:51], a[80:87], v60
    v_smfmac_f32_16x16x64_bf16 v[4:7], v[48:51], a[160:167], v60
    v_smfmac_f32_16x16x64_bf16 v[8:11], v[48:51], a[88:95], v60
    v_smfmac_f32_16x16x64_bf16 v[12:15], v[48:51], a[168:175], v60
    v_smfmac_f32_16x16x64_bf16 v[16:19], v[48:51], v[112:119], v60
    buffer_load_dword v79, s[4:7], s24 offen sc1 lds
    v_smfmac_f32_16x16x64_bf16 v[20:23], v[48:51], v[120:127], v60
    ds_read_b128 v[48:51], v62 offset:24576
    v_smfmac_f32_16x16x64_bf16 v[0:3], v[56:59], a[96:103], v60
    v_smfmac_f32_16x16x64_bf16 v[4:7], v[56:59], a[176:183], v60
    s_waitcnt lgkmcnt(3)
    v_smfmac_f32_16x16x64_bf16 v[0:3], v[24:27], a[112:119], v60
    s_cmp_ge_u32 s28, 62
    v_smfmac_f32_16x16x64_bf16 v[8:11], v[56:59], a[104:111], v60
    s_waitcnt lgkmcnt(0)
    v_smfmac_f32_16x16x64_bf16 v[4:7], v[24:27], v[48:55], v60
    ds_read_b128 v[48:51], v62 offset:32768
    v_cvt_pk_bf16_f32 v0, v0, v1
    v_smfmac_f32_16x16x64_bf16 v[12:15], v[56:59], a[184:191], v60
    ds_read_b128 v[52:55], v62 offset:36864
    v_cvt_pk_bf16_f32 v1, v2, v3
    v_smfmac_f32_16x16x64_bf16 v[8:11], v[24:27], a[120:127], v60
    v_cvt_pk_bf16_f32 v2, v4, v5
    v_smfmac_f32_16x16x64_bf16 v[16:19], v[56:59], v[128:135], v60
    v_cvt_pk_bf16_f32 v3, v6, v7
    s_nop 1
    v_mfma_f32_16x16x32_bf16 v[4:7], v[0:3], v[28:31], 0
    v_cvt_pk_bf16_f32 v8, v8, v9
    s_waitcnt lgkmcnt(0)
    v_smfmac_f32_16x16x64_bf16 v[12:15], v[24:27], v[48:55], v60
    ds_read_b128 v[48:51], v63 offset:0
    v_cvt_pk_bf16_f32 v9, v10, v11
    v_smfmac_f32_16x16x64_bf16 v[20:23], v[56:59], v[136:143], v60
    ds_read_b128 v[52:55], v71 offset:0
    v_cvt_pk_bf16_f32 v0, v4, v5
    s_nop 0
    v_cvt_pk_bf16_f32 v10, v12, v13
    v_cvt_pk_bf16_f32 v11, v14, v15
    v_cvt_pk_bf16_f32 v1, v6, v7
    s_waitcnt vmcnt(1)
    v_mfma_f32_16x16x32_bf16 v[12:15], v[8:11], v[28:31], 0
    s_mov_b64 exec, s[36:37]
    ds_read_b128 v[56:59], v69
    s_mov_b64 exec, -1
    v_smfmac_f32_16x16x64_bf16 v[16:19], v[24:27], v[144:151], v60
    s_nop 3
    v_cvt_pk_bf16_f32 v2, v12, v13
    v_cvt_pk_bf16_f32 v3, v14, v15
    s_nop 1
    v_mfma_f32_16x16x32_bf16 v[8:11], v[0:3], v[0:3], 0
    s_cbranch_scc1 cs_last
cs_back:
    v_mfma_f32_16x16x32_bf16 v[4:7], v[36:39], v[0:3], 0
    ds_read_b128 v[36:39], v63 offset:53248
    v_mfma_f32_16x16x32_bf16 v[12:15], v[32:35], v[0:3], 0
    ds_read_b128 v[32:35], v63 offset:49152
    v_mov_b32_dpp v8, v10 row_ror:8 row_mask:0xf bank_mask:0xc
    v_mov_b32_dpp v9, v11 row_ror:8 row_mask:0xf bank_mask:0xc
    ds_write_b64 v70, v[8:9]
    s_nop 1
    v_mov_b32_dpp v12, v4 row_ror:8 row_mask:0xf bank_mask:0xc
    v_mov_b32_dpp v13, v5 row_ror:8 row_mask:0xf bank_mask:0xc
    v_mov_b32_dpp v14, v6 row_ror:8 row_mask:0xf bank_mask:0xc
    v_mov_b32_dpp v15, v7 row_ror:8 row_mask:0xf bank_mask:0xc
    ds_write_b128 v62, v[12:15] offset:53248
    v_smfmac_f32_16x16x64_bf16 v[20:23], v[24:27], v[152:159], v60
    s_waitcnt lgkmcnt(4)
    s_mov_b64 exec, s[36:37]
    s_cbranch_execz cs_np3447
    buffer_store_dwordx4 v[56:59], v61, s[4:7], s65 offen sc1
cs_np3447:
    s_mov_b64 exec, -1
    v_smfmac_f32_16x16x64_bf16 v[16:19], v[48:51], a[208:215], v60
    v_smfmac_f32_16x16x64_bf16 v[20:23], v[48:51], a[216:223], v60
    s_waitcnt lgkmcnt(0)
    s_barrier
    ds_read_b128 v[56:59], v78 offset:10752
    ds_read_b128 v[28:31], v78 offset:11264
    v_smfmac_f32_16x16x64_bf16 v[16:19], v[52:55], a[240:247], v60
    ds_read_b128 v[4:7], v63 offset:12288
    ds_read_b128 v[8:11], v64 offset:12288
    v_smfmac_f32_16x16x64_bf16 v[20:23], v[52:55], a[248:255], v60
    ds_read_b128 v[0:3], v71 offset:12288
    ds_read_b128 v[48:51], v63 offset:57344
    ds_read_b128 v[52:55], v63 offset:61440
    v_mul_f32 v12, s44, v12
    v_mul_f32 v13, s44, v13
    v_mul_f32 v14, s44, v14
    v_mul_f32 v15, s44, v15
    v_mov_b64 v[24:25], s[62:63]
    v_cvt_pk_bf16_f32 v16, v16, v17
    s_waitcnt lgkmcnt(5)
    v_pk_add_f32 v[56:57], v[56:57], v[58:59]
    v_pk_add_f32 v[28:29], v[28:29], v[30:31]
    v_pk_add_f32 v[56:57], v[56:57], v[28:29]
    v_pk_mul_f32 v[56:57], v[56:57], s[44:45]
    v_exp_f32 v58, v56
    v_exp_f32 v59, v57
    s_waitcnt lgkmcnt(4)
    v_pk_fma_f32 v[12:13], v[4:5], s[44:45], v[12:13]
    v_pk_fma_f32 v[14:15], v[6:7], s[44:45], v[14:15]
    v_cvt_pk_bf16_f32 v6, v58, v59
    v_cvt_pk_bf16_f32 v17, v18, v19
    s_waitcnt lgkmcnt(2)
    v_pk_fma_f32 v[12:13], v[8:9], s[44:45], v[12:13]
    v_pk_fma_f32 v[14:15], v[10:11], s[44:45], v[14:15]
    v_pk_fma_f32 v[12:13], v[0:1], s[44:45], v[12:13]
    v_mov_b32_dpp v7, v6 row_ror:8 row_mask:0xf bank_mask:0xf
    v_pk_fma_f32 v[14:15], v[2:3], s[44:45], v[14:15]
    v_exp_f32 v0, v12
    v_mfma_f32_16x16x16_bf16 v[28:31], v[16:17], v[6:7], 0
    v_exp_f32 v1, v13
    v_cvt_pk_bf16_f32 v18, v20, v21
    v_exp_f32 v2, v14
    v_cvt_pk_bf16_f32 v19, v22, v23
    v_cvt_pk_bf16_f32 v8, v0, v1
    v_exp_f32 v3, v15
    v_mfma_f32_16x16x16_bf16 v[20:23], v[18:19], v[6:7], 0
    v_mov_b64 v[26:27], s[60:61]
    v_cvt_pk_bf16_f32 v9, v2, v3
    v_mov_b32_dpp v10, v8 row_ror:8 row_mask:0xf bank_mask:0xf
    v_max3_f32 v4, |v12|, |v13|, |v14|
    v_mfma_f32_16x16x32_bf16 v[0:3], v[24:27], v[6:9], 0
    v_mov_b32_dpp v11, v9 row_ror:8 row_mask:0xf bank_mask:0xf
    v_max3_f32 v4, v4, |v15|, |v56|
    v_max_f32_e64 v4, v4, |v57|
    v_mfma_f32_16x16x32_bf16 v[28:31], v[40:43], v[8:11], v[28:31]
    v_cmp_nge_f32 vcc, s46, v4
    v_mfma_f32_16x16x32_bf16 v[20:23], v[44:47], v[8:11], v[20:23]
    s_cbranch_scc1 cs_stash
cs_back2:
    s_cbranch_vccnz cs_guard
cs_norm:
    v_add_f32_dpp v0, v0, v0 row_ror:8 row_mask:0xf bank_mask:0xf
    v_rcp_f32 v0, v0
    v_mfma_f32_16x16x16_bf16 v[12:15], v[72:73], v[72:73], 0
    v_mul_f32 v28, v28, v0
    v_mul_f32 v29, v29, v0
    v_mul_f32 v30, v30, v0
    v_mul_f32 v31, v31, v0
    v_mul_f32_dpp v28, v20, v0 row_ror:8 row_mask:0xf bank_mask:0xc
    v_mul_f32_dpp v29, v21, v0 row_ror:8 row_mask:0xf bank_mask:0xc
    v_mul_f32_dpp v30, v22, v0 row_ror:8 row_mask:0xf bank_mask:0xc
    v_mul_f32_dpp v31, v23, v0 row_ror:8 row_mask:0xf bank_mask:0xc
    v_cvt_pk_bf16_f32 v28, v28, v29
    v_cvt_pk_bf16_f32 v29, v30, v31
    v_mfma_f32_16x16x16_bf16 v[8:11], v[72:73], v[72:73], 0
    ds_write_b64 v77, v[28:29]
    v_mfma_f32_16x16x16_bf16 v[4:7], v[72:73], v[72:73], 0
    ds_read_b128 v[0:3], v68
    v_mfma_f32_16x16x16_bf16 v[16:19], v[72:73], v[72:73], 0
    ds_read_b128 v[40:43], v63 offset:16384
    v_mfma_f32_16x16x16_bf16 v[20:23], v[72:73], v[72:73], 0
    ds_read_b128 v[44:47], v63 offset:20480
    s_waitcnt lgkmcnt(3)
    s_barrier
    ds_read_b128 v[24:27], v74
    ds_read_b128 v[28:31], v75
    ds_read_b128 v[56:59], v76
    s_waitcnt lgkmcnt(5)
    v_smfmac_f32_16x16x64_bf16 v[12:15], v[0:3], v[160:167], v60
    v_smfmac_f32_16x16x64_bf16 v[8:11], v[0:3], v[192:199], v60
    v_smfmac_f32_16x16x64_bf16 v[4:7], v[0:3], v[32:39], v60
    ds_read_b128 v[32:35], v63 offset:32768
    v_smfmac_f32_16x16x64_bf16 v[16:19], v[0:3], v[224:231], v60
    ds_read_b128 v[36:39], v63 offset:36864
    s_waitcnt lgkmcnt(3)
    v_smfmac_f32_16x16x64_bf16 v[12:15], v[24:27], v[168:175], v60
    v_smfmac_f32_16x16x64_bf16 v[4:7], v[28:31], v[48:55], v60
    ds_read_b128 v[48:51], v63 offset:24576
    v_smfmac_f32_16x16x64_bf16 v[12:15], v[28:31], v[176:183], v60
    ds_read_b128 v[52:55], v63 offset:28672
    s_waitcnt lgkmcnt(4)
    v_smfmac_f32_16x16x64_bf16 v[12:15], v[56:59], v[184:191], v60
    v_cvt_pk_bf16_f32 v4, v4, v5
    v_smfmac_f32_16x16x64_bf16 v[16:19], v[28:31], v[40:47], v60
    ds_read_b128 v[40:43], v63 offset:40960
    v_and_or_b32 v4, v4, -2, s30
    v_smfmac_f32_16x16x64_bf16 v[8:11], v[24:27], v[200:207], v60
    ds_read_b128 v[44:47], v63 offset:45056
    v_cvt_pk_bf16_f32 v5, v6, v7
    v_smfmac_f32_16x16x64_bf16 v[8:11], v[28:31], v[208:215], v60
    buffer_store_dwordx2 v[4:5], v67, s[4:7], s22 offen sc1
    v_cvt_pk_bf16_f32 v12, v12, v13
    v_smfmac_f32_16x16x64_bf16 v[8:11], v[56:59], v[216:223], v60
    v_and_or_b32 v12, v12, -2, s30
    v_smfmac_f32_16x16x64_bf16 v[16:19], v[24:27], v[232:239], v60
    v_cvt_pk_bf16_f32 v13, v14, v15
    s_waitcnt lgkmcnt(4)
    v_smfmac_f32_16x16x64_bf16 v[16:19], v[56:59], v[32:39], v60
    buffer_store_dwordx2 v[12:13], v66, s[4:7], s20 offen sc1
    v_cvt_pk_bf16_f32 v8, v8, v9
    s_waitcnt lgkmcnt(0)
    v_smfmac_f32_16x16x64_bf16 v[20:23], v[0:3], v[240:247], v60
    v_and_or_b32 v8, v8, -2, s30
    v_smfmac_f32_16x16x64_bf16 v[20:23], v[24:27], v[248:255], v60
    v_cvt_pk_bf16_f32 v9, v10, v11
    v_smfmac_f32_16x16x64_bf16 v[20:23], v[28:31], v[48:55], v60
    buffer_store_dwordx2 v[8:9], v66, s[4:7], s21 offen sc1
    v_cvt_pk_bf16_f32 v16, v16, v17
    v_smfmac_f32_16x16x64_bf16 v[20:23], v[56:59], v[40:47], v60
    v_and_or_b32 v16, v16, -2, s30
    v_cvt_pk_bf16_f32 v17, v18, v19
    buffer_store_dwordx2 v[16:17], v66, s[4:7], s38 offen sc1
    s_cmp_lg_u32 s13, 2
    s_nop 1
    v_cvt_pk_bf16_f32 v20, v20, v21
    v_and_or_b32 v20, v20, -2, s30
    v_cvt_pk_bf16_f32 v21, v22, v23
    buffer_store_dwordx2 v[20:21], v66, s[4:7], s39 offen sc1
    s_cbranch_scc1 cs_w013
    s_nop 15
    s_nop 15
    s_nop 15
    s_nop 15
    s_nop 15
    s_nop 15
    s_nop 15
    s_nop 15
    s_nop 15
    s_nop 15
    s_nop 15
    s_nop 15
    s_nop 7
    buffer_load_dwordx4 v[40:43], v65, s[4:7], s19 offen offset:0 sc1
    buffer_load_dwordx4 v[44:47], v65, s[4:7], s19 offen offset:1024 sc1
    buffer_load_dwordx4 v[48:51], v65, s[4:7], s19 offen offset:2048 sc1
    buffer_load_dwordx4 v[52:55], v65, s[4:7], s19 offen offset:3072 sc1
    ds_read_b128 v[56:59], v65 offset:10240
    s_add_u32 s28, s28, 1
    s_mov_b32 s14, s41
    s_add_u32 s23, s23, 524288
    s_add_u32 s24, s24, 524288
    s_min_u32 s24, s24, s66
    s_add_u32 s15, s14, 4096
    s_add_u32 s16, s14, 8192
    v_mov_b32 v21, -1
    s_add_u32 s65, s65, 12288
    s_mov_b32 s40, 1
    v_mov_b64 v[0:1], 0
    v_mov_b64 v[2:3], 0
    v_mov_b64 v[4:5], 0
    v_mov_b64 v[6:7], 0
    v_mov_b64 v[8:9], 0
    v_mov_b64 v[10:11], 0
    v_mov_b64 v[12:13], 0
    v_mov_b64 v[14:15], 0
cs_chkF:
    v_mov_b32 v20, 0
    s_waitcnt vmcnt(3)
    s_waitcnt lgkmcnt(0)
    v_mfma_f32_16x16x32_bf16 v[28:31], v[40:43], v[56:59], 0
    v_bitop3_b32 v20, v20, v40, s30 bitop3:0xf6
    v_bitop3_b32 v20, v20, v42, s30 bitop3:0xf6
    s_waitcnt vmcnt(2)
    v_mfma_f32_16x16x32_bf16 v[28:31], v[44:47], v[56:59], v[28:31]
    v_bitop3_b32 v20, v20, v44, s30 bitop3:0xf6
    v_bitop3_b32 v20, v20, v46, s30 bitop3:0xf6
    s_waitcnt vmcnt(1)
    v_mfma_f32_16x16x32_bf16 v[28:31], v[48:51], v[56:59], v[28:31]
    v_bitop3_b32 v20, v20, v48, s30 bitop3:0xf6
    v_bitop3_b32 v20, v20, v50, s30 bitop3:0xf6
    s_waitcnt vmcnt(0)
    v_mfma_f32_16x16x32_bf16 v[28:31], v[52:55], v[56:59], v[28:31]
    v_bitop3_b32 v20, v20, v52, s30 bitop3:0xf6
    v_bitop3_b32 v20, v20, v54, s30 bitop3:0xf6
    v_and_b32 v20, s40, v20
    v_cmp_ne_u32 vcc, 0, v20
    s_cbranch_vccnz cs_spinF
    v_permlane32_swap_b32 v28, v30
    v_permlane32_swap_b32 v29, v31
    v_add_f32 v28, v28, v30
    v_add_f32 v30, v29, v31
    v_cvt_pk_bf16_f32 v28, v28, v30
    s_mov_b64 exec, s[32:33]
    buffer_store_dword v28, v69, s[4:7], s17 offen sc1
    buffer_store_dword v21, v69, s[4:7], s18 offen sc1
    s_mov_b64 exec, -1
    ds_read_b128 v[32:35], v62 offset:16384
    ds_read_b128 v[36:39], v62 offset:20480
    ds_read_b128 v[40:43], v61 offset:0
    ds_read_b128 v[44:47], v61 offset:4096
    ds_read_b128 v[48:51], v61 offset:8192
    ds_read_b128 v[52:55], v61 offset:12288
    s_nop 15
    s_nop 15
    s_nop 15
    s_nop 15
    s_nop 15
    s_nop 15
    s_nop 3
    buffer_load_dwordx4 v[24:27], v61, s[4:7], s14 offen sc1
    s_branch cs_loop2
cs_w013:
    ds_read_b128 v[56:59], v65 offset:10240
    ds_read_b128 v[32:35], v62 offset:16384
    ds_read_b128 v[36:39], v62 offset:20480
    ds_read_b128 v[40:43], v61 offset:0
    ds_read_b128 v[44:47], v61 offset:4096
    ds_read_b128 v[48:51], v61 offset:8192
    ds_read_b128 v[52:55], v61 offset:12288
    s_add_u32 s28, s28, 1
    s_mov_b32 s14, s41
    s_add_u32 s23, s23, 524288
    s_add_u32 s24, s24, 524288
    s_min_u32 s24, s24, s66
    s_add_u32 s15, s14, 4096
    s_add_u32 s16, s14, 8192
    v_mov_b32 v21, -1
    s_add_u32 s65, s65, 12288
    s_mov_b32 s40, 1
    s_cmp_eq_u32 s64, 0
    s_cbranch_scc1 cs_w0
    s_cmp_eq_u32 s13, 1
    s_cbranch_scc1 cs_sx
    s_nop 15
    s_nop 15
    s_nop 15
    s_nop 15
    s_nop 15
    s_nop 15
    s_nop 15
    s_nop 15
    s_nop 15
    s_nop 15
    s_nop 15
    s_nop 15
    s_nop 7
cs_sx:
    buffer_load_dwordx4 v[0:3], v65, s[4:7], s19 offen offset:0 sc1
    buffer_load_dwordx4 v[4:7], v65, s[4:7], s19 offen offset:1024 sc1
    buffer_load_dwordx4 v[8:11], v65, s[4:7], s19 offen offset:2048 sc1
    buffer_load_dwordx4 v[12:15], v65, s[4:7], s19 offen offset:3072 sc1
cs_chkG:
    v_mov_b32 v20, 0
    s_waitcnt vmcnt(3)
    s_waitcnt lgkmcnt(6)
    v_mfma_f32_16x16x32_bf16 v[28:31], v[0:3], v[56:59], 0
    v_bitop3_b32 v20, v20, v0, s30 bitop3:0xf6
    v_bitop3_b32 v20, v20, v2, s30 bitop3:0xf6
    s_waitcnt vmcnt(2)
    v_mfma_f32_16x16x32_bf16 v[28:31], v[4:7], v[56:59], v[28:31]
    v_bitop3_b32 v20, v20, v4, s30 bitop3:0xf6
    v_bitop3_b32 v20, v20, v6, s30 bitop3:0xf6
    s_waitcnt vmcnt(1)
    v_mfma_f32_16x16x32_bf16 v[28:31], v[8:11], v[56:59], v[28:31]
    v_bitop3_b32 v20, v20, v8, s30 bitop3:0xf6
    v_bitop3_b32 v20, v20, v10, s30 bitop3:0xf6
    s_waitcnt vmcnt(0)
    v_mfma_f32_16x16x32_bf16 v[28:31], v[12:15], v[56:59], v[28:31]
    v_bitop3_b32 v20, v20, v12, s30 bitop3:0xf6
    v_bitop3_b32 v20, v20, v14, s30 bitop3:0xf6
    v_and_b32 v20, s40, v20
    v_cmp_ne_u32 vcc, 0, v20
    s_cbranch_vccnz cs_spinG
    v_permlane32_swap_b32 v28, v30
    v_permlane32_swap_b32 v29, v31
    v_add_f32 v28, v28, v30
    v_add_f32 v30, v29, v31
    s_cmp_eq_u32 s13, 3
    s_cbranch_scc1 cs_w3
    v_mov_b32 v29, v28
    v_mov_b32 v31, v30
    s_nop 0
    v_permlane16_swap_b32 v28, v29
    v_permlane16_swap_b32 v30, v31
    v_add_f32 v28, v28, v29
    v_add_f32 v30, v30, v31
cs_w3:
    v_cvt_pk_bf16_f32 v28, v28, v30
    s_mov_b64 exec, s[32:33]
    buffer_store_dword v28, v69, s[4:7], s17 offen sc1
    buffer_store_dword v21, v69, s[4:7], s18 offen sc1
    s_mov_b64 exec, -1
    buffer_load_dwordx4 v[24:27], v61, s[4:7], s14 offen sc1
    s_branch cs_loop
cs_w0:
    v_mov_b64 v[0:1], 0
    v_mov_b64 v[2:3], 0
    v_mov_b64 v[4:5], 0
    v_mov_b64 v[6:7], 0
    v_mov_b64 v[8:9], 0
    v_mov_b64 v[10:11], 0
    v_mov_b64 v[12:13], 0
    v_mov_b64 v[14:15], 0
    s_cmp_lg_u32 s28, 10
    s_cbranch_scc1 cs_nokv
    s_lshr_b32 s92, s12, 1
    s_lshl_b32 s92, s92, 8
    s_add_u32 s92, s92, 125829120
    v_bfe_u32 v28, v61, 4, 6
    v_min_u32 v28, 11, v28
    v_lshlrev_b32 v28, 2, v28
    s_add_u32 s93, s95, 63
    s_mov_b32 s94, 4194304
cs_kv1:
    buffer_load_dword v29, v28, s[4:7], s92 offen sc1
    s_sub_u32 s94, s94, 1
    s_cbranch_scc1 cs_kv1_go
    s_waitcnt vmcnt(0)
    v_subrev_u32 v29, s93, v29
    v_cmp_lt_u32 vcc, 64, v29
    s_cbranch_vccz cs_kv1_go
    s_sleep 2
    s_branch cs_kv1
cs_kv1_go:
cs_nokv:
    s_nop 15
    s_nop 15
    s_nop 15
    s_nop 15
    s_nop 15
    s_nop 15
    s_nop 15
    s_nop 15
    s_nop 15
    s_nop 15
    s_nop 15
    s_nop 15
    s_nop 15
    s_nop 15
    s_nop 15
    s_nop 15
    s_nop 15
    s_nop 15
    s_nop 15
    s_nop 15
    s_nop 15
    s_nop 15
    s_nop 15
    s_nop 15
    s_nop 15
    buffer_load_dwordx4 v[24:27], v61, s[4:7], s14 offen sc1
    s_branch cs_loop2
cs_spinF:
    buffer_load_dwordx4 v[40:43], v65, s[4:7], s19 offen offset:0 sc1
    buffer_load_dwordx4 v[44:47], v65, s[4:7], s19 offen offset:1024 sc1
    buffer_load_dwordx4 v[48:51], v65, s[4:7], s19 offen offset:2048 sc1
    buffer_load_dwordx4 v[52:55], v65, s[4:7], s19 offen offset:3072 sc1
    s_sub_u32 s29, s29, 1
    s_cmp_lt_i32 s29, 0
    s_cselect_b32 s40, 0, 1
    s_branch cs_chkF
cs_spinG:
    buffer_load_dwordx4 v[0:3], v65, s[4:7], s19 offen offset:0 sc1
    buffer_load_dwordx4 v[4:7], v65, s[4:7], s19 offen offset:1024 sc1
    buffer_load_dwordx4 v[8:11], v65, s[4:7], s19 offen offset:2048 sc1
    buffer_load_dwordx4 v[12:15], v65, s[4:7], s19 offen offset:3072 sc1
    s_sub_u32 s29, s29, 1
    s_cmp_lt_i32 s29, 0
    s_cselect_b32 s40, 0, 1
    s_branch cs_chkG
cs_guard:
    s_nop 7
    v_max3_f32 v6, v12, v13, v14
    v_max3_f32 v7, v15, v56, v57
    v_max_f32 v6, v6, v7
    s_nop 1
    v_max_f32_dpp v6, v6, v6 row_ror:8 row_mask:0xf bank_mask:0xf
    v_mov_b32 v7, v6
    s_nop 1
    v_permlane32_swap_b32 v6, v7
    v_max_f32 v6, v6, v7
    v_mov_b32 v7, v6
    s_nop 1
    v_permlane16_swap_b32 v6, v7
    v_max_f32 v6, v6, v7
    v_sub_f32 v12, v12, v6
    v_sub_f32 v13, v13, v6
    v_sub_f32 v14, v14, v6
    v_sub_f32 v15, v15, v6
    v_sub_f32 v56, v56, v6
    v_sub_f32 v57, v57, v6
    v_exp_f32 v58, v56
    v_exp_f32 v59, v57
    s_nop 0
    v_cvt_pk_bf16_f32 v6, v58, v59
    s_nop 1
    v_mov_b32_dpp v7, v6 row_ror:8 row_mask:0xf bank_mask:0xf
    v_exp_f32 v0, v12
    s_nop 0
    v_mfma_f32_16x16x16_bf16 v[28:31], v[16:17], v[6:7], 0
    v_exp_f32 v1, v13
    v_exp_f32 v2, v14
    v_cvt_pk_bf16_f32 v8, v0, v1
    v_exp_f32 v3, v15
    v_mfma_f32_16x16x16_bf16 v[20:23], v[18:19], v[6:7], 0
    v_cvt_pk_bf16_f32 v9, v2, v3
    v_mov_b32_dpp v10, v8 row_ror:8 row_mask:0xf bank_mask:0xf
    v_max3_f32 v4, |v12|, |v13|, |v14|
    v_mfma_f32_16x16x32_bf16 v[0:3], v[24:27], v[6:9], 0
    v_mov_b32_dpp v11, v9 row_ror:8 row_mask:0xf bank_mask:0xf
    v_max3_f32 v4, v4, |v15|, |v56|
    v_max_f32_e64 v4, v4, |v57|
    v_mfma_f32_16x16x32_bf16 v[28:31], v[40:43], v[8:11], v[28:31]
    v_cmp_nge_f32 vcc, s46, v4
    v_mfma_f32_16x16x32_bf16 v[20:23], v[44:47], v[8:11], v[20:23]
    s_nop 7
    s_branch cs_norm
cs_stash:
    buffer_store_dwordx4 v[16:19], v61, s[4:7], s26 offen sc1
    s_add_u32 s26, s26, 131072
    s_nop 1
    s_branch cs_back2
cs_spin0:
    buffer_load_dwordx4 v[24:27], v61, s[4:7], s14 offen sc1
    s_sub_u32 s29, s29, 1
    s_cmp_lt_i32 s29, 0
    s_cbranch_scc0 cs_chk0
    s_waitcnt vmcnt(0)
    v_min_u32 v24, -2, v24
    v_min_u32 v25, -2, v25
    v_min_u32 v26, -2, v26
    v_min_u32 v27, -2, v27
    s_branch cs_chk0
cs_spin1:
    buffer_load_dwordx4 v[28:31], v61, s[4:7], s15 offen sc1
    buffer_load_dword v59, v56, s[4:7], s16 offen sc1
    s_sub_u32 s29, s29, 1
    s_cmp_lt_i32 s29, 0
    s_waitcnt vmcnt(0)
    v_max3_u32 v57, v28, v29, v30
    v_max3_u32 v57, v57, v31, v59
    v_cmp_eq_u32 vcc, -1, v57
    ds_write_b128 v62, v[28:31] offset:45056
    ds_write_b32 v58, v59
    s_waitcnt lgkmcnt(0)
    s_cbranch_scc1 cs_go1
    s_cbranch_vccnz cs_spin1
    s_branch cs_go1
cs_last:
    s_nop 1
    s_cmp_eq_u32 s28, 63
    s_cbranch_scc1 cs_last2
    s_mov_b64 exec, s[34:35]
    buffer_store_dwordx4 v[0:3], v61, s[4:7], s25 offen sc1
    s_mov_b64 exec, -1
    s_add_u32 s25, s25, 131072
    s_cmp_eq_u32 0, 0
    s_branch cs_back
cs_last2:
    s_waitcnt lgkmcnt(0)
    s_mov_b64 exec, s[34:35]
    buffer_store_dwordx4 v[0:3], v61, s[4:7], s25 offen sc1
    s_mov_b64 exec, -1
    s_add_u32 s40, s95, 64
    v_mov_b32 v32, s40
    v_smfmac_f32_16x16x64_bf16 v[20:23], v[24:27], v[152:159], v60
    v_smfmac_f32_16x16x64_bf16 v[16:19], v[48:51], a[208:215], v60
    v_smfmac_f32_16x16x64_bf16 v[20:23], v[48:51], a[216:223], v60
    v_smfmac_f32_16x16x64_bf16 v[16:19], v[52:55], a[240:247], v60
    v_smfmac_f32_16x16x64_bf16 v[20:23], v[52:55], a[248:255], v60
    s_nop 3
    v_cvt_pk_bf16_f32 v16, v16, v17
    v_cvt_pk_bf16_f32 v17, v18, v19
    s_nop 1
    v_cvt_pk_bf16_f32 v18, v20, v21
    v_cvt_pk_bf16_f32 v19, v22, v23
    buffer_store_dwordx4 v[16:19], v61, s[4:7], s26 offen sc1
    s_waitcnt vmcnt(0)
    s_mov_b64 exec, 1
    buffer_store_dword v32, off, s[4:7], s27 sc1
    s_mov_b64 exec, -1
    s_endpgm
cs_dma:
    s_xor_b32 s74, s76, s81
    s_add_u32 m0, s74, s80
    s_add_u32 s76, s76, 4096
    buffer_load_dwordx4 v58, s[8:11], s78 offen lds
    s_add_u32 s78, s78, s79
    s_cmp_lt_u32 s76, s77
    s_cbranch_scc1 cs_dma
    s_setpc_b64 s[82:83]
L_helper:
    s_load_dwordx16 s[64:79], s[0:1], 64
    s_sub_u32 s33, s3, 1
    s_and_b32 s33, s33, 7
L_pool:
    s_lshl_b32 s35, s33, 2
    s_add_u32 s35, s35, 32
    s_mov_b32 s37, s35
    v_mov_b32 v250, 1
    v_mov_b32 v251, 163832
    v_cmp_eq_u32 vcc, 0, v0
    s_nop 0
    s_and_saveexec_b64 s[38:39], vcc
    s_cbranch_execz tk6
    buffer_atomic_add v250, off, s[96:99], s37 sc0
    s_waitcnt vmcnt(0)
    ds_write_b32 v251, v250
    s_waitcnt lgkmcnt(0)
tk6:
    s_mov_b64 exec, -1
    s_barrier
    ds_read_b32 v252, v251
    s_waitcnt lgkmcnt(0)
    v_readfirstlane_b32 s34, v252
    s_barrier
    s_nop 3
    s_mov_b32 s36, s33
    s_or_b32 s33, s34, s32
    s_cmp_lg_u32 s33, 0
    s_cbranch_scc1 L_helper1
    s_memrealtime s[90:91]
    s_waitcnt lgkmcnt(0)
    s_lshl_b32 s90, s90, 8
    s_or_b32 s90, s90, 1
    v_mov_b32 v250, s90
    v_mov_b32 v251, 0
    s_mov_b64 exec, 1
    buffer_atomic_cmpswap v[250:251], off, s[96:99], 0 offset:64
    s_mov_b64 exec, -1
L_helper1:
    s_cmp_ge_u32 s34, 32
    s_cbranch_scc1 L_qkv_next
    s_cmp_ge_u32 s36, 7
    s_cbranch_scc1 L_qkv_next
    s_max_u32 s37, s36, 4
    s_sub_u32 s37, s37, 4
    s_mul_i32 s37, s37, 6
    s_lshl_b32 s38, s36, 1
    s_add_u32 s38, s38, s37
    s_cmp_lt_u32 s36, 4
    s_cselect_b32 s39, 2, 8
    s_mul_i32 s36, s36, 30
    s_sub_u32 s36, s36, s37
    s_cmp_lt_u32 s34, s39
    s_cbranch_scc1 L_copy
    s_add_u32 s36, s36, s34
    s_sub_u32 s36, s36, s39
    s_mul_i32 s37, s36, 171
    s_lshr_b32 s37, s37, 10
    s_mul_i32 s38, s37, 6
    s_sub_u32 s36, s36, s38
    s_lshl_b32 s36, s36, 5
    s_add_u32 s36, s36, s37
    s_branch L_job
L_copy:
    s_add_u32 s36, s38, s34
    s_mul_i32 s36, s36, 11
    s_and_b32 s36, s36, 31
    s_cmp_ge_u32 s36, 18
    s_cbranch_scc1 L_qkv_next
    s_mul_i32 s39, s36, 57
    s_lshr_b32 s39, s39, 9
    s_mul_i32 s37, s39, 9
    s_sub_u32 s37, s36, s37
    s_sub_u32 s33, 1, s39
    s_mul_i32 s36, s37, 3
    s_add_u32 s36, s36, s33
    s_lshl_b32 s38, s37, 2
    s_add_u32 s38, s38, 1
    s_min_u32 s38, s38, 31
    s_lshr_b32 s39, s52, 8
    s_sub_u32 s38, s38, s39
    s_and_b32 s38, s38, 31
    s_lshl_b32 s38, s38, 8
    s_cmp_eq_u32 s33, 1
    s_cselect_b64 s[12:13], s[54:55], s[52:53]
    s_mov_b32 s14, 4718592
    s_mov_b32 s15, 0x20000
    v_lshrrev_b32 v1, 4, v0
    v_lshlrev_b32 v1, 13, v1
    v_and_b32 v2, 15, v0
    v_lshl_add_u32 v1, v2, 4, v1
    v_lshlrev_b32 v2, 4, v0
    s_mul_i32 s39, s36, 147456
    s_add_u32 s39, s39, 96468992
    buffer_load_dwordx4 v[8:11], v1, s[12:15], s38 offen
    s_add_u32 s38, s38, 131072
    buffer_load_dwordx4 v[12:15], v1, s[12:15], s38 offen
    s_add_u32 s38, s38, 131072
    buffer_load_dwordx4 v[16:19], v1, s[12:15], s38 offen
    s_add_u32 s38, s38, 131072
    buffer_load_dwordx4 v[20:23], v1, s[12:15], s38 offen
    s_add_u32 s38, s38, 131072
    buffer_load_dwordx4 v[24:27], v1, s[12:15], s38 offen
    s_add_u32 s38, s38, 131072
    buffer_load_dwordx4 v[28:31], v1, s[12:15], s38 offen
    s_add_u32 s38, s38, 131072
    buffer_load_dwordx4 v[32:35], v1, s[12:15], s38 offen
    s_add_u32 s38, s38, 131072
    buffer_load_dwordx4 v[36:39], v1, s[12:15], s38 offen
    s_add_u32 s38, s38, 131072
    buffer_load_dwordx4 v[40:43], v1, s[12:15], s38 offen
    s_add_u32 s38, s38, 131072
    buffer_load_dwordx4 v[44:47], v1, s[12:15], s38 offen
    s_add_u32 s38, s38, 131072
    buffer_load_dwordx4 v[48:51], v1, s[12:15], s38 offen
    s_add_u32 s38, s38, 131072
    buffer_load_dwordx4 v[52:55], v1, s[12:15], s38 offen
    s_add_u32 s38, s38, 131072
    buffer_load_dwordx4 v[56:59], v1, s[12:15], s38 offen
    s_add_u32 s38, s38, 131072
    buffer_load_dwordx4 v[60:63], v1, s[12:15], s38 offen
    s_add_u32 s38, s38, 131072
    buffer_load_dwordx4 v[64:67], v1, s[12:15], s38 offen
    s_add_u32 s38, s38, 131072
    buffer_load_dwordx4 v[68:71], v1, s[12:15], s38 offen
    s_add_u32 s38, s38, 131072
    buffer_load_dwordx4 v[72:75], v1, s[12:15], s38 offen
    s_add_u32 s38, s38, 131072
    buffer_load_dwordx4 v[76:79], v1, s[12:15], s38 offen
    s_add_u32 s38, s38, 131072
    buffer_load_dwordx4 v[80:83], v1, s[12:15], s38 offen
    s_add_u32 s38, s38, 131072
    buffer_load_dwordx4 v[84:87], v1, s[12:15], s38 offen
    s_add_u32 s38, s38, 131072
    buffer_load_dwordx4 v[88:91], v1, s[12:15], s38 offen
    s_add_u32 s38, s38, 131072
    buffer_load_dwordx4 v[92:95], v1, s[12:15], s38 offen
    s_add_u32 s38, s38, 131072
    buffer_load_dwordx4 v[96:99], v1, s[12:15], s38 offen
    s_add_u32 s38, s38, 131072
    buffer_load_dwordx4 v[100:103], v1, s[12:15], s38 offen
    s_add_u32 s38, s38, 131072
    buffer_load_dwordx4 v[104:107], v1, s[12:15], s38 offen
    s_add_u32 s38, s38, 131072
    buffer_load_dwordx4 v[108:111], v1, s[12:15], s38 offen
    s_add_u32 s38, s38, 131072
    buffer_load_dwordx4 v[112:115], v1, s[12:15], s38 offen
    s_add_u32 s38, s38, 131072
    buffer_load_dwordx4 v[116:119], v1, s[12:15], s38 offen
    s_add_u32 s38, s38, 131072
    buffer_load_dwordx4 v[120:123], v1, s[12:15], s38 offen
    s_add_u32 s38, s38, 131072
    buffer_load_dwordx4 v[124:127], v1, s[12:15], s38 offen
    s_add_u32 s38, s38, 131072
    buffer_load_dwordx4 v[128:131], v1, s[12:15], s38 offen
    s_add_u32 s38, s38, 131072
    buffer_load_dwordx4 v[132:135], v1, s[12:15], s38 offen
    s_add_u32 s38, s38, 131072
    buffer_load_dwordx4 v[136:139], v1, s[12:15], s38 offen
    s_add_u32 s38, s38, 131072
    buffer_load_dwordx4 v[140:143], v1, s[12:15], s38 offen
    s_add_u32 s38, s38, 131072
    buffer_load_dwordx4 v[144:147], v1, s[12:15], s38 offen
    s_add_u32 s38, s38, 131072
    buffer_load_dwordx4 v[148:151], v1, s[12:15], s38 offen
    s_add_u32 s38, s38, 131072
    s_waitcnt vmcnt(0)
    buffer_store_dwordx4 v[8:11], v2, s[4:7], s39 offen sc1
    s_add_u32 s39, s39, 4096
    buffer_store_dwordx4 v[12:15], v2, s[4:7], s39 offen sc1
    s_add_u32 s39, s39, 4096
    buffer_store_dwordx4 v[16:19], v2, s[4:7], s39 offen sc1
    s_add_u32 s39, s39, 4096
    buffer_store_dwordx4 v[20:23], v2, s[4:7], s39 offen sc1
    s_add_u32 s39, s39, 4096
    buffer_store_dwordx4 v[24:27], v2, s[4:7], s39 offen sc1
    s_add_u32 s39, s39, 4096
    buffer_store_dwordx4 v[28:31], v2, s[4:7], s39 offen sc1
    s_add_u32 s39, s39, 4096
    buffer_store_dwordx4 v[32:35], v2, s[4:7], s39 offen sc1
    s_add_u32 s39, s39, 4096
    buffer_store_dwordx4 v[36:39], v2, s[4:7], s39 offen sc1
    s_add_u32 s39, s39, 4096
    buffer_store_dwordx4 v[40:43], v2, s[4:7], s39 offen sc1
    s_add_u32 s39, s39, 4096
    buffer_store_dwordx4 v[44:47], v2, s[4:7], s39 offen sc1
    s_add_u32 s39, s39, 4096
    buffer_store_dwordx4 v[48:51], v2, s[4:7], s39 offen sc1
    s_add_u32 s39, s39, 4096
    buffer_store_dwordx4 v[52:55], v2, s[4:7], s39 offen sc1
    s_add_u32 s39, s39, 4096
    buffer_store_dwordx4 v[56:59], v2, s[4:7], s39 offen sc1
    s_add_u32 s39, s39, 4096
    buffer_store_dwordx4 v[60:63], v2, s[4:7], s39 offen sc1
    s_add_u32 s39, s39, 4096
    buffer_store_dwordx4 v[64:67], v2, s[4:7], s39 offen sc1
    s_add_u32 s39, s39, 4096
    buffer_store_dwordx4 v[68:71], v2, s[4:7], s39 offen sc1
    s_add_u32 s39, s39, 4096
    buffer_store_dwordx4 v[72:75], v2, s[4:7], s39 offen sc1
    s_add_u32 s39, s39, 4096
    buffer_store_dwordx4 v[76:79], v2, s[4:7], s39 offen sc1
    s_add_u32 s39, s39, 4096
    buffer_store_dwordx4 v[80:83], v2, s[4:7], s39 offen sc1
    s_add_u32 s39, s39, 4096
    buffer_store_dwordx4 v[84:87], v2, s[4:7], s39 offen sc1
    s_add_u32 s39, s39, 4096
    buffer_store_dwordx4 v[88:91], v2, s[4:7], s39 offen sc1
    s_add_u32 s39, s39, 4096
    buffer_store_dwordx4 v[92:95], v2, s[4:7], s39 offen sc1
    s_add_u32 s39, s39, 4096
    buffer_store_dwordx4 v[96:99], v2, s[4:7], s39 offen sc1
    s_add_u32 s39, s39, 4096
    buffer_store_dwordx4 v[100:103], v2, s[4:7], s39 offen sc1
    s_add_u32 s39, s39, 4096
    buffer_store_dwordx4 v[104:107], v2, s[4:7], s39 offen sc1
    s_add_u32 s39, s39, 4096
    buffer_store_dwordx4 v[108:111], v2, s[4:7], s39 offen sc1
    s_add_u32 s39, s39, 4096
    buffer_store_dwordx4 v[112:115], v2, s[4:7], s39 offen sc1
    s_add_u32 s39, s39, 4096
    buffer_store_dwordx4 v[116:119], v2, s[4:7], s39 offen sc1
    s_add_u32 s39, s39, 4096
    buffer_store_dwordx4 v[120:123], v2, s[4:7], s39 offen sc1
    s_add_u32 s39, s39, 4096
    buffer_store_dwordx4 v[124:127], v2, s[4:7], s39 offen sc1
    s_add_u32 s39, s39, 4096
    buffer_store_dwordx4 v[128:131], v2, s[4:7], s39 offen sc1
    s_add_u32 s39, s39, 4096
    buffer_store_dwordx4 v[132:135], v2, s[4:7], s39 offen sc1
    s_add_u32 s39, s39, 4096
    buffer_store_dwordx4 v[136:139], v2, s[4:7], s39 offen sc1
    s_add_u32 s39, s39, 4096
    buffer_store_dwordx4 v[140:143], v2, s[4:7], s39 offen sc1
    s_add_u32 s39, s39, 4096
    buffer_store_dwordx4 v[144:147], v2, s[4:7], s39 offen sc1
    s_add_u32 s39, s39, 4096
    buffer_store_dwordx4 v[148:151], v2, s[4:7], s39 offen sc1
    s_add_u32 s39, s39, 4096
    s_nop 0
    s_mov_b32 s88, 4194304
gn7:
    s_cmp_lg_u32 s95, 0
    s_cbranch_scc1 gn7x
    buffer_load_dword v3, off, s[96:99], 0 offset:64 sc1
    s_sub_u32 s88, s88, 1
    s_cbranch_scc1 gn7x
    s_waitcnt vmcnt(0)
    v_readfirstlane_b32 s95, v3
    s_nop 1
    s_branch gn7
gn7x:
    s_lshl_b32 s37, s37, 7
    s_lshl_b32 s36, s33, 2
    s_add_u32 s36, s36, s32
    s_lshl_b32 s36, s36, 2
    s_add_u32 s37, s37, s36
    s_add_u32 s37, s37, 125853696
    v_mov_b32 v3, s95
    s_waitcnt vmcnt(0)
    s_mov_b64 exec, 1
    buffer_store_dword v3, off, s[4:7], s37 sc1
    s_mov_b64 exec, -1
L_qkv_next:
    s_mov_b32 s37, 4
    v_mov_b32 v250, 1
    v_mov_b32 v251, 163832
    v_cmp_eq_u32 vcc, 0, v0
    s_nop 0
    s_and_saveexec_b64 s[38:39], vcc
    s_cbranch_execz tk8
    buffer_atomic_add v250, off, s[96:99], s37 sc0
    s_waitcnt vmcnt(0)
    ds_write_b32 v251, v250
    s_waitcnt lgkmcnt(0)
tk8:
    s_mov_b64 exec, -1
    s_barrier
    ds_read_b32 v252, v251
    s_waitcnt lgkmcnt(0)
    v_readfirstlane_b32 s36, v252
    s_barrier
    s_nop 3
    s_add_u32 s36, s36, 192
    s_cmp_ge_u32 s36, 320
    s_cbranch_scc1 L_ssm_next
L_job:
    s_and_b32 s17, s36, 15
    s_lshl_b32 s17, s17, 1
    s_bfe_u32 s16, s36, 0x10004
    s_lshr_b32 s19, s36, 5
    s_mul_i32 s33, s16, 6
    s_add_u32 s33, s33, s19
    s_add_u32 s16, s16, 1
    s_lshr_b32 s37, s36, 4
    s_sub_u32 s38, s37, 12
    s_cmp_ge_u32 s36, 192
    s_cselect_b32 s16, 0, s16
    s_cselect_b32 s19, s38, s19
    s_cselect_b32 s33, s37, s33
    s_cselect_b32 s20, 8, 6
    v_lshrrev_b32 v4, 6, v0
    s_nop 0
    v_readfirstlane_b32 s18, v4
    v_lshlrev_b32 v7, 4, v0
    v_and_b32 v4, 63, v0
    v_lshrrev_b32 v6, 2, v4
    v_lshlrev_b32 v6, 13, v6
    v_lshrrev_b32 v5, 4, v4
    v_and_b32 v5, 2, v5
    v_xor_b32 v5, v5, v4
    v_and_b32 v5, 3, v5
    v_lshl_add_u32 v6, v5, 4, v6
    v_lshrrev_b32 v24, 4, v4
    v_lshlrev_b32 v24, 9, v24
    v_bfe_u32 v5, v4, 2, 2
    v_lshl_add_u32 v24, v5, 6, v24
    v_bfe_u32 v5, v4, 4, 1
    v_lshl_add_u32 v24, v5, 5, v24
    v_and_b32 v5, 3, v4
    v_lshl_add_u32 v24, v5, 3, v24
    s_lshl_b32 s31, s18, 12
    v_add_u32 v24, s31, v24
    s_cmp_eq_u32 s16, 1
    s_cselect_b64 s[12:13], s[54:55], s[52:53]
    s_cmp_eq_u32 s16, 2
    s_cselect_b64 s[12:13], s[56:57], s[12:13]
    s_mov_b32 s14, 4718592
    s_mov_b32 s15, 0x20000
    s_lshl_b32 s28, s17, 8
    s_lshl_b32 s21, s18, 6
    s_add_u32 s28, s28, s21
    s_add_u32 s21, s28, 0
    s_add_u32 m0, s31, 40960
    s_nop 0
    buffer_load_dwordx4 v6, s[12:15], s21 offen lds
    s_add_u32 m0, s31, 41984
    s_add_u32 s21, s21, 131072
    buffer_load_dwordx4 v6, s[12:15], s21 offen lds
    s_add_u32 m0, s31, 43008
    s_add_u32 s21, s21, 131072
    buffer_load_dwordx4 v6, s[12:15], s21 offen lds
    s_add_u32 m0, s31, 44032
    s_add_u32 s21, s21, 131072
    buffer_load_dwordx4 v6, s[12:15], s21 offen lds
    s_add_u32 s21, s28, 256
    s_add_u32 m0, s31, 57344
    s_nop 0
    buffer_load_dwordx4 v6, s[12:15], s21 offen lds
    s_add_u32 m0, s31, 58368
    s_add_u32 s21, s21, 131072
    buffer_load_dwordx4 v6, s[12:15], s21 offen lds
    s_add_u32 m0, s31, 59392
    s_add_u32 s21, s21, 131072
    buffer_load_dwordx4 v6, s[12:15], s21 offen lds
    s_add_u32 m0, s31, 60416
    s_add_u32 s21, s21, 131072
    buffer_load_dwordx4 v6, s[12:15], s21 offen lds
    s_add_u32 s21, s28, 524288
    s_add_u32 m0, s31, 73728
    s_nop 0
    buffer_load_dwordx4 v6, s[12:15], s21 offen lds
    s_add_u32 m0, s31, 74752
    s_add_u32 s21, s21, 131072
    buffer_load_dwordx4 v6, s[12:15], s21 offen lds
    s_add_u32 m0, s31, 75776
    s_add_u32 s21, s21, 131072
    buffer_load_dwordx4 v6, s[12:15], s21 offen lds
    s_add_u32 m0, s31, 76800
    s_add_u32 s21, s21, 131072
    buffer_load_dwordx4 v6, s[12:15], s21 offen lds
    s_add_u32 s21, s28, 524544
    s_add_u32 m0, s31, 90112
    s_nop 0
    buffer_load_dwordx4 v6, s[12:15], s21 offen lds
    s_add_u32 m0, s31, 91136
    s_add_u32 s21, s21, 131072
    buffer_load_dwordx4 v6, s[12:15], s21 offen lds
    s_add_u32 m0, s31, 92160
    s_add_u32 s21, s21, 131072
    buffer_load_dwordx4 v6, s[12:15], s21 offen lds
    s_add_u32 m0, s31, 93184
    s_add_u32 s21, s21, 131072
    buffer_load_dwordx4 v6, s[12:15], s21 offen lds
    s_add_u32 s21, s28, 1048576
    s_add_u32 m0, s31, 106496
    s_nop 0
    buffer_load_dwordx4 v6, s[12:15], s21 offen lds
    s_add_u32 m0, s31, 107520
    s_add_u32 s21, s21, 131072
    buffer_load_dwordx4 v6, s[12:15], s21 offen lds
    s_add_u32 m0, s31, 108544
    s_add_u32 s21, s21, 131072
    buffer_load_dwordx4 v6, s[12:15], s21 offen lds
    s_add_u32 m0, s31, 109568
    s_add_u32 s21, s21, 131072
    buffer_load_dwordx4 v6, s[12:15], s21 offen lds
    s_add_u32 s21, s28, 1048832
    s_add_u32 m0, s31, 122880
    s_nop 0
    buffer_load_dwordx4 v6, s[12:15], s21 offen lds
    s_add_u32 m0, s31, 123904
    s_add_u32 s21, s21, 131072
    buffer_load_dwordx4 v6, s[12:15], s21 offen lds
    s_add_u32 m0, s31, 124928
    s_add_u32 s21, s21, 131072
    buffer_load_dwordx4 v6, s[12:15], s21 offen lds
    s_add_u32 m0, s31, 125952
    s_add_u32 s21, s21, 131072
    buffer_load_dwordx4 v6, s[12:15], s21 offen lds
    s_add_u32 s21, s28, 1572864
    s_add_u32 m0, s31, 139264
    s_nop 0
    buffer_load_dwordx4 v6, s[12:15], s21 offen lds
    s_add_u32 m0, s31, 140288
    s_add_u32 s21, s21, 131072
    buffer_load_dwordx4 v6, s[12:15], s21 offen lds
    s_add_u32 m0, s31, 141312
    s_add_u32 s21, s21, 131072
    buffer_load_dwordx4 v6, s[12:15], s21 offen lds
    s_add_u32 m0, s31, 142336
    s_add_u32 s21, s21, 131072
    buffer_load_dwordx4 v6, s[12:15], s21 offen lds
    v_and_b32 v5, 15, v4
    v_lshrrev_b32 v3, 4, v4
    v_lshrrev_b32 v2, 2, v5
    v_xor_b32 v3, v3, v2
    v_lshl_add_u32 v3, v5, 2, v3
    v_lshlrev_b32 v1, 4, v3
    v_lshrrev_b32 v5, 2, v4
    v_lshrrev_b32 v3, 4, v4
    v_and_b32 v4, 3, v4
    v_xor_b32 v4, v4, v3
    v_lshlrev_b32 v3, 3, v3
    v_and_b32 v5, 3, v5
    v_add_u32 v3, v3, v5
    v_mul_u32_u24 v2, 1152, v3
    v_lshl_add_u32 v2, v4, 4, v2
    s_mov_b32 s8, s48
    s_mov_b32 s9, s49
    s_mov_b32 s10, 2359296
    s_mov_b32 s11, 0x20000
    s_lshr_b32 s22, s18, 1
    s_mul_i32 s24, s22, 4608
    s_and_b32 s22, s18, 1
    s_mul_i32 s23, s22, 576
    s_add_u32 s24, s24, s23
    s_mul_i32 s25, s18, 9216
    s_mul_i32 s22, s19, 36864
    s_add_u32 s24, s24, s22
    s_mul_i32 s42, s20, 36864
    s_mov_b32 s27, 0
    s_add_u32 s23, s27, s25
    s_add_u32 m0, s23, 0
    s_nop 0
    buffer_load_dwordx4 v2, s[8:11], s24 offen offset:0 lds
    s_add_u32 m0, s23, 960
    s_nop 0
    buffer_load_dwordx4 v2, s[8:11], s24 offen offset:64 lds
    s_add_u32 m0, s23, 1920
    s_nop 0
    buffer_load_dwordx4 v2, s[8:11], s24 offen offset:128 lds
    s_add_u32 m0, s23, 2880
    s_nop 0
    buffer_load_dwordx4 v2, s[8:11], s24 offen offset:192 lds
    s_add_u32 m0, s23, 3840
    s_nop 0
    buffer_load_dwordx4 v2, s[8:11], s24 offen offset:256 lds
    s_add_u32 m0, s23, 4800
    s_nop 0
    buffer_load_dwordx4 v2, s[8:11], s24 offen offset:320 lds
    s_add_u32 m0, s23, 5760
    s_nop 0
    buffer_load_dwordx4 v2, s[8:11], s24 offen offset:384 lds
    s_add_u32 m0, s23, 6720
    s_nop 0
    buffer_load_dwordx4 v2, s[8:11], s24 offen offset:448 lds
    s_add_u32 m0, s23, 7680
    s_nop 0
    buffer_load_dwordx4 v2, s[8:11], s24 offen offset:512 lds
    s_add_u32 s24, s24, s42
    s_lshl_b32 s22, s19, 5
    s_add_u32 s22, s22, s17
    s_lshl_b32 s26, s22, 14
    s_mul_i32 s23, s18, 3072
    s_add_u32 s26, s26, s23
    s_lshl_b32 s23, s16, 11
    s_add_u32 s26, s26, s23
    s_add_u32 s26, s26, -2048
    s_lshl_b32 s22, s22, 13
    s_add_u32 s22, s22, 33554432
    s_cmp_eq_u32 s16, 0
    s_cselect_b32 s26, s22, s26
    s_cselect_b32 s40, 4, 1
    s_cselect_b32 s43, 1, 2
    s_lshl_b32 s40, s40, 10
    s_lshl_b32 s43, s43, 13
    s_lshl_b32 s41, s43, 5
    s_mul_i32 s41, s41, s20
    s_lshl_b32 s29, s17, 7
    s_lshl_b32 s22, s33, 2
    s_add_u32 s29, s29, s22
    s_add_u32 s29, s29, 125829120
    v_add_u32 v25, 40960, v24
    v_xor_b32 v26, 32, v25
    s_waitcnt vmcnt(33)
    ds_read_b64_tr_b16 v[64:65], v25 offset:0
    ds_read_b64_tr_b16 v[66:67], v25 offset:256
    ds_read_b64_tr_b16 v[136:137], v26 offset:0
    ds_read_b64_tr_b16 v[138:139], v26 offset:256
    ds_read_b64_tr_b16 v[68:69], v25 offset:2048
    ds_read_b64_tr_b16 v[70:71], v25 offset:2304
    ds_read_b64_tr_b16 v[140:141], v26 offset:2048
    ds_read_b64_tr_b16 v[142:143], v26 offset:2304
    s_waitcnt lgkmcnt(0)
    s_add_u32 s21, s28, 1573120
    s_add_u32 m0, s31, 40960
    s_nop 0
    buffer_load_dwordx4 v6, s[12:15], s21 offen lds
    s_add_u32 m0, s31, 41984
    s_add_u32 s21, s21, 131072
    buffer_load_dwordx4 v6, s[12:15], s21 offen lds
    s_add_u32 m0, s31, 43008
    s_add_u32 s21, s21, 131072
    buffer_load_dwordx4 v6, s[12:15], s21 offen lds
    s_add_u32 m0, s31, 44032
    s_add_u32 s21, s21, 131072
    buffer_load_dwordx4 v6, s[12:15], s21 offen lds
    v_add_u32 v25, 57344, v24
    v_xor_b32 v26, 32, v25
    s_waitcnt vmcnt(33)
    ds_read_b64_tr_b16 a[0:1], v25 offset:0
    ds_read_b64_tr_b16 a[2:3], v25 offset:256
    ds_read_b64_tr_b16 a[72:73], v26 offset:0
    ds_read_b64_tr_b16 a[74:75], v26 offset:256
    ds_read_b64_tr_b16 a[4:5], v25 offset:2048
    ds_read_b64_tr_b16 a[6:7], v25 offset:2304
    ds_read_b64_tr_b16 a[76:77], v26 offset:2048
    ds_read_b64_tr_b16 a[78:79], v26 offset:2304
    s_waitcnt lgkmcnt(0)
    s_add_u32 s21, s28, 2097152
    s_add_u32 m0, s31, 57344
    s_nop 0
    buffer_load_dwordx4 v6, s[12:15], s21 offen lds
    s_add_u32 m0, s31, 58368
    s_add_u32 s21, s21, 131072
    buffer_load_dwordx4 v6, s[12:15], s21 offen lds
    s_add_u32 m0, s31, 59392
    s_add_u32 s21, s21, 131072
    buffer_load_dwordx4 v6, s[12:15], s21 offen lds
    s_add_u32 m0, s31, 60416
    s_add_u32 s21, s21, 131072
    buffer_load_dwordx4 v6, s[12:15], s21 offen lds
    v_add_u32 v25, 73728, v24
    v_xor_b32 v26, 32, v25
    s_waitcnt vmcnt(33)
    ds_read_b64_tr_b16 v[72:73], v25 offset:0
    ds_read_b64_tr_b16 v[74:75], v25 offset:256
    ds_read_b64_tr_b16 v[144:145], v26 offset:0
    ds_read_b64_tr_b16 v[146:147], v26 offset:256
    ds_read_b64_tr_b16 v[76:77], v25 offset:2048
    ds_read_b64_tr_b16 v[78:79], v25 offset:2304
    ds_read_b64_tr_b16 v[148:149], v26 offset:2048
    ds_read_b64_tr_b16 v[150:151], v26 offset:2304
    s_waitcnt lgkmcnt(0)
    s_add_u32 s21, s28, 2097408
    s_add_u32 m0, s31, 73728
    s_nop 0
    buffer_load_dwordx4 v6, s[12:15], s21 offen lds
    s_add_u32 m0, s31, 74752
    s_add_u32 s21, s21, 131072
    buffer_load_dwordx4 v6, s[12:15], s21 offen lds
    s_add_u32 m0, s31, 75776
    s_add_u32 s21, s21, 131072
    buffer_load_dwordx4 v6, s[12:15], s21 offen lds
    s_add_u32 m0, s31, 76800
    s_add_u32 s21, s21, 131072
    buffer_load_dwordx4 v6, s[12:15], s21 offen lds
    v_add_u32 v25, 90112, v24
    v_xor_b32 v26, 32, v25
    s_waitcnt vmcnt(33)
    ds_read_b64_tr_b16 a[8:9], v25 offset:0
    ds_read_b64_tr_b16 a[10:11], v25 offset:256
    ds_read_b64_tr_b16 a[80:81], v26 offset:0
    ds_read_b64_tr_b16 a[82:83], v26 offset:256
    ds_read_b64_tr_b16 a[12:13], v25 offset:2048
    ds_read_b64_tr_b16 a[14:15], v25 offset:2304
    ds_read_b64_tr_b16 a[84:85], v26 offset:2048
    ds_read_b64_tr_b16 a[86:87], v26 offset:2304
    s_waitcnt lgkmcnt(0)
    s_add_u32 s21, s28, 2621440
    s_add_u32 m0, s31, 90112
    s_nop 0
    buffer_load_dwordx4 v6, s[12:15], s21 offen lds
    s_add_u32 m0, s31, 91136
    s_add_u32 s21, s21, 131072
    buffer_load_dwordx4 v6, s[12:15], s21 offen lds
    s_add_u32 m0, s31, 92160
    s_add_u32 s21, s21, 131072
    buffer_load_dwordx4 v6, s[12:15], s21 offen lds
    s_add_u32 m0, s31, 93184
    s_add_u32 s21, s21, 131072
    buffer_load_dwordx4 v6, s[12:15], s21 offen lds
    v_add_u32 v25, 106496, v24
    v_xor_b32 v26, 32, v25
    s_waitcnt vmcnt(33)
    ds_read_b64_tr_b16 v[80:81], v25 offset:0
    ds_read_b64_tr_b16 v[82:83], v25 offset:256
    ds_read_b64_tr_b16 v[152:153], v26 offset:0
    ds_read_b64_tr_b16 v[154:155], v26 offset:256
    ds_read_b64_tr_b16 v[84:85], v25 offset:2048
    ds_read_b64_tr_b16 v[86:87], v25 offset:2304
    ds_read_b64_tr_b16 v[156:157], v26 offset:2048
    ds_read_b64_tr_b16 v[158:159], v26 offset:2304
    s_waitcnt lgkmcnt(0)
    s_add_u32 s21, s28, 2621696
    s_add_u32 m0, s31, 106496
    s_nop 0
    buffer_load_dwordx4 v6, s[12:15], s21 offen lds
    s_add_u32 m0, s31, 107520
    s_add_u32 s21, s21, 131072
    buffer_load_dwordx4 v6, s[12:15], s21 offen lds
    s_add_u32 m0, s31, 108544
    s_add_u32 s21, s21, 131072
    buffer_load_dwordx4 v6, s[12:15], s21 offen lds
    s_add_u32 m0, s31, 109568
    s_add_u32 s21, s21, 131072
    buffer_load_dwordx4 v6, s[12:15], s21 offen lds
    v_add_u32 v25, 122880, v24
    v_xor_b32 v26, 32, v25
    s_waitcnt vmcnt(33)
    ds_read_b64_tr_b16 a[16:17], v25 offset:0
    ds_read_b64_tr_b16 a[18:19], v25 offset:256
    ds_read_b64_tr_b16 a[88:89], v26 offset:0
    ds_read_b64_tr_b16 a[90:91], v26 offset:256
    ds_read_b64_tr_b16 a[20:21], v25 offset:2048
    ds_read_b64_tr_b16 a[22:23], v25 offset:2304
    ds_read_b64_tr_b16 a[92:93], v26 offset:2048
    ds_read_b64_tr_b16 a[94:95], v26 offset:2304
    s_waitcnt lgkmcnt(0)
    s_add_u32 s21, s28, 3145728
    s_add_u32 m0, s31, 122880
    s_nop 0
    buffer_load_dwordx4 v6, s[12:15], s21 offen lds
    s_add_u32 m0, s31, 123904
    s_add_u32 s21, s21, 131072
    buffer_load_dwordx4 v6, s[12:15], s21 offen lds
    s_add_u32 m0, s31, 124928
    s_add_u32 s21, s21, 131072
    buffer_load_dwordx4 v6, s[12:15], s21 offen lds
    s_add_u32 m0, s31, 125952
    s_add_u32 s21, s21, 131072
    buffer_load_dwordx4 v6, s[12:15], s21 offen lds
    v_add_u32 v25, 139264, v24
    v_xor_b32 v26, 32, v25
    s_waitcnt vmcnt(33)
    ds_read_b64_tr_b16 v[88:89], v25 offset:0
    ds_read_b64_tr_b16 v[90:91], v25 offset:256
    ds_read_b64_tr_b16 v[160:161], v26 offset:0
    ds_read_b64_tr_b16 v[162:163], v26 offset:256
    ds_read_b64_tr_b16 v[92:93], v25 offset:2048
    ds_read_b64_tr_b16 v[94:95], v25 offset:2304
    ds_read_b64_tr_b16 v[164:165], v26 offset:2048
    ds_read_b64_tr_b16 v[166:167], v26 offset:2304
    s_waitcnt lgkmcnt(0)
    s_add_u32 s21, s28, 3145984
    s_add_u32 m0, s31, 139264
    s_nop 0
    buffer_load_dwordx4 v6, s[12:15], s21 offen lds
    s_add_u32 m0, s31, 140288
    s_add_u32 s21, s21, 131072
    buffer_load_dwordx4 v6, s[12:15], s21 offen lds
    s_add_u32 m0, s31, 141312
    s_add_u32 s21, s21, 131072
    buffer_load_dwordx4 v6, s[12:15], s21 offen lds
    s_add_u32 m0, s31, 142336
    s_add_u32 s21, s21, 131072
    buffer_load_dwordx4 v6, s[12:15], s21 offen lds
    v_add_u32 v25, 40960, v24
    v_xor_b32 v26, 32, v25
    s_waitcnt vmcnt(24)
    ds_read_b64_tr_b16 a[24:25], v25 offset:0
    ds_read_b64_tr_b16 a[26:27], v25 offset:256
    ds_read_b64_tr_b16 a[96:97], v26 offset:0
    ds_read_b64_tr_b16 a[98:99], v26 offset:256
    ds_read_b64_tr_b16 a[28:29], v25 offset:2048
    ds_read_b64_tr_b16 a[30:31], v25 offset:2304
    ds_read_b64_tr_b16 a[100:101], v26 offset:2048
    ds_read_b64_tr_b16 a[102:103], v26 offset:2304
    s_waitcnt lgkmcnt(0)
    s_add_u32 s21, s28, 3670016
    s_add_u32 m0, s31, 40960
    s_nop 0
    buffer_load_dwordx4 v6, s[12:15], s21 offen lds
    s_add_u32 m0, s31, 41984
    s_add_u32 s21, s21, 131072
    buffer_load_dwordx4 v6, s[12:15], s21 offen lds
    s_add_u32 m0, s31, 43008
    s_add_u32 s21, s21, 131072
    buffer_load_dwordx4 v6, s[12:15], s21 offen lds
    s_add_u32 m0, s31, 44032
    s_add_u32 s21, s21, 131072
    buffer_load_dwordx4 v6, s[12:15], s21 offen lds
    v_add_u32 v25, 57344, v24
    v_xor_b32 v26, 32, v25
    s_waitcnt vmcnt(24)
    ds_read_b64_tr_b16 v[96:97], v25 offset:0
    ds_read_b64_tr_b16 v[98:99], v25 offset:256
    ds_read_b64_tr_b16 v[168:169], v26 offset:0
    ds_read_b64_tr_b16 v[170:171], v26 offset:256
    ds_read_b64_tr_b16 v[100:101], v25 offset:2048
    ds_read_b64_tr_b16 v[102:103], v25 offset:2304
    ds_read_b64_tr_b16 v[172:173], v26 offset:2048
    ds_read_b64_tr_b16 v[174:175], v26 offset:2304
    s_waitcnt lgkmcnt(0)
    s_add_u32 s21, s28, 3670272
    s_add_u32 m0, s31, 57344
    s_nop 0
    buffer_load_dwordx4 v6, s[12:15], s21 offen lds
    s_add_u32 m0, s31, 58368
    s_add_u32 s21, s21, 131072
    buffer_load_dwordx4 v6, s[12:15], s21 offen lds
    s_add_u32 m0, s31, 59392
    s_add_u32 s21, s21, 131072
    buffer_load_dwordx4 v6, s[12:15], s21 offen lds
    s_add_u32 m0, s31, 60416
    s_add_u32 s21, s21, 131072
    buffer_load_dwordx4 v6, s[12:15], s21 offen lds
    v_add_u32 v25, 73728, v24
    v_xor_b32 v26, 32, v25
    s_waitcnt vmcnt(24)
    ds_read_b64_tr_b16 a[32:33], v25 offset:0
    ds_read_b64_tr_b16 a[34:35], v25 offset:256
    ds_read_b64_tr_b16 a[104:105], v26 offset:0
    ds_read_b64_tr_b16 a[106:107], v26 offset:256
    ds_read_b64_tr_b16 a[36:37], v25 offset:2048
    ds_read_b64_tr_b16 a[38:39], v25 offset:2304
    ds_read_b64_tr_b16 a[108:109], v26 offset:2048
    ds_read_b64_tr_b16 a[110:111], v26 offset:2304
    s_waitcnt lgkmcnt(0)
    s_add_u32 s21, s28, 4194304
    s_add_u32 m0, s31, 73728
    s_nop 0
    buffer_load_dwordx4 v6, s[12:15], s21 offen lds
    s_add_u32 m0, s31, 74752
    s_add_u32 s21, s21, 131072
    buffer_load_dwordx4 v6, s[12:15], s21 offen lds
    s_add_u32 m0, s31, 75776
    s_add_u32 s21, s21, 131072
    buffer_load_dwordx4 v6, s[12:15], s21 offen lds
    s_add_u32 m0, s31, 76800
    s_add_u32 s21, s21, 131072
    buffer_load_dwordx4 v6, s[12:15], s21 offen lds
    v_add_u32 v25, 90112, v24
    v_xor_b32 v26, 32, v25
    s_waitcnt vmcnt(24)
    ds_read_b64_tr_b16 v[104:105], v25 offset:0
    ds_read_b64_tr_b16 v[106:107], v25 offset:256
    ds_read_b64_tr_b16 v[176:177], v26 offset:0
    ds_read_b64_tr_b16 v[178:179], v26 offset:256
    ds_read_b64_tr_b16 v[108:109], v25 offset:2048
    ds_read_b64_tr_b16 v[110:111], v25 offset:2304
    ds_read_b64_tr_b16 v[180:181], v26 offset:2048
    ds_read_b64_tr_b16 v[182:183], v26 offset:2304
    s_waitcnt lgkmcnt(0)
    s_add_u32 s21, s28, 4194560
    s_add_u32 m0, s31, 90112
    s_nop 0
    buffer_load_dwordx4 v6, s[12:15], s21 offen lds
    s_add_u32 m0, s31, 91136
    s_add_u32 s21, s21, 131072
    buffer_load_dwordx4 v6, s[12:15], s21 offen lds
    s_add_u32 m0, s31, 92160
    s_add_u32 s21, s21, 131072
    buffer_load_dwordx4 v6, s[12:15], s21 offen lds
    s_add_u32 m0, s31, 93184
    s_add_u32 s21, s21, 131072
    buffer_load_dwordx4 v6, s[12:15], s21 offen lds
    v_add_u32 v25, 106496, v24
    v_xor_b32 v26, 32, v25
    s_waitcnt vmcnt(24)
    ds_read_b64_tr_b16 a[40:41], v25 offset:0
    ds_read_b64_tr_b16 a[42:43], v25 offset:256
    ds_read_b64_tr_b16 a[112:113], v26 offset:0
    ds_read_b64_tr_b16 a[114:115], v26 offset:256
    ds_read_b64_tr_b16 a[44:45], v25 offset:2048
    ds_read_b64_tr_b16 a[46:47], v25 offset:2304
    ds_read_b64_tr_b16 a[116:117], v26 offset:2048
    ds_read_b64_tr_b16 a[118:119], v26 offset:2304
    s_waitcnt lgkmcnt(0)
    v_add_u32 v25, 122880, v24
    v_xor_b32 v26, 32, v25
    s_waitcnt vmcnt(20)
    ds_read_b64_tr_b16 v[112:113], v25 offset:0
    ds_read_b64_tr_b16 v[114:115], v25 offset:256
    ds_read_b64_tr_b16 v[184:185], v26 offset:0
    ds_read_b64_tr_b16 v[186:187], v26 offset:256
    ds_read_b64_tr_b16 v[116:117], v25 offset:2048
    ds_read_b64_tr_b16 v[118:119], v25 offset:2304
    ds_read_b64_tr_b16 v[188:189], v26 offset:2048
    ds_read_b64_tr_b16 v[190:191], v26 offset:2304
    s_waitcnt lgkmcnt(0)
    v_add_u32 v25, 139264, v24
    v_xor_b32 v26, 32, v25
    s_waitcnt vmcnt(16)
    ds_read_b64_tr_b16 a[48:49], v25 offset:0
    ds_read_b64_tr_b16 a[50:51], v25 offset:256
    ds_read_b64_tr_b16 a[120:121], v26 offset:0
    ds_read_b64_tr_b16 a[122:123], v26 offset:256
    ds_read_b64_tr_b16 a[52:53], v25 offset:2048
    ds_read_b64_tr_b16 a[54:55], v25 offset:2304
    ds_read_b64_tr_b16 a[124:125], v26 offset:2048
    ds_read_b64_tr_b16 a[126:127], v26 offset:2304
    s_waitcnt lgkmcnt(0)
    v_add_u32 v25, 40960, v24
    v_xor_b32 v26, 32, v25
    s_waitcnt vmcnt(12)
    ds_read_b64_tr_b16 v[120:121], v25 offset:0
    ds_read_b64_tr_b16 v[122:123], v25 offset:256
    ds_read_b64_tr_b16 v[192:193], v26 offset:0
    ds_read_b64_tr_b16 v[194:195], v26 offset:256
    ds_read_b64_tr_b16 v[124:125], v25 offset:2048
    ds_read_b64_tr_b16 v[126:127], v25 offset:2304
    ds_read_b64_tr_b16 v[196:197], v26 offset:2048
    ds_read_b64_tr_b16 v[198:199], v26 offset:2304
    s_waitcnt lgkmcnt(0)
    v_add_u32 v25, 57344, v24
    v_xor_b32 v26, 32, v25
    s_waitcnt vmcnt(8)
    ds_read_b64_tr_b16 a[56:57], v25 offset:0
    ds_read_b64_tr_b16 a[58:59], v25 offset:256
    ds_read_b64_tr_b16 a[128:129], v26 offset:0
    ds_read_b64_tr_b16 a[130:131], v26 offset:256
    ds_read_b64_tr_b16 a[60:61], v25 offset:2048
    ds_read_b64_tr_b16 a[62:63], v25 offset:2304
    ds_read_b64_tr_b16 a[132:133], v26 offset:2048
    ds_read_b64_tr_b16 a[134:135], v26 offset:2304
    s_waitcnt lgkmcnt(0)
    v_add_u32 v25, 73728, v24
    v_xor_b32 v26, 32, v25
    s_waitcnt vmcnt(4)
    ds_read_b64_tr_b16 v[128:129], v25 offset:0
    ds_read_b64_tr_b16 v[130:131], v25 offset:256
    ds_read_b64_tr_b16 v[200:201], v26 offset:0
    ds_read_b64_tr_b16 v[202:203], v26 offset:256
    ds_read_b64_tr_b16 v[132:133], v25 offset:2048
    ds_read_b64_tr_b16 v[134:135], v25 offset:2304
    ds_read_b64_tr_b16 v[204:205], v26 offset:2048
    ds_read_b64_tr_b16 v[206:207], v26 offset:2304
    s_waitcnt lgkmcnt(0)
    v_add_u32 v25, 90112, v24
    v_xor_b32 v26, 32, v25
    s_waitcnt vmcnt(0)
    ds_read_b64_tr_b16 a[64:65], v25 offset:0
    ds_read_b64_tr_b16 a[66:67], v25 offset:256
    ds_read_b64_tr_b16 a[136:137], v26 offset:0
    ds_read_b64_tr_b16 a[138:139], v26 offset:256
    ds_read_b64_tr_b16 a[68:69], v25 offset:2048
    ds_read_b64_tr_b16 a[70:71], v25 offset:2304
    ds_read_b64_tr_b16 a[140:141], v26 offset:2048
    ds_read_b64_tr_b16 a[142:143], v26 offset:2304
    s_waitcnt lgkmcnt(0)
    s_mov_b32 s88, 4194304
gn9:
    s_cmp_lg_u32 s95, 0
    s_cbranch_scc1 gn9x
    buffer_load_dword v25, off, s[96:99], 0 offset:64 sc1
    s_sub_u32 s88, s88, 1
    s_cbranch_scc1 gn9x
    s_waitcnt vmcnt(0)
    v_readfirstlane_b32 s95, v25
    s_nop 1
    s_branch gn9
gn9x:
    s_barrier
    s_mov_b32 s27, 36864
    s_add_u32 s23, s27, s25
    s_add_u32 m0, s23, 0
    s_nop 0
    buffer_load_dwordx4 v2, s[8:11], s24 offen offset:0 lds
    s_add_u32 m0, s23, 960
    s_nop 0
    buffer_load_dwordx4 v2, s[8:11], s24 offen offset:64 lds
    s_add_u32 m0, s23, 1920
    s_nop 0
    buffer_load_dwordx4 v2, s[8:11], s24 offen offset:128 lds
    s_add_u32 m0, s23, 2880
    s_nop 0
    buffer_load_dwordx4 v2, s[8:11], s24 offen offset:192 lds
    s_add_u32 m0, s23, 3840
    s_nop 0
    buffer_load_dwordx4 v2, s[8:11], s24 offen offset:256 lds
    s_add_u32 m0, s23, 4800
    s_nop 0
    buffer_load_dwordx4 v2, s[8:11], s24 offen offset:320 lds
    s_add_u32 m0, s23, 5760
    s_nop 0
    buffer_load_dwordx4 v2, s[8:11], s24 offen offset:384 lds
    s_add_u32 m0, s23, 6720
    s_nop 0
    buffer_load_dwordx4 v2, s[8:11], s24 offen offset:448 lds
    s_add_u32 m0, s23, 7680
    s_nop 0
    buffer_load_dwordx4 v2, s[8:11], s24 offen offset:512 lds
    s_add_u32 s24, s24, s42
    s_mov_b32 s27, 0
    s_mov_b32 s30, s95
    s_cmp_eq_u32 s18, 0
    s_cselect_b32 s34, 1, 0
    s_mov_b32 s35, 0
    s_cmp_eq_u32 s16, 2
    s_cbranch_scc1 qk_vloop
qk_loop:
    s_barrier
    v_add_u32 v3, s27, v1
    ds_read_b128 v[32:35], v3 offset:0
    ds_read_b128 v[36:39], v3 offset:18432
    ds_read_b128 v[40:43], v3 offset:1024
    ds_read_b128 v[44:47], v3 offset:19456
    ds_read_b128 v[48:51], v3 offset:2048
    ds_read_b128 v[52:55], v3 offset:20480
    s_sub_u32 s22, s30, 1
    v_mov_b32 v4, s22
    s_mov_b64 exec, s[34:35]
    buffer_store_dword v4, off, s[4:7], s29 sc1
    s_mov_b64 exec, -1
    s_add_u32 s22, s27, 73728
    s_sub_u32 s21, s22, 110592
    s_cselect_b32 s22, s22, s21
    ds_read_b128 v[56:59], v3 offset:3072
    ds_read_b128 v[60:63], v3 offset:21504
    s_add_u32 s23, s22, s25
    s_add_u32 m0, s23, 0
    s_nop 0
    buffer_load_dwordx4 v2, s[8:11], s24 offen offset:0 lds
    s_waitcnt lgkmcnt(6)
    v_mfma_f32_16x16x32_bf16 v[208:211], v[64:67], v[32:35], 0
    v_mfma_f32_16x16x32_bf16 v[212:215], v[136:139], v[32:35], 0
    v_mfma_f32_16x16x32_bf16 v[216:219], v[64:67], v[36:39], 0
    v_mfma_f32_16x16x32_bf16 v[220:223], v[136:139], v[36:39], 0
    v_mfma_f32_16x16x32_bf16 v[224:227], a[0:3], v[32:35], 0
    v_mfma_f32_16x16x32_bf16 v[228:231], a[72:75], v[32:35], 0
    v_mfma_f32_16x16x32_bf16 v[232:235], a[0:3], v[36:39], 0
    v_mfma_f32_16x16x32_bf16 v[236:239], a[72:75], v[36:39], 0
    ds_read_b128 v[32:35], v3 offset:4096
    ds_read_b128 v[36:39], v3 offset:22528
    s_add_u32 m0, s23, 960
    s_nop 0
    buffer_load_dwordx4 v2, s[8:11], s24 offen offset:64 lds
    s_waitcnt lgkmcnt(6)
    v_mfma_f32_16x16x32_bf16 v[208:211], v[68:71], v[40:43], v[208:211]
    v_mfma_f32_16x16x32_bf16 v[212:215], v[140:143], v[40:43], v[212:215]
    v_mfma_f32_16x16x32_bf16 v[216:219], v[68:71], v[44:47], v[216:219]
    v_mfma_f32_16x16x32_bf16 v[220:223], v[140:143], v[44:47], v[220:223]
    v_mfma_f32_16x16x32_bf16 v[224:227], a[4:7], v[40:43], v[224:227]
    v_mfma_f32_16x16x32_bf16 v[228:231], a[76:79], v[40:43], v[228:231]
    v_mfma_f32_16x16x32_bf16 v[232:235], a[4:7], v[44:47], v[232:235]
    v_mfma_f32_16x16x32_bf16 v[236:239], a[76:79], v[44:47], v[236:239]
    ds_read_b128 v[40:43], v3 offset:5120
    ds_read_b128 v[44:47], v3 offset:23552
    s_add_u32 m0, s23, 1920
    s_nop 0
    buffer_load_dwordx4 v2, s[8:11], s24 offen offset:128 lds
    s_waitcnt lgkmcnt(6)
    v_mfma_f32_16x16x32_bf16 v[208:211], v[72:75], v[48:51], v[208:211]
    v_mfma_f32_16x16x32_bf16 v[212:215], v[144:147], v[48:51], v[212:215]
    v_mfma_f32_16x16x32_bf16 v[216:219], v[72:75], v[52:55], v[216:219]
    v_mfma_f32_16x16x32_bf16 v[220:223], v[144:147], v[52:55], v[220:223]
    v_mfma_f32_16x16x32_bf16 v[224:227], a[8:11], v[48:51], v[224:227]
    v_mfma_f32_16x16x32_bf16 v[228:231], a[80:83], v[48:51], v[228:231]
    v_mfma_f32_16x16x32_bf16 v[232:235], a[8:11], v[52:55], v[232:235]
    v_mfma_f32_16x16x32_bf16 v[236:239], a[80:83], v[52:55], v[236:239]
    ds_read_b128 v[48:51], v3 offset:6144
    ds_read_b128 v[52:55], v3 offset:24576
    s_add_u32 m0, s23, 2880
    s_nop 0
    buffer_load_dwordx4 v2, s[8:11], s24 offen offset:192 lds
    s_waitcnt lgkmcnt(6)
    v_mfma_f32_16x16x32_bf16 v[208:211], v[76:79], v[56:59], v[208:211]
    v_mfma_f32_16x16x32_bf16 v[212:215], v[148:151], v[56:59], v[212:215]
    v_mfma_f32_16x16x32_bf16 v[216:219], v[76:79], v[60:63], v[216:219]
    v_mfma_f32_16x16x32_bf16 v[220:223], v[148:151], v[60:63], v[220:223]
    v_mfma_f32_16x16x32_bf16 v[224:227], a[12:15], v[56:59], v[224:227]
    v_mfma_f32_16x16x32_bf16 v[228:231], a[84:87], v[56:59], v[228:231]
    v_mfma_f32_16x16x32_bf16 v[232:235], a[12:15], v[60:63], v[232:235]
    v_mfma_f32_16x16x32_bf16 v[236:239], a[84:87], v[60:63], v[236:239]
    ds_read_b128 v[56:59], v3 offset:7168
    ds_read_b128 v[60:63], v3 offset:25600
    s_add_u32 m0, s23, 3840
    s_nop 0
    buffer_load_dwordx4 v2, s[8:11], s24 offen offset:256 lds
    s_waitcnt lgkmcnt(6)
    v_mfma_f32_16x16x32_bf16 v[208:211], v[80:83], v[32:35], v[208:211]
    v_mfma_f32_16x16x32_bf16 v[212:215], v[152:155], v[32:35], v[212:215]
    v_mfma_f32_16x16x32_bf16 v[216:219], v[80:83], v[36:39], v[216:219]
    v_mfma_f32_16x16x32_bf16 v[220:223], v[152:155], v[36:39], v[220:223]
    v_mfma_f32_16x16x32_bf16 v[224:227], a[16:19], v[32:35], v[224:227]
    v_mfma_f32_16x16x32_bf16 v[228:231], a[88:91], v[32:35], v[228:231]
    v_mfma_f32_16x16x32_bf16 v[232:235], a[16:19], v[36:39], v[232:235]
    v_mfma_f32_16x16x32_bf16 v[236:239], a[88:91], v[36:39], v[236:239]
    ds_read_b128 v[32:35], v3 offset:8192
    ds_read_b128 v[36:39], v3 offset:26624
    s_add_u32 m0, s23, 4800
    s_nop 0
    buffer_load_dwordx4 v2, s[8:11], s24 offen offset:320 lds
    s_waitcnt lgkmcnt(6)
    v_mfma_f32_16x16x32_bf16 v[208:211], v[84:87], v[40:43], v[208:211]
    v_mfma_f32_16x16x32_bf16 v[212:215], v[156:159], v[40:43], v[212:215]
    v_mfma_f32_16x16x32_bf16 v[216:219], v[84:87], v[44:47], v[216:219]
    v_mfma_f32_16x16x32_bf16 v[220:223], v[156:159], v[44:47], v[220:223]
    v_mfma_f32_16x16x32_bf16 v[224:227], a[20:23], v[40:43], v[224:227]
    v_mfma_f32_16x16x32_bf16 v[228:231], a[92:95], v[40:43], v[228:231]
    v_mfma_f32_16x16x32_bf16 v[232:235], a[20:23], v[44:47], v[232:235]
    v_mfma_f32_16x16x32_bf16 v[236:239], a[92:95], v[44:47], v[236:239]
    ds_read_b128 v[40:43], v3 offset:9216
    ds_read_b128 v[44:47], v3 offset:27648
    s_add_u32 m0, s23, 5760
    s_nop 0
    buffer_load_dwordx4 v2, s[8:11], s24 offen offset:384 lds
    s_waitcnt lgkmcnt(6)
    v_mfma_f32_16x16x32_bf16 v[208:211], v[88:91], v[48:51], v[208:211]
    v_mfma_f32_16x16x32_bf16 v[212:215], v[160:163], v[48:51], v[212:215]
    v_mfma_f32_16x16x32_bf16 v[216:219], v[88:91], v[52:55], v[216:219]
    v_mfma_f32_16x16x32_bf16 v[220:223], v[160:163], v[52:55], v[220:223]
    v_mfma_f32_16x16x32_bf16 v[224:227], a[24:27], v[48:51], v[224:227]
    v_mfma_f32_16x16x32_bf16 v[228:231], a[96:99], v[48:51], v[228:231]
    v_mfma_f32_16x16x32_bf16 v[232:235], a[24:27], v[52:55], v[232:235]
    v_mfma_f32_16x16x32_bf16 v[236:239], a[96:99], v[52:55], v[236:239]
    ds_read_b128 v[48:51], v3 offset:10240
    ds_read_b128 v[52:55], v3 offset:28672
    s_add_u32 m0, s23, 6720
    s_nop 0
    buffer_load_dwordx4 v2, s[8:11], s24 offen offset:448 lds
    s_waitcnt lgkmcnt(6)
    v_mfma_f32_16x16x32_bf16 v[208:211], v[92:95], v[56:59], v[208:211]
    v_mfma_f32_16x16x32_bf16 v[212:215], v[164:167], v[56:59], v[212:215]
    v_mfma_f32_16x16x32_bf16 v[216:219], v[92:95], v[60:63], v[216:219]
    v_mfma_f32_16x16x32_bf16 v[220:223], v[164:167], v[60:63], v[220:223]
    v_mfma_f32_16x16x32_bf16 v[224:227], a[28:31], v[56:59], v[224:227]
    v_mfma_f32_16x16x32_bf16 v[228:231], a[100:103], v[56:59], v[228:231]
    v_mfma_f32_16x16x32_bf16 v[232:235], a[28:31], v[60:63], v[232:235]
    v_mfma_f32_16x16x32_bf16 v[236:239], a[100:103], v[60:63], v[236:239]
    ds_read_b128 v[56:59], v3 offset:11264
    ds_read_b128 v[60:63], v3 offset:29696
    s_add_u32 m0, s23, 7680
    s_nop 0
    buffer_load_dwordx4 v2, s[8:11], s24 offen offset:512 lds
    s_add_u32 s24, s24, s42
    s_waitcnt lgkmcnt(6)
    v_mfma_f32_16x16x32_bf16 v[208:211], v[96:99], v[32:35], v[208:211]
    v_mfma_f32_16x16x32_bf16 v[212:215], v[168:171], v[32:35], v[212:215]
    v_mfma_f32_16x16x32_bf16 v[216:219], v[96:99], v[36:39], v[216:219]
    v_mfma_f32_16x16x32_bf16 v[220:223], v[168:171], v[36:39], v[220:223]
    v_mfma_f32_16x16x32_bf16 v[224:227], a[32:35], v[32:35], v[224:227]
    v_mfma_f32_16x16x32_bf16 v[228:231], a[104:107], v[32:35], v[228:231]
    v_mfma_f32_16x16x32_bf16 v[232:235], a[32:35], v[36:39], v[232:235]
    v_mfma_f32_16x16x32_bf16 v[236:239], a[104:107], v[36:39], v[236:239]
    ds_read_b128 v[32:35], v3 offset:12288
    ds_read_b128 v[36:39], v3 offset:30720
    s_waitcnt lgkmcnt(6)
    v_mfma_f32_16x16x32_bf16 v[208:211], v[100:103], v[40:43], v[208:211]
    v_mfma_f32_16x16x32_bf16 v[212:215], v[172:175], v[40:43], v[212:215]
    v_mfma_f32_16x16x32_bf16 v[216:219], v[100:103], v[44:47], v[216:219]
    v_mfma_f32_16x16x32_bf16 v[220:223], v[172:175], v[44:47], v[220:223]
    v_mfma_f32_16x16x32_bf16 v[224:227], a[36:39], v[40:43], v[224:227]
    v_mfma_f32_16x16x32_bf16 v[228:231], a[108:111], v[40:43], v[228:231]
    v_mfma_f32_16x16x32_bf16 v[232:235], a[36:39], v[44:47], v[232:235]
    v_mfma_f32_16x16x32_bf16 v[236:239], a[108:111], v[44:47], v[236:239]
    ds_read_b128 v[40:43], v3 offset:13312
    ds_read_b128 v[44:47], v3 offset:31744
    s_waitcnt lgkmcnt(6)
    v_mfma_f32_16x16x32_bf16 v[208:211], v[104:107], v[48:51], v[208:211]
    v_mfma_f32_16x16x32_bf16 v[212:215], v[176:179], v[48:51], v[212:215]
    v_mfma_f32_16x16x32_bf16 v[216:219], v[104:107], v[52:55], v[216:219]
    v_mfma_f32_16x16x32_bf16 v[220:223], v[176:179], v[52:55], v[220:223]
    v_mfma_f32_16x16x32_bf16 v[224:227], a[40:43], v[48:51], v[224:227]
    v_mfma_f32_16x16x32_bf16 v[228:231], a[112:115], v[48:51], v[228:231]
    v_mfma_f32_16x16x32_bf16 v[232:235], a[40:43], v[52:55], v[232:235]
    v_mfma_f32_16x16x32_bf16 v[236:239], a[112:115], v[52:55], v[236:239]
    ds_read_b128 v[48:51], v3 offset:14336
    ds_read_b128 v[52:55], v3 offset:32768
    s_waitcnt lgkmcnt(6)
    v_mfma_f32_16x16x32_bf16 v[208:211], v[108:111], v[56:59], v[208:211]
    v_mfma_f32_16x16x32_bf16 v[212:215], v[180:183], v[56:59], v[212:215]
    v_mfma_f32_16x16x32_bf16 v[216:219], v[108:111], v[60:63], v[216:219]
    v_mfma_f32_16x16x32_bf16 v[220:223], v[180:183], v[60:63], v[220:223]
    v_mfma_f32_16x16x32_bf16 v[224:227], a[44:47], v[56:59], v[224:227]
    v_mfma_f32_16x16x32_bf16 v[228:231], a[116:119], v[56:59], v[228:231]
    v_mfma_f32_16x16x32_bf16 v[232:235], a[44:47], v[60:63], v[232:235]
    v_mfma_f32_16x16x32_bf16 v[236:239], a[116:119], v[60:63], v[236:239]
    ds_read_b128 v[56:59], v3 offset:15360
    ds_read_b128 v[60:63], v3 offset:33792
    s_waitcnt lgkmcnt(6)
    v_mfma_f32_16x16x32_bf16 v[208:211], v[112:115], v[32:35], v[208:211]
    v_mfma_f32_16x16x32_bf16 v[212:215], v[184:187], v[32:35], v[212:215]
    v_mfma_f32_16x16x32_bf16 v[216:219], v[112:115], v[36:39], v[216:219]
    v_mfma_f32_16x16x32_bf16 v[220:223], v[184:187], v[36:39], v[220:223]
    v_mfma_f32_16x16x32_bf16 v[224:227], a[48:51], v[32:35], v[224:227]
    v_mfma_f32_16x16x32_bf16 v[228:231], a[120:123], v[32:35], v[228:231]
    v_mfma_f32_16x16x32_bf16 v[232:235], a[48:51], v[36:39], v[232:235]
    v_mfma_f32_16x16x32_bf16 v[236:239], a[120:123], v[36:39], v[236:239]
    ds_read_b128 v[32:35], v3 offset:16384
    ds_read_b128 v[36:39], v3 offset:34816
    s_waitcnt lgkmcnt(6)
    v_mfma_f32_16x16x32_bf16 v[208:211], v[116:119], v[40:43], v[208:211]
    v_mfma_f32_16x16x32_bf16 v[212:215], v[188:191], v[40:43], v[212:215]
    v_mfma_f32_16x16x32_bf16 v[216:219], v[116:119], v[44:47], v[216:219]
    v_mfma_f32_16x16x32_bf16 v[220:223], v[188:191], v[44:47], v[220:223]
    v_mfma_f32_16x16x32_bf16 v[224:227], a[52:55], v[40:43], v[224:227]
    v_mfma_f32_16x16x32_bf16 v[228:231], a[124:127], v[40:43], v[228:231]
    v_mfma_f32_16x16x32_bf16 v[232:235], a[52:55], v[44:47], v[232:235]
    v_mfma_f32_16x16x32_bf16 v[236:239], a[124:127], v[44:47], v[236:239]
    ds_read_b128 v[40:43], v3 offset:17408
    ds_read_b128 v[44:47], v3 offset:35840
    s_waitcnt lgkmcnt(6)
    v_mfma_f32_16x16x32_bf16 v[208:211], v[120:123], v[48:51], v[208:211]
    v_mfma_f32_16x16x32_bf16 v[212:215], v[192:195], v[48:51], v[212:215]
    v_mfma_f32_16x16x32_bf16 v[216:219], v[120:123], v[52:55], v[216:219]
    v_mfma_f32_16x16x32_bf16 v[220:223], v[192:195], v[52:55], v[220:223]
    v_mfma_f32_16x16x32_bf16 v[224:227], a[56:59], v[48:51], v[224:227]
    v_mfma_f32_16x16x32_bf16 v[228:231], a[128:131], v[48:51], v[228:231]
    v_mfma_f32_16x16x32_bf16 v[232:235], a[56:59], v[52:55], v[232:235]
    v_mfma_f32_16x16x32_bf16 v[236:239], a[128:131], v[52:55], v[236:239]
    s_waitcnt lgkmcnt(4)
    v_mfma_f32_16x16x32_bf16 v[208:211], v[124:127], v[56:59], v[208:211]
    v_mfma_f32_16x16x32_bf16 v[212:215], v[196:199], v[56:59], v[212:215]
    v_mfma_f32_16x16x32_bf16 v[216:219], v[124:127], v[60:63], v[216:219]
    v_mfma_f32_16x16x32_bf16 v[220:223], v[196:199], v[60:63], v[220:223]
    v_mfma_f32_16x16x32_bf16 v[224:227], a[60:63], v[56:59], v[224:227]
    v_mfma_f32_16x16x32_bf16 v[228:231], a[132:135], v[56:59], v[228:231]
    v_mfma_f32_16x16x32_bf16 v[232:235], a[60:63], v[60:63], v[232:235]
    v_mfma_f32_16x16x32_bf16 v[236:239], a[132:135], v[60:63], v[236:239]
    s_waitcnt lgkmcnt(2)
    v_mfma_f32_16x16x32_bf16 v[208:211], v[128:131], v[32:35], v[208:211]
    v_mfma_f32_16x16x32_bf16 v[212:215], v[200:203], v[32:35], v[212:215]
    v_mfma_f32_16x16x32_bf16 v[216:219], v[128:131], v[36:39], v[216:219]
    v_mfma_f32_16x16x32_bf16 v[220:223], v[200:203], v[36:39], v[220:223]
    v_mfma_f32_16x16x32_bf16 v[224:227], a[64:67], v[32:35], v[224:227]
    v_mfma_f32_16x16x32_bf16 v[228:231], a[136:139], v[32:35], v[228:231]
    v_mfma_f32_16x16x32_bf16 v[232:235], a[64:67], v[36:39], v[232:235]
    v_mfma_f32_16x16x32_bf16 v[236:239], a[136:139], v[36:39], v[236:239]
    s_waitcnt lgkmcnt(0)
    v_mfma_f32_16x16x32_bf16 v[208:211], v[132:135], v[40:43], v[208:211]
    v_mfma_f32_16x16x32_bf16 v[212:215], v[204:207], v[40:43], v[212:215]
    v_mfma_f32_16x16x32_bf16 v[216:219], v[132:135], v[44:47], v[216:219]
    v_mfma_f32_16x16x32_bf16 v[220:223], v[204:207], v[44:47], v[220:223]
    v_mfma_f32_16x16x32_bf16 v[224:227], a[68:71], v[40:43], v[224:227]
    v_mfma_f32_16x16x32_bf16 v[228:231], a[140:143], v[40:43], v[228:231]
    v_mfma_f32_16x16x32_bf16 v[232:235], a[68:71], v[44:47], v[232:235]
    v_mfma_f32_16x16x32_bf16 v[236:239], a[140:143], v[44:47], v[236:239]
    s_waitcnt vmcnt(9)
    v_cvt_pk_bf16_f32 v8, v208, v209
    v_cvt_pk_bf16_f32 v9, v210, v211
    v_cvt_pk_bf16_f32 v10, v212, v213
    v_cvt_pk_bf16_f32 v11, v214, v215
    s_mov_b32 s28, s26
    buffer_store_dwordx4 v[8:11], v7, s[4:7], s28 offen sc1
    v_cvt_pk_bf16_f32 v12, v216, v217
    v_cvt_pk_bf16_f32 v13, v218, v219
    v_cvt_pk_bf16_f32 v14, v220, v221
    v_cvt_pk_bf16_f32 v15, v222, v223
    s_add_u32 s28, s28, s40
    buffer_store_dwordx4 v[12:15], v7, s[4:7], s28 offen sc1
    v_cvt_pk_bf16_f32 v16, v224, v225
    v_cvt_pk_bf16_f32 v17, v226, v227
    v_cvt_pk_bf16_f32 v18, v228, v229
    v_cvt_pk_bf16_f32 v19, v230, v231
    s_add_u32 s28, s26, s43
    buffer_store_dwordx4 v[16:19], v7, s[4:7], s28 offen sc1
    v_cvt_pk_bf16_f32 v20, v232, v233
    v_cvt_pk_bf16_f32 v21, v234, v235
    v_cvt_pk_bf16_f32 v22, v236, v237
    v_cvt_pk_bf16_f32 v23, v238, v239
    s_add_u32 s28, s28, s40
    buffer_store_dwordx4 v[20:23], v7, s[4:7], s28 offen sc1
    s_add_u32 s26, s26, s41
    s_add_u32 s27, s27, 36864
    s_cmp_eq_u32 s27, 110592
    s_cselect_b32 s27, 0, s27
    s_add_u32 s30, s30, 1
    s_add_u32 s19, s19, s20
    s_cmp_lt_u32 s19, 64
    s_cbranch_scc1 qk_loop
    s_branch qk_done
qk_vloop:
    s_barrier
    v_add_u32 v3, s27, v1
    ds_read_b128 v[32:35], v3 offset:0
    ds_read_b128 v[36:39], v3 offset:18432
    ds_read_b128 v[40:43], v3 offset:1024
    ds_read_b128 v[44:47], v3 offset:19456
    ds_read_b128 v[48:51], v3 offset:2048
    ds_read_b128 v[52:55], v3 offset:20480
    s_sub_u32 s22, s30, 1
    v_mov_b32 v4, s22
    s_mov_b64 exec, s[34:35]
    buffer_store_dword v4, off, s[4:7], s29 sc1
    s_mov_b64 exec, -1
    s_add_u32 s22, s27, 73728
    s_sub_u32 s21, s22, 110592
    s_cselect_b32 s22, s22, s21
    ds_read_b128 v[56:59], v3 offset:3072
    ds_read_b128 v[60:63], v3 offset:21504
    s_add_u32 s23, s22, s25
    s_add_u32 m0, s23, 0
    s_nop 0
    buffer_load_dwordx4 v2, s[8:11], s24 offen offset:0 lds
    s_waitcnt lgkmcnt(6)
    v_mfma_f32_16x16x32_bf16 v[208:211], v[32:35], v[64:67], 0
    v_mfma_f32_16x16x32_bf16 v[212:215], v[32:35], v[136:139], 0
    v_mfma_f32_16x16x32_bf16 v[216:219], v[36:39], v[64:67], 0
    v_mfma_f32_16x16x32_bf16 v[220:223], v[36:39], v[136:139], 0
    v_mfma_f32_16x16x32_bf16 v[224:227], v[32:35], a[0:3], 0
    v_mfma_f32_16x16x32_bf16 v[228:231], v[32:35], a[72:75], 0
    v_mfma_f32_16x16x32_bf16 v[232:235], v[36:39], a[0:3], 0
    v_mfma_f32_16x16x32_bf16 v[236:239], v[36:39], a[72:75], 0
    ds_read_b128 v[32:35], v3 offset:4096
    ds_read_b128 v[36:39], v3 offset:22528
    s_add_u32 m0, s23, 960
    s_nop 0
    buffer_load_dwordx4 v2, s[8:11], s24 offen offset:64 lds
    s_waitcnt lgkmcnt(6)
    v_mfma_f32_16x16x32_bf16 v[208:211], v[40:43], v[68:71], v[208:211]
    v_mfma_f32_16x16x32_bf16 v[212:215], v[40:43], v[140:143], v[212:215]
    v_mfma_f32_16x16x32_bf16 v[216:219], v[44:47], v[68:71], v[216:219]
    v_mfma_f32_16x16x32_bf16 v[220:223], v[44:47], v[140:143], v[220:223]
    v_mfma_f32_16x16x32_bf16 v[224:227], v[40:43], a[4:7], v[224:227]
    v_mfma_f32_16x16x32_bf16 v[228:231], v[40:43], a[76:79], v[228:231]
    v_mfma_f32_16x16x32_bf16 v[232:235], v[44:47], a[4:7], v[232:235]
    v_mfma_f32_16x16x32_bf16 v[236:239], v[44:47], a[76:79], v[236:239]
    ds_read_b128 v[40:43], v3 offset:5120
    ds_read_b128 v[44:47], v3 offset:23552
    s_add_u32 m0, s23, 1920
    s_nop 0
    buffer_load_dwordx4 v2, s[8:11], s24 offen offset:128 lds
    s_waitcnt lgkmcnt(6)
    v_mfma_f32_16x16x32_bf16 v[208:211], v[48:51], v[72:75], v[208:211]
    v_mfma_f32_16x16x32_bf16 v[212:215], v[48:51], v[144:147], v[212:215]
    v_mfma_f32_16x16x32_bf16 v[216:219], v[52:55], v[72:75], v[216:219]
    v_mfma_f32_16x16x32_bf16 v[220:223], v[52:55], v[144:147], v[220:223]
    v_mfma_f32_16x16x32_bf16 v[224:227], v[48:51], a[8:11], v[224:227]
    v_mfma_f32_16x16x32_bf16 v[228:231], v[48:51], a[80:83], v[228:231]
    v_mfma_f32_16x16x32_bf16 v[232:235], v[52:55], a[8:11], v[232:235]
    v_mfma_f32_16x16x32_bf16 v[236:239], v[52:55], a[80:83], v[236:239]
    ds_read_b128 v[48:51], v3 offset:6144
    ds_read_b128 v[52:55], v3 offset:24576
    s_add_u32 m0, s23, 2880
    s_nop 0
    buffer_load_dwordx4 v2, s[8:11], s24 offen offset:192 lds
    s_waitcnt lgkmcnt(6)
    v_mfma_f32_16x16x32_bf16 v[208:211], v[56:59], v[76:79], v[208:211]
    v_mfma_f32_16x16x32_bf16 v[212:215], v[56:59], v[148:151], v[212:215]
    v_mfma_f32_16x16x32_bf16 v[216:219], v[60:63], v[76:79], v[216:219]
    v_mfma_f32_16x16x32_bf16 v[220:223], v[60:63], v[148:151], v[220:223]
    v_mfma_f32_16x16x32_bf16 v[224:227], v[56:59], a[12:15], v[224:227]
    v_mfma_f32_16x16x32_bf16 v[228:231], v[56:59], a[84:87], v[228:231]
    v_mfma_f32_16x16x32_bf16 v[232:235], v[60:63], a[12:15], v[232:235]
    v_mfma_f32_16x16x32_bf16 v[236:239], v[60:63], a[84:87], v[236:239]
    ds_read_b128 v[56:59], v3 offset:7168
    ds_read_b128 v[60:63], v3 offset:25600
    s_add_u32 m0, s23, 3840
    s_nop 0
    buffer_load_dwordx4 v2, s[8:11], s24 offen offset:256 lds
    s_waitcnt lgkmcnt(6)
    v_mfma_f32_16x16x32_bf16 v[208:211], v[32:35], v[80:83], v[208:211]
    v_mfma_f32_16x16x32_bf16 v[212:215], v[32:35], v[152:155], v[212:215]
    v_mfma_f32_16x16x32_bf16 v[216:219], v[36:39], v[80:83], v[216:219]
    v_mfma_f32_16x16x32_bf16 v[220:223], v[36:39], v[152:155], v[220:223]
    v_mfma_f32_16x16x32_bf16 v[224:227], v[32:35], a[16:19], v[224:227]
    v_mfma_f32_16x16x32_bf16 v[228:231], v[32:35], a[88:91], v[228:231]
    v_mfma_f32_16x16x32_bf16 v[232:235], v[36:39], a[16:19], v[232:235]
    v_mfma_f32_16x16x32_bf16 v[236:239], v[36:39], a[88:91], v[236:239]
    ds_read_b128 v[32:35], v3 offset:8192
    ds_read_b128 v[36:39], v3 offset:26624
    s_add_u32 m0, s23, 4800
    s_nop 0
    buffer_load_dwordx4 v2, s[8:11], s24 offen offset:320 lds
    s_waitcnt lgkmcnt(6)
    v_mfma_f32_16x16x32_bf16 v[208:211], v[40:43], v[84:87], v[208:211]
    v_mfma_f32_16x16x32_bf16 v[212:215], v[40:43], v[156:159], v[212:215]
    v_mfma_f32_16x16x32_bf16 v[216:219], v[44:47], v[84:87], v[216:219]
    v_mfma_f32_16x16x32_bf16 v[220:223], v[44:47], v[156:159], v[220:223]
    v_mfma_f32_16x16x32_bf16 v[224:227], v[40:43], a[20:23], v[224:227]
    v_mfma_f32_16x16x32_bf16 v[228:231], v[40:43], a[92:95], v[228:231]
    v_mfma_f32_16x16x32_bf16 v[232:235], v[44:47], a[20:23], v[232:235]
    v_mfma_f32_16x16x32_bf16 v[236:239], v[44:47], a[92:95], v[236:239]
    ds_read_b128 v[40:43], v3 offset:9216
    ds_read_b128 v[44:47], v3 offset:27648
    s_add_u32 m0, s23, 5760
    s_nop 0
    buffer_load_dwordx4 v2, s[8:11], s24 offen offset:384 lds
    s_waitcnt lgkmcnt(6)
    v_mfma_f32_16x16x32_bf16 v[208:211], v[48:51], v[88:91], v[208:211]
    v_mfma_f32_16x16x32_bf16 v[212:215], v[48:51], v[160:163], v[212:215]
    v_mfma_f32_16x16x32_bf16 v[216:219], v[52:55], v[88:91], v[216:219]
    v_mfma_f32_16x16x32_bf16 v[220:223], v[52:55], v[160:163], v[220:223]
    v_mfma_f32_16x16x32_bf16 v[224:227], v[48:51], a[24:27], v[224:227]
    v_mfma_f32_16x16x32_bf16 v[228:231], v[48:51], a[96:99], v[228:231]
    v_mfma_f32_16x16x32_bf16 v[232:235], v[52:55], a[24:27], v[232:235]
    v_mfma_f32_16x16x32_bf16 v[236:239], v[52:55], a[96:99], v[236:239]
    ds_read_b128 v[48:51], v3 offset:10240
    ds_read_b128 v[52:55], v3 offset:28672
    s_add_u32 m0, s23, 6720
    s_nop 0
    buffer_load_dwordx4 v2, s[8:11], s24 offen offset:448 lds
    s_waitcnt lgkmcnt(6)
    v_mfma_f32_16x16x32_bf16 v[208:211], v[56:59], v[92:95], v[208:211]
    v_mfma_f32_16x16x32_bf16 v[212:215], v[56:59], v[164:167], v[212:215]
    v_mfma_f32_16x16x32_bf16 v[216:219], v[60:63], v[92:95], v[216:219]
    v_mfma_f32_16x16x32_bf16 v[220:223], v[60:63], v[164:167], v[220:223]
    v_mfma_f32_16x16x32_bf16 v[224:227], v[56:59], a[28:31], v[224:227]
    v_mfma_f32_16x16x32_bf16 v[228:231], v[56:59], a[100:103], v[228:231]
    v_mfma_f32_16x16x32_bf16 v[232:235], v[60:63], a[28:31], v[232:235]
    v_mfma_f32_16x16x32_bf16 v[236:239], v[60:63], a[100:103], v[236:239]
    ds_read_b128 v[56:59], v3 offset:11264
    ds_read_b128 v[60:63], v3 offset:29696
    s_add_u32 m0, s23, 7680
    s_nop 0
    buffer_load_dwordx4 v2, s[8:11], s24 offen offset:512 lds
    s_add_u32 s24, s24, s42
    s_waitcnt lgkmcnt(6)
    v_mfma_f32_16x16x32_bf16 v[208:211], v[32:35], v[96:99], v[208:211]
    v_mfma_f32_16x16x32_bf16 v[212:215], v[32:35], v[168:171], v[212:215]
    v_mfma_f32_16x16x32_bf16 v[216:219], v[36:39], v[96:99], v[216:219]
    v_mfma_f32_16x16x32_bf16 v[220:223], v[36:39], v[168:171], v[220:223]
    v_mfma_f32_16x16x32_bf16 v[224:227], v[32:35], a[32:35], v[224:227]
    v_mfma_f32_16x16x32_bf16 v[228:231], v[32:35], a[104:107], v[228:231]
    v_mfma_f32_16x16x32_bf16 v[232:235], v[36:39], a[32:35], v[232:235]
    v_mfma_f32_16x16x32_bf16 v[236:239], v[36:39], a[104:107], v[236:239]
    ds_read_b128 v[32:35], v3 offset:12288
    ds_read_b128 v[36:39], v3 offset:30720
    s_waitcnt lgkmcnt(6)
    v_mfma_f32_16x16x32_bf16 v[208:211], v[40:43], v[100:103], v[208:211]
    v_mfma_f32_16x16x32_bf16 v[212:215], v[40:43], v[172:175], v[212:215]
    v_mfma_f32_16x16x32_bf16 v[216:219], v[44:47], v[100:103], v[216:219]
    v_mfma_f32_16x16x32_bf16 v[220:223], v[44:47], v[172:175], v[220:223]
    v_mfma_f32_16x16x32_bf16 v[224:227], v[40:43], a[36:39], v[224:227]
    v_mfma_f32_16x16x32_bf16 v[228:231], v[40:43], a[108:111], v[228:231]
    v_mfma_f32_16x16x32_bf16 v[232:235], v[44:47], a[36:39], v[232:235]
    v_mfma_f32_16x16x32_bf16 v[236:239], v[44:47], a[108:111], v[236:239]
    ds_read_b128 v[40:43], v3 offset:13312
    ds_read_b128 v[44:47], v3 offset:31744
    s_waitcnt lgkmcnt(6)
    v_mfma_f32_16x16x32_bf16 v[208:211], v[48:51], v[104:107], v[208:211]
    v_mfma_f32_16x16x32_bf16 v[212:215], v[48:51], v[176:179], v[212:215]
    v_mfma_f32_16x16x32_bf16 v[216:219], v[52:55], v[104:107], v[216:219]
    v_mfma_f32_16x16x32_bf16 v[220:223], v[52:55], v[176:179], v[220:223]
    v_mfma_f32_16x16x32_bf16 v[224:227], v[48:51], a[40:43], v[224:227]
    v_mfma_f32_16x16x32_bf16 v[228:231], v[48:51], a[112:115], v[228:231]
    v_mfma_f32_16x16x32_bf16 v[232:235], v[52:55], a[40:43], v[232:235]
    v_mfma_f32_16x16x32_bf16 v[236:239], v[52:55], a[112:115], v[236:239]
    ds_read_b128 v[48:51], v3 offset:14336
    ds_read_b128 v[52:55], v3 offset:32768
    s_waitcnt lgkmcnt(6)
    v_mfma_f32_16x16x32_bf16 v[208:211], v[56:59], v[108:111], v[208:211]
    v_mfma_f32_16x16x32_bf16 v[212:215], v[56:59], v[180:183], v[212:215]
    v_mfma_f32_16x16x32_bf16 v[216:219], v[60:63], v[108:111], v[216:219]
    v_mfma_f32_16x16x32_bf16 v[220:223], v[60:63], v[180:183], v[220:223]
    v_mfma_f32_16x16x32_bf16 v[224:227], v[56:59], a[44:47], v[224:227]
    v_mfma_f32_16x16x32_bf16 v[228:231], v[56:59], a[116:119], v[228:231]
    v_mfma_f32_16x16x32_bf16 v[232:235], v[60:63], a[44:47], v[232:235]
    v_mfma_f32_16x16x32_bf16 v[236:239], v[60:63], a[116:119], v[236:239]
    ds_read_b128 v[56:59], v3 offset:15360
    ds_read_b128 v[60:63], v3 offset:33792
    s_waitcnt lgkmcnt(6)
    v_mfma_f32_16x16x32_bf16 v[208:211], v[32:35], v[112:115], v[208:211]
    v_mfma_f32_16x16x32_bf16 v[212:215], v[32:35], v[184:187], v[212:215]
    v_mfma_f32_16x16x32_bf16 v[216:219], v[36:39], v[112:115], v[216:219]
    v_mfma_f32_16x16x32_bf16 v[220:223], v[36:39], v[184:187], v[220:223]
    v_mfma_f32_16x16x32_bf16 v[224:227], v[32:35], a[48:51], v[224:227]
    v_mfma_f32_16x16x32_bf16 v[228:231], v[32:35], a[120:123], v[228:231]
    v_mfma_f32_16x16x32_bf16 v[232:235], v[36:39], a[48:51], v[232:235]
    v_mfma_f32_16x16x32_bf16 v[236:239], v[36:39], a[120:123], v[236:239]
    ds_read_b128 v[32:35], v3 offset:16384
    ds_read_b128 v[36:39], v3 offset:34816
    s_waitcnt lgkmcnt(6)
    v_mfma_f32_16x16x32_bf16 v[208:211], v[40:43], v[116:119], v[208:211]
    v_mfma_f32_16x16x32_bf16 v[212:215], v[40:43], v[188:191], v[212:215]
    v_mfma_f32_16x16x32_bf16 v[216:219], v[44:47], v[116:119], v[216:219]
    v_mfma_f32_16x16x32_bf16 v[220:223], v[44:47], v[188:191], v[220:223]
    v_mfma_f32_16x16x32_bf16 v[224:227], v[40:43], a[52:55], v[224:227]
    v_mfma_f32_16x16x32_bf16 v[228:231], v[40:43], a[124:127], v[228:231]
    v_mfma_f32_16x16x32_bf16 v[232:235], v[44:47], a[52:55], v[232:235]
    v_mfma_f32_16x16x32_bf16 v[236:239], v[44:47], a[124:127], v[236:239]
    ds_read_b128 v[40:43], v3 offset:17408
    ds_read_b128 v[44:47], v3 offset:35840
    s_waitcnt lgkmcnt(6)
    v_mfma_f32_16x16x32_bf16 v[208:211], v[48:51], v[120:123], v[208:211]
    v_mfma_f32_16x16x32_bf16 v[212:215], v[48:51], v[192:195], v[212:215]
    v_mfma_f32_16x16x32_bf16 v[216:219], v[52:55], v[120:123], v[216:219]
    v_mfma_f32_16x16x32_bf16 v[220:223], v[52:55], v[192:195], v[220:223]
    v_mfma_f32_16x16x32_bf16 v[224:227], v[48:51], a[56:59], v[224:227]
    v_mfma_f32_16x16x32_bf16 v[228:231], v[48:51], a[128:131], v[228:231]
    v_mfma_f32_16x16x32_bf16 v[232:235], v[52:55], a[56:59], v[232:235]
    v_mfma_f32_16x16x32_bf16 v[236:239], v[52:55], a[128:131], v[236:239]
    s_waitcnt lgkmcnt(4)
    v_mfma_f32_16x16x32_bf16 v[208:211], v[56:59], v[124:127], v[208:211]
    v_mfma_f32_16x16x32_bf16 v[212:215], v[56:59], v[196:199], v[212:215]
    v_mfma_f32_16x16x32_bf16 v[216:219], v[60:63], v[124:127], v[216:219]
    v_mfma_f32_16x16x32_bf16 v[220:223], v[60:63], v[196:199], v[220:223]
    v_mfma_f32_16x16x32_bf16 v[224:227], v[56:59], a[60:63], v[224:227]
    v_mfma_f32_16x16x32_bf16 v[228:231], v[56:59], a[132:135], v[228:231]
    v_mfma_f32_16x16x32_bf16 v[232:235], v[60:63], a[60:63], v[232:235]
    v_mfma_f32_16x16x32_bf16 v[236:239], v[60:63], a[132:135], v[236:239]
    s_waitcnt lgkmcnt(2)
    v_mfma_f32_16x16x32_bf16 v[208:211], v[32:35], v[128:131], v[208:211]
    v_mfma_f32_16x16x32_bf16 v[212:215], v[32:35], v[200:203], v[212:215]
    v_mfma_f32_16x16x32_bf16 v[216:219], v[36:39], v[128:131], v[216:219]
    v_mfma_f32_16x16x32_bf16 v[220:223], v[36:39], v[200:203], v[220:223]
    v_mfma_f32_16x16x32_bf16 v[224:227], v[32:35], a[64:67], v[224:227]
    v_mfma_f32_16x16x32_bf16 v[228:231], v[32:35], a[136:139], v[228:231]
    v_mfma_f32_16x16x32_bf16 v[232:235], v[36:39], a[64:67], v[232:235]
    v_mfma_f32_16x16x32_bf16 v[236:239], v[36:39], a[136:139], v[236:239]
    s_waitcnt lgkmcnt(0)
    v_mfma_f32_16x16x32_bf16 v[208:211], v[40:43], v[132:135], v[208:211]
    v_mfma_f32_16x16x32_bf16 v[212:215], v[40:43], v[204:207], v[212:215]
    v_mfma_f32_16x16x32_bf16 v[216:219], v[44:47], v[132:135], v[216:219]
    v_mfma_f32_16x16x32_bf16 v[220:223], v[44:47], v[204:207], v[220:223]
    v_mfma_f32_16x16x32_bf16 v[224:227], v[40:43], a[68:71], v[224:227]
    v_mfma_f32_16x16x32_bf16 v[228:231], v[40:43], a[140:143], v[228:231]
    v_mfma_f32_16x16x32_bf16 v[232:235], v[44:47], a[68:71], v[232:235]
    v_mfma_f32_16x16x32_bf16 v[236:239], v[44:47], a[140:143], v[236:239]
    s_waitcnt vmcnt(9)
    v_cvt_pk_bf16_f32 v8, v208, v209
    v_cvt_pk_bf16_f32 v9, v210, v211
    v_cvt_pk_bf16_f32 v10, v216, v217
    v_cvt_pk_bf16_f32 v11, v218, v219
    s_mov_b32 s28, s26
    buffer_store_dwordx4 v[8:11], v7, s[4:7], s28 offen sc1
    v_cvt_pk_bf16_f32 v12, v212, v213
    v_cvt_pk_bf16_f32 v13, v214, v215
    v_cvt_pk_bf16_f32 v14, v220, v221
    v_cvt_pk_bf16_f32 v15, v222, v223
    s_add_u32 s28, s28, s40
    buffer_store_dwordx4 v[12:15], v7, s[4:7], s28 offen sc1
    v_cvt_pk_bf16_f32 v16, v224, v225
    v_cvt_pk_bf16_f32 v17, v226, v227
    v_cvt_pk_bf16_f32 v18, v232, v233
    v_cvt_pk_bf16_f32 v19, v234, v235
    s_add_u32 s28, s26, s43
    buffer_store_dwordx4 v[16:19], v7, s[4:7], s28 offen sc1
    v_cvt_pk_bf16_f32 v20, v228, v229
    v_cvt_pk_bf16_f32 v21, v230, v231
    v_cvt_pk_bf16_f32 v22, v236, v237
    v_cvt_pk_bf16_f32 v23, v238, v239
    s_add_u32 s28, s28, s40
    buffer_store_dwordx4 v[20:23], v7, s[4:7], s28 offen sc1
    s_add_u32 s26, s26, s41
    s_add_u32 s27, s27, 36864
    s_cmp_eq_u32 s27, 110592
    s_cselect_b32 s27, 0, s27
    s_add_u32 s30, s30, 1
    s_add_u32 s19, s19, s20
    s_cmp_lt_u32 s19, 64
    s_cbranch_scc1 qk_vloop
qk_done:
    s_waitcnt vmcnt(0)
    s_barrier
    s_add_u32 s22, s95, 63
    v_mov_b32 v4, s22
    s_mov_b64 exec, s[34:35]
    buffer_store_dword v4, off, s[4:7], s29 sc1
    s_mov_b64 exec, -1
    s_cmp_ge_u32 s36, 64
    s_cbranch_scc1 L_qkv_next
    s_lshr_b32 s33, s36, 5
    v_and_b32 v4, 63, v0
    v_lshrrev_b32 v5, 4, v4
    v_add_u32 v1, 0, v5
    v_mul_u32_u24 v6, 11, v1
    v_lshrrev_b32 v6, 5, v6
    v_add_u32 v1, v1, v6
    v_lshlrev_b32 v1, 7, v1
    v_and_b32 v6, 7, v4
    v_lshl_add_u32 v1, v6, 4, v1
    v_add_u32 v2, 4, v5
    v_mul_u32_u24 v6, 11, v2
    v_lshrrev_b32 v6, 5, v6
    v_add_u32 v2, v2, v6
    v_lshlrev_b32 v2, 7, v2
    v_and_b32 v6, 7, v4
    v_lshl_add_u32 v2, v6, 4, v2
    v_add_u32 v3, 8, v5
    v_mul_u32_u24 v6, 11, v3
    v_lshrrev_b32 v6, 5, v6
    v_add_u32 v3, v3, v6
    v_lshlrev_b32 v3, 7, v3
    v_and_b32 v6, 7, v4
    v_lshl_add_u32 v3, v6, 4, v3
    v_min_u32 v6, 23, v4
    v_lshlrev_b32 v6, 9, v6
    s_mov_b32 s19, s33
    s_mul_i32 s24, s19, 12288
    s_add_u32 s24, s24, 90177536
    s_lshl_b32 s26, s19, 5
    s_add_u32 s26, s26, s17
    s_lshl_b32 s26, s26, 12
    s_mov_b32 s21, 71303168
    s_cmp_eq_u32 s16, 2
    s_cselect_b32 s21, 80740352, s21
    s_add_u32 s26, s26, s21
    s_lshl_b32 s29, s17, 7
    s_lshl_b32 s21, s16, 1
    s_add_u32 s21, s21, s33
    s_lshl_b32 s21, s21, 2
    s_add_u32 s29, s29, s21
    s_add_u32 s29, s29, 125829240
mk_loop:
    s_cmp_lg_u32 s18, 0
    s_cbranch_scc1 mk_go
    s_add_u32 s23, s24, 12288
    s_mov_b32 s21, 4194304
mk_wait:
    buffer_load_dword v4, v6, s[4:7], s23 offen offset:384 sc1
    s_sub_u32 s21, s21, 1
    s_cbranch_scc1 mk_go
    s_waitcnt vmcnt(0)
    v_cmp_ne_u32 vcc, s95, v4
    s_cbranch_vccz mk_go
    s_sleep 4
    s_branch mk_wait
mk_go:
    s_barrier
    s_add_u32 s23, s24, 0
    buffer_load_dwordx4 v[24:27], v1, s[4:7], s23 offen offset:0 sc1
    buffer_load_dwordx4 v[28:31], v2, s[4:7], s23 offen offset:0 sc1
    buffer_load_dwordx4 v[32:35], v3, s[4:7], s23 offen offset:0 sc1
    buffer_load_dwordx4 v[36:39], v1, s[4:7], s23 offen offset:2048 sc1
    buffer_load_dwordx4 v[40:43], v2, s[4:7], s23 offen offset:2048 sc1
    buffer_load_dwordx4 v[44:47], v3, s[4:7], s23 offen offset:2048 sc1
    s_add_u32 s23, s24, 4096
    buffer_load_dwordx4 v[48:51], v1, s[4:7], s23 offen offset:0 sc1
    buffer_load_dwordx4 v[52:55], v2, s[4:7], s23 offen offset:0 sc1
    buffer_load_dwordx4 v[56:59], v3, s[4:7], s23 offen offset:0 sc1
    buffer_load_dwordx4 v[60:63], v1, s[4:7], s23 offen offset:2048 sc1
    buffer_load_dwordx4 v[208:211], v2, s[4:7], s23 offen offset:2048 sc1
    buffer_load_dwordx4 v[212:215], v3, s[4:7], s23 offen offset:2048 sc1
    s_add_u32 s23, s24, 8192
    buffer_load_dwordx4 v[216:219], v1, s[4:7], s23 offen offset:0 sc1
    buffer_load_dwordx4 v[220:223], v2, s[4:7], s23 offen offset:0 sc1
    buffer_load_dwordx4 v[224:227], v3, s[4:7], s23 offen offset:0 sc1
    buffer_load_dwordx4 v[228:231], v1, s[4:7], s23 offen offset:2048 sc1
    buffer_load_dwordx4 v[232:235], v2, s[4:7], s23 offen offset:2048 sc1
    buffer_load_dwordx4 v[236:239], v3, s[4:7], s23 offen offset:2048 sc1
    s_add_u32 s24, s24, 24576
    s_add_u32 s22, s19, s95
    s_add_u32 s22, s22, 1
    s_cmp_eq_u32 s16, 2
    s_cbranch_scc1 mk_v
    s_waitcnt vmcnt(17)
    v_mfma_f32_16x16x32_bf16 v[8:11], v[64:67], v[24:27], 0
    v_mfma_f32_16x16x32_bf16 v[12:15], v[136:139], v[24:27], 0
    v_mfma_f32_16x16x32_bf16 v[16:19], a[0:3], v[24:27], 0
    v_mfma_f32_16x16x32_bf16 v[20:23], a[72:75], v[24:27], 0
    s_waitcnt vmcnt(16)
    v_mfma_f32_16x16x32_bf16 v[8:11], v[68:71], v[28:31], v[8:11]
    v_mfma_f32_16x16x32_bf16 v[12:15], v[140:143], v[28:31], v[12:15]
    v_mfma_f32_16x16x32_bf16 v[16:19], a[4:7], v[28:31], v[16:19]
    v_mfma_f32_16x16x32_bf16 v[20:23], a[76:79], v[28:31], v[20:23]
    s_waitcnt vmcnt(15)
    v_mfma_f32_16x16x32_bf16 v[8:11], v[72:75], v[32:35], v[8:11]
    v_mfma_f32_16x16x32_bf16 v[12:15], v[144:147], v[32:35], v[12:15]
    v_mfma_f32_16x16x32_bf16 v[16:19], a[8:11], v[32:35], v[16:19]
    v_mfma_f32_16x16x32_bf16 v[20:23], a[80:83], v[32:35], v[20:23]
    s_waitcnt vmcnt(14)
    v_mfma_f32_16x16x32_bf16 v[8:11], v[76:79], v[36:39], v[8:11]
    v_mfma_f32_16x16x32_bf16 v[12:15], v[148:151], v[36:39], v[12:15]
    v_mfma_f32_16x16x32_bf16 v[16:19], a[12:15], v[36:39], v[16:19]
    v_mfma_f32_16x16x32_bf16 v[20:23], a[84:87], v[36:39], v[20:23]
    s_waitcnt vmcnt(13)
    v_mfma_f32_16x16x32_bf16 v[8:11], v[80:83], v[40:43], v[8:11]
    v_mfma_f32_16x16x32_bf16 v[12:15], v[152:155], v[40:43], v[12:15]
    v_mfma_f32_16x16x32_bf16 v[16:19], a[16:19], v[40:43], v[16:19]
    v_mfma_f32_16x16x32_bf16 v[20:23], a[88:91], v[40:43], v[20:23]
    s_waitcnt vmcnt(12)
    v_mfma_f32_16x16x32_bf16 v[8:11], v[84:87], v[44:47], v[8:11]
    v_mfma_f32_16x16x32_bf16 v[12:15], v[156:159], v[44:47], v[12:15]
    v_mfma_f32_16x16x32_bf16 v[16:19], a[20:23], v[44:47], v[16:19]
    v_mfma_f32_16x16x32_bf16 v[20:23], a[92:95], v[44:47], v[20:23]
    s_waitcnt vmcnt(11)
    v_mfma_f32_16x16x32_bf16 v[8:11], v[88:91], v[48:51], v[8:11]
    v_mfma_f32_16x16x32_bf16 v[12:15], v[160:163], v[48:51], v[12:15]
    v_mfma_f32_16x16x32_bf16 v[16:19], a[24:27], v[48:51], v[16:19]
    v_mfma_f32_16x16x32_bf16 v[20:23], a[96:99], v[48:51], v[20:23]
    s_waitcnt vmcnt(10)
    v_mfma_f32_16x16x32_bf16 v[8:11], v[92:95], v[52:55], v[8:11]
    v_mfma_f32_16x16x32_bf16 v[12:15], v[164:167], v[52:55], v[12:15]
    v_mfma_f32_16x16x32_bf16 v[16:19], a[28:31], v[52:55], v[16:19]
    v_mfma_f32_16x16x32_bf16 v[20:23], a[100:103], v[52:55], v[20:23]
    s_waitcnt vmcnt(9)
    v_mfma_f32_16x16x32_bf16 v[8:11], v[96:99], v[56:59], v[8:11]
    v_mfma_f32_16x16x32_bf16 v[12:15], v[168:171], v[56:59], v[12:15]
    v_mfma_f32_16x16x32_bf16 v[16:19], a[32:35], v[56:59], v[16:19]
    v_mfma_f32_16x16x32_bf16 v[20:23], a[104:107], v[56:59], v[20:23]
    s_waitcnt vmcnt(8)
    v_mfma_f32_16x16x32_bf16 v[8:11], v[100:103], v[60:63], v[8:11]
    v_mfma_f32_16x16x32_bf16 v[12:15], v[172:175], v[60:63], v[12:15]
    v_mfma_f32_16x16x32_bf16 v[16:19], a[36:39], v[60:63], v[16:19]
    v_mfma_f32_16x16x32_bf16 v[20:23], a[108:111], v[60:63], v[20:23]
    s_waitcnt vmcnt(7)
    v_mfma_f32_16x16x32_bf16 v[8:11], v[104:107], v[208:211], v[8:11]
    v_mfma_f32_16x16x32_bf16 v[12:15], v[176:179], v[208:211], v[12:15]
    v_mfma_f32_16x16x32_bf16 v[16:19], a[40:43], v[208:211], v[16:19]
    v_mfma_f32_16x16x32_bf16 v[20:23], a[112:115], v[208:211], v[20:23]
    s_waitcnt vmcnt(6)
    v_mfma_f32_16x16x32_bf16 v[8:11], v[108:111], v[212:215], v[8:11]
    v_mfma_f32_16x16x32_bf16 v[12:15], v[180:183], v[212:215], v[12:15]
    v_mfma_f32_16x16x32_bf16 v[16:19], a[44:47], v[212:215], v[16:19]
    v_mfma_f32_16x16x32_bf16 v[20:23], a[116:119], v[212:215], v[20:23]
    s_waitcnt vmcnt(5)
    v_mfma_f32_16x16x32_bf16 v[8:11], v[112:115], v[216:219], v[8:11]
    v_mfma_f32_16x16x32_bf16 v[12:15], v[184:187], v[216:219], v[12:15]
    v_mfma_f32_16x16x32_bf16 v[16:19], a[48:51], v[216:219], v[16:19]
    v_mfma_f32_16x16x32_bf16 v[20:23], a[120:123], v[216:219], v[20:23]
    s_waitcnt vmcnt(4)
    v_mfma_f32_16x16x32_bf16 v[8:11], v[116:119], v[220:223], v[8:11]
    v_mfma_f32_16x16x32_bf16 v[12:15], v[188:191], v[220:223], v[12:15]
    v_mfma_f32_16x16x32_bf16 v[16:19], a[52:55], v[220:223], v[16:19]
    v_mfma_f32_16x16x32_bf16 v[20:23], a[124:127], v[220:223], v[20:23]
    s_waitcnt vmcnt(3)
    v_mfma_f32_16x16x32_bf16 v[8:11], v[120:123], v[224:227], v[8:11]
    v_mfma_f32_16x16x32_bf16 v[12:15], v[192:195], v[224:227], v[12:15]
    v_mfma_f32_16x16x32_bf16 v[16:19], a[56:59], v[224:227], v[16:19]
    v_mfma_f32_16x16x32_bf16 v[20:23], a[128:131], v[224:227], v[20:23]
    s_waitcnt vmcnt(2)
    v_mfma_f32_16x16x32_bf16 v[8:11], v[124:127], v[228:231], v[8:11]
    v_mfma_f32_16x16x32_bf16 v[12:15], v[196:199], v[228:231], v[12:15]
    v_mfma_f32_16x16x32_bf16 v[16:19], a[60:63], v[228:231], v[16:19]
    v_mfma_f32_16x16x32_bf16 v[20:23], a[132:135], v[228:231], v[20:23]
    s_waitcnt vmcnt(1)
    v_mfma_f32_16x16x32_bf16 v[8:11], v[128:131], v[232:235], v[8:11]
    v_mfma_f32_16x16x32_bf16 v[12:15], v[200:203], v[232:235], v[12:15]
    v_mfma_f32_16x16x32_bf16 v[16:19], a[64:67], v[232:235], v[16:19]
    v_mfma_f32_16x16x32_bf16 v[20:23], a[136:139], v[232:235], v[20:23]
    s_waitcnt vmcnt(0)
    v_mfma_f32_16x16x32_bf16 v[8:11], v[132:135], v[236:239], v[8:11]
    v_mfma_f32_16x16x32_bf16 v[12:15], v[204:207], v[236:239], v[12:15]
    v_mfma_f32_16x16x32_bf16 v[16:19], a[68:71], v[236:239], v[16:19]
    v_mfma_f32_16x16x32_bf16 v[20:23], a[140:143], v[236:239], v[20:23]
    s_nop 7
    s_branch mk_st
mk_v:
    s_waitcnt vmcnt(17)
    v_mfma_f32_16x16x32_bf16 v[8:11], v[24:27], v[64:67], 0
    v_mfma_f32_16x16x32_bf16 v[12:15], v[24:27], v[136:139], 0
    v_mfma_f32_16x16x32_bf16 v[16:19], v[24:27], a[0:3], 0
    v_mfma_f32_16x16x32_bf16 v[20:23], v[24:27], a[72:75], 0
    s_waitcnt vmcnt(16)
    v_mfma_f32_16x16x32_bf16 v[8:11], v[28:31], v[68:71], v[8:11]
    v_mfma_f32_16x16x32_bf16 v[12:15], v[28:31], v[140:143], v[12:15]
    v_mfma_f32_16x16x32_bf16 v[16:19], v[28:31], a[4:7], v[16:19]
    v_mfma_f32_16x16x32_bf16 v[20:23], v[28:31], a[76:79], v[20:23]
    s_waitcnt vmcnt(15)
    v_mfma_f32_16x16x32_bf16 v[8:11], v[32:35], v[72:75], v[8:11]
    v_mfma_f32_16x16x32_bf16 v[12:15], v[32:35], v[144:147], v[12:15]
    v_mfma_f32_16x16x32_bf16 v[16:19], v[32:35], a[8:11], v[16:19]
    v_mfma_f32_16x16x32_bf16 v[20:23], v[32:35], a[80:83], v[20:23]
    s_waitcnt vmcnt(14)
    v_mfma_f32_16x16x32_bf16 v[8:11], v[36:39], v[76:79], v[8:11]
    v_mfma_f32_16x16x32_bf16 v[12:15], v[36:39], v[148:151], v[12:15]
    v_mfma_f32_16x16x32_bf16 v[16:19], v[36:39], a[12:15], v[16:19]
    v_mfma_f32_16x16x32_bf16 v[20:23], v[36:39], a[84:87], v[20:23]
    s_waitcnt vmcnt(13)
    v_mfma_f32_16x16x32_bf16 v[8:11], v[40:43], v[80:83], v[8:11]
    v_mfma_f32_16x16x32_bf16 v[12:15], v[40:43], v[152:155], v[12:15]
    v_mfma_f32_16x16x32_bf16 v[16:19], v[40:43], a[16:19], v[16:19]
    v_mfma_f32_16x16x32_bf16 v[20:23], v[40:43], a[88:91], v[20:23]
    s_waitcnt vmcnt(12)
    v_mfma_f32_16x16x32_bf16 v[8:11], v[44:47], v[84:87], v[8:11]
    v_mfma_f32_16x16x32_bf16 v[12:15], v[44:47], v[156:159], v[12:15]
    v_mfma_f32_16x16x32_bf16 v[16:19], v[44:47], a[20:23], v[16:19]
    v_mfma_f32_16x16x32_bf16 v[20:23], v[44:47], a[92:95], v[20:23]
    s_waitcnt vmcnt(11)
    v_mfma_f32_16x16x32_bf16 v[8:11], v[48:51], v[88:91], v[8:11]
    v_mfma_f32_16x16x32_bf16 v[12:15], v[48:51], v[160:163], v[12:15]
    v_mfma_f32_16x16x32_bf16 v[16:19], v[48:51], a[24:27], v[16:19]
    v_mfma_f32_16x16x32_bf16 v[20:23], v[48:51], a[96:99], v[20:23]
    s_waitcnt vmcnt(10)
    v_mfma_f32_16x16x32_bf16 v[8:11], v[52:55], v[92:95], v[8:11]
    v_mfma_f32_16x16x32_bf16 v[12:15], v[52:55], v[164:167], v[12:15]
    v_mfma_f32_16x16x32_bf16 v[16:19], v[52:55], a[28:31], v[16:19]
    v_mfma_f32_16x16x32_bf16 v[20:23], v[52:55], a[100:103], v[20:23]
    s_waitcnt vmcnt(9)
    v_mfma_f32_16x16x32_bf16 v[8:11], v[56:59], v[96:99], v[8:11]
    v_mfma_f32_16x16x32_bf16 v[12:15], v[56:59], v[168:171], v[12:15]
    v_mfma_f32_16x16x32_bf16 v[16:19], v[56:59], a[32:35], v[16:19]
    v_mfma_f32_16x16x32_bf16 v[20:23], v[56:59], a[104:107], v[20:23]
    s_waitcnt vmcnt(8)
    v_mfma_f32_16x16x32_bf16 v[8:11], v[60:63], v[100:103], v[8:11]
    v_mfma_f32_16x16x32_bf16 v[12:15], v[60:63], v[172:175], v[12:15]
    v_mfma_f32_16x16x32_bf16 v[16:19], v[60:63], a[36:39], v[16:19]
    v_mfma_f32_16x16x32_bf16 v[20:23], v[60:63], a[108:111], v[20:23]
    s_waitcnt vmcnt(7)
    v_mfma_f32_16x16x32_bf16 v[8:11], v[208:211], v[104:107], v[8:11]
    v_mfma_f32_16x16x32_bf16 v[12:15], v[208:211], v[176:179], v[12:15]
    v_mfma_f32_16x16x32_bf16 v[16:19], v[208:211], a[40:43], v[16:19]
    v_mfma_f32_16x16x32_bf16 v[20:23], v[208:211], a[112:115], v[20:23]
    s_waitcnt vmcnt(6)
    v_mfma_f32_16x16x32_bf16 v[8:11], v[212:215], v[108:111], v[8:11]
    v_mfma_f32_16x16x32_bf16 v[12:15], v[212:215], v[180:183], v[12:15]
    v_mfma_f32_16x16x32_bf16 v[16:19], v[212:215], a[44:47], v[16:19]
    v_mfma_f32_16x16x32_bf16 v[20:23], v[212:215], a[116:119], v[20:23]
    s_waitcnt vmcnt(5)
    v_mfma_f32_16x16x32_bf16 v[8:11], v[216:219], v[112:115], v[8:11]
    v_mfma_f32_16x16x32_bf16 v[12:15], v[216:219], v[184:187], v[12:15]
    v_mfma_f32_16x16x32_bf16 v[16:19], v[216:219], a[48:51], v[16:19]
    v_mfma_f32_16x16x32_bf16 v[20:23], v[216:219], a[120:123], v[20:23]
    s_waitcnt vmcnt(4)
    v_mfma_f32_16x16x32_bf16 v[8:11], v[220:223], v[116:119], v[8:11]
    v_mfma_f32_16x16x32_bf16 v[12:15], v[220:223], v[188:191], v[12:15]
    v_mfma_f32_16x16x32_bf16 v[16:19], v[220:223], a[52:55], v[16:19]
    v_mfma_f32_16x16x32_bf16 v[20:23], v[220:223], a[124:127], v[20:23]
    s_waitcnt vmcnt(3)
    v_mfma_f32_16x16x32_bf16 v[8:11], v[224:227], v[120:123], v[8:11]
    v_mfma_f32_16x16x32_bf16 v[12:15], v[224:227], v[192:195], v[12:15]
    v_mfma_f32_16x16x32_bf16 v[16:19], v[224:227], a[56:59], v[16:19]
    v_mfma_f32_16x16x32_bf16 v[20:23], v[224:227], a[128:131], v[20:23]
    s_waitcnt vmcnt(2)
    v_mfma_f32_16x16x32_bf16 v[8:11], v[228:231], v[124:127], v[8:11]
    v_mfma_f32_16x16x32_bf16 v[12:15], v[228:231], v[196:199], v[12:15]
    v_mfma_f32_16x16x32_bf16 v[16:19], v[228:231], a[60:63], v[16:19]
    v_mfma_f32_16x16x32_bf16 v[20:23], v[228:231], a[132:135], v[20:23]
    s_waitcnt vmcnt(1)
    v_mfma_f32_16x16x32_bf16 v[8:11], v[232:235], v[128:131], v[8:11]
    v_mfma_f32_16x16x32_bf16 v[12:15], v[232:235], v[200:203], v[12:15]
    v_mfma_f32_16x16x32_bf16 v[16:19], v[232:235], a[64:67], v[16:19]
    v_mfma_f32_16x16x32_bf16 v[20:23], v[232:235], a[136:139], v[20:23]
    s_waitcnt vmcnt(0)
    v_mfma_f32_16x16x32_bf16 v[8:11], v[236:239], v[132:135], v[8:11]
    v_mfma_f32_16x16x32_bf16 v[12:15], v[236:239], v[204:207], v[12:15]
    v_mfma_f32_16x16x32_bf16 v[16:19], v[236:239], a[68:71], v[16:19]
    v_mfma_f32_16x16x32_bf16 v[20:23], v[236:239], a[140:143], v[20:23]
    v_pk_mul_f32 v[8:9], v[8:9], 0.5 op_sel_hi:[1,0]
    v_pk_mul_f32 v[10:11], v[10:11], 0.5 op_sel_hi:[1,0]
    v_pk_mul_f32 v[12:13], v[12:13], 0.5 op_sel_hi:[1,0]
    v_pk_mul_f32 v[14:15], v[14:15], 0.5 op_sel_hi:[1,0]
    v_pk_mul_f32 v[16:17], v[16:17], 0.5 op_sel_hi:[1,0]
    v_pk_mul_f32 v[18:19], v[18:19], 0.5 op_sel_hi:[1,0]
    s_nop 0
    v_pk_mul_f32 v[20:21], v[20:21], 0.5 op_sel_hi:[1,0]
    v_pk_mul_f32 v[22:23], v[22:23], 0.5 op_sel_hi:[1,0]
    s_nop 1
mk_st:
    v_cvt_pk_bf16_f32 v24, v8, v9
    v_cvt_pk_bf16_f32 v25, v10, v11
    v_cvt_pk_bf16_f32 v26, v12, v13
    v_cvt_pk_bf16_f32 v27, v14, v15
    v_cvt_pk_bf16_f32 v28, v16, v17
    v_cvt_pk_bf16_f32 v29, v18, v19
    v_cvt_pk_bf16_f32 v30, v20, v21
    v_cvt_pk_bf16_f32 v31, v22, v23
    s_add_u32 s21, s26, 4096
    buffer_store_dwordx4 v[24:27], v7, s[4:7], s26 offen sc1
    buffer_store_dwordx4 v[28:31], v7, s[4:7], s21 offen sc1
    s_waitcnt vmcnt(0)
    s_barrier
    v_mov_b32 v4, s22
    s_mov_b64 exec, s[34:35]
    buffer_store_dword v4, off, s[4:7], s29 sc1
    s_mov_b64 exec, -1
    s_add_u32 s19, s19, 2
    s_add_u32 s26, s26, 262144
    s_cmp_lt_u32 s19, 62
    s_cbranch_scc1 mk_loop
    s_endpgm
L_ssm_next:
    s_mov_b32 s37, 8
    v_mov_b32 v250, 1
    v_mov_b32 v251, 163832
    v_cmp_eq_u32 vcc, 0, v0
    s_nop 0
    s_and_saveexec_b64 s[38:39], vcc
    s_cbranch_execz tk10
    buffer_atomic_add v250, off, s[96:99], s37 sc0
    s_waitcnt vmcnt(0)
    ds_write_b32 v251, v250
    s_waitcnt lgkmcnt(0)
tk10:
    s_mov_b64 exec, -1
    s_barrier
    ds_read_b32 v252, v251
    s_waitcnt lgkmcnt(0)
    v_readfirstlane_b32 s20, v252
    s_barrier
    s_nop 3
    s_cmp_ge_u32 s20, 144
    s_cbranch_scc1 L_phase2
    s_lshl_b32 s20, s20, 2
    v_lshrrev_b32 v5, 6, v0
    s_nop 0
    v_readfirstlane_b32 s21, v5
    v_and_b32 v1, 63, v0
    v_and_b32 v2, 15, v1
    v_lshrrev_b32 v3, 4, v1
    v_lshlrev_b32 v4, 14, v5
    s_mov_b32 s8, s62
    s_mov_b32 s9, s63
    s_mov_b32 s10, 2359296
    s_mov_b32 s11, 0x20000
    s_mov_b32 s16, s76
    s_mov_b32 s17, s77
    s_mov_b32 s18, 4718592
    s_mov_b32 s19, 0x20000
    v_mul_u32_u24 v5, 9216, v0
    s_lshl_b32 s22, s20, 1
    s_add_u32 s23, s22, 0
    buffer_load_dwordx2 v[8:9], v5, s[8:11], s23 offen
    s_add_u32 s23, s22, 1152
    buffer_load_dwordx2 v[10:11], v5, s[8:11], s23 offen
    s_add_u32 s23, s22, 2304
    buffer_load_dwordx2 v[12:13], v5, s[8:11], s23 offen
    s_add_u32 s23, s22, 3456
    buffer_load_dwordx2 v[14:15], v5, s[8:11], s23 offen
    s_add_u32 s23, s22, 4608
    buffer_load_dwordx2 v[16:17], v5, s[8:11], s23 offen
    s_add_u32 s23, s22, 5760
    buffer_load_dwordx2 v[18:19], v5, s[8:11], s23 offen
    s_add_u32 s23, s22, 6912
    buffer_load_dwordx2 v[20:21], v5, s[8:11], s23 offen
    s_add_u32 s23, s22, 8064
    buffer_load_dwordx2 v[22:23], v5, s[8:11], s23 offen
    s_add_u32 s22, s20, s21
    s_lshl_b32 s23, s22, 8
    v_lshlrev_b32 v6, 3, v2
    v_lshl_add_u32 v6, v3, 1, v6
    s_mov_b32 s12, s64
    s_mov_b32 s13, s65
    s_mov_b32 s14, 147456
    s_mov_b32 s15, 0x20000
    buffer_load_ushort v24, v6, s[12:15], s23 offen offset:0
    buffer_load_ushort v28, v6, s[12:15], s23 offen offset:128
    s_mov_b32 s12, s66
    s_mov_b32 s13, s67
    s_mov_b32 s14, 147456
    s_mov_b32 s15, 0x20000
    buffer_load_ushort v25, v6, s[12:15], s23 offen offset:0
    buffer_load_ushort v29, v6, s[12:15], s23 offen offset:128
    s_mov_b32 s12, s68
    s_mov_b32 s13, s69
    s_mov_b32 s14, 147456
    s_mov_b32 s15, 0x20000
    buffer_load_ushort v26, v6, s[12:15], s23 offen offset:0
    buffer_load_ushort v30, v6, s[12:15], s23 offen offset:128
    s_mov_b32 s12, s70
    s_mov_b32 s13, s71
    s_mov_b32 s14, 147456
    s_mov_b32 s15, 0x20000
    buffer_load_ushort v27, v6, s[12:15], s23 offen offset:0
    buffer_load_ushort v31, v6, s[12:15], s23 offen offset:128
    s_mov_b32 s12, s72
    s_mov_b32 s13, s73
    s_mov_b32 s14, 1152
    s_mov_b32 s15, 0x20000
    s_lshl_b32 s23, s22, 1
    buffer_load_ushort v32, off, s[12:15], s23
    s_mov_b32 s26, 0x3fb8aa3b
    s_mov_b32 s27, 0x3e22f983
    v_mov_b32 v34, 0
    v_mov_b32 v35, 0
    v_lshl_add_u32 v6, v1, 3, v4
    ds_write_b64 v6, v[34:35] offset:0
    s_waitcnt vmcnt(0)
    v_mov_b32 v36, 0x05040100
    v_mov_b32 v37, 0x07060302
    v_lshlrev_b32 v6, 4, v0
    v_perm_b32 v40, v10, v8, v36
    v_perm_b32 v41, v14, v12, v36
    v_perm_b32 v42, v18, v16, v36
    v_perm_b32 v43, v22, v20, v36
    ds_write_b128 v6, v[40:43] offset:512
    s_nop 1
    v_perm_b32 v40, v10, v8, v37
    v_perm_b32 v41, v14, v12, v37
    v_perm_b32 v42, v18, v16, v37
    v_perm_b32 v43, v22, v20, v37
    ds_write_b128 v6, v[40:43] offset:16896
    s_nop 1
    v_perm_b32 v40, v11, v9, v36
    v_perm_b32 v41, v15, v13, v36
    v_perm_b32 v42, v19, v17, v36
    v_perm_b32 v43, v23, v21, v36
    ds_write_b128 v6, v[40:43] offset:33280
    s_nop 1
    v_perm_b32 v40, v11, v9, v37
    v_perm_b32 v41, v15, v13, v37
    v_perm_b32 v42, v19, v17, v37
    v_perm_b32 v43, v23, v21, v37
    ds_write_b128 v6, v[40:43] offset:49664
    s_nop 1
    v_lshlrev_b32 v32, 16, v32
    v_mul_f32 v32, s26, v32
    v_exp_f32 v32, v32
    s_nop 0
    v_cvt_pk_bf16_f32 v32, v32, v32
    v_and_b32 v32, 0xffff0000, v32
    v_add_f32 v33, v32, v32
    v_lshlrev_b32 v24, 16, v24
    v_mul_f32 v24, s26, v24
    v_exp_f32 v24, v24
    s_nop 0
    v_cvt_pk_bf16_f32 v24, v24, v24
    v_and_b32 v24, 0xffff0000, v24
    v_mul_f32 v24, v24, v32
    v_mul_f32 v24, s26, v24
    v_sub_f32 v24, 0, v24
    v_lshlrev_b32 v25, 16, v25
    v_mul_f32 v25, v25, v32
    v_mul_f32 v25, s27, v25
    v_lshlrev_b32 v26, 16, v26
    v_mul_f32 v26, v26, v33
    v_lshlrev_b32 v27, 16, v27
    v_mul_f32 v27, v27, v33
    v_lshlrev_b32 v28, 16, v28
    v_mul_f32 v28, s26, v28
    v_exp_f32 v28, v28
    s_nop 0
    v_cvt_pk_bf16_f32 v28, v28, v28
    v_and_b32 v28, 0xffff0000, v28
    v_mul_f32 v28, v28, v32
    v_mul_f32 v28, s26, v28
    v_sub_f32 v28, 0, v28
    v_lshlrev_b32 v29, 16, v29
    v_mul_f32 v29, v29, v32
    v_mul_f32 v29, s27, v29
    v_lshlrev_b32 v30, 16, v30
    v_mul_f32 v30, v30, v33
    v_lshlrev_b32 v31, 16, v31
    v_mul_f32 v31, v31, v33
    v_cvt_f32_u32 v47, v2
    v_mul_f32 v44, 0x41800000, v47
    v_and_b32 v5, 7, v2
    v_add_u32 v5, 8, v5
    v_cvt_f32_u32 v5, v5
    v_mul_f32 v45, 0x42000000, v5
    v_mul_f32 v6, 0x42800000, v5
    v_cmp_lt_u32 vcc, 7, v2
    s_nop 1
    v_cndmask_b32 v45, v45, v6, vcc
    v_add_f32 v5, 0x41000000, v47
    v_mul_f32 v46, 0x43000000, v5
    v_mov_b32 v48, 0
    v_mov_b32 v49, 0
    v_mov_b32 v50, 0
    v_mov_b32 v51, 0
    v_mov_b32 v52, 0
    v_mov_b32 v53, 0
    v_mov_b32 v54, 0
    v_mov_b32 v55, 0
    v_mov_b32 v56, 0
    v_mov_b32 v57, 0
    v_mov_b32 v58, 0
    v_mov_b32 v59, 0
    v_mov_b32 v60, 0
    v_mov_b32 v61, 0
    v_mov_b32 v62, 0
    v_mov_b32 v63, 0
    v_mov_b32_dpp v64, v24 row_newbcast:0 row_mask:0xf bank_mask:0xf
    v_mov_b32_dpp v65, v25 row_newbcast:0 row_mask:0xf bank_mask:0xf
    v_mov_b32_dpp v66, v26 row_newbcast:0 row_mask:0xf bank_mask:0xf
    v_mov_b32_dpp v67, v27 row_newbcast:0 row_mask:0xf bank_mask:0xf
    v_mul_f32 v82, v64, v47
    v_mul_f32 v83, v65, v47
    v_exp_f32 v82, v82
    v_fract_f32 v83, v83
    v_cos_f32 v74, v83
    v_sin_f32 v75, v83
    v_mul_f32 v74, v74, v82
    v_mul_f32 v75, v75, v82
    v_mul_f32 v84, v75, v75
    v_add_f32 v85, v74, v74
    v_fma_f32 v76, v74, v74, -v84
    v_mul_f32 v77, v85, v75
    v_mul_f32 v84, v77, v77
    v_add_f32 v85, v76, v76
    v_fma_f32 v78, v76, v76, -v84
    v_mul_f32 v79, v85, v77
    v_mul_f32 v84, v79, v79
    v_add_f32 v85, v78, v78
    v_fma_f32 v80, v78, v78, -v84
    v_mul_f32 v81, v85, v79
    v_mul_f32 v82, v64, v44
    v_mul_f32 v83, v65, v44
    v_exp_f32 v82, v82
    v_fract_f32 v83, v83
    v_cos_f32 v68, v83
    v_sin_f32 v69, v83
    v_mul_f32 v68, v68, v82
    v_mul_f32 v69, v69, v82
    v_mul_f32 v84, v67, v69
    v_mul_f32 v85, v67, v68
    v_fma_f32 v68, v66, v68, -v84
    v_fma_f32 v69, -v66, v69, -v85
    v_mul_f32 v82, v64, v45
    v_mul_f32 v83, v65, v45
    v_exp_f32 v82, v82
    v_fract_f32 v83, v83
    v_cos_f32 v70, v83
    v_sin_f32 v71, v83
    v_mul_f32 v70, v70, v82
    v_mul_f32 v71, v71, v82
    v_mul_f32 v84, v67, v71
    v_mul_f32 v85, v67, v70
    v_fma_f32 v70, v66, v70, -v84
    v_fma_f32 v71, -v66, v71, -v85
    v_mul_f32 v82, v64, v46
    v_mul_f32 v83, v65, v46
    v_exp_f32 v82, v82
    v_fract_f32 v83, v83
    v_cos_f32 v72, v83
    v_sin_f32 v73, v83
    v_mul_f32 v72, v72, v82
    v_mul_f32 v73, v73, v82
    v_mul_f32 v84, v67, v73
    v_mul_f32 v85, v67, v72
    v_fma_f32 v72, v66, v72, -v84
    v_fma_f32 v73, -v66, v73, -v85
    v_mfma_f32_16x16x4_f32 v[48:51], v68, v74, v[48:51]
    v_mfma_f32_16x16x4_f32 v[52:55], v70, v76, v[52:55]
    v_mfma_f32_16x16x4_f32 v[56:59], v70, v78, v[56:59]
    v_mfma_f32_16x16x4_f32 v[60:63], v72, v80, v[60:63]
    v_mfma_f32_16x16x4_f32 v[48:51], v69, v75, v[48:51]
    v_mfma_f32_16x16x4_f32 v[52:55], v71, v77, v[52:55]
    v_mfma_f32_16x16x4_f32 v[56:59], v71, v79, v[56:59]
    v_mfma_f32_16x16x4_f32 v[60:63], v73, v81, v[60:63]
    v_mov_b32_dpp v64, v24 row_newbcast:1 row_mask:0xf bank_mask:0xf
    v_mov_b32_dpp v65, v25 row_newbcast:1 row_mask:0xf bank_mask:0xf
    v_mov_b32_dpp v66, v26 row_newbcast:1 row_mask:0xf bank_mask:0xf
    v_mov_b32_dpp v67, v27 row_newbcast:1 row_mask:0xf bank_mask:0xf
    v_mul_f32 v82, v64, v47
    v_mul_f32 v83, v65, v47
    v_exp_f32 v82, v82
    v_fract_f32 v83, v83
    v_cos_f32 v74, v83
    v_sin_f32 v75, v83
    v_mul_f32 v74, v74, v82
    v_mul_f32 v75, v75, v82
    v_mul_f32 v84, v75, v75
    v_add_f32 v85, v74, v74
    v_fma_f32 v76, v74, v74, -v84
    v_mul_f32 v77, v85, v75
    v_mul_f32 v84, v77, v77
    v_add_f32 v85, v76, v76
    v_fma_f32 v78, v76, v76, -v84
    v_mul_f32 v79, v85, v77
    v_mul_f32 v84, v79, v79
    v_add_f32 v85, v78, v78
    v_fma_f32 v80, v78, v78, -v84
    v_mul_f32 v81, v85, v79
    v_mul_f32 v82, v64, v44
    v_mul_f32 v83, v65, v44
    v_exp_f32 v82, v82
    v_fract_f32 v83, v83
    v_cos_f32 v68, v83
    v_sin_f32 v69, v83
    v_mul_f32 v68, v68, v82
    v_mul_f32 v69, v69, v82
    v_mul_f32 v84, v67, v69
    v_mul_f32 v85, v67, v68
    v_fma_f32 v68, v66, v68, -v84
    v_fma_f32 v69, -v66, v69, -v85
    v_mul_f32 v82, v64, v45
    v_mul_f32 v83, v65, v45
    v_exp_f32 v82, v82
    v_fract_f32 v83, v83
    v_cos_f32 v70, v83
    v_sin_f32 v71, v83
    v_mul_f32 v70, v70, v82
    v_mul_f32 v71, v71, v82
    v_mul_f32 v84, v67, v71
    v_mul_f32 v85, v67, v70
    v_fma_f32 v70, v66, v70, -v84
    v_fma_f32 v71, -v66, v71, -v85
    v_mul_f32 v82, v64, v46
    v_mul_f32 v83, v65, v46
    v_exp_f32 v82, v82
    v_fract_f32 v83, v83
    v_cos_f32 v72, v83
    v_sin_f32 v73, v83
    v_mul_f32 v72, v72, v82
    v_mul_f32 v73, v73, v82
    v_mul_f32 v84, v67, v73
    v_mul_f32 v85, v67, v72
    v_fma_f32 v72, v66, v72, -v84
    v_fma_f32 v73, -v66, v73, -v85
    v_mfma_f32_16x16x4_f32 v[48:51], v68, v74, v[48:51]
    v_mfma_f32_16x16x4_f32 v[52:55], v70, v76, v[52:55]
    v_mfma_f32_16x16x4_f32 v[56:59], v70, v78, v[56:59]
    v_mfma_f32_16x16x4_f32 v[60:63], v72, v80, v[60:63]
    v_mfma_f32_16x16x4_f32 v[48:51], v69, v75, v[48:51]
    v_mfma_f32_16x16x4_f32 v[52:55], v71, v77, v[52:55]
    v_mfma_f32_16x16x4_f32 v[56:59], v71, v79, v[56:59]
    v_mfma_f32_16x16x4_f32 v[60:63], v73, v81, v[60:63]
    v_mov_b32_dpp v64, v24 row_newbcast:2 row_mask:0xf bank_mask:0xf
    v_mov_b32_dpp v65, v25 row_newbcast:2 row_mask:0xf bank_mask:0xf
    v_mov_b32_dpp v66, v26 row_newbcast:2 row_mask:0xf bank_mask:0xf
    v_mov_b32_dpp v67, v27 row_newbcast:2 row_mask:0xf bank_mask:0xf
    v_mul_f32 v82, v64, v47
    v_mul_f32 v83, v65, v47
    v_exp_f32 v82, v82
    v_fract_f32 v83, v83
    v_cos_f32 v74, v83
    v_sin_f32 v75, v83
    v_mul_f32 v74, v74, v82
    v_mul_f32 v75, v75, v82
    v_mul_f32 v84, v75, v75
    v_add_f32 v85, v74, v74
    v_fma_f32 v76, v74, v74, -v84
    v_mul_f32 v77, v85, v75
    v_mul_f32 v84, v77, v77
    v_add_f32 v85, v76, v76
    v_fma_f32 v78, v76, v76, -v84
    v_mul_f32 v79, v85, v77
    v_mul_f32 v84, v79, v79
    v_add_f32 v85, v78, v78
    v_fma_f32 v80, v78, v78, -v84
    v_mul_f32 v81, v85, v79
    v_mul_f32 v82, v64, v44
    v_mul_f32 v83, v65, v44
    v_exp_f32 v82, v82
    v_fract_f32 v83, v83
    v_cos_f32 v68, v83
    v_sin_f32 v69, v83
    v_mul_f32 v68, v68, v82
    v_mul_f32 v69, v69, v82
    v_mul_f32 v84, v67, v69
    v_mul_f32 v85, v67, v68
    v_fma_f32 v68, v66, v68, -v84
    v_fma_f32 v69, -v66, v69, -v85
    v_mul_f32 v82, v64, v45
    v_mul_f32 v83, v65, v45
    v_exp_f32 v82, v82
    v_fract_f32 v83, v83
    v_cos_f32 v70, v83
    v_sin_f32 v71, v83
    v_mul_f32 v70, v70, v82
    v_mul_f32 v71, v71, v82
    v_mul_f32 v84, v67, v71
    v_mul_f32 v85, v67, v70
    v_fma_f32 v70, v66, v70, -v84
    v_fma_f32 v71, -v66, v71, -v85
    v_mul_f32 v82, v64, v46
    v_mul_f32 v83, v65, v46
    v_exp_f32 v82, v82
    v_fract_f32 v83, v83
    v_cos_f32 v72, v83
    v_sin_f32 v73, v83
    v_mul_f32 v72, v72, v82
    v_mul_f32 v73, v73, v82
    v_mul_f32 v84, v67, v73
    v_mul_f32 v85, v67, v72
    v_fma_f32 v72, v66, v72, -v84
    v_fma_f32 v73, -v66, v73, -v85
    v_mfma_f32_16x16x4_f32 v[48:51], v68, v74, v[48:51]
    v_mfma_f32_16x16x4_f32 v[52:55], v70, v76, v[52:55]
    v_mfma_f32_16x16x4_f32 v[56:59], v70, v78, v[56:59]
    v_mfma_f32_16x16x4_f32 v[60:63], v72, v80, v[60:63]
    v_mfma_f32_16x16x4_f32 v[48:51], v69, v75, v[48:51]
    v_mfma_f32_16x16x4_f32 v[52:55], v71, v77, v[52:55]
    v_mfma_f32_16x16x4_f32 v[56:59], v71, v79, v[56:59]
    v_mfma_f32_16x16x4_f32 v[60:63], v73, v81, v[60:63]
    v_mov_b32_dpp v64, v24 row_newbcast:3 row_mask:0xf bank_mask:0xf
    v_mov_b32_dpp v65, v25 row_newbcast:3 row_mask:0xf bank_mask:0xf
    v_mov_b32_dpp v66, v26 row_newbcast:3 row_mask:0xf bank_mask:0xf
    v_mov_b32_dpp v67, v27 row_newbcast:3 row_mask:0xf bank_mask:0xf
    v_mul_f32 v82, v64, v47
    v_mul_f32 v83, v65, v47
    v_exp_f32 v82, v82
    v_fract_f32 v83, v83
    v_cos_f32 v74, v83
    v_sin_f32 v75, v83
    v_mul_f32 v74, v74, v82
    v_mul_f32 v75, v75, v82
    v_mul_f32 v84, v75, v75
    v_add_f32 v85, v74, v74
    v_fma_f32 v76, v74, v74, -v84
    v_mul_f32 v77, v85, v75
    v_mul_f32 v84, v77, v77
    v_add_f32 v85, v76, v76
    v_fma_f32 v78, v76, v76, -v84
    v_mul_f32 v79, v85, v77
    v_mul_f32 v84, v79, v79
    v_add_f32 v85, v78, v78
    v_fma_f32 v80, v78, v78, -v84
    v_mul_f32 v81, v85, v79
    v_mul_f32 v82, v64, v44
    v_mul_f32 v83, v65, v44
    v_exp_f32 v82, v82
    v_fract_f32 v83, v83
    v_cos_f32 v68, v83
    v_sin_f32 v69, v83
    v_mul_f32 v68, v68, v82
    v_mul_f32 v69, v69, v82
    v_mul_f32 v84, v67, v69
    v_mul_f32 v85, v67, v68
    v_fma_f32 v68, v66, v68, -v84
    v_fma_f32 v69, -v66, v69, -v85
    v_mul_f32 v82, v64, v45
    v_mul_f32 v83, v65, v45
    v_exp_f32 v82, v82
    v_fract_f32 v83, v83
    v_cos_f32 v70, v83
    v_sin_f32 v71, v83
    v_mul_f32 v70, v70, v82
    v_mul_f32 v71, v71, v82
    v_mul_f32 v84, v67, v71
    v_mul_f32 v85, v67, v70
    v_fma_f32 v70, v66, v70, -v84
    v_fma_f32 v71, -v66, v71, -v85
    v_mul_f32 v82, v64, v46
    v_mul_f32 v83, v65, v46
    v_exp_f32 v82, v82
    v_fract_f32 v83, v83
    v_cos_f32 v72, v83
    v_sin_f32 v73, v83
    v_mul_f32 v72, v72, v82
    v_mul_f32 v73, v73, v82
    v_mul_f32 v84, v67, v73
    v_mul_f32 v85, v67, v72
    v_fma_f32 v72, v66, v72, -v84
    v_fma_f32 v73, -v66, v73, -v85
    v_mfma_f32_16x16x4_f32 v[48:51], v68, v74, v[48:51]
    v_mfma_f32_16x16x4_f32 v[52:55], v70, v76, v[52:55]
    v_mfma_f32_16x16x4_f32 v[56:59], v70, v78, v[56:59]
    v_mfma_f32_16x16x4_f32 v[60:63], v72, v80, v[60:63]
    v_mfma_f32_16x16x4_f32 v[48:51], v69, v75, v[48:51]
    v_mfma_f32_16x16x4_f32 v[52:55], v71, v77, v[52:55]
    v_mfma_f32_16x16x4_f32 v[56:59], v71, v79, v[56:59]
    v_mfma_f32_16x16x4_f32 v[60:63], v73, v81, v[60:63]
    v_mov_b32_dpp v64, v24 row_newbcast:4 row_mask:0xf bank_mask:0xf
    v_mov_b32_dpp v65, v25 row_newbcast:4 row_mask:0xf bank_mask:0xf
    v_mov_b32_dpp v66, v26 row_newbcast:4 row_mask:0xf bank_mask:0xf
    v_mov_b32_dpp v67, v27 row_newbcast:4 row_mask:0xf bank_mask:0xf
    v_mul_f32 v82, v64, v47
    v_mul_f32 v83, v65, v47
    v_exp_f32 v82, v82
    v_fract_f32 v83, v83
    v_cos_f32 v74, v83
    v_sin_f32 v75, v83
    v_mul_f32 v74, v74, v82
    v_mul_f32 v75, v75, v82
    v_mul_f32 v84, v75, v75
    v_add_f32 v85, v74, v74
    v_fma_f32 v76, v74, v74, -v84
    v_mul_f32 v77, v85, v75
    v_mul_f32 v84, v77, v77
    v_add_f32 v85, v76, v76
    v_fma_f32 v78, v76, v76, -v84
    v_mul_f32 v79, v85, v77
    v_mul_f32 v84, v79, v79
    v_add_f32 v85, v78, v78
    v_fma_f32 v80, v78, v78, -v84
    v_mul_f32 v81, v85, v79
    v_mul_f32 v82, v64, v44
    v_mul_f32 v83, v65, v44
    v_exp_f32 v82, v82
    v_fract_f32 v83, v83
    v_cos_f32 v68, v83
    v_sin_f32 v69, v83
    v_mul_f32 v68, v68, v82
    v_mul_f32 v69, v69, v82
    v_mul_f32 v84, v67, v69
    v_mul_f32 v85, v67, v68
    v_fma_f32 v68, v66, v68, -v84
    v_fma_f32 v69, -v66, v69, -v85
    v_mul_f32 v82, v64, v45
    v_mul_f32 v83, v65, v45
    v_exp_f32 v82, v82
    v_fract_f32 v83, v83
    v_cos_f32 v70, v83
    v_sin_f32 v71, v83
    v_mul_f32 v70, v70, v82
    v_mul_f32 v71, v71, v82
    v_mul_f32 v84, v67, v71
    v_mul_f32 v85, v67, v70
    v_fma_f32 v70, v66, v70, -v84
    v_fma_f32 v71, -v66, v71, -v85
    v_mul_f32 v82, v64, v46
    v_mul_f32 v83, v65, v46
    v_exp_f32 v82, v82
    v_fract_f32 v83, v83
    v_cos_f32 v72, v83
    v_sin_f32 v73, v83
    v_mul_f32 v72, v72, v82
    v_mul_f32 v73, v73, v82
    v_mul_f32 v84, v67, v73
    v_mul_f32 v85, v67, v72
    v_fma_f32 v72, v66, v72, -v84
    v_fma_f32 v73, -v66, v73, -v85
    v_mfma_f32_16x16x4_f32 v[48:51], v68, v74, v[48:51]
    v_mfma_f32_16x16x4_f32 v[52:55], v70, v76, v[52:55]
    v_mfma_f32_16x16x4_f32 v[56:59], v70, v78, v[56:59]
    v_mfma_f32_16x16x4_f32 v[60:63], v72, v80, v[60:63]
    v_mfma_f32_16x16x4_f32 v[48:51], v69, v75, v[48:51]
    v_mfma_f32_16x16x4_f32 v[52:55], v71, v77, v[52:55]
    v_mfma_f32_16x16x4_f32 v[56:59], v71, v79, v[56:59]
    v_mfma_f32_16x16x4_f32 v[60:63], v73, v81, v[60:63]
    v_mov_b32_dpp v64, v24 row_newbcast:5 row_mask:0xf bank_mask:0xf
    v_mov_b32_dpp v65, v25 row_newbcast:5 row_mask:0xf bank_mask:0xf
    v_mov_b32_dpp v66, v26 row_newbcast:5 row_mask:0xf bank_mask:0xf
    v_mov_b32_dpp v67, v27 row_newbcast:5 row_mask:0xf bank_mask:0xf
    v_mul_f32 v82, v64, v47
    v_mul_f32 v83, v65, v47
    v_exp_f32 v82, v82
    v_fract_f32 v83, v83
    v_cos_f32 v74, v83
    v_sin_f32 v75, v83
    v_mul_f32 v74, v74, v82
    v_mul_f32 v75, v75, v82
    v_mul_f32 v84, v75, v75
    v_add_f32 v85, v74, v74
    v_fma_f32 v76, v74, v74, -v84
    v_mul_f32 v77, v85, v75
    v_mul_f32 v84, v77, v77
    v_add_f32 v85, v76, v76
    v_fma_f32 v78, v76, v76, -v84
    v_mul_f32 v79, v85, v77
    v_mul_f32 v84, v79, v79
    v_add_f32 v85, v78, v78
    v_fma_f32 v80, v78, v78, -v84
    v_mul_f32 v81, v85, v79
    v_mul_f32 v82, v64, v44
    v_mul_f32 v83, v65, v44
    v_exp_f32 v82, v82
    v_fract_f32 v83, v83
    v_cos_f32 v68, v83
    v_sin_f32 v69, v83
    v_mul_f32 v68, v68, v82
    v_mul_f32 v69, v69, v82
    v_mul_f32 v84, v67, v69
    v_mul_f32 v85, v67, v68
    v_fma_f32 v68, v66, v68, -v84
    v_fma_f32 v69, -v66, v69, -v85
    v_mul_f32 v82, v64, v45
    v_mul_f32 v83, v65, v45
    v_exp_f32 v82, v82
    v_fract_f32 v83, v83
    v_cos_f32 v70, v83
    v_sin_f32 v71, v83
    v_mul_f32 v70, v70, v82
    v_mul_f32 v71, v71, v82
    v_mul_f32 v84, v67, v71
    v_mul_f32 v85, v67, v70
    v_fma_f32 v70, v66, v70, -v84
    v_fma_f32 v71, -v66, v71, -v85
    v_mul_f32 v82, v64, v46
    v_mul_f32 v83, v65, v46
    v_exp_f32 v82, v82
    v_fract_f32 v83, v83
    v_cos_f32 v72, v83
    v_sin_f32 v73, v83
    v_mul_f32 v72, v72, v82
    v_mul_f32 v73, v73, v82
    v_mul_f32 v84, v67, v73
    v_mul_f32 v85, v67, v72
    v_fma_f32 v72, v66, v72, -v84
    v_fma_f32 v73, -v66, v73, -v85
    v_mfma_f32_16x16x4_f32 v[48:51], v68, v74, v[48:51]
    v_mfma_f32_16x16x4_f32 v[52:55], v70, v76, v[52:55]
    v_mfma_f32_16x16x4_f32 v[56:59], v70, v78, v[56:59]
    v_mfma_f32_16x16x4_f32 v[60:63], v72, v80, v[60:63]
    v_mfma_f32_16x16x4_f32 v[48:51], v69, v75, v[48:51]
    v_mfma_f32_16x16x4_f32 v[52:55], v71, v77, v[52:55]
    v_mfma_f32_16x16x4_f32 v[56:59], v71, v79, v[56:59]
    v_mfma_f32_16x16x4_f32 v[60:63], v73, v81, v[60:63]
    v_mov_b32_dpp v64, v24 row_newbcast:6 row_mask:0xf bank_mask:0xf
    v_mov_b32_dpp v65, v25 row_newbcast:6 row_mask:0xf bank_mask:0xf
    v_mov_b32_dpp v66, v26 row_newbcast:6 row_mask:0xf bank_mask:0xf
    v_mov_b32_dpp v67, v27 row_newbcast:6 row_mask:0xf bank_mask:0xf
    v_mul_f32 v82, v64, v47
    v_mul_f32 v83, v65, v47
    v_exp_f32 v82, v82
    v_fract_f32 v83, v83
    v_cos_f32 v74, v83
    v_sin_f32 v75, v83
    v_mul_f32 v74, v74, v82
    v_mul_f32 v75, v75, v82
    v_mul_f32 v84, v75, v75
    v_add_f32 v85, v74, v74
    v_fma_f32 v76, v74, v74, -v84
    v_mul_f32 v77, v85, v75
    v_mul_f32 v84, v77, v77
    v_add_f32 v85, v76, v76
    v_fma_f32 v78, v76, v76, -v84
    v_mul_f32 v79, v85, v77
    v_mul_f32 v84, v79, v79
    v_add_f32 v85, v78, v78
    v_fma_f32 v80, v78, v78, -v84
    v_mul_f32 v81, v85, v79
    v_mul_f32 v82, v64, v44
    v_mul_f32 v83, v65, v44
    v_exp_f32 v82, v82
    v_fract_f32 v83, v83
    v_cos_f32 v68, v83
    v_sin_f32 v69, v83
    v_mul_f32 v68, v68, v82
    v_mul_f32 v69, v69, v82
    v_mul_f32 v84, v67, v69
    v_mul_f32 v85, v67, v68
    v_fma_f32 v68, v66, v68, -v84
    v_fma_f32 v69, -v66, v69, -v85
    v_mul_f32 v82, v64, v45
    v_mul_f32 v83, v65, v45
    v_exp_f32 v82, v82
    v_fract_f32 v83, v83
    v_cos_f32 v70, v83
    v_sin_f32 v71, v83
    v_mul_f32 v70, v70, v82
    v_mul_f32 v71, v71, v82
    v_mul_f32 v84, v67, v71
    v_mul_f32 v85, v67, v70
    v_fma_f32 v70, v66, v70, -v84
    v_fma_f32 v71, -v66, v71, -v85
    v_mul_f32 v82, v64, v46
    v_mul_f32 v83, v65, v46
    v_exp_f32 v82, v82
    v_fract_f32 v83, v83
    v_cos_f32 v72, v83
    v_sin_f32 v73, v83
    v_mul_f32 v72, v72, v82
    v_mul_f32 v73, v73, v82
    v_mul_f32 v84, v67, v73
    v_mul_f32 v85, v67, v72
    v_fma_f32 v72, v66, v72, -v84
    v_fma_f32 v73, -v66, v73, -v85
    v_mfma_f32_16x16x4_f32 v[48:51], v68, v74, v[48:51]
    v_mfma_f32_16x16x4_f32 v[52:55], v70, v76, v[52:55]
    v_mfma_f32_16x16x4_f32 v[56:59], v70, v78, v[56:59]
    v_mfma_f32_16x16x4_f32 v[60:63], v72, v80, v[60:63]
    v_mfma_f32_16x16x4_f32 v[48:51], v69, v75, v[48:51]
    v_mfma_f32_16x16x4_f32 v[52:55], v71, v77, v[52:55]
    v_mfma_f32_16x16x4_f32 v[56:59], v71, v79, v[56:59]
    v_mfma_f32_16x16x4_f32 v[60:63], v73, v81, v[60:63]
    v_mov_b32_dpp v64, v24 row_newbcast:7 row_mask:0xf bank_mask:0xf
    v_mov_b32_dpp v65, v25 row_newbcast:7 row_mask:0xf bank_mask:0xf
    v_mov_b32_dpp v66, v26 row_newbcast:7 row_mask:0xf bank_mask:0xf
    v_mov_b32_dpp v67, v27 row_newbcast:7 row_mask:0xf bank_mask:0xf
    v_mul_f32 v82, v64, v47
    v_mul_f32 v83, v65, v47
    v_exp_f32 v82, v82
    v_fract_f32 v83, v83
    v_cos_f32 v74, v83
    v_sin_f32 v75, v83
    v_mul_f32 v74, v74, v82
    v_mul_f32 v75, v75, v82
    v_mul_f32 v84, v75, v75
    v_add_f32 v85, v74, v74
    v_fma_f32 v76, v74, v74, -v84
    v_mul_f32 v77, v85, v75
    v_mul_f32 v84, v77, v77
    v_add_f32 v85, v76, v76
    v_fma_f32 v78, v76, v76, -v84
    v_mul_f32 v79, v85, v77
    v_mul_f32 v84, v79, v79
    v_add_f32 v85, v78, v78
    v_fma_f32 v80, v78, v78, -v84
    v_mul_f32 v81, v85, v79
    v_mul_f32 v82, v64, v44
    v_mul_f32 v83, v65, v44
    v_exp_f32 v82, v82
    v_fract_f32 v83, v83
    v_cos_f32 v68, v83
    v_sin_f32 v69, v83
    v_mul_f32 v68, v68, v82
    v_mul_f32 v69, v69, v82
    v_mul_f32 v84, v67, v69
    v_mul_f32 v85, v67, v68
    v_fma_f32 v68, v66, v68, -v84
    v_fma_f32 v69, -v66, v69, -v85
    v_mul_f32 v82, v64, v45
    v_mul_f32 v83, v65, v45
    v_exp_f32 v82, v82
    v_fract_f32 v83, v83
    v_cos_f32 v70, v83
    v_sin_f32 v71, v83
    v_mul_f32 v70, v70, v82
    v_mul_f32 v71, v71, v82
    v_mul_f32 v84, v67, v71
    v_mul_f32 v85, v67, v70
    v_fma_f32 v70, v66, v70, -v84
    v_fma_f32 v71, -v66, v71, -v85
    v_mul_f32 v82, v64, v46
    v_mul_f32 v83, v65, v46
    v_exp_f32 v82, v82
    v_fract_f32 v83, v83
    v_cos_f32 v72, v83
    v_sin_f32 v73, v83
    v_mul_f32 v72, v72, v82
    v_mul_f32 v73, v73, v82
    v_mul_f32 v84, v67, v73
    v_mul_f32 v85, v67, v72
    v_fma_f32 v72, v66, v72, -v84
    v_fma_f32 v73, -v66, v73, -v85
    v_mfma_f32_16x16x4_f32 v[48:51], v68, v74, v[48:51]
    v_mfma_f32_16x16x4_f32 v[52:55], v70, v76, v[52:55]
    v_mfma_f32_16x16x4_f32 v[56:59], v70, v78, v[56:59]
    v_mfma_f32_16x16x4_f32 v[60:63], v72, v80, v[60:63]
    v_mfma_f32_16x16x4_f32 v[48:51], v69, v75, v[48:51]
    v_mfma_f32_16x16x4_f32 v[52:55], v71, v77, v[52:55]
    v_mfma_f32_16x16x4_f32 v[56:59], v71, v79, v[56:59]
    v_mfma_f32_16x16x4_f32 v[60:63], v73, v81, v[60:63]
    v_mov_b32_dpp v64, v24 row_newbcast:8 row_mask:0xf bank_mask:0xf
    v_mov_b32_dpp v65, v25 row_newbcast:8 row_mask:0xf bank_mask:0xf
    v_mov_b32_dpp v66, v26 row_newbcast:8 row_mask:0xf bank_mask:0xf
    v_mov_b32_dpp v67, v27 row_newbcast:8 row_mask:0xf bank_mask:0xf
    v_mul_f32 v82, v64, v47
    v_mul_f32 v83, v65, v47
    v_exp_f32 v82, v82
    v_fract_f32 v83, v83
    v_cos_f32 v74, v83
    v_sin_f32 v75, v83
    v_mul_f32 v74, v74, v82
    v_mul_f32 v75, v75, v82
    v_mul_f32 v84, v75, v75
    v_add_f32 v85, v74, v74
    v_fma_f32 v76, v74, v74, -v84
    v_mul_f32 v77, v85, v75
    v_mul_f32 v84, v77, v77
    v_add_f32 v85, v76, v76
    v_fma_f32 v78, v76, v76, -v84
    v_mul_f32 v79, v85, v77
    v_mul_f32 v84, v79, v79
    v_add_f32 v85, v78, v78
    v_fma_f32 v80, v78, v78, -v84
    v_mul_f32 v81, v85, v79
    v_mul_f32 v82, v64, v44
    v_mul_f32 v83, v65, v44
    v_exp_f32 v82, v82
    v_fract_f32 v83, v83
    v_cos_f32 v68, v83
    v_sin_f32 v69, v83
    v_mul_f32 v68, v68, v82
    v_mul_f32 v69, v69, v82
    v_mul_f32 v84, v67, v69
    v_mul_f32 v85, v67, v68
    v_fma_f32 v68, v66, v68, -v84
    v_fma_f32 v69, -v66, v69, -v85
    v_mul_f32 v82, v64, v45
    v_mul_f32 v83, v65, v45
    v_exp_f32 v82, v82
    v_fract_f32 v83, v83
    v_cos_f32 v70, v83
    v_sin_f32 v71, v83
    v_mul_f32 v70, v70, v82
    v_mul_f32 v71, v71, v82
    v_mul_f32 v84, v67, v71
    v_mul_f32 v85, v67, v70
    v_fma_f32 v70, v66, v70, -v84
    v_fma_f32 v71, -v66, v71, -v85
    v_mul_f32 v82, v64, v46
    v_mul_f32 v83, v65, v46
    v_exp_f32 v82, v82
    v_fract_f32 v83, v83
    v_cos_f32 v72, v83
    v_sin_f32 v73, v83
    v_mul_f32 v72, v72, v82
    v_mul_f32 v73, v73, v82
    v_mul_f32 v84, v67, v73
    v_mul_f32 v85, v67, v72
    v_fma_f32 v72, v66, v72, -v84
    v_fma_f32 v73, -v66, v73, -v85
    v_mfma_f32_16x16x4_f32 v[48:51], v68, v74, v[48:51]
    v_mfma_f32_16x16x4_f32 v[52:55], v70, v76, v[52:55]
    v_mfma_f32_16x16x4_f32 v[56:59], v70, v78, v[56:59]
    v_mfma_f32_16x16x4_f32 v[60:63], v72, v80, v[60:63]
    v_mfma_f32_16x16x4_f32 v[48:51], v69, v75, v[48:51]
    v_mfma_f32_16x16x4_f32 v[52:55], v71, v77, v[52:55]
    v_mfma_f32_16x16x4_f32 v[56:59], v71, v79, v[56:59]
    v_mfma_f32_16x16x4_f32 v[60:63], v73, v81, v[60:63]
    v_mov_b32_dpp v64, v24 row_newbcast:9 row_mask:0xf bank_mask:0xf
    v_mov_b32_dpp v65, v25 row_newbcast:9 row_mask:0xf bank_mask:0xf
    v_mov_b32_dpp v66, v26 row_newbcast:9 row_mask:0xf bank_mask:0xf
    v_mov_b32_dpp v67, v27 row_newbcast:9 row_mask:0xf bank_mask:0xf
    v_mul_f32 v82, v64, v47
    v_mul_f32 v83, v65, v47
    v_exp_f32 v82, v82
    v_fract_f32 v83, v83
    v_cos_f32 v74, v83
    v_sin_f32 v75, v83
    v_mul_f32 v74, v74, v82
    v_mul_f32 v75, v75, v82
    v_mul_f32 v84, v75, v75
    v_add_f32 v85, v74, v74
    v_fma_f32 v76, v74, v74, -v84
    v_mul_f32 v77, v85, v75
    v_mul_f32 v84, v77, v77
    v_add_f32 v85, v76, v76
    v_fma_f32 v78, v76, v76, -v84
    v_mul_f32 v79, v85, v77
    v_mul_f32 v84, v79, v79
    v_add_f32 v85, v78, v78
    v_fma_f32 v80, v78, v78, -v84
    v_mul_f32 v81, v85, v79
    v_mul_f32 v82, v64, v44
    v_mul_f32 v83, v65, v44
    v_exp_f32 v82, v82
    v_fract_f32 v83, v83
    v_cos_f32 v68, v83
    v_sin_f32 v69, v83
    v_mul_f32 v68, v68, v82
    v_mul_f32 v69, v69, v82
    v_mul_f32 v84, v67, v69
    v_mul_f32 v85, v67, v68
    v_fma_f32 v68, v66, v68, -v84
    v_fma_f32 v69, -v66, v69, -v85
    v_mul_f32 v82, v64, v45
    v_mul_f32 v83, v65, v45
    v_exp_f32 v82, v82
    v_fract_f32 v83, v83
    v_cos_f32 v70, v83
    v_sin_f32 v71, v83
    v_mul_f32 v70, v70, v82
    v_mul_f32 v71, v71, v82
    v_mul_f32 v84, v67, v71
    v_mul_f32 v85, v67, v70
    v_fma_f32 v70, v66, v70, -v84
    v_fma_f32 v71, -v66, v71, -v85
    v_mul_f32 v82, v64, v46
    v_mul_f32 v83, v65, v46
    v_exp_f32 v82, v82
    v_fract_f32 v83, v83
    v_cos_f32 v72, v83
    v_sin_f32 v73, v83
    v_mul_f32 v72, v72, v82
    v_mul_f32 v73, v73, v82
    v_mul_f32 v84, v67, v73
    v_mul_f32 v85, v67, v72
    v_fma_f32 v72, v66, v72, -v84
    v_fma_f32 v73, -v66, v73, -v85
    v_mfma_f32_16x16x4_f32 v[48:51], v68, v74, v[48:51]
    v_mfma_f32_16x16x4_f32 v[52:55], v70, v76, v[52:55]
    v_mfma_f32_16x16x4_f32 v[56:59], v70, v78, v[56:59]
    v_mfma_f32_16x16x4_f32 v[60:63], v72, v80, v[60:63]
    v_mfma_f32_16x16x4_f32 v[48:51], v69, v75, v[48:51]
    v_mfma_f32_16x16x4_f32 v[52:55], v71, v77, v[52:55]
    v_mfma_f32_16x16x4_f32 v[56:59], v71, v79, v[56:59]
    v_mfma_f32_16x16x4_f32 v[60:63], v73, v81, v[60:63]
    v_mov_b32_dpp v64, v24 row_newbcast:10 row_mask:0xf bank_mask:0xf
    v_mov_b32_dpp v65, v25 row_newbcast:10 row_mask:0xf bank_mask:0xf
    v_mov_b32_dpp v66, v26 row_newbcast:10 row_mask:0xf bank_mask:0xf
    v_mov_b32_dpp v67, v27 row_newbcast:10 row_mask:0xf bank_mask:0xf
    v_mul_f32 v82, v64, v47
    v_mul_f32 v83, v65, v47
    v_exp_f32 v82, v82
    v_fract_f32 v83, v83
    v_cos_f32 v74, v83
    v_sin_f32 v75, v83
    v_mul_f32 v74, v74, v82
    v_mul_f32 v75, v75, v82
    v_mul_f32 v84, v75, v75
    v_add_f32 v85, v74, v74
    v_fma_f32 v76, v74, v74, -v84
    v_mul_f32 v77, v85, v75
    v_mul_f32 v84, v77, v77
    v_add_f32 v85, v76, v76
    v_fma_f32 v78, v76, v76, -v84
    v_mul_f32 v79, v85, v77
    v_mul_f32 v84, v79, v79
    v_add_f32 v85, v78, v78
    v_fma_f32 v80, v78, v78, -v84
    v_mul_f32 v81, v85, v79
    v_mul_f32 v82, v64, v44
    v_mul_f32 v83, v65, v44
    v_exp_f32 v82, v82
    v_fract_f32 v83, v83
    v_cos_f32 v68, v83
    v_sin_f32 v69, v83
    v_mul_f32 v68, v68, v82
    v_mul_f32 v69, v69, v82
    v_mul_f32 v84, v67, v69
    v_mul_f32 v85, v67, v68
    v_fma_f32 v68, v66, v68, -v84
    v_fma_f32 v69, -v66, v69, -v85
    v_mul_f32 v82, v64, v45
    v_mul_f32 v83, v65, v45
    v_exp_f32 v82, v82
    v_fract_f32 v83, v83
    v_cos_f32 v70, v83
    v_sin_f32 v71, v83
    v_mul_f32 v70, v70, v82
    v_mul_f32 v71, v71, v82
    v_mul_f32 v84, v67, v71
    v_mul_f32 v85, v67, v70
    v_fma_f32 v70, v66, v70, -v84
    v_fma_f32 v71, -v66, v71, -v85
    v_mul_f32 v82, v64, v46
    v_mul_f32 v83, v65, v46
    v_exp_f32 v82, v82
    v_fract_f32 v83, v83
    v_cos_f32 v72, v83
    v_sin_f32 v73, v83
    v_mul_f32 v72, v72, v82
    v_mul_f32 v73, v73, v82
    v_mul_f32 v84, v67, v73
    v_mul_f32 v85, v67, v72
    v_fma_f32 v72, v66, v72, -v84
    v_fma_f32 v73, -v66, v73, -v85
    v_mfma_f32_16x16x4_f32 v[48:51], v68, v74, v[48:51]
    v_mfma_f32_16x16x4_f32 v[52:55], v70, v76, v[52:55]
    v_mfma_f32_16x16x4_f32 v[56:59], v70, v78, v[56:59]
    v_mfma_f32_16x16x4_f32 v[60:63], v72, v80, v[60:63]
    v_mfma_f32_16x16x4_f32 v[48:51], v69, v75, v[48:51]
    v_mfma_f32_16x16x4_f32 v[52:55], v71, v77, v[52:55]
    v_mfma_f32_16x16x4_f32 v[56:59], v71, v79, v[56:59]
    v_mfma_f32_16x16x4_f32 v[60:63], v73, v81, v[60:63]
    v_mov_b32_dpp v64, v24 row_newbcast:11 row_mask:0xf bank_mask:0xf
    v_mov_b32_dpp v65, v25 row_newbcast:11 row_mask:0xf bank_mask:0xf
    v_mov_b32_dpp v66, v26 row_newbcast:11 row_mask:0xf bank_mask:0xf
    v_mov_b32_dpp v67, v27 row_newbcast:11 row_mask:0xf bank_mask:0xf
    v_mul_f32 v82, v64, v47
    v_mul_f32 v83, v65, v47
    v_exp_f32 v82, v82
    v_fract_f32 v83, v83
    v_cos_f32 v74, v83
    v_sin_f32 v75, v83
    v_mul_f32 v74, v74, v82
    v_mul_f32 v75, v75, v82
    v_mul_f32 v84, v75, v75
    v_add_f32 v85, v74, v74
    v_fma_f32 v76, v74, v74, -v84
    v_mul_f32 v77, v85, v75
    v_mul_f32 v84, v77, v77
    v_add_f32 v85, v76, v76
    v_fma_f32 v78, v76, v76, -v84
    v_mul_f32 v79, v85, v77
    v_mul_f32 v84, v79, v79
    v_add_f32 v85, v78, v78
    v_fma_f32 v80, v78, v78, -v84
    v_mul_f32 v81, v85, v79
    v_mul_f32 v82, v64, v44
    v_mul_f32 v83, v65, v44
    v_exp_f32 v82, v82
    v_fract_f32 v83, v83
    v_cos_f32 v68, v83
    v_sin_f32 v69, v83
    v_mul_f32 v68, v68, v82
    v_mul_f32 v69, v69, v82
    v_mul_f32 v84, v67, v69
    v_mul_f32 v85, v67, v68
    v_fma_f32 v68, v66, v68, -v84
    v_fma_f32 v69, -v66, v69, -v85
    v_mul_f32 v82, v64, v45
    v_mul_f32 v83, v65, v45
    v_exp_f32 v82, v82
    v_fract_f32 v83, v83
    v_cos_f32 v70, v83
    v_sin_f32 v71, v83
    v_mul_f32 v70, v70, v82
    v_mul_f32 v71, v71, v82
    v_mul_f32 v84, v67, v71
    v_mul_f32 v85, v67, v70
    v_fma_f32 v70, v66, v70, -v84
    v_fma_f32 v71, -v66, v71, -v85
    v_mul_f32 v82, v64, v46
    v_mul_f32 v83, v65, v46
    v_exp_f32 v82, v82
    v_fract_f32 v83, v83
    v_cos_f32 v72, v83
    v_sin_f32 v73, v83
    v_mul_f32 v72, v72, v82
    v_mul_f32 v73, v73, v82
    v_mul_f32 v84, v67, v73
    v_mul_f32 v85, v67, v72
    v_fma_f32 v72, v66, v72, -v84
    v_fma_f32 v73, -v66, v73, -v85
    v_mfma_f32_16x16x4_f32 v[48:51], v68, v74, v[48:51]
    v_mfma_f32_16x16x4_f32 v[52:55], v70, v76, v[52:55]
    v_mfma_f32_16x16x4_f32 v[56:59], v70, v78, v[56:59]
    v_mfma_f32_16x16x4_f32 v[60:63], v72, v80, v[60:63]
    v_mfma_f32_16x16x4_f32 v[48:51], v69, v75, v[48:51]
    v_mfma_f32_16x16x4_f32 v[52:55], v71, v77, v[52:55]
    v_mfma_f32_16x16x4_f32 v[56:59], v71, v79, v[56:59]
    v_mfma_f32_16x16x4_f32 v[60:63], v73, v81, v[60:63]
    v_mov_b32_dpp v64, v24 row_newbcast:12 row_mask:0xf bank_mask:0xf
    v_mov_b32_dpp v65, v25 row_newbcast:12 row_mask:0xf bank_mask:0xf
    v_mov_b32_dpp v66, v26 row_newbcast:12 row_mask:0xf bank_mask:0xf
    v_mov_b32_dpp v67, v27 row_newbcast:12 row_mask:0xf bank_mask:0xf
    v_mul_f32 v82, v64, v47
    v_mul_f32 v83, v65, v47
    v_exp_f32 v82, v82
    v_fract_f32 v83, v83
    v_cos_f32 v74, v83
    v_sin_f32 v75, v83
    v_mul_f32 v74, v74, v82
    v_mul_f32 v75, v75, v82
    v_mul_f32 v84, v75, v75
    v_add_f32 v85, v74, v74
    v_fma_f32 v76, v74, v74, -v84
    v_mul_f32 v77, v85, v75
    v_mul_f32 v84, v77, v77
    v_add_f32 v85, v76, v76
    v_fma_f32 v78, v76, v76, -v84
    v_mul_f32 v79, v85, v77
    v_mul_f32 v84, v79, v79
    v_add_f32 v85, v78, v78
    v_fma_f32 v80, v78, v78, -v84
    v_mul_f32 v81, v85, v79
    v_mul_f32 v82, v64, v44
    v_mul_f32 v83, v65, v44
    v_exp_f32 v82, v82
    v_fract_f32 v83, v83
    v_cos_f32 v68, v83
    v_sin_f32 v69, v83
    v_mul_f32 v68, v68, v82
    v_mul_f32 v69, v69, v82
    v_mul_f32 v84, v67, v69
    v_mul_f32 v85, v67, v68
    v_fma_f32 v68, v66, v68, -v84
    v_fma_f32 v69, -v66, v69, -v85
    v_mul_f32 v82, v64, v45
    v_mul_f32 v83, v65, v45
    v_exp_f32 v82, v82
    v_fract_f32 v83, v83
    v_cos_f32 v70, v83
    v_sin_f32 v71, v83
    v_mul_f32 v70, v70, v82
    v_mul_f32 v71, v71, v82
    v_mul_f32 v84, v67, v71
    v_mul_f32 v85, v67, v70
    v_fma_f32 v70, v66, v70, -v84
    v_fma_f32 v71, -v66, v71, -v85
    v_mul_f32 v82, v64, v46
    v_mul_f32 v83, v65, v46
    v_exp_f32 v82, v82
    v_fract_f32 v83, v83
    v_cos_f32 v72, v83
    v_sin_f32 v73, v83
    v_mul_f32 v72, v72, v82
    v_mul_f32 v73, v73, v82
    v_mul_f32 v84, v67, v73
    v_mul_f32 v85, v67, v72
    v_fma_f32 v72, v66, v72, -v84
    v_fma_f32 v73, -v66, v73, -v85
    v_mfma_f32_16x16x4_f32 v[48:51], v68, v74, v[48:51]
    v_mfma_f32_16x16x4_f32 v[52:55], v70, v76, v[52:55]
    v_mfma_f32_16x16x4_f32 v[56:59], v70, v78, v[56:59]
    v_mfma_f32_16x16x4_f32 v[60:63], v72, v80, v[60:63]
    v_mfma_f32_16x16x4_f32 v[48:51], v69, v75, v[48:51]
    v_mfma_f32_16x16x4_f32 v[52:55], v71, v77, v[52:55]
    v_mfma_f32_16x16x4_f32 v[56:59], v71, v79, v[56:59]
    v_mfma_f32_16x16x4_f32 v[60:63], v73, v81, v[60:63]
    v_mov_b32_dpp v64, v24 row_newbcast:13 row_mask:0xf bank_mask:0xf
    v_mov_b32_dpp v65, v25 row_newbcast:13 row_mask:0xf bank_mask:0xf
    v_mov_b32_dpp v66, v26 row_newbcast:13 row_mask:0xf bank_mask:0xf
    v_mov_b32_dpp v67, v27 row_newbcast:13 row_mask:0xf bank_mask:0xf
    v_mul_f32 v82, v64, v47
    v_mul_f32 v83, v65, v47
    v_exp_f32 v82, v82
    v_fract_f32 v83, v83
    v_cos_f32 v74, v83
    v_sin_f32 v75, v83
    v_mul_f32 v74, v74, v82
    v_mul_f32 v75, v75, v82
    v_mul_f32 v84, v75, v75
    v_add_f32 v85, v74, v74
    v_fma_f32 v76, v74, v74, -v84
    v_mul_f32 v77, v85, v75
    v_mul_f32 v84, v77, v77
    v_add_f32 v85, v76, v76
    v_fma_f32 v78, v76, v76, -v84
    v_mul_f32 v79, v85, v77
    v_mul_f32 v84, v79, v79
    v_add_f32 v85, v78, v78
    v_fma_f32 v80, v78, v78, -v84
    v_mul_f32 v81, v85, v79
    v_mul_f32 v82, v64, v44
    v_mul_f32 v83, v65, v44
    v_exp_f32 v82, v82
    v_fract_f32 v83, v83
    v_cos_f32 v68, v83
    v_sin_f32 v69, v83
    v_mul_f32 v68, v68, v82
    v_mul_f32 v69, v69, v82
    v_mul_f32 v84, v67, v69
    v_mul_f32 v85, v67, v68
    v_fma_f32 v68, v66, v68, -v84
    v_fma_f32 v69, -v66, v69, -v85
    v_mul_f32 v82, v64, v45
    v_mul_f32 v83, v65, v45
    v_exp_f32 v82, v82
    v_fract_f32 v83, v83
    v_cos_f32 v70, v83
    v_sin_f32 v71, v83
    v_mul_f32 v70, v70, v82
    v_mul_f32 v71, v71, v82
    v_mul_f32 v84, v67, v71
    v_mul_f32 v85, v67, v70
    v_fma_f32 v70, v66, v70, -v84
    v_fma_f32 v71, -v66, v71, -v85
    v_mul_f32 v82, v64, v46
    v_mul_f32 v83, v65, v46
    v_exp_f32 v82, v82
    v_fract_f32 v83, v83
    v_cos_f32 v72, v83
    v_sin_f32 v73, v83
    v_mul_f32 v72, v72, v82
    v_mul_f32 v73, v73, v82
    v_mul_f32 v84, v67, v73
    v_mul_f32 v85, v67, v72
    v_fma_f32 v72, v66, v72, -v84
    v_fma_f32 v73, -v66, v73, -v85
    v_mfma_f32_16x16x4_f32 v[48:51], v68, v74, v[48:51]
    v_mfma_f32_16x16x4_f32 v[52:55], v70, v76, v[52:55]
    v_mfma_f32_16x16x4_f32 v[56:59], v70, v78, v[56:59]
    v_mfma_f32_16x16x4_f32 v[60:63], v72, v80, v[60:63]
    v_mfma_f32_16x16x4_f32 v[48:51], v69, v75, v[48:51]
    v_mfma_f32_16x16x4_f32 v[52:55], v71, v77, v[52:55]
    v_mfma_f32_16x16x4_f32 v[56:59], v71, v79, v[56:59]
    v_mfma_f32_16x16x4_f32 v[60:63], v73, v81, v[60:63]
    v_mov_b32_dpp v64, v24 row_newbcast:14 row_mask:0xf bank_mask:0xf
    v_mov_b32_dpp v65, v25 row_newbcast:14 row_mask:0xf bank_mask:0xf
    v_mov_b32_dpp v66, v26 row_newbcast:14 row_mask:0xf bank_mask:0xf
    v_mov_b32_dpp v67, v27 row_newbcast:14 row_mask:0xf bank_mask:0xf
    v_mul_f32 v82, v64, v47
    v_mul_f32 v83, v65, v47
    v_exp_f32 v82, v82
    v_fract_f32 v83, v83
    v_cos_f32 v74, v83
    v_sin_f32 v75, v83
    v_mul_f32 v74, v74, v82
    v_mul_f32 v75, v75, v82
    v_mul_f32 v84, v75, v75
    v_add_f32 v85, v74, v74
    v_fma_f32 v76, v74, v74, -v84
    v_mul_f32 v77, v85, v75
    v_mul_f32 v84, v77, v77
    v_add_f32 v85, v76, v76
    v_fma_f32 v78, v76, v76, -v84
    v_mul_f32 v79, v85, v77
    v_mul_f32 v84, v79, v79
    v_add_f32 v85, v78, v78
    v_fma_f32 v80, v78, v78, -v84
    v_mul_f32 v81, v85, v79
    v_mul_f32 v82, v64, v44
    v_mul_f32 v83, v65, v44
    v_exp_f32 v82, v82
    v_fract_f32 v83, v83
    v_cos_f32 v68, v83
    v_sin_f32 v69, v83
    v_mul_f32 v68, v68, v82
    v_mul_f32 v69, v69, v82
    v_mul_f32 v84, v67, v69
    v_mul_f32 v85, v67, v68
    v_fma_f32 v68, v66, v68, -v84
    v_fma_f32 v69, -v66, v69, -v85
    v_mul_f32 v82, v64, v45
    v_mul_f32 v83, v65, v45
    v_exp_f32 v82, v82
    v_fract_f32 v83, v83
    v_cos_f32 v70, v83
    v_sin_f32 v71, v83
    v_mul_f32 v70, v70, v82
    v_mul_f32 v71, v71, v82
    v_mul_f32 v84, v67, v71
    v_mul_f32 v85, v67, v70
    v_fma_f32 v70, v66, v70, -v84
    v_fma_f32 v71, -v66, v71, -v85
    v_mul_f32 v82, v64, v46
    v_mul_f32 v83, v65, v46
    v_exp_f32 v82, v82
    v_fract_f32 v83, v83
    v_cos_f32 v72, v83
    v_sin_f32 v73, v83
    v_mul_f32 v72, v72, v82
    v_mul_f32 v73, v73, v82
    v_mul_f32 v84, v67, v73
    v_mul_f32 v85, v67, v72
    v_fma_f32 v72, v66, v72, -v84
    v_fma_f32 v73, -v66, v73, -v85
    v_mfma_f32_16x16x4_f32 v[48:51], v68, v74, v[48:51]
    v_mfma_f32_16x16x4_f32 v[52:55], v70, v76, v[52:55]
    v_mfma_f32_16x16x4_f32 v[56:59], v70, v78, v[56:59]
    v_mfma_f32_16x16x4_f32 v[60:63], v72, v80, v[60:63]
    v_mfma_f32_16x16x4_f32 v[48:51], v69, v75, v[48:51]
    v_mfma_f32_16x16x4_f32 v[52:55], v71, v77, v[52:55]
    v_mfma_f32_16x16x4_f32 v[56:59], v71, v79, v[56:59]
    v_mfma_f32_16x16x4_f32 v[60:63], v73, v81, v[60:63]
    v_mov_b32_dpp v64, v24 row_newbcast:15 row_mask:0xf bank_mask:0xf
    v_mov_b32_dpp v65, v25 row_newbcast:15 row_mask:0xf bank_mask:0xf
    v_mov_b32_dpp v66, v26 row_newbcast:15 row_mask:0xf bank_mask:0xf
    v_mov_b32_dpp v67, v27 row_newbcast:15 row_mask:0xf bank_mask:0xf
    v_mul_f32 v82, v64, v47
    v_mul_f32 v83, v65, v47
    v_exp_f32 v82, v82
    v_fract_f32 v83, v83
    v_cos_f32 v74, v83
    v_sin_f32 v75, v83
    v_mul_f32 v74, v74, v82
    v_mul_f32 v75, v75, v82
    v_mul_f32 v84, v75, v75
    v_add_f32 v85, v74, v74
    v_fma_f32 v76, v74, v74, -v84
    v_mul_f32 v77, v85, v75
    v_mul_f32 v84, v77, v77
    v_add_f32 v85, v76, v76
    v_fma_f32 v78, v76, v76, -v84
    v_mul_f32 v79, v85, v77
    v_mul_f32 v84, v79, v79
    v_add_f32 v85, v78, v78
    v_fma_f32 v80, v78, v78, -v84
    v_mul_f32 v81, v85, v79
    v_mul_f32 v82, v64, v44
    v_mul_f32 v83, v65, v44
    v_exp_f32 v82, v82
    v_fract_f32 v83, v83
    v_cos_f32 v68, v83
    v_sin_f32 v69, v83
    v_mul_f32 v68, v68, v82
    v_mul_f32 v69, v69, v82
    v_mul_f32 v84, v67, v69
    v_mul_f32 v85, v67, v68
    v_fma_f32 v68, v66, v68, -v84
    v_fma_f32 v69, -v66, v69, -v85
    v_mul_f32 v82, v64, v45
    v_mul_f32 v83, v65, v45
    v_exp_f32 v82, v82
    v_fract_f32 v83, v83
    v_cos_f32 v70, v83
    v_sin_f32 v71, v83
    v_mul_f32 v70, v70, v82
    v_mul_f32 v71, v71, v82
    v_mul_f32 v84, v67, v71
    v_mul_f32 v85, v67, v70
    v_fma_f32 v70, v66, v70, -v84
    v_fma_f32 v71, -v66, v71, -v85
    v_mul_f32 v82, v64, v46
    v_mul_f32 v83, v65, v46
    v_exp_f32 v82, v82
    v_fract_f32 v83, v83
    v_cos_f32 v72, v83
    v_sin_f32 v73, v83
    v_mul_f32 v72, v72, v82
    v_mul_f32 v73, v73, v82
    v_mul_f32 v84, v67, v73
    v_mul_f32 v85, v67, v72
    v_fma_f32 v72, v66, v72, -v84
    v_fma_f32 v73, -v66, v73, -v85
    v_mfma_f32_16x16x4_f32 v[48:51], v68, v74, v[48:51]
    v_mfma_f32_16x16x4_f32 v[52:55], v70, v76, v[52:55]
    v_mfma_f32_16x16x4_f32 v[56:59], v70, v78, v[56:59]
    v_mfma_f32_16x16x4_f32 v[60:63], v72, v80, v[60:63]
    v_mfma_f32_16x16x4_f32 v[48:51], v69, v75, v[48:51]
    v_mfma_f32_16x16x4_f32 v[52:55], v71, v77, v[52:55]
    v_mfma_f32_16x16x4_f32 v[56:59], v71, v79, v[56:59]
    v_mfma_f32_16x16x4_f32 v[60:63], v73, v81, v[60:63]
    v_mov_b32_dpp v64, v28 row_newbcast:0 row_mask:0xf bank_mask:0xf
    v_mov_b32_dpp v65, v29 row_newbcast:0 row_mask:0xf bank_mask:0xf
    v_mov_b32_dpp v66, v30 row_newbcast:0 row_mask:0xf bank_mask:0xf
    v_mov_b32_dpp v67, v31 row_newbcast:0 row_mask:0xf bank_mask:0xf
    v_mul_f32 v82, v64, v47
    v_mul_f32 v83, v65, v47
    v_exp_f32 v82, v82
    v_fract_f32 v83, v83
    v_cos_f32 v74, v83
    v_sin_f32 v75, v83
    v_mul_f32 v74, v74, v82
    v_mul_f32 v75, v75, v82
    v_mul_f32 v84, v75, v75
    v_add_f32 v85, v74, v74
    v_fma_f32 v76, v74, v74, -v84
    v_mul_f32 v77, v85, v75
    v_mul_f32 v84, v77, v77
    v_add_f32 v85, v76, v76
    v_fma_f32 v78, v76, v76, -v84
    v_mul_f32 v79, v85, v77
    v_mul_f32 v84, v79, v79
    v_add_f32 v85, v78, v78
    v_fma_f32 v80, v78, v78, -v84
    v_mul_f32 v81, v85, v79
    v_mul_f32 v82, v64, v44
    v_mul_f32 v83, v65, v44
    v_exp_f32 v82, v82
    v_fract_f32 v83, v83
    v_cos_f32 v68, v83
    v_sin_f32 v69, v83
    v_mul_f32 v68, v68, v82
    v_mul_f32 v69, v69, v82
    v_mul_f32 v84, v67, v69
    v_mul_f32 v85, v67, v68
    v_fma_f32 v68, v66, v68, -v84
    v_fma_f32 v69, -v66, v69, -v85
    v_mul_f32 v82, v64, v45
    v_mul_f32 v83, v65, v45
    v_exp_f32 v82, v82
    v_fract_f32 v83, v83
    v_cos_f32 v70, v83
    v_sin_f32 v71, v83
    v_mul_f32 v70, v70, v82
    v_mul_f32 v71, v71, v82
    v_mul_f32 v84, v67, v71
    v_mul_f32 v85, v67, v70
    v_fma_f32 v70, v66, v70, -v84
    v_fma_f32 v71, -v66, v71, -v85
    v_mul_f32 v82, v64, v46
    v_mul_f32 v83, v65, v46
    v_exp_f32 v82, v82
    v_fract_f32 v83, v83
    v_cos_f32 v72, v83
    v_sin_f32 v73, v83
    v_mul_f32 v72, v72, v82
    v_mul_f32 v73, v73, v82
    v_mul_f32 v84, v67, v73
    v_mul_f32 v85, v67, v72
    v_fma_f32 v72, v66, v72, -v84
    v_fma_f32 v73, -v66, v73, -v85
    v_mfma_f32_16x16x4_f32 v[48:51], v68, v74, v[48:51]
    v_mfma_f32_16x16x4_f32 v[52:55], v70, v76, v[52:55]
    v_mfma_f32_16x16x4_f32 v[56:59], v70, v78, v[56:59]
    v_mfma_f32_16x16x4_f32 v[60:63], v72, v80, v[60:63]
    v_mfma_f32_16x16x4_f32 v[48:51], v69, v75, v[48:51]
    v_mfma_f32_16x16x4_f32 v[52:55], v71, v77, v[52:55]
    v_mfma_f32_16x16x4_f32 v[56:59], v71, v79, v[56:59]
    v_mfma_f32_16x16x4_f32 v[60:63], v73, v81, v[60:63]
    v_mov_b32_dpp v64, v28 row_newbcast:1 row_mask:0xf bank_mask:0xf
    v_mov_b32_dpp v65, v29 row_newbcast:1 row_mask:0xf bank_mask:0xf
    v_mov_b32_dpp v66, v30 row_newbcast:1 row_mask:0xf bank_mask:0xf
    v_mov_b32_dpp v67, v31 row_newbcast:1 row_mask:0xf bank_mask:0xf
    v_mul_f32 v82, v64, v47
    v_mul_f32 v83, v65, v47
    v_exp_f32 v82, v82
    v_fract_f32 v83, v83
    v_cos_f32 v74, v83
    v_sin_f32 v75, v83
    v_mul_f32 v74, v74, v82
    v_mul_f32 v75, v75, v82
    v_mul_f32 v84, v75, v75
    v_add_f32 v85, v74, v74
    v_fma_f32 v76, v74, v74, -v84
    v_mul_f32 v77, v85, v75
    v_mul_f32 v84, v77, v77
    v_add_f32 v85, v76, v76
    v_fma_f32 v78, v76, v76, -v84
    v_mul_f32 v79, v85, v77
    v_mul_f32 v84, v79, v79
    v_add_f32 v85, v78, v78
    v_fma_f32 v80, v78, v78, -v84
    v_mul_f32 v81, v85, v79
    v_mul_f32 v82, v64, v44
    v_mul_f32 v83, v65, v44
    v_exp_f32 v82, v82
    v_fract_f32 v83, v83
    v_cos_f32 v68, v83
    v_sin_f32 v69, v83
    v_mul_f32 v68, v68, v82
    v_mul_f32 v69, v69, v82
    v_mul_f32 v84, v67, v69
    v_mul_f32 v85, v67, v68
    v_fma_f32 v68, v66, v68, -v84
    v_fma_f32 v69, -v66, v69, -v85
    v_mul_f32 v82, v64, v45
    v_mul_f32 v83, v65, v45
    v_exp_f32 v82, v82
    v_fract_f32 v83, v83
    v_cos_f32 v70, v83
    v_sin_f32 v71, v83
    v_mul_f32 v70, v70, v82
    v_mul_f32 v71, v71, v82
    v_mul_f32 v84, v67, v71
    v_mul_f32 v85, v67, v70
    v_fma_f32 v70, v66, v70, -v84
    v_fma_f32 v71, -v66, v71, -v85
    v_mul_f32 v82, v64, v46
    v_mul_f32 v83, v65, v46
    v_exp_f32 v82, v82
    v_fract_f32 v83, v83
    v_cos_f32 v72, v83
    v_sin_f32 v73, v83
    v_mul_f32 v72, v72, v82
    v_mul_f32 v73, v73, v82
    v_mul_f32 v84, v67, v73
    v_mul_f32 v85, v67, v72
    v_fma_f32 v72, v66, v72, -v84
    v_fma_f32 v73, -v66, v73, -v85
    v_mfma_f32_16x16x4_f32 v[48:51], v68, v74, v[48:51]
    v_mfma_f32_16x16x4_f32 v[52:55], v70, v76, v[52:55]
    v_mfma_f32_16x16x4_f32 v[56:59], v70, v78, v[56:59]
    v_mfma_f32_16x16x4_f32 v[60:63], v72, v80, v[60:63]
    v_mfma_f32_16x16x4_f32 v[48:51], v69, v75, v[48:51]
    v_mfma_f32_16x16x4_f32 v[52:55], v71, v77, v[52:55]
    v_mfma_f32_16x16x4_f32 v[56:59], v71, v79, v[56:59]
    v_mfma_f32_16x16x4_f32 v[60:63], v73, v81, v[60:63]
    v_mov_b32_dpp v64, v28 row_newbcast:2 row_mask:0xf bank_mask:0xf
    v_mov_b32_dpp v65, v29 row_newbcast:2 row_mask:0xf bank_mask:0xf
    v_mov_b32_dpp v66, v30 row_newbcast:2 row_mask:0xf bank_mask:0xf
    v_mov_b32_dpp v67, v31 row_newbcast:2 row_mask:0xf bank_mask:0xf
    v_mul_f32 v82, v64, v47
    v_mul_f32 v83, v65, v47
    v_exp_f32 v82, v82
    v_fract_f32 v83, v83
    v_cos_f32 v74, v83
    v_sin_f32 v75, v83
    v_mul_f32 v74, v74, v82
    v_mul_f32 v75, v75, v82
    v_mul_f32 v84, v75, v75
    v_add_f32 v85, v74, v74
    v_fma_f32 v76, v74, v74, -v84
    v_mul_f32 v77, v85, v75
    v_mul_f32 v84, v77, v77
    v_add_f32 v85, v76, v76
    v_fma_f32 v78, v76, v76, -v84
    v_mul_f32 v79, v85, v77
    v_mul_f32 v84, v79, v79
    v_add_f32 v85, v78, v78
    v_fma_f32 v80, v78, v78, -v84
    v_mul_f32 v81, v85, v79
    v_mul_f32 v82, v64, v44
    v_mul_f32 v83, v65, v44
    v_exp_f32 v82, v82
    v_fract_f32 v83, v83
    v_cos_f32 v68, v83
    v_sin_f32 v69, v83
    v_mul_f32 v68, v68, v82
    v_mul_f32 v69, v69, v82
    v_mul_f32 v84, v67, v69
    v_mul_f32 v85, v67, v68
    v_fma_f32 v68, v66, v68, -v84
    v_fma_f32 v69, -v66, v69, -v85
    v_mul_f32 v82, v64, v45
    v_mul_f32 v83, v65, v45
    v_exp_f32 v82, v82
    v_fract_f32 v83, v83
    v_cos_f32 v70, v83
    v_sin_f32 v71, v83
    v_mul_f32 v70, v70, v82
    v_mul_f32 v71, v71, v82
    v_mul_f32 v84, v67, v71
    v_mul_f32 v85, v67, v70
    v_fma_f32 v70, v66, v70, -v84
    v_fma_f32 v71, -v66, v71, -v85
    v_mul_f32 v82, v64, v46
    v_mul_f32 v83, v65, v46
    v_exp_f32 v82, v82
    v_fract_f32 v83, v83
    v_cos_f32 v72, v83
    v_sin_f32 v73, v83
    v_mul_f32 v72, v72, v82
    v_mul_f32 v73, v73, v82
    v_mul_f32 v84, v67, v73
    v_mul_f32 v85, v67, v72
    v_fma_f32 v72, v66, v72, -v84
    v_fma_f32 v73, -v66, v73, -v85
    v_mfma_f32_16x16x4_f32 v[48:51], v68, v74, v[48:51]
    v_mfma_f32_16x16x4_f32 v[52:55], v70, v76, v[52:55]
    v_mfma_f32_16x16x4_f32 v[56:59], v70, v78, v[56:59]
    v_mfma_f32_16x16x4_f32 v[60:63], v72, v80, v[60:63]
    v_mfma_f32_16x16x4_f32 v[48:51], v69, v75, v[48:51]
    v_mfma_f32_16x16x4_f32 v[52:55], v71, v77, v[52:55]
    v_mfma_f32_16x16x4_f32 v[56:59], v71, v79, v[56:59]
    v_mfma_f32_16x16x4_f32 v[60:63], v73, v81, v[60:63]
    v_mov_b32_dpp v64, v28 row_newbcast:3 row_mask:0xf bank_mask:0xf
    v_mov_b32_dpp v65, v29 row_newbcast:3 row_mask:0xf bank_mask:0xf
    v_mov_b32_dpp v66, v30 row_newbcast:3 row_mask:0xf bank_mask:0xf
    v_mov_b32_dpp v67, v31 row_newbcast:3 row_mask:0xf bank_mask:0xf
    v_mul_f32 v82, v64, v47
    v_mul_f32 v83, v65, v47
    v_exp_f32 v82, v82
    v_fract_f32 v83, v83
    v_cos_f32 v74, v83
    v_sin_f32 v75, v83
    v_mul_f32 v74, v74, v82
    v_mul_f32 v75, v75, v82
    v_mul_f32 v84, v75, v75
    v_add_f32 v85, v74, v74
    v_fma_f32 v76, v74, v74, -v84
    v_mul_f32 v77, v85, v75
    v_mul_f32 v84, v77, v77
    v_add_f32 v85, v76, v76
    v_fma_f32 v78, v76, v76, -v84
    v_mul_f32 v79, v85, v77
    v_mul_f32 v84, v79, v79
    v_add_f32 v85, v78, v78
    v_fma_f32 v80, v78, v78, -v84
    v_mul_f32 v81, v85, v79
    v_mul_f32 v82, v64, v44
    v_mul_f32 v83, v65, v44
    v_exp_f32 v82, v82
    v_fract_f32 v83, v83
    v_cos_f32 v68, v83
    v_sin_f32 v69, v83
    v_mul_f32 v68, v68, v82
    v_mul_f32 v69, v69, v82
    v_mul_f32 v84, v67, v69
    v_mul_f32 v85, v67, v68
    v_fma_f32 v68, v66, v68, -v84
    v_fma_f32 v69, -v66, v69, -v85
    v_mul_f32 v82, v64, v45
    v_mul_f32 v83, v65, v45
    v_exp_f32 v82, v82
    v_fract_f32 v83, v83
    v_cos_f32 v70, v83
    v_sin_f32 v71, v83
    v_mul_f32 v70, v70, v82
    v_mul_f32 v71, v71, v82
    v_mul_f32 v84, v67, v71
    v_mul_f32 v85, v67, v70
    v_fma_f32 v70, v66, v70, -v84
    v_fma_f32 v71, -v66, v71, -v85
    v_mul_f32 v82, v64, v46
    v_mul_f32 v83, v65, v46
    v_exp_f32 v82, v82
    v_fract_f32 v83, v83
    v_cos_f32 v72, v83
    v_sin_f32 v73, v83
    v_mul_f32 v72, v72, v82
    v_mul_f32 v73, v73, v82
    v_mul_f32 v84, v67, v73
    v_mul_f32 v85, v67, v72
    v_fma_f32 v72, v66, v72, -v84
    v_fma_f32 v73, -v66, v73, -v85
    v_mfma_f32_16x16x4_f32 v[48:51], v68, v74, v[48:51]
    v_mfma_f32_16x16x4_f32 v[52:55], v70, v76, v[52:55]
    v_mfma_f32_16x16x4_f32 v[56:59], v70, v78, v[56:59]
    v_mfma_f32_16x16x4_f32 v[60:63], v72, v80, v[60:63]
    v_mfma_f32_16x16x4_f32 v[48:51], v69, v75, v[48:51]
    v_mfma_f32_16x16x4_f32 v[52:55], v71, v77, v[52:55]
    v_mfma_f32_16x16x4_f32 v[56:59], v71, v79, v[56:59]
    v_mfma_f32_16x16x4_f32 v[60:63], v73, v81, v[60:63]
    v_mov_b32_dpp v64, v28 row_newbcast:4 row_mask:0xf bank_mask:0xf
    v_mov_b32_dpp v65, v29 row_newbcast:4 row_mask:0xf bank_mask:0xf
    v_mov_b32_dpp v66, v30 row_newbcast:4 row_mask:0xf bank_mask:0xf
    v_mov_b32_dpp v67, v31 row_newbcast:4 row_mask:0xf bank_mask:0xf
    v_mul_f32 v82, v64, v47
    v_mul_f32 v83, v65, v47
    v_exp_f32 v82, v82
    v_fract_f32 v83, v83
    v_cos_f32 v74, v83
    v_sin_f32 v75, v83
    v_mul_f32 v74, v74, v82
    v_mul_f32 v75, v75, v82
    v_mul_f32 v84, v75, v75
    v_add_f32 v85, v74, v74
    v_fma_f32 v76, v74, v74, -v84
    v_mul_f32 v77, v85, v75
    v_mul_f32 v84, v77, v77
    v_add_f32 v85, v76, v76
    v_fma_f32 v78, v76, v76, -v84
    v_mul_f32 v79, v85, v77
    v_mul_f32 v84, v79, v79
    v_add_f32 v85, v78, v78
    v_fma_f32 v80, v78, v78, -v84
    v_mul_f32 v81, v85, v79
    v_mul_f32 v82, v64, v44
    v_mul_f32 v83, v65, v44
    v_exp_f32 v82, v82
    v_fract_f32 v83, v83
    v_cos_f32 v68, v83
    v_sin_f32 v69, v83
    v_mul_f32 v68, v68, v82
    v_mul_f32 v69, v69, v82
    v_mul_f32 v84, v67, v69
    v_mul_f32 v85, v67, v68
    v_fma_f32 v68, v66, v68, -v84
    v_fma_f32 v69, -v66, v69, -v85
    v_mul_f32 v82, v64, v45
    v_mul_f32 v83, v65, v45
    v_exp_f32 v82, v82
    v_fract_f32 v83, v83
    v_cos_f32 v70, v83
    v_sin_f32 v71, v83
    v_mul_f32 v70, v70, v82
    v_mul_f32 v71, v71, v82
    v_mul_f32 v84, v67, v71
    v_mul_f32 v85, v67, v70
    v_fma_f32 v70, v66, v70, -v84
    v_fma_f32 v71, -v66, v71, -v85
    v_mul_f32 v82, v64, v46
    v_mul_f32 v83, v65, v46
    v_exp_f32 v82, v82
    v_fract_f32 v83, v83
    v_cos_f32 v72, v83
    v_sin_f32 v73, v83
    v_mul_f32 v72, v72, v82
    v_mul_f32 v73, v73, v82
    v_mul_f32 v84, v67, v73
    v_mul_f32 v85, v67, v72
    v_fma_f32 v72, v66, v72, -v84
    v_fma_f32 v73, -v66, v73, -v85
    v_mfma_f32_16x16x4_f32 v[48:51], v68, v74, v[48:51]
    v_mfma_f32_16x16x4_f32 v[52:55], v70, v76, v[52:55]
    v_mfma_f32_16x16x4_f32 v[56:59], v70, v78, v[56:59]
    v_mfma_f32_16x16x4_f32 v[60:63], v72, v80, v[60:63]
    v_mfma_f32_16x16x4_f32 v[48:51], v69, v75, v[48:51]
    v_mfma_f32_16x16x4_f32 v[52:55], v71, v77, v[52:55]
    v_mfma_f32_16x16x4_f32 v[56:59], v71, v79, v[56:59]
    v_mfma_f32_16x16x4_f32 v[60:63], v73, v81, v[60:63]
    v_mov_b32_dpp v64, v28 row_newbcast:5 row_mask:0xf bank_mask:0xf
    v_mov_b32_dpp v65, v29 row_newbcast:5 row_mask:0xf bank_mask:0xf
    v_mov_b32_dpp v66, v30 row_newbcast:5 row_mask:0xf bank_mask:0xf
    v_mov_b32_dpp v67, v31 row_newbcast:5 row_mask:0xf bank_mask:0xf
    v_mul_f32 v82, v64, v47
    v_mul_f32 v83, v65, v47
    v_exp_f32 v82, v82
    v_fract_f32 v83, v83
    v_cos_f32 v74, v83
    v_sin_f32 v75, v83
    v_mul_f32 v74, v74, v82
    v_mul_f32 v75, v75, v82
    v_mul_f32 v84, v75, v75
    v_add_f32 v85, v74, v74
    v_fma_f32 v76, v74, v74, -v84
    v_mul_f32 v77, v85, v75
    v_mul_f32 v84, v77, v77
    v_add_f32 v85, v76, v76
    v_fma_f32 v78, v76, v76, -v84
    v_mul_f32 v79, v85, v77
    v_mul_f32 v84, v79, v79
    v_add_f32 v85, v78, v78
    v_fma_f32 v80, v78, v78, -v84
    v_mul_f32 v81, v85, v79
    v_mul_f32 v82, v64, v44
    v_mul_f32 v83, v65, v44
    v_exp_f32 v82, v82
    v_fract_f32 v83, v83
    v_cos_f32 v68, v83
    v_sin_f32 v69, v83
    v_mul_f32 v68, v68, v82
    v_mul_f32 v69, v69, v82
    v_mul_f32 v84, v67, v69
    v_mul_f32 v85, v67, v68
    v_fma_f32 v68, v66, v68, -v84
    v_fma_f32 v69, -v66, v69, -v85
    v_mul_f32 v82, v64, v45
    v_mul_f32 v83, v65, v45
    v_exp_f32 v82, v82
    v_fract_f32 v83, v83
    v_cos_f32 v70, v83
    v_sin_f32 v71, v83
    v_mul_f32 v70, v70, v82
    v_mul_f32 v71, v71, v82
    v_mul_f32 v84, v67, v71
    v_mul_f32 v85, v67, v70
    v_fma_f32 v70, v66, v70, -v84
    v_fma_f32 v71, -v66, v71, -v85
    v_mul_f32 v82, v64, v46
    v_mul_f32 v83, v65, v46
    v_exp_f32 v82, v82
    v_fract_f32 v83, v83
    v_cos_f32 v72, v83
    v_sin_f32 v73, v83
    v_mul_f32 v72, v72, v82
    v_mul_f32 v73, v73, v82
    v_mul_f32 v84, v67, v73
    v_mul_f32 v85, v67, v72
    v_fma_f32 v72, v66, v72, -v84
    v_fma_f32 v73, -v66, v73, -v85
    v_mfma_f32_16x16x4_f32 v[48:51], v68, v74, v[48:51]
    v_mfma_f32_16x16x4_f32 v[52:55], v70, v76, v[52:55]
    v_mfma_f32_16x16x4_f32 v[56:59], v70, v78, v[56:59]
    v_mfma_f32_16x16x4_f32 v[60:63], v72, v80, v[60:63]
    v_mfma_f32_16x16x4_f32 v[48:51], v69, v75, v[48:51]
    v_mfma_f32_16x16x4_f32 v[52:55], v71, v77, v[52:55]
    v_mfma_f32_16x16x4_f32 v[56:59], v71, v79, v[56:59]
    v_mfma_f32_16x16x4_f32 v[60:63], v73, v81, v[60:63]
    v_mov_b32_dpp v64, v28 row_newbcast:6 row_mask:0xf bank_mask:0xf
    v_mov_b32_dpp v65, v29 row_newbcast:6 row_mask:0xf bank_mask:0xf
    v_mov_b32_dpp v66, v30 row_newbcast:6 row_mask:0xf bank_mask:0xf
    v_mov_b32_dpp v67, v31 row_newbcast:6 row_mask:0xf bank_mask:0xf
    v_mul_f32 v82, v64, v47
    v_mul_f32 v83, v65, v47
    v_exp_f32 v82, v82
    v_fract_f32 v83, v83
    v_cos_f32 v74, v83
    v_sin_f32 v75, v83
    v_mul_f32 v74, v74, v82
    v_mul_f32 v75, v75, v82
    v_mul_f32 v84, v75, v75
    v_add_f32 v85, v74, v74
    v_fma_f32 v76, v74, v74, -v84
    v_mul_f32 v77, v85, v75
    v_mul_f32 v84, v77, v77
    v_add_f32 v85, v76, v76
    v_fma_f32 v78, v76, v76, -v84
    v_mul_f32 v79, v85, v77
    v_mul_f32 v84, v79, v79
    v_add_f32 v85, v78, v78
    v_fma_f32 v80, v78, v78, -v84
    v_mul_f32 v81, v85, v79
    v_mul_f32 v82, v64, v44
    v_mul_f32 v83, v65, v44
    v_exp_f32 v82, v82
    v_fract_f32 v83, v83
    v_cos_f32 v68, v83
    v_sin_f32 v69, v83
    v_mul_f32 v68, v68, v82
    v_mul_f32 v69, v69, v82
    v_mul_f32 v84, v67, v69
    v_mul_f32 v85, v67, v68
    v_fma_f32 v68, v66, v68, -v84
    v_fma_f32 v69, -v66, v69, -v85
    v_mul_f32 v82, v64, v45
    v_mul_f32 v83, v65, v45
    v_exp_f32 v82, v82
    v_fract_f32 v83, v83
    v_cos_f32 v70, v83
    v_sin_f32 v71, v83
    v_mul_f32 v70, v70, v82
    v_mul_f32 v71, v71, v82
    v_mul_f32 v84, v67, v71
    v_mul_f32 v85, v67, v70
    v_fma_f32 v70, v66, v70, -v84
    v_fma_f32 v71, -v66, v71, -v85
    v_mul_f32 v82, v64, v46
    v_mul_f32 v83, v65, v46
    v_exp_f32 v82, v82
    v_fract_f32 v83, v83
    v_cos_f32 v72, v83
    v_sin_f32 v73, v83
    v_mul_f32 v72, v72, v82
    v_mul_f32 v73, v73, v82
    v_mul_f32 v84, v67, v73
    v_mul_f32 v85, v67, v72
    v_fma_f32 v72, v66, v72, -v84
    v_fma_f32 v73, -v66, v73, -v85
    v_mfma_f32_16x16x4_f32 v[48:51], v68, v74, v[48:51]
    v_mfma_f32_16x16x4_f32 v[52:55], v70, v76, v[52:55]
    v_mfma_f32_16x16x4_f32 v[56:59], v70, v78, v[56:59]
    v_mfma_f32_16x16x4_f32 v[60:63], v72, v80, v[60:63]
    v_mfma_f32_16x16x4_f32 v[48:51], v69, v75, v[48:51]
    v_mfma_f32_16x16x4_f32 v[52:55], v71, v77, v[52:55]
    v_mfma_f32_16x16x4_f32 v[56:59], v71, v79, v[56:59]
    v_mfma_f32_16x16x4_f32 v[60:63], v73, v81, v[60:63]
    v_mov_b32_dpp v64, v28 row_newbcast:7 row_mask:0xf bank_mask:0xf
    v_mov_b32_dpp v65, v29 row_newbcast:7 row_mask:0xf bank_mask:0xf
    v_mov_b32_dpp v66, v30 row_newbcast:7 row_mask:0xf bank_mask:0xf
    v_mov_b32_dpp v67, v31 row_newbcast:7 row_mask:0xf bank_mask:0xf
    v_mul_f32 v82, v64, v47
    v_mul_f32 v83, v65, v47
    v_exp_f32 v82, v82
    v_fract_f32 v83, v83
    v_cos_f32 v74, v83
    v_sin_f32 v75, v83
    v_mul_f32 v74, v74, v82
    v_mul_f32 v75, v75, v82
    v_mul_f32 v84, v75, v75
    v_add_f32 v85, v74, v74
    v_fma_f32 v76, v74, v74, -v84
    v_mul_f32 v77, v85, v75
    v_mul_f32 v84, v77, v77
    v_add_f32 v85, v76, v76
    v_fma_f32 v78, v76, v76, -v84
    v_mul_f32 v79, v85, v77
    v_mul_f32 v84, v79, v79
    v_add_f32 v85, v78, v78
    v_fma_f32 v80, v78, v78, -v84
    v_mul_f32 v81, v85, v79
    v_mul_f32 v82, v64, v44
    v_mul_f32 v83, v65, v44
    v_exp_f32 v82, v82
    v_fract_f32 v83, v83
    v_cos_f32 v68, v83
    v_sin_f32 v69, v83
    v_mul_f32 v68, v68, v82
    v_mul_f32 v69, v69, v82
    v_mul_f32 v84, v67, v69
    v_mul_f32 v85, v67, v68
    v_fma_f32 v68, v66, v68, -v84
    v_fma_f32 v69, -v66, v69, -v85
    v_mul_f32 v82, v64, v45
    v_mul_f32 v83, v65, v45
    v_exp_f32 v82, v82
    v_fract_f32 v83, v83
    v_cos_f32 v70, v83
    v_sin_f32 v71, v83
    v_mul_f32 v70, v70, v82
    v_mul_f32 v71, v71, v82
    v_mul_f32 v84, v67, v71
    v_mul_f32 v85, v67, v70
    v_fma_f32 v70, v66, v70, -v84
    v_fma_f32 v71, -v66, v71, -v85
    v_mul_f32 v82, v64, v46
    v_mul_f32 v83, v65, v46
    v_exp_f32 v82, v82
    v_fract_f32 v83, v83
    v_cos_f32 v72, v83
    v_sin_f32 v73, v83
    v_mul_f32 v72, v72, v82
    v_mul_f32 v73, v73, v82
    v_mul_f32 v84, v67, v73
    v_mul_f32 v85, v67, v72
    v_fma_f32 v72, v66, v72, -v84
    v_fma_f32 v73, -v66, v73, -v85
    v_mfma_f32_16x16x4_f32 v[48:51], v68, v74, v[48:51]
    v_mfma_f32_16x16x4_f32 v[52:55], v70, v76, v[52:55]
    v_mfma_f32_16x16x4_f32 v[56:59], v70, v78, v[56:59]
    v_mfma_f32_16x16x4_f32 v[60:63], v72, v80, v[60:63]
    v_mfma_f32_16x16x4_f32 v[48:51], v69, v75, v[48:51]
    v_mfma_f32_16x16x4_f32 v[52:55], v71, v77, v[52:55]
    v_mfma_f32_16x16x4_f32 v[56:59], v71, v79, v[56:59]
    v_mfma_f32_16x16x4_f32 v[60:63], v73, v81, v[60:63]
    v_mov_b32_dpp v64, v28 row_newbcast:8 row_mask:0xf bank_mask:0xf
    v_mov_b32_dpp v65, v29 row_newbcast:8 row_mask:0xf bank_mask:0xf
    v_mov_b32_dpp v66, v30 row_newbcast:8 row_mask:0xf bank_mask:0xf
    v_mov_b32_dpp v67, v31 row_newbcast:8 row_mask:0xf bank_mask:0xf
    v_mul_f32 v82, v64, v47
    v_mul_f32 v83, v65, v47
    v_exp_f32 v82, v82
    v_fract_f32 v83, v83
    v_cos_f32 v74, v83
    v_sin_f32 v75, v83
    v_mul_f32 v74, v74, v82
    v_mul_f32 v75, v75, v82
    v_mul_f32 v84, v75, v75
    v_add_f32 v85, v74, v74
    v_fma_f32 v76, v74, v74, -v84
    v_mul_f32 v77, v85, v75
    v_mul_f32 v84, v77, v77
    v_add_f32 v85, v76, v76
    v_fma_f32 v78, v76, v76, -v84
    v_mul_f32 v79, v85, v77
    v_mul_f32 v84, v79, v79
    v_add_f32 v85, v78, v78
    v_fma_f32 v80, v78, v78, -v84
    v_mul_f32 v81, v85, v79
    v_mul_f32 v82, v64, v44
    v_mul_f32 v83, v65, v44
    v_exp_f32 v82, v82
    v_fract_f32 v83, v83
    v_cos_f32 v68, v83
    v_sin_f32 v69, v83
    v_mul_f32 v68, v68, v82
    v_mul_f32 v69, v69, v82
    v_mul_f32 v84, v67, v69
    v_mul_f32 v85, v67, v68
    v_fma_f32 v68, v66, v68, -v84
    v_fma_f32 v69, -v66, v69, -v85
    v_mul_f32 v82, v64, v45
    v_mul_f32 v83, v65, v45
    v_exp_f32 v82, v82
    v_fract_f32 v83, v83
    v_cos_f32 v70, v83
    v_sin_f32 v71, v83
    v_mul_f32 v70, v70, v82
    v_mul_f32 v71, v71, v82
    v_mul_f32 v84, v67, v71
    v_mul_f32 v85, v67, v70
    v_fma_f32 v70, v66, v70, -v84
    v_fma_f32 v71, -v66, v71, -v85
    v_mul_f32 v82, v64, v46
    v_mul_f32 v83, v65, v46
    v_exp_f32 v82, v82
    v_fract_f32 v83, v83
    v_cos_f32 v72, v83
    v_sin_f32 v73, v83
    v_mul_f32 v72, v72, v82
    v_mul_f32 v73, v73, v82
    v_mul_f32 v84, v67, v73
    v_mul_f32 v85, v67, v72
    v_fma_f32 v72, v66, v72, -v84
    v_fma_f32 v73, -v66, v73, -v85
    v_mfma_f32_16x16x4_f32 v[48:51], v68, v74, v[48:51]
    v_mfma_f32_16x16x4_f32 v[52:55], v70, v76, v[52:55]
    v_mfma_f32_16x16x4_f32 v[56:59], v70, v78, v[56:59]
    v_mfma_f32_16x16x4_f32 v[60:63], v72, v80, v[60:63]
    v_mfma_f32_16x16x4_f32 v[48:51], v69, v75, v[48:51]
    v_mfma_f32_16x16x4_f32 v[52:55], v71, v77, v[52:55]
    v_mfma_f32_16x16x4_f32 v[56:59], v71, v79, v[56:59]
    v_mfma_f32_16x16x4_f32 v[60:63], v73, v81, v[60:63]
    v_mov_b32_dpp v64, v28 row_newbcast:9 row_mask:0xf bank_mask:0xf
    v_mov_b32_dpp v65, v29 row_newbcast:9 row_mask:0xf bank_mask:0xf
    v_mov_b32_dpp v66, v30 row_newbcast:9 row_mask:0xf bank_mask:0xf
    v_mov_b32_dpp v67, v31 row_newbcast:9 row_mask:0xf bank_mask:0xf
    v_mul_f32 v82, v64, v47
    v_mul_f32 v83, v65, v47
    v_exp_f32 v82, v82
    v_fract_f32 v83, v83
    v_cos_f32 v74, v83
    v_sin_f32 v75, v83
    v_mul_f32 v74, v74, v82
    v_mul_f32 v75, v75, v82
    v_mul_f32 v84, v75, v75
    v_add_f32 v85, v74, v74
    v_fma_f32 v76, v74, v74, -v84
    v_mul_f32 v77, v85, v75
    v_mul_f32 v84, v77, v77
    v_add_f32 v85, v76, v76
    v_fma_f32 v78, v76, v76, -v84
    v_mul_f32 v79, v85, v77
    v_mul_f32 v84, v79, v79
    v_add_f32 v85, v78, v78
    v_fma_f32 v80, v78, v78, -v84
    v_mul_f32 v81, v85, v79
    v_mul_f32 v82, v64, v44
    v_mul_f32 v83, v65, v44
    v_exp_f32 v82, v82
    v_fract_f32 v83, v83
    v_cos_f32 v68, v83
    v_sin_f32 v69, v83
    v_mul_f32 v68, v68, v82
    v_mul_f32 v69, v69, v82
    v_mul_f32 v84, v67, v69
    v_mul_f32 v85, v67, v68
    v_fma_f32 v68, v66, v68, -v84
    v_fma_f32 v69, -v66, v69, -v85
    v_mul_f32 v82, v64, v45
    v_mul_f32 v83, v65, v45
    v_exp_f32 v82, v82
    v_fract_f32 v83, v83
    v_cos_f32 v70, v83
    v_sin_f32 v71, v83
    v_mul_f32 v70, v70, v82
    v_mul_f32 v71, v71, v82
    v_mul_f32 v84, v67, v71
    v_mul_f32 v85, v67, v70
    v_fma_f32 v70, v66, v70, -v84
    v_fma_f32 v71, -v66, v71, -v85
    v_mul_f32 v82, v64, v46
    v_mul_f32 v83, v65, v46
    v_exp_f32 v82, v82
    v_fract_f32 v83, v83
    v_cos_f32 v72, v83
    v_sin_f32 v73, v83
    v_mul_f32 v72, v72, v82
    v_mul_f32 v73, v73, v82
    v_mul_f32 v84, v67, v73
    v_mul_f32 v85, v67, v72
    v_fma_f32 v72, v66, v72, -v84
    v_fma_f32 v73, -v66, v73, -v85
    v_mfma_f32_16x16x4_f32 v[48:51], v68, v74, v[48:51]
    v_mfma_f32_16x16x4_f32 v[52:55], v70, v76, v[52:55]
    v_mfma_f32_16x16x4_f32 v[56:59], v70, v78, v[56:59]
    v_mfma_f32_16x16x4_f32 v[60:63], v72, v80, v[60:63]
    v_mfma_f32_16x16x4_f32 v[48:51], v69, v75, v[48:51]
    v_mfma_f32_16x16x4_f32 v[52:55], v71, v77, v[52:55]
    v_mfma_f32_16x16x4_f32 v[56:59], v71, v79, v[56:59]
    v_mfma_f32_16x16x4_f32 v[60:63], v73, v81, v[60:63]
    v_mov_b32_dpp v64, v28 row_newbcast:10 row_mask:0xf bank_mask:0xf
    v_mov_b32_dpp v65, v29 row_newbcast:10 row_mask:0xf bank_mask:0xf
    v_mov_b32_dpp v66, v30 row_newbcast:10 row_mask:0xf bank_mask:0xf
    v_mov_b32_dpp v67, v31 row_newbcast:10 row_mask:0xf bank_mask:0xf
    v_mul_f32 v82, v64, v47
    v_mul_f32 v83, v65, v47
    v_exp_f32 v82, v82
    v_fract_f32 v83, v83
    v_cos_f32 v74, v83
    v_sin_f32 v75, v83
    v_mul_f32 v74, v74, v82
    v_mul_f32 v75, v75, v82
    v_mul_f32 v84, v75, v75
    v_add_f32 v85, v74, v74
    v_fma_f32 v76, v74, v74, -v84
    v_mul_f32 v77, v85, v75
    v_mul_f32 v84, v77, v77
    v_add_f32 v85, v76, v76
    v_fma_f32 v78, v76, v76, -v84
    v_mul_f32 v79, v85, v77
    v_mul_f32 v84, v79, v79
    v_add_f32 v85, v78, v78
    v_fma_f32 v80, v78, v78, -v84
    v_mul_f32 v81, v85, v79
    v_mul_f32 v82, v64, v44
    v_mul_f32 v83, v65, v44
    v_exp_f32 v82, v82
    v_fract_f32 v83, v83
    v_cos_f32 v68, v83
    v_sin_f32 v69, v83
    v_mul_f32 v68, v68, v82
    v_mul_f32 v69, v69, v82
    v_mul_f32 v84, v67, v69
    v_mul_f32 v85, v67, v68
    v_fma_f32 v68, v66, v68, -v84
    v_fma_f32 v69, -v66, v69, -v85
    v_mul_f32 v82, v64, v45
    v_mul_f32 v83, v65, v45
    v_exp_f32 v82, v82
    v_fract_f32 v83, v83
    v_cos_f32 v70, v83
    v_sin_f32 v71, v83
    v_mul_f32 v70, v70, v82
    v_mul_f32 v71, v71, v82
    v_mul_f32 v84, v67, v71
    v_mul_f32 v85, v67, v70
    v_fma_f32 v70, v66, v70, -v84
    v_fma_f32 v71, -v66, v71, -v85
    v_mul_f32 v82, v64, v46
    v_mul_f32 v83, v65, v46
    v_exp_f32 v82, v82
    v_fract_f32 v83, v83
    v_cos_f32 v72, v83
    v_sin_f32 v73, v83
    v_mul_f32 v72, v72, v82
    v_mul_f32 v73, v73, v82
    v_mul_f32 v84, v67, v73
    v_mul_f32 v85, v67, v72
    v_fma_f32 v72, v66, v72, -v84
    v_fma_f32 v73, -v66, v73, -v85
    v_mfma_f32_16x16x4_f32 v[48:51], v68, v74, v[48:51]
    v_mfma_f32_16x16x4_f32 v[52:55], v70, v76, v[52:55]
    v_mfma_f32_16x16x4_f32 v[56:59], v70, v78, v[56:59]
    v_mfma_f32_16x16x4_f32 v[60:63], v72, v80, v[60:63]
    v_mfma_f32_16x16x4_f32 v[48:51], v69, v75, v[48:51]
    v_mfma_f32_16x16x4_f32 v[52:55], v71, v77, v[52:55]
    v_mfma_f32_16x16x4_f32 v[56:59], v71, v79, v[56:59]
    v_mfma_f32_16x16x4_f32 v[60:63], v73, v81, v[60:63]
    v_mov_b32_dpp v64, v28 row_newbcast:11 row_mask:0xf bank_mask:0xf
    v_mov_b32_dpp v65, v29 row_newbcast:11 row_mask:0xf bank_mask:0xf
    v_mov_b32_dpp v66, v30 row_newbcast:11 row_mask:0xf bank_mask:0xf
    v_mov_b32_dpp v67, v31 row_newbcast:11 row_mask:0xf bank_mask:0xf
    v_mul_f32 v82, v64, v47
    v_mul_f32 v83, v65, v47
    v_exp_f32 v82, v82
    v_fract_f32 v83, v83
    v_cos_f32 v74, v83
    v_sin_f32 v75, v83
    v_mul_f32 v74, v74, v82
    v_mul_f32 v75, v75, v82
    v_mul_f32 v84, v75, v75
    v_add_f32 v85, v74, v74
    v_fma_f32 v76, v74, v74, -v84
    v_mul_f32 v77, v85, v75
    v_mul_f32 v84, v77, v77
    v_add_f32 v85, v76, v76
    v_fma_f32 v78, v76, v76, -v84
    v_mul_f32 v79, v85, v77
    v_mul_f32 v84, v79, v79
    v_add_f32 v85, v78, v78
    v_fma_f32 v80, v78, v78, -v84
    v_mul_f32 v81, v85, v79
    v_mul_f32 v82, v64, v44
    v_mul_f32 v83, v65, v44
    v_exp_f32 v82, v82
    v_fract_f32 v83, v83
    v_cos_f32 v68, v83
    v_sin_f32 v69, v83
    v_mul_f32 v68, v68, v82
    v_mul_f32 v69, v69, v82
    v_mul_f32 v84, v67, v69
    v_mul_f32 v85, v67, v68
    v_fma_f32 v68, v66, v68, -v84
    v_fma_f32 v69, -v66, v69, -v85
    v_mul_f32 v82, v64, v45
    v_mul_f32 v83, v65, v45
    v_exp_f32 v82, v82
    v_fract_f32 v83, v83
    v_cos_f32 v70, v83
    v_sin_f32 v71, v83
    v_mul_f32 v70, v70, v82
    v_mul_f32 v71, v71, v82
    v_mul_f32 v84, v67, v71
    v_mul_f32 v85, v67, v70
    v_fma_f32 v70, v66, v70, -v84
    v_fma_f32 v71, -v66, v71, -v85
    v_mul_f32 v82, v64, v46
    v_mul_f32 v83, v65, v46
    v_exp_f32 v82, v82
    v_fract_f32 v83, v83
    v_cos_f32 v72, v83
    v_sin_f32 v73, v83
    v_mul_f32 v72, v72, v82
    v_mul_f32 v73, v73, v82
    v_mul_f32 v84, v67, v73
    v_mul_f32 v85, v67, v72
    v_fma_f32 v72, v66, v72, -v84
    v_fma_f32 v73, -v66, v73, -v85
    v_mfma_f32_16x16x4_f32 v[48:51], v68, v74, v[48:51]
    v_mfma_f32_16x16x4_f32 v[52:55], v70, v76, v[52:55]
    v_mfma_f32_16x16x4_f32 v[56:59], v70, v78, v[56:59]
    v_mfma_f32_16x16x4_f32 v[60:63], v72, v80, v[60:63]
    v_mfma_f32_16x16x4_f32 v[48:51], v69, v75, v[48:51]
    v_mfma_f32_16x16x4_f32 v[52:55], v71, v77, v[52:55]
    v_mfma_f32_16x16x4_f32 v[56:59], v71, v79, v[56:59]
    v_mfma_f32_16x16x4_f32 v[60:63], v73, v81, v[60:63]
    v_mov_b32_dpp v64, v28 row_newbcast:12 row_mask:0xf bank_mask:0xf
    v_mov_b32_dpp v65, v29 row_newbcast:12 row_mask:0xf bank_mask:0xf
    v_mov_b32_dpp v66, v30 row_newbcast:12 row_mask:0xf bank_mask:0xf
    v_mov_b32_dpp v67, v31 row_newbcast:12 row_mask:0xf bank_mask:0xf
    v_mul_f32 v82, v64, v47
    v_mul_f32 v83, v65, v47
    v_exp_f32 v82, v82
    v_fract_f32 v83, v83
    v_cos_f32 v74, v83
    v_sin_f32 v75, v83
    v_mul_f32 v74, v74, v82
    v_mul_f32 v75, v75, v82
    v_mul_f32 v84, v75, v75
    v_add_f32 v85, v74, v74
    v_fma_f32 v76, v74, v74, -v84
    v_mul_f32 v77, v85, v75
    v_mul_f32 v84, v77, v77
    v_add_f32 v85, v76, v76
    v_fma_f32 v78, v76, v76, -v84
    v_mul_f32 v79, v85, v77
    v_mul_f32 v84, v79, v79
    v_add_f32 v85, v78, v78
    v_fma_f32 v80, v78, v78, -v84
    v_mul_f32 v81, v85, v79
    v_mul_f32 v82, v64, v44
    v_mul_f32 v83, v65, v44
    v_exp_f32 v82, v82
    v_fract_f32 v83, v83
    v_cos_f32 v68, v83
    v_sin_f32 v69, v83
    v_mul_f32 v68, v68, v82
    v_mul_f32 v69, v69, v82
    v_mul_f32 v84, v67, v69
    v_mul_f32 v85, v67, v68
    v_fma_f32 v68, v66, v68, -v84
    v_fma_f32 v69, -v66, v69, -v85
    v_mul_f32 v82, v64, v45
    v_mul_f32 v83, v65, v45
    v_exp_f32 v82, v82
    v_fract_f32 v83, v83
    v_cos_f32 v70, v83
    v_sin_f32 v71, v83
    v_mul_f32 v70, v70, v82
    v_mul_f32 v71, v71, v82
    v_mul_f32 v84, v67, v71
    v_mul_f32 v85, v67, v70
    v_fma_f32 v70, v66, v70, -v84
    v_fma_f32 v71, -v66, v71, -v85
    v_mul_f32 v82, v64, v46
    v_mul_f32 v83, v65, v46
    v_exp_f32 v82, v82
    v_fract_f32 v83, v83
    v_cos_f32 v72, v83
    v_sin_f32 v73, v83
    v_mul_f32 v72, v72, v82
    v_mul_f32 v73, v73, v82
    v_mul_f32 v84, v67, v73
    v_mul_f32 v85, v67, v72
    v_fma_f32 v72, v66, v72, -v84
    v_fma_f32 v73, -v66, v73, -v85
    v_mfma_f32_16x16x4_f32 v[48:51], v68, v74, v[48:51]
    v_mfma_f32_16x16x4_f32 v[52:55], v70, v76, v[52:55]
    v_mfma_f32_16x16x4_f32 v[56:59], v70, v78, v[56:59]
    v_mfma_f32_16x16x4_f32 v[60:63], v72, v80, v[60:63]
    v_mfma_f32_16x16x4_f32 v[48:51], v69, v75, v[48:51]
    v_mfma_f32_16x16x4_f32 v[52:55], v71, v77, v[52:55]
    v_mfma_f32_16x16x4_f32 v[56:59], v71, v79, v[56:59]
    v_mfma_f32_16x16x4_f32 v[60:63], v73, v81, v[60:63]
    v_mov_b32_dpp v64, v28 row_newbcast:13 row_mask:0xf bank_mask:0xf
    v_mov_b32_dpp v65, v29 row_newbcast:13 row_mask:0xf bank_mask:0xf
    v_mov_b32_dpp v66, v30 row_newbcast:13 row_mask:0xf bank_mask:0xf
    v_mov_b32_dpp v67, v31 row_newbcast:13 row_mask:0xf bank_mask:0xf
    v_mul_f32 v82, v64, v47
    v_mul_f32 v83, v65, v47
    v_exp_f32 v82, v82
    v_fract_f32 v83, v83
    v_cos_f32 v74, v83
    v_sin_f32 v75, v83
    v_mul_f32 v74, v74, v82
    v_mul_f32 v75, v75, v82
    v_mul_f32 v84, v75, v75
    v_add_f32 v85, v74, v74
    v_fma_f32 v76, v74, v74, -v84
    v_mul_f32 v77, v85, v75
    v_mul_f32 v84, v77, v77
    v_add_f32 v85, v76, v76
    v_fma_f32 v78, v76, v76, -v84
    v_mul_f32 v79, v85, v77
    v_mul_f32 v84, v79, v79
    v_add_f32 v85, v78, v78
    v_fma_f32 v80, v78, v78, -v84
    v_mul_f32 v81, v85, v79
    v_mul_f32 v82, v64, v44
    v_mul_f32 v83, v65, v44
    v_exp_f32 v82, v82
    v_fract_f32 v83, v83
    v_cos_f32 v68, v83
    v_sin_f32 v69, v83
    v_mul_f32 v68, v68, v82
    v_mul_f32 v69, v69, v82
    v_mul_f32 v84, v67, v69
    v_mul_f32 v85, v67, v68
    v_fma_f32 v68, v66, v68, -v84
    v_fma_f32 v69, -v66, v69, -v85
    v_mul_f32 v82, v64, v45
    v_mul_f32 v83, v65, v45
    v_exp_f32 v82, v82
    v_fract_f32 v83, v83
    v_cos_f32 v70, v83
    v_sin_f32 v71, v83
    v_mul_f32 v70, v70, v82
    v_mul_f32 v71, v71, v82
    v_mul_f32 v84, v67, v71
    v_mul_f32 v85, v67, v70
    v_fma_f32 v70, v66, v70, -v84
    v_fma_f32 v71, -v66, v71, -v85
    v_mul_f32 v82, v64, v46
    v_mul_f32 v83, v65, v46
    v_exp_f32 v82, v82
    v_fract_f32 v83, v83
    v_cos_f32 v72, v83
    v_sin_f32 v73, v83
    v_mul_f32 v72, v72, v82
    v_mul_f32 v73, v73, v82
    v_mul_f32 v84, v67, v73
    v_mul_f32 v85, v67, v72
    v_fma_f32 v72, v66, v72, -v84
    v_fma_f32 v73, -v66, v73, -v85
    v_mfma_f32_16x16x4_f32 v[48:51], v68, v74, v[48:51]
    v_mfma_f32_16x16x4_f32 v[52:55], v70, v76, v[52:55]
    v_mfma_f32_16x16x4_f32 v[56:59], v70, v78, v[56:59]
    v_mfma_f32_16x16x4_f32 v[60:63], v72, v80, v[60:63]
    v_mfma_f32_16x16x4_f32 v[48:51], v69, v75, v[48:51]
    v_mfma_f32_16x16x4_f32 v[52:55], v71, v77, v[52:55]
    v_mfma_f32_16x16x4_f32 v[56:59], v71, v79, v[56:59]
    v_mfma_f32_16x16x4_f32 v[60:63], v73, v81, v[60:63]
    v_mov_b32_dpp v64, v28 row_newbcast:14 row_mask:0xf bank_mask:0xf
    v_mov_b32_dpp v65, v29 row_newbcast:14 row_mask:0xf bank_mask:0xf
    v_mov_b32_dpp v66, v30 row_newbcast:14 row_mask:0xf bank_mask:0xf
    v_mov_b32_dpp v67, v31 row_newbcast:14 row_mask:0xf bank_mask:0xf
    v_mul_f32 v82, v64, v47
    v_mul_f32 v83, v65, v47
    v_exp_f32 v82, v82
    v_fract_f32 v83, v83
    v_cos_f32 v74, v83
    v_sin_f32 v75, v83
    v_mul_f32 v74, v74, v82
    v_mul_f32 v75, v75, v82
    v_mul_f32 v84, v75, v75
    v_add_f32 v85, v74, v74
    v_fma_f32 v76, v74, v74, -v84
    v_mul_f32 v77, v85, v75
    v_mul_f32 v84, v77, v77
    v_add_f32 v85, v76, v76
    v_fma_f32 v78, v76, v76, -v84
    v_mul_f32 v79, v85, v77
    v_mul_f32 v84, v79, v79
    v_add_f32 v85, v78, v78
    v_fma_f32 v80, v78, v78, -v84
    v_mul_f32 v81, v85, v79
    v_mul_f32 v82, v64, v44
    v_mul_f32 v83, v65, v44
    v_exp_f32 v82, v82
    v_fract_f32 v83, v83
    v_cos_f32 v68, v83
    v_sin_f32 v69, v83
    v_mul_f32 v68, v68, v82
    v_mul_f32 v69, v69, v82
    v_mul_f32 v84, v67, v69
    v_mul_f32 v85, v67, v68
    v_fma_f32 v68, v66, v68, -v84
    v_fma_f32 v69, -v66, v69, -v85
    v_mul_f32 v82, v64, v45
    v_mul_f32 v83, v65, v45
    v_exp_f32 v82, v82
    v_fract_f32 v83, v83
    v_cos_f32 v70, v83
    v_sin_f32 v71, v83
    v_mul_f32 v70, v70, v82
    v_mul_f32 v71, v71, v82
    v_mul_f32 v84, v67, v71
    v_mul_f32 v85, v67, v70
    v_fma_f32 v70, v66, v70, -v84
    v_fma_f32 v71, -v66, v71, -v85
    v_mul_f32 v82, v64, v46
    v_mul_f32 v83, v65, v46
    v_exp_f32 v82, v82
    v_fract_f32 v83, v83
    v_cos_f32 v72, v83
    v_sin_f32 v73, v83
    v_mul_f32 v72, v72, v82
    v_mul_f32 v73, v73, v82
    v_mul_f32 v84, v67, v73
    v_mul_f32 v85, v67, v72
    v_fma_f32 v72, v66, v72, -v84
    v_fma_f32 v73, -v66, v73, -v85
    v_mfma_f32_16x16x4_f32 v[48:51], v68, v74, v[48:51]
    v_mfma_f32_16x16x4_f32 v[52:55], v70, v76, v[52:55]
    v_mfma_f32_16x16x4_f32 v[56:59], v70, v78, v[56:59]
    v_mfma_f32_16x16x4_f32 v[60:63], v72, v80, v[60:63]
    v_mfma_f32_16x16x4_f32 v[48:51], v69, v75, v[48:51]
    v_mfma_f32_16x16x4_f32 v[52:55], v71, v77, v[52:55]
    v_mfma_f32_16x16x4_f32 v[56:59], v71, v79, v[56:59]
    v_mfma_f32_16x16x4_f32 v[60:63], v73, v81, v[60:63]
    v_mov_b32_dpp v64, v28 row_newbcast:15 row_mask:0xf bank_mask:0xf
    v_mov_b32_dpp v65, v29 row_newbcast:15 row_mask:0xf bank_mask:0xf
    v_mov_b32_dpp v66, v30 row_newbcast:15 row_mask:0xf bank_mask:0xf
    v_mov_b32_dpp v67, v31 row_newbcast:15 row_mask:0xf bank_mask:0xf
    v_mul_f32 v82, v64, v47
    v_mul_f32 v83, v65, v47
    v_exp_f32 v82, v82
    v_fract_f32 v83, v83
    v_cos_f32 v74, v83
    v_sin_f32 v75, v83
    v_mul_f32 v74, v74, v82
    v_mul_f32 v75, v75, v82
    v_mul_f32 v84, v75, v75
    v_add_f32 v85, v74, v74
    v_fma_f32 v76, v74, v74, -v84
    v_mul_f32 v77, v85, v75
    v_mul_f32 v84, v77, v77
    v_add_f32 v85, v76, v76
    v_fma_f32 v78, v76, v76, -v84
    v_mul_f32 v79, v85, v77
    v_mul_f32 v84, v79, v79
    v_add_f32 v85, v78, v78
    v_fma_f32 v80, v78, v78, -v84
    v_mul_f32 v81, v85, v79
    v_mul_f32 v82, v64, v44
    v_mul_f32 v83, v65, v44
    v_exp_f32 v82, v82
    v_fract_f32 v83, v83
    v_cos_f32 v68, v83
    v_sin_f32 v69, v83
    v_mul_f32 v68, v68, v82
    v_mul_f32 v69, v69, v82
    v_mul_f32 v84, v67, v69
    v_mul_f32 v85, v67, v68
    v_fma_f32 v68, v66, v68, -v84
    v_fma_f32 v69, -v66, v69, -v85
    v_mul_f32 v82, v64, v45
    v_mul_f32 v83, v65, v45
    v_exp_f32 v82, v82
    v_fract_f32 v83, v83
    v_cos_f32 v70, v83
    v_sin_f32 v71, v83
    v_mul_f32 v70, v70, v82
    v_mul_f32 v71, v71, v82
    v_mul_f32 v84, v67, v71
    v_mul_f32 v85, v67, v70
    v_fma_f32 v70, v66, v70, -v84
    v_fma_f32 v71, -v66, v71, -v85
    v_mul_f32 v82, v64, v46
    v_mul_f32 v83, v65, v46
    v_exp_f32 v82, v82
    v_fract_f32 v83, v83
    v_cos_f32 v72, v83
    v_sin_f32 v73, v83
    v_mul_f32 v72, v72, v82
    v_mul_f32 v73, v73, v82
    v_mul_f32 v84, v67, v73
    v_mul_f32 v85, v67, v72
    v_fma_f32 v72, v66, v72, -v84
    v_fma_f32 v73, -v66, v73, -v85
    v_mfma_f32_16x16x4_f32 v[48:51], v68, v74, v[48:51]
    v_mfma_f32_16x16x4_f32 v[52:55], v70, v76, v[52:55]
    v_mfma_f32_16x16x4_f32 v[56:59], v70, v78, v[56:59]
    v_mfma_f32_16x16x4_f32 v[60:63], v72, v80, v[60:63]
    v_mfma_f32_16x16x4_f32 v[48:51], v69, v75, v[48:51]
    v_mfma_f32_16x16x4_f32 v[52:55], v71, v77, v[52:55]
    v_mfma_f32_16x16x4_f32 v[56:59], v71, v79, v[56:59]
    v_mfma_f32_16x16x4_f32 v[60:63], v73, v81, v[60:63]
    v_lshlrev_b32 v5, 8, v3
    v_lshl_add_u32 v5, v2, 2, v5
    v_add_u32 v5, v5, v4
    ds_write_b32 v5, v48 offset:4608
    ds_write_b32 v5, v49 offset:4672
    ds_write_b32 v5, v50 offset:4736
    ds_write_b32 v5, v51 offset:4800
    v_cmp_gt_u32 vcc, 2, v3
    s_nop 0
    s_mov_b64 exec, vcc
    ds_write_b32 v5, v52 offset:5632
    ds_write_b32 v5, v53 offset:5696
    ds_write_b32 v5, v54 offset:5760
    ds_write_b32 v5, v55 offset:5824
    ds_write_b32 v5, v60 offset:6656
    ds_write_b32 v5, v61 offset:6720
    ds_write_b32 v5, v62 offset:6784
    ds_write_b32 v5, v63 offset:6848
    s_not_b64 exec, exec
    ds_write_b32 v5, v56 offset:5632
    ds_write_b32 v5, v57 offset:5696
    ds_write_b32 v5, v58 offset:5760
    ds_write_b32 v5, v59 offset:5824
    s_mov_b32 exec_lo, 0
    s_mov_b32 exec_hi, 3
    v_cmp_eq_u32 vcc, 0, v2
    s_nop 1
    v_cndmask_b32 v6, 0, v60, vcc
    ds_write_b32 v5, v6 offset:6656
    s_mov_b64 exec, -1
    s_waitcnt lgkmcnt(0)
    v_lshlrev_b32 v7, 1, v1
    v_sub_u32 v7, 2065, v7
    v_lshl_add_u32 v64, v1, 2, v4
    v_mov_b32 v65, 641
    s_mov_b32 s25, 17
ss_exp:
    v_subrev_u32 v66, 0, v7
    v_cvt_f32_u32 v70, v66
    v_cvt_pk_bf16_f32 v70, v70, v70
    v_and_b32 v70, 0xffff, v70
    v_subrev_u32 v70, 0x4280, v70
    v_cmp_gt_u32 vcc, 256, v66
    s_nop 1
    v_cndmask_b32 v70, v70, v66, vcc
    v_cmp_gt_u32 vcc, 2048, v66
    s_nop 1
    v_cndmask_b32 v70, v65, v70, vcc
    v_lshl_add_u32 v70, v70, 2, v4
    ds_read_b32 v74, v70 offset:4608
    v_subrev_u32 v67, 1, v7
    v_cvt_f32_u32 v71, v67
    v_cvt_pk_bf16_f32 v71, v71, v71
    v_and_b32 v71, 0xffff, v71
    v_subrev_u32 v71, 0x4280, v71
    v_cmp_gt_u32 vcc, 256, v67
    s_nop 1
    v_cndmask_b32 v71, v71, v67, vcc
    v_cmp_gt_u32 vcc, 2048, v67
    s_nop 1
    v_cndmask_b32 v71, v65, v71, vcc
    v_lshl_add_u32 v71, v71, 2, v4
    ds_read_b32 v75, v71 offset:4608
    v_subrev_u32 v68, 2, v7
    v_cvt_f32_u32 v72, v68
    v_cvt_pk_bf16_f32 v72, v72, v72
    v_and_b32 v72, 0xffff, v72
    v_subrev_u32 v72, 0x4280, v72
    v_cmp_gt_u32 vcc, 256, v68
    s_nop 1
    v_cndmask_b32 v72, v72, v68, vcc
    v_cmp_gt_u32 vcc, 2048, v68
    s_nop 1
    v_cndmask_b32 v72, v65, v72, vcc
    v_lshl_add_u32 v72, v72, 2, v4
    ds_read_b32 v76, v72 offset:4608
    s_waitcnt lgkmcnt(0)
    v_cvt_pk_bf16_f32 v78, v75, v76
    v_cvt_pk_bf16_f32 v79, v74, v75
    ds_write_b32 v64, v78 offset:7424
    ds_write_b32 v64, v79 offset:11776
    v_subrev_u32 v7, 128, v7
    v_add_u32 v64, 256, v64
    s_sub_u32 s25, s25, 1
    s_cmp_lg_u32 s25, 0
    s_cbranch_scc1 ss_exp
    s_waitcnt lgkmcnt(0)
    s_barrier
    v_and_b32 v5, 1, v2
    v_mul_u32_u24 v64, 4352, v5
    v_sub_u32 v5, v5, v2
    v_lshl_add_u32 v5, v3, 3, v5
    v_lshl_add_u32 v64, v5, 1, v64
    v_add_u32 v64, 11520, v64
    v_add_u32 v64, v64, v4
    v_lshlrev_b32 v65, 5, v2
    v_lshl_add_u32 v65, v3, 4, v65
    v_add_u32 v65, 480, v65
    v_add_u32 v65, v65, v4
    v_mov_b32 v96, 0
    v_mov_b32 v97, 0
    v_mov_b32 v98, 0
    v_mov_b32 v99, 0
    v_mov_b32 v100, 0
    v_mov_b32 v101, 0
    v_mov_b32 v102, 0
    v_mov_b32 v103, 0
    v_mov_b32 v104, 0
    v_mov_b32 v105, 0
    v_mov_b32 v106, 0
    v_mov_b32 v107, 0
    v_mov_b32 v108, 0
    v_mov_b32 v109, 0
    v_mov_b32 v110, 0
    v_mov_b32 v111, 0
    v_mov_b32 v112, 0
    v_mov_b32 v113, 0
    v_mov_b32 v114, 0
    v_mov_b32 v115, 0
    v_mov_b32 v116, 0
    v_mov_b32 v117, 0
    v_mov_b32 v118, 0
    v_mov_b32 v119, 0
    v_mov_b32 v120, 0
    v_mov_b32 v121, 0
    v_mov_b32 v122, 0
    v_mov_b32 v123, 0
    v_mov_b32 v124, 0
    v_mov_b32 v125, 0
    v_mov_b32 v126, 0
    v_mov_b32 v127, 0
    s_mov_b32 s25, 8
ss_cv0:
    ds_read2_b32 v[68:69], v64 offset0:0 offset1:1
    ds_read2_b32 v[70:71], v64 offset0:2 offset1:3
    ds_read_b128 v[128:131], v65 offset:0
    ds_read_b128 v[132:135], v65 offset:512
    ds_read_b128 v[136:139], v65 offset:1024
    ds_read_b128 v[140:143], v65 offset:1536
    ds_read_b128 v[144:147], v65 offset:2048
    ds_read_b128 v[148:151], v65 offset:2560
    ds_read_b128 v[152:155], v65 offset:3072
    ds_read_b128 v[156:159], v65 offset:3584
    v_subrev_u32 v64, 64, v64
    v_subrev_u32 v65, 64, v65
    s_waitcnt lgkmcnt(7)
    v_mfma_f32_16x16x32_bf16 v[96:99], v[68:71], v[128:131], v[96:99]
    s_waitcnt lgkmcnt(6)
    v_mfma_f32_16x16x32_bf16 v[100:103], v[68:71], v[132:135], v[100:103]
    s_waitcnt lgkmcnt(5)
    v_mfma_f32_16x16x32_bf16 v[104:107], v[68:71], v[136:139], v[104:107]
    s_waitcnt lgkmcnt(4)
    v_mfma_f32_16x16x32_bf16 v[108:111], v[68:71], v[140:143], v[108:111]
    s_waitcnt lgkmcnt(3)
    v_mfma_f32_16x16x32_bf16 v[112:115], v[68:71], v[144:147], v[112:115]
    s_waitcnt lgkmcnt(2)
    v_mfma_f32_16x16x32_bf16 v[116:119], v[68:71], v[148:151], v[116:119]
    s_waitcnt lgkmcnt(1)
    v_mfma_f32_16x16x32_bf16 v[120:123], v[68:71], v[152:155], v[120:123]
    s_waitcnt lgkmcnt(0)
    v_mfma_f32_16x16x32_bf16 v[124:127], v[68:71], v[156:159], v[124:127]
    s_sub_u32 s25, s25, 1
    s_cmp_lg_u32 s25, 0
    s_cbranch_scc1 ss_cv0
    v_add_u32 v65, 512, v65
    s_mov_b32 s25, 8
ss_cv1:
    ds_read2_b32 v[68:69], v64 offset0:0 offset1:1
    ds_read2_b32 v[70:71], v64 offset0:2 offset1:3
    ds_read_b128 v[132:135], v65 offset:0
    ds_read_b128 v[136:139], v65 offset:512
    ds_read_b128 v[140:143], v65 offset:1024
    ds_read_b128 v[144:147], v65 offset:1536
    ds_read_b128 v[148:151], v65 offset:2048
    ds_read_b128 v[152:155], v65 offset:2560
    ds_read_b128 v[156:159], v65 offset:3072
    v_subrev_u32 v64, 64, v64
    v_subrev_u32 v65, 64, v65
    s_waitcnt lgkmcnt(6)
    v_mfma_f32_16x16x32_bf16 v[100:103], v[68:71], v[132:135], v[100:103]
    s_waitcnt lgkmcnt(5)
    v_mfma_f32_16x16x32_bf16 v[104:107], v[68:71], v[136:139], v[104:107]
    s_waitcnt lgkmcnt(4)
    v_mfma_f32_16x16x32_bf16 v[108:111], v[68:71], v[140:143], v[108:111]
    s_waitcnt lgkmcnt(3)
    v_mfma_f32_16x16x32_bf16 v[112:115], v[68:71], v[144:147], v[112:115]
    s_waitcnt lgkmcnt(2)
    v_mfma_f32_16x16x32_bf16 v[116:119], v[68:71], v[148:151], v[116:119]
    s_waitcnt lgkmcnt(1)
    v_mfma_f32_16x16x32_bf16 v[120:123], v[68:71], v[152:155], v[120:123]
    s_waitcnt lgkmcnt(0)
    v_mfma_f32_16x16x32_bf16 v[124:127], v[68:71], v[156:159], v[124:127]
    s_sub_u32 s25, s25, 1
    s_cmp_lg_u32 s25, 0
    s_cbranch_scc1 ss_cv1
    v_add_u32 v65, 512, v65
    s_mov_b32 s25, 8
ss_cv2:
    ds_read2_b32 v[68:69], v64 offset0:0 offset1:1
    ds_read2_b32 v[70:71], v64 offset0:2 offset1:3
    ds_read_b128 v[136:139], v65 offset:0
    ds_read_b128 v[140:143], v65 offset:512
    ds_read_b128 v[144:147], v65 offset:1024
    ds_read_b128 v[148:151], v65 offset:1536
    ds_read_b128 v[152:155], v65 offset:2048
    ds_read_b128 v[156:159], v65 offset:2560
    v_subrev_u32 v64, 64, v64
    v_subrev_u32 v65, 64, v65
    s_waitcnt lgkmcnt(5)
    v_mfma_f32_16x16x32_bf16 v[104:107], v[68:71], v[136:139], v[104:107]
    s_waitcnt lgkmcnt(4)
    v_mfma_f32_16x16x32_bf16 v[108:111], v[68:71], v[140:143], v[108:111]
    s_waitcnt lgkmcnt(3)
    v_mfma_f32_16x16x32_bf16 v[112:115], v[68:71], v[144:147], v[112:115]
    s_waitcnt lgkmcnt(2)
    v_mfma_f32_16x16x32_bf16 v[116:119], v[68:71], v[148:151], v[116:119]
    s_waitcnt lgkmcnt(1)
    v_mfma_f32_16x16x32_bf16 v[120:123], v[68:71], v[152:155], v[120:123]
    s_waitcnt lgkmcnt(0)
    v_mfma_f32_16x16x32_bf16 v[124:127], v[68:71], v[156:159], v[124:127]
    s_sub_u32 s25, s25, 1
    s_cmp_lg_u32 s25, 0
    s_cbranch_scc1 ss_cv2
    v_add_u32 v65, 512, v65
    s_mov_b32 s25, 8
ss_cv3:
    ds_read2_b32 v[68:69], v64 offset0:0 offset1:1
    ds_read2_b32 v[70:71], v64 offset0:2 offset1:3
    ds_read_b128 v[140:143], v65 offset:0
    ds_read_b128 v[144:147], v65 offset:512
    ds_read_b128 v[148:151], v65 offset:1024
    ds_read_b128 v[152:155], v65 offset:1536
    ds_read_b128 v[156:159], v65 offset:2048
    v_subrev_u32 v64, 64, v64
    v_subrev_u32 v65, 64, v65
    s_waitcnt lgkmcnt(4)
    v_mfma_f32_16x16x32_bf16 v[108:111], v[68:71], v[140:143], v[108:111]
    s_waitcnt lgkmcnt(3)
    v_mfma_f32_16x16x32_bf16 v[112:115], v[68:71], v[144:147], v[112:115]
    s_waitcnt lgkmcnt(2)
    v_mfma_f32_16x16x32_bf16 v[116:119], v[68:71], v[148:151], v[116:119]
    s_waitcnt lgkmcnt(1)
    v_mfma_f32_16x16x32_bf16 v[120:123], v[68:71], v[152:155], v[120:123]
    s_waitcnt lgkmcnt(0)
    v_mfma_f32_16x16x32_bf16 v[124:127], v[68:71], v[156:159], v[124:127]
    s_sub_u32 s25, s25, 1
    s_cmp_lg_u32 s25, 0
    s_cbranch_scc1 ss_cv3
    v_add_u32 v65, 512, v65
    s_mov_b32 s25, 8
ss_cv4:
    ds_read2_b32 v[68:69], v64 offset0:0 offset1:1
    ds_read2_b32 v[70:71], v64 offset0:2 offset1:3
    ds_read_b128 v[144:147], v65 offset:0
    ds_read_b128 v[148:151], v65 offset:512
    ds_read_b128 v[152:155], v65 offset:1024
    ds_read_b128 v[156:159], v65 offset:1536
    v_subrev_u32 v64, 64, v64
    v_subrev_u32 v65, 64, v65
    s_waitcnt lgkmcnt(3)
    v_mfma_f32_16x16x32_bf16 v[112:115], v[68:71], v[144:147], v[112:115]
    s_waitcnt lgkmcnt(2)
    v_mfma_f32_16x16x32_bf16 v[116:119], v[68:71], v[148:151], v[116:119]
    s_waitcnt lgkmcnt(1)
    v_mfma_f32_16x16x32_bf16 v[120:123], v[68:71], v[152:155], v[120:123]
    s_waitcnt lgkmcnt(0)
    v_mfma_f32_16x16x32_bf16 v[124:127], v[68:71], v[156:159], v[124:127]
    s_sub_u32 s25, s25, 1
    s_cmp_lg_u32 s25, 0
    s_cbranch_scc1 ss_cv4
    v_add_u32 v65, 512, v65
    s_mov_b32 s25, 8
ss_cv5:
    ds_read2_b32 v[68:69], v64 offset0:0 offset1:1
    ds_read2_b32 v[70:71], v64 offset0:2 offset1:3
    ds_read_b128 v[148:151], v65 offset:0
    ds_read_b128 v[152:155], v65 offset:512
    ds_read_b128 v[156:159], v65 offset:1024
    v_subrev_u32 v64, 64, v64
    v_subrev_u32 v65, 64, v65
    s_waitcnt lgkmcnt(2)
    v_mfma_f32_16x16x32_bf16 v[116:119], v[68:71], v[148:151], v[116:119]
    s_waitcnt lgkmcnt(1)
    v_mfma_f32_16x16x32_bf16 v[120:123], v[68:71], v[152:155], v[120:123]
    s_waitcnt lgkmcnt(0)
    v_mfma_f32_16x16x32_bf16 v[124:127], v[68:71], v[156:159], v[124:127]
    s_sub_u32 s25, s25, 1
    s_cmp_lg_u32 s25, 0
    s_cbranch_scc1 ss_cv5
    v_add_u32 v65, 512, v65
    s_mov_b32 s25, 8
ss_cv6:
    ds_read2_b32 v[68:69], v64 offset0:0 offset1:1
    ds_read2_b32 v[70:71], v64 offset0:2 offset1:3
    ds_read_b128 v[152:155], v65 offset:0
    ds_read_b128 v[156:159], v65 offset:512
    v_subrev_u32 v64, 64, v64
    v_subrev_u32 v65, 64, v65
    s_waitcnt lgkmcnt(1)
    v_mfma_f32_16x16x32_bf16 v[120:123], v[68:71], v[152:155], v[120:123]
    s_waitcnt lgkmcnt(0)
    v_mfma_f32_16x16x32_bf16 v[124:127], v[68:71], v[156:159], v[124:127]
    s_sub_u32 s25, s25, 1
    s_cmp_lg_u32 s25, 0
    s_cbranch_scc1 ss_cv6
    v_add_u32 v65, 512, v65
    s_mov_b32 s25, 8
ss_cv7:
    ds_read2_b32 v[68:69], v64 offset0:0 offset1:1
    ds_read2_b32 v[70:71], v64 offset0:2 offset1:3
    ds_read_b128 v[156:159], v65 offset:0
    v_subrev_u32 v64, 64, v64
    v_subrev_u32 v65, 64, v65
    s_waitcnt lgkmcnt(0)
    v_mfma_f32_16x16x32_bf16 v[124:127], v[68:71], v[156:159], v[124:127]
    s_sub_u32 s25, s25, 1
    s_cmp_lg_u32 s25, 0
    s_cbranch_scc1 ss_cv7
    v_add_u32 v65, 512, v65
    s_nop 3
    v_lshlrev_b32 v5, 6, v2
    v_lshl_add_u32 v5, v3, 4, v5
    v_add_u32 v5, v5, v4
    ds_write_b128 v5, v[96:99] offset:7424
    ds_write_b128 v5, v[100:103] offset:8448
    ds_write_b128 v5, v[104:107] offset:9472
    ds_write_b128 v5, v[108:111] offset:10496
    ds_write_b128 v5, v[112:115] offset:11520
    ds_write_b128 v5, v[116:119] offset:12544
    ds_write_b128 v5, v[120:123] offset:13568
    ds_write_b128 v5, v[124:127] offset:14592
    s_mov_b32 s12, s74
    s_mov_b32 s13, s75
    s_mov_b32 s14, 1152
    s_mov_b32 s15, 0x20000
    s_lshl_b32 s23, s20, 1
    buffer_load_dwordx2 v[24:25], off, s[12:15], s23
    s_waitcnt vmcnt(0) lgkmcnt(0)
    s_barrier
    v_lshlrev_b32 v26, 16, v24
    v_and_b32 v27, 0xffff0000, v24
    v_lshlrev_b32 v28, 16, v25
    v_and_b32 v29, 0xffff0000, v25
    v_lshlrev_b32 v5, 5, v0
    ds_read_b128 v[64:67], v5 offset:7424
    ds_read_b128 v[68:71], v5 offset:7440
    ds_read_b128 v[72:75], v5 offset:23808
    ds_read_b128 v[76:79], v5 offset:23824
    ds_read_b128 v[80:83], v5 offset:40192
    ds_read_b128 v[84:87], v5 offset:40208
    ds_read_b128 v[88:91], v5 offset:56576
    ds_read_b128 v[92:95], v5 offset:56592
    s_waitcnt lgkmcnt(0)
    v_mul_u32_u24 v5, 18432, v0
    s_lshl_b32 s22, s20, 1
    s_add_u32 s22, s22, 1152
    v_lshlrev_b32 v6, 16, v8
    v_fmac_f32 v64, v6, v26
    v_and_b32 v6, 0xffff0000, v8
    v_fmac_f32 v72, v6, v27
    v_lshlrev_b32 v6, 16, v9
    v_fmac_f32 v80, v6, v28
    v_and_b32 v6, 0xffff0000, v9
    v_fmac_f32 v88, v6, v29
    v_cvt_pk_bf16_f32 v8, v64, v72
    v_cvt_pk_bf16_f32 v9, v80, v88
    s_add_u32 s23, s22, 0
    buffer_store_dwordx2 v[8:9], v5, s[16:19], s23 offen
    v_lshlrev_b32 v6, 16, v10
    v_fmac_f32 v65, v6, v26
    v_and_b32 v6, 0xffff0000, v10
    v_fmac_f32 v73, v6, v27
    v_lshlrev_b32 v6, 16, v11
    v_fmac_f32 v81, v6, v28
    v_and_b32 v6, 0xffff0000, v11
    v_fmac_f32 v89, v6, v29
    v_cvt_pk_bf16_f32 v10, v65, v73
    v_cvt_pk_bf16_f32 v11, v81, v89
    s_add_u32 s23, s22, 2304
    buffer_store_dwordx2 v[10:11], v5, s[16:19], s23 offen
    v_lshlrev_b32 v6, 16, v12
    v_fmac_f32 v66, v6, v26
    v_and_b32 v6, 0xffff0000, v12
    v_fmac_f32 v74, v6, v27
    v_lshlrev_b32 v6, 16, v13
    v_fmac_f32 v82, v6, v28
    v_and_b32 v6, 0xffff0000, v13
    v_fmac_f32 v90, v6, v29
    v_cvt_pk_bf16_f32 v12, v66, v74
    v_cvt_pk_bf16_f32 v13, v82, v90
    s_add_u32 s23, s22, 4608
    buffer_store_dwordx2 v[12:13], v5, s[16:19], s23 offen
    v_lshlrev_b32 v6, 16, v14
    v_fmac_f32 v67, v6, v26
    v_and_b32 v6, 0xffff0000, v14
    v_fmac_f32 v75, v6, v27
    v_lshlrev_b32 v6, 16, v15
    v_fmac_f32 v83, v6, v28
    v_and_b32 v6, 0xffff0000, v15
    v_fmac_f32 v91, v6, v29
    v_cvt_pk_bf16_f32 v14, v67, v75
    v_cvt_pk_bf16_f32 v15, v83, v91
    s_add_u32 s23, s22, 6912
    buffer_store_dwordx2 v[14:15], v5, s[16:19], s23 offen
    v_lshlrev_b32 v6, 16, v16
    v_fmac_f32 v68, v6, v26
    v_and_b32 v6, 0xffff0000, v16
    v_fmac_f32 v76, v6, v27
    v_lshlrev_b32 v6, 16, v17
    v_fmac_f32 v84, v6, v28
    v_and_b32 v6, 0xffff0000, v17
    v_fmac_f32 v92, v6, v29
    v_cvt_pk_bf16_f32 v16, v68, v76
    v_cvt_pk_bf16_f32 v17, v84, v92
    s_add_u32 s23, s22, 9216
    buffer_store_dwordx2 v[16:17], v5, s[16:19], s23 offen
    v_lshlrev_b32 v6, 16, v18
    v_fmac_f32 v69, v6, v26
    v_and_b32 v6, 0xffff0000, v18
    v_fmac_f32 v77, v6, v27
    v_lshlrev_b32 v6, 16, v19
    v_fmac_f32 v85, v6, v28
    v_and_b32 v6, 0xffff0000, v19
    v_fmac_f32 v93, v6, v29
    v_cvt_pk_bf16_f32 v18, v69, v77
    v_cvt_pk_bf16_f32 v19, v85, v93
    s_add_u32 s23, s22, 11520
    buffer_store_dwordx2 v[18:19], v5, s[16:19], s23 offen
    v_lshlrev_b32 v6, 16, v20
    v_fmac_f32 v70, v6, v26
    v_and_b32 v6, 0xffff0000, v20
    v_fmac_f32 v78, v6, v27
    v_lshlrev_b32 v6, 16, v21
    v_fmac_f32 v86, v6, v28
    v_and_b32 v6, 0xffff0000, v21
    v_fmac_f32 v94, v6, v29
    v_cvt_pk_bf16_f32 v20, v70, v78
    v_cvt_pk_bf16_f32 v21, v86, v94
    s_add_u32 s23, s22, 13824
    buffer_store_dwordx2 v[20:21], v5, s[16:19], s23 offen
    v_lshlrev_b32 v6, 16, v22
    v_fmac_f32 v71, v6, v26
    v_and_b32 v6, 0xffff0000, v22
    v_fmac_f32 v79, v6, v27
    v_lshlrev_b32 v6, 16, v23
    v_fmac_f32 v87, v6, v28
    v_and_b32 v6, 0xffff0000, v23
    v_fmac_f32 v95, v6, v29
    v_cvt_pk_bf16_f32 v22, v71, v79
    v_cvt_pk_bf16_f32 v23, v87, v95
    s_add_u32 s23, s22, 16128
    buffer_store_dwordx2 v[22:23], v5, s[16:19], s23 offen
    s_branch L_ssm_next
L_phase2:
    v_and_b32 v1, 63, v0
    v_min_u32 v1, 6, v1
    v_lshlrev_b32 v2, 2, v1
    s_cmp_lg_u32 s32, 0
    v_mov_b32 v251, 163832
    s_cbranch_scc1 sw11
    buffer_load_dword v3, v2, s[96:99], 0 offen offset:32 sc1
    v_mov_b32 v4, 32
    s_waitcnt vmcnt(0)
    v_cmp_lt_u32 vcc, v3, v4
    s_nop 0
    s_ff1_i32_b64 s40, vcc
    v_mov_b32 v250, s40
    ds_write_b32 v251, v250
    s_waitcnt lgkmcnt(0)
sw11:
    s_barrier
    ds_read_b32 v252, v251
    s_waitcnt lgkmcnt(0)
    v_readfirstlane_b32 s33, v252
    s_barrier
    s_nop 1
    s_cmp_lt_u32 s33, 7
    s_cbranch_scc1 L_pool
    s_mov_b32 s88, 4194304
gn12:
    s_cmp_lg_u32 s95, 0
    s_cbranch_scc1 gn12x
    buffer_load_dword v250, off, s[96:99], 0 offset:64 sc1
    s_sub_u32 s88, s88, 1
    s_cbranch_scc1 gn12x
    s_waitcnt vmcnt(0)
    v_readfirstlane_b32 s95, v250
    s_nop 1
    s_branch gn12
gn12x:
    s_mov_b32 s40, 524288
mc2_w:
    buffer_load_dword v250, off, s[96:99], 0 offset:140 sc1
    s_waitcnt vmcnt(0)
    v_readfirstlane_b32 s41, v250
    s_nop 0
    s_cmp_lg_u32 s41, 0
    s_cbranch_scc1 mc2_known
    s_sub_u32 s40, s40, 1
    s_cbranch_scc1 mc2_force
    s_sleep 2
    s_branch mc2_w
mc2_force:
    v_mov_b32 v250, 2
    v_mov_b32 v251, 0
    s_mov_b64 exec, 1
    buffer_atomic_cmpswap v[250:251], off, s[96:99], 0 offset:140
    s_mov_b64 exec, -1
    s_waitcnt vmcnt(0)
    s_mov_b32 s40, 524288
    s_branch mc2_w
mc2_known:
    s_cmp_eq_u32 s41, 1
    s_cbranch_scc1 L_phase2b
    s_mov_b32 s37, 208
    v_mov_b32 v250, 1
    v_mov_b32 v251, 163832
    v_cmp_eq_u32 vcc, 0, v0
    s_nop 0
    s_and_saveexec_b64 s[38:39], vcc
    s_cbranch_execz tk13
    buffer_atomic_add v250, off, s[96:99], s37 sc0
    s_waitcnt vmcnt(0)
    ds_write_b32 v251, v250
    s_waitcnt lgkmcnt(0)
tk13:
    s_mov_b64 exec, -1
    s_barrier
    ds_read_b32 v252, v251
    s_waitcnt lgkmcnt(0)
    v_readfirstlane_b32 s12, v252
    s_barrier
    s_nop 3
    s_cmp_lt_u32 s12, 32
    s_cbranch_scc1 L_chain_safe
L_phase2b:
    s_mov_b32 s8, s76
    s_mov_b32 s9, s77
    s_mov_b32 s10, 4718592
    s_mov_b32 s11, 0x20000
    s_sub_u32 s33, s3, 1
    s_and_b32 s33, s33, 7
    s_cmp_eq_u32 s33, 7
    s_cbranch_scc1 L_p2scan
L_p2take:
    s_lshl_b32 s35, s33, 2
    s_add_u32 s35, s35, 160
    s_mov_b32 s37, s35
    v_mov_b32 v250, 1
    v_mov_b32 v251, 163832
    v_cmp_eq_u32 vcc, 0, v0
    s_nop 0
    s_and_saveexec_b64 s[38:39], vcc
    s_cbranch_execz tk14
    buffer_atomic_add v250, off, s[96:99], s37 sc0
    s_waitcnt vmcnt(0)
    ds_write_b32 v251, v250
    s_waitcnt lgkmcnt(0)
tk14:
    s_mov_b64 exec, -1
    s_barrier
    ds_read_b32 v252, v251
    s_waitcnt lgkmcnt(0)
    v_readfirstlane_b32 s34, v252
    s_barrier
    s_nop 3
    s_cmp_lt_u32 s33, 4
    s_cselect_b32 s36, 4, 6
    s_cmp_lt_u32 s34, s36
    s_cbranch_scc1 L_att0
    s_sub_u32 s34, s34, s36
    s_cmp_lt_u32 s34, 18
    s_cbranch_scc1 L_op_start
L_p2scan:
    v_and_b32 v1, 63, v0
    v_min_u32 v1, 6, v1
    v_lshlrev_b32 v2, 2, v1
    s_cmp_lg_u32 s32, 0
    v_mov_b32 v251, 163832
    s_cbranch_scc1 sw15
    buffer_load_dword v3, v2, s[96:99], 0 offen offset:160 sc1
    v_mov_b32 v4, 24
    v_cmp_gt_u32 vcc, 4, v1
    s_nop 1
    v_cndmask_b32 v4, v4, 22, vcc
    s_waitcnt vmcnt(0)
    v_cmp_lt_u32 vcc, v3, v4
    s_nop 0
    s_ff1_i32_b64 s40, vcc
    v_mov_b32 v250, s40
    ds_write_b32 v251, v250
    s_waitcnt lgkmcnt(0)
sw15:
    s_barrier
    ds_read_b32 v252, v251
    s_waitcnt lgkmcnt(0)
    v_readfirstlane_b32 s33, v252
    s_barrier
    s_nop 1
    s_cmp_lt_u32 s33, 7
    s_cbranch_scc1 L_p2take
    s_branch L_done
L_att0:
    s_mul_i32 s36, s34, 7
    s_mul_i32 s37, s34, 3
    s_add_u32 s37, s37, 12
    s_cmp_lt_u32 s34, 4
    s_cselect_b32 s34, s36, s37
    s_add_u32 s34, s34, s33
    s_cmp_ge_u32 s34, 32
    s_cbranch_scc1 L_done
L_att_next:
    s_lshr_b32 s16, s34, 3
    s_and_b32 s17, s34, 7
    s_lshl_b32 s17, s17, 2
    s_add_u32 s17, s17, s32
    s_lshr_b32 s36, s17, 1
    s_lshl_b32 s36, s36, 8
    s_add_u32 s36, s36, 125829120
    s_mul_i32 s37, s16, 43
    s_lshr_b32 s37, s37, 8
    s_mul_i32 s41, s37, 6
    s_sub_u32 s41, s16, s41
    v_and_b32 v1, 63, v0
    v_mul_u32_u24 v2, 6, v1
    v_add_u32 v2, s41, v2
    v_mov_b32 v4, s37
    s_and_b32 s41, s16, 7
    s_add_u32 s41, s41, 12
    s_lshr_b32 s37, s16, 3
    v_mov_b32 v5, s41
    v_mov_b32 v6, s37
    v_cmp_lt_u32 vcc, 1, v1
    s_nop 1
    v_cndmask_b32 v2, v2, v5, vcc
    v_cndmask_b32 v4, v4, v6, vcc
    v_lshlrev_b32 v2, 2, v2
    v_add3_u32 v4, v4, s95, 1
    s_mov_b32 s40, 4194304
L_aw1:
    buffer_load_dword v3, v2, s[4:7], s36 offen sc1
    s_sub_u32 s40, s40, 1
    s_cbranch_scc1 L_aw1_go
    s_waitcnt vmcnt(0)
    v_subrev_u32 v3, v4, v3
    v_cmp_lt_u32 vcc, 64, v3
    s_cbranch_vccz L_aw1_go
    s_sleep 4
    s_branch L_aw1
L_aw1_go:
    v_and_b32 v5, 63, v0
    v_lshlrev_b32 v1, 4, v5
    v_or_b32 v3, 128, v1
    v_lshrrev_b32 v4, 4, v5
    v_bfe_u32 v6, v5, 2, 2
    v_sub_u32 v4, v6, v4
    v_lshlrev_b32 v4, 3, v4
    v_and_b32 v6, 3, v5
    v_add_u32 v4, v4, v6
    v_mov_b32 v6, 0xf149f2ca
    s_mov_b32 s22, 0x3e0293ee
    s_lshl_b32 s18, s16, 5
    s_add_u32 s18, s18, s17
    s_lshl_b32 s19, s18, 13
    s_add_u32 s20, s19, 33554432
    buffer_load_dwordx4 v[8:11], v1, s[4:7], s20 offen offset:0 sc1
    s_add_u32 s20, s19, 33554432
    buffer_load_dwordx4 v[12:15], v1, s[4:7], s20 offen offset:1024 sc1
    s_add_u32 s20, s19, 33554432
    buffer_load_dwordx4 v[16:19], v1, s[4:7], s20 offen offset:2048 sc1
    s_add_u32 s20, s19, 33554432
    buffer_load_dwordx4 v[20:23], v1, s[4:7], s20 offen offset:3072 sc1
    s_add_u32 s20, s19, 33558528
    buffer_load_dwordx4 v[24:27], v1, s[4:7], s20 offen offset:0 sc1
    s_add_u32 s20, s19, 33558528
    buffer_load_dwordx4 v[28:31], v1, s[4:7], s20 offen offset:1024 sc1
    s_add_u32 s20, s19, 33558528
    buffer_load_dwordx4 v[32:35], v1, s[4:7], s20 offen offset:2048 sc1
    s_add_u32 s20, s19, 33558528
    buffer_load_dwordx4 v[36:39], v1, s[4:7], s20 offen offset:3072 sc1
    s_lshl_b32 s21, s18, 14
    s_add_u32 s20, s21, 0
    buffer_load_dwordx4 v[40:43], v1, s[4:7], s20 offen offset:0 sc1
    s_add_u32 s20, s21, 4096
    buffer_load_dwordx4 v[44:47], v1, s[4:7], s20 offen offset:0 sc1
    s_add_u32 s20, s21, 8192
    buffer_load_dwordx4 v[48:51], v1, s[4:7], s20 offen offset:0 sc1
    s_add_u32 s20, s21, 12288
    buffer_load_dwordx4 v[52:55], v1, s[4:7], s20 offen offset:0 sc1
    s_add_u32 s20, s21, 0
    buffer_load_dwordx4 v[56:59], v1, s[4:7], s20 offen offset:1024 sc1
    s_add_u32 s20, s21, 4096
    buffer_load_dwordx4 v[60:63], v1, s[4:7], s20 offen offset:1024 sc1
    s_add_u32 s20, s21, 8192
    buffer_load_dwordx4 v[64:67], v1, s[4:7], s20 offen offset:1024 sc1
    s_add_u32 s20, s21, 12288
    buffer_load_dwordx4 v[68:71], v1, s[4:7], s20 offen offset:1024 sc1
    s_add_u32 s20, s21, 0
    buffer_load_dwordx4 v[88:91], v1, s[4:7], s20 offen offset:2048 sc1
    s_add_u32 s20, s21, 4096
    buffer_load_dwordx4 v[92:95], v1, s[4:7], s20 offen offset:2048 sc1
    s_add_u32 s20, s21, 8192
    buffer_load_dwordx4 v[96:99], v1, s[4:7], s20 offen offset:2048 sc1
    s_add_u32 s20, s21, 12288
    buffer_load_dwordx4 v[100:103], v1, s[4:7], s20 offen offset:2048 sc1
    s_add_u32 s20, s21, 0
    buffer_load_dwordx4 v[104:107], v1, s[4:7], s20 offen offset:3072 sc1
    s_add_u32 s20, s21, 4096
    buffer_load_dwordx4 v[108:111], v1, s[4:7], s20 offen offset:3072 sc1
    s_add_u32 s20, s21, 8192
    buffer_load_dwordx4 v[112:115], v1, s[4:7], s20 offen offset:3072 sc1
    s_add_u32 s20, s21, 12288
    buffer_load_dwordx4 v[116:119], v1, s[4:7], s20 offen offset:3072 sc1
    v_mov_b32 v172, 0x3f803f80
    v_mov_b32 v173, 0x3f803f80
    v_mov_b32 v174, 0x3f803f80
    v_mov_b32 v175, 0x3f803f80
    v_mov_b32 v176, 0x3f003f00
    v_mov_b32 v177, 0x3f003f00
    s_waitcnt vmcnt(8)
    v_mfma_f32_16x16x32_bf16 v[136:139], v[40:43], v[8:11], 0
    v_mfma_f32_16x16x32_bf16 v[140:143], v[56:59], v[8:11], 0
    v_mfma_f32_16x16x32_bf16 v[148:151], v[40:43], v[24:27], 0
    v_mfma_f32_16x16x32_bf16 v[152:155], v[56:59], v[24:27], 0
    v_mfma_f32_16x16x32_bf16 v[136:139], v[44:47], v[12:15], v[136:139]
    v_mfma_f32_16x16x32_bf16 v[140:143], v[60:63], v[12:15], v[140:143]
    v_mfma_f32_16x16x32_bf16 v[148:151], v[44:47], v[28:31], v[148:151]
    v_mfma_f32_16x16x32_bf16 v[152:155], v[60:63], v[28:31], v[152:155]
    v_mfma_f32_16x16x32_bf16 v[136:139], v[48:51], v[16:19], v[136:139]
    v_mfma_f32_16x16x32_bf16 v[140:143], v[64:67], v[16:19], v[140:143]
    v_mfma_f32_16x16x32_bf16 v[148:151], v[48:51], v[32:35], v[148:151]
    v_mfma_f32_16x16x32_bf16 v[152:155], v[64:67], v[32:35], v[152:155]
    v_mfma_f32_16x16x32_bf16 v[136:139], v[52:55], v[20:23], v[136:139]
    v_mfma_f32_16x16x32_bf16 v[140:143], v[68:71], v[20:23], v[140:143]
    v_mfma_f32_16x16x32_bf16 v[148:151], v[52:55], v[36:39], v[148:151]
    v_mfma_f32_16x16x32_bf16 v[152:155], v[68:71], v[36:39], v[152:155]
    v_cmp_le_i32 vcc, 0, v4
    s_nop 1
    v_cndmask_b32 v136, v6, v136, vcc
    v_cmp_le_i32 vcc, 1, v4
    s_nop 1
    v_cndmask_b32 v137, v6, v137, vcc
    v_cmp_le_i32 vcc, 2, v4
    s_nop 1
    v_cndmask_b32 v138, v6, v138, vcc
    v_cmp_le_i32 vcc, 3, v4
    s_nop 1
    v_cndmask_b32 v139, v6, v139, vcc
    v_cmp_le_i32 vcc, 4, v4
    s_nop 1
    v_cndmask_b32 v140, v6, v140, vcc
    v_cmp_le_i32 vcc, 5, v4
    s_nop 1
    v_cndmask_b32 v141, v6, v141, vcc
    v_cmp_le_i32 vcc, 6, v4
    s_nop 1
    v_cndmask_b32 v142, v6, v142, vcc
    v_cmp_le_i32 vcc, 7, v4
    s_nop 1
    v_cndmask_b32 v143, v6, v143, vcc
    v_cmp_le_i32 vcc, -4, v4
    s_nop 1
    v_cndmask_b32 v148, v6, v148, vcc
    v_cmp_le_i32 vcc, -3, v4
    s_nop 1
    v_cndmask_b32 v149, v6, v149, vcc
    v_cmp_le_i32 vcc, -2, v4
    s_nop 1
    v_cndmask_b32 v150, v6, v150, vcc
    v_cmp_le_i32 vcc, -1, v4
    s_nop 1
    v_cndmask_b32 v151, v6, v151, vcc
    v_cmp_le_i32 vcc, 0, v4
    s_nop 1
    v_cndmask_b32 v152, v6, v152, vcc
    v_cmp_le_i32 vcc, 1, v4
    s_nop 1
    v_cndmask_b32 v153, v6, v153, vcc
    v_cmp_le_i32 vcc, 2, v4
    s_nop 1
    v_cndmask_b32 v154, v6, v154, vcc
    v_cmp_le_i32 vcc, 3, v4
    s_nop 1
    v_cndmask_b32 v155, v6, v155, vcc
    s_nop 1
    s_mov_b32 s88, 65536
cw16:
    buffer_load_dword v199, off, s[4:7], s36 offset:128 sc1
    s_waitcnt vmcnt(0)
    v_readfirstlane_b32 s42, v199
    s_nop 0
    s_sub_u32 s42, s42, s95
    s_cmp_gt_u32 s42, 64
    s_cselect_b32 s42, 0, s42
    s_add_u32 s42, s42, 2
    s_cmp_ge_u32 s42, s16
    s_cbranch_scc1 cw16x
    s_sub_u32 s88, s88, 1
    s_cbranch_scc1 cw16x
    s_sub_u32 s42, s16, s42
    s_min_u32 s42, s42, 6
cw16s:
    s_sleep 24
    s_sub_u32 s42, s42, 1
    s_cmp_lg_u32 s42, 0
    s_cbranch_scc1 cw16s
    s_branch cw16
cw16x:
    s_and_b32 s37, s16, 1
    s_lshl_b32 s37, s37, 2
    s_add_u32 s37, s37, s36
    s_add_u32 s37, s37, 128
    s_add_u32 s41, s16, s95
    s_add_u32 s41, s41, 1
    s_lshl_b32 s42, s17, 7
    s_add_u32 s42, s42, 125845504
    s_cmp_ge_u32 s16, 62
    s_cselect_b32 s37, s42, s37
    s_cselect_b32 s42, 12, 8
    v_lshlrev_b32 v198, 2, v0
    v_and_b32 v198, s42, v198
    s_mov_b32 s40, 4194304
L_aw2:
    buffer_load_dword v199, v198, s[4:7], s37 offen sc1
    s_sub_u32 s40, s40, 1
    s_cbranch_scc1 L_aw2_go
    s_waitcnt vmcnt(0)
    v_subrev_u32 v199, s41, v199
    v_cmp_lt_u32 vcc, 64, v199
    s_cbranch_vccz L_aw2_go
    s_sleep 3
    s_branch L_aw2
L_aw2_go:
    s_lshl_b32 s20, s18, 12
    s_add_u32 s20, s20, 71303168
    buffer_load_dwordx4 v[72:75], v3, s[4:7], s20 offen offset:0 sc1
    buffer_load_dwordx4 v[76:79], v3, s[4:7], s20 offen offset:1024 sc1
    buffer_load_dwordx4 v[80:83], v3, s[4:7], s20 offen offset:2048 sc1
    buffer_load_dwordx4 v[84:87], v3, s[4:7], s20 offen offset:3072 sc1
    s_lshl_b32 s20, s18, 12
    s_add_u32 s20, s20, 80740352
    buffer_load_dwordx4 v[120:123], v1, s[4:7], s20 offen offset:0 sc1
    buffer_load_dwordx4 v[124:127], v1, s[4:7], s20 offen offset:1024 sc1
    buffer_load_dwordx4 v[128:131], v1, s[4:7], s20 offen offset:2048 sc1
    buffer_load_dwordx4 v[132:135], v1, s[4:7], s20 offen offset:3072 sc1
    s_waitcnt vmcnt(4)
    v_mfma_f32_16x16x32_bf16 v[144:147], v[72:75], v[8:11], 0
    v_mfma_f32_16x16x32_bf16 v[156:159], v[72:75], v[24:27], 0
    v_mfma_f32_16x16x32_bf16 v[144:147], v[76:79], v[12:15], v[144:147]
    v_mfma_f32_16x16x32_bf16 v[156:159], v[76:79], v[28:31], v[156:159]
    v_mfma_f32_16x16x32_bf16 v[144:147], v[80:83], v[16:19], v[144:147]
    v_mfma_f32_16x16x32_bf16 v[156:159], v[80:83], v[32:35], v[156:159]
    v_mfma_f32_16x16x32_bf16 v[144:147], v[84:87], v[20:23], v[144:147]
    v_mfma_f32_16x16x32_bf16 v[156:159], v[84:87], v[36:39], v[156:159]
    v_max3_f32 v196, v136, v137, v138
    v_max3_f32 v197, v139, v140, v141
    v_max3_f32 v196, v196, v142, v143
    v_max3_f32 v197, v197, v144, v145
    v_max3_f32 v196, v196, v146, v147
    v_max_f32 v196, v196, v197
    v_mov_b32 v197, v196
    s_nop 1
    v_permlane32_swap_b32 v196, v197
    v_max_f32 v196, v196, v197
    v_mov_b32 v197, v196
    s_nop 1
    v_permlane16_swap_b32 v196, v197
    v_max_f32 v196, v196, v197
    v_mul_f32 v196, s22, v196
    v_sub_f32 v196, 0, v196
    v_fma_f32 v136, v136, s22, v196
    v_fma_f32 v137, v137, s22, v196
    v_fma_f32 v138, v138, s22, v196
    v_fma_f32 v139, v139, s22, v196
    v_fma_f32 v140, v140, s22, v196
    v_fma_f32 v141, v141, s22, v196
    v_fma_f32 v142, v142, s22, v196
    v_fma_f32 v143, v143, s22, v196
    v_fma_f32 v144, v144, s22, v196
    v_fma_f32 v145, v145, s22, v196
    v_fma_f32 v146, v146, s22, v196
    v_fma_f32 v147, v147, s22, v196
    v_exp_f32 v136, v136
    v_exp_f32 v137, v137
    v_exp_f32 v138, v138
    v_exp_f32 v139, v139
    v_exp_f32 v140, v140
    v_exp_f32 v141, v141
    v_exp_f32 v142, v142
    v_exp_f32 v143, v143
    v_exp_f32 v144, v144
    v_exp_f32 v145, v145
    v_exp_f32 v146, v146
    v_exp_f32 v147, v147
    v_cvt_pk_bf16_f32 v160, v136, v137
    v_cvt_pk_bf16_f32 v161, v138, v139
    v_cvt_pk_bf16_f32 v162, v140, v141
    v_cvt_pk_bf16_f32 v163, v142, v143
    v_cvt_pk_bf16_f32 v164, v144, v145
    v_cvt_pk_bf16_f32 v165, v146, v147
    v_max3_f32 v196, v148, v149, v150
    v_max3_f32 v197, v151, v152, v153
    v_max3_f32 v196, v196, v154, v155
    v_max3_f32 v197, v197, v156, v157
    v_max3_f32 v196, v196, v158, v159
    v_max_f32 v196, v196, v197
    v_mov_b32 v197, v196
    s_nop 1
    v_permlane32_swap_b32 v196, v197
    v_max_f32 v196, v196, v197
    v_mov_b32 v197, v196
    s_nop 1
    v_permlane16_swap_b32 v196, v197
    v_max_f32 v196, v196, v197
    v_mul_f32 v196, s22, v196
    v_sub_f32 v196, 0, v196
    v_fma_f32 v148, v148, s22, v196
    v_fma_f32 v149, v149, s22, v196
    v_fma_f32 v150, v150, s22, v196
    v_fma_f32 v151, v151, s22, v196
    v_fma_f32 v152, v152, s22, v196
    v_fma_f32 v153, v153, s22, v196
    v_fma_f32 v154, v154, s22, v196
    v_fma_f32 v155, v155, s22, v196
    v_fma_f32 v156, v156, s22, v196
    v_fma_f32 v157, v157, s22, v196
    v_fma_f32 v158, v158, s22, v196
    v_fma_f32 v159, v159, s22, v196
    v_exp_f32 v148, v148
    v_exp_f32 v149, v149
    v_exp_f32 v150, v150
    v_exp_f32 v151, v151
    v_exp_f32 v152, v152
    v_exp_f32 v153, v153
    v_exp_f32 v154, v154
    v_exp_f32 v155, v155
    v_exp_f32 v156, v156
    v_exp_f32 v157, v157
    v_exp_f32 v158, v158
    v_exp_f32 v159, v159
    v_cvt_pk_bf16_f32 v166, v148, v149
    v_cvt_pk_bf16_f32 v167, v150, v151
    v_cvt_pk_bf16_f32 v168, v152, v153
    v_cvt_pk_bf16_f32 v169, v154, v155
    v_cvt_pk_bf16_f32 v170, v156, v157
    v_cvt_pk_bf16_f32 v171, v158, v159
    v_mfma_f32_16x16x32_bf16 v[180:183], v[172:175], v[160:163], 0
    v_mfma_f32_16x16x32_bf16 v[184:187], v[172:175], v[166:169], 0
    v_mfma_f32_16x16x16_bf16 v[180:183], v[176:177], v[164:165], v[180:183]
    v_mfma_f32_16x16x16_bf16 v[184:187], v[176:177], v[170:171], v[184:187]
    s_nop 3
    v_rcp_f32 v180, v180
    s_nop 2
    v_rcp_f32 v184, v184
    s_waitcnt vmcnt(0)
    s_lshl_b32 s18, s16, 18
    s_lshl_b32 s19, s17, 12
    s_add_u32 s18, s18, s19
    s_add_u32 s18, s18, 50331648
    s_add_u32 s19, s18, 131072
    v_mfma_f32_16x16x32_bf16 v[8:11], v[88:91], v[160:163], 0
    v_mfma_f32_16x16x32_bf16 v[12:15], v[104:107], v[160:163], 0
    v_mfma_f32_16x16x32_bf16 v[16:19], v[88:91], v[166:169], 0
    v_mfma_f32_16x16x32_bf16 v[20:23], v[104:107], v[166:169], 0
    v_mfma_f32_16x16x32_bf16 v[24:27], v[92:95], v[160:163], 0
    v_mfma_f32_16x16x32_bf16 v[28:31], v[108:111], v[160:163], 0
    v_mfma_f32_16x16x32_bf16 v[32:35], v[92:95], v[166:169], 0
    v_mfma_f32_16x16x32_bf16 v[36:39], v[108:111], v[166:169], 0
    v_mfma_f32_16x16x32_bf16 v[40:43], v[96:99], v[160:163], 0
    v_mfma_f32_16x16x32_bf16 v[44:47], v[112:115], v[160:163], 0
    v_mfma_f32_16x16x32_bf16 v[48:51], v[96:99], v[166:169], 0
    v_mfma_f32_16x16x32_bf16 v[52:55], v[112:115], v[166:169], 0
    v_mfma_f32_16x16x32_bf16 v[56:59], v[100:103], v[160:163], 0
    v_mfma_f32_16x16x32_bf16 v[60:63], v[116:119], v[160:163], 0
    v_mfma_f32_16x16x32_bf16 v[64:67], v[100:103], v[166:169], 0
    v_mfma_f32_16x16x32_bf16 v[68:71], v[116:119], v[166:169], 0
    v_mfma_f32_16x16x16_bf16 v[8:11], v[120:121], v[164:165], v[8:11]
    v_mfma_f32_16x16x16_bf16 v[12:15], v[122:123], v[164:165], v[12:15]
    v_mfma_f32_16x16x16_bf16 v[16:19], v[120:121], v[170:171], v[16:19]
    v_mfma_f32_16x16x16_bf16 v[20:23], v[122:123], v[170:171], v[20:23]
    v_mfma_f32_16x16x16_bf16 v[24:27], v[124:125], v[164:165], v[24:27]
    v_mfma_f32_16x16x16_bf16 v[28:31], v[126:127], v[164:165], v[28:31]
    v_mfma_f32_16x16x16_bf16 v[32:35], v[124:125], v[170:171], v[32:35]
    v_mfma_f32_16x16x16_bf16 v[36:39], v[126:127], v[170:171], v[36:39]
    v_mfma_f32_16x16x16_bf16 v[40:43], v[128:129], v[164:165], v[40:43]
    v_mfma_f32_16x16x16_bf16 v[44:47], v[130:131], v[164:165], v[44:47]
    v_mfma_f32_16x16x16_bf16 v[48:51], v[128:129], v[170:171], v[48:51]
    v_mfma_f32_16x16x16_bf16 v[52:55], v[130:131], v[170:171], v[52:55]
    v_mfma_f32_16x16x16_bf16 v[56:59], v[132:133], v[164:165], v[56:59]
    v_mfma_f32_16x16x16_bf16 v[60:63], v[134:135], v[164:165], v[60:63]
    v_mfma_f32_16x16x16_bf16 v[64:67], v[132:133], v[170:171], v[64:67]
    v_mfma_f32_16x16x16_bf16 v[68:71], v[134:135], v[170:171], v[68:71]
    v_mul_f32 v8, v8, v180
    v_mul_f32 v12, v12, v180
    v_mul_f32 v9, v9, v180
    v_mul_f32 v13, v13, v180
    v_mul_f32 v10, v10, v180
    v_mul_f32 v14, v14, v180
    v_mul_f32 v11, v11, v180
    v_mul_f32 v15, v15, v180
    v_cvt_pk_bf16_f32 v8, v8, v9
    v_cvt_pk_bf16_f32 v9, v10, v11
    v_cvt_pk_bf16_f32 v10, v12, v13
    v_cvt_pk_bf16_f32 v11, v14, v15
    buffer_store_dwordx4 v[8:11], v1, s[4:7], s18 offen offset:0 sc1
    v_mul_f32 v16, v16, v184
    v_mul_f32 v20, v20, v184
    v_mul_f32 v17, v17, v184
    v_mul_f32 v21, v21, v184
    v_mul_f32 v18, v18, v184
    v_mul_f32 v22, v22, v184
    v_mul_f32 v19, v19, v184
    v_mul_f32 v23, v23, v184
    v_cvt_pk_bf16_f32 v16, v16, v17
    v_cvt_pk_bf16_f32 v17, v18, v19
    v_cvt_pk_bf16_f32 v18, v20, v21
    v_cvt_pk_bf16_f32 v19, v22, v23
    buffer_store_dwordx4 v[16:19], v1, s[4:7], s19 offen offset:0 sc1
    v_mul_f32 v24, v24, v180
    v_mul_f32 v28, v28, v180
    v_mul_f32 v25, v25, v180
    v_mul_f32 v29, v29, v180
    v_mul_f32 v26, v26, v180
    v_mul_f32 v30, v30, v180
    v_mul_f32 v27, v27, v180
    v_mul_f32 v31, v31, v180
    v_cvt_pk_bf16_f32 v24, v24, v25
    v_cvt_pk_bf16_f32 v25, v26, v27
    v_cvt_pk_bf16_f32 v26, v28, v29
    v_cvt_pk_bf16_f32 v27, v30, v31
    buffer_store_dwordx4 v[24:27], v1, s[4:7], s18 offen offset:1024 sc1
    v_mul_f32 v32, v32, v184
    v_mul_f32 v36, v36, v184
    v_mul_f32 v33, v33, v184
    v_mul_f32 v37, v37, v184
    v_mul_f32 v34, v34, v184
    v_mul_f32 v38, v38, v184
    v_mul_f32 v35, v35, v184
    v_mul_f32 v39, v39, v184
    v_cvt_pk_bf16_f32 v32, v32, v33
    v_cvt_pk_bf16_f32 v33, v34, v35
    v_cvt_pk_bf16_f32 v34, v36, v37
    v_cvt_pk_bf16_f32 v35, v38, v39
    buffer_store_dwordx4 v[32:35], v1, s[4:7], s19 offen offset:1024 sc1
    v_mul_f32 v40, v40, v180
    v_mul_f32 v44, v44, v180
    v_mul_f32 v41, v41, v180
    v_mul_f32 v45, v45, v180
    v_mul_f32 v42, v42, v180
    v_mul_f32 v46, v46, v180
    v_mul_f32 v43, v43, v180
    v_mul_f32 v47, v47, v180
    v_cvt_pk_bf16_f32 v40, v40, v41
    v_cvt_pk_bf16_f32 v41, v42, v43
    v_cvt_pk_bf16_f32 v42, v44, v45
    v_cvt_pk_bf16_f32 v43, v46, v47
    buffer_store_dwordx4 v[40:43], v1, s[4:7], s18 offen offset:2048 sc1
    v_mul_f32 v48, v48, v184
    v_mul_f32 v52, v52, v184
    v_mul_f32 v49, v49, v184
    v_mul_f32 v53, v53, v184
    v_mul_f32 v50, v50, v184
    v_mul_f32 v54, v54, v184
    v_mul_f32 v51, v51, v184
    v_mul_f32 v55, v55, v184
    v_cvt_pk_bf16_f32 v48, v48, v49
    v_cvt_pk_bf16_f32 v49, v50, v51
    v_cvt_pk_bf16_f32 v50, v52, v53
    v_cvt_pk_bf16_f32 v51, v54, v55
    buffer_store_dwordx4 v[48:51], v1, s[4:7], s19 offen offset:2048 sc1
    v_mul_f32 v56, v56, v180
    v_mul_f32 v60, v60, v180
    v_mul_f32 v57, v57, v180
    v_mul_f32 v61, v61, v180
    v_mul_f32 v58, v58, v180
    v_mul_f32 v62, v62, v180
    v_mul_f32 v59, v59, v180
    v_mul_f32 v63, v63, v180
    v_cvt_pk_bf16_f32 v56, v56, v57
    v_cvt_pk_bf16_f32 v57, v58, v59
    v_cvt_pk_bf16_f32 v58, v60, v61
    v_cvt_pk_bf16_f32 v59, v62, v63
    buffer_store_dwordx4 v[56:59], v1, s[4:7], s18 offen offset:3072 sc1
    v_mul_f32 v64, v64, v184
    v_mul_f32 v68, v68, v184
    v_mul_f32 v65, v65, v184
    v_mul_f32 v69, v69, v184
    v_mul_f32 v66, v66, v184
    v_mul_f32 v70, v70, v184
    v_mul_f32 v67, v67, v184
    v_mul_f32 v71, v71, v184
    v_cvt_pk_bf16_f32 v64, v64, v65
    v_cvt_pk_bf16_f32 v65, v66, v67
    v_cvt_pk_bf16_f32 v66, v68, v69
    v_cvt_pk_bf16_f32 v67, v70, v71
    buffer_store_dwordx4 v[64:67], v1, s[4:7], s19 offen offset:3072 sc1
    s_lshr_b32 s40, s34, 1
    s_lshl_b32 s40, s40, 7
    s_and_b32 s41, s17, 7
    s_lshl_b32 s41, s41, 2
    s_add_u32 s40, s40, s41
    s_add_u32 s40, s40, 125894656
    v_mov_b32 v250, s95
    s_waitcnt vmcnt(0)
    s_mov_b64 exec, 1
    buffer_store_dword v250, off, s[4:7], s40 sc1
    s_mov_b64 exec, -1
    s_add_u32 s34, s34, 32
    s_cmp_lt_u32 s34, 512
    s_cbranch_scc1 L_att_next
    s_branch L_done
L_op_start:
    s_mov_b32 s16, s33
    s_mov_b32 s33, s34
    v_and_b32 v2, 63, v0
    v_lshlrev_b32 v1, 4, v2
    v_lshrrev_b32 v5, 2, v2
    v_mul_u32_u24 v3, 1152, v5
    v_and_b32 v5, 3, v2
    v_lshl_add_u32 v3, v5, 4, v3
    s_lshl_b32 s21, s32, 12
    v_add_u32 v4, s21, v1
    s_mov_b64 s[12:13], s[58:59]
    s_mov_b32 s14, 4718592
    s_mov_b32 s15, 0x20000
    s_mul_i32 s19, s32, 1179648
    s_lshl_b32 s18, s33, 6
    s_add_u32 s19, s19, s18
    s_add_u32 s18, s19, 0
    s_add_u32 m0, s21, 0
    s_nop 0
    buffer_load_dwordx4 v3, s[12:15], s18 offen lds
    s_add_u32 m0, s21, 1024
    s_add_u32 s18, s18, 18432
    buffer_load_dwordx4 v3, s[12:15], s18 offen lds
    s_add_u32 m0, s21, 2048
    s_add_u32 s18, s18, 18432
    buffer_load_dwordx4 v3, s[12:15], s18 offen lds
    s_add_u32 m0, s21, 3072
    s_add_u32 s18, s18, 18432
    buffer_load_dwordx4 v3, s[12:15], s18 offen lds
    s_add_u32 s18, s19, 73728
    s_add_u32 m0, s21, 16384
    s_nop 0
    buffer_load_dwordx4 v3, s[12:15], s18 offen lds
    s_add_u32 m0, s21, 17408
    s_add_u32 s18, s18, 18432
    buffer_load_dwordx4 v3, s[12:15], s18 offen lds
    s_add_u32 m0, s21, 18432
    s_add_u32 s18, s18, 18432
    buffer_load_dwordx4 v3, s[12:15], s18 offen lds
    s_add_u32 m0, s21, 19456
    s_add_u32 s18, s18, 18432
    buffer_load_dwordx4 v3, s[12:15], s18 offen lds
    s_add_u32 s18, s19, 147456
    s_add_u32 m0, s21, 32768
    s_nop 0
    buffer_load_dwordx4 v3, s[12:15], s18 offen lds
    s_add_u32 m0, s21, 33792
    s_add_u32 s18, s18, 18432
    buffer_load_dwordx4 v3, s[12:15], s18 offen lds
    s_add_u32 m0, s21, 34816
    s_add_u32 s18, s18, 18432
    buffer_load_dwordx4 v3, s[12:15], s18 offen lds
    s_add_u32 m0, s21, 35840
    s_add_u32 s18, s18, 18432
    buffer_load_dwordx4 v3, s[12:15], s18 offen lds
    s_add_u32 s18, s19, 221184
    s_add_u32 m0, s21, 49152
    s_nop 0
    buffer_load_dwordx4 v3, s[12:15], s18 offen lds
    s_add_u32 m0, s21, 50176
    s_add_u32 s18, s18, 18432
    buffer_load_dwordx4 v3, s[12:15], s18 offen lds
    s_add_u32 m0, s21, 51200
    s_add_u32 s18, s18, 18432
    buffer_load_dwordx4 v3, s[12:15], s18 offen lds
    s_add_u32 m0, s21, 52224
    s_add_u32 s18, s18, 18432
    buffer_load_dwordx4 v3, s[12:15], s18 offen lds
    s_add_u32 s18, s19, 294912
    s_add_u32 m0, s21, 65536
    s_nop 0
    buffer_load_dwordx4 v3, s[12:15], s18 offen lds
    s_add_u32 m0, s21, 66560
    s_add_u32 s18, s18, 18432
    buffer_load_dwordx4 v3, s[12:15], s18 offen lds
    s_add_u32 m0, s21, 67584
    s_add_u32 s18, s18, 18432
    buffer_load_dwordx4 v3, s[12:15], s18 offen lds
    s_add_u32 m0, s21, 68608
    s_add_u32 s18, s18, 18432
    buffer_load_dwordx4 v3, s[12:15], s18 offen lds
    s_add_u32 s18, s19, 368640
    s_add_u32 m0, s21, 81920
    s_nop 0
    buffer_load_dwordx4 v3, s[12:15], s18 offen lds
    s_add_u32 m0, s21, 82944
    s_add_u32 s18, s18, 18432
    buffer_load_dwordx4 v3, s[12:15], s18 offen lds
    s_add_u32 m0, s21, 83968
    s_add_u32 s18, s18, 18432
    buffer_load_dwordx4 v3, s[12:15], s18 offen lds
    s_add_u32 m0, s21, 84992
    s_add_u32 s18, s18, 18432
    buffer_load_dwordx4 v3, s[12:15], s18 offen lds
    s_add_u32 s18, s19, 442368
    s_add_u32 m0, s21, 98304
    s_nop 0
    buffer_load_dwordx4 v3, s[12:15], s18 offen lds
    s_add_u32 m0, s21, 99328
    s_add_u32 s18, s18, 18432
    buffer_load_dwordx4 v3, s[12:15], s18 offen lds
    s_add_u32 m0, s21, 100352
    s_add_u32 s18, s18, 18432
    buffer_load_dwordx4 v3, s[12:15], s18 offen lds
    s_add_u32 m0, s21, 101376
    s_add_u32 s18, s18, 18432
    buffer_load_dwordx4 v3, s[12:15], s18 offen lds
    s_add_u32 s18, s19, 516096
    s_add_u32 m0, s21, 114688
    s_nop 0
    buffer_load_dwordx4 v3, s[12:15], s18 offen lds
    s_add_u32 m0, s21, 115712
    s_add_u32 s18, s18, 18432
    buffer_load_dwordx4 v3, s[12:15], s18 offen lds
    s_add_u32 m0, s21, 116736
    s_add_u32 s18, s18, 18432
    buffer_load_dwordx4 v3, s[12:15], s18 offen lds
    s_add_u32 m0, s21, 117760
    s_add_u32 s18, s18, 18432
    buffer_load_dwordx4 v3, s[12:15], s18 offen lds
    s_add_u32 s18, s19, 589824
    s_add_u32 m0, s21, 131072
    s_nop 0
    buffer_load_dwordx4 v3, s[12:15], s18 offen lds
    s_add_u32 m0, s21, 132096
    s_add_u32 s18, s18, 18432
    buffer_load_dwordx4 v3, s[12:15], s18 offen lds
    s_add_u32 m0, s21, 133120
    s_add_u32 s18, s18, 18432
    buffer_load_dwordx4 v3, s[12:15], s18 offen lds
    s_add_u32 m0, s21, 134144
    s_add_u32 s18, s18, 18432
    buffer_load_dwordx4 v3, s[12:15], s18 offen lds
    v_add_u32 v6, 0, v4
    v_xor_b32 v7, 32, v6
    s_waitcnt vmcnt(32)
    ds_read_b64_tr_b16 a[0:1], v6 offset:0
    ds_read_b64_tr_b16 a[2:3], v6 offset:1024
    ds_read_b64_tr_b16 a[4:5], v6 offset:8
    ds_read_b64_tr_b16 a[6:7], v6 offset:1032
    ds_read_b64_tr_b16 a[8:9], v6 offset:2048
    ds_read_b64_tr_b16 a[10:11], v6 offset:3072
    ds_read_b64_tr_b16 a[12:13], v6 offset:2056
    ds_read_b64_tr_b16 a[14:15], v6 offset:3080
    s_waitcnt lgkmcnt(0)
    s_add_u32 s18, s19, 663552
    s_add_u32 m0, s21, 0
    s_nop 0
    buffer_load_dwordx4 v3, s[12:15], s18 offen lds
    s_add_u32 m0, s21, 1024
    s_add_u32 s18, s18, 18432
    buffer_load_dwordx4 v3, s[12:15], s18 offen lds
    s_add_u32 m0, s21, 2048
    s_add_u32 s18, s18, 18432
    buffer_load_dwordx4 v3, s[12:15], s18 offen lds
    s_add_u32 m0, s21, 3072
    s_add_u32 s18, s18, 18432
    buffer_load_dwordx4 v3, s[12:15], s18 offen lds
    v_add_u32 v6, 16384, v4
    v_xor_b32 v7, 32, v6
    s_waitcnt vmcnt(32)
    ds_read_b64_tr_b16 a[16:17], v6 offset:0
    ds_read_b64_tr_b16 a[18:19], v6 offset:1024
    ds_read_b64_tr_b16 a[20:21], v6 offset:8
    ds_read_b64_tr_b16 a[22:23], v6 offset:1032
    ds_read_b64_tr_b16 a[24:25], v6 offset:2048
    ds_read_b64_tr_b16 a[26:27], v6 offset:3072
    ds_read_b64_tr_b16 a[28:29], v6 offset:2056
    ds_read_b64_tr_b16 a[30:31], v6 offset:3080
    s_waitcnt lgkmcnt(0)
    s_add_u32 s18, s19, 737280
    s_add_u32 m0, s21, 16384
    s_nop 0
    buffer_load_dwordx4 v3, s[12:15], s18 offen lds
    s_add_u32 m0, s21, 17408
    s_add_u32 s18, s18, 18432
    buffer_load_dwordx4 v3, s[12:15], s18 offen lds
    s_add_u32 m0, s21, 18432
    s_add_u32 s18, s18, 18432
    buffer_load_dwordx4 v3, s[12:15], s18 offen lds
    s_add_u32 m0, s21, 19456
    s_add_u32 s18, s18, 18432
    buffer_load_dwordx4 v3, s[12:15], s18 offen lds
    v_add_u32 v6, 32768, v4
    v_xor_b32 v7, 32, v6
    s_waitcnt vmcnt(32)
    ds_read_b64_tr_b16 a[32:33], v6 offset:0
    ds_read_b64_tr_b16 a[34:35], v6 offset:1024
    ds_read_b64_tr_b16 a[36:37], v6 offset:8
    ds_read_b64_tr_b16 a[38:39], v6 offset:1032
    ds_read_b64_tr_b16 a[40:41], v6 offset:2048
    ds_read_b64_tr_b16 a[42:43], v6 offset:3072
    ds_read_b64_tr_b16 a[44:45], v6 offset:2056
    ds_read_b64_tr_b16 a[46:47], v6 offset:3080
    s_waitcnt lgkmcnt(0)
    s_add_u32 s18, s19, 811008
    s_add_u32 m0, s21, 32768
    s_nop 0
    buffer_load_dwordx4 v3, s[12:15], s18 offen lds
    s_add_u32 m0, s21, 33792
    s_add_u32 s18, s18, 18432
    buffer_load_dwordx4 v3, s[12:15], s18 offen lds
    s_add_u32 m0, s21, 34816
    s_add_u32 s18, s18, 18432
    buffer_load_dwordx4 v3, s[12:15], s18 offen lds
    s_add_u32 m0, s21, 35840
    s_add_u32 s18, s18, 18432
    buffer_load_dwordx4 v3, s[12:15], s18 offen lds
    v_add_u32 v6, 49152, v4
    v_xor_b32 v7, 32, v6
    s_waitcnt vmcnt(32)
    ds_read_b64_tr_b16 a[48:49], v6 offset:0
    ds_read_b64_tr_b16 a[50:51], v6 offset:1024
    ds_read_b64_tr_b16 a[52:53], v6 offset:8
    ds_read_b64_tr_b16 a[54:55], v6 offset:1032
    ds_read_b64_tr_b16 a[56:57], v6 offset:2048
    ds_read_b64_tr_b16 a[58:59], v6 offset:3072
    ds_read_b64_tr_b16 a[60:61], v6 offset:2056
    ds_read_b64_tr_b16 a[62:63], v6 offset:3080
    s_waitcnt lgkmcnt(0)
    s_add_u32 s18, s19, 884736
    s_add_u32 m0, s21, 49152
    s_nop 0
    buffer_load_dwordx4 v3, s[12:15], s18 offen lds
    s_add_u32 m0, s21, 50176
    s_add_u32 s18, s18, 18432
    buffer_load_dwordx4 v3, s[12:15], s18 offen lds
    s_add_u32 m0, s21, 51200
    s_add_u32 s18, s18, 18432
    buffer_load_dwordx4 v3, s[12:15], s18 offen lds
    s_add_u32 m0, s21, 52224
    s_add_u32 s18, s18, 18432
    buffer_load_dwordx4 v3, s[12:15], s18 offen lds
    v_add_u32 v6, 65536, v4
    v_xor_b32 v7, 32, v6
    s_waitcnt vmcnt(32)
    ds_read_b64_tr_b16 a[64:65], v6 offset:0
    ds_read_b64_tr_b16 a[66:67], v6 offset:1024
    ds_read_b64_tr_b16 a[68:69], v6 offset:8
    ds_read_b64_tr_b16 a[70:71], v6 offset:1032
    ds_read_b64_tr_b16 a[72:73], v6 offset:2048
    ds_read_b64_tr_b16 a[74:75], v6 offset:3072
    ds_read_b64_tr_b16 a[76:77], v6 offset:2056
    ds_read_b64_tr_b16 a[78:79], v6 offset:3080
    s_waitcnt lgkmcnt(0)
    s_add_u32 s18, s19, 958464
    s_add_u32 m0, s21, 65536
    s_nop 0
    buffer_load_dwordx4 v3, s[12:15], s18 offen lds
    s_add_u32 m0, s21, 66560
    s_add_u32 s18, s18, 18432
    buffer_load_dwordx4 v3, s[12:15], s18 offen lds
    s_add_u32 m0, s21, 67584
    s_add_u32 s18, s18, 18432
    buffer_load_dwordx4 v3, s[12:15], s18 offen lds
    s_add_u32 m0, s21, 68608
    s_add_u32 s18, s18, 18432
    buffer_load_dwordx4 v3, s[12:15], s18 offen lds
    v_add_u32 v6, 81920, v4
    v_xor_b32 v7, 32, v6
    s_waitcnt vmcnt(32)
    ds_read_b64_tr_b16 a[80:81], v6 offset:0
    ds_read_b64_tr_b16 a[82:83], v6 offset:1024
    ds_read_b64_tr_b16 a[84:85], v6 offset:8
    ds_read_b64_tr_b16 a[86:87], v6 offset:1032
    ds_read_b64_tr_b16 a[88:89], v6 offset:2048
    ds_read_b64_tr_b16 a[90:91], v6 offset:3072
    ds_read_b64_tr_b16 a[92:93], v6 offset:2056
    ds_read_b64_tr_b16 a[94:95], v6 offset:3080
    s_waitcnt lgkmcnt(0)
    s_add_u32 s18, s19, 1032192
    s_add_u32 m0, s21, 81920
    s_nop 0
    buffer_load_dwordx4 v3, s[12:15], s18 offen lds
    s_add_u32 m0, s21, 82944
    s_add_u32 s18, s18, 18432
    buffer_load_dwordx4 v3, s[12:15], s18 offen lds
    s_add_u32 m0, s21, 83968
    s_add_u32 s18, s18, 18432
    buffer_load_dwordx4 v3, s[12:15], s18 offen lds
    s_add_u32 m0, s21, 84992
    s_add_u32 s18, s18, 18432
    buffer_load_dwordx4 v3, s[12:15], s18 offen lds
    v_add_u32 v6, 98304, v4
    v_xor_b32 v7, 32, v6
    s_waitcnt vmcnt(32)
    ds_read_b64_tr_b16 a[96:97], v6 offset:0
    ds_read_b64_tr_b16 a[98:99], v6 offset:1024
    ds_read_b64_tr_b16 a[100:101], v6 offset:8
    ds_read_b64_tr_b16 a[102:103], v6 offset:1032
    ds_read_b64_tr_b16 a[104:105], v6 offset:2048
    ds_read_b64_tr_b16 a[106:107], v6 offset:3072
    ds_read_b64_tr_b16 a[108:109], v6 offset:2056
    ds_read_b64_tr_b16 a[110:111], v6 offset:3080
    s_waitcnt lgkmcnt(0)
    s_add_u32 s18, s19, 1105920
    s_add_u32 m0, s21, 98304
    s_nop 0
    buffer_load_dwordx4 v3, s[12:15], s18 offen lds
    s_add_u32 m0, s21, 99328
    s_add_u32 s18, s18, 18432
    buffer_load_dwordx4 v3, s[12:15], s18 offen lds
    s_add_u32 m0, s21, 100352
    s_add_u32 s18, s18, 18432
    buffer_load_dwordx4 v3, s[12:15], s18 offen lds
    s_add_u32 m0, s21, 101376
    s_add_u32 s18, s18, 18432
    buffer_load_dwordx4 v3, s[12:15], s18 offen lds
    v_add_u32 v6, 114688, v4
    v_xor_b32 v7, 32, v6
    s_waitcnt vmcnt(32)
    ds_read_b64_tr_b16 a[112:113], v6 offset:0
    ds_read_b64_tr_b16 a[114:115], v6 offset:1024
    ds_read_b64_tr_b16 a[116:117], v6 offset:8
    ds_read_b64_tr_b16 a[118:119], v6 offset:1032
    ds_read_b64_tr_b16 a[120:121], v6 offset:2048
    ds_read_b64_tr_b16 a[122:123], v6 offset:3072
    ds_read_b64_tr_b16 a[124:125], v6 offset:2056
    ds_read_b64_tr_b16 a[126:127], v6 offset:3080
    s_waitcnt lgkmcnt(0)
    v_add_u32 v6, 131072, v4
    v_xor_b32 v7, 32, v6
    s_waitcnt vmcnt(28)
    ds_read_b64_tr_b16 a[128:129], v6 offset:0
    ds_read_b64_tr_b16 a[130:131], v6 offset:1024
    ds_read_b64_tr_b16 a[132:133], v6 offset:8
    ds_read_b64_tr_b16 a[134:135], v6 offset:1032
    ds_read_b64_tr_b16 a[136:137], v6 offset:2048
    ds_read_b64_tr_b16 a[138:139], v6 offset:3072
    ds_read_b64_tr_b16 a[140:141], v6 offset:2056
    ds_read_b64_tr_b16 a[142:143], v6 offset:3080
    s_waitcnt lgkmcnt(0)
    v_add_u32 v6, 0, v4
    v_xor_b32 v7, 32, v6
    s_waitcnt vmcnt(24)
    ds_read_b64_tr_b16 a[144:145], v6 offset:0
    ds_read_b64_tr_b16 a[146:147], v6 offset:1024
    ds_read_b64_tr_b16 a[148:149], v6 offset:8
    ds_read_b64_tr_b16 a[150:151], v6 offset:1032
    ds_read_b64_tr_b16 a[152:153], v6 offset:2048
    ds_read_b64_tr_b16 a[154:155], v6 offset:3072
    ds_read_b64_tr_b16 a[156:157], v6 offset:2056
    ds_read_b64_tr_b16 a[158:159], v6 offset:3080
    s_waitcnt lgkmcnt(0)
    v_add_u32 v6, 16384, v4
    v_xor_b32 v7, 32, v6
    s_waitcnt vmcnt(20)
    ds_read_b64_tr_b16 a[160:161], v6 offset:0
    ds_read_b64_tr_b16 a[162:163], v6 offset:1024
    ds_read_b64_tr_b16 a[164:165], v6 offset:8
    ds_read_b64_tr_b16 a[166:167], v6 offset:1032
    ds_read_b64_tr_b16 a[168:169], v6 offset:2048
    ds_read_b64_tr_b16 a[170:171], v6 offset:3072
    ds_read_b64_tr_b16 a[172:173], v6 offset:2056
    ds_read_b64_tr_b16 a[174:175], v6 offset:3080
    s_waitcnt lgkmcnt(0)
    v_add_u32 v6, 32768, v4
    v_xor_b32 v7, 32, v6
    s_waitcnt vmcnt(16)
    ds_read_b64_tr_b16 a[176:177], v6 offset:0
    ds_read_b64_tr_b16 a[178:179], v6 offset:1024
    ds_read_b64_tr_b16 a[180:181], v6 offset:8
    ds_read_b64_tr_b16 a[182:183], v6 offset:1032
    ds_read_b64_tr_b16 a[184:185], v6 offset:2048
    ds_read_b64_tr_b16 a[186:187], v6 offset:3072
    ds_read_b64_tr_b16 a[188:189], v6 offset:2056
    ds_read_b64_tr_b16 a[190:191], v6 offset:3080
    s_waitcnt lgkmcnt(0)
    v_add_u32 v6, 49152, v4
    v_xor_b32 v7, 32, v6
    s_waitcnt vmcnt(12)
    ds_read_b64_tr_b16 a[192:193], v6 offset:0
    ds_read_b64_tr_b16 a[194:195], v6 offset:1024
    ds_read_b64_tr_b16 a[196:197], v6 offset:8
    ds_read_b64_tr_b16 a[198:199], v6 offset:1032
    ds_read_b64_tr_b16 a[200:201], v6 offset:2048
    ds_read_b64_tr_b16 a[202:203], v6 offset:3072
    ds_read_b64_tr_b16 a[204:205], v6 offset:2056
    ds_read_b64_tr_b16 a[206:207], v6 offset:3080
    s_waitcnt lgkmcnt(0)
    v_add_u32 v6, 65536, v4
    v_xor_b32 v7, 32, v6
    s_waitcnt vmcnt(8)
    ds_read_b64_tr_b16 a[208:209], v6 offset:0
    ds_read_b64_tr_b16 a[210:211], v6 offset:1024
    ds_read_b64_tr_b16 a[212:213], v6 offset:8
    ds_read_b64_tr_b16 a[214:215], v6 offset:1032
    ds_read_b64_tr_b16 a[216:217], v6 offset:2048
    ds_read_b64_tr_b16 a[218:219], v6 offset:3072
    ds_read_b64_tr_b16 a[220:221], v6 offset:2056
    ds_read_b64_tr_b16 a[222:223], v6 offset:3080
    s_waitcnt lgkmcnt(0)
    v_add_u32 v6, 81920, v4
    v_xor_b32 v7, 32, v6
    s_waitcnt vmcnt(4)
    ds_read_b64_tr_b16 a[224:225], v6 offset:0
    ds_read_b64_tr_b16 a[226:227], v6 offset:1024
    ds_read_b64_tr_b16 a[228:229], v6 offset:8
    ds_read_b64_tr_b16 a[230:231], v6 offset:1032
    ds_read_b64_tr_b16 a[232:233], v6 offset:2048
    ds_read_b64_tr_b16 a[234:235], v6 offset:3072
    ds_read_b64_tr_b16 a[236:237], v6 offset:2056
    ds_read_b64_tr_b16 a[238:239], v6 offset:3080
    s_waitcnt lgkmcnt(0)
    v_add_u32 v6, 98304, v4
    v_xor_b32 v7, 32, v6
    s_waitcnt vmcnt(0)
    ds_read_b64_tr_b16 a[240:241], v6 offset:0
    ds_read_b64_tr_b16 a[242:243], v6 offset:1024
    ds_read_b64_tr_b16 a[244:245], v6 offset:8
    ds_read_b64_tr_b16 a[246:247], v6 offset:1032
    ds_read_b64_tr_b16 a[248:249], v6 offset:2048
    ds_read_b64_tr_b16 a[250:251], v6 offset:3072
    ds_read_b64_tr_b16 a[252:253], v6 offset:2056
    ds_read_b64_tr_b16 a[254:255], v6 offset:3080
    s_waitcnt lgkmcnt(0)
    s_barrier
L_op_seg:
    s_lshr_b32 s43, s16, 1
    s_add_u32 s43, s43, 1
    s_min_u32 s43, s43, 63
    s_and_b32 s36, s33, 15
    s_lshl_b32 s36, s36, 8
    s_add_u32 s36, s36, 125829120
    s_lshl_b32 s94, s33, 7
    s_add_u32 s94, s94, s16
    s_mov_b32 s88, 65536
cw17:
    buffer_load_dword v3, off, s[4:7], s36 offset:128 sc1
    s_waitcnt vmcnt(0)
    v_readfirstlane_b32 s42, v3
    s_nop 0
    s_sub_u32 s42, s42, s95
    s_cmp_gt_u32 s42, 64
    s_cselect_b32 s42, 0, s42
    s_add_u32 s42, s42, 2
    s_cmp_ge_u32 s42, s43
    s_cbranch_scc1 cw17x
    s_sub_u32 s88, s88, 1
    s_cbranch_scc1 cw17x
    s_sub_u32 s42, s43, s42
    s_min_u32 s42, s42, 6
cw17s:
    s_sleep 24
    s_sub_u32 s42, s42, 1
    s_cmp_lg_u32 s42, 0
    s_cbranch_scc1 cw17s
    s_branch cw17
cw17x:
    s_lshr_b32 s89, s16, 1
    s_lshl_b32 s89, s89, 2
    s_add_u32 s89, s89, s32
    s_lshl_b32 s89, s89, 7
    s_add_u32 s89, s89, 125894656
    v_mbcnt_lo_u32_b32 v2, -1, 0
    v_mbcnt_hi_u32_b32 v2, -1, v2
    v_min_u32 v2, 7, v2
    v_lshlrev_b32 v2, 2, v2
    s_mov_b32 s88, 4194304
fw18:
    buffer_load_dword v3, v2, s[4:7], s89 offen offset:0 sc1
    s_sub_u32 s88, s88, 1
    s_cbranch_scc1 fw18x
    s_waitcnt vmcnt(0)
    v_cmp_ne_u32 vcc, s95, v3
    s_cbranch_vccz fw18x
    s_sleep 4
    s_cmp_gt_u32 s88, 4194280
    s_cbranch_scc1 fw18
    s_sleep 40
    s_branch fw18
fw18x:
    s_lshl_b32 s18, s16, 17
    s_lshl_b32 s19, s32, 15
    s_add_u32 s18, s18, s19
    s_add_u32 s18, s18, 50331648
    buffer_load_dwordx4 v[32:35], v1, s[4:7], s18 offen offset:0 sc1
    buffer_load_dwordx4 v[36:39], v1, s[4:7], s18 offen offset:1024 sc1
    buffer_load_dwordx4 v[40:43], v1, s[4:7], s18 offen offset:2048 sc1
    buffer_load_dwordx4 v[44:47], v1, s[4:7], s18 offen offset:3072 sc1
    s_add_u32 s18, s18, 4096
    buffer_load_dwordx4 v[48:51], v1, s[4:7], s18 offen offset:0 sc1
    buffer_load_dwordx4 v[52:55], v1, s[4:7], s18 offen offset:1024 sc1
    buffer_load_dwordx4 v[56:59], v1, s[4:7], s18 offen offset:2048 sc1
    buffer_load_dwordx4 v[60:63], v1, s[4:7], s18 offen offset:3072 sc1
    s_add_u32 s18, s18, 4096
    buffer_load_dwordx4 v[64:67], v1, s[4:7], s18 offen offset:0 sc1
    buffer_load_dwordx4 v[68:71], v1, s[4:7], s18 offen offset:1024 sc1
    buffer_load_dwordx4 v[72:75], v1, s[4:7], s18 offen offset:2048 sc1
    buffer_load_dwordx4 v[76:79], v1, s[4:7], s18 offen offset:3072 sc1
    s_add_u32 s18, s18, 4096
    buffer_load_dwordx4 v[80:83], v1, s[4:7], s18 offen offset:0 sc1
    buffer_load_dwordx4 v[84:87], v1, s[4:7], s18 offen offset:1024 sc1
    buffer_load_dwordx4 v[88:91], v1, s[4:7], s18 offen offset:2048 sc1
    buffer_load_dwordx4 v[92:95], v1, s[4:7], s18 offen offset:3072 sc1
    s_add_u32 s18, s18, 4096
    buffer_load_dwordx4 v[96:99], v1, s[4:7], s18 offen offset:0 sc1
    buffer_load_dwordx4 v[100:103], v1, s[4:7], s18 offen offset:1024 sc1
    buffer_load_dwordx4 v[104:107], v1, s[4:7], s18 offen offset:2048 sc1
    buffer_load_dwordx4 v[108:111], v1, s[4:7], s18 offen offset:3072 sc1
    s_add_u32 s18, s18, 4096
    buffer_load_dwordx4 v[112:115], v1, s[4:7], s18 offen offset:0 sc1
    buffer_load_dwordx4 v[116:119], v1, s[4:7], s18 offen offset:1024 sc1
    buffer_load_dwordx4 v[120:123], v1, s[4:7], s18 offen offset:2048 sc1
    buffer_load_dwordx4 v[124:127], v1, s[4:7], s18 offen offset:3072 sc1
    s_add_u32 s18, s18, 4096
    buffer_load_dwordx4 v[128:131], v1, s[4:7], s18 offen offset:0 sc1
    buffer_load_dwordx4 v[132:135], v1, s[4:7], s18 offen offset:1024 sc1
    buffer_load_dwordx4 v[136:139], v1, s[4:7], s18 offen offset:2048 sc1
    buffer_load_dwordx4 v[140:143], v1, s[4:7], s18 offen offset:3072 sc1
    s_add_u32 s18, s18, 4096
    buffer_load_dwordx4 v[144:147], v1, s[4:7], s18 offen offset:0 sc1
    buffer_load_dwordx4 v[148:151], v1, s[4:7], s18 offen offset:1024 sc1
    buffer_load_dwordx4 v[152:155], v1, s[4:7], s18 offen offset:2048 sc1
    buffer_load_dwordx4 v[156:159], v1, s[4:7], s18 offen offset:3072 sc1
    v_lshlrev_b32 v2, 4, v0
    v_and_b32 v3, 3072, v2
    v_lshl_add_u32 v2, v3, 1, v1
    s_waitcnt vmcnt(31)
    v_mfma_f32_16x16x32_bf16 v[8:11], a[0:3], v[32:35], 0
    v_mfma_f32_16x16x32_bf16 v[12:15], a[4:7], v[32:35], 0
    s_waitcnt vmcnt(30)
    v_mfma_f32_16x16x32_bf16 v[8:11], a[8:11], v[36:39], v[8:11]
    v_mfma_f32_16x16x32_bf16 v[12:15], a[12:15], v[36:39], v[12:15]
    s_waitcnt vmcnt(29)
    v_mfma_f32_16x16x32_bf16 v[8:11], a[16:19], v[40:43], v[8:11]
    v_mfma_f32_16x16x32_bf16 v[12:15], a[20:23], v[40:43], v[12:15]
    s_waitcnt vmcnt(28)
    v_mfma_f32_16x16x32_bf16 v[8:11], a[24:27], v[44:47], v[8:11]
    v_mfma_f32_16x16x32_bf16 v[12:15], a[28:31], v[44:47], v[12:15]
    s_waitcnt vmcnt(27)
    v_mfma_f32_16x16x32_bf16 v[8:11], a[32:35], v[48:51], v[8:11]
    v_mfma_f32_16x16x32_bf16 v[12:15], a[36:39], v[48:51], v[12:15]
    s_waitcnt vmcnt(26)
    v_mfma_f32_16x16x32_bf16 v[8:11], a[40:43], v[52:55], v[8:11]
    v_mfma_f32_16x16x32_bf16 v[12:15], a[44:47], v[52:55], v[12:15]
    s_waitcnt vmcnt(25)
    v_mfma_f32_16x16x32_bf16 v[8:11], a[48:51], v[56:59], v[8:11]
    v_mfma_f32_16x16x32_bf16 v[12:15], a[52:55], v[56:59], v[12:15]
    s_waitcnt vmcnt(24)
    v_mfma_f32_16x16x32_bf16 v[8:11], a[56:59], v[60:63], v[8:11]
    v_mfma_f32_16x16x32_bf16 v[12:15], a[60:63], v[60:63], v[12:15]
    s_waitcnt vmcnt(23)
    v_mfma_f32_16x16x32_bf16 v[8:11], a[64:67], v[64:67], v[8:11]
    v_mfma_f32_16x16x32_bf16 v[12:15], a[68:71], v[64:67], v[12:15]
    s_waitcnt vmcnt(22)
    v_mfma_f32_16x16x32_bf16 v[8:11], a[72:75], v[68:71], v[8:11]
    v_mfma_f32_16x16x32_bf16 v[12:15], a[76:79], v[68:71], v[12:15]
    s_waitcnt vmcnt(21)
    v_mfma_f32_16x16x32_bf16 v[8:11], a[80:83], v[72:75], v[8:11]
    v_mfma_f32_16x16x32_bf16 v[12:15], a[84:87], v[72:75], v[12:15]
    s_waitcnt vmcnt(20)
    v_mfma_f32_16x16x32_bf16 v[8:11], a[88:91], v[76:79], v[8:11]
    v_mfma_f32_16x16x32_bf16 v[12:15], a[92:95], v[76:79], v[12:15]
    s_waitcnt vmcnt(19)
    v_mfma_f32_16x16x32_bf16 v[8:11], a[96:99], v[80:83], v[8:11]
    v_mfma_f32_16x16x32_bf16 v[12:15], a[100:103], v[80:83], v[12:15]
    s_waitcnt vmcnt(18)
    v_mfma_f32_16x16x32_bf16 v[8:11], a[104:107], v[84:87], v[8:11]
    v_mfma_f32_16x16x32_bf16 v[12:15], a[108:111], v[84:87], v[12:15]
    s_waitcnt vmcnt(17)
    v_mfma_f32_16x16x32_bf16 v[8:11], a[112:115], v[88:91], v[8:11]
    v_mfma_f32_16x16x32_bf16 v[12:15], a[116:119], v[88:91], v[12:15]
    s_waitcnt vmcnt(16)
    v_mfma_f32_16x16x32_bf16 v[8:11], a[120:123], v[92:95], v[8:11]
    v_mfma_f32_16x16x32_bf16 v[12:15], a[124:127], v[92:95], v[12:15]
    s_waitcnt vmcnt(15)
    v_mfma_f32_16x16x32_bf16 v[8:11], a[128:131], v[96:99], v[8:11]
    v_mfma_f32_16x16x32_bf16 v[12:15], a[132:135], v[96:99], v[12:15]
    s_waitcnt vmcnt(14)
    v_mfma_f32_16x16x32_bf16 v[8:11], a[136:139], v[100:103], v[8:11]
    v_mfma_f32_16x16x32_bf16 v[12:15], a[140:143], v[100:103], v[12:15]
    s_waitcnt vmcnt(13)
    v_mfma_f32_16x16x32_bf16 v[8:11], a[144:147], v[104:107], v[8:11]
    v_mfma_f32_16x16x32_bf16 v[12:15], a[148:151], v[104:107], v[12:15]
    s_waitcnt vmcnt(12)
    v_mfma_f32_16x16x32_bf16 v[8:11], a[152:155], v[108:111], v[8:11]
    v_mfma_f32_16x16x32_bf16 v[12:15], a[156:159], v[108:111], v[12:15]
    s_waitcnt vmcnt(11)
    v_mfma_f32_16x16x32_bf16 v[8:11], a[160:163], v[112:115], v[8:11]
    v_mfma_f32_16x16x32_bf16 v[12:15], a[164:167], v[112:115], v[12:15]
    s_waitcnt vmcnt(10)
    v_mfma_f32_16x16x32_bf16 v[8:11], a[168:171], v[116:119], v[8:11]
    v_mfma_f32_16x16x32_bf16 v[12:15], a[172:175], v[116:119], v[12:15]
    s_waitcnt vmcnt(9)
    v_mfma_f32_16x16x32_bf16 v[8:11], a[176:179], v[120:123], v[8:11]
    v_mfma_f32_16x16x32_bf16 v[12:15], a[180:183], v[120:123], v[12:15]
    s_waitcnt vmcnt(8)
    v_mfma_f32_16x16x32_bf16 v[8:11], a[184:187], v[124:127], v[8:11]
    v_mfma_f32_16x16x32_bf16 v[12:15], a[188:191], v[124:127], v[12:15]
    s_waitcnt vmcnt(7)
    v_mfma_f32_16x16x32_bf16 v[8:11], a[192:195], v[128:131], v[8:11]
    v_mfma_f32_16x16x32_bf16 v[12:15], a[196:199], v[128:131], v[12:15]
    s_waitcnt vmcnt(6)
    v_mfma_f32_16x16x32_bf16 v[8:11], a[200:203], v[132:135], v[8:11]
    v_mfma_f32_16x16x32_bf16 v[12:15], a[204:207], v[132:135], v[12:15]
    s_waitcnt vmcnt(5)
    v_mfma_f32_16x16x32_bf16 v[8:11], a[208:211], v[136:139], v[8:11]
    v_mfma_f32_16x16x32_bf16 v[12:15], a[212:215], v[136:139], v[12:15]
    s_waitcnt vmcnt(4)
    v_mfma_f32_16x16x32_bf16 v[8:11], a[216:219], v[140:143], v[8:11]
    v_mfma_f32_16x16x32_bf16 v[12:15], a[220:223], v[140:143], v[12:15]
    s_waitcnt vmcnt(3)
    v_mfma_f32_16x16x32_bf16 v[8:11], a[224:227], v[144:147], v[8:11]
    v_mfma_f32_16x16x32_bf16 v[12:15], a[228:231], v[144:147], v[12:15]
    s_waitcnt vmcnt(2)
    v_mfma_f32_16x16x32_bf16 v[8:11], a[232:235], v[148:151], v[8:11]
    v_mfma_f32_16x16x32_bf16 v[12:15], a[236:239], v[148:151], v[12:15]
    s_waitcnt vmcnt(1)
    v_mfma_f32_16x16x32_bf16 v[8:11], a[240:243], v[152:155], v[8:11]
    v_mfma_f32_16x16x32_bf16 v[12:15], a[244:247], v[152:155], v[12:15]
    s_waitcnt vmcnt(0)
    v_mfma_f32_16x16x32_bf16 v[8:11], a[248:251], v[156:159], v[8:11]
    v_mfma_f32_16x16x32_bf16 v[12:15], a[252:255], v[156:159], v[12:15]
    s_nop 3
    ds_write_b128 v2, v[8:11] offset:0
    s_nop 2
    ds_write_b128 v2, v[12:15] offset:1024
    s_waitcnt lgkmcnt(0)
    s_barrier
    s_cmp_lg_u32 s32, 0
    s_cbranch_scc1 os_skip
    ds_read_b128 v[40:43], v1 offset:2048
    ds_read_b128 v[44:47], v1 offset:3072
    ds_read_b128 v[48:51], v1 offset:4096
    ds_read_b128 v[52:55], v1 offset:5120
    ds_read_b128 v[56:59], v1 offset:6144
    ds_read_b128 v[60:63], v1 offset:7168
    v_lshrrev_b32 v3, 4, v1
    v_bfe_u32 v4, v3, 2, 2
    v_lshlrev_b32 v4, 3, v4
    v_and_b32 v2, 3, v3
    v_add_u32 v4, v4, v2
    v_mul_u32_u24 v4, 2304, v4
    v_lshrrev_b32 v3, 4, v3
    v_lshl_add_u32 v4, v3, 4, v4
    s_lshr_b32 s18, s16, 1
    s_lshl_b32 s18, s18, 3
    s_and_b32 s19, s16, 1
    s_add_u32 s18, s18, s19
    s_mul_i32 s18, s18, 9216
    s_lshl_b32 s19, s33, 6
    s_add_u32 s18, s18, s19
    s_waitcnt lgkmcnt(0)
    v_pk_add_f32 v[8:9], v[8:9], v[40:41]
    v_pk_add_f32 v[48:49], v[48:49], v[56:57]
    v_pk_add_f32 v[8:9], v[8:9], v[48:49]
    v_pk_add_f32 v[10:11], v[10:11], v[42:43]
    v_pk_add_f32 v[50:51], v[50:51], v[58:59]
    v_pk_add_f32 v[10:11], v[10:11], v[50:51]
    v_pk_add_f32 v[12:13], v[12:13], v[44:45]
    v_pk_add_f32 v[52:53], v[52:53], v[60:61]
    v_pk_add_f32 v[12:13], v[12:13], v[52:53]
    v_pk_add_f32 v[14:15], v[14:15], v[46:47]
    v_pk_add_f32 v[54:55], v[54:55], v[62:63]
    v_pk_add_f32 v[14:15], v[14:15], v[54:55]
    v_cvt_pk_bf16_f32 v32, v8, v9
    v_cvt_pk_bf16_f32 v33, v10, v11
    v_cvt_pk_bf16_f32 v34, v12, v13
    v_cvt_pk_bf16_f32 v35, v14, v15
    buffer_store_dwordx4 v[32:35], v4, s[8:11], s18 offen sc1
os_skip:
    s_nop 1
    s_add_u32 s16, s16, 7
    s_cmp_ge_u32 s16, 128
    s_cbranch_scc1 L_done
    s_barrier
    s_branch L_op_seg
L_done:
L_exit:
    s_endpgm
.section .rodata,"a"
.p2align 6
.amdhsa_kernel concat_heads__memory_aug_recurrent_mem_tr__ssm_conv_s4d__prompt_kernel
  .amdhsa_next_free_vgpr 512
  .amdhsa_next_free_sgpr 102
  .amdhsa_accum_offset 256
  .amdhsa_group_segment_fixed_size 0
  .amdhsa_kernarg_size 136
  .amdhsa_user_sgpr_count 2
  .amdhsa_user_sgpr_kernarg_segment_ptr 1
  .amdhsa_system_sgpr_workgroup_id_x 1
.end_amdhsa_kernel
.text
```

```asm
; @launch grid=(256,1,1) block=(256,1,1) lds=163840
.amdgcn_target "amdgcn-amd-amdhsa--gfx950"
.text
.globl concat_heads__memory_aug_recurrent_mem_tr__ssm_conv_s4d__prompt_kernel
.p2align 8
.type concat_heads__memory_aug_recurrent_mem_tr__ssm_conv_s4d__prompt_kernel,@function
concat_heads__memory_aug_recurrent_mem_tr__ssm_conv_s4d__prompt_kernel:
    s_cmp_ge_u32 s2, 256
    s_cbranch_scc1 L_exit
    s_load_dwordx4 s[84:87], s[0:1], 120
    s_load_dwordx16 s[48:63], s[0:1], 0
    v_lshrrev_b32 v1, 6, v0
    s_nop 0
    v_readfirstlane_b32 s32, v1
    s_getreg_b32 s3, hwreg(HW_REG_XCC_ID)
    s_and_b32 s3, s3, 15
    s_cmp_lg_u32 s32, 3
    s_cbranch_scc1 L_nowarm
    s_getpc_b64 s[44:45]
L_pcw:
    v_and_b32 v1, 63, v0
    v_lshlrev_b32 v1, 7, v1
    s_cmp_lg_u32 s3, 0
    s_cselect_b32 s33, L_helper-L_pcw, 0
    v_add_u32 v1, s33, v1
    v_min_u32 v2, L_exit-L_pcw, v1
    global_load_dword v240, v2, s[44:45]
    v_add_u32 v1, 8192, v1
    v_min_u32 v2, L_exit-L_pcw, v1
    global_load_dword v241, v2, s[44:45]
    v_add_u32 v1, 8192, v1
    s_cbranch_scc0 L_nowarm
    v_min_u32 v2, L_exit-L_pcw, v1
    global_load_dword v242, v2, s[44:45]
    v_add_u32 v1, 8192, v1
    v_min_u32 v2, L_exit-L_pcw, v1
    global_load_dword v243, v2, s[44:45]
    v_add_u32 v1, 8192, v1
    v_min_u32 v2, L_exit-L_pcw, v1
    global_load_dword v244, v2, s[44:45]
    v_add_u32 v1, 8192, v1
L_nowarm:
    s_waitcnt lgkmcnt(0)
    s_mov_b32 s4, s86
    s_mov_b32 s5, s87
    s_mov_b32 s6, 268435456
    s_mov_b32 s7, 0x20000
    s_mov_b32 s96, s84
    s_mov_b32 s97, s85
    s_mov_b32 s98, 256
    s_mov_b32 s99, 0x20000
    s_mov_b32 s95, 0
    s_cmp_lg_u32 s3, 0
    s_cbranch_scc1 L_helper
    s_mov_b32 s37, 128
    v_mov_b32 v250, 1
    v_mov_b32 v251, 163832
    v_cmp_eq_u32 vcc, 0, v0
    s_nop 0
    s_and_saveexec_b64 s[38:39], vcc
    s_cbranch_execz tk1m
    buffer_atomic_add v250, off, s[96:99], s37 sc0
tk1m:
    s_mov_b64 s[38:39], exec
    s_mov_b64 exec, -1
    v_lshrrev_b32 v54, 6, v0
    s_nop 0
    v_readfirstlane_b32 s13, v54
    v_and_b32 v57, 63, v0
    v_bfe_u32 v54, v57, 2, 1
    v_lshlrev_b32 v48, 13, v54
    v_bfe_u32 v54, v57, 3, 1
    v_lshl_add_u32 v48, v54, 15, v48
    v_bfe_u32 v54, v57, 4, 1
    v_lshl_add_u32 v48, v54, 14, v48
    v_bfe_u32 v54, v57, 5, 1
    v_lshl_add_u32 v48, v54, 16, v48
    v_lshrrev_b32 v55, 4, v57
    v_and_b32 v55, 2, v55
    v_xor_b32 v55, v55, v57
    v_and_b32 v55, 3, v55
    v_lshl_add_u32 v48, v55, 4, v48
    v_bfe_u32 v54, v57, 2, 1
    v_lshlrev_b32 v51, 6, v54
    v_bfe_u32 v54, v57, 3, 1
    v_lshl_add_u32 v51, v54, 9, v51
    v_bfe_u32 v54, v57, 4, 1
    v_lshl_add_u32 v51, v54, 7, v51
    v_bfe_u32 v54, v57, 5, 1
    v_lshl_add_u32 v51, v54, 12, v51
    v_bfe_u32 v54, v57, 0, 1
    v_lshl_add_u32 v51, v54, 3, v51
    v_bfe_u32 v54, v57, 1, 1
    v_lshl_add_u32 v51, v54, 4, v51
    v_bfe_u32 v54, v57, 3, 1
    v_lshl_add_u32 v51, v54, 5, v51
    v_lshrrev_b32 v55, 3, v57
    v_mul_u32_u24 v49, 1152, v55
    v_and_b32 v55, 7, v57
    v_lshl_add_u32 v49, v55, 4, v49
    v_bfe_u32 v54, v57, 4, 1
    v_lshlrev_b32 v52, 13, v54
    v_bfe_u32 v54, v57, 5, 1
    v_lshl_add_u32 v52, v54, 9, v52
    v_bfe_u32 v54, v57, 2, 1
    v_lshl_add_u32 v52, v54, 7, v52
    v_bfe_u32 v54, v57, 3, 1
    v_lshl_add_u32 v52, v54, 5, v52
    v_and_b32 v55, 3, v57
    v_lshl_add_u32 v52, v55, 3, v52
    v_lshrrev_b32 v55, 2, v57
    v_mul_u32_u24 v50, 1152, v55
    v_and_b32 v55, 3, v57
    v_lshl_add_u32 v50, v55, 4, v50
    v_bfe_u32 v54, v57, 4, 1
    v_lshlrev_b32 v53, 12, v54
    v_bfe_u32 v54, v57, 5, 1
    v_lshl_add_u32 v53, v54, 8, v53
    v_bfe_u32 v54, v57, 2, 1
    v_lshl_add_u32 v53, v54, 6, v53
    v_bfe_u32 v54, v57, 3, 1
    v_lshl_add_u32 v53, v54, 5, v53
    v_and_b32 v55, 3, v57
    v_lshl_add_u32 v53, v55, 3, v53
    s_lshl_b32 s66, s13, 10
    s_and_b32 s93, s13, 1
    s_lshl_b32 s93, s93, 14
    s_and_b32 s75, s13, 2
    s_lshl_b32 s75, s75, 19
    v_add_u32 v51, s66, v51
    v_add_u32 v52, s66, v52
    v_add_u32 v53, s66, v53
    v_mov_b32 v58, v48
    s_mov_b32 s10, 4718592
    s_mov_b32 s11, 0x20000
    s_mov_b64 exec, s[38:39]
    s_cbranch_execz tk1
    s_waitcnt vmcnt(0)
    ds_write_b32 v251, v250
    s_waitcnt lgkmcnt(0)
tk1:
    s_mov_b64 exec, -1
    s_barrier
    ds_read_b32 v252, v251
    s_waitcnt lgkmcnt(0)
    v_readfirstlane_b32 s12, v252
    s_barrier
    s_nop 3
    s_cmp_ge_u32 s12, 32
    s_cbranch_scc1 L_helper
L_chain:
    s_mov_b64 s[48:49], s[50:51]
    s_mov_b64 s[50:51], s[52:53]
    s_mov_b64 s[52:53], s[54:55]
    s_mov_b64 s[54:55], s[56:57]
    s_mov_b64 s[56:57], s[58:59]
    s_lshl_b32 s67, s12, 8
    s_lshl_b32 s40, s13, 6
    s_add_u32 s67, s67, s40
    s_mul_i32 s92, s12, 147456
    s_lshr_b32 s73, s50, 8
    s_add_u32 s73, s73, s12
    s_and_b32 s73, s73, 31
    s_bitcmp1_b32 0xa2222222, s73
    s_cselect_b32 s88, 1, 0
    s_mov_b32 s72, 0
    s_add_u32 s73, s73, 1
    s_lshr_b32 s73, s73, 2
    s_xor_b32 s94, s13, 0
    s_mul_i32 s94, s94, 36864
    s_add_u32 s94, s94, s92
    s_lshl_b32 s74, s13, 7
    s_add_u32 s94, s94, s74
    s_add_u32 s78, s94, 0
    s_mov_b64 s[8:9], s[56:57]
    v_mov_b32 v58, v49
    s_mov_b32 s79, 9216
    s_mov_b32 s81, 0
    s_add_u32 s80, s66, 114688
    s_mov_b32 s76, 0
    s_mov_b32 s77, 8192
    s_call_b64 s[82:83], cf_dma
    s_mov_b32 s77, 16384
    s_call_b64 s[82:83], cf_dma
    s_xor_b32 s94, s13, 1
    s_mul_i32 s94, s94, 36864
    s_add_u32 s94, s94, s92
    s_lshl_b32 s74, s13, 7
    s_add_u32 s94, s94, s74
    s_add_u32 s78, s94, 0
    s_add_u32 s80, s66, 81920
    s_mov_b32 s76, 0
    s_mov_b32 s77, 8192
    s_call_b64 s[82:83], cf_dma
    s_mov_b32 s77, 16384
    s_call_b64 s[82:83], cf_dma
    s_xor_b32 s94, s13, 2
    s_mul_i32 s94, s94, 36864
    s_add_u32 s94, s94, s92
    s_lshl_b32 s74, s13, 7
    s_add_u32 s94, s94, s74
    s_add_u32 s78, s94, 0
    s_add_u32 s80, s66, 16384
    s_mov_b32 s76, 0
    s_mov_b32 s77, 8192
    s_call_b64 s[82:83], cf_dma
    v_lshrrev_b32 v24, 6, v0
    v_lshlrev_b32 v61, 4, v0
    v_add_u32 v62, 57344, v61
    v_xor_b32 v63, 1024, v61
    v_add_u32 v63, 98304, v63
    v_xor_b32 v64, 2048, v61
    v_add_u32 v64, 98304, v64
    v_and_b32 v65, 1023, v61
    v_add_u32 v65, 98304, v65
    v_and_b32 v26, 15, v0
    v_bfe_u32 v27, v0, 4, 2
    v_mov_b32 v60, 0x4444
    v_mov_b32 v25, 0xeeee
    v_cmp_lt_u32 vcc, 7, v26
    s_nop 1
    v_cndmask_b32 v60, v60, v25, vcc
    s_mov_b32 s77, 16384
    s_call_b64 s[82:83], cf_dma
    v_and_b32 v67, 12, v26
    v_lshlrev_b32 v67, 3, v67
    v_and_b32 v25, 1, v26
    v_lshl_add_u32 v67, v25, 4, v67
    v_bfe_u32 v25, v26, 1, 1
    v_lshl_add_u32 v67, v25, 3, v67
    v_lshl_add_u32 v66, v27, 14, v67
    v_lshl_add_u32 v66, v24, 17, v66
    s_xor_b32 s94, s13, 3
    s_mul_i32 s94, s94, 36864
    s_add_u32 s94, s94, s92
    s_lshl_b32 s74, s13, 7
    s_add_u32 s94, s94, s74
    s_add_u32 s78, s94, 0
    s_add_u32 s80, s66, 0
    s_mov_b32 s76, 0
    s_mov_b32 s77, 8192
    s_call_b64 s[82:83], cf_dma
    v_and_b32 v67, 63, v67
    v_lshrrev_b32 v25, 1, v24
    v_lshl_add_u32 v67, v25, 18, v67
    v_lshl_add_u32 v67, v27, 16, v67
    v_lshrrev_b32 v25, 3, v26
    v_lshl_add_u32 v67, v25, 15, v67
    v_and_b32 v25, 1, v24
    v_lshl_add_u32 v67, v25, 6, v67
    s_mov_b32 s77, 16384
    s_call_b64 s[82:83], cf_dma
    v_and_b32 v25, 31, v0
    v_lshlrev_b32 v70, 4, v25
    v_lshlrev_b32 v28, 3, v25
    v_lshl_add_u32 v28, v24, 10, v28
    v_add_u32 v28, 110592, v28
    v_lshrrev_b32 v25, 1, v24
    v_lshl_add_u32 v70, v25, 9, v70
    v_and_b32 v25, 1, v24
    v_lshl_add_u32 v70, v25, 3, v70
    v_add_u32 v70, 109568, v70
    v_cmp_gt_u32 vcc, 2, v27
    s_nop 1
    v_cndmask_b32 v70, v70, v28, vcc
    v_xor_b32 v71, 2048, v63
    v_lshrrev_b32 v68, 4, v0
    v_lshlrev_b32 v68, 7, v68
    v_and_b32 v25, 7, v26
    v_lshl_add_u32 v68, v25, 4, v68
    v_add_u32 v68, 98304, v68
    v_xor_b32 v74, 512, v68
    v_xor_b32 v75, 1024, v68
    v_xor_b32 v76, 1536, v68
    v_lshrrev_b32 v25, 3, v26
    v_lshl_add_u32 v77, v25, 3, v68
    v_or_b32 v78, 512, v65
    v_lshlrev_b32 v79, 2, v61
    v_mov_b64 v[72:73], 0
    v_and_b32 v25, 1, v27
    v_lshlrev_b32 v69, 7, v25
    v_lshrrev_b32 v25, 1, v27
    v_lshl_add_u32 v69, v25, 3, v69
    v_and_b32 v25, 3, v26
    v_lshl_add_u32 v69, v25, 4, v69
    v_bfe_u32 v25, v26, 2, 1
    v_lshl_add_u32 v69, v25, 2, v69
    s_mov_b32 s32, 0x00ff00ff
    s_mov_b32 s33, 0x00ff00ff
    s_not_b64 s[34:35], s[32:33]
    s_lshr_b32 s31, s12, 1
    s_lshl_b32 s31, s31, 8
    s_and_b32 s40, s12, 1
    s_lshl_b32 s40, s40, 6
    s_add_u32 s31, s31, s40
    s_and_b32 s40, s13, 1
    s_lshl_b32 s40, s40, 12
    s_add_u32 s31, s31, s40
    s_lshl_b32 s19, s12, 14
    s_add_u32 s19, s19, 67076096
    s_add_u32 s41, s19, 8192
    s_add_u32 s19, s19, s40
    s_and_b32 s40, s12, 1
    s_lshl_b32 s40, s40, 2
    s_or_b32 s40, s40, s13
    s_cmp_eq_u32 s40, 5
    s_cselect_b32 s64, 0, s13
    s_cmp_lg_u32 s13, 1
    s_cbranch_scc1 cf_notx
    s_mov_b32 s32, 0xff
    s_mov_b32 s33, 0xff
    s_mov_b32 s19, s41
    s_lshr_b32 s31, s12, 3
    s_lshl_b32 s31, s31, 8
    s_and_b32 s40, s12, 2
    s_lshl_b32 s40, s40, 6
    s_add_u32 s31, s31, s40
    s_and_b32 s40, s12, 4
    s_lshl_b32 s40, s40, 4
    s_add_u32 s31, s31, s40
    s_add_u32 s31, s31, 8192
cf_notx:
    s_cmp_lg_u32 s13, 0
    s_cbranch_scc1 cf_notp
    s_min_u32 s40, s12, 23
    s_mul_i32 s40, s40, 384
    s_add_u32 s40, s40, 98304
    v_add_u32 v69, s40, v61
    v_mov_b32 v25, 108288
    v_cmp_lt_u32 vcc, 23, v0
    s_nop 1
    v_cndmask_b32 v69, v69, v25, vcc
cf_notp:
    s_nop 1
    v_mov_b32 v28, 1
    v_mov_b32 v29, 1
    v_mov_b32 v30, 1
    v_mov_b32 v31, 1
    s_lshl_b32 s40, s12, 14
    s_add_u32 s40, s40, 67174400
    s_add_u32 s41, s40, 0
    buffer_store_dwordx4 v[28:31], v61, s[4:7], s41 offen
    s_add_u32 s41, s40, 4096
    buffer_store_dwordx4 v[28:31], v61, s[4:7], s41 offen
    s_add_u32 s41, s40, 8192
    buffer_store_dwordx4 v[28:31], v61, s[4:7], s41 offen
    s_cmp_eq_u32 s64, 0
    s_cselect_b64 exec, 0, s[32:33]
    v_mov_b32 v27, -1
    s_add_u32 s41, s31, 67108864
    buffer_store_dword v27, v69, s[4:7], s41 offen
    s_add_u32 s41, s31, 67125248
    buffer_store_dword v27, v69, s[4:7], s41 offen
    s_add_u32 s41, s31, 67141632
    buffer_store_dword v27, v69, s[4:7], s41 offen
    s_add_u32 s41, s31, 67158016
    buffer_store_dword v27, v69, s[4:7], s41 offen
    s_mov_b64 exec, -1
    s_mov_b64 s[68:69], s[48:49]
    s_mov_b32 s70, 9216
    s_mov_b32 s71, 0x20000
    v_and_b32 v25, 7, v0
    v_mul_u32_u24 v25, 1152, v25
    v_lshrrev_b32 v26, 3, v0
    v_lshl_add_u32 v25, v26, 4, v25
    buffer_load_dwordx4 v[36:39], v25, s[68:71], 0 offen
    buffer_load_dwordx4 v[40:43], v25, s[68:71], 0 offen offset:512
    v_bfe_u32 v25, v0, 2, 3
    v_mul_u32_u24 v25, 1152, v25
    v_lshrrev_b32 v26, 5, v0
    v_lshl_add_u32 v25, v26, 4, v25
    v_and_b32 v26, 3, v0
    v_lshl_add_u32 v25, v26, 2, v25
    buffer_load_dword v44, v25, s[68:71], 0 offen offset:1024
    s_waitcnt vmcnt(15)
    v_add_u32 v55, 114688, v52
    ds_read_b64_tr_b16 v[160:161], v55 offset:0
    ds_read_b64_tr_b16 v[162:163], v55 offset:256
    ds_read_b64_tr_b16 v[164:165], v55 offset:4096
    ds_read_b64_tr_b16 v[166:167], v55 offset:4352
    s_xor_b32 s94, s13, 0
    s_mul_i32 s94, s94, 36864
    s_add_u32 s94, s94, s92
    s_lshl_b32 s74, s13, 7
    s_add_u32 s94, s94, s74
    s_add_u32 s78, s94, 512
    s_add_u32 s80, s66, 147456
    s_mov_b32 s76, 0
    s_mov_b32 s77, 8192
    s_call_b64 s[82:83], cf_dma
    ds_read_b64_tr_b16 v[192:193], v55 offset:64
    ds_read_b64_tr_b16 v[194:195], v55 offset:320
    ds_read_b64_tr_b16 v[196:197], v55 offset:4160
    ds_read_b64_tr_b16 v[198:199], v55 offset:4416
    s_mov_b32 s77, 16384
    s_call_b64 s[82:83], cf_dma
    s_waitcnt lgkmcnt(0)
    s_waitcnt vmcnt(15)
    v_add_u32 v55, 81920, v52
    ds_read_b64_tr_b16 v[168:169], v55 offset:0
    ds_read_b64_tr_b16 v[170:171], v55 offset:256
    ds_read_b64_tr_b16 v[172:173], v55 offset:4096
    ds_read_b64_tr_b16 v[174:175], v55 offset:4352
    s_xor_b32 s94, s13, 1
    s_mul_i32 s94, s94, 36864
    s_add_u32 s94, s94, s92
    s_lshl_b32 s74, s13, 7
    s_add_u32 s94, s94, s74
    s_add_u32 s78, s94, 512
    s_add_u32 s80, s66, 98304
    s_mov_b32 s76, 0
    s_mov_b32 s77, 8192
    s_call_b64 s[82:83], cf_dma
    ds_read_b64_tr_b16 v[200:201], v55 offset:64
    ds_read_b64_tr_b16 v[202:203], v55 offset:320
    ds_read_b64_tr_b16 v[204:205], v55 offset:4160
    ds_read_b64_tr_b16 v[206:207], v55 offset:4416
    s_mov_b32 s77, 16384
    s_call_b64 s[82:83], cf_dma
    s_waitcnt lgkmcnt(0)
    s_waitcnt vmcnt(15)
    v_add_u32 v55, 16384, v52
    ds_read_b64_tr_b16 v[176:177], v55 offset:0
    ds_read_b64_tr_b16 v[178:179], v55 offset:256
    ds_read_b64_tr_b16 v[180:181], v55 offset:4096
    ds_read_b64_tr_b16 v[182:183], v55 offset:4352
    s_add_u32 s78, s67, 4194304
    s_mov_b64 s[8:9], s[54:55]
    v_mov_b32 v58, v48
    s_mov_b32 s79, 131072
    s_add_u32 s80, s66, 32768
    s_mov_b32 s76, 0
    s_mov_b32 s77, 8192
    s_call_b64 s[82:83], cf_dma
    ds_read_b64_tr_b16 v[208:209], v55 offset:64
    ds_read_b64_tr_b16 v[210:211], v55 offset:320
    ds_read_b64_tr_b16 v[212:213], v55 offset:4160
    ds_read_b64_tr_b16 v[214:215], v55 offset:4416
    s_mov_b32 s77, 16384
    s_call_b64 s[82:83], cf_dma
    s_waitcnt lgkmcnt(0)
    s_waitcnt vmcnt(15)
    v_add_u32 v55, 0, v52
    ds_read_b64_tr_b16 v[184:185], v55 offset:0
    ds_read_b64_tr_b16 v[186:187], v55 offset:256
    ds_read_b64_tr_b16 v[188:189], v55 offset:4096
    ds_read_b64_tr_b16 v[190:191], v55 offset:4352
    s_xor_b32 s78, s75, 0
    s_add_u32 s78, s78, s67
    s_mov_b32 s81, s93
    s_add_u32 s80, s66, 114688
    s_mov_b32 s76, 0
    s_mov_b32 s77, 8192
    s_call_b64 s[82:83], cf_dma
    ds_read_b64_tr_b16 v[216:217], v55 offset:64
    ds_read_b64_tr_b16 v[218:219], v55 offset:320
    ds_read_b64_tr_b16 v[220:221], v55 offset:4160
    ds_read_b64_tr_b16 v[222:223], v55 offset:4416
    s_mov_b32 s77, 16384
    s_call_b64 s[82:83], cf_dma
    s_waitcnt lgkmcnt(0)
    s_waitcnt vmcnt(12)
    v_add_u32 v55, 147456, v52
    ds_read_b64_tr_b16 v[224:225], v55 offset:0
    ds_read_b64_tr_b16 v[226:227], v55 offset:256
    ds_read_b64_tr_b16 v[228:229], v55 offset:4096
    ds_read_b64_tr_b16 v[230:231], v55 offset:4352
    s_mov_b32 s77, 24576
    s_call_b64 s[82:83], cf_dma
    ds_read_b64_tr_b16 v[240:241], v55 offset:64
    ds_read_b64_tr_b16 v[242:243], v55 offset:320
    ds_read_b64_tr_b16 v[244:245], v55 offset:4160
    ds_read_b64_tr_b16 v[246:247], v55 offset:4416
    s_mov_b32 s77, 32768
    s_call_b64 s[82:83], cf_dma
    s_waitcnt lgkmcnt(0)
    v_min_u32 v36, -2, v36
    v_min_u32 v37, -2, v37
    v_min_u32 v38, -2, v38
    v_min_u32 v39, -2, v39
    v_min_u32 v40, -2, v40
    v_min_u32 v41, -2, v41
    v_min_u32 v42, -2, v42
    v_min_u32 v43, -2, v43
    v_min_u32 v44, -2, v44
    s_lshl_b32 s14, s12, 16
    s_add_u32 s14, s14, 92274688
    s_add_u32 s41, s14, 4096
    s_add_u32 s42, s14, 8192
    v_lshrrev_b32 v45, 2, v61
    buffer_store_dwordx4 v[36:39], v61, s[4:7], s14 offen
    buffer_store_dwordx4 v[40:43], v61, s[4:7], s41 offen
    buffer_store_dword v44, v45, s[4:7], s42 offen
    v_mov_b32 v46, 1
    s_mov_b64 exec, 1
    buffer_atomic_add v46, off, s[96:99], 0 offset:132 sc0
    s_mov_b64 exec, -1
    s_mov_b32 s44, 0x3e0293ee
    s_mov_b32 s45, s44
    s_mov_b32 s46, 0x42000000
    s_mov_b32 s60, 0x3f803f80
    s_mov_b32 s61, s60
    s_mov_b32 s62, 0x3e803e80
    s_mov_b32 s63, s62
    s_mov_b32 s28, 0
    s_lshl_b32 s24, s12, 14
    s_add_u32 s24, s24, 0
    s_add_u32 s47, s24, 33030144
    s_mul_i32 s40, s13, 3072
    s_add_u32 s23, s24, s40
    s_lshl_b32 s20, s12, 7
    s_add_u32 s20, s20, 67174400
    s_add_u32 s21, s20, 65536
    s_add_u32 s38, s20, 4096
    s_add_u32 s39, s21, 4096
    s_lshl_b32 s22, s12, 7
    s_add_u32 s22, s22, 67182592
    s_lshl_b32 s40, s12, 12
    s_add_u32 s25, s40, 79429632
    s_add_u32 s26, s40, 88866816
    s_lshl_b32 s65, s12, 9
    s_add_u32 s65, s65, 90177536
    s_lshl_b32 s40, s13, 5
    s_or_b32 s40, s40, s12
    s_cmp_lt_u32 s40, 24
    s_cselect_b32 s36, 0x1ffffff, 0
    s_mov_b32 s37, 0
    s_lshl_b32 s27, s12, 7
    s_add_u32 s27, s27, 125845504
    s_lshl_b32 s40, s13, 2
    s_add_u32 s27, s27, s40
    v_bfe_u32 v24, v61, 4, 4
    v_bfe_u32 v25, v61, 8, 1
    v_lshlrev_b32 v25, 2, v25
    v_sub_u32 v25, v24, v25
    v_mov_b32 v26, 0x3f80
    v_mov_b32 v27, 0x3f800000
    v_cmp_eq_u32 vcc, 0, v25
    s_nop 1
    v_cndmask_b32 v16, 0, v26, vcc
    v_cmp_eq_u32 vcc, 1, v25
    s_nop 1
    v_cndmask_b32 v16, v16, v27, vcc
    v_cmp_eq_u32 vcc, 0, v24
    s_nop 1
    v_cndmask_b32 v20, 0, v26, vcc
    v_cmp_eq_u32 vcc, 1, v24
    s_nop 1
    v_cndmask_b32 v20, v20, v27, vcc
    v_cmp_eq_u32 vcc, 2, v25
    s_nop 1
    v_cndmask_b32 v17, 0, v26, vcc
    v_cmp_eq_u32 vcc, 3, v25
    s_nop 1
    v_cndmask_b32 v17, v17, v27, vcc
    v_cmp_eq_u32 vcc, 2, v24
    s_nop 1
    v_cndmask_b32 v21, 0, v26, vcc
    v_cmp_eq_u32 vcc, 3, v24
    s_nop 1
    v_cndmask_b32 v21, v21, v27, vcc
    v_cmp_eq_u32 vcc, 8, v25
    s_nop 1
    v_cndmask_b32 v18, 0, v26, vcc
    v_cmp_eq_u32 vcc, 9, v25
    s_nop 1
    v_cndmask_b32 v18, v18, v27, vcc
    v_cmp_eq_u32 vcc, 4, v24
    s_nop 1
    v_cndmask_b32 v22, 0, v26, vcc
    v_cmp_eq_u32 vcc, 5, v24
    s_nop 1
    v_cndmask_b32 v22, v22, v27, vcc
    v_cmp_eq_u32 vcc, 10, v25
    s_nop 1
    v_cndmask_b32 v19, 0, v26, vcc
    v_cmp_eq_u32 vcc, 11, v25
    s_nop 1
    v_cndmask_b32 v19, v19, v27, vcc
    v_cmp_eq_u32 vcc, 6, v24
    s_nop 1
    v_cndmask_b32 v23, 0, v26, vcc
    v_cmp_eq_u32 vcc, 7, v24
    s_nop 1
    v_cndmask_b32 v23, v23, v27, vcc
    s_waitcnt vmcnt(13)
    v_add_u32 v55, 98304, v52
    ds_read_b64_tr_b16 v[232:233], v55 offset:0
    ds_read_b64_tr_b16 v[234:235], v55 offset:256
    ds_read_b64_tr_b16 v[236:237], v55 offset:4096
    ds_read_b64_tr_b16 v[238:239], v55 offset:4352
    s_xor_b32 s78, s75, 1048576
    s_add_u32 s78, s78, s67
    s_add_u32 s80, s66, 65536
    s_mov_b32 s76, 0
    s_mov_b32 s77, 8192
    s_call_b64 s[82:83], cf_dma
    ds_read_b64_tr_b16 v[248:249], v55 offset:64
    ds_read_b64_tr_b16 v[250:251], v55 offset:320
    ds_read_b64_tr_b16 v[252:253], v55 offset:4160
    ds_read_b64_tr_b16 v[254:255], v55 offset:4416
    s_mov_b32 s77, 16384
    s_call_b64 s[82:83], cf_dma
    s_waitcnt lgkmcnt(0)
    s_waitcnt vmcnt(13)
    v_add_u32 v55, 32768, v51
    v_xor_b32 v56, 32, v55
    ds_read_b64_tr_b16 v[144:145], v55 offset:0
    ds_read_b64_tr_b16 v[146:147], v55 offset:256
    ds_read_b64_tr_b16 v[148:149], v55 offset:8192
    ds_read_b64_tr_b16 v[150:151], v55 offset:8448
    s_mov_b32 s77, 24576
    s_call_b64 s[82:83], cf_dma
    ds_read_b64_tr_b16 v[152:153], v56 offset:0
    ds_read_b64_tr_b16 v[154:155], v56 offset:256
    ds_read_b64_tr_b16 v[156:157], v56 offset:8192
    ds_read_b64_tr_b16 v[158:159], v56 offset:8448
    s_mov_b32 s77, 32768
    s_call_b64 s[82:83], cf_dma
    s_waitcnt lgkmcnt(0)
    s_waitcnt vmcnt(9)
    v_add_u32 v55, 114688, v51
    v_xor_b32 v56, 32, v55
    ds_read_b64_tr_b16 a[192:193], v55 offset:0
    ds_read_b64_tr_b16 a[194:195], v55 offset:256
    ds_read_b64_tr_b16 a[196:197], v55 offset:8192
    ds_read_b64_tr_b16 a[198:199], v55 offset:8448
    s_xor_b32 s78, s75, 2097152
    s_add_u32 s78, s78, s67
    s_add_u32 s80, s66, 0
    s_mov_b32 s76, 0
    s_mov_b32 s77, 8192
    s_call_b64 s[82:83], cf_dma
    ds_read_b64_tr_b16 a[200:201], v56 offset:0
    ds_read_b64_tr_b16 a[202:203], v56 offset:256
    ds_read_b64_tr_b16 a[204:205], v56 offset:8192
    ds_read_b64_tr_b16 a[206:207], v56 offset:8448
    s_mov_b32 s77, 16384
    s_call_b64 s[82:83], cf_dma
    s_waitcnt lgkmcnt(0)
    v_add_u32 v55, 131072, v51
    v_xor_b32 v56, 32, v55
    ds_read_b64_tr_b16 a[208:209], v55 offset:0
    ds_read_b64_tr_b16 a[210:211], v55 offset:256
    ds_read_b64_tr_b16 a[212:213], v55 offset:8192
    ds_read_b64_tr_b16 a[214:215], v55 offset:8448
    s_mov_b32 s77, 24576
    s_call_b64 s[82:83], cf_dma
    ds_read_b64_tr_b16 a[216:217], v56 offset:0
    ds_read_b64_tr_b16 a[218:219], v56 offset:256
    ds_read_b64_tr_b16 a[220:221], v56 offset:8192
    ds_read_b64_tr_b16 a[222:223], v56 offset:8448
    s_mov_b32 s77, 32768
    s_call_b64 s[82:83], cf_dma
    s_waitcnt lgkmcnt(0)
    s_waitcnt vmcnt(8)
    v_add_u32 v55, 65536, v51
    v_xor_b32 v56, 32, v55
    ds_read_b64_tr_b16 a[224:225], v55 offset:0
    ds_read_b64_tr_b16 a[226:227], v55 offset:256
    ds_read_b64_tr_b16 a[228:229], v55 offset:8192
    ds_read_b64_tr_b16 a[230:231], v55 offset:8448
    s_cmp_eq_u32 s88, 0
    s_cbranch_scc1 cf_cpe659
    s_lshl_b32 s89, s73, 7
    s_add_u32 s89, s89, 125853696
    v_min_u32 v33, 11, v57
    v_lshlrev_b32 v33, 2, v33
    buffer_load_dword v34, off, s[96:99], 0 offset:64 sc1
    buffer_load_dword v35, v33, s[4:7], s89 offen sc1
cf_cpe659:
    s_xor_b32 s78, s75, 3145728
    s_add_u32 s78, s78, s67
    s_add_u32 s80, s66, 32768
    s_mov_b32 s76, 0
    s_mov_b32 s77, 8192
    s_call_b64 s[82:83], cf_dma
    ds_read_b64_tr_b16 a[232:233], v56 offset:0
    ds_read_b64_tr_b16 a[234:235], v56 offset:256
    ds_read_b64_tr_b16 a[236:237], v56 offset:8192
    ds_read_b64_tr_b16 a[238:239], v56 offset:8448
    s_mov_b32 s77, 16384
    s_call_b64 s[82:83], cf_dma
    s_waitcnt lgkmcnt(0)
    v_add_u32 v55, 81920, v51
    v_xor_b32 v56, 32, v55
    ds_read_b64_tr_b16 a[240:241], v55 offset:0
    ds_read_b64_tr_b16 a[242:243], v55 offset:256
    ds_read_b64_tr_b16 a[244:245], v55 offset:8192
    ds_read_b64_tr_b16 a[246:247], v55 offset:8448
    s_mov_b32 s77, 24576
    s_call_b64 s[82:83], cf_dma
    ds_read_b64_tr_b16 a[248:249], v56 offset:0
    ds_read_b64_tr_b16 a[250:251], v56 offset:256
    ds_read_b64_tr_b16 a[252:253], v56 offset:8192
    ds_read_b64_tr_b16 a[254:255], v56 offset:8448
    s_mov_b32 s77, 32768
    s_call_b64 s[82:83], cf_dma
    s_waitcnt lgkmcnt(0)
    v_readfirstlane_b32 s41, v46
    v_mov_b32 v36, 1
    v_mov_b32 v37, 0
    s_cmp_eq_u32 s41, 127
    s_cselect_b64 exec, 1, 0
    buffer_atomic_cmpswap v[36:37], off, s[96:99], 0 offset:140
    s_mov_b64 exec, -1
    s_waitcnt vmcnt(8)
    v_add_u32 v55, 0, v51
    v_xor_b32 v56, 32, v55
    ds_read_b64_tr_b16 v[80:81], v55 offset:0
    ds_read_b64_tr_b16 v[82:83], v55 offset:256
    ds_read_b64_tr_b16 v[84:85], v55 offset:8192
    ds_read_b64_tr_b16 v[86:87], v55 offset:8448
    s_cmp_eq_u32 s88, 0
    s_cbranch_scc1 cf_ncp710
    s_waitcnt vmcnt(8)
    v_max_u32 v34, 1, v34
    v_cmp_eq_u32 vcc, 1, v34
    s_cbranch_vccnz cf_ncp710
    v_cmp_ne_u32 vcc, v34, v35
    s_cbranch_vccnz cf_ncp710
    s_mov_b32 s88, 0
    s_mov_b32 s72, 5
    s_lshl_b32 s74, s73, 19
    s_add_u32 s74, s74, 96468992
    s_add_u32 s50, s4, s74
    s_addc_u32 s51, s5, 0
    s_add_u32 s52, s50, 147456
    s_addc_u32 s53, s51, 0
    s_lshl_b32 s67, s13, 6
    v_and_b32 v54, 63, v48
    v_lshrrev_b32 v48, 13, v48
    v_lshl_add_u32 v48, v48, 8, v54
cf_ncp710:
    s_cmp_eq_u32 s88, 0
    s_cbranch_scc1 cf_cpe731
    s_lshl_b32 s89, s73, 7
    s_add_u32 s89, s89, 125853696
    v_min_u32 v33, 11, v57
    v_lshlrev_b32 v33, 2, v33
    buffer_load_dword v34, off, s[96:99], 0 offset:64 sc1
    buffer_load_dword v35, v33, s[4:7], s89 offen sc1
cf_cpe731:
    s_xor_b32 s78, s75, 2097152
    s_lshr_b32 s78, s78, s72
    s_add_u32 s78, s78, s67
    s_mov_b64 s[8:9], s[52:53]
    v_mov_b32 v58, v48
    s_lshr_b32 s79, 131072, s72
    s_add_u32 s80, s66, 131072
    s_mov_b32 s76, 0
    s_mov_b32 s77, 8192
    s_call_b64 s[82:83], cf_dma
    ds_read_b64_tr_b16 v[88:89], v56 offset:0
    ds_read_b64_tr_b16 v[90:91], v56 offset:256
    ds_read_b64_tr_b16 v[92:93], v56 offset:8192
    ds_read_b64_tr_b16 v[94:95], v56 offset:8448
    s_mov_b32 s77, 16384
    s_call_b64 s[82:83], cf_dma
    s_waitcnt lgkmcnt(0)
    v_add_u32 v55, 16384, v51
    v_xor_b32 v56, 32, v55
    ds_read_b64_tr_b16 v[96:97], v55 offset:0
    ds_read_b64_tr_b16 v[98:99], v55 offset:256
    ds_read_b64_tr_b16 v[100:101], v55 offset:8192
    ds_read_b64_tr_b16 v[102:103], v55 offset:8448
    s_mov_b32 s77, 24576
    s_call_b64 s[82:83], cf_dma
    ds_read_b64_tr_b16 v[104:105], v56 offset:0
    ds_read_b64_tr_b16 v[106:107], v56 offset:256
    ds_read_b64_tr_b16 v[108:109], v56 offset:8192
    ds_read_b64_tr_b16 v[110:111], v56 offset:8448
    s_mov_b32 s77, 32768
    s_call_b64 s[82:83], cf_dma
    s_waitcnt lgkmcnt(0)
    s_waitcnt vmcnt(8)
    v_add_u32 v55, 32768, v51
    v_xor_b32 v56, 32, v55
    ds_read_b64_tr_b16 v[112:113], v55 offset:0
    ds_read_b64_tr_b16 v[114:115], v55 offset:256
    ds_read_b64_tr_b16 v[116:117], v55 offset:8192
    ds_read_b64_tr_b16 v[118:119], v55 offset:8448
    s_cmp_eq_u32 s88, 0
    s_cbranch_scc1 cf_ncp779
    s_waitcnt vmcnt(8)
    v_max_u32 v34, 1, v34
    v_cmp_eq_u32 vcc, 1, v34
    s_cbranch_vccnz cf_ncp779
    v_cmp_ne_u32 vcc, v34, v35
    s_cbranch_vccnz cf_ncp779
    s_mov_b32 s88, 0
    s_mov_b32 s72, 5
    s_lshl_b32 s74, s73, 19
    s_add_u32 s74, s74, 96468992
    s_add_u32 s50, s4, s74
    s_addc_u32 s51, s5, 0
    s_add_u32 s52, s50, 147456
    s_addc_u32 s53, s51, 0
    s_lshl_b32 s67, s13, 6
    v_and_b32 v54, 63, v48
    v_lshrrev_b32 v48, 13, v48
    v_lshl_add_u32 v48, v48, 8, v54
cf_ncp779:
    s_cmp_eq_u32 s88, 0
    s_cbranch_scc1 cf_cpe800
    s_lshl_b32 s89, s73, 7
    s_add_u32 s89, s89, 125853696
    v_min_u32 v33, 11, v57
    v_lshlrev_b32 v33, 2, v33
    buffer_load_dword v34, off, s[96:99], 0 offset:64 sc1
    buffer_load_dword v35, v33, s[4:7], s89 offen sc1
cf_cpe800:
    s_xor_b32 s78, s75, 3145728
    s_lshr_b32 s78, s78, s72
    s_add_u32 s78, s78, s67
    s_mov_b64 s[8:9], s[52:53]
    v_mov_b32 v58, v48
    s_lshr_b32 s79, 131072, s72
    s_add_u32 s80, s66, 65536
    s_mov_b32 s76, 0
    s_mov_b32 s77, 8192
    s_call_b64 s[82:83], cf_dma
    ds_read_b64_tr_b16 v[120:121], v56 offset:0
    ds_read_b64_tr_b16 v[122:123], v56 offset:256
    ds_read_b64_tr_b16 v[124:125], v56 offset:8192
    ds_read_b64_tr_b16 v[126:127], v56 offset:8448
    s_mov_b32 s77, 16384
    s_call_b64 s[82:83], cf_dma
    s_waitcnt lgkmcnt(0)
    v_add_u32 v55, 49152, v51
    v_xor_b32 v56, 32, v55
    ds_read_b64_tr_b16 v[128:129], v55 offset:0
    ds_read_b64_tr_b16 v[130:131], v55 offset:256
    ds_read_b64_tr_b16 v[132:133], v55 offset:8192
    ds_read_b64_tr_b16 v[134:135], v55 offset:8448
    s_mov_b32 s77, 24576
    s_call_b64 s[82:83], cf_dma
    ds_read_b64_tr_b16 v[136:137], v56 offset:0
    ds_read_b64_tr_b16 v[138:139], v56 offset:256
    ds_read_b64_tr_b16 v[140:141], v56 offset:8192
    ds_read_b64_tr_b16 v[142:143], v56 offset:8448
    s_mov_b32 s77, 32768
    s_call_b64 s[82:83], cf_dma
    s_waitcnt lgkmcnt(0)
    s_waitcnt vmcnt(8)
    v_add_u32 v55, 131072, v51
    v_xor_b32 v56, 32, v55
    ds_read_b64_tr_b16 a[128:129], v55 offset:0
    ds_read_b64_tr_b16 a[130:131], v55 offset:256
    ds_read_b64_tr_b16 a[132:133], v55 offset:8192
    ds_read_b64_tr_b16 a[134:135], v55 offset:8448
    s_cmp_eq_u32 s88, 0
    s_cbranch_scc1 cf_ncp848
    s_waitcnt vmcnt(8)
    v_max_u32 v34, 1, v34
    v_cmp_eq_u32 vcc, 1, v34
    s_cbranch_vccnz cf_ncp848
    v_cmp_ne_u32 vcc, v34, v35
    s_cbranch_vccnz cf_ncp848
    s_mov_b32 s88, 0
    s_mov_b32 s72, 5
    s_lshl_b32 s74, s73, 19
    s_add_u32 s74, s74, 96468992
    s_add_u32 s50, s4, s74
    s_addc_u32 s51, s5, 0
    s_add_u32 s52, s50, 147456
    s_addc_u32 s53, s51, 0
    s_lshl_b32 s67, s13, 6
    v_and_b32 v54, 63, v48
    v_lshrrev_b32 v48, 13, v48
    v_lshl_add_u32 v48, v48, 8, v54
cf_ncp848:
    s_cmp_eq_u32 s88, 0
    s_cbranch_scc1 cf_cpe869
    s_lshl_b32 s89, s73, 7
    s_add_u32 s89, s89, 125853696
    v_min_u32 v33, 11, v57
    v_lshlrev_b32 v33, 2, v33
    buffer_load_dword v34, off, s[96:99], 0 offset:64 sc1
    buffer_load_dword v35, v33, s[4:7], s89 offen sc1
cf_cpe869:
    s_xor_b32 s78, s75, 2097152
    s_lshr_b32 s78, s78, s72
    s_add_u32 s78, s78, s67
    s_mov_b64 s[8:9], s[50:51]
    v_mov_b32 v58, v48
    s_lshr_b32 s79, 131072, s72
    s_add_u32 s80, s66, 0
    s_mov_b32 s76, 0
    s_mov_b32 s77, 8192
    s_call_b64 s[82:83], cf_dma
    ds_read_b64_tr_b16 a[136:137], v56 offset:0
    ds_read_b64_tr_b16 a[138:139], v56 offset:256
    ds_read_b64_tr_b16 a[140:141], v56 offset:8192
    ds_read_b64_tr_b16 a[142:143], v56 offset:8448
    s_mov_b32 s77, 16384
    s_call_b64 s[82:83], cf_dma
    s_waitcnt lgkmcnt(0)
    v_add_u32 v55, 147456, v51
    v_xor_b32 v56, 32, v55
    ds_read_b64_tr_b16 a[144:145], v55 offset:0
    ds_read_b64_tr_b16 a[146:147], v55 offset:256
    ds_read_b64_tr_b16 a[148:149], v55 offset:8192
    ds_read_b64_tr_b16 a[150:151], v55 offset:8448
    s_mov_b32 s77, 24576
    s_call_b64 s[82:83], cf_dma
    ds_read_b64_tr_b16 a[152:153], v56 offset:0
    ds_read_b64_tr_b16 a[154:155], v56 offset:256
    ds_read_b64_tr_b16 a[156:157], v56 offset:8192
    ds_read_b64_tr_b16 a[158:159], v56 offset:8448
    s_mov_b32 s77, 32768
    s_call_b64 s[82:83], cf_dma
    s_waitcnt lgkmcnt(0)
    s_waitcnt vmcnt(8)
    v_add_u32 v55, 65536, v51
    v_xor_b32 v56, 32, v55
    ds_read_b64_tr_b16 a[160:161], v55 offset:0
    ds_read_b64_tr_b16 a[162:163], v55 offset:256
    ds_read_b64_tr_b16 a[164:165], v55 offset:8192
    ds_read_b64_tr_b16 a[166:167], v55 offset:8448
    s_cmp_eq_u32 s88, 0
    s_cbranch_scc1 cf_ncp917
    s_waitcnt vmcnt(8)
    v_max_u32 v34, 1, v34
    v_cmp_eq_u32 vcc, 1, v34
    s_cbranch_vccnz cf_ncp917
    v_cmp_ne_u32 vcc, v34, v35
    s_cbranch_vccnz cf_ncp917
    s_mov_b32 s88, 0
    s_mov_b32 s72, 5
    s_lshl_b32 s74, s73, 19
    s_add_u32 s74, s74, 96468992
    s_add_u32 s50, s4, s74
    s_addc_u32 s51, s5, 0
    s_add_u32 s52, s50, 147456
    s_addc_u32 s53, s51, 0
    s_lshl_b32 s67, s13, 6
    v_and_b32 v54, 63, v48
    v_lshrrev_b32 v48, 13, v48
    v_lshl_add_u32 v48, v48, 8, v54
cf_ncp917:
    s_cmp_eq_u32 s88, 0
    s_cbranch_scc1 cf_cpe938
    s_lshl_b32 s89, s73, 7
    s_add_u32 s89, s89, 125853696
    v_min_u32 v33, 11, v57
    v_lshlrev_b32 v33, 2, v33
    buffer_load_dword v34, off, s[96:99], 0 offset:64 sc1
    buffer_load_dword v35, v33, s[4:7], s89 offen sc1
cf_cpe938:
    s_xor_b32 s78, s75, 3145728
    s_lshr_b32 s78, s78, s72
    s_add_u32 s78, s78, s67
    s_mov_b64 s[8:9], s[50:51]
    v_mov_b32 v58, v48
    s_lshr_b32 s79, 131072, s72
    s_add_u32 s80, s66, 32768
    s_mov_b32 s76, 0
    s_mov_b32 s77, 8192
    s_call_b64 s[82:83], cf_dma
    ds_read_b64_tr_b16 a[168:169], v56 offset:0
    ds_read_b64_tr_b16 a[170:171], v56 offset:256
    ds_read_b64_tr_b16 a[172:173], v56 offset:8192
    ds_read_b64_tr_b16 a[174:175], v56 offset:8448
    s_mov_b32 s77, 16384
    s_call_b64 s[82:83], cf_dma
    s_waitcnt lgkmcnt(0)
    v_add_u32 v55, 81920, v51
    v_xor_b32 v56, 32, v55
    ds_read_b64_tr_b16 a[176:177], v55 offset:0
    ds_read_b64_tr_b16 a[178:179], v55 offset:256
    ds_read_b64_tr_b16 a[180:181], v55 offset:8192
    ds_read_b64_tr_b16 a[182:183], v55 offset:8448
    s_mov_b32 s77, 24576
    s_call_b64 s[82:83], cf_dma
    ds_read_b64_tr_b16 a[184:185], v56 offset:0
    ds_read_b64_tr_b16 a[186:187], v56 offset:256
    ds_read_b64_tr_b16 a[188:189], v56 offset:8192
    ds_read_b64_tr_b16 a[190:191], v56 offset:8448
    s_mov_b32 s77, 32768
    s_call_b64 s[82:83], cf_dma
    s_waitcnt lgkmcnt(0)
    s_waitcnt vmcnt(8)
    v_add_u32 v55, 0, v51
    v_xor_b32 v56, 32, v55
    ds_read_b64_tr_b16 a[48:49], v55 offset:0
    ds_read_b64_tr_b16 a[50:51], v55 offset:256
    ds_read_b64_tr_b16 a[52:53], v55 offset:8192
    ds_read_b64_tr_b16 a[54:55], v55 offset:8448
    s_lshr_b32 s78, 4194304, s72
    s_add_u32 s78, s78, s67
    s_mov_b32 s81, 0
    s_add_u32 s80, s66, 98304
    s_mov_b32 s76, 0
    s_mov_b32 s77, 8192
    s_call_b64 s[82:83], cf_dma
    ds_read_b64_tr_b16 a[56:57], v56 offset:0
    ds_read_b64_tr_b16 a[58:59], v56 offset:256
    ds_read_b64_tr_b16 a[60:61], v56 offset:8192
    ds_read_b64_tr_b16 a[62:63], v56 offset:8448
    s_mov_b32 s77, 16384
    s_call_b64 s[82:83], cf_dma
    s_waitcnt lgkmcnt(0)
    v_add_u32 v55, 16384, v51
    v_xor_b32 v56, 32, v55
    ds_read_b64_tr_b16 a[64:65], v55 offset:0
    ds_read_b64_tr_b16 a[66:67], v55 offset:256
    ds_read_b64_tr_b16 a[68:69], v55 offset:8192
    ds_read_b64_tr_b16 a[70:71], v55 offset:8448
    s_cmp_eq_u32 s88, 0
    s_cbranch_scc1 cf_ncp1006
    s_waitcnt vmcnt(12)
    v_max_u32 v34, 1, v34
    v_cmp_eq_u32 vcc, 1, v34
    s_cbranch_vccnz cf_ncp1006
    v_cmp_ne_u32 vcc, v34, v35
    s_cbranch_vccnz cf_ncp1006
    s_mov_b32 s88, 0
    s_mov_b32 s72, 5
    s_lshl_b32 s74, s73, 19
    s_add_u32 s74, s74, 96468992
    s_add_u32 s50, s4, s74
    s_addc_u32 s51, s5, 0
    s_add_u32 s52, s50, 147456
    s_addc_u32 s53, s51, 0
    s_lshl_b32 s67, s13, 6
    v_and_b32 v54, 63, v48
    v_lshrrev_b32 v48, 13, v48
    v_lshl_add_u32 v48, v48, 8, v54
cf_ncp1006:
    s_xor_b32 s78, s75, 1048576
    s_lshr_b32 s78, s78, s72
    s_add_u32 s78, s78, s67
    s_mov_b64 s[8:9], s[50:51]
    v_mov_b32 v58, v48
    s_lshr_b32 s79, 131072, s72
    s_mov_b32 s81, s93
    s_add_u32 s80, s66, 114688
    s_mov_b32 s76, 0
    s_mov_b32 s77, 8192
    s_call_b64 s[82:83], cf_dma
    ds_read_b64_tr_b16 a[72:73], v56 offset:0
    ds_read_b64_tr_b16 a[74:75], v56 offset:256
    ds_read_b64_tr_b16 a[76:77], v56 offset:8192
    ds_read_b64_tr_b16 a[78:79], v56 offset:8448
    s_mov_b32 s77, 16384
    s_call_b64 s[82:83], cf_dma
    s_waitcnt lgkmcnt(0)
    s_waitcnt vmcnt(8)
    v_add_u32 v55, 32768, v51
    v_xor_b32 v56, 32, v55
    ds_read_b64_tr_b16 a[80:81], v55 offset:0
    ds_read_b64_tr_b16 a[82:83], v55 offset:256
    ds_read_b64_tr_b16 a[84:85], v55 offset:8192
    ds_read_b64_tr_b16 a[86:87], v55 offset:8448
    s_mov_b32 s77, 24576
    s_call_b64 s[82:83], cf_dma
    ds_read_b64_tr_b16 a[88:89], v56 offset:0
    ds_read_b64_tr_b16 a[90:91], v56 offset:256
    ds_read_b64_tr_b16 a[92:93], v56 offset:8192
    ds_read_b64_tr_b16 a[94:95], v56 offset:8448
    s_mov_b32 s77, 32768
    s_call_b64 s[82:83], cf_dma
    s_waitcnt lgkmcnt(0)
    v_add_u32 v55, 49152, v51
    v_xor_b32 v56, 32, v55
    ds_read_b64_tr_b16 a[96:97], v55 offset:0
    ds_read_b64_tr_b16 a[98:99], v55 offset:256
    ds_read_b64_tr_b16 a[100:101], v55 offset:8192
    ds_read_b64_tr_b16 a[102:103], v55 offset:8448
    s_xor_b32 s78, s75, 0
    s_lshr_b32 s78, s78, s72
    s_add_u32 s78, s78, s67
    s_add_u32 s80, s66, 65536
    s_mov_b32 s76, 0
    s_mov_b32 s77, 8192
    s_call_b64 s[82:83], cf_dma
    ds_read_b64_tr_b16 a[104:105], v56 offset:0
    ds_read_b64_tr_b16 a[106:107], v56 offset:256
    ds_read_b64_tr_b16 a[108:109], v56 offset:8192
    ds_read_b64_tr_b16 a[110:111], v56 offset:8448
    s_mov_b32 s77, 16384
    s_call_b64 s[82:83], cf_dma
    s_waitcnt lgkmcnt(0)
    s_waitcnt vmcnt(12)
    v_add_u32 v55, 98304, v51
    v_xor_b32 v56, 32, v55
    ds_read_b64_tr_b16 a[112:113], v55 offset:0
    ds_read_b64_tr_b16 a[114:115], v55 offset:256
    ds_read_b64_tr_b16 a[116:117], v55 offset:8192
    ds_read_b64_tr_b16 a[118:119], v55 offset:8448
    s_mov_b32 s77, 24576
    s_call_b64 s[82:83], cf_dma
    ds_read_b64_tr_b16 a[120:121], v56 offset:0
    ds_read_b64_tr_b16 a[122:123], v56 offset:256
    ds_read_b64_tr_b16 a[124:125], v56 offset:8192
    ds_read_b64_tr_b16 a[126:127], v56 offset:8448
    s_mov_b32 s77, 32768
    s_call_b64 s[82:83], cf_dma
    s_waitcnt lgkmcnt(0)
    s_waitcnt vmcnt(8)
    v_add_u32 v55, 114688, v51
    v_xor_b32 v56, 32, v55
    ds_read_b64_tr_b16 a[16:17], v55 offset:0
    ds_read_b64_tr_b16 a[18:19], v55 offset:256
    ds_read_b64_tr_b16 a[20:21], v55 offset:8192
    ds_read_b64_tr_b16 a[22:23], v55 offset:8448
    s_xor_b32 s78, s75, 0
    s_lshr_b32 s78, s78, s72
    s_add_u32 s78, s78, s67
    s_mov_b64 s[8:9], s[52:53]
    s_add_u32 s80, s66, 0
    s_mov_b32 s76, 0
    s_mov_b32 s77, 8192
    s_call_b64 s[82:83], cf_dma
    ds_read_b64_tr_b16 a[24:25], v56 offset:0
    ds_read_b64_tr_b16 a[26:27], v56 offset:256
    ds_read_b64_tr_b16 a[28:29], v56 offset:8192
    ds_read_b64_tr_b16 a[30:31], v56 offset:8448
    s_mov_b32 s77, 16384
    s_call_b64 s[82:83], cf_dma
    s_waitcnt lgkmcnt(0)
    v_add_u32 v55, 131072, v51
    v_xor_b32 v56, 32, v55
    ds_read_b64_tr_b16 a[32:33], v55 offset:0
    ds_read_b64_tr_b16 a[34:35], v55 offset:256
    ds_read_b64_tr_b16 a[36:37], v55 offset:8192
    ds_read_b64_tr_b16 a[38:39], v55 offset:8448
    s_mov_b32 s77, 24576
    s_call_b64 s[82:83], cf_dma
    ds_read_b64_tr_b16 a[40:41], v56 offset:0
    ds_read_b64_tr_b16 a[42:43], v56 offset:256
    ds_read_b64_tr_b16 a[44:45], v56 offset:8192
    ds_read_b64_tr_b16 a[46:47], v56 offset:8448
    s_mov_b32 s77, 32768
    s_call_b64 s[82:83], cf_dma
    s_waitcnt lgkmcnt(0)
    s_waitcnt vmcnt(8)
    v_add_u32 v55, 65536, v51
    v_xor_b32 v56, 32, v55
    ds_read_b64_tr_b16 v[0:1], v55 offset:0
    ds_read_b64_tr_b16 v[2:3], v55 offset:256
    ds_read_b64_tr_b16 v[4:5], v55 offset:8192
    ds_read_b64_tr_b16 v[6:7], v55 offset:8448
    s_xor_b32 s78, s75, 1048576
    s_lshr_b32 s78, s78, s72
    s_add_u32 s78, s78, s67
    s_add_u32 s80, s66, 32768
    s_mov_b32 s76, 0
    s_mov_b32 s77, 8192
    s_call_b64 s[82:83], cf_dma
    ds_read_b64_tr_b16 v[8:9], v56 offset:0
    ds_read_b64_tr_b16 v[10:11], v56 offset:256
    ds_read_b64_tr_b16 v[12:13], v56 offset:8192
    ds_read_b64_tr_b16 v[14:15], v56 offset:8448
    s_mov_b32 s77, 16384
    s_call_b64 s[82:83], cf_dma
    s_waitcnt lgkmcnt(0)
    ds_write_b128 v62, v[0:3] offset:8192
    ds_write_b128 v62, v[4:7] offset:12288
    ds_write_b128 v62, v[8:11] offset:16384
    ds_write_b128 v62, v[12:15] offset:20480
    s_waitcnt lgkmcnt(0)
    v_add_u32 v55, 81920, v51
    v_xor_b32 v56, 32, v55
    ds_read_b64_tr_b16 a[0:1], v55 offset:0
    ds_read_b64_tr_b16 a[2:3], v55 offset:256
    ds_read_b64_tr_b16 a[4:5], v55 offset:8192
    ds_read_b64_tr_b16 a[6:7], v55 offset:8448
    s_mov_b32 s77, 24576
    s_call_b64 s[82:83], cf_dma
    ds_read_b64_tr_b16 a[8:9], v56 offset:0
    ds_read_b64_tr_b16 a[10:11], v56 offset:256
    ds_read_b64_tr_b16 a[12:13], v56 offset:8192
    ds_read_b64_tr_b16 a[14:15], v56 offset:8448
    s_mov_b32 s77, 32768
    s_call_b64 s[82:83], cf_dma
    s_waitcnt lgkmcnt(0)
    s_waitcnt vmcnt(8)
    v_add_u32 v55, 0, v51
    v_xor_b32 v56, 32, v55
    ds_read_b64_tr_b16 v[0:1], v55 offset:0
    ds_read_b64_tr_b16 v[2:3], v55 offset:256
    ds_read_b64_tr_b16 v[4:5], v55 offset:8192
    ds_read_b64_tr_b16 v[6:7], v55 offset:8448
    s_xor_b32 s94, s13, 0
    s_mul_i32 s94, s94, 36864
    s_add_u32 s94, s94, s92
    s_lshr_b32 s74, s13, 1
    s_lshl_b32 s74, s74, 6
    s_add_u32 s94, s94, s74
    s_add_u32 s78, s94, 1024
    s_mov_b64 s[8:9], s[56:57]
    v_mov_b32 v58, v50
    s_mov_b32 s79, 18432
    s_mov_b32 s81, 0
    s_add_u32 s80, s66, 147456
    s_mov_b32 s76, 0
    s_mov_b32 s77, 8192
    s_call_b64 s[82:83], cf_dma
    ds_read_b64_tr_b16 v[8:9], v56 offset:0
    ds_read_b64_tr_b16 v[10:11], v56 offset:256
    ds_read_b64_tr_b16 v[12:13], v56 offset:8192
    ds_read_b64_tr_b16 v[14:15], v56 offset:8448
    s_xor_b32 s94, s13, 2
    s_mul_i32 s94, s94, 36864
    s_add_u32 s94, s94, s92
    s_lshr_b32 s74, s13, 1
    s_lshl_b32 s74, s74, 6
    s_add_u32 s94, s94, s74
    s_add_u32 s78, s94, 1024
    s_mov_b32 s77, 16384
    s_call_b64 s[82:83], cf_dma
    s_waitcnt lgkmcnt(0)
    ds_write_b128 v61, v[0:3] offset:0
    ds_write_b128 v61, v[4:7] offset:4096
    ds_write_b128 v61, v[8:11] offset:8192
    ds_write_b128 v61, v[12:15] offset:12288
    s_waitcnt lgkmcnt(0)
    v_add_u32 v55, 16384, v51
    v_xor_b32 v56, 32, v55
    ds_read_b64_tr_b16 v[0:1], v55 offset:0
    ds_read_b64_tr_b16 v[2:3], v55 offset:256
    ds_read_b64_tr_b16 v[4:5], v55 offset:8192
    ds_read_b64_tr_b16 v[6:7], v55 offset:8448
    s_xor_b32 s94, s13, 3
    s_mul_i32 s94, s94, 36864
    s_add_u32 s94, s94, s92
    s_lshl_b32 s74, s13, 7
    s_add_u32 s94, s94, s74
    s_add_u32 s78, s94, 512
    v_mov_b32 v58, v49
    s_mov_b32 s79, 9216
    s_add_u32 s80, s66, 131072
    s_mov_b32 s76, 0
    s_mov_b32 s77, 8192
    s_call_b64 s[82:83], cf_dma
    ds_read_b64_tr_b16 v[8:9], v56 offset:0
    ds_read_b64_tr_b16 v[10:11], v56 offset:256
    ds_read_b64_tr_b16 v[12:13], v56 offset:8192
    ds_read_b64_tr_b16 v[14:15], v56 offset:8448
    s_mov_b32 s77, 16384
    s_call_b64 s[82:83], cf_dma
    s_waitcnt lgkmcnt(0)
    ds_write_b128 v61, v[0:3] offset:16384
    ds_write_b128 v61, v[4:7] offset:20480
    ds_write_b128 v61, v[8:11] offset:24576
    ds_write_b128 v61, v[12:15] offset:28672
    s_waitcnt lgkmcnt(0)
    s_waitcnt vmcnt(8)
    v_add_u32 v55, 32768, v51
    v_xor_b32 v56, 32, v55
    ds_read_b64_tr_b16 v[0:1], v55 offset:0
    ds_read_b64_tr_b16 v[2:3], v55 offset:256
    ds_read_b64_tr_b16 v[4:5], v55 offset:8192
    ds_read_b64_tr_b16 v[6:7], v55 offset:8448
    s_xor_b32 s94, s13, 2
    s_mul_i32 s94, s94, 36864
    s_add_u32 s94, s94, s92
    s_lshl_b32 s74, s13, 7
    s_add_u32 s94, s94, s74
    s_add_u32 s78, s94, 512
    s_add_u32 s80, s66, 114688
    s_mov_b32 s76, 0
    s_mov_b32 s77, 8192
    s_call_b64 s[82:83], cf_dma
    ds_read_b64_tr_b16 v[8:9], v56 offset:0
    ds_read_b64_tr_b16 v[10:11], v56 offset:256
    ds_read_b64_tr_b16 v[12:13], v56 offset:8192
    ds_read_b64_tr_b16 v[14:15], v56 offset:8448
    s_mov_b32 s77, 16384
    s_call_b64 s[82:83], cf_dma
    s_waitcnt lgkmcnt(0)
    ds_write_b128 v61, v[0:3] offset:32768
    ds_write_b128 v61, v[4:7] offset:36864
    ds_write_b128 v61, v[8:11] offset:40960
    ds_write_b128 v61, v[12:15] offset:45056
    s_waitcnt lgkmcnt(0)
    v_add_u32 v55, 49152, v51
    v_xor_b32 v56, 32, v55
    ds_read_b64_tr_b16 v[0:1], v55 offset:0
    ds_read_b64_tr_b16 v[2:3], v55 offset:256
    ds_read_b64_tr_b16 v[4:5], v55 offset:8192
    ds_read_b64_tr_b16 v[6:7], v55 offset:8448
    s_lshr_b32 s78, 4194304, s72
    s_add_u32 s78, s78, s67
    s_mov_b64 s[8:9], s[52:53]
    v_mov_b32 v58, v48
    s_lshr_b32 s79, 131072, s72
    s_add_u32 s80, s66, 81920
    s_mov_b32 s76, 0
    s_mov_b32 s77, 8192
    s_call_b64 s[82:83], cf_dma
    ds_read_b64_tr_b16 v[8:9], v56 offset:0
    ds_read_b64_tr_b16 v[10:11], v56 offset:256
    ds_read_b64_tr_b16 v[12:13], v56 offset:8192
    ds_read_b64_tr_b16 v[14:15], v56 offset:8448
    s_mov_b32 s77, 16384
    s_call_b64 s[82:83], cf_dma
    s_waitcnt lgkmcnt(0)
    ds_write_b128 v61, v[0:3] offset:49152
    ds_write_b128 v61, v[4:7] offset:53248
    ds_write_b128 v61, v[8:11] offset:57344
    ds_write_b128 v61, v[12:15] offset:61440
    s_waitcnt lgkmcnt(0)
    buffer_load_dword v38, off, s[96:99], 0 offset:140 sc1
    buffer_load_dword v39, off, s[96:99], 0 offset:64 sc1
    s_lshr_b32 s84, s12, 1
    s_lshl_b32 s84, s84, 8
    s_add_u32 s84, s84, 125829120
    v_bfe_u32 v40, v61, 4, 6
    v_min_u32 v40, 11, v40
    v_lshlrev_b32 v40, 2, v40
    buffer_load_dword v41, v40, s[4:7], s84 offen sc1
    s_waitcnt vmcnt(15)
    v_add_u32 v55, 147456, v53
    ds_read_b64_tr_b16 v[0:1], v55 offset:0
    ds_read_b64_tr_b16 v[2:3], v55 offset:128
    ds_read_b64_tr_b16 v[4:5], v55 offset:512
    ds_read_b64_tr_b16 v[6:7], v55 offset:640
    ds_read_b64_tr_b16 v[8:9], v55 offset:8192
    ds_read_b64_tr_b16 v[10:11], v55 offset:8320
    ds_read_b64_tr_b16 v[12:13], v55 offset:8704
    ds_read_b64_tr_b16 v[14:15], v55 offset:8832
    s_waitcnt lgkmcnt(0)
    s_barrier
    ds_write_b128 v63, v[0:3] offset:49152
    ds_write_b128 v63, v[4:7] offset:53248
    s_barrier
    ds_write_b128 v63, v[8:11] offset:57344
    ds_write_b128 v63, v[12:15] offset:61440
    s_waitcnt lgkmcnt(0)
    s_waitcnt vmcnt(11)
    v_add_u32 v55, 131072, v52
    ds_read_b64_tr_b16 v[0:1], v55 offset:0
    ds_read_b64_tr_b16 v[2:3], v55 offset:256
    ds_read_b64_tr_b16 v[4:5], v55 offset:4096
    ds_read_b64_tr_b16 v[6:7], v55 offset:4352
    ds_read_b64_tr_b16 v[8:9], v55 offset:64
    ds_read_b64_tr_b16 v[10:11], v55 offset:320
    ds_read_b64_tr_b16 v[12:13], v55 offset:4160
    ds_read_b64_tr_b16 v[14:15], v55 offset:4416
    s_waitcnt lgkmcnt(0)
    s_barrier
    ds_write_b128 v63, v[0:3] offset:32768
    ds_write_b128 v63, v[4:7] offset:36864
    s_barrier
    ds_write_b128 v63, v[8:11] offset:40960
    ds_write_b128 v63, v[12:15] offset:45056
    s_waitcnt lgkmcnt(0)
    s_waitcnt vmcnt(7)
    v_add_u32 v55, 114688, v52
    ds_read_b64_tr_b16 v[0:1], v55 offset:0
    ds_read_b64_tr_b16 v[2:3], v55 offset:256
    ds_read_b64_tr_b16 v[4:5], v55 offset:4096
    ds_read_b64_tr_b16 v[6:7], v55 offset:4352
    ds_read_b64_tr_b16 v[8:9], v55 offset:64
    ds_read_b64_tr_b16 v[10:11], v55 offset:320
    ds_read_b64_tr_b16 v[12:13], v55 offset:4160
    ds_read_b64_tr_b16 v[14:15], v55 offset:4416
    s_waitcnt lgkmcnt(0)
    s_barrier
    ds_write_b128 v63, v[0:3] offset:16384
    ds_write_b128 v63, v[4:7] offset:20480
    s_barrier
    ds_write_b128 v63, v[8:11] offset:24576
    ds_write_b128 v63, v[12:15] offset:28672
    s_waitcnt lgkmcnt(0)
    buffer_load_dword v30, v79, s[4:7], s14 offen sc1
    s_lshl_b32 s40, s12, 14
    s_add_u32 s40, s40, 67174400
    buffer_load_dword v30, v79, s[4:7], s40 offen sc1
    s_and_b32 s40, s12, 3
    s_lshl_b32 s40, s40, 14
    s_add_u32 s40, s40, 67108864
    buffer_load_dword v30, v79, s[4:7], s40 offen sc1
    s_waitcnt vmcnt(1)
    v_readfirstlane_b32 s95, v39
    v_readfirstlane_b32 s85, v38
    s_add_u32 s86, s95, 2
    s_waitcnt vmcnt(0)
    v_subrev_u32 v41, s86, v41
    v_cmp_lt_u32 s[86:87], 64, v41
    s_cmp_eq_u32 s95, 0
    s_cselect_b64 s[86:87], -1, s[86:87]
    s_cmp_lg_u64 s[86:87], 0
    s_cbranch_scc1 cf_nt
    s_add_u32 s40, s24, 524288
    buffer_load_dword v30, v79, s[4:7], s24 offen sc1
    buffer_load_dword v30, v79, s[4:7], s40 offen sc1
cf_nt:
    s_waitcnt vmcnt(3)
    v_add_u32 v55, 81920, v51
    v_xor_b32 v56, 32, v55
    ds_read_b64_tr_b16 v[0:1], v55 offset:0
    ds_read_b64_tr_b16 v[2:3], v55 offset:256
    ds_read_b64_tr_b16 v[4:5], v55 offset:8192
    ds_read_b64_tr_b16 v[6:7], v55 offset:8448
    ds_read_b64_tr_b16 v[8:9], v56 offset:0
    ds_read_b64_tr_b16 v[10:11], v56 offset:256
    ds_read_b64_tr_b16 v[12:13], v56 offset:8192
    ds_read_b64_tr_b16 v[14:15], v56 offset:8448
    s_waitcnt lgkmcnt(0)
    ds_write_b128 v62, v[0:3] offset:24576
    ds_write_b128 v62, v[4:7] offset:28672
    ds_write_b128 v62, v[8:11] offset:32768
    ds_write_b128 v62, v[12:15] offset:36864
    s_waitcnt lgkmcnt(0)
    s_barrier
    s_mov_b32 s88, 4194304
gn2:
    s_cmp_lg_u32 s95, 0
    s_cbranch_scc1 gn2x
    buffer_load_dword v24, off, s[96:99], 0 offset:64 sc1
    s_sub_u32 s88, s88, 1
    s_cbranch_scc1 gn2x
    s_waitcnt vmcnt(0)
    v_readfirstlane_b32 s95, v24
    s_nop 1
    s_branch gn2
gn2x:
    ds_write_b128 v78, v[16:19] offset:8704
    ds_write_b128 v65, v[20:23] offset:10240
    v_mov_b32 v44, s95
    v_mov_b32 v45, s95
    v_mov_b32 v46, s95
    v_mov_b32 v47, s95
    v_mov_b32 v48, 108288
    ds_write_b128 v48, v[44:47]
    s_waitcnt vmcnt(0) lgkmcnt(0)
    s_cmp_eq_u32 s85, 1
    s_cbranch_scc1 cf_run
    s_mov_b32 s40, 131072
cf_startpoll:
    buffer_load_dword v3, off, s[96:99], 0 offset:140 sc1
    s_waitcnt vmcnt(0)
    v_readfirstlane_b32 s85, v3
    s_nop 0
    s_cmp_eq_u32 s85, 1
    s_cbranch_scc1 cf_run
    s_cmp_eq_u32 s85, 2
    s_cbranch_scc1 cf_leave
    s_sleep 1
    s_sub_u32 s40, s40, 1
    s_cbranch_scc0 cf_startpoll
    v_mov_b32 v4, 2
    v_mov_b32 v5, 0
    s_mov_b64 exec, 1
    buffer_atomic_cmpswap v[4:5], off, s[96:99], 0 offset:140
    s_mov_b64 exec, -1
    s_mov_b32 s40, 1048576
    s_branch cf_startpoll
cf_leave:
    v_lshrrev_b32 v0, 4, v61
    s_mov_b32 s32, s13
    s_load_dwordx16 s[48:63], s[0:1], 0
    s_waitcnt lgkmcnt(0)
    s_branch L_helper
cf_run:
    s_cmp_eq_u64 s[86:87], 0
    s_cbranch_scc1 cf_kvok
    s_lshr_b32 s92, s12, 1
    s_lshl_b32 s92, s92, 8
    s_add_u32 s92, s92, 125829120
    v_bfe_u32 v2, v61, 4, 6
    v_min_u32 v2, 11, v2
    v_lshlrev_b32 v2, 2, v2
    s_add_u32 s93, s95, 2
    s_mov_b32 s94, 4194304
cf_kv0:
    buffer_load_dword v3, v2, s[4:7], s92 offen sc1
    s_sub_u32 s94, s94, 1
    s_cbranch_scc1 cf_kv0_go
    s_waitcnt vmcnt(0)
    v_subrev_u32 v3, s93, v3
    v_cmp_lt_u32 vcc, 64, v3
    s_cbranch_vccz cf_kv0_go
    s_sleep 2
    s_branch cf_kv0
cf_kv0_go:
    s_add_u32 s40, s24, 524288
    buffer_load_dword v30, v79, s[4:7], s24 offen sc1
    buffer_load_dword v30, v79, s[4:7], s40 offen sc1
    s_waitcnt vmcnt(0)
cf_kvok:
    s_mov_b32 m0, 108032
    s_add_u32 s24, s24, 1048576
    s_add_u32 s15, s14, 4096
    s_add_u32 s16, s14, 8192
    ds_read_b128 v[32:35], v62 offset:16384
    ds_read_b128 v[36:39], v62 offset:20480
    ds_read_b128 v[40:43], v61 offset:0
    ds_read_b128 v[44:47], v61 offset:4096
    ds_read_b128 v[48:51], v61 offset:8192
    ds_read_b128 v[52:55], v61 offset:12288
    s_mov_b32 s29, 1048576
    buffer_load_dwordx4 v[24:27], v61, s[4:7], s14 offen nt
.p2align 6
cf_loop:
    v_mov_b64 v[0:1], 0
    v_mov_b64 v[2:3], 0
    v_mov_b64 v[4:5], 0
    v_mov_b64 v[6:7], 0
    v_mov_b64 v[8:9], 0
    v_mov_b64 v[10:11], 0
    v_mov_b64 v[12:13], 0
    v_mov_b64 v[14:15], 0
cf_loop2:
    ds_read_b128 v[16:19], v62 offset:8192
    ds_read_b128 v[20:23], v62 offset:12288
    v_lshrrev_b32 v56, 2, v61
    v_add_u32 v58, 106496, v56
    s_mov_b32 s29, 1048576
    s_nop 13
    buffer_load_dwordx4 v[24:27], v61, s[4:7], s14 offen nt
    s_waitcnt lgkmcnt(0)
cf_chk0:
    s_waitcnt vmcnt(1)
    v_max3_u32 v57, v24, v25, v26
    v_max_u32 v57, v57, v27
    v_cmp_eq_u32 vcc, -1, v57
    ds_write_b128 v62, v[24:27] offset:40960
    s_cbranch_vccnz cf_spin0
    v_smfmac_f32_16x16x64_bf16 v[0:3], v[24:27], v[16:23], v60
    buffer_load_dwordx4 v[28:31], v61, s[4:7], s15 offen nt
    buffer_load_dword v59, v56, s[4:7], s16 offen nt
    v_smfmac_f32_16x16x64_bf16 v[8:11], v[24:27], v[32:39], v60
    ds_read_b128 v[32:35], v61 offset:16384
    v_smfmac_f32_16x16x64_bf16 v[12:15], v[24:27], v[48:55], v60
    ds_read_b128 v[36:39], v61 offset:20480
    v_mfma_f32_16x16x16_bf16 v[16:19], v[72:73], v[72:73], 0
    s_waitcnt lgkmcnt(2)
    s_barrier
    ds_read_b128 v[48:51], v63 offset:0
    v_mfma_f32_16x16x16_bf16 v[20:23], v[72:73], v[72:73], 0
    ds_read_b128 v[52:55], v64 offset:0
    v_smfmac_f32_16x16x64_bf16 v[4:7], v[24:27], v[40:47], v60
    ds_read_b128 v[40:43], v61 offset:24576
    v_smfmac_f32_16x16x64_bf16 v[16:19], v[24:27], a[192:199], v60
    ds_read_b128 v[44:47], v61 offset:28672
    v_smfmac_f32_16x16x64_bf16 v[20:23], v[24:27], a[200:207], v60
    s_waitcnt lgkmcnt(3)
    v_smfmac_f32_16x16x64_bf16 v[0:3], v[48:51], a[0:7], v60
    s_add_u32 s18, s14, s31
    s_add_u32 s41, s14, 16384
    v_smfmac_f32_16x16x64_bf16 v[4:7], v[48:51], v[32:39], v60
    ds_read_b128 v[32:35], v61 offset:32768
    v_smfmac_f32_16x16x64_bf16 v[8:11], v[48:51], a[8:15], v60
    ds_read_b128 v[36:39], v61 offset:36864
    s_waitcnt lgkmcnt(2)
    v_smfmac_f32_16x16x64_bf16 v[12:15], v[48:51], v[40:47], v60
    ds_read_b128 v[40:43], v61 offset:40960
    v_smfmac_f32_16x16x64_bf16 v[0:3], v[52:55], a[16:23], v60
    ds_read_b128 v[44:47], v61 offset:45056
    v_smfmac_f32_16x16x64_bf16 v[8:11], v[52:55], a[24:31], v60
    ds_read_b128 v[48:51], v71 offset:0
    s_waitcnt lgkmcnt(3)
    v_smfmac_f32_16x16x64_bf16 v[4:7], v[52:55], v[32:39], v60
    s_waitcnt vmcnt(0)
    ds_write_b128 v62, v[28:31] offset:45056
    s_waitcnt lgkmcnt(2)
    v_smfmac_f32_16x16x64_bf16 v[12:15], v[52:55], v[40:47], v60
    ds_write_b32 v58, v59
    v_max3_u32 v57, v28, v29, v30
    s_waitcnt lgkmcnt(2)
    v_smfmac_f32_16x16x64_bf16 v[0:3], v[48:51], a[32:39], v60
    ds_read_b128 v[32:35], v61 offset:49152
    v_max3_u32 v57, v57, v31, v59
    v_smfmac_f32_16x16x64_bf16 v[8:11], v[48:51], a[40:47], v60
    ds_read_b128 v[36:39], v61 offset:53248
    v_cmp_eq_u32 vcc, -1, v57
    v_smfmac_f32_16x16x64_bf16 v[16:19], v[52:55], a[224:231], v60
    ds_read_b128 v[40:43], v61 offset:57344
    v_smfmac_f32_16x16x64_bf16 v[20:23], v[52:55], a[232:239], v60
    ds_read_b128 v[44:47], v61 offset:61440
    s_cbranch_vccnz cf_spin1
cf_go1:
    v_smfmac_f32_16x16x64_bf16 v[0:3], v[28:31], a[48:55], v60
    s_waitcnt lgkmcnt(4)
    s_barrier
    ds_read_b128 v[52:55], v63 offset:4096
    v_smfmac_f32_16x16x64_bf16 v[8:11], v[28:31], a[56:63], v60
    ds_read_b128 v[56:59], v71 offset:4096
    v_smfmac_f32_16x16x64_bf16 v[4:7], v[28:31], a[128:135], v60
    s_waitcnt lgkmcnt(2)
    v_smfmac_f32_16x16x64_bf16 v[4:7], v[48:51], v[32:39], v60
    buffer_load_dwordx4 v[32:35], v61, s[4:7], s23 offen offset:0 sc1
    v_smfmac_f32_16x16x64_bf16 v[12:15], v[48:51], v[40:47], v60
    ds_read_b128 v[48:51], v64 offset:4096
    v_smfmac_f32_16x16x64_bf16 v[12:15], v[28:31], a[136:143], v60
    ds_read_b128 v[24:27], v65 offset:8192
    s_and_b32 s41, s41, 65535
    s_add_u32 s41, s41, 67108864
    v_smfmac_f32_16x16x64_bf16 v[16:19], v[28:31], v[80:87], v60
    buffer_load_dwordx4 v[36:39], v61, s[4:7], s23 offen offset:1024 sc1
    v_smfmac_f32_16x16x64_bf16 v[20:23], v[28:31], v[88:95], v60
    s_add_u32 s17, s41, s31
    s_and_b32 s30, s28, 1
    s_waitcnt lgkmcnt(3)
    v_smfmac_f32_16x16x64_bf16 v[0:3], v[52:55], a[64:71], v60
    ds_read_b128 v[28:31], v78 offset:8704
    v_smfmac_f32_16x16x64_bf16 v[4:7], v[52:55], a[144:151], v60
    buffer_load_dwordx4 v[40:43], v61, s[4:7], s23 offen offset:2048 sc1
    v_smfmac_f32_16x16x64_bf16 v[8:11], v[52:55], a[72:79], v60
    v_smfmac_f32_16x16x64_bf16 v[12:15], v[52:55], a[152:159], v60
    v_smfmac_f32_16x16x64_bf16 v[16:19], v[52:55], v[96:103], v60
    buffer_load_dwordx4 v[44:47], v61, s[4:7], s23 offen offset:3072 sc1
    v_smfmac_f32_16x16x64_bf16 v[20:23], v[52:55], v[104:111], v60
    ds_read_b128 v[52:55], v62 offset:28672
    s_waitcnt lgkmcnt(3)
    v_smfmac_f32_16x16x64_bf16 v[0:3], v[48:51], a[80:87], v60
    v_smfmac_f32_16x16x64_bf16 v[4:7], v[48:51], a[160:167], v60
    v_smfmac_f32_16x16x64_bf16 v[8:11], v[48:51], a[88:95], v60
    v_smfmac_f32_16x16x64_bf16 v[12:15], v[48:51], a[168:175], v60
    v_smfmac_f32_16x16x64_bf16 v[16:19], v[48:51], v[112:119], v60
    buffer_load_dword v79, s[4:7], s24 offen sc1 lds
    v_smfmac_f32_16x16x64_bf16 v[20:23], v[48:51], v[120:127], v60
    ds_read_b128 v[48:51], v62 offset:24576
    v_smfmac_f32_16x16x64_bf16 v[0:3], v[56:59], a[96:103], v60
    v_smfmac_f32_16x16x64_bf16 v[4:7], v[56:59], a[176:183], v60
    s_waitcnt lgkmcnt(3)
    v_smfmac_f32_16x16x64_bf16 v[0:3], v[24:27], a[112:119], v60
    s_cmp_ge_u32 s28, 62
    v_smfmac_f32_16x16x64_bf16 v[8:11], v[56:59], a[104:111], v60
    s_waitcnt lgkmcnt(0)
    v_smfmac_f32_16x16x64_bf16 v[4:7], v[24:27], v[48:55], v60
    ds_read_b128 v[48:51], v62 offset:32768
    v_cvt_pk_bf16_f32 v0, v0, v1
    v_smfmac_f32_16x16x64_bf16 v[12:15], v[56:59], a[184:191], v60
    ds_read_b128 v[52:55], v62 offset:36864
    v_cvt_pk_bf16_f32 v1, v2, v3
    v_smfmac_f32_16x16x64_bf16 v[8:11], v[24:27], a[120:127], v60
    v_cvt_pk_bf16_f32 v2, v4, v5
    v_smfmac_f32_16x16x64_bf16 v[16:19], v[56:59], v[128:135], v60
    v_cvt_pk_bf16_f32 v3, v6, v7
    s_nop 1
    v_mfma_f32_16x16x32_bf16 v[4:7], v[0:3], v[28:31], 0
    v_cvt_pk_bf16_f32 v8, v8, v9
    s_waitcnt lgkmcnt(0)
    v_smfmac_f32_16x16x64_bf16 v[12:15], v[24:27], v[48:55], v60
    ds_read_b128 v[48:51], v63 offset:0
    v_cvt_pk_bf16_f32 v9, v10, v11
    v_smfmac_f32_16x16x64_bf16 v[20:23], v[56:59], v[136:143], v60
    ds_read_b128 v[52:55], v71 offset:0
    v_cvt_pk_bf16_f32 v0, v4, v5
    s_nop 0
    v_cvt_pk_bf16_f32 v10, v12, v13
    v_cvt_pk_bf16_f32 v11, v14, v15
    v_cvt_pk_bf16_f32 v1, v6, v7
    s_waitcnt vmcnt(1)
    v_mfma_f32_16x16x32_bf16 v[12:15], v[8:11], v[28:31], 0
    s_mov_b64 exec, s[36:37]
    ds_read_b128 v[56:59], v69
    s_mov_b64 exec, -1
    v_smfmac_f32_16x16x64_bf16 v[16:19], v[24:27], v[144:151], v60
    s_nop 3
    v_cvt_pk_bf16_f32 v2, v12, v13
    v_cvt_pk_bf16_f32 v3, v14, v15
    s_nop 1
    v_mfma_f32_16x16x32_bf16 v[8:11], v[0:3], v[0:3], 0
    s_cbranch_scc1 cf_last
cf_back:
    v_mfma_f32_16x16x32_bf16 v[4:7], v[36:39], v[0:3], 0
    ds_read_b128 v[36:39], v63 offset:53248
    v_mfma_f32_16x16x32_bf16 v[12:15], v[32:35], v[0:3], 0
    ds_read_b128 v[32:35], v63 offset:49152
    v_mov_b32_dpp v8, v10 row_ror:8 row_mask:0xf bank_mask:0xc
    v_mov_b32_dpp v9, v11 row_ror:8 row_mask:0xf bank_mask:0xc
    ds_write_b64 v70, v[8:9]
    s_nop 1
    v_mov_b32_dpp v12, v4 row_ror:8 row_mask:0xf bank_mask:0xc
    v_mov_b32_dpp v13, v5 row_ror:8 row_mask:0xf bank_mask:0xc
    v_mov_b32_dpp v14, v6 row_ror:8 row_mask:0xf bank_mask:0xc
    v_mov_b32_dpp v15, v7 row_ror:8 row_mask:0xf bank_mask:0xc
    ds_write_b128 v62, v[12:15] offset:53248
    v_smfmac_f32_16x16x64_bf16 v[20:23], v[24:27], v[152:159], v60
    s_waitcnt lgkmcnt(4)
    s_mov_b64 exec, s[36:37]
    buffer_store_dwordx4 v[56:59], v61, s[4:7], s65 offen sc1
    s_mov_b64 exec, -1
    v_smfmac_f32_16x16x64_bf16 v[16:19], v[48:51], a[208:215], v60
    v_smfmac_f32_16x16x64_bf16 v[20:23], v[48:51], a[216:223], v60
    s_waitcnt lgkmcnt(0)
    s_barrier
    ds_read_b128 v[56:59], v78 offset:10752
    ds_read_b128 v[28:31], v78 offset:11264
    v_smfmac_f32_16x16x64_bf16 v[16:19], v[52:55], a[240:247], v60
    ds_read_b128 v[4:7], v63 offset:12288
    ds_read_b128 v[8:11], v64 offset:12288
    v_smfmac_f32_16x16x64_bf16 v[20:23], v[52:55], a[248:255], v60
    ds_read_b128 v[0:3], v71 offset:12288
    ds_read_b128 v[48:51], v63 offset:57344
    ds_read_b128 v[52:55], v63 offset:61440
    v_mov_b64 v[24:25], s[62:63]
    v_mov_b64 v[26:27], s[60:61]
    v_cvt_pk_bf16_f32 v16, v16, v17
    v_cvt_pk_bf16_f32 v17, v18, v19
    v_pk_mul_f32 v[12:13], v[12:13], s[44:45]
    v_pk_mul_f32 v[14:15], v[14:15], s[44:45]
    s_waitcnt lgkmcnt(5)
    v_pk_add_f32 v[56:57], v[56:57], v[58:59]
    v_pk_add_f32 v[28:29], v[28:29], v[30:31]
    v_pk_add_f32 v[56:57], v[56:57], v[28:29]
    v_pk_mul_f32 v[56:57], v[56:57], s[44:45]
    v_exp_f32 v58, v56
    v_exp_f32 v59, v57
    s_waitcnt lgkmcnt(3)
    v_pk_fma_f32 v[12:13], v[4:5], s[44:45], v[12:13]
    v_pk_fma_f32 v[14:15], v[6:7], s[44:45], v[14:15]
    v_cvt_pk_bf16_f32 v6, v58, v59
    v_pk_fma_f32 v[12:13], v[8:9], s[44:45], v[12:13]
    v_pk_fma_f32 v[14:15], v[10:11], s[44:45], v[14:15]
    s_waitcnt lgkmcnt(2)
    v_pk_fma_f32 v[12:13], v[0:1], s[44:45], v[12:13]
    v_mov_b32_dpp v7, v6 row_ror:8 row_mask:0xf bank_mask:0xf
    v_pk_fma_f32 v[14:15], v[2:3], s[44:45], v[14:15]
    v_exp_f32 v0, v12
    v_mfma_f32_16x16x16_bf16 v[28:31], v[16:17], v[6:7], 0
    v_exp_f32 v1, v13
    v_cvt_pk_bf16_f32 v18, v20, v21
    v_exp_f32 v2, v14
    v_cvt_pk_bf16_f32 v19, v22, v23
    v_cvt_pk_bf16_f32 v8, v0, v1
    v_exp_f32 v3, v15
    v_mfma_f32_16x16x16_bf16 v[20:23], v[18:19], v[6:7], 0
    v_cvt_pk_bf16_f32 v9, v2, v3
    v_mov_b32_dpp v10, v8 row_ror:8 row_mask:0xf bank_mask:0xf
    v_max3_f32 v4, |v12|, |v13|, |v14|
    v_mov_b32_dpp v11, v9 row_ror:8 row_mask:0xf bank_mask:0xf
    v_mfma_f32_16x16x32_bf16 v[0:3], v[24:27], v[6:9], 0
    v_max3_f32 v4, v4, |v15|, |v56|
    v_max_f32_e64 v4, v4, |v57|
    v_mfma_f32_16x16x32_bf16 v[28:31], v[40:43], v[8:11], v[28:31]
    v_cmp_nge_f32 vcc, s46, v4
    v_mfma_f32_16x16x32_bf16 v[20:23], v[44:47], v[8:11], v[20:23]
    v_add_f32_dpp v0, v0, v0 row_ror:8 row_mask:0xf bank_mask:0xf
    v_rcp_f32 v0, v0
    s_cbranch_vccnz cf_guard
cf_norm:
    v_mfma_f32_16x16x16_bf16 v[12:15], v[72:73], v[72:73], 0
    v_mul_f32 v28, v28, v0
    v_mul_f32 v29, v29, v0
    v_mul_f32 v30, v30, v0
    v_mul_f32 v31, v31, v0
    v_mul_f32_dpp v28, v20, v0 row_ror:8 row_mask:0xf bank_mask:0xc
    v_mul_f32_dpp v29, v21, v0 row_ror:8 row_mask:0xf bank_mask:0xc
    v_mul_f32_dpp v30, v22, v0 row_ror:8 row_mask:0xf bank_mask:0xc
    v_mul_f32_dpp v31, v23, v0 row_ror:8 row_mask:0xf bank_mask:0xc
    v_cvt_pk_bf16_f32 v28, v28, v29
    v_cvt_pk_bf16_f32 v29, v30, v31
    v_mfma_f32_16x16x16_bf16 v[8:11], v[72:73], v[72:73], 0
    ds_write_b64 v77, v[28:29]
    v_mfma_f32_16x16x16_bf16 v[4:7], v[72:73], v[72:73], 0
    ds_read_b128 v[0:3], v68
    v_mfma_f32_16x16x16_bf16 v[16:19], v[72:73], v[72:73], 0
    ds_read_b128 v[40:43], v63 offset:16384
    v_mfma_f32_16x16x16_bf16 v[20:23], v[72:73], v[72:73], 0
    ds_read_b128 v[44:47], v63 offset:20480
    s_waitcnt lgkmcnt(3)
    s_barrier
    ds_read_b128 v[24:27], v74
    ds_read_b128 v[28:31], v75
    ds_read_b128 v[56:59], v76
    s_waitcnt lgkmcnt(5)
    v_smfmac_f32_16x16x64_bf16 v[12:15], v[0:3], v[160:167], v60
    v_smfmac_f32_16x16x64_bf16 v[8:11], v[0:3], v[192:199], v60
    v_smfmac_f32_16x16x64_bf16 v[4:7], v[0:3], v[32:39], v60
    ds_read_b128 v[32:35], v63 offset:32768
    v_smfmac_f32_16x16x64_bf16 v[16:19], v[0:3], v[224:231], v60
    ds_read_b128 v[36:39], v63 offset:36864
    s_waitcnt lgkmcnt(3)
    v_smfmac_f32_16x16x64_bf16 v[12:15], v[24:27], v[168:175], v60
    v_smfmac_f32_16x16x64_bf16 v[4:7], v[28:31], v[48:55], v60
    ds_read_b128 v[48:51], v63 offset:24576
    v_smfmac_f32_16x16x64_bf16 v[12:15], v[28:31], v[176:183], v60
    ds_read_b128 v[52:55], v63 offset:28672
    s_waitcnt lgkmcnt(4)
    v_smfmac_f32_16x16x64_bf16 v[12:15], v[56:59], v[184:191], v60
    v_cvt_pk_bf16_f32 v4, v4, v5
    v_smfmac_f32_16x16x64_bf16 v[16:19], v[28:31], v[40:47], v60
    ds_read_b128 v[40:43], v63 offset:40960
    v_and_or_b32 v4, v4, -2, s30
    v_smfmac_f32_16x16x64_bf16 v[8:11], v[24:27], v[200:207], v60
    ds_read_b128 v[44:47], v63 offset:45056
    v_cvt_pk_bf16_f32 v5, v6, v7
    v_smfmac_f32_16x16x64_bf16 v[8:11], v[28:31], v[208:215], v60
    buffer_store_dwordx2 v[4:5], v67, s[4:7], s22 offen
    v_cvt_pk_bf16_f32 v12, v12, v13
    v_smfmac_f32_16x16x64_bf16 v[8:11], v[56:59], v[216:223], v60
    v_and_or_b32 v12, v12, -2, s30
    v_smfmac_f32_16x16x64_bf16 v[16:19], v[24:27], v[232:239], v60
    v_cvt_pk_bf16_f32 v13, v14, v15
    s_waitcnt lgkmcnt(4)
    v_smfmac_f32_16x16x64_bf16 v[16:19], v[56:59], v[32:39], v60
    buffer_store_dwordx2 v[12:13], v66, s[4:7], s20 offen
    v_cvt_pk_bf16_f32 v8, v8, v9
    s_waitcnt lgkmcnt(0)
    v_smfmac_f32_16x16x64_bf16 v[20:23], v[0:3], v[240:247], v60
    v_and_or_b32 v8, v8, -2, s30
    v_smfmac_f32_16x16x64_bf16 v[20:23], v[24:27], v[248:255], v60
    v_cvt_pk_bf16_f32 v9, v10, v11
    v_smfmac_f32_16x16x64_bf16 v[20:23], v[28:31], v[48:55], v60
    buffer_store_dwordx2 v[8:9], v66, s[4:7], s21 offen
    v_cvt_pk_bf16_f32 v16, v16, v17
    v_smfmac_f32_16x16x64_bf16 v[20:23], v[56:59], v[40:47], v60
    v_and_or_b32 v16, v16, -2, s30
    v_cvt_pk_bf16_f32 v17, v18, v19
    buffer_store_dwordx2 v[16:17], v66, s[4:7], s38 offen
    s_cmp_lg_u32 s13, 2
    s_nop 1
    v_cvt_pk_bf16_f32 v20, v20, v21
    v_and_or_b32 v20, v20, -2, s30
    v_cvt_pk_bf16_f32 v21, v22, v23
    buffer_store_dwordx2 v[20:21], v66, s[4:7], s39 offen
    s_cbranch_scc1 cf_w013
    s_nop 15
    s_nop 15
    s_nop 15
    s_nop 15
    s_nop 7
    buffer_load_dwordx4 v[40:43], v65, s[4:7], s19 offen offset:0 nt
    buffer_load_dwordx4 v[44:47], v65, s[4:7], s19 offen offset:1024 nt
    buffer_load_dwordx4 v[48:51], v65, s[4:7], s19 offen offset:2048 nt
    buffer_load_dwordx4 v[52:55], v65, s[4:7], s19 offen offset:3072 nt
    ds_read_b128 v[56:59], v65 offset:10240
    s_add_u32 s28, s28, 1
    s_mov_b32 s14, s41
    s_add_u32 s23, s23, 524288
    s_add_u32 s24, s24, 524288
    s_min_u32 s24, s24, s47
    s_add_u32 s15, s14, 4096
    s_add_u32 s16, s14, 8192
    v_mov_b32 v21, -1
    s_add_u32 s65, s65, 12288
    s_mov_b32 s40, 1
    v_mov_b64 v[0:1], 0
    v_mov_b64 v[2:3], 0
    v_mov_b64 v[4:5], 0
    v_mov_b64 v[6:7], 0
    v_mov_b64 v[8:9], 0
    v_mov_b64 v[10:11], 0
    v_mov_b64 v[12:13], 0
    v_mov_b64 v[14:15], 0
cf_chkF:
    v_mov_b32 v20, 0
    s_waitcnt vmcnt(3)
    s_waitcnt lgkmcnt(0)
    v_mfma_f32_16x16x32_bf16 v[28:31], v[40:43], v[56:59], 0
    v_bitop3_b32 v20, v20, v40, s30 bitop3:0xf6
    v_bitop3_b32 v20, v20, v42, s30 bitop3:0xf6
    s_waitcnt vmcnt(2)
    v_mfma_f32_16x16x32_bf16 v[28:31], v[44:47], v[56:59], v[28:31]
    v_bitop3_b32 v20, v20, v44, s30 bitop3:0xf6
    v_bitop3_b32 v20, v20, v46, s30 bitop3:0xf6
    s_waitcnt vmcnt(1)
    v_mfma_f32_16x16x32_bf16 v[28:31], v[48:51], v[56:59], v[28:31]
    v_bitop3_b32 v20, v20, v48, s30 bitop3:0xf6
    v_bitop3_b32 v20, v20, v50, s30 bitop3:0xf6
    s_waitcnt vmcnt(0)
    v_mfma_f32_16x16x32_bf16 v[28:31], v[52:55], v[56:59], v[28:31]
    v_bitop3_b32 v20, v20, v52, s30 bitop3:0xf6
    v_bitop3_b32 v20, v20, v54, s30 bitop3:0xf6
    v_and_b32 v20, s40, v20
    v_cmp_ne_u32 vcc, 0, v20
    s_cbranch_vccnz cf_spinF
    v_permlane32_swap_b32 v28, v30
    v_permlane32_swap_b32 v29, v31
    v_add_f32 v28, v28, v30
    v_add_f32 v30, v29, v31
    v_cvt_pk_bf16_f32 v28, v28, v30
    s_mov_b64 exec, s[32:33]
    buffer_store_dword v28, v69, s[4:7], s17 offen
    buffer_store_dword v21, v69, s[4:7], s18 offen
    s_mov_b64 exec, -1
    ds_read_b128 v[32:35], v62 offset:16384
    ds_read_b128 v[36:39], v62 offset:20480
    ds_read_b128 v[40:43], v61 offset:0
    ds_read_b128 v[44:47], v61 offset:4096
    ds_read_b128 v[48:51], v61 offset:8192
    ds_read_b128 v[52:55], v61 offset:12288
    s_nop 14
    buffer_load_dwordx4 v[24:27], v61, s[4:7], s14 offen nt
    s_branch cf_loop2
cf_w013:
    ds_read_b128 v[56:59], v65 offset:10240
    ds_read_b128 v[32:35], v62 offset:16384
    ds_read_b128 v[36:39], v62 offset:20480
    ds_read_b128 v[40:43], v61 offset:0
    ds_read_b128 v[44:47], v61 offset:4096
    ds_read_b128 v[48:51], v61 offset:8192
    ds_read_b128 v[52:55], v61 offset:12288
    s_add_u32 s28, s28, 1
    s_mov_b32 s14, s41
    s_add_u32 s23, s23, 524288
    s_add_u32 s24, s24, 524288
    s_min_u32 s24, s24, s47
    s_add_u32 s15, s14, 4096
    s_add_u32 s16, s14, 8192
    v_mov_b32 v21, -1
    s_add_u32 s65, s65, 12288
    s_mov_b32 s40, 1
    s_cmp_eq_u32 s64, 0
    s_cbranch_scc1 cf_w0
    s_cmp_eq_u32 s13, 1
    s_nop 15
    s_nop 15
    s_nop 7
    s_cbranch_scc1 cf_sx
    s_nop 15
    s_nop 13
cf_sx:
    buffer_load_dwordx4 v[0:3], v65, s[4:7], s19 offen offset:0 nt
    buffer_load_dwordx4 v[4:7], v65, s[4:7], s19 offen offset:1024 nt
    buffer_load_dwordx4 v[8:11], v65, s[4:7], s19 offen offset:2048 nt
    buffer_load_dwordx4 v[12:15], v65, s[4:7], s19 offen offset:3072 nt
cf_chkG:
    v_mov_b32 v20, 0
    s_waitcnt vmcnt(3)
    s_waitcnt lgkmcnt(6)
    v_mfma_f32_16x16x32_bf16 v[28:31], v[0:3], v[56:59], 0
    v_bitop3_b32 v20, v20, v0, s30 bitop3:0xf6
    v_bitop3_b32 v20, v20, v2, s30 bitop3:0xf6
    s_waitcnt vmcnt(2)
    v_mfma_f32_16x16x32_bf16 v[28:31], v[4:7], v[56:59], v[28:31]
    v_bitop3_b32 v20, v20, v4, s30 bitop3:0xf6
    v_bitop3_b32 v20, v20, v6, s30 bitop3:0xf6
    s_waitcnt vmcnt(1)
    v_mfma_f32_16x16x32_bf16 v[28:31], v[8:11], v[56:59], v[28:31]
    v_bitop3_b32 v20, v20, v8, s30 bitop3:0xf6
    v_bitop3_b32 v20, v20, v10, s30 bitop3:0xf6
    s_waitcnt vmcnt(0)
    v_mfma_f32_16x16x32_bf16 v[28:31], v[12:15], v[56:59], v[28:31]
    v_bitop3_b32 v20, v20, v12, s30 bitop3:0xf6
    v_bitop3_b32 v20, v20, v14, s30 bitop3:0xf6
    v_and_b32 v20, s40, v20
    v_cmp_ne_u32 vcc, 0, v20
    s_cbranch_vccnz cf_spinG
    v_permlane32_swap_b32 v28, v30
    v_permlane32_swap_b32 v29, v31
    v_add_f32 v28, v28, v30
    v_add_f32 v30, v29, v31
    s_cmp_eq_u32 s13, 3
    s_cbranch_scc1 cf_w3
    v_mov_b32 v29, v28
    v_mov_b32 v31, v30
    s_nop 0
    v_permlane16_swap_b32 v28, v29
    v_permlane16_swap_b32 v30, v31
    v_add_f32 v28, v28, v29
    v_add_f32 v30, v30, v31
cf_w3:
    v_cvt_pk_bf16_f32 v28, v28, v30
    s_mov_b64 exec, s[32:33]
    buffer_store_dword v28, v69, s[4:7], s17 offen
    buffer_store_dword v21, v69, s[4:7], s18 offen
    s_mov_b64 exec, -1
    buffer_load_dwordx4 v[24:27], v61, s[4:7], s14 offen nt
    s_branch cf_loop
cf_w0:
    v_mov_b64 v[0:1], 0
    v_mov_b64 v[2:3], 0
    v_mov_b64 v[4:5], 0
    v_mov_b64 v[6:7], 0
    v_mov_b64 v[8:9], 0
    v_mov_b64 v[10:11], 0
    v_mov_b64 v[12:13], 0
    v_mov_b64 v[14:15], 0
    s_cmp_lg_u32 s28, 10
    s_cbranch_scc1 cf_nokv
    s_lshr_b32 s92, s12, 1
    s_lshl_b32 s92, s92, 8
    s_add_u32 s92, s92, 125829120
    v_bfe_u32 v28, v61, 4, 6
    v_min_u32 v28, 11, v28
    v_lshlrev_b32 v28, 2, v28
    s_add_u32 s93, s95, 63
    s_mov_b32 s94, 4194304
cf_kv1:
    buffer_load_dword v29, v28, s[4:7], s92 offen sc1
    s_sub_u32 s94, s94, 1
    s_cbranch_scc1 cf_kv1_go
    s_waitcnt vmcnt(0)
    v_subrev_u32 v29, s93, v29
    v_cmp_lt_u32 vcc, 64, v29
    s_cbranch_vccz cf_kv1_go
    s_sleep 2
    s_branch cf_kv1
cf_kv1_go:
cf_nokv:
    s_nop 15
    s_nop 15
    s_nop 15
    s_nop 15
    s_nop 15
    s_nop 15
    s_nop 15
    s_nop 15
    s_nop 15
    s_nop 15
    s_nop 7
    buffer_load_dwordx4 v[24:27], v61, s[4:7], s14 offen nt
    s_branch cf_loop2
cf_spinF:
    buffer_load_dwordx4 v[40:43], v65, s[4:7], s19 offen offset:0 nt
    buffer_load_dwordx4 v[44:47], v65, s[4:7], s19 offen offset:1024 nt
    buffer_load_dwordx4 v[48:51], v65, s[4:7], s19 offen offset:2048 nt
    buffer_load_dwordx4 v[52:55], v65, s[4:7], s19 offen offset:3072 nt
    s_sub_u32 s29, s29, 1
    s_cmp_lt_i32 s29, 0
    s_cselect_b32 s40, 0, 1
    s_branch cf_chkF
cf_spinG:
    buffer_load_dwordx4 v[0:3], v65, s[4:7], s19 offen offset:0 nt
    buffer_load_dwordx4 v[4:7], v65, s[4:7], s19 offen offset:1024 nt
    buffer_load_dwordx4 v[8:11], v65, s[4:7], s19 offen offset:2048 nt
    buffer_load_dwordx4 v[12:15], v65, s[4:7], s19 offen offset:3072 nt
    s_sub_u32 s29, s29, 1
    s_cmp_lt_i32 s29, 0
    s_cselect_b32 s40, 0, 1
    s_branch cf_chkG
cf_guard:
    s_cbranch_scc0 cf_guard2
    buffer_store_dwordx4 v[16:19], v61, s[4:7], s26 offen sc1
    s_add_u32 s26, s26, 131072
cf_guard2:
    s_nop 7
    v_max3_f32 v6, v12, v13, v14
    v_max3_f32 v7, v15, v56, v57
    v_max_f32 v6, v6, v7
    s_nop 1
    v_max_f32_dpp v6, v6, v6 row_ror:8 row_mask:0xf bank_mask:0xf
    v_mov_b32 v7, v6
    s_nop 1
    v_permlane32_swap_b32 v6, v7
    v_max_f32 v6, v6, v7
    v_mov_b32 v7, v6
    s_nop 1
    v_permlane16_swap_b32 v6, v7
    v_max_f32 v6, v6, v7
    v_sub_f32 v12, v12, v6
    v_sub_f32 v13, v13, v6
    v_sub_f32 v14, v14, v6
    v_sub_f32 v15, v15, v6
    v_sub_f32 v56, v56, v6
    v_sub_f32 v57, v57, v6
    v_exp_f32 v58, v56
    v_exp_f32 v59, v57
    s_nop 0
    v_cvt_pk_bf16_f32 v6, v58, v59
    s_nop 1
    v_mov_b32_dpp v7, v6 row_ror:8 row_mask:0xf bank_mask:0xf
    v_exp_f32 v0, v12
    s_nop 0
    v_mfma_f32_16x16x16_bf16 v[28:31], v[16:17], v[6:7], 0
    v_exp_f32 v1, v13
    v_exp_f32 v2, v14
    v_cvt_pk_bf16_f32 v8, v0, v1
    v_exp_f32 v3, v15
    v_mfma_f32_16x16x16_bf16 v[20:23], v[18:19], v[6:7], 0
    v_cvt_pk_bf16_f32 v9, v2, v3
    v_mov_b32_dpp v10, v8 row_ror:8 row_mask:0xf bank_mask:0xf
    v_max3_f32 v4, |v12|, |v13|, |v14|
    v_mov_b32_dpp v11, v9 row_ror:8 row_mask:0xf bank_mask:0xf
    v_mfma_f32_16x16x32_bf16 v[0:3], v[24:27], v[6:9], 0
    v_max3_f32 v4, v4, |v15|, |v56|
    v_max_f32_e64 v4, v4, |v57|
    v_mfma_f32_16x16x32_bf16 v[28:31], v[40:43], v[8:11], v[28:31]
    v_cmp_nge_f32 vcc, s46, v4
    v_mfma_f32_16x16x32_bf16 v[20:23], v[44:47], v[8:11], v[20:23]
    v_add_f32_dpp v0, v0, v0 row_ror:8 row_mask:0xf bank_mask:0xf
    v_rcp_f32 v0, v0
    s_nop 4
    s_branch cf_norm
cf_spin0:
    buffer_load_dwordx4 v[24:27], v61, s[4:7], s14 offen nt
    s_sub_u32 s29, s29, 1
    s_cmp_lt_i32 s29, 0
    s_cbranch_scc0 cf_chk0
    s_waitcnt vmcnt(0)
    v_min_u32 v24, -2, v24
    v_min_u32 v25, -2, v25
    v_min_u32 v26, -2, v26
    v_min_u32 v27, -2, v27
    s_branch cf_chk0
cf_spin1:
    buffer_load_dwordx4 v[28:31], v61, s[4:7], s15 offen nt
    buffer_load_dword v59, v56, s[4:7], s16 offen nt
    s_sub_u32 s29, s29, 1
    s_cmp_lt_i32 s29, 0
    s_waitcnt vmcnt(0)
    v_max3_u32 v57, v28, v29, v30
    v_max3_u32 v57, v57, v31, v59
    v_cmp_eq_u32 vcc, -1, v57
    ds_write_b128 v62, v[28:31] offset:45056
    ds_write_b32 v58, v59
    s_waitcnt lgkmcnt(0)
    s_cbranch_scc1 cf_go1
    s_cbranch_vccnz cf_spin1
    s_branch cf_go1
cf_last:
    s_nop 1
    s_cmp_eq_u32 s28, 63
    s_cbranch_scc1 cf_last2
    s_mov_b64 exec, s[34:35]
    buffer_store_dwordx4 v[0:3], v61, s[4:7], s25 offen sc1
    s_mov_b64 exec, -1
    s_add_u32 s25, s25, 131072
    s_mov_b32 s46, 0xbf800000
    s_cmp_eq_u32 0, 0
    s_branch cf_back
cf_last2:
    s_waitcnt lgkmcnt(0)
    s_mov_b64 exec, s[34:35]
    buffer_store_dwordx4 v[0:3], v61, s[4:7], s25 offen sc1
    s_mov_b64 exec, -1
    s_add_u32 s40, s95, 64
    v_mov_b32 v32, s40
    v_smfmac_f32_16x16x64_bf16 v[20:23], v[24:27], v[152:159], v60
    v_smfmac_f32_16x16x64_bf16 v[16:19], v[48:51], a[208:215], v60
    v_smfmac_f32_16x16x64_bf16 v[20:23], v[48:51], a[216:223], v60
    v_smfmac_f32_16x16x64_bf16 v[16:19], v[52:55], a[240:247], v60
    v_smfmac_f32_16x16x64_bf16 v[20:23], v[52:55], a[248:255], v60
    s_nop 3
    v_cvt_pk_bf16_f32 v16, v16, v17
    v_cvt_pk_bf16_f32 v17, v18, v19
    s_nop 1
    v_cvt_pk_bf16_f32 v18, v20, v21
    v_cvt_pk_bf16_f32 v19, v22, v23
    buffer_store_dwordx4 v[16:19], v61, s[4:7], s26 offen sc1
    s_waitcnt vmcnt(0)
    s_mov_b64 exec, 1
    buffer_store_dword v32, off, s[4:7], s27 sc1
    s_mov_b64 exec, -1
    s_endpgm
cf_dma:
    s_xor_b32 s74, s76, s81
    s_add_u32 m0, s74, s80
    s_add_u32 s76, s76, 4096
    buffer_load_dwordx4 v58, s[8:11], s78 offen lds
    s_add_u32 s78, s78, s79
    s_cmp_lt_u32 s76, s77
    s_cbranch_scc1 cf_dma
    s_setpc_b64 s[82:83]
L_chain_safe:
    s_mov_b64 s[48:49], s[50:51]
    s_mov_b64 s[50:51], s[52:53]
    s_mov_b64 s[52:53], s[54:55]
    s_mov_b64 s[54:55], s[56:57]
    s_mov_b64 s[56:57], s[58:59]
    v_lshrrev_b32 v54, 6, v0
    s_nop 0
    v_readfirstlane_b32 s13, v54
    v_and_b32 v57, 63, v0
    v_bfe_u32 v54, v57, 2, 1
    v_lshlrev_b32 v48, 13, v54
    v_bfe_u32 v54, v57, 3, 1
    v_lshl_add_u32 v48, v54, 15, v48
    v_bfe_u32 v54, v57, 4, 1
    v_lshl_add_u32 v48, v54, 14, v48
    v_bfe_u32 v54, v57, 5, 1
    v_lshl_add_u32 v48, v54, 16, v48
    v_lshrrev_b32 v55, 4, v57
    v_and_b32 v55, 2, v55
    v_xor_b32 v55, v55, v57
    v_and_b32 v55, 3, v55
    v_lshl_add_u32 v48, v55, 4, v48
    v_bfe_u32 v54, v57, 2, 1
    v_lshlrev_b32 v51, 6, v54
    v_bfe_u32 v54, v57, 3, 1
    v_lshl_add_u32 v51, v54, 9, v51
    v_bfe_u32 v54, v57, 4, 1
    v_lshl_add_u32 v51, v54, 7, v51
    v_bfe_u32 v54, v57, 5, 1
    v_lshl_add_u32 v51, v54, 12, v51
    v_bfe_u32 v54, v57, 0, 1
    v_lshl_add_u32 v51, v54, 3, v51
    v_bfe_u32 v54, v57, 1, 1
    v_lshl_add_u32 v51, v54, 4, v51
    v_bfe_u32 v54, v57, 3, 1
    v_lshl_add_u32 v51, v54, 5, v51
    v_lshrrev_b32 v55, 3, v57
    v_mul_u32_u24 v49, 1152, v55
    v_and_b32 v55, 7, v57
    v_lshl_add_u32 v49, v55, 4, v49
    v_bfe_u32 v54, v57, 4, 1
    v_lshlrev_b32 v52, 13, v54
    v_bfe_u32 v54, v57, 5, 1
    v_lshl_add_u32 v52, v54, 9, v52
    v_bfe_u32 v54, v57, 2, 1
    v_lshl_add_u32 v52, v54, 7, v52
    v_bfe_u32 v54, v57, 3, 1
    v_lshl_add_u32 v52, v54, 5, v52
    v_and_b32 v55, 3, v57
    v_lshl_add_u32 v52, v55, 3, v52
    v_lshrrev_b32 v55, 2, v57
    v_mul_u32_u24 v50, 1152, v55
    v_and_b32 v55, 3, v57
    v_lshl_add_u32 v50, v55, 4, v50
    v_bfe_u32 v54, v57, 4, 1
    v_lshlrev_b32 v53, 12, v54
    v_bfe_u32 v54, v57, 5, 1
    v_lshl_add_u32 v53, v54, 8, v53
    v_bfe_u32 v54, v57, 2, 1
    v_lshl_add_u32 v53, v54, 6, v53
    v_bfe_u32 v54, v57, 3, 1
    v_lshl_add_u32 v53, v54, 5, v53
    v_and_b32 v55, 3, v57
    v_lshl_add_u32 v53, v55, 3, v53
    s_lshl_b32 s66, s13, 10
    s_and_b32 s93, s13, 1
    s_lshl_b32 s93, s93, 14
    s_and_b32 s75, s13, 2
    s_lshl_b32 s75, s75, 19
    v_add_u32 v51, s66, v51
    v_add_u32 v52, s66, v52
    v_add_u32 v53, s66, v53
    v_mov_b32 v58, v48
    s_mov_b32 s10, 4718592
    s_mov_b32 s11, 0x20000
    s_lshl_b32 s67, s12, 8
    s_lshl_b32 s40, s13, 6
    s_add_u32 s67, s67, s40
    s_mul_i32 s92, s12, 147456
    s_lshr_b32 s73, s50, 8
    s_add_u32 s73, s73, s12
    s_and_b32 s73, s73, 31
    s_bitcmp1_b32 0xa2222222, s73
    s_cselect_b32 s88, 0, 0
    s_mov_b32 s72, 0
    s_add_u32 s73, s73, 1
    s_lshr_b32 s73, s73, 2
    s_xor_b32 s94, s13, 0
    s_mul_i32 s94, s94, 36864
    s_add_u32 s94, s94, s92
    s_lshl_b32 s74, s13, 7
    s_add_u32 s94, s94, s74
    s_add_u32 s78, s94, 0
    s_mov_b64 s[8:9], s[56:57]
    v_mov_b32 v58, v49
    s_mov_b32 s79, 9216
    s_mov_b32 s81, 0
    s_add_u32 s80, s66, 114688
    s_mov_b32 s76, 0
    s_mov_b32 s77, 8192
    s_call_b64 s[82:83], cs_dma
    s_mov_b32 s77, 16384
    s_call_b64 s[82:83], cs_dma
    s_xor_b32 s94, s13, 1
    s_mul_i32 s94, s94, 36864
    s_add_u32 s94, s94, s92
    s_lshl_b32 s74, s13, 7
    s_add_u32 s94, s94, s74
    s_add_u32 s78, s94, 0
    s_add_u32 s80, s66, 81920
    s_mov_b32 s76, 0
    s_mov_b32 s77, 8192
    s_call_b64 s[82:83], cs_dma
    s_mov_b32 s77, 16384
    s_call_b64 s[82:83], cs_dma
    s_xor_b32 s94, s13, 2
    s_mul_i32 s94, s94, 36864
    s_add_u32 s94, s94, s92
    s_lshl_b32 s74, s13, 7
    s_add_u32 s94, s94, s74
    s_add_u32 s78, s94, 0
    s_add_u32 s80, s66, 16384
    s_mov_b32 s76, 0
    s_mov_b32 s77, 8192
    s_call_b64 s[82:83], cs_dma
    v_lshrrev_b32 v24, 6, v0
    v_lshlrev_b32 v61, 4, v0
    v_add_u32 v62, 57344, v61
    v_xor_b32 v63, 1024, v61
    v_add_u32 v63, 98304, v63
    v_xor_b32 v64, 2048, v61
    v_add_u32 v64, 98304, v64
    v_and_b32 v65, 1023, v61
    v_add_u32 v65, 98304, v65
    v_and_b32 v26, 15, v0
    v_bfe_u32 v27, v0, 4, 2
    v_mov_b32 v60, 0x4444
    v_mov_b32 v25, 0xeeee
    v_cmp_lt_u32 vcc, 7, v26
    s_nop 1
    v_cndmask_b32 v60, v60, v25, vcc
    s_mov_b32 s77, 16384
    s_call_b64 s[82:83], cs_dma
    v_and_b32 v67, 12, v26
    v_lshlrev_b32 v67, 3, v67
    v_and_b32 v25, 1, v26
    v_lshl_add_u32 v67, v25, 4, v67
    v_bfe_u32 v25, v26, 1, 1
    v_lshl_add_u32 v67, v25, 3, v67
    v_lshl_add_u32 v66, v27, 14, v67
    v_lshl_add_u32 v66, v24, 17, v66
    s_xor_b32 s94, s13, 3
    s_mul_i32 s94, s94, 36864
    s_add_u32 s94, s94, s92
    s_lshl_b32 s74, s13, 7
    s_add_u32 s94, s94, s74
    s_add_u32 s78, s94, 0
    s_add_u32 s80, s66, 0
    s_mov_b32 s76, 0
    s_mov_b32 s77, 8192
    s_call_b64 s[82:83], cs_dma
    v_and_b32 v67, 63, v67
    v_lshrrev_b32 v25, 1, v24
    v_lshl_add_u32 v67, v25, 18, v67
    v_lshl_add_u32 v67, v27, 16, v67
    v_lshrrev_b32 v25, 3, v26
    v_lshl_add_u32 v67, v25, 15, v67
    v_and_b32 v25, 1, v24
    v_lshl_add_u32 v67, v25, 6, v67
    s_mov_b32 s77, 16384
    s_call_b64 s[82:83], cs_dma
    v_and_b32 v25, 31, v0
    v_lshlrev_b32 v70, 4, v25
    v_lshlrev_b32 v28, 3, v25
    v_lshl_add_u32 v28, v24, 10, v28
    v_add_u32 v28, 110592, v28
    v_lshrrev_b32 v25, 1, v24
    v_lshl_add_u32 v70, v25, 9, v70
    v_and_b32 v25, 1, v24
    v_lshl_add_u32 v70, v25, 3, v70
    v_add_u32 v70, 109568, v70
    v_cmp_gt_u32 vcc, 2, v27
    s_nop 1
    v_cndmask_b32 v70, v70, v28, vcc
    v_xor_b32 v71, 2048, v63
    v_lshrrev_b32 v68, 4, v0
    v_lshlrev_b32 v68, 7, v68
    v_and_b32 v25, 7, v26
    v_lshl_add_u32 v68, v25, 4, v68
    v_add_u32 v68, 98304, v68
    v_xor_b32 v74, 512, v68
    v_xor_b32 v75, 1024, v68
    v_xor_b32 v76, 1536, v68
    v_lshrrev_b32 v25, 3, v26
    v_lshl_add_u32 v77, v25, 3, v68
    v_or_b32 v78, 512, v65
    v_lshlrev_b32 v79, 2, v61
    v_mov_b64 v[72:73], 0
    v_and_b32 v25, 1, v27
    v_lshlrev_b32 v69, 7, v25
    v_lshrrev_b32 v25, 1, v27
    v_lshl_add_u32 v69, v25, 3, v69
    v_and_b32 v25, 3, v26
    v_lshl_add_u32 v69, v25, 4, v69
    v_bfe_u32 v25, v26, 2, 1
    v_lshl_add_u32 v69, v25, 2, v69
    s_mov_b32 s32, 0x00ff00ff
    s_mov_b32 s33, 0x00ff00ff
    s_not_b64 s[34:35], s[32:33]
    s_lshr_b32 s31, s12, 1
    s_lshl_b32 s31, s31, 8
    s_and_b32 s40, s12, 1
    s_lshl_b32 s40, s40, 6
    s_add_u32 s31, s31, s40
    s_and_b32 s40, s13, 1
    s_lshl_b32 s40, s40, 12
    s_add_u32 s31, s31, s40
    s_lshl_b32 s19, s12, 14
    s_add_u32 s19, s19, 68124672
    s_add_u32 s41, s19, 8192
    s_add_u32 s19, s19, s40
    s_and_b32 s40, s12, 1
    s_lshl_b32 s40, s40, 2
    s_or_b32 s40, s40, s13
    s_cmp_eq_u32 s40, 5
    s_cselect_b32 s64, 0, s13
    s_cmp_lg_u32 s13, 1
    s_cbranch_scc1 cs_notx
    s_mov_b32 s32, 0xff
    s_mov_b32 s33, 0xff
    s_mov_b32 s19, s41
    s_lshr_b32 s31, s12, 3
    s_lshl_b32 s31, s31, 8
    s_and_b32 s40, s12, 2
    s_lshl_b32 s40, s40, 6
    s_add_u32 s31, s31, s40
    s_and_b32 s40, s12, 4
    s_lshl_b32 s40, s40, 4
    s_add_u32 s31, s31, s40
    s_add_u32 s31, s31, 8192
cs_notx:
    s_cmp_lg_u32 s13, 0
    s_cbranch_scc1 cs_notp
    s_min_u32 s40, s12, 23
    s_mul_i32 s40, s40, 384
    s_add_u32 s40, s40, 98304
    v_add_u32 v69, s40, v61
    v_mov_b32 v25, 108288
    v_cmp_lt_u32 vcc, 23, v0
    s_nop 1
    v_cndmask_b32 v69, v69, v25, vcc
cs_notp:
    s_nop 1
    v_mov_b32 v28, 1
    v_mov_b32 v29, 1
    v_mov_b32 v30, 1
    v_mov_b32 v31, 1
    s_lshl_b32 s40, s12, 14
    s_add_u32 s40, s40, 68222976
    s_add_u32 s41, s40, 0
    buffer_store_dwordx4 v[28:31], v61, s[4:7], s41 offen sc1
    s_add_u32 s41, s40, 4096
    buffer_store_dwordx4 v[28:31], v61, s[4:7], s41 offen sc1
    s_add_u32 s41, s40, 8192
    buffer_store_dwordx4 v[28:31], v61, s[4:7], s41 offen sc1
    s_cmp_eq_u32 s64, 0
    s_cselect_b64 exec, 0, s[32:33]
    v_mov_b32 v27, -1
    s_add_u32 s41, s31, 68157440
    buffer_store_dword v27, v69, s[4:7], s41 offen sc1
    s_add_u32 s41, s31, 68173824
    buffer_store_dword v27, v69, s[4:7], s41 offen sc1
    s_add_u32 s41, s31, 68190208
    buffer_store_dword v27, v69, s[4:7], s41 offen sc1
    s_add_u32 s41, s31, 68206592
    buffer_store_dword v27, v69, s[4:7], s41 offen sc1
    s_mov_b64 exec, -1
    s_mov_b64 s[68:69], s[48:49]
    s_mov_b32 s70, 9216
    s_mov_b32 s71, 0x20000
    v_and_b32 v25, 7, v0
    v_mul_u32_u24 v25, 1152, v25
    v_lshrrev_b32 v26, 3, v0
    v_lshl_add_u32 v25, v26, 4, v25
    buffer_load_dwordx4 v[36:39], v25, s[68:71], 0 offen
    buffer_load_dwordx4 v[40:43], v25, s[68:71], 0 offen offset:512
    v_bfe_u32 v25, v0, 2, 3
    v_mul_u32_u24 v25, 1152, v25
    v_lshrrev_b32 v26, 5, v0
    v_lshl_add_u32 v25, v26, 4, v25
    v_and_b32 v26, 3, v0
    v_lshl_add_u32 v25, v26, 2, v25
    buffer_load_dword v44, v25, s[68:71], 0 offen offset:1024
    s_waitcnt vmcnt(15)
    v_add_u32 v55, 114688, v52
    ds_read_b64_tr_b16 v[160:161], v55 offset:0
    ds_read_b64_tr_b16 v[162:163], v55 offset:256
    ds_read_b64_tr_b16 v[164:165], v55 offset:4096
    ds_read_b64_tr_b16 v[166:167], v55 offset:4352
    s_xor_b32 s94, s13, 0
    s_mul_i32 s94, s94, 36864
    s_add_u32 s94, s94, s92
    s_lshl_b32 s74, s13, 7
    s_add_u32 s94, s94, s74
    s_add_u32 s78, s94, 512
    s_add_u32 s80, s66, 147456
    s_mov_b32 s76, 0
    s_mov_b32 s77, 8192
    s_call_b64 s[82:83], cs_dma
    ds_read_b64_tr_b16 v[192:193], v55 offset:64
    ds_read_b64_tr_b16 v[194:195], v55 offset:320
    ds_read_b64_tr_b16 v[196:197], v55 offset:4160
    ds_read_b64_tr_b16 v[198:199], v55 offset:4416
    s_mov_b32 s77, 16384
    s_call_b64 s[82:83], cs_dma
    s_waitcnt lgkmcnt(0)
    s_waitcnt vmcnt(15)
    v_add_u32 v55, 81920, v52
    ds_read_b64_tr_b16 v[168:169], v55 offset:0
    ds_read_b64_tr_b16 v[170:171], v55 offset:256
    ds_read_b64_tr_b16 v[172:173], v55 offset:4096
    ds_read_b64_tr_b16 v[174:175], v55 offset:4352
    s_xor_b32 s94, s13, 1
    s_mul_i32 s94, s94, 36864
    s_add_u32 s94, s94, s92
    s_lshl_b32 s74, s13, 7
    s_add_u32 s94, s94, s74
    s_add_u32 s78, s94, 512
    s_add_u32 s80, s66, 98304
    s_mov_b32 s76, 0
    s_mov_b32 s77, 8192
    s_call_b64 s[82:83], cs_dma
    ds_read_b64_tr_b16 v[200:201], v55 offset:64
    ds_read_b64_tr_b16 v[202:203], v55 offset:320
    ds_read_b64_tr_b16 v[204:205], v55 offset:4160
    ds_read_b64_tr_b16 v[206:207], v55 offset:4416
    s_mov_b32 s77, 16384
    s_call_b64 s[82:83], cs_dma
    s_waitcnt lgkmcnt(0)
    s_waitcnt vmcnt(15)
    v_add_u32 v55, 16384, v52
    ds_read_b64_tr_b16 v[176:177], v55 offset:0
    ds_read_b64_tr_b16 v[178:179], v55 offset:256
    ds_read_b64_tr_b16 v[180:181], v55 offset:4096
    ds_read_b64_tr_b16 v[182:183], v55 offset:4352
    s_add_u32 s78, s67, 4194304
    s_mov_b64 s[8:9], s[54:55]
    v_mov_b32 v58, v48
    s_mov_b32 s79, 131072
    s_add_u32 s80, s66, 32768
    s_mov_b32 s76, 0
    s_mov_b32 s77, 8192
    s_call_b64 s[82:83], cs_dma
    ds_read_b64_tr_b16 v[208:209], v55 offset:64
    ds_read_b64_tr_b16 v[210:211], v55 offset:320
    ds_read_b64_tr_b16 v[212:213], v55 offset:4160
    ds_read_b64_tr_b16 v[214:215], v55 offset:4416
    s_mov_b32 s77, 16384
    s_call_b64 s[82:83], cs_dma
    s_waitcnt lgkmcnt(0)
    s_waitcnt vmcnt(15)
    v_add_u32 v55, 0, v52
    ds_read_b64_tr_b16 v[184:185], v55 offset:0
    ds_read_b64_tr_b16 v[186:187], v55 offset:256
    ds_read_b64_tr_b16 v[188:189], v55 offset:4096
    ds_read_b64_tr_b16 v[190:191], v55 offset:4352
    s_xor_b32 s78, s75, 0
    s_add_u32 s78, s78, s67
    s_mov_b32 s81, s93
    s_add_u32 s80, s66, 114688
    s_mov_b32 s76, 0
    s_mov_b32 s77, 8192
    s_call_b64 s[82:83], cs_dma
    ds_read_b64_tr_b16 v[216:217], v55 offset:64
    ds_read_b64_tr_b16 v[218:219], v55 offset:320
    ds_read_b64_tr_b16 v[220:221], v55 offset:4160
    ds_read_b64_tr_b16 v[222:223], v55 offset:4416
    s_mov_b32 s77, 16384
    s_call_b64 s[82:83], cs_dma
    s_waitcnt lgkmcnt(0)
    s_waitcnt vmcnt(12)
    v_add_u32 v55, 147456, v52
    ds_read_b64_tr_b16 v[224:225], v55 offset:0
    ds_read_b64_tr_b16 v[226:227], v55 offset:256
    ds_read_b64_tr_b16 v[228:229], v55 offset:4096
    ds_read_b64_tr_b16 v[230:231], v55 offset:4352
    s_mov_b32 s77, 24576
    s_call_b64 s[82:83], cs_dma
    ds_read_b64_tr_b16 v[240:241], v55 offset:64
    ds_read_b64_tr_b16 v[242:243], v55 offset:320
    ds_read_b64_tr_b16 v[244:245], v55 offset:4160
    ds_read_b64_tr_b16 v[246:247], v55 offset:4416
    s_mov_b32 s77, 32768
    s_call_b64 s[82:83], cs_dma
    s_waitcnt lgkmcnt(0)
    v_min_u32 v36, -2, v36
    v_min_u32 v37, -2, v37
    v_min_u32 v38, -2, v38
    v_min_u32 v39, -2, v39
    v_min_u32 v40, -2, v40
    v_min_u32 v41, -2, v41
    v_min_u32 v42, -2, v42
    v_min_u32 v43, -2, v43
    v_min_u32 v44, -2, v44
    s_lshl_b32 s14, s12, 16
    s_add_u32 s14, s14, 92274688
    s_add_u32 s41, s14, 4096
    s_add_u32 s42, s14, 8192
    v_lshrrev_b32 v45, 2, v61
    buffer_store_dwordx4 v[36:39], v61, s[4:7], s14 offen sc1
    buffer_store_dwordx4 v[40:43], v61, s[4:7], s41 offen sc1
    buffer_store_dword v44, v45, s[4:7], s42 offen sc1
    v_mov_b32 v46, 1
    s_mov_b64 exec, 1
    buffer_atomic_add v46, off, s[96:99], 0 offset:212 sc0
    s_mov_b64 exec, -1
    s_mov_b32 s44, 0x3e0293ee
    s_mov_b32 s45, s44
    s_mov_b32 s46, 0x42000000
    s_mov_b32 s60, 0x3f803f80
    s_mov_b32 s61, s60
    s_mov_b32 s62, 0x3e803e80
    s_mov_b32 s63, s62
    s_mov_b32 s28, 0
    s_lshl_b32 s24, s12, 14
    s_add_u32 s24, s24, 0
    s_add_u32 s47, s24, 33030144
    s_mul_i32 s40, s13, 3072
    s_add_u32 s23, s24, s40
    s_lshl_b32 s20, s12, 7
    s_add_u32 s20, s20, 68222976
    s_add_u32 s21, s20, 65536
    s_add_u32 s38, s20, 4096
    s_add_u32 s39, s21, 4096
    s_lshl_b32 s22, s12, 7
    s_add_u32 s22, s22, 68231168
    s_lshl_b32 s40, s12, 12
    s_add_u32 s25, s40, 79429632
    s_add_u32 s26, s40, 88866816
    s_lshl_b32 s65, s12, 9
    s_add_u32 s65, s65, 90177536
    s_lshl_b32 s40, s13, 5
    s_or_b32 s40, s40, s12
    s_cmp_lt_u32 s40, 24
    s_cselect_b32 s36, 0x1ffffff, 0
    s_mov_b32 s37, 0
    s_lshl_b32 s27, s12, 7
    s_add_u32 s27, s27, 125845504
    s_lshl_b32 s40, s13, 2
    s_add_u32 s27, s27, s40
    v_bfe_u32 v24, v61, 4, 4
    v_bfe_u32 v25, v61, 8, 1
    v_lshlrev_b32 v25, 2, v25
    v_sub_u32 v25, v24, v25
    v_mov_b32 v26, 0x3f80
    v_mov_b32 v27, 0x3f800000
    v_cmp_eq_u32 vcc, 0, v25
    s_nop 1
    v_cndmask_b32 v16, 0, v26, vcc
    v_cmp_eq_u32 vcc, 1, v25
    s_nop 1
    v_cndmask_b32 v16, v16, v27, vcc
    v_cmp_eq_u32 vcc, 0, v24
    s_nop 1
    v_cndmask_b32 v20, 0, v26, vcc
    v_cmp_eq_u32 vcc, 1, v24
    s_nop 1
    v_cndmask_b32 v20, v20, v27, vcc
    v_cmp_eq_u32 vcc, 2, v25
    s_nop 1
    v_cndmask_b32 v17, 0, v26, vcc
    v_cmp_eq_u32 vcc, 3, v25
    s_nop 1
    v_cndmask_b32 v17, v17, v27, vcc
    v_cmp_eq_u32 vcc, 2, v24
    s_nop 1
    v_cndmask_b32 v21, 0, v26, vcc
    v_cmp_eq_u32 vcc, 3, v24
    s_nop 1
    v_cndmask_b32 v21, v21, v27, vcc
    v_cmp_eq_u32 vcc, 8, v25
    s_nop 1
    v_cndmask_b32 v18, 0, v26, vcc
    v_cmp_eq_u32 vcc, 9, v25
    s_nop 1
    v_cndmask_b32 v18, v18, v27, vcc
    v_cmp_eq_u32 vcc, 4, v24
    s_nop 1
    v_cndmask_b32 v22, 0, v26, vcc
    v_cmp_eq_u32 vcc, 5, v24
    s_nop 1
    v_cndmask_b32 v22, v22, v27, vcc
    v_cmp_eq_u32 vcc, 10, v25
    s_nop 1
    v_cndmask_b32 v19, 0, v26, vcc
    v_cmp_eq_u32 vcc, 11, v25
    s_nop 1
    v_cndmask_b32 v19, v19, v27, vcc
    v_cmp_eq_u32 vcc, 6, v24
    s_nop 1
    v_cndmask_b32 v23, 0, v26, vcc
    v_cmp_eq_u32 vcc, 7, v24
    s_nop 1
    v_cndmask_b32 v23, v23, v27, vcc
    s_waitcnt vmcnt(13)
    v_add_u32 v55, 98304, v52
    ds_read_b64_tr_b16 v[232:233], v55 offset:0
    ds_read_b64_tr_b16 v[234:235], v55 offset:256
    ds_read_b64_tr_b16 v[236:237], v55 offset:4096
    ds_read_b64_tr_b16 v[238:239], v55 offset:4352
    s_xor_b32 s78, s75, 1048576
    s_add_u32 s78, s78, s67
    s_add_u32 s80, s66, 65536
    s_mov_b32 s76, 0
    s_mov_b32 s77, 8192
    s_call_b64 s[82:83], cs_dma
    ds_read_b64_tr_b16 v[248:249], v55 offset:64
    ds_read_b64_tr_b16 v[250:251], v55 offset:320
    ds_read_b64_tr_b16 v[252:253], v55 offset:4160
    ds_read_b64_tr_b16 v[254:255], v55 offset:4416
    s_mov_b32 s77, 16384
    s_call_b64 s[82:83], cs_dma
    s_waitcnt lgkmcnt(0)
    s_waitcnt vmcnt(13)
    v_add_u32 v55, 32768, v51
    v_xor_b32 v56, 32, v55
    ds_read_b64_tr_b16 v[144:145], v55 offset:0
    ds_read_b64_tr_b16 v[146:147], v55 offset:256
    ds_read_b64_tr_b16 v[148:149], v55 offset:8192
    ds_read_b64_tr_b16 v[150:151], v55 offset:8448
    s_mov_b32 s77, 24576
    s_call_b64 s[82:83], cs_dma
    ds_read_b64_tr_b16 v[152:153], v56 offset:0
    ds_read_b64_tr_b16 v[154:155], v56 offset:256
    ds_read_b64_tr_b16 v[156:157], v56 offset:8192
    ds_read_b64_tr_b16 v[158:159], v56 offset:8448
    s_mov_b32 s77, 32768
    s_call_b64 s[82:83], cs_dma
    s_waitcnt lgkmcnt(0)
    s_waitcnt vmcnt(9)
    v_add_u32 v55, 114688, v51
    v_xor_b32 v56, 32, v55
    ds_read_b64_tr_b16 a[192:193], v55 offset:0
    ds_read_b64_tr_b16 a[194:195], v55 offset:256
    ds_read_b64_tr_b16 a[196:197], v55 offset:8192
    ds_read_b64_tr_b16 a[198:199], v55 offset:8448
    s_xor_b32 s78, s75, 2097152
    s_add_u32 s78, s78, s67
    s_add_u32 s80, s66, 0
    s_mov_b32 s76, 0
    s_mov_b32 s77, 8192
    s_call_b64 s[82:83], cs_dma
    ds_read_b64_tr_b16 a[200:201], v56 offset:0
    ds_read_b64_tr_b16 a[202:203], v56 offset:256
    ds_read_b64_tr_b16 a[204:205], v56 offset:8192
    ds_read_b64_tr_b16 a[206:207], v56 offset:8448
    s_mov_b32 s77, 16384
    s_call_b64 s[82:83], cs_dma
    s_waitcnt lgkmcnt(0)
    v_add_u32 v55, 131072, v51
    v_xor_b32 v56, 32, v55
    ds_read_b64_tr_b16 a[208:209], v55 offset:0
    ds_read_b64_tr_b16 a[210:211], v55 offset:256
    ds_read_b64_tr_b16 a[212:213], v55 offset:8192
    ds_read_b64_tr_b16 a[214:215], v55 offset:8448
    s_mov_b32 s77, 24576
    s_call_b64 s[82:83], cs_dma
    ds_read_b64_tr_b16 a[216:217], v56 offset:0
    ds_read_b64_tr_b16 a[218:219], v56 offset:256
    ds_read_b64_tr_b16 a[220:221], v56 offset:8192
    ds_read_b64_tr_b16 a[222:223], v56 offset:8448
    s_mov_b32 s77, 32768
    s_call_b64 s[82:83], cs_dma
    s_waitcnt lgkmcnt(0)
    s_waitcnt vmcnt(8)
    v_add_u32 v55, 65536, v51
    v_xor_b32 v56, 32, v55
    ds_read_b64_tr_b16 a[224:225], v55 offset:0
    ds_read_b64_tr_b16 a[226:227], v55 offset:256
    ds_read_b64_tr_b16 a[228:229], v55 offset:8192
    ds_read_b64_tr_b16 a[230:231], v55 offset:8448
    s_xor_b32 s78, s75, 3145728
    s_add_u32 s78, s78, s67
    s_add_u32 s80, s66, 32768
    s_mov_b32 s76, 0
    s_mov_b32 s77, 8192
    s_call_b64 s[82:83], cs_dma
    ds_read_b64_tr_b16 a[232:233], v56 offset:0
    ds_read_b64_tr_b16 a[234:235], v56 offset:256
    ds_read_b64_tr_b16 a[236:237], v56 offset:8192
    ds_read_b64_tr_b16 a[238:239], v56 offset:8448
    s_mov_b32 s77, 16384
    s_call_b64 s[82:83], cs_dma
    s_waitcnt lgkmcnt(0)
    v_add_u32 v55, 81920, v51
    v_xor_b32 v56, 32, v55
    ds_read_b64_tr_b16 a[240:241], v55 offset:0
    ds_read_b64_tr_b16 a[242:243], v55 offset:256
    ds_read_b64_tr_b16 a[244:245], v55 offset:8192
    ds_read_b64_tr_b16 a[246:247], v55 offset:8448
    s_mov_b32 s77, 24576
    s_call_b64 s[82:83], cs_dma
    ds_read_b64_tr_b16 a[248:249], v56 offset:0
    ds_read_b64_tr_b16 a[250:251], v56 offset:256
    ds_read_b64_tr_b16 a[252:253], v56 offset:8192
    ds_read_b64_tr_b16 a[254:255], v56 offset:8448
    s_mov_b32 s77, 32768
    s_call_b64 s[82:83], cs_dma
    s_waitcnt lgkmcnt(0)
    v_readfirstlane_b32 s41, v46
    v_mov_b32 v36, 1
    v_mov_b32 v37, 0
    s_cmp_eq_u32 s41, 127
    s_cselect_b64 exec, 1, 0
    buffer_atomic_cmpswap v[36:37], off, s[96:99], 0 offset:216
    s_mov_b64 exec, -1
    s_waitcnt vmcnt(8)
    v_add_u32 v55, 0, v51
    v_xor_b32 v56, 32, v55
    ds_read_b64_tr_b16 v[80:81], v55 offset:0
    ds_read_b64_tr_b16 v[82:83], v55 offset:256
    ds_read_b64_tr_b16 v[84:85], v55 offset:8192
    ds_read_b64_tr_b16 v[86:87], v55 offset:8448
    s_xor_b32 s78, s75, 2097152
    s_add_u32 s78, s78, s67
    s_mov_b64 s[8:9], s[52:53]
    s_add_u32 s80, s66, 131072
    s_mov_b32 s76, 0
    s_mov_b32 s77, 8192
    s_call_b64 s[82:83], cs_dma
    ds_read_b64_tr_b16 v[88:89], v56 offset:0
    ds_read_b64_tr_b16 v[90:91], v56 offset:256
    ds_read_b64_tr_b16 v[92:93], v56 offset:8192
    ds_read_b64_tr_b16 v[94:95], v56 offset:8448
    s_mov_b32 s77, 16384
    s_call_b64 s[82:83], cs_dma
    s_waitcnt lgkmcnt(0)
    v_add_u32 v55, 16384, v51
    v_xor_b32 v56, 32, v55
    ds_read_b64_tr_b16 v[96:97], v55 offset:0
    ds_read_b64_tr_b16 v[98:99], v55 offset:256
    ds_read_b64_tr_b16 v[100:101], v55 offset:8192
    ds_read_b64_tr_b16 v[102:103], v55 offset:8448
    s_mov_b32 s77, 24576
    s_call_b64 s[82:83], cs_dma
    ds_read_b64_tr_b16 v[104:105], v56 offset:0
    ds_read_b64_tr_b16 v[106:107], v56 offset:256
    ds_read_b64_tr_b16 v[108:109], v56 offset:8192
    ds_read_b64_tr_b16 v[110:111], v56 offset:8448
    s_mov_b32 s77, 32768
    s_call_b64 s[82:83], cs_dma
    s_waitcnt lgkmcnt(0)
    s_waitcnt vmcnt(8)
    v_add_u32 v55, 32768, v51
    v_xor_b32 v56, 32, v55
    ds_read_b64_tr_b16 v[112:113], v55 offset:0
    ds_read_b64_tr_b16 v[114:115], v55 offset:256
    ds_read_b64_tr_b16 v[116:117], v55 offset:8192
    ds_read_b64_tr_b16 v[118:119], v55 offset:8448
    s_xor_b32 s78, s75, 3145728
    s_add_u32 s78, s78, s67
    s_add_u32 s80, s66, 65536
    s_mov_b32 s76, 0
    s_mov_b32 s77, 8192
    s_call_b64 s[82:83], cs_dma
    ds_read_b64_tr_b16 v[120:121], v56 offset:0
    ds_read_b64_tr_b16 v[122:123], v56 offset:256
    ds_read_b64_tr_b16 v[124:125], v56 offset:8192
    ds_read_b64_tr_b16 v[126:127], v56 offset:8448
    s_mov_b32 s77, 16384
    s_call_b64 s[82:83], cs_dma
    s_waitcnt lgkmcnt(0)
    v_add_u32 v55, 49152, v51
    v_xor_b32 v56, 32, v55
    ds_read_b64_tr_b16 v[128:129], v55 offset:0
    ds_read_b64_tr_b16 v[130:131], v55 offset:256
    ds_read_b64_tr_b16 v[132:133], v55 offset:8192
    ds_read_b64_tr_b16 v[134:135], v55 offset:8448
    s_mov_b32 s77, 24576
    s_call_b64 s[82:83], cs_dma
    ds_read_b64_tr_b16 v[136:137], v56 offset:0
    ds_read_b64_tr_b16 v[138:139], v56 offset:256
    ds_read_b64_tr_b16 v[140:141], v56 offset:8192
    ds_read_b64_tr_b16 v[142:143], v56 offset:8448
    s_mov_b32 s77, 32768
    s_call_b64 s[82:83], cs_dma
    s_waitcnt lgkmcnt(0)
    s_waitcnt vmcnt(8)
    v_add_u32 v55, 131072, v51
    v_xor_b32 v56, 32, v55
    ds_read_b64_tr_b16 a[128:129], v55 offset:0
    ds_read_b64_tr_b16 a[130:131], v55 offset:256
    ds_read_b64_tr_b16 a[132:133], v55 offset:8192
    ds_read_b64_tr_b16 a[134:135], v55 offset:8448
    s_xor_b32 s78, s75, 2097152
    s_add_u32 s78, s78, s67
    s_mov_b64 s[8:9], s[50:51]
    s_add_u32 s80, s66, 0
    s_mov_b32 s76, 0
    s_mov_b32 s77, 8192
    s_call_b64 s[82:83], cs_dma
    ds_read_b64_tr_b16 a[136:137], v56 offset:0
    ds_read_b64_tr_b16 a[138:139], v56 offset:256
    ds_read_b64_tr_b16 a[140:141], v56 offset:8192
    ds_read_b64_tr_b16 a[142:143], v56 offset:8448
    s_mov_b32 s77, 16384
    s_call_b64 s[82:83], cs_dma
    s_waitcnt lgkmcnt(0)
    v_add_u32 v55, 147456, v51
    v_xor_b32 v56, 32, v55
    ds_read_b64_tr_b16 a[144:145], v55 offset:0
    ds_read_b64_tr_b16 a[146:147], v55 offset:256
    ds_read_b64_tr_b16 a[148:149], v55 offset:8192
    ds_read_b64_tr_b16 a[150:151], v55 offset:8448
    s_mov_b32 s77, 24576
    s_call_b64 s[82:83], cs_dma
    ds_read_b64_tr_b16 a[152:153], v56 offset:0
    ds_read_b64_tr_b16 a[154:155], v56 offset:256
    ds_read_b64_tr_b16 a[156:157], v56 offset:8192
    ds_read_b64_tr_b16 a[158:159], v56 offset:8448
    s_mov_b32 s77, 32768
    s_call_b64 s[82:83], cs_dma
    s_waitcnt lgkmcnt(0)
    s_waitcnt vmcnt(8)
    v_add_u32 v55, 65536, v51
    v_xor_b32 v56, 32, v55
    ds_read_b64_tr_b16 a[160:161], v55 offset:0
    ds_read_b64_tr_b16 a[162:163], v55 offset:256
    ds_read_b64_tr_b16 a[164:165], v55 offset:8192
    ds_read_b64_tr_b16 a[166:167], v55 offset:8448
    s_xor_b32 s78, s75, 3145728
    s_add_u32 s78, s78, s67
    s_add_u32 s80, s66, 32768
    s_mov_b32 s76, 0
    s_mov_b32 s77, 8192
    s_call_b64 s[82:83], cs_dma
    ds_read_b64_tr_b16 a[168:169], v56 offset:0
    ds_read_b64_tr_b16 a[170:171], v56 offset:256
    ds_read_b64_tr_b16 a[172:173], v56 offset:8192
    ds_read_b64_tr_b16 a[174:175], v56 offset:8448
    s_mov_b32 s77, 16384
    s_call_b64 s[82:83], cs_dma
    s_waitcnt lgkmcnt(0)
    v_add_u32 v55, 81920, v51
    v_xor_b32 v56, 32, v55
    ds_read_b64_tr_b16 a[176:177], v55 offset:0
    ds_read_b64_tr_b16 a[178:179], v55 offset:256
    ds_read_b64_tr_b16 a[180:181], v55 offset:8192
    ds_read_b64_tr_b16 a[182:183], v55 offset:8448
    s_mov_b32 s77, 24576
    s_call_b64 s[82:83], cs_dma
    ds_read_b64_tr_b16 a[184:185], v56 offset:0
    ds_read_b64_tr_b16 a[186:187], v56 offset:256
    ds_read_b64_tr_b16 a[188:189], v56 offset:8192
    ds_read_b64_tr_b16 a[190:191], v56 offset:8448
    s_mov_b32 s77, 32768
    s_call_b64 s[82:83], cs_dma
    s_waitcnt lgkmcnt(0)
    s_waitcnt vmcnt(8)
    v_add_u32 v55, 0, v51
    v_xor_b32 v56, 32, v55
    ds_read_b64_tr_b16 a[48:49], v55 offset:0
    ds_read_b64_tr_b16 a[50:51], v55 offset:256
    ds_read_b64_tr_b16 a[52:53], v55 offset:8192
    ds_read_b64_tr_b16 a[54:55], v55 offset:8448
    s_add_u32 s78, s67, 4194304
    s_mov_b32 s81, 0
    s_add_u32 s80, s66, 98304
    s_mov_b32 s76, 0
    s_mov_b32 s77, 8192
    s_call_b64 s[82:83], cs_dma
    ds_read_b64_tr_b16 a[56:57], v56 offset:0
    ds_read_b64_tr_b16 a[58:59], v56 offset:256
    ds_read_b64_tr_b16 a[60:61], v56 offset:8192
    ds_read_b64_tr_b16 a[62:63], v56 offset:8448
    s_mov_b32 s77, 16384
    s_call_b64 s[82:83], cs_dma
    s_waitcnt lgkmcnt(0)
    v_add_u32 v55, 16384, v51
    v_xor_b32 v56, 32, v55
    ds_read_b64_tr_b16 a[64:65], v55 offset:0
    ds_read_b64_tr_b16 a[66:67], v55 offset:256
    ds_read_b64_tr_b16 a[68:69], v55 offset:8192
    ds_read_b64_tr_b16 a[70:71], v55 offset:8448
    s_xor_b32 s78, s75, 1048576
    s_add_u32 s78, s78, s67
    s_mov_b32 s81, s93
    s_add_u32 s80, s66, 114688
    s_mov_b32 s76, 0
    s_mov_b32 s77, 8192
    s_call_b64 s[82:83], cs_dma
    ds_read_b64_tr_b16 a[72:73], v56 offset:0
    ds_read_b64_tr_b16 a[74:75], v56 offset:256
    ds_read_b64_tr_b16 a[76:77], v56 offset:8192
    ds_read_b64_tr_b16 a[78:79], v56 offset:8448
    s_mov_b32 s77, 16384
    s_call_b64 s[82:83], cs_dma
    s_waitcnt lgkmcnt(0)
    s_waitcnt vmcnt(8)
    v_add_u32 v55, 32768, v51
    v_xor_b32 v56, 32, v55
    ds_read_b64_tr_b16 a[80:81], v55 offset:0
    ds_read_b64_tr_b16 a[82:83], v55 offset:256
    ds_read_b64_tr_b16 a[84:85], v55 offset:8192
    ds_read_b64_tr_b16 a[86:87], v55 offset:8448
    s_mov_b32 s77, 24576
    s_call_b64 s[82:83], cs_dma
    ds_read_b64_tr_b16 a[88:89], v56 offset:0
    ds_read_b64_tr_b16 a[90:91], v56 offset:256
    ds_read_b64_tr_b16 a[92:93], v56 offset:8192
    ds_read_b64_tr_b16 a[94:95], v56 offset:8448
    s_mov_b32 s77, 32768
    s_call_b64 s[82:83], cs_dma
    s_waitcnt lgkmcnt(0)
    v_add_u32 v55, 49152, v51
    v_xor_b32 v56, 32, v55
    ds_read_b64_tr_b16 a[96:97], v55 offset:0
    ds_read_b64_tr_b16 a[98:99], v55 offset:256
    ds_read_b64_tr_b16 a[100:101], v55 offset:8192
    ds_read_b64_tr_b16 a[102:103], v55 offset:8448
    s_xor_b32 s78, s75, 0
    s_add_u32 s78, s78, s67
    s_add_u32 s80, s66, 65536
    s_mov_b32 s76, 0
    s_mov_b32 s77, 8192
    s_call_b64 s[82:83], cs_dma
    ds_read_b64_tr_b16 a[104:105], v56 offset:0
    ds_read_b64_tr_b16 a[106:107], v56 offset:256
    ds_read_b64_tr_b16 a[108:109], v56 offset:8192
    ds_read_b64_tr_b16 a[110:111], v56 offset:8448
    s_mov_b32 s77, 16384
    s_call_b64 s[82:83], cs_dma
    s_waitcnt lgkmcnt(0)
    s_waitcnt vmcnt(12)
    v_add_u32 v55, 98304, v51
    v_xor_b32 v56, 32, v55
    ds_read_b64_tr_b16 a[112:113], v55 offset:0
    ds_read_b64_tr_b16 a[114:115], v55 offset:256
    ds_read_b64_tr_b16 a[116:117], v55 offset:8192
    ds_read_b64_tr_b16 a[118:119], v55 offset:8448
    s_mov_b32 s77, 24576
    s_call_b64 s[82:83], cs_dma
    ds_read_b64_tr_b16 a[120:121], v56 offset:0
    ds_read_b64_tr_b16 a[122:123], v56 offset:256
    ds_read_b64_tr_b16 a[124:125], v56 offset:8192
    ds_read_b64_tr_b16 a[126:127], v56 offset:8448
    s_mov_b32 s77, 32768
    s_call_b64 s[82:83], cs_dma
    s_waitcnt lgkmcnt(0)
    s_waitcnt vmcnt(8)
    v_add_u32 v55, 114688, v51
    v_xor_b32 v56, 32, v55
    ds_read_b64_tr_b16 a[16:17], v55 offset:0
    ds_read_b64_tr_b16 a[18:19], v55 offset:256
    ds_read_b64_tr_b16 a[20:21], v55 offset:8192
    ds_read_b64_tr_b16 a[22:23], v55 offset:8448
    s_xor_b32 s78, s75, 0
    s_add_u32 s78, s78, s67
    s_mov_b64 s[8:9], s[52:53]
    s_add_u32 s80, s66, 0
    s_mov_b32 s76, 0
    s_mov_b32 s77, 8192
    s_call_b64 s[82:83], cs_dma
    ds_read_b64_tr_b16 a[24:25], v56 offset:0
    ds_read_b64_tr_b16 a[26:27], v56 offset:256
    ds_read_b64_tr_b16 a[28:29], v56 offset:8192
    ds_read_b64_tr_b16 a[30:31], v56 offset:8448
    s_mov_b32 s77, 16384
    s_call_b64 s[82:83], cs_dma
    s_waitcnt lgkmcnt(0)
    v_add_u32 v55, 131072, v51
    v_xor_b32 v56, 32, v55
    ds_read_b64_tr_b16 a[32:33], v55 offset:0
    ds_read_b64_tr_b16 a[34:35], v55 offset:256
    ds_read_b64_tr_b16 a[36:37], v55 offset:8192
    ds_read_b64_tr_b16 a[38:39], v55 offset:8448
    s_mov_b32 s77, 24576
    s_call_b64 s[82:83], cs_dma
    ds_read_b64_tr_b16 a[40:41], v56 offset:0
    ds_read_b64_tr_b16 a[42:43], v56 offset:256
    ds_read_b64_tr_b16 a[44:45], v56 offset:8192
    ds_read_b64_tr_b16 a[46:47], v56 offset:8448
    s_mov_b32 s77, 32768
    s_call_b64 s[82:83], cs_dma
    s_waitcnt lgkmcnt(0)
    s_waitcnt vmcnt(8)
    v_add_u32 v55, 65536, v51
    v_xor_b32 v56, 32, v55
    ds_read_b64_tr_b16 v[0:1], v55 offset:0
    ds_read_b64_tr_b16 v[2:3], v55 offset:256
    ds_read_b64_tr_b16 v[4:5], v55 offset:8192
    ds_read_b64_tr_b16 v[6:7], v55 offset:8448
    s_xor_b32 s78, s75, 1048576
    s_add_u32 s78, s78, s67
    s_add_u32 s80, s66, 32768
    s_mov_b32 s76, 0
    s_mov_b32 s77, 8192
    s_call_b64 s[82:83], cs_dma
    ds_read_b64_tr_b16 v[8:9], v56 offset:0
    ds_read_b64_tr_b16 v[10:11], v56 offset:256
    ds_read_b64_tr_b16 v[12:13], v56 offset:8192
    ds_read_b64_tr_b16 v[14:15], v56 offset:8448
    s_mov_b32 s77, 16384
    s_call_b64 s[82:83], cs_dma
    s_waitcnt lgkmcnt(0)
    ds_write_b128 v62, v[0:3] offset:8192
    ds_write_b128 v62, v[4:7] offset:12288
    ds_write_b128 v62, v[8:11] offset:16384
    ds_write_b128 v62, v[12:15] offset:20480
    s_waitcnt lgkmcnt(0)
    v_add_u32 v55, 81920, v51
    v_xor_b32 v56, 32, v55
    ds_read_b64_tr_b16 a[0:1], v55 offset:0
    ds_read_b64_tr_b16 a[2:3], v55 offset:256
    ds_read_b64_tr_b16 a[4:5], v55 offset:8192
    ds_read_b64_tr_b16 a[6:7], v55 offset:8448
    s_mov_b32 s77, 24576
    s_call_b64 s[82:83], cs_dma
    ds_read_b64_tr_b16 a[8:9], v56 offset:0
    ds_read_b64_tr_b16 a[10:11], v56 offset:256
    ds_read_b64_tr_b16 a[12:13], v56 offset:8192
    ds_read_b64_tr_b16 a[14:15], v56 offset:8448
    s_mov_b32 s77, 32768
    s_call_b64 s[82:83], cs_dma
    s_waitcnt lgkmcnt(0)
    s_waitcnt vmcnt(8)
    v_add_u32 v55, 0, v51
    v_xor_b32 v56, 32, v55
    ds_read_b64_tr_b16 v[0:1], v55 offset:0
    ds_read_b64_tr_b16 v[2:3], v55 offset:256
    ds_read_b64_tr_b16 v[4:5], v55 offset:8192
    ds_read_b64_tr_b16 v[6:7], v55 offset:8448
    s_xor_b32 s94, s13, 0
    s_mul_i32 s94, s94, 36864
    s_add_u32 s94, s94, s92
    s_lshr_b32 s74, s13, 1
    s_lshl_b32 s74, s74, 6
    s_add_u32 s94, s94, s74
    s_add_u32 s78, s94, 1024
    s_mov_b64 s[8:9], s[56:57]
    v_mov_b32 v58, v50
    s_mov_b32 s79, 18432
    s_mov_b32 s81, 0
    s_add_u32 s80, s66, 147456
    s_mov_b32 s76, 0
    s_mov_b32 s77, 8192
    s_call_b64 s[82:83], cs_dma
    ds_read_b64_tr_b16 v[8:9], v56 offset:0
    ds_read_b64_tr_b16 v[10:11], v56 offset:256
    ds_read_b64_tr_b16 v[12:13], v56 offset:8192
    ds_read_b64_tr_b16 v[14:15], v56 offset:8448
    s_xor_b32 s94, s13, 2
    s_mul_i32 s94, s94, 36864
    s_add_u32 s94, s94, s92
    s_lshr_b32 s74, s13, 1
    s_lshl_b32 s74, s74, 6
    s_add_u32 s94, s94, s74
    s_add_u32 s78, s94, 1024
    s_mov_b32 s77, 16384
    s_call_b64 s[82:83], cs_dma
    s_waitcnt lgkmcnt(0)
    ds_write_b128 v61, v[0:3] offset:0
    ds_write_b128 v61, v[4:7] offset:4096
    ds_write_b128 v61, v[8:11] offset:8192
    ds_write_b128 v61, v[12:15] offset:12288
    s_waitcnt lgkmcnt(0)
    v_add_u32 v55, 16384, v51
    v_xor_b32 v56, 32, v55
    ds_read_b64_tr_b16 v[0:1], v55 offset:0
    ds_read_b64_tr_b16 v[2:3], v55 offset:256
    ds_read_b64_tr_b16 v[4:5], v55 offset:8192
    ds_read_b64_tr_b16 v[6:7], v55 offset:8448
    s_xor_b32 s94, s13, 3
    s_mul_i32 s94, s94, 36864
    s_add_u32 s94, s94, s92
    s_lshl_b32 s74, s13, 7
    s_add_u32 s94, s94, s74
    s_add_u32 s78, s94, 512
    v_mov_b32 v58, v49
    s_mov_b32 s79, 9216
    s_add_u32 s80, s66, 131072
    s_mov_b32 s76, 0
    s_mov_b32 s77, 8192
    s_call_b64 s[82:83], cs_dma
    ds_read_b64_tr_b16 v[8:9], v56 offset:0
    ds_read_b64_tr_b16 v[10:11], v56 offset:256
    ds_read_b64_tr_b16 v[12:13], v56 offset:8192
    ds_read_b64_tr_b16 v[14:15], v56 offset:8448
    s_mov_b32 s77, 16384
    s_call_b64 s[82:83], cs_dma
    s_waitcnt lgkmcnt(0)
    ds_write_b128 v61, v[0:3] offset:16384
    ds_write_b128 v61, v[4:7] offset:20480
    ds_write_b128 v61, v[8:11] offset:24576
    ds_write_b128 v61, v[12:15] offset:28672
    s_waitcnt lgkmcnt(0)
    s_waitcnt vmcnt(8)
    v_add_u32 v55, 32768, v51
    v_xor_b32 v56, 32, v55
    ds_read_b64_tr_b16 v[0:1], v55 offset:0
    ds_read_b64_tr_b16 v[2:3], v55 offset:256
    ds_read_b64_tr_b16 v[4:5], v55 offset:8192
    ds_read_b64_tr_b16 v[6:7], v55 offset:8448
    s_xor_b32 s94, s13, 2
    s_mul_i32 s94, s94, 36864
    s_add_u32 s94, s94, s92
    s_lshl_b32 s74, s13, 7
    s_add_u32 s94, s94, s74
    s_add_u32 s78, s94, 512
    s_add_u32 s80, s66, 114688
    s_mov_b32 s76, 0
    s_mov_b32 s77, 8192
    s_call_b64 s[82:83], cs_dma
    ds_read_b64_tr_b16 v[8:9], v56 offset:0
    ds_read_b64_tr_b16 v[10:11], v56 offset:256
    ds_read_b64_tr_b16 v[12:13], v56 offset:8192
    ds_read_b64_tr_b16 v[14:15], v56 offset:8448
    s_mov_b32 s77, 16384
    s_call_b64 s[82:83], cs_dma
    s_waitcnt lgkmcnt(0)
    ds_write_b128 v61, v[0:3] offset:32768
    ds_write_b128 v61, v[4:7] offset:36864
    ds_write_b128 v61, v[8:11] offset:40960
    ds_write_b128 v61, v[12:15] offset:45056
    s_waitcnt lgkmcnt(0)
    v_add_u32 v55, 49152, v51
    v_xor_b32 v56, 32, v55
    ds_read_b64_tr_b16 v[0:1], v55 offset:0
    ds_read_b64_tr_b16 v[2:3], v55 offset:256
    ds_read_b64_tr_b16 v[4:5], v55 offset:8192
    ds_read_b64_tr_b16 v[6:7], v55 offset:8448
    s_add_u32 s78, s67, 4194304
    s_mov_b64 s[8:9], s[52:53]
    v_mov_b32 v58, v48
    s_mov_b32 s79, 131072
    s_add_u32 s80, s66, 81920
    s_mov_b32 s76, 0
    s_mov_b32 s77, 8192
    s_call_b64 s[82:83], cs_dma
    ds_read_b64_tr_b16 v[8:9], v56 offset:0
    ds_read_b64_tr_b16 v[10:11], v56 offset:256
    ds_read_b64_tr_b16 v[12:13], v56 offset:8192
    ds_read_b64_tr_b16 v[14:15], v56 offset:8448
    s_mov_b32 s77, 16384
    s_call_b64 s[82:83], cs_dma
    s_waitcnt lgkmcnt(0)
    ds_write_b128 v61, v[0:3] offset:49152
    ds_write_b128 v61, v[4:7] offset:53248
    ds_write_b128 v61, v[8:11] offset:57344
    ds_write_b128 v61, v[12:15] offset:61440
    s_waitcnt lgkmcnt(0)
    buffer_load_dword v38, off, s[96:99], 0 offset:216 sc1
    buffer_load_dword v39, off, s[96:99], 0 offset:64 sc1
    s_lshr_b32 s84, s12, 1
    s_lshl_b32 s84, s84, 8
    s_add_u32 s84, s84, 125829120
    v_bfe_u32 v40, v61, 4, 6
    v_min_u32 v40, 11, v40
    v_lshlrev_b32 v40, 2, v40
    buffer_load_dword v41, v40, s[4:7], s84 offen sc1
    s_waitcnt vmcnt(15)
    v_add_u32 v55, 147456, v53
    ds_read_b64_tr_b16 v[0:1], v55 offset:0
    ds_read_b64_tr_b16 v[2:3], v55 offset:128
    ds_read_b64_tr_b16 v[4:5], v55 offset:512
    ds_read_b64_tr_b16 v[6:7], v55 offset:640
    ds_read_b64_tr_b16 v[8:9], v55 offset:8192
    ds_read_b64_tr_b16 v[10:11], v55 offset:8320
    ds_read_b64_tr_b16 v[12:13], v55 offset:8704
    ds_read_b64_tr_b16 v[14:15], v55 offset:8832
    s_waitcnt lgkmcnt(0)
    s_barrier
    ds_write_b128 v63, v[0:3] offset:49152
    ds_write_b128 v63, v[4:7] offset:53248
    s_barrier
    ds_write_b128 v63, v[8:11] offset:57344
    ds_write_b128 v63, v[12:15] offset:61440
    s_waitcnt lgkmcnt(0)
    s_waitcnt vmcnt(11)
    v_add_u32 v55, 131072, v52
    ds_read_b64_tr_b16 v[0:1], v55 offset:0
    ds_read_b64_tr_b16 v[2:3], v55 offset:256
    ds_read_b64_tr_b16 v[4:5], v55 offset:4096
    ds_read_b64_tr_b16 v[6:7], v55 offset:4352
    ds_read_b64_tr_b16 v[8:9], v55 offset:64
    ds_read_b64_tr_b16 v[10:11], v55 offset:320
    ds_read_b64_tr_b16 v[12:13], v55 offset:4160
    ds_read_b64_tr_b16 v[14:15], v55 offset:4416
    s_waitcnt lgkmcnt(0)
    s_barrier
    ds_write_b128 v63, v[0:3] offset:32768
    ds_write_b128 v63, v[4:7] offset:36864
    s_barrier
    ds_write_b128 v63, v[8:11] offset:40960
    ds_write_b128 v63, v[12:15] offset:45056
    s_waitcnt lgkmcnt(0)
    s_waitcnt vmcnt(7)
    v_add_u32 v55, 114688, v52
    ds_read_b64_tr_b16 v[0:1], v55 offset:0
    ds_read_b64_tr_b16 v[2:3], v55 offset:256
    ds_read_b64_tr_b16 v[4:5], v55 offset:4096
    ds_read_b64_tr_b16 v[6:7], v55 offset:4352
    ds_read_b64_tr_b16 v[8:9], v55 offset:64
    ds_read_b64_tr_b16 v[10:11], v55 offset:320
    ds_read_b64_tr_b16 v[12:13], v55 offset:4160
    ds_read_b64_tr_b16 v[14:15], v55 offset:4416
    s_waitcnt lgkmcnt(0)
    s_barrier
    ds_write_b128 v63, v[0:3] offset:16384
    ds_write_b128 v63, v[4:7] offset:20480
    s_barrier
    ds_write_b128 v63, v[8:11] offset:24576
    ds_write_b128 v63, v[12:15] offset:28672
    s_waitcnt lgkmcnt(0)
    buffer_load_dword v30, v79, s[4:7], s14 offen sc1
    s_lshl_b32 s40, s12, 14
    s_add_u32 s40, s40, 68222976
    buffer_load_dword v30, v79, s[4:7], s40 offen sc1
    s_and_b32 s40, s12, 3
    s_lshl_b32 s40, s40, 14
    s_add_u32 s40, s40, 68157440
    buffer_load_dword v30, v79, s[4:7], s40 offen sc1
    s_waitcnt vmcnt(1)
    v_readfirstlane_b32 s95, v39
    v_readfirstlane_b32 s85, v38
    s_add_u32 s86, s95, 2
    s_waitcnt vmcnt(0)
    v_subrev_u32 v41, s86, v41
    v_cmp_lt_u32 s[86:87], 64, v41
    s_cmp_eq_u32 s95, 0
    s_cselect_b64 s[86:87], -1, s[86:87]
    s_cmp_lg_u64 s[86:87], 0
    s_cbranch_scc1 cs_nt
    s_add_u32 s40, s24, 524288
    buffer_load_dword v30, v79, s[4:7], s24 offen sc1
    buffer_load_dword v30, v79, s[4:7], s40 offen sc1
cs_nt:
    s_waitcnt vmcnt(3)
    v_add_u32 v55, 81920, v51
    v_xor_b32 v56, 32, v55
    ds_read_b64_tr_b16 v[0:1], v55 offset:0
    ds_read_b64_tr_b16 v[2:3], v55 offset:256
    ds_read_b64_tr_b16 v[4:5], v55 offset:8192
    ds_read_b64_tr_b16 v[6:7], v55 offset:8448
    ds_read_b64_tr_b16 v[8:9], v56 offset:0
    ds_read_b64_tr_b16 v[10:11], v56 offset:256
    ds_read_b64_tr_b16 v[12:13], v56 offset:8192
    ds_read_b64_tr_b16 v[14:15], v56 offset:8448
    s_waitcnt lgkmcnt(0)
    ds_write_b128 v62, v[0:3] offset:24576
    ds_write_b128 v62, v[4:7] offset:28672
    ds_write_b128 v62, v[8:11] offset:32768
    ds_write_b128 v62, v[12:15] offset:36864
    s_waitcnt lgkmcnt(0)
    s_barrier
    s_mov_b32 s88, 4194304
gn3:
    s_cmp_lg_u32 s95, 0
    s_cbranch_scc1 gn3x
    buffer_load_dword v24, off, s[96:99], 0 offset:64 sc1
    s_sub_u32 s88, s88, 1
    s_cbranch_scc1 gn3x
    s_waitcnt vmcnt(0)
    v_readfirstlane_b32 s95, v24
    s_nop 1
    s_branch gn3
gn3x:
    ds_write_b128 v78, v[16:19] offset:8704
    ds_write_b128 v65, v[20:23] offset:10240
    v_mov_b32 v44, s95
    v_mov_b32 v45, s95
    v_mov_b32 v46, s95
    v_mov_b32 v47, s95
    v_mov_b32 v48, 108288
    ds_write_b128 v48, v[44:47]
    s_waitcnt vmcnt(0) lgkmcnt(0)
    s_cmp_eq_u32 s85, 1
    s_cbranch_scc1 cs_run
    s_mov_b32 s40, 16777216
cs_startpoll:
    buffer_load_dword v3, off, s[96:99], 0 offset:216 sc1
    s_waitcnt vmcnt(0)
    v_readfirstlane_b32 s85, v3
    s_nop 0
    s_cmp_eq_u32 s85, 1
    s_cbranch_scc1 cs_run
    s_sleep 1
    s_sub_u32 s40, s40, 1
    s_cbranch_scc0 cs_startpoll
    s_endpgm
cs_run:
    s_cmp_eq_u64 s[86:87], 0
    s_cbranch_scc1 cs_kvok
    s_lshr_b32 s92, s12, 1
    s_lshl_b32 s92, s92, 8
    s_add_u32 s92, s92, 125829120
    v_bfe_u32 v2, v61, 4, 6
    v_min_u32 v2, 11, v2
    v_lshlrev_b32 v2, 2, v2
    s_add_u32 s93, s95, 2
    s_mov_b32 s94, 4194304
cs_kv0:
    buffer_load_dword v3, v2, s[4:7], s92 offen sc1
    s_sub_u32 s94, s94, 1
    s_cbranch_scc1 cs_kv0_go
    s_waitcnt vmcnt(0)
    v_subrev_u32 v3, s93, v3
    v_cmp_lt_u32 vcc, 64, v3
    s_cbranch_vccz cs_kv0_go
    s_sleep 2
    s_branch cs_kv0
cs_kv0_go:
    s_add_u32 s40, s24, 524288
    buffer_load_dword v30, v79, s[4:7], s24 offen sc1
    buffer_load_dword v30, v79, s[4:7], s40 offen sc1
    s_waitcnt vmcnt(0)
cs_kvok:
    s_mov_b32 m0, 108032
    s_add_u32 s24, s24, 1048576
    s_add_u32 s15, s14, 4096
    s_add_u32 s16, s14, 8192
    ds_read_b128 v[32:35], v62 offset:16384
    ds_read_b128 v[36:39], v62 offset:20480
    ds_read_b128 v[40:43], v61 offset:0
    ds_read_b128 v[44:47], v61 offset:4096
    ds_read_b128 v[48:51], v61 offset:8192
    ds_read_b128 v[52:55], v61 offset:12288
    s_mov_b32 s29, 1048576
    buffer_load_dwordx4 v[24:27], v61, s[4:7], s14 offen sc1
.p2align 6
cs_loop:
    v_mov_b64 v[0:1], 0
    v_mov_b64 v[2:3], 0
    v_mov_b64 v[4:5], 0
    v_mov_b64 v[6:7], 0
    v_mov_b64 v[8:9], 0
    v_mov_b64 v[10:11], 0
    v_mov_b64 v[12:13], 0
    v_mov_b64 v[14:15], 0
cs_loop2:
    ds_read_b128 v[16:19], v62 offset:8192
    ds_read_b128 v[20:23], v62 offset:12288
    v_lshrrev_b32 v56, 2, v61
    v_add_u32 v58, 106496, v56
    s_mov_b32 s29, 1048576
    s_waitcnt lgkmcnt(0)
cs_chk0:
    s_waitcnt vmcnt(0)
    v_max3_u32 v57, v24, v25, v26
    v_max_u32 v57, v57, v27
    v_cmp_eq_u32 vcc, -1, v57
    ds_write_b128 v62, v[24:27] offset:40960
    s_cbranch_vccnz cs_spin0
    v_smfmac_f32_16x16x64_bf16 v[0:3], v[24:27], v[16:23], v60
    buffer_load_dwordx4 v[28:31], v61, s[4:7], s15 offen sc1
    buffer_load_dword v59, v56, s[4:7], s16 offen sc1
    v_smfmac_f32_16x16x64_bf16 v[8:11], v[24:27], v[32:39], v60
    ds_read_b128 v[32:35], v61 offset:16384
    v_smfmac_f32_16x16x64_bf16 v[12:15], v[24:27], v[48:55], v60
    ds_read_b128 v[36:39], v61 offset:20480
    v_mfma_f32_16x16x16_bf16 v[16:19], v[72:73], v[72:73], 0
    s_waitcnt lgkmcnt(2)
    s_barrier
    ds_read_b128 v[48:51], v63 offset:0
    v_mfma_f32_16x16x16_bf16 v[20:23], v[72:73], v[72:73], 0
    ds_read_b128 v[52:55], v64 offset:0
    v_smfmac_f32_16x16x64_bf16 v[4:7], v[24:27], v[40:47], v60
    ds_read_b128 v[40:43], v61 offset:24576
    v_smfmac_f32_16x16x64_bf16 v[16:19], v[24:27], a[192:199], v60
    ds_read_b128 v[44:47], v61 offset:28672
    v_smfmac_f32_16x16x64_bf16 v[20:23], v[24:27], a[200:207], v60
    s_waitcnt lgkmcnt(3)
    v_smfmac_f32_16x16x64_bf16 v[0:3], v[48:51], a[0:7], v60
    s_add_u32 s18, s14, s31
    s_add_u32 s41, s14, 16384
    v_smfmac_f32_16x16x64_bf16 v[4:7], v[48:51], v[32:39], v60
    ds_read_b128 v[32:35], v61 offset:32768
    v_smfmac_f32_16x16x64_bf16 v[8:11], v[48:51], a[8:15], v60
    ds_read_b128 v[36:39], v61 offset:36864
    s_waitcnt lgkmcnt(2)
    v_smfmac_f32_16x16x64_bf16 v[12:15], v[48:51], v[40:47], v60
    ds_read_b128 v[40:43], v61 offset:40960
    v_smfmac_f32_16x16x64_bf16 v[0:3], v[52:55], a[16:23], v60
    ds_read_b128 v[44:47], v61 offset:45056
    v_smfmac_f32_16x16x64_bf16 v[8:11], v[52:55], a[24:31], v60
    ds_read_b128 v[48:51], v71 offset:0
    s_waitcnt lgkmcnt(3)
    v_smfmac_f32_16x16x64_bf16 v[4:7], v[52:55], v[32:39], v60
    s_waitcnt vmcnt(0)
    ds_write_b128 v62, v[28:31] offset:45056
    s_waitcnt lgkmcnt(2)
    v_smfmac_f32_16x16x64_bf16 v[12:15], v[52:55], v[40:47], v60
    ds_write_b32 v58, v59
    v_max3_u32 v57, v28, v29, v30
    s_waitcnt lgkmcnt(2)
    v_smfmac_f32_16x16x64_bf16 v[0:3], v[48:51], a[32:39], v60
    ds_read_b128 v[32:35], v61 offset:49152
    v_max3_u32 v57, v57, v31, v59
    v_smfmac_f32_16x16x64_bf16 v[8:11], v[48:51], a[40:47], v60
    ds_read_b128 v[36:39], v61 offset:53248
    v_cmp_eq_u32 vcc, -1, v57
    v_smfmac_f32_16x16x64_bf16 v[16:19], v[52:55], a[224:231], v60
    ds_read_b128 v[40:43], v61 offset:57344
    v_smfmac_f32_16x16x64_bf16 v[20:23], v[52:55], a[232:239], v60
    ds_read_b128 v[44:47], v61 offset:61440
    s_cbranch_vccnz cs_spin1
cs_go1:
    v_smfmac_f32_16x16x64_bf16 v[0:3], v[28:31], a[48:55], v60
    s_waitcnt lgkmcnt(4)
    s_barrier
    ds_read_b128 v[52:55], v63 offset:4096
    v_smfmac_f32_16x16x64_bf16 v[8:11], v[28:31], a[56:63], v60
    ds_read_b128 v[56:59], v71 offset:4096
    v_smfmac_f32_16x16x64_bf16 v[4:7], v[28:31], a[128:135], v60
    s_waitcnt lgkmcnt(2)
    v_smfmac_f32_16x16x64_bf16 v[4:7], v[48:51], v[32:39], v60
    buffer_load_dwordx4 v[32:35], v61, s[4:7], s23 offen offset:0 sc1
    v_smfmac_f32_16x16x64_bf16 v[12:15], v[48:51], v[40:47], v60
    ds_read_b128 v[48:51], v64 offset:4096
    v_smfmac_f32_16x16x64_bf16 v[12:15], v[28:31], a[136:143], v60
    ds_read_b128 v[24:27], v65 offset:8192
    s_and_b32 s41, s41, 65535
    s_add_u32 s41, s41, 68157440
    v_smfmac_f32_16x16x64_bf16 v[16:19], v[28:31], v[80:87], v60
    buffer_load_dwordx4 v[36:39], v61, s[4:7], s23 offen offset:1024 sc1
    v_smfmac_f32_16x16x64_bf16 v[20:23], v[28:31], v[88:95], v60
    s_add_u32 s17, s41, s31
    s_and_b32 s30, s28, 1
    s_waitcnt lgkmcnt(3)
    v_smfmac_f32_16x16x64_bf16 v[0:3], v[52:55], a[64:71], v60
    ds_read_b128 v[28:31], v78 offset:8704
    v_smfmac_f32_16x16x64_bf16 v[4:7], v[52:55], a[144:151], v60
    buffer_load_dwordx4 v[40:43], v61, s[4:7], s23 offen offset:2048 sc1
    v_smfmac_f32_16x16x64_bf16 v[8:11], v[52:55], a[72:79], v60
    v_smfmac_f32_16x16x64_bf16 v[12:15], v[52:55], a[152:159], v60
    v_smfmac_f32_16x16x64_bf16 v[16:19], v[52:55], v[96:103], v60
    buffer_load_dwordx4 v[44:47], v61, s[4:7], s23 offen offset:3072 sc1
    v_smfmac_f32_16x16x64_bf16 v[20:23], v[52:55], v[104:111], v60
    ds_read_b128 v[52:55], v62 offset:28672
    s_waitcnt lgkmcnt(3)
    v_smfmac_f32_16x16x64_bf16 v[0:3], v[48:51], a[80:87], v60
    v_smfmac_f32_16x16x64_bf16 v[4:7], v[48:51], a[160:167], v60
    v_smfmac_f32_16x16x64_bf16 v[8:11], v[48:51], a[88:95], v60
    v_smfmac_f32_16x16x64_bf16 v[12:15], v[48:51], a[168:175], v60
    v_smfmac_f32_16x16x64_bf16 v[16:19], v[48:51], v[112:119], v60
    buffer_load_dword v79, s[4:7], s24 offen sc1 lds
    v_smfmac_f32_16x16x64_bf16 v[20:23], v[48:51], v[120:127], v60
    ds_read_b128 v[48:51], v62 offset:24576
    v_smfmac_f32_16x16x64_bf16 v[0:3], v[56:59], a[96:103], v60
    v_smfmac_f32_16x16x64_bf16 v[4:7], v[56:59], a[176:183], v60
    s_waitcnt lgkmcnt(3)
    v_smfmac_f32_16x16x64_bf16 v[0:3], v[24:27], a[112:119], v60
    s_cmp_ge_u32 s28, 62
    v_smfmac_f32_16x16x64_bf16 v[8:11], v[56:59], a[104:111], v60
    s_waitcnt lgkmcnt(0)
    v_smfmac_f32_16x16x64_bf16 v[4:7], v[24:27], v[48:55], v60
    ds_read_b128 v[48:51], v62 offset:32768
    v_cvt_pk_bf16_f32 v0, v0, v1
    v_smfmac_f32_16x16x64_bf16 v[12:15], v[56:59], a[184:191], v60
    ds_read_b128 v[52:55], v62 offset:36864
    v_cvt_pk_bf16_f32 v1, v2, v3
    v_smfmac_f32_16x16x64_bf16 v[8:11], v[24:27], a[120:127], v60
    v_cvt_pk_bf16_f32 v2, v4, v5
    v_smfmac_f32_16x16x64_bf16 v[16:19], v[56:59], v[128:135], v60
    v_cvt_pk_bf16_f32 v3, v6, v7
    s_nop 1
    v_mfma_f32_16x16x32_bf16 v[4:7], v[0:3], v[28:31], 0
    v_cvt_pk_bf16_f32 v8, v8, v9
    s_waitcnt lgkmcnt(0)
    v_smfmac_f32_16x16x64_bf16 v[12:15], v[24:27], v[48:55], v60
    ds_read_b128 v[48:51], v63 offset:0
    v_cvt_pk_bf16_f32 v9, v10, v11
    v_smfmac_f32_16x16x64_bf16 v[20:23], v[56:59], v[136:143], v60
    ds_read_b128 v[52:55], v71 offset:0
    v_cvt_pk_bf16_f32 v0, v4, v5
    s_nop 0
    v_cvt_pk_bf16_f32 v10, v12, v13
    v_cvt_pk_bf16_f32 v11, v14, v15
    v_cvt_pk_bf16_f32 v1, v6, v7
    s_waitcnt vmcnt(1)
    v_mfma_f32_16x16x32_bf16 v[12:15], v[8:11], v[28:31], 0
    s_mov_b64 exec, s[36:37]
    ds_read_b128 v[56:59], v69
    s_mov_b64 exec, -1
    v_smfmac_f32_16x16x64_bf16 v[16:19], v[24:27], v[144:151], v60
    s_nop 3
    v_cvt_pk_bf16_f32 v2, v12, v13
    v_cvt_pk_bf16_f32 v3, v14, v15
    s_nop 1
    v_mfma_f32_16x16x32_bf16 v[8:11], v[0:3], v[0:3], 0
    s_cbranch_scc1 cs_last
cs_back:
    v_mfma_f32_16x16x32_bf16 v[4:7], v[36:39], v[0:3], 0
    ds_read_b128 v[36:39], v63 offset:53248
    v_mfma_f32_16x16x32_bf16 v[12:15], v[32:35], v[0:3], 0
    ds_read_b128 v[32:35], v63 offset:49152
    v_mov_b32_dpp v8, v10 row_ror:8 row_mask:0xf bank_mask:0xc
    v_mov_b32_dpp v9, v11 row_ror:8 row_mask:0xf bank_mask:0xc
    ds_write_b64 v70, v[8:9]
    s_nop 1
    v_mov_b32_dpp v12, v4 row_ror:8 row_mask:0xf bank_mask:0xc
    v_mov_b32_dpp v13, v5 row_ror:8 row_mask:0xf bank_mask:0xc
    v_mov_b32_dpp v14, v6 row_ror:8 row_mask:0xf bank_mask:0xc
    v_mov_b32_dpp v15, v7 row_ror:8 row_mask:0xf bank_mask:0xc
    ds_write_b128 v62, v[12:15] offset:53248
    v_smfmac_f32_16x16x64_bf16 v[20:23], v[24:27], v[152:159], v60
    s_waitcnt lgkmcnt(4)
    s_mov_b64 exec, s[36:37]
    s_cbranch_execz cs_np3548
    buffer_store_dwordx4 v[56:59], v61, s[4:7], s65 offen sc1
cs_np3548:
    s_mov_b64 exec, -1
    v_smfmac_f32_16x16x64_bf16 v[16:19], v[48:51], a[208:215], v60
    v_smfmac_f32_16x16x64_bf16 v[20:23], v[48:51], a[216:223], v60
    s_waitcnt lgkmcnt(0)
    s_barrier
    ds_read_b128 v[56:59], v78 offset:10752
    ds_read_b128 v[28:31], v78 offset:11264
    v_smfmac_f32_16x16x64_bf16 v[16:19], v[52:55], a[240:247], v60
    ds_read_b128 v[4:7], v63 offset:12288
    ds_read_b128 v[8:11], v64 offset:12288
    v_smfmac_f32_16x16x64_bf16 v[20:23], v[52:55], a[248:255], v60
    ds_read_b128 v[0:3], v71 offset:12288
    ds_read_b128 v[48:51], v63 offset:57344
    ds_read_b128 v[52:55], v63 offset:61440
    v_mov_b64 v[24:25], s[62:63]
    v_mov_b64 v[26:27], s[60:61]
    v_cvt_pk_bf16_f32 v16, v16, v17
    v_cvt_pk_bf16_f32 v17, v18, v19
    v_pk_mul_f32 v[12:13], v[12:13], s[44:45]
    v_pk_mul_f32 v[14:15], v[14:15], s[44:45]
    s_waitcnt lgkmcnt(5)
    v_pk_add_f32 v[56:57], v[56:57], v[58:59]
    v_pk_add_f32 v[28:29], v[28:29], v[30:31]
    v_pk_add_f32 v[56:57], v[56:57], v[28:29]
    v_pk_mul_f32 v[56:57], v[56:57], s[44:45]
    v_exp_f32 v58, v56
    v_exp_f32 v59, v57
    s_waitcnt lgkmcnt(3)
    v_pk_fma_f32 v[12:13], v[4:5], s[44:45], v[12:13]
    v_pk_fma_f32 v[14:15], v[6:7], s[44:45], v[14:15]
    v_cvt_pk_bf16_f32 v6, v58, v59
    v_pk_fma_f32 v[12:13], v[8:9], s[44:45], v[12:13]
    v_pk_fma_f32 v[14:15], v[10:11], s[44:45], v[14:15]
    s_waitcnt lgkmcnt(2)
    v_pk_fma_f32 v[12:13], v[0:1], s[44:45], v[12:13]
    v_mov_b32_dpp v7, v6 row_ror:8 row_mask:0xf bank_mask:0xf
    v_pk_fma_f32 v[14:15], v[2:3], s[44:45], v[14:15]
    v_exp_f32 v0, v12
    v_mfma_f32_16x16x16_bf16 v[28:31], v[16:17], v[6:7], 0
    v_exp_f32 v1, v13
    v_cvt_pk_bf16_f32 v18, v20, v21
    v_exp_f32 v2, v14
    v_cvt_pk_bf16_f32 v19, v22, v23
    v_cvt_pk_bf16_f32 v8, v0, v1
    v_exp_f32 v3, v15
    v_mfma_f32_16x16x16_bf16 v[20:23], v[18:19], v[6:7], 0
    v_cvt_pk_bf16_f32 v9, v2, v3
    v_mov_b32_dpp v10, v8 row_ror:8 row_mask:0xf bank_mask:0xf
    v_max3_f32 v4, |v12|, |v13|, |v14|
    v_mov_b32_dpp v11, v9 row_ror:8 row_mask:0xf bank_mask:0xf
    v_mfma_f32_16x16x32_bf16 v[0:3], v[24:27], v[6:9], 0
    v_max3_f32 v4, v4, |v15|, |v56|
    v_max_f32_e64 v4, v4, |v57|
    v_mfma_f32_16x16x32_bf16 v[28:31], v[40:43], v[8:11], v[28:31]
    v_cmp_nge_f32 vcc, s46, v4
    v_mfma_f32_16x16x32_bf16 v[20:23], v[44:47], v[8:11], v[20:23]
    v_add_f32_dpp v0, v0, v0 row_ror:8 row_mask:0xf bank_mask:0xf
    v_rcp_f32 v0, v0
    s_cbranch_vccnz cs_guard
cs_norm:
    v_mfma_f32_16x16x16_bf16 v[12:15], v[72:73], v[72:73], 0
    v_mul_f32 v28, v28, v0
    v_mul_f32 v29, v29, v0
    v_mul_f32 v30, v30, v0
    v_mul_f32 v31, v31, v0
    v_mul_f32_dpp v28, v20, v0 row_ror:8 row_mask:0xf bank_mask:0xc
    v_mul_f32_dpp v29, v21, v0 row_ror:8 row_mask:0xf bank_mask:0xc
    v_mul_f32_dpp v30, v22, v0 row_ror:8 row_mask:0xf bank_mask:0xc
    v_mul_f32_dpp v31, v23, v0 row_ror:8 row_mask:0xf bank_mask:0xc
    v_cvt_pk_bf16_f32 v28, v28, v29
    v_cvt_pk_bf16_f32 v29, v30, v31
    v_mfma_f32_16x16x16_bf16 v[8:11], v[72:73], v[72:73], 0
    ds_write_b64 v77, v[28:29]
    v_mfma_f32_16x16x16_bf16 v[4:7], v[72:73], v[72:73], 0
    ds_read_b128 v[0:3], v68
    v_mfma_f32_16x16x16_bf16 v[16:19], v[72:73], v[72:73], 0
    ds_read_b128 v[40:43], v63 offset:16384
    v_mfma_f32_16x16x16_bf16 v[20:23], v[72:73], v[72:73], 0
    ds_read_b128 v[44:47], v63 offset:20480
    s_waitcnt lgkmcnt(3)
    s_barrier
    ds_read_b128 v[24:27], v74
    ds_read_b128 v[28:31], v75
    ds_read_b128 v[56:59], v76
    s_waitcnt lgkmcnt(5)
    v_smfmac_f32_16x16x64_bf16 v[12:15], v[0:3], v[160:167], v60
    v_smfmac_f32_16x16x64_bf16 v[8:11], v[0:3], v[192:199], v60
    v_smfmac_f32_16x16x64_bf16 v[4:7], v[0:3], v[32:39], v60
    ds_read_b128 v[32:35], v63 offset:32768
    v_smfmac_f32_16x16x64_bf16 v[16:19], v[0:3], v[224:231], v60
    ds_read_b128 v[36:39], v63 offset:36864
    s_waitcnt lgkmcnt(3)
    v_smfmac_f32_16x16x64_bf16 v[12:15], v[24:27], v[168:175], v60
    v_smfmac_f32_16x16x64_bf16 v[4:7], v[28:31], v[48:55], v60
    ds_read_b128 v[48:51], v63 offset:24576
    v_smfmac_f32_16x16x64_bf16 v[12:15], v[28:31], v[176:183], v60
    ds_read_b128 v[52:55], v63 offset:28672
    s_waitcnt lgkmcnt(4)
    v_smfmac_f32_16x16x64_bf16 v[12:15], v[56:59], v[184:191], v60
    v_cvt_pk_bf16_f32 v4, v4, v5
    v_smfmac_f32_16x16x64_bf16 v[16:19], v[28:31], v[40:47], v60
    ds_read_b128 v[40:43], v63 offset:40960
    v_and_or_b32 v4, v4, -2, s30
    v_smfmac_f32_16x16x64_bf16 v[8:11], v[24:27], v[200:207], v60
    ds_read_b128 v[44:47], v63 offset:45056
    v_cvt_pk_bf16_f32 v5, v6, v7
    v_smfmac_f32_16x16x64_bf16 v[8:11], v[28:31], v[208:215], v60
    buffer_store_dwordx2 v[4:5], v67, s[4:7], s22 offen sc1
    v_cvt_pk_bf16_f32 v12, v12, v13
    v_smfmac_f32_16x16x64_bf16 v[8:11], v[56:59], v[216:223], v60
    v_and_or_b32 v12, v12, -2, s30
    v_smfmac_f32_16x16x64_bf16 v[16:19], v[24:27], v[232:239], v60
    v_cvt_pk_bf16_f32 v13, v14, v15
    s_waitcnt lgkmcnt(4)
    v_smfmac_f32_16x16x64_bf16 v[16:19], v[56:59], v[32:39], v60
    buffer_store_dwordx2 v[12:13], v66, s[4:7], s20 offen sc1
    v_cvt_pk_bf16_f32 v8, v8, v9
    s_waitcnt lgkmcnt(0)
    v_smfmac_f32_16x16x64_bf16 v[20:23], v[0:3], v[240:247], v60
    v_and_or_b32 v8, v8, -2, s30
    v_smfmac_f32_16x16x64_bf16 v[20:23], v[24:27], v[248:255], v60
    v_cvt_pk_bf16_f32 v9, v10, v11
    v_smfmac_f32_16x16x64_bf16 v[20:23], v[28:31], v[48:55], v60
    buffer_store_dwordx2 v[8:9], v66, s[4:7], s21 offen sc1
    v_cvt_pk_bf16_f32 v16, v16, v17
    v_smfmac_f32_16x16x64_bf16 v[20:23], v[56:59], v[40:47], v60
    v_and_or_b32 v16, v16, -2, s30
    v_cvt_pk_bf16_f32 v17, v18, v19
    buffer_store_dwordx2 v[16:17], v66, s[4:7], s38 offen sc1
    s_cmp_lg_u32 s13, 2
    s_nop 1
    v_cvt_pk_bf16_f32 v20, v20, v21
    v_and_or_b32 v20, v20, -2, s30
    v_cvt_pk_bf16_f32 v21, v22, v23
    buffer_store_dwordx2 v[20:21], v66, s[4:7], s39 offen sc1
    s_cbranch_scc1 cs_w013
    s_nop 15
    s_nop 15
    s_nop 15
    s_nop 15
    s_nop 15
    s_nop 15
    s_nop 15
    s_nop 15
    s_nop 15
    s_nop 15
    s_nop 15
    s_nop 15
    s_nop 7
    buffer_load_dwordx4 v[40:43], v65, s[4:7], s19 offen offset:0 sc1
    buffer_load_dwordx4 v[44:47], v65, s[4:7], s19 offen offset:1024 sc1
    buffer_load_dwordx4 v[48:51], v65, s[4:7], s19 offen offset:2048 sc1
    buffer_load_dwordx4 v[52:55], v65, s[4:7], s19 offen offset:3072 sc1
    ds_read_b128 v[56:59], v65 offset:10240
    s_add_u32 s28, s28, 1
    s_mov_b32 s14, s41
    s_add_u32 s23, s23, 524288
    s_add_u32 s24, s24, 524288
    s_min_u32 s24, s24, s47
    s_add_u32 s15, s14, 4096
    s_add_u32 s16, s14, 8192
    v_mov_b32 v21, -1
    s_add_u32 s65, s65, 12288
    s_mov_b32 s40, 1
    v_mov_b64 v[0:1], 0
    v_mov_b64 v[2:3], 0
    v_mov_b64 v[4:5], 0
    v_mov_b64 v[6:7], 0
    v_mov_b64 v[8:9], 0
    v_mov_b64 v[10:11], 0
    v_mov_b64 v[12:13], 0
    v_mov_b64 v[14:15], 0
cs_chkF:
    v_mov_b32 v20, 0
    s_waitcnt vmcnt(3)
    s_waitcnt lgkmcnt(0)
    v_mfma_f32_16x16x32_bf16 v[28:31], v[40:43], v[56:59], 0
    v_bitop3_b32 v20, v20, v40, s30 bitop3:0xf6
    v_bitop3_b32 v20, v20, v42, s30 bitop3:0xf6
    s_waitcnt vmcnt(2)
    v_mfma_f32_16x16x32_bf16 v[28:31], v[44:47], v[56:59], v[28:31]
    v_bitop3_b32 v20, v20, v44, s30 bitop3:0xf6
    v_bitop3_b32 v20, v20, v46, s30 bitop3:0xf6
    s_waitcnt vmcnt(1)
    v_mfma_f32_16x16x32_bf16 v[28:31], v[48:51], v[56:59], v[28:31]
    v_bitop3_b32 v20, v20, v48, s30 bitop3:0xf6
    v_bitop3_b32 v20, v20, v50, s30 bitop3:0xf6
    s_waitcnt vmcnt(0)
    v_mfma_f32_16x16x32_bf16 v[28:31], v[52:55], v[56:59], v[28:31]
    v_bitop3_b32 v20, v20, v52, s30 bitop3:0xf6
    v_bitop3_b32 v20, v20, v54, s30 bitop3:0xf6
    v_and_b32 v20, s40, v20
    v_cmp_ne_u32 vcc, 0, v20
    s_cbranch_vccnz cs_spinF
    v_permlane32_swap_b32 v28, v30
    v_permlane32_swap_b32 v29, v31
    v_add_f32 v28, v28, v30
    v_add_f32 v30, v29, v31
    v_cvt_pk_bf16_f32 v28, v28, v30
    s_mov_b64 exec, s[32:33]
    buffer_store_dword v28, v69, s[4:7], s17 offen sc1
    buffer_store_dword v21, v69, s[4:7], s18 offen sc1
    s_mov_b64 exec, -1
    ds_read_b128 v[32:35], v62 offset:16384
    ds_read_b128 v[36:39], v62 offset:20480
    ds_read_b128 v[40:43], v61 offset:0
    ds_read_b128 v[44:47], v61 offset:4096
    ds_read_b128 v[48:51], v61 offset:8192
    ds_read_b128 v[52:55], v61 offset:12288
    s_nop 15
    s_nop 15
    s_nop 15
    s_nop 15
    s_nop 15
    s_nop 15
    s_nop 3
    buffer_load_dwordx4 v[24:27], v61, s[4:7], s14 offen sc1
    s_branch cs_loop2
cs_w013:
    ds_read_b128 v[56:59], v65 offset:10240
    ds_read_b128 v[32:35], v62 offset:16384
    ds_read_b128 v[36:39], v62 offset:20480
    ds_read_b128 v[40:43], v61 offset:0
    ds_read_b128 v[44:47], v61 offset:4096
    ds_read_b128 v[48:51], v61 offset:8192
    ds_read_b128 v[52:55], v61 offset:12288
    s_add_u32 s28, s28, 1
    s_mov_b32 s14, s41
    s_add_u32 s23, s23, 524288
    s_add_u32 s24, s24, 524288
    s_min_u32 s24, s24, s47
    s_add_u32 s15, s14, 4096
    s_add_u32 s16, s14, 8192
    v_mov_b32 v21, -1
    s_add_u32 s65, s65, 12288
    s_mov_b32 s40, 1
    s_cmp_eq_u32 s64, 0
    s_cbranch_scc1 cs_w0
    s_cmp_eq_u32 s13, 1
    s_cbranch_scc1 cs_sx
    s_nop 15
    s_nop 15
    s_nop 15
    s_nop 15
    s_nop 15
    s_nop 15
    s_nop 15
    s_nop 15
    s_nop 15
    s_nop 15
    s_nop 15
    s_nop 15
    s_nop 7
cs_sx:
    buffer_load_dwordx4 v[0:3], v65, s[4:7], s19 offen offset:0 sc1
    buffer_load_dwordx4 v[4:7], v65, s[4:7], s19 offen offset:1024 sc1
    buffer_load_dwordx4 v[8:11], v65, s[4:7], s19 offen offset:2048 sc1
    buffer_load_dwordx4 v[12:15], v65, s[4:7], s19 offen offset:3072 sc1
cs_chkG:
    v_mov_b32 v20, 0
    s_waitcnt vmcnt(3)
    s_waitcnt lgkmcnt(6)
    v_mfma_f32_16x16x32_bf16 v[28:31], v[0:3], v[56:59], 0
    v_bitop3_b32 v20, v20, v0, s30 bitop3:0xf6
    v_bitop3_b32 v20, v20, v2, s30 bitop3:0xf6
    s_waitcnt vmcnt(2)
    v_mfma_f32_16x16x32_bf16 v[28:31], v[4:7], v[56:59], v[28:31]
    v_bitop3_b32 v20, v20, v4, s30 bitop3:0xf6
    v_bitop3_b32 v20, v20, v6, s30 bitop3:0xf6
    s_waitcnt vmcnt(1)
    v_mfma_f32_16x16x32_bf16 v[28:31], v[8:11], v[56:59], v[28:31]
    v_bitop3_b32 v20, v20, v8, s30 bitop3:0xf6
    v_bitop3_b32 v20, v20, v10, s30 bitop3:0xf6
    s_waitcnt vmcnt(0)
    v_mfma_f32_16x16x32_bf16 v[28:31], v[12:15], v[56:59], v[28:31]
    v_bitop3_b32 v20, v20, v12, s30 bitop3:0xf6
    v_bitop3_b32 v20, v20, v14, s30 bitop3:0xf6
    v_and_b32 v20, s40, v20
    v_cmp_ne_u32 vcc, 0, v20
    s_cbranch_vccnz cs_spinG
    v_permlane32_swap_b32 v28, v30
    v_permlane32_swap_b32 v29, v31
    v_add_f32 v28, v28, v30
    v_add_f32 v30, v29, v31
    s_cmp_eq_u32 s13, 3
    s_cbranch_scc1 cs_w3
    v_mov_b32 v29, v28
    v_mov_b32 v31, v30
    s_nop 0
    v_permlane16_swap_b32 v28, v29
    v_permlane16_swap_b32 v30, v31
    v_add_f32 v28, v28, v29
    v_add_f32 v30, v30, v31
cs_w3:
    v_cvt_pk_bf16_f32 v28, v28, v30
    s_mov_b64 exec, s[32:33]
    buffer_store_dword v28, v69, s[4:7], s17 offen sc1
    buffer_store_dword v21, v69, s[4:7], s18 offen sc1
    s_mov_b64 exec, -1
    buffer_load_dwordx4 v[24:27], v61, s[4:7], s14 offen sc1
    s_branch cs_loop
cs_w0:
    v_mov_b64 v[0:1], 0
    v_mov_b64 v[2:3], 0
    v_mov_b64 v[4:5], 0
    v_mov_b64 v[6:7], 0
    v_mov_b64 v[8:9], 0
    v_mov_b64 v[10:11], 0
    v_mov_b64 v[12:13], 0
    v_mov_b64 v[14:15], 0
    s_cmp_lg_u32 s28, 10
    s_cbranch_scc1 cs_nokv
    s_lshr_b32 s92, s12, 1
    s_lshl_b32 s92, s92, 8
    s_add_u32 s92, s92, 125829120
    v_bfe_u32 v28, v61, 4, 6
    v_min_u32 v28, 11, v28
    v_lshlrev_b32 v28, 2, v28
    s_add_u32 s93, s95, 63
    s_mov_b32 s94, 4194304
cs_kv1:
    buffer_load_dword v29, v28, s[4:7], s92 offen sc1
    s_sub_u32 s94, s94, 1
    s_cbranch_scc1 cs_kv1_go
    s_waitcnt vmcnt(0)
    v_subrev_u32 v29, s93, v29
    v_cmp_lt_u32 vcc, 64, v29
    s_cbranch_vccz cs_kv1_go
    s_sleep 2
    s_branch cs_kv1
cs_kv1_go:
cs_nokv:
    s_nop 15
    s_nop 15
    s_nop 15
    s_nop 15
    s_nop 15
    s_nop 15
    s_nop 15
    s_nop 15
    s_nop 15
    s_nop 15
    s_nop 15
    s_nop 15
    s_nop 15
    s_nop 15
    s_nop 15
    s_nop 15
    s_nop 15
    s_nop 15
    s_nop 15
    s_nop 15
    s_nop 15
    s_nop 15
    s_nop 15
    s_nop 15
    s_nop 15
    buffer_load_dwordx4 v[24:27], v61, s[4:7], s14 offen sc1
    s_branch cs_loop2
cs_spinF:
    buffer_load_dwordx4 v[40:43], v65, s[4:7], s19 offen offset:0 sc1
    buffer_load_dwordx4 v[44:47], v65, s[4:7], s19 offen offset:1024 sc1
    buffer_load_dwordx4 v[48:51], v65, s[4:7], s19 offen offset:2048 sc1
    buffer_load_dwordx4 v[52:55], v65, s[4:7], s19 offen offset:3072 sc1
    s_sub_u32 s29, s29, 1
    s_cmp_lt_i32 s29, 0
    s_cselect_b32 s40, 0, 1
    s_branch cs_chkF
cs_spinG:
    buffer_load_dwordx4 v[0:3], v65, s[4:7], s19 offen offset:0 sc1
    buffer_load_dwordx4 v[4:7], v65, s[4:7], s19 offen offset:1024 sc1
    buffer_load_dwordx4 v[8:11], v65, s[4:7], s19 offen offset:2048 sc1
    buffer_load_dwordx4 v[12:15], v65, s[4:7], s19 offen offset:3072 sc1
    s_sub_u32 s29, s29, 1
    s_cmp_lt_i32 s29, 0
    s_cselect_b32 s40, 0, 1
    s_branch cs_chkG
cs_guard:
    s_cbranch_scc0 cs_guard2
    buffer_store_dwordx4 v[16:19], v61, s[4:7], s26 offen sc1
    s_add_u32 s26, s26, 131072
cs_guard2:
    s_nop 7
    v_max3_f32 v6, v12, v13, v14
    v_max3_f32 v7, v15, v56, v57
    v_max_f32 v6, v6, v7
    s_nop 1
    v_max_f32_dpp v6, v6, v6 row_ror:8 row_mask:0xf bank_mask:0xf
    v_mov_b32 v7, v6
    s_nop 1
    v_permlane32_swap_b32 v6, v7
    v_max_f32 v6, v6, v7
    v_mov_b32 v7, v6
    s_nop 1
    v_permlane16_swap_b32 v6, v7
    v_max_f32 v6, v6, v7
    v_sub_f32 v12, v12, v6
    v_sub_f32 v13, v13, v6
    v_sub_f32 v14, v14, v6
    v_sub_f32 v15, v15, v6
    v_sub_f32 v56, v56, v6
    v_sub_f32 v57, v57, v6
    v_exp_f32 v58, v56
    v_exp_f32 v59, v57
    s_nop 0
    v_cvt_pk_bf16_f32 v6, v58, v59
    s_nop 1
    v_mov_b32_dpp v7, v6 row_ror:8 row_mask:0xf bank_mask:0xf
    v_exp_f32 v0, v12
    s_nop 0
    v_mfma_f32_16x16x16_bf16 v[28:31], v[16:17], v[6:7], 0
    v_exp_f32 v1, v13
    v_exp_f32 v2, v14
    v_cvt_pk_bf16_f32 v8, v0, v1
    v_exp_f32 v3, v15
    v_mfma_f32_16x16x16_bf16 v[20:23], v[18:19], v[6:7], 0
    v_cvt_pk_bf16_f32 v9, v2, v3
    v_mov_b32_dpp v10, v8 row_ror:8 row_mask:0xf bank_mask:0xf
    v_max3_f32 v4, |v12|, |v13|, |v14|
    v_mov_b32_dpp v11, v9 row_ror:8 row_mask:0xf bank_mask:0xf
    v_mfma_f32_16x16x32_bf16 v[0:3], v[24:27], v[6:9], 0
    v_max3_f32 v4, v4, |v15|, |v56|
    v_max_f32_e64 v4, v4, |v57|
    v_mfma_f32_16x16x32_bf16 v[28:31], v[40:43], v[8:11], v[28:31]
    v_cmp_nge_f32 vcc, s46, v4
    v_mfma_f32_16x16x32_bf16 v[20:23], v[44:47], v[8:11], v[20:23]
    v_add_f32_dpp v0, v0, v0 row_ror:8 row_mask:0xf bank_mask:0xf
    v_rcp_f32 v0, v0
    s_nop 4
    s_branch cs_norm
cs_spin0:
    buffer_load_dwordx4 v[24:27], v61, s[4:7], s14 offen sc1
    s_sub_u32 s29, s29, 1
    s_cmp_lt_i32 s29, 0
    s_cbranch_scc0 cs_chk0
    s_waitcnt vmcnt(0)
    v_min_u32 v24, -2, v24
    v_min_u32 v25, -2, v25
    v_min_u32 v26, -2, v26
    v_min_u32 v27, -2, v27
    s_branch cs_chk0
cs_spin1:
    buffer_load_dwordx4 v[28:31], v61, s[4:7], s15 offen sc1
    buffer_load_dword v59, v56, s[4:7], s16 offen sc1
    s_sub_u32 s29, s29, 1
    s_cmp_lt_i32 s29, 0
    s_waitcnt vmcnt(0)
    v_max3_u32 v57, v28, v29, v30
    v_max3_u32 v57, v57, v31, v59
    v_cmp_eq_u32 vcc, -1, v57
    ds_write_b128 v62, v[28:31] offset:45056
    ds_write_b32 v58, v59
    s_waitcnt lgkmcnt(0)
    s_cbranch_scc1 cs_go1
    s_cbranch_vccnz cs_spin1
    s_branch cs_go1
cs_last:
    s_nop 1
    s_cmp_eq_u32 s28, 63
    s_cbranch_scc1 cs_last2
    s_mov_b64 exec, s[34:35]
    buffer_store_dwordx4 v[0:3], v61, s[4:7], s25 offen sc1
    s_mov_b64 exec, -1
    s_add_u32 s25, s25, 131072
    s_mov_b32 s46, 0xbf800000
    s_cmp_eq_u32 0, 0
    s_branch cs_back
cs_last2:
    s_waitcnt lgkmcnt(0)
    s_mov_b64 exec, s[34:35]
    buffer_store_dwordx4 v[0:3], v61, s[4:7], s25 offen sc1
    s_mov_b64 exec, -1
    s_add_u32 s40, s95, 64
    v_mov_b32 v32, s40
    v_smfmac_f32_16x16x64_bf16 v[20:23], v[24:27], v[152:159], v60
    v_smfmac_f32_16x16x64_bf16 v[16:19], v[48:51], a[208:215], v60
    v_smfmac_f32_16x16x64_bf16 v[20:23], v[48:51], a[216:223], v60
    v_smfmac_f32_16x16x64_bf16 v[16:19], v[52:55], a[240:247], v60
    v_smfmac_f32_16x16x64_bf16 v[20:23], v[52:55], a[248:255], v60
    s_nop 3
    v_cvt_pk_bf16_f32 v16, v16, v17
    v_cvt_pk_bf16_f32 v17, v18, v19
    s_nop 1
    v_cvt_pk_bf16_f32 v18, v20, v21
    v_cvt_pk_bf16_f32 v19, v22, v23
    buffer_store_dwordx4 v[16:19], v61, s[4:7], s26 offen sc1
    s_waitcnt vmcnt(0)
    s_mov_b64 exec, 1
    buffer_store_dword v32, off, s[4:7], s27 sc1
    s_mov_b64 exec, -1
    s_endpgm
cs_dma:
    s_xor_b32 s74, s76, s81
    s_add_u32 m0, s74, s80
    s_add_u32 s76, s76, 4096
    buffer_load_dwordx4 v58, s[8:11], s78 offen lds
    s_add_u32 s78, s78, s79
    s_cmp_lt_u32 s76, s77
    s_cbranch_scc1 cs_dma
    s_setpc_b64 s[82:83]
L_helper:
    s_load_dwordx16 s[64:79], s[0:1], 64
    s_sub_u32 s33, s3, 1
    s_and_b32 s33, s33, 7
L_pool:
    s_lshl_b32 s35, s33, 2
    s_add_u32 s35, s35, 32
    s_mov_b32 s37, s35
    v_mov_b32 v250, 1
    v_mov_b32 v251, 163832
    v_cmp_eq_u32 vcc, 0, v0
    s_nop 0
    s_and_saveexec_b64 s[38:39], vcc
    s_cbranch_execz tk4
    buffer_atomic_add v250, off, s[96:99], s37 sc0
    s_waitcnt vmcnt(0)
    ds_write_b32 v251, v250
    s_waitcnt lgkmcnt(0)
tk4:
    s_mov_b64 exec, -1
    s_barrier
    ds_read_b32 v252, v251
    s_waitcnt lgkmcnt(0)
    v_readfirstlane_b32 s34, v252
    s_barrier
    s_nop 3
    s_mov_b32 s36, s33
    s_or_b32 s33, s34, s32
    s_cmp_lg_u32 s33, 0
    s_cbranch_scc1 L_helper1
    s_memrealtime s[90:91]
    s_waitcnt lgkmcnt(0)
    s_lshl_b32 s90, s90, 8
    s_or_b32 s90, s90, 1
    v_mov_b32 v250, s90
    v_mov_b32 v251, 0
    s_mov_b64 exec, 1
    buffer_atomic_cmpswap v[250:251], off, s[96:99], 0 offset:64
    s_mov_b64 exec, -1
L_helper1:
    s_cmp_ge_u32 s34, 32
    s_cbranch_scc1 L_qkv_next
    s_cmp_ge_u32 s36, 7
    s_cbranch_scc1 L_qkv_next
    s_max_u32 s37, s36, 4
    s_sub_u32 s37, s37, 4
    s_mul_i32 s37, s37, 6
    s_lshl_b32 s38, s36, 1
    s_add_u32 s38, s38, s37
    s_cmp_lt_u32 s36, 4
    s_cselect_b32 s39, 2, 8
    s_mul_i32 s36, s36, 30
    s_sub_u32 s36, s36, s37
    s_cmp_lt_u32 s34, s39
    s_cbranch_scc1 L_copy
    s_add_u32 s36, s36, s34
    s_sub_u32 s36, s36, s39
    s_cmp_lg_u32 s95, 0
    s_cbranch_scc1 L_nowm
    s_mul_i32 s37, s36, 24576
    s_mov_b32 s14, 4718592
    s_mov_b32 s15, 0x20000
    s_mov_b32 m0, 155648
    v_lshlrev_b32 v1, 7, v0
    v_min_u32 v1, 24448, v1
    s_mov_b64 s[12:13], s[58:59]
    buffer_load_dword v1, s[12:15], s37 offen lds
    s_mov_b64 s[12:13], s[52:53]
    buffer_load_dword v1, s[12:15], s37 offen lds
L_nowm:
    s_mul_i32 s37, s36, 171
    s_lshr_b32 s37, s37, 10
    s_mul_i32 s38, s37, 6
    s_sub_u32 s36, s36, s38
    s_lshl_b32 s36, s36, 5
    s_add_u32 s36, s36, s37
    s_branch L_job
L_copy:
    s_add_u32 s36, s38, s34
    s_mul_i32 s36, s36, 11
    s_and_b32 s36, s36, 31
    s_cmp_ge_u32 s36, 27
    s_cbranch_scc1 L_qkv_next
    s_mul_i32 s33, s36, 57
    s_lshr_b32 s33, s33, 9
    s_mul_i32 s37, s33, 9
    s_sub_u32 s37, s36, s37
    s_lshl_b32 s36, s37, 2
    s_add_u32 s36, s36, 1
    s_min_u32 s36, s36, 31
    s_lshr_b32 s39, s52, 8
    s_sub_u32 s36, s36, s39
    s_and_b32 s36, s36, 31
    s_lshl_b32 s36, s36, 8
    s_mov_b32 s14, 4718592
    s_mov_b32 s15, 0x20000
    v_lshrrev_b32 v1, 4, v0
    v_lshlrev_b32 v1, 13, v1
    v_and_b32 v2, 15, v0
    v_lshl_add_u32 v1, v2, 4, v1
    v_lshlrev_b32 v2, 4, v0
    s_lshl_b32 s40, s33, 1
    s_mul_i32 s39, s40, 49152
    s_lshl_b32 s41, s37, 19
    s_add_u32 s39, s39, s41
    s_add_u32 s39, s39, 96468992
    s_add_u32 s41, s40, 0
    s_cmp_lt_u32 s41, 3
    s_cselect_b64 s[12:13], s[52:53], s[54:55]
    s_cselect_b32 s42, 0, 3
    s_sub_u32 s41, s41, s42
    s_mul_i32 s38, s41, 1572864
    s_add_u32 s38, s38, s36
    buffer_load_dwordx4 v[8:11], v1, s[12:15], s38 offen
    s_add_u32 s38, s38, 131072
    buffer_load_dwordx4 v[12:15], v1, s[12:15], s38 offen
    s_add_u32 s38, s38, 131072
    buffer_load_dwordx4 v[16:19], v1, s[12:15], s38 offen
    s_add_u32 s38, s38, 131072
    buffer_load_dwordx4 v[20:23], v1, s[12:15], s38 offen
    s_add_u32 s38, s38, 131072
    buffer_load_dwordx4 v[24:27], v1, s[12:15], s38 offen
    s_add_u32 s38, s38, 131072
    buffer_load_dwordx4 v[28:31], v1, s[12:15], s38 offen
    s_add_u32 s38, s38, 131072
    buffer_load_dwordx4 v[32:35], v1, s[12:15], s38 offen
    s_add_u32 s38, s38, 131072
    buffer_load_dwordx4 v[36:39], v1, s[12:15], s38 offen
    s_add_u32 s38, s38, 131072
    buffer_load_dwordx4 v[40:43], v1, s[12:15], s38 offen
    s_add_u32 s38, s38, 131072
    buffer_load_dwordx4 v[44:47], v1, s[12:15], s38 offen
    s_add_u32 s38, s38, 131072
    buffer_load_dwordx4 v[48:51], v1, s[12:15], s38 offen
    s_add_u32 s38, s38, 131072
    buffer_load_dwordx4 v[52:55], v1, s[12:15], s38 offen
    s_add_u32 s38, s38, 131072
    s_add_u32 s41, s40, 1
    s_cmp_lt_u32 s41, 3
    s_cselect_b64 s[12:13], s[52:53], s[54:55]
    s_cselect_b32 s42, 0, 3
    s_sub_u32 s41, s41, s42
    s_mul_i32 s38, s41, 1572864
    s_add_u32 s38, s38, s36
    buffer_load_dwordx4 v[56:59], v1, s[12:15], s38 offen
    s_add_u32 s38, s38, 131072
    buffer_load_dwordx4 v[60:63], v1, s[12:15], s38 offen
    s_add_u32 s38, s38, 131072
    buffer_load_dwordx4 v[64:67], v1, s[12:15], s38 offen
    s_add_u32 s38, s38, 131072
    buffer_load_dwordx4 v[68:71], v1, s[12:15], s38 offen
    s_add_u32 s38, s38, 131072
    buffer_load_dwordx4 v[72:75], v1, s[12:15], s38 offen
    s_add_u32 s38, s38, 131072
    buffer_load_dwordx4 v[76:79], v1, s[12:15], s38 offen
    s_add_u32 s38, s38, 131072
    buffer_load_dwordx4 v[80:83], v1, s[12:15], s38 offen
    s_add_u32 s38, s38, 131072
    buffer_load_dwordx4 v[84:87], v1, s[12:15], s38 offen
    s_add_u32 s38, s38, 131072
    buffer_load_dwordx4 v[88:91], v1, s[12:15], s38 offen
    s_add_u32 s38, s38, 131072
    buffer_load_dwordx4 v[92:95], v1, s[12:15], s38 offen
    s_add_u32 s38, s38, 131072
    buffer_load_dwordx4 v[96:99], v1, s[12:15], s38 offen
    s_add_u32 s38, s38, 131072
    buffer_load_dwordx4 v[100:103], v1, s[12:15], s38 offen
    s_add_u32 s38, s38, 131072
    buffer_load_dword v3, off, s[96:99], 0 offset:64 sc1
    s_waitcnt vmcnt(0)
    buffer_store_dwordx4 v[8:11], v2, s[4:7], s39 offen sc1
    s_add_u32 s39, s39, 4096
    buffer_store_dwordx4 v[12:15], v2, s[4:7], s39 offen sc1
    s_add_u32 s39, s39, 4096
    buffer_store_dwordx4 v[16:19], v2, s[4:7], s39 offen sc1
    s_add_u32 s39, s39, 4096
    buffer_store_dwordx4 v[20:23], v2, s[4:7], s39 offen sc1
    s_add_u32 s39, s39, 4096
    buffer_store_dwordx4 v[24:27], v2, s[4:7], s39 offen sc1
    s_add_u32 s39, s39, 4096
    buffer_store_dwordx4 v[28:31], v2, s[4:7], s39 offen sc1
    s_add_u32 s39, s39, 4096
    buffer_store_dwordx4 v[32:35], v2, s[4:7], s39 offen sc1
    s_add_u32 s39, s39, 4096
    buffer_store_dwordx4 v[36:39], v2, s[4:7], s39 offen sc1
    s_add_u32 s39, s39, 4096
    buffer_store_dwordx4 v[40:43], v2, s[4:7], s39 offen sc1
    s_add_u32 s39, s39, 4096
    buffer_store_dwordx4 v[44:47], v2, s[4:7], s39 offen sc1
    s_add_u32 s39, s39, 4096
    buffer_store_dwordx4 v[48:51], v2, s[4:7], s39 offen sc1
    s_add_u32 s39, s39, 4096
    buffer_store_dwordx4 v[52:55], v2, s[4:7], s39 offen sc1
    s_add_u32 s39, s39, 4096
    buffer_store_dwordx4 v[56:59], v2, s[4:7], s39 offen sc1
    s_add_u32 s39, s39, 4096
    buffer_store_dwordx4 v[60:63], v2, s[4:7], s39 offen sc1
    s_add_u32 s39, s39, 4096
    buffer_store_dwordx4 v[64:67], v2, s[4:7], s39 offen sc1
    s_add_u32 s39, s39, 4096
    buffer_store_dwordx4 v[68:71], v2, s[4:7], s39 offen sc1
    s_add_u32 s39, s39, 4096
    buffer_store_dwordx4 v[72:75], v2, s[4:7], s39 offen sc1
    s_add_u32 s39, s39, 4096
    buffer_store_dwordx4 v[76:79], v2, s[4:7], s39 offen sc1
    s_add_u32 s39, s39, 4096
    buffer_store_dwordx4 v[80:83], v2, s[4:7], s39 offen sc1
    s_add_u32 s39, s39, 4096
    buffer_store_dwordx4 v[84:87], v2, s[4:7], s39 offen sc1
    s_add_u32 s39, s39, 4096
    buffer_store_dwordx4 v[88:91], v2, s[4:7], s39 offen sc1
    s_add_u32 s39, s39, 4096
    buffer_store_dwordx4 v[92:95], v2, s[4:7], s39 offen sc1
    s_add_u32 s39, s39, 4096
    buffer_store_dwordx4 v[96:99], v2, s[4:7], s39 offen sc1
    s_add_u32 s39, s39, 4096
    buffer_store_dwordx4 v[100:103], v2, s[4:7], s39 offen sc1
    s_add_u32 s39, s39, 4096
    v_readfirstlane_b32 s95, v3
    s_nop 4
    s_mov_b32 s88, 4194304
gn5:
    s_cmp_lg_u32 s95, 0
    s_cbranch_scc1 gn5x
    buffer_load_dword v3, off, s[96:99], 0 offset:64 sc1
    s_sub_u32 s88, s88, 1
    s_cbranch_scc1 gn5x
    s_waitcnt vmcnt(0)
    v_readfirstlane_b32 s95, v3
    s_nop 1
    s_branch gn5
gn5x:
    s_lshl_b32 s37, s37, 7
    s_lshl_b32 s36, s33, 2
    s_add_u32 s36, s36, s32
    s_lshl_b32 s36, s36, 2
    s_add_u32 s37, s37, s36
    s_add_u32 s37, s37, 125853696
    v_mov_b32 v3, s95
    s_waitcnt vmcnt(0)
    s_mov_b64 exec, 1
    buffer_store_dword v3, off, s[4:7], s37 sc1
    s_mov_b64 exec, -1
L_qkv_next:
    s_mov_b32 s37, 4
    v_mov_b32 v250, 1
    v_mov_b32 v251, 163832
    v_cmp_eq_u32 vcc, 0, v0
    s_nop 0
    s_and_saveexec_b64 s[38:39], vcc
    s_cbranch_execz tk6
    buffer_atomic_add v250, off, s[96:99], s37 sc0
    s_waitcnt vmcnt(0)
    ds_write_b32 v251, v250
    s_waitcnt lgkmcnt(0)
tk6:
    s_mov_b64 exec, -1
    s_barrier
    ds_read_b32 v252, v251
    s_waitcnt lgkmcnt(0)
    v_readfirstlane_b32 s36, v252
    s_barrier
    s_nop 3
    s_add_u32 s36, s36, 192
    s_cmp_ge_u32 s36, 320
    s_cbranch_scc1 L_ssm_next
L_job:
    s_and_b32 s17, s36, 15
    s_lshl_b32 s17, s17, 1
    s_bfe_u32 s16, s36, 0x10004
    s_lshr_b32 s19, s36, 5
    s_mul_i32 s33, s16, 6
    s_add_u32 s33, s33, s19
    s_add_u32 s16, s16, 1
    s_lshr_b32 s37, s36, 4
    s_sub_u32 s38, s37, 12
    s_cmp_ge_u32 s36, 192
    s_cselect_b32 s16, 0, s16
    s_cselect_b32 s19, s38, s19
    s_cselect_b32 s33, s37, s33
    s_cselect_b32 s20, 8, 6
    v_lshrrev_b32 v4, 6, v0
    s_nop 0
    v_readfirstlane_b32 s18, v4
    v_lshlrev_b32 v7, 4, v0
    v_and_b32 v4, 63, v0
    v_lshrrev_b32 v6, 2, v4
    v_lshlrev_b32 v6, 13, v6
    v_lshrrev_b32 v5, 4, v4
    v_and_b32 v5, 2, v5
    v_xor_b32 v5, v5, v4
    v_and_b32 v5, 3, v5
    v_lshl_add_u32 v6, v5, 4, v6
    v_lshrrev_b32 v24, 4, v4
    v_lshlrev_b32 v24, 9, v24
    v_bfe_u32 v5, v4, 2, 2
    v_lshl_add_u32 v24, v5, 6, v24
    v_bfe_u32 v5, v4, 4, 1
    v_lshl_add_u32 v24, v5, 5, v24
    v_and_b32 v5, 3, v4
    v_lshl_add_u32 v24, v5, 3, v24
    s_lshl_b32 s31, s18, 12
    v_add_u32 v24, s31, v24
    s_cmp_eq_u32 s16, 1
    s_cselect_b64 s[12:13], s[54:55], s[52:53]
    s_cmp_eq_u32 s16, 2
    s_cselect_b64 s[12:13], s[56:57], s[12:13]
    s_mov_b32 s14, 4718592
    s_mov_b32 s15, 0x20000
    s_lshl_b32 s28, s17, 8
    s_lshl_b32 s21, s18, 6
    s_add_u32 s28, s28, s21
    s_add_u32 s21, s28, 0
    s_add_u32 m0, s31, 40960
    s_nop 0
    buffer_load_dwordx4 v6, s[12:15], s21 offen lds
    s_add_u32 m0, s31, 41984
    s_add_u32 s21, s21, 131072
    buffer_load_dwordx4 v6, s[12:15], s21 offen lds
    s_add_u32 m0, s31, 43008
    s_add_u32 s21, s21, 131072
    buffer_load_dwordx4 v6, s[12:15], s21 offen lds
    s_add_u32 m0, s31, 44032
    s_add_u32 s21, s21, 131072
    buffer_load_dwordx4 v6, s[12:15], s21 offen lds
    s_add_u32 s21, s28, 256
    s_add_u32 m0, s31, 57344
    s_nop 0
    buffer_load_dwordx4 v6, s[12:15], s21 offen lds
    s_add_u32 m0, s31, 58368
    s_add_u32 s21, s21, 131072
    buffer_load_dwordx4 v6, s[12:15], s21 offen lds
    s_add_u32 m0, s31, 59392
    s_add_u32 s21, s21, 131072
    buffer_load_dwordx4 v6, s[12:15], s21 offen lds
    s_add_u32 m0, s31, 60416
    s_add_u32 s21, s21, 131072
    buffer_load_dwordx4 v6, s[12:15], s21 offen lds
    s_add_u32 s21, s28, 524288
    s_add_u32 m0, s31, 73728
    s_nop 0
    buffer_load_dwordx4 v6, s[12:15], s21 offen lds
    s_add_u32 m0, s31, 74752
    s_add_u32 s21, s21, 131072
    buffer_load_dwordx4 v6, s[12:15], s21 offen lds
    s_add_u32 m0, s31, 75776
    s_add_u32 s21, s21, 131072
    buffer_load_dwordx4 v6, s[12:15], s21 offen lds
    s_add_u32 m0, s31, 76800
    s_add_u32 s21, s21, 131072
    buffer_load_dwordx4 v6, s[12:15], s21 offen lds
    s_add_u32 s21, s28, 524544
    s_add_u32 m0, s31, 90112
    s_nop 0
    buffer_load_dwordx4 v6, s[12:15], s21 offen lds
    s_add_u32 m0, s31, 91136
    s_add_u32 s21, s21, 131072
    buffer_load_dwordx4 v6, s[12:15], s21 offen lds
    s_add_u32 m0, s31, 92160
    s_add_u32 s21, s21, 131072
    buffer_load_dwordx4 v6, s[12:15], s21 offen lds
    s_add_u32 m0, s31, 93184
    s_add_u32 s21, s21, 131072
    buffer_load_dwordx4 v6, s[12:15], s21 offen lds
    s_add_u32 s21, s28, 1048576
    s_add_u32 m0, s31, 106496
    s_nop 0
    buffer_load_dwordx4 v6, s[12:15], s21 offen lds
    s_add_u32 m0, s31, 107520
    s_add_u32 s21, s21, 131072
    buffer_load_dwordx4 v6, s[12:15], s21 offen lds
    s_add_u32 m0, s31, 108544
    s_add_u32 s21, s21, 131072
    buffer_load_dwordx4 v6, s[12:15], s21 offen lds
    s_add_u32 m0, s31, 109568
    s_add_u32 s21, s21, 131072
    buffer_load_dwordx4 v6, s[12:15], s21 offen lds
    s_add_u32 s21, s28, 1048832
    s_add_u32 m0, s31, 122880
    s_nop 0
    buffer_load_dwordx4 v6, s[12:15], s21 offen lds
    s_add_u32 m0, s31, 123904
    s_add_u32 s21, s21, 131072
    buffer_load_dwordx4 v6, s[12:15], s21 offen lds
    s_add_u32 m0, s31, 124928
    s_add_u32 s21, s21, 131072
    buffer_load_dwordx4 v6, s[12:15], s21 offen lds
    s_add_u32 m0, s31, 125952
    s_add_u32 s21, s21, 131072
    buffer_load_dwordx4 v6, s[12:15], s21 offen lds
    s_add_u32 s21, s28, 1572864
    s_add_u32 m0, s31, 139264
    s_nop 0
    buffer_load_dwordx4 v6, s[12:15], s21 offen lds
    s_add_u32 m0, s31, 140288
    s_add_u32 s21, s21, 131072
    buffer_load_dwordx4 v6, s[12:15], s21 offen lds
    s_add_u32 m0, s31, 141312
    s_add_u32 s21, s21, 131072
    buffer_load_dwordx4 v6, s[12:15], s21 offen lds
    s_add_u32 m0, s31, 142336
    s_add_u32 s21, s21, 131072
    buffer_load_dwordx4 v6, s[12:15], s21 offen lds
    v_and_b32 v5, 15, v4
    v_lshrrev_b32 v3, 4, v4
    v_lshrrev_b32 v2, 2, v5
    v_xor_b32 v3, v3, v2
    v_lshl_add_u32 v3, v5, 2, v3
    v_lshlrev_b32 v1, 4, v3
    v_lshrrev_b32 v5, 2, v4
    v_lshrrev_b32 v3, 4, v4
    v_and_b32 v4, 3, v4
    v_xor_b32 v4, v4, v3
    v_lshlrev_b32 v3, 3, v3
    v_and_b32 v5, 3, v5
    v_add_u32 v3, v3, v5
    v_mul_u32_u24 v2, 1152, v3
    v_lshl_add_u32 v2, v4, 4, v2
    s_mov_b32 s8, s48
    s_mov_b32 s9, s49
    s_mov_b32 s10, 2359296
    s_mov_b32 s11, 0x20000
    s_lshr_b32 s22, s18, 1
    s_mul_i32 s24, s22, 4608
    s_and_b32 s22, s18, 1
    s_mul_i32 s23, s22, 576
    s_add_u32 s24, s24, s23
    s_mul_i32 s25, s18, 9216
    s_mul_i32 s22, s19, 36864
    s_add_u32 s24, s24, s22
    s_mul_i32 s42, s20, 36864
    s_mov_b32 s27, 0
    s_add_u32 s23, s27, s25
    s_add_u32 m0, s23, 0
    s_nop 0
    buffer_load_dwordx4 v2, s[8:11], s24 offen offset:0 lds
    s_add_u32 m0, s23, 960
    s_nop 0
    buffer_load_dwordx4 v2, s[8:11], s24 offen offset:64 lds
    s_add_u32 m0, s23, 1920
    s_nop 0
    buffer_load_dwordx4 v2, s[8:11], s24 offen offset:128 lds
    s_add_u32 m0, s23, 2880
    s_nop 0
    buffer_load_dwordx4 v2, s[8:11], s24 offen offset:192 lds
    s_add_u32 m0, s23, 3840
    s_nop 0
    buffer_load_dwordx4 v2, s[8:11], s24 offen offset:256 lds
    s_add_u32 m0, s23, 4800
    s_nop 0
    buffer_load_dwordx4 v2, s[8:11], s24 offen offset:320 lds
    s_add_u32 m0, s23, 5760
    s_nop 0
    buffer_load_dwordx4 v2, s[8:11], s24 offen offset:384 lds
    s_add_u32 m0, s23, 6720
    s_nop 0
    buffer_load_dwordx4 v2, s[8:11], s24 offen offset:448 lds
    s_add_u32 m0, s23, 7680
    s_nop 0
    buffer_load_dwordx4 v2, s[8:11], s24 offen offset:512 lds
    s_add_u32 s24, s24, s42
    s_lshl_b32 s22, s19, 5
    s_add_u32 s22, s22, s17
    s_lshl_b32 s26, s22, 14
    s_mul_i32 s23, s18, 3072
    s_add_u32 s26, s26, s23
    s_lshl_b32 s23, s16, 11
    s_add_u32 s26, s26, s23
    s_add_u32 s26, s26, -2048
    s_lshl_b32 s22, s22, 13
    s_add_u32 s22, s22, 33554432
    s_cmp_eq_u32 s16, 0
    s_cselect_b32 s26, s22, s26
    s_cselect_b32 s40, 4, 1
    s_cselect_b32 s43, 1, 2
    s_lshl_b32 s40, s40, 10
    s_lshl_b32 s43, s43, 13
    s_lshl_b32 s41, s43, 5
    s_mul_i32 s41, s41, s20
    s_lshl_b32 s29, s17, 7
    s_lshl_b32 s22, s33, 2
    s_add_u32 s29, s29, s22
    s_add_u32 s29, s29, 125829120
    v_add_u32 v25, 40960, v24
    v_xor_b32 v26, 32, v25
    s_waitcnt vmcnt(33)
    ds_read_b64_tr_b16 v[64:65], v25 offset:0
    ds_read_b64_tr_b16 v[66:67], v25 offset:256
    ds_read_b64_tr_b16 v[136:137], v26 offset:0
    ds_read_b64_tr_b16 v[138:139], v26 offset:256
    ds_read_b64_tr_b16 v[68:69], v25 offset:2048
    ds_read_b64_tr_b16 v[70:71], v25 offset:2304
    ds_read_b64_tr_b16 v[140:141], v26 offset:2048
    ds_read_b64_tr_b16 v[142:143], v26 offset:2304
    s_waitcnt lgkmcnt(0)
    s_add_u32 s21, s28, 1573120
    s_add_u32 m0, s31, 40960
    s_nop 0
    buffer_load_dwordx4 v6, s[12:15], s21 offen lds
    s_add_u32 m0, s31, 41984
    s_add_u32 s21, s21, 131072
    buffer_load_dwordx4 v6, s[12:15], s21 offen lds
    s_add_u32 m0, s31, 43008
    s_add_u32 s21, s21, 131072
    buffer_load_dwordx4 v6, s[12:15], s21 offen lds
    s_add_u32 m0, s31, 44032
    s_add_u32 s21, s21, 131072
    buffer_load_dwordx4 v6, s[12:15], s21 offen lds
    v_add_u32 v25, 57344, v24
    v_xor_b32 v26, 32, v25
    s_waitcnt vmcnt(33)
    ds_read_b64_tr_b16 a[0:1], v25 offset:0
    ds_read_b64_tr_b16 a[2:3], v25 offset:256
    ds_read_b64_tr_b16 a[72:73], v26 offset:0
    ds_read_b64_tr_b16 a[74:75], v26 offset:256
    ds_read_b64_tr_b16 a[4:5], v25 offset:2048
    ds_read_b64_tr_b16 a[6:7], v25 offset:2304
    ds_read_b64_tr_b16 a[76:77], v26 offset:2048
    ds_read_b64_tr_b16 a[78:79], v26 offset:2304
    s_waitcnt lgkmcnt(0)
    s_add_u32 s21, s28, 2097152
    s_add_u32 m0, s31, 57344
    s_nop 0
    buffer_load_dwordx4 v6, s[12:15], s21 offen lds
    s_add_u32 m0, s31, 58368
    s_add_u32 s21, s21, 131072
    buffer_load_dwordx4 v6, s[12:15], s21 offen lds
    s_add_u32 m0, s31, 59392
    s_add_u32 s21, s21, 131072
    buffer_load_dwordx4 v6, s[12:15], s21 offen lds
    s_add_u32 m0, s31, 60416
    s_add_u32 s21, s21, 131072
    buffer_load_dwordx4 v6, s[12:15], s21 offen lds
    v_add_u32 v25, 73728, v24
    v_xor_b32 v26, 32, v25
    s_waitcnt vmcnt(33)
    ds_read_b64_tr_b16 v[72:73], v25 offset:0
    ds_read_b64_tr_b16 v[74:75], v25 offset:256
    ds_read_b64_tr_b16 v[144:145], v26 offset:0
    ds_read_b64_tr_b16 v[146:147], v26 offset:256
    ds_read_b64_tr_b16 v[76:77], v25 offset:2048
    ds_read_b64_tr_b16 v[78:79], v25 offset:2304
    ds_read_b64_tr_b16 v[148:149], v26 offset:2048
    ds_read_b64_tr_b16 v[150:151], v26 offset:2304
    s_waitcnt lgkmcnt(0)
    s_add_u32 s21, s28, 2097408
    s_add_u32 m0, s31, 73728
    s_nop 0
    buffer_load_dwordx4 v6, s[12:15], s21 offen lds
    s_add_u32 m0, s31, 74752
    s_add_u32 s21, s21, 131072
    buffer_load_dwordx4 v6, s[12:15], s21 offen lds
    s_add_u32 m0, s31, 75776
    s_add_u32 s21, s21, 131072
    buffer_load_dwordx4 v6, s[12:15], s21 offen lds
    s_add_u32 m0, s31, 76800
    s_add_u32 s21, s21, 131072
    buffer_load_dwordx4 v6, s[12:15], s21 offen lds
    v_add_u32 v25, 90112, v24
    v_xor_b32 v26, 32, v25
    s_waitcnt vmcnt(33)
    ds_read_b64_tr_b16 a[8:9], v25 offset:0
    ds_read_b64_tr_b16 a[10:11], v25 offset:256
    ds_read_b64_tr_b16 a[80:81], v26 offset:0
    ds_read_b64_tr_b16 a[82:83], v26 offset:256
    ds_read_b64_tr_b16 a[12:13], v25 offset:2048
    ds_read_b64_tr_b16 a[14:15], v25 offset:2304
    ds_read_b64_tr_b16 a[84:85], v26 offset:2048
    ds_read_b64_tr_b16 a[86:87], v26 offset:2304
    s_waitcnt lgkmcnt(0)
    s_add_u32 s21, s28, 2621440
    s_add_u32 m0, s31, 90112
    s_nop 0
    buffer_load_dwordx4 v6, s[12:15], s21 offen lds
    s_add_u32 m0, s31, 91136
    s_add_u32 s21, s21, 131072
    buffer_load_dwordx4 v6, s[12:15], s21 offen lds
    s_add_u32 m0, s31, 92160
    s_add_u32 s21, s21, 131072
    buffer_load_dwordx4 v6, s[12:15], s21 offen lds
    s_add_u32 m0, s31, 93184
    s_add_u32 s21, s21, 131072
    buffer_load_dwordx4 v6, s[12:15], s21 offen lds
    v_add_u32 v25, 106496, v24
    v_xor_b32 v26, 32, v25
    s_waitcnt vmcnt(33)
    ds_read_b64_tr_b16 v[80:81], v25 offset:0
    ds_read_b64_tr_b16 v[82:83], v25 offset:256
    ds_read_b64_tr_b16 v[152:153], v26 offset:0
    ds_read_b64_tr_b16 v[154:155], v26 offset:256
    ds_read_b64_tr_b16 v[84:85], v25 offset:2048
    ds_read_b64_tr_b16 v[86:87], v25 offset:2304
    ds_read_b64_tr_b16 v[156:157], v26 offset:2048
    ds_read_b64_tr_b16 v[158:159], v26 offset:2304
    s_waitcnt lgkmcnt(0)
    s_add_u32 s21, s28, 2621696
    s_add_u32 m0, s31, 106496
    s_nop 0
    buffer_load_dwordx4 v6, s[12:15], s21 offen lds
    s_add_u32 m0, s31, 107520
    s_add_u32 s21, s21, 131072
    buffer_load_dwordx4 v6, s[12:15], s21 offen lds
    s_add_u32 m0, s31, 108544
    s_add_u32 s21, s21, 131072
    buffer_load_dwordx4 v6, s[12:15], s21 offen lds
    s_add_u32 m0, s31, 109568
    s_add_u32 s21, s21, 131072
    buffer_load_dwordx4 v6, s[12:15], s21 offen lds
    v_add_u32 v25, 122880, v24
    v_xor_b32 v26, 32, v25
    s_waitcnt vmcnt(33)
    ds_read_b64_tr_b16 a[16:17], v25 offset:0
    ds_read_b64_tr_b16 a[18:19], v25 offset:256
    ds_read_b64_tr_b16 a[88:89], v26 offset:0
    ds_read_b64_tr_b16 a[90:91], v26 offset:256
    ds_read_b64_tr_b16 a[20:21], v25 offset:2048
    ds_read_b64_tr_b16 a[22:23], v25 offset:2304
    ds_read_b64_tr_b16 a[92:93], v26 offset:2048
    ds_read_b64_tr_b16 a[94:95], v26 offset:2304
    s_waitcnt lgkmcnt(0)
    v_mov_b32 v28, s95
    s_cmp_lg_u32 s95, 0
    s_cbranch_scc1 L_ne
    buffer_load_dword v28, off, s[96:99], 0 offset:64 sc1
L_ne:
    s_add_u32 s21, s28, 3145728
    s_add_u32 m0, s31, 122880
    s_nop 0
    buffer_load_dwordx4 v6, s[12:15], s21 offen lds
    s_add_u32 m0, s31, 123904
    s_add_u32 s21, s21, 131072
    buffer_load_dwordx4 v6, s[12:15], s21 offen lds
    s_add_u32 m0, s31, 124928
    s_add_u32 s21, s21, 131072
    buffer_load_dwordx4 v6, s[12:15], s21 offen lds
    s_add_u32 m0, s31, 125952
    s_add_u32 s21, s21, 131072
    buffer_load_dwordx4 v6, s[12:15], s21 offen lds
    v_add_u32 v25, 139264, v24
    v_xor_b32 v26, 32, v25
    s_waitcnt vmcnt(33)
    ds_read_b64_tr_b16 v[88:89], v25 offset:0
    ds_read_b64_tr_b16 v[90:91], v25 offset:256
    ds_read_b64_tr_b16 v[160:161], v26 offset:0
    ds_read_b64_tr_b16 v[162:163], v26 offset:256
    ds_read_b64_tr_b16 v[92:93], v25 offset:2048
    ds_read_b64_tr_b16 v[94:95], v25 offset:2304
    ds_read_b64_tr_b16 v[164:165], v26 offset:2048
    ds_read_b64_tr_b16 v[166:167], v26 offset:2304
    s_waitcnt lgkmcnt(0)
    s_add_u32 s21, s28, 3145984
    s_add_u32 m0, s31, 139264
    s_nop 0
    buffer_load_dwordx4 v6, s[12:15], s21 offen lds
    s_add_u32 m0, s31, 140288
    s_add_u32 s21, s21, 131072
    buffer_load_dwordx4 v6, s[12:15], s21 offen lds
    s_add_u32 m0, s31, 141312
    s_add_u32 s21, s21, 131072
    buffer_load_dwordx4 v6, s[12:15], s21 offen lds
    s_add_u32 m0, s31, 142336
    s_add_u32 s21, s21, 131072
    buffer_load_dwordx4 v6, s[12:15], s21 offen lds
    v_add_u32 v25, 40960, v24
    v_xor_b32 v26, 32, v25
    s_waitcnt vmcnt(24)
    ds_read_b64_tr_b16 a[24:25], v25 offset:0
    ds_read_b64_tr_b16 a[26:27], v25 offset:256
    ds_read_b64_tr_b16 a[96:97], v26 offset:0
    ds_read_b64_tr_b16 a[98:99], v26 offset:256
    ds_read_b64_tr_b16 a[28:29], v25 offset:2048
    ds_read_b64_tr_b16 a[30:31], v25 offset:2304
    ds_read_b64_tr_b16 a[100:101], v26 offset:2048
    ds_read_b64_tr_b16 a[102:103], v26 offset:2304
    s_waitcnt lgkmcnt(0)
    s_add_u32 s21, s28, 3670016
    s_add_u32 m0, s31, 40960
    s_nop 0
    buffer_load_dwordx4 v6, s[12:15], s21 offen lds
    s_add_u32 m0, s31, 41984
    s_add_u32 s21, s21, 131072
    buffer_load_dwordx4 v6, s[12:15], s21 offen lds
    s_add_u32 m0, s31, 43008
    s_add_u32 s21, s21, 131072
    buffer_load_dwordx4 v6, s[12:15], s21 offen lds
    s_add_u32 m0, s31, 44032
    s_add_u32 s21, s21, 131072
    buffer_load_dwordx4 v6, s[12:15], s21 offen lds
    v_add_u32 v25, 57344, v24
    v_xor_b32 v26, 32, v25
    s_waitcnt vmcnt(24)
    ds_read_b64_tr_b16 v[96:97], v25 offset:0
    ds_read_b64_tr_b16 v[98:99], v25 offset:256
    ds_read_b64_tr_b16 v[168:169], v26 offset:0
    ds_read_b64_tr_b16 v[170:171], v26 offset:256
    ds_read_b64_tr_b16 v[100:101], v25 offset:2048
    ds_read_b64_tr_b16 v[102:103], v25 offset:2304
    ds_read_b64_tr_b16 v[172:173], v26 offset:2048
    ds_read_b64_tr_b16 v[174:175], v26 offset:2304
    s_waitcnt lgkmcnt(0)
    s_add_u32 s21, s28, 3670272
    s_add_u32 m0, s31, 57344
    s_nop 0
    buffer_load_dwordx4 v6, s[12:15], s21 offen lds
    s_add_u32 m0, s31, 58368
    s_add_u32 s21, s21, 131072
    buffer_load_dwordx4 v6, s[12:15], s21 offen lds
    s_add_u32 m0, s31, 59392
    s_add_u32 s21, s21, 131072
    buffer_load_dwordx4 v6, s[12:15], s21 offen lds
    s_add_u32 m0, s31, 60416
    s_add_u32 s21, s21, 131072
    buffer_load_dwordx4 v6, s[12:15], s21 offen lds
    v_add_u32 v25, 73728, v24
    v_xor_b32 v26, 32, v25
    s_waitcnt vmcnt(24)
    ds_read_b64_tr_b16 a[32:33], v25 offset:0
    ds_read_b64_tr_b16 a[34:35], v25 offset:256
    ds_read_b64_tr_b16 a[104:105], v26 offset:0
    ds_read_b64_tr_b16 a[106:107], v26 offset:256
    ds_read_b64_tr_b16 a[36:37], v25 offset:2048
    ds_read_b64_tr_b16 a[38:39], v25 offset:2304
    ds_read_b64_tr_b16 a[108:109], v26 offset:2048
    ds_read_b64_tr_b16 a[110:111], v26 offset:2304
    s_waitcnt lgkmcnt(0)
    s_add_u32 s21, s28, 4194304
    s_add_u32 m0, s31, 73728
    s_nop 0
    buffer_load_dwordx4 v6, s[12:15], s21 offen lds
    s_add_u32 m0, s31, 74752
    s_add_u32 s21, s21, 131072
    buffer_load_dwordx4 v6, s[12:15], s21 offen lds
    s_add_u32 m0, s31, 75776
    s_add_u32 s21, s21, 131072
    buffer_load_dwordx4 v6, s[12:15], s21 offen lds
    s_add_u32 m0, s31, 76800
    s_add_u32 s21, s21, 131072
    buffer_load_dwordx4 v6, s[12:15], s21 offen lds
    v_add_u32 v25, 90112, v24
    v_xor_b32 v26, 32, v25
    s_waitcnt vmcnt(24)
    ds_read_b64_tr_b16 v[104:105], v25 offset:0
    ds_read_b64_tr_b16 v[106:107], v25 offset:256
    ds_read_b64_tr_b16 v[176:177], v26 offset:0
    ds_read_b64_tr_b16 v[178:179], v26 offset:256
    ds_read_b64_tr_b16 v[108:109], v25 offset:2048
    ds_read_b64_tr_b16 v[110:111], v25 offset:2304
    ds_read_b64_tr_b16 v[180:181], v26 offset:2048
    ds_read_b64_tr_b16 v[182:183], v26 offset:2304
    s_waitcnt lgkmcnt(0)
    s_add_u32 s21, s28, 4194560
    s_add_u32 m0, s31, 90112
    s_nop 0
    buffer_load_dwordx4 v6, s[12:15], s21 offen lds
    s_add_u32 m0, s31, 91136
    s_add_u32 s21, s21, 131072
    buffer_load_dwordx4 v6, s[12:15], s21 offen lds
    s_add_u32 m0, s31, 92160
    s_add_u32 s21, s21, 131072
    buffer_load_dwordx4 v6, s[12:15], s21 offen lds
    s_add_u32 m0, s31, 93184
    s_add_u32 s21, s21, 131072
    buffer_load_dwordx4 v6, s[12:15], s21 offen lds
    v_add_u32 v25, 106496, v24
    v_xor_b32 v26, 32, v25
    s_waitcnt vmcnt(24)
    ds_read_b64_tr_b16 a[40:41], v25 offset:0
    ds_read_b64_tr_b16 a[42:43], v25 offset:256
    ds_read_b64_tr_b16 a[112:113], v26 offset:0
    ds_read_b64_tr_b16 a[114:115], v26 offset:256
    ds_read_b64_tr_b16 a[44:45], v25 offset:2048
    ds_read_b64_tr_b16 a[46:47], v25 offset:2304
    ds_read_b64_tr_b16 a[116:117], v26 offset:2048
    ds_read_b64_tr_b16 a[118:119], v26 offset:2304
    s_waitcnt lgkmcnt(0)
    v_add_u32 v25, 122880, v24
    v_xor_b32 v26, 32, v25
    s_waitcnt vmcnt(20)
    ds_read_b64_tr_b16 v[112:113], v25 offset:0
    ds_read_b64_tr_b16 v[114:115], v25 offset:256
    ds_read_b64_tr_b16 v[184:185], v26 offset:0
    ds_read_b64_tr_b16 v[186:187], v26 offset:256
    ds_read_b64_tr_b16 v[116:117], v25 offset:2048
    ds_read_b64_tr_b16 v[118:119], v25 offset:2304
    ds_read_b64_tr_b16 v[188:189], v26 offset:2048
    ds_read_b64_tr_b16 v[190:191], v26 offset:2304
    s_waitcnt lgkmcnt(0)
    v_add_u32 v25, 139264, v24
    v_xor_b32 v26, 32, v25
    s_waitcnt vmcnt(16)
    ds_read_b64_tr_b16 a[48:49], v25 offset:0
    ds_read_b64_tr_b16 a[50:51], v25 offset:256
    ds_read_b64_tr_b16 a[120:121], v26 offset:0
    ds_read_b64_tr_b16 a[122:123], v26 offset:256
    ds_read_b64_tr_b16 a[52:53], v25 offset:2048
    ds_read_b64_tr_b16 a[54:55], v25 offset:2304
    ds_read_b64_tr_b16 a[124:125], v26 offset:2048
    ds_read_b64_tr_b16 a[126:127], v26 offset:2304
    s_waitcnt lgkmcnt(0)
    v_add_u32 v25, 40960, v24
    v_xor_b32 v26, 32, v25
    s_waitcnt vmcnt(12)
    ds_read_b64_tr_b16 v[120:121], v25 offset:0
    ds_read_b64_tr_b16 v[122:123], v25 offset:256
    ds_read_b64_tr_b16 v[192:193], v26 offset:0
    ds_read_b64_tr_b16 v[194:195], v26 offset:256
    ds_read_b64_tr_b16 v[124:125], v25 offset:2048
    ds_read_b64_tr_b16 v[126:127], v25 offset:2304
    ds_read_b64_tr_b16 v[196:197], v26 offset:2048
    ds_read_b64_tr_b16 v[198:199], v26 offset:2304
    s_waitcnt lgkmcnt(0)
    v_add_u32 v25, 57344, v24
    v_xor_b32 v26, 32, v25
    s_waitcnt vmcnt(8)
    ds_read_b64_tr_b16 a[56:57], v25 offset:0
    ds_read_b64_tr_b16 a[58:59], v25 offset:256
    ds_read_b64_tr_b16 a[128:129], v26 offset:0
    ds_read_b64_tr_b16 a[130:131], v26 offset:256
    ds_read_b64_tr_b16 a[60:61], v25 offset:2048
    ds_read_b64_tr_b16 a[62:63], v25 offset:2304
    ds_read_b64_tr_b16 a[132:133], v26 offset:2048
    ds_read_b64_tr_b16 a[134:135], v26 offset:2304
    s_waitcnt lgkmcnt(0)
    v_add_u32 v25, 73728, v24
    v_xor_b32 v26, 32, v25
    s_waitcnt vmcnt(4)
    ds_read_b64_tr_b16 v[128:129], v25 offset:0
    ds_read_b64_tr_b16 v[130:131], v25 offset:256
    ds_read_b64_tr_b16 v[200:201], v26 offset:0
    ds_read_b64_tr_b16 v[202:203], v26 offset:256
    ds_read_b64_tr_b16 v[132:133], v25 offset:2048
    ds_read_b64_tr_b16 v[134:135], v25 offset:2304
    ds_read_b64_tr_b16 v[204:205], v26 offset:2048
    ds_read_b64_tr_b16 v[206:207], v26 offset:2304
    s_waitcnt lgkmcnt(0)
    v_add_u32 v25, 90112, v24
    v_xor_b32 v26, 32, v25
    s_waitcnt vmcnt(0)
    ds_read_b64_tr_b16 a[64:65], v25 offset:0
    ds_read_b64_tr_b16 a[66:67], v25 offset:256
    ds_read_b64_tr_b16 a[136:137], v26 offset:0
    ds_read_b64_tr_b16 a[138:139], v26 offset:256
    ds_read_b64_tr_b16 a[68:69], v25 offset:2048
    ds_read_b64_tr_b16 a[70:71], v25 offset:2304
    ds_read_b64_tr_b16 a[140:141], v26 offset:2048
    ds_read_b64_tr_b16 a[142:143], v26 offset:2304
    s_waitcnt lgkmcnt(0)
    v_readfirstlane_b32 s95, v28
    s_nop 4
    s_mov_b32 s88, 4194304
gn7:
    s_cmp_lg_u32 s95, 0
    s_cbranch_scc1 gn7x
    buffer_load_dword v25, off, s[96:99], 0 offset:64 sc1
    s_sub_u32 s88, s88, 1
    s_cbranch_scc1 gn7x
    s_waitcnt vmcnt(0)
    v_readfirstlane_b32 s95, v25
    s_nop 1
    s_branch gn7
gn7x:
    s_barrier
    s_mov_b32 s27, 36864
    s_add_u32 s23, s27, s25
    s_add_u32 m0, s23, 0
    s_nop 0
    buffer_load_dwordx4 v2, s[8:11], s24 offen offset:0 lds
    s_add_u32 m0, s23, 960
    s_nop 0
    buffer_load_dwordx4 v2, s[8:11], s24 offen offset:64 lds
    s_add_u32 m0, s23, 1920
    s_nop 0
    buffer_load_dwordx4 v2, s[8:11], s24 offen offset:128 lds
    s_add_u32 m0, s23, 2880
    s_nop 0
    buffer_load_dwordx4 v2, s[8:11], s24 offen offset:192 lds
    s_add_u32 m0, s23, 3840
    s_nop 0
    buffer_load_dwordx4 v2, s[8:11], s24 offen offset:256 lds
    s_add_u32 m0, s23, 4800
    s_nop 0
    buffer_load_dwordx4 v2, s[8:11], s24 offen offset:320 lds
    s_add_u32 m0, s23, 5760
    s_nop 0
    buffer_load_dwordx4 v2, s[8:11], s24 offen offset:384 lds
    s_add_u32 m0, s23, 6720
    s_nop 0
    buffer_load_dwordx4 v2, s[8:11], s24 offen offset:448 lds
    s_add_u32 m0, s23, 7680
    s_nop 0
    buffer_load_dwordx4 v2, s[8:11], s24 offen offset:512 lds
    s_add_u32 s24, s24, s42
    s_mov_b32 s27, 0
    s_mov_b32 s30, s95
    s_cmp_eq_u32 s18, 0
    s_cselect_b32 s34, 1, 0
    s_mov_b32 s35, 0
    s_cmp_eq_u32 s16, 2
    s_cbranch_scc1 qk_vloop
qk_loop:
    s_barrier
    v_add_u32 v3, s27, v1
    ds_read_b128 v[32:35], v3 offset:0
    ds_read_b128 v[36:39], v3 offset:18432
    ds_read_b128 v[40:43], v3 offset:1024
    ds_read_b128 v[44:47], v3 offset:19456
    ds_read_b128 v[48:51], v3 offset:2048
    ds_read_b128 v[52:55], v3 offset:20480
    s_sub_u32 s22, s30, 1
    v_mov_b32 v4, s22
    s_mov_b64 exec, s[34:35]
    buffer_store_dword v4, off, s[4:7], s29 sc1
    s_mov_b64 exec, -1
    s_add_u32 s22, s27, 73728
    s_sub_u32 s21, s22, 110592
    s_cselect_b32 s22, s22, s21
    ds_read_b128 v[56:59], v3 offset:3072
    ds_read_b128 v[60:63], v3 offset:21504
    s_add_u32 s23, s22, s25
    s_add_u32 m0, s23, 0
    s_nop 0
    buffer_load_dwordx4 v2, s[8:11], s24 offen offset:0 lds
    s_waitcnt lgkmcnt(6)
    v_mfma_f32_16x16x32_bf16 v[208:211], v[64:67], v[32:35], 0
    v_mfma_f32_16x16x32_bf16 v[212:215], v[136:139], v[32:35], 0
    v_mfma_f32_16x16x32_bf16 v[216:219], v[64:67], v[36:39], 0
    v_mfma_f32_16x16x32_bf16 v[220:223], v[136:139], v[36:39], 0
    v_mfma_f32_16x16x32_bf16 v[224:227], a[0:3], v[32:35], 0
    v_mfma_f32_16x16x32_bf16 v[228:231], a[72:75], v[32:35], 0
    v_mfma_f32_16x16x32_bf16 v[232:235], a[0:3], v[36:39], 0
    v_mfma_f32_16x16x32_bf16 v[236:239], a[72:75], v[36:39], 0
    ds_read_b128 v[32:35], v3 offset:4096
    ds_read_b128 v[36:39], v3 offset:22528
    s_add_u32 m0, s23, 960
    s_nop 0
    buffer_load_dwordx4 v2, s[8:11], s24 offen offset:64 lds
    s_waitcnt lgkmcnt(6)
    v_mfma_f32_16x16x32_bf16 v[208:211], v[68:71], v[40:43], v[208:211]
    v_mfma_f32_16x16x32_bf16 v[212:215], v[140:143], v[40:43], v[212:215]
    v_mfma_f32_16x16x32_bf16 v[216:219], v[68:71], v[44:47], v[216:219]
    v_mfma_f32_16x16x32_bf16 v[220:223], v[140:143], v[44:47], v[220:223]
    v_mfma_f32_16x16x32_bf16 v[224:227], a[4:7], v[40:43], v[224:227]
    v_mfma_f32_16x16x32_bf16 v[228:231], a[76:79], v[40:43], v[228:231]
    v_mfma_f32_16x16x32_bf16 v[232:235], a[4:7], v[44:47], v[232:235]
    v_mfma_f32_16x16x32_bf16 v[236:239], a[76:79], v[44:47], v[236:239]
    ds_read_b128 v[40:43], v3 offset:5120
    ds_read_b128 v[44:47], v3 offset:23552
    s_add_u32 m0, s23, 1920
    s_nop 0
    buffer_load_dwordx4 v2, s[8:11], s24 offen offset:128 lds
    s_waitcnt lgkmcnt(6)
    v_mfma_f32_16x16x32_bf16 v[208:211], v[72:75], v[48:51], v[208:211]
    v_mfma_f32_16x16x32_bf16 v[212:215], v[144:147], v[48:51], v[212:215]
    v_mfma_f32_16x16x32_bf16 v[216:219], v[72:75], v[52:55], v[216:219]
    v_mfma_f32_16x16x32_bf16 v[220:223], v[144:147], v[52:55], v[220:223]
    v_mfma_f32_16x16x32_bf16 v[224:227], a[8:11], v[48:51], v[224:227]
    v_mfma_f32_16x16x32_bf16 v[228:231], a[80:83], v[48:51], v[228:231]
    v_mfma_f32_16x16x32_bf16 v[232:235], a[8:11], v[52:55], v[232:235]
    v_mfma_f32_16x16x32_bf16 v[236:239], a[80:83], v[52:55], v[236:239]
    ds_read_b128 v[48:51], v3 offset:6144
    ds_read_b128 v[52:55], v3 offset:24576
    s_add_u32 m0, s23, 2880
    s_nop 0
    buffer_load_dwordx4 v2, s[8:11], s24 offen offset:192 lds
    s_waitcnt lgkmcnt(6)
    v_mfma_f32_16x16x32_bf16 v[208:211], v[76:79], v[56:59], v[208:211]
    v_mfma_f32_16x16x32_bf16 v[212:215], v[148:151], v[56:59], v[212:215]
    v_mfma_f32_16x16x32_bf16 v[216:219], v[76:79], v[60:63], v[216:219]
    v_mfma_f32_16x16x32_bf16 v[220:223], v[148:151], v[60:63], v[220:223]
    v_mfma_f32_16x16x32_bf16 v[224:227], a[12:15], v[56:59], v[224:227]
    v_mfma_f32_16x16x32_bf16 v[228:231], a[84:87], v[56:59], v[228:231]
    v_mfma_f32_16x16x32_bf16 v[232:235], a[12:15], v[60:63], v[232:235]
    v_mfma_f32_16x16x32_bf16 v[236:239], a[84:87], v[60:63], v[236:239]
    ds_read_b128 v[56:59], v3 offset:7168
    ds_read_b128 v[60:63], v3 offset:25600
    s_add_u32 m0, s23, 3840
    s_nop 0
    buffer_load_dwordx4 v2, s[8:11], s24 offen offset:256 lds
    s_waitcnt lgkmcnt(6)
    v_mfma_f32_16x16x32_bf16 v[208:211], v[80:83], v[32:35], v[208:211]
    v_mfma_f32_16x16x32_bf16 v[212:215], v[152:155], v[32:35], v[212:215]
    v_mfma_f32_16x16x32_bf16 v[216:219], v[80:83], v[36:39], v[216:219]
    v_mfma_f32_16x16x32_bf16 v[220:223], v[152:155], v[36:39], v[220:223]
    v_mfma_f32_16x16x32_bf16 v[224:227], a[16:19], v[32:35], v[224:227]
    v_mfma_f32_16x16x32_bf16 v[228:231], a[88:91], v[32:35], v[228:231]
    v_mfma_f32_16x16x32_bf16 v[232:235], a[16:19], v[36:39], v[232:235]
    v_mfma_f32_16x16x32_bf16 v[236:239], a[88:91], v[36:39], v[236:239]
    ds_read_b128 v[32:35], v3 offset:8192
    ds_read_b128 v[36:39], v3 offset:26624
    s_add_u32 m0, s23, 4800
    s_nop 0
    buffer_load_dwordx4 v2, s[8:11], s24 offen offset:320 lds
    s_waitcnt lgkmcnt(6)
    v_mfma_f32_16x16x32_bf16 v[208:211], v[84:87], v[40:43], v[208:211]
    v_mfma_f32_16x16x32_bf16 v[212:215], v[156:159], v[40:43], v[212:215]
    v_mfma_f32_16x16x32_bf16 v[216:219], v[84:87], v[44:47], v[216:219]
    v_mfma_f32_16x16x32_bf16 v[220:223], v[156:159], v[44:47], v[220:223]
    v_mfma_f32_16x16x32_bf16 v[224:227], a[20:23], v[40:43], v[224:227]
    v_mfma_f32_16x16x32_bf16 v[228:231], a[92:95], v[40:43], v[228:231]
    v_mfma_f32_16x16x32_bf16 v[232:235], a[20:23], v[44:47], v[232:235]
    v_mfma_f32_16x16x32_bf16 v[236:239], a[92:95], v[44:47], v[236:239]
    ds_read_b128 v[40:43], v3 offset:9216
    ds_read_b128 v[44:47], v3 offset:27648
    s_add_u32 m0, s23, 5760
    s_nop 0
    buffer_load_dwordx4 v2, s[8:11], s24 offen offset:384 lds
    s_waitcnt lgkmcnt(6)
    v_mfma_f32_16x16x32_bf16 v[208:211], v[88:91], v[48:51], v[208:211]
    v_mfma_f32_16x16x32_bf16 v[212:215], v[160:163], v[48:51], v[212:215]
    v_mfma_f32_16x16x32_bf16 v[216:219], v[88:91], v[52:55], v[216:219]
    v_mfma_f32_16x16x32_bf16 v[220:223], v[160:163], v[52:55], v[220:223]
    v_mfma_f32_16x16x32_bf16 v[224:227], a[24:27], v[48:51], v[224:227]
    v_mfma_f32_16x16x32_bf16 v[228:231], a[96:99], v[48:51], v[228:231]
    v_mfma_f32_16x16x32_bf16 v[232:235], a[24:27], v[52:55], v[232:235]
    v_mfma_f32_16x16x32_bf16 v[236:239], a[96:99], v[52:55], v[236:239]
    ds_read_b128 v[48:51], v3 offset:10240
    ds_read_b128 v[52:55], v3 offset:28672
    s_add_u32 m0, s23, 6720
    s_nop 0
    buffer_load_dwordx4 v2, s[8:11], s24 offen offset:448 lds
    s_waitcnt lgkmcnt(6)
    v_mfma_f32_16x16x32_bf16 v[208:211], v[92:95], v[56:59], v[208:211]
    v_mfma_f32_16x16x32_bf16 v[212:215], v[164:167], v[56:59], v[212:215]
    v_mfma_f32_16x16x32_bf16 v[216:219], v[92:95], v[60:63], v[216:219]
    v_mfma_f32_16x16x32_bf16 v[220:223], v[164:167], v[60:63], v[220:223]
    v_mfma_f32_16x16x32_bf16 v[224:227], a[28:31], v[56:59], v[224:227]
    v_mfma_f32_16x16x32_bf16 v[228:231], a[100:103], v[56:59], v[228:231]
    v_mfma_f32_16x16x32_bf16 v[232:235], a[28:31], v[60:63], v[232:235]
    v_mfma_f32_16x16x32_bf16 v[236:239], a[100:103], v[60:63], v[236:239]
    ds_read_b128 v[56:59], v3 offset:11264
    ds_read_b128 v[60:63], v3 offset:29696
    s_add_u32 m0, s23, 7680
    s_nop 0
    buffer_load_dwordx4 v2, s[8:11], s24 offen offset:512 lds
    s_add_u32 s24, s24, s42
    s_waitcnt lgkmcnt(6)
    v_mfma_f32_16x16x32_bf16 v[208:211], v[96:99], v[32:35], v[208:211]
    v_mfma_f32_16x16x32_bf16 v[212:215], v[168:171], v[32:35], v[212:215]
    v_mfma_f32_16x16x32_bf16 v[216:219], v[96:99], v[36:39], v[216:219]
    v_mfma_f32_16x16x32_bf16 v[220:223], v[168:171], v[36:39], v[220:223]
    v_mfma_f32_16x16x32_bf16 v[224:227], a[32:35], v[32:35], v[224:227]
    v_mfma_f32_16x16x32_bf16 v[228:231], a[104:107], v[32:35], v[228:231]
    v_mfma_f32_16x16x32_bf16 v[232:235], a[32:35], v[36:39], v[232:235]
    v_mfma_f32_16x16x32_bf16 v[236:239], a[104:107], v[36:39], v[236:239]
    ds_read_b128 v[32:35], v3 offset:12288
    ds_read_b128 v[36:39], v3 offset:30720
    s_waitcnt lgkmcnt(6)
    v_mfma_f32_16x16x32_bf16 v[208:211], v[100:103], v[40:43], v[208:211]
    v_mfma_f32_16x16x32_bf16 v[212:215], v[172:175], v[40:43], v[212:215]
    v_mfma_f32_16x16x32_bf16 v[216:219], v[100:103], v[44:47], v[216:219]
    v_mfma_f32_16x16x32_bf16 v[220:223], v[172:175], v[44:47], v[220:223]
    v_mfma_f32_16x16x32_bf16 v[224:227], a[36:39], v[40:43], v[224:227]
    v_mfma_f32_16x16x32_bf16 v[228:231], a[108:111], v[40:43], v[228:231]
    v_mfma_f32_16x16x32_bf16 v[232:235], a[36:39], v[44:47], v[232:235]
    v_mfma_f32_16x16x32_bf16 v[236:239], a[108:111], v[44:47], v[236:239]
    ds_read_b128 v[40:43], v3 offset:13312
    ds_read_b128 v[44:47], v3 offset:31744
    s_waitcnt lgkmcnt(6)
    v_mfma_f32_16x16x32_bf16 v[208:211], v[104:107], v[48:51], v[208:211]
    v_mfma_f32_16x16x32_bf16 v[212:215], v[176:179], v[48:51], v[212:215]
    v_mfma_f32_16x16x32_bf16 v[216:219], v[104:107], v[52:55], v[216:219]
    v_mfma_f32_16x16x32_bf16 v[220:223], v[176:179], v[52:55], v[220:223]
    v_mfma_f32_16x16x32_bf16 v[224:227], a[40:43], v[48:51], v[224:227]
    v_mfma_f32_16x16x32_bf16 v[228:231], a[112:115], v[48:51], v[228:231]
    v_mfma_f32_16x16x32_bf16 v[232:235], a[40:43], v[52:55], v[232:235]
    v_mfma_f32_16x16x32_bf16 v[236:239], a[112:115], v[52:55], v[236:239]
    ds_read_b128 v[48:51], v3 offset:14336
    ds_read_b128 v[52:55], v3 offset:32768
    s_waitcnt lgkmcnt(6)
    v_mfma_f32_16x16x32_bf16 v[208:211], v[108:111], v[56:59], v[208:211]
    v_mfma_f32_16x16x32_bf16 v[212:215], v[180:183], v[56:59], v[212:215]
    v_mfma_f32_16x16x32_bf16 v[216:219], v[108:111], v[60:63], v[216:219]
    v_mfma_f32_16x16x32_bf16 v[220:223], v[180:183], v[60:63], v[220:223]
    v_mfma_f32_16x16x32_bf16 v[224:227], a[44:47], v[56:59], v[224:227]
    v_mfma_f32_16x16x32_bf16 v[228:231], a[116:119], v[56:59], v[228:231]
    v_mfma_f32_16x16x32_bf16 v[232:235], a[44:47], v[60:63], v[232:235]
    v_mfma_f32_16x16x32_bf16 v[236:239], a[116:119], v[60:63], v[236:239]
    ds_read_b128 v[56:59], v3 offset:15360
    ds_read_b128 v[60:63], v3 offset:33792
    s_waitcnt lgkmcnt(6)
    v_mfma_f32_16x16x32_bf16 v[208:211], v[112:115], v[32:35], v[208:211]
    v_mfma_f32_16x16x32_bf16 v[212:215], v[184:187], v[32:35], v[212:215]
    v_mfma_f32_16x16x32_bf16 v[216:219], v[112:115], v[36:39], v[216:219]
    v_mfma_f32_16x16x32_bf16 v[220:223], v[184:187], v[36:39], v[220:223]
    v_mfma_f32_16x16x32_bf16 v[224:227], a[48:51], v[32:35], v[224:227]
    v_mfma_f32_16x16x32_bf16 v[228:231], a[120:123], v[32:35], v[228:231]
    v_mfma_f32_16x16x32_bf16 v[232:235], a[48:51], v[36:39], v[232:235]
    v_mfma_f32_16x16x32_bf16 v[236:239], a[120:123], v[36:39], v[236:239]
    ds_read_b128 v[32:35], v3 offset:16384
    ds_read_b128 v[36:39], v3 offset:34816
    s_waitcnt lgkmcnt(6)
    v_mfma_f32_16x16x32_bf16 v[208:211], v[116:119], v[40:43], v[208:211]
    v_mfma_f32_16x16x32_bf16 v[212:215], v[188:191], v[40:43], v[212:215]
    v_mfma_f32_16x16x32_bf16 v[216:219], v[116:119], v[44:47], v[216:219]
    v_mfma_f32_16x16x32_bf16 v[220:223], v[188:191], v[44:47], v[220:223]
    v_mfma_f32_16x16x32_bf16 v[224:227], a[52:55], v[40:43], v[224:227]
    v_mfma_f32_16x16x32_bf16 v[228:231], a[124:127], v[40:43], v[228:231]
    v_mfma_f32_16x16x32_bf16 v[232:235], a[52:55], v[44:47], v[232:235]
    v_mfma_f32_16x16x32_bf16 v[236:239], a[124:127], v[44:47], v[236:239]
    ds_read_b128 v[40:43], v3 offset:17408
    ds_read_b128 v[44:47], v3 offset:35840
    s_waitcnt lgkmcnt(6)
    v_mfma_f32_16x16x32_bf16 v[208:211], v[120:123], v[48:51], v[208:211]
    v_mfma_f32_16x16x32_bf16 v[212:215], v[192:195], v[48:51], v[212:215]
    v_mfma_f32_16x16x32_bf16 v[216:219], v[120:123], v[52:55], v[216:219]
    v_mfma_f32_16x16x32_bf16 v[220:223], v[192:195], v[52:55], v[220:223]
    v_mfma_f32_16x16x32_bf16 v[224:227], a[56:59], v[48:51], v[224:227]
    v_mfma_f32_16x16x32_bf16 v[228:231], a[128:131], v[48:51], v[228:231]
    v_mfma_f32_16x16x32_bf16 v[232:235], a[56:59], v[52:55], v[232:235]
    v_mfma_f32_16x16x32_bf16 v[236:239], a[128:131], v[52:55], v[236:239]
    s_waitcnt lgkmcnt(4)
    v_mfma_f32_16x16x32_bf16 v[208:211], v[124:127], v[56:59], v[208:211]
    v_mfma_f32_16x16x32_bf16 v[212:215], v[196:199], v[56:59], v[212:215]
    v_mfma_f32_16x16x32_bf16 v[216:219], v[124:127], v[60:63], v[216:219]
    v_mfma_f32_16x16x32_bf16 v[220:223], v[196:199], v[60:63], v[220:223]
    v_mfma_f32_16x16x32_bf16 v[224:227], a[60:63], v[56:59], v[224:227]
    v_mfma_f32_16x16x32_bf16 v[228:231], a[132:135], v[56:59], v[228:231]
    v_mfma_f32_16x16x32_bf16 v[232:235], a[60:63], v[60:63], v[232:235]
    v_mfma_f32_16x16x32_bf16 v[236:239], a[132:135], v[60:63], v[236:239]
    s_waitcnt lgkmcnt(2)
    v_mfma_f32_16x16x32_bf16 v[208:211], v[128:131], v[32:35], v[208:211]
    v_mfma_f32_16x16x32_bf16 v[212:215], v[200:203], v[32:35], v[212:215]
    v_mfma_f32_16x16x32_bf16 v[216:219], v[128:131], v[36:39], v[216:219]
    v_mfma_f32_16x16x32_bf16 v[220:223], v[200:203], v[36:39], v[220:223]
    v_mfma_f32_16x16x32_bf16 v[224:227], a[64:67], v[32:35], v[224:227]
    v_mfma_f32_16x16x32_bf16 v[228:231], a[136:139], v[32:35], v[228:231]
    v_mfma_f32_16x16x32_bf16 v[232:235], a[64:67], v[36:39], v[232:235]
    v_mfma_f32_16x16x32_bf16 v[236:239], a[136:139], v[36:39], v[236:239]
    s_waitcnt lgkmcnt(0)
    v_mfma_f32_16x16x32_bf16 v[208:211], v[132:135], v[40:43], v[208:211]
    v_mfma_f32_16x16x32_bf16 v[212:215], v[204:207], v[40:43], v[212:215]
    v_mfma_f32_16x16x32_bf16 v[216:219], v[132:135], v[44:47], v[216:219]
    v_mfma_f32_16x16x32_bf16 v[220:223], v[204:207], v[44:47], v[220:223]
    v_mfma_f32_16x16x32_bf16 v[224:227], a[68:71], v[40:43], v[224:227]
    v_mfma_f32_16x16x32_bf16 v[228:231], a[140:143], v[40:43], v[228:231]
    v_mfma_f32_16x16x32_bf16 v[232:235], a[68:71], v[44:47], v[232:235]
    v_mfma_f32_16x16x32_bf16 v[236:239], a[140:143], v[44:47], v[236:239]
    s_waitcnt vmcnt(9)
    v_cvt_pk_bf16_f32 v8, v208, v209
    v_cvt_pk_bf16_f32 v9, v210, v211
    v_cvt_pk_bf16_f32 v10, v212, v213
    v_cvt_pk_bf16_f32 v11, v214, v215
    s_mov_b32 s28, s26
    buffer_store_dwordx4 v[8:11], v7, s[4:7], s28 offen sc1
    v_cvt_pk_bf16_f32 v12, v216, v217
    v_cvt_pk_bf16_f32 v13, v218, v219
    v_cvt_pk_bf16_f32 v14, v220, v221
    v_cvt_pk_bf16_f32 v15, v222, v223
    s_add_u32 s28, s28, s40
    buffer_store_dwordx4 v[12:15], v7, s[4:7], s28 offen sc1
    v_cvt_pk_bf16_f32 v16, v224, v225
    v_cvt_pk_bf16_f32 v17, v226, v227
    v_cvt_pk_bf16_f32 v18, v228, v229
    v_cvt_pk_bf16_f32 v19, v230, v231
    s_add_u32 s28, s26, s43
    buffer_store_dwordx4 v[16:19], v7, s[4:7], s28 offen sc1
    v_cvt_pk_bf16_f32 v20, v232, v233
    v_cvt_pk_bf16_f32 v21, v234, v235
    v_cvt_pk_bf16_f32 v22, v236, v237
    v_cvt_pk_bf16_f32 v23, v238, v239
    s_add_u32 s28, s28, s40
    buffer_store_dwordx4 v[20:23], v7, s[4:7], s28 offen sc1
    s_add_u32 s26, s26, s41
    s_add_u32 s27, s27, 36864
    s_cmp_eq_u32 s27, 110592
    s_cselect_b32 s27, 0, s27
    s_add_u32 s30, s30, 1
    s_add_u32 s19, s19, s20
    s_cmp_lt_u32 s19, 64
    s_cbranch_scc1 qk_loop
    s_branch qk_done
qk_vloop:
    s_barrier
    v_add_u32 v3, s27, v1
    ds_read_b128 v[32:35], v3 offset:0
    ds_read_b128 v[36:39], v3 offset:18432
    ds_read_b128 v[40:43], v3 offset:1024
    ds_read_b128 v[44:47], v3 offset:19456
    ds_read_b128 v[48:51], v3 offset:2048
    ds_read_b128 v[52:55], v3 offset:20480
    s_sub_u32 s22, s30, 1
    v_mov_b32 v4, s22
    s_mov_b64 exec, s[34:35]
    buffer_store_dword v4, off, s[4:7], s29 sc1
    s_mov_b64 exec, -1
    s_add_u32 s22, s27, 73728
    s_sub_u32 s21, s22, 110592
    s_cselect_b32 s22, s22, s21
    ds_read_b128 v[56:59], v3 offset:3072
    ds_read_b128 v[60:63], v3 offset:21504
    s_add_u32 s23, s22, s25
    s_add_u32 m0, s23, 0
    s_nop 0
    buffer_load_dwordx4 v2, s[8:11], s24 offen offset:0 lds
    s_waitcnt lgkmcnt(6)
    v_mfma_f32_16x16x32_bf16 v[208:211], v[32:35], v[64:67], 0
    v_mfma_f32_16x16x32_bf16 v[212:215], v[32:35], v[136:139], 0
    v_mfma_f32_16x16x32_bf16 v[216:219], v[36:39], v[64:67], 0
    v_mfma_f32_16x16x32_bf16 v[220:223], v[36:39], v[136:139], 0
    v_mfma_f32_16x16x32_bf16 v[224:227], v[32:35], a[0:3], 0
    v_mfma_f32_16x16x32_bf16 v[228:231], v[32:35], a[72:75], 0
    v_mfma_f32_16x16x32_bf16 v[232:235], v[36:39], a[0:3], 0
    v_mfma_f32_16x16x32_bf16 v[236:239], v[36:39], a[72:75], 0
    ds_read_b128 v[32:35], v3 offset:4096
    ds_read_b128 v[36:39], v3 offset:22528
    s_add_u32 m0, s23, 960
    s_nop 0
    buffer_load_dwordx4 v2, s[8:11], s24 offen offset:64 lds
    s_waitcnt lgkmcnt(6)
    v_mfma_f32_16x16x32_bf16 v[208:211], v[40:43], v[68:71], v[208:211]
    v_mfma_f32_16x16x32_bf16 v[212:215], v[40:43], v[140:143], v[212:215]
    v_mfma_f32_16x16x32_bf16 v[216:219], v[44:47], v[68:71], v[216:219]
    v_mfma_f32_16x16x32_bf16 v[220:223], v[44:47], v[140:143], v[220:223]
    v_mfma_f32_16x16x32_bf16 v[224:227], v[40:43], a[4:7], v[224:227]
    v_mfma_f32_16x16x32_bf16 v[228:231], v[40:43], a[76:79], v[228:231]
    v_mfma_f32_16x16x32_bf16 v[232:235], v[44:47], a[4:7], v[232:235]
    v_mfma_f32_16x16x32_bf16 v[236:239], v[44:47], a[76:79], v[236:239]
    ds_read_b128 v[40:43], v3 offset:5120
    ds_read_b128 v[44:47], v3 offset:23552
    s_add_u32 m0, s23, 1920
    s_nop 0
    buffer_load_dwordx4 v2, s[8:11], s24 offen offset:128 lds
    s_waitcnt lgkmcnt(6)
    v_mfma_f32_16x16x32_bf16 v[208:211], v[48:51], v[72:75], v[208:211]
    v_mfma_f32_16x16x32_bf16 v[212:215], v[48:51], v[144:147], v[212:215]
    v_mfma_f32_16x16x32_bf16 v[216:219], v[52:55], v[72:75], v[216:219]
    v_mfma_f32_16x16x32_bf16 v[220:223], v[52:55], v[144:147], v[220:223]
    v_mfma_f32_16x16x32_bf16 v[224:227], v[48:51], a[8:11], v[224:227]
    v_mfma_f32_16x16x32_bf16 v[228:231], v[48:51], a[80:83], v[228:231]
    v_mfma_f32_16x16x32_bf16 v[232:235], v[52:55], a[8:11], v[232:235]
    v_mfma_f32_16x16x32_bf16 v[236:239], v[52:55], a[80:83], v[236:239]
    ds_read_b128 v[48:51], v3 offset:6144
    ds_read_b128 v[52:55], v3 offset:24576
    s_add_u32 m0, s23, 2880
    s_nop 0
    buffer_load_dwordx4 v2, s[8:11], s24 offen offset:192 lds
    s_waitcnt lgkmcnt(6)
    v_mfma_f32_16x16x32_bf16 v[208:211], v[56:59], v[76:79], v[208:211]
    v_mfma_f32_16x16x32_bf16 v[212:215], v[56:59], v[148:151], v[212:215]
    v_mfma_f32_16x16x32_bf16 v[216:219], v[60:63], v[76:79], v[216:219]
    v_mfma_f32_16x16x32_bf16 v[220:223], v[60:63], v[148:151], v[220:223]
    v_mfma_f32_16x16x32_bf16 v[224:227], v[56:59], a[12:15], v[224:227]
    v_mfma_f32_16x16x32_bf16 v[228:231], v[56:59], a[84:87], v[228:231]
    v_mfma_f32_16x16x32_bf16 v[232:235], v[60:63], a[12:15], v[232:235]
    v_mfma_f32_16x16x32_bf16 v[236:239], v[60:63], a[84:87], v[236:239]
    ds_read_b128 v[56:59], v3 offset:7168
    ds_read_b128 v[60:63], v3 offset:25600
    s_add_u32 m0, s23, 3840
    s_nop 0
    buffer_load_dwordx4 v2, s[8:11], s24 offen offset:256 lds
    s_waitcnt lgkmcnt(6)
    v_mfma_f32_16x16x32_bf16 v[208:211], v[32:35], v[80:83], v[208:211]
    v_mfma_f32_16x16x32_bf16 v[212:215], v[32:35], v[152:155], v[212:215]
    v_mfma_f32_16x16x32_bf16 v[216:219], v[36:39], v[80:83], v[216:219]
    v_mfma_f32_16x16x32_bf16 v[220:223], v[36:39], v[152:155], v[220:223]
    v_mfma_f32_16x16x32_bf16 v[224:227], v[32:35], a[16:19], v[224:227]
    v_mfma_f32_16x16x32_bf16 v[228:231], v[32:35], a[88:91], v[228:231]
    v_mfma_f32_16x16x32_bf16 v[232:235], v[36:39], a[16:19], v[232:235]
    v_mfma_f32_16x16x32_bf16 v[236:239], v[36:39], a[88:91], v[236:239]
    ds_read_b128 v[32:35], v3 offset:8192
    ds_read_b128 v[36:39], v3 offset:26624
    s_add_u32 m0, s23, 4800
    s_nop 0
    buffer_load_dwordx4 v2, s[8:11], s24 offen offset:320 lds
    s_waitcnt lgkmcnt(6)
    v_mfma_f32_16x16x32_bf16 v[208:211], v[40:43], v[84:87], v[208:211]
    v_mfma_f32_16x16x32_bf16 v[212:215], v[40:43], v[156:159], v[212:215]
    v_mfma_f32_16x16x32_bf16 v[216:219], v[44:47], v[84:87], v[216:219]
    v_mfma_f32_16x16x32_bf16 v[220:223], v[44:47], v[156:159], v[220:223]
    v_mfma_f32_16x16x32_bf16 v[224:227], v[40:43], a[20:23], v[224:227]
    v_mfma_f32_16x16x32_bf16 v[228:231], v[40:43], a[92:95], v[228:231]
    v_mfma_f32_16x16x32_bf16 v[232:235], v[44:47], a[20:23], v[232:235]
    v_mfma_f32_16x16x32_bf16 v[236:239], v[44:47], a[92:95], v[236:239]
    ds_read_b128 v[40:43], v3 offset:9216
    ds_read_b128 v[44:47], v3 offset:27648
    s_add_u32 m0, s23, 5760
    s_nop 0
    buffer_load_dwordx4 v2, s[8:11], s24 offen offset:384 lds
    s_waitcnt lgkmcnt(6)
    v_mfma_f32_16x16x32_bf16 v[208:211], v[48:51], v[88:91], v[208:211]
    v_mfma_f32_16x16x32_bf16 v[212:215], v[48:51], v[160:163], v[212:215]
    v_mfma_f32_16x16x32_bf16 v[216:219], v[52:55], v[88:91], v[216:219]
    v_mfma_f32_16x16x32_bf16 v[220:223], v[52:55], v[160:163], v[220:223]
    v_mfma_f32_16x16x32_bf16 v[224:227], v[48:51], a[24:27], v[224:227]
    v_mfma_f32_16x16x32_bf16 v[228:231], v[48:51], a[96:99], v[228:231]
    v_mfma_f32_16x16x32_bf16 v[232:235], v[52:55], a[24:27], v[232:235]
    v_mfma_f32_16x16x32_bf16 v[236:239], v[52:55], a[96:99], v[236:239]
    ds_read_b128 v[48:51], v3 offset:10240
    ds_read_b128 v[52:55], v3 offset:28672
    s_add_u32 m0, s23, 6720
    s_nop 0
    buffer_load_dwordx4 v2, s[8:11], s24 offen offset:448 lds
    s_waitcnt lgkmcnt(6)
    v_mfma_f32_16x16x32_bf16 v[208:211], v[56:59], v[92:95], v[208:211]
    v_mfma_f32_16x16x32_bf16 v[212:215], v[56:59], v[164:167], v[212:215]
    v_mfma_f32_16x16x32_bf16 v[216:219], v[60:63], v[92:95], v[216:219]
    v_mfma_f32_16x16x32_bf16 v[220:223], v[60:63], v[164:167], v[220:223]
    v_mfma_f32_16x16x32_bf16 v[224:227], v[56:59], a[28:31], v[224:227]
    v_mfma_f32_16x16x32_bf16 v[228:231], v[56:59], a[100:103], v[228:231]
    v_mfma_f32_16x16x32_bf16 v[232:235], v[60:63], a[28:31], v[232:235]
    v_mfma_f32_16x16x32_bf16 v[236:239], v[60:63], a[100:103], v[236:239]
    ds_read_b128 v[56:59], v3 offset:11264
    ds_read_b128 v[60:63], v3 offset:29696
    s_add_u32 m0, s23, 7680
    s_nop 0
    buffer_load_dwordx4 v2, s[8:11], s24 offen offset:512 lds
    s_add_u32 s24, s24, s42
    s_waitcnt lgkmcnt(6)
    v_mfma_f32_16x16x32_bf16 v[208:211], v[32:35], v[96:99], v[208:211]
    v_mfma_f32_16x16x32_bf16 v[212:215], v[32:35], v[168:171], v[212:215]
    v_mfma_f32_16x16x32_bf16 v[216:219], v[36:39], v[96:99], v[216:219]
    v_mfma_f32_16x16x32_bf16 v[220:223], v[36:39], v[168:171], v[220:223]
    v_mfma_f32_16x16x32_bf16 v[224:227], v[32:35], a[32:35], v[224:227]
    v_mfma_f32_16x16x32_bf16 v[228:231], v[32:35], a[104:107], v[228:231]
    v_mfma_f32_16x16x32_bf16 v[232:235], v[36:39], a[32:35], v[232:235]
    v_mfma_f32_16x16x32_bf16 v[236:239], v[36:39], a[104:107], v[236:239]
    ds_read_b128 v[32:35], v3 offset:12288
    ds_read_b128 v[36:39], v3 offset:30720
    s_waitcnt lgkmcnt(6)
    v_mfma_f32_16x16x32_bf16 v[208:211], v[40:43], v[100:103], v[208:211]
    v_mfma_f32_16x16x32_bf16 v[212:215], v[40:43], v[172:175], v[212:215]
    v_mfma_f32_16x16x32_bf16 v[216:219], v[44:47], v[100:103], v[216:219]
    v_mfma_f32_16x16x32_bf16 v[220:223], v[44:47], v[172:175], v[220:223]
    v_mfma_f32_16x16x32_bf16 v[224:227], v[40:43], a[36:39], v[224:227]
    v_mfma_f32_16x16x32_bf16 v[228:231], v[40:43], a[108:111], v[228:231]
    v_mfma_f32_16x16x32_bf16 v[232:235], v[44:47], a[36:39], v[232:235]
    v_mfma_f32_16x16x32_bf16 v[236:239], v[44:47], a[108:111], v[236:239]
    ds_read_b128 v[40:43], v3 offset:13312
    ds_read_b128 v[44:47], v3 offset:31744
    s_waitcnt lgkmcnt(6)
    v_mfma_f32_16x16x32_bf16 v[208:211], v[48:51], v[104:107], v[208:211]
    v_mfma_f32_16x16x32_bf16 v[212:215], v[48:51], v[176:179], v[212:215]
    v_mfma_f32_16x16x32_bf16 v[216:219], v[52:55], v[104:107], v[216:219]
    v_mfma_f32_16x16x32_bf16 v[220:223], v[52:55], v[176:179], v[220:223]
    v_mfma_f32_16x16x32_bf16 v[224:227], v[48:51], a[40:43], v[224:227]
    v_mfma_f32_16x16x32_bf16 v[228:231], v[48:51], a[112:115], v[228:231]
    v_mfma_f32_16x16x32_bf16 v[232:235], v[52:55], a[40:43], v[232:235]
    v_mfma_f32_16x16x32_bf16 v[236:239], v[52:55], a[112:115], v[236:239]
    ds_read_b128 v[48:51], v3 offset:14336
    ds_read_b128 v[52:55], v3 offset:32768
    s_waitcnt lgkmcnt(6)
    v_mfma_f32_16x16x32_bf16 v[208:211], v[56:59], v[108:111], v[208:211]
    v_mfma_f32_16x16x32_bf16 v[212:215], v[56:59], v[180:183], v[212:215]
    v_mfma_f32_16x16x32_bf16 v[216:219], v[60:63], v[108:111], v[216:219]
    v_mfma_f32_16x16x32_bf16 v[220:223], v[60:63], v[180:183], v[220:223]
    v_mfma_f32_16x16x32_bf16 v[224:227], v[56:59], a[44:47], v[224:227]
    v_mfma_f32_16x16x32_bf16 v[228:231], v[56:59], a[116:119], v[228:231]
    v_mfma_f32_16x16x32_bf16 v[232:235], v[60:63], a[44:47], v[232:235]
    v_mfma_f32_16x16x32_bf16 v[236:239], v[60:63], a[116:119], v[236:239]
    ds_read_b128 v[56:59], v3 offset:15360
    ds_read_b128 v[60:63], v3 offset:33792
    s_waitcnt lgkmcnt(6)
    v_mfma_f32_16x16x32_bf16 v[208:211], v[32:35], v[112:115], v[208:211]
    v_mfma_f32_16x16x32_bf16 v[212:215], v[32:35], v[184:187], v[212:215]
    v_mfma_f32_16x16x32_bf16 v[216:219], v[36:39], v[112:115], v[216:219]
    v_mfma_f32_16x16x32_bf16 v[220:223], v[36:39], v[184:187], v[220:223]
    v_mfma_f32_16x16x32_bf16 v[224:227], v[32:35], a[48:51], v[224:227]
    v_mfma_f32_16x16x32_bf16 v[228:231], v[32:35], a[120:123], v[228:231]
    v_mfma_f32_16x16x32_bf16 v[232:235], v[36:39], a[48:51], v[232:235]
    v_mfma_f32_16x16x32_bf16 v[236:239], v[36:39], a[120:123], v[236:239]
    ds_read_b128 v[32:35], v3 offset:16384
    ds_read_b128 v[36:39], v3 offset:34816
    s_waitcnt lgkmcnt(6)
    v_mfma_f32_16x16x32_bf16 v[208:211], v[40:43], v[116:119], v[208:211]
    v_mfma_f32_16x16x32_bf16 v[212:215], v[40:43], v[188:191], v[212:215]
    v_mfma_f32_16x16x32_bf16 v[216:219], v[44:47], v[116:119], v[216:219]
    v_mfma_f32_16x16x32_bf16 v[220:223], v[44:47], v[188:191], v[220:223]
    v_mfma_f32_16x16x32_bf16 v[224:227], v[40:43], a[52:55], v[224:227]
    v_mfma_f32_16x16x32_bf16 v[228:231], v[40:43], a[124:127], v[228:231]
    v_mfma_f32_16x16x32_bf16 v[232:235], v[44:47], a[52:55], v[232:235]
    v_mfma_f32_16x16x32_bf16 v[236:239], v[44:47], a[124:127], v[236:239]
    ds_read_b128 v[40:43], v3 offset:17408
    ds_read_b128 v[44:47], v3 offset:35840
    s_waitcnt lgkmcnt(6)
    v_mfma_f32_16x16x32_bf16 v[208:211], v[48:51], v[120:123], v[208:211]
    v_mfma_f32_16x16x32_bf16 v[212:215], v[48:51], v[192:195], v[212:215]
    v_mfma_f32_16x16x32_bf16 v[216:219], v[52:55], v[120:123], v[216:219]
    v_mfma_f32_16x16x32_bf16 v[220:223], v[52:55], v[192:195], v[220:223]
    v_mfma_f32_16x16x32_bf16 v[224:227], v[48:51], a[56:59], v[224:227]
    v_mfma_f32_16x16x32_bf16 v[228:231], v[48:51], a[128:131], v[228:231]
    v_mfma_f32_16x16x32_bf16 v[232:235], v[52:55], a[56:59], v[232:235]
    v_mfma_f32_16x16x32_bf16 v[236:239], v[52:55], a[128:131], v[236:239]
    s_waitcnt lgkmcnt(4)
    v_mfma_f32_16x16x32_bf16 v[208:211], v[56:59], v[124:127], v[208:211]
    v_mfma_f32_16x16x32_bf16 v[212:215], v[56:59], v[196:199], v[212:215]
    v_mfma_f32_16x16x32_bf16 v[216:219], v[60:63], v[124:127], v[216:219]
    v_mfma_f32_16x16x32_bf16 v[220:223], v[60:63], v[196:199], v[220:223]
    v_mfma_f32_16x16x32_bf16 v[224:227], v[56:59], a[60:63], v[224:227]
    v_mfma_f32_16x16x32_bf16 v[228:231], v[56:59], a[132:135], v[228:231]
    v_mfma_f32_16x16x32_bf16 v[232:235], v[60:63], a[60:63], v[232:235]
    v_mfma_f32_16x16x32_bf16 v[236:239], v[60:63], a[132:135], v[236:239]
    s_waitcnt lgkmcnt(2)
    v_mfma_f32_16x16x32_bf16 v[208:211], v[32:35], v[128:131], v[208:211]
    v_mfma_f32_16x16x32_bf16 v[212:215], v[32:35], v[200:203], v[212:215]
    v_mfma_f32_16x16x32_bf16 v[216:219], v[36:39], v[128:131], v[216:219]
    v_mfma_f32_16x16x32_bf16 v[220:223], v[36:39], v[200:203], v[220:223]
    v_mfma_f32_16x16x32_bf16 v[224:227], v[32:35], a[64:67], v[224:227]
    v_mfma_f32_16x16x32_bf16 v[228:231], v[32:35], a[136:139], v[228:231]
    v_mfma_f32_16x16x32_bf16 v[232:235], v[36:39], a[64:67], v[232:235]
    v_mfma_f32_16x16x32_bf16 v[236:239], v[36:39], a[136:139], v[236:239]
    s_waitcnt lgkmcnt(0)
    v_mfma_f32_16x16x32_bf16 v[208:211], v[40:43], v[132:135], v[208:211]
    v_mfma_f32_16x16x32_bf16 v[212:215], v[40:43], v[204:207], v[212:215]
    v_mfma_f32_16x16x32_bf16 v[216:219], v[44:47], v[132:135], v[216:219]
    v_mfma_f32_16x16x32_bf16 v[220:223], v[44:47], v[204:207], v[220:223]
    v_mfma_f32_16x16x32_bf16 v[224:227], v[40:43], a[68:71], v[224:227]
    v_mfma_f32_16x16x32_bf16 v[228:231], v[40:43], a[140:143], v[228:231]
    v_mfma_f32_16x16x32_bf16 v[232:235], v[44:47], a[68:71], v[232:235]
    v_mfma_f32_16x16x32_bf16 v[236:239], v[44:47], a[140:143], v[236:239]
    s_waitcnt vmcnt(9)
    v_cvt_pk_bf16_f32 v8, v208, v209
    v_cvt_pk_bf16_f32 v9, v210, v211
    v_cvt_pk_bf16_f32 v10, v216, v217
    v_cvt_pk_bf16_f32 v11, v218, v219
    s_mov_b32 s28, s26
    buffer_store_dwordx4 v[8:11], v7, s[4:7], s28 offen sc1
    v_cvt_pk_bf16_f32 v12, v212, v213
    v_cvt_pk_bf16_f32 v13, v214, v215
    v_cvt_pk_bf16_f32 v14, v220, v221
    v_cvt_pk_bf16_f32 v15, v222, v223
    s_add_u32 s28, s28, s40
    buffer_store_dwordx4 v[12:15], v7, s[4:7], s28 offen sc1
    v_cvt_pk_bf16_f32 v16, v224, v225
    v_cvt_pk_bf16_f32 v17, v226, v227
    v_cvt_pk_bf16_f32 v18, v232, v233
    v_cvt_pk_bf16_f32 v19, v234, v235
    s_add_u32 s28, s26, s43
    buffer_store_dwordx4 v[16:19], v7, s[4:7], s28 offen sc1
    v_cvt_pk_bf16_f32 v20, v228, v229
    v_cvt_pk_bf16_f32 v21, v230, v231
    v_cvt_pk_bf16_f32 v22, v236, v237
    v_cvt_pk_bf16_f32 v23, v238, v239
    s_add_u32 s28, s28, s40
    buffer_store_dwordx4 v[20:23], v7, s[4:7], s28 offen sc1
    s_add_u32 s26, s26, s41
    s_add_u32 s27, s27, 36864
    s_cmp_eq_u32 s27, 110592
    s_cselect_b32 s27, 0, s27
    s_add_u32 s30, s30, 1
    s_add_u32 s19, s19, s20
    s_cmp_lt_u32 s19, 64
    s_cbranch_scc1 qk_vloop
qk_done:
    s_waitcnt vmcnt(0)
    s_barrier
    s_add_u32 s22, s95, 63
    v_mov_b32 v4, s22
    s_mov_b64 exec, s[34:35]
    buffer_store_dword v4, off, s[4:7], s29 sc1
    s_mov_b64 exec, -1
    s_cmp_ge_u32 s36, 64
    s_cbranch_scc1 L_qkv_next
    s_lshr_b32 s33, s36, 5
    v_and_b32 v4, 63, v0
    v_lshrrev_b32 v5, 4, v4
    v_add_u32 v1, 0, v5
    v_mul_u32_u24 v6, 11, v1
    v_lshrrev_b32 v6, 5, v6
    v_add_u32 v1, v1, v6
    v_lshlrev_b32 v1, 7, v1
    v_and_b32 v6, 7, v4
    v_lshl_add_u32 v1, v6, 4, v1
    v_add_u32 v2, 4, v5
    v_mul_u32_u24 v6, 11, v2
    v_lshrrev_b32 v6, 5, v6
    v_add_u32 v2, v2, v6
    v_lshlrev_b32 v2, 7, v2
    v_and_b32 v6, 7, v4
    v_lshl_add_u32 v2, v6, 4, v2
    v_add_u32 v3, 8, v5
    v_mul_u32_u24 v6, 11, v3
    v_lshrrev_b32 v6, 5, v6
    v_add_u32 v3, v3, v6
    v_lshlrev_b32 v3, 7, v3
    v_and_b32 v6, 7, v4
    v_lshl_add_u32 v3, v6, 4, v3
    v_min_u32 v6, 23, v4
    v_lshlrev_b32 v6, 9, v6
    s_mov_b32 s19, s33
    s_mul_i32 s24, s19, 12288
    s_add_u32 s24, s24, 90177536
    s_lshl_b32 s26, s19, 5
    s_add_u32 s26, s26, s17
    s_lshl_b32 s26, s26, 12
    s_mov_b32 s21, 71303168
    s_cmp_eq_u32 s16, 2
    s_cselect_b32 s21, 80740352, s21
    s_add_u32 s26, s26, s21
    s_lshl_b32 s29, s17, 7
    s_lshl_b32 s21, s16, 1
    s_add_u32 s21, s21, s33
    s_lshl_b32 s21, s21, 2
    s_add_u32 s29, s29, s21
    s_add_u32 s29, s29, 125829240
mk_loop:
    s_cmp_lg_u32 s18, 0
    s_cbranch_scc1 mk_go
    s_add_u32 s23, s24, 12288
    s_mov_b32 s21, 4194304
mk_wait:
    buffer_load_dword v4, v6, s[4:7], s23 offen offset:384 sc1
    s_sub_u32 s21, s21, 1
    s_cbranch_scc1 mk_go
    s_waitcnt vmcnt(0)
    v_cmp_ne_u32 vcc, s95, v4
    s_cbranch_vccz mk_go
    s_sleep 4
    s_branch mk_wait
mk_go:
    s_barrier
    s_add_u32 s23, s24, 0
    buffer_load_dwordx4 v[24:27], v1, s[4:7], s23 offen offset:0 sc1
    buffer_load_dwordx4 v[28:31], v2, s[4:7], s23 offen offset:0 sc1
    buffer_load_dwordx4 v[32:35], v3, s[4:7], s23 offen offset:0 sc1
    buffer_load_dwordx4 v[36:39], v1, s[4:7], s23 offen offset:2048 sc1
    buffer_load_dwordx4 v[40:43], v2, s[4:7], s23 offen offset:2048 sc1
    buffer_load_dwordx4 v[44:47], v3, s[4:7], s23 offen offset:2048 sc1
    s_add_u32 s23, s24, 4096
    buffer_load_dwordx4 v[48:51], v1, s[4:7], s23 offen offset:0 sc1
    buffer_load_dwordx4 v[52:55], v2, s[4:7], s23 offen offset:0 sc1
    buffer_load_dwordx4 v[56:59], v3, s[4:7], s23 offen offset:0 sc1
    buffer_load_dwordx4 v[60:63], v1, s[4:7], s23 offen offset:2048 sc1
    buffer_load_dwordx4 v[208:211], v2, s[4:7], s23 offen offset:2048 sc1
    buffer_load_dwordx4 v[212:215], v3, s[4:7], s23 offen offset:2048 sc1
    s_add_u32 s23, s24, 8192
    buffer_load_dwordx4 v[216:219], v1, s[4:7], s23 offen offset:0 sc1
    buffer_load_dwordx4 v[220:223], v2, s[4:7], s23 offen offset:0 sc1
    buffer_load_dwordx4 v[224:227], v3, s[4:7], s23 offen offset:0 sc1
    buffer_load_dwordx4 v[228:231], v1, s[4:7], s23 offen offset:2048 sc1
    buffer_load_dwordx4 v[232:235], v2, s[4:7], s23 offen offset:2048 sc1
    buffer_load_dwordx4 v[236:239], v3, s[4:7], s23 offen offset:2048 sc1
    s_add_u32 s24, s24, 24576
    s_add_u32 s22, s19, s95
    s_add_u32 s22, s22, 1
    s_cmp_eq_u32 s16, 2
    s_cbranch_scc1 mk_v
    s_waitcnt vmcnt(17)
    v_mfma_f32_16x16x32_bf16 v[8:11], v[64:67], v[24:27], 0
    v_mfma_f32_16x16x32_bf16 v[12:15], v[136:139], v[24:27], 0
    v_mfma_f32_16x16x32_bf16 v[16:19], a[0:3], v[24:27], 0
    v_mfma_f32_16x16x32_bf16 v[20:23], a[72:75], v[24:27], 0
    s_waitcnt vmcnt(16)
    v_mfma_f32_16x16x32_bf16 v[8:11], v[68:71], v[28:31], v[8:11]
    v_mfma_f32_16x16x32_bf16 v[12:15], v[140:143], v[28:31], v[12:15]
    v_mfma_f32_16x16x32_bf16 v[16:19], a[4:7], v[28:31], v[16:19]
    v_mfma_f32_16x16x32_bf16 v[20:23], a[76:79], v[28:31], v[20:23]
    s_waitcnt vmcnt(15)
    v_mfma_f32_16x16x32_bf16 v[8:11], v[72:75], v[32:35], v[8:11]
    v_mfma_f32_16x16x32_bf16 v[12:15], v[144:147], v[32:35], v[12:15]
    v_mfma_f32_16x16x32_bf16 v[16:19], a[8:11], v[32:35], v[16:19]
    v_mfma_f32_16x16x32_bf16 v[20:23], a[80:83], v[32:35], v[20:23]
    s_waitcnt vmcnt(14)
    v_mfma_f32_16x16x32_bf16 v[8:11], v[76:79], v[36:39], v[8:11]
    v_mfma_f32_16x16x32_bf16 v[12:15], v[148:151], v[36:39], v[12:15]
    v_mfma_f32_16x16x32_bf16 v[16:19], a[12:15], v[36:39], v[16:19]
    v_mfma_f32_16x16x32_bf16 v[20:23], a[84:87], v[36:39], v[20:23]
    s_waitcnt vmcnt(13)
    v_mfma_f32_16x16x32_bf16 v[8:11], v[80:83], v[40:43], v[8:11]
    v_mfma_f32_16x16x32_bf16 v[12:15], v[152:155], v[40:43], v[12:15]
    v_mfma_f32_16x16x32_bf16 v[16:19], a[16:19], v[40:43], v[16:19]
    v_mfma_f32_16x16x32_bf16 v[20:23], a[88:91], v[40:43], v[20:23]
    s_waitcnt vmcnt(12)
    v_mfma_f32_16x16x32_bf16 v[8:11], v[84:87], v[44:47], v[8:11]
    v_mfma_f32_16x16x32_bf16 v[12:15], v[156:159], v[44:47], v[12:15]
    v_mfma_f32_16x16x32_bf16 v[16:19], a[20:23], v[44:47], v[16:19]
    v_mfma_f32_16x16x32_bf16 v[20:23], a[92:95], v[44:47], v[20:23]
    s_waitcnt vmcnt(11)
    v_mfma_f32_16x16x32_bf16 v[8:11], v[88:91], v[48:51], v[8:11]
    v_mfma_f32_16x16x32_bf16 v[12:15], v[160:163], v[48:51], v[12:15]
    v_mfma_f32_16x16x32_bf16 v[16:19], a[24:27], v[48:51], v[16:19]
    v_mfma_f32_16x16x32_bf16 v[20:23], a[96:99], v[48:51], v[20:23]
    s_waitcnt vmcnt(10)
    v_mfma_f32_16x16x32_bf16 v[8:11], v[92:95], v[52:55], v[8:11]
    v_mfma_f32_16x16x32_bf16 v[12:15], v[164:167], v[52:55], v[12:15]
    v_mfma_f32_16x16x32_bf16 v[16:19], a[28:31], v[52:55], v[16:19]
    v_mfma_f32_16x16x32_bf16 v[20:23], a[100:103], v[52:55], v[20:23]
    s_waitcnt vmcnt(9)
    v_mfma_f32_16x16x32_bf16 v[8:11], v[96:99], v[56:59], v[8:11]
    v_mfma_f32_16x16x32_bf16 v[12:15], v[168:171], v[56:59], v[12:15]
    v_mfma_f32_16x16x32_bf16 v[16:19], a[32:35], v[56:59], v[16:19]
    v_mfma_f32_16x16x32_bf16 v[20:23], a[104:107], v[56:59], v[20:23]
    s_waitcnt vmcnt(8)
    v_mfma_f32_16x16x32_bf16 v[8:11], v[100:103], v[60:63], v[8:11]
    v_mfma_f32_16x16x32_bf16 v[12:15], v[172:175], v[60:63], v[12:15]
    v_mfma_f32_16x16x32_bf16 v[16:19], a[36:39], v[60:63], v[16:19]
    v_mfma_f32_16x16x32_bf16 v[20:23], a[108:111], v[60:63], v[20:23]
    s_waitcnt vmcnt(7)
    v_mfma_f32_16x16x32_bf16 v[8:11], v[104:107], v[208:211], v[8:11]
    v_mfma_f32_16x16x32_bf16 v[12:15], v[176:179], v[208:211], v[12:15]
    v_mfma_f32_16x16x32_bf16 v[16:19], a[40:43], v[208:211], v[16:19]
    v_mfma_f32_16x16x32_bf16 v[20:23], a[112:115], v[208:211], v[20:23]
    s_waitcnt vmcnt(6)
    v_mfma_f32_16x16x32_bf16 v[8:11], v[108:111], v[212:215], v[8:11]
    v_mfma_f32_16x16x32_bf16 v[12:15], v[180:183], v[212:215], v[12:15]
    v_mfma_f32_16x16x32_bf16 v[16:19], a[44:47], v[212:215], v[16:19]
    v_mfma_f32_16x16x32_bf16 v[20:23], a[116:119], v[212:215], v[20:23]
    s_waitcnt vmcnt(5)
    v_mfma_f32_16x16x32_bf16 v[8:11], v[112:115], v[216:219], v[8:11]
    v_mfma_f32_16x16x32_bf16 v[12:15], v[184:187], v[216:219], v[12:15]
    v_mfma_f32_16x16x32_bf16 v[16:19], a[48:51], v[216:219], v[16:19]
    v_mfma_f32_16x16x32_bf16 v[20:23], a[120:123], v[216:219], v[20:23]
    s_waitcnt vmcnt(4)
    v_mfma_f32_16x16x32_bf16 v[8:11], v[116:119], v[220:223], v[8:11]
    v_mfma_f32_16x16x32_bf16 v[12:15], v[188:191], v[220:223], v[12:15]
    v_mfma_f32_16x16x32_bf16 v[16:19], a[52:55], v[220:223], v[16:19]
    v_mfma_f32_16x16x32_bf16 v[20:23], a[124:127], v[220:223], v[20:23]
    s_waitcnt vmcnt(3)
    v_mfma_f32_16x16x32_bf16 v[8:11], v[120:123], v[224:227], v[8:11]
    v_mfma_f32_16x16x32_bf16 v[12:15], v[192:195], v[224:227], v[12:15]
    v_mfma_f32_16x16x32_bf16 v[16:19], a[56:59], v[224:227], v[16:19]
    v_mfma_f32_16x16x32_bf16 v[20:23], a[128:131], v[224:227], v[20:23]
    s_waitcnt vmcnt(2)
    v_mfma_f32_16x16x32_bf16 v[8:11], v[124:127], v[228:231], v[8:11]
    v_mfma_f32_16x16x32_bf16 v[12:15], v[196:199], v[228:231], v[12:15]
    v_mfma_f32_16x16x32_bf16 v[16:19], a[60:63], v[228:231], v[16:19]
    v_mfma_f32_16x16x32_bf16 v[20:23], a[132:135], v[228:231], v[20:23]
    s_waitcnt vmcnt(1)
    v_mfma_f32_16x16x32_bf16 v[8:11], v[128:131], v[232:235], v[8:11]
    v_mfma_f32_16x16x32_bf16 v[12:15], v[200:203], v[232:235], v[12:15]
    v_mfma_f32_16x16x32_bf16 v[16:19], a[64:67], v[232:235], v[16:19]
    v_mfma_f32_16x16x32_bf16 v[20:23], a[136:139], v[232:235], v[20:23]
    s_waitcnt vmcnt(0)
    v_mfma_f32_16x16x32_bf16 v[8:11], v[132:135], v[236:239], v[8:11]
    v_mfma_f32_16x16x32_bf16 v[12:15], v[204:207], v[236:239], v[12:15]
    v_mfma_f32_16x16x32_bf16 v[16:19], a[68:71], v[236:239], v[16:19]
    v_mfma_f32_16x16x32_bf16 v[20:23], a[140:143], v[236:239], v[20:23]
    s_nop 7
    s_branch mk_st
mk_v:
    s_waitcnt vmcnt(17)
    v_mfma_f32_16x16x32_bf16 v[8:11], v[24:27], v[64:67], 0
    v_mfma_f32_16x16x32_bf16 v[12:15], v[24:27], v[136:139], 0
    v_mfma_f32_16x16x32_bf16 v[16:19], v[24:27], a[0:3], 0
    v_mfma_f32_16x16x32_bf16 v[20:23], v[24:27], a[72:75], 0
    s_waitcnt vmcnt(16)
    v_mfma_f32_16x16x32_bf16 v[8:11], v[28:31], v[68:71], v[8:11]
    v_mfma_f32_16x16x32_bf16 v[12:15], v[28:31], v[140:143], v[12:15]
    v_mfma_f32_16x16x32_bf16 v[16:19], v[28:31], a[4:7], v[16:19]
    v_mfma_f32_16x16x32_bf16 v[20:23], v[28:31], a[76:79], v[20:23]
    s_waitcnt vmcnt(15)
    v_mfma_f32_16x16x32_bf16 v[8:11], v[32:35], v[72:75], v[8:11]
    v_mfma_f32_16x16x32_bf16 v[12:15], v[32:35], v[144:147], v[12:15]
    v_mfma_f32_16x16x32_bf16 v[16:19], v[32:35], a[8:11], v[16:19]
    v_mfma_f32_16x16x32_bf16 v[20:23], v[32:35], a[80:83], v[20:23]
    s_waitcnt vmcnt(14)
    v_mfma_f32_16x16x32_bf16 v[8:11], v[36:39], v[76:79], v[8:11]
    v_mfma_f32_16x16x32_bf16 v[12:15], v[36:39], v[148:151], v[12:15]
    v_mfma_f32_16x16x32_bf16 v[16:19], v[36:39], a[12:15], v[16:19]
    v_mfma_f32_16x16x32_bf16 v[20:23], v[36:39], a[84:87], v[20:23]
    s_waitcnt vmcnt(13)
    v_mfma_f32_16x16x32_bf16 v[8:11], v[40:43], v[80:83], v[8:11]
    v_mfma_f32_16x16x32_bf16 v[12:15], v[40:43], v[152:155], v[12:15]
    v_mfma_f32_16x16x32_bf16 v[16:19], v[40:43], a[16:19], v[16:19]
    v_mfma_f32_16x16x32_bf16 v[20:23], v[40:43], a[88:91], v[20:23]
    s_waitcnt vmcnt(12)
    v_mfma_f32_16x16x32_bf16 v[8:11], v[44:47], v[84:87], v[8:11]
    v_mfma_f32_16x16x32_bf16 v[12:15], v[44:47], v[156:159], v[12:15]
    v_mfma_f32_16x16x32_bf16 v[16:19], v[44:47], a[20:23], v[16:19]
    v_mfma_f32_16x16x32_bf16 v[20:23], v[44:47], a[92:95], v[20:23]
    s_waitcnt vmcnt(11)
    v_mfma_f32_16x16x32_bf16 v[8:11], v[48:51], v[88:91], v[8:11]
    v_mfma_f32_16x16x32_bf16 v[12:15], v[48:51], v[160:163], v[12:15]
    v_mfma_f32_16x16x32_bf16 v[16:19], v[48:51], a[24:27], v[16:19]
    v_mfma_f32_16x16x32_bf16 v[20:23], v[48:51], a[96:99], v[20:23]
    s_waitcnt vmcnt(10)
    v_mfma_f32_16x16x32_bf16 v[8:11], v[52:55], v[92:95], v[8:11]
    v_mfma_f32_16x16x32_bf16 v[12:15], v[52:55], v[164:167], v[12:15]
    v_mfma_f32_16x16x32_bf16 v[16:19], v[52:55], a[28:31], v[16:19]
    v_mfma_f32_16x16x32_bf16 v[20:23], v[52:55], a[100:103], v[20:23]
    s_waitcnt vmcnt(9)
    v_mfma_f32_16x16x32_bf16 v[8:11], v[56:59], v[96:99], v[8:11]
    v_mfma_f32_16x16x32_bf16 v[12:15], v[56:59], v[168:171], v[12:15]
    v_mfma_f32_16x16x32_bf16 v[16:19], v[56:59], a[32:35], v[16:19]
    v_mfma_f32_16x16x32_bf16 v[20:23], v[56:59], a[104:107], v[20:23]
    s_waitcnt vmcnt(8)
    v_mfma_f32_16x16x32_bf16 v[8:11], v[60:63], v[100:103], v[8:11]
    v_mfma_f32_16x16x32_bf16 v[12:15], v[60:63], v[172:175], v[12:15]
    v_mfma_f32_16x16x32_bf16 v[16:19], v[60:63], a[36:39], v[16:19]
    v_mfma_f32_16x16x32_bf16 v[20:23], v[60:63], a[108:111], v[20:23]
    s_waitcnt vmcnt(7)
    v_mfma_f32_16x16x32_bf16 v[8:11], v[208:211], v[104:107], v[8:11]
    v_mfma_f32_16x16x32_bf16 v[12:15], v[208:211], v[176:179], v[12:15]
    v_mfma_f32_16x16x32_bf16 v[16:19], v[208:211], a[40:43], v[16:19]
    v_mfma_f32_16x16x32_bf16 v[20:23], v[208:211], a[112:115], v[20:23]
    s_waitcnt vmcnt(6)
    v_mfma_f32_16x16x32_bf16 v[8:11], v[212:215], v[108:111], v[8:11]
    v_mfma_f32_16x16x32_bf16 v[12:15], v[212:215], v[180:183], v[12:15]
    v_mfma_f32_16x16x32_bf16 v[16:19], v[212:215], a[44:47], v[16:19]
    v_mfma_f32_16x16x32_bf16 v[20:23], v[212:215], a[116:119], v[20:23]
    s_waitcnt vmcnt(5)
    v_mfma_f32_16x16x32_bf16 v[8:11], v[216:219], v[112:115], v[8:11]
    v_mfma_f32_16x16x32_bf16 v[12:15], v[216:219], v[184:187], v[12:15]
    v_mfma_f32_16x16x32_bf16 v[16:19], v[216:219], a[48:51], v[16:19]
    v_mfma_f32_16x16x32_bf16 v[20:23], v[216:219], a[120:123], v[20:23]
    s_waitcnt vmcnt(4)
    v_mfma_f32_16x16x32_bf16 v[8:11], v[220:223], v[116:119], v[8:11]
    v_mfma_f32_16x16x32_bf16 v[12:15], v[220:223], v[188:191], v[12:15]
    v_mfma_f32_16x16x32_bf16 v[16:19], v[220:223], a[52:55], v[16:19]
    v_mfma_f32_16x16x32_bf16 v[20:23], v[220:223], a[124:127], v[20:23]
    s_waitcnt vmcnt(3)
    v_mfma_f32_16x16x32_bf16 v[8:11], v[224:227], v[120:123], v[8:11]
    v_mfma_f32_16x16x32_bf16 v[12:15], v[224:227], v[192:195], v[12:15]
    v_mfma_f32_16x16x32_bf16 v[16:19], v[224:227], a[56:59], v[16:19]
    v_mfma_f32_16x16x32_bf16 v[20:23], v[224:227], a[128:131], v[20:23]
    s_waitcnt vmcnt(2)
    v_mfma_f32_16x16x32_bf16 v[8:11], v[228:231], v[124:127], v[8:11]
    v_mfma_f32_16x16x32_bf16 v[12:15], v[228:231], v[196:199], v[12:15]
    v_mfma_f32_16x16x32_bf16 v[16:19], v[228:231], a[60:63], v[16:19]
    v_mfma_f32_16x16x32_bf16 v[20:23], v[228:231], a[132:135], v[20:23]
    s_waitcnt vmcnt(1)
    v_mfma_f32_16x16x32_bf16 v[8:11], v[232:235], v[128:131], v[8:11]
    v_mfma_f32_16x16x32_bf16 v[12:15], v[232:235], v[200:203], v[12:15]
    v_mfma_f32_16x16x32_bf16 v[16:19], v[232:235], a[64:67], v[16:19]
    v_mfma_f32_16x16x32_bf16 v[20:23], v[232:235], a[136:139], v[20:23]
    s_waitcnt vmcnt(0)
    v_mfma_f32_16x16x32_bf16 v[8:11], v[236:239], v[132:135], v[8:11]
    v_mfma_f32_16x16x32_bf16 v[12:15], v[236:239], v[204:207], v[12:15]
    v_mfma_f32_16x16x32_bf16 v[16:19], v[236:239], a[68:71], v[16:19]
    v_mfma_f32_16x16x32_bf16 v[20:23], v[236:239], a[140:143], v[20:23]
    v_pk_mul_f32 v[8:9], v[8:9], 0.5 op_sel_hi:[1,0]
    v_pk_mul_f32 v[10:11], v[10:11], 0.5 op_sel_hi:[1,0]
    v_pk_mul_f32 v[12:13], v[12:13], 0.5 op_sel_hi:[1,0]
    v_pk_mul_f32 v[14:15], v[14:15], 0.5 op_sel_hi:[1,0]
    v_pk_mul_f32 v[16:17], v[16:17], 0.5 op_sel_hi:[1,0]
    v_pk_mul_f32 v[18:19], v[18:19], 0.5 op_sel_hi:[1,0]
    s_nop 0
    v_pk_mul_f32 v[20:21], v[20:21], 0.5 op_sel_hi:[1,0]
    v_pk_mul_f32 v[22:23], v[22:23], 0.5 op_sel_hi:[1,0]
    s_nop 1
mk_st:
    v_cvt_pk_bf16_f32 v24, v8, v9
    v_cvt_pk_bf16_f32 v25, v10, v11
    v_cvt_pk_bf16_f32 v26, v12, v13
    v_cvt_pk_bf16_f32 v27, v14, v15
    v_cvt_pk_bf16_f32 v28, v16, v17
    v_cvt_pk_bf16_f32 v29, v18, v19
    v_cvt_pk_bf16_f32 v30, v20, v21
    v_cvt_pk_bf16_f32 v31, v22, v23
    s_add_u32 s21, s26, 4096
    buffer_store_dwordx4 v[24:27], v7, s[4:7], s26 offen sc1
    buffer_store_dwordx4 v[28:31], v7, s[4:7], s21 offen sc1
    s_waitcnt vmcnt(0)
    s_barrier
    v_mov_b32 v4, s22
    s_mov_b64 exec, s[34:35]
    buffer_store_dword v4, off, s[4:7], s29 sc1
    s_mov_b64 exec, -1
    s_add_u32 s19, s19, 2
    s_add_u32 s26, s26, 262144
    s_cmp_lt_u32 s19, 62
    s_cbranch_scc1 mk_loop
    s_endpgm
L_ssm_next:
    s_mov_b32 s37, 8
    v_mov_b32 v250, 1
    v_mov_b32 v251, 163832
    v_cmp_eq_u32 vcc, 0, v0
    s_nop 0
    s_and_saveexec_b64 s[38:39], vcc
    s_cbranch_execz tk8
    buffer_atomic_add v250, off, s[96:99], s37 sc0
    s_waitcnt vmcnt(0)
    ds_write_b32 v251, v250
    s_waitcnt lgkmcnt(0)
tk8:
    s_mov_b64 exec, -1
    s_barrier
    ds_read_b32 v252, v251
    s_waitcnt lgkmcnt(0)
    v_readfirstlane_b32 s20, v252
    s_barrier
    s_nop 3
    s_cmp_ge_u32 s20, 144
    s_cbranch_scc1 L_phase2
    s_lshl_b32 s20, s20, 2
    v_lshrrev_b32 v5, 6, v0
    s_nop 0
    v_readfirstlane_b32 s21, v5
    v_and_b32 v1, 63, v0
    v_and_b32 v2, 15, v1
    v_lshrrev_b32 v3, 4, v1
    v_lshlrev_b32 v4, 14, v5
    s_mov_b32 s8, s62
    s_mov_b32 s9, s63
    s_mov_b32 s10, 2359296
    s_mov_b32 s11, 0x20000
    s_mov_b32 s16, s76
    s_mov_b32 s17, s77
    s_mov_b32 s18, 4718592
    s_mov_b32 s19, 0x20000
    v_mul_u32_u24 v5, 9216, v0
    s_lshl_b32 s22, s20, 1
    s_add_u32 s23, s22, 0
    buffer_load_dwordx2 v[8:9], v5, s[8:11], s23 offen
    s_add_u32 s23, s22, 1152
    buffer_load_dwordx2 v[10:11], v5, s[8:11], s23 offen
    s_add_u32 s23, s22, 2304
    buffer_load_dwordx2 v[12:13], v5, s[8:11], s23 offen
    s_add_u32 s23, s22, 3456
    buffer_load_dwordx2 v[14:15], v5, s[8:11], s23 offen
    s_add_u32 s23, s22, 4608
    buffer_load_dwordx2 v[16:17], v5, s[8:11], s23 offen
    s_add_u32 s23, s22, 5760
    buffer_load_dwordx2 v[18:19], v5, s[8:11], s23 offen
    s_add_u32 s23, s22, 6912
    buffer_load_dwordx2 v[20:21], v5, s[8:11], s23 offen
    s_add_u32 s23, s22, 8064
    buffer_load_dwordx2 v[22:23], v5, s[8:11], s23 offen
    s_add_u32 s22, s20, s21
    s_lshl_b32 s23, s22, 8
    v_lshlrev_b32 v6, 3, v2
    v_lshl_add_u32 v6, v3, 1, v6
    s_mov_b32 s12, s64
    s_mov_b32 s13, s65
    s_mov_b32 s14, 147456
    s_mov_b32 s15, 0x20000
    buffer_load_ushort v24, v6, s[12:15], s23 offen offset:0
    buffer_load_ushort v28, v6, s[12:15], s23 offen offset:128
    s_mov_b32 s12, s66
    s_mov_b32 s13, s67
    s_mov_b32 s14, 147456
    s_mov_b32 s15, 0x20000
    buffer_load_ushort v25, v6, s[12:15], s23 offen offset:0
    buffer_load_ushort v29, v6, s[12:15], s23 offen offset:128
    s_mov_b32 s12, s68
    s_mov_b32 s13, s69
    s_mov_b32 s14, 147456
    s_mov_b32 s15, 0x20000
    buffer_load_ushort v26, v6, s[12:15], s23 offen offset:0
    buffer_load_ushort v30, v6, s[12:15], s23 offen offset:128
    s_mov_b32 s12, s70
    s_mov_b32 s13, s71
    s_mov_b32 s14, 147456
    s_mov_b32 s15, 0x20000
    buffer_load_ushort v27, v6, s[12:15], s23 offen offset:0
    buffer_load_ushort v31, v6, s[12:15], s23 offen offset:128
    s_mov_b32 s12, s72
    s_mov_b32 s13, s73
    s_mov_b32 s14, 1152
    s_mov_b32 s15, 0x20000
    s_lshl_b32 s23, s22, 1
    buffer_load_ushort v32, off, s[12:15], s23
    s_mov_b32 s26, 0x3fb8aa3b
    s_mov_b32 s27, 0x3e22f983
    v_mov_b32 v34, 0
    v_mov_b32 v35, 0
    v_lshl_add_u32 v6, v1, 3, v4
    ds_write_b64 v6, v[34:35] offset:0
    s_waitcnt vmcnt(0)
    v_mov_b32 v36, 0x05040100
    v_mov_b32 v37, 0x07060302
    v_lshlrev_b32 v6, 4, v0
    v_perm_b32 v40, v10, v8, v36
    v_perm_b32 v41, v14, v12, v36
    v_perm_b32 v42, v18, v16, v36
    v_perm_b32 v43, v22, v20, v36
    ds_write_b128 v6, v[40:43] offset:512
    s_nop 1
    v_perm_b32 v40, v10, v8, v37
    v_perm_b32 v41, v14, v12, v37
    v_perm_b32 v42, v18, v16, v37
    v_perm_b32 v43, v22, v20, v37
    ds_write_b128 v6, v[40:43] offset:16896
    s_nop 1
    v_perm_b32 v40, v11, v9, v36
    v_perm_b32 v41, v15, v13, v36
    v_perm_b32 v42, v19, v17, v36
    v_perm_b32 v43, v23, v21, v36
    ds_write_b128 v6, v[40:43] offset:33280
    s_nop 1
    v_perm_b32 v40, v11, v9, v37
    v_perm_b32 v41, v15, v13, v37
    v_perm_b32 v42, v19, v17, v37
    v_perm_b32 v43, v23, v21, v37
    ds_write_b128 v6, v[40:43] offset:49664
    s_nop 1
    v_lshlrev_b32 v32, 16, v32
    v_mul_f32 v32, s26, v32
    v_exp_f32 v32, v32
    s_nop 0
    v_cvt_pk_bf16_f32 v32, v32, v32
    v_and_b32 v32, 0xffff0000, v32
    v_add_f32 v33, v32, v32
    v_lshlrev_b32 v24, 16, v24
    v_mul_f32 v24, s26, v24
    v_exp_f32 v24, v24
    s_nop 0
    v_cvt_pk_bf16_f32 v24, v24, v24
    v_and_b32 v24, 0xffff0000, v24
    v_mul_f32 v24, v24, v32
    v_mul_f32 v24, s26, v24
    v_sub_f32 v24, 0, v24
    v_lshlrev_b32 v25, 16, v25
    v_mul_f32 v25, v25, v32
    v_mul_f32 v25, s27, v25
    v_lshlrev_b32 v26, 16, v26
    v_mul_f32 v26, v26, v33
    v_lshlrev_b32 v27, 16, v27
    v_mul_f32 v27, v27, v33
    v_lshlrev_b32 v28, 16, v28
    v_mul_f32 v28, s26, v28
    v_exp_f32 v28, v28
    s_nop 0
    v_cvt_pk_bf16_f32 v28, v28, v28
    v_and_b32 v28, 0xffff0000, v28
    v_mul_f32 v28, v28, v32
    v_mul_f32 v28, s26, v28
    v_sub_f32 v28, 0, v28
    v_lshlrev_b32 v29, 16, v29
    v_mul_f32 v29, v29, v32
    v_mul_f32 v29, s27, v29
    v_lshlrev_b32 v30, 16, v30
    v_mul_f32 v30, v30, v33
    v_lshlrev_b32 v31, 16, v31
    v_mul_f32 v31, v31, v33
    v_cvt_f32_u32 v47, v2
    v_mul_f32 v44, 0x41800000, v47
    v_and_b32 v5, 7, v2
    v_add_u32 v5, 8, v5
    v_cvt_f32_u32 v5, v5
    v_mul_f32 v45, 0x42000000, v5
    v_mul_f32 v6, 0x42800000, v5
    v_cmp_lt_u32 vcc, 7, v2
    s_nop 1
    v_cndmask_b32 v45, v45, v6, vcc
    v_add_f32 v5, 0x41000000, v47
    v_mul_f32 v46, 0x43000000, v5
    v_mov_b32 v48, 0
    v_mov_b32 v49, 0
    v_mov_b32 v50, 0
    v_mov_b32 v51, 0
    v_mov_b32 v52, 0
    v_mov_b32 v53, 0
    v_mov_b32 v54, 0
    v_mov_b32 v55, 0
    v_mov_b32 v56, 0
    v_mov_b32 v57, 0
    v_mov_b32 v58, 0
    v_mov_b32 v59, 0
    v_mov_b32 v60, 0
    v_mov_b32 v61, 0
    v_mov_b32 v62, 0
    v_mov_b32 v63, 0
    v_mov_b32_dpp v64, v24 row_newbcast:0 row_mask:0xf bank_mask:0xf
    v_mov_b32_dpp v65, v25 row_newbcast:0 row_mask:0xf bank_mask:0xf
    v_mov_b32_dpp v66, v26 row_newbcast:0 row_mask:0xf bank_mask:0xf
    v_mov_b32_dpp v67, v27 row_newbcast:0 row_mask:0xf bank_mask:0xf
    v_mul_f32 v82, v64, v47
    v_mul_f32 v83, v65, v47
    v_exp_f32 v82, v82
    v_fract_f32 v83, v83
    v_cos_f32 v74, v83
    v_sin_f32 v75, v83
    v_mul_f32 v74, v74, v82
    v_mul_f32 v75, v75, v82
    v_mul_f32 v84, v75, v75
    v_add_f32 v85, v74, v74
    v_fma_f32 v76, v74, v74, -v84
    v_mul_f32 v77, v85, v75
    v_mul_f32 v84, v77, v77
    v_add_f32 v85, v76, v76
    v_fma_f32 v78, v76, v76, -v84
    v_mul_f32 v79, v85, v77
    v_mul_f32 v84, v79, v79
    v_add_f32 v85, v78, v78
    v_fma_f32 v80, v78, v78, -v84
    v_mul_f32 v81, v85, v79
    v_mul_f32 v82, v64, v44
    v_mul_f32 v83, v65, v44
    v_exp_f32 v82, v82
    v_fract_f32 v83, v83
    v_cos_f32 v68, v83
    v_sin_f32 v69, v83
    v_mul_f32 v68, v68, v82
    v_mul_f32 v69, v69, v82
    v_mul_f32 v84, v67, v69
    v_mul_f32 v85, v67, v68
    v_fma_f32 v68, v66, v68, -v84
    v_fma_f32 v69, -v66, v69, -v85
    v_mul_f32 v82, v64, v45
    v_mul_f32 v83, v65, v45
    v_exp_f32 v82, v82
    v_fract_f32 v83, v83
    v_cos_f32 v70, v83
    v_sin_f32 v71, v83
    v_mul_f32 v70, v70, v82
    v_mul_f32 v71, v71, v82
    v_mul_f32 v84, v67, v71
    v_mul_f32 v85, v67, v70
    v_fma_f32 v70, v66, v70, -v84
    v_fma_f32 v71, -v66, v71, -v85
    v_mul_f32 v82, v64, v46
    v_mul_f32 v83, v65, v46
    v_exp_f32 v82, v82
    v_fract_f32 v83, v83
    v_cos_f32 v72, v83
    v_sin_f32 v73, v83
    v_mul_f32 v72, v72, v82
    v_mul_f32 v73, v73, v82
    v_mul_f32 v84, v67, v73
    v_mul_f32 v85, v67, v72
    v_fma_f32 v72, v66, v72, -v84
    v_fma_f32 v73, -v66, v73, -v85
    v_mfma_f32_16x16x4_f32 v[48:51], v68, v74, v[48:51]
    v_mfma_f32_16x16x4_f32 v[52:55], v70, v76, v[52:55]
    v_mfma_f32_16x16x4_f32 v[56:59], v70, v78, v[56:59]
    v_mfma_f32_16x16x4_f32 v[60:63], v72, v80, v[60:63]
    v_mfma_f32_16x16x4_f32 v[48:51], v69, v75, v[48:51]
    v_mfma_f32_16x16x4_f32 v[52:55], v71, v77, v[52:55]
    v_mfma_f32_16x16x4_f32 v[56:59], v71, v79, v[56:59]
    v_mfma_f32_16x16x4_f32 v[60:63], v73, v81, v[60:63]
    v_mov_b32_dpp v64, v24 row_newbcast:1 row_mask:0xf bank_mask:0xf
    v_mov_b32_dpp v65, v25 row_newbcast:1 row_mask:0xf bank_mask:0xf
    v_mov_b32_dpp v66, v26 row_newbcast:1 row_mask:0xf bank_mask:0xf
    v_mov_b32_dpp v67, v27 row_newbcast:1 row_mask:0xf bank_mask:0xf
    v_mul_f32 v82, v64, v47
    v_mul_f32 v83, v65, v47
    v_exp_f32 v82, v82
    v_fract_f32 v83, v83
    v_cos_f32 v74, v83
    v_sin_f32 v75, v83
    v_mul_f32 v74, v74, v82
    v_mul_f32 v75, v75, v82
    v_mul_f32 v84, v75, v75
    v_add_f32 v85, v74, v74
    v_fma_f32 v76, v74, v74, -v84
    v_mul_f32 v77, v85, v75
    v_mul_f32 v84, v77, v77
    v_add_f32 v85, v76, v76
    v_fma_f32 v78, v76, v76, -v84
    v_mul_f32 v79, v85, v77
    v_mul_f32 v84, v79, v79
    v_add_f32 v85, v78, v78
    v_fma_f32 v80, v78, v78, -v84
    v_mul_f32 v81, v85, v79
    v_mul_f32 v82, v64, v44
    v_mul_f32 v83, v65, v44
    v_exp_f32 v82, v82
    v_fract_f32 v83, v83
    v_cos_f32 v68, v83
    v_sin_f32 v69, v83
    v_mul_f32 v68, v68, v82
    v_mul_f32 v69, v69, v82
    v_mul_f32 v84, v67, v69
    v_mul_f32 v85, v67, v68
    v_fma_f32 v68, v66, v68, -v84
    v_fma_f32 v69, -v66, v69, -v85
    v_mul_f32 v82, v64, v45
    v_mul_f32 v83, v65, v45
    v_exp_f32 v82, v82
    v_fract_f32 v83, v83
    v_cos_f32 v70, v83
    v_sin_f32 v71, v83
    v_mul_f32 v70, v70, v82
    v_mul_f32 v71, v71, v82
    v_mul_f32 v84, v67, v71
    v_mul_f32 v85, v67, v70
    v_fma_f32 v70, v66, v70, -v84
    v_fma_f32 v71, -v66, v71, -v85
    v_mul_f32 v82, v64, v46
    v_mul_f32 v83, v65, v46
    v_exp_f32 v82, v82
    v_fract_f32 v83, v83
    v_cos_f32 v72, v83
    v_sin_f32 v73, v83
    v_mul_f32 v72, v72, v82
    v_mul_f32 v73, v73, v82
    v_mul_f32 v84, v67, v73
    v_mul_f32 v85, v67, v72
    v_fma_f32 v72, v66, v72, -v84
    v_fma_f32 v73, -v66, v73, -v85
    v_mfma_f32_16x16x4_f32 v[48:51], v68, v74, v[48:51]
    v_mfma_f32_16x16x4_f32 v[52:55], v70, v76, v[52:55]
    v_mfma_f32_16x16x4_f32 v[56:59], v70, v78, v[56:59]
    v_mfma_f32_16x16x4_f32 v[60:63], v72, v80, v[60:63]
    v_mfma_f32_16x16x4_f32 v[48:51], v69, v75, v[48:51]
    v_mfma_f32_16x16x4_f32 v[52:55], v71, v77, v[52:55]
    v_mfma_f32_16x16x4_f32 v[56:59], v71, v79, v[56:59]
    v_mfma_f32_16x16x4_f32 v[60:63], v73, v81, v[60:63]
    v_mov_b32_dpp v64, v24 row_newbcast:2 row_mask:0xf bank_mask:0xf
    v_mov_b32_dpp v65, v25 row_newbcast:2 row_mask:0xf bank_mask:0xf
    v_mov_b32_dpp v66, v26 row_newbcast:2 row_mask:0xf bank_mask:0xf
    v_mov_b32_dpp v67, v27 row_newbcast:2 row_mask:0xf bank_mask:0xf
    v_mul_f32 v82, v64, v47
    v_mul_f32 v83, v65, v47
    v_exp_f32 v82, v82
    v_fract_f32 v83, v83
    v_cos_f32 v74, v83
    v_sin_f32 v75, v83
    v_mul_f32 v74, v74, v82
    v_mul_f32 v75, v75, v82
    v_mul_f32 v84, v75, v75
    v_add_f32 v85, v74, v74
    v_fma_f32 v76, v74, v74, -v84
    v_mul_f32 v77, v85, v75
    v_mul_f32 v84, v77, v77
    v_add_f32 v85, v76, v76
    v_fma_f32 v78, v76, v76, -v84
    v_mul_f32 v79, v85, v77
    v_mul_f32 v84, v79, v79
    v_add_f32 v85, v78, v78
    v_fma_f32 v80, v78, v78, -v84
    v_mul_f32 v81, v85, v79
    v_mul_f32 v82, v64, v44
    v_mul_f32 v83, v65, v44
    v_exp_f32 v82, v82
    v_fract_f32 v83, v83
    v_cos_f32 v68, v83
    v_sin_f32 v69, v83
    v_mul_f32 v68, v68, v82
    v_mul_f32 v69, v69, v82
    v_mul_f32 v84, v67, v69
    v_mul_f32 v85, v67, v68
    v_fma_f32 v68, v66, v68, -v84
    v_fma_f32 v69, -v66, v69, -v85
    v_mul_f32 v82, v64, v45
    v_mul_f32 v83, v65, v45
    v_exp_f32 v82, v82
    v_fract_f32 v83, v83
    v_cos_f32 v70, v83
    v_sin_f32 v71, v83
    v_mul_f32 v70, v70, v82
    v_mul_f32 v71, v71, v82
    v_mul_f32 v84, v67, v71
    v_mul_f32 v85, v67, v70
    v_fma_f32 v70, v66, v70, -v84
    v_fma_f32 v71, -v66, v71, -v85
    v_mul_f32 v82, v64, v46
    v_mul_f32 v83, v65, v46
    v_exp_f32 v82, v82
    v_fract_f32 v83, v83
    v_cos_f32 v72, v83
    v_sin_f32 v73, v83
    v_mul_f32 v72, v72, v82
    v_mul_f32 v73, v73, v82
    v_mul_f32 v84, v67, v73
    v_mul_f32 v85, v67, v72
    v_fma_f32 v72, v66, v72, -v84
    v_fma_f32 v73, -v66, v73, -v85
    v_mfma_f32_16x16x4_f32 v[48:51], v68, v74, v[48:51]
    v_mfma_f32_16x16x4_f32 v[52:55], v70, v76, v[52:55]
    v_mfma_f32_16x16x4_f32 v[56:59], v70, v78, v[56:59]
    v_mfma_f32_16x16x4_f32 v[60:63], v72, v80, v[60:63]
    v_mfma_f32_16x16x4_f32 v[48:51], v69, v75, v[48:51]
    v_mfma_f32_16x16x4_f32 v[52:55], v71, v77, v[52:55]
    v_mfma_f32_16x16x4_f32 v[56:59], v71, v79, v[56:59]
    v_mfma_f32_16x16x4_f32 v[60:63], v73, v81, v[60:63]
    v_mov_b32_dpp v64, v24 row_newbcast:3 row_mask:0xf bank_mask:0xf
    v_mov_b32_dpp v65, v25 row_newbcast:3 row_mask:0xf bank_mask:0xf
    v_mov_b32_dpp v66, v26 row_newbcast:3 row_mask:0xf bank_mask:0xf
    v_mov_b32_dpp v67, v27 row_newbcast:3 row_mask:0xf bank_mask:0xf
    v_mul_f32 v82, v64, v47
    v_mul_f32 v83, v65, v47
    v_exp_f32 v82, v82
    v_fract_f32 v83, v83
    v_cos_f32 v74, v83
    v_sin_f32 v75, v83
    v_mul_f32 v74, v74, v82
    v_mul_f32 v75, v75, v82
    v_mul_f32 v84, v75, v75
    v_add_f32 v85, v74, v74
    v_fma_f32 v76, v74, v74, -v84
    v_mul_f32 v77, v85, v75
    v_mul_f32 v84, v77, v77
    v_add_f32 v85, v76, v76
    v_fma_f32 v78, v76, v76, -v84
    v_mul_f32 v79, v85, v77
    v_mul_f32 v84, v79, v79
    v_add_f32 v85, v78, v78
    v_fma_f32 v80, v78, v78, -v84
    v_mul_f32 v81, v85, v79
    v_mul_f32 v82, v64, v44
    v_mul_f32 v83, v65, v44
    v_exp_f32 v82, v82
    v_fract_f32 v83, v83
    v_cos_f32 v68, v83
    v_sin_f32 v69, v83
    v_mul_f32 v68, v68, v82
    v_mul_f32 v69, v69, v82
    v_mul_f32 v84, v67, v69
    v_mul_f32 v85, v67, v68
    v_fma_f32 v68, v66, v68, -v84
    v_fma_f32 v69, -v66, v69, -v85
    v_mul_f32 v82, v64, v45
    v_mul_f32 v83, v65, v45
    v_exp_f32 v82, v82
    v_fract_f32 v83, v83
    v_cos_f32 v70, v83
    v_sin_f32 v71, v83
    v_mul_f32 v70, v70, v82
    v_mul_f32 v71, v71, v82
    v_mul_f32 v84, v67, v71
    v_mul_f32 v85, v67, v70
    v_fma_f32 v70, v66, v70, -v84
    v_fma_f32 v71, -v66, v71, -v85
    v_mul_f32 v82, v64, v46
    v_mul_f32 v83, v65, v46
    v_exp_f32 v82, v82
    v_fract_f32 v83, v83
    v_cos_f32 v72, v83
    v_sin_f32 v73, v83
    v_mul_f32 v72, v72, v82
    v_mul_f32 v73, v73, v82
    v_mul_f32 v84, v67, v73
    v_mul_f32 v85, v67, v72
    v_fma_f32 v72, v66, v72, -v84
    v_fma_f32 v73, -v66, v73, -v85
    v_mfma_f32_16x16x4_f32 v[48:51], v68, v74, v[48:51]
    v_mfma_f32_16x16x4_f32 v[52:55], v70, v76, v[52:55]
    v_mfma_f32_16x16x4_f32 v[56:59], v70, v78, v[56:59]
    v_mfma_f32_16x16x4_f32 v[60:63], v72, v80, v[60:63]
    v_mfma_f32_16x16x4_f32 v[48:51], v69, v75, v[48:51]
    v_mfma_f32_16x16x4_f32 v[52:55], v71, v77, v[52:55]
    v_mfma_f32_16x16x4_f32 v[56:59], v71, v79, v[56:59]
    v_mfma_f32_16x16x4_f32 v[60:63], v73, v81, v[60:63]
    v_mov_b32_dpp v64, v24 row_newbcast:4 row_mask:0xf bank_mask:0xf
    v_mov_b32_dpp v65, v25 row_newbcast:4 row_mask:0xf bank_mask:0xf
    v_mov_b32_dpp v66, v26 row_newbcast:4 row_mask:0xf bank_mask:0xf
    v_mov_b32_dpp v67, v27 row_newbcast:4 row_mask:0xf bank_mask:0xf
    v_mul_f32 v82, v64, v47
    v_mul_f32 v83, v65, v47
    v_exp_f32 v82, v82
    v_fract_f32 v83, v83
    v_cos_f32 v74, v83
    v_sin_f32 v75, v83
    v_mul_f32 v74, v74, v82
    v_mul_f32 v75, v75, v82
    v_mul_f32 v84, v75, v75
    v_add_f32 v85, v74, v74
    v_fma_f32 v76, v74, v74, -v84
    v_mul_f32 v77, v85, v75
    v_mul_f32 v84, v77, v77
    v_add_f32 v85, v76, v76
    v_fma_f32 v78, v76, v76, -v84
    v_mul_f32 v79, v85, v77
    v_mul_f32 v84, v79, v79
    v_add_f32 v85, v78, v78
    v_fma_f32 v80, v78, v78, -v84
    v_mul_f32 v81, v85, v79
    v_mul_f32 v82, v64, v44
    v_mul_f32 v83, v65, v44
    v_exp_f32 v82, v82
    v_fract_f32 v83, v83
    v_cos_f32 v68, v83
    v_sin_f32 v69, v83
    v_mul_f32 v68, v68, v82
    v_mul_f32 v69, v69, v82
    v_mul_f32 v84, v67, v69
    v_mul_f32 v85, v67, v68
    v_fma_f32 v68, v66, v68, -v84
    v_fma_f32 v69, -v66, v69, -v85
    v_mul_f32 v82, v64, v45
    v_mul_f32 v83, v65, v45
    v_exp_f32 v82, v82
    v_fract_f32 v83, v83
    v_cos_f32 v70, v83
    v_sin_f32 v71, v83
    v_mul_f32 v70, v70, v82
    v_mul_f32 v71, v71, v82
    v_mul_f32 v84, v67, v71
    v_mul_f32 v85, v67, v70
    v_fma_f32 v70, v66, v70, -v84
    v_fma_f32 v71, -v66, v71, -v85
    v_mul_f32 v82, v64, v46
    v_mul_f32 v83, v65, v46
    v_exp_f32 v82, v82
    v_fract_f32 v83, v83
    v_cos_f32 v72, v83
    v_sin_f32 v73, v83
    v_mul_f32 v72, v72, v82
    v_mul_f32 v73, v73, v82
    v_mul_f32 v84, v67, v73
    v_mul_f32 v85, v67, v72
    v_fma_f32 v72, v66, v72, -v84
    v_fma_f32 v73, -v66, v73, -v85
    v_mfma_f32_16x16x4_f32 v[48:51], v68, v74, v[48:51]
    v_mfma_f32_16x16x4_f32 v[52:55], v70, v76, v[52:55]
    v_mfma_f32_16x16x4_f32 v[56:59], v70, v78, v[56:59]
    v_mfma_f32_16x16x4_f32 v[60:63], v72, v80, v[60:63]
    v_mfma_f32_16x16x4_f32 v[48:51], v69, v75, v[48:51]
    v_mfma_f32_16x16x4_f32 v[52:55], v71, v77, v[52:55]
    v_mfma_f32_16x16x4_f32 v[56:59], v71, v79, v[56:59]
    v_mfma_f32_16x16x4_f32 v[60:63], v73, v81, v[60:63]
    v_mov_b32_dpp v64, v24 row_newbcast:5 row_mask:0xf bank_mask:0xf
    v_mov_b32_dpp v65, v25 row_newbcast:5 row_mask:0xf bank_mask:0xf
    v_mov_b32_dpp v66, v26 row_newbcast:5 row_mask:0xf bank_mask:0xf
    v_mov_b32_dpp v67, v27 row_newbcast:5 row_mask:0xf bank_mask:0xf
    v_mul_f32 v82, v64, v47
    v_mul_f32 v83, v65, v47
    v_exp_f32 v82, v82
    v_fract_f32 v83, v83
    v_cos_f32 v74, v83
    v_sin_f32 v75, v83
    v_mul_f32 v74, v74, v82
    v_mul_f32 v75, v75, v82
    v_mul_f32 v84, v75, v75
    v_add_f32 v85, v74, v74
    v_fma_f32 v76, v74, v74, -v84
    v_mul_f32 v77, v85, v75
    v_mul_f32 v84, v77, v77
    v_add_f32 v85, v76, v76
    v_fma_f32 v78, v76, v76, -v84
    v_mul_f32 v79, v85, v77
    v_mul_f32 v84, v79, v79
    v_add_f32 v85, v78, v78
    v_fma_f32 v80, v78, v78, -v84
    v_mul_f32 v81, v85, v79
    v_mul_f32 v82, v64, v44
    v_mul_f32 v83, v65, v44
    v_exp_f32 v82, v82
    v_fract_f32 v83, v83
    v_cos_f32 v68, v83
    v_sin_f32 v69, v83
    v_mul_f32 v68, v68, v82
    v_mul_f32 v69, v69, v82
    v_mul_f32 v84, v67, v69
    v_mul_f32 v85, v67, v68
    v_fma_f32 v68, v66, v68, -v84
    v_fma_f32 v69, -v66, v69, -v85
    v_mul_f32 v82, v64, v45
    v_mul_f32 v83, v65, v45
    v_exp_f32 v82, v82
    v_fract_f32 v83, v83
    v_cos_f32 v70, v83
    v_sin_f32 v71, v83
    v_mul_f32 v70, v70, v82
    v_mul_f32 v71, v71, v82
    v_mul_f32 v84, v67, v71
    v_mul_f32 v85, v67, v70
    v_fma_f32 v70, v66, v70, -v84
    v_fma_f32 v71, -v66, v71, -v85
    v_mul_f32 v82, v64, v46
    v_mul_f32 v83, v65, v46
    v_exp_f32 v82, v82
    v_fract_f32 v83, v83
    v_cos_f32 v72, v83
    v_sin_f32 v73, v83
    v_mul_f32 v72, v72, v82
    v_mul_f32 v73, v73, v82
    v_mul_f32 v84, v67, v73
    v_mul_f32 v85, v67, v72
    v_fma_f32 v72, v66, v72, -v84
    v_fma_f32 v73, -v66, v73, -v85
    v_mfma_f32_16x16x4_f32 v[48:51], v68, v74, v[48:51]
    v_mfma_f32_16x16x4_f32 v[52:55], v70, v76, v[52:55]
    v_mfma_f32_16x16x4_f32 v[56:59], v70, v78, v[56:59]
    v_mfma_f32_16x16x4_f32 v[60:63], v72, v80, v[60:63]
    v_mfma_f32_16x16x4_f32 v[48:51], v69, v75, v[48:51]
    v_mfma_f32_16x16x4_f32 v[52:55], v71, v77, v[52:55]
    v_mfma_f32_16x16x4_f32 v[56:59], v71, v79, v[56:59]
    v_mfma_f32_16x16x4_f32 v[60:63], v73, v81, v[60:63]
    v_mov_b32_dpp v64, v24 row_newbcast:6 row_mask:0xf bank_mask:0xf
    v_mov_b32_dpp v65, v25 row_newbcast:6 row_mask:0xf bank_mask:0xf
    v_mov_b32_dpp v66, v26 row_newbcast:6 row_mask:0xf bank_mask:0xf
    v_mov_b32_dpp v67, v27 row_newbcast:6 row_mask:0xf bank_mask:0xf
    v_mul_f32 v82, v64, v47
    v_mul_f32 v83, v65, v47
    v_exp_f32 v82, v82
    v_fract_f32 v83, v83
    v_cos_f32 v74, v83
    v_sin_f32 v75, v83
    v_mul_f32 v74, v74, v82
    v_mul_f32 v75, v75, v82
    v_mul_f32 v84, v75, v75
    v_add_f32 v85, v74, v74
    v_fma_f32 v76, v74, v74, -v84
    v_mul_f32 v77, v85, v75
    v_mul_f32 v84, v77, v77
    v_add_f32 v85, v76, v76
    v_fma_f32 v78, v76, v76, -v84
    v_mul_f32 v79, v85, v77
    v_mul_f32 v84, v79, v79
    v_add_f32 v85, v78, v78
    v_fma_f32 v80, v78, v78, -v84
    v_mul_f32 v81, v85, v79
    v_mul_f32 v82, v64, v44
    v_mul_f32 v83, v65, v44
    v_exp_f32 v82, v82
    v_fract_f32 v83, v83
    v_cos_f32 v68, v83
    v_sin_f32 v69, v83
    v_mul_f32 v68, v68, v82
    v_mul_f32 v69, v69, v82
    v_mul_f32 v84, v67, v69
    v_mul_f32 v85, v67, v68
    v_fma_f32 v68, v66, v68, -v84
    v_fma_f32 v69, -v66, v69, -v85
    v_mul_f32 v82, v64, v45
    v_mul_f32 v83, v65, v45
    v_exp_f32 v82, v82
    v_fract_f32 v83, v83
    v_cos_f32 v70, v83
    v_sin_f32 v71, v83
    v_mul_f32 v70, v70, v82
    v_mul_f32 v71, v71, v82
    v_mul_f32 v84, v67, v71
    v_mul_f32 v85, v67, v70
    v_fma_f32 v70, v66, v70, -v84
    v_fma_f32 v71, -v66, v71, -v85
    v_mul_f32 v82, v64, v46
    v_mul_f32 v83, v65, v46
    v_exp_f32 v82, v82
    v_fract_f32 v83, v83
    v_cos_f32 v72, v83
    v_sin_f32 v73, v83
    v_mul_f32 v72, v72, v82
    v_mul_f32 v73, v73, v82
    v_mul_f32 v84, v67, v73
    v_mul_f32 v85, v67, v72
    v_fma_f32 v72, v66, v72, -v84
    v_fma_f32 v73, -v66, v73, -v85
    v_mfma_f32_16x16x4_f32 v[48:51], v68, v74, v[48:51]
    v_mfma_f32_16x16x4_f32 v[52:55], v70, v76, v[52:55]
    v_mfma_f32_16x16x4_f32 v[56:59], v70, v78, v[56:59]
    v_mfma_f32_16x16x4_f32 v[60:63], v72, v80, v[60:63]
    v_mfma_f32_16x16x4_f32 v[48:51], v69, v75, v[48:51]
    v_mfma_f32_16x16x4_f32 v[52:55], v71, v77, v[52:55]
    v_mfma_f32_16x16x4_f32 v[56:59], v71, v79, v[56:59]
    v_mfma_f32_16x16x4_f32 v[60:63], v73, v81, v[60:63]
    v_mov_b32_dpp v64, v24 row_newbcast:7 row_mask:0xf bank_mask:0xf
    v_mov_b32_dpp v65, v25 row_newbcast:7 row_mask:0xf bank_mask:0xf
    v_mov_b32_dpp v66, v26 row_newbcast:7 row_mask:0xf bank_mask:0xf
    v_mov_b32_dpp v67, v27 row_newbcast:7 row_mask:0xf bank_mask:0xf
    v_mul_f32 v82, v64, v47
    v_mul_f32 v83, v65, v47
    v_exp_f32 v82, v82
    v_fract_f32 v83, v83
    v_cos_f32 v74, v83
    v_sin_f32 v75, v83
    v_mul_f32 v74, v74, v82
    v_mul_f32 v75, v75, v82
    v_mul_f32 v84, v75, v75
    v_add_f32 v85, v74, v74
    v_fma_f32 v76, v74, v74, -v84
    v_mul_f32 v77, v85, v75
    v_mul_f32 v84, v77, v77
    v_add_f32 v85, v76, v76
    v_fma_f32 v78, v76, v76, -v84
    v_mul_f32 v79, v85, v77
    v_mul_f32 v84, v79, v79
    v_add_f32 v85, v78, v78
    v_fma_f32 v80, v78, v78, -v84
    v_mul_f32 v81, v85, v79
    v_mul_f32 v82, v64, v44
    v_mul_f32 v83, v65, v44
    v_exp_f32 v82, v82
    v_fract_f32 v83, v83
    v_cos_f32 v68, v83
    v_sin_f32 v69, v83
    v_mul_f32 v68, v68, v82
    v_mul_f32 v69, v69, v82
    v_mul_f32 v84, v67, v69
    v_mul_f32 v85, v67, v68
    v_fma_f32 v68, v66, v68, -v84
    v_fma_f32 v69, -v66, v69, -v85
    v_mul_f32 v82, v64, v45
    v_mul_f32 v83, v65, v45
    v_exp_f32 v82, v82
    v_fract_f32 v83, v83
    v_cos_f32 v70, v83
    v_sin_f32 v71, v83
    v_mul_f32 v70, v70, v82
    v_mul_f32 v71, v71, v82
    v_mul_f32 v84, v67, v71
    v_mul_f32 v85, v67, v70
    v_fma_f32 v70, v66, v70, -v84
    v_fma_f32 v71, -v66, v71, -v85
    v_mul_f32 v82, v64, v46
    v_mul_f32 v83, v65, v46
    v_exp_f32 v82, v82
    v_fract_f32 v83, v83
    v_cos_f32 v72, v83
    v_sin_f32 v73, v83
    v_mul_f32 v72, v72, v82
    v_mul_f32 v73, v73, v82
    v_mul_f32 v84, v67, v73
    v_mul_f32 v85, v67, v72
    v_fma_f32 v72, v66, v72, -v84
    v_fma_f32 v73, -v66, v73, -v85
    v_mfma_f32_16x16x4_f32 v[48:51], v68, v74, v[48:51]
    v_mfma_f32_16x16x4_f32 v[52:55], v70, v76, v[52:55]
    v_mfma_f32_16x16x4_f32 v[56:59], v70, v78, v[56:59]
    v_mfma_f32_16x16x4_f32 v[60:63], v72, v80, v[60:63]
    v_mfma_f32_16x16x4_f32 v[48:51], v69, v75, v[48:51]
    v_mfma_f32_16x16x4_f32 v[52:55], v71, v77, v[52:55]
    v_mfma_f32_16x16x4_f32 v[56:59], v71, v79, v[56:59]
    v_mfma_f32_16x16x4_f32 v[60:63], v73, v81, v[60:63]
    v_mov_b32_dpp v64, v24 row_newbcast:8 row_mask:0xf bank_mask:0xf
    v_mov_b32_dpp v65, v25 row_newbcast:8 row_mask:0xf bank_mask:0xf
    v_mov_b32_dpp v66, v26 row_newbcast:8 row_mask:0xf bank_mask:0xf
    v_mov_b32_dpp v67, v27 row_newbcast:8 row_mask:0xf bank_mask:0xf
    v_mul_f32 v82, v64, v47
    v_mul_f32 v83, v65, v47
    v_exp_f32 v82, v82
    v_fract_f32 v83, v83
    v_cos_f32 v74, v83
    v_sin_f32 v75, v83
    v_mul_f32 v74, v74, v82
    v_mul_f32 v75, v75, v82
    v_mul_f32 v84, v75, v75
    v_add_f32 v85, v74, v74
    v_fma_f32 v76, v74, v74, -v84
    v_mul_f32 v77, v85, v75
    v_mul_f32 v84, v77, v77
    v_add_f32 v85, v76, v76
    v_fma_f32 v78, v76, v76, -v84
    v_mul_f32 v79, v85, v77
    v_mul_f32 v84, v79, v79
    v_add_f32 v85, v78, v78
    v_fma_f32 v80, v78, v78, -v84
    v_mul_f32 v81, v85, v79
    v_mul_f32 v82, v64, v44
    v_mul_f32 v83, v65, v44
    v_exp_f32 v82, v82
    v_fract_f32 v83, v83
    v_cos_f32 v68, v83
    v_sin_f32 v69, v83
    v_mul_f32 v68, v68, v82
    v_mul_f32 v69, v69, v82
    v_mul_f32 v84, v67, v69
    v_mul_f32 v85, v67, v68
    v_fma_f32 v68, v66, v68, -v84
    v_fma_f32 v69, -v66, v69, -v85
    v_mul_f32 v82, v64, v45
    v_mul_f32 v83, v65, v45
    v_exp_f32 v82, v82
    v_fract_f32 v83, v83
    v_cos_f32 v70, v83
    v_sin_f32 v71, v83
    v_mul_f32 v70, v70, v82
    v_mul_f32 v71, v71, v82
    v_mul_f32 v84, v67, v71
    v_mul_f32 v85, v67, v70
    v_fma_f32 v70, v66, v70, -v84
    v_fma_f32 v71, -v66, v71, -v85
    v_mul_f32 v82, v64, v46
    v_mul_f32 v83, v65, v46
    v_exp_f32 v82, v82
    v_fract_f32 v83, v83
    v_cos_f32 v72, v83
    v_sin_f32 v73, v83
    v_mul_f32 v72, v72, v82
    v_mul_f32 v73, v73, v82
    v_mul_f32 v84, v67, v73
    v_mul_f32 v85, v67, v72
    v_fma_f32 v72, v66, v72, -v84
    v_fma_f32 v73, -v66, v73, -v85
    v_mfma_f32_16x16x4_f32 v[48:51], v68, v74, v[48:51]
    v_mfma_f32_16x16x4_f32 v[52:55], v70, v76, v[52:55]
    v_mfma_f32_16x16x4_f32 v[56:59], v70, v78, v[56:59]
    v_mfma_f32_16x16x4_f32 v[60:63], v72, v80, v[60:63]
    v_mfma_f32_16x16x4_f32 v[48:51], v69, v75, v[48:51]
    v_mfma_f32_16x16x4_f32 v[52:55], v71, v77, v[52:55]
    v_mfma_f32_16x16x4_f32 v[56:59], v71, v79, v[56:59]
    v_mfma_f32_16x16x4_f32 v[60:63], v73, v81, v[60:63]
    v_mov_b32_dpp v64, v24 row_newbcast:9 row_mask:0xf bank_mask:0xf
    v_mov_b32_dpp v65, v25 row_newbcast:9 row_mask:0xf bank_mask:0xf
    v_mov_b32_dpp v66, v26 row_newbcast:9 row_mask:0xf bank_mask:0xf
    v_mov_b32_dpp v67, v27 row_newbcast:9 row_mask:0xf bank_mask:0xf
    v_mul_f32 v82, v64, v47
    v_mul_f32 v83, v65, v47
    v_exp_f32 v82, v82
    v_fract_f32 v83, v83
    v_cos_f32 v74, v83
    v_sin_f32 v75, v83
    v_mul_f32 v74, v74, v82
    v_mul_f32 v75, v75, v82
    v_mul_f32 v84, v75, v75
    v_add_f32 v85, v74, v74
    v_fma_f32 v76, v74, v74, -v84
    v_mul_f32 v77, v85, v75
    v_mul_f32 v84, v77, v77
    v_add_f32 v85, v76, v76
    v_fma_f32 v78, v76, v76, -v84
    v_mul_f32 v79, v85, v77
    v_mul_f32 v84, v79, v79
    v_add_f32 v85, v78, v78
    v_fma_f32 v80, v78, v78, -v84
    v_mul_f32 v81, v85, v79
    v_mul_f32 v82, v64, v44
    v_mul_f32 v83, v65, v44
    v_exp_f32 v82, v82
    v_fract_f32 v83, v83
    v_cos_f32 v68, v83
    v_sin_f32 v69, v83
    v_mul_f32 v68, v68, v82
    v_mul_f32 v69, v69, v82
    v_mul_f32 v84, v67, v69
    v_mul_f32 v85, v67, v68
    v_fma_f32 v68, v66, v68, -v84
    v_fma_f32 v69, -v66, v69, -v85
    v_mul_f32 v82, v64, v45
    v_mul_f32 v83, v65, v45
    v_exp_f32 v82, v82
    v_fract_f32 v83, v83
    v_cos_f32 v70, v83
    v_sin_f32 v71, v83
    v_mul_f32 v70, v70, v82
    v_mul_f32 v71, v71, v82
    v_mul_f32 v84, v67, v71
    v_mul_f32 v85, v67, v70
    v_fma_f32 v70, v66, v70, -v84
    v_fma_f32 v71, -v66, v71, -v85
    v_mul_f32 v82, v64, v46
    v_mul_f32 v83, v65, v46
    v_exp_f32 v82, v82
    v_fract_f32 v83, v83
    v_cos_f32 v72, v83
    v_sin_f32 v73, v83
    v_mul_f32 v72, v72, v82
    v_mul_f32 v73, v73, v82
    v_mul_f32 v84, v67, v73
    v_mul_f32 v85, v67, v72
    v_fma_f32 v72, v66, v72, -v84
    v_fma_f32 v73, -v66, v73, -v85
    v_mfma_f32_16x16x4_f32 v[48:51], v68, v74, v[48:51]
    v_mfma_f32_16x16x4_f32 v[52:55], v70, v76, v[52:55]
    v_mfma_f32_16x16x4_f32 v[56:59], v70, v78, v[56:59]
    v_mfma_f32_16x16x4_f32 v[60:63], v72, v80, v[60:63]
    v_mfma_f32_16x16x4_f32 v[48:51], v69, v75, v[48:51]
    v_mfma_f32_16x16x4_f32 v[52:55], v71, v77, v[52:55]
    v_mfma_f32_16x16x4_f32 v[56:59], v71, v79, v[56:59]
    v_mfma_f32_16x16x4_f32 v[60:63], v73, v81, v[60:63]
    v_mov_b32_dpp v64, v24 row_newbcast:10 row_mask:0xf bank_mask:0xf
    v_mov_b32_dpp v65, v25 row_newbcast:10 row_mask:0xf bank_mask:0xf
    v_mov_b32_dpp v66, v26 row_newbcast:10 row_mask:0xf bank_mask:0xf
    v_mov_b32_dpp v67, v27 row_newbcast:10 row_mask:0xf bank_mask:0xf
    v_mul_f32 v82, v64, v47
    v_mul_f32 v83, v65, v47
    v_exp_f32 v82, v82
    v_fract_f32 v83, v83
    v_cos_f32 v74, v83
    v_sin_f32 v75, v83
    v_mul_f32 v74, v74, v82
    v_mul_f32 v75, v75, v82
    v_mul_f32 v84, v75, v75
    v_add_f32 v85, v74, v74
    v_fma_f32 v76, v74, v74, -v84
    v_mul_f32 v77, v85, v75
    v_mul_f32 v84, v77, v77
    v_add_f32 v85, v76, v76
    v_fma_f32 v78, v76, v76, -v84
    v_mul_f32 v79, v85, v77
    v_mul_f32 v84, v79, v79
    v_add_f32 v85, v78, v78
    v_fma_f32 v80, v78, v78, -v84
    v_mul_f32 v81, v85, v79
    v_mul_f32 v82, v64, v44
    v_mul_f32 v83, v65, v44
    v_exp_f32 v82, v82
    v_fract_f32 v83, v83
    v_cos_f32 v68, v83
    v_sin_f32 v69, v83
    v_mul_f32 v68, v68, v82
    v_mul_f32 v69, v69, v82
    v_mul_f32 v84, v67, v69
    v_mul_f32 v85, v67, v68
    v_fma_f32 v68, v66, v68, -v84
    v_fma_f32 v69, -v66, v69, -v85
    v_mul_f32 v82, v64, v45
    v_mul_f32 v83, v65, v45
    v_exp_f32 v82, v82
    v_fract_f32 v83, v83
    v_cos_f32 v70, v83
    v_sin_f32 v71, v83
    v_mul_f32 v70, v70, v82
    v_mul_f32 v71, v71, v82
    v_mul_f32 v84, v67, v71
    v_mul_f32 v85, v67, v70
    v_fma_f32 v70, v66, v70, -v84
    v_fma_f32 v71, -v66, v71, -v85
    v_mul_f32 v82, v64, v46
    v_mul_f32 v83, v65, v46
    v_exp_f32 v82, v82
    v_fract_f32 v83, v83
    v_cos_f32 v72, v83
    v_sin_f32 v73, v83
    v_mul_f32 v72, v72, v82
    v_mul_f32 v73, v73, v82
    v_mul_f32 v84, v67, v73
    v_mul_f32 v85, v67, v72
    v_fma_f32 v72, v66, v72, -v84
    v_fma_f32 v73, -v66, v73, -v85
    v_mfma_f32_16x16x4_f32 v[48:51], v68, v74, v[48:51]
    v_mfma_f32_16x16x4_f32 v[52:55], v70, v76, v[52:55]
    v_mfma_f32_16x16x4_f32 v[56:59], v70, v78, v[56:59]
    v_mfma_f32_16x16x4_f32 v[60:63], v72, v80, v[60:63]
    v_mfma_f32_16x16x4_f32 v[48:51], v69, v75, v[48:51]
    v_mfma_f32_16x16x4_f32 v[52:55], v71, v77, v[52:55]
    v_mfma_f32_16x16x4_f32 v[56:59], v71, v79, v[56:59]
    v_mfma_f32_16x16x4_f32 v[60:63], v73, v81, v[60:63]
    v_mov_b32_dpp v64, v24 row_newbcast:11 row_mask:0xf bank_mask:0xf
    v_mov_b32_dpp v65, v25 row_newbcast:11 row_mask:0xf bank_mask:0xf
    v_mov_b32_dpp v66, v26 row_newbcast:11 row_mask:0xf bank_mask:0xf
    v_mov_b32_dpp v67, v27 row_newbcast:11 row_mask:0xf bank_mask:0xf
    v_mul_f32 v82, v64, v47
    v_mul_f32 v83, v65, v47
    v_exp_f32 v82, v82
    v_fract_f32 v83, v83
    v_cos_f32 v74, v83
    v_sin_f32 v75, v83
    v_mul_f32 v74, v74, v82
    v_mul_f32 v75, v75, v82
    v_mul_f32 v84, v75, v75
    v_add_f32 v85, v74, v74
    v_fma_f32 v76, v74, v74, -v84
    v_mul_f32 v77, v85, v75
    v_mul_f32 v84, v77, v77
    v_add_f32 v85, v76, v76
    v_fma_f32 v78, v76, v76, -v84
    v_mul_f32 v79, v85, v77
    v_mul_f32 v84, v79, v79
    v_add_f32 v85, v78, v78
    v_fma_f32 v80, v78, v78, -v84
    v_mul_f32 v81, v85, v79
    v_mul_f32 v82, v64, v44
    v_mul_f32 v83, v65, v44
    v_exp_f32 v82, v82
    v_fract_f32 v83, v83
    v_cos_f32 v68, v83
    v_sin_f32 v69, v83
    v_mul_f32 v68, v68, v82
    v_mul_f32 v69, v69, v82
    v_mul_f32 v84, v67, v69
    v_mul_f32 v85, v67, v68
    v_fma_f32 v68, v66, v68, -v84
    v_fma_f32 v69, -v66, v69, -v85
    v_mul_f32 v82, v64, v45
    v_mul_f32 v83, v65, v45
    v_exp_f32 v82, v82
    v_fract_f32 v83, v83
    v_cos_f32 v70, v83
    v_sin_f32 v71, v83
    v_mul_f32 v70, v70, v82
    v_mul_f32 v71, v71, v82
    v_mul_f32 v84, v67, v71
    v_mul_f32 v85, v67, v70
    v_fma_f32 v70, v66, v70, -v84
    v_fma_f32 v71, -v66, v71, -v85
    v_mul_f32 v82, v64, v46
    v_mul_f32 v83, v65, v46
    v_exp_f32 v82, v82
    v_fract_f32 v83, v83
    v_cos_f32 v72, v83
    v_sin_f32 v73, v83
    v_mul_f32 v72, v72, v82
    v_mul_f32 v73, v73, v82
    v_mul_f32 v84, v67, v73
    v_mul_f32 v85, v67, v72
    v_fma_f32 v72, v66, v72, -v84
    v_fma_f32 v73, -v66, v73, -v85
    v_mfma_f32_16x16x4_f32 v[48:51], v68, v74, v[48:51]
    v_mfma_f32_16x16x4_f32 v[52:55], v70, v76, v[52:55]
    v_mfma_f32_16x16x4_f32 v[56:59], v70, v78, v[56:59]
    v_mfma_f32_16x16x4_f32 v[60:63], v72, v80, v[60:63]
    v_mfma_f32_16x16x4_f32 v[48:51], v69, v75, v[48:51]
    v_mfma_f32_16x16x4_f32 v[52:55], v71, v77, v[52:55]
    v_mfma_f32_16x16x4_f32 v[56:59], v71, v79, v[56:59]
    v_mfma_f32_16x16x4_f32 v[60:63], v73, v81, v[60:63]
    v_mov_b32_dpp v64, v24 row_newbcast:12 row_mask:0xf bank_mask:0xf
    v_mov_b32_dpp v65, v25 row_newbcast:12 row_mask:0xf bank_mask:0xf
    v_mov_b32_dpp v66, v26 row_newbcast:12 row_mask:0xf bank_mask:0xf
    v_mov_b32_dpp v67, v27 row_newbcast:12 row_mask:0xf bank_mask:0xf
    v_mul_f32 v82, v64, v47
    v_mul_f32 v83, v65, v47
    v_exp_f32 v82, v82
    v_fract_f32 v83, v83
    v_cos_f32 v74, v83
    v_sin_f32 v75, v83
    v_mul_f32 v74, v74, v82
    v_mul_f32 v75, v75, v82
    v_mul_f32 v84, v75, v75
    v_add_f32 v85, v74, v74
    v_fma_f32 v76, v74, v74, -v84
    v_mul_f32 v77, v85, v75
    v_mul_f32 v84, v77, v77
    v_add_f32 v85, v76, v76
    v_fma_f32 v78, v76, v76, -v84
    v_mul_f32 v79, v85, v77
    v_mul_f32 v84, v79, v79
    v_add_f32 v85, v78, v78
    v_fma_f32 v80, v78, v78, -v84
    v_mul_f32 v81, v85, v79
    v_mul_f32 v82, v64, v44
    v_mul_f32 v83, v65, v44
    v_exp_f32 v82, v82
    v_fract_f32 v83, v83
    v_cos_f32 v68, v83
    v_sin_f32 v69, v83
    v_mul_f32 v68, v68, v82
    v_mul_f32 v69, v69, v82
    v_mul_f32 v84, v67, v69
    v_mul_f32 v85, v67, v68
    v_fma_f32 v68, v66, v68, -v84
    v_fma_f32 v69, -v66, v69, -v85
    v_mul_f32 v82, v64, v45
    v_mul_f32 v83, v65, v45
    v_exp_f32 v82, v82
    v_fract_f32 v83, v83
    v_cos_f32 v70, v83
    v_sin_f32 v71, v83
    v_mul_f32 v70, v70, v82
    v_mul_f32 v71, v71, v82
    v_mul_f32 v84, v67, v71
    v_mul_f32 v85, v67, v70
    v_fma_f32 v70, v66, v70, -v84
    v_fma_f32 v71, -v66, v71, -v85
    v_mul_f32 v82, v64, v46
    v_mul_f32 v83, v65, v46
    v_exp_f32 v82, v82
    v_fract_f32 v83, v83
    v_cos_f32 v72, v83
    v_sin_f32 v73, v83
    v_mul_f32 v72, v72, v82
    v_mul_f32 v73, v73, v82
    v_mul_f32 v84, v67, v73
    v_mul_f32 v85, v67, v72
    v_fma_f32 v72, v66, v72, -v84
    v_fma_f32 v73, -v66, v73, -v85
    v_mfma_f32_16x16x4_f32 v[48:51], v68, v74, v[48:51]
    v_mfma_f32_16x16x4_f32 v[52:55], v70, v76, v[52:55]
    v_mfma_f32_16x16x4_f32 v[56:59], v70, v78, v[56:59]
    v_mfma_f32_16x16x4_f32 v[60:63], v72, v80, v[60:63]
    v_mfma_f32_16x16x4_f32 v[48:51], v69, v75, v[48:51]
    v_mfma_f32_16x16x4_f32 v[52:55], v71, v77, v[52:55]
    v_mfma_f32_16x16x4_f32 v[56:59], v71, v79, v[56:59]
    v_mfma_f32_16x16x4_f32 v[60:63], v73, v81, v[60:63]
    v_mov_b32_dpp v64, v24 row_newbcast:13 row_mask:0xf bank_mask:0xf
    v_mov_b32_dpp v65, v25 row_newbcast:13 row_mask:0xf bank_mask:0xf
    v_mov_b32_dpp v66, v26 row_newbcast:13 row_mask:0xf bank_mask:0xf
    v_mov_b32_dpp v67, v27 row_newbcast:13 row_mask:0xf bank_mask:0xf
    v_mul_f32 v82, v64, v47
    v_mul_f32 v83, v65, v47
    v_exp_f32 v82, v82
    v_fract_f32 v83, v83
    v_cos_f32 v74, v83
    v_sin_f32 v75, v83
    v_mul_f32 v74, v74, v82
    v_mul_f32 v75, v75, v82
    v_mul_f32 v84, v75, v75
    v_add_f32 v85, v74, v74
    v_fma_f32 v76, v74, v74, -v84
    v_mul_f32 v77, v85, v75
    v_mul_f32 v84, v77, v77
    v_add_f32 v85, v76, v76
    v_fma_f32 v78, v76, v76, -v84
    v_mul_f32 v79, v85, v77
    v_mul_f32 v84, v79, v79
    v_add_f32 v85, v78, v78
    v_fma_f32 v80, v78, v78, -v84
    v_mul_f32 v81, v85, v79
    v_mul_f32 v82, v64, v44
    v_mul_f32 v83, v65, v44
    v_exp_f32 v82, v82
    v_fract_f32 v83, v83
    v_cos_f32 v68, v83
    v_sin_f32 v69, v83
    v_mul_f32 v68, v68, v82
    v_mul_f32 v69, v69, v82
    v_mul_f32 v84, v67, v69
    v_mul_f32 v85, v67, v68
    v_fma_f32 v68, v66, v68, -v84
    v_fma_f32 v69, -v66, v69, -v85
    v_mul_f32 v82, v64, v45
    v_mul_f32 v83, v65, v45
    v_exp_f32 v82, v82
    v_fract_f32 v83, v83
    v_cos_f32 v70, v83
    v_sin_f32 v71, v83
    v_mul_f32 v70, v70, v82
    v_mul_f32 v71, v71, v82
    v_mul_f32 v84, v67, v71
    v_mul_f32 v85, v67, v70
    v_fma_f32 v70, v66, v70, -v84
    v_fma_f32 v71, -v66, v71, -v85
    v_mul_f32 v82, v64, v46
    v_mul_f32 v83, v65, v46
    v_exp_f32 v82, v82
    v_fract_f32 v83, v83
    v_cos_f32 v72, v83
    v_sin_f32 v73, v83
    v_mul_f32 v72, v72, v82
    v_mul_f32 v73, v73, v82
    v_mul_f32 v84, v67, v73
    v_mul_f32 v85, v67, v72
    v_fma_f32 v72, v66, v72, -v84
    v_fma_f32 v73, -v66, v73, -v85
    v_mfma_f32_16x16x4_f32 v[48:51], v68, v74, v[48:51]
    v_mfma_f32_16x16x4_f32 v[52:55], v70, v76, v[52:55]
    v_mfma_f32_16x16x4_f32 v[56:59], v70, v78, v[56:59]
    v_mfma_f32_16x16x4_f32 v[60:63], v72, v80, v[60:63]
    v_mfma_f32_16x16x4_f32 v[48:51], v69, v75, v[48:51]
    v_mfma_f32_16x16x4_f32 v[52:55], v71, v77, v[52:55]
    v_mfma_f32_16x16x4_f32 v[56:59], v71, v79, v[56:59]
    v_mfma_f32_16x16x4_f32 v[60:63], v73, v81, v[60:63]
    v_mov_b32_dpp v64, v24 row_newbcast:14 row_mask:0xf bank_mask:0xf
    v_mov_b32_dpp v65, v25 row_newbcast:14 row_mask:0xf bank_mask:0xf
    v_mov_b32_dpp v66, v26 row_newbcast:14 row_mask:0xf bank_mask:0xf
    v_mov_b32_dpp v67, v27 row_newbcast:14 row_mask:0xf bank_mask:0xf
    v_mul_f32 v82, v64, v47
    v_mul_f32 v83, v65, v47
    v_exp_f32 v82, v82
    v_fract_f32 v83, v83
    v_cos_f32 v74, v83
    v_sin_f32 v75, v83
    v_mul_f32 v74, v74, v82
    v_mul_f32 v75, v75, v82
    v_mul_f32 v84, v75, v75
    v_add_f32 v85, v74, v74
    v_fma_f32 v76, v74, v74, -v84
    v_mul_f32 v77, v85, v75
    v_mul_f32 v84, v77, v77
    v_add_f32 v85, v76, v76
    v_fma_f32 v78, v76, v76, -v84
    v_mul_f32 v79, v85, v77
    v_mul_f32 v84, v79, v79
    v_add_f32 v85, v78, v78
    v_fma_f32 v80, v78, v78, -v84
    v_mul_f32 v81, v85, v79
    v_mul_f32 v82, v64, v44
    v_mul_f32 v83, v65, v44
    v_exp_f32 v82, v82
    v_fract_f32 v83, v83
    v_cos_f32 v68, v83
    v_sin_f32 v69, v83
    v_mul_f32 v68, v68, v82
    v_mul_f32 v69, v69, v82
    v_mul_f32 v84, v67, v69
    v_mul_f32 v85, v67, v68
    v_fma_f32 v68, v66, v68, -v84
    v_fma_f32 v69, -v66, v69, -v85
    v_mul_f32 v82, v64, v45
    v_mul_f32 v83, v65, v45
    v_exp_f32 v82, v82
    v_fract_f32 v83, v83
    v_cos_f32 v70, v83
    v_sin_f32 v71, v83
    v_mul_f32 v70, v70, v82
    v_mul_f32 v71, v71, v82
    v_mul_f32 v84, v67, v71
    v_mul_f32 v85, v67, v70
    v_fma_f32 v70, v66, v70, -v84
    v_fma_f32 v71, -v66, v71, -v85
    v_mul_f32 v82, v64, v46
    v_mul_f32 v83, v65, v46
    v_exp_f32 v82, v82
    v_fract_f32 v83, v83
    v_cos_f32 v72, v83
    v_sin_f32 v73, v83
    v_mul_f32 v72, v72, v82
    v_mul_f32 v73, v73, v82
    v_mul_f32 v84, v67, v73
    v_mul_f32 v85, v67, v72
    v_fma_f32 v72, v66, v72, -v84
    v_fma_f32 v73, -v66, v73, -v85
    v_mfma_f32_16x16x4_f32 v[48:51], v68, v74, v[48:51]
    v_mfma_f32_16x16x4_f32 v[52:55], v70, v76, v[52:55]
    v_mfma_f32_16x16x4_f32 v[56:59], v70, v78, v[56:59]
    v_mfma_f32_16x16x4_f32 v[60:63], v72, v80, v[60:63]
    v_mfma_f32_16x16x4_f32 v[48:51], v69, v75, v[48:51]
    v_mfma_f32_16x16x4_f32 v[52:55], v71, v77, v[52:55]
    v_mfma_f32_16x16x4_f32 v[56:59], v71, v79, v[56:59]
    v_mfma_f32_16x16x4_f32 v[60:63], v73, v81, v[60:63]
    v_mov_b32_dpp v64, v24 row_newbcast:15 row_mask:0xf bank_mask:0xf
    v_mov_b32_dpp v65, v25 row_newbcast:15 row_mask:0xf bank_mask:0xf
    v_mov_b32_dpp v66, v26 row_newbcast:15 row_mask:0xf bank_mask:0xf
    v_mov_b32_dpp v67, v27 row_newbcast:15 row_mask:0xf bank_mask:0xf
    v_mul_f32 v82, v64, v47
    v_mul_f32 v83, v65, v47
    v_exp_f32 v82, v82
    v_fract_f32 v83, v83
    v_cos_f32 v74, v83
    v_sin_f32 v75, v83
    v_mul_f32 v74, v74, v82
    v_mul_f32 v75, v75, v82
    v_mul_f32 v84, v75, v75
    v_add_f32 v85, v74, v74
    v_fma_f32 v76, v74, v74, -v84
    v_mul_f32 v77, v85, v75
    v_mul_f32 v84, v77, v77
    v_add_f32 v85, v76, v76
    v_fma_f32 v78, v76, v76, -v84
    v_mul_f32 v79, v85, v77
    v_mul_f32 v84, v79, v79
    v_add_f32 v85, v78, v78
    v_fma_f32 v80, v78, v78, -v84
    v_mul_f32 v81, v85, v79
    v_mul_f32 v82, v64, v44
    v_mul_f32 v83, v65, v44
    v_exp_f32 v82, v82
    v_fract_f32 v83, v83
    v_cos_f32 v68, v83
    v_sin_f32 v69, v83
    v_mul_f32 v68, v68, v82
    v_mul_f32 v69, v69, v82
    v_mul_f32 v84, v67, v69
    v_mul_f32 v85, v67, v68
    v_fma_f32 v68, v66, v68, -v84
    v_fma_f32 v69, -v66, v69, -v85
    v_mul_f32 v82, v64, v45
    v_mul_f32 v83, v65, v45
    v_exp_f32 v82, v82
    v_fract_f32 v83, v83
    v_cos_f32 v70, v83
    v_sin_f32 v71, v83
    v_mul_f32 v70, v70, v82
    v_mul_f32 v71, v71, v82
    v_mul_f32 v84, v67, v71
    v_mul_f32 v85, v67, v70
    v_fma_f32 v70, v66, v70, -v84
    v_fma_f32 v71, -v66, v71, -v85
    v_mul_f32 v82, v64, v46
    v_mul_f32 v83, v65, v46
    v_exp_f32 v82, v82
    v_fract_f32 v83, v83
    v_cos_f32 v72, v83
    v_sin_f32 v73, v83
    v_mul_f32 v72, v72, v82
    v_mul_f32 v73, v73, v82
    v_mul_f32 v84, v67, v73
    v_mul_f32 v85, v67, v72
    v_fma_f32 v72, v66, v72, -v84
    v_fma_f32 v73, -v66, v73, -v85
    v_mfma_f32_16x16x4_f32 v[48:51], v68, v74, v[48:51]
    v_mfma_f32_16x16x4_f32 v[52:55], v70, v76, v[52:55]
    v_mfma_f32_16x16x4_f32 v[56:59], v70, v78, v[56:59]
    v_mfma_f32_16x16x4_f32 v[60:63], v72, v80, v[60:63]
    v_mfma_f32_16x16x4_f32 v[48:51], v69, v75, v[48:51]
    v_mfma_f32_16x16x4_f32 v[52:55], v71, v77, v[52:55]
    v_mfma_f32_16x16x4_f32 v[56:59], v71, v79, v[56:59]
    v_mfma_f32_16x16x4_f32 v[60:63], v73, v81, v[60:63]
    v_mov_b32_dpp v64, v28 row_newbcast:0 row_mask:0xf bank_mask:0xf
    v_mov_b32_dpp v65, v29 row_newbcast:0 row_mask:0xf bank_mask:0xf
    v_mov_b32_dpp v66, v30 row_newbcast:0 row_mask:0xf bank_mask:0xf
    v_mov_b32_dpp v67, v31 row_newbcast:0 row_mask:0xf bank_mask:0xf
    v_mul_f32 v82, v64, v47
    v_mul_f32 v83, v65, v47
    v_exp_f32 v82, v82
    v_fract_f32 v83, v83
    v_cos_f32 v74, v83
    v_sin_f32 v75, v83
    v_mul_f32 v74, v74, v82
    v_mul_f32 v75, v75, v82
    v_mul_f32 v84, v75, v75
    v_add_f32 v85, v74, v74
    v_fma_f32 v76, v74, v74, -v84
    v_mul_f32 v77, v85, v75
    v_mul_f32 v84, v77, v77
    v_add_f32 v85, v76, v76
    v_fma_f32 v78, v76, v76, -v84
    v_mul_f32 v79, v85, v77
    v_mul_f32 v84, v79, v79
    v_add_f32 v85, v78, v78
    v_fma_f32 v80, v78, v78, -v84
    v_mul_f32 v81, v85, v79
    v_mul_f32 v82, v64, v44
    v_mul_f32 v83, v65, v44
    v_exp_f32 v82, v82
    v_fract_f32 v83, v83
    v_cos_f32 v68, v83
    v_sin_f32 v69, v83
    v_mul_f32 v68, v68, v82
    v_mul_f32 v69, v69, v82
    v_mul_f32 v84, v67, v69
    v_mul_f32 v85, v67, v68
    v_fma_f32 v68, v66, v68, -v84
    v_fma_f32 v69, -v66, v69, -v85
    v_mul_f32 v82, v64, v45
    v_mul_f32 v83, v65, v45
    v_exp_f32 v82, v82
    v_fract_f32 v83, v83
    v_cos_f32 v70, v83
    v_sin_f32 v71, v83
    v_mul_f32 v70, v70, v82
    v_mul_f32 v71, v71, v82
    v_mul_f32 v84, v67, v71
    v_mul_f32 v85, v67, v70
    v_fma_f32 v70, v66, v70, -v84
    v_fma_f32 v71, -v66, v71, -v85
    v_mul_f32 v82, v64, v46
    v_mul_f32 v83, v65, v46
    v_exp_f32 v82, v82
    v_fract_f32 v83, v83
    v_cos_f32 v72, v83
    v_sin_f32 v73, v83
    v_mul_f32 v72, v72, v82
    v_mul_f32 v73, v73, v82
    v_mul_f32 v84, v67, v73
    v_mul_f32 v85, v67, v72
    v_fma_f32 v72, v66, v72, -v84
    v_fma_f32 v73, -v66, v73, -v85
    v_mfma_f32_16x16x4_f32 v[48:51], v68, v74, v[48:51]
    v_mfma_f32_16x16x4_f32 v[52:55], v70, v76, v[52:55]
    v_mfma_f32_16x16x4_f32 v[56:59], v70, v78, v[56:59]
    v_mfma_f32_16x16x4_f32 v[60:63], v72, v80, v[60:63]
    v_mfma_f32_16x16x4_f32 v[48:51], v69, v75, v[48:51]
    v_mfma_f32_16x16x4_f32 v[52:55], v71, v77, v[52:55]
    v_mfma_f32_16x16x4_f32 v[56:59], v71, v79, v[56:59]
    v_mfma_f32_16x16x4_f32 v[60:63], v73, v81, v[60:63]
    v_mov_b32_dpp v64, v28 row_newbcast:1 row_mask:0xf bank_mask:0xf
    v_mov_b32_dpp v65, v29 row_newbcast:1 row_mask:0xf bank_mask:0xf
    v_mov_b32_dpp v66, v30 row_newbcast:1 row_mask:0xf bank_mask:0xf
    v_mov_b32_dpp v67, v31 row_newbcast:1 row_mask:0xf bank_mask:0xf
    v_mul_f32 v82, v64, v47
    v_mul_f32 v83, v65, v47
    v_exp_f32 v82, v82
    v_fract_f32 v83, v83
    v_cos_f32 v74, v83
    v_sin_f32 v75, v83
    v_mul_f32 v74, v74, v82
    v_mul_f32 v75, v75, v82
    v_mul_f32 v84, v75, v75
    v_add_f32 v85, v74, v74
    v_fma_f32 v76, v74, v74, -v84
    v_mul_f32 v77, v85, v75
    v_mul_f32 v84, v77, v77
    v_add_f32 v85, v76, v76
    v_fma_f32 v78, v76, v76, -v84
    v_mul_f32 v79, v85, v77
    v_mul_f32 v84, v79, v79
    v_add_f32 v85, v78, v78
    v_fma_f32 v80, v78, v78, -v84
    v_mul_f32 v81, v85, v79
    v_mul_f32 v82, v64, v44
    v_mul_f32 v83, v65, v44
    v_exp_f32 v82, v82
    v_fract_f32 v83, v83
    v_cos_f32 v68, v83
    v_sin_f32 v69, v83
    v_mul_f32 v68, v68, v82
    v_mul_f32 v69, v69, v82
    v_mul_f32 v84, v67, v69
    v_mul_f32 v85, v67, v68
    v_fma_f32 v68, v66, v68, -v84
    v_fma_f32 v69, -v66, v69, -v85
    v_mul_f32 v82, v64, v45
    v_mul_f32 v83, v65, v45
    v_exp_f32 v82, v82
    v_fract_f32 v83, v83
    v_cos_f32 v70, v83
    v_sin_f32 v71, v83
    v_mul_f32 v70, v70, v82
    v_mul_f32 v71, v71, v82
    v_mul_f32 v84, v67, v71
    v_mul_f32 v85, v67, v70
    v_fma_f32 v70, v66, v70, -v84
    v_fma_f32 v71, -v66, v71, -v85
    v_mul_f32 v82, v64, v46
    v_mul_f32 v83, v65, v46
    v_exp_f32 v82, v82
    v_fract_f32 v83, v83
    v_cos_f32 v72, v83
    v_sin_f32 v73, v83
    v_mul_f32 v72, v72, v82
    v_mul_f32 v73, v73, v82
    v_mul_f32 v84, v67, v73
    v_mul_f32 v85, v67, v72
    v_fma_f32 v72, v66, v72, -v84
    v_fma_f32 v73, -v66, v73, -v85
    v_mfma_f32_16x16x4_f32 v[48:51], v68, v74, v[48:51]
    v_mfma_f32_16x16x4_f32 v[52:55], v70, v76, v[52:55]
    v_mfma_f32_16x16x4_f32 v[56:59], v70, v78, v[56:59]
    v_mfma_f32_16x16x4_f32 v[60:63], v72, v80, v[60:63]
    v_mfma_f32_16x16x4_f32 v[48:51], v69, v75, v[48:51]
    v_mfma_f32_16x16x4_f32 v[52:55], v71, v77, v[52:55]
    v_mfma_f32_16x16x4_f32 v[56:59], v71, v79, v[56:59]
    v_mfma_f32_16x16x4_f32 v[60:63], v73, v81, v[60:63]
    v_mov_b32_dpp v64, v28 row_newbcast:2 row_mask:0xf bank_mask:0xf
    v_mov_b32_dpp v65, v29 row_newbcast:2 row_mask:0xf bank_mask:0xf
    v_mov_b32_dpp v66, v30 row_newbcast:2 row_mask:0xf bank_mask:0xf
    v_mov_b32_dpp v67, v31 row_newbcast:2 row_mask:0xf bank_mask:0xf
    v_mul_f32 v82, v64, v47
    v_mul_f32 v83, v65, v47
    v_exp_f32 v82, v82
    v_fract_f32 v83, v83
    v_cos_f32 v74, v83
    v_sin_f32 v75, v83
    v_mul_f32 v74, v74, v82
    v_mul_f32 v75, v75, v82
    v_mul_f32 v84, v75, v75
    v_add_f32 v85, v74, v74
    v_fma_f32 v76, v74, v74, -v84
    v_mul_f32 v77, v85, v75
    v_mul_f32 v84, v77, v77
    v_add_f32 v85, v76, v76
    v_fma_f32 v78, v76, v76, -v84
    v_mul_f32 v79, v85, v77
    v_mul_f32 v84, v79, v79
    v_add_f32 v85, v78, v78
    v_fma_f32 v80, v78, v78, -v84
    v_mul_f32 v81, v85, v79
    v_mul_f32 v82, v64, v44
    v_mul_f32 v83, v65, v44
    v_exp_f32 v82, v82
    v_fract_f32 v83, v83
    v_cos_f32 v68, v83
    v_sin_f32 v69, v83
    v_mul_f32 v68, v68, v82
    v_mul_f32 v69, v69, v82
    v_mul_f32 v84, v67, v69
    v_mul_f32 v85, v67, v68
    v_fma_f32 v68, v66, v68, -v84
    v_fma_f32 v69, -v66, v69, -v85
    v_mul_f32 v82, v64, v45
    v_mul_f32 v83, v65, v45
    v_exp_f32 v82, v82
    v_fract_f32 v83, v83
    v_cos_f32 v70, v83
    v_sin_f32 v71, v83
    v_mul_f32 v70, v70, v82
    v_mul_f32 v71, v71, v82
    v_mul_f32 v84, v67, v71
    v_mul_f32 v85, v67, v70
    v_fma_f32 v70, v66, v70, -v84
    v_fma_f32 v71, -v66, v71, -v85
    v_mul_f32 v82, v64, v46
    v_mul_f32 v83, v65, v46
    v_exp_f32 v82, v82
    v_fract_f32 v83, v83
    v_cos_f32 v72, v83
    v_sin_f32 v73, v83
    v_mul_f32 v72, v72, v82
    v_mul_f32 v73, v73, v82
    v_mul_f32 v84, v67, v73
    v_mul_f32 v85, v67, v72
    v_fma_f32 v72, v66, v72, -v84
    v_fma_f32 v73, -v66, v73, -v85
    v_mfma_f32_16x16x4_f32 v[48:51], v68, v74, v[48:51]
    v_mfma_f32_16x16x4_f32 v[52:55], v70, v76, v[52:55]
    v_mfma_f32_16x16x4_f32 v[56:59], v70, v78, v[56:59]
    v_mfma_f32_16x16x4_f32 v[60:63], v72, v80, v[60:63]
    v_mfma_f32_16x16x4_f32 v[48:51], v69, v75, v[48:51]
    v_mfma_f32_16x16x4_f32 v[52:55], v71, v77, v[52:55]
    v_mfma_f32_16x16x4_f32 v[56:59], v71, v79, v[56:59]
    v_mfma_f32_16x16x4_f32 v[60:63], v73, v81, v[60:63]
    v_mov_b32_dpp v64, v28 row_newbcast:3 row_mask:0xf bank_mask:0xf
    v_mov_b32_dpp v65, v29 row_newbcast:3 row_mask:0xf bank_mask:0xf
    v_mov_b32_dpp v66, v30 row_newbcast:3 row_mask:0xf bank_mask:0xf
    v_mov_b32_dpp v67, v31 row_newbcast:3 row_mask:0xf bank_mask:0xf
    v_mul_f32 v82, v64, v47
    v_mul_f32 v83, v65, v47
    v_exp_f32 v82, v82
    v_fract_f32 v83, v83
    v_cos_f32 v74, v83
    v_sin_f32 v75, v83
    v_mul_f32 v74, v74, v82
    v_mul_f32 v75, v75, v82
    v_mul_f32 v84, v75, v75
    v_add_f32 v85, v74, v74
    v_fma_f32 v76, v74, v74, -v84
    v_mul_f32 v77, v85, v75
    v_mul_f32 v84, v77, v77
    v_add_f32 v85, v76, v76
    v_fma_f32 v78, v76, v76, -v84
    v_mul_f32 v79, v85, v77
    v_mul_f32 v84, v79, v79
    v_add_f32 v85, v78, v78
    v_fma_f32 v80, v78, v78, -v84
    v_mul_f32 v81, v85, v79
    v_mul_f32 v82, v64, v44
    v_mul_f32 v83, v65, v44
    v_exp_f32 v82, v82
    v_fract_f32 v83, v83
    v_cos_f32 v68, v83
    v_sin_f32 v69, v83
    v_mul_f32 v68, v68, v82
    v_mul_f32 v69, v69, v82
    v_mul_f32 v84, v67, v69
    v_mul_f32 v85, v67, v68
    v_fma_f32 v68, v66, v68, -v84
    v_fma_f32 v69, -v66, v69, -v85
    v_mul_f32 v82, v64, v45
    v_mul_f32 v83, v65, v45
    v_exp_f32 v82, v82
    v_fract_f32 v83, v83
    v_cos_f32 v70, v83
    v_sin_f32 v71, v83
    v_mul_f32 v70, v70, v82
    v_mul_f32 v71, v71, v82
    v_mul_f32 v84, v67, v71
    v_mul_f32 v85, v67, v70
    v_fma_f32 v70, v66, v70, -v84
    v_fma_f32 v71, -v66, v71, -v85
    v_mul_f32 v82, v64, v46
    v_mul_f32 v83, v65, v46
    v_exp_f32 v82, v82
    v_fract_f32 v83, v83
    v_cos_f32 v72, v83
    v_sin_f32 v73, v83
    v_mul_f32 v72, v72, v82
    v_mul_f32 v73, v73, v82
    v_mul_f32 v84, v67, v73
    v_mul_f32 v85, v67, v72
    v_fma_f32 v72, v66, v72, -v84
    v_fma_f32 v73, -v66, v73, -v85
    v_mfma_f32_16x16x4_f32 v[48:51], v68, v74, v[48:51]
    v_mfma_f32_16x16x4_f32 v[52:55], v70, v76, v[52:55]
    v_mfma_f32_16x16x4_f32 v[56:59], v70, v78, v[56:59]
    v_mfma_f32_16x16x4_f32 v[60:63], v72, v80, v[60:63]
    v_mfma_f32_16x16x4_f32 v[48:51], v69, v75, v[48:51]
    v_mfma_f32_16x16x4_f32 v[52:55], v71, v77, v[52:55]
    v_mfma_f32_16x16x4_f32 v[56:59], v71, v79, v[56:59]
    v_mfma_f32_16x16x4_f32 v[60:63], v73, v81, v[60:63]
    v_mov_b32_dpp v64, v28 row_newbcast:4 row_mask:0xf bank_mask:0xf
    v_mov_b32_dpp v65, v29 row_newbcast:4 row_mask:0xf bank_mask:0xf
    v_mov_b32_dpp v66, v30 row_newbcast:4 row_mask:0xf bank_mask:0xf
    v_mov_b32_dpp v67, v31 row_newbcast:4 row_mask:0xf bank_mask:0xf
    v_mul_f32 v82, v64, v47
    v_mul_f32 v83, v65, v47
    v_exp_f32 v82, v82
    v_fract_f32 v83, v83
    v_cos_f32 v74, v83
    v_sin_f32 v75, v83
    v_mul_f32 v74, v74, v82
    v_mul_f32 v75, v75, v82
    v_mul_f32 v84, v75, v75
    v_add_f32 v85, v74, v74
    v_fma_f32 v76, v74, v74, -v84
    v_mul_f32 v77, v85, v75
    v_mul_f32 v84, v77, v77
    v_add_f32 v85, v76, v76
    v_fma_f32 v78, v76, v76, -v84
    v_mul_f32 v79, v85, v77
    v_mul_f32 v84, v79, v79
    v_add_f32 v85, v78, v78
    v_fma_f32 v80, v78, v78, -v84
    v_mul_f32 v81, v85, v79
    v_mul_f32 v82, v64, v44
    v_mul_f32 v83, v65, v44
    v_exp_f32 v82, v82
    v_fract_f32 v83, v83
    v_cos_f32 v68, v83
    v_sin_f32 v69, v83
    v_mul_f32 v68, v68, v82
    v_mul_f32 v69, v69, v82
    v_mul_f32 v84, v67, v69
    v_mul_f32 v85, v67, v68
    v_fma_f32 v68, v66, v68, -v84
    v_fma_f32 v69, -v66, v69, -v85
    v_mul_f32 v82, v64, v45
    v_mul_f32 v83, v65, v45
    v_exp_f32 v82, v82
    v_fract_f32 v83, v83
    v_cos_f32 v70, v83
    v_sin_f32 v71, v83
    v_mul_f32 v70, v70, v82
    v_mul_f32 v71, v71, v82
    v_mul_f32 v84, v67, v71
    v_mul_f32 v85, v67, v70
    v_fma_f32 v70, v66, v70, -v84
    v_fma_f32 v71, -v66, v71, -v85
    v_mul_f32 v82, v64, v46
    v_mul_f32 v83, v65, v46
    v_exp_f32 v82, v82
    v_fract_f32 v83, v83
    v_cos_f32 v72, v83
    v_sin_f32 v73, v83
    v_mul_f32 v72, v72, v82
    v_mul_f32 v73, v73, v82
    v_mul_f32 v84, v67, v73
    v_mul_f32 v85, v67, v72
    v_fma_f32 v72, v66, v72, -v84
    v_fma_f32 v73, -v66, v73, -v85
    v_mfma_f32_16x16x4_f32 v[48:51], v68, v74, v[48:51]
    v_mfma_f32_16x16x4_f32 v[52:55], v70, v76, v[52:55]
    v_mfma_f32_16x16x4_f32 v[56:59], v70, v78, v[56:59]
    v_mfma_f32_16x16x4_f32 v[60:63], v72, v80, v[60:63]
    v_mfma_f32_16x16x4_f32 v[48:51], v69, v75, v[48:51]
    v_mfma_f32_16x16x4_f32 v[52:55], v71, v77, v[52:55]
    v_mfma_f32_16x16x4_f32 v[56:59], v71, v79, v[56:59]
    v_mfma_f32_16x16x4_f32 v[60:63], v73, v81, v[60:63]
    v_mov_b32_dpp v64, v28 row_newbcast:5 row_mask:0xf bank_mask:0xf
    v_mov_b32_dpp v65, v29 row_newbcast:5 row_mask:0xf bank_mask:0xf
    v_mov_b32_dpp v66, v30 row_newbcast:5 row_mask:0xf bank_mask:0xf
    v_mov_b32_dpp v67, v31 row_newbcast:5 row_mask:0xf bank_mask:0xf
    v_mul_f32 v82, v64, v47
    v_mul_f32 v83, v65, v47
    v_exp_f32 v82, v82
    v_fract_f32 v83, v83
    v_cos_f32 v74, v83
    v_sin_f32 v75, v83
    v_mul_f32 v74, v74, v82
    v_mul_f32 v75, v75, v82
    v_mul_f32 v84, v75, v75
    v_add_f32 v85, v74, v74
    v_fma_f32 v76, v74, v74, -v84
    v_mul_f32 v77, v85, v75
    v_mul_f32 v84, v77, v77
    v_add_f32 v85, v76, v76
    v_fma_f32 v78, v76, v76, -v84
    v_mul_f32 v79, v85, v77
    v_mul_f32 v84, v79, v79
    v_add_f32 v85, v78, v78
    v_fma_f32 v80, v78, v78, -v84
    v_mul_f32 v81, v85, v79
    v_mul_f32 v82, v64, v44
    v_mul_f32 v83, v65, v44
    v_exp_f32 v82, v82
    v_fract_f32 v83, v83
    v_cos_f32 v68, v83
    v_sin_f32 v69, v83
    v_mul_f32 v68, v68, v82
    v_mul_f32 v69, v69, v82
    v_mul_f32 v84, v67, v69
    v_mul_f32 v85, v67, v68
    v_fma_f32 v68, v66, v68, -v84
    v_fma_f32 v69, -v66, v69, -v85
    v_mul_f32 v82, v64, v45
    v_mul_f32 v83, v65, v45
    v_exp_f32 v82, v82
    v_fract_f32 v83, v83
    v_cos_f32 v70, v83
    v_sin_f32 v71, v83
    v_mul_f32 v70, v70, v82
    v_mul_f32 v71, v71, v82
    v_mul_f32 v84, v67, v71
    v_mul_f32 v85, v67, v70
    v_fma_f32 v70, v66, v70, -v84
    v_fma_f32 v71, -v66, v71, -v85
    v_mul_f32 v82, v64, v46
    v_mul_f32 v83, v65, v46
    v_exp_f32 v82, v82
    v_fract_f32 v83, v83
    v_cos_f32 v72, v83
    v_sin_f32 v73, v83
    v_mul_f32 v72, v72, v82
    v_mul_f32 v73, v73, v82
    v_mul_f32 v84, v67, v73
    v_mul_f32 v85, v67, v72
    v_fma_f32 v72, v66, v72, -v84
    v_fma_f32 v73, -v66, v73, -v85
    v_mfma_f32_16x16x4_f32 v[48:51], v68, v74, v[48:51]
    v_mfma_f32_16x16x4_f32 v[52:55], v70, v76, v[52:55]
    v_mfma_f32_16x16x4_f32 v[56:59], v70, v78, v[56:59]
    v_mfma_f32_16x16x4_f32 v[60:63], v72, v80, v[60:63]
    v_mfma_f32_16x16x4_f32 v[48:51], v69, v75, v[48:51]
    v_mfma_f32_16x16x4_f32 v[52:55], v71, v77, v[52:55]
    v_mfma_f32_16x16x4_f32 v[56:59], v71, v79, v[56:59]
    v_mfma_f32_16x16x4_f32 v[60:63], v73, v81, v[60:63]
    v_mov_b32_dpp v64, v28 row_newbcast:6 row_mask:0xf bank_mask:0xf
    v_mov_b32_dpp v65, v29 row_newbcast:6 row_mask:0xf bank_mask:0xf
    v_mov_b32_dpp v66, v30 row_newbcast:6 row_mask:0xf bank_mask:0xf
    v_mov_b32_dpp v67, v31 row_newbcast:6 row_mask:0xf bank_mask:0xf
    v_mul_f32 v82, v64, v47
    v_mul_f32 v83, v65, v47
    v_exp_f32 v82, v82
    v_fract_f32 v83, v83
    v_cos_f32 v74, v83
    v_sin_f32 v75, v83
    v_mul_f32 v74, v74, v82
    v_mul_f32 v75, v75, v82
    v_mul_f32 v84, v75, v75
    v_add_f32 v85, v74, v74
    v_fma_f32 v76, v74, v74, -v84
    v_mul_f32 v77, v85, v75
    v_mul_f32 v84, v77, v77
    v_add_f32 v85, v76, v76
    v_fma_f32 v78, v76, v76, -v84
    v_mul_f32 v79, v85, v77
    v_mul_f32 v84, v79, v79
    v_add_f32 v85, v78, v78
    v_fma_f32 v80, v78, v78, -v84
    v_mul_f32 v81, v85, v79
    v_mul_f32 v82, v64, v44
    v_mul_f32 v83, v65, v44
    v_exp_f32 v82, v82
    v_fract_f32 v83, v83
    v_cos_f32 v68, v83
    v_sin_f32 v69, v83
    v_mul_f32 v68, v68, v82
    v_mul_f32 v69, v69, v82
    v_mul_f32 v84, v67, v69
    v_mul_f32 v85, v67, v68
    v_fma_f32 v68, v66, v68, -v84
    v_fma_f32 v69, -v66, v69, -v85
    v_mul_f32 v82, v64, v45
    v_mul_f32 v83, v65, v45
    v_exp_f32 v82, v82
    v_fract_f32 v83, v83
    v_cos_f32 v70, v83
    v_sin_f32 v71, v83
    v_mul_f32 v70, v70, v82
    v_mul_f32 v71, v71, v82
    v_mul_f32 v84, v67, v71
    v_mul_f32 v85, v67, v70
    v_fma_f32 v70, v66, v70, -v84
    v_fma_f32 v71, -v66, v71, -v85
    v_mul_f32 v82, v64, v46
    v_mul_f32 v83, v65, v46
    v_exp_f32 v82, v82
    v_fract_f32 v83, v83
    v_cos_f32 v72, v83
    v_sin_f32 v73, v83
    v_mul_f32 v72, v72, v82
    v_mul_f32 v73, v73, v82
    v_mul_f32 v84, v67, v73
    v_mul_f32 v85, v67, v72
    v_fma_f32 v72, v66, v72, -v84
    v_fma_f32 v73, -v66, v73, -v85
    v_mfma_f32_16x16x4_f32 v[48:51], v68, v74, v[48:51]
    v_mfma_f32_16x16x4_f32 v[52:55], v70, v76, v[52:55]
    v_mfma_f32_16x16x4_f32 v[56:59], v70, v78, v[56:59]
    v_mfma_f32_16x16x4_f32 v[60:63], v72, v80, v[60:63]
    v_mfma_f32_16x16x4_f32 v[48:51], v69, v75, v[48:51]
    v_mfma_f32_16x16x4_f32 v[52:55], v71, v77, v[52:55]
    v_mfma_f32_16x16x4_f32 v[56:59], v71, v79, v[56:59]
    v_mfma_f32_16x16x4_f32 v[60:63], v73, v81, v[60:63]
    v_mov_b32_dpp v64, v28 row_newbcast:7 row_mask:0xf bank_mask:0xf
    v_mov_b32_dpp v65, v29 row_newbcast:7 row_mask:0xf bank_mask:0xf
    v_mov_b32_dpp v66, v30 row_newbcast:7 row_mask:0xf bank_mask:0xf
    v_mov_b32_dpp v67, v31 row_newbcast:7 row_mask:0xf bank_mask:0xf
    v_mul_f32 v82, v64, v47
    v_mul_f32 v83, v65, v47
    v_exp_f32 v82, v82
    v_fract_f32 v83, v83
    v_cos_f32 v74, v83
    v_sin_f32 v75, v83
    v_mul_f32 v74, v74, v82
    v_mul_f32 v75, v75, v82
    v_mul_f32 v84, v75, v75
    v_add_f32 v85, v74, v74
    v_fma_f32 v76, v74, v74, -v84
    v_mul_f32 v77, v85, v75
    v_mul_f32 v84, v77, v77
    v_add_f32 v85, v76, v76
    v_fma_f32 v78, v76, v76, -v84
    v_mul_f32 v79, v85, v77
    v_mul_f32 v84, v79, v79
    v_add_f32 v85, v78, v78
    v_fma_f32 v80, v78, v78, -v84
    v_mul_f32 v81, v85, v79
    v_mul_f32 v82, v64, v44
    v_mul_f32 v83, v65, v44
    v_exp_f32 v82, v82
    v_fract_f32 v83, v83
    v_cos_f32 v68, v83
    v_sin_f32 v69, v83
    v_mul_f32 v68, v68, v82
    v_mul_f32 v69, v69, v82
    v_mul_f32 v84, v67, v69
    v_mul_f32 v85, v67, v68
    v_fma_f32 v68, v66, v68, -v84
    v_fma_f32 v69, -v66, v69, -v85
    v_mul_f32 v82, v64, v45
    v_mul_f32 v83, v65, v45
    v_exp_f32 v82, v82
    v_fract_f32 v83, v83
    v_cos_f32 v70, v83
    v_sin_f32 v71, v83
    v_mul_f32 v70, v70, v82
    v_mul_f32 v71, v71, v82
    v_mul_f32 v84, v67, v71
    v_mul_f32 v85, v67, v70
    v_fma_f32 v70, v66, v70, -v84
    v_fma_f32 v71, -v66, v71, -v85
    v_mul_f32 v82, v64, v46
    v_mul_f32 v83, v65, v46
    v_exp_f32 v82, v82
    v_fract_f32 v83, v83
    v_cos_f32 v72, v83
    v_sin_f32 v73, v83
    v_mul_f32 v72, v72, v82
    v_mul_f32 v73, v73, v82
    v_mul_f32 v84, v67, v73
    v_mul_f32 v85, v67, v72
    v_fma_f32 v72, v66, v72, -v84
    v_fma_f32 v73, -v66, v73, -v85
    v_mfma_f32_16x16x4_f32 v[48:51], v68, v74, v[48:51]
    v_mfma_f32_16x16x4_f32 v[52:55], v70, v76, v[52:55]
    v_mfma_f32_16x16x4_f32 v[56:59], v70, v78, v[56:59]
    v_mfma_f32_16x16x4_f32 v[60:63], v72, v80, v[60:63]
    v_mfma_f32_16x16x4_f32 v[48:51], v69, v75, v[48:51]
    v_mfma_f32_16x16x4_f32 v[52:55], v71, v77, v[52:55]
    v_mfma_f32_16x16x4_f32 v[56:59], v71, v79, v[56:59]
    v_mfma_f32_16x16x4_f32 v[60:63], v73, v81, v[60:63]
    v_mov_b32_dpp v64, v28 row_newbcast:8 row_mask:0xf bank_mask:0xf
    v_mov_b32_dpp v65, v29 row_newbcast:8 row_mask:0xf bank_mask:0xf
    v_mov_b32_dpp v66, v30 row_newbcast:8 row_mask:0xf bank_mask:0xf
    v_mov_b32_dpp v67, v31 row_newbcast:8 row_mask:0xf bank_mask:0xf
    v_mul_f32 v82, v64, v47
    v_mul_f32 v83, v65, v47
    v_exp_f32 v82, v82
    v_fract_f32 v83, v83
    v_cos_f32 v74, v83
    v_sin_f32 v75, v83
    v_mul_f32 v74, v74, v82
    v_mul_f32 v75, v75, v82
    v_mul_f32 v84, v75, v75
    v_add_f32 v85, v74, v74
    v_fma_f32 v76, v74, v74, -v84
    v_mul_f32 v77, v85, v75
    v_mul_f32 v84, v77, v77
    v_add_f32 v85, v76, v76
    v_fma_f32 v78, v76, v76, -v84
    v_mul_f32 v79, v85, v77
    v_mul_f32 v84, v79, v79
    v_add_f32 v85, v78, v78
    v_fma_f32 v80, v78, v78, -v84
    v_mul_f32 v81, v85, v79
    v_mul_f32 v82, v64, v44
    v_mul_f32 v83, v65, v44
    v_exp_f32 v82, v82
    v_fract_f32 v83, v83
    v_cos_f32 v68, v83
    v_sin_f32 v69, v83
    v_mul_f32 v68, v68, v82
    v_mul_f32 v69, v69, v82
    v_mul_f32 v84, v67, v69
    v_mul_f32 v85, v67, v68
    v_fma_f32 v68, v66, v68, -v84
    v_fma_f32 v69, -v66, v69, -v85
    v_mul_f32 v82, v64, v45
    v_mul_f32 v83, v65, v45
    v_exp_f32 v82, v82
    v_fract_f32 v83, v83
    v_cos_f32 v70, v83
    v_sin_f32 v71, v83
    v_mul_f32 v70, v70, v82
    v_mul_f32 v71, v71, v82
    v_mul_f32 v84, v67, v71
    v_mul_f32 v85, v67, v70
    v_fma_f32 v70, v66, v70, -v84
    v_fma_f32 v71, -v66, v71, -v85
    v_mul_f32 v82, v64, v46
    v_mul_f32 v83, v65, v46
    v_exp_f32 v82, v82
    v_fract_f32 v83, v83
    v_cos_f32 v72, v83
    v_sin_f32 v73, v83
    v_mul_f32 v72, v72, v82
    v_mul_f32 v73, v73, v82
    v_mul_f32 v84, v67, v73
    v_mul_f32 v85, v67, v72
    v_fma_f32 v72, v66, v72, -v84
    v_fma_f32 v73, -v66, v73, -v85
    v_mfma_f32_16x16x4_f32 v[48:51], v68, v74, v[48:51]
    v_mfma_f32_16x16x4_f32 v[52:55], v70, v76, v[52:55]
    v_mfma_f32_16x16x4_f32 v[56:59], v70, v78, v[56:59]
    v_mfma_f32_16x16x4_f32 v[60:63], v72, v80, v[60:63]
    v_mfma_f32_16x16x4_f32 v[48:51], v69, v75, v[48:51]
    v_mfma_f32_16x16x4_f32 v[52:55], v71, v77, v[52:55]
    v_mfma_f32_16x16x4_f32 v[56:59], v71, v79, v[56:59]
    v_mfma_f32_16x16x4_f32 v[60:63], v73, v81, v[60:63]
    v_mov_b32_dpp v64, v28 row_newbcast:9 row_mask:0xf bank_mask:0xf
    v_mov_b32_dpp v65, v29 row_newbcast:9 row_mask:0xf bank_mask:0xf
    v_mov_b32_dpp v66, v30 row_newbcast:9 row_mask:0xf bank_mask:0xf
    v_mov_b32_dpp v67, v31 row_newbcast:9 row_mask:0xf bank_mask:0xf
    v_mul_f32 v82, v64, v47
    v_mul_f32 v83, v65, v47
    v_exp_f32 v82, v82
    v_fract_f32 v83, v83
    v_cos_f32 v74, v83
    v_sin_f32 v75, v83
    v_mul_f32 v74, v74, v82
    v_mul_f32 v75, v75, v82
    v_mul_f32 v84, v75, v75
    v_add_f32 v85, v74, v74
    v_fma_f32 v76, v74, v74, -v84
    v_mul_f32 v77, v85, v75
    v_mul_f32 v84, v77, v77
    v_add_f32 v85, v76, v76
    v_fma_f32 v78, v76, v76, -v84
    v_mul_f32 v79, v85, v77
    v_mul_f32 v84, v79, v79
    v_add_f32 v85, v78, v78
    v_fma_f32 v80, v78, v78, -v84
    v_mul_f32 v81, v85, v79
    v_mul_f32 v82, v64, v44
    v_mul_f32 v83, v65, v44
    v_exp_f32 v82, v82
    v_fract_f32 v83, v83
    v_cos_f32 v68, v83
    v_sin_f32 v69, v83
    v_mul_f32 v68, v68, v82
    v_mul_f32 v69, v69, v82
    v_mul_f32 v84, v67, v69
    v_mul_f32 v85, v67, v68
    v_fma_f32 v68, v66, v68, -v84
    v_fma_f32 v69, -v66, v69, -v85
    v_mul_f32 v82, v64, v45
    v_mul_f32 v83, v65, v45
    v_exp_f32 v82, v82
    v_fract_f32 v83, v83
    v_cos_f32 v70, v83
    v_sin_f32 v71, v83
    v_mul_f32 v70, v70, v82
    v_mul_f32 v71, v71, v82
    v_mul_f32 v84, v67, v71
    v_mul_f32 v85, v67, v70
    v_fma_f32 v70, v66, v70, -v84
    v_fma_f32 v71, -v66, v71, -v85
    v_mul_f32 v82, v64, v46
    v_mul_f32 v83, v65, v46
    v_exp_f32 v82, v82
    v_fract_f32 v83, v83
    v_cos_f32 v72, v83
    v_sin_f32 v73, v83
    v_mul_f32 v72, v72, v82
    v_mul_f32 v73, v73, v82
    v_mul_f32 v84, v67, v73
    v_mul_f32 v85, v67, v72
    v_fma_f32 v72, v66, v72, -v84
    v_fma_f32 v73, -v66, v73, -v85
    v_mfma_f32_16x16x4_f32 v[48:51], v68, v74, v[48:51]
    v_mfma_f32_16x16x4_f32 v[52:55], v70, v76, v[52:55]
    v_mfma_f32_16x16x4_f32 v[56:59], v70, v78, v[56:59]
    v_mfma_f32_16x16x4_f32 v[60:63], v72, v80, v[60:63]
    v_mfma_f32_16x16x4_f32 v[48:51], v69, v75, v[48:51]
    v_mfma_f32_16x16x4_f32 v[52:55], v71, v77, v[52:55]
    v_mfma_f32_16x16x4_f32 v[56:59], v71, v79, v[56:59]
    v_mfma_f32_16x16x4_f32 v[60:63], v73, v81, v[60:63]
    v_mov_b32_dpp v64, v28 row_newbcast:10 row_mask:0xf bank_mask:0xf
    v_mov_b32_dpp v65, v29 row_newbcast:10 row_mask:0xf bank_mask:0xf
    v_mov_b32_dpp v66, v30 row_newbcast:10 row_mask:0xf bank_mask:0xf
    v_mov_b32_dpp v67, v31 row_newbcast:10 row_mask:0xf bank_mask:0xf
    v_mul_f32 v82, v64, v47
    v_mul_f32 v83, v65, v47
    v_exp_f32 v82, v82
    v_fract_f32 v83, v83
    v_cos_f32 v74, v83
    v_sin_f32 v75, v83
    v_mul_f32 v74, v74, v82
    v_mul_f32 v75, v75, v82
    v_mul_f32 v84, v75, v75
    v_add_f32 v85, v74, v74
    v_fma_f32 v76, v74, v74, -v84
    v_mul_f32 v77, v85, v75
    v_mul_f32 v84, v77, v77
    v_add_f32 v85, v76, v76
    v_fma_f32 v78, v76, v76, -v84
    v_mul_f32 v79, v85, v77
    v_mul_f32 v84, v79, v79
    v_add_f32 v85, v78, v78
    v_fma_f32 v80, v78, v78, -v84
    v_mul_f32 v81, v85, v79
    v_mul_f32 v82, v64, v44
    v_mul_f32 v83, v65, v44
    v_exp_f32 v82, v82
    v_fract_f32 v83, v83
    v_cos_f32 v68, v83
    v_sin_f32 v69, v83
    v_mul_f32 v68, v68, v82
    v_mul_f32 v69, v69, v82
    v_mul_f32 v84, v67, v69
    v_mul_f32 v85, v67, v68
    v_fma_f32 v68, v66, v68, -v84
    v_fma_f32 v69, -v66, v69, -v85
    v_mul_f32 v82, v64, v45
    v_mul_f32 v83, v65, v45
    v_exp_f32 v82, v82
    v_fract_f32 v83, v83
    v_cos_f32 v70, v83
    v_sin_f32 v71, v83
    v_mul_f32 v70, v70, v82
    v_mul_f32 v71, v71, v82
    v_mul_f32 v84, v67, v71
    v_mul_f32 v85, v67, v70
    v_fma_f32 v70, v66, v70, -v84
    v_fma_f32 v71, -v66, v71, -v85
    v_mul_f32 v82, v64, v46
    v_mul_f32 v83, v65, v46
    v_exp_f32 v82, v82
    v_fract_f32 v83, v83
    v_cos_f32 v72, v83
    v_sin_f32 v73, v83
    v_mul_f32 v72, v72, v82
    v_mul_f32 v73, v73, v82
    v_mul_f32 v84, v67, v73
    v_mul_f32 v85, v67, v72
    v_fma_f32 v72, v66, v72, -v84
    v_fma_f32 v73, -v66, v73, -v85
    v_mfma_f32_16x16x4_f32 v[48:51], v68, v74, v[48:51]
    v_mfma_f32_16x16x4_f32 v[52:55], v70, v76, v[52:55]
    v_mfma_f32_16x16x4_f32 v[56:59], v70, v78, v[56:59]
    v_mfma_f32_16x16x4_f32 v[60:63], v72, v80, v[60:63]
    v_mfma_f32_16x16x4_f32 v[48:51], v69, v75, v[48:51]
    v_mfma_f32_16x16x4_f32 v[52:55], v71, v77, v[52:55]
    v_mfma_f32_16x16x4_f32 v[56:59], v71, v79, v[56:59]
    v_mfma_f32_16x16x4_f32 v[60:63], v73, v81, v[60:63]
    v_mov_b32_dpp v64, v28 row_newbcast:11 row_mask:0xf bank_mask:0xf
    v_mov_b32_dpp v65, v29 row_newbcast:11 row_mask:0xf bank_mask:0xf
    v_mov_b32_dpp v66, v30 row_newbcast:11 row_mask:0xf bank_mask:0xf
    v_mov_b32_dpp v67, v31 row_newbcast:11 row_mask:0xf bank_mask:0xf
    v_mul_f32 v82, v64, v47
    v_mul_f32 v83, v65, v47
    v_exp_f32 v82, v82
    v_fract_f32 v83, v83
    v_cos_f32 v74, v83
    v_sin_f32 v75, v83
    v_mul_f32 v74, v74, v82
    v_mul_f32 v75, v75, v82
    v_mul_f32 v84, v75, v75
    v_add_f32 v85, v74, v74
    v_fma_f32 v76, v74, v74, -v84
    v_mul_f32 v77, v85, v75
    v_mul_f32 v84, v77, v77
    v_add_f32 v85, v76, v76
    v_fma_f32 v78, v76, v76, -v84
    v_mul_f32 v79, v85, v77
    v_mul_f32 v84, v79, v79
    v_add_f32 v85, v78, v78
    v_fma_f32 v80, v78, v78, -v84
    v_mul_f32 v81, v85, v79
    v_mul_f32 v82, v64, v44
    v_mul_f32 v83, v65, v44
    v_exp_f32 v82, v82
    v_fract_f32 v83, v83
    v_cos_f32 v68, v83
    v_sin_f32 v69, v83
    v_mul_f32 v68, v68, v82
    v_mul_f32 v69, v69, v82
    v_mul_f32 v84, v67, v69
    v_mul_f32 v85, v67, v68
    v_fma_f32 v68, v66, v68, -v84
    v_fma_f32 v69, -v66, v69, -v85
    v_mul_f32 v82, v64, v45
    v_mul_f32 v83, v65, v45
    v_exp_f32 v82, v82
    v_fract_f32 v83, v83
    v_cos_f32 v70, v83
    v_sin_f32 v71, v83
    v_mul_f32 v70, v70, v82
    v_mul_f32 v71, v71, v82
    v_mul_f32 v84, v67, v71
    v_mul_f32 v85, v67, v70
    v_fma_f32 v70, v66, v70, -v84
    v_fma_f32 v71, -v66, v71, -v85
    v_mul_f32 v82, v64, v46
    v_mul_f32 v83, v65, v46
    v_exp_f32 v82, v82
    v_fract_f32 v83, v83
    v_cos_f32 v72, v83
    v_sin_f32 v73, v83
    v_mul_f32 v72, v72, v82
    v_mul_f32 v73, v73, v82
    v_mul_f32 v84, v67, v73
    v_mul_f32 v85, v67, v72
    v_fma_f32 v72, v66, v72, -v84
    v_fma_f32 v73, -v66, v73, -v85
    v_mfma_f32_16x16x4_f32 v[48:51], v68, v74, v[48:51]
    v_mfma_f32_16x16x4_f32 v[52:55], v70, v76, v[52:55]
    v_mfma_f32_16x16x4_f32 v[56:59], v70, v78, v[56:59]
    v_mfma_f32_16x16x4_f32 v[60:63], v72, v80, v[60:63]
    v_mfma_f32_16x16x4_f32 v[48:51], v69, v75, v[48:51]
    v_mfma_f32_16x16x4_f32 v[52:55], v71, v77, v[52:55]
    v_mfma_f32_16x16x4_f32 v[56:59], v71, v79, v[56:59]
    v_mfma_f32_16x16x4_f32 v[60:63], v73, v81, v[60:63]
    v_mov_b32_dpp v64, v28 row_newbcast:12 row_mask:0xf bank_mask:0xf
    v_mov_b32_dpp v65, v29 row_newbcast:12 row_mask:0xf bank_mask:0xf
    v_mov_b32_dpp v66, v30 row_newbcast:12 row_mask:0xf bank_mask:0xf
    v_mov_b32_dpp v67, v31 row_newbcast:12 row_mask:0xf bank_mask:0xf
    v_mul_f32 v82, v64, v47
    v_mul_f32 v83, v65, v47
    v_exp_f32 v82, v82
    v_fract_f32 v83, v83
    v_cos_f32 v74, v83
    v_sin_f32 v75, v83
    v_mul_f32 v74, v74, v82
    v_mul_f32 v75, v75, v82
    v_mul_f32 v84, v75, v75
    v_add_f32 v85, v74, v74
    v_fma_f32 v76, v74, v74, -v84
    v_mul_f32 v77, v85, v75
    v_mul_f32 v84, v77, v77
    v_add_f32 v85, v76, v76
    v_fma_f32 v78, v76, v76, -v84
    v_mul_f32 v79, v85, v77
    v_mul_f32 v84, v79, v79
    v_add_f32 v85, v78, v78
    v_fma_f32 v80, v78, v78, -v84
    v_mul_f32 v81, v85, v79
    v_mul_f32 v82, v64, v44
    v_mul_f32 v83, v65, v44
    v_exp_f32 v82, v82
    v_fract_f32 v83, v83
    v_cos_f32 v68, v83
    v_sin_f32 v69, v83
    v_mul_f32 v68, v68, v82
    v_mul_f32 v69, v69, v82
    v_mul_f32 v84, v67, v69
    v_mul_f32 v85, v67, v68
    v_fma_f32 v68, v66, v68, -v84
    v_fma_f32 v69, -v66, v69, -v85
    v_mul_f32 v82, v64, v45
    v_mul_f32 v83, v65, v45
    v_exp_f32 v82, v82
    v_fract_f32 v83, v83
    v_cos_f32 v70, v83
    v_sin_f32 v71, v83
    v_mul_f32 v70, v70, v82
    v_mul_f32 v71, v71, v82
    v_mul_f32 v84, v67, v71
    v_mul_f32 v85, v67, v70
    v_fma_f32 v70, v66, v70, -v84
    v_fma_f32 v71, -v66, v71, -v85
    v_mul_f32 v82, v64, v46
    v_mul_f32 v83, v65, v46
    v_exp_f32 v82, v82
    v_fract_f32 v83, v83
    v_cos_f32 v72, v83
    v_sin_f32 v73, v83
    v_mul_f32 v72, v72, v82
    v_mul_f32 v73, v73, v82
    v_mul_f32 v84, v67, v73
    v_mul_f32 v85, v67, v72
    v_fma_f32 v72, v66, v72, -v84
    v_fma_f32 v73, -v66, v73, -v85
    v_mfma_f32_16x16x4_f32 v[48:51], v68, v74, v[48:51]
    v_mfma_f32_16x16x4_f32 v[52:55], v70, v76, v[52:55]
    v_mfma_f32_16x16x4_f32 v[56:59], v70, v78, v[56:59]
    v_mfma_f32_16x16x4_f32 v[60:63], v72, v80, v[60:63]
    v_mfma_f32_16x16x4_f32 v[48:51], v69, v75, v[48:51]
    v_mfma_f32_16x16x4_f32 v[52:55], v71, v77, v[52:55]
    v_mfma_f32_16x16x4_f32 v[56:59], v71, v79, v[56:59]
    v_mfma_f32_16x16x4_f32 v[60:63], v73, v81, v[60:63]
    v_mov_b32_dpp v64, v28 row_newbcast:13 row_mask:0xf bank_mask:0xf
    v_mov_b32_dpp v65, v29 row_newbcast:13 row_mask:0xf bank_mask:0xf
    v_mov_b32_dpp v66, v30 row_newbcast:13 row_mask:0xf bank_mask:0xf
    v_mov_b32_dpp v67, v31 row_newbcast:13 row_mask:0xf bank_mask:0xf
    v_mul_f32 v82, v64, v47
    v_mul_f32 v83, v65, v47
    v_exp_f32 v82, v82
    v_fract_f32 v83, v83
    v_cos_f32 v74, v83
    v_sin_f32 v75, v83
    v_mul_f32 v74, v74, v82
    v_mul_f32 v75, v75, v82
    v_mul_f32 v84, v75, v75
    v_add_f32 v85, v74, v74
    v_fma_f32 v76, v74, v74, -v84
    v_mul_f32 v77, v85, v75
    v_mul_f32 v84, v77, v77
    v_add_f32 v85, v76, v76
    v_fma_f32 v78, v76, v76, -v84
    v_mul_f32 v79, v85, v77
    v_mul_f32 v84, v79, v79
    v_add_f32 v85, v78, v78
    v_fma_f32 v80, v78, v78, -v84
    v_mul_f32 v81, v85, v79
    v_mul_f32 v82, v64, v44
    v_mul_f32 v83, v65, v44
    v_exp_f32 v82, v82
    v_fract_f32 v83, v83
    v_cos_f32 v68, v83
    v_sin_f32 v69, v83
    v_mul_f32 v68, v68, v82
    v_mul_f32 v69, v69, v82
    v_mul_f32 v84, v67, v69
    v_mul_f32 v85, v67, v68
    v_fma_f32 v68, v66, v68, -v84
    v_fma_f32 v69, -v66, v69, -v85
    v_mul_f32 v82, v64, v45
    v_mul_f32 v83, v65, v45
    v_exp_f32 v82, v82
    v_fract_f32 v83, v83
    v_cos_f32 v70, v83
    v_sin_f32 v71, v83
    v_mul_f32 v70, v70, v82
    v_mul_f32 v71, v71, v82
    v_mul_f32 v84, v67, v71
    v_mul_f32 v85, v67, v70
    v_fma_f32 v70, v66, v70, -v84
    v_fma_f32 v71, -v66, v71, -v85
    v_mul_f32 v82, v64, v46
    v_mul_f32 v83, v65, v46
    v_exp_f32 v82, v82
    v_fract_f32 v83, v83
    v_cos_f32 v72, v83
    v_sin_f32 v73, v83
    v_mul_f32 v72, v72, v82
    v_mul_f32 v73, v73, v82
    v_mul_f32 v84, v67, v73
    v_mul_f32 v85, v67, v72
    v_fma_f32 v72, v66, v72, -v84
    v_fma_f32 v73, -v66, v73, -v85
    v_mfma_f32_16x16x4_f32 v[48:51], v68, v74, v[48:51]
    v_mfma_f32_16x16x4_f32 v[52:55], v70, v76, v[52:55]
    v_mfma_f32_16x16x4_f32 v[56:59], v70, v78, v[56:59]
    v_mfma_f32_16x16x4_f32 v[60:63], v72, v80, v[60:63]
    v_mfma_f32_16x16x4_f32 v[48:51], v69, v75, v[48:51]
    v_mfma_f32_16x16x4_f32 v[52:55], v71, v77, v[52:55]
    v_mfma_f32_16x16x4_f32 v[56:59], v71, v79, v[56:59]
    v_mfma_f32_16x16x4_f32 v[60:63], v73, v81, v[60:63]
    v_mov_b32_dpp v64, v28 row_newbcast:14 row_mask:0xf bank_mask:0xf
    v_mov_b32_dpp v65, v29 row_newbcast:14 row_mask:0xf bank_mask:0xf
    v_mov_b32_dpp v66, v30 row_newbcast:14 row_mask:0xf bank_mask:0xf
    v_mov_b32_dpp v67, v31 row_newbcast:14 row_mask:0xf bank_mask:0xf
    v_mul_f32 v82, v64, v47
    v_mul_f32 v83, v65, v47
    v_exp_f32 v82, v82
    v_fract_f32 v83, v83
    v_cos_f32 v74, v83
    v_sin_f32 v75, v83
    v_mul_f32 v74, v74, v82
    v_mul_f32 v75, v75, v82
    v_mul_f32 v84, v75, v75
    v_add_f32 v85, v74, v74
    v_fma_f32 v76, v74, v74, -v84
    v_mul_f32 v77, v85, v75
    v_mul_f32 v84, v77, v77
    v_add_f32 v85, v76, v76
    v_fma_f32 v78, v76, v76, -v84
    v_mul_f32 v79, v85, v77
    v_mul_f32 v84, v79, v79
    v_add_f32 v85, v78, v78
    v_fma_f32 v80, v78, v78, -v84
    v_mul_f32 v81, v85, v79
    v_mul_f32 v82, v64, v44
    v_mul_f32 v83, v65, v44
    v_exp_f32 v82, v82
    v_fract_f32 v83, v83
    v_cos_f32 v68, v83
    v_sin_f32 v69, v83
    v_mul_f32 v68, v68, v82
    v_mul_f32 v69, v69, v82
    v_mul_f32 v84, v67, v69
    v_mul_f32 v85, v67, v68
    v_fma_f32 v68, v66, v68, -v84
    v_fma_f32 v69, -v66, v69, -v85
    v_mul_f32 v82, v64, v45
    v_mul_f32 v83, v65, v45
    v_exp_f32 v82, v82
    v_fract_f32 v83, v83
    v_cos_f32 v70, v83
    v_sin_f32 v71, v83
    v_mul_f32 v70, v70, v82
    v_mul_f32 v71, v71, v82
    v_mul_f32 v84, v67, v71
    v_mul_f32 v85, v67, v70
    v_fma_f32 v70, v66, v70, -v84
    v_fma_f32 v71, -v66, v71, -v85
    v_mul_f32 v82, v64, v46
    v_mul_f32 v83, v65, v46
    v_exp_f32 v82, v82
    v_fract_f32 v83, v83
    v_cos_f32 v72, v83
    v_sin_f32 v73, v83
    v_mul_f32 v72, v72, v82
    v_mul_f32 v73, v73, v82
    v_mul_f32 v84, v67, v73
    v_mul_f32 v85, v67, v72
    v_fma_f32 v72, v66, v72, -v84
    v_fma_f32 v73, -v66, v73, -v85
    v_mfma_f32_16x16x4_f32 v[48:51], v68, v74, v[48:51]
    v_mfma_f32_16x16x4_f32 v[52:55], v70, v76, v[52:55]
    v_mfma_f32_16x16x4_f32 v[56:59], v70, v78, v[56:59]
    v_mfma_f32_16x16x4_f32 v[60:63], v72, v80, v[60:63]
    v_mfma_f32_16x16x4_f32 v[48:51], v69, v75, v[48:51]
    v_mfma_f32_16x16x4_f32 v[52:55], v71, v77, v[52:55]
    v_mfma_f32_16x16x4_f32 v[56:59], v71, v79, v[56:59]
    v_mfma_f32_16x16x4_f32 v[60:63], v73, v81, v[60:63]
    v_mov_b32_dpp v64, v28 row_newbcast:15 row_mask:0xf bank_mask:0xf
    v_mov_b32_dpp v65, v29 row_newbcast:15 row_mask:0xf bank_mask:0xf
    v_mov_b32_dpp v66, v30 row_newbcast:15 row_mask:0xf bank_mask:0xf
    v_mov_b32_dpp v67, v31 row_newbcast:15 row_mask:0xf bank_mask:0xf
    v_mul_f32 v82, v64, v47
    v_mul_f32 v83, v65, v47
    v_exp_f32 v82, v82
    v_fract_f32 v83, v83
    v_cos_f32 v74, v83
    v_sin_f32 v75, v83
    v_mul_f32 v74, v74, v82
    v_mul_f32 v75, v75, v82
    v_mul_f32 v84, v75, v75
    v_add_f32 v85, v74, v74
    v_fma_f32 v76, v74, v74, -v84
    v_mul_f32 v77, v85, v75
    v_mul_f32 v84, v77, v77
    v_add_f32 v85, v76, v76
    v_fma_f32 v78, v76, v76, -v84
    v_mul_f32 v79, v85, v77
    v_mul_f32 v84, v79, v79
    v_add_f32 v85, v78, v78
    v_fma_f32 v80, v78, v78, -v84
    v_mul_f32 v81, v85, v79
    v_mul_f32 v82, v64, v44
    v_mul_f32 v83, v65, v44
    v_exp_f32 v82, v82
    v_fract_f32 v83, v83
    v_cos_f32 v68, v83
    v_sin_f32 v69, v83
    v_mul_f32 v68, v68, v82
    v_mul_f32 v69, v69, v82
    v_mul_f32 v84, v67, v69
    v_mul_f32 v85, v67, v68
    v_fma_f32 v68, v66, v68, -v84
    v_fma_f32 v69, -v66, v69, -v85
    v_mul_f32 v82, v64, v45
    v_mul_f32 v83, v65, v45
    v_exp_f32 v82, v82
    v_fract_f32 v83, v83
    v_cos_f32 v70, v83
    v_sin_f32 v71, v83
    v_mul_f32 v70, v70, v82
    v_mul_f32 v71, v71, v82
    v_mul_f32 v84, v67, v71
    v_mul_f32 v85, v67, v70
    v_fma_f32 v70, v66, v70, -v84
    v_fma_f32 v71, -v66, v71, -v85
    v_mul_f32 v82, v64, v46
    v_mul_f32 v83, v65, v46
    v_exp_f32 v82, v82
    v_fract_f32 v83, v83
    v_cos_f32 v72, v83
    v_sin_f32 v73, v83
    v_mul_f32 v72, v72, v82
    v_mul_f32 v73, v73, v82
    v_mul_f32 v84, v67, v73
    v_mul_f32 v85, v67, v72
    v_fma_f32 v72, v66, v72, -v84
    v_fma_f32 v73, -v66, v73, -v85
    v_mfma_f32_16x16x4_f32 v[48:51], v68, v74, v[48:51]
    v_mfma_f32_16x16x4_f32 v[52:55], v70, v76, v[52:55]
    v_mfma_f32_16x16x4_f32 v[56:59], v70, v78, v[56:59]
    v_mfma_f32_16x16x4_f32 v[60:63], v72, v80, v[60:63]
    v_mfma_f32_16x16x4_f32 v[48:51], v69, v75, v[48:51]
    v_mfma_f32_16x16x4_f32 v[52:55], v71, v77, v[52:55]
    v_mfma_f32_16x16x4_f32 v[56:59], v71, v79, v[56:59]
    v_mfma_f32_16x16x4_f32 v[60:63], v73, v81, v[60:63]
    v_lshlrev_b32 v5, 8, v3
    v_lshl_add_u32 v5, v2, 2, v5
    v_add_u32 v5, v5, v4
    ds_write_b32 v5, v48 offset:4608
    ds_write_b32 v5, v49 offset:4672
    ds_write_b32 v5, v50 offset:4736
    ds_write_b32 v5, v51 offset:4800
    v_cmp_gt_u32 vcc, 2, v3
    s_nop 0
    s_mov_b64 exec, vcc
    ds_write_b32 v5, v52 offset:5632
    ds_write_b32 v5, v53 offset:5696
    ds_write_b32 v5, v54 offset:5760
    ds_write_b32 v5, v55 offset:5824
    ds_write_b32 v5, v60 offset:6656
    ds_write_b32 v5, v61 offset:6720
    ds_write_b32 v5, v62 offset:6784
    ds_write_b32 v5, v63 offset:6848
    s_not_b64 exec, exec
    ds_write_b32 v5, v56 offset:5632
    ds_write_b32 v5, v57 offset:5696
    ds_write_b32 v5, v58 offset:5760
    ds_write_b32 v5, v59 offset:5824
    s_mov_b32 exec_lo, 0
    s_mov_b32 exec_hi, 3
    v_cmp_eq_u32 vcc, 0, v2
    s_nop 1
    v_cndmask_b32 v6, 0, v60, vcc
    ds_write_b32 v5, v6 offset:6656
    s_mov_b64 exec, -1
    s_waitcnt lgkmcnt(0)
    v_lshlrev_b32 v7, 1, v1
    v_sub_u32 v7, 2065, v7
    v_lshl_add_u32 v64, v1, 2, v4
    v_mov_b32 v65, 641
    s_mov_b32 s25, 17
ss_exp:
    v_subrev_u32 v66, 0, v7
    v_cvt_f32_u32 v70, v66
    v_cvt_pk_bf16_f32 v70, v70, v70
    v_and_b32 v70, 0xffff, v70
    v_subrev_u32 v70, 0x4280, v70
    v_cmp_gt_u32 vcc, 256, v66
    s_nop 1
    v_cndmask_b32 v70, v70, v66, vcc
    v_cmp_gt_u32 vcc, 2048, v66
    s_nop 1
    v_cndmask_b32 v70, v65, v70, vcc
    v_lshl_add_u32 v70, v70, 2, v4
    ds_read_b32 v74, v70 offset:4608
    v_subrev_u32 v67, 1, v7
    v_cvt_f32_u32 v71, v67
    v_cvt_pk_bf16_f32 v71, v71, v71
    v_and_b32 v71, 0xffff, v71
    v_subrev_u32 v71, 0x4280, v71
    v_cmp_gt_u32 vcc, 256, v67
    s_nop 1
    v_cndmask_b32 v71, v71, v67, vcc
    v_cmp_gt_u32 vcc, 2048, v67
    s_nop 1
    v_cndmask_b32 v71, v65, v71, vcc
    v_lshl_add_u32 v71, v71, 2, v4
    ds_read_b32 v75, v71 offset:4608
    v_subrev_u32 v68, 2, v7
    v_cvt_f32_u32 v72, v68
    v_cvt_pk_bf16_f32 v72, v72, v72
    v_and_b32 v72, 0xffff, v72
    v_subrev_u32 v72, 0x4280, v72
    v_cmp_gt_u32 vcc, 256, v68
    s_nop 1
    v_cndmask_b32 v72, v72, v68, vcc
    v_cmp_gt_u32 vcc, 2048, v68
    s_nop 1
    v_cndmask_b32 v72, v65, v72, vcc
    v_lshl_add_u32 v72, v72, 2, v4
    ds_read_b32 v76, v72 offset:4608
    s_waitcnt lgkmcnt(0)
    v_cvt_pk_bf16_f32 v78, v75, v76
    v_cvt_pk_bf16_f32 v79, v74, v75
    ds_write_b32 v64, v78 offset:7424
    ds_write_b32 v64, v79 offset:11776
    v_subrev_u32 v7, 128, v7
    v_add_u32 v64, 256, v64
    s_sub_u32 s25, s25, 1
    s_cmp_lg_u32 s25, 0
    s_cbranch_scc1 ss_exp
    s_waitcnt lgkmcnt(0)
    s_barrier
    v_and_b32 v5, 1, v2
    v_mul_u32_u24 v64, 4352, v5
    v_sub_u32 v5, v5, v2
    v_lshl_add_u32 v5, v3, 3, v5
    v_lshl_add_u32 v64, v5, 1, v64
    v_add_u32 v64, 11520, v64
    v_add_u32 v64, v64, v4
    v_lshlrev_b32 v65, 5, v2
    v_lshl_add_u32 v65, v3, 4, v65
    v_add_u32 v65, 480, v65
    v_add_u32 v65, v65, v4
    v_mov_b32 v96, 0
    v_mov_b32 v97, 0
    v_mov_b32 v98, 0
    v_mov_b32 v99, 0
    v_mov_b32 v100, 0
    v_mov_b32 v101, 0
    v_mov_b32 v102, 0
    v_mov_b32 v103, 0
    v_mov_b32 v104, 0
    v_mov_b32 v105, 0
    v_mov_b32 v106, 0
    v_mov_b32 v107, 0
    v_mov_b32 v108, 0
    v_mov_b32 v109, 0
    v_mov_b32 v110, 0
    v_mov_b32 v111, 0
    v_mov_b32 v112, 0
    v_mov_b32 v113, 0
    v_mov_b32 v114, 0
    v_mov_b32 v115, 0
    v_mov_b32 v116, 0
    v_mov_b32 v117, 0
    v_mov_b32 v118, 0
    v_mov_b32 v119, 0
    v_mov_b32 v120, 0
    v_mov_b32 v121, 0
    v_mov_b32 v122, 0
    v_mov_b32 v123, 0
    v_mov_b32 v124, 0
    v_mov_b32 v125, 0
    v_mov_b32 v126, 0
    v_mov_b32 v127, 0
    s_mov_b32 s25, 8
ss_cv0:
    ds_read2_b32 v[68:69], v64 offset0:0 offset1:1
    ds_read2_b32 v[70:71], v64 offset0:2 offset1:3
    ds_read_b128 v[128:131], v65 offset:0
    ds_read_b128 v[132:135], v65 offset:512
    ds_read_b128 v[136:139], v65 offset:1024
    ds_read_b128 v[140:143], v65 offset:1536
    ds_read_b128 v[144:147], v65 offset:2048
    ds_read_b128 v[148:151], v65 offset:2560
    ds_read_b128 v[152:155], v65 offset:3072
    ds_read_b128 v[156:159], v65 offset:3584
    v_subrev_u32 v64, 64, v64
    v_subrev_u32 v65, 64, v65
    s_waitcnt lgkmcnt(7)
    v_mfma_f32_16x16x32_bf16 v[96:99], v[68:71], v[128:131], v[96:99]
    s_waitcnt lgkmcnt(6)
    v_mfma_f32_16x16x32_bf16 v[100:103], v[68:71], v[132:135], v[100:103]
    s_waitcnt lgkmcnt(5)
    v_mfma_f32_16x16x32_bf16 v[104:107], v[68:71], v[136:139], v[104:107]
    s_waitcnt lgkmcnt(4)
    v_mfma_f32_16x16x32_bf16 v[108:111], v[68:71], v[140:143], v[108:111]
    s_waitcnt lgkmcnt(3)
    v_mfma_f32_16x16x32_bf16 v[112:115], v[68:71], v[144:147], v[112:115]
    s_waitcnt lgkmcnt(2)
    v_mfma_f32_16x16x32_bf16 v[116:119], v[68:71], v[148:151], v[116:119]
    s_waitcnt lgkmcnt(1)
    v_mfma_f32_16x16x32_bf16 v[120:123], v[68:71], v[152:155], v[120:123]
    s_waitcnt lgkmcnt(0)
    v_mfma_f32_16x16x32_bf16 v[124:127], v[68:71], v[156:159], v[124:127]
    s_sub_u32 s25, s25, 1
    s_cmp_lg_u32 s25, 0
    s_cbranch_scc1 ss_cv0
    v_add_u32 v65, 512, v65
    s_mov_b32 s25, 8
ss_cv1:
    ds_read2_b32 v[68:69], v64 offset0:0 offset1:1
    ds_read2_b32 v[70:71], v64 offset0:2 offset1:3
    ds_read_b128 v[132:135], v65 offset:0
    ds_read_b128 v[136:139], v65 offset:512
    ds_read_b128 v[140:143], v65 offset:1024
    ds_read_b128 v[144:147], v65 offset:1536
    ds_read_b128 v[148:151], v65 offset:2048
    ds_read_b128 v[152:155], v65 offset:2560
    ds_read_b128 v[156:159], v65 offset:3072
    v_subrev_u32 v64, 64, v64
    v_subrev_u32 v65, 64, v65
    s_waitcnt lgkmcnt(6)
    v_mfma_f32_16x16x32_bf16 v[100:103], v[68:71], v[132:135], v[100:103]
    s_waitcnt lgkmcnt(5)
    v_mfma_f32_16x16x32_bf16 v[104:107], v[68:71], v[136:139], v[104:107]
    s_waitcnt lgkmcnt(4)
    v_mfma_f32_16x16x32_bf16 v[108:111], v[68:71], v[140:143], v[108:111]
    s_waitcnt lgkmcnt(3)
    v_mfma_f32_16x16x32_bf16 v[112:115], v[68:71], v[144:147], v[112:115]
    s_waitcnt lgkmcnt(2)
    v_mfma_f32_16x16x32_bf16 v[116:119], v[68:71], v[148:151], v[116:119]
    s_waitcnt lgkmcnt(1)
    v_mfma_f32_16x16x32_bf16 v[120:123], v[68:71], v[152:155], v[120:123]
    s_waitcnt lgkmcnt(0)
    v_mfma_f32_16x16x32_bf16 v[124:127], v[68:71], v[156:159], v[124:127]
    s_sub_u32 s25, s25, 1
    s_cmp_lg_u32 s25, 0
    s_cbranch_scc1 ss_cv1
    v_add_u32 v65, 512, v65
    s_mov_b32 s25, 8
ss_cv2:
    ds_read2_b32 v[68:69], v64 offset0:0 offset1:1
    ds_read2_b32 v[70:71], v64 offset0:2 offset1:3
    ds_read_b128 v[136:139], v65 offset:0
    ds_read_b128 v[140:143], v65 offset:512
    ds_read_b128 v[144:147], v65 offset:1024
    ds_read_b128 v[148:151], v65 offset:1536
    ds_read_b128 v[152:155], v65 offset:2048
    ds_read_b128 v[156:159], v65 offset:2560
    v_subrev_u32 v64, 64, v64
    v_subrev_u32 v65, 64, v65
    s_waitcnt lgkmcnt(5)
    v_mfma_f32_16x16x32_bf16 v[104:107], v[68:71], v[136:139], v[104:107]
    s_waitcnt lgkmcnt(4)
    v_mfma_f32_16x16x32_bf16 v[108:111], v[68:71], v[140:143], v[108:111]
    s_waitcnt lgkmcnt(3)
    v_mfma_f32_16x16x32_bf16 v[112:115], v[68:71], v[144:147], v[112:115]
    s_waitcnt lgkmcnt(2)
    v_mfma_f32_16x16x32_bf16 v[116:119], v[68:71], v[148:151], v[116:119]
    s_waitcnt lgkmcnt(1)
    v_mfma_f32_16x16x32_bf16 v[120:123], v[68:71], v[152:155], v[120:123]
    s_waitcnt lgkmcnt(0)
    v_mfma_f32_16x16x32_bf16 v[124:127], v[68:71], v[156:159], v[124:127]
    s_sub_u32 s25, s25, 1
    s_cmp_lg_u32 s25, 0
    s_cbranch_scc1 ss_cv2
    v_add_u32 v65, 512, v65
    s_mov_b32 s25, 8
ss_cv3:
    ds_read2_b32 v[68:69], v64 offset0:0 offset1:1
    ds_read2_b32 v[70:71], v64 offset0:2 offset1:3
    ds_read_b128 v[140:143], v65 offset:0
    ds_read_b128 v[144:147], v65 offset:512
    ds_read_b128 v[148:151], v65 offset:1024
    ds_read_b128 v[152:155], v65 offset:1536
    ds_read_b128 v[156:159], v65 offset:2048
    v_subrev_u32 v64, 64, v64
    v_subrev_u32 v65, 64, v65
    s_waitcnt lgkmcnt(4)
    v_mfma_f32_16x16x32_bf16 v[108:111], v[68:71], v[140:143], v[108:111]
    s_waitcnt lgkmcnt(3)
    v_mfma_f32_16x16x32_bf16 v[112:115], v[68:71], v[144:147], v[112:115]
    s_waitcnt lgkmcnt(2)
    v_mfma_f32_16x16x32_bf16 v[116:119], v[68:71], v[148:151], v[116:119]
    s_waitcnt lgkmcnt(1)
    v_mfma_f32_16x16x32_bf16 v[120:123], v[68:71], v[152:155], v[120:123]
    s_waitcnt lgkmcnt(0)
    v_mfma_f32_16x16x32_bf16 v[124:127], v[68:71], v[156:159], v[124:127]
    s_sub_u32 s25, s25, 1
    s_cmp_lg_u32 s25, 0
    s_cbranch_scc1 ss_cv3
    v_add_u32 v65, 512, v65
    s_mov_b32 s25, 8
ss_cv4:
    ds_read2_b32 v[68:69], v64 offset0:0 offset1:1
    ds_read2_b32 v[70:71], v64 offset0:2 offset1:3
    ds_read_b128 v[144:147], v65 offset:0
    ds_read_b128 v[148:151], v65 offset:512
    ds_read_b128 v[152:155], v65 offset:1024
    ds_read_b128 v[156:159], v65 offset:1536
    v_subrev_u32 v64, 64, v64
    v_subrev_u32 v65, 64, v65
    s_waitcnt lgkmcnt(3)
    v_mfma_f32_16x16x32_bf16 v[112:115], v[68:71], v[144:147], v[112:115]
    s_waitcnt lgkmcnt(2)
    v_mfma_f32_16x16x32_bf16 v[116:119], v[68:71], v[148:151], v[116:119]
    s_waitcnt lgkmcnt(1)
    v_mfma_f32_16x16x32_bf16 v[120:123], v[68:71], v[152:155], v[120:123]
    s_waitcnt lgkmcnt(0)
    v_mfma_f32_16x16x32_bf16 v[124:127], v[68:71], v[156:159], v[124:127]
    s_sub_u32 s25, s25, 1
    s_cmp_lg_u32 s25, 0
    s_cbranch_scc1 ss_cv4
    v_add_u32 v65, 512, v65
    s_mov_b32 s25, 8
ss_cv5:
    ds_read2_b32 v[68:69], v64 offset0:0 offset1:1
    ds_read2_b32 v[70:71], v64 offset0:2 offset1:3
    ds_read_b128 v[148:151], v65 offset:0
    ds_read_b128 v[152:155], v65 offset:512
    ds_read_b128 v[156:159], v65 offset:1024
    v_subrev_u32 v64, 64, v64
    v_subrev_u32 v65, 64, v65
    s_waitcnt lgkmcnt(2)
    v_mfma_f32_16x16x32_bf16 v[116:119], v[68:71], v[148:151], v[116:119]
    s_waitcnt lgkmcnt(1)
    v_mfma_f32_16x16x32_bf16 v[120:123], v[68:71], v[152:155], v[120:123]
    s_waitcnt lgkmcnt(0)
    v_mfma_f32_16x16x32_bf16 v[124:127], v[68:71], v[156:159], v[124:127]
    s_sub_u32 s25, s25, 1
    s_cmp_lg_u32 s25, 0
    s_cbranch_scc1 ss_cv5
    v_add_u32 v65, 512, v65
    s_mov_b32 s25, 8
ss_cv6:
    ds_read2_b32 v[68:69], v64 offset0:0 offset1:1
    ds_read2_b32 v[70:71], v64 offset0:2 offset1:3
    ds_read_b128 v[152:155], v65 offset:0
    ds_read_b128 v[156:159], v65 offset:512
    v_subrev_u32 v64, 64, v64
    v_subrev_u32 v65, 64, v65
    s_waitcnt lgkmcnt(1)
    v_mfma_f32_16x16x32_bf16 v[120:123], v[68:71], v[152:155], v[120:123]
    s_waitcnt lgkmcnt(0)
    v_mfma_f32_16x16x32_bf16 v[124:127], v[68:71], v[156:159], v[124:127]
    s_sub_u32 s25, s25, 1
    s_cmp_lg_u32 s25, 0
    s_cbranch_scc1 ss_cv6
    v_add_u32 v65, 512, v65
    s_mov_b32 s25, 8
ss_cv7:
    ds_read2_b32 v[68:69], v64 offset0:0 offset1:1
    ds_read2_b32 v[70:71], v64 offset0:2 offset1:3
    ds_read_b128 v[156:159], v65 offset:0
    v_subrev_u32 v64, 64, v64
    v_subrev_u32 v65, 64, v65
    s_waitcnt lgkmcnt(0)
    v_mfma_f32_16x16x32_bf16 v[124:127], v[68:71], v[156:159], v[124:127]
    s_sub_u32 s25, s25, 1
    s_cmp_lg_u32 s25, 0
    s_cbranch_scc1 ss_cv7
    v_add_u32 v65, 512, v65
    s_nop 3
    v_lshlrev_b32 v5, 6, v2
    v_lshl_add_u32 v5, v3, 4, v5
    v_add_u32 v5, v5, v4
    ds_write_b128 v5, v[96:99] offset:7424
    ds_write_b128 v5, v[100:103] offset:8448
    ds_write_b128 v5, v[104:107] offset:9472
    ds_write_b128 v5, v[108:111] offset:10496
    ds_write_b128 v5, v[112:115] offset:11520
    ds_write_b128 v5, v[116:119] offset:12544
    ds_write_b128 v5, v[120:123] offset:13568
    ds_write_b128 v5, v[124:127] offset:14592
    s_mov_b32 s12, s74
    s_mov_b32 s13, s75
    s_mov_b32 s14, 1152
    s_mov_b32 s15, 0x20000
    s_lshl_b32 s23, s20, 1
    buffer_load_dwordx2 v[24:25], off, s[12:15], s23
    s_waitcnt vmcnt(0) lgkmcnt(0)
    s_barrier
    v_lshlrev_b32 v26, 16, v24
    v_and_b32 v27, 0xffff0000, v24
    v_lshlrev_b32 v28, 16, v25
    v_and_b32 v29, 0xffff0000, v25
    v_lshlrev_b32 v5, 5, v0
    ds_read_b128 v[64:67], v5 offset:7424
    ds_read_b128 v[68:71], v5 offset:7440
    ds_read_b128 v[72:75], v5 offset:23808
    ds_read_b128 v[76:79], v5 offset:23824
    ds_read_b128 v[80:83], v5 offset:40192
    ds_read_b128 v[84:87], v5 offset:40208
    ds_read_b128 v[88:91], v5 offset:56576
    ds_read_b128 v[92:95], v5 offset:56592
    s_waitcnt lgkmcnt(0)
    v_mul_u32_u24 v5, 18432, v0
    s_lshl_b32 s22, s20, 1
    s_add_u32 s22, s22, 1152
    v_lshlrev_b32 v6, 16, v8
    v_fmac_f32 v64, v6, v26
    v_and_b32 v6, 0xffff0000, v8
    v_fmac_f32 v72, v6, v27
    v_lshlrev_b32 v6, 16, v9
    v_fmac_f32 v80, v6, v28
    v_and_b32 v6, 0xffff0000, v9
    v_fmac_f32 v88, v6, v29
    v_cvt_pk_bf16_f32 v8, v64, v72
    v_cvt_pk_bf16_f32 v9, v80, v88
    s_add_u32 s23, s22, 0
    buffer_store_dwordx2 v[8:9], v5, s[16:19], s23 offen
    v_lshlrev_b32 v6, 16, v10
    v_fmac_f32 v65, v6, v26
    v_and_b32 v6, 0xffff0000, v10
    v_fmac_f32 v73, v6, v27
    v_lshlrev_b32 v6, 16, v11
    v_fmac_f32 v81, v6, v28
    v_and_b32 v6, 0xffff0000, v11
    v_fmac_f32 v89, v6, v29
    v_cvt_pk_bf16_f32 v10, v65, v73
    v_cvt_pk_bf16_f32 v11, v81, v89
    s_add_u32 s23, s22, 2304
    buffer_store_dwordx2 v[10:11], v5, s[16:19], s23 offen
    v_lshlrev_b32 v6, 16, v12
    v_fmac_f32 v66, v6, v26
    v_and_b32 v6, 0xffff0000, v12
    v_fmac_f32 v74, v6, v27
    v_lshlrev_b32 v6, 16, v13
    v_fmac_f32 v82, v6, v28
    v_and_b32 v6, 0xffff0000, v13
    v_fmac_f32 v90, v6, v29
    v_cvt_pk_bf16_f32 v12, v66, v74
    v_cvt_pk_bf16_f32 v13, v82, v90
    s_add_u32 s23, s22, 4608
    buffer_store_dwordx2 v[12:13], v5, s[16:19], s23 offen
    v_lshlrev_b32 v6, 16, v14
    v_fmac_f32 v67, v6, v26
    v_and_b32 v6, 0xffff0000, v14
    v_fmac_f32 v75, v6, v27
    v_lshlrev_b32 v6, 16, v15
    v_fmac_f32 v83, v6, v28
    v_and_b32 v6, 0xffff0000, v15
    v_fmac_f32 v91, v6, v29
    v_cvt_pk_bf16_f32 v14, v67, v75
    v_cvt_pk_bf16_f32 v15, v83, v91
    s_add_u32 s23, s22, 6912
    buffer_store_dwordx2 v[14:15], v5, s[16:19], s23 offen
    v_lshlrev_b32 v6, 16, v16
    v_fmac_f32 v68, v6, v26
    v_and_b32 v6, 0xffff0000, v16
    v_fmac_f32 v76, v6, v27
    v_lshlrev_b32 v6, 16, v17
    v_fmac_f32 v84, v6, v28
    v_and_b32 v6, 0xffff0000, v17
    v_fmac_f32 v92, v6, v29
    v_cvt_pk_bf16_f32 v16, v68, v76
    v_cvt_pk_bf16_f32 v17, v84, v92
    s_add_u32 s23, s22, 9216
    buffer_store_dwordx2 v[16:17], v5, s[16:19], s23 offen
    v_lshlrev_b32 v6, 16, v18
    v_fmac_f32 v69, v6, v26
    v_and_b32 v6, 0xffff0000, v18
    v_fmac_f32 v77, v6, v27
    v_lshlrev_b32 v6, 16, v19
    v_fmac_f32 v85, v6, v28
    v_and_b32 v6, 0xffff0000, v19
    v_fmac_f32 v93, v6, v29
    v_cvt_pk_bf16_f32 v18, v69, v77
    v_cvt_pk_bf16_f32 v19, v85, v93
    s_add_u32 s23, s22, 11520
    buffer_store_dwordx2 v[18:19], v5, s[16:19], s23 offen
    v_lshlrev_b32 v6, 16, v20
    v_fmac_f32 v70, v6, v26
    v_and_b32 v6, 0xffff0000, v20
    v_fmac_f32 v78, v6, v27
    v_lshlrev_b32 v6, 16, v21
    v_fmac_f32 v86, v6, v28
    v_and_b32 v6, 0xffff0000, v21
    v_fmac_f32 v94, v6, v29
    v_cvt_pk_bf16_f32 v20, v70, v78
    v_cvt_pk_bf16_f32 v21, v86, v94
    s_add_u32 s23, s22, 13824
    buffer_store_dwordx2 v[20:21], v5, s[16:19], s23 offen
    v_lshlrev_b32 v6, 16, v22
    v_fmac_f32 v71, v6, v26
    v_and_b32 v6, 0xffff0000, v22
    v_fmac_f32 v79, v6, v27
    v_lshlrev_b32 v6, 16, v23
    v_fmac_f32 v87, v6, v28
    v_and_b32 v6, 0xffff0000, v23
    v_fmac_f32 v95, v6, v29
    v_cvt_pk_bf16_f32 v22, v71, v79
    v_cvt_pk_bf16_f32 v23, v87, v95
    s_add_u32 s23, s22, 16128
    buffer_store_dwordx2 v[22:23], v5, s[16:19], s23 offen
    s_branch L_ssm_next
L_phase2:
    v_and_b32 v1, 63, v0
    v_min_u32 v1, 6, v1
    v_lshlrev_b32 v2, 2, v1
    s_cmp_lg_u32 s32, 0
    v_mov_b32 v251, 163832
    s_cbranch_scc1 sw9
    buffer_load_dword v3, v2, s[96:99], 0 offen offset:32 sc1
    v_mov_b32 v4, 32
    s_waitcnt vmcnt(0)
    v_cmp_lt_u32 vcc, v3, v4
    s_nop 0
    s_ff1_i32_b64 s40, vcc
    v_mov_b32 v250, s40
    ds_write_b32 v251, v250
    s_waitcnt lgkmcnt(0)
sw9:
    s_barrier
    ds_read_b32 v252, v251
    s_waitcnt lgkmcnt(0)
    v_readfirstlane_b32 s33, v252
    s_barrier
    s_nop 1
    s_cmp_lt_u32 s33, 7
    s_cbranch_scc1 L_pool
    s_mov_b32 s88, 4194304
gn10:
    s_cmp_lg_u32 s95, 0
    s_cbranch_scc1 gn10x
    buffer_load_dword v250, off, s[96:99], 0 offset:64 sc1
    s_sub_u32 s88, s88, 1
    s_cbranch_scc1 gn10x
    s_waitcnt vmcnt(0)
    v_readfirstlane_b32 s95, v250
    s_nop 1
    s_branch gn10
gn10x:
    s_mov_b32 s40, 524288
mc2_w:
    buffer_load_dword v250, off, s[96:99], 0 offset:140 sc1
    s_waitcnt vmcnt(0)
    v_readfirstlane_b32 s41, v250
    s_nop 0
    s_cmp_lg_u32 s41, 0
    s_cbranch_scc1 mc2_known
    s_sub_u32 s40, s40, 1
    s_cbranch_scc1 mc2_force
    s_sleep 2
    s_branch mc2_w
mc2_force:
    v_mov_b32 v250, 2
    v_mov_b32 v251, 0
    s_mov_b64 exec, 1
    buffer_atomic_cmpswap v[250:251], off, s[96:99], 0 offset:140
    s_mov_b64 exec, -1
    s_waitcnt vmcnt(0)
    s_mov_b32 s40, 524288
    s_branch mc2_w
mc2_known:
    s_cmp_eq_u32 s41, 1
    s_cbranch_scc1 L_phase2b
    s_mov_b32 s37, 208
    v_mov_b32 v250, 1
    v_mov_b32 v251, 163832
    v_cmp_eq_u32 vcc, 0, v0
    s_nop 0
    s_and_saveexec_b64 s[38:39], vcc
    s_cbranch_execz tk11
    buffer_atomic_add v250, off, s[96:99], s37 sc0
    s_waitcnt vmcnt(0)
    ds_write_b32 v251, v250
    s_waitcnt lgkmcnt(0)
tk11:
    s_mov_b64 exec, -1
    s_barrier
    ds_read_b32 v252, v251
    s_waitcnt lgkmcnt(0)
    v_readfirstlane_b32 s12, v252
    s_barrier
    s_nop 3
    s_cmp_lt_u32 s12, 32
    s_cbranch_scc1 L_chain_safe
L_phase2b:
    s_mov_b32 s8, s76
    s_mov_b32 s9, s77
    s_mov_b32 s10, 4718592
    s_mov_b32 s11, 0x20000
    s_sub_u32 s33, s3, 1
    s_and_b32 s33, s33, 7
    s_cmp_eq_u32 s33, 7
    s_cbranch_scc1 L_p2scan
L_p2take:
    s_lshl_b32 s35, s33, 2
    s_add_u32 s35, s35, 160
    s_mov_b32 s37, s35
    v_mov_b32 v250, 1
    v_mov_b32 v251, 163832
    v_cmp_eq_u32 vcc, 0, v0
    s_nop 0
    s_and_saveexec_b64 s[38:39], vcc
    s_cbranch_execz tk12
    buffer_atomic_add v250, off, s[96:99], s37 sc0
    s_waitcnt vmcnt(0)
    ds_write_b32 v251, v250
    s_waitcnt lgkmcnt(0)
tk12:
    s_mov_b64 exec, -1
    s_barrier
    ds_read_b32 v252, v251
    s_waitcnt lgkmcnt(0)
    v_readfirstlane_b32 s34, v252
    s_barrier
    s_nop 3
    s_cmp_lt_u32 s33, 4
    s_cselect_b32 s36, 4, 6
    s_cmp_lt_u32 s34, s36
    s_cbranch_scc1 L_att0
    s_sub_u32 s34, s34, s36
    s_cmp_lt_u32 s34, 18
    s_cbranch_scc1 L_op_start
L_p2scan:
    v_and_b32 v1, 63, v0
    v_min_u32 v1, 6, v1
    v_lshlrev_b32 v2, 2, v1
    s_cmp_lg_u32 s32, 0
    v_mov_b32 v251, 163832
    s_cbranch_scc1 sw13
    buffer_load_dword v3, v2, s[96:99], 0 offen offset:160 sc1
    v_mov_b32 v4, 24
    v_cmp_gt_u32 vcc, 4, v1
    s_nop 1
    v_cndmask_b32 v4, v4, 22, vcc
    s_waitcnt vmcnt(0)
    v_cmp_lt_u32 vcc, v3, v4
    s_nop 0
    s_ff1_i32_b64 s40, vcc
    v_mov_b32 v250, s40
    ds_write_b32 v251, v250
    s_waitcnt lgkmcnt(0)
sw13:
    s_barrier
    ds_read_b32 v252, v251
    s_waitcnt lgkmcnt(0)
    v_readfirstlane_b32 s33, v252
    s_barrier
    s_nop 1
    s_cmp_lt_u32 s33, 7
    s_cbranch_scc1 L_p2take
    s_branch L_done
L_att0:
    s_mul_i32 s36, s34, 7
    s_mul_i32 s37, s34, 3
    s_add_u32 s37, s37, 12
    s_cmp_lt_u32 s34, 4
    s_cselect_b32 s34, s36, s37
    s_add_u32 s34, s34, s33
    s_cmp_ge_u32 s34, 32
    s_cbranch_scc1 L_done
L_att_next:
    s_lshr_b32 s16, s34, 3
    s_and_b32 s17, s34, 7
    s_lshl_b32 s17, s17, 2
    s_add_u32 s17, s17, s32
    s_lshr_b32 s36, s17, 1
    s_lshl_b32 s36, s36, 8
    s_add_u32 s36, s36, 125829120
    s_mul_i32 s37, s16, 43
    s_lshr_b32 s37, s37, 8
    s_mul_i32 s41, s37, 6
    s_sub_u32 s41, s16, s41
    v_and_b32 v1, 63, v0
    v_mul_u32_u24 v2, 6, v1
    v_add_u32 v2, s41, v2
    v_mov_b32 v4, s37
    s_and_b32 s41, s16, 7
    s_add_u32 s41, s41, 12
    s_lshr_b32 s37, s16, 3
    v_mov_b32 v5, s41
    v_mov_b32 v6, s37
    v_cmp_lt_u32 vcc, 1, v1
    s_nop 1
    v_cndmask_b32 v2, v2, v5, vcc
    v_cndmask_b32 v4, v4, v6, vcc
    v_lshlrev_b32 v2, 2, v2
    v_add3_u32 v4, v4, s95, 1
    s_mov_b32 s40, 4194304
L_aw1:
    buffer_load_dword v3, v2, s[4:7], s36 offen sc1
    s_sub_u32 s40, s40, 1
    s_cbranch_scc1 L_aw1_go
    s_waitcnt vmcnt(0)
    v_subrev_u32 v3, v4, v3
    v_cmp_lt_u32 vcc, 64, v3
    s_cbranch_vccz L_aw1_go
    s_sleep 4
    s_branch L_aw1
L_aw1_go:
    v_and_b32 v5, 63, v0
    v_lshlrev_b32 v1, 4, v5
    v_or_b32 v3, 128, v1
    v_lshrrev_b32 v4, 4, v5
    v_bfe_u32 v6, v5, 2, 2
    v_sub_u32 v4, v6, v4
    v_lshlrev_b32 v4, 3, v4
    v_and_b32 v6, 3, v5
    v_add_u32 v4, v4, v6
    v_mov_b32 v6, 0xf149f2ca
    s_mov_b32 s22, 0x3e0293ee
    s_lshl_b32 s18, s16, 5
    s_add_u32 s18, s18, s17
    s_lshl_b32 s19, s18, 13
    s_add_u32 s20, s19, 33554432
    buffer_load_dwordx4 v[8:11], v1, s[4:7], s20 offen offset:0 sc1
    s_add_u32 s20, s19, 33554432
    buffer_load_dwordx4 v[12:15], v1, s[4:7], s20 offen offset:1024 sc1
    s_add_u32 s20, s19, 33554432
    buffer_load_dwordx4 v[16:19], v1, s[4:7], s20 offen offset:2048 sc1
    s_add_u32 s20, s19, 33554432
    buffer_load_dwordx4 v[20:23], v1, s[4:7], s20 offen offset:3072 sc1
    s_add_u32 s20, s19, 33558528
    buffer_load_dwordx4 v[24:27], v1, s[4:7], s20 offen offset:0 sc1
    s_add_u32 s20, s19, 33558528
    buffer_load_dwordx4 v[28:31], v1, s[4:7], s20 offen offset:1024 sc1
    s_add_u32 s20, s19, 33558528
    buffer_load_dwordx4 v[32:35], v1, s[4:7], s20 offen offset:2048 sc1
    s_add_u32 s20, s19, 33558528
    buffer_load_dwordx4 v[36:39], v1, s[4:7], s20 offen offset:3072 sc1
    s_lshl_b32 s21, s18, 14
    s_add_u32 s20, s21, 0
    buffer_load_dwordx4 v[40:43], v1, s[4:7], s20 offen offset:0 sc1
    s_add_u32 s20, s21, 4096
    buffer_load_dwordx4 v[44:47], v1, s[4:7], s20 offen offset:0 sc1
    s_add_u32 s20, s21, 8192
    buffer_load_dwordx4 v[48:51], v1, s[4:7], s20 offen offset:0 sc1
    s_add_u32 s20, s21, 12288
    buffer_load_dwordx4 v[52:55], v1, s[4:7], s20 offen offset:0 sc1
    s_add_u32 s20, s21, 0
    buffer_load_dwordx4 v[56:59], v1, s[4:7], s20 offen offset:1024 sc1
    s_add_u32 s20, s21, 4096
    buffer_load_dwordx4 v[60:63], v1, s[4:7], s20 offen offset:1024 sc1
    s_add_u32 s20, s21, 8192
    buffer_load_dwordx4 v[64:67], v1, s[4:7], s20 offen offset:1024 sc1
    s_add_u32 s20, s21, 12288
    buffer_load_dwordx4 v[68:71], v1, s[4:7], s20 offen offset:1024 sc1
    s_add_u32 s20, s21, 0
    buffer_load_dwordx4 v[88:91], v1, s[4:7], s20 offen offset:2048 sc1
    s_add_u32 s20, s21, 4096
    buffer_load_dwordx4 v[92:95], v1, s[4:7], s20 offen offset:2048 sc1
    s_add_u32 s20, s21, 8192
    buffer_load_dwordx4 v[96:99], v1, s[4:7], s20 offen offset:2048 sc1
    s_add_u32 s20, s21, 12288
    buffer_load_dwordx4 v[100:103], v1, s[4:7], s20 offen offset:2048 sc1
    s_add_u32 s20, s21, 0
    buffer_load_dwordx4 v[104:107], v1, s[4:7], s20 offen offset:3072 sc1
    s_add_u32 s20, s21, 4096
    buffer_load_dwordx4 v[108:111], v1, s[4:7], s20 offen offset:3072 sc1
    s_add_u32 s20, s21, 8192
    buffer_load_dwordx4 v[112:115], v1, s[4:7], s20 offen offset:3072 sc1
    s_add_u32 s20, s21, 12288
    buffer_load_dwordx4 v[116:119], v1, s[4:7], s20 offen offset:3072 sc1
    v_mov_b32 v172, 0x3f803f80
    v_mov_b32 v173, 0x3f803f80
    v_mov_b32 v174, 0x3f803f80
    v_mov_b32 v175, 0x3f803f80
    v_mov_b32 v176, 0x3f003f00
    v_mov_b32 v177, 0x3f003f00
    s_waitcnt vmcnt(8)
    v_mfma_f32_16x16x32_bf16 v[136:139], v[40:43], v[8:11], 0
    v_mfma_f32_16x16x32_bf16 v[140:143], v[56:59], v[8:11], 0
    v_mfma_f32_16x16x32_bf16 v[148:151], v[40:43], v[24:27], 0
    v_mfma_f32_16x16x32_bf16 v[152:155], v[56:59], v[24:27], 0
    v_mfma_f32_16x16x32_bf16 v[136:139], v[44:47], v[12:15], v[136:139]
    v_mfma_f32_16x16x32_bf16 v[140:143], v[60:63], v[12:15], v[140:143]
    v_mfma_f32_16x16x32_bf16 v[148:151], v[44:47], v[28:31], v[148:151]
    v_mfma_f32_16x16x32_bf16 v[152:155], v[60:63], v[28:31], v[152:155]
    v_mfma_f32_16x16x32_bf16 v[136:139], v[48:51], v[16:19], v[136:139]
    v_mfma_f32_16x16x32_bf16 v[140:143], v[64:67], v[16:19], v[140:143]
    v_mfma_f32_16x16x32_bf16 v[148:151], v[48:51], v[32:35], v[148:151]
    v_mfma_f32_16x16x32_bf16 v[152:155], v[64:67], v[32:35], v[152:155]
    v_mfma_f32_16x16x32_bf16 v[136:139], v[52:55], v[20:23], v[136:139]
    v_mfma_f32_16x16x32_bf16 v[140:143], v[68:71], v[20:23], v[140:143]
    v_mfma_f32_16x16x32_bf16 v[148:151], v[52:55], v[36:39], v[148:151]
    v_mfma_f32_16x16x32_bf16 v[152:155], v[68:71], v[36:39], v[152:155]
    v_cmp_le_i32 vcc, 0, v4
    s_nop 1
    v_cndmask_b32 v136, v6, v136, vcc
    v_cmp_le_i32 vcc, 1, v4
    s_nop 1
    v_cndmask_b32 v137, v6, v137, vcc
    v_cmp_le_i32 vcc, 2, v4
    s_nop 1
    v_cndmask_b32 v138, v6, v138, vcc
    v_cmp_le_i32 vcc, 3, v4
    s_nop 1
    v_cndmask_b32 v139, v6, v139, vcc
    v_cmp_le_i32 vcc, 4, v4
    s_nop 1
    v_cndmask_b32 v140, v6, v140, vcc
    v_cmp_le_i32 vcc, 5, v4
    s_nop 1
    v_cndmask_b32 v141, v6, v141, vcc
    v_cmp_le_i32 vcc, 6, v4
    s_nop 1
    v_cndmask_b32 v142, v6, v142, vcc
    v_cmp_le_i32 vcc, 7, v4
    s_nop 1
    v_cndmask_b32 v143, v6, v143, vcc
    v_cmp_le_i32 vcc, -4, v4
    s_nop 1
    v_cndmask_b32 v148, v6, v148, vcc
    v_cmp_le_i32 vcc, -3, v4
    s_nop 1
    v_cndmask_b32 v149, v6, v149, vcc
    v_cmp_le_i32 vcc, -2, v4
    s_nop 1
    v_cndmask_b32 v150, v6, v150, vcc
    v_cmp_le_i32 vcc, -1, v4
    s_nop 1
    v_cndmask_b32 v151, v6, v151, vcc
    v_cmp_le_i32 vcc, 0, v4
    s_nop 1
    v_cndmask_b32 v152, v6, v152, vcc
    v_cmp_le_i32 vcc, 1, v4
    s_nop 1
    v_cndmask_b32 v153, v6, v153, vcc
    v_cmp_le_i32 vcc, 2, v4
    s_nop 1
    v_cndmask_b32 v154, v6, v154, vcc
    v_cmp_le_i32 vcc, 3, v4
    s_nop 1
    v_cndmask_b32 v155, v6, v155, vcc
    s_nop 1
    s_mov_b32 s88, 65536
cw14:
    buffer_load_dword v199, off, s[4:7], s36 offset:128 sc1
    s_waitcnt vmcnt(0)
    v_readfirstlane_b32 s42, v199
    s_nop 0
    s_sub_u32 s42, s42, s95
    s_cmp_gt_u32 s42, 64
    s_cselect_b32 s42, 0, s42
    s_add_u32 s42, s42, 2
    s_cmp_ge_u32 s42, s16
    s_cbranch_scc1 cw14x
    s_sub_u32 s88, s88, 1
    s_cbranch_scc1 cw14x
    s_sub_u32 s42, s16, s42
    s_min_u32 s42, s42, 6
cw14s:
    s_sleep 24
    s_sub_u32 s42, s42, 1
    s_cmp_lg_u32 s42, 0
    s_cbranch_scc1 cw14s
    s_branch cw14
cw14x:
    s_and_b32 s37, s16, 1
    s_lshl_b32 s37, s37, 2
    s_add_u32 s37, s37, s36
    s_add_u32 s37, s37, 128
    s_add_u32 s41, s16, s95
    s_add_u32 s41, s41, 1
    s_lshl_b32 s42, s17, 7
    s_add_u32 s42, s42, 125845504
    s_cmp_ge_u32 s16, 62
    s_cselect_b32 s37, s42, s37
    s_cselect_b32 s42, 12, 8
    v_lshlrev_b32 v198, 2, v0
    v_and_b32 v198, s42, v198
    s_mov_b32 s40, 4194304
L_aw2:
    buffer_load_dword v199, v198, s[4:7], s37 offen sc1
    s_sub_u32 s40, s40, 1
    s_cbranch_scc1 L_aw2_go
    s_waitcnt vmcnt(0)
    v_subrev_u32 v199, s41, v199
    v_cmp_lt_u32 vcc, 64, v199
    s_cbranch_vccz L_aw2_go
    s_sleep 3
    s_branch L_aw2
L_aw2_go:
    s_lshl_b32 s20, s18, 12
    s_add_u32 s20, s20, 71303168
    buffer_load_dwordx4 v[72:75], v3, s[4:7], s20 offen offset:0 sc1
    buffer_load_dwordx4 v[76:79], v3, s[4:7], s20 offen offset:1024 sc1
    buffer_load_dwordx4 v[80:83], v3, s[4:7], s20 offen offset:2048 sc1
    buffer_load_dwordx4 v[84:87], v3, s[4:7], s20 offen offset:3072 sc1
    s_lshl_b32 s20, s18, 12
    s_add_u32 s20, s20, 80740352
    buffer_load_dwordx4 v[120:123], v1, s[4:7], s20 offen offset:0 sc1
    buffer_load_dwordx4 v[124:127], v1, s[4:7], s20 offen offset:1024 sc1
    buffer_load_dwordx4 v[128:131], v1, s[4:7], s20 offen offset:2048 sc1
    buffer_load_dwordx4 v[132:135], v1, s[4:7], s20 offen offset:3072 sc1
    s_waitcnt vmcnt(4)
    v_mfma_f32_16x16x32_bf16 v[144:147], v[72:75], v[8:11], 0
    v_mfma_f32_16x16x32_bf16 v[156:159], v[72:75], v[24:27], 0
    v_mfma_f32_16x16x32_bf16 v[144:147], v[76:79], v[12:15], v[144:147]
    v_mfma_f32_16x16x32_bf16 v[156:159], v[76:79], v[28:31], v[156:159]
    v_mfma_f32_16x16x32_bf16 v[144:147], v[80:83], v[16:19], v[144:147]
    v_mfma_f32_16x16x32_bf16 v[156:159], v[80:83], v[32:35], v[156:159]
    v_mfma_f32_16x16x32_bf16 v[144:147], v[84:87], v[20:23], v[144:147]
    v_mfma_f32_16x16x32_bf16 v[156:159], v[84:87], v[36:39], v[156:159]
    v_max3_f32 v196, v136, v137, v138
    v_max3_f32 v197, v139, v140, v141
    v_max3_f32 v196, v196, v142, v143
    v_max3_f32 v197, v197, v144, v145
    v_max3_f32 v196, v196, v146, v147
    v_max_f32 v196, v196, v197
    v_mov_b32 v197, v196
    s_nop 1
    v_permlane32_swap_b32 v196, v197
    v_max_f32 v196, v196, v197
    v_mov_b32 v197, v196
    s_nop 1
    v_permlane16_swap_b32 v196, v197
    v_max_f32 v196, v196, v197
    v_mul_f32 v196, s22, v196
    v_sub_f32 v196, 0, v196
    v_fma_f32 v136, v136, s22, v196
    v_fma_f32 v137, v137, s22, v196
    v_fma_f32 v138, v138, s22, v196
    v_fma_f32 v139, v139, s22, v196
    v_fma_f32 v140, v140, s22, v196
    v_fma_f32 v141, v141, s22, v196
    v_fma_f32 v142, v142, s22, v196
    v_fma_f32 v143, v143, s22, v196
    v_fma_f32 v144, v144, s22, v196
    v_fma_f32 v145, v145, s22, v196
    v_fma_f32 v146, v146, s22, v196
    v_fma_f32 v147, v147, s22, v196
    v_exp_f32 v136, v136
    v_exp_f32 v137, v137
    v_exp_f32 v138, v138
    v_exp_f32 v139, v139
    v_exp_f32 v140, v140
    v_exp_f32 v141, v141
    v_exp_f32 v142, v142
    v_exp_f32 v143, v143
    v_exp_f32 v144, v144
    v_exp_f32 v145, v145
    v_exp_f32 v146, v146
    v_exp_f32 v147, v147
    v_cvt_pk_bf16_f32 v160, v136, v137
    v_cvt_pk_bf16_f32 v161, v138, v139
    v_cvt_pk_bf16_f32 v162, v140, v141
    v_cvt_pk_bf16_f32 v163, v142, v143
    v_cvt_pk_bf16_f32 v164, v144, v145
    v_cvt_pk_bf16_f32 v165, v146, v147
    v_max3_f32 v196, v148, v149, v150
    v_max3_f32 v197, v151, v152, v153
    v_max3_f32 v196, v196, v154, v155
    v_max3_f32 v197, v197, v156, v157
    v_max3_f32 v196, v196, v158, v159
    v_max_f32 v196, v196, v197
    v_mov_b32 v197, v196
    s_nop 1
    v_permlane32_swap_b32 v196, v197
    v_max_f32 v196, v196, v197
    v_mov_b32 v197, v196
    s_nop 1
    v_permlane16_swap_b32 v196, v197
    v_max_f32 v196, v196, v197
    v_mul_f32 v196, s22, v196
    v_sub_f32 v196, 0, v196
    v_fma_f32 v148, v148, s22, v196
    v_fma_f32 v149, v149, s22, v196
    v_fma_f32 v150, v150, s22, v196
    v_fma_f32 v151, v151, s22, v196
    v_fma_f32 v152, v152, s22, v196
    v_fma_f32 v153, v153, s22, v196
    v_fma_f32 v154, v154, s22, v196
    v_fma_f32 v155, v155, s22, v196
    v_fma_f32 v156, v156, s22, v196
    v_fma_f32 v157, v157, s22, v196
    v_fma_f32 v158, v158, s22, v196
    v_fma_f32 v159, v159, s22, v196
    v_exp_f32 v148, v148
    v_exp_f32 v149, v149
    v_exp_f32 v150, v150
    v_exp_f32 v151, v151
    v_exp_f32 v152, v152
    v_exp_f32 v153, v153
    v_exp_f32 v154, v154
    v_exp_f32 v155, v155
    v_exp_f32 v156, v156
    v_exp_f32 v157, v157
    v_exp_f32 v158, v158
    v_exp_f32 v159, v159
    v_cvt_pk_bf16_f32 v166, v148, v149
    v_cvt_pk_bf16_f32 v167, v150, v151
    v_cvt_pk_bf16_f32 v168, v152, v153
    v_cvt_pk_bf16_f32 v169, v154, v155
    v_cvt_pk_bf16_f32 v170, v156, v157
    v_cvt_pk_bf16_f32 v171, v158, v159
    v_mfma_f32_16x16x32_bf16 v[180:183], v[172:175], v[160:163], 0
    v_mfma_f32_16x16x32_bf16 v[184:187], v[172:175], v[166:169], 0
    v_mfma_f32_16x16x16_bf16 v[180:183], v[176:177], v[164:165], v[180:183]
    v_mfma_f32_16x16x16_bf16 v[184:187], v[176:177], v[170:171], v[184:187]
    s_nop 3
    v_rcp_f32 v180, v180
    s_nop 2
    v_rcp_f32 v184, v184
    s_waitcnt vmcnt(0)
    s_lshl_b32 s18, s16, 18
    s_lshl_b32 s19, s17, 12
    s_add_u32 s18, s18, s19
    s_add_u32 s18, s18, 50331648
    s_add_u32 s19, s18, 131072
    v_mfma_f32_16x16x32_bf16 v[8:11], v[88:91], v[160:163], 0
    v_mfma_f32_16x16x32_bf16 v[12:15], v[104:107], v[160:163], 0
    v_mfma_f32_16x16x32_bf16 v[16:19], v[88:91], v[166:169], 0
    v_mfma_f32_16x16x32_bf16 v[20:23], v[104:107], v[166:169], 0
    v_mfma_f32_16x16x32_bf16 v[24:27], v[92:95], v[160:163], 0
    v_mfma_f32_16x16x32_bf16 v[28:31], v[108:111], v[160:163], 0
    v_mfma_f32_16x16x32_bf16 v[32:35], v[92:95], v[166:169], 0
    v_mfma_f32_16x16x32_bf16 v[36:39], v[108:111], v[166:169], 0
    v_mfma_f32_16x16x32_bf16 v[40:43], v[96:99], v[160:163], 0
    v_mfma_f32_16x16x32_bf16 v[44:47], v[112:115], v[160:163], 0
    v_mfma_f32_16x16x32_bf16 v[48:51], v[96:99], v[166:169], 0
    v_mfma_f32_16x16x32_bf16 v[52:55], v[112:115], v[166:169], 0
    v_mfma_f32_16x16x32_bf16 v[56:59], v[100:103], v[160:163], 0
    v_mfma_f32_16x16x32_bf16 v[60:63], v[116:119], v[160:163], 0
    v_mfma_f32_16x16x32_bf16 v[64:67], v[100:103], v[166:169], 0
    v_mfma_f32_16x16x32_bf16 v[68:71], v[116:119], v[166:169], 0
    v_mfma_f32_16x16x16_bf16 v[8:11], v[120:121], v[164:165], v[8:11]
    v_mfma_f32_16x16x16_bf16 v[12:15], v[122:123], v[164:165], v[12:15]
    v_mfma_f32_16x16x16_bf16 v[16:19], v[120:121], v[170:171], v[16:19]
    v_mfma_f32_16x16x16_bf16 v[20:23], v[122:123], v[170:171], v[20:23]
    v_mfma_f32_16x16x16_bf16 v[24:27], v[124:125], v[164:165], v[24:27]
    v_mfma_f32_16x16x16_bf16 v[28:31], v[126:127], v[164:165], v[28:31]
    v_mfma_f32_16x16x16_bf16 v[32:35], v[124:125], v[170:171], v[32:35]
    v_mfma_f32_16x16x16_bf16 v[36:39], v[126:127], v[170:171], v[36:39]
    v_mfma_f32_16x16x16_bf16 v[40:43], v[128:129], v[164:165], v[40:43]
    v_mfma_f32_16x16x16_bf16 v[44:47], v[130:131], v[164:165], v[44:47]
    v_mfma_f32_16x16x16_bf16 v[48:51], v[128:129], v[170:171], v[48:51]
    v_mfma_f32_16x16x16_bf16 v[52:55], v[130:131], v[170:171], v[52:55]
    v_mfma_f32_16x16x16_bf16 v[56:59], v[132:133], v[164:165], v[56:59]
    v_mfma_f32_16x16x16_bf16 v[60:63], v[134:135], v[164:165], v[60:63]
    v_mfma_f32_16x16x16_bf16 v[64:67], v[132:133], v[170:171], v[64:67]
    v_mfma_f32_16x16x16_bf16 v[68:71], v[134:135], v[170:171], v[68:71]
    v_mul_f32 v8, v8, v180
    v_mul_f32 v12, v12, v180
    v_mul_f32 v9, v9, v180
    v_mul_f32 v13, v13, v180
    v_mul_f32 v10, v10, v180
    v_mul_f32 v14, v14, v180
    v_mul_f32 v11, v11, v180
    v_mul_f32 v15, v15, v180
    v_cvt_pk_bf16_f32 v8, v8, v9
    v_cvt_pk_bf16_f32 v9, v10, v11
    v_cvt_pk_bf16_f32 v10, v12, v13
    v_cvt_pk_bf16_f32 v11, v14, v15
    buffer_store_dwordx4 v[8:11], v1, s[4:7], s18 offen offset:0 sc1
    v_mul_f32 v16, v16, v184
    v_mul_f32 v20, v20, v184
    v_mul_f32 v17, v17, v184
    v_mul_f32 v21, v21, v184
    v_mul_f32 v18, v18, v184
    v_mul_f32 v22, v22, v184
    v_mul_f32 v19, v19, v184
    v_mul_f32 v23, v23, v184
    v_cvt_pk_bf16_f32 v16, v16, v17
    v_cvt_pk_bf16_f32 v17, v18, v19
    v_cvt_pk_bf16_f32 v18, v20, v21
    v_cvt_pk_bf16_f32 v19, v22, v23
    buffer_store_dwordx4 v[16:19], v1, s[4:7], s19 offen offset:0 sc1
    v_mul_f32 v24, v24, v180
    v_mul_f32 v28, v28, v180
    v_mul_f32 v25, v25, v180
    v_mul_f32 v29, v29, v180
    v_mul_f32 v26, v26, v180
    v_mul_f32 v30, v30, v180
    v_mul_f32 v27, v27, v180
    v_mul_f32 v31, v31, v180
    v_cvt_pk_bf16_f32 v24, v24, v25
    v_cvt_pk_bf16_f32 v25, v26, v27
    v_cvt_pk_bf16_f32 v26, v28, v29
    v_cvt_pk_bf16_f32 v27, v30, v31
    buffer_store_dwordx4 v[24:27], v1, s[4:7], s18 offen offset:1024 sc1
    v_mul_f32 v32, v32, v184
    v_mul_f32 v36, v36, v184
    v_mul_f32 v33, v33, v184
    v_mul_f32 v37, v37, v184
    v_mul_f32 v34, v34, v184
    v_mul_f32 v38, v38, v184
    v_mul_f32 v35, v35, v184
    v_mul_f32 v39, v39, v184
    v_cvt_pk_bf16_f32 v32, v32, v33
    v_cvt_pk_bf16_f32 v33, v34, v35
    v_cvt_pk_bf16_f32 v34, v36, v37
    v_cvt_pk_bf16_f32 v35, v38, v39
    buffer_store_dwordx4 v[32:35], v1, s[4:7], s19 offen offset:1024 sc1
    v_mul_f32 v40, v40, v180
    v_mul_f32 v44, v44, v180
    v_mul_f32 v41, v41, v180
    v_mul_f32 v45, v45, v180
    v_mul_f32 v42, v42, v180
    v_mul_f32 v46, v46, v180
    v_mul_f32 v43, v43, v180
    v_mul_f32 v47, v47, v180
    v_cvt_pk_bf16_f32 v40, v40, v41
    v_cvt_pk_bf16_f32 v41, v42, v43
    v_cvt_pk_bf16_f32 v42, v44, v45
    v_cvt_pk_bf16_f32 v43, v46, v47
    buffer_store_dwordx4 v[40:43], v1, s[4:7], s18 offen offset:2048 sc1
    v_mul_f32 v48, v48, v184
    v_mul_f32 v52, v52, v184
    v_mul_f32 v49, v49, v184
    v_mul_f32 v53, v53, v184
    v_mul_f32 v50, v50, v184
    v_mul_f32 v54, v54, v184
    v_mul_f32 v51, v51, v184
    v_mul_f32 v55, v55, v184
    v_cvt_pk_bf16_f32 v48, v48, v49
    v_cvt_pk_bf16_f32 v49, v50, v51
    v_cvt_pk_bf16_f32 v50, v52, v53
    v_cvt_pk_bf16_f32 v51, v54, v55
    buffer_store_dwordx4 v[48:51], v1, s[4:7], s19 offen offset:2048 sc1
    v_mul_f32 v56, v56, v180
    v_mul_f32 v60, v60, v180
    v_mul_f32 v57, v57, v180
    v_mul_f32 v61, v61, v180
    v_mul_f32 v58, v58, v180
    v_mul_f32 v62, v62, v180
    v_mul_f32 v59, v59, v180
    v_mul_f32 v63, v63, v180
    v_cvt_pk_bf16_f32 v56, v56, v57
    v_cvt_pk_bf16_f32 v57, v58, v59
    v_cvt_pk_bf16_f32 v58, v60, v61
    v_cvt_pk_bf16_f32 v59, v62, v63
    buffer_store_dwordx4 v[56:59], v1, s[4:7], s18 offen offset:3072 sc1
    v_mul_f32 v64, v64, v184
    v_mul_f32 v68, v68, v184
    v_mul_f32 v65, v65, v184
    v_mul_f32 v69, v69, v184
    v_mul_f32 v66, v66, v184
    v_mul_f32 v70, v70, v184
    v_mul_f32 v67, v67, v184
    v_mul_f32 v71, v71, v184
    v_cvt_pk_bf16_f32 v64, v64, v65
    v_cvt_pk_bf16_f32 v65, v66, v67
    v_cvt_pk_bf16_f32 v66, v68, v69
    v_cvt_pk_bf16_f32 v67, v70, v71
    buffer_store_dwordx4 v[64:67], v1, s[4:7], s19 offen offset:3072 sc1
    s_lshr_b32 s40, s34, 1
    s_lshl_b32 s40, s40, 7
    s_and_b32 s41, s17, 7
    s_lshl_b32 s41, s41, 2
    s_add_u32 s40, s40, s41
    s_add_u32 s40, s40, 125894656
    v_mov_b32 v250, s95
    s_waitcnt vmcnt(0)
    s_mov_b64 exec, 1
    buffer_store_dword v250, off, s[4:7], s40 sc1
    s_mov_b64 exec, -1
    s_add_u32 s34, s34, 32
    s_cmp_lt_u32 s34, 512
    s_cbranch_scc1 L_att_next
    s_branch L_done
L_op_start:
    s_mov_b32 s16, s33
    s_mov_b32 s33, s34
    v_and_b32 v2, 63, v0
    v_lshlrev_b32 v1, 4, v2
    v_lshrrev_b32 v5, 2, v2
    v_mul_u32_u24 v3, 1152, v5
    v_and_b32 v5, 3, v2
    v_lshl_add_u32 v3, v5, 4, v3
    s_lshl_b32 s21, s32, 12
    v_add_u32 v4, s21, v1
    s_mov_b64 s[12:13], s[58:59]
    s_mov_b32 s14, 4718592
    s_mov_b32 s15, 0x20000
    s_mul_i32 s19, s32, 1179648
    s_lshl_b32 s18, s33, 6
    s_add_u32 s19, s19, s18
    s_add_u32 s18, s19, 0
    s_add_u32 m0, s21, 0
    s_nop 0
    buffer_load_dwordx4 v3, s[12:15], s18 offen lds
    s_add_u32 m0, s21, 1024
    s_add_u32 s18, s18, 18432
    buffer_load_dwordx4 v3, s[12:15], s18 offen lds
    s_add_u32 m0, s21, 2048
    s_add_u32 s18, s18, 18432
    buffer_load_dwordx4 v3, s[12:15], s18 offen lds
    s_add_u32 m0, s21, 3072
    s_add_u32 s18, s18, 18432
    buffer_load_dwordx4 v3, s[12:15], s18 offen lds
    s_add_u32 s18, s19, 73728
    s_add_u32 m0, s21, 16384
    s_nop 0
    buffer_load_dwordx4 v3, s[12:15], s18 offen lds
    s_add_u32 m0, s21, 17408
    s_add_u32 s18, s18, 18432
    buffer_load_dwordx4 v3, s[12:15], s18 offen lds
    s_add_u32 m0, s21, 18432
    s_add_u32 s18, s18, 18432
    buffer_load_dwordx4 v3, s[12:15], s18 offen lds
    s_add_u32 m0, s21, 19456
    s_add_u32 s18, s18, 18432
    buffer_load_dwordx4 v3, s[12:15], s18 offen lds
    s_add_u32 s18, s19, 147456
    s_add_u32 m0, s21, 32768
    s_nop 0
    buffer_load_dwordx4 v3, s[12:15], s18 offen lds
    s_add_u32 m0, s21, 33792
    s_add_u32 s18, s18, 18432
    buffer_load_dwordx4 v3, s[12:15], s18 offen lds
    s_add_u32 m0, s21, 34816
    s_add_u32 s18, s18, 18432
    buffer_load_dwordx4 v3, s[12:15], s18 offen lds
    s_add_u32 m0, s21, 35840
    s_add_u32 s18, s18, 18432
    buffer_load_dwordx4 v3, s[12:15], s18 offen lds
    s_add_u32 s18, s19, 221184
    s_add_u32 m0, s21, 49152
    s_nop 0
    buffer_load_dwordx4 v3, s[12:15], s18 offen lds
    s_add_u32 m0, s21, 50176
    s_add_u32 s18, s18, 18432
    buffer_load_dwordx4 v3, s[12:15], s18 offen lds
    s_add_u32 m0, s21, 51200
    s_add_u32 s18, s18, 18432
    buffer_load_dwordx4 v3, s[12:15], s18 offen lds
    s_add_u32 m0, s21, 52224
    s_add_u32 s18, s18, 18432
    buffer_load_dwordx4 v3, s[12:15], s18 offen lds
    s_add_u32 s18, s19, 294912
    s_add_u32 m0, s21, 65536
    s_nop 0
    buffer_load_dwordx4 v3, s[12:15], s18 offen lds
    s_add_u32 m0, s21, 66560
    s_add_u32 s18, s18, 18432
    buffer_load_dwordx4 v3, s[12:15], s18 offen lds
    s_add_u32 m0, s21, 67584
    s_add_u32 s18, s18, 18432
    buffer_load_dwordx4 v3, s[12:15], s18 offen lds
    s_add_u32 m0, s21, 68608
    s_add_u32 s18, s18, 18432
    buffer_load_dwordx4 v3, s[12:15], s18 offen lds
    s_add_u32 s18, s19, 368640
    s_add_u32 m0, s21, 81920
    s_nop 0
    buffer_load_dwordx4 v3, s[12:15], s18 offen lds
    s_add_u32 m0, s21, 82944
    s_add_u32 s18, s18, 18432
    buffer_load_dwordx4 v3, s[12:15], s18 offen lds
    s_add_u32 m0, s21, 83968
    s_add_u32 s18, s18, 18432
    buffer_load_dwordx4 v3, s[12:15], s18 offen lds
    s_add_u32 m0, s21, 84992
    s_add_u32 s18, s18, 18432
    buffer_load_dwordx4 v3, s[12:15], s18 offen lds
    s_add_u32 s18, s19, 442368
    s_add_u32 m0, s21, 98304
    s_nop 0
    buffer_load_dwordx4 v3, s[12:15], s18 offen lds
    s_add_u32 m0, s21, 99328
    s_add_u32 s18, s18, 18432
    buffer_load_dwordx4 v3, s[12:15], s18 offen lds
    s_add_u32 m0, s21, 100352
    s_add_u32 s18, s18, 18432
    buffer_load_dwordx4 v3, s[12:15], s18 offen lds
    s_add_u32 m0, s21, 101376
    s_add_u32 s18, s18, 18432
    buffer_load_dwordx4 v3, s[12:15], s18 offen lds
    s_add_u32 s18, s19, 516096
    s_add_u32 m0, s21, 114688
    s_nop 0
    buffer_load_dwordx4 v3, s[12:15], s18 offen lds
    s_add_u32 m0, s21, 115712
    s_add_u32 s18, s18, 18432
    buffer_load_dwordx4 v3, s[12:15], s18 offen lds
    s_add_u32 m0, s21, 116736
    s_add_u32 s18, s18, 18432
    buffer_load_dwordx4 v3, s[12:15], s18 offen lds
    s_add_u32 m0, s21, 117760
    s_add_u32 s18, s18, 18432
    buffer_load_dwordx4 v3, s[12:15], s18 offen lds
    s_add_u32 s18, s19, 589824
    s_add_u32 m0, s21, 131072
    s_nop 0
    buffer_load_dwordx4 v3, s[12:15], s18 offen lds
    s_add_u32 m0, s21, 132096
    s_add_u32 s18, s18, 18432
    buffer_load_dwordx4 v3, s[12:15], s18 offen lds
    s_add_u32 m0, s21, 133120
    s_add_u32 s18, s18, 18432
    buffer_load_dwordx4 v3, s[12:15], s18 offen lds
    s_add_u32 m0, s21, 134144
    s_add_u32 s18, s18, 18432
    buffer_load_dwordx4 v3, s[12:15], s18 offen lds
    v_add_u32 v6, 0, v4
    v_xor_b32 v7, 32, v6
    s_waitcnt vmcnt(32)
    ds_read_b64_tr_b16 a[0:1], v6 offset:0
    ds_read_b64_tr_b16 a[2:3], v6 offset:1024
    ds_read_b64_tr_b16 a[4:5], v6 offset:8
    ds_read_b64_tr_b16 a[6:7], v6 offset:1032
    ds_read_b64_tr_b16 a[8:9], v6 offset:2048
    ds_read_b64_tr_b16 a[10:11], v6 offset:3072
    ds_read_b64_tr_b16 a[12:13], v6 offset:2056
    ds_read_b64_tr_b16 a[14:15], v6 offset:3080
    s_waitcnt lgkmcnt(0)
    s_add_u32 s18, s19, 663552
    s_add_u32 m0, s21, 0
    s_nop 0
    buffer_load_dwordx4 v3, s[12:15], s18 offen lds
    s_add_u32 m0, s21, 1024
    s_add_u32 s18, s18, 18432
    buffer_load_dwordx4 v3, s[12:15], s18 offen lds
    s_add_u32 m0, s21, 2048
    s_add_u32 s18, s18, 18432
    buffer_load_dwordx4 v3, s[12:15], s18 offen lds
    s_add_u32 m0, s21, 3072
    s_add_u32 s18, s18, 18432
    buffer_load_dwordx4 v3, s[12:15], s18 offen lds
    v_add_u32 v6, 16384, v4
    v_xor_b32 v7, 32, v6
    s_waitcnt vmcnt(32)
    ds_read_b64_tr_b16 a[16:17], v6 offset:0
    ds_read_b64_tr_b16 a[18:19], v6 offset:1024
    ds_read_b64_tr_b16 a[20:21], v6 offset:8
    ds_read_b64_tr_b16 a[22:23], v6 offset:1032
    ds_read_b64_tr_b16 a[24:25], v6 offset:2048
    ds_read_b64_tr_b16 a[26:27], v6 offset:3072
    ds_read_b64_tr_b16 a[28:29], v6 offset:2056
    ds_read_b64_tr_b16 a[30:31], v6 offset:3080
    s_waitcnt lgkmcnt(0)
    s_add_u32 s18, s19, 737280
    s_add_u32 m0, s21, 16384
    s_nop 0
    buffer_load_dwordx4 v3, s[12:15], s18 offen lds
    s_add_u32 m0, s21, 17408
    s_add_u32 s18, s18, 18432
    buffer_load_dwordx4 v3, s[12:15], s18 offen lds
    s_add_u32 m0, s21, 18432
    s_add_u32 s18, s18, 18432
    buffer_load_dwordx4 v3, s[12:15], s18 offen lds
    s_add_u32 m0, s21, 19456
    s_add_u32 s18, s18, 18432
    buffer_load_dwordx4 v3, s[12:15], s18 offen lds
    v_add_u32 v6, 32768, v4
    v_xor_b32 v7, 32, v6
    s_waitcnt vmcnt(32)
    ds_read_b64_tr_b16 a[32:33], v6 offset:0
    ds_read_b64_tr_b16 a[34:35], v6 offset:1024
    ds_read_b64_tr_b16 a[36:37], v6 offset:8
    ds_read_b64_tr_b16 a[38:39], v6 offset:1032
    ds_read_b64_tr_b16 a[40:41], v6 offset:2048
    ds_read_b64_tr_b16 a[42:43], v6 offset:3072
    ds_read_b64_tr_b16 a[44:45], v6 offset:2056
    ds_read_b64_tr_b16 a[46:47], v6 offset:3080
    s_waitcnt lgkmcnt(0)
    s_add_u32 s18, s19, 811008
    s_add_u32 m0, s21, 32768
    s_nop 0
    buffer_load_dwordx4 v3, s[12:15], s18 offen lds
    s_add_u32 m0, s21, 33792
    s_add_u32 s18, s18, 18432
    buffer_load_dwordx4 v3, s[12:15], s18 offen lds
    s_add_u32 m0, s21, 34816
    s_add_u32 s18, s18, 18432
    buffer_load_dwordx4 v3, s[12:15], s18 offen lds
    s_add_u32 m0, s21, 35840
    s_add_u32 s18, s18, 18432
    buffer_load_dwordx4 v3, s[12:15], s18 offen lds
    v_add_u32 v6, 49152, v4
    v_xor_b32 v7, 32, v6
    s_waitcnt vmcnt(32)
    ds_read_b64_tr_b16 a[48:49], v6 offset:0
    ds_read_b64_tr_b16 a[50:51], v6 offset:1024
    ds_read_b64_tr_b16 a[52:53], v6 offset:8
    ds_read_b64_tr_b16 a[54:55], v6 offset:1032
    ds_read_b64_tr_b16 a[56:57], v6 offset:2048
    ds_read_b64_tr_b16 a[58:59], v6 offset:3072
    ds_read_b64_tr_b16 a[60:61], v6 offset:2056
    ds_read_b64_tr_b16 a[62:63], v6 offset:3080
    s_waitcnt lgkmcnt(0)
    s_add_u32 s18, s19, 884736
    s_add_u32 m0, s21, 49152
    s_nop 0
    buffer_load_dwordx4 v3, s[12:15], s18 offen lds
    s_add_u32 m0, s21, 50176
    s_add_u32 s18, s18, 18432
    buffer_load_dwordx4 v3, s[12:15], s18 offen lds
    s_add_u32 m0, s21, 51200
    s_add_u32 s18, s18, 18432
    buffer_load_dwordx4 v3, s[12:15], s18 offen lds
    s_add_u32 m0, s21, 52224
    s_add_u32 s18, s18, 18432
    buffer_load_dwordx4 v3, s[12:15], s18 offen lds
    v_add_u32 v6, 65536, v4
    v_xor_b32 v7, 32, v6
    s_waitcnt vmcnt(32)
    ds_read_b64_tr_b16 a[64:65], v6 offset:0
    ds_read_b64_tr_b16 a[66:67], v6 offset:1024
    ds_read_b64_tr_b16 a[68:69], v6 offset:8
    ds_read_b64_tr_b16 a[70:71], v6 offset:1032
    ds_read_b64_tr_b16 a[72:73], v6 offset:2048
    ds_read_b64_tr_b16 a[74:75], v6 offset:3072
    ds_read_b64_tr_b16 a[76:77], v6 offset:2056
    ds_read_b64_tr_b16 a[78:79], v6 offset:3080
    s_waitcnt lgkmcnt(0)
    s_add_u32 s18, s19, 958464
    s_add_u32 m0, s21, 65536
    s_nop 0
    buffer_load_dwordx4 v3, s[12:15], s18 offen lds
    s_add_u32 m0, s21, 66560
    s_add_u32 s18, s18, 18432
    buffer_load_dwordx4 v3, s[12:15], s18 offen lds
    s_add_u32 m0, s21, 67584
    s_add_u32 s18, s18, 18432
    buffer_load_dwordx4 v3, s[12:15], s18 offen lds
    s_add_u32 m0, s21, 68608
    s_add_u32 s18, s18, 18432
    buffer_load_dwordx4 v3, s[12:15], s18 offen lds
    v_add_u32 v6, 81920, v4
    v_xor_b32 v7, 32, v6
    s_waitcnt vmcnt(32)
    ds_read_b64_tr_b16 a[80:81], v6 offset:0
    ds_read_b64_tr_b16 a[82:83], v6 offset:1024
    ds_read_b64_tr_b16 a[84:85], v6 offset:8
    ds_read_b64_tr_b16 a[86:87], v6 offset:1032
    ds_read_b64_tr_b16 a[88:89], v6 offset:2048
    ds_read_b64_tr_b16 a[90:91], v6 offset:3072
    ds_read_b64_tr_b16 a[92:93], v6 offset:2056
    ds_read_b64_tr_b16 a[94:95], v6 offset:3080
    s_waitcnt lgkmcnt(0)
    s_add_u32 s18, s19, 1032192
    s_add_u32 m0, s21, 81920
    s_nop 0
    buffer_load_dwordx4 v3, s[12:15], s18 offen lds
    s_add_u32 m0, s21, 82944
    s_add_u32 s18, s18, 18432
    buffer_load_dwordx4 v3, s[12:15], s18 offen lds
    s_add_u32 m0, s21, 83968
    s_add_u32 s18, s18, 18432
    buffer_load_dwordx4 v3, s[12:15], s18 offen lds
    s_add_u32 m0, s21, 84992
    s_add_u32 s18, s18, 18432
    buffer_load_dwordx4 v3, s[12:15], s18 offen lds
    v_add_u32 v6, 98304, v4
    v_xor_b32 v7, 32, v6
    s_waitcnt vmcnt(32)
    ds_read_b64_tr_b16 a[96:97], v6 offset:0
    ds_read_b64_tr_b16 a[98:99], v6 offset:1024
    ds_read_b64_tr_b16 a[100:101], v6 offset:8
    ds_read_b64_tr_b16 a[102:103], v6 offset:1032
    ds_read_b64_tr_b16 a[104:105], v6 offset:2048
    ds_read_b64_tr_b16 a[106:107], v6 offset:3072
    ds_read_b64_tr_b16 a[108:109], v6 offset:2056
    ds_read_b64_tr_b16 a[110:111], v6 offset:3080
    s_waitcnt lgkmcnt(0)
    s_add_u32 s18, s19, 1105920
    s_add_u32 m0, s21, 98304
    s_nop 0
    buffer_load_dwordx4 v3, s[12:15], s18 offen lds
    s_add_u32 m0, s21, 99328
    s_add_u32 s18, s18, 18432
    buffer_load_dwordx4 v3, s[12:15], s18 offen lds
    s_add_u32 m0, s21, 100352
    s_add_u32 s18, s18, 18432
    buffer_load_dwordx4 v3, s[12:15], s18 offen lds
    s_add_u32 m0, s21, 101376
    s_add_u32 s18, s18, 18432
    buffer_load_dwordx4 v3, s[12:15], s18 offen lds
    v_add_u32 v6, 114688, v4
    v_xor_b32 v7, 32, v6
    s_waitcnt vmcnt(32)
    ds_read_b64_tr_b16 a[112:113], v6 offset:0
    ds_read_b64_tr_b16 a[114:115], v6 offset:1024
    ds_read_b64_tr_b16 a[116:117], v6 offset:8
    ds_read_b64_tr_b16 a[118:119], v6 offset:1032
    ds_read_b64_tr_b16 a[120:121], v6 offset:2048
    ds_read_b64_tr_b16 a[122:123], v6 offset:3072
    ds_read_b64_tr_b16 a[124:125], v6 offset:2056
    ds_read_b64_tr_b16 a[126:127], v6 offset:3080
    s_waitcnt lgkmcnt(0)
    v_add_u32 v6, 131072, v4
    v_xor_b32 v7, 32, v6
    s_waitcnt vmcnt(28)
    ds_read_b64_tr_b16 a[128:129], v6 offset:0
    ds_read_b64_tr_b16 a[130:131], v6 offset:1024
    ds_read_b64_tr_b16 a[132:133], v6 offset:8
    ds_read_b64_tr_b16 a[134:135], v6 offset:1032
    ds_read_b64_tr_b16 a[136:137], v6 offset:2048
    ds_read_b64_tr_b16 a[138:139], v6 offset:3072
    ds_read_b64_tr_b16 a[140:141], v6 offset:2056
    ds_read_b64_tr_b16 a[142:143], v6 offset:3080
    s_waitcnt lgkmcnt(0)
    v_add_u32 v6, 0, v4
    v_xor_b32 v7, 32, v6
    s_waitcnt vmcnt(24)
    ds_read_b64_tr_b16 a[144:145], v6 offset:0
    ds_read_b64_tr_b16 a[146:147], v6 offset:1024
    ds_read_b64_tr_b16 a[148:149], v6 offset:8
    ds_read_b64_tr_b16 a[150:151], v6 offset:1032
    ds_read_b64_tr_b16 a[152:153], v6 offset:2048
    ds_read_b64_tr_b16 a[154:155], v6 offset:3072
    ds_read_b64_tr_b16 a[156:157], v6 offset:2056
    ds_read_b64_tr_b16 a[158:159], v6 offset:3080
    s_waitcnt lgkmcnt(0)
    v_add_u32 v6, 16384, v4
    v_xor_b32 v7, 32, v6
    s_waitcnt vmcnt(20)
    ds_read_b64_tr_b16 a[160:161], v6 offset:0
    ds_read_b64_tr_b16 a[162:163], v6 offset:1024
    ds_read_b64_tr_b16 a[164:165], v6 offset:8
    ds_read_b64_tr_b16 a[166:167], v6 offset:1032
    ds_read_b64_tr_b16 a[168:169], v6 offset:2048
    ds_read_b64_tr_b16 a[170:171], v6 offset:3072
    ds_read_b64_tr_b16 a[172:173], v6 offset:2056
    ds_read_b64_tr_b16 a[174:175], v6 offset:3080
    s_waitcnt lgkmcnt(0)
    v_add_u32 v6, 32768, v4
    v_xor_b32 v7, 32, v6
    s_waitcnt vmcnt(16)
    ds_read_b64_tr_b16 a[176:177], v6 offset:0
    ds_read_b64_tr_b16 a[178:179], v6 offset:1024
    ds_read_b64_tr_b16 a[180:181], v6 offset:8
    ds_read_b64_tr_b16 a[182:183], v6 offset:1032
    ds_read_b64_tr_b16 a[184:185], v6 offset:2048
    ds_read_b64_tr_b16 a[186:187], v6 offset:3072
    ds_read_b64_tr_b16 a[188:189], v6 offset:2056
    ds_read_b64_tr_b16 a[190:191], v6 offset:3080
    s_waitcnt lgkmcnt(0)
    v_add_u32 v6, 49152, v4
    v_xor_b32 v7, 32, v6
    s_waitcnt vmcnt(12)
    ds_read_b64_tr_b16 a[192:193], v6 offset:0
    ds_read_b64_tr_b16 a[194:195], v6 offset:1024
    ds_read_b64_tr_b16 a[196:197], v6 offset:8
    ds_read_b64_tr_b16 a[198:199], v6 offset:1032
    ds_read_b64_tr_b16 a[200:201], v6 offset:2048
    ds_read_b64_tr_b16 a[202:203], v6 offset:3072
    ds_read_b64_tr_b16 a[204:205], v6 offset:2056
    ds_read_b64_tr_b16 a[206:207], v6 offset:3080
    s_waitcnt lgkmcnt(0)
    v_add_u32 v6, 65536, v4
    v_xor_b32 v7, 32, v6
    s_waitcnt vmcnt(8)
    ds_read_b64_tr_b16 a[208:209], v6 offset:0
    ds_read_b64_tr_b16 a[210:211], v6 offset:1024
    ds_read_b64_tr_b16 a[212:213], v6 offset:8
    ds_read_b64_tr_b16 a[214:215], v6 offset:1032
    ds_read_b64_tr_b16 a[216:217], v6 offset:2048
    ds_read_b64_tr_b16 a[218:219], v6 offset:3072
    ds_read_b64_tr_b16 a[220:221], v6 offset:2056
    ds_read_b64_tr_b16 a[222:223], v6 offset:3080
    s_waitcnt lgkmcnt(0)
    v_add_u32 v6, 81920, v4
    v_xor_b32 v7, 32, v6
    s_waitcnt vmcnt(4)
    ds_read_b64_tr_b16 a[224:225], v6 offset:0
    ds_read_b64_tr_b16 a[226:227], v6 offset:1024
    ds_read_b64_tr_b16 a[228:229], v6 offset:8
    ds_read_b64_tr_b16 a[230:231], v6 offset:1032
    ds_read_b64_tr_b16 a[232:233], v6 offset:2048
    ds_read_b64_tr_b16 a[234:235], v6 offset:3072
    ds_read_b64_tr_b16 a[236:237], v6 offset:2056
    ds_read_b64_tr_b16 a[238:239], v6 offset:3080
    s_waitcnt lgkmcnt(0)
    v_add_u32 v6, 98304, v4
    v_xor_b32 v7, 32, v6
    s_waitcnt vmcnt(0)
    ds_read_b64_tr_b16 a[240:241], v6 offset:0
    ds_read_b64_tr_b16 a[242:243], v6 offset:1024
    ds_read_b64_tr_b16 a[244:245], v6 offset:8
    ds_read_b64_tr_b16 a[246:247], v6 offset:1032
    ds_read_b64_tr_b16 a[248:249], v6 offset:2048
    ds_read_b64_tr_b16 a[250:251], v6 offset:3072
    ds_read_b64_tr_b16 a[252:253], v6 offset:2056
    ds_read_b64_tr_b16 a[254:255], v6 offset:3080
    s_waitcnt lgkmcnt(0)
    s_barrier
L_op_seg:
    s_lshr_b32 s43, s16, 1
    s_add_u32 s43, s43, 1
    s_min_u32 s43, s43, 63
    s_and_b32 s36, s33, 15
    s_lshl_b32 s36, s36, 8
    s_add_u32 s36, s36, 125829120
    s_lshl_b32 s94, s33, 7
    s_add_u32 s94, s94, s16
    s_mov_b32 s88, 65536
cw15:
    buffer_load_dword v3, off, s[4:7], s36 offset:128 sc1
    s_waitcnt vmcnt(0)
    v_readfirstlane_b32 s42, v3
    s_nop 0
    s_sub_u32 s42, s42, s95
    s_cmp_gt_u32 s42, 64
    s_cselect_b32 s42, 0, s42
    s_add_u32 s42, s42, 2
    s_cmp_ge_u32 s42, s43
    s_cbranch_scc1 cw15x
    s_sub_u32 s88, s88, 1
    s_cbranch_scc1 cw15x
    s_sub_u32 s42, s43, s42
    s_min_u32 s42, s42, 6
cw15s:
    s_sleep 24
    s_sub_u32 s42, s42, 1
    s_cmp_lg_u32 s42, 0
    s_cbranch_scc1 cw15s
    s_branch cw15
cw15x:
    s_lshr_b32 s89, s16, 1
    s_lshl_b32 s89, s89, 2
    s_add_u32 s89, s89, s32
    s_lshl_b32 s89, s89, 7
    s_add_u32 s89, s89, 125894656
    v_mbcnt_lo_u32_b32 v2, -1, 0
    v_mbcnt_hi_u32_b32 v2, -1, v2
    v_min_u32 v2, 7, v2
    v_lshlrev_b32 v2, 2, v2
    s_mov_b32 s88, 4194304
fw16:
    buffer_load_dword v3, v2, s[4:7], s89 offen offset:0 sc1
    s_sub_u32 s88, s88, 1
    s_cbranch_scc1 fw16x
    s_waitcnt vmcnt(0)
    v_cmp_ne_u32 vcc, s95, v3
    s_cbranch_vccz fw16x
    s_sleep 4
    s_cmp_gt_u32 s88, 4194280
    s_cbranch_scc1 fw16
    s_sleep 40
    s_branch fw16
fw16x:
    s_lshl_b32 s18, s16, 17
    s_lshl_b32 s19, s32, 15
    s_add_u32 s18, s18, s19
    s_add_u32 s18, s18, 50331648
    buffer_load_dwordx4 v[32:35], v1, s[4:7], s18 offen offset:0 sc1
    buffer_load_dwordx4 v[36:39], v1, s[4:7], s18 offen offset:1024 sc1
    buffer_load_dwordx4 v[40:43], v1, s[4:7], s18 offen offset:2048 sc1
    buffer_load_dwordx4 v[44:47], v1, s[4:7], s18 offen offset:3072 sc1
    s_add_u32 s18, s18, 4096
    buffer_load_dwordx4 v[48:51], v1, s[4:7], s18 offen offset:0 sc1
    buffer_load_dwordx4 v[52:55], v1, s[4:7], s18 offen offset:1024 sc1
    buffer_load_dwordx4 v[56:59], v1, s[4:7], s18 offen offset:2048 sc1
    buffer_load_dwordx4 v[60:63], v1, s[4:7], s18 offen offset:3072 sc1
    s_add_u32 s18, s18, 4096
    buffer_load_dwordx4 v[64:67], v1, s[4:7], s18 offen offset:0 sc1
    buffer_load_dwordx4 v[68:71], v1, s[4:7], s18 offen offset:1024 sc1
    buffer_load_dwordx4 v[72:75], v1, s[4:7], s18 offen offset:2048 sc1
    buffer_load_dwordx4 v[76:79], v1, s[4:7], s18 offen offset:3072 sc1
    s_add_u32 s18, s18, 4096
    buffer_load_dwordx4 v[80:83], v1, s[4:7], s18 offen offset:0 sc1
    buffer_load_dwordx4 v[84:87], v1, s[4:7], s18 offen offset:1024 sc1
    buffer_load_dwordx4 v[88:91], v1, s[4:7], s18 offen offset:2048 sc1
    buffer_load_dwordx4 v[92:95], v1, s[4:7], s18 offen offset:3072 sc1
    s_add_u32 s18, s18, 4096
    buffer_load_dwordx4 v[96:99], v1, s[4:7], s18 offen offset:0 sc1
    buffer_load_dwordx4 v[100:103], v1, s[4:7], s18 offen offset:1024 sc1
    buffer_load_dwordx4 v[104:107], v1, s[4:7], s18 offen offset:2048 sc1
    buffer_load_dwordx4 v[108:111], v1, s[4:7], s18 offen offset:3072 sc1
    s_add_u32 s18, s18, 4096
    buffer_load_dwordx4 v[112:115], v1, s[4:7], s18 offen offset:0 sc1
    buffer_load_dwordx4 v[116:119], v1, s[4:7], s18 offen offset:1024 sc1
    buffer_load_dwordx4 v[120:123], v1, s[4:7], s18 offen offset:2048 sc1
    buffer_load_dwordx4 v[124:127], v1, s[4:7], s18 offen offset:3072 sc1
    s_add_u32 s18, s18, 4096
    buffer_load_dwordx4 v[128:131], v1, s[4:7], s18 offen offset:0 sc1
    buffer_load_dwordx4 v[132:135], v1, s[4:7], s18 offen offset:1024 sc1
    buffer_load_dwordx4 v[136:139], v1, s[4:7], s18 offen offset:2048 sc1
    buffer_load_dwordx4 v[140:143], v1, s[4:7], s18 offen offset:3072 sc1
    s_add_u32 s18, s18, 4096
    buffer_load_dwordx4 v[144:147], v1, s[4:7], s18 offen offset:0 sc1
    buffer_load_dwordx4 v[148:151], v1, s[4:7], s18 offen offset:1024 sc1
    buffer_load_dwordx4 v[152:155], v1, s[4:7], s18 offen offset:2048 sc1
    buffer_load_dwordx4 v[156:159], v1, s[4:7], s18 offen offset:3072 sc1
    v_lshlrev_b32 v2, 4, v0
    v_and_b32 v3, 3072, v2
    v_lshl_add_u32 v2, v3, 1, v1
    s_waitcnt vmcnt(31)
    v_mfma_f32_16x16x32_bf16 v[8:11], a[0:3], v[32:35], 0
    v_mfma_f32_16x16x32_bf16 v[12:15], a[4:7], v[32:35], 0
    s_waitcnt vmcnt(30)
    v_mfma_f32_16x16x32_bf16 v[8:11], a[8:11], v[36:39], v[8:11]
    v_mfma_f32_16x16x32_bf16 v[12:15], a[12:15], v[36:39], v[12:15]
    s_waitcnt vmcnt(29)
    v_mfma_f32_16x16x32_bf16 v[8:11], a[16:19], v[40:43], v[8:11]
    v_mfma_f32_16x16x32_bf16 v[12:15], a[20:23], v[40:43], v[12:15]
    s_waitcnt vmcnt(28)
    v_mfma_f32_16x16x32_bf16 v[8:11], a[24:27], v[44:47], v[8:11]
    v_mfma_f32_16x16x32_bf16 v[12:15], a[28:31], v[44:47], v[12:15]
    s_waitcnt vmcnt(27)
    v_mfma_f32_16x16x32_bf16 v[8:11], a[32:35], v[48:51], v[8:11]
    v_mfma_f32_16x16x32_bf16 v[12:15], a[36:39], v[48:51], v[12:15]
    s_waitcnt vmcnt(26)
    v_mfma_f32_16x16x32_bf16 v[8:11], a[40:43], v[52:55], v[8:11]
    v_mfma_f32_16x16x32_bf16 v[12:15], a[44:47], v[52:55], v[12:15]
    s_waitcnt vmcnt(25)
    v_mfma_f32_16x16x32_bf16 v[8:11], a[48:51], v[56:59], v[8:11]
    v_mfma_f32_16x16x32_bf16 v[12:15], a[52:55], v[56:59], v[12:15]
    s_waitcnt vmcnt(24)
    v_mfma_f32_16x16x32_bf16 v[8:11], a[56:59], v[60:63], v[8:11]
    v_mfma_f32_16x16x32_bf16 v[12:15], a[60:63], v[60:63], v[12:15]
    s_waitcnt vmcnt(23)
    v_mfma_f32_16x16x32_bf16 v[8:11], a[64:67], v[64:67], v[8:11]
    v_mfma_f32_16x16x32_bf16 v[12:15], a[68:71], v[64:67], v[12:15]
    s_waitcnt vmcnt(22)
    v_mfma_f32_16x16x32_bf16 v[8:11], a[72:75], v[68:71], v[8:11]
    v_mfma_f32_16x16x32_bf16 v[12:15], a[76:79], v[68:71], v[12:15]
    s_waitcnt vmcnt(21)
    v_mfma_f32_16x16x32_bf16 v[8:11], a[80:83], v[72:75], v[8:11]
    v_mfma_f32_16x16x32_bf16 v[12:15], a[84:87], v[72:75], v[12:15]
    s_waitcnt vmcnt(20)
    v_mfma_f32_16x16x32_bf16 v[8:11], a[88:91], v[76:79], v[8:11]
    v_mfma_f32_16x16x32_bf16 v[12:15], a[92:95], v[76:79], v[12:15]
    s_waitcnt vmcnt(19)
    v_mfma_f32_16x16x32_bf16 v[8:11], a[96:99], v[80:83], v[8:11]
    v_mfma_f32_16x16x32_bf16 v[12:15], a[100:103], v[80:83], v[12:15]
    s_waitcnt vmcnt(18)
    v_mfma_f32_16x16x32_bf16 v[8:11], a[104:107], v[84:87], v[8:11]
    v_mfma_f32_16x16x32_bf16 v[12:15], a[108:111], v[84:87], v[12:15]
    s_waitcnt vmcnt(17)
    v_mfma_f32_16x16x32_bf16 v[8:11], a[112:115], v[88:91], v[8:11]
    v_mfma_f32_16x16x32_bf16 v[12:15], a[116:119], v[88:91], v[12:15]
    s_waitcnt vmcnt(16)
    v_mfma_f32_16x16x32_bf16 v[8:11], a[120:123], v[92:95], v[8:11]
    v_mfma_f32_16x16x32_bf16 v[12:15], a[124:127], v[92:95], v[12:15]
    s_waitcnt vmcnt(15)
    v_mfma_f32_16x16x32_bf16 v[8:11], a[128:131], v[96:99], v[8:11]
    v_mfma_f32_16x16x32_bf16 v[12:15], a[132:135], v[96:99], v[12:15]
    s_waitcnt vmcnt(14)
    v_mfma_f32_16x16x32_bf16 v[8:11], a[136:139], v[100:103], v[8:11]
    v_mfma_f32_16x16x32_bf16 v[12:15], a[140:143], v[100:103], v[12:15]
    s_waitcnt vmcnt(13)
    v_mfma_f32_16x16x32_bf16 v[8:11], a[144:147], v[104:107], v[8:11]
    v_mfma_f32_16x16x32_bf16 v[12:15], a[148:151], v[104:107], v[12:15]
    s_waitcnt vmcnt(12)
    v_mfma_f32_16x16x32_bf16 v[8:11], a[152:155], v[108:111], v[8:11]
    v_mfma_f32_16x16x32_bf16 v[12:15], a[156:159], v[108:111], v[12:15]
    s_waitcnt vmcnt(11)
    v_mfma_f32_16x16x32_bf16 v[8:11], a[160:163], v[112:115], v[8:11]
    v_mfma_f32_16x16x32_bf16 v[12:15], a[164:167], v[112:115], v[12:15]
    s_waitcnt vmcnt(10)
    v_mfma_f32_16x16x32_bf16 v[8:11], a[168:171], v[116:119], v[8:11]
    v_mfma_f32_16x16x32_bf16 v[12:15], a[172:175], v[116:119], v[12:15]
    s_waitcnt vmcnt(9)
    v_mfma_f32_16x16x32_bf16 v[8:11], a[176:179], v[120:123], v[8:11]
    v_mfma_f32_16x16x32_bf16 v[12:15], a[180:183], v[120:123], v[12:15]
    s_waitcnt vmcnt(8)
    v_mfma_f32_16x16x32_bf16 v[8:11], a[184:187], v[124:127], v[8:11]
    v_mfma_f32_16x16x32_bf16 v[12:15], a[188:191], v[124:127], v[12:15]
    s_waitcnt vmcnt(7)
    v_mfma_f32_16x16x32_bf16 v[8:11], a[192:195], v[128:131], v[8:11]
    v_mfma_f32_16x16x32_bf16 v[12:15], a[196:199], v[128:131], v[12:15]
    s_waitcnt vmcnt(6)
    v_mfma_f32_16x16x32_bf16 v[8:11], a[200:203], v[132:135], v[8:11]
    v_mfma_f32_16x16x32_bf16 v[12:15], a[204:207], v[132:135], v[12:15]
    s_waitcnt vmcnt(5)
    v_mfma_f32_16x16x32_bf16 v[8:11], a[208:211], v[136:139], v[8:11]
    v_mfma_f32_16x16x32_bf16 v[12:15], a[212:215], v[136:139], v[12:15]
    s_waitcnt vmcnt(4)
    v_mfma_f32_16x16x32_bf16 v[8:11], a[216:219], v[140:143], v[8:11]
    v_mfma_f32_16x16x32_bf16 v[12:15], a[220:223], v[140:143], v[12:15]
    s_waitcnt vmcnt(3)
    v_mfma_f32_16x16x32_bf16 v[8:11], a[224:227], v[144:147], v[8:11]
    v_mfma_f32_16x16x32_bf16 v[12:15], a[228:231], v[144:147], v[12:15]
    s_waitcnt vmcnt(2)
    v_mfma_f32_16x16x32_bf16 v[8:11], a[232:235], v[148:151], v[8:11]
    v_mfma_f32_16x16x32_bf16 v[12:15], a[236:239], v[148:151], v[12:15]
    s_waitcnt vmcnt(1)
    v_mfma_f32_16x16x32_bf16 v[8:11], a[240:243], v[152:155], v[8:11]
    v_mfma_f32_16x16x32_bf16 v[12:15], a[244:247], v[152:155], v[12:15]
    s_waitcnt vmcnt(0)
    v_mfma_f32_16x16x32_bf16 v[8:11], a[248:251], v[156:159], v[8:11]
    v_mfma_f32_16x16x32_bf16 v[12:15], a[252:255], v[156:159], v[12:15]
    s_nop 3
    ds_write_b128 v2, v[8:11] offset:0
    s_nop 2
    ds_write_b128 v2, v[12:15] offset:1024
    s_waitcnt lgkmcnt(0)
    s_barrier
    s_cmp_lg_u32 s32, 0
    s_cbranch_scc1 os_skip
    ds_read_b128 v[40:43], v1 offset:2048
    ds_read_b128 v[44:47], v1 offset:3072
    ds_read_b128 v[48:51], v1 offset:4096
    ds_read_b128 v[52:55], v1 offset:5120
    ds_read_b128 v[56:59], v1 offset:6144
    ds_read_b128 v[60:63], v1 offset:7168
    v_lshrrev_b32 v3, 4, v1
    v_bfe_u32 v4, v3, 2, 2
    v_lshlrev_b32 v4, 3, v4
    v_and_b32 v2, 3, v3
    v_add_u32 v4, v4, v2
    v_mul_u32_u24 v4, 2304, v4
    v_lshrrev_b32 v3, 4, v3
    v_lshl_add_u32 v4, v3, 4, v4
    s_lshr_b32 s18, s16, 1
    s_lshl_b32 s18, s18, 3
    s_and_b32 s19, s16, 1
    s_add_u32 s18, s18, s19
    s_mul_i32 s18, s18, 9216
    s_lshl_b32 s19, s33, 6
    s_add_u32 s18, s18, s19
    s_waitcnt lgkmcnt(0)
    v_pk_add_f32 v[8:9], v[8:9], v[40:41]
    v_pk_add_f32 v[48:49], v[48:49], v[56:57]
    v_pk_add_f32 v[8:9], v[8:9], v[48:49]
    v_pk_add_f32 v[10:11], v[10:11], v[42:43]
    v_pk_add_f32 v[50:51], v[50:51], v[58:59]
    v_pk_add_f32 v[10:11], v[10:11], v[50:51]
    v_pk_add_f32 v[12:13], v[12:13], v[44:45]
    v_pk_add_f32 v[52:53], v[52:53], v[60:61]
    v_pk_add_f32 v[12:13], v[12:13], v[52:53]
    v_pk_add_f32 v[14:15], v[14:15], v[46:47]
    v_pk_add_f32 v[54:55], v[54:55], v[62:63]
    v_pk_add_f32 v[14:15], v[14:15], v[54:55]
    v_cvt_pk_bf16_f32 v32, v8, v9
    v_cvt_pk_bf16_f32 v33, v10, v11
    v_cvt_pk_bf16_f32 v34, v12, v13
    v_cvt_pk_bf16_f32 v35, v14, v15
    buffer_store_dwordx4 v[32:35], v4, s[8:11], s18 offen sc1
os_skip:
    s_nop 1
    s_add_u32 s16, s16, 7
    s_cmp_ge_u32 s16, 128
    s_cbranch_scc1 L_done
    s_barrier
    s_branch L_op_seg
L_done:
L_exit:
    s_endpgm
.section .rodata,"a"
.p2align 6
.amdhsa_kernel concat_heads__memory_aug_recurrent_mem_tr__ssm_conv_s4d__prompt_kernel
  .amdhsa_next_free_vgpr 512
  .amdhsa_next_free_sgpr 102
  .amdhsa_accum_offset 256
  .amdhsa_group_segment_fixed_size 0
  .amdhsa_kernarg_size 136
  .amdhsa_user_sgpr_count 2
  .amdhsa_user_sgpr_kernarg_segment_ptr 1
  .amdhsa_system_sgpr_workgroup_id_x 1
.end_amdhsa_kernel
.text
```

```asm
; @launch grid=(256,1,1) block=(256,1,1) lds=163840
.amdgcn_target "amdgcn-amd-amdhsa--gfx950"
.text
.globl concat_heads__memory_aug_recurrent_mem_tr__ssm_conv_s4d__prompt_kernel
.p2align 8
.type concat_heads__memory_aug_recurrent_mem_tr__ssm_conv_s4d__prompt_kernel,@function
concat_heads__memory_aug_recurrent_mem_tr__ssm_conv_s4d__prompt_kernel:
    s_cmp_ge_u32 s2, 256
    s_cbranch_scc1 L_exit
    s_load_dwordx4 s[84:87], s[0:1], 120
    s_load_dwordx16 s[48:63], s[0:1], 0
    v_lshrrev_b32 v1, 6, v0
    s_nop 0
    v_readfirstlane_b32 s32, v1
    s_getreg_b32 s3, hwreg(HW_REG_XCC_ID)
    s_and_b32 s3, s3, 15
    s_cmp_lg_u32 s32, 3
    s_cbranch_scc1 L_nowarm
    s_getpc_b64 s[44:45]
L_pcw:
    v_and_b32 v1, 63, v0
    v_lshlrev_b32 v1, 7, v1
    s_cmp_lg_u32 s3, 0
    s_cselect_b32 s33, L_helper-L_pcw, 0
    v_add_u32 v1, s33, v1
    v_min_u32 v2, L_exit-L_pcw, v1
    global_load_dword v240, v2, s[44:45]
    v_add_u32 v1, 8192, v1
    v_min_u32 v2, L_exit-L_pcw, v1
    global_load_dword v241, v2, s[44:45]
    v_add_u32 v1, 8192, v1
    s_cbranch_scc0 L_nowarm
    v_min_u32 v2, L_exit-L_pcw, v1
    global_load_dword v242, v2, s[44:45]
    v_add_u32 v1, 8192, v1
    v_min_u32 v2, L_exit-L_pcw, v1
    global_load_dword v243, v2, s[44:45]
    v_add_u32 v1, 8192, v1
    v_min_u32 v2, L_exit-L_pcw, v1
    global_load_dword v244, v2, s[44:45]
    v_add_u32 v1, 8192, v1
L_nowarm:
    s_waitcnt lgkmcnt(0)
    s_mov_b32 s4, s86
    s_mov_b32 s5, s87
    s_mov_b32 s6, 268435456
    s_mov_b32 s7, 0x20000
    s_mov_b32 s96, s84
    s_mov_b32 s97, s85
    s_mov_b32 s98, 256
    s_mov_b32 s99, 0x20000
    s_mov_b32 s95, 0
    s_cmp_lg_u32 s3, 0
    s_cbranch_scc1 L_helper
    s_mov_b32 s37, 128
    v_mov_b32 v250, 1
    v_mov_b32 v251, 163832
    v_cmp_eq_u32 vcc, 0, v0
    s_nop 0
    s_and_saveexec_b64 s[38:39], vcc
    s_cbranch_execz tk1m
    buffer_atomic_add v250, off, s[96:99], s37 sc0
tk1m:
    s_mov_b64 s[38:39], exec
    s_mov_b64 exec, -1
    v_lshrrev_b32 v54, 6, v0
    s_nop 0
    v_readfirstlane_b32 s13, v54
    v_and_b32 v57, 63, v0
    v_bfe_u32 v54, v57, 2, 1
    v_lshlrev_b32 v48, 13, v54
    v_bfe_u32 v54, v57, 3, 1
    v_lshl_add_u32 v48, v54, 15, v48
    v_bfe_u32 v54, v57, 4, 1
    v_lshl_add_u32 v48, v54, 14, v48
    v_bfe_u32 v54, v57, 5, 1
    v_lshl_add_u32 v48, v54, 16, v48
    v_lshrrev_b32 v55, 4, v57
    v_and_b32 v55, 2, v55
    v_xor_b32 v55, v55, v57
    v_and_b32 v55, 3, v55
    v_lshl_add_u32 v48, v55, 4, v48
    v_bfe_u32 v54, v57, 2, 1
    v_lshlrev_b32 v51, 6, v54
    v_bfe_u32 v54, v57, 3, 1
    v_lshl_add_u32 v51, v54, 9, v51
    v_bfe_u32 v54, v57, 4, 1
    v_lshl_add_u32 v51, v54, 7, v51
    v_bfe_u32 v54, v57, 5, 1
    v_lshl_add_u32 v51, v54, 12, v51
    v_bfe_u32 v54, v57, 0, 1
    v_lshl_add_u32 v51, v54, 3, v51
    v_bfe_u32 v54, v57, 1, 1
    v_lshl_add_u32 v51, v54, 4, v51
    v_bfe_u32 v54, v57, 3, 1
    v_lshl_add_u32 v51, v54, 5, v51
    v_lshrrev_b32 v55, 3, v57
    v_mul_u32_u24 v49, 1152, v55
    v_and_b32 v55, 7, v57
    v_lshl_add_u32 v49, v55, 4, v49
    v_bfe_u32 v54, v57, 4, 1
    v_lshlrev_b32 v52, 13, v54
    v_bfe_u32 v54, v57, 5, 1
    v_lshl_add_u32 v52, v54, 9, v52
    v_bfe_u32 v54, v57, 2, 1
    v_lshl_add_u32 v52, v54, 7, v52
    v_bfe_u32 v54, v57, 3, 1
    v_lshl_add_u32 v52, v54, 5, v52
    v_and_b32 v55, 3, v57
    v_lshl_add_u32 v52, v55, 3, v52
    v_lshrrev_b32 v55, 2, v57
    v_mul_u32_u24 v50, 1152, v55
    v_and_b32 v55, 3, v57
    v_lshl_add_u32 v50, v55, 4, v50
    v_bfe_u32 v54, v57, 4, 1
    v_lshlrev_b32 v53, 12, v54
    v_bfe_u32 v54, v57, 5, 1
    v_lshl_add_u32 v53, v54, 8, v53
    v_bfe_u32 v54, v57, 2, 1
    v_lshl_add_u32 v53, v54, 6, v53
    v_bfe_u32 v54, v57, 3, 1
    v_lshl_add_u32 v53, v54, 5, v53
    v_and_b32 v55, 3, v57
    v_lshl_add_u32 v53, v55, 3, v53
    s_lshl_b32 s66, s13, 10
    s_and_b32 s93, s13, 1
    s_lshl_b32 s93, s93, 14
    s_and_b32 s75, s13, 2
    s_lshl_b32 s75, s75, 19
    v_add_u32 v51, s66, v51
    v_add_u32 v52, s66, v52
    v_add_u32 v53, s66, v53
    v_mov_b32 v58, v48
    s_mov_b32 s10, 4718592
    s_mov_b32 s11, 0x20000
    s_mov_b64 exec, s[38:39]
    s_cbranch_execz tk1
    s_waitcnt vmcnt(0)
    ds_write_b32 v251, v250
    s_waitcnt lgkmcnt(0)
tk1:
    s_mov_b64 exec, -1
    s_barrier
    ds_read_b32 v252, v251
    s_waitcnt lgkmcnt(0)
    v_readfirstlane_b32 s12, v252
    s_barrier
    s_nop 3
    s_cmp_ge_u32 s12, 32
    s_cbranch_scc1 L_helper
L_chain:
    s_mov_b64 s[48:49], s[50:51]
    s_mov_b64 s[50:51], s[52:53]
    s_mov_b64 s[52:53], s[54:55]
    s_mov_b64 s[54:55], s[56:57]
    s_mov_b64 s[56:57], s[58:59]
    s_lshl_b32 s67, s12, 8
    s_lshl_b32 s40, s13, 6
    s_add_u32 s67, s67, s40
    s_mul_i32 s92, s12, 147456
    s_lshr_b32 s73, s50, 8
    s_add_u32 s73, s73, s12
    s_and_b32 s73, s73, 31
    s_bitcmp1_b32 0xa2222222, s73
    s_cselect_b32 s88, 1, 0
    s_mov_b32 s72, 0
    s_add_u32 s73, s73, 1
    s_lshr_b32 s73, s73, 2
    s_xor_b32 s94, s13, 0
    s_mul_i32 s94, s94, 36864
    s_add_u32 s94, s94, s92
    s_lshl_b32 s74, s13, 7
    s_add_u32 s94, s94, s74
    s_add_u32 s78, s94, 0
    s_mov_b64 s[8:9], s[56:57]
    v_mov_b32 v58, v49
    s_mov_b32 s79, 9216
    s_mov_b32 s81, 0
    s_add_u32 s80, s66, 114688
    s_mov_b32 s76, 0
    s_mov_b32 s77, 8192
    s_call_b64 s[82:83], cf_dma
    s_mov_b32 s77, 16384
    s_call_b64 s[82:83], cf_dma
    s_xor_b32 s94, s13, 1
    s_mul_i32 s94, s94, 36864
    s_add_u32 s94, s94, s92
    s_lshl_b32 s74, s13, 7
    s_add_u32 s94, s94, s74
    s_add_u32 s78, s94, 0
    s_add_u32 s80, s66, 81920
    s_mov_b32 s76, 0
    s_mov_b32 s77, 8192
    s_call_b64 s[82:83], cf_dma
    s_mov_b32 s77, 16384
    s_call_b64 s[82:83], cf_dma
    s_xor_b32 s94, s13, 2
    s_mul_i32 s94, s94, 36864
    s_add_u32 s94, s94, s92
    s_lshl_b32 s74, s13, 7
    s_add_u32 s94, s94, s74
    s_add_u32 s78, s94, 0
    s_add_u32 s80, s66, 16384
    s_mov_b32 s76, 0
    s_mov_b32 s77, 8192
    s_call_b64 s[82:83], cf_dma
    v_lshrrev_b32 v24, 6, v0
    v_lshlrev_b32 v61, 4, v0
    v_add_u32 v62, 57344, v61
    v_xor_b32 v63, 1024, v61
    v_add_u32 v63, 98304, v63
    v_xor_b32 v64, 2048, v61
    v_add_u32 v64, 98304, v64
    v_and_b32 v65, 1023, v61
    v_add_u32 v65, 98304, v65
    v_and_b32 v26, 15, v0
    v_bfe_u32 v27, v0, 4, 2
    v_mov_b32 v60, 0x4444
    v_mov_b32 v25, 0xeeee
    v_cmp_lt_u32 vcc, 7, v26
    s_nop 1
    v_cndmask_b32 v60, v60, v25, vcc
    s_mov_b32 s77, 16384
    s_call_b64 s[82:83], cf_dma
    v_and_b32 v67, 12, v26
    v_lshlrev_b32 v67, 3, v67
    v_and_b32 v25, 1, v26
    v_lshl_add_u32 v67, v25, 4, v67
    v_bfe_u32 v25, v26, 1, 1
    v_lshl_add_u32 v67, v25, 3, v67
    v_lshl_add_u32 v66, v27, 14, v67
    v_lshl_add_u32 v66, v24, 17, v66
    s_xor_b32 s94, s13, 3
    s_mul_i32 s94, s94, 36864
    s_add_u32 s94, s94, s92
    s_lshl_b32 s74, s13, 7
    s_add_u32 s94, s94, s74
    s_add_u32 s78, s94, 0
    s_add_u32 s80, s66, 0
    s_mov_b32 s76, 0
    s_mov_b32 s77, 8192
    s_call_b64 s[82:83], cf_dma
    v_and_b32 v67, 63, v67
    v_lshrrev_b32 v25, 1, v24
    v_lshl_add_u32 v67, v25, 18, v67
    v_lshl_add_u32 v67, v27, 16, v67
    v_lshrrev_b32 v25, 3, v26
    v_lshl_add_u32 v67, v25, 15, v67
    v_and_b32 v25, 1, v24
    v_lshl_add_u32 v67, v25, 6, v67
    s_mov_b32 s77, 16384
    s_call_b64 s[82:83], cf_dma
    v_and_b32 v25, 31, v0
    v_lshlrev_b32 v70, 4, v25
    v_lshlrev_b32 v28, 3, v25
    v_add_u32 v28, 108032, v28
    v_lshrrev_b32 v25, 1, v24
    v_lshl_add_u32 v70, v25, 9, v70
    v_and_b32 v25, 1, v24
    v_lshl_add_u32 v70, v25, 3, v70
    v_add_u32 v70, 109568, v70
    v_cmp_gt_u32 vcc, 2, v27
    s_nop 1
    v_cndmask_b32 v70, v70, v28, vcc
    v_xor_b32 v71, 2048, v63
    v_lshrrev_b32 v68, 4, v0
    v_lshlrev_b32 v68, 7, v68
    v_and_b32 v25, 7, v26
    v_lshl_add_u32 v68, v25, 4, v68
    v_add_u32 v68, 98304, v68
    v_xor_b32 v74, 512, v68
    v_xor_b32 v75, 1024, v68
    v_xor_b32 v76, 1536, v68
    v_lshrrev_b32 v25, 3, v26
    v_lshl_add_u32 v77, v25, 3, v68
    v_or_b32 v78, 512, v65
    v_lshlrev_b32 v79, 2, v61
    v_mov_b64 v[72:73], 0
    v_and_b32 v25, 1, v27
    v_lshlrev_b32 v69, 7, v25
    v_lshrrev_b32 v25, 1, v27
    v_lshl_add_u32 v69, v25, 3, v69
    v_and_b32 v25, 3, v26
    v_lshl_add_u32 v69, v25, 4, v69
    v_bfe_u32 v25, v26, 2, 1
    v_lshl_add_u32 v69, v25, 2, v69
    s_mov_b32 s32, 0x00ff00ff
    s_mov_b32 s33, 0x00ff00ff
    s_not_b64 s[34:35], s[32:33]
    s_lshr_b32 s31, s12, 1
    s_lshl_b32 s31, s31, 8
    s_and_b32 s40, s12, 1
    s_lshl_b32 s40, s40, 6
    s_add_u32 s31, s31, s40
    s_and_b32 s40, s13, 1
    s_lshl_b32 s40, s40, 12
    s_add_u32 s31, s31, s40
    s_lshl_b32 s19, s12, 14
    s_add_u32 s19, s19, 67076096
    s_add_u32 s41, s19, 8192
    s_add_u32 s19, s19, s40
    s_and_b32 s40, s12, 1
    s_lshl_b32 s40, s40, 2
    s_or_b32 s40, s40, s13
    s_cmp_eq_u32 s40, 5
    s_cselect_b32 s64, 0, s13
    s_cmp_lg_u32 s13, 1
    s_cbranch_scc1 cf_notx
    s_mov_b32 s32, 0xff
    s_mov_b32 s33, 0xff
    s_mov_b32 s19, s41
    s_lshr_b32 s31, s12, 3
    s_lshl_b32 s31, s31, 8
    s_and_b32 s40, s12, 2
    s_lshl_b32 s40, s40, 6
    s_add_u32 s31, s31, s40
    s_and_b32 s40, s12, 4
    s_lshl_b32 s40, s40, 4
    s_add_u32 s31, s31, s40
    s_add_u32 s31, s31, 8192
cf_notx:
    s_cmp_lg_u32 s13, 0
    s_cbranch_scc1 cf_notp
    s_min_u32 s40, s12, 23
    s_mul_i32 s40, s40, 384
    s_add_u32 s40, s40, 98304
    v_add_u32 v69, s40, v61
    v_mov_b32 v25, 108288
    v_cmp_lt_u32 vcc, 23, v0
    s_nop 1
    v_cndmask_b32 v69, v69, v25, vcc
cf_notp:
    s_nop 1
    v_mov_b32 v28, 1
    v_mov_b32 v29, 1
    v_mov_b32 v30, 1
    v_mov_b32 v31, 1
    s_lshl_b32 s40, s12, 14
    s_add_u32 s40, s40, 67174400
    s_add_u32 s41, s40, 0
    buffer_store_dwordx4 v[28:31], v61, s[4:7], s41 offen
    s_add_u32 s41, s40, 4096
    buffer_store_dwordx4 v[28:31], v61, s[4:7], s41 offen
    s_add_u32 s41, s40, 8192
    buffer_store_dwordx4 v[28:31], v61, s[4:7], s41 offen
    s_cmp_eq_u32 s64, 0
    s_cselect_b64 exec, 0, s[32:33]
    v_mov_b32 v27, -1
    s_add_u32 s41, s31, 67108864
    buffer_store_dword v27, v69, s[4:7], s41 offen
    s_add_u32 s41, s31, 67125248
    buffer_store_dword v27, v69, s[4:7], s41 offen
    s_add_u32 s41, s31, 67141632
    buffer_store_dword v27, v69, s[4:7], s41 offen
    s_add_u32 s41, s31, 67158016
    buffer_store_dword v27, v69, s[4:7], s41 offen
    s_mov_b64 exec, -1
    s_mov_b64 s[68:69], s[48:49]
    s_mov_b32 s70, 9216
    s_mov_b32 s71, 0x20000
    v_and_b32 v25, 7, v0
    v_mul_u32_u24 v25, 1152, v25
    v_lshrrev_b32 v26, 3, v0
    v_lshl_add_u32 v25, v26, 4, v25
    buffer_load_dwordx4 v[36:39], v25, s[68:71], 0 offen
    buffer_load_dwordx4 v[40:43], v25, s[68:71], 0 offen offset:512
    v_bfe_u32 v25, v0, 2, 3
    v_mul_u32_u24 v25, 1152, v25
    v_lshrrev_b32 v26, 5, v0
    v_lshl_add_u32 v25, v26, 4, v25
    v_and_b32 v26, 3, v0
    v_lshl_add_u32 v25, v26, 2, v25
    buffer_load_dword v44, v25, s[68:71], 0 offen offset:1024
    s_waitcnt vmcnt(15)
    v_add_u32 v55, 114688, v52
    ds_read_b64_tr_b16 v[160:161], v55 offset:0
    ds_read_b64_tr_b16 v[162:163], v55 offset:256
    ds_read_b64_tr_b16 v[164:165], v55 offset:4096
    ds_read_b64_tr_b16 v[166:167], v55 offset:4352
    s_xor_b32 s94, s13, 0
    s_mul_i32 s94, s94, 36864
    s_add_u32 s94, s94, s92
    s_lshl_b32 s74, s13, 7
    s_add_u32 s94, s94, s74
    s_add_u32 s78, s94, 512
    s_add_u32 s80, s66, 147456
    s_mov_b32 s76, 0
    s_mov_b32 s77, 8192
    s_call_b64 s[82:83], cf_dma
    ds_read_b64_tr_b16 v[192:193], v55 offset:64
    ds_read_b64_tr_b16 v[194:195], v55 offset:320
    ds_read_b64_tr_b16 v[196:197], v55 offset:4160
    ds_read_b64_tr_b16 v[198:199], v55 offset:4416
    s_mov_b32 s77, 16384
    s_call_b64 s[82:83], cf_dma
    s_waitcnt lgkmcnt(0)
    s_waitcnt vmcnt(15)
    v_add_u32 v55, 81920, v52
    ds_read_b64_tr_b16 v[168:169], v55 offset:0
    ds_read_b64_tr_b16 v[170:171], v55 offset:256
    ds_read_b64_tr_b16 v[172:173], v55 offset:4096
    ds_read_b64_tr_b16 v[174:175], v55 offset:4352
    s_xor_b32 s94, s13, 1
    s_mul_i32 s94, s94, 36864
    s_add_u32 s94, s94, s92
    s_lshl_b32 s74, s13, 7
    s_add_u32 s94, s94, s74
    s_add_u32 s78, s94, 512
    s_add_u32 s80, s66, 98304
    s_mov_b32 s76, 0
    s_mov_b32 s77, 8192
    s_call_b64 s[82:83], cf_dma
    ds_read_b64_tr_b16 v[200:201], v55 offset:64
    ds_read_b64_tr_b16 v[202:203], v55 offset:320
    ds_read_b64_tr_b16 v[204:205], v55 offset:4160
    ds_read_b64_tr_b16 v[206:207], v55 offset:4416
    s_mov_b32 s77, 16384
    s_call_b64 s[82:83], cf_dma
    s_waitcnt lgkmcnt(0)
    s_waitcnt vmcnt(15)
    v_add_u32 v55, 16384, v52
    ds_read_b64_tr_b16 v[176:177], v55 offset:0
    ds_read_b64_tr_b16 v[178:179], v55 offset:256
    ds_read_b64_tr_b16 v[180:181], v55 offset:4096
    ds_read_b64_tr_b16 v[182:183], v55 offset:4352
    s_add_u32 s78, s67, 4194304
    s_mov_b64 s[8:9], s[54:55]
    v_mov_b32 v58, v48
    s_mov_b32 s79, 131072
    s_add_u32 s80, s66, 32768
    s_mov_b32 s76, 0
    s_mov_b32 s77, 8192
    s_call_b64 s[82:83], cf_dma
    ds_read_b64_tr_b16 v[208:209], v55 offset:64
    ds_read_b64_tr_b16 v[210:211], v55 offset:320
    ds_read_b64_tr_b16 v[212:213], v55 offset:4160
    ds_read_b64_tr_b16 v[214:215], v55 offset:4416
    s_mov_b32 s77, 16384
    s_call_b64 s[82:83], cf_dma
    s_waitcnt lgkmcnt(0)
    s_waitcnt vmcnt(15)
    v_add_u32 v55, 0, v52
    ds_read_b64_tr_b16 v[184:185], v55 offset:0
    ds_read_b64_tr_b16 v[186:187], v55 offset:256
    ds_read_b64_tr_b16 v[188:189], v55 offset:4096
    ds_read_b64_tr_b16 v[190:191], v55 offset:4352
    s_xor_b32 s78, s75, 0
    s_add_u32 s78, s78, s67
    s_mov_b32 s81, s93
    s_add_u32 s80, s66, 114688
    s_mov_b32 s76, 0
    s_mov_b32 s77, 8192
    s_call_b64 s[82:83], cf_dma
    ds_read_b64_tr_b16 v[216:217], v55 offset:64
    ds_read_b64_tr_b16 v[218:219], v55 offset:320
    ds_read_b64_tr_b16 v[220:221], v55 offset:4160
    ds_read_b64_tr_b16 v[222:223], v55 offset:4416
    s_mov_b32 s77, 16384
    s_call_b64 s[82:83], cf_dma
    s_waitcnt lgkmcnt(0)
    s_waitcnt vmcnt(12)
    v_add_u32 v55, 147456, v52
    ds_read_b64_tr_b16 v[224:225], v55 offset:0
    ds_read_b64_tr_b16 v[226:227], v55 offset:256
    ds_read_b64_tr_b16 v[228:229], v55 offset:4096
    ds_read_b64_tr_b16 v[230:231], v55 offset:4352
    s_mov_b32 s77, 24576
    s_call_b64 s[82:83], cf_dma
    ds_read_b64_tr_b16 v[240:241], v55 offset:64
    ds_read_b64_tr_b16 v[242:243], v55 offset:320
    ds_read_b64_tr_b16 v[244:245], v55 offset:4160
    ds_read_b64_tr_b16 v[246:247], v55 offset:4416
    s_mov_b32 s77, 32768
    s_call_b64 s[82:83], cf_dma
    s_waitcnt lgkmcnt(0)
    v_min_u32 v36, -2, v36
    v_min_u32 v37, -2, v37
    v_min_u32 v38, -2, v38
    v_min_u32 v39, -2, v39
    v_min_u32 v40, -2, v40
    v_min_u32 v41, -2, v41
    v_min_u32 v42, -2, v42
    v_min_u32 v43, -2, v43
    v_min_u32 v44, -2, v44
    s_lshl_b32 s14, s12, 16
    s_add_u32 s14, s14, 92274688
    s_add_u32 s41, s14, 4096
    s_add_u32 s42, s14, 8192
    v_lshrrev_b32 v45, 2, v61
    buffer_store_dwordx4 v[36:39], v61, s[4:7], s14 offen
    buffer_store_dwordx4 v[40:43], v61, s[4:7], s41 offen
    buffer_store_dword v44, v45, s[4:7], s42 offen
    v_mov_b32 v46, 1
    s_mov_b64 exec, 1
    buffer_atomic_add v46, off, s[96:99], 0 offset:132 sc0
    s_mov_b64 exec, -1
    s_mov_b32 s44, 0x3e0293ee
    s_mov_b32 s45, s44
    s_mov_b32 s46, 0x42000000
    s_mov_b32 s60, 0x3f803f80
    s_mov_b32 s61, s60
    s_mov_b32 s62, 0x3e803e80
    s_mov_b32 s63, s62
    s_mov_b32 s28, 0
    s_lshl_b32 s24, s12, 14
    s_add_u32 s24, s24, 0
    s_add_u32 s47, s24, 33030144
    s_mul_i32 s40, s13, 3072
    s_add_u32 s23, s24, s40
    s_lshl_b32 s20, s12, 7
    s_add_u32 s20, s20, 67174400
    s_add_u32 s21, s20, 65536
    s_add_u32 s38, s20, 4096
    s_add_u32 s39, s21, 4096
    s_lshl_b32 s22, s12, 7
    s_add_u32 s22, s22, 67182592
    s_lshl_b32 s40, s12, 12
    s_add_u32 s25, s40, 79429632
    s_add_u32 s26, s40, 88866816
    s_lshl_b32 s65, s12, 9
    s_add_u32 s65, s65, 90177536
    s_lshl_b32 s40, s13, 5
    s_or_b32 s40, s40, s12
    s_cmp_lt_u32 s40, 24
    s_cselect_b32 s36, 0x1ffffff, 0
    s_mov_b32 s37, 0
    s_lshl_b32 s27, s12, 7
    s_add_u32 s27, s27, 125845504
    s_lshl_b32 s40, s13, 2
    s_add_u32 s27, s27, s40
    v_bfe_u32 v24, v61, 4, 4
    v_bfe_u32 v25, v61, 8, 1
    v_lshlrev_b32 v25, 2, v25
    v_sub_u32 v25, v24, v25
    v_mov_b32 v26, 0x3f80
    v_mov_b32 v27, 0x3f800000
    v_cmp_eq_u32 vcc, 0, v25
    s_nop 1
    v_cndmask_b32 v16, 0, v26, vcc
    v_cmp_eq_u32 vcc, 1, v25
    s_nop 1
    v_cndmask_b32 v16, v16, v27, vcc
    v_cmp_eq_u32 vcc, 0, v24
    s_nop 1
    v_cndmask_b32 v20, 0, v26, vcc
    v_cmp_eq_u32 vcc, 1, v24
    s_nop 1
    v_cndmask_b32 v20, v20, v27, vcc
    v_cmp_eq_u32 vcc, 2, v25
    s_nop 1
    v_cndmask_b32 v17, 0, v26, vcc
    v_cmp_eq_u32 vcc, 3, v25
    s_nop 1
    v_cndmask_b32 v17, v17, v27, vcc
    v_cmp_eq_u32 vcc, 2, v24
    s_nop 1
    v_cndmask_b32 v21, 0, v26, vcc
    v_cmp_eq_u32 vcc, 3, v24
    s_nop 1
    v_cndmask_b32 v21, v21, v27, vcc
    v_cmp_eq_u32 vcc, 8, v25
    s_nop 1
    v_cndmask_b32 v18, 0, v26, vcc
    v_cmp_eq_u32 vcc, 9, v25
    s_nop 1
    v_cndmask_b32 v18, v18, v27, vcc
    v_cmp_eq_u32 vcc, 4, v24
    s_nop 1
    v_cndmask_b32 v22, 0, v26, vcc
    v_cmp_eq_u32 vcc, 5, v24
    s_nop 1
    v_cndmask_b32 v22, v22, v27, vcc
    v_cmp_eq_u32 vcc, 10, v25
    s_nop 1
    v_cndmask_b32 v19, 0, v26, vcc
    v_cmp_eq_u32 vcc, 11, v25
    s_nop 1
    v_cndmask_b32 v19, v19, v27, vcc
    v_cmp_eq_u32 vcc, 6, v24
    s_nop 1
    v_cndmask_b32 v23, 0, v26, vcc
    v_cmp_eq_u32 vcc, 7, v24
    s_nop 1
    v_cndmask_b32 v23, v23, v27, vcc
    s_waitcnt vmcnt(13)
    v_add_u32 v55, 98304, v52
    ds_read_b64_tr_b16 v[232:233], v55 offset:0
    ds_read_b64_tr_b16 v[234:235], v55 offset:256
    ds_read_b64_tr_b16 v[236:237], v55 offset:4096
    ds_read_b64_tr_b16 v[238:239], v55 offset:4352
    s_xor_b32 s78, s75, 1048576
    s_add_u32 s78, s78, s67
    s_add_u32 s80, s66, 65536
    s_mov_b32 s76, 0
    s_mov_b32 s77, 8192
    s_call_b64 s[82:83], cf_dma
    ds_read_b64_tr_b16 v[248:249], v55 offset:64
    ds_read_b64_tr_b16 v[250:251], v55 offset:320
    ds_read_b64_tr_b16 v[252:253], v55 offset:4160
    ds_read_b64_tr_b16 v[254:255], v55 offset:4416
    s_mov_b32 s77, 16384
    s_call_b64 s[82:83], cf_dma
    s_waitcnt lgkmcnt(0)
    s_waitcnt vmcnt(13)
    v_add_u32 v55, 32768, v51
    v_xor_b32 v56, 32, v55
    ds_read_b64_tr_b16 v[144:145], v55 offset:0
    ds_read_b64_tr_b16 v[146:147], v55 offset:256
    ds_read_b64_tr_b16 v[148:149], v55 offset:8192
    ds_read_b64_tr_b16 v[150:151], v55 offset:8448
    s_mov_b32 s77, 24576
    s_call_b64 s[82:83], cf_dma
    ds_read_b64_tr_b16 v[152:153], v56 offset:0
    ds_read_b64_tr_b16 v[154:155], v56 offset:256
    ds_read_b64_tr_b16 v[156:157], v56 offset:8192
    ds_read_b64_tr_b16 v[158:159], v56 offset:8448
    s_mov_b32 s77, 32768
    s_call_b64 s[82:83], cf_dma
    s_waitcnt lgkmcnt(0)
    s_waitcnt vmcnt(9)
    v_add_u32 v55, 114688, v51
    v_xor_b32 v56, 32, v55
    ds_read_b64_tr_b16 a[192:193], v55 offset:0
    ds_read_b64_tr_b16 a[194:195], v55 offset:256
    ds_read_b64_tr_b16 a[196:197], v55 offset:8192
    ds_read_b64_tr_b16 a[198:199], v55 offset:8448
    s_xor_b32 s78, s75, 2097152
    s_add_u32 s78, s78, s67
    s_add_u32 s80, s66, 0
    s_mov_b32 s76, 0
    s_mov_b32 s77, 8192
    s_call_b64 s[82:83], cf_dma
    ds_read_b64_tr_b16 a[200:201], v56 offset:0
    ds_read_b64_tr_b16 a[202:203], v56 offset:256
    ds_read_b64_tr_b16 a[204:205], v56 offset:8192
    ds_read_b64_tr_b16 a[206:207], v56 offset:8448
    s_mov_b32 s77, 16384
    s_call_b64 s[82:83], cf_dma
    s_waitcnt lgkmcnt(0)
    v_add_u32 v55, 131072, v51
    v_xor_b32 v56, 32, v55
    ds_read_b64_tr_b16 a[208:209], v55 offset:0
    ds_read_b64_tr_b16 a[210:211], v55 offset:256
    ds_read_b64_tr_b16 a[212:213], v55 offset:8192
    ds_read_b64_tr_b16 a[214:215], v55 offset:8448
    s_mov_b32 s77, 24576
    s_call_b64 s[82:83], cf_dma
    ds_read_b64_tr_b16 a[216:217], v56 offset:0
    ds_read_b64_tr_b16 a[218:219], v56 offset:256
    ds_read_b64_tr_b16 a[220:221], v56 offset:8192
    ds_read_b64_tr_b16 a[222:223], v56 offset:8448
    s_mov_b32 s77, 32768
    s_call_b64 s[82:83], cf_dma
    s_waitcnt lgkmcnt(0)
    s_waitcnt vmcnt(8)
    v_add_u32 v55, 65536, v51
    v_xor_b32 v56, 32, v55
    ds_read_b64_tr_b16 a[224:225], v55 offset:0
    ds_read_b64_tr_b16 a[226:227], v55 offset:256
    ds_read_b64_tr_b16 a[228:229], v55 offset:8192
    ds_read_b64_tr_b16 a[230:231], v55 offset:8448
    s_cmp_eq_u32 s88, 0
    s_cbranch_scc1 cf_cpe658
    s_lshl_b32 s89, s73, 7
    s_add_u32 s89, s89, 125853696
    v_min_u32 v33, 11, v57
    v_lshlrev_b32 v33, 2, v33
    buffer_load_dword v34, off, s[96:99], 0 offset:64 sc1
    buffer_load_dword v35, v33, s[4:7], s89 offen sc1
cf_cpe658:
    s_xor_b32 s78, s75, 3145728
    s_add_u32 s78, s78, s67
    s_add_u32 s80, s66, 32768
    s_mov_b32 s76, 0
    s_mov_b32 s77, 8192
    s_call_b64 s[82:83], cf_dma
    ds_read_b64_tr_b16 a[232:233], v56 offset:0
    ds_read_b64_tr_b16 a[234:235], v56 offset:256
    ds_read_b64_tr_b16 a[236:237], v56 offset:8192
    ds_read_b64_tr_b16 a[238:239], v56 offset:8448
    s_mov_b32 s77, 16384
    s_call_b64 s[82:83], cf_dma
    s_waitcnt lgkmcnt(0)
    v_add_u32 v55, 81920, v51
    v_xor_b32 v56, 32, v55
    ds_read_b64_tr_b16 a[240:241], v55 offset:0
    ds_read_b64_tr_b16 a[242:243], v55 offset:256
    ds_read_b64_tr_b16 a[244:245], v55 offset:8192
    ds_read_b64_tr_b16 a[246:247], v55 offset:8448
    s_mov_b32 s77, 24576
    s_call_b64 s[82:83], cf_dma
    ds_read_b64_tr_b16 a[248:249], v56 offset:0
    ds_read_b64_tr_b16 a[250:251], v56 offset:256
    ds_read_b64_tr_b16 a[252:253], v56 offset:8192
    ds_read_b64_tr_b16 a[254:255], v56 offset:8448
    s_mov_b32 s77, 32768
    s_call_b64 s[82:83], cf_dma
    s_waitcnt lgkmcnt(0)
    v_readfirstlane_b32 s41, v46
    v_mov_b32 v36, 1
    v_mov_b32 v37, 0
    s_cmp_eq_u32 s41, 127
    s_cselect_b64 exec, 1, 0
    buffer_atomic_cmpswap v[36:37], off, s[96:99], 0 offset:140
    s_mov_b64 exec, -1
    s_waitcnt vmcnt(8)
    v_add_u32 v55, 0, v51
    v_xor_b32 v56, 32, v55
    ds_read_b64_tr_b16 v[80:81], v55 offset:0
    ds_read_b64_tr_b16 v[82:83], v55 offset:256
    ds_read_b64_tr_b16 v[84:85], v55 offset:8192
    ds_read_b64_tr_b16 v[86:87], v55 offset:8448
    s_cmp_eq_u32 s88, 0
    s_cbranch_scc1 cf_ncp709
    s_waitcnt vmcnt(8)
    v_max_u32 v34, 1, v34
    v_cmp_eq_u32 vcc, 1, v34
    s_cbranch_vccnz cf_ncp709
    v_cmp_ne_u32 vcc, v34, v35
    s_cbranch_vccnz cf_ncp709
    s_mov_b32 s88, 0
    s_mov_b32 s72, 5
    s_lshl_b32 s74, s73, 19
    s_add_u32 s74, s74, 96468992
    s_add_u32 s50, s4, s74
    s_addc_u32 s51, s5, 0
    s_add_u32 s52, s50, 147456
    s_addc_u32 s53, s51, 0
    s_lshl_b32 s67, s13, 6
    v_and_b32 v54, 63, v48
    v_lshrrev_b32 v48, 13, v48
    v_lshl_add_u32 v48, v48, 8, v54
cf_ncp709:
    s_cmp_eq_u32 s88, 0
    s_cbranch_scc1 cf_cpe730
    s_lshl_b32 s89, s73, 7
    s_add_u32 s89, s89, 125853696
    v_min_u32 v33, 11, v57
    v_lshlrev_b32 v33, 2, v33
    buffer_load_dword v34, off, s[96:99], 0 offset:64 sc1
    buffer_load_dword v35, v33, s[4:7], s89 offen sc1
cf_cpe730:
    s_xor_b32 s78, s75, 2097152
    s_lshr_b32 s78, s78, s72
    s_add_u32 s78, s78, s67
    s_mov_b64 s[8:9], s[52:53]
    v_mov_b32 v58, v48
    s_lshr_b32 s79, 131072, s72
    s_add_u32 s80, s66, 131072
    s_mov_b32 s76, 0
    s_mov_b32 s77, 8192
    s_call_b64 s[82:83], cf_dma
    ds_read_b64_tr_b16 v[88:89], v56 offset:0
    ds_read_b64_tr_b16 v[90:91], v56 offset:256
    ds_read_b64_tr_b16 v[92:93], v56 offset:8192
    ds_read_b64_tr_b16 v[94:95], v56 offset:8448
    s_mov_b32 s77, 16384
    s_call_b64 s[82:83], cf_dma
    s_waitcnt lgkmcnt(0)
    v_add_u32 v55, 16384, v51
    v_xor_b32 v56, 32, v55
    ds_read_b64_tr_b16 v[96:97], v55 offset:0
    ds_read_b64_tr_b16 v[98:99], v55 offset:256
    ds_read_b64_tr_b16 v[100:101], v55 offset:8192
    ds_read_b64_tr_b16 v[102:103], v55 offset:8448
    s_mov_b32 s77, 24576
    s_call_b64 s[82:83], cf_dma
    ds_read_b64_tr_b16 v[104:105], v56 offset:0
    ds_read_b64_tr_b16 v[106:107], v56 offset:256
    ds_read_b64_tr_b16 v[108:109], v56 offset:8192
    ds_read_b64_tr_b16 v[110:111], v56 offset:8448
    s_mov_b32 s77, 32768
    s_call_b64 s[82:83], cf_dma
    s_waitcnt lgkmcnt(0)
    s_waitcnt vmcnt(8)
    v_add_u32 v55, 32768, v51
    v_xor_b32 v56, 32, v55
    ds_read_b64_tr_b16 v[112:113], v55 offset:0
    ds_read_b64_tr_b16 v[114:115], v55 offset:256
    ds_read_b64_tr_b16 v[116:117], v55 offset:8192
    ds_read_b64_tr_b16 v[118:119], v55 offset:8448
    s_cmp_eq_u32 s88, 0
    s_cbranch_scc1 cf_ncp778
    s_waitcnt vmcnt(8)
    v_max_u32 v34, 1, v34
    v_cmp_eq_u32 vcc, 1, v34
    s_cbranch_vccnz cf_ncp778
    v_cmp_ne_u32 vcc, v34, v35
    s_cbranch_vccnz cf_ncp778
    s_mov_b32 s88, 0
    s_mov_b32 s72, 5
    s_lshl_b32 s74, s73, 19
    s_add_u32 s74, s74, 96468992
    s_add_u32 s50, s4, s74
    s_addc_u32 s51, s5, 0
    s_add_u32 s52, s50, 147456
    s_addc_u32 s53, s51, 0
    s_lshl_b32 s67, s13, 6
    v_and_b32 v54, 63, v48
    v_lshrrev_b32 v48, 13, v48
    v_lshl_add_u32 v48, v48, 8, v54
cf_ncp778:
    s_cmp_eq_u32 s88, 0
    s_cbranch_scc1 cf_cpe799
    s_lshl_b32 s89, s73, 7
    s_add_u32 s89, s89, 125853696
    v_min_u32 v33, 11, v57
    v_lshlrev_b32 v33, 2, v33
    buffer_load_dword v34, off, s[96:99], 0 offset:64 sc1
    buffer_load_dword v35, v33, s[4:7], s89 offen sc1
cf_cpe799:
    s_xor_b32 s78, s75, 3145728
    s_lshr_b32 s78, s78, s72
    s_add_u32 s78, s78, s67
    s_mov_b64 s[8:9], s[52:53]
    v_mov_b32 v58, v48
    s_lshr_b32 s79, 131072, s72
    s_add_u32 s80, s66, 65536
    s_mov_b32 s76, 0
    s_mov_b32 s77, 8192
    s_call_b64 s[82:83], cf_dma
    ds_read_b64_tr_b16 v[120:121], v56 offset:0
    ds_read_b64_tr_b16 v[122:123], v56 offset:256
    ds_read_b64_tr_b16 v[124:125], v56 offset:8192
    ds_read_b64_tr_b16 v[126:127], v56 offset:8448
    s_mov_b32 s77, 16384
    s_call_b64 s[82:83], cf_dma
    s_waitcnt lgkmcnt(0)
    v_add_u32 v55, 49152, v51
    v_xor_b32 v56, 32, v55
    ds_read_b64_tr_b16 v[128:129], v55 offset:0
    ds_read_b64_tr_b16 v[130:131], v55 offset:256
    ds_read_b64_tr_b16 v[132:133], v55 offset:8192
    ds_read_b64_tr_b16 v[134:135], v55 offset:8448
    s_mov_b32 s77, 24576
    s_call_b64 s[82:83], cf_dma
    ds_read_b64_tr_b16 v[136:137], v56 offset:0
    ds_read_b64_tr_b16 v[138:139], v56 offset:256
    ds_read_b64_tr_b16 v[140:141], v56 offset:8192
    ds_read_b64_tr_b16 v[142:143], v56 offset:8448
    s_mov_b32 s77, 32768
    s_call_b64 s[82:83], cf_dma
    s_waitcnt lgkmcnt(0)
    s_waitcnt vmcnt(8)
    v_add_u32 v55, 131072, v51
    v_xor_b32 v56, 32, v55
    ds_read_b64_tr_b16 a[128:129], v55 offset:0
    ds_read_b64_tr_b16 a[130:131], v55 offset:256
    ds_read_b64_tr_b16 a[132:133], v55 offset:8192
    ds_read_b64_tr_b16 a[134:135], v55 offset:8448
    s_cmp_eq_u32 s88, 0
    s_cbranch_scc1 cf_ncp847
    s_waitcnt vmcnt(8)
    v_max_u32 v34, 1, v34
    v_cmp_eq_u32 vcc, 1, v34
    s_cbranch_vccnz cf_ncp847
    v_cmp_ne_u32 vcc, v34, v35
    s_cbranch_vccnz cf_ncp847
    s_mov_b32 s88, 0
    s_mov_b32 s72, 5
    s_lshl_b32 s74, s73, 19
    s_add_u32 s74, s74, 96468992
    s_add_u32 s50, s4, s74
    s_addc_u32 s51, s5, 0
    s_add_u32 s52, s50, 147456
    s_addc_u32 s53, s51, 0
    s_lshl_b32 s67, s13, 6
    v_and_b32 v54, 63, v48
    v_lshrrev_b32 v48, 13, v48
    v_lshl_add_u32 v48, v48, 8, v54
cf_ncp847:
    s_cmp_eq_u32 s88, 0
    s_cbranch_scc1 cf_cpe868
    s_lshl_b32 s89, s73, 7
    s_add_u32 s89, s89, 125853696
    v_min_u32 v33, 11, v57
    v_lshlrev_b32 v33, 2, v33
    buffer_load_dword v34, off, s[96:99], 0 offset:64 sc1
    buffer_load_dword v35, v33, s[4:7], s89 offen sc1
cf_cpe868:
    s_xor_b32 s78, s75, 2097152
    s_lshr_b32 s78, s78, s72
    s_add_u32 s78, s78, s67
    s_mov_b64 s[8:9], s[50:51]
    v_mov_b32 v58, v48
    s_lshr_b32 s79, 131072, s72
    s_add_u32 s80, s66, 0
    s_mov_b32 s76, 0
    s_mov_b32 s77, 8192
    s_call_b64 s[82:83], cf_dma
    ds_read_b64_tr_b16 a[136:137], v56 offset:0
    ds_read_b64_tr_b16 a[138:139], v56 offset:256
    ds_read_b64_tr_b16 a[140:141], v56 offset:8192
    ds_read_b64_tr_b16 a[142:143], v56 offset:8448
    s_mov_b32 s77, 16384
    s_call_b64 s[82:83], cf_dma
    s_waitcnt lgkmcnt(0)
    v_add_u32 v55, 147456, v51
    v_xor_b32 v56, 32, v55
    ds_read_b64_tr_b16 a[144:145], v55 offset:0
    ds_read_b64_tr_b16 a[146:147], v55 offset:256
    ds_read_b64_tr_b16 a[148:149], v55 offset:8192
    ds_read_b64_tr_b16 a[150:151], v55 offset:8448
    s_mov_b32 s77, 24576
    s_call_b64 s[82:83], cf_dma
    ds_read_b64_tr_b16 a[152:153], v56 offset:0
    ds_read_b64_tr_b16 a[154:155], v56 offset:256
    ds_read_b64_tr_b16 a[156:157], v56 offset:8192
    ds_read_b64_tr_b16 a[158:159], v56 offset:8448
    s_mov_b32 s77, 32768
    s_call_b64 s[82:83], cf_dma
    s_waitcnt lgkmcnt(0)
    s_waitcnt vmcnt(8)
    v_add_u32 v55, 65536, v51
    v_xor_b32 v56, 32, v55
    ds_read_b64_tr_b16 a[160:161], v55 offset:0
    ds_read_b64_tr_b16 a[162:163], v55 offset:256
    ds_read_b64_tr_b16 a[164:165], v55 offset:8192
    ds_read_b64_tr_b16 a[166:167], v55 offset:8448
    s_cmp_eq_u32 s88, 0
    s_cbranch_scc1 cf_ncp916
    s_waitcnt vmcnt(8)
    v_max_u32 v34, 1, v34
    v_cmp_eq_u32 vcc, 1, v34
    s_cbranch_vccnz cf_ncp916
    v_cmp_ne_u32 vcc, v34, v35
    s_cbranch_vccnz cf_ncp916
    s_mov_b32 s88, 0
    s_mov_b32 s72, 5
    s_lshl_b32 s74, s73, 19
    s_add_u32 s74, s74, 96468992
    s_add_u32 s50, s4, s74
    s_addc_u32 s51, s5, 0
    s_add_u32 s52, s50, 147456
    s_addc_u32 s53, s51, 0
    s_lshl_b32 s67, s13, 6
    v_and_b32 v54, 63, v48
    v_lshrrev_b32 v48, 13, v48
    v_lshl_add_u32 v48, v48, 8, v54
cf_ncp916:
    s_cmp_eq_u32 s88, 0
    s_cbranch_scc1 cf_cpe937
    s_lshl_b32 s89, s73, 7
    s_add_u32 s89, s89, 125853696
    v_min_u32 v33, 11, v57
    v_lshlrev_b32 v33, 2, v33
    buffer_load_dword v34, off, s[96:99], 0 offset:64 sc1
    buffer_load_dword v35, v33, s[4:7], s89 offen sc1
cf_cpe937:
    s_xor_b32 s78, s75, 3145728
    s_lshr_b32 s78, s78, s72
    s_add_u32 s78, s78, s67
    s_mov_b64 s[8:9], s[50:51]
    v_mov_b32 v58, v48
    s_lshr_b32 s79, 131072, s72
    s_add_u32 s80, s66, 32768
    s_mov_b32 s76, 0
    s_mov_b32 s77, 8192
    s_call_b64 s[82:83], cf_dma
    ds_read_b64_tr_b16 a[168:169], v56 offset:0
    ds_read_b64_tr_b16 a[170:171], v56 offset:256
    ds_read_b64_tr_b16 a[172:173], v56 offset:8192
    ds_read_b64_tr_b16 a[174:175], v56 offset:8448
    s_mov_b32 s77, 16384
    s_call_b64 s[82:83], cf_dma
    s_waitcnt lgkmcnt(0)
    v_add_u32 v55, 81920, v51
    v_xor_b32 v56, 32, v55
    ds_read_b64_tr_b16 a[176:177], v55 offset:0
    ds_read_b64_tr_b16 a[178:179], v55 offset:256
    ds_read_b64_tr_b16 a[180:181], v55 offset:8192
    ds_read_b64_tr_b16 a[182:183], v55 offset:8448
    s_mov_b32 s77, 24576
    s_call_b64 s[82:83], cf_dma
    ds_read_b64_tr_b16 a[184:185], v56 offset:0
    ds_read_b64_tr_b16 a[186:187], v56 offset:256
    ds_read_b64_tr_b16 a[188:189], v56 offset:8192
    ds_read_b64_tr_b16 a[190:191], v56 offset:8448
    s_mov_b32 s77, 32768
    s_call_b64 s[82:83], cf_dma
    s_waitcnt lgkmcnt(0)
    s_waitcnt vmcnt(8)
    v_add_u32 v55, 0, v51
    v_xor_b32 v56, 32, v55
    ds_read_b64_tr_b16 a[48:49], v55 offset:0
    ds_read_b64_tr_b16 a[50:51], v55 offset:256
    ds_read_b64_tr_b16 a[52:53], v55 offset:8192
    ds_read_b64_tr_b16 a[54:55], v55 offset:8448
    s_lshr_b32 s78, 4194304, s72
    s_add_u32 s78, s78, s67
    s_mov_b32 s81, 0
    s_add_u32 s80, s66, 98304
    s_mov_b32 s76, 0
    s_mov_b32 s77, 8192
    s_call_b64 s[82:83], cf_dma
    ds_read_b64_tr_b16 a[56:57], v56 offset:0
    ds_read_b64_tr_b16 a[58:59], v56 offset:256
    ds_read_b64_tr_b16 a[60:61], v56 offset:8192
    ds_read_b64_tr_b16 a[62:63], v56 offset:8448
    s_mov_b32 s77, 16384
    s_call_b64 s[82:83], cf_dma
    s_waitcnt lgkmcnt(0)
    v_add_u32 v55, 16384, v51
    v_xor_b32 v56, 32, v55
    ds_read_b64_tr_b16 a[64:65], v55 offset:0
    ds_read_b64_tr_b16 a[66:67], v55 offset:256
    ds_read_b64_tr_b16 a[68:69], v55 offset:8192
    ds_read_b64_tr_b16 a[70:71], v55 offset:8448
    s_cmp_eq_u32 s88, 0
    s_cbranch_scc1 cf_ncp1005
    s_waitcnt vmcnt(12)
    v_max_u32 v34, 1, v34
    v_cmp_eq_u32 vcc, 1, v34
    s_cbranch_vccnz cf_ncp1005
    v_cmp_ne_u32 vcc, v34, v35
    s_cbranch_vccnz cf_ncp1005
    s_mov_b32 s88, 0
    s_mov_b32 s72, 5
    s_lshl_b32 s74, s73, 19
    s_add_u32 s74, s74, 96468992
    s_add_u32 s50, s4, s74
    s_addc_u32 s51, s5, 0
    s_add_u32 s52, s50, 147456
    s_addc_u32 s53, s51, 0
    s_lshl_b32 s67, s13, 6
    v_and_b32 v54, 63, v48
    v_lshrrev_b32 v48, 13, v48
    v_lshl_add_u32 v48, v48, 8, v54
cf_ncp1005:
    s_xor_b32 s78, s75, 1048576
    s_lshr_b32 s78, s78, s72
    s_add_u32 s78, s78, s67
    s_mov_b64 s[8:9], s[50:51]
    v_mov_b32 v58, v48
    s_lshr_b32 s79, 131072, s72
    s_mov_b32 s81, s93
    s_add_u32 s80, s66, 114688
    s_mov_b32 s76, 0
    s_mov_b32 s77, 8192
    s_call_b64 s[82:83], cf_dma
    ds_read_b64_tr_b16 a[72:73], v56 offset:0
    ds_read_b64_tr_b16 a[74:75], v56 offset:256
    ds_read_b64_tr_b16 a[76:77], v56 offset:8192
    ds_read_b64_tr_b16 a[78:79], v56 offset:8448
    s_mov_b32 s77, 16384
    s_call_b64 s[82:83], cf_dma
    s_waitcnt lgkmcnt(0)
    s_waitcnt vmcnt(8)
    v_add_u32 v55, 32768, v51
    v_xor_b32 v56, 32, v55
    ds_read_b64_tr_b16 a[80:81], v55 offset:0
    ds_read_b64_tr_b16 a[82:83], v55 offset:256
    ds_read_b64_tr_b16 a[84:85], v55 offset:8192
    ds_read_b64_tr_b16 a[86:87], v55 offset:8448
    s_mov_b32 s77, 24576
    s_call_b64 s[82:83], cf_dma
    ds_read_b64_tr_b16 a[88:89], v56 offset:0
    ds_read_b64_tr_b16 a[90:91], v56 offset:256
    ds_read_b64_tr_b16 a[92:93], v56 offset:8192
    ds_read_b64_tr_b16 a[94:95], v56 offset:8448
    s_mov_b32 s77, 32768
    s_call_b64 s[82:83], cf_dma
    s_waitcnt lgkmcnt(0)
    v_add_u32 v55, 49152, v51
    v_xor_b32 v56, 32, v55
    ds_read_b64_tr_b16 a[96:97], v55 offset:0
    ds_read_b64_tr_b16 a[98:99], v55 offset:256
    ds_read_b64_tr_b16 a[100:101], v55 offset:8192
    ds_read_b64_tr_b16 a[102:103], v55 offset:8448
    s_xor_b32 s78, s75, 0
    s_lshr_b32 s78, s78, s72
    s_add_u32 s78, s78, s67
    s_add_u32 s80, s66, 65536
    s_mov_b32 s76, 0
    s_mov_b32 s77, 8192
    s_call_b64 s[82:83], cf_dma
    ds_read_b64_tr_b16 a[104:105], v56 offset:0
    ds_read_b64_tr_b16 a[106:107], v56 offset:256
    ds_read_b64_tr_b16 a[108:109], v56 offset:8192
    ds_read_b64_tr_b16 a[110:111], v56 offset:8448
    s_mov_b32 s77, 16384
    s_call_b64 s[82:83], cf_dma
    s_waitcnt lgkmcnt(0)
    s_waitcnt vmcnt(12)
    v_add_u32 v55, 98304, v51
    v_xor_b32 v56, 32, v55
    ds_read_b64_tr_b16 a[112:113], v55 offset:0
    ds_read_b64_tr_b16 a[114:115], v55 offset:256
    ds_read_b64_tr_b16 a[116:117], v55 offset:8192
    ds_read_b64_tr_b16 a[118:119], v55 offset:8448
    s_mov_b32 s77, 24576
    s_call_b64 s[82:83], cf_dma
    ds_read_b64_tr_b16 a[120:121], v56 offset:0
    ds_read_b64_tr_b16 a[122:123], v56 offset:256
    ds_read_b64_tr_b16 a[124:125], v56 offset:8192
    ds_read_b64_tr_b16 a[126:127], v56 offset:8448
    s_mov_b32 s77, 32768
    s_call_b64 s[82:83], cf_dma
    s_waitcnt lgkmcnt(0)
    s_waitcnt vmcnt(8)
    v_add_u32 v55, 114688, v51
    v_xor_b32 v56, 32, v55
    ds_read_b64_tr_b16 a[16:17], v55 offset:0
    ds_read_b64_tr_b16 a[18:19], v55 offset:256
    ds_read_b64_tr_b16 a[20:21], v55 offset:8192
    ds_read_b64_tr_b16 a[22:23], v55 offset:8448
    s_xor_b32 s78, s75, 0
    s_lshr_b32 s78, s78, s72
    s_add_u32 s78, s78, s67
    s_mov_b64 s[8:9], s[52:53]
    s_add_u32 s80, s66, 0
    s_mov_b32 s76, 0
    s_mov_b32 s77, 8192
    s_call_b64 s[82:83], cf_dma
    ds_read_b64_tr_b16 a[24:25], v56 offset:0
    ds_read_b64_tr_b16 a[26:27], v56 offset:256
    ds_read_b64_tr_b16 a[28:29], v56 offset:8192
    ds_read_b64_tr_b16 a[30:31], v56 offset:8448
    s_mov_b32 s77, 16384
    s_call_b64 s[82:83], cf_dma
    s_waitcnt lgkmcnt(0)
    v_add_u32 v55, 131072, v51
    v_xor_b32 v56, 32, v55
    ds_read_b64_tr_b16 a[32:33], v55 offset:0
    ds_read_b64_tr_b16 a[34:35], v55 offset:256
    ds_read_b64_tr_b16 a[36:37], v55 offset:8192
    ds_read_b64_tr_b16 a[38:39], v55 offset:8448
    s_mov_b32 s77, 24576
    s_call_b64 s[82:83], cf_dma
    ds_read_b64_tr_b16 a[40:41], v56 offset:0
    ds_read_b64_tr_b16 a[42:43], v56 offset:256
    ds_read_b64_tr_b16 a[44:45], v56 offset:8192
    ds_read_b64_tr_b16 a[46:47], v56 offset:8448
    s_mov_b32 s77, 32768
    s_call_b64 s[82:83], cf_dma
    s_waitcnt lgkmcnt(0)
    s_waitcnt vmcnt(8)
    v_add_u32 v55, 65536, v51
    v_xor_b32 v56, 32, v55
    ds_read_b64_tr_b16 v[0:1], v55 offset:0
    ds_read_b64_tr_b16 v[2:3], v55 offset:256
    ds_read_b64_tr_b16 v[4:5], v55 offset:8192
    ds_read_b64_tr_b16 v[6:7], v55 offset:8448
    s_xor_b32 s78, s75, 1048576
    s_lshr_b32 s78, s78, s72
    s_add_u32 s78, s78, s67
    s_add_u32 s80, s66, 32768
    s_mov_b32 s76, 0
    s_mov_b32 s77, 8192
    s_call_b64 s[82:83], cf_dma
    ds_read_b64_tr_b16 v[8:9], v56 offset:0
    ds_read_b64_tr_b16 v[10:11], v56 offset:256
    ds_read_b64_tr_b16 v[12:13], v56 offset:8192
    ds_read_b64_tr_b16 v[14:15], v56 offset:8448
    s_mov_b32 s77, 16384
    s_call_b64 s[82:83], cf_dma
    s_waitcnt lgkmcnt(0)
    ds_write_b128 v62, v[0:3] offset:8192
    ds_write_b128 v62, v[4:7] offset:12288
    ds_write_b128 v62, v[8:11] offset:16384
    ds_write_b128 v62, v[12:15] offset:20480
    s_waitcnt lgkmcnt(0)
    v_add_u32 v55, 81920, v51
    v_xor_b32 v56, 32, v55
    ds_read_b64_tr_b16 a[0:1], v55 offset:0
    ds_read_b64_tr_b16 a[2:3], v55 offset:256
    ds_read_b64_tr_b16 a[4:5], v55 offset:8192
    ds_read_b64_tr_b16 a[6:7], v55 offset:8448
    s_mov_b32 s77, 24576
    s_call_b64 s[82:83], cf_dma
    ds_read_b64_tr_b16 a[8:9], v56 offset:0
    ds_read_b64_tr_b16 a[10:11], v56 offset:256
    ds_read_b64_tr_b16 a[12:13], v56 offset:8192
    ds_read_b64_tr_b16 a[14:15], v56 offset:8448
    s_mov_b32 s77, 32768
    s_call_b64 s[82:83], cf_dma
    s_waitcnt lgkmcnt(0)
    s_waitcnt vmcnt(8)
    v_add_u32 v55, 0, v51
    v_xor_b32 v56, 32, v55
    ds_read_b64_tr_b16 v[0:1], v55 offset:0
    ds_read_b64_tr_b16 v[2:3], v55 offset:256
    ds_read_b64_tr_b16 v[4:5], v55 offset:8192
    ds_read_b64_tr_b16 v[6:7], v55 offset:8448
    s_xor_b32 s94, s13, 0
    s_mul_i32 s94, s94, 36864
    s_add_u32 s94, s94, s92
    s_lshr_b32 s74, s13, 1
    s_lshl_b32 s74, s74, 6
    s_add_u32 s94, s94, s74
    s_add_u32 s78, s94, 1024
    s_mov_b64 s[8:9], s[56:57]
    v_mov_b32 v58, v50
    s_mov_b32 s79, 18432
    s_mov_b32 s81, 0
    s_add_u32 s80, s66, 147456
    s_mov_b32 s76, 0
    s_mov_b32 s77, 8192
    s_call_b64 s[82:83], cf_dma
    ds_read_b64_tr_b16 v[8:9], v56 offset:0
    ds_read_b64_tr_b16 v[10:11], v56 offset:256
    ds_read_b64_tr_b16 v[12:13], v56 offset:8192
    ds_read_b64_tr_b16 v[14:15], v56 offset:8448
    s_xor_b32 s94, s13, 2
    s_mul_i32 s94, s94, 36864
    s_add_u32 s94, s94, s92
    s_lshr_b32 s74, s13, 1
    s_lshl_b32 s74, s74, 6
    s_add_u32 s94, s94, s74
    s_add_u32 s78, s94, 1024
    s_mov_b32 s77, 16384
    s_call_b64 s[82:83], cf_dma
    s_waitcnt lgkmcnt(0)
    ds_write_b128 v61, v[0:3] offset:0
    ds_write_b128 v61, v[4:7] offset:4096
    ds_write_b128 v61, v[8:11] offset:8192
    ds_write_b128 v61, v[12:15] offset:12288
    s_waitcnt lgkmcnt(0)
    v_add_u32 v55, 16384, v51
    v_xor_b32 v56, 32, v55
    ds_read_b64_tr_b16 v[0:1], v55 offset:0
    ds_read_b64_tr_b16 v[2:3], v55 offset:256
    ds_read_b64_tr_b16 v[4:5], v55 offset:8192
    ds_read_b64_tr_b16 v[6:7], v55 offset:8448
    s_xor_b32 s94, s13, 3
    s_mul_i32 s94, s94, 36864
    s_add_u32 s94, s94, s92
    s_lshl_b32 s74, s13, 7
    s_add_u32 s94, s94, s74
    s_add_u32 s78, s94, 512
    v_mov_b32 v58, v49
    s_mov_b32 s79, 9216
    s_add_u32 s80, s66, 131072
    s_mov_b32 s76, 0
    s_mov_b32 s77, 8192
    s_call_b64 s[82:83], cf_dma
    ds_read_b64_tr_b16 v[8:9], v56 offset:0
    ds_read_b64_tr_b16 v[10:11], v56 offset:256
    ds_read_b64_tr_b16 v[12:13], v56 offset:8192
    ds_read_b64_tr_b16 v[14:15], v56 offset:8448
    s_mov_b32 s77, 16384
    s_call_b64 s[82:83], cf_dma
    s_waitcnt lgkmcnt(0)
    ds_write_b128 v61, v[0:3] offset:16384
    ds_write_b128 v61, v[4:7] offset:20480
    ds_write_b128 v61, v[8:11] offset:24576
    ds_write_b128 v61, v[12:15] offset:28672
    s_waitcnt lgkmcnt(0)
    s_waitcnt vmcnt(8)
    v_add_u32 v55, 32768, v51
    v_xor_b32 v56, 32, v55
    ds_read_b64_tr_b16 v[0:1], v55 offset:0
    ds_read_b64_tr_b16 v[2:3], v55 offset:256
    ds_read_b64_tr_b16 v[4:5], v55 offset:8192
    ds_read_b64_tr_b16 v[6:7], v55 offset:8448
    s_xor_b32 s94, s13, 2
    s_mul_i32 s94, s94, 36864
    s_add_u32 s94, s94, s92
    s_lshl_b32 s74, s13, 7
    s_add_u32 s94, s94, s74
    s_add_u32 s78, s94, 512
    s_add_u32 s80, s66, 114688
    s_mov_b32 s76, 0
    s_mov_b32 s77, 8192
    s_call_b64 s[82:83], cf_dma
    ds_read_b64_tr_b16 v[8:9], v56 offset:0
    ds_read_b64_tr_b16 v[10:11], v56 offset:256
    ds_read_b64_tr_b16 v[12:13], v56 offset:8192
    ds_read_b64_tr_b16 v[14:15], v56 offset:8448
    s_mov_b32 s77, 16384
    s_call_b64 s[82:83], cf_dma
    s_waitcnt lgkmcnt(0)
    ds_write_b128 v61, v[0:3] offset:32768
    ds_write_b128 v61, v[4:7] offset:36864
    ds_write_b128 v61, v[8:11] offset:40960
    ds_write_b128 v61, v[12:15] offset:45056
    s_waitcnt lgkmcnt(0)
    v_add_u32 v55, 49152, v51
    v_xor_b32 v56, 32, v55
    ds_read_b64_tr_b16 v[0:1], v55 offset:0
    ds_read_b64_tr_b16 v[2:3], v55 offset:256
    ds_read_b64_tr_b16 v[4:5], v55 offset:8192
    ds_read_b64_tr_b16 v[6:7], v55 offset:8448
    s_lshr_b32 s78, 4194304, s72
    s_add_u32 s78, s78, s67
    s_mov_b64 s[8:9], s[52:53]
    v_mov_b32 v58, v48
    s_lshr_b32 s79, 131072, s72
    s_add_u32 s80, s66, 81920
    s_mov_b32 s76, 0
    s_mov_b32 s77, 8192
    s_call_b64 s[82:83], cf_dma
    ds_read_b64_tr_b16 v[8:9], v56 offset:0
    ds_read_b64_tr_b16 v[10:11], v56 offset:256
    ds_read_b64_tr_b16 v[12:13], v56 offset:8192
    ds_read_b64_tr_b16 v[14:15], v56 offset:8448
    s_mov_b32 s77, 16384
    s_call_b64 s[82:83], cf_dma
    s_waitcnt lgkmcnt(0)
    ds_write_b128 v61, v[0:3] offset:49152
    ds_write_b128 v61, v[4:7] offset:53248
    ds_write_b128 v61, v[8:11] offset:57344
    ds_write_b128 v61, v[12:15] offset:61440
    s_waitcnt lgkmcnt(0)
    buffer_load_dword v38, off, s[96:99], 0 offset:140 sc1
    buffer_load_dword v39, off, s[96:99], 0 offset:64 sc1
    s_lshr_b32 s84, s12, 1
    s_lshl_b32 s84, s84, 8
    s_add_u32 s84, s84, 125829120
    v_bfe_u32 v40, v61, 4, 6
    v_min_u32 v40, 11, v40
    v_lshlrev_b32 v40, 2, v40
    buffer_load_dword v41, v40, s[4:7], s84 offen sc1
    s_waitcnt vmcnt(15)
    v_add_u32 v55, 147456, v53
    ds_read_b64_tr_b16 v[0:1], v55 offset:0
    ds_read_b64_tr_b16 v[2:3], v55 offset:128
    ds_read_b64_tr_b16 v[4:5], v55 offset:512
    ds_read_b64_tr_b16 v[6:7], v55 offset:640
    ds_read_b64_tr_b16 v[8:9], v55 offset:8192
    ds_read_b64_tr_b16 v[10:11], v55 offset:8320
    ds_read_b64_tr_b16 v[12:13], v55 offset:8704
    ds_read_b64_tr_b16 v[14:15], v55 offset:8832
    s_waitcnt lgkmcnt(0)
    s_barrier
    ds_write_b128 v63, v[0:3] offset:49152
    ds_write_b128 v63, v[4:7] offset:53248
    s_barrier
    ds_write_b128 v63, v[8:11] offset:57344
    ds_write_b128 v63, v[12:15] offset:61440
    s_waitcnt lgkmcnt(0)
    s_waitcnt vmcnt(11)
    v_add_u32 v55, 131072, v52
    ds_read_b64_tr_b16 v[0:1], v55 offset:0
    ds_read_b64_tr_b16 v[2:3], v55 offset:256
    ds_read_b64_tr_b16 v[4:5], v55 offset:4096
    ds_read_b64_tr_b16 v[6:7], v55 offset:4352
    ds_read_b64_tr_b16 v[8:9], v55 offset:64
    ds_read_b64_tr_b16 v[10:11], v55 offset:320
    ds_read_b64_tr_b16 v[12:13], v55 offset:4160
    ds_read_b64_tr_b16 v[14:15], v55 offset:4416
    s_waitcnt lgkmcnt(0)
    s_barrier
    ds_write_b128 v63, v[0:3] offset:32768
    ds_write_b128 v63, v[4:7] offset:36864
    s_barrier
    ds_write_b128 v63, v[8:11] offset:40960
    ds_write_b128 v63, v[12:15] offset:45056
    s_waitcnt lgkmcnt(0)
    s_waitcnt vmcnt(7)
    v_add_u32 v55, 114688, v52
    ds_read_b64_tr_b16 v[0:1], v55 offset:0
    ds_read_b64_tr_b16 v[2:3], v55 offset:256
    ds_read_b64_tr_b16 v[4:5], v55 offset:4096
    ds_read_b64_tr_b16 v[6:7], v55 offset:4352
    ds_read_b64_tr_b16 v[8:9], v55 offset:64
    ds_read_b64_tr_b16 v[10:11], v55 offset:320
    ds_read_b64_tr_b16 v[12:13], v55 offset:4160
    ds_read_b64_tr_b16 v[14:15], v55 offset:4416
    s_waitcnt lgkmcnt(0)
    s_barrier
    ds_write_b128 v63, v[0:3] offset:16384
    ds_write_b128 v63, v[4:7] offset:20480
    s_barrier
    ds_write_b128 v63, v[8:11] offset:24576
    ds_write_b128 v63, v[12:15] offset:28672
    s_waitcnt lgkmcnt(0)
    buffer_load_dword v30, v79, s[4:7], s14 offen sc1
    s_lshl_b32 s40, s12, 14
    s_add_u32 s40, s40, 67174400
    buffer_load_dword v30, v79, s[4:7], s40 offen sc1
    s_and_b32 s40, s12, 3
    s_lshl_b32 s40, s40, 14
    s_add_u32 s40, s40, 67108864
    buffer_load_dword v30, v79, s[4:7], s40 offen sc1
    s_waitcnt vmcnt(1)
    v_readfirstlane_b32 s95, v39
    v_readfirstlane_b32 s85, v38
    s_add_u32 s86, s95, 2
    s_waitcnt vmcnt(0)
    v_subrev_u32 v41, s86, v41
    v_cmp_lt_u32 s[86:87], 64, v41
    s_cmp_eq_u32 s95, 0
    s_cselect_b64 s[86:87], -1, s[86:87]
    s_cmp_lg_u64 s[86:87], 0
    s_cbranch_scc1 cf_nt
    s_add_u32 s40, s24, 524288
    buffer_load_dword v30, v79, s[4:7], s24 offen sc1
    buffer_load_dword v30, v79, s[4:7], s40 offen sc1
cf_nt:
    s_waitcnt vmcnt(3)
    v_add_u32 v55, 81920, v51
    v_xor_b32 v56, 32, v55
    ds_read_b64_tr_b16 v[0:1], v55 offset:0
    ds_read_b64_tr_b16 v[2:3], v55 offset:256
    ds_read_b64_tr_b16 v[4:5], v55 offset:8192
    ds_read_b64_tr_b16 v[6:7], v55 offset:8448
    ds_read_b64_tr_b16 v[8:9], v56 offset:0
    ds_read_b64_tr_b16 v[10:11], v56 offset:256
    ds_read_b64_tr_b16 v[12:13], v56 offset:8192
    ds_read_b64_tr_b16 v[14:15], v56 offset:8448
    s_waitcnt lgkmcnt(0)
    ds_write_b128 v62, v[0:3] offset:24576
    ds_write_b128 v62, v[4:7] offset:28672
    ds_write_b128 v62, v[8:11] offset:32768
    ds_write_b128 v62, v[12:15] offset:36864
    s_waitcnt lgkmcnt(0)
    s_barrier
    s_mov_b32 s88, 4194304
gn2:
    s_cmp_lg_u32 s95, 0
    s_cbranch_scc1 gn2x
    buffer_load_dword v24, off, s[96:99], 0 offset:64 sc1
    s_sub_u32 s88, s88, 1
    s_cbranch_scc1 gn2x
    s_waitcnt vmcnt(0)
    v_readfirstlane_b32 s95, v24
    s_nop 1
    s_branch gn2
gn2x:
    ds_write_b128 v78, v[16:19] offset:8704
    ds_write_b128 v65, v[20:23] offset:10240
    v_mov_b32 v44, s95
    v_mov_b32 v45, s95
    v_mov_b32 v46, s95
    v_mov_b32 v47, s95
    v_mov_b32 v48, 108288
    ds_write_b128 v48, v[44:47]
    s_waitcnt vmcnt(0) lgkmcnt(0)
    s_cmp_eq_u32 s85, 1
    s_cbranch_scc1 cf_run
    s_mov_b32 s40, 131072
cf_startpoll:
    buffer_load_dword v3, off, s[96:99], 0 offset:140 sc1
    s_waitcnt vmcnt(0)
    v_readfirstlane_b32 s85, v3
    s_nop 0
    s_cmp_eq_u32 s85, 1
    s_cbranch_scc1 cf_run
    s_cmp_eq_u32 s85, 2
    s_cbranch_scc1 cf_leave
    s_sleep 1
    s_sub_u32 s40, s40, 1
    s_cbranch_scc0 cf_startpoll
    v_mov_b32 v4, 2
    v_mov_b32 v5, 0
    s_mov_b64 exec, 1
    buffer_atomic_cmpswap v[4:5], off, s[96:99], 0 offset:140
    s_mov_b64 exec, -1
    s_mov_b32 s40, 1048576
    s_branch cf_startpoll
cf_leave:
    v_lshrrev_b32 v0, 4, v61
    s_mov_b32 s32, s13
    s_load_dwordx16 s[48:63], s[0:1], 0
    s_waitcnt lgkmcnt(0)
    s_branch L_helper
cf_run:
    s_cmp_eq_u64 s[86:87], 0
    s_cbranch_scc1 cf_kvok
    s_lshr_b32 s92, s12, 1
    s_lshl_b32 s92, s92, 8
    s_add_u32 s92, s92, 125829120
    v_bfe_u32 v2, v61, 4, 6
    v_min_u32 v2, 11, v2
    v_lshlrev_b32 v2, 2, v2
    s_add_u32 s93, s95, 2
    s_mov_b32 s94, 4194304
cf_kv0:
    buffer_load_dword v3, v2, s[4:7], s92 offen sc1
    s_sub_u32 s94, s94, 1
    s_cbranch_scc1 cf_kv0_go
    s_waitcnt vmcnt(0)
    v_subrev_u32 v3, s93, v3
    v_cmp_lt_u32 vcc, 64, v3
    s_cbranch_vccz cf_kv0_go
    s_sleep 2
    s_branch cf_kv0
cf_kv0_go:
    s_add_u32 s40, s24, 524288
    buffer_load_dword v30, v79, s[4:7], s24 offen sc1
    buffer_load_dword v30, v79, s[4:7], s40 offen sc1
    s_waitcnt vmcnt(0)
cf_kvok:
    s_mov_b32 m0, 108032
    s_add_u32 s24, s24, 1048576
    s_add_u32 s15, s14, 4096
    s_add_u32 s16, s14, 8192
    ds_read_b128 v[32:35], v62 offset:16384
    ds_read_b128 v[36:39], v62 offset:20480
    ds_read_b128 v[40:43], v61 offset:0
    ds_read_b128 v[44:47], v61 offset:4096
    ds_read_b128 v[48:51], v61 offset:8192
    ds_read_b128 v[52:55], v61 offset:12288
    s_mov_b32 s29, 1048576
    buffer_load_dwordx4 v[24:27], v61, s[4:7], s14 offen nt
.p2align 6
cf_loop:
    v_mov_b64 v[0:1], 0
    v_mov_b64 v[2:3], 0
    v_mov_b64 v[4:5], 0
    v_mov_b64 v[6:7], 0
    v_mov_b64 v[8:9], 0
    v_mov_b64 v[10:11], 0
    v_mov_b64 v[12:13], 0
    v_mov_b64 v[14:15], 0
cf_loop2:
    ds_read_b128 v[16:19], v62 offset:8192
    ds_read_b128 v[20:23], v62 offset:12288
    v_lshrrev_b32 v56, 2, v61
    v_add_u32 v58, 106496, v56
    s_mov_b32 s29, 1048576
    s_nop 13
    buffer_load_dwordx4 v[24:27], v61, s[4:7], s14 offen nt
    s_waitcnt lgkmcnt(0)
cf_chk0:
    s_waitcnt vmcnt(1)
    v_max3_u32 v57, v24, v25, v26
    v_max_u32 v57, v57, v27
    v_cmp_eq_u32 vcc, -1, v57
    ds_write_b128 v62, v[24:27] offset:40960
    s_cbranch_vccnz cf_spin0
    v_smfmac_f32_16x16x64_bf16 v[0:3], v[24:27], v[16:23], v60
    buffer_load_dwordx4 v[28:31], v61, s[4:7], s15 offen nt
    buffer_load_dword v59, v56, s[4:7], s16 offen nt
    v_smfmac_f32_16x16x64_bf16 v[8:11], v[24:27], v[32:39], v60
    ds_read_b128 v[32:35], v61 offset:16384
    v_smfmac_f32_16x16x64_bf16 v[12:15], v[24:27], v[48:55], v60
    ds_read_b128 v[36:39], v61 offset:20480
    v_mfma_f32_16x16x16_bf16 v[16:19], v[72:73], v[72:73], 0
    s_waitcnt lgkmcnt(2)
    s_barrier
    ds_read_b128 v[48:51], v63 offset:0
    v_mfma_f32_16x16x16_bf16 v[20:23], v[72:73], v[72:73], 0
    ds_read_b128 v[52:55], v64 offset:0
    v_smfmac_f32_16x16x64_bf16 v[4:7], v[24:27], v[40:47], v60
    ds_read_b128 v[40:43], v61 offset:24576
    v_smfmac_f32_16x16x64_bf16 v[16:19], v[24:27], a[192:199], v60
    ds_read_b128 v[44:47], v61 offset:28672
    v_smfmac_f32_16x16x64_bf16 v[20:23], v[24:27], a[200:207], v60
    s_waitcnt lgkmcnt(3)
    v_smfmac_f32_16x16x64_bf16 v[0:3], v[48:51], a[0:7], v60
    s_add_u32 s18, s14, s31
    s_add_u32 s41, s14, 16384
    v_smfmac_f32_16x16x64_bf16 v[4:7], v[48:51], v[32:39], v60
    ds_read_b128 v[32:35], v61 offset:32768
    v_smfmac_f32_16x16x64_bf16 v[8:11], v[48:51], a[8:15], v60
    ds_read_b128 v[36:39], v61 offset:36864
    s_waitcnt lgkmcnt(2)
    v_smfmac_f32_16x16x64_bf16 v[12:15], v[48:51], v[40:47], v60
    ds_read_b128 v[40:43], v61 offset:40960
    v_smfmac_f32_16x16x64_bf16 v[0:3], v[52:55], a[16:23], v60
    ds_read_b128 v[44:47], v61 offset:45056
    v_smfmac_f32_16x16x64_bf16 v[8:11], v[52:55], a[24:31], v60
    ds_read_b128 v[48:51], v71 offset:0
    s_waitcnt lgkmcnt(3)
    v_smfmac_f32_16x16x64_bf16 v[4:7], v[52:55], v[32:39], v60
    s_waitcnt vmcnt(0)
    ds_write_b128 v62, v[28:31] offset:45056
    s_waitcnt lgkmcnt(2)
    v_smfmac_f32_16x16x64_bf16 v[12:15], v[52:55], v[40:47], v60
    ds_write_b32 v58, v59
    v_max3_u32 v57, v28, v29, v30
    s_waitcnt lgkmcnt(2)
    v_smfmac_f32_16x16x64_bf16 v[0:3], v[48:51], a[32:39], v60
    ds_read_b128 v[32:35], v61 offset:49152
    v_max3_u32 v57, v57, v31, v59
    v_smfmac_f32_16x16x64_bf16 v[8:11], v[48:51], a[40:47], v60
    ds_read_b128 v[36:39], v61 offset:53248
    v_cmp_eq_u32 vcc, -1, v57
    v_smfmac_f32_16x16x64_bf16 v[16:19], v[52:55], a[224:231], v60
    ds_read_b128 v[40:43], v61 offset:57344
    v_smfmac_f32_16x16x64_bf16 v[20:23], v[52:55], a[232:239], v60
    ds_read_b128 v[44:47], v61 offset:61440
    s_cbranch_vccnz cf_spin1
cf_go1:
    v_smfmac_f32_16x16x64_bf16 v[0:3], v[28:31], a[48:55], v60
    s_waitcnt lgkmcnt(4)
    s_barrier
    ds_read_b128 v[52:55], v63 offset:4096
    v_smfmac_f32_16x16x64_bf16 v[8:11], v[28:31], a[56:63], v60
    ds_read_b128 v[56:59], v71 offset:4096
    v_smfmac_f32_16x16x64_bf16 v[4:7], v[28:31], a[128:135], v60
    s_waitcnt lgkmcnt(2)
    v_smfmac_f32_16x16x64_bf16 v[4:7], v[48:51], v[32:39], v60
    buffer_load_dwordx4 v[32:35], v61, s[4:7], s23 offen offset:0 sc1
    v_smfmac_f32_16x16x64_bf16 v[12:15], v[48:51], v[40:47], v60
    ds_read_b128 v[48:51], v64 offset:4096
    v_smfmac_f32_16x16x64_bf16 v[12:15], v[28:31], a[136:143], v60
    ds_read_b128 v[24:27], v65 offset:8192
    s_and_b32 s41, s41, 65535
    s_add_u32 s41, s41, 67108864
    v_smfmac_f32_16x16x64_bf16 v[16:19], v[28:31], v[80:87], v60
    buffer_load_dwordx4 v[36:39], v61, s[4:7], s23 offen offset:1024 sc1
    v_smfmac_f32_16x16x64_bf16 v[20:23], v[28:31], v[88:95], v60
    s_add_u32 s17, s41, s31
    s_and_b32 s30, s28, 1
    s_waitcnt lgkmcnt(3)
    v_smfmac_f32_16x16x64_bf16 v[0:3], v[52:55], a[64:71], v60
    ds_read_b128 v[28:31], v78 offset:8704
    v_smfmac_f32_16x16x64_bf16 v[4:7], v[52:55], a[144:151], v60
    buffer_load_dwordx4 v[40:43], v61, s[4:7], s23 offen offset:2048 sc1
    v_smfmac_f32_16x16x64_bf16 v[8:11], v[52:55], a[72:79], v60
    v_smfmac_f32_16x16x64_bf16 v[12:15], v[52:55], a[152:159], v60
    v_smfmac_f32_16x16x64_bf16 v[16:19], v[52:55], v[96:103], v60
    buffer_load_dwordx4 v[44:47], v61, s[4:7], s23 offen offset:3072 sc1
    v_smfmac_f32_16x16x64_bf16 v[20:23], v[52:55], v[104:111], v60
    ds_read_b128 v[52:55], v62 offset:28672
    s_waitcnt lgkmcnt(3)
    v_smfmac_f32_16x16x64_bf16 v[0:3], v[48:51], a[80:87], v60
    v_smfmac_f32_16x16x64_bf16 v[4:7], v[48:51], a[160:167], v60
    v_smfmac_f32_16x16x64_bf16 v[8:11], v[48:51], a[88:95], v60
    v_smfmac_f32_16x16x64_bf16 v[12:15], v[48:51], a[168:175], v60
    v_smfmac_f32_16x16x64_bf16 v[16:19], v[48:51], v[112:119], v60
    buffer_load_dword v79, s[4:7], s24 offen sc1 lds
    v_smfmac_f32_16x16x64_bf16 v[20:23], v[48:51], v[120:127], v60
    ds_read_b128 v[48:51], v62 offset:24576
    v_smfmac_f32_16x16x64_bf16 v[0:3], v[56:59], a[96:103], v60
    s_cmp_ge_u32 s28, 62
    v_smfmac_f32_16x16x64_bf16 v[8:11], v[56:59], a[104:111], v60
    s_waitcnt lgkmcnt(3)
    v_smfmac_f32_16x16x64_bf16 v[0:3], v[24:27], a[112:119], v60
    v_smfmac_f32_16x16x64_bf16 v[8:11], v[24:27], a[120:127], v60
    v_smfmac_f32_16x16x64_bf16 v[4:7], v[56:59], a[176:183], v60
    s_waitcnt lgkmcnt(0)
    v_cvt_pk_bf16_f32 v0, v0, v1
    v_smfmac_f32_16x16x64_bf16 v[4:7], v[24:27], v[48:55], v60
    ds_read_b128 v[48:51], v62 offset:32768
    v_cvt_pk_bf16_f32 v8, v8, v9
    v_smfmac_f32_16x16x64_bf16 v[12:15], v[56:59], a[184:191], v60
    ds_read_b128 v[52:55], v62 offset:36864
    v_cvt_pk_bf16_f32 v9, v10, v11
    v_smfmac_f32_16x16x64_bf16 v[16:19], v[56:59], v[128:135], v60
    v_cvt_pk_bf16_f32 v1, v2, v3
    v_mfma_f32_16x16x16_bf16 v[8:11], v[8:9], v[28:29], 0
    v_cvt_pk_bf16_f32 v2, v4, v5
    v_cvt_pk_bf16_f32 v3, v6, v7
    v_smfmac_f32_16x16x64_bf16 v[20:23], v[56:59], v[136:143], v60
    s_mov_b64 exec, s[36:37]
    ds_read_b128 v[56:59], v69
    s_mov_b64 exec, -1
    v_mfma_f32_16x16x32_bf16 v[4:7], v[0:3], v[28:31], 0
    v_cvt_pk_bf16_f32 v2, v8, v9
    s_waitcnt lgkmcnt(1)
    v_smfmac_f32_16x16x64_bf16 v[12:15], v[24:27], v[48:55], v60
    ds_read_b128 v[48:51], v63 offset:0
    v_cvt_pk_bf16_f32 v3, v10, v11
    s_waitcnt vmcnt(3)
    v_cvt_pk_bf16_f32 v0, v4, v5
    v_cvt_pk_bf16_f32 v1, v6, v7
    s_nop 1
    v_mfma_f32_16x16x32_bf16 v[4:7], v[36:39], v[0:3], 0
    v_cvt_pk_bf16_f32 v12, v12, v13
    v_cvt_pk_bf16_f32 v13, v14, v15
    s_nop 1
    v_mfma_f32_16x16x16_bf16 v[12:15], v[12:13], v[30:31], 0
    ds_read_b128 v[52:55], v71 offset:0
    ds_read_b128 v[36:39], v63 offset:53248
    v_mfma_f32_16x16x32_bf16 v[28:31], v[32:35], v[0:3], 0
    s_waitcnt vmcnt(1)
    ds_read_b128 v[32:35], v63 offset:49152
    s_mov_b64 exec, s[34:35]
    s_nop 0
    v_cvt_pk_bf16_f32 v2, v12, v13
    v_cvt_pk_bf16_f32 v3, v14, v15
    s_mov_b64 exec, -1
    s_nop 0
    v_mfma_f32_16x16x32_bf16 v[8:11], v[0:3], v[0:3], 0
    v_mov_b32_dpp v28, v4 row_ror:8 row_mask:0xf bank_mask:0xc
    v_mov_b32_dpp v29, v5 row_ror:8 row_mask:0xf bank_mask:0xc
    v_mov_b32_dpp v30, v6 row_ror:8 row_mask:0xf bank_mask:0xc
    v_mov_b32_dpp v31, v7 row_ror:8 row_mask:0xf bank_mask:0xc
    v_smfmac_f32_16x16x64_bf16 v[16:19], v[24:27], v[144:151], v60
    ds_write_b128 v62, v[28:31] offset:53248
    v_mov_b32_dpp v8, v10 row_ror:8 row_mask:0xf bank_mask:0xc
    v_mov_b32_dpp v9, v11 row_ror:8 row_mask:0xf bank_mask:0xc
    v_smfmac_f32_16x16x64_bf16 v[20:23], v[24:27], v[152:159], v60
    ds_write_b64 v70, v[8:9]
    s_waitcnt lgkmcnt(5)
    v_smfmac_f32_16x16x64_bf16 v[16:19], v[48:51], a[208:215], v60
    s_mov_b64 exec, s[36:37]
    buffer_store_dwordx4 v[56:59], v61, s[4:7], s65 offen sc1
    s_mov_b64 exec, -1
    v_smfmac_f32_16x16x64_bf16 v[20:23], v[48:51], a[216:223], v60
    s_cbranch_scc1 cf_last
cf_back:
    s_waitcnt lgkmcnt(0)
    s_barrier
    ds_read_b128 v[56:59], v78 offset:10752
    v_smfmac_f32_16x16x64_bf16 v[16:19], v[52:55], a[240:247], v60
    ds_read_b128 v[12:15], v78 offset:11264
    ds_read_b128 v[4:7], v63 offset:12288
    v_smfmac_f32_16x16x64_bf16 v[20:23], v[52:55], a[248:255], v60
    ds_read_b128 v[8:11], v64 offset:12288
    ds_read_b128 v[0:3], v71 offset:12288
    v_mov_b64 v[24:25], s[62:63]
    v_mov_b64 v[26:27], s[60:61]
    v_cvt_pk_bf16_f32 v16, v16, v17
    v_cvt_pk_bf16_f32 v17, v18, v19
    v_pk_mul_f32 v[28:29], v[28:29], s[44:45]
    v_pk_mul_f32 v[30:31], v[30:31], s[44:45]
    s_waitcnt lgkmcnt(3)
    v_pk_add_f32 v[56:57], v[56:57], v[58:59]
    v_pk_add_f32 v[12:13], v[12:13], v[14:15]
    v_pk_add_f32 v[56:57], v[56:57], v[12:13]
    v_pk_mul_f32 v[56:57], v[56:57], s[44:45]
    v_exp_f32 v58, v56
    v_exp_f32 v59, v57
    s_waitcnt lgkmcnt(1)
    v_pk_fma_f32 v[28:29], v[4:5], s[44:45], v[28:29]
    v_pk_fma_f32 v[30:31], v[6:7], s[44:45], v[30:31]
    v_cvt_pk_bf16_f32 v6, v58, v59
    v_pk_fma_f32 v[28:29], v[8:9], s[44:45], v[28:29]
    v_pk_fma_f32 v[30:31], v[10:11], s[44:45], v[30:31]
    s_waitcnt lgkmcnt(0)
    v_pk_fma_f32 v[28:29], v[0:1], s[44:45], v[28:29]
    v_mov_b32_dpp v7, v6 row_ror:8 row_mask:0xf bank_mask:0xf
    v_pk_fma_f32 v[30:31], v[2:3], s[44:45], v[30:31]
    v_exp_f32 v0, v28
    v_mfma_f32_16x16x16_bf16 v[12:15], v[16:17], v[6:7], 0
    ds_read_b128 v[48:51], v63 offset:57344
    v_exp_f32 v1, v29
    v_cvt_pk_bf16_f32 v18, v20, v21
    v_exp_f32 v2, v30
    v_cvt_pk_bf16_f32 v19, v22, v23
    v_cvt_pk_bf16_f32 v8, v0, v1
    v_exp_f32 v3, v31
    v_mfma_f32_16x16x16_bf16 v[20:23], v[18:19], v[6:7], 0
    ds_read_b128 v[52:55], v63 offset:61440
    v_cvt_pk_bf16_f32 v9, v2, v3
    v_mov_b32_dpp v10, v8 row_ror:8 row_mask:0xf bank_mask:0xf
    v_max3_f32 v4, |v28|, |v29|, |v30|
    v_mov_b32_dpp v11, v9 row_ror:8 row_mask:0xf bank_mask:0xf
    v_mfma_f32_16x16x32_bf16 v[0:3], v[24:27], v[6:9], 0
    v_max3_f32 v4, v4, |v31|, |v56|
    v_max_f32_e64 v4, v4, |v57|
    v_mfma_f32_16x16x32_bf16 v[12:15], v[40:43], v[8:11], v[12:15]
    v_cmp_nge_f32 vcc, s46, v4
    v_mfma_f32_16x16x32_bf16 v[20:23], v[44:47], v[8:11], v[20:23]
    v_add_f32_dpp v0, v0, v0 row_ror:8 row_mask:0xf bank_mask:0xf
    v_rcp_f32 v0, v0
    s_cbranch_vccnz cf_guard
cf_norm:
    v_mfma_f32_16x16x16_bf16 v[28:31], v[72:73], v[72:73], 0
    v_mul_f32 v12, v12, v0
    v_mul_f32 v13, v13, v0
    v_mul_f32 v14, v14, v0
    v_mul_f32 v15, v15, v0
    v_mul_f32_dpp v12, v20, v0 row_ror:8 row_mask:0xf bank_mask:0xc
    v_mul_f32_dpp v13, v21, v0 row_ror:8 row_mask:0xf bank_mask:0xc
    v_mul_f32_dpp v14, v22, v0 row_ror:8 row_mask:0xf bank_mask:0xc
    v_mul_f32_dpp v15, v23, v0 row_ror:8 row_mask:0xf bank_mask:0xc
    v_cvt_pk_bf16_f32 v12, v12, v13
    v_cvt_pk_bf16_f32 v13, v14, v15
    v_mfma_f32_16x16x16_bf16 v[8:11], v[72:73], v[72:73], 0
    ds_write_b64 v77, v[12:13]
    v_mfma_f32_16x16x16_bf16 v[4:7], v[72:73], v[72:73], 0
    ds_read_b128 v[0:3], v68
    v_mfma_f32_16x16x16_bf16 v[16:19], v[72:73], v[72:73], 0
    ds_read_b128 v[40:43], v63 offset:16384
    v_mfma_f32_16x16x16_bf16 v[20:23], v[72:73], v[72:73], 0
    ds_read_b128 v[44:47], v63 offset:20480
    s_waitcnt lgkmcnt(3)
    s_barrier
    ds_read_b128 v[24:27], v74
    ds_read_b128 v[12:15], v75
    ds_read_b128 v[56:59], v76
    s_waitcnt lgkmcnt(5)
    v_smfmac_f32_16x16x64_bf16 v[28:31], v[0:3], v[160:167], v60
    v_smfmac_f32_16x16x64_bf16 v[8:11], v[0:3], v[192:199], v60
    v_smfmac_f32_16x16x64_bf16 v[4:7], v[0:3], v[32:39], v60
    ds_read_b128 v[32:35], v63 offset:32768
    v_smfmac_f32_16x16x64_bf16 v[16:19], v[0:3], v[224:231], v60
    ds_read_b128 v[36:39], v63 offset:36864
    s_waitcnt lgkmcnt(3)
    v_smfmac_f32_16x16x64_bf16 v[28:31], v[24:27], v[168:175], v60
    v_smfmac_f32_16x16x64_bf16 v[4:7], v[12:15], v[48:55], v60
    ds_read_b128 v[48:51], v63 offset:24576
    v_smfmac_f32_16x16x64_bf16 v[28:31], v[12:15], v[176:183], v60
    ds_read_b128 v[52:55], v63 offset:28672
    s_waitcnt lgkmcnt(4)
    v_smfmac_f32_16x16x64_bf16 v[28:31], v[56:59], v[184:191], v60
    v_cvt_pk_bf16_f32 v4, v4, v5
    v_smfmac_f32_16x16x64_bf16 v[16:19], v[12:15], v[40:47], v60
    ds_read_b128 v[40:43], v63 offset:40960
    v_and_or_b32 v4, v4, -2, s30
    v_smfmac_f32_16x16x64_bf16 v[8:11], v[24:27], v[200:207], v60
    ds_read_b128 v[44:47], v63 offset:45056
    v_cvt_pk_bf16_f32 v5, v6, v7
    v_smfmac_f32_16x16x64_bf16 v[8:11], v[12:15], v[208:215], v60
    buffer_store_dwordx2 v[4:5], v67, s[4:7], s22 offen
    v_cvt_pk_bf16_f32 v28, v28, v29
    v_smfmac_f32_16x16x64_bf16 v[8:11], v[56:59], v[216:223], v60
    v_and_or_b32 v28, v28, -2, s30
    v_smfmac_f32_16x16x64_bf16 v[16:19], v[24:27], v[232:239], v60
    v_cvt_pk_bf16_f32 v29, v30, v31
    s_waitcnt lgkmcnt(4)
    v_smfmac_f32_16x16x64_bf16 v[16:19], v[56:59], v[32:39], v60
    buffer_store_dwordx2 v[28:29], v66, s[4:7], s20 offen
    v_cvt_pk_bf16_f32 v8, v8, v9
    s_waitcnt lgkmcnt(0)
    v_smfmac_f32_16x16x64_bf16 v[20:23], v[0:3], v[240:247], v60
    v_and_or_b32 v8, v8, -2, s30
    v_smfmac_f32_16x16x64_bf16 v[20:23], v[24:27], v[248:255], v60
    v_cvt_pk_bf16_f32 v9, v10, v11
    v_smfmac_f32_16x16x64_bf16 v[20:23], v[12:15], v[48:55], v60
    buffer_store_dwordx2 v[8:9], v66, s[4:7], s21 offen
    v_cvt_pk_bf16_f32 v16, v16, v17
    v_smfmac_f32_16x16x64_bf16 v[20:23], v[56:59], v[40:47], v60
    v_and_or_b32 v16, v16, -2, s30
    v_cvt_pk_bf16_f32 v17, v18, v19
    buffer_store_dwordx2 v[16:17], v66, s[4:7], s38 offen
    s_cmp_lg_u32 s13, 2
    s_nop 1
    v_cvt_pk_bf16_f32 v20, v20, v21
    v_and_or_b32 v20, v20, -2, s30
    v_cvt_pk_bf16_f32 v21, v22, v23
    buffer_store_dwordx2 v[20:21], v66, s[4:7], s39 offen
    s_cbranch_scc1 cf_w013
    s_nop 15
    s_nop 15
    s_nop 15
    s_nop 15
    s_nop 7
    buffer_load_dwordx4 v[40:43], v65, s[4:7], s19 offen offset:0 nt
    buffer_load_dwordx4 v[44:47], v65, s[4:7], s19 offen offset:1024 nt
    buffer_load_dwordx4 v[48:51], v65, s[4:7], s19 offen offset:2048 nt
    buffer_load_dwordx4 v[52:55], v65, s[4:7], s19 offen offset:3072 nt
    ds_read_b128 v[56:59], v65 offset:10240
    s_add_u32 s28, s28, 1
    s_mov_b32 s14, s41
    s_add_u32 s23, s23, 524288
    s_add_u32 s24, s24, 524288
    s_min_u32 s24, s24, s47
    s_add_u32 s15, s14, 4096
    s_add_u32 s16, s14, 8192
    v_mov_b32 v21, -1
    s_add_u32 s65, s65, 12288
    s_mov_b32 s40, 1
    v_mov_b64 v[0:1], 0
    v_mov_b64 v[2:3], 0
    v_mov_b64 v[4:5], 0
    v_mov_b64 v[6:7], 0
    v_mov_b64 v[8:9], 0
    v_mov_b64 v[10:11], 0
    v_mov_b64 v[12:13], 0
    v_mov_b64 v[14:15], 0
cf_chkF:
    v_mov_b32 v20, 0
    s_waitcnt vmcnt(3)
    s_waitcnt lgkmcnt(0)
    v_mfma_f32_16x16x32_bf16 v[28:31], v[40:43], v[56:59], 0
    v_bitop3_b32 v20, v20, v40, s30 bitop3:0xf6
    v_bitop3_b32 v20, v20, v42, s30 bitop3:0xf6
    s_waitcnt vmcnt(2)
    v_mfma_f32_16x16x32_bf16 v[28:31], v[44:47], v[56:59], v[28:31]
    v_bitop3_b32 v20, v20, v44, s30 bitop3:0xf6
    v_bitop3_b32 v20, v20, v46, s30 bitop3:0xf6
    s_waitcnt vmcnt(1)
    v_mfma_f32_16x16x32_bf16 v[28:31], v[48:51], v[56:59], v[28:31]
    v_bitop3_b32 v20, v20, v48, s30 bitop3:0xf6
    v_bitop3_b32 v20, v20, v50, s30 bitop3:0xf6
    s_waitcnt vmcnt(0)
    v_mfma_f32_16x16x32_bf16 v[28:31], v[52:55], v[56:59], v[28:31]
    v_bitop3_b32 v20, v20, v52, s30 bitop3:0xf6
    v_bitop3_b32 v20, v20, v54, s30 bitop3:0xf6
    v_and_b32 v20, s40, v20
    v_cmp_ne_u32 vcc, 0, v20
    s_cbranch_vccnz cf_spinF
    v_permlane32_swap_b32 v28, v30
    v_permlane32_swap_b32 v29, v31
    v_add_f32 v28, v28, v30
    v_add_f32 v30, v29, v31
    v_cvt_pk_bf16_f32 v28, v28, v30
    s_mov_b64 exec, s[32:33]
    buffer_store_dword v28, v69, s[4:7], s17 offen
    buffer_store_dword v21, v69, s[4:7], s18 offen
    s_mov_b64 exec, -1
    ds_read_b128 v[32:35], v62 offset:16384
    ds_read_b128 v[36:39], v62 offset:20480
    ds_read_b128 v[40:43], v61 offset:0
    ds_read_b128 v[44:47], v61 offset:4096
    ds_read_b128 v[48:51], v61 offset:8192
    ds_read_b128 v[52:55], v61 offset:12288
    s_nop 14
    buffer_load_dwordx4 v[24:27], v61, s[4:7], s14 offen nt
    s_branch cf_loop2
cf_w013:
    ds_read_b128 v[56:59], v65 offset:10240
    ds_read_b128 v[32:35], v62 offset:16384
    ds_read_b128 v[36:39], v62 offset:20480
    ds_read_b128 v[40:43], v61 offset:0
    ds_read_b128 v[44:47], v61 offset:4096
    ds_read_b128 v[48:51], v61 offset:8192
    ds_read_b128 v[52:55], v61 offset:12288
    s_add_u32 s28, s28, 1
    s_mov_b32 s14, s41
    s_add_u32 s23, s23, 524288
    s_add_u32 s24, s24, 524288
    s_min_u32 s24, s24, s47
    s_add_u32 s15, s14, 4096
    s_add_u32 s16, s14, 8192
    v_mov_b32 v21, -1
    s_add_u32 s65, s65, 12288
    s_mov_b32 s40, 1
    s_cmp_eq_u32 s64, 0
    s_cbranch_scc1 cf_w0
    s_cmp_eq_u32 s13, 1
    s_nop 15
    s_nop 15
    s_nop 7
    s_cbranch_scc1 cf_sx
    s_nop 15
    s_nop 13
cf_sx:
    buffer_load_dwordx4 v[0:3], v65, s[4:7], s19 offen offset:0 nt
    buffer_load_dwordx4 v[4:7], v65, s[4:7], s19 offen offset:1024 nt
    buffer_load_dwordx4 v[8:11], v65, s[4:7], s19 offen offset:2048 nt
    buffer_load_dwordx4 v[12:15], v65, s[4:7], s19 offen offset:3072 nt
cf_chkG:
    v_mov_b32 v20, 0
    s_waitcnt vmcnt(3)
    s_waitcnt lgkmcnt(6)
    v_mfma_f32_16x16x32_bf16 v[28:31], v[0:3], v[56:59], 0
    v_bitop3_b32 v20, v20, v0, s30 bitop3:0xf6
    v_bitop3_b32 v20, v20, v2, s30 bitop3:0xf6
    s_waitcnt vmcnt(2)
    v_mfma_f32_16x16x32_bf16 v[28:31], v[4:7], v[56:59], v[28:31]
    v_bitop3_b32 v20, v20, v4, s30 bitop3:0xf6
    v_bitop3_b32 v20, v20, v6, s30 bitop3:0xf6
    s_waitcnt vmcnt(1)
    v_mfma_f32_16x16x32_bf16 v[28:31], v[8:11], v[56:59], v[28:31]
    v_bitop3_b32 v20, v20, v8, s30 bitop3:0xf6
    v_bitop3_b32 v20, v20, v10, s30 bitop3:0xf6
    s_waitcnt vmcnt(0)
    v_mfma_f32_16x16x32_bf16 v[28:31], v[12:15], v[56:59], v[28:31]
    v_bitop3_b32 v20, v20, v12, s30 bitop3:0xf6
    v_bitop3_b32 v20, v20, v14, s30 bitop3:0xf6
    v_and_b32 v20, s40, v20
    v_cmp_ne_u32 vcc, 0, v20
    s_cbranch_vccnz cf_spinG
    v_permlane32_swap_b32 v28, v30
    v_permlane32_swap_b32 v29, v31
    v_add_f32 v28, v28, v30
    v_add_f32 v30, v29, v31
    s_cmp_eq_u32 s13, 3
    s_cbranch_scc1 cf_w3
    v_mov_b32 v29, v28
    v_mov_b32 v31, v30
    s_nop 0
    v_permlane16_swap_b32 v28, v29
    v_permlane16_swap_b32 v30, v31
    v_add_f32 v28, v28, v29
    v_add_f32 v30, v30, v31
cf_w3:
    v_cvt_pk_bf16_f32 v28, v28, v30
    s_mov_b64 exec, s[32:33]
    buffer_store_dword v28, v69, s[4:7], s17 offen
    buffer_store_dword v21, v69, s[4:7], s18 offen
    s_mov_b64 exec, -1
    buffer_load_dwordx4 v[24:27], v61, s[4:7], s14 offen nt
    s_branch cf_loop
cf_w0:
    v_mov_b64 v[0:1], 0
    v_mov_b64 v[2:3], 0
    v_mov_b64 v[4:5], 0
    v_mov_b64 v[6:7], 0
    v_mov_b64 v[8:9], 0
    v_mov_b64 v[10:11], 0
    v_mov_b64 v[12:13], 0
    v_mov_b64 v[14:15], 0
    s_cmp_lg_u32 s28, 10
    s_cbranch_scc1 cf_nokv
    s_lshr_b32 s92, s12, 1
    s_lshl_b32 s92, s92, 8
    s_add_u32 s92, s92, 125829120
    v_bfe_u32 v28, v61, 4, 6
    v_min_u32 v28, 11, v28
    v_lshlrev_b32 v28, 2, v28
    s_add_u32 s93, s95, 63
    s_mov_b32 s94, 4194304
cf_kv1:
    buffer_load_dword v29, v28, s[4:7], s92 offen sc1
    s_sub_u32 s94, s94, 1
    s_cbranch_scc1 cf_kv1_go
    s_waitcnt vmcnt(0)
    v_subrev_u32 v29, s93, v29
    v_cmp_lt_u32 vcc, 64, v29
    s_cbranch_vccz cf_kv1_go
    s_sleep 2
    s_branch cf_kv1
cf_kv1_go:
cf_nokv:
    s_nop 15
    s_nop 15
    s_nop 15
    s_nop 15
    s_nop 15
    s_nop 15
    s_nop 15
    s_nop 15
    s_nop 15
    s_nop 15
    s_nop 7
    buffer_load_dwordx4 v[24:27], v61, s[4:7], s14 offen nt
    s_branch cf_loop2
cf_spinF:
    buffer_load_dwordx4 v[40:43], v65, s[4:7], s19 offen offset:0 nt
    buffer_load_dwordx4 v[44:47], v65, s[4:7], s19 offen offset:1024 nt
    buffer_load_dwordx4 v[48:51], v65, s[4:7], s19 offen offset:2048 nt
    buffer_load_dwordx4 v[52:55], v65, s[4:7], s19 offen offset:3072 nt
    s_sub_u32 s29, s29, 1
    s_cmp_lt_i32 s29, 0
    s_cselect_b32 s40, 0, 1
    s_branch cf_chkF
cf_spinG:
    buffer_load_dwordx4 v[0:3], v65, s[4:7], s19 offen offset:0 nt
    buffer_load_dwordx4 v[4:7], v65, s[4:7], s19 offen offset:1024 nt
    buffer_load_dwordx4 v[8:11], v65, s[4:7], s19 offen offset:2048 nt
    buffer_load_dwordx4 v[12:15], v65, s[4:7], s19 offen offset:3072 nt
    s_sub_u32 s29, s29, 1
    s_cmp_lt_i32 s29, 0
    s_cselect_b32 s40, 0, 1
    s_branch cf_chkG
cf_guard:
    s_cbranch_scc0 cf_guard2
    buffer_store_dwordx4 v[16:19], v61, s[4:7], s26 offen sc1
    s_add_u32 s26, s26, 131072
cf_guard2:
    s_nop 7
    v_max3_f32 v6, v28, v29, v30
    v_max3_f32 v7, v31, v56, v57
    v_max_f32 v6, v6, v7
    s_nop 1
    v_max_f32_dpp v6, v6, v6 row_ror:8 row_mask:0xf bank_mask:0xf
    v_mov_b32 v7, v6
    s_nop 1
    v_permlane32_swap_b32 v6, v7
    v_max_f32 v6, v6, v7
    v_mov_b32 v7, v6
    s_nop 1
    v_permlane16_swap_b32 v6, v7
    v_max_f32 v6, v6, v7
    v_sub_f32 v28, v28, v6
    v_sub_f32 v29, v29, v6
    v_sub_f32 v30, v30, v6
    v_sub_f32 v31, v31, v6
    v_sub_f32 v56, v56, v6
    v_sub_f32 v57, v57, v6
    v_exp_f32 v58, v56
    v_exp_f32 v59, v57
    s_nop 0
    v_cvt_pk_bf16_f32 v6, v58, v59
    s_nop 1
    v_mov_b32_dpp v7, v6 row_ror:8 row_mask:0xf bank_mask:0xf
    v_exp_f32 v0, v28
    s_nop 0
    v_mfma_f32_16x16x16_bf16 v[12:15], v[16:17], v[6:7], 0
    v_exp_f32 v1, v29
    v_exp_f32 v2, v30
    v_cvt_pk_bf16_f32 v8, v0, v1
    v_exp_f32 v3, v31
    v_mfma_f32_16x16x16_bf16 v[20:23], v[18:19], v[6:7], 0
    v_cvt_pk_bf16_f32 v9, v2, v3
    v_mov_b32_dpp v10, v8 row_ror:8 row_mask:0xf bank_mask:0xf
    v_max3_f32 v4, |v28|, |v29|, |v30|
    v_mov_b32_dpp v11, v9 row_ror:8 row_mask:0xf bank_mask:0xf
    v_mfma_f32_16x16x32_bf16 v[0:3], v[24:27], v[6:9], 0
    v_max3_f32 v4, v4, |v31|, |v56|
    v_max_f32_e64 v4, v4, |v57|
    v_mfma_f32_16x16x32_bf16 v[12:15], v[40:43], v[8:11], v[12:15]
    v_cmp_nge_f32 vcc, s46, v4
    v_mfma_f32_16x16x32_bf16 v[20:23], v[44:47], v[8:11], v[20:23]
    v_add_f32_dpp v0, v0, v0 row_ror:8 row_mask:0xf bank_mask:0xf
    v_rcp_f32 v0, v0
    s_nop 4
    s_branch cf_norm
cf_spin0:
    buffer_load_dwordx4 v[24:27], v61, s[4:7], s14 offen nt
    s_sub_u32 s29, s29, 1
    s_cmp_lt_i32 s29, 0
    s_cbranch_scc0 cf_chk0
    s_waitcnt vmcnt(0)
    v_min_u32 v24, -2, v24
    v_min_u32 v25, -2, v25
    v_min_u32 v26, -2, v26
    v_min_u32 v27, -2, v27
    s_branch cf_chk0
cf_spin1:
    buffer_load_dwordx4 v[28:31], v61, s[4:7], s15 offen nt
    buffer_load_dword v59, v56, s[4:7], s16 offen nt
    s_sub_u32 s29, s29, 1
    s_cmp_lt_i32 s29, 0
    s_waitcnt vmcnt(0)
    v_max3_u32 v57, v28, v29, v30
    v_max3_u32 v57, v57, v31, v59
    v_cmp_eq_u32 vcc, -1, v57
    ds_write_b128 v62, v[28:31] offset:45056
    ds_write_b32 v58, v59
    s_waitcnt lgkmcnt(0)
    s_cbranch_scc1 cf_go1
    s_cbranch_vccnz cf_spin1
    s_branch cf_go1
cf_last:
    s_nop 1
    s_cmp_eq_u32 s28, 63
    s_cbranch_scc1 cf_last2
    s_mov_b64 exec, s[34:35]
    buffer_store_dwordx4 v[0:3], v61, s[4:7], s25 offen sc1
    s_mov_b64 exec, -1
    s_add_u32 s25, s25, 131072
    s_mov_b32 s46, 0xbf800000
    s_cmp_eq_u32 0, 0
    s_branch cf_back
cf_last2:
    s_waitcnt lgkmcnt(0)
    s_mov_b64 exec, s[34:35]
    buffer_store_dwordx4 v[0:3], v61, s[4:7], s25 offen sc1
    s_mov_b64 exec, -1
    s_add_u32 s40, s95, 64
    v_mov_b32 v40, s40
    v_smfmac_f32_16x16x64_bf16 v[16:19], v[52:55], a[240:247], v60
    v_smfmac_f32_16x16x64_bf16 v[20:23], v[52:55], a[248:255], v60
    s_nop 3
    v_cvt_pk_bf16_f32 v16, v16, v17
    v_cvt_pk_bf16_f32 v17, v18, v19
    s_nop 1
    v_cvt_pk_bf16_f32 v18, v20, v21
    v_cvt_pk_bf16_f32 v19, v22, v23
    buffer_store_dwordx4 v[16:19], v61, s[4:7], s26 offen sc1
    s_waitcnt vmcnt(0)
    s_mov_b64 exec, 1
    buffer_store_dword v40, off, s[4:7], s27 sc1
    s_mov_b64 exec, -1
    s_endpgm
cf_dma:
    s_xor_b32 s74, s76, s81
    s_add_u32 m0, s74, s80
    s_add_u32 s76, s76, 4096
    buffer_load_dwordx4 v58, s[8:11], s78 offen lds
    s_add_u32 s78, s78, s79
    s_cmp_lt_u32 s76, s77
    s_cbranch_scc1 cf_dma
    s_setpc_b64 s[82:83]
L_chain_safe:
    s_mov_b64 s[48:49], s[50:51]
    s_mov_b64 s[50:51], s[52:53]
    s_mov_b64 s[52:53], s[54:55]
    s_mov_b64 s[54:55], s[56:57]
    s_mov_b64 s[56:57], s[58:59]
    v_lshrrev_b32 v54, 6, v0
    s_nop 0
    v_readfirstlane_b32 s13, v54
    v_and_b32 v57, 63, v0
    v_bfe_u32 v54, v57, 2, 1
    v_lshlrev_b32 v48, 13, v54
    v_bfe_u32 v54, v57, 3, 1
    v_lshl_add_u32 v48, v54, 15, v48
    v_bfe_u32 v54, v57, 4, 1
    v_lshl_add_u32 v48, v54, 14, v48
    v_bfe_u32 v54, v57, 5, 1
    v_lshl_add_u32 v48, v54, 16, v48
    v_lshrrev_b32 v55, 4, v57
    v_and_b32 v55, 2, v55
    v_xor_b32 v55, v55, v57
    v_and_b32 v55, 3, v55
    v_lshl_add_u32 v48, v55, 4, v48
    v_bfe_u32 v54, v57, 2, 1
    v_lshlrev_b32 v51, 6, v54
    v_bfe_u32 v54, v57, 3, 1
    v_lshl_add_u32 v51, v54, 9, v51
    v_bfe_u32 v54, v57, 4, 1
    v_lshl_add_u32 v51, v54, 7, v51
    v_bfe_u32 v54, v57, 5, 1
    v_lshl_add_u32 v51, v54, 12, v51
    v_bfe_u32 v54, v57, 0, 1
    v_lshl_add_u32 v51, v54, 3, v51
    v_bfe_u32 v54, v57, 1, 1
    v_lshl_add_u32 v51, v54, 4, v51
    v_bfe_u32 v54, v57, 3, 1
    v_lshl_add_u32 v51, v54, 5, v51
    v_lshrrev_b32 v55, 3, v57
    v_mul_u32_u24 v49, 1152, v55
    v_and_b32 v55, 7, v57
    v_lshl_add_u32 v49, v55, 4, v49
    v_bfe_u32 v54, v57, 4, 1
    v_lshlrev_b32 v52, 13, v54
    v_bfe_u32 v54, v57, 5, 1
    v_lshl_add_u32 v52, v54, 9, v52
    v_bfe_u32 v54, v57, 2, 1
    v_lshl_add_u32 v52, v54, 7, v52
    v_bfe_u32 v54, v57, 3, 1
    v_lshl_add_u32 v52, v54, 5, v52
    v_and_b32 v55, 3, v57
    v_lshl_add_u32 v52, v55, 3, v52
    v_lshrrev_b32 v55, 2, v57
    v_mul_u32_u24 v50, 1152, v55
    v_and_b32 v55, 3, v57
    v_lshl_add_u32 v50, v55, 4, v50
    v_bfe_u32 v54, v57, 4, 1
    v_lshlrev_b32 v53, 12, v54
    v_bfe_u32 v54, v57, 5, 1
    v_lshl_add_u32 v53, v54, 8, v53
    v_bfe_u32 v54, v57, 2, 1
    v_lshl_add_u32 v53, v54, 6, v53
    v_bfe_u32 v54, v57, 3, 1
    v_lshl_add_u32 v53, v54, 5, v53
    v_and_b32 v55, 3, v57
    v_lshl_add_u32 v53, v55, 3, v53
    s_lshl_b32 s66, s13, 10
    s_and_b32 s93, s13, 1
    s_lshl_b32 s93, s93, 14
    s_and_b32 s75, s13, 2
    s_lshl_b32 s75, s75, 19
    v_add_u32 v51, s66, v51
    v_add_u32 v52, s66, v52
    v_add_u32 v53, s66, v53
    v_mov_b32 v58, v48
    s_mov_b32 s10, 4718592
    s_mov_b32 s11, 0x20000
    s_lshl_b32 s67, s12, 8
    s_lshl_b32 s40, s13, 6
    s_add_u32 s67, s67, s40
    s_mul_i32 s92, s12, 147456
    s_lshr_b32 s73, s50, 8
    s_add_u32 s73, s73, s12
    s_and_b32 s73, s73, 31
    s_bitcmp1_b32 0xa2222222, s73
    s_cselect_b32 s88, 0, 0
    s_mov_b32 s72, 0
    s_add_u32 s73, s73, 1
    s_lshr_b32 s73, s73, 2
    s_xor_b32 s94, s13, 0
    s_mul_i32 s94, s94, 36864
    s_add_u32 s94, s94, s92
    s_lshl_b32 s74, s13, 7
    s_add_u32 s94, s94, s74
    s_add_u32 s78, s94, 0
    s_mov_b64 s[8:9], s[56:57]
    v_mov_b32 v58, v49
    s_mov_b32 s79, 9216
    s_mov_b32 s81, 0
    s_add_u32 s80, s66, 114688
    s_mov_b32 s76, 0
    s_mov_b32 s77, 8192
    s_call_b64 s[82:83], cs_dma
    s_mov_b32 s77, 16384
    s_call_b64 s[82:83], cs_dma
    s_xor_b32 s94, s13, 1
    s_mul_i32 s94, s94, 36864
    s_add_u32 s94, s94, s92
    s_lshl_b32 s74, s13, 7
    s_add_u32 s94, s94, s74
    s_add_u32 s78, s94, 0
    s_add_u32 s80, s66, 81920
    s_mov_b32 s76, 0
    s_mov_b32 s77, 8192
    s_call_b64 s[82:83], cs_dma
    s_mov_b32 s77, 16384
    s_call_b64 s[82:83], cs_dma
    s_xor_b32 s94, s13, 2
    s_mul_i32 s94, s94, 36864
    s_add_u32 s94, s94, s92
    s_lshl_b32 s74, s13, 7
    s_add_u32 s94, s94, s74
    s_add_u32 s78, s94, 0
    s_add_u32 s80, s66, 16384
    s_mov_b32 s76, 0
    s_mov_b32 s77, 8192
    s_call_b64 s[82:83], cs_dma
    v_lshrrev_b32 v24, 6, v0
    v_lshlrev_b32 v61, 4, v0
    v_add_u32 v62, 57344, v61
    v_xor_b32 v63, 1024, v61
    v_add_u32 v63, 98304, v63
    v_xor_b32 v64, 2048, v61
    v_add_u32 v64, 98304, v64
    v_and_b32 v65, 1023, v61
    v_add_u32 v65, 98304, v65
    v_and_b32 v26, 15, v0
    v_bfe_u32 v27, v0, 4, 2
    v_mov_b32 v60, 0x4444
    v_mov_b32 v25, 0xeeee
    v_cmp_lt_u32 vcc, 7, v26
    s_nop 1
    v_cndmask_b32 v60, v60, v25, vcc
    s_mov_b32 s77, 16384
    s_call_b64 s[82:83], cs_dma
    v_and_b32 v67, 12, v26
    v_lshlrev_b32 v67, 3, v67
    v_and_b32 v25, 1, v26
    v_lshl_add_u32 v67, v25, 4, v67
    v_bfe_u32 v25, v26, 1, 1
    v_lshl_add_u32 v67, v25, 3, v67
    v_lshl_add_u32 v66, v27, 14, v67
    v_lshl_add_u32 v66, v24, 17, v66
    s_xor_b32 s94, s13, 3
    s_mul_i32 s94, s94, 36864
    s_add_u32 s94, s94, s92
    s_lshl_b32 s74, s13, 7
    s_add_u32 s94, s94, s74
    s_add_u32 s78, s94, 0
    s_add_u32 s80, s66, 0
    s_mov_b32 s76, 0
    s_mov_b32 s77, 8192
    s_call_b64 s[82:83], cs_dma
    v_and_b32 v67, 63, v67
    v_lshrrev_b32 v25, 1, v24
    v_lshl_add_u32 v67, v25, 18, v67
    v_lshl_add_u32 v67, v27, 16, v67
    v_lshrrev_b32 v25, 3, v26
    v_lshl_add_u32 v67, v25, 15, v67
    v_and_b32 v25, 1, v24
    v_lshl_add_u32 v67, v25, 6, v67
    s_mov_b32 s77, 16384
    s_call_b64 s[82:83], cs_dma
    v_and_b32 v25, 31, v0
    v_lshlrev_b32 v70, 4, v25
    v_lshlrev_b32 v28, 3, v25
    v_add_u32 v28, 108032, v28
    v_lshrrev_b32 v25, 1, v24
    v_lshl_add_u32 v70, v25, 9, v70
    v_and_b32 v25, 1, v24
    v_lshl_add_u32 v70, v25, 3, v70
    v_add_u32 v70, 109568, v70
    v_cmp_gt_u32 vcc, 2, v27
    s_nop 1
    v_cndmask_b32 v70, v70, v28, vcc
    v_xor_b32 v71, 2048, v63
    v_lshrrev_b32 v68, 4, v0
    v_lshlrev_b32 v68, 7, v68
    v_and_b32 v25, 7, v26
    v_lshl_add_u32 v68, v25, 4, v68
    v_add_u32 v68, 98304, v68
    v_xor_b32 v74, 512, v68
    v_xor_b32 v75, 1024, v68
    v_xor_b32 v76, 1536, v68
    v_lshrrev_b32 v25, 3, v26
    v_lshl_add_u32 v77, v25, 3, v68
    v_or_b32 v78, 512, v65
    v_lshlrev_b32 v79, 2, v61
    v_mov_b64 v[72:73], 0
    v_and_b32 v25, 1, v27
    v_lshlrev_b32 v69, 7, v25
    v_lshrrev_b32 v25, 1, v27
    v_lshl_add_u32 v69, v25, 3, v69
    v_and_b32 v25, 3, v26
    v_lshl_add_u32 v69, v25, 4, v69
    v_bfe_u32 v25, v26, 2, 1
    v_lshl_add_u32 v69, v25, 2, v69
    s_mov_b32 s32, 0x00ff00ff
    s_mov_b32 s33, 0x00ff00ff
    s_not_b64 s[34:35], s[32:33]
    s_lshr_b32 s31, s12, 1
    s_lshl_b32 s31, s31, 8
    s_and_b32 s40, s12, 1
    s_lshl_b32 s40, s40, 6
    s_add_u32 s31, s31, s40
    s_and_b32 s40, s13, 1
    s_lshl_b32 s40, s40, 12
    s_add_u32 s31, s31, s40
    s_lshl_b32 s19, s12, 14
    s_add_u32 s19, s19, 68124672
    s_add_u32 s41, s19, 8192
    s_add_u32 s19, s19, s40
    s_and_b32 s40, s12, 1
    s_lshl_b32 s40, s40, 2
    s_or_b32 s40, s40, s13
    s_cmp_eq_u32 s40, 5
    s_cselect_b32 s64, 0, s13
    s_cmp_lg_u32 s13, 1
    s_cbranch_scc1 cs_notx
    s_mov_b32 s32, 0xff
    s_mov_b32 s33, 0xff
    s_mov_b32 s19, s41
    s_lshr_b32 s31, s12, 3
    s_lshl_b32 s31, s31, 8
    s_and_b32 s40, s12, 2
    s_lshl_b32 s40, s40, 6
    s_add_u32 s31, s31, s40
    s_and_b32 s40, s12, 4
    s_lshl_b32 s40, s40, 4
    s_add_u32 s31, s31, s40
    s_add_u32 s31, s31, 8192
cs_notx:
    s_cmp_lg_u32 s13, 0
    s_cbranch_scc1 cs_notp
    s_min_u32 s40, s12, 23
    s_mul_i32 s40, s40, 384
    s_add_u32 s40, s40, 98304
    v_add_u32 v69, s40, v61
    v_mov_b32 v25, 108288
    v_cmp_lt_u32 vcc, 23, v0
    s_nop 1
    v_cndmask_b32 v69, v69, v25, vcc
cs_notp:
    s_nop 1
    v_mov_b32 v28, 1
    v_mov_b32 v29, 1
    v_mov_b32 v30, 1
    v_mov_b32 v31, 1
    s_lshl_b32 s40, s12, 14
    s_add_u32 s40, s40, 68222976
    s_add_u32 s41, s40, 0
    buffer_store_dwordx4 v[28:31], v61, s[4:7], s41 offen sc1
    s_add_u32 s41, s40, 4096
    buffer_store_dwordx4 v[28:31], v61, s[4:7], s41 offen sc1
    s_add_u32 s41, s40, 8192
    buffer_store_dwordx4 v[28:31], v61, s[4:7], s41 offen sc1
    s_cmp_eq_u32 s64, 0
    s_cselect_b64 exec, 0, s[32:33]
    v_mov_b32 v27, -1
    s_add_u32 s41, s31, 68157440
    buffer_store_dword v27, v69, s[4:7], s41 offen sc1
    s_add_u32 s41, s31, 68173824
    buffer_store_dword v27, v69, s[4:7], s41 offen sc1
    s_add_u32 s41, s31, 68190208
    buffer_store_dword v27, v69, s[4:7], s41 offen sc1
    s_add_u32 s41, s31, 68206592
    buffer_store_dword v27, v69, s[4:7], s41 offen sc1
    s_mov_b64 exec, -1
    s_mov_b64 s[68:69], s[48:49]
    s_mov_b32 s70, 9216
    s_mov_b32 s71, 0x20000
    v_and_b32 v25, 7, v0
    v_mul_u32_u24 v25, 1152, v25
    v_lshrrev_b32 v26, 3, v0
    v_lshl_add_u32 v25, v26, 4, v25
    buffer_load_dwordx4 v[36:39], v25, s[68:71], 0 offen
    buffer_load_dwordx4 v[40:43], v25, s[68:71], 0 offen offset:512
    v_bfe_u32 v25, v0, 2, 3
    v_mul_u32_u24 v25, 1152, v25
    v_lshrrev_b32 v26, 5, v0
    v_lshl_add_u32 v25, v26, 4, v25
    v_and_b32 v26, 3, v0
    v_lshl_add_u32 v25, v26, 2, v25
    buffer_load_dword v44, v25, s[68:71], 0 offen offset:1024
    s_waitcnt vmcnt(15)
    v_add_u32 v55, 114688, v52
    ds_read_b64_tr_b16 v[160:161], v55 offset:0
    ds_read_b64_tr_b16 v[162:163], v55 offset:256
    ds_read_b64_tr_b16 v[164:165], v55 offset:4096
    ds_read_b64_tr_b16 v[166:167], v55 offset:4352
    s_xor_b32 s94, s13, 0
    s_mul_i32 s94, s94, 36864
    s_add_u32 s94, s94, s92
    s_lshl_b32 s74, s13, 7
    s_add_u32 s94, s94, s74
    s_add_u32 s78, s94, 512
    s_add_u32 s80, s66, 147456
    s_mov_b32 s76, 0
    s_mov_b32 s77, 8192
    s_call_b64 s[82:83], cs_dma
    ds_read_b64_tr_b16 v[192:193], v55 offset:64
    ds_read_b64_tr_b16 v[194:195], v55 offset:320
    ds_read_b64_tr_b16 v[196:197], v55 offset:4160
    ds_read_b64_tr_b16 v[198:199], v55 offset:4416
    s_mov_b32 s77, 16384
    s_call_b64 s[82:83], cs_dma
    s_waitcnt lgkmcnt(0)
    s_waitcnt vmcnt(15)
    v_add_u32 v55, 81920, v52
    ds_read_b64_tr_b16 v[168:169], v55 offset:0
    ds_read_b64_tr_b16 v[170:171], v55 offset:256
    ds_read_b64_tr_b16 v[172:173], v55 offset:4096
    ds_read_b64_tr_b16 v[174:175], v55 offset:4352
    s_xor_b32 s94, s13, 1
    s_mul_i32 s94, s94, 36864
    s_add_u32 s94, s94, s92
    s_lshl_b32 s74, s13, 7
    s_add_u32 s94, s94, s74
    s_add_u32 s78, s94, 512
    s_add_u32 s80, s66, 98304
    s_mov_b32 s76, 0
    s_mov_b32 s77, 8192
    s_call_b64 s[82:83], cs_dma
    ds_read_b64_tr_b16 v[200:201], v55 offset:64
    ds_read_b64_tr_b16 v[202:203], v55 offset:320
    ds_read_b64_tr_b16 v[204:205], v55 offset:4160
    ds_read_b64_tr_b16 v[206:207], v55 offset:4416
    s_mov_b32 s77, 16384
    s_call_b64 s[82:83], cs_dma
    s_waitcnt lgkmcnt(0)
    s_waitcnt vmcnt(15)
    v_add_u32 v55, 16384, v52
    ds_read_b64_tr_b16 v[176:177], v55 offset:0
    ds_read_b64_tr_b16 v[178:179], v55 offset:256
    ds_read_b64_tr_b16 v[180:181], v55 offset:4096
    ds_read_b64_tr_b16 v[182:183], v55 offset:4352
    s_add_u32 s78, s67, 4194304
    s_mov_b64 s[8:9], s[54:55]
    v_mov_b32 v58, v48
    s_mov_b32 s79, 131072
    s_add_u32 s80, s66, 32768
    s_mov_b32 s76, 0
    s_mov_b32 s77, 8192
    s_call_b64 s[82:83], cs_dma
    ds_read_b64_tr_b16 v[208:209], v55 offset:64
    ds_read_b64_tr_b16 v[210:211], v55 offset:320
    ds_read_b64_tr_b16 v[212:213], v55 offset:4160
    ds_read_b64_tr_b16 v[214:215], v55 offset:4416
    s_mov_b32 s77, 16384
    s_call_b64 s[82:83], cs_dma
    s_waitcnt lgkmcnt(0)
    s_waitcnt vmcnt(15)
    v_add_u32 v55, 0, v52
    ds_read_b64_tr_b16 v[184:185], v55 offset:0
    ds_read_b64_tr_b16 v[186:187], v55 offset:256
    ds_read_b64_tr_b16 v[188:189], v55 offset:4096
    ds_read_b64_tr_b16 v[190:191], v55 offset:4352
    s_xor_b32 s78, s75, 0
    s_add_u32 s78, s78, s67
    s_mov_b32 s81, s93
    s_add_u32 s80, s66, 114688
    s_mov_b32 s76, 0
    s_mov_b32 s77, 8192
    s_call_b64 s[82:83], cs_dma
    ds_read_b64_tr_b16 v[216:217], v55 offset:64
    ds_read_b64_tr_b16 v[218:219], v55 offset:320
    ds_read_b64_tr_b16 v[220:221], v55 offset:4160
    ds_read_b64_tr_b16 v[222:223], v55 offset:4416
    s_mov_b32 s77, 16384
    s_call_b64 s[82:83], cs_dma
    s_waitcnt lgkmcnt(0)
    s_waitcnt vmcnt(12)
    v_add_u32 v55, 147456, v52
    ds_read_b64_tr_b16 v[224:225], v55 offset:0
    ds_read_b64_tr_b16 v[226:227], v55 offset:256
    ds_read_b64_tr_b16 v[228:229], v55 offset:4096
    ds_read_b64_tr_b16 v[230:231], v55 offset:4352
    s_mov_b32 s77, 24576
    s_call_b64 s[82:83], cs_dma
    ds_read_b64_tr_b16 v[240:241], v55 offset:64
    ds_read_b64_tr_b16 v[242:243], v55 offset:320
    ds_read_b64_tr_b16 v[244:245], v55 offset:4160
    ds_read_b64_tr_b16 v[246:247], v55 offset:4416
    s_mov_b32 s77, 32768
    s_call_b64 s[82:83], cs_dma
    s_waitcnt lgkmcnt(0)
    v_min_u32 v36, -2, v36
    v_min_u32 v37, -2, v37
    v_min_u32 v38, -2, v38
    v_min_u32 v39, -2, v39
    v_min_u32 v40, -2, v40
    v_min_u32 v41, -2, v41
    v_min_u32 v42, -2, v42
    v_min_u32 v43, -2, v43
    v_min_u32 v44, -2, v44
    s_lshl_b32 s14, s12, 16
    s_add_u32 s14, s14, 92274688
    s_add_u32 s41, s14, 4096
    s_add_u32 s42, s14, 8192
    v_lshrrev_b32 v45, 2, v61
    buffer_store_dwordx4 v[36:39], v61, s[4:7], s14 offen sc1
    buffer_store_dwordx4 v[40:43], v61, s[4:7], s41 offen sc1
    buffer_store_dword v44, v45, s[4:7], s42 offen sc1
    v_mov_b32 v46, 1
    s_mov_b64 exec, 1
    buffer_atomic_add v46, off, s[96:99], 0 offset:212 sc0
    s_mov_b64 exec, -1
    s_mov_b32 s44, 0x3e0293ee
    s_mov_b32 s45, s44
    s_mov_b32 s46, 0x42000000
    s_mov_b32 s60, 0x3f803f80
    s_mov_b32 s61, s60
    s_mov_b32 s62, 0x3e803e80
    s_mov_b32 s63, s62
    s_mov_b32 s28, 0
    s_lshl_b32 s24, s12, 14
    s_add_u32 s24, s24, 0
    s_add_u32 s47, s24, 33030144
    s_mul_i32 s40, s13, 3072
    s_add_u32 s23, s24, s40
    s_lshl_b32 s20, s12, 7
    s_add_u32 s20, s20, 68222976
    s_add_u32 s21, s20, 65536
    s_add_u32 s38, s20, 4096
    s_add_u32 s39, s21, 4096
    s_lshl_b32 s22, s12, 7
    s_add_u32 s22, s22, 68231168
    s_lshl_b32 s40, s12, 12
    s_add_u32 s25, s40, 79429632
    s_add_u32 s26, s40, 88866816
    s_lshl_b32 s65, s12, 9
    s_add_u32 s65, s65, 90177536
    s_lshl_b32 s40, s13, 5
    s_or_b32 s40, s40, s12
    s_cmp_lt_u32 s40, 24
    s_cselect_b32 s36, 0x1ffffff, 0
    s_mov_b32 s37, 0
    s_lshl_b32 s27, s12, 7
    s_add_u32 s27, s27, 125845504
    s_lshl_b32 s40, s13, 2
    s_add_u32 s27, s27, s40
    v_bfe_u32 v24, v61, 4, 4
    v_bfe_u32 v25, v61, 8, 1
    v_lshlrev_b32 v25, 2, v25
    v_sub_u32 v25, v24, v25
    v_mov_b32 v26, 0x3f80
    v_mov_b32 v27, 0x3f800000
    v_cmp_eq_u32 vcc, 0, v25
    s_nop 1
    v_cndmask_b32 v16, 0, v26, vcc
    v_cmp_eq_u32 vcc, 1, v25
    s_nop 1
    v_cndmask_b32 v16, v16, v27, vcc
    v_cmp_eq_u32 vcc, 0, v24
    s_nop 1
    v_cndmask_b32 v20, 0, v26, vcc
    v_cmp_eq_u32 vcc, 1, v24
    s_nop 1
    v_cndmask_b32 v20, v20, v27, vcc
    v_cmp_eq_u32 vcc, 2, v25
    s_nop 1
    v_cndmask_b32 v17, 0, v26, vcc
    v_cmp_eq_u32 vcc, 3, v25
    s_nop 1
    v_cndmask_b32 v17, v17, v27, vcc
    v_cmp_eq_u32 vcc, 2, v24
    s_nop 1
    v_cndmask_b32 v21, 0, v26, vcc
    v_cmp_eq_u32 vcc, 3, v24
    s_nop 1
    v_cndmask_b32 v21, v21, v27, vcc
    v_cmp_eq_u32 vcc, 8, v25
    s_nop 1
    v_cndmask_b32 v18, 0, v26, vcc
    v_cmp_eq_u32 vcc, 9, v25
    s_nop 1
    v_cndmask_b32 v18, v18, v27, vcc
    v_cmp_eq_u32 vcc, 4, v24
    s_nop 1
    v_cndmask_b32 v22, 0, v26, vcc
    v_cmp_eq_u32 vcc, 5, v24
    s_nop 1
    v_cndmask_b32 v22, v22, v27, vcc
    v_cmp_eq_u32 vcc, 10, v25
    s_nop 1
    v_cndmask_b32 v19, 0, v26, vcc
    v_cmp_eq_u32 vcc, 11, v25
    s_nop 1
    v_cndmask_b32 v19, v19, v27, vcc
    v_cmp_eq_u32 vcc, 6, v24
    s_nop 1
    v_cndmask_b32 v23, 0, v26, vcc
    v_cmp_eq_u32 vcc, 7, v24
    s_nop 1
    v_cndmask_b32 v23, v23, v27, vcc
    s_waitcnt vmcnt(13)
    v_add_u32 v55, 98304, v52
    ds_read_b64_tr_b16 v[232:233], v55 offset:0
    ds_read_b64_tr_b16 v[234:235], v55 offset:256
    ds_read_b64_tr_b16 v[236:237], v55 offset:4096
    ds_read_b64_tr_b16 v[238:239], v55 offset:4352
    s_xor_b32 s78, s75, 1048576
    s_add_u32 s78, s78, s67
    s_add_u32 s80, s66, 65536
    s_mov_b32 s76, 0
    s_mov_b32 s77, 8192
    s_call_b64 s[82:83], cs_dma
    ds_read_b64_tr_b16 v[248:249], v55 offset:64
    ds_read_b64_tr_b16 v[250:251], v55 offset:320
    ds_read_b64_tr_b16 v[252:253], v55 offset:4160
    ds_read_b64_tr_b16 v[254:255], v55 offset:4416
    s_mov_b32 s77, 16384
    s_call_b64 s[82:83], cs_dma
    s_waitcnt lgkmcnt(0)
    s_waitcnt vmcnt(13)
    v_add_u32 v55, 32768, v51
    v_xor_b32 v56, 32, v55
    ds_read_b64_tr_b16 v[144:145], v55 offset:0
    ds_read_b64_tr_b16 v[146:147], v55 offset:256
    ds_read_b64_tr_b16 v[148:149], v55 offset:8192
    ds_read_b64_tr_b16 v[150:151], v55 offset:8448
    s_mov_b32 s77, 24576
    s_call_b64 s[82:83], cs_dma
    ds_read_b64_tr_b16 v[152:153], v56 offset:0
    ds_read_b64_tr_b16 v[154:155], v56 offset:256
    ds_read_b64_tr_b16 v[156:157], v56 offset:8192
    ds_read_b64_tr_b16 v[158:159], v56 offset:8448
    s_mov_b32 s77, 32768
    s_call_b64 s[82:83], cs_dma
    s_waitcnt lgkmcnt(0)
    s_waitcnt vmcnt(9)
    v_add_u32 v55, 114688, v51
    v_xor_b32 v56, 32, v55
    ds_read_b64_tr_b16 a[192:193], v55 offset:0
    ds_read_b64_tr_b16 a[194:195], v55 offset:256
    ds_read_b64_tr_b16 a[196:197], v55 offset:8192
    ds_read_b64_tr_b16 a[198:199], v55 offset:8448
    s_xor_b32 s78, s75, 2097152
    s_add_u32 s78, s78, s67
    s_add_u32 s80, s66, 0
    s_mov_b32 s76, 0
    s_mov_b32 s77, 8192
    s_call_b64 s[82:83], cs_dma
    ds_read_b64_tr_b16 a[200:201], v56 offset:0
    ds_read_b64_tr_b16 a[202:203], v56 offset:256
    ds_read_b64_tr_b16 a[204:205], v56 offset:8192
    ds_read_b64_tr_b16 a[206:207], v56 offset:8448
    s_mov_b32 s77, 16384
    s_call_b64 s[82:83], cs_dma
    s_waitcnt lgkmcnt(0)
    v_add_u32 v55, 131072, v51
    v_xor_b32 v56, 32, v55
    ds_read_b64_tr_b16 a[208:209], v55 offset:0
    ds_read_b64_tr_b16 a[210:211], v55 offset:256
    ds_read_b64_tr_b16 a[212:213], v55 offset:8192
    ds_read_b64_tr_b16 a[214:215], v55 offset:8448
    s_mov_b32 s77, 24576
    s_call_b64 s[82:83], cs_dma
    ds_read_b64_tr_b16 a[216:217], v56 offset:0
    ds_read_b64_tr_b16 a[218:219], v56 offset:256
    ds_read_b64_tr_b16 a[220:221], v56 offset:8192
    ds_read_b64_tr_b16 a[222:223], v56 offset:8448
    s_mov_b32 s77, 32768
    s_call_b64 s[82:83], cs_dma
    s_waitcnt lgkmcnt(0)
    s_waitcnt vmcnt(8)
    v_add_u32 v55, 65536, v51
    v_xor_b32 v56, 32, v55
    ds_read_b64_tr_b16 a[224:225], v55 offset:0
    ds_read_b64_tr_b16 a[226:227], v55 offset:256
    ds_read_b64_tr_b16 a[228:229], v55 offset:8192
    ds_read_b64_tr_b16 a[230:231], v55 offset:8448
    s_xor_b32 s78, s75, 3145728
    s_add_u32 s78, s78, s67
    s_add_u32 s80, s66, 32768
    s_mov_b32 s76, 0
    s_mov_b32 s77, 8192
    s_call_b64 s[82:83], cs_dma
    ds_read_b64_tr_b16 a[232:233], v56 offset:0
    ds_read_b64_tr_b16 a[234:235], v56 offset:256
    ds_read_b64_tr_b16 a[236:237], v56 offset:8192
    ds_read_b64_tr_b16 a[238:239], v56 offset:8448
    s_mov_b32 s77, 16384
    s_call_b64 s[82:83], cs_dma
    s_waitcnt lgkmcnt(0)
    v_add_u32 v55, 81920, v51
    v_xor_b32 v56, 32, v55
    ds_read_b64_tr_b16 a[240:241], v55 offset:0
    ds_read_b64_tr_b16 a[242:243], v55 offset:256
    ds_read_b64_tr_b16 a[244:245], v55 offset:8192
    ds_read_b64_tr_b16 a[246:247], v55 offset:8448
    s_mov_b32 s77, 24576
    s_call_b64 s[82:83], cs_dma
    ds_read_b64_tr_b16 a[248:249], v56 offset:0
    ds_read_b64_tr_b16 a[250:251], v56 offset:256
    ds_read_b64_tr_b16 a[252:253], v56 offset:8192
    ds_read_b64_tr_b16 a[254:255], v56 offset:8448
    s_mov_b32 s77, 32768
    s_call_b64 s[82:83], cs_dma
    s_waitcnt lgkmcnt(0)
    v_readfirstlane_b32 s41, v46
    v_mov_b32 v36, 1
    v_mov_b32 v37, 0
    s_cmp_eq_u32 s41, 127
    s_cselect_b64 exec, 1, 0
    buffer_atomic_cmpswap v[36:37], off, s[96:99], 0 offset:216
    s_mov_b64 exec, -1
    s_waitcnt vmcnt(8)
    v_add_u32 v55, 0, v51
    v_xor_b32 v56, 32, v55
    ds_read_b64_tr_b16 v[80:81], v55 offset:0
    ds_read_b64_tr_b16 v[82:83], v55 offset:256
    ds_read_b64_tr_b16 v[84:85], v55 offset:8192
    ds_read_b64_tr_b16 v[86:87], v55 offset:8448
    s_xor_b32 s78, s75, 2097152
    s_add_u32 s78, s78, s67
    s_mov_b64 s[8:9], s[52:53]
    s_add_u32 s80, s66, 131072
    s_mov_b32 s76, 0
    s_mov_b32 s77, 8192
    s_call_b64 s[82:83], cs_dma
    ds_read_b64_tr_b16 v[88:89], v56 offset:0
    ds_read_b64_tr_b16 v[90:91], v56 offset:256
    ds_read_b64_tr_b16 v[92:93], v56 offset:8192
    ds_read_b64_tr_b16 v[94:95], v56 offset:8448
    s_mov_b32 s77, 16384
    s_call_b64 s[82:83], cs_dma
    s_waitcnt lgkmcnt(0)
    v_add_u32 v55, 16384, v51
    v_xor_b32 v56, 32, v55
    ds_read_b64_tr_b16 v[96:97], v55 offset:0
    ds_read_b64_tr_b16 v[98:99], v55 offset:256
    ds_read_b64_tr_b16 v[100:101], v55 offset:8192
    ds_read_b64_tr_b16 v[102:103], v55 offset:8448
    s_mov_b32 s77, 24576
    s_call_b64 s[82:83], cs_dma
    ds_read_b64_tr_b16 v[104:105], v56 offset:0
    ds_read_b64_tr_b16 v[106:107], v56 offset:256
    ds_read_b64_tr_b16 v[108:109], v56 offset:8192
    ds_read_b64_tr_b16 v[110:111], v56 offset:8448
    s_mov_b32 s77, 32768
    s_call_b64 s[82:83], cs_dma
    s_waitcnt lgkmcnt(0)
    s_waitcnt vmcnt(8)
    v_add_u32 v55, 32768, v51
    v_xor_b32 v56, 32, v55
    ds_read_b64_tr_b16 v[112:113], v55 offset:0
    ds_read_b64_tr_b16 v[114:115], v55 offset:256
    ds_read_b64_tr_b16 v[116:117], v55 offset:8192
    ds_read_b64_tr_b16 v[118:119], v55 offset:8448
    s_xor_b32 s78, s75, 3145728
    s_add_u32 s78, s78, s67
    s_add_u32 s80, s66, 65536
    s_mov_b32 s76, 0
    s_mov_b32 s77, 8192
    s_call_b64 s[82:83], cs_dma
    ds_read_b64_tr_b16 v[120:121], v56 offset:0
    ds_read_b64_tr_b16 v[122:123], v56 offset:256
    ds_read_b64_tr_b16 v[124:125], v56 offset:8192
    ds_read_b64_tr_b16 v[126:127], v56 offset:8448
    s_mov_b32 s77, 16384
    s_call_b64 s[82:83], cs_dma
    s_waitcnt lgkmcnt(0)
    v_add_u32 v55, 49152, v51
    v_xor_b32 v56, 32, v55
    ds_read_b64_tr_b16 v[128:129], v55 offset:0
    ds_read_b64_tr_b16 v[130:131], v55 offset:256
    ds_read_b64_tr_b16 v[132:133], v55 offset:8192
    ds_read_b64_tr_b16 v[134:135], v55 offset:8448
    s_mov_b32 s77, 24576
    s_call_b64 s[82:83], cs_dma
    ds_read_b64_tr_b16 v[136:137], v56 offset:0
    ds_read_b64_tr_b16 v[138:139], v56 offset:256
    ds_read_b64_tr_b16 v[140:141], v56 offset:8192
    ds_read_b64_tr_b16 v[142:143], v56 offset:8448
    s_mov_b32 s77, 32768
    s_call_b64 s[82:83], cs_dma
    s_waitcnt lgkmcnt(0)
    s_waitcnt vmcnt(8)
    v_add_u32 v55, 131072, v51
    v_xor_b32 v56, 32, v55
    ds_read_b64_tr_b16 a[128:129], v55 offset:0
    ds_read_b64_tr_b16 a[130:131], v55 offset:256
    ds_read_b64_tr_b16 a[132:133], v55 offset:8192
    ds_read_b64_tr_b16 a[134:135], v55 offset:8448
    s_xor_b32 s78, s75, 2097152
    s_add_u32 s78, s78, s67
    s_mov_b64 s[8:9], s[50:51]
    s_add_u32 s80, s66, 0
    s_mov_b32 s76, 0
    s_mov_b32 s77, 8192
    s_call_b64 s[82:83], cs_dma
    ds_read_b64_tr_b16 a[136:137], v56 offset:0
    ds_read_b64_tr_b16 a[138:139], v56 offset:256
    ds_read_b64_tr_b16 a[140:141], v56 offset:8192
    ds_read_b64_tr_b16 a[142:143], v56 offset:8448
    s_mov_b32 s77, 16384
    s_call_b64 s[82:83], cs_dma
    s_waitcnt lgkmcnt(0)
    v_add_u32 v55, 147456, v51
    v_xor_b32 v56, 32, v55
    ds_read_b64_tr_b16 a[144:145], v55 offset:0
    ds_read_b64_tr_b16 a[146:147], v55 offset:256
    ds_read_b64_tr_b16 a[148:149], v55 offset:8192
    ds_read_b64_tr_b16 a[150:151], v55 offset:8448
    s_mov_b32 s77, 24576
    s_call_b64 s[82:83], cs_dma
    ds_read_b64_tr_b16 a[152:153], v56 offset:0
    ds_read_b64_tr_b16 a[154:155], v56 offset:256
    ds_read_b64_tr_b16 a[156:157], v56 offset:8192
    ds_read_b64_tr_b16 a[158:159], v56 offset:8448
    s_mov_b32 s77, 32768
    s_call_b64 s[82:83], cs_dma
    s_waitcnt lgkmcnt(0)
    s_waitcnt vmcnt(8)
    v_add_u32 v55, 65536, v51
    v_xor_b32 v56, 32, v55
    ds_read_b64_tr_b16 a[160:161], v55 offset:0
    ds_read_b64_tr_b16 a[162:163], v55 offset:256
    ds_read_b64_tr_b16 a[164:165], v55 offset:8192
    ds_read_b64_tr_b16 a[166:167], v55 offset:8448
    s_xor_b32 s78, s75, 3145728
    s_add_u32 s78, s78, s67
    s_add_u32 s80, s66, 32768
    s_mov_b32 s76, 0
    s_mov_b32 s77, 8192
    s_call_b64 s[82:83], cs_dma
    ds_read_b64_tr_b16 a[168:169], v56 offset:0
    ds_read_b64_tr_b16 a[170:171], v56 offset:256
    ds_read_b64_tr_b16 a[172:173], v56 offset:8192
    ds_read_b64_tr_b16 a[174:175], v56 offset:8448
    s_mov_b32 s77, 16384
    s_call_b64 s[82:83], cs_dma
    s_waitcnt lgkmcnt(0)
    v_add_u32 v55, 81920, v51
    v_xor_b32 v56, 32, v55
    ds_read_b64_tr_b16 a[176:177], v55 offset:0
    ds_read_b64_tr_b16 a[178:179], v55 offset:256
    ds_read_b64_tr_b16 a[180:181], v55 offset:8192
    ds_read_b64_tr_b16 a[182:183], v55 offset:8448
    s_mov_b32 s77, 24576
    s_call_b64 s[82:83], cs_dma
    ds_read_b64_tr_b16 a[184:185], v56 offset:0
    ds_read_b64_tr_b16 a[186:187], v56 offset:256
    ds_read_b64_tr_b16 a[188:189], v56 offset:8192
    ds_read_b64_tr_b16 a[190:191], v56 offset:8448
    s_mov_b32 s77, 32768
    s_call_b64 s[82:83], cs_dma
    s_waitcnt lgkmcnt(0)
    s_waitcnt vmcnt(8)
    v_add_u32 v55, 0, v51
    v_xor_b32 v56, 32, v55
    ds_read_b64_tr_b16 a[48:49], v55 offset:0
    ds_read_b64_tr_b16 a[50:51], v55 offset:256
    ds_read_b64_tr_b16 a[52:53], v55 offset:8192
    ds_read_b64_tr_b16 a[54:55], v55 offset:8448
    s_add_u32 s78, s67, 4194304
    s_mov_b32 s81, 0
    s_add_u32 s80, s66, 98304
    s_mov_b32 s76, 0
    s_mov_b32 s77, 8192
    s_call_b64 s[82:83], cs_dma
    ds_read_b64_tr_b16 a[56:57], v56 offset:0
    ds_read_b64_tr_b16 a[58:59], v56 offset:256
    ds_read_b64_tr_b16 a[60:61], v56 offset:8192
    ds_read_b64_tr_b16 a[62:63], v56 offset:8448
    s_mov_b32 s77, 16384
    s_call_b64 s[82:83], cs_dma
    s_waitcnt lgkmcnt(0)
    v_add_u32 v55, 16384, v51
    v_xor_b32 v56, 32, v55
    ds_read_b64_tr_b16 a[64:65], v55 offset:0
    ds_read_b64_tr_b16 a[66:67], v55 offset:256
    ds_read_b64_tr_b16 a[68:69], v55 offset:8192
    ds_read_b64_tr_b16 a[70:71], v55 offset:8448
    s_xor_b32 s78, s75, 1048576
    s_add_u32 s78, s78, s67
    s_mov_b32 s81, s93
    s_add_u32 s80, s66, 114688
    s_mov_b32 s76, 0
    s_mov_b32 s77, 8192
    s_call_b64 s[82:83], cs_dma
    ds_read_b64_tr_b16 a[72:73], v56 offset:0
    ds_read_b64_tr_b16 a[74:75], v56 offset:256
    ds_read_b64_tr_b16 a[76:77], v56 offset:8192
    ds_read_b64_tr_b16 a[78:79], v56 offset:8448
    s_mov_b32 s77, 16384
    s_call_b64 s[82:83], cs_dma
    s_waitcnt lgkmcnt(0)
    s_waitcnt vmcnt(8)
    v_add_u32 v55, 32768, v51
    v_xor_b32 v56, 32, v55
    ds_read_b64_tr_b16 a[80:81], v55 offset:0
    ds_read_b64_tr_b16 a[82:83], v55 offset:256
    ds_read_b64_tr_b16 a[84:85], v55 offset:8192
    ds_read_b64_tr_b16 a[86:87], v55 offset:8448
    s_mov_b32 s77, 24576
    s_call_b64 s[82:83], cs_dma
    ds_read_b64_tr_b16 a[88:89], v56 offset:0
    ds_read_b64_tr_b16 a[90:91], v56 offset:256
    ds_read_b64_tr_b16 a[92:93], v56 offset:8192
    ds_read_b64_tr_b16 a[94:95], v56 offset:8448
    s_mov_b32 s77, 32768
    s_call_b64 s[82:83], cs_dma
    s_waitcnt lgkmcnt(0)
    v_add_u32 v55, 49152, v51
    v_xor_b32 v56, 32, v55
    ds_read_b64_tr_b16 a[96:97], v55 offset:0
    ds_read_b64_tr_b16 a[98:99], v55 offset:256
    ds_read_b64_tr_b16 a[100:101], v55 offset:8192
    ds_read_b64_tr_b16 a[102:103], v55 offset:8448
    s_xor_b32 s78, s75, 0
    s_add_u32 s78, s78, s67
    s_add_u32 s80, s66, 65536
    s_mov_b32 s76, 0
    s_mov_b32 s77, 8192
    s_call_b64 s[82:83], cs_dma
    ds_read_b64_tr_b16 a[104:105], v56 offset:0
    ds_read_b64_tr_b16 a[106:107], v56 offset:256
    ds_read_b64_tr_b16 a[108:109], v56 offset:8192
    ds_read_b64_tr_b16 a[110:111], v56 offset:8448
    s_mov_b32 s77, 16384
    s_call_b64 s[82:83], cs_dma
    s_waitcnt lgkmcnt(0)
    s_waitcnt vmcnt(12)
    v_add_u32 v55, 98304, v51
    v_xor_b32 v56, 32, v55
    ds_read_b64_tr_b16 a[112:113], v55 offset:0
    ds_read_b64_tr_b16 a[114:115], v55 offset:256
    ds_read_b64_tr_b16 a[116:117], v55 offset:8192
    ds_read_b64_tr_b16 a[118:119], v55 offset:8448
    s_mov_b32 s77, 24576
    s_call_b64 s[82:83], cs_dma
    ds_read_b64_tr_b16 a[120:121], v56 offset:0
    ds_read_b64_tr_b16 a[122:123], v56 offset:256
    ds_read_b64_tr_b16 a[124:125], v56 offset:8192
    ds_read_b64_tr_b16 a[126:127], v56 offset:8448
    s_mov_b32 s77, 32768
    s_call_b64 s[82:83], cs_dma
    s_waitcnt lgkmcnt(0)
    s_waitcnt vmcnt(8)
    v_add_u32 v55, 114688, v51
    v_xor_b32 v56, 32, v55
    ds_read_b64_tr_b16 a[16:17], v55 offset:0
    ds_read_b64_tr_b16 a[18:19], v55 offset:256
    ds_read_b64_tr_b16 a[20:21], v55 offset:8192
    ds_read_b64_tr_b16 a[22:23], v55 offset:8448
    s_xor_b32 s78, s75, 0
    s_add_u32 s78, s78, s67
    s_mov_b64 s[8:9], s[52:53]
    s_add_u32 s80, s66, 0
    s_mov_b32 s76, 0
    s_mov_b32 s77, 8192
    s_call_b64 s[82:83], cs_dma
    ds_read_b64_tr_b16 a[24:25], v56 offset:0
    ds_read_b64_tr_b16 a[26:27], v56 offset:256
    ds_read_b64_tr_b16 a[28:29], v56 offset:8192
    ds_read_b64_tr_b16 a[30:31], v56 offset:8448
    s_mov_b32 s77, 16384
    s_call_b64 s[82:83], cs_dma
    s_waitcnt lgkmcnt(0)
    v_add_u32 v55, 131072, v51
    v_xor_b32 v56, 32, v55
    ds_read_b64_tr_b16 a[32:33], v55 offset:0
    ds_read_b64_tr_b16 a[34:35], v55 offset:256
    ds_read_b64_tr_b16 a[36:37], v55 offset:8192
    ds_read_b64_tr_b16 a[38:39], v55 offset:8448
    s_mov_b32 s77, 24576
    s_call_b64 s[82:83], cs_dma
    ds_read_b64_tr_b16 a[40:41], v56 offset:0
    ds_read_b64_tr_b16 a[42:43], v56 offset:256
    ds_read_b64_tr_b16 a[44:45], v56 offset:8192
    ds_read_b64_tr_b16 a[46:47], v56 offset:8448
    s_mov_b32 s77, 32768
    s_call_b64 s[82:83], cs_dma
    s_waitcnt lgkmcnt(0)
    s_waitcnt vmcnt(8)
    v_add_u32 v55, 65536, v51
    v_xor_b32 v56, 32, v55
    ds_read_b64_tr_b16 v[0:1], v55 offset:0
    ds_read_b64_tr_b16 v[2:3], v55 offset:256
    ds_read_b64_tr_b16 v[4:5], v55 offset:8192
    ds_read_b64_tr_b16 v[6:7], v55 offset:8448
    s_xor_b32 s78, s75, 1048576
    s_add_u32 s78, s78, s67
    s_add_u32 s80, s66, 32768
    s_mov_b32 s76, 0
    s_mov_b32 s77, 8192
    s_call_b64 s[82:83], cs_dma
    ds_read_b64_tr_b16 v[8:9], v56 offset:0
    ds_read_b64_tr_b16 v[10:11], v56 offset:256
    ds_read_b64_tr_b16 v[12:13], v56 offset:8192
    ds_read_b64_tr_b16 v[14:15], v56 offset:8448
    s_mov_b32 s77, 16384
    s_call_b64 s[82:83], cs_dma
    s_waitcnt lgkmcnt(0)
    ds_write_b128 v62, v[0:3] offset:8192
    ds_write_b128 v62, v[4:7] offset:12288
    ds_write_b128 v62, v[8:11] offset:16384
    ds_write_b128 v62, v[12:15] offset:20480
    s_waitcnt lgkmcnt(0)
    v_add_u32 v55, 81920, v51
    v_xor_b32 v56, 32, v55
    ds_read_b64_tr_b16 a[0:1], v55 offset:0
    ds_read_b64_tr_b16 a[2:3], v55 offset:256
    ds_read_b64_tr_b16 a[4:5], v55 offset:8192
    ds_read_b64_tr_b16 a[6:7], v55 offset:8448
    s_mov_b32 s77, 24576
    s_call_b64 s[82:83], cs_dma
    ds_read_b64_tr_b16 a[8:9], v56 offset:0
    ds_read_b64_tr_b16 a[10:11], v56 offset:256
    ds_read_b64_tr_b16 a[12:13], v56 offset:8192
    ds_read_b64_tr_b16 a[14:15], v56 offset:8448
    s_mov_b32 s77, 32768
    s_call_b64 s[82:83], cs_dma
    s_waitcnt lgkmcnt(0)
    s_waitcnt vmcnt(8)
    v_add_u32 v55, 0, v51
    v_xor_b32 v56, 32, v55
    ds_read_b64_tr_b16 v[0:1], v55 offset:0
    ds_read_b64_tr_b16 v[2:3], v55 offset:256
    ds_read_b64_tr_b16 v[4:5], v55 offset:8192
    ds_read_b64_tr_b16 v[6:7], v55 offset:8448
    s_xor_b32 s94, s13, 0
    s_mul_i32 s94, s94, 36864
    s_add_u32 s94, s94, s92
    s_lshr_b32 s74, s13, 1
    s_lshl_b32 s74, s74, 6
    s_add_u32 s94, s94, s74
    s_add_u32 s78, s94, 1024
    s_mov_b64 s[8:9], s[56:57]
    v_mov_b32 v58, v50
    s_mov_b32 s79, 18432
    s_mov_b32 s81, 0
    s_add_u32 s80, s66, 147456
    s_mov_b32 s76, 0
    s_mov_b32 s77, 8192
    s_call_b64 s[82:83], cs_dma
    ds_read_b64_tr_b16 v[8:9], v56 offset:0
    ds_read_b64_tr_b16 v[10:11], v56 offset:256
    ds_read_b64_tr_b16 v[12:13], v56 offset:8192
    ds_read_b64_tr_b16 v[14:15], v56 offset:8448
    s_xor_b32 s94, s13, 2
    s_mul_i32 s94, s94, 36864
    s_add_u32 s94, s94, s92
    s_lshr_b32 s74, s13, 1
    s_lshl_b32 s74, s74, 6
    s_add_u32 s94, s94, s74
    s_add_u32 s78, s94, 1024
    s_mov_b32 s77, 16384
    s_call_b64 s[82:83], cs_dma
    s_waitcnt lgkmcnt(0)
    ds_write_b128 v61, v[0:3] offset:0
    ds_write_b128 v61, v[4:7] offset:4096
    ds_write_b128 v61, v[8:11] offset:8192
    ds_write_b128 v61, v[12:15] offset:12288
    s_waitcnt lgkmcnt(0)
    v_add_u32 v55, 16384, v51
    v_xor_b32 v56, 32, v55
    ds_read_b64_tr_b16 v[0:1], v55 offset:0
    ds_read_b64_tr_b16 v[2:3], v55 offset:256
    ds_read_b64_tr_b16 v[4:5], v55 offset:8192
    ds_read_b64_tr_b16 v[6:7], v55 offset:8448
    s_xor_b32 s94, s13, 3
    s_mul_i32 s94, s94, 36864
    s_add_u32 s94, s94, s92
    s_lshl_b32 s74, s13, 7
    s_add_u32 s94, s94, s74
    s_add_u32 s78, s94, 512
    v_mov_b32 v58, v49
    s_mov_b32 s79, 9216
    s_add_u32 s80, s66, 131072
    s_mov_b32 s76, 0
    s_mov_b32 s77, 8192
    s_call_b64 s[82:83], cs_dma
    ds_read_b64_tr_b16 v[8:9], v56 offset:0
    ds_read_b64_tr_b16 v[10:11], v56 offset:256
    ds_read_b64_tr_b16 v[12:13], v56 offset:8192
    ds_read_b64_tr_b16 v[14:15], v56 offset:8448
    s_mov_b32 s77, 16384
    s_call_b64 s[82:83], cs_dma
    s_waitcnt lgkmcnt(0)
    ds_write_b128 v61, v[0:3] offset:16384
    ds_write_b128 v61, v[4:7] offset:20480
    ds_write_b128 v61, v[8:11] offset:24576
    ds_write_b128 v61, v[12:15] offset:28672
    s_waitcnt lgkmcnt(0)
    s_waitcnt vmcnt(8)
    v_add_u32 v55, 32768, v51
    v_xor_b32 v56, 32, v55
    ds_read_b64_tr_b16 v[0:1], v55 offset:0
    ds_read_b64_tr_b16 v[2:3], v55 offset:256
    ds_read_b64_tr_b16 v[4:5], v55 offset:8192
    ds_read_b64_tr_b16 v[6:7], v55 offset:8448
    s_xor_b32 s94, s13, 2
    s_mul_i32 s94, s94, 36864
    s_add_u32 s94, s94, s92
    s_lshl_b32 s74, s13, 7
    s_add_u32 s94, s94, s74
    s_add_u32 s78, s94, 512
    s_add_u32 s80, s66, 114688
    s_mov_b32 s76, 0
    s_mov_b32 s77, 8192
    s_call_b64 s[82:83], cs_dma
    ds_read_b64_tr_b16 v[8:9], v56 offset:0
    ds_read_b64_tr_b16 v[10:11], v56 offset:256
    ds_read_b64_tr_b16 v[12:13], v56 offset:8192
    ds_read_b64_tr_b16 v[14:15], v56 offset:8448
    s_mov_b32 s77, 16384
    s_call_b64 s[82:83], cs_dma
    s_waitcnt lgkmcnt(0)
    ds_write_b128 v61, v[0:3] offset:32768
    ds_write_b128 v61, v[4:7] offset:36864
    ds_write_b128 v61, v[8:11] offset:40960
    ds_write_b128 v61, v[12:15] offset:45056
    s_waitcnt lgkmcnt(0)
    v_add_u32 v55, 49152, v51
    v_xor_b32 v56, 32, v55
    ds_read_b64_tr_b16 v[0:1], v55 offset:0
    ds_read_b64_tr_b16 v[2:3], v55 offset:256
    ds_read_b64_tr_b16 v[4:5], v55 offset:8192
    ds_read_b64_tr_b16 v[6:7], v55 offset:8448
    s_add_u32 s78, s67, 4194304
    s_mov_b64 s[8:9], s[52:53]
    v_mov_b32 v58, v48
    s_mov_b32 s79, 131072
    s_add_u32 s80, s66, 81920
    s_mov_b32 s76, 0
    s_mov_b32 s77, 8192
    s_call_b64 s[82:83], cs_dma
    ds_read_b64_tr_b16 v[8:9], v56 offset:0
    ds_read_b64_tr_b16 v[10:11], v56 offset:256
    ds_read_b64_tr_b16 v[12:13], v56 offset:8192
    ds_read_b64_tr_b16 v[14:15], v56 offset:8448
    s_mov_b32 s77, 16384
    s_call_b64 s[82:83], cs_dma
    s_waitcnt lgkmcnt(0)
    ds_write_b128 v61, v[0:3] offset:49152
    ds_write_b128 v61, v[4:7] offset:53248
    ds_write_b128 v61, v[8:11] offset:57344
    ds_write_b128 v61, v[12:15] offset:61440
    s_waitcnt lgkmcnt(0)
    buffer_load_dword v38, off, s[96:99], 0 offset:216 sc1
    buffer_load_dword v39, off, s[96:99], 0 offset:64 sc1
    s_lshr_b32 s84, s12, 1
    s_lshl_b32 s84, s84, 8
    s_add_u32 s84, s84, 125829120
    v_bfe_u32 v40, v61, 4, 6
    v_min_u32 v40, 11, v40
    v_lshlrev_b32 v40, 2, v40
    buffer_load_dword v41, v40, s[4:7], s84 offen sc1
    s_waitcnt vmcnt(15)
    v_add_u32 v55, 147456, v53
    ds_read_b64_tr_b16 v[0:1], v55 offset:0
    ds_read_b64_tr_b16 v[2:3], v55 offset:128
    ds_read_b64_tr_b16 v[4:5], v55 offset:512
    ds_read_b64_tr_b16 v[6:7], v55 offset:640
    ds_read_b64_tr_b16 v[8:9], v55 offset:8192
    ds_read_b64_tr_b16 v[10:11], v55 offset:8320
    ds_read_b64_tr_b16 v[12:13], v55 offset:8704
    ds_read_b64_tr_b16 v[14:15], v55 offset:8832
    s_waitcnt lgkmcnt(0)
    s_barrier
    ds_write_b128 v63, v[0:3] offset:49152
    ds_write_b128 v63, v[4:7] offset:53248
    s_barrier
    ds_write_b128 v63, v[8:11] offset:57344
    ds_write_b128 v63, v[12:15] offset:61440
    s_waitcnt lgkmcnt(0)
    s_waitcnt vmcnt(11)
    v_add_u32 v55, 131072, v52
    ds_read_b64_tr_b16 v[0:1], v55 offset:0
    ds_read_b64_tr_b16 v[2:3], v55 offset:256
    ds_read_b64_tr_b16 v[4:5], v55 offset:4096
    ds_read_b64_tr_b16 v[6:7], v55 offset:4352
    ds_read_b64_tr_b16 v[8:9], v55 offset:64
    ds_read_b64_tr_b16 v[10:11], v55 offset:320
    ds_read_b64_tr_b16 v[12:13], v55 offset:4160
    ds_read_b64_tr_b16 v[14:15], v55 offset:4416
    s_waitcnt lgkmcnt(0)
    s_barrier
    ds_write_b128 v63, v[0:3] offset:32768
    ds_write_b128 v63, v[4:7] offset:36864
    s_barrier
    ds_write_b128 v63, v[8:11] offset:40960
    ds_write_b128 v63, v[12:15] offset:45056
    s_waitcnt lgkmcnt(0)
    s_waitcnt vmcnt(7)
    v_add_u32 v55, 114688, v52
    ds_read_b64_tr_b16 v[0:1], v55 offset:0
    ds_read_b64_tr_b16 v[2:3], v55 offset:256
    ds_read_b64_tr_b16 v[4:5], v55 offset:4096
    ds_read_b64_tr_b16 v[6:7], v55 offset:4352
    ds_read_b64_tr_b16 v[8:9], v55 offset:64
    ds_read_b64_tr_b16 v[10:11], v55 offset:320
    ds_read_b64_tr_b16 v[12:13], v55 offset:4160
    ds_read_b64_tr_b16 v[14:15], v55 offset:4416
    s_waitcnt lgkmcnt(0)
    s_barrier
    ds_write_b128 v63, v[0:3] offset:16384
    ds_write_b128 v63, v[4:7] offset:20480
    s_barrier
    ds_write_b128 v63, v[8:11] offset:24576
    ds_write_b128 v63, v[12:15] offset:28672
    s_waitcnt lgkmcnt(0)
    buffer_load_dword v30, v79, s[4:7], s14 offen sc1
    s_lshl_b32 s40, s12, 14
    s_add_u32 s40, s40, 68222976
    buffer_load_dword v30, v79, s[4:7], s40 offen sc1
    s_and_b32 s40, s12, 3
    s_lshl_b32 s40, s40, 14
    s_add_u32 s40, s40, 68157440
    buffer_load_dword v30, v79, s[4:7], s40 offen sc1
    s_waitcnt vmcnt(1)
    v_readfirstlane_b32 s95, v39
    v_readfirstlane_b32 s85, v38
    s_add_u32 s86, s95, 2
    s_waitcnt vmcnt(0)
    v_subrev_u32 v41, s86, v41
    v_cmp_lt_u32 s[86:87], 64, v41
    s_cmp_eq_u32 s95, 0
    s_cselect_b64 s[86:87], -1, s[86:87]
    s_cmp_lg_u64 s[86:87], 0
    s_cbranch_scc1 cs_nt
    s_add_u32 s40, s24, 524288
    buffer_load_dword v30, v79, s[4:7], s24 offen sc1
    buffer_load_dword v30, v79, s[4:7], s40 offen sc1
cs_nt:
    s_waitcnt vmcnt(3)
    v_add_u32 v55, 81920, v51
    v_xor_b32 v56, 32, v55
    ds_read_b64_tr_b16 v[0:1], v55 offset:0
    ds_read_b64_tr_b16 v[2:3], v55 offset:256
    ds_read_b64_tr_b16 v[4:5], v55 offset:8192
    ds_read_b64_tr_b16 v[6:7], v55 offset:8448
    ds_read_b64_tr_b16 v[8:9], v56 offset:0
    ds_read_b64_tr_b16 v[10:11], v56 offset:256
    ds_read_b64_tr_b16 v[12:13], v56 offset:8192
    ds_read_b64_tr_b16 v[14:15], v56 offset:8448
    s_waitcnt lgkmcnt(0)
    ds_write_b128 v62, v[0:3] offset:24576
    ds_write_b128 v62, v[4:7] offset:28672
    ds_write_b128 v62, v[8:11] offset:32768
    ds_write_b128 v62, v[12:15] offset:36864
    s_waitcnt lgkmcnt(0)
    s_barrier
    s_mov_b32 s88, 4194304
gn3:
    s_cmp_lg_u32 s95, 0
    s_cbranch_scc1 gn3x
    buffer_load_dword v24, off, s[96:99], 0 offset:64 sc1
    s_sub_u32 s88, s88, 1
    s_cbranch_scc1 gn3x
    s_waitcnt vmcnt(0)
    v_readfirstlane_b32 s95, v24
    s_nop 1
    s_branch gn3
gn3x:
    ds_write_b128 v78, v[16:19] offset:8704
    ds_write_b128 v65, v[20:23] offset:10240
    v_mov_b32 v44, s95
    v_mov_b32 v45, s95
    v_mov_b32 v46, s95
    v_mov_b32 v47, s95
    v_mov_b32 v48, 108288
    ds_write_b128 v48, v[44:47]
    s_waitcnt vmcnt(0) lgkmcnt(0)
    s_cmp_eq_u32 s85, 1
    s_cbranch_scc1 cs_run
    s_mov_b32 s40, 16777216
cs_startpoll:
    buffer_load_dword v3, off, s[96:99], 0 offset:216 sc1
    s_waitcnt vmcnt(0)
    v_readfirstlane_b32 s85, v3
    s_nop 0
    s_cmp_eq_u32 s85, 1
    s_cbranch_scc1 cs_run
    s_sleep 1
    s_sub_u32 s40, s40, 1
    s_cbranch_scc0 cs_startpoll
    s_endpgm
cs_run:
    s_cmp_eq_u64 s[86:87], 0
    s_cbranch_scc1 cs_kvok
    s_lshr_b32 s92, s12, 1
    s_lshl_b32 s92, s92, 8
    s_add_u32 s92, s92, 125829120
    v_bfe_u32 v2, v61, 4, 6
    v_min_u32 v2, 11, v2
    v_lshlrev_b32 v2, 2, v2
    s_add_u32 s93, s95, 2
    s_mov_b32 s94, 4194304
cs_kv0:
    buffer_load_dword v3, v2, s[4:7], s92 offen sc1
    s_sub_u32 s94, s94, 1
    s_cbranch_scc1 cs_kv0_go
    s_waitcnt vmcnt(0)
    v_subrev_u32 v3, s93, v3
    v_cmp_lt_u32 vcc, 64, v3
    s_cbranch_vccz cs_kv0_go
    s_sleep 2
    s_branch cs_kv0
cs_kv0_go:
    s_add_u32 s40, s24, 524288
    buffer_load_dword v30, v79, s[4:7], s24 offen sc1
    buffer_load_dword v30, v79, s[4:7], s40 offen sc1
    s_waitcnt vmcnt(0)
cs_kvok:
    s_mov_b32 m0, 108032
    s_add_u32 s24, s24, 1048576
    s_add_u32 s15, s14, 4096
    s_add_u32 s16, s14, 8192
    ds_read_b128 v[32:35], v62 offset:16384
    ds_read_b128 v[36:39], v62 offset:20480
    ds_read_b128 v[40:43], v61 offset:0
    ds_read_b128 v[44:47], v61 offset:4096
    ds_read_b128 v[48:51], v61 offset:8192
    ds_read_b128 v[52:55], v61 offset:12288
    s_mov_b32 s29, 1048576
    buffer_load_dwordx4 v[24:27], v61, s[4:7], s14 offen sc1
.p2align 6
cs_loop:
    v_mov_b64 v[0:1], 0
    v_mov_b64 v[2:3], 0
    v_mov_b64 v[4:5], 0
    v_mov_b64 v[6:7], 0
    v_mov_b64 v[8:9], 0
    v_mov_b64 v[10:11], 0
    v_mov_b64 v[12:13], 0
    v_mov_b64 v[14:15], 0
cs_loop2:
    ds_read_b128 v[16:19], v62 offset:8192
    ds_read_b128 v[20:23], v62 offset:12288
    v_lshrrev_b32 v56, 2, v61
    v_add_u32 v58, 106496, v56
    s_mov_b32 s29, 1048576
    s_waitcnt lgkmcnt(0)
cs_chk0:
    s_waitcnt vmcnt(0)
    v_max3_u32 v57, v24, v25, v26
    v_max_u32 v57, v57, v27
    v_cmp_eq_u32 vcc, -1, v57
    ds_write_b128 v62, v[24:27] offset:40960
    s_cbranch_vccnz cs_spin0
    v_smfmac_f32_16x16x64_bf16 v[0:3], v[24:27], v[16:23], v60
    buffer_load_dwordx4 v[28:31], v61, s[4:7], s15 offen sc1
    buffer_load_dword v59, v56, s[4:7], s16 offen sc1
    v_smfmac_f32_16x16x64_bf16 v[8:11], v[24:27], v[32:39], v60
    ds_read_b128 v[32:35], v61 offset:16384
    v_smfmac_f32_16x16x64_bf16 v[12:15], v[24:27], v[48:55], v60
    ds_read_b128 v[36:39], v61 offset:20480
    v_mfma_f32_16x16x16_bf16 v[16:19], v[72:73], v[72:73], 0
    s_waitcnt lgkmcnt(2)
    s_barrier
    ds_read_b128 v[48:51], v63 offset:0
    v_mfma_f32_16x16x16_bf16 v[20:23], v[72:73], v[72:73], 0
    ds_read_b128 v[52:55], v64 offset:0
    v_smfmac_f32_16x16x64_bf16 v[4:7], v[24:27], v[40:47], v60
    ds_read_b128 v[40:43], v61 offset:24576
    v_smfmac_f32_16x16x64_bf16 v[16:19], v[24:27], a[192:199], v60
    ds_read_b128 v[44:47], v61 offset:28672
    v_smfmac_f32_16x16x64_bf16 v[20:23], v[24:27], a[200:207], v60
    s_waitcnt lgkmcnt(3)
    v_smfmac_f32_16x16x64_bf16 v[0:3], v[48:51], a[0:7], v60
    s_add_u32 s18, s14, s31
    s_add_u32 s41, s14, 16384
    v_smfmac_f32_16x16x64_bf16 v[4:7], v[48:51], v[32:39], v60
    ds_read_b128 v[32:35], v61 offset:32768
    v_smfmac_f32_16x16x64_bf16 v[8:11], v[48:51], a[8:15], v60
    ds_read_b128 v[36:39], v61 offset:36864
    s_waitcnt lgkmcnt(2)
    v_smfmac_f32_16x16x64_bf16 v[12:15], v[48:51], v[40:47], v60
    ds_read_b128 v[40:43], v61 offset:40960
    v_smfmac_f32_16x16x64_bf16 v[0:3], v[52:55], a[16:23], v60
    ds_read_b128 v[44:47], v61 offset:45056
    v_smfmac_f32_16x16x64_bf16 v[8:11], v[52:55], a[24:31], v60
    ds_read_b128 v[48:51], v71 offset:0
    s_waitcnt lgkmcnt(3)
    v_smfmac_f32_16x16x64_bf16 v[4:7], v[52:55], v[32:39], v60
    s_waitcnt vmcnt(0)
    ds_write_b128 v62, v[28:31] offset:45056
    s_waitcnt lgkmcnt(2)
    v_smfmac_f32_16x16x64_bf16 v[12:15], v[52:55], v[40:47], v60
    ds_write_b32 v58, v59
    v_max3_u32 v57, v28, v29, v30
    s_waitcnt lgkmcnt(2)
    v_smfmac_f32_16x16x64_bf16 v[0:3], v[48:51], a[32:39], v60
    ds_read_b128 v[32:35], v61 offset:49152
    v_max3_u32 v57, v57, v31, v59
    v_smfmac_f32_16x16x64_bf16 v[8:11], v[48:51], a[40:47], v60
    ds_read_b128 v[36:39], v61 offset:53248
    v_cmp_eq_u32 vcc, -1, v57
    v_smfmac_f32_16x16x64_bf16 v[16:19], v[52:55], a[224:231], v60
    ds_read_b128 v[40:43], v61 offset:57344
    v_smfmac_f32_16x16x64_bf16 v[20:23], v[52:55], a[232:239], v60
    ds_read_b128 v[44:47], v61 offset:61440
    s_cbranch_vccnz cs_spin1
cs_go1:
    v_smfmac_f32_16x16x64_bf16 v[0:3], v[28:31], a[48:55], v60
    s_waitcnt lgkmcnt(4)
    s_barrier
    ds_read_b128 v[52:55], v63 offset:4096
    v_smfmac_f32_16x16x64_bf16 v[8:11], v[28:31], a[56:63], v60
    ds_read_b128 v[56:59], v71 offset:4096
    v_smfmac_f32_16x16x64_bf16 v[4:7], v[28:31], a[128:135], v60
    s_waitcnt lgkmcnt(2)
    v_smfmac_f32_16x16x64_bf16 v[4:7], v[48:51], v[32:39], v60
    buffer_load_dwordx4 v[32:35], v61, s[4:7], s23 offen offset:0 sc1
    v_smfmac_f32_16x16x64_bf16 v[12:15], v[48:51], v[40:47], v60
    ds_read_b128 v[48:51], v64 offset:4096
    v_smfmac_f32_16x16x64_bf16 v[12:15], v[28:31], a[136:143], v60
    ds_read_b128 v[24:27], v65 offset:8192
    s_and_b32 s41, s41, 65535
    s_add_u32 s41, s41, 68157440
    v_smfmac_f32_16x16x64_bf16 v[16:19], v[28:31], v[80:87], v60
    buffer_load_dwordx4 v[36:39], v61, s[4:7], s23 offen offset:1024 sc1
    v_smfmac_f32_16x16x64_bf16 v[20:23], v[28:31], v[88:95], v60
    s_add_u32 s17, s41, s31
    s_and_b32 s30, s28, 1
    s_waitcnt lgkmcnt(3)
    v_smfmac_f32_16x16x64_bf16 v[0:3], v[52:55], a[64:71], v60
    ds_read_b128 v[28:31], v78 offset:8704
    v_smfmac_f32_16x16x64_bf16 v[4:7], v[52:55], a[144:151], v60
    buffer_load_dwordx4 v[40:43], v61, s[4:7], s23 offen offset:2048 sc1
    v_smfmac_f32_16x16x64_bf16 v[8:11], v[52:55], a[72:79], v60
    v_smfmac_f32_16x16x64_bf16 v[12:15], v[52:55], a[152:159], v60
    v_smfmac_f32_16x16x64_bf16 v[16:19], v[52:55], v[96:103], v60
    buffer_load_dwordx4 v[44:47], v61, s[4:7], s23 offen offset:3072 sc1
    v_smfmac_f32_16x16x64_bf16 v[20:23], v[52:55], v[104:111], v60
    ds_read_b128 v[52:55], v62 offset:28672
    s_waitcnt lgkmcnt(3)
    v_smfmac_f32_16x16x64_bf16 v[0:3], v[48:51], a[80:87], v60
    v_smfmac_f32_16x16x64_bf16 v[4:7], v[48:51], a[160:167], v60
    v_smfmac_f32_16x16x64_bf16 v[8:11], v[48:51], a[88:95], v60
    v_smfmac_f32_16x16x64_bf16 v[12:15], v[48:51], a[168:175], v60
    v_smfmac_f32_16x16x64_bf16 v[16:19], v[48:51], v[112:119], v60
    buffer_load_dword v79, s[4:7], s24 offen sc1 lds
    v_smfmac_f32_16x16x64_bf16 v[20:23], v[48:51], v[120:127], v60
    ds_read_b128 v[48:51], v62 offset:24576
    v_smfmac_f32_16x16x64_bf16 v[0:3], v[56:59], a[96:103], v60
    s_cmp_ge_u32 s28, 62
    v_smfmac_f32_16x16x64_bf16 v[8:11], v[56:59], a[104:111], v60
    s_waitcnt lgkmcnt(3)
    v_smfmac_f32_16x16x64_bf16 v[0:3], v[24:27], a[112:119], v60
    v_smfmac_f32_16x16x64_bf16 v[8:11], v[24:27], a[120:127], v60
    v_smfmac_f32_16x16x64_bf16 v[4:7], v[56:59], a[176:183], v60
    s_waitcnt lgkmcnt(0)
    v_cvt_pk_bf16_f32 v0, v0, v1
    v_smfmac_f32_16x16x64_bf16 v[4:7], v[24:27], v[48:55], v60
    ds_read_b128 v[48:51], v62 offset:32768
    v_cvt_pk_bf16_f32 v8, v8, v9
    v_smfmac_f32_16x16x64_bf16 v[12:15], v[56:59], a[184:191], v60
    ds_read_b128 v[52:55], v62 offset:36864
    v_cvt_pk_bf16_f32 v9, v10, v11
    v_smfmac_f32_16x16x64_bf16 v[16:19], v[56:59], v[128:135], v60
    v_cvt_pk_bf16_f32 v1, v2, v3
    v_mfma_f32_16x16x16_bf16 v[8:11], v[8:9], v[28:29], 0
    v_cvt_pk_bf16_f32 v2, v4, v5
    v_cvt_pk_bf16_f32 v3, v6, v7
    v_smfmac_f32_16x16x64_bf16 v[20:23], v[56:59], v[136:143], v60
    s_mov_b64 exec, s[36:37]
    ds_read_b128 v[56:59], v69
    s_mov_b64 exec, -1
    v_mfma_f32_16x16x32_bf16 v[4:7], v[0:3], v[28:31], 0
    v_cvt_pk_bf16_f32 v2, v8, v9
    s_waitcnt lgkmcnt(1)
    v_smfmac_f32_16x16x64_bf16 v[12:15], v[24:27], v[48:55], v60
    ds_read_b128 v[48:51], v63 offset:0
    v_cvt_pk_bf16_f32 v3, v10, v11
    s_waitcnt vmcnt(3)
    v_cvt_pk_bf16_f32 v0, v4, v5
    v_cvt_pk_bf16_f32 v1, v6, v7
    s_nop 1
    v_mfma_f32_16x16x32_bf16 v[4:7], v[36:39], v[0:3], 0
    v_cvt_pk_bf16_f32 v12, v12, v13
    v_cvt_pk_bf16_f32 v13, v14, v15
    s_nop 1
    v_mfma_f32_16x16x16_bf16 v[12:15], v[12:13], v[30:31], 0
    ds_read_b128 v[52:55], v71 offset:0
    ds_read_b128 v[36:39], v63 offset:53248
    v_mfma_f32_16x16x32_bf16 v[28:31], v[32:35], v[0:3], 0
    s_waitcnt vmcnt(1)
    ds_read_b128 v[32:35], v63 offset:49152
    s_mov_b64 exec, s[34:35]
    s_nop 0
    v_cvt_pk_bf16_f32 v2, v12, v13
    v_cvt_pk_bf16_f32 v3, v14, v15
    s_mov_b64 exec, -1
    s_nop 0
    v_mfma_f32_16x16x32_bf16 v[8:11], v[0:3], v[0:3], 0
    v_mov_b32_dpp v28, v4 row_ror:8 row_mask:0xf bank_mask:0xc
    v_mov_b32_dpp v29, v5 row_ror:8 row_mask:0xf bank_mask:0xc
    v_mov_b32_dpp v30, v6 row_ror:8 row_mask:0xf bank_mask:0xc
    v_mov_b32_dpp v31, v7 row_ror:8 row_mask:0xf bank_mask:0xc
    v_smfmac_f32_16x16x64_bf16 v[16:19], v[24:27], v[144:151], v60
    ds_write_b128 v62, v[28:31] offset:53248
    v_mov_b32_dpp v8, v10 row_ror:8 row_mask:0xf bank_mask:0xc
    v_mov_b32_dpp v9, v11 row_ror:8 row_mask:0xf bank_mask:0xc
    v_smfmac_f32_16x16x64_bf16 v[20:23], v[24:27], v[152:159], v60
    ds_write_b64 v70, v[8:9]
    s_waitcnt lgkmcnt(5)
    v_smfmac_f32_16x16x64_bf16 v[16:19], v[48:51], a[208:215], v60
    s_mov_b64 exec, s[36:37]
    s_cbranch_execz cs_np3552
    buffer_store_dwordx4 v[56:59], v61, s[4:7], s65 offen sc1
cs_np3552:
    s_mov_b64 exec, -1
    v_smfmac_f32_16x16x64_bf16 v[20:23], v[48:51], a[216:223], v60
    s_cbranch_scc1 cs_last
cs_back:
    s_waitcnt lgkmcnt(0)
    s_barrier
    ds_read_b128 v[56:59], v78 offset:10752
    v_smfmac_f32_16x16x64_bf16 v[16:19], v[52:55], a[240:247], v60
    ds_read_b128 v[12:15], v78 offset:11264
    ds_read_b128 v[4:7], v63 offset:12288
    v_smfmac_f32_16x16x64_bf16 v[20:23], v[52:55], a[248:255], v60
    ds_read_b128 v[8:11], v64 offset:12288
    ds_read_b128 v[0:3], v71 offset:12288
    v_mov_b64 v[24:25], s[62:63]
    v_mov_b64 v[26:27], s[60:61]
    v_cvt_pk_bf16_f32 v16, v16, v17
    v_cvt_pk_bf16_f32 v17, v18, v19
    v_pk_mul_f32 v[28:29], v[28:29], s[44:45]
    v_pk_mul_f32 v[30:31], v[30:31], s[44:45]
    s_waitcnt lgkmcnt(3)
    v_pk_add_f32 v[56:57], v[56:57], v[58:59]
    v_pk_add_f32 v[12:13], v[12:13], v[14:15]
    v_pk_add_f32 v[56:57], v[56:57], v[12:13]
    v_pk_mul_f32 v[56:57], v[56:57], s[44:45]
    v_exp_f32 v58, v56
    v_exp_f32 v59, v57
    s_waitcnt lgkmcnt(1)
    v_pk_fma_f32 v[28:29], v[4:5], s[44:45], v[28:29]
    v_pk_fma_f32 v[30:31], v[6:7], s[44:45], v[30:31]
    v_cvt_pk_bf16_f32 v6, v58, v59
    v_pk_fma_f32 v[28:29], v[8:9], s[44:45], v[28:29]
    v_pk_fma_f32 v[30:31], v[10:11], s[44:45], v[30:31]
    s_waitcnt lgkmcnt(0)
    v_pk_fma_f32 v[28:29], v[0:1], s[44:45], v[28:29]
    v_mov_b32_dpp v7, v6 row_ror:8 row_mask:0xf bank_mask:0xf
    v_pk_fma_f32 v[30:31], v[2:3], s[44:45], v[30:31]
    v_exp_f32 v0, v28
    v_mfma_f32_16x16x16_bf16 v[12:15], v[16:17], v[6:7], 0
    ds_read_b128 v[48:51], v63 offset:57344
    v_exp_f32 v1, v29
    v_cvt_pk_bf16_f32 v18, v20, v21
    v_exp_f32 v2, v30
    v_cvt_pk_bf16_f32 v19, v22, v23
    v_cvt_pk_bf16_f32 v8, v0, v1
    v_exp_f32 v3, v31
    v_mfma_f32_16x16x16_bf16 v[20:23], v[18:19], v[6:7], 0
    ds_read_b128 v[52:55], v63 offset:61440
    v_cvt_pk_bf16_f32 v9, v2, v3
    v_mov_b32_dpp v10, v8 row_ror:8 row_mask:0xf bank_mask:0xf
    v_max3_f32 v4, |v28|, |v29|, |v30|
    v_mov_b32_dpp v11, v9 row_ror:8 row_mask:0xf bank_mask:0xf
    v_mfma_f32_16x16x32_bf16 v[0:3], v[24:27], v[6:9], 0
    v_max3_f32 v4, v4, |v31|, |v56|
    v_max_f32_e64 v4, v4, |v57|
    v_mfma_f32_16x16x32_bf16 v[12:15], v[40:43], v[8:11], v[12:15]
    v_cmp_nge_f32 vcc, s46, v4
    v_mfma_f32_16x16x32_bf16 v[20:23], v[44:47], v[8:11], v[20:23]
    v_add_f32_dpp v0, v0, v0 row_ror:8 row_mask:0xf bank_mask:0xf
    v_rcp_f32 v0, v0
    s_cbranch_vccnz cs_guard
cs_norm:
    v_mfma_f32_16x16x16_bf16 v[28:31], v[72:73], v[72:73], 0
    v_mul_f32 v12, v12, v0
    v_mul_f32 v13, v13, v0
    v_mul_f32 v14, v14, v0
    v_mul_f32 v15, v15, v0
    v_mul_f32_dpp v12, v20, v0 row_ror:8 row_mask:0xf bank_mask:0xc
    v_mul_f32_dpp v13, v21, v0 row_ror:8 row_mask:0xf bank_mask:0xc
    v_mul_f32_dpp v14, v22, v0 row_ror:8 row_mask:0xf bank_mask:0xc
    v_mul_f32_dpp v15, v23, v0 row_ror:8 row_mask:0xf bank_mask:0xc
    v_cvt_pk_bf16_f32 v12, v12, v13
    v_cvt_pk_bf16_f32 v13, v14, v15
    v_mfma_f32_16x16x16_bf16 v[8:11], v[72:73], v[72:73], 0
    ds_write_b64 v77, v[12:13]
    v_mfma_f32_16x16x16_bf16 v[4:7], v[72:73], v[72:73], 0
    ds_read_b128 v[0:3], v68
    v_mfma_f32_16x16x16_bf16 v[16:19], v[72:73], v[72:73], 0
    ds_read_b128 v[40:43], v63 offset:16384
    v_mfma_f32_16x16x16_bf16 v[20:23], v[72:73], v[72:73], 0
    ds_read_b128 v[44:47], v63 offset:20480
    s_waitcnt lgkmcnt(3)
    s_barrier
    ds_read_b128 v[24:27], v74
    ds_read_b128 v[12:15], v75
    ds_read_b128 v[56:59], v76
    s_waitcnt lgkmcnt(5)
    v_smfmac_f32_16x16x64_bf16 v[28:31], v[0:3], v[160:167], v60
    v_smfmac_f32_16x16x64_bf16 v[8:11], v[0:3], v[192:199], v60
    v_smfmac_f32_16x16x64_bf16 v[4:7], v[0:3], v[32:39], v60
    ds_read_b128 v[32:35], v63 offset:32768
    v_smfmac_f32_16x16x64_bf16 v[16:19], v[0:3], v[224:231], v60
    ds_read_b128 v[36:39], v63 offset:36864
    s_waitcnt lgkmcnt(3)
    v_smfmac_f32_16x16x64_bf16 v[28:31], v[24:27], v[168:175], v60
    v_smfmac_f32_16x16x64_bf16 v[4:7], v[12:15], v[48:55], v60
    ds_read_b128 v[48:51], v63 offset:24576
    v_smfmac_f32_16x16x64_bf16 v[28:31], v[12:15], v[176:183], v60
    ds_read_b128 v[52:55], v63 offset:28672
    s_waitcnt lgkmcnt(4)
    v_smfmac_f32_16x16x64_bf16 v[28:31], v[56:59], v[184:191], v60
    v_cvt_pk_bf16_f32 v4, v4, v5
    v_smfmac_f32_16x16x64_bf16 v[16:19], v[12:15], v[40:47], v60
    ds_read_b128 v[40:43], v63 offset:40960
    v_and_or_b32 v4, v4, -2, s30
    v_smfmac_f32_16x16x64_bf16 v[8:11], v[24:27], v[200:207], v60
    ds_read_b128 v[44:47], v63 offset:45056
    v_cvt_pk_bf16_f32 v5, v6, v7
    v_smfmac_f32_16x16x64_bf16 v[8:11], v[12:15], v[208:215], v60
    buffer_store_dwordx2 v[4:5], v67, s[4:7], s22 offen sc1
    v_cvt_pk_bf16_f32 v28, v28, v29
    v_smfmac_f32_16x16x64_bf16 v[8:11], v[56:59], v[216:223], v60
    v_and_or_b32 v28, v28, -2, s30
    v_smfmac_f32_16x16x64_bf16 v[16:19], v[24:27], v[232:239], v60
    v_cvt_pk_bf16_f32 v29, v30, v31
    s_waitcnt lgkmcnt(4)
    v_smfmac_f32_16x16x64_bf16 v[16:19], v[56:59], v[32:39], v60
    buffer_store_dwordx2 v[28:29], v66, s[4:7], s20 offen sc1
    v_cvt_pk_bf16_f32 v8, v8, v9
    s_waitcnt lgkmcnt(0)
    v_smfmac_f32_16x16x64_bf16 v[20:23], v[0:3], v[240:247], v60
    v_and_or_b32 v8, v8, -2, s30
    v_smfmac_f32_16x16x64_bf16 v[20:23], v[24:27], v[248:255], v60
    v_cvt_pk_bf16_f32 v9, v10, v11
    v_smfmac_f32_16x16x64_bf16 v[20:23], v[12:15], v[48:55], v60
    buffer_store_dwordx2 v[8:9], v66, s[4:7], s21 offen sc1
    v_cvt_pk_bf16_f32 v16, v16, v17
    v_smfmac_f32_16x16x64_bf16 v[20:23], v[56:59], v[40:47], v60
    v_and_or_b32 v16, v16, -2, s30
    v_cvt_pk_bf16_f32 v17, v18, v19
    buffer_store_dwordx2 v[16:17], v66, s[4:7], s38 offen sc1
    s_cmp_lg_u32 s13, 2
    s_nop 1
    v_cvt_pk_bf16_f32 v20, v20, v21
    v_and_or_b32 v20, v20, -2, s30
    v_cvt_pk_bf16_f32 v21, v22, v23
    buffer_store_dwordx2 v[20:21], v66, s[4:7], s39 offen sc1
    s_cbranch_scc1 cs_w013
    s_nop 15
    s_nop 15
    s_nop 15
    s_nop 15
    s_nop 15
    s_nop 15
    s_nop 15
    s_nop 15
    s_nop 15
    s_nop 15
    s_nop 15
    s_nop 15
    s_nop 7
    buffer_load_dwordx4 v[40:43], v65, s[4:7], s19 offen offset:0 sc1
    buffer_load_dwordx4 v[44:47], v65, s[4:7], s19 offen offset:1024 sc1
    buffer_load_dwordx4 v[48:51], v65, s[4:7], s19 offen offset:2048 sc1
    buffer_load_dwordx4 v[52:55], v65, s[4:7], s19 offen offset:3072 sc1
    ds_read_b128 v[56:59], v65 offset:10240
    s_add_u32 s28, s28, 1
    s_mov_b32 s14, s41
    s_add_u32 s23, s23, 524288
    s_add_u32 s24, s24, 524288
    s_min_u32 s24, s24, s47
    s_add_u32 s15, s14, 4096
    s_add_u32 s16, s14, 8192
    v_mov_b32 v21, -1
    s_add_u32 s65, s65, 12288
    s_mov_b32 s40, 1
    v_mov_b64 v[0:1], 0
    v_mov_b64 v[2:3], 0
    v_mov_b64 v[4:5], 0
    v_mov_b64 v[6:7], 0
    v_mov_b64 v[8:9], 0
    v_mov_b64 v[10:11], 0
    v_mov_b64 v[12:13], 0
    v_mov_b64 v[14:15], 0
cs_chkF:
    v_mov_b32 v20, 0
    s_waitcnt vmcnt(3)
    s_waitcnt lgkmcnt(0)
    v_mfma_f32_16x16x32_bf16 v[28:31], v[40:43], v[56:59], 0
    v_bitop3_b32 v20, v20, v40, s30 bitop3:0xf6
    v_bitop3_b32 v20, v20, v42, s30 bitop3:0xf6
    s_waitcnt vmcnt(2)
    v_mfma_f32_16x16x32_bf16 v[28:31], v[44:47], v[56:59], v[28:31]
    v_bitop3_b32 v20, v20, v44, s30 bitop3:0xf6
    v_bitop3_b32 v20, v20, v46, s30 bitop3:0xf6
    s_waitcnt vmcnt(1)
    v_mfma_f32_16x16x32_bf16 v[28:31], v[48:51], v[56:59], v[28:31]
    v_bitop3_b32 v20, v20, v48, s30 bitop3:0xf6
    v_bitop3_b32 v20, v20, v50, s30 bitop3:0xf6
    s_waitcnt vmcnt(0)
    v_mfma_f32_16x16x32_bf16 v[28:31], v[52:55], v[56:59], v[28:31]
    v_bitop3_b32 v20, v20, v52, s30 bitop3:0xf6
    v_bitop3_b32 v20, v20, v54, s30 bitop3:0xf6
    v_and_b32 v20, s40, v20
    v_cmp_ne_u32 vcc, 0, v20
    s_cbranch_vccnz cs_spinF
    v_permlane32_swap_b32 v28, v30
    v_permlane32_swap_b32 v29, v31
    v_add_f32 v28, v28, v30
    v_add_f32 v30, v29, v31
    v_cvt_pk_bf16_f32 v28, v28, v30
    s_mov_b64 exec, s[32:33]
    buffer_store_dword v28, v69, s[4:7], s17 offen sc1
    buffer_store_dword v21, v69, s[4:7], s18 offen sc1
    s_mov_b64 exec, -1
    ds_read_b128 v[32:35], v62 offset:16384
    ds_read_b128 v[36:39], v62 offset:20480
    ds_read_b128 v[40:43], v61 offset:0
    ds_read_b128 v[44:47], v61 offset:4096
    ds_read_b128 v[48:51], v61 offset:8192
    ds_read_b128 v[52:55], v61 offset:12288
    s_nop 15
    s_nop 15
    s_nop 15
    s_nop 15
    s_nop 15
    s_nop 15
    s_nop 3
    buffer_load_dwordx4 v[24:27], v61, s[4:7], s14 offen sc1
    s_branch cs_loop2
cs_w013:
    ds_read_b128 v[56:59], v65 offset:10240
    ds_read_b128 v[32:35], v62 offset:16384
    ds_read_b128 v[36:39], v62 offset:20480
    ds_read_b128 v[40:43], v61 offset:0
    ds_read_b128 v[44:47], v61 offset:4096
    ds_read_b128 v[48:51], v61 offset:8192
    ds_read_b128 v[52:55], v61 offset:12288
    s_add_u32 s28, s28, 1
    s_mov_b32 s14, s41
    s_add_u32 s23, s23, 524288
    s_add_u32 s24, s24, 524288
    s_min_u32 s24, s24, s47
    s_add_u32 s15, s14, 4096
    s_add_u32 s16, s14, 8192
    v_mov_b32 v21, -1
    s_add_u32 s65, s65, 12288
    s_mov_b32 s40, 1
    s_cmp_eq_u32 s64, 0
    s_cbranch_scc1 cs_w0
    s_cmp_eq_u32 s13, 1
    s_cbranch_scc1 cs_sx
    s_nop 15
    s_nop 15
    s_nop 15
    s_nop 15
    s_nop 15
    s_nop 15
    s_nop 15
    s_nop 15
    s_nop 15
    s_nop 15
    s_nop 15
    s_nop 15
    s_nop 7
cs_sx:
    buffer_load_dwordx4 v[0:3], v65, s[4:7], s19 offen offset:0 sc1
    buffer_load_dwordx4 v[4:7], v65, s[4:7], s19 offen offset:1024 sc1
    buffer_load_dwordx4 v[8:11], v65, s[4:7], s19 offen offset:2048 sc1
    buffer_load_dwordx4 v[12:15], v65, s[4:7], s19 offen offset:3072 sc1
cs_chkG:
    v_mov_b32 v20, 0
    s_waitcnt vmcnt(3)
    s_waitcnt lgkmcnt(6)
    v_mfma_f32_16x16x32_bf16 v[28:31], v[0:3], v[56:59], 0
    v_bitop3_b32 v20, v20, v0, s30 bitop3:0xf6
    v_bitop3_b32 v20, v20, v2, s30 bitop3:0xf6
    s_waitcnt vmcnt(2)
    v_mfma_f32_16x16x32_bf16 v[28:31], v[4:7], v[56:59], v[28:31]
    v_bitop3_b32 v20, v20, v4, s30 bitop3:0xf6
    v_bitop3_b32 v20, v20, v6, s30 bitop3:0xf6
    s_waitcnt vmcnt(1)
    v_mfma_f32_16x16x32_bf16 v[28:31], v[8:11], v[56:59], v[28:31]
    v_bitop3_b32 v20, v20, v8, s30 bitop3:0xf6
    v_bitop3_b32 v20, v20, v10, s30 bitop3:0xf6
    s_waitcnt vmcnt(0)
    v_mfma_f32_16x16x32_bf16 v[28:31], v[12:15], v[56:59], v[28:31]
    v_bitop3_b32 v20, v20, v12, s30 bitop3:0xf6
    v_bitop3_b32 v20, v20, v14, s30 bitop3:0xf6
    v_and_b32 v20, s40, v20
    v_cmp_ne_u32 vcc, 0, v20
    s_cbranch_vccnz cs_spinG
    v_permlane32_swap_b32 v28, v30
    v_permlane32_swap_b32 v29, v31
    v_add_f32 v28, v28, v30
    v_add_f32 v30, v29, v31
    s_cmp_eq_u32 s13, 3
    s_cbranch_scc1 cs_w3
    v_mov_b32 v29, v28
    v_mov_b32 v31, v30
    s_nop 0
    v_permlane16_swap_b32 v28, v29
    v_permlane16_swap_b32 v30, v31
    v_add_f32 v28, v28, v29
    v_add_f32 v30, v30, v31
cs_w3:
    v_cvt_pk_bf16_f32 v28, v28, v30
    s_mov_b64 exec, s[32:33]
    buffer_store_dword v28, v69, s[4:7], s17 offen sc1
    buffer_store_dword v21, v69, s[4:7], s18 offen sc1
    s_mov_b64 exec, -1
    buffer_load_dwordx4 v[24:27], v61, s[4:7], s14 offen sc1
    s_branch cs_loop
cs_w0:
    v_mov_b64 v[0:1], 0
    v_mov_b64 v[2:3], 0
    v_mov_b64 v[4:5], 0
    v_mov_b64 v[6:7], 0
    v_mov_b64 v[8:9], 0
    v_mov_b64 v[10:11], 0
    v_mov_b64 v[12:13], 0
    v_mov_b64 v[14:15], 0
    s_cmp_lg_u32 s28, 10
    s_cbranch_scc1 cs_nokv
    s_lshr_b32 s92, s12, 1
    s_lshl_b32 s92, s92, 8
    s_add_u32 s92, s92, 125829120
    v_bfe_u32 v28, v61, 4, 6
    v_min_u32 v28, 11, v28
    v_lshlrev_b32 v28, 2, v28
    s_add_u32 s93, s95, 63
    s_mov_b32 s94, 4194304
cs_kv1:
    buffer_load_dword v29, v28, s[4:7], s92 offen sc1
    s_sub_u32 s94, s94, 1
    s_cbranch_scc1 cs_kv1_go
    s_waitcnt vmcnt(0)
    v_subrev_u32 v29, s93, v29
    v_cmp_lt_u32 vcc, 64, v29
    s_cbranch_vccz cs_kv1_go
    s_sleep 2
    s_branch cs_kv1
cs_kv1_go:
cs_nokv:
    s_nop 15
    s_nop 15
    s_nop 15
    s_nop 15
    s_nop 15
    s_nop 15
    s_nop 15
    s_nop 15
    s_nop 15
    s_nop 15
    s_nop 15
    s_nop 15
    s_nop 15
    s_nop 15
    s_nop 15
    s_nop 15
    s_nop 15
    s_nop 15
    s_nop 15
    s_nop 15
    s_nop 15
    s_nop 15
    s_nop 15
    s_nop 15
    s_nop 15
    buffer_load_dwordx4 v[24:27], v61, s[4:7], s14 offen sc1
    s_branch cs_loop2
cs_spinF:
    buffer_load_dwordx4 v[40:43], v65, s[4:7], s19 offen offset:0 sc1
    buffer_load_dwordx4 v[44:47], v65, s[4:7], s19 offen offset:1024 sc1
    buffer_load_dwordx4 v[48:51], v65, s[4:7], s19 offen offset:2048 sc1
    buffer_load_dwordx4 v[52:55], v65, s[4:7], s19 offen offset:3072 sc1
    s_sub_u32 s29, s29, 1
    s_cmp_lt_i32 s29, 0
    s_cselect_b32 s40, 0, 1
    s_branch cs_chkF
cs_spinG:
    buffer_load_dwordx4 v[0:3], v65, s[4:7], s19 offen offset:0 sc1
    buffer_load_dwordx4 v[4:7], v65, s[4:7], s19 offen offset:1024 sc1
    buffer_load_dwordx4 v[8:11], v65, s[4:7], s19 offen offset:2048 sc1
    buffer_load_dwordx4 v[12:15], v65, s[4:7], s19 offen offset:3072 sc1
    s_sub_u32 s29, s29, 1
    s_cmp_lt_i32 s29, 0
    s_cselect_b32 s40, 0, 1
    s_branch cs_chkG
cs_guard:
    s_cbranch_scc0 cs_guard2
    buffer_store_dwordx4 v[16:19], v61, s[4:7], s26 offen sc1
    s_add_u32 s26, s26, 131072
cs_guard2:
    s_nop 7
    v_max3_f32 v6, v28, v29, v30
    v_max3_f32 v7, v31, v56, v57
    v_max_f32 v6, v6, v7
    s_nop 1
    v_max_f32_dpp v6, v6, v6 row_ror:8 row_mask:0xf bank_mask:0xf
    v_mov_b32 v7, v6
    s_nop 1
    v_permlane32_swap_b32 v6, v7
    v_max_f32 v6, v6, v7
    v_mov_b32 v7, v6
    s_nop 1
    v_permlane16_swap_b32 v6, v7
    v_max_f32 v6, v6, v7
    v_sub_f32 v28, v28, v6
    v_sub_f32 v29, v29, v6
    v_sub_f32 v30, v30, v6
    v_sub_f32 v31, v31, v6
    v_sub_f32 v56, v56, v6
    v_sub_f32 v57, v57, v6
    v_exp_f32 v58, v56
    v_exp_f32 v59, v57
    s_nop 0
    v_cvt_pk_bf16_f32 v6, v58, v59
    s_nop 1
    v_mov_b32_dpp v7, v6 row_ror:8 row_mask:0xf bank_mask:0xf
    v_exp_f32 v0, v28
    s_nop 0
    v_mfma_f32_16x16x16_bf16 v[12:15], v[16:17], v[6:7], 0
    v_exp_f32 v1, v29
    v_exp_f32 v2, v30
    v_cvt_pk_bf16_f32 v8, v0, v1
    v_exp_f32 v3, v31
    v_mfma_f32_16x16x16_bf16 v[20:23], v[18:19], v[6:7], 0
    v_cvt_pk_bf16_f32 v9, v2, v3
    v_mov_b32_dpp v10, v8 row_ror:8 row_mask:0xf bank_mask:0xf
    v_max3_f32 v4, |v28|, |v29|, |v30|
    v_mov_b32_dpp v11, v9 row_ror:8 row_mask:0xf bank_mask:0xf
    v_mfma_f32_16x16x32_bf16 v[0:3], v[24:27], v[6:9], 0
    v_max3_f32 v4, v4, |v31|, |v56|
    v_max_f32_e64 v4, v4, |v57|
    v_mfma_f32_16x16x32_bf16 v[12:15], v[40:43], v[8:11], v[12:15]
    v_cmp_nge_f32 vcc, s46, v4
    v_mfma_f32_16x16x32_bf16 v[20:23], v[44:47], v[8:11], v[20:23]
    v_add_f32_dpp v0, v0, v0 row_ror:8 row_mask:0xf bank_mask:0xf
    v_rcp_f32 v0, v0
    s_nop 4
    s_branch cs_norm
cs_spin0:
    buffer_load_dwordx4 v[24:27], v61, s[4:7], s14 offen sc1
    s_sub_u32 s29, s29, 1
    s_cmp_lt_i32 s29, 0
    s_cbranch_scc0 cs_chk0
    s_waitcnt vmcnt(0)
    v_min_u32 v24, -2, v24
    v_min_u32 v25, -2, v25
    v_min_u32 v26, -2, v26
    v_min_u32 v27, -2, v27
    s_branch cs_chk0
cs_spin1:
    buffer_load_dwordx4 v[28:31], v61, s[4:7], s15 offen sc1
    buffer_load_dword v59, v56, s[4:7], s16 offen sc1
    s_sub_u32 s29, s29, 1
    s_cmp_lt_i32 s29, 0
    s_waitcnt vmcnt(0)
    v_max3_u32 v57, v28, v29, v30
    v_max3_u32 v57, v57, v31, v59
    v_cmp_eq_u32 vcc, -1, v57
    ds_write_b128 v62, v[28:31] offset:45056
    ds_write_b32 v58, v59
    s_waitcnt lgkmcnt(0)
    s_cbranch_scc1 cs_go1
    s_cbranch_vccnz cs_spin1
    s_branch cs_go1
cs_last:
    s_nop 1
    s_cmp_eq_u32 s28, 63
    s_cbranch_scc1 cs_last2
    s_mov_b64 exec, s[34:35]
    buffer_store_dwordx4 v[0:3], v61, s[4:7], s25 offen sc1
    s_mov_b64 exec, -1
    s_add_u32 s25, s25, 131072
    s_mov_b32 s46, 0xbf800000
    s_cmp_eq_u32 0, 0
    s_branch cs_back
cs_last2:
    s_waitcnt lgkmcnt(0)
    s_mov_b64 exec, s[34:35]
    buffer_store_dwordx4 v[0:3], v61, s[4:7], s25 offen sc1
    s_mov_b64 exec, -1
    s_add_u32 s40, s95, 64
    v_mov_b32 v40, s40
    v_smfmac_f32_16x16x64_bf16 v[16:19], v[52:55], a[240:247], v60
    v_smfmac_f32_16x16x64_bf16 v[20:23], v[52:55], a[248:255], v60
    s_nop 3
    v_cvt_pk_bf16_f32 v16, v16, v17
    v_cvt_pk_bf16_f32 v17, v18, v19
    s_nop 1
    v_cvt_pk_bf16_f32 v18, v20, v21
    v_cvt_pk_bf16_f32 v19, v22, v23
    buffer_store_dwordx4 v[16:19], v61, s[4:7], s26 offen sc1
    s_waitcnt vmcnt(0)
    s_mov_b64 exec, 1
    buffer_store_dword v40, off, s[4:7], s27 sc1
    s_mov_b64 exec, -1
    s_endpgm
cs_dma:
    s_xor_b32 s74, s76, s81
    s_add_u32 m0, s74, s80
    s_add_u32 s76, s76, 4096
    buffer_load_dwordx4 v58, s[8:11], s78 offen lds
    s_add_u32 s78, s78, s79
    s_cmp_lt_u32 s76, s77
    s_cbranch_scc1 cs_dma
    s_setpc_b64 s[82:83]
L_helper:
    s_load_dwordx16 s[64:79], s[0:1], 64
    s_sub_u32 s33, s3, 1
    s_and_b32 s33, s33, 7
L_pool:
    s_lshl_b32 s35, s33, 2
    s_add_u32 s35, s35, 32
    s_mov_b32 s37, s35
    v_mov_b32 v250, 1
    v_mov_b32 v251, 163832
    v_cmp_eq_u32 vcc, 0, v0
    s_nop 0
    s_and_saveexec_b64 s[38:39], vcc
    s_cbranch_execz tk4
    buffer_atomic_add v250, off, s[96:99], s37 sc0
    s_waitcnt vmcnt(0)
    ds_write_b32 v251, v250
    s_waitcnt lgkmcnt(0)
tk4:
    s_mov_b64 exec, -1
    s_barrier
    ds_read_b32 v252, v251
    s_waitcnt lgkmcnt(0)
    v_readfirstlane_b32 s34, v252
    s_barrier
    s_nop 3
    s_mov_b32 s36, s33
    s_or_b32 s33, s34, s32
    s_cmp_lg_u32 s33, 0
    s_cbranch_scc1 L_helper1
    s_memrealtime s[90:91]
    s_waitcnt lgkmcnt(0)
    s_lshl_b32 s90, s90, 8
    s_or_b32 s90, s90, 1
    v_mov_b32 v250, s90
    v_mov_b32 v251, 0
    s_mov_b64 exec, 1
    buffer_atomic_cmpswap v[250:251], off, s[96:99], 0 offset:64
    s_mov_b64 exec, -1
L_helper1:
    s_cmp_ge_u32 s34, 32
    s_cbranch_scc1 L_qkv_next
    s_cmp_ge_u32 s36, 7
    s_cbranch_scc1 L_qkv_next
    s_max_u32 s37, s36, 4
    s_sub_u32 s37, s37, 4
    s_mul_i32 s37, s37, 6
    s_lshl_b32 s38, s36, 1
    s_add_u32 s38, s38, s37
    s_cmp_lt_u32 s36, 4
    s_cselect_b32 s39, 2, 8
    s_mul_i32 s36, s36, 30
    s_sub_u32 s36, s36, s37
    s_cmp_lt_u32 s34, s39
    s_cbranch_scc1 L_copy
    s_add_u32 s36, s36, s34
    s_sub_u32 s36, s36, s39
    s_cmp_lg_u32 s95, 0
    s_cbranch_scc1 L_nowm
    s_mul_i32 s37, s36, 24576
    s_mov_b32 s14, 4718592
    s_mov_b32 s15, 0x20000
    s_mov_b32 m0, 155648
    v_lshlrev_b32 v1, 7, v0
    v_min_u32 v1, 24448, v1
    s_mov_b64 s[12:13], s[58:59]
    buffer_load_dword v1, s[12:15], s37 offen lds
    s_mov_b64 s[12:13], s[52:53]
    buffer_load_dword v1, s[12:15], s37 offen lds
L_nowm:
    s_mul_i32 s37, s36, 171
    s_lshr_b32 s37, s37, 10
    s_mul_i32 s38, s37, 6
    s_sub_u32 s36, s36, s38
    s_lshl_b32 s36, s36, 5
    s_add_u32 s36, s36, s37
    s_branch L_job
L_copy:
    s_add_u32 s36, s38, s34
    s_mul_i32 s36, s36, 11
    s_and_b32 s36, s36, 31
    s_cmp_ge_u32 s36, 27
    s_cbranch_scc1 L_qkv_next
    s_mul_i32 s33, s36, 57
    s_lshr_b32 s33, s33, 9
    s_mul_i32 s37, s33, 9
    s_sub_u32 s37, s36, s37
    s_lshl_b32 s36, s37, 2
    s_add_u32 s36, s36, 1
    s_min_u32 s36, s36, 31
    s_lshr_b32 s39, s52, 8
    s_sub_u32 s36, s36, s39
    s_and_b32 s36, s36, 31
    s_lshl_b32 s36, s36, 8
    s_mov_b32 s14, 4718592
    s_mov_b32 s15, 0x20000
    v_lshrrev_b32 v1, 4, v0
    v_lshlrev_b32 v1, 13, v1
    v_and_b32 v2, 15, v0
    v_lshl_add_u32 v1, v2, 4, v1
    v_lshlrev_b32 v2, 4, v0
    s_lshl_b32 s40, s33, 1
    s_mul_i32 s39, s40, 49152
    s_lshl_b32 s41, s37, 19
    s_add_u32 s39, s39, s41
    s_add_u32 s39, s39, 96468992
    s_add_u32 s41, s40, 0
    s_cmp_lt_u32 s41, 3
    s_cselect_b64 s[12:13], s[52:53], s[54:55]
    s_cselect_b32 s42, 0, 3
    s_sub_u32 s41, s41, s42
    s_mul_i32 s38, s41, 1572864
    s_add_u32 s38, s38, s36
    buffer_load_dwordx4 v[8:11], v1, s[12:15], s38 offen
    s_add_u32 s38, s38, 131072
    buffer_load_dwordx4 v[12:15], v1, s[12:15], s38 offen
    s_add_u32 s38, s38, 131072
    buffer_load_dwordx4 v[16:19], v1, s[12:15], s38 offen
    s_add_u32 s38, s38, 131072
    buffer_load_dwordx4 v[20:23], v1, s[12:15], s38 offen
    s_add_u32 s38, s38, 131072
    buffer_load_dwordx4 v[24:27], v1, s[12:15], s38 offen
    s_add_u32 s38, s38, 131072
    buffer_load_dwordx4 v[28:31], v1, s[12:15], s38 offen
    s_add_u32 s38, s38, 131072
    buffer_load_dwordx4 v[32:35], v1, s[12:15], s38 offen
    s_add_u32 s38, s38, 131072
    buffer_load_dwordx4 v[36:39], v1, s[12:15], s38 offen
    s_add_u32 s38, s38, 131072
    buffer_load_dwordx4 v[40:43], v1, s[12:15], s38 offen
    s_add_u32 s38, s38, 131072
    buffer_load_dwordx4 v[44:47], v1, s[12:15], s38 offen
    s_add_u32 s38, s38, 131072
    buffer_load_dwordx4 v[48:51], v1, s[12:15], s38 offen
    s_add_u32 s38, s38, 131072
    buffer_load_dwordx4 v[52:55], v1, s[12:15], s38 offen
    s_add_u32 s38, s38, 131072
    s_add_u32 s41, s40, 1
    s_cmp_lt_u32 s41, 3
    s_cselect_b64 s[12:13], s[52:53], s[54:55]
    s_cselect_b32 s42, 0, 3
    s_sub_u32 s41, s41, s42
    s_mul_i32 s38, s41, 1572864
    s_add_u32 s38, s38, s36
    buffer_load_dwordx4 v[56:59], v1, s[12:15], s38 offen
    s_add_u32 s38, s38, 131072
    buffer_load_dwordx4 v[60:63], v1, s[12:15], s38 offen
    s_add_u32 s38, s38, 131072
    buffer_load_dwordx4 v[64:67], v1, s[12:15], s38 offen
    s_add_u32 s38, s38, 131072
    buffer_load_dwordx4 v[68:71], v1, s[12:15], s38 offen
    s_add_u32 s38, s38, 131072
    buffer_load_dwordx4 v[72:75], v1, s[12:15], s38 offen
    s_add_u32 s38, s38, 131072
    buffer_load_dwordx4 v[76:79], v1, s[12:15], s38 offen
    s_add_u32 s38, s38, 131072
    buffer_load_dwordx4 v[80:83], v1, s[12:15], s38 offen
    s_add_u32 s38, s38, 131072
    buffer_load_dwordx4 v[84:87], v1, s[12:15], s38 offen
    s_add_u32 s38, s38, 131072
    buffer_load_dwordx4 v[88:91], v1, s[12:15], s38 offen
    s_add_u32 s38, s38, 131072
    buffer_load_dwordx4 v[92:95], v1, s[12:15], s38 offen
    s_add_u32 s38, s38, 131072
    buffer_load_dwordx4 v[96:99], v1, s[12:15], s38 offen
    s_add_u32 s38, s38, 131072
    buffer_load_dwordx4 v[100:103], v1, s[12:15], s38 offen
    s_add_u32 s38, s38, 131072
    buffer_load_dword v3, off, s[96:99], 0 offset:64 sc1
    s_waitcnt vmcnt(0)
    buffer_store_dwordx4 v[8:11], v2, s[4:7], s39 offen sc1
    s_add_u32 s39, s39, 4096
    buffer_store_dwordx4 v[12:15], v2, s[4:7], s39 offen sc1
    s_add_u32 s39, s39, 4096
    buffer_store_dwordx4 v[16:19], v2, s[4:7], s39 offen sc1
    s_add_u32 s39, s39, 4096
    buffer_store_dwordx4 v[20:23], v2, s[4:7], s39 offen sc1
    s_add_u32 s39, s39, 4096
    buffer_store_dwordx4 v[24:27], v2, s[4:7], s39 offen sc1
    s_add_u32 s39, s39, 4096
    buffer_store_dwordx4 v[28:31], v2, s[4:7], s39 offen sc1
    s_add_u32 s39, s39, 4096
    buffer_store_dwordx4 v[32:35], v2, s[4:7], s39 offen sc1
    s_add_u32 s39, s39, 4096
    buffer_store_dwordx4 v[36:39], v2, s[4:7], s39 offen sc1
    s_add_u32 s39, s39, 4096
    buffer_store_dwordx4 v[40:43], v2, s[4:7], s39 offen sc1
    s_add_u32 s39, s39, 4096
    buffer_store_dwordx4 v[44:47], v2, s[4:7], s39 offen sc1
    s_add_u32 s39, s39, 4096
    buffer_store_dwordx4 v[48:51], v2, s[4:7], s39 offen sc1
    s_add_u32 s39, s39, 4096
    buffer_store_dwordx4 v[52:55], v2, s[4:7], s39 offen sc1
    s_add_u32 s39, s39, 4096
    buffer_store_dwordx4 v[56:59], v2, s[4:7], s39 offen sc1
    s_add_u32 s39, s39, 4096
    buffer_store_dwordx4 v[60:63], v2, s[4:7], s39 offen sc1
    s_add_u32 s39, s39, 4096
    buffer_store_dwordx4 v[64:67], v2, s[4:7], s39 offen sc1
    s_add_u32 s39, s39, 4096
    buffer_store_dwordx4 v[68:71], v2, s[4:7], s39 offen sc1
    s_add_u32 s39, s39, 4096
    buffer_store_dwordx4 v[72:75], v2, s[4:7], s39 offen sc1
    s_add_u32 s39, s39, 4096
    buffer_store_dwordx4 v[76:79], v2, s[4:7], s39 offen sc1
    s_add_u32 s39, s39, 4096
    buffer_store_dwordx4 v[80:83], v2, s[4:7], s39 offen sc1
    s_add_u32 s39, s39, 4096
    buffer_store_dwordx4 v[84:87], v2, s[4:7], s39 offen sc1
    s_add_u32 s39, s39, 4096
    buffer_store_dwordx4 v[88:91], v2, s[4:7], s39 offen sc1
    s_add_u32 s39, s39, 4096
    buffer_store_dwordx4 v[92:95], v2, s[4:7], s39 offen sc1
    s_add_u32 s39, s39, 4096
    buffer_store_dwordx4 v[96:99], v2, s[4:7], s39 offen sc1
    s_add_u32 s39, s39, 4096
    buffer_store_dwordx4 v[100:103], v2, s[4:7], s39 offen sc1
    s_add_u32 s39, s39, 4096
    v_readfirstlane_b32 s95, v3
    s_nop 4
    s_mov_b32 s88, 4194304
gn5:
    s_cmp_lg_u32 s95, 0
    s_cbranch_scc1 gn5x
    buffer_load_dword v3, off, s[96:99], 0 offset:64 sc1
    s_sub_u32 s88, s88, 1
    s_cbranch_scc1 gn5x
    s_waitcnt vmcnt(0)
    v_readfirstlane_b32 s95, v3
    s_nop 1
    s_branch gn5
gn5x:
    s_lshl_b32 s37, s37, 7
    s_lshl_b32 s36, s33, 2
    s_add_u32 s36, s36, s32
    s_lshl_b32 s36, s36, 2
    s_add_u32 s37, s37, s36
    s_add_u32 s37, s37, 125853696
    v_mov_b32 v3, s95
    s_waitcnt vmcnt(0)
    s_mov_b64 exec, 1
    buffer_store_dword v3, off, s[4:7], s37 sc1
    s_mov_b64 exec, -1
L_qkv_next:
    s_mov_b32 s37, 4
    v_mov_b32 v250, 1
    v_mov_b32 v251, 163832
    v_cmp_eq_u32 vcc, 0, v0
    s_nop 0
    s_and_saveexec_b64 s[38:39], vcc
    s_cbranch_execz tk6
    buffer_atomic_add v250, off, s[96:99], s37 sc0
    s_waitcnt vmcnt(0)
    ds_write_b32 v251, v250
    s_waitcnt lgkmcnt(0)
tk6:
    s_mov_b64 exec, -1
    s_barrier
    ds_read_b32 v252, v251
    s_waitcnt lgkmcnt(0)
    v_readfirstlane_b32 s36, v252
    s_barrier
    s_nop 3
    s_add_u32 s36, s36, 192
    s_cmp_ge_u32 s36, 320
    s_cbranch_scc1 L_ssm_next
L_job:
    s_and_b32 s17, s36, 15
    s_lshl_b32 s17, s17, 1
    s_bfe_u32 s16, s36, 0x10004
    s_lshr_b32 s19, s36, 5
    s_mul_i32 s33, s16, 6
    s_add_u32 s33, s33, s19
    s_add_u32 s16, s16, 1
    s_lshr_b32 s37, s36, 4
    s_sub_u32 s38, s37, 12
    s_cmp_ge_u32 s36, 192
    s_cselect_b32 s16, 0, s16
    s_cselect_b32 s19, s38, s19
    s_cselect_b32 s33, s37, s33
    s_cselect_b32 s20, 8, 6
    v_lshrrev_b32 v4, 6, v0
    s_nop 0
    v_readfirstlane_b32 s18, v4
    v_lshlrev_b32 v7, 4, v0
    v_and_b32 v4, 63, v0
    v_lshrrev_b32 v6, 2, v4
    v_lshlrev_b32 v6, 13, v6
    v_lshrrev_b32 v5, 4, v4
    v_and_b32 v5, 2, v5
    v_xor_b32 v5, v5, v4
    v_and_b32 v5, 3, v5
    v_lshl_add_u32 v6, v5, 4, v6
    v_lshrrev_b32 v24, 4, v4
    v_lshlrev_b32 v24, 9, v24
    v_bfe_u32 v5, v4, 2, 2
    v_lshl_add_u32 v24, v5, 6, v24
    v_bfe_u32 v5, v4, 4, 1
    v_lshl_add_u32 v24, v5, 5, v24
    v_and_b32 v5, 3, v4
    v_lshl_add_u32 v24, v5, 3, v24
    s_lshl_b32 s31, s18, 12
    v_add_u32 v24, s31, v24
    s_cmp_eq_u32 s16, 1
    s_cselect_b64 s[12:13], s[54:55], s[52:53]
    s_cmp_eq_u32 s16, 2
    s_cselect_b64 s[12:13], s[56:57], s[12:13]
    s_mov_b32 s14, 4718592
    s_mov_b32 s15, 0x20000
    s_lshl_b32 s28, s17, 8
    s_lshl_b32 s21, s18, 6
    s_add_u32 s28, s28, s21
    s_add_u32 s21, s28, 0
    s_add_u32 m0, s31, 40960
    s_nop 0
    buffer_load_dwordx4 v6, s[12:15], s21 offen lds
    s_add_u32 m0, s31, 41984
    s_add_u32 s21, s21, 131072
    buffer_load_dwordx4 v6, s[12:15], s21 offen lds
    s_add_u32 m0, s31, 43008
    s_add_u32 s21, s21, 131072
    buffer_load_dwordx4 v6, s[12:15], s21 offen lds
    s_add_u32 m0, s31, 44032
    s_add_u32 s21, s21, 131072
    buffer_load_dwordx4 v6, s[12:15], s21 offen lds
    s_add_u32 s21, s28, 256
    s_add_u32 m0, s31, 57344
    s_nop 0
    buffer_load_dwordx4 v6, s[12:15], s21 offen lds
    s_add_u32 m0, s31, 58368
    s_add_u32 s21, s21, 131072
    buffer_load_dwordx4 v6, s[12:15], s21 offen lds
    s_add_u32 m0, s31, 59392
    s_add_u32 s21, s21, 131072
    buffer_load_dwordx4 v6, s[12:15], s21 offen lds
    s_add_u32 m0, s31, 60416
    s_add_u32 s21, s21, 131072
    buffer_load_dwordx4 v6, s[12:15], s21 offen lds
    s_add_u32 s21, s28, 524288
    s_add_u32 m0, s31, 73728
    s_nop 0
    buffer_load_dwordx4 v6, s[12:15], s21 offen lds
    s_add_u32 m0, s31, 74752
    s_add_u32 s21, s21, 131072
    buffer_load_dwordx4 v6, s[12:15], s21 offen lds
    s_add_u32 m0, s31, 75776
    s_add_u32 s21, s21, 131072
    buffer_load_dwordx4 v6, s[12:15], s21 offen lds
    s_add_u32 m0, s31, 76800
    s_add_u32 s21, s21, 131072
    buffer_load_dwordx4 v6, s[12:15], s21 offen lds
    s_add_u32 s21, s28, 524544
    s_add_u32 m0, s31, 90112
    s_nop 0
    buffer_load_dwordx4 v6, s[12:15], s21 offen lds
    s_add_u32 m0, s31, 91136
    s_add_u32 s21, s21, 131072
    buffer_load_dwordx4 v6, s[12:15], s21 offen lds
    s_add_u32 m0, s31, 92160
    s_add_u32 s21, s21, 131072
    buffer_load_dwordx4 v6, s[12:15], s21 offen lds
    s_add_u32 m0, s31, 93184
    s_add_u32 s21, s21, 131072
    buffer_load_dwordx4 v6, s[12:15], s21 offen lds
    s_add_u32 s21, s28, 1048576
    s_add_u32 m0, s31, 106496
    s_nop 0
    buffer_load_dwordx4 v6, s[12:15], s21 offen lds
    s_add_u32 m0, s31, 107520
    s_add_u32 s21, s21, 131072
    buffer_load_dwordx4 v6, s[12:15], s21 offen lds
    s_add_u32 m0, s31, 108544
    s_add_u32 s21, s21, 131072
    buffer_load_dwordx4 v6, s[12:15], s21 offen lds
    s_add_u32 m0, s31, 109568
    s_add_u32 s21, s21, 131072
    buffer_load_dwordx4 v6, s[12:15], s21 offen lds
    s_add_u32 s21, s28, 1048832
    s_add_u32 m0, s31, 122880
    s_nop 0
    buffer_load_dwordx4 v6, s[12:15], s21 offen lds
    s_add_u32 m0, s31, 123904
    s_add_u32 s21, s21, 131072
    buffer_load_dwordx4 v6, s[12:15], s21 offen lds
    s_add_u32 m0, s31, 124928
    s_add_u32 s21, s21, 131072
    buffer_load_dwordx4 v6, s[12:15], s21 offen lds
    s_add_u32 m0, s31, 125952
    s_add_u32 s21, s21, 131072
    buffer_load_dwordx4 v6, s[12:15], s21 offen lds
    s_add_u32 s21, s28, 1572864
    s_add_u32 m0, s31, 139264
    s_nop 0
    buffer_load_dwordx4 v6, s[12:15], s21 offen lds
    s_add_u32 m0, s31, 140288
    s_add_u32 s21, s21, 131072
    buffer_load_dwordx4 v6, s[12:15], s21 offen lds
    s_add_u32 m0, s31, 141312
    s_add_u32 s21, s21, 131072
    buffer_load_dwordx4 v6, s[12:15], s21 offen lds
    s_add_u32 m0, s31, 142336
    s_add_u32 s21, s21, 131072
    buffer_load_dwordx4 v6, s[12:15], s21 offen lds
    v_and_b32 v5, 15, v4
    v_lshrrev_b32 v3, 4, v4
    v_lshrrev_b32 v2, 2, v5
    v_xor_b32 v3, v3, v2
    v_lshl_add_u32 v3, v5, 2, v3
    v_lshlrev_b32 v1, 4, v3
    v_lshrrev_b32 v5, 2, v4
    v_lshrrev_b32 v3, 4, v4
    v_and_b32 v4, 3, v4
    v_xor_b32 v4, v4, v3
    v_lshlrev_b32 v3, 3, v3
    v_and_b32 v5, 3, v5
    v_add_u32 v3, v3, v5
    v_mul_u32_u24 v2, 1152, v3
    v_lshl_add_u32 v2, v4, 4, v2
    s_mov_b32 s8, s48
    s_mov_b32 s9, s49
    s_mov_b32 s10, 2359296
    s_mov_b32 s11, 0x20000
    s_lshr_b32 s22, s18, 1
    s_mul_i32 s24, s22, 4608
    s_and_b32 s22, s18, 1
    s_mul_i32 s23, s22, 576
    s_add_u32 s24, s24, s23
    s_mul_i32 s25, s18, 9216
    s_mul_i32 s22, s19, 36864
    s_add_u32 s24, s24, s22
    s_mul_i32 s42, s20, 36864
    s_mov_b32 s27, 0
    s_add_u32 s23, s27, s25
    s_add_u32 m0, s23, 0
    s_nop 0
    buffer_load_dwordx4 v2, s[8:11], s24 offen offset:0 lds
    s_add_u32 m0, s23, 960
    s_nop 0
    buffer_load_dwordx4 v2, s[8:11], s24 offen offset:64 lds
    s_add_u32 m0, s23, 1920
    s_nop 0
    buffer_load_dwordx4 v2, s[8:11], s24 offen offset:128 lds
    s_add_u32 m0, s23, 2880
    s_nop 0
    buffer_load_dwordx4 v2, s[8:11], s24 offen offset:192 lds
    s_add_u32 m0, s23, 3840
    s_nop 0
    buffer_load_dwordx4 v2, s[8:11], s24 offen offset:256 lds
    s_add_u32 m0, s23, 4800
    s_nop 0
    buffer_load_dwordx4 v2, s[8:11], s24 offen offset:320 lds
    s_add_u32 m0, s23, 5760
    s_nop 0
    buffer_load_dwordx4 v2, s[8:11], s24 offen offset:384 lds
    s_add_u32 m0, s23, 6720
    s_nop 0
    buffer_load_dwordx4 v2, s[8:11], s24 offen offset:448 lds
    s_add_u32 m0, s23, 7680
    s_nop 0
    buffer_load_dwordx4 v2, s[8:11], s24 offen offset:512 lds
    s_add_u32 s24, s24, s42
    s_lshl_b32 s22, s19, 5
    s_add_u32 s22, s22, s17
    s_lshl_b32 s26, s22, 14
    s_mul_i32 s23, s18, 3072
    s_add_u32 s26, s26, s23
    s_lshl_b32 s23, s16, 11
    s_add_u32 s26, s26, s23
    s_add_u32 s26, s26, -2048
    s_lshl_b32 s22, s22, 13
    s_add_u32 s22, s22, 33554432
    s_cmp_eq_u32 s16, 0
    s_cselect_b32 s26, s22, s26
    s_cselect_b32 s40, 4, 1
    s_cselect_b32 s43, 1, 2
    s_lshl_b32 s40, s40, 10
    s_lshl_b32 s43, s43, 13
    s_lshl_b32 s41, s43, 5
    s_mul_i32 s41, s41, s20
    s_lshl_b32 s29, s17, 7
    s_lshl_b32 s22, s33, 2
    s_add_u32 s29, s29, s22
    s_add_u32 s29, s29, 125829120
    v_add_u32 v25, 40960, v24
    v_xor_b32 v26, 32, v25
    s_waitcnt vmcnt(33)
    ds_read_b64_tr_b16 v[64:65], v25 offset:0
    ds_read_b64_tr_b16 v[66:67], v25 offset:256
    ds_read_b64_tr_b16 v[136:137], v26 offset:0
    ds_read_b64_tr_b16 v[138:139], v26 offset:256
    ds_read_b64_tr_b16 v[68:69], v25 offset:2048
    ds_read_b64_tr_b16 v[70:71], v25 offset:2304
    ds_read_b64_tr_b16 v[140:141], v26 offset:2048
    ds_read_b64_tr_b16 v[142:143], v26 offset:2304
    s_waitcnt lgkmcnt(0)
    s_add_u32 s21, s28, 1573120
    s_add_u32 m0, s31, 40960
    s_nop 0
    buffer_load_dwordx4 v6, s[12:15], s21 offen lds
    s_add_u32 m0, s31, 41984
    s_add_u32 s21, s21, 131072
    buffer_load_dwordx4 v6, s[12:15], s21 offen lds
    s_add_u32 m0, s31, 43008
    s_add_u32 s21, s21, 131072
    buffer_load_dwordx4 v6, s[12:15], s21 offen lds
    s_add_u32 m0, s31, 44032
    s_add_u32 s21, s21, 131072
    buffer_load_dwordx4 v6, s[12:15], s21 offen lds
    v_add_u32 v25, 57344, v24
    v_xor_b32 v26, 32, v25
    s_waitcnt vmcnt(33)
    ds_read_b64_tr_b16 a[0:1], v25 offset:0
    ds_read_b64_tr_b16 a[2:3], v25 offset:256
    ds_read_b64_tr_b16 a[72:73], v26 offset:0
    ds_read_b64_tr_b16 a[74:75], v26 offset:256
    ds_read_b64_tr_b16 a[4:5], v25 offset:2048
    ds_read_b64_tr_b16 a[6:7], v25 offset:2304
    ds_read_b64_tr_b16 a[76:77], v26 offset:2048
    ds_read_b64_tr_b16 a[78:79], v26 offset:2304
    s_waitcnt lgkmcnt(0)
    s_add_u32 s21, s28, 2097152
    s_add_u32 m0, s31, 57344
    s_nop 0
    buffer_load_dwordx4 v6, s[12:15], s21 offen lds
    s_add_u32 m0, s31, 58368
    s_add_u32 s21, s21, 131072
    buffer_load_dwordx4 v6, s[12:15], s21 offen lds
    s_add_u32 m0, s31, 59392
    s_add_u32 s21, s21, 131072
    buffer_load_dwordx4 v6, s[12:15], s21 offen lds
    s_add_u32 m0, s31, 60416
    s_add_u32 s21, s21, 131072
    buffer_load_dwordx4 v6, s[12:15], s21 offen lds
    v_add_u32 v25, 73728, v24
    v_xor_b32 v26, 32, v25
    s_waitcnt vmcnt(33)
    ds_read_b64_tr_b16 v[72:73], v25 offset:0
    ds_read_b64_tr_b16 v[74:75], v25 offset:256
    ds_read_b64_tr_b16 v[144:145], v26 offset:0
    ds_read_b64_tr_b16 v[146:147], v26 offset:256
    ds_read_b64_tr_b16 v[76:77], v25 offset:2048
    ds_read_b64_tr_b16 v[78:79], v25 offset:2304
    ds_read_b64_tr_b16 v[148:149], v26 offset:2048
    ds_read_b64_tr_b16 v[150:151], v26 offset:2304
    s_waitcnt lgkmcnt(0)
    s_add_u32 s21, s28, 2097408
    s_add_u32 m0, s31, 73728
    s_nop 0
    buffer_load_dwordx4 v6, s[12:15], s21 offen lds
    s_add_u32 m0, s31, 74752
    s_add_u32 s21, s21, 131072
    buffer_load_dwordx4 v6, s[12:15], s21 offen lds
    s_add_u32 m0, s31, 75776
    s_add_u32 s21, s21, 131072
    buffer_load_dwordx4 v6, s[12:15], s21 offen lds
    s_add_u32 m0, s31, 76800
    s_add_u32 s21, s21, 131072
    buffer_load_dwordx4 v6, s[12:15], s21 offen lds
    v_add_u32 v25, 90112, v24
    v_xor_b32 v26, 32, v25
    s_waitcnt vmcnt(33)
    ds_read_b64_tr_b16 a[8:9], v25 offset:0
    ds_read_b64_tr_b16 a[10:11], v25 offset:256
    ds_read_b64_tr_b16 a[80:81], v26 offset:0
    ds_read_b64_tr_b16 a[82:83], v26 offset:256
    ds_read_b64_tr_b16 a[12:13], v25 offset:2048
    ds_read_b64_tr_b16 a[14:15], v25 offset:2304
    ds_read_b64_tr_b16 a[84:85], v26 offset:2048
    ds_read_b64_tr_b16 a[86:87], v26 offset:2304
    s_waitcnt lgkmcnt(0)
    s_add_u32 s21, s28, 2621440
    s_add_u32 m0, s31, 90112
    s_nop 0
    buffer_load_dwordx4 v6, s[12:15], s21 offen lds
    s_add_u32 m0, s31, 91136
    s_add_u32 s21, s21, 131072
    buffer_load_dwordx4 v6, s[12:15], s21 offen lds
    s_add_u32 m0, s31, 92160
    s_add_u32 s21, s21, 131072
    buffer_load_dwordx4 v6, s[12:15], s21 offen lds
    s_add_u32 m0, s31, 93184
    s_add_u32 s21, s21, 131072
    buffer_load_dwordx4 v6, s[12:15], s21 offen lds
    v_add_u32 v25, 106496, v24
    v_xor_b32 v26, 32, v25
    s_waitcnt vmcnt(33)
    ds_read_b64_tr_b16 v[80:81], v25 offset:0
    ds_read_b64_tr_b16 v[82:83], v25 offset:256
    ds_read_b64_tr_b16 v[152:153], v26 offset:0
    ds_read_b64_tr_b16 v[154:155], v26 offset:256
    ds_read_b64_tr_b16 v[84:85], v25 offset:2048
    ds_read_b64_tr_b16 v[86:87], v25 offset:2304
    ds_read_b64_tr_b16 v[156:157], v26 offset:2048
    ds_read_b64_tr_b16 v[158:159], v26 offset:2304
    s_waitcnt lgkmcnt(0)
    s_add_u32 s21, s28, 2621696
    s_add_u32 m0, s31, 106496
    s_nop 0
    buffer_load_dwordx4 v6, s[12:15], s21 offen lds
    s_add_u32 m0, s31, 107520
    s_add_u32 s21, s21, 131072
    buffer_load_dwordx4 v6, s[12:15], s21 offen lds
    s_add_u32 m0, s31, 108544
    s_add_u32 s21, s21, 131072
    buffer_load_dwordx4 v6, s[12:15], s21 offen lds
    s_add_u32 m0, s31, 109568
    s_add_u32 s21, s21, 131072
    buffer_load_dwordx4 v6, s[12:15], s21 offen lds
    v_add_u32 v25, 122880, v24
    v_xor_b32 v26, 32, v25
    s_waitcnt vmcnt(33)
    ds_read_b64_tr_b16 a[16:17], v25 offset:0
    ds_read_b64_tr_b16 a[18:19], v25 offset:256
    ds_read_b64_tr_b16 a[88:89], v26 offset:0
    ds_read_b64_tr_b16 a[90:91], v26 offset:256
    ds_read_b64_tr_b16 a[20:21], v25 offset:2048
    ds_read_b64_tr_b16 a[22:23], v25 offset:2304
    ds_read_b64_tr_b16 a[92:93], v26 offset:2048
    ds_read_b64_tr_b16 a[94:95], v26 offset:2304
    s_waitcnt lgkmcnt(0)
    v_mov_b32 v28, s95
    s_cmp_lg_u32 s95, 0
    s_cbranch_scc1 L_ne
    buffer_load_dword v28, off, s[96:99], 0 offset:64 sc1
L_ne:
    s_add_u32 s21, s28, 3145728
    s_add_u32 m0, s31, 122880
    s_nop 0
    buffer_load_dwordx4 v6, s[12:15], s21 offen lds
    s_add_u32 m0, s31, 123904
    s_add_u32 s21, s21, 131072
    buffer_load_dwordx4 v6, s[12:15], s21 offen lds
    s_add_u32 m0, s31, 124928
    s_add_u32 s21, s21, 131072
    buffer_load_dwordx4 v6, s[12:15], s21 offen lds
    s_add_u32 m0, s31, 125952
    s_add_u32 s21, s21, 131072
    buffer_load_dwordx4 v6, s[12:15], s21 offen lds
    v_add_u32 v25, 139264, v24
    v_xor_b32 v26, 32, v25
    s_waitcnt vmcnt(33)
    ds_read_b64_tr_b16 v[88:89], v25 offset:0
    ds_read_b64_tr_b16 v[90:91], v25 offset:256
    ds_read_b64_tr_b16 v[160:161], v26 offset:0
    ds_read_b64_tr_b16 v[162:163], v26 offset:256
    ds_read_b64_tr_b16 v[92:93], v25 offset:2048
    ds_read_b64_tr_b16 v[94:95], v25 offset:2304
    ds_read_b64_tr_b16 v[164:165], v26 offset:2048
    ds_read_b64_tr_b16 v[166:167], v26 offset:2304
    s_waitcnt lgkmcnt(0)
    s_add_u32 s21, s28, 3145984
    s_add_u32 m0, s31, 139264
    s_nop 0
    buffer_load_dwordx4 v6, s[12:15], s21 offen lds
    s_add_u32 m0, s31, 140288
    s_add_u32 s21, s21, 131072
    buffer_load_dwordx4 v6, s[12:15], s21 offen lds
    s_add_u32 m0, s31, 141312
    s_add_u32 s21, s21, 131072
    buffer_load_dwordx4 v6, s[12:15], s21 offen lds
    s_add_u32 m0, s31, 142336
    s_add_u32 s21, s21, 131072
    buffer_load_dwordx4 v6, s[12:15], s21 offen lds
    v_add_u32 v25, 40960, v24
    v_xor_b32 v26, 32, v25
    s_waitcnt vmcnt(24)
    ds_read_b64_tr_b16 a[24:25], v25 offset:0
    ds_read_b64_tr_b16 a[26:27], v25 offset:256
    ds_read_b64_tr_b16 a[96:97], v26 offset:0
    ds_read_b64_tr_b16 a[98:99], v26 offset:256
    ds_read_b64_tr_b16 a[28:29], v25 offset:2048
    ds_read_b64_tr_b16 a[30:31], v25 offset:2304
    ds_read_b64_tr_b16 a[100:101], v26 offset:2048
    ds_read_b64_tr_b16 a[102:103], v26 offset:2304
    s_waitcnt lgkmcnt(0)
    s_add_u32 s21, s28, 3670016
    s_add_u32 m0, s31, 40960
    s_nop 0
    buffer_load_dwordx4 v6, s[12:15], s21 offen lds
    s_add_u32 m0, s31, 41984
    s_add_u32 s21, s21, 131072
    buffer_load_dwordx4 v6, s[12:15], s21 offen lds
    s_add_u32 m0, s31, 43008
    s_add_u32 s21, s21, 131072
    buffer_load_dwordx4 v6, s[12:15], s21 offen lds
    s_add_u32 m0, s31, 44032
    s_add_u32 s21, s21, 131072
    buffer_load_dwordx4 v6, s[12:15], s21 offen lds
    v_add_u32 v25, 57344, v24
    v_xor_b32 v26, 32, v25
    s_waitcnt vmcnt(24)
    ds_read_b64_tr_b16 v[96:97], v25 offset:0
    ds_read_b64_tr_b16 v[98:99], v25 offset:256
    ds_read_b64_tr_b16 v[168:169], v26 offset:0
    ds_read_b64_tr_b16 v[170:171], v26 offset:256
    ds_read_b64_tr_b16 v[100:101], v25 offset:2048
    ds_read_b64_tr_b16 v[102:103], v25 offset:2304
    ds_read_b64_tr_b16 v[172:173], v26 offset:2048
    ds_read_b64_tr_b16 v[174:175], v26 offset:2304
    s_waitcnt lgkmcnt(0)
    s_add_u32 s21, s28, 3670272
    s_add_u32 m0, s31, 57344
    s_nop 0
    buffer_load_dwordx4 v6, s[12:15], s21 offen lds
    s_add_u32 m0, s31, 58368
    s_add_u32 s21, s21, 131072
    buffer_load_dwordx4 v6, s[12:15], s21 offen lds
    s_add_u32 m0, s31, 59392
    s_add_u32 s21, s21, 131072
    buffer_load_dwordx4 v6, s[12:15], s21 offen lds
    s_add_u32 m0, s31, 60416
    s_add_u32 s21, s21, 131072
    buffer_load_dwordx4 v6, s[12:15], s21 offen lds
    v_add_u32 v25, 73728, v24
    v_xor_b32 v26, 32, v25
    s_waitcnt vmcnt(24)
    ds_read_b64_tr_b16 a[32:33], v25 offset:0
    ds_read_b64_tr_b16 a[34:35], v25 offset:256
    ds_read_b64_tr_b16 a[104:105], v26 offset:0
    ds_read_b64_tr_b16 a[106:107], v26 offset:256
    ds_read_b64_tr_b16 a[36:37], v25 offset:2048
    ds_read_b64_tr_b16 a[38:39], v25 offset:2304
    ds_read_b64_tr_b16 a[108:109], v26 offset:2048
    ds_read_b64_tr_b16 a[110:111], v26 offset:2304
    s_waitcnt lgkmcnt(0)
    s_add_u32 s21, s28, 4194304
    s_add_u32 m0, s31, 73728
    s_nop 0
    buffer_load_dwordx4 v6, s[12:15], s21 offen lds
    s_add_u32 m0, s31, 74752
    s_add_u32 s21, s21, 131072
    buffer_load_dwordx4 v6, s[12:15], s21 offen lds
    s_add_u32 m0, s31, 75776
    s_add_u32 s21, s21, 131072
    buffer_load_dwordx4 v6, s[12:15], s21 offen lds
    s_add_u32 m0, s31, 76800
    s_add_u32 s21, s21, 131072
    buffer_load_dwordx4 v6, s[12:15], s21 offen lds
    v_add_u32 v25, 90112, v24
    v_xor_b32 v26, 32, v25
    s_waitcnt vmcnt(24)
    ds_read_b64_tr_b16 v[104:105], v25 offset:0
    ds_read_b64_tr_b16 v[106:107], v25 offset:256
    ds_read_b64_tr_b16 v[176:177], v26 offset:0
    ds_read_b64_tr_b16 v[178:179], v26 offset:256
    ds_read_b64_tr_b16 v[108:109], v25 offset:2048
    ds_read_b64_tr_b16 v[110:111], v25 offset:2304
    ds_read_b64_tr_b16 v[180:181], v26 offset:2048
    ds_read_b64_tr_b16 v[182:183], v26 offset:2304
    s_waitcnt lgkmcnt(0)
    s_add_u32 s21, s28, 4194560
    s_add_u32 m0, s31, 90112
    s_nop 0
    buffer_load_dwordx4 v6, s[12:15], s21 offen lds
    s_add_u32 m0, s31, 91136
    s_add_u32 s21, s21, 131072
    buffer_load_dwordx4 v6, s[12:15], s21 offen lds
    s_add_u32 m0, s31, 92160
    s_add_u32 s21, s21, 131072
    buffer_load_dwordx4 v6, s[12:15], s21 offen lds
    s_add_u32 m0, s31, 93184
    s_add_u32 s21, s21, 131072
    buffer_load_dwordx4 v6, s[12:15], s21 offen lds
    v_add_u32 v25, 106496, v24
    v_xor_b32 v26, 32, v25
    s_waitcnt vmcnt(24)
    ds_read_b64_tr_b16 a[40:41], v25 offset:0
    ds_read_b64_tr_b16 a[42:43], v25 offset:256
    ds_read_b64_tr_b16 a[112:113], v26 offset:0
    ds_read_b64_tr_b16 a[114:115], v26 offset:256
    ds_read_b64_tr_b16 a[44:45], v25 offset:2048
    ds_read_b64_tr_b16 a[46:47], v25 offset:2304
    ds_read_b64_tr_b16 a[116:117], v26 offset:2048
    ds_read_b64_tr_b16 a[118:119], v26 offset:2304
    s_waitcnt lgkmcnt(0)
    v_add_u32 v25, 122880, v24
    v_xor_b32 v26, 32, v25
    s_waitcnt vmcnt(20)
    ds_read_b64_tr_b16 v[112:113], v25 offset:0
    ds_read_b64_tr_b16 v[114:115], v25 offset:256
    ds_read_b64_tr_b16 v[184:185], v26 offset:0
    ds_read_b64_tr_b16 v[186:187], v26 offset:256
    ds_read_b64_tr_b16 v[116:117], v25 offset:2048
    ds_read_b64_tr_b16 v[118:119], v25 offset:2304
    ds_read_b64_tr_b16 v[188:189], v26 offset:2048
    ds_read_b64_tr_b16 v[190:191], v26 offset:2304
    s_waitcnt lgkmcnt(0)
    v_add_u32 v25, 139264, v24
    v_xor_b32 v26, 32, v25
    s_waitcnt vmcnt(16)
    ds_read_b64_tr_b16 a[48:49], v25 offset:0
    ds_read_b64_tr_b16 a[50:51], v25 offset:256
    ds_read_b64_tr_b16 a[120:121], v26 offset:0
    ds_read_b64_tr_b16 a[122:123], v26 offset:256
    ds_read_b64_tr_b16 a[52:53], v25 offset:2048
    ds_read_b64_tr_b16 a[54:55], v25 offset:2304
    ds_read_b64_tr_b16 a[124:125], v26 offset:2048
    ds_read_b64_tr_b16 a[126:127], v26 offset:2304
    s_waitcnt lgkmcnt(0)
    v_add_u32 v25, 40960, v24
    v_xor_b32 v26, 32, v25
    s_waitcnt vmcnt(12)
    ds_read_b64_tr_b16 v[120:121], v25 offset:0
    ds_read_b64_tr_b16 v[122:123], v25 offset:256
    ds_read_b64_tr_b16 v[192:193], v26 offset:0
    ds_read_b64_tr_b16 v[194:195], v26 offset:256
    ds_read_b64_tr_b16 v[124:125], v25 offset:2048
    ds_read_b64_tr_b16 v[126:127], v25 offset:2304
    ds_read_b64_tr_b16 v[196:197], v26 offset:2048
    ds_read_b64_tr_b16 v[198:199], v26 offset:2304
    s_waitcnt lgkmcnt(0)
    v_add_u32 v25, 57344, v24
    v_xor_b32 v26, 32, v25
    s_waitcnt vmcnt(8)
    ds_read_b64_tr_b16 a[56:57], v25 offset:0
    ds_read_b64_tr_b16 a[58:59], v25 offset:256
    ds_read_b64_tr_b16 a[128:129], v26 offset:0
    ds_read_b64_tr_b16 a[130:131], v26 offset:256
    ds_read_b64_tr_b16 a[60:61], v25 offset:2048
    ds_read_b64_tr_b16 a[62:63], v25 offset:2304
    ds_read_b64_tr_b16 a[132:133], v26 offset:2048
    ds_read_b64_tr_b16 a[134:135], v26 offset:2304
    s_waitcnt lgkmcnt(0)
    v_add_u32 v25, 73728, v24
    v_xor_b32 v26, 32, v25
    s_waitcnt vmcnt(4)
    ds_read_b64_tr_b16 v[128:129], v25 offset:0
    ds_read_b64_tr_b16 v[130:131], v25 offset:256
    ds_read_b64_tr_b16 v[200:201], v26 offset:0
    ds_read_b64_tr_b16 v[202:203], v26 offset:256
    ds_read_b64_tr_b16 v[132:133], v25 offset:2048
    ds_read_b64_tr_b16 v[134:135], v25 offset:2304
    ds_read_b64_tr_b16 v[204:205], v26 offset:2048
    ds_read_b64_tr_b16 v[206:207], v26 offset:2304
    s_waitcnt lgkmcnt(0)
    v_add_u32 v25, 90112, v24
    v_xor_b32 v26, 32, v25
    s_waitcnt vmcnt(0)
    ds_read_b64_tr_b16 a[64:65], v25 offset:0
    ds_read_b64_tr_b16 a[66:67], v25 offset:256
    ds_read_b64_tr_b16 a[136:137], v26 offset:0
    ds_read_b64_tr_b16 a[138:139], v26 offset:256
    ds_read_b64_tr_b16 a[68:69], v25 offset:2048
    ds_read_b64_tr_b16 a[70:71], v25 offset:2304
    ds_read_b64_tr_b16 a[140:141], v26 offset:2048
    ds_read_b64_tr_b16 a[142:143], v26 offset:2304
    s_waitcnt lgkmcnt(0)
    v_readfirstlane_b32 s95, v28
    s_nop 4
    s_mov_b32 s88, 4194304
gn7:
    s_cmp_lg_u32 s95, 0
    s_cbranch_scc1 gn7x
    buffer_load_dword v25, off, s[96:99], 0 offset:64 sc1
    s_sub_u32 s88, s88, 1
    s_cbranch_scc1 gn7x
    s_waitcnt vmcnt(0)
    v_readfirstlane_b32 s95, v25
    s_nop 1
    s_branch gn7
gn7x:
    s_barrier
    s_mov_b32 s27, 36864
    s_add_u32 s23, s27, s25
    s_add_u32 m0, s23, 0
    s_nop 0
    buffer_load_dwordx4 v2, s[8:11], s24 offen offset:0 lds
    s_add_u32 m0, s23, 960
    s_nop 0
    buffer_load_dwordx4 v2, s[8:11], s24 offen offset:64 lds
    s_add_u32 m0, s23, 1920
    s_nop 0
    buffer_load_dwordx4 v2, s[8:11], s24 offen offset:128 lds
    s_add_u32 m0, s23, 2880
    s_nop 0
    buffer_load_dwordx4 v2, s[8:11], s24 offen offset:192 lds
    s_add_u32 m0, s23, 3840
    s_nop 0
    buffer_load_dwordx4 v2, s[8:11], s24 offen offset:256 lds
    s_add_u32 m0, s23, 4800
    s_nop 0
    buffer_load_dwordx4 v2, s[8:11], s24 offen offset:320 lds
    s_add_u32 m0, s23, 5760
    s_nop 0
    buffer_load_dwordx4 v2, s[8:11], s24 offen offset:384 lds
    s_add_u32 m0, s23, 6720
    s_nop 0
    buffer_load_dwordx4 v2, s[8:11], s24 offen offset:448 lds
    s_add_u32 m0, s23, 7680
    s_nop 0
    buffer_load_dwordx4 v2, s[8:11], s24 offen offset:512 lds
    s_add_u32 s24, s24, s42
    s_mov_b32 s27, 0
    s_mov_b32 s30, s95
    s_cmp_eq_u32 s18, 0
    s_cselect_b32 s34, 1, 0
    s_mov_b32 s35, 0
    s_cmp_eq_u32 s16, 2
    s_cbranch_scc1 qk_vloop
qk_loop:
    s_barrier
    v_add_u32 v3, s27, v1
    ds_read_b128 v[32:35], v3 offset:0
    ds_read_b128 v[36:39], v3 offset:18432
    ds_read_b128 v[40:43], v3 offset:1024
    ds_read_b128 v[44:47], v3 offset:19456
    ds_read_b128 v[48:51], v3 offset:2048
    ds_read_b128 v[52:55], v3 offset:20480
    s_sub_u32 s22, s30, 1
    v_mov_b32 v4, s22
    s_mov_b64 exec, s[34:35]
    buffer_store_dword v4, off, s[4:7], s29 sc1
    s_mov_b64 exec, -1
    s_add_u32 s22, s27, 73728
    s_sub_u32 s21, s22, 110592
    s_cselect_b32 s22, s22, s21
    ds_read_b128 v[56:59], v3 offset:3072
    ds_read_b128 v[60:63], v3 offset:21504
    s_add_u32 s23, s22, s25
    s_add_u32 m0, s23, 0
    s_nop 0
    buffer_load_dwordx4 v2, s[8:11], s24 offen offset:0 lds
    s_waitcnt lgkmcnt(6)
    v_mfma_f32_16x16x32_bf16 v[208:211], v[64:67], v[32:35], 0
    v_mfma_f32_16x16x32_bf16 v[212:215], v[136:139], v[32:35], 0
    v_mfma_f32_16x16x32_bf16 v[216:219], v[64:67], v[36:39], 0
    v_mfma_f32_16x16x32_bf16 v[220:223], v[136:139], v[36:39], 0
    v_mfma_f32_16x16x32_bf16 v[224:227], a[0:3], v[32:35], 0
    v_mfma_f32_16x16x32_bf16 v[228:231], a[72:75], v[32:35], 0
    v_mfma_f32_16x16x32_bf16 v[232:235], a[0:3], v[36:39], 0
    v_mfma_f32_16x16x32_bf16 v[236:239], a[72:75], v[36:39], 0
    ds_read_b128 v[32:35], v3 offset:4096
    ds_read_b128 v[36:39], v3 offset:22528
    s_add_u32 m0, s23, 960
    s_nop 0
    buffer_load_dwordx4 v2, s[8:11], s24 offen offset:64 lds
    s_waitcnt lgkmcnt(6)
    v_mfma_f32_16x16x32_bf16 v[208:211], v[68:71], v[40:43], v[208:211]
    v_mfma_f32_16x16x32_bf16 v[212:215], v[140:143], v[40:43], v[212:215]
    v_mfma_f32_16x16x32_bf16 v[216:219], v[68:71], v[44:47], v[216:219]
    v_mfma_f32_16x16x32_bf16 v[220:223], v[140:143], v[44:47], v[220:223]
    v_mfma_f32_16x16x32_bf16 v[224:227], a[4:7], v[40:43], v[224:227]
    v_mfma_f32_16x16x32_bf16 v[228:231], a[76:79], v[40:43], v[228:231]
    v_mfma_f32_16x16x32_bf16 v[232:235], a[4:7], v[44:47], v[232:235]
    v_mfma_f32_16x16x32_bf16 v[236:239], a[76:79], v[44:47], v[236:239]
    ds_read_b128 v[40:43], v3 offset:5120
    ds_read_b128 v[44:47], v3 offset:23552
    s_add_u32 m0, s23, 1920
    s_nop 0
    buffer_load_dwordx4 v2, s[8:11], s24 offen offset:128 lds
    s_waitcnt lgkmcnt(6)
    v_mfma_f32_16x16x32_bf16 v[208:211], v[72:75], v[48:51], v[208:211]
    v_mfma_f32_16x16x32_bf16 v[212:215], v[144:147], v[48:51], v[212:215]
    v_mfma_f32_16x16x32_bf16 v[216:219], v[72:75], v[52:55], v[216:219]
    v_mfma_f32_16x16x32_bf16 v[220:223], v[144:147], v[52:55], v[220:223]
    v_mfma_f32_16x16x32_bf16 v[224:227], a[8:11], v[48:51], v[224:227]
    v_mfma_f32_16x16x32_bf16 v[228:231], a[80:83], v[48:51], v[228:231]
    v_mfma_f32_16x16x32_bf16 v[232:235], a[8:11], v[52:55], v[232:235]
    v_mfma_f32_16x16x32_bf16 v[236:239], a[80:83], v[52:55], v[236:239]
    ds_read_b128 v[48:51], v3 offset:6144
    ds_read_b128 v[52:55], v3 offset:24576
    s_add_u32 m0, s23, 2880
    s_nop 0
    buffer_load_dwordx4 v2, s[8:11], s24 offen offset:192 lds
    s_waitcnt lgkmcnt(6)
    v_mfma_f32_16x16x32_bf16 v[208:211], v[76:79], v[56:59], v[208:211]
    v_mfma_f32_16x16x32_bf16 v[212:215], v[148:151], v[56:59], v[212:215]
    v_mfma_f32_16x16x32_bf16 v[216:219], v[76:79], v[60:63], v[216:219]
    v_mfma_f32_16x16x32_bf16 v[220:223], v[148:151], v[60:63], v[220:223]
    v_mfma_f32_16x16x32_bf16 v[224:227], a[12:15], v[56:59], v[224:227]
    v_mfma_f32_16x16x32_bf16 v[228:231], a[84:87], v[56:59], v[228:231]
    v_mfma_f32_16x16x32_bf16 v[232:235], a[12:15], v[60:63], v[232:235]
    v_mfma_f32_16x16x32_bf16 v[236:239], a[84:87], v[60:63], v[236:239]
    ds_read_b128 v[56:59], v3 offset:7168
    ds_read_b128 v[60:63], v3 offset:25600
    s_add_u32 m0, s23, 3840
    s_nop 0
    buffer_load_dwordx4 v2, s[8:11], s24 offen offset:256 lds
    s_waitcnt lgkmcnt(6)
    v_mfma_f32_16x16x32_bf16 v[208:211], v[80:83], v[32:35], v[208:211]
    v_mfma_f32_16x16x32_bf16 v[212:215], v[152:155], v[32:35], v[212:215]
    v_mfma_f32_16x16x32_bf16 v[216:219], v[80:83], v[36:39], v[216:219]
    v_mfma_f32_16x16x32_bf16 v[220:223], v[152:155], v[36:39], v[220:223]
    v_mfma_f32_16x16x32_bf16 v[224:227], a[16:19], v[32:35], v[224:227]
    v_mfma_f32_16x16x32_bf16 v[228:231], a[88:91], v[32:35], v[228:231]
    v_mfma_f32_16x16x32_bf16 v[232:235], a[16:19], v[36:39], v[232:235]
    v_mfma_f32_16x16x32_bf16 v[236:239], a[88:91], v[36:39], v[236:239]
    ds_read_b128 v[32:35], v3 offset:8192
    ds_read_b128 v[36:39], v3 offset:26624
    s_add_u32 m0, s23, 4800
    s_nop 0
    buffer_load_dwordx4 v2, s[8:11], s24 offen offset:320 lds
    s_waitcnt lgkmcnt(6)
    v_mfma_f32_16x16x32_bf16 v[208:211], v[84:87], v[40:43], v[208:211]
    v_mfma_f32_16x16x32_bf16 v[212:215], v[156:159], v[40:43], v[212:215]
    v_mfma_f32_16x16x32_bf16 v[216:219], v[84:87], v[44:47], v[216:219]
    v_mfma_f32_16x16x32_bf16 v[220:223], v[156:159], v[44:47], v[220:223]
    v_mfma_f32_16x16x32_bf16 v[224:227], a[20:23], v[40:43], v[224:227]
    v_mfma_f32_16x16x32_bf16 v[228:231], a[92:95], v[40:43], v[228:231]
    v_mfma_f32_16x16x32_bf16 v[232:235], a[20:23], v[44:47], v[232:235]
    v_mfma_f32_16x16x32_bf16 v[236:239], a[92:95], v[44:47], v[236:239]
    ds_read_b128 v[40:43], v3 offset:9216
    ds_read_b128 v[44:47], v3 offset:27648
    s_add_u32 m0, s23, 5760
    s_nop 0
    buffer_load_dwordx4 v2, s[8:11], s24 offen offset:384 lds
    s_waitcnt lgkmcnt(6)
    v_mfma_f32_16x16x32_bf16 v[208:211], v[88:91], v[48:51], v[208:211]
    v_mfma_f32_16x16x32_bf16 v[212:215], v[160:163], v[48:51], v[212:215]
    v_mfma_f32_16x16x32_bf16 v[216:219], v[88:91], v[52:55], v[216:219]
    v_mfma_f32_16x16x32_bf16 v[220:223], v[160:163], v[52:55], v[220:223]
    v_mfma_f32_16x16x32_bf16 v[224:227], a[24:27], v[48:51], v[224:227]
    v_mfma_f32_16x16x32_bf16 v[228:231], a[96:99], v[48:51], v[228:231]
    v_mfma_f32_16x16x32_bf16 v[232:235], a[24:27], v[52:55], v[232:235]
    v_mfma_f32_16x16x32_bf16 v[236:239], a[96:99], v[52:55], v[236:239]
    ds_read_b128 v[48:51], v3 offset:10240
    ds_read_b128 v[52:55], v3 offset:28672
    s_add_u32 m0, s23, 6720
    s_nop 0
    buffer_load_dwordx4 v2, s[8:11], s24 offen offset:448 lds
    s_waitcnt lgkmcnt(6)
    v_mfma_f32_16x16x32_bf16 v[208:211], v[92:95], v[56:59], v[208:211]
    v_mfma_f32_16x16x32_bf16 v[212:215], v[164:167], v[56:59], v[212:215]
    v_mfma_f32_16x16x32_bf16 v[216:219], v[92:95], v[60:63], v[216:219]
    v_mfma_f32_16x16x32_bf16 v[220:223], v[164:167], v[60:63], v[220:223]
    v_mfma_f32_16x16x32_bf16 v[224:227], a[28:31], v[56:59], v[224:227]
    v_mfma_f32_16x16x32_bf16 v[228:231], a[100:103], v[56:59], v[228:231]
    v_mfma_f32_16x16x32_bf16 v[232:235], a[28:31], v[60:63], v[232:235]
    v_mfma_f32_16x16x32_bf16 v[236:239], a[100:103], v[60:63], v[236:239]
    ds_read_b128 v[56:59], v3 offset:11264
    ds_read_b128 v[60:63], v3 offset:29696
    s_add_u32 m0, s23, 7680
    s_nop 0
    buffer_load_dwordx4 v2, s[8:11], s24 offen offset:512 lds
    s_add_u32 s24, s24, s42
    s_waitcnt lgkmcnt(6)
    v_mfma_f32_16x16x32_bf16 v[208:211], v[96:99], v[32:35], v[208:211]
    v_mfma_f32_16x16x32_bf16 v[212:215], v[168:171], v[32:35], v[212:215]
    v_mfma_f32_16x16x32_bf16 v[216:219], v[96:99], v[36:39], v[216:219]
    v_mfma_f32_16x16x32_bf16 v[220:223], v[168:171], v[36:39], v[220:223]
    v_mfma_f32_16x16x32_bf16 v[224:227], a[32:35], v[32:35], v[224:227]
    v_mfma_f32_16x16x32_bf16 v[228:231], a[104:107], v[32:35], v[228:231]
    v_mfma_f32_16x16x32_bf16 v[232:235], a[32:35], v[36:39], v[232:235]
    v_mfma_f32_16x16x32_bf16 v[236:239], a[104:107], v[36:39], v[236:239]
    ds_read_b128 v[32:35], v3 offset:12288
    ds_read_b128 v[36:39], v3 offset:30720
    s_waitcnt lgkmcnt(6)
    v_mfma_f32_16x16x32_bf16 v[208:211], v[100:103], v[40:43], v[208:211]
    v_mfma_f32_16x16x32_bf16 v[212:215], v[172:175], v[40:43], v[212:215]
    v_mfma_f32_16x16x32_bf16 v[216:219], v[100:103], v[44:47], v[216:219]
    v_mfma_f32_16x16x32_bf16 v[220:223], v[172:175], v[44:47], v[220:223]
    v_mfma_f32_16x16x32_bf16 v[224:227], a[36:39], v[40:43], v[224:227]
    v_mfma_f32_16x16x32_bf16 v[228:231], a[108:111], v[40:43], v[228:231]
    v_mfma_f32_16x16x32_bf16 v[232:235], a[36:39], v[44:47], v[232:235]
    v_mfma_f32_16x16x32_bf16 v[236:239], a[108:111], v[44:47], v[236:239]
    ds_read_b128 v[40:43], v3 offset:13312
    ds_read_b128 v[44:47], v3 offset:31744
    s_waitcnt lgkmcnt(6)
    v_mfma_f32_16x16x32_bf16 v[208:211], v[104:107], v[48:51], v[208:211]
    v_mfma_f32_16x16x32_bf16 v[212:215], v[176:179], v[48:51], v[212:215]
    v_mfma_f32_16x16x32_bf16 v[216:219], v[104:107], v[52:55], v[216:219]
    v_mfma_f32_16x16x32_bf16 v[220:223], v[176:179], v[52:55], v[220:223]
    v_mfma_f32_16x16x32_bf16 v[224:227], a[40:43], v[48:51], v[224:227]
    v_mfma_f32_16x16x32_bf16 v[228:231], a[112:115], v[48:51], v[228:231]
    v_mfma_f32_16x16x32_bf16 v[232:235], a[40:43], v[52:55], v[232:235]
    v_mfma_f32_16x16x32_bf16 v[236:239], a[112:115], v[52:55], v[236:239]
    ds_read_b128 v[48:51], v3 offset:14336
    ds_read_b128 v[52:55], v3 offset:32768
    s_waitcnt lgkmcnt(6)
    v_mfma_f32_16x16x32_bf16 v[208:211], v[108:111], v[56:59], v[208:211]
    v_mfma_f32_16x16x32_bf16 v[212:215], v[180:183], v[56:59], v[212:215]
    v_mfma_f32_16x16x32_bf16 v[216:219], v[108:111], v[60:63], v[216:219]
    v_mfma_f32_16x16x32_bf16 v[220:223], v[180:183], v[60:63], v[220:223]
    v_mfma_f32_16x16x32_bf16 v[224:227], a[44:47], v[56:59], v[224:227]
    v_mfma_f32_16x16x32_bf16 v[228:231], a[116:119], v[56:59], v[228:231]
    v_mfma_f32_16x16x32_bf16 v[232:235], a[44:47], v[60:63], v[232:235]
    v_mfma_f32_16x16x32_bf16 v[236:239], a[116:119], v[60:63], v[236:239]
    ds_read_b128 v[56:59], v3 offset:15360
    ds_read_b128 v[60:63], v3 offset:33792
    s_waitcnt lgkmcnt(6)
    v_mfma_f32_16x16x32_bf16 v[208:211], v[112:115], v[32:35], v[208:211]
    v_mfma_f32_16x16x32_bf16 v[212:215], v[184:187], v[32:35], v[212:215]
    v_mfma_f32_16x16x32_bf16 v[216:219], v[112:115], v[36:39], v[216:219]
    v_mfma_f32_16x16x32_bf16 v[220:223], v[184:187], v[36:39], v[220:223]
    v_mfma_f32_16x16x32_bf16 v[224:227], a[48:51], v[32:35], v[224:227]
    v_mfma_f32_16x16x32_bf16 v[228:231], a[120:123], v[32:35], v[228:231]
    v_mfma_f32_16x16x32_bf16 v[232:235], a[48:51], v[36:39], v[232:235]
    v_mfma_f32_16x16x32_bf16 v[236:239], a[120:123], v[36:39], v[236:239]
    ds_read_b128 v[32:35], v3 offset:16384
    ds_read_b128 v[36:39], v3 offset:34816
    s_waitcnt lgkmcnt(6)
    v_mfma_f32_16x16x32_bf16 v[208:211], v[116:119], v[40:43], v[208:211]
    v_mfma_f32_16x16x32_bf16 v[212:215], v[188:191], v[40:43], v[212:215]
    v_mfma_f32_16x16x32_bf16 v[216:219], v[116:119], v[44:47], v[216:219]
    v_mfma_f32_16x16x32_bf16 v[220:223], v[188:191], v[44:47], v[220:223]
    v_mfma_f32_16x16x32_bf16 v[224:227], a[52:55], v[40:43], v[224:227]
    v_mfma_f32_16x16x32_bf16 v[228:231], a[124:127], v[40:43], v[228:231]
    v_mfma_f32_16x16x32_bf16 v[232:235], a[52:55], v[44:47], v[232:235]
    v_mfma_f32_16x16x32_bf16 v[236:239], a[124:127], v[44:47], v[236:239]
    ds_read_b128 v[40:43], v3 offset:17408
    ds_read_b128 v[44:47], v3 offset:35840
    s_waitcnt lgkmcnt(6)
    v_mfma_f32_16x16x32_bf16 v[208:211], v[120:123], v[48:51], v[208:211]
    v_mfma_f32_16x16x32_bf16 v[212:215], v[192:195], v[48:51], v[212:215]
    v_mfma_f32_16x16x32_bf16 v[216:219], v[120:123], v[52:55], v[216:219]
    v_mfma_f32_16x16x32_bf16 v[220:223], v[192:195], v[52:55], v[220:223]
    v_mfma_f32_16x16x32_bf16 v[224:227], a[56:59], v[48:51], v[224:227]
    v_mfma_f32_16x16x32_bf16 v[228:231], a[128:131], v[48:51], v[228:231]
    v_mfma_f32_16x16x32_bf16 v[232:235], a[56:59], v[52:55], v[232:235]
    v_mfma_f32_16x16x32_bf16 v[236:239], a[128:131], v[52:55], v[236:239]
    s_waitcnt lgkmcnt(4)
    v_mfma_f32_16x16x32_bf16 v[208:211], v[124:127], v[56:59], v[208:211]
    v_mfma_f32_16x16x32_bf16 v[212:215], v[196:199], v[56:59], v[212:215]
    v_mfma_f32_16x16x32_bf16 v[216:219], v[124:127], v[60:63], v[216:219]
    v_mfma_f32_16x16x32_bf16 v[220:223], v[196:199], v[60:63], v[220:223]
    v_mfma_f32_16x16x32_bf16 v[224:227], a[60:63], v[56:59], v[224:227]
    v_mfma_f32_16x16x32_bf16 v[228:231], a[132:135], v[56:59], v[228:231]
    v_mfma_f32_16x16x32_bf16 v[232:235], a[60:63], v[60:63], v[232:235]
    v_mfma_f32_16x16x32_bf16 v[236:239], a[132:135], v[60:63], v[236:239]
    s_waitcnt lgkmcnt(2)
    v_mfma_f32_16x16x32_bf16 v[208:211], v[128:131], v[32:35], v[208:211]
    v_mfma_f32_16x16x32_bf16 v[212:215], v[200:203], v[32:35], v[212:215]
    v_mfma_f32_16x16x32_bf16 v[216:219], v[128:131], v[36:39], v[216:219]
    v_mfma_f32_16x16x32_bf16 v[220:223], v[200:203], v[36:39], v[220:223]
    v_mfma_f32_16x16x32_bf16 v[224:227], a[64:67], v[32:35], v[224:227]
    v_mfma_f32_16x16x32_bf16 v[228:231], a[136:139], v[32:35], v[228:231]
    v_mfma_f32_16x16x32_bf16 v[232:235], a[64:67], v[36:39], v[232:235]
    v_mfma_f32_16x16x32_bf16 v[236:239], a[136:139], v[36:39], v[236:239]
    s_waitcnt lgkmcnt(0)
    v_mfma_f32_16x16x32_bf16 v[208:211], v[132:135], v[40:43], v[208:211]
    v_mfma_f32_16x16x32_bf16 v[212:215], v[204:207], v[40:43], v[212:215]
    v_mfma_f32_16x16x32_bf16 v[216:219], v[132:135], v[44:47], v[216:219]
    v_mfma_f32_16x16x32_bf16 v[220:223], v[204:207], v[44:47], v[220:223]
    v_mfma_f32_16x16x32_bf16 v[224:227], a[68:71], v[40:43], v[224:227]
    v_mfma_f32_16x16x32_bf16 v[228:231], a[140:143], v[40:43], v[228:231]
    v_mfma_f32_16x16x32_bf16 v[232:235], a[68:71], v[44:47], v[232:235]
    v_mfma_f32_16x16x32_bf16 v[236:239], a[140:143], v[44:47], v[236:239]
    s_waitcnt vmcnt(9)
    v_cvt_pk_bf16_f32 v8, v208, v209
    v_cvt_pk_bf16_f32 v9, v210, v211
    v_cvt_pk_bf16_f32 v10, v212, v213
    v_cvt_pk_bf16_f32 v11, v214, v215
    s_mov_b32 s28, s26
    buffer_store_dwordx4 v[8:11], v7, s[4:7], s28 offen sc1
    v_cvt_pk_bf16_f32 v12, v216, v217
    v_cvt_pk_bf16_f32 v13, v218, v219
    v_cvt_pk_bf16_f32 v14, v220, v221
    v_cvt_pk_bf16_f32 v15, v222, v223
    s_add_u32 s28, s28, s40
    buffer_store_dwordx4 v[12:15], v7, s[4:7], s28 offen sc1
    v_cvt_pk_bf16_f32 v16, v224, v225
    v_cvt_pk_bf16_f32 v17, v226, v227
    v_cvt_pk_bf16_f32 v18, v228, v229
    v_cvt_pk_bf16_f32 v19, v230, v231
    s_add_u32 s28, s26, s43
    buffer_store_dwordx4 v[16:19], v7, s[4:7], s28 offen sc1
    v_cvt_pk_bf16_f32 v20, v232, v233
    v_cvt_pk_bf16_f32 v21, v234, v235
    v_cvt_pk_bf16_f32 v22, v236, v237
    v_cvt_pk_bf16_f32 v23, v238, v239
    s_add_u32 s28, s28, s40
    buffer_store_dwordx4 v[20:23], v7, s[4:7], s28 offen sc1
    s_add_u32 s26, s26, s41
    s_add_u32 s27, s27, 36864
    s_cmp_eq_u32 s27, 110592
    s_cselect_b32 s27, 0, s27
    s_add_u32 s30, s30, 1
    s_add_u32 s19, s19, s20
    s_cmp_lt_u32 s19, 64
    s_cbranch_scc1 qk_loop
    s_branch qk_done
qk_vloop:
    s_barrier
    v_add_u32 v3, s27, v1
    ds_read_b128 v[32:35], v3 offset:0
    ds_read_b128 v[36:39], v3 offset:18432
    ds_read_b128 v[40:43], v3 offset:1024
    ds_read_b128 v[44:47], v3 offset:19456
    ds_read_b128 v[48:51], v3 offset:2048
    ds_read_b128 v[52:55], v3 offset:20480
    s_sub_u32 s22, s30, 1
    v_mov_b32 v4, s22
    s_mov_b64 exec, s[34:35]
    buffer_store_dword v4, off, s[4:7], s29 sc1
    s_mov_b64 exec, -1
    s_add_u32 s22, s27, 73728
    s_sub_u32 s21, s22, 110592
    s_cselect_b32 s22, s22, s21
    ds_read_b128 v[56:59], v3 offset:3072
    ds_read_b128 v[60:63], v3 offset:21504
    s_add_u32 s23, s22, s25
    s_add_u32 m0, s23, 0
    s_nop 0
    buffer_load_dwordx4 v2, s[8:11], s24 offen offset:0 lds
    s_waitcnt lgkmcnt(6)
    v_mfma_f32_16x16x32_bf16 v[208:211], v[32:35], v[64:67], 0
    v_mfma_f32_16x16x32_bf16 v[212:215], v[32:35], v[136:139], 0
    v_mfma_f32_16x16x32_bf16 v[216:219], v[36:39], v[64:67], 0
    v_mfma_f32_16x16x32_bf16 v[220:223], v[36:39], v[136:139], 0
    v_mfma_f32_16x16x32_bf16 v[224:227], v[32:35], a[0:3], 0
    v_mfma_f32_16x16x32_bf16 v[228:231], v[32:35], a[72:75], 0
    v_mfma_f32_16x16x32_bf16 v[232:235], v[36:39], a[0:3], 0
    v_mfma_f32_16x16x32_bf16 v[236:239], v[36:39], a[72:75], 0
    ds_read_b128 v[32:35], v3 offset:4096
    ds_read_b128 v[36:39], v3 offset:22528
    s_add_u32 m0, s23, 960
    s_nop 0
    buffer_load_dwordx4 v2, s[8:11], s24 offen offset:64 lds
    s_waitcnt lgkmcnt(6)
    v_mfma_f32_16x16x32_bf16 v[208:211], v[40:43], v[68:71], v[208:211]
    v_mfma_f32_16x16x32_bf16 v[212:215], v[40:43], v[140:143], v[212:215]
    v_mfma_f32_16x16x32_bf16 v[216:219], v[44:47], v[68:71], v[216:219]
    v_mfma_f32_16x16x32_bf16 v[220:223], v[44:47], v[140:143], v[220:223]
    v_mfma_f32_16x16x32_bf16 v[224:227], v[40:43], a[4:7], v[224:227]
    v_mfma_f32_16x16x32_bf16 v[228:231], v[40:43], a[76:79], v[228:231]
    v_mfma_f32_16x16x32_bf16 v[232:235], v[44:47], a[4:7], v[232:235]
    v_mfma_f32_16x16x32_bf16 v[236:239], v[44:47], a[76:79], v[236:239]
    ds_read_b128 v[40:43], v3 offset:5120
    ds_read_b128 v[44:47], v3 offset:23552
    s_add_u32 m0, s23, 1920
    s_nop 0
    buffer_load_dwordx4 v2, s[8:11], s24 offen offset:128 lds
    s_waitcnt lgkmcnt(6)
    v_mfma_f32_16x16x32_bf16 v[208:211], v[48:51], v[72:75], v[208:211]
    v_mfma_f32_16x16x32_bf16 v[212:215], v[48:51], v[144:147], v[212:215]
    v_mfma_f32_16x16x32_bf16 v[216:219], v[52:55], v[72:75], v[216:219]
    v_mfma_f32_16x16x32_bf16 v[220:223], v[52:55], v[144:147], v[220:223]
    v_mfma_f32_16x16x32_bf16 v[224:227], v[48:51], a[8:11], v[224:227]
    v_mfma_f32_16x16x32_bf16 v[228:231], v[48:51], a[80:83], v[228:231]
    v_mfma_f32_16x16x32_bf16 v[232:235], v[52:55], a[8:11], v[232:235]
    v_mfma_f32_16x16x32_bf16 v[236:239], v[52:55], a[80:83], v[236:239]
    ds_read_b128 v[48:51], v3 offset:6144
    ds_read_b128 v[52:55], v3 offset:24576
    s_add_u32 m0, s23, 2880
    s_nop 0
    buffer_load_dwordx4 v2, s[8:11], s24 offen offset:192 lds
    s_waitcnt lgkmcnt(6)
    v_mfma_f32_16x16x32_bf16 v[208:211], v[56:59], v[76:79], v[208:211]
    v_mfma_f32_16x16x32_bf16 v[212:215], v[56:59], v[148:151], v[212:215]
    v_mfma_f32_16x16x32_bf16 v[216:219], v[60:63], v[76:79], v[216:219]
    v_mfma_f32_16x16x32_bf16 v[220:223], v[60:63], v[148:151], v[220:223]
    v_mfma_f32_16x16x32_bf16 v[224:227], v[56:59], a[12:15], v[224:227]
    v_mfma_f32_16x16x32_bf16 v[228:231], v[56:59], a[84:87], v[228:231]
    v_mfma_f32_16x16x32_bf16 v[232:235], v[60:63], a[12:15], v[232:235]
    v_mfma_f32_16x16x32_bf16 v[236:239], v[60:63], a[84:87], v[236:239]
    ds_read_b128 v[56:59], v3 offset:7168
    ds_read_b128 v[60:63], v3 offset:25600
    s_add_u32 m0, s23, 3840
    s_nop 0
    buffer_load_dwordx4 v2, s[8:11], s24 offen offset:256 lds
    s_waitcnt lgkmcnt(6)
    v_mfma_f32_16x16x32_bf16 v[208:211], v[32:35], v[80:83], v[208:211]
    v_mfma_f32_16x16x32_bf16 v[212:215], v[32:35], v[152:155], v[212:215]
    v_mfma_f32_16x16x32_bf16 v[216:219], v[36:39], v[80:83], v[216:219]
    v_mfma_f32_16x16x32_bf16 v[220:223], v[36:39], v[152:155], v[220:223]
    v_mfma_f32_16x16x32_bf16 v[224:227], v[32:35], a[16:19], v[224:227]
    v_mfma_f32_16x16x32_bf16 v[228:231], v[32:35], a[88:91], v[228:231]
    v_mfma_f32_16x16x32_bf16 v[232:235], v[36:39], a[16:19], v[232:235]
    v_mfma_f32_16x16x32_bf16 v[236:239], v[36:39], a[88:91], v[236:239]
    ds_read_b128 v[32:35], v3 offset:8192
    ds_read_b128 v[36:39], v3 offset:26624
    s_add_u32 m0, s23, 4800
    s_nop 0
    buffer_load_dwordx4 v2, s[8:11], s24 offen offset:320 lds
    s_waitcnt lgkmcnt(6)
    v_mfma_f32_16x16x32_bf16 v[208:211], v[40:43], v[84:87], v[208:211]
    v_mfma_f32_16x16x32_bf16 v[212:215], v[40:43], v[156:159], v[212:215]
    v_mfma_f32_16x16x32_bf16 v[216:219], v[44:47], v[84:87], v[216:219]
    v_mfma_f32_16x16x32_bf16 v[220:223], v[44:47], v[156:159], v[220:223]
    v_mfma_f32_16x16x32_bf16 v[224:227], v[40:43], a[20:23], v[224:227]
    v_mfma_f32_16x16x32_bf16 v[228:231], v[40:43], a[92:95], v[228:231]
    v_mfma_f32_16x16x32_bf16 v[232:235], v[44:47], a[20:23], v[232:235]
    v_mfma_f32_16x16x32_bf16 v[236:239], v[44:47], a[92:95], v[236:239]
    ds_read_b128 v[40:43], v3 offset:9216
    ds_read_b128 v[44:47], v3 offset:27648
    s_add_u32 m0, s23, 5760
    s_nop 0
    buffer_load_dwordx4 v2, s[8:11], s24 offen offset:384 lds
    s_waitcnt lgkmcnt(6)
    v_mfma_f32_16x16x32_bf16 v[208:211], v[48:51], v[88:91], v[208:211]
    v_mfma_f32_16x16x32_bf16 v[212:215], v[48:51], v[160:163], v[212:215]
    v_mfma_f32_16x16x32_bf16 v[216:219], v[52:55], v[88:91], v[216:219]
    v_mfma_f32_16x16x32_bf16 v[220:223], v[52:55], v[160:163], v[220:223]
    v_mfma_f32_16x16x32_bf16 v[224:227], v[48:51], a[24:27], v[224:227]
    v_mfma_f32_16x16x32_bf16 v[228:231], v[48:51], a[96:99], v[228:231]
    v_mfma_f32_16x16x32_bf16 v[232:235], v[52:55], a[24:27], v[232:235]
    v_mfma_f32_16x16x32_bf16 v[236:239], v[52:55], a[96:99], v[236:239]
    ds_read_b128 v[48:51], v3 offset:10240
    ds_read_b128 v[52:55], v3 offset:28672
    s_add_u32 m0, s23, 6720
    s_nop 0
    buffer_load_dwordx4 v2, s[8:11], s24 offen offset:448 lds
    s_waitcnt lgkmcnt(6)
    v_mfma_f32_16x16x32_bf16 v[208:211], v[56:59], v[92:95], v[208:211]
    v_mfma_f32_16x16x32_bf16 v[212:215], v[56:59], v[164:167], v[212:215]
    v_mfma_f32_16x16x32_bf16 v[216:219], v[60:63], v[92:95], v[216:219]
    v_mfma_f32_16x16x32_bf16 v[220:223], v[60:63], v[164:167], v[220:223]
    v_mfma_f32_16x16x32_bf16 v[224:227], v[56:59], a[28:31], v[224:227]
    v_mfma_f32_16x16x32_bf16 v[228:231], v[56:59], a[100:103], v[228:231]
    v_mfma_f32_16x16x32_bf16 v[232:235], v[60:63], a[28:31], v[232:235]
    v_mfma_f32_16x16x32_bf16 v[236:239], v[60:63], a[100:103], v[236:239]
    ds_read_b128 v[56:59], v3 offset:11264
    ds_read_b128 v[60:63], v3 offset:29696
    s_add_u32 m0, s23, 7680
    s_nop 0
    buffer_load_dwordx4 v2, s[8:11], s24 offen offset:512 lds
    s_add_u32 s24, s24, s42
    s_waitcnt lgkmcnt(6)
    v_mfma_f32_16x16x32_bf16 v[208:211], v[32:35], v[96:99], v[208:211]
    v_mfma_f32_16x16x32_bf16 v[212:215], v[32:35], v[168:171], v[212:215]
    v_mfma_f32_16x16x32_bf16 v[216:219], v[36:39], v[96:99], v[216:219]
    v_mfma_f32_16x16x32_bf16 v[220:223], v[36:39], v[168:171], v[220:223]
    v_mfma_f32_16x16x32_bf16 v[224:227], v[32:35], a[32:35], v[224:227]
    v_mfma_f32_16x16x32_bf16 v[228:231], v[32:35], a[104:107], v[228:231]
    v_mfma_f32_16x16x32_bf16 v[232:235], v[36:39], a[32:35], v[232:235]
    v_mfma_f32_16x16x32_bf16 v[236:239], v[36:39], a[104:107], v[236:239]
    ds_read_b128 v[32:35], v3 offset:12288
    ds_read_b128 v[36:39], v3 offset:30720
    s_waitcnt lgkmcnt(6)
    v_mfma_f32_16x16x32_bf16 v[208:211], v[40:43], v[100:103], v[208:211]
    v_mfma_f32_16x16x32_bf16 v[212:215], v[40:43], v[172:175], v[212:215]
    v_mfma_f32_16x16x32_bf16 v[216:219], v[44:47], v[100:103], v[216:219]
    v_mfma_f32_16x16x32_bf16 v[220:223], v[44:47], v[172:175], v[220:223]
    v_mfma_f32_16x16x32_bf16 v[224:227], v[40:43], a[36:39], v[224:227]
    v_mfma_f32_16x16x32_bf16 v[228:231], v[40:43], a[108:111], v[228:231]
    v_mfma_f32_16x16x32_bf16 v[232:235], v[44:47], a[36:39], v[232:235]
    v_mfma_f32_16x16x32_bf16 v[236:239], v[44:47], a[108:111], v[236:239]
    ds_read_b128 v[40:43], v3 offset:13312
    ds_read_b128 v[44:47], v3 offset:31744
    s_waitcnt lgkmcnt(6)
    v_mfma_f32_16x16x32_bf16 v[208:211], v[48:51], v[104:107], v[208:211]
    v_mfma_f32_16x16x32_bf16 v[212:215], v[48:51], v[176:179], v[212:215]
    v_mfma_f32_16x16x32_bf16 v[216:219], v[52:55], v[104:107], v[216:219]
    v_mfma_f32_16x16x32_bf16 v[220:223], v[52:55], v[176:179], v[220:223]
    v_mfma_f32_16x16x32_bf16 v[224:227], v[48:51], a[40:43], v[224:227]
    v_mfma_f32_16x16x32_bf16 v[228:231], v[48:51], a[112:115], v[228:231]
    v_mfma_f32_16x16x32_bf16 v[232:235], v[52:55], a[40:43], v[232:235]
    v_mfma_f32_16x16x32_bf16 v[236:239], v[52:55], a[112:115], v[236:239]
    ds_read_b128 v[48:51], v3 offset:14336
    ds_read_b128 v[52:55], v3 offset:32768
    s_waitcnt lgkmcnt(6)
    v_mfma_f32_16x16x32_bf16 v[208:211], v[56:59], v[108:111], v[208:211]
    v_mfma_f32_16x16x32_bf16 v[212:215], v[56:59], v[180:183], v[212:215]
    v_mfma_f32_16x16x32_bf16 v[216:219], v[60:63], v[108:111], v[216:219]
    v_mfma_f32_16x16x32_bf16 v[220:223], v[60:63], v[180:183], v[220:223]
    v_mfma_f32_16x16x32_bf16 v[224:227], v[56:59], a[44:47], v[224:227]
    v_mfma_f32_16x16x32_bf16 v[228:231], v[56:59], a[116:119], v[228:231]
    v_mfma_f32_16x16x32_bf16 v[232:235], v[60:63], a[44:47], v[232:235]
    v_mfma_f32_16x16x32_bf16 v[236:239], v[60:63], a[116:119], v[236:239]
    ds_read_b128 v[56:59], v3 offset:15360
    ds_read_b128 v[60:63], v3 offset:33792
    s_waitcnt lgkmcnt(6)
    v_mfma_f32_16x16x32_bf16 v[208:211], v[32:35], v[112:115], v[208:211]
    v_mfma_f32_16x16x32_bf16 v[212:215], v[32:35], v[184:187], v[212:215]
    v_mfma_f32_16x16x32_bf16 v[216:219], v[36:39], v[112:115], v[216:219]
    v_mfma_f32_16x16x32_bf16 v[220:223], v[36:39], v[184:187], v[220:223]
    v_mfma_f32_16x16x32_bf16 v[224:227], v[32:35], a[48:51], v[224:227]
    v_mfma_f32_16x16x32_bf16 v[228:231], v[32:35], a[120:123], v[228:231]
    v_mfma_f32_16x16x32_bf16 v[232:235], v[36:39], a[48:51], v[232:235]
    v_mfma_f32_16x16x32_bf16 v[236:239], v[36:39], a[120:123], v[236:239]
    ds_read_b128 v[32:35], v3 offset:16384
    ds_read_b128 v[36:39], v3 offset:34816
    s_waitcnt lgkmcnt(6)
    v_mfma_f32_16x16x32_bf16 v[208:211], v[40:43], v[116:119], v[208:211]
    v_mfma_f32_16x16x32_bf16 v[212:215], v[40:43], v[188:191], v[212:215]
    v_mfma_f32_16x16x32_bf16 v[216:219], v[44:47], v[116:119], v[216:219]
    v_mfma_f32_16x16x32_bf16 v[220:223], v[44:47], v[188:191], v[220:223]
    v_mfma_f32_16x16x32_bf16 v[224:227], v[40:43], a[52:55], v[224:227]
    v_mfma_f32_16x16x32_bf16 v[228:231], v[40:43], a[124:127], v[228:231]
    v_mfma_f32_16x16x32_bf16 v[232:235], v[44:47], a[52:55], v[232:235]
    v_mfma_f32_16x16x32_bf16 v[236:239], v[44:47], a[124:127], v[236:239]
    ds_read_b128 v[40:43], v3 offset:17408
    ds_read_b128 v[44:47], v3 offset:35840
    s_waitcnt lgkmcnt(6)
    v_mfma_f32_16x16x32_bf16 v[208:211], v[48:51], v[120:123], v[208:211]
    v_mfma_f32_16x16x32_bf16 v[212:215], v[48:51], v[192:195], v[212:215]
    v_mfma_f32_16x16x32_bf16 v[216:219], v[52:55], v[120:123], v[216:219]
    v_mfma_f32_16x16x32_bf16 v[220:223], v[52:55], v[192:195], v[220:223]
    v_mfma_f32_16x16x32_bf16 v[224:227], v[48:51], a[56:59], v[224:227]
    v_mfma_f32_16x16x32_bf16 v[228:231], v[48:51], a[128:131], v[228:231]
    v_mfma_f32_16x16x32_bf16 v[232:235], v[52:55], a[56:59], v[232:235]
    v_mfma_f32_16x16x32_bf16 v[236:239], v[52:55], a[128:131], v[236:239]
    s_waitcnt lgkmcnt(4)
    v_mfma_f32_16x16x32_bf16 v[208:211], v[56:59], v[124:127], v[208:211]
    v_mfma_f32_16x16x32_bf16 v[212:215], v[56:59], v[196:199], v[212:215]
    v_mfma_f32_16x16x32_bf16 v[216:219], v[60:63], v[124:127], v[216:219]
    v_mfma_f32_16x16x32_bf16 v[220:223], v[60:63], v[196:199], v[220:223]
    v_mfma_f32_16x16x32_bf16 v[224:227], v[56:59], a[60:63], v[224:227]
    v_mfma_f32_16x16x32_bf16 v[228:231], v[56:59], a[132:135], v[228:231]
    v_mfma_f32_16x16x32_bf16 v[232:235], v[60:63], a[60:63], v[232:235]
    v_mfma_f32_16x16x32_bf16 v[236:239], v[60:63], a[132:135], v[236:239]
    s_waitcnt lgkmcnt(2)
    v_mfma_f32_16x16x32_bf16 v[208:211], v[32:35], v[128:131], v[208:211]
    v_mfma_f32_16x16x32_bf16 v[212:215], v[32:35], v[200:203], v[212:215]
    v_mfma_f32_16x16x32_bf16 v[216:219], v[36:39], v[128:131], v[216:219]
    v_mfma_f32_16x16x32_bf16 v[220:223], v[36:39], v[200:203], v[220:223]
    v_mfma_f32_16x16x32_bf16 v[224:227], v[32:35], a[64:67], v[224:227]
    v_mfma_f32_16x16x32_bf16 v[228:231], v[32:35], a[136:139], v[228:231]
    v_mfma_f32_16x16x32_bf16 v[232:235], v[36:39], a[64:67], v[232:235]
    v_mfma_f32_16x16x32_bf16 v[236:239], v[36:39], a[136:139], v[236:239]
    s_waitcnt lgkmcnt(0)
    v_mfma_f32_16x16x32_bf16 v[208:211], v[40:43], v[132:135], v[208:211]
    v_mfma_f32_16x16x32_bf16 v[212:215], v[40:43], v[204:207], v[212:215]
    v_mfma_f32_16x16x32_bf16 v[216:219], v[44:47], v[132:135], v[216:219]
    v_mfma_f32_16x16x32_bf16 v[220:223], v[44:47], v[204:207], v[220:223]
    v_mfma_f32_16x16x32_bf16 v[224:227], v[40:43], a[68:71], v[224:227]
    v_mfma_f32_16x16x32_bf16 v[228:231], v[40:43], a[140:143], v[228:231]
    v_mfma_f32_16x16x32_bf16 v[232:235], v[44:47], a[68:71], v[232:235]
    v_mfma_f32_16x16x32_bf16 v[236:239], v[44:47], a[140:143], v[236:239]
    s_waitcnt vmcnt(9)
    v_cvt_pk_bf16_f32 v8, v208, v209
    v_cvt_pk_bf16_f32 v9, v210, v211
    v_cvt_pk_bf16_f32 v10, v216, v217
    v_cvt_pk_bf16_f32 v11, v218, v219
    s_mov_b32 s28, s26
    buffer_store_dwordx4 v[8:11], v7, s[4:7], s28 offen sc1
    v_cvt_pk_bf16_f32 v12, v212, v213
    v_cvt_pk_bf16_f32 v13, v214, v215
    v_cvt_pk_bf16_f32 v14, v220, v221
    v_cvt_pk_bf16_f32 v15, v222, v223
    s_add_u32 s28, s28, s40
    buffer_store_dwordx4 v[12:15], v7, s[4:7], s28 offen sc1
    v_cvt_pk_bf16_f32 v16, v224, v225
    v_cvt_pk_bf16_f32 v17, v226, v227
    v_cvt_pk_bf16_f32 v18, v232, v233
    v_cvt_pk_bf16_f32 v19, v234, v235
    s_add_u32 s28, s26, s43
    buffer_store_dwordx4 v[16:19], v7, s[4:7], s28 offen sc1
    v_cvt_pk_bf16_f32 v20, v228, v229
    v_cvt_pk_bf16_f32 v21, v230, v231
    v_cvt_pk_bf16_f32 v22, v236, v237
    v_cvt_pk_bf16_f32 v23, v238, v239
    s_add_u32 s28, s28, s40
    buffer_store_dwordx4 v[20:23], v7, s[4:7], s28 offen sc1
    s_add_u32 s26, s26, s41
    s_add_u32 s27, s27, 36864
    s_cmp_eq_u32 s27, 110592
    s_cselect_b32 s27, 0, s27
    s_add_u32 s30, s30, 1
    s_add_u32 s19, s19, s20
    s_cmp_lt_u32 s19, 64
    s_cbranch_scc1 qk_vloop
qk_done:
    s_waitcnt vmcnt(0)
    s_barrier
    s_add_u32 s22, s95, 63
    v_mov_b32 v4, s22
    s_mov_b64 exec, s[34:35]
    buffer_store_dword v4, off, s[4:7], s29 sc1
    s_mov_b64 exec, -1
    s_cmp_ge_u32 s36, 64
    s_cbranch_scc1 L_qkv_next
    s_lshr_b32 s33, s36, 5
    v_and_b32 v4, 63, v0
    v_lshrrev_b32 v5, 4, v4
    v_add_u32 v1, 0, v5
    v_mul_u32_u24 v6, 11, v1
    v_lshrrev_b32 v6, 5, v6
    v_add_u32 v1, v1, v6
    v_lshlrev_b32 v1, 7, v1
    v_and_b32 v6, 7, v4
    v_lshl_add_u32 v1, v6, 4, v1
    v_add_u32 v2, 4, v5
    v_mul_u32_u24 v6, 11, v2
    v_lshrrev_b32 v6, 5, v6
    v_add_u32 v2, v2, v6
    v_lshlrev_b32 v2, 7, v2
    v_and_b32 v6, 7, v4
    v_lshl_add_u32 v2, v6, 4, v2
    v_add_u32 v3, 8, v5
    v_mul_u32_u24 v6, 11, v3
    v_lshrrev_b32 v6, 5, v6
    v_add_u32 v3, v3, v6
    v_lshlrev_b32 v3, 7, v3
    v_and_b32 v6, 7, v4
    v_lshl_add_u32 v3, v6, 4, v3
    v_min_u32 v6, 23, v4
    v_lshlrev_b32 v6, 9, v6
    s_mov_b32 s19, s33
    s_mul_i32 s24, s19, 12288
    s_add_u32 s24, s24, 90177536
    s_lshl_b32 s26, s19, 5
    s_add_u32 s26, s26, s17
    s_lshl_b32 s26, s26, 12
    s_mov_b32 s21, 71303168
    s_cmp_eq_u32 s16, 2
    s_cselect_b32 s21, 80740352, s21
    s_add_u32 s26, s26, s21
    s_lshl_b32 s29, s17, 7
    s_lshl_b32 s21, s16, 1
    s_add_u32 s21, s21, s33
    s_lshl_b32 s21, s21, 2
    s_add_u32 s29, s29, s21
    s_add_u32 s29, s29, 125829240
mk_loop:
    s_cmp_lg_u32 s18, 0
    s_cbranch_scc1 mk_go
    s_add_u32 s23, s24, 12288
    s_mov_b32 s21, 4194304
mk_wait:
    buffer_load_dword v4, v6, s[4:7], s23 offen offset:384 sc1
    s_sub_u32 s21, s21, 1
    s_cbranch_scc1 mk_go
    s_waitcnt vmcnt(0)
    v_cmp_ne_u32 vcc, s95, v4
    s_cbranch_vccz mk_go
    s_sleep 4
    s_branch mk_wait
mk_go:
    s_barrier
    s_add_u32 s23, s24, 0
    buffer_load_dwordx4 v[24:27], v1, s[4:7], s23 offen offset:0 sc1
    buffer_load_dwordx4 v[28:31], v2, s[4:7], s23 offen offset:0 sc1
    buffer_load_dwordx4 v[32:35], v3, s[4:7], s23 offen offset:0 sc1
    buffer_load_dwordx4 v[36:39], v1, s[4:7], s23 offen offset:2048 sc1
    buffer_load_dwordx4 v[40:43], v2, s[4:7], s23 offen offset:2048 sc1
    buffer_load_dwordx4 v[44:47], v3, s[4:7], s23 offen offset:2048 sc1
    s_add_u32 s23, s24, 4096
    buffer_load_dwordx4 v[48:51], v1, s[4:7], s23 offen offset:0 sc1
    buffer_load_dwordx4 v[52:55], v2, s[4:7], s23 offen offset:0 sc1
    buffer_load_dwordx4 v[56:59], v3, s[4:7], s23 offen offset:0 sc1
    buffer_load_dwordx4 v[60:63], v1, s[4:7], s23 offen offset:2048 sc1
    buffer_load_dwordx4 v[208:211], v2, s[4:7], s23 offen offset:2048 sc1
    buffer_load_dwordx4 v[212:215], v3, s[4:7], s23 offen offset:2048 sc1
    s_add_u32 s23, s24, 8192
    buffer_load_dwordx4 v[216:219], v1, s[4:7], s23 offen offset:0 sc1
    buffer_load_dwordx4 v[220:223], v2, s[4:7], s23 offen offset:0 sc1
    buffer_load_dwordx4 v[224:227], v3, s[4:7], s23 offen offset:0 sc1
    buffer_load_dwordx4 v[228:231], v1, s[4:7], s23 offen offset:2048 sc1
    buffer_load_dwordx4 v[232:235], v2, s[4:7], s23 offen offset:2048 sc1
    buffer_load_dwordx4 v[236:239], v3, s[4:7], s23 offen offset:2048 sc1
    s_add_u32 s24, s24, 24576
    s_add_u32 s22, s19, s95
    s_add_u32 s22, s22, 1
    s_cmp_eq_u32 s16, 2
    s_cbranch_scc1 mk_v
    s_waitcnt vmcnt(17)
    v_mfma_f32_16x16x32_bf16 v[8:11], v[64:67], v[24:27], 0
    v_mfma_f32_16x16x32_bf16 v[12:15], v[136:139], v[24:27], 0
    v_mfma_f32_16x16x32_bf16 v[16:19], a[0:3], v[24:27], 0
    v_mfma_f32_16x16x32_bf16 v[20:23], a[72:75], v[24:27], 0
    s_waitcnt vmcnt(16)
    v_mfma_f32_16x16x32_bf16 v[8:11], v[68:71], v[28:31], v[8:11]
    v_mfma_f32_16x16x32_bf16 v[12:15], v[140:143], v[28:31], v[12:15]
    v_mfma_f32_16x16x32_bf16 v[16:19], a[4:7], v[28:31], v[16:19]
    v_mfma_f32_16x16x32_bf16 v[20:23], a[76:79], v[28:31], v[20:23]
    s_waitcnt vmcnt(15)
    v_mfma_f32_16x16x32_bf16 v[8:11], v[72:75], v[32:35], v[8:11]
    v_mfma_f32_16x16x32_bf16 v[12:15], v[144:147], v[32:35], v[12:15]
    v_mfma_f32_16x16x32_bf16 v[16:19], a[8:11], v[32:35], v[16:19]
    v_mfma_f32_16x16x32_bf16 v[20:23], a[80:83], v[32:35], v[20:23]
    s_waitcnt vmcnt(14)
    v_mfma_f32_16x16x32_bf16 v[8:11], v[76:79], v[36:39], v[8:11]
    v_mfma_f32_16x16x32_bf16 v[12:15], v[148:151], v[36:39], v[12:15]
    v_mfma_f32_16x16x32_bf16 v[16:19], a[12:15], v[36:39], v[16:19]
    v_mfma_f32_16x16x32_bf16 v[20:23], a[84:87], v[36:39], v[20:23]
    s_waitcnt vmcnt(13)
    v_mfma_f32_16x16x32_bf16 v[8:11], v[80:83], v[40:43], v[8:11]
    v_mfma_f32_16x16x32_bf16 v[12:15], v[152:155], v[40:43], v[12:15]
    v_mfma_f32_16x16x32_bf16 v[16:19], a[16:19], v[40:43], v[16:19]
    v_mfma_f32_16x16x32_bf16 v[20:23], a[88:91], v[40:43], v[20:23]
    s_waitcnt vmcnt(12)
    v_mfma_f32_16x16x32_bf16 v[8:11], v[84:87], v[44:47], v[8:11]
    v_mfma_f32_16x16x32_bf16 v[12:15], v[156:159], v[44:47], v[12:15]
    v_mfma_f32_16x16x32_bf16 v[16:19], a[20:23], v[44:47], v[16:19]
    v_mfma_f32_16x16x32_bf16 v[20:23], a[92:95], v[44:47], v[20:23]
    s_waitcnt vmcnt(11)
    v_mfma_f32_16x16x32_bf16 v[8:11], v[88:91], v[48:51], v[8:11]
    v_mfma_f32_16x16x32_bf16 v[12:15], v[160:163], v[48:51], v[12:15]
    v_mfma_f32_16x16x32_bf16 v[16:19], a[24:27], v[48:51], v[16:19]
    v_mfma_f32_16x16x32_bf16 v[20:23], a[96:99], v[48:51], v[20:23]
    s_waitcnt vmcnt(10)
    v_mfma_f32_16x16x32_bf16 v[8:11], v[92:95], v[52:55], v[8:11]
    v_mfma_f32_16x16x32_bf16 v[12:15], v[164:167], v[52:55], v[12:15]
    v_mfma_f32_16x16x32_bf16 v[16:19], a[28:31], v[52:55], v[16:19]
    v_mfma_f32_16x16x32_bf16 v[20:23], a[100:103], v[52:55], v[20:23]
    s_waitcnt vmcnt(9)
    v_mfma_f32_16x16x32_bf16 v[8:11], v[96:99], v[56:59], v[8:11]
    v_mfma_f32_16x16x32_bf16 v[12:15], v[168:171], v[56:59], v[12:15]
    v_mfma_f32_16x16x32_bf16 v[16:19], a[32:35], v[56:59], v[16:19]
    v_mfma_f32_16x16x32_bf16 v[20:23], a[104:107], v[56:59], v[20:23]
    s_waitcnt vmcnt(8)
    v_mfma_f32_16x16x32_bf16 v[8:11], v[100:103], v[60:63], v[8:11]
    v_mfma_f32_16x16x32_bf16 v[12:15], v[172:175], v[60:63], v[12:15]
    v_mfma_f32_16x16x32_bf16 v[16:19], a[36:39], v[60:63], v[16:19]
    v_mfma_f32_16x16x32_bf16 v[20:23], a[108:111], v[60:63], v[20:23]
    s_waitcnt vmcnt(7)
    v_mfma_f32_16x16x32_bf16 v[8:11], v[104:107], v[208:211], v[8:11]
    v_mfma_f32_16x16x32_bf16 v[12:15], v[176:179], v[208:211], v[12:15]
    v_mfma_f32_16x16x32_bf16 v[16:19], a[40:43], v[208:211], v[16:19]
    v_mfma_f32_16x16x32_bf16 v[20:23], a[112:115], v[208:211], v[20:23]
    s_waitcnt vmcnt(6)
    v_mfma_f32_16x16x32_bf16 v[8:11], v[108:111], v[212:215], v[8:11]
    v_mfma_f32_16x16x32_bf16 v[12:15], v[180:183], v[212:215], v[12:15]
    v_mfma_f32_16x16x32_bf16 v[16:19], a[44:47], v[212:215], v[16:19]
    v_mfma_f32_16x16x32_bf16 v[20:23], a[116:119], v[212:215], v[20:23]
    s_waitcnt vmcnt(5)
    v_mfma_f32_16x16x32_bf16 v[8:11], v[112:115], v[216:219], v[8:11]
    v_mfma_f32_16x16x32_bf16 v[12:15], v[184:187], v[216:219], v[12:15]
    v_mfma_f32_16x16x32_bf16 v[16:19], a[48:51], v[216:219], v[16:19]
    v_mfma_f32_16x16x32_bf16 v[20:23], a[120:123], v[216:219], v[20:23]
    s_waitcnt vmcnt(4)
    v_mfma_f32_16x16x32_bf16 v[8:11], v[116:119], v[220:223], v[8:11]
    v_mfma_f32_16x16x32_bf16 v[12:15], v[188:191], v[220:223], v[12:15]
    v_mfma_f32_16x16x32_bf16 v[16:19], a[52:55], v[220:223], v[16:19]
    v_mfma_f32_16x16x32_bf16 v[20:23], a[124:127], v[220:223], v[20:23]
    s_waitcnt vmcnt(3)
    v_mfma_f32_16x16x32_bf16 v[8:11], v[120:123], v[224:227], v[8:11]
    v_mfma_f32_16x16x32_bf16 v[12:15], v[192:195], v[224:227], v[12:15]
    v_mfma_f32_16x16x32_bf16 v[16:19], a[56:59], v[224:227], v[16:19]
    v_mfma_f32_16x16x32_bf16 v[20:23], a[128:131], v[224:227], v[20:23]
    s_waitcnt vmcnt(2)
    v_mfma_f32_16x16x32_bf16 v[8:11], v[124:127], v[228:231], v[8:11]
    v_mfma_f32_16x16x32_bf16 v[12:15], v[196:199], v[228:231], v[12:15]
    v_mfma_f32_16x16x32_bf16 v[16:19], a[60:63], v[228:231], v[16:19]
    v_mfma_f32_16x16x32_bf16 v[20:23], a[132:135], v[228:231], v[20:23]
    s_waitcnt vmcnt(1)
    v_mfma_f32_16x16x32_bf16 v[8:11], v[128:131], v[232:235], v[8:11]
    v_mfma_f32_16x16x32_bf16 v[12:15], v[200:203], v[232:235], v[12:15]
    v_mfma_f32_16x16x32_bf16 v[16:19], a[64:67], v[232:235], v[16:19]
    v_mfma_f32_16x16x32_bf16 v[20:23], a[136:139], v[232:235], v[20:23]
    s_waitcnt vmcnt(0)
    v_mfma_f32_16x16x32_bf16 v[8:11], v[132:135], v[236:239], v[8:11]
    v_mfma_f32_16x16x32_bf16 v[12:15], v[204:207], v[236:239], v[12:15]
    v_mfma_f32_16x16x32_bf16 v[16:19], a[68:71], v[236:239], v[16:19]
    v_mfma_f32_16x16x32_bf16 v[20:23], a[140:143], v[236:239], v[20:23]
    s_nop 7
    s_branch mk_st
mk_v:
    s_waitcnt vmcnt(17)
    v_mfma_f32_16x16x32_bf16 v[8:11], v[24:27], v[64:67], 0
    v_mfma_f32_16x16x32_bf16 v[12:15], v[24:27], v[136:139], 0
    v_mfma_f32_16x16x32_bf16 v[16:19], v[24:27], a[0:3], 0
    v_mfma_f32_16x16x32_bf16 v[20:23], v[24:27], a[72:75], 0
    s_waitcnt vmcnt(16)
    v_mfma_f32_16x16x32_bf16 v[8:11], v[28:31], v[68:71], v[8:11]
    v_mfma_f32_16x16x32_bf16 v[12:15], v[28:31], v[140:143], v[12:15]
    v_mfma_f32_16x16x32_bf16 v[16:19], v[28:31], a[4:7], v[16:19]
    v_mfma_f32_16x16x32_bf16 v[20:23], v[28:31], a[76:79], v[20:23]
    s_waitcnt vmcnt(15)
    v_mfma_f32_16x16x32_bf16 v[8:11], v[32:35], v[72:75], v[8:11]
    v_mfma_f32_16x16x32_bf16 v[12:15], v[32:35], v[144:147], v[12:15]
    v_mfma_f32_16x16x32_bf16 v[16:19], v[32:35], a[8:11], v[16:19]
    v_mfma_f32_16x16x32_bf16 v[20:23], v[32:35], a[80:83], v[20:23]
    s_waitcnt vmcnt(14)
    v_mfma_f32_16x16x32_bf16 v[8:11], v[36:39], v[76:79], v[8:11]
    v_mfma_f32_16x16x32_bf16 v[12:15], v[36:39], v[148:151], v[12:15]
    v_mfma_f32_16x16x32_bf16 v[16:19], v[36:39], a[12:15], v[16:19]
    v_mfma_f32_16x16x32_bf16 v[20:23], v[36:39], a[84:87], v[20:23]
    s_waitcnt vmcnt(13)
    v_mfma_f32_16x16x32_bf16 v[8:11], v[40:43], v[80:83], v[8:11]
    v_mfma_f32_16x16x32_bf16 v[12:15], v[40:43], v[152:155], v[12:15]
    v_mfma_f32_16x16x32_bf16 v[16:19], v[40:43], a[16:19], v[16:19]
    v_mfma_f32_16x16x32_bf16 v[20:23], v[40:43], a[88:91], v[20:23]
    s_waitcnt vmcnt(12)
    v_mfma_f32_16x16x32_bf16 v[8:11], v[44:47], v[84:87], v[8:11]
    v_mfma_f32_16x16x32_bf16 v[12:15], v[44:47], v[156:159], v[12:15]
    v_mfma_f32_16x16x32_bf16 v[16:19], v[44:47], a[20:23], v[16:19]
    v_mfma_f32_16x16x32_bf16 v[20:23], v[44:47], a[92:95], v[20:23]
    s_waitcnt vmcnt(11)
    v_mfma_f32_16x16x32_bf16 v[8:11], v[48:51], v[88:91], v[8:11]
    v_mfma_f32_16x16x32_bf16 v[12:15], v[48:51], v[160:163], v[12:15]
    v_mfma_f32_16x16x32_bf16 v[16:19], v[48:51], a[24:27], v[16:19]
    v_mfma_f32_16x16x32_bf16 v[20:23], v[48:51], a[96:99], v[20:23]
    s_waitcnt vmcnt(10)
    v_mfma_f32_16x16x32_bf16 v[8:11], v[52:55], v[92:95], v[8:11]
    v_mfma_f32_16x16x32_bf16 v[12:15], v[52:55], v[164:167], v[12:15]
    v_mfma_f32_16x16x32_bf16 v[16:19], v[52:55], a[28:31], v[16:19]
    v_mfma_f32_16x16x32_bf16 v[20:23], v[52:55], a[100:103], v[20:23]
    s_waitcnt vmcnt(9)
    v_mfma_f32_16x16x32_bf16 v[8:11], v[56:59], v[96:99], v[8:11]
    v_mfma_f32_16x16x32_bf16 v[12:15], v[56:59], v[168:171], v[12:15]
    v_mfma_f32_16x16x32_bf16 v[16:19], v[56:59], a[32:35], v[16:19]
    v_mfma_f32_16x16x32_bf16 v[20:23], v[56:59], a[104:107], v[20:23]
    s_waitcnt vmcnt(8)
    v_mfma_f32_16x16x32_bf16 v[8:11], v[60:63], v[100:103], v[8:11]
    v_mfma_f32_16x16x32_bf16 v[12:15], v[60:63], v[172:175], v[12:15]
    v_mfma_f32_16x16x32_bf16 v[16:19], v[60:63], a[36:39], v[16:19]
    v_mfma_f32_16x16x32_bf16 v[20:23], v[60:63], a[108:111], v[20:23]
    s_waitcnt vmcnt(7)
    v_mfma_f32_16x16x32_bf16 v[8:11], v[208:211], v[104:107], v[8:11]
    v_mfma_f32_16x16x32_bf16 v[12:15], v[208:211], v[176:179], v[12:15]
    v_mfma_f32_16x16x32_bf16 v[16:19], v[208:211], a[40:43], v[16:19]
    v_mfma_f32_16x16x32_bf16 v[20:23], v[208:211], a[112:115], v[20:23]
    s_waitcnt vmcnt(6)
    v_mfma_f32_16x16x32_bf16 v[8:11], v[212:215], v[108:111], v[8:11]
    v_mfma_f32_16x16x32_bf16 v[12:15], v[212:215], v[180:183], v[12:15]
    v_mfma_f32_16x16x32_bf16 v[16:19], v[212:215], a[44:47], v[16:19]
    v_mfma_f32_16x16x32_bf16 v[20:23], v[212:215], a[116:119], v[20:23]
    s_waitcnt vmcnt(5)
    v_mfma_f32_16x16x32_bf16 v[8:11], v[216:219], v[112:115], v[8:11]
    v_mfma_f32_16x16x32_bf16 v[12:15], v[216:219], v[184:187], v[12:15]
    v_mfma_f32_16x16x32_bf16 v[16:19], v[216:219], a[48:51], v[16:19]
    v_mfma_f32_16x16x32_bf16 v[20:23], v[216:219], a[120:123], v[20:23]
    s_waitcnt vmcnt(4)
    v_mfma_f32_16x16x32_bf16 v[8:11], v[220:223], v[116:119], v[8:11]
    v_mfma_f32_16x16x32_bf16 v[12:15], v[220:223], v[188:191], v[12:15]
    v_mfma_f32_16x16x32_bf16 v[16:19], v[220:223], a[52:55], v[16:19]
    v_mfma_f32_16x16x32_bf16 v[20:23], v[220:223], a[124:127], v[20:23]
    s_waitcnt vmcnt(3)
    v_mfma_f32_16x16x32_bf16 v[8:11], v[224:227], v[120:123], v[8:11]
    v_mfma_f32_16x16x32_bf16 v[12:15], v[224:227], v[192:195], v[12:15]
    v_mfma_f32_16x16x32_bf16 v[16:19], v[224:227], a[56:59], v[16:19]
    v_mfma_f32_16x16x32_bf16 v[20:23], v[224:227], a[128:131], v[20:23]
    s_waitcnt vmcnt(2)
    v_mfma_f32_16x16x32_bf16 v[8:11], v[228:231], v[124:127], v[8:11]
    v_mfma_f32_16x16x32_bf16 v[12:15], v[228:231], v[196:199], v[12:15]
    v_mfma_f32_16x16x32_bf16 v[16:19], v[228:231], a[60:63], v[16:19]
    v_mfma_f32_16x16x32_bf16 v[20:23], v[228:231], a[132:135], v[20:23]
    s_waitcnt vmcnt(1)
    v_mfma_f32_16x16x32_bf16 v[8:11], v[232:235], v[128:131], v[8:11]
    v_mfma_f32_16x16x32_bf16 v[12:15], v[232:235], v[200:203], v[12:15]
    v_mfma_f32_16x16x32_bf16 v[16:19], v[232:235], a[64:67], v[16:19]
    v_mfma_f32_16x16x32_bf16 v[20:23], v[232:235], a[136:139], v[20:23]
    s_waitcnt vmcnt(0)
    v_mfma_f32_16x16x32_bf16 v[8:11], v[236:239], v[132:135], v[8:11]
    v_mfma_f32_16x16x32_bf16 v[12:15], v[236:239], v[204:207], v[12:15]
    v_mfma_f32_16x16x32_bf16 v[16:19], v[236:239], a[68:71], v[16:19]
    v_mfma_f32_16x16x32_bf16 v[20:23], v[236:239], a[140:143], v[20:23]
    v_pk_mul_f32 v[8:9], v[8:9], 0.5 op_sel_hi:[1,0]
    v_pk_mul_f32 v[10:11], v[10:11], 0.5 op_sel_hi:[1,0]
    v_pk_mul_f32 v[12:13], v[12:13], 0.5 op_sel_hi:[1,0]
    v_pk_mul_f32 v[14:15], v[14:15], 0.5 op_sel_hi:[1,0]
    v_pk_mul_f32 v[16:17], v[16:17], 0.5 op_sel_hi:[1,0]
    v_pk_mul_f32 v[18:19], v[18:19], 0.5 op_sel_hi:[1,0]
    s_nop 0
    v_pk_mul_f32 v[20:21], v[20:21], 0.5 op_sel_hi:[1,0]
    v_pk_mul_f32 v[22:23], v[22:23], 0.5 op_sel_hi:[1,0]
    s_nop 1
mk_st:
    v_cvt_pk_bf16_f32 v24, v8, v9
    v_cvt_pk_bf16_f32 v25, v10, v11
    v_cvt_pk_bf16_f32 v26, v12, v13
    v_cvt_pk_bf16_f32 v27, v14, v15
    v_cvt_pk_bf16_f32 v28, v16, v17
    v_cvt_pk_bf16_f32 v29, v18, v19
    v_cvt_pk_bf16_f32 v30, v20, v21
    v_cvt_pk_bf16_f32 v31, v22, v23
    s_add_u32 s21, s26, 4096
    buffer_store_dwordx4 v[24:27], v7, s[4:7], s26 offen sc1
    buffer_store_dwordx4 v[28:31], v7, s[4:7], s21 offen sc1
    s_waitcnt vmcnt(0)
    s_barrier
    v_mov_b32 v4, s22
    s_mov_b64 exec, s[34:35]
    buffer_store_dword v4, off, s[4:7], s29 sc1
    s_mov_b64 exec, -1
    s_add_u32 s19, s19, 2
    s_add_u32 s26, s26, 262144
    s_cmp_lt_u32 s19, 62
    s_cbranch_scc1 mk_loop
    s_endpgm
L_ssm_next:
    s_mov_b32 s37, 8
    v_mov_b32 v250, 1
    v_mov_b32 v251, 163832
    v_cmp_eq_u32 vcc, 0, v0
    s_nop 0
    s_and_saveexec_b64 s[38:39], vcc
    s_cbranch_execz tk8
    buffer_atomic_add v250, off, s[96:99], s37 sc0
    s_waitcnt vmcnt(0)
    ds_write_b32 v251, v250
    s_waitcnt lgkmcnt(0)
tk8:
    s_mov_b64 exec, -1
    s_barrier
    ds_read_b32 v252, v251
    s_waitcnt lgkmcnt(0)
    v_readfirstlane_b32 s20, v252
    s_barrier
    s_nop 3
    s_cmp_ge_u32 s20, 144
    s_cbranch_scc1 L_phase2
    s_lshl_b32 s20, s20, 2
    v_lshrrev_b32 v5, 6, v0
    s_nop 0
    v_readfirstlane_b32 s21, v5
    v_and_b32 v1, 63, v0
    v_and_b32 v2, 15, v1
    v_lshrrev_b32 v3, 4, v1
    v_lshlrev_b32 v4, 14, v5
    s_mov_b32 s8, s62
    s_mov_b32 s9, s63
    s_mov_b32 s10, 2359296
    s_mov_b32 s11, 0x20000
    s_mov_b32 s16, s76
    s_mov_b32 s17, s77
    s_mov_b32 s18, 4718592
    s_mov_b32 s19, 0x20000
    v_mul_u32_u24 v5, 9216, v0
    s_lshl_b32 s22, s20, 1
    s_add_u32 s23, s22, 0
    buffer_load_dwordx2 v[8:9], v5, s[8:11], s23 offen
    s_add_u32 s23, s22, 1152
    buffer_load_dwordx2 v[10:11], v5, s[8:11], s23 offen
    s_add_u32 s23, s22, 2304
    buffer_load_dwordx2 v[12:13], v5, s[8:11], s23 offen
    s_add_u32 s23, s22, 3456
    buffer_load_dwordx2 v[14:15], v5, s[8:11], s23 offen
    s_add_u32 s23, s22, 4608
    buffer_load_dwordx2 v[16:17], v5, s[8:11], s23 offen
    s_add_u32 s23, s22, 5760
    buffer_load_dwordx2 v[18:19], v5, s[8:11], s23 offen
    s_add_u32 s23, s22, 6912
    buffer_load_dwordx2 v[20:21], v5, s[8:11], s23 offen
    s_add_u32 s23, s22, 8064
    buffer_load_dwordx2 v[22:23], v5, s[8:11], s23 offen
    s_add_u32 s22, s20, s21
    s_lshl_b32 s23, s22, 8
    v_lshlrev_b32 v6, 3, v2
    v_lshl_add_u32 v6, v3, 1, v6
    s_mov_b32 s12, s64
    s_mov_b32 s13, s65
    s_mov_b32 s14, 147456
    s_mov_b32 s15, 0x20000
    buffer_load_ushort v24, v6, s[12:15], s23 offen offset:0
    buffer_load_ushort v28, v6, s[12:15], s23 offen offset:128
    s_mov_b32 s12, s66
    s_mov_b32 s13, s67
    s_mov_b32 s14, 147456
    s_mov_b32 s15, 0x20000
    buffer_load_ushort v25, v6, s[12:15], s23 offen offset:0
    buffer_load_ushort v29, v6, s[12:15], s23 offen offset:128
    s_mov_b32 s12, s68
    s_mov_b32 s13, s69
    s_mov_b32 s14, 147456
    s_mov_b32 s15, 0x20000
    buffer_load_ushort v26, v6, s[12:15], s23 offen offset:0
    buffer_load_ushort v30, v6, s[12:15], s23 offen offset:128
    s_mov_b32 s12, s70
    s_mov_b32 s13, s71
    s_mov_b32 s14, 147456
    s_mov_b32 s15, 0x20000
    buffer_load_ushort v27, v6, s[12:15], s23 offen offset:0
    buffer_load_ushort v31, v6, s[12:15], s23 offen offset:128
    s_mov_b32 s12, s72
    s_mov_b32 s13, s73
    s_mov_b32 s14, 1152
    s_mov_b32 s15, 0x20000
    s_lshl_b32 s23, s22, 1
    buffer_load_ushort v32, off, s[12:15], s23
    s_mov_b32 s26, 0x3fb8aa3b
    s_mov_b32 s27, 0x3e22f983
    v_mov_b32 v34, 0
    v_mov_b32 v35, 0
    v_lshl_add_u32 v6, v1, 3, v4
    ds_write_b64 v6, v[34:35] offset:0
    s_waitcnt vmcnt(0)
    v_mov_b32 v36, 0x05040100
    v_mov_b32 v37, 0x07060302
    v_lshlrev_b32 v6, 4, v0
    v_perm_b32 v40, v10, v8, v36
    v_perm_b32 v41, v14, v12, v36
    v_perm_b32 v42, v18, v16, v36
    v_perm_b32 v43, v22, v20, v36
    ds_write_b128 v6, v[40:43] offset:512
    s_nop 1
    v_perm_b32 v40, v10, v8, v37
    v_perm_b32 v41, v14, v12, v37
    v_perm_b32 v42, v18, v16, v37
    v_perm_b32 v43, v22, v20, v37
    ds_write_b128 v6, v[40:43] offset:16896
    s_nop 1
    v_perm_b32 v40, v11, v9, v36
    v_perm_b32 v41, v15, v13, v36
    v_perm_b32 v42, v19, v17, v36
    v_perm_b32 v43, v23, v21, v36
    ds_write_b128 v6, v[40:43] offset:33280
    s_nop 1
    v_perm_b32 v40, v11, v9, v37
    v_perm_b32 v41, v15, v13, v37
    v_perm_b32 v42, v19, v17, v37
    v_perm_b32 v43, v23, v21, v37
    ds_write_b128 v6, v[40:43] offset:49664
    s_nop 1
    v_lshlrev_b32 v32, 16, v32
    v_mul_f32 v32, s26, v32
    v_exp_f32 v32, v32
    s_nop 0
    v_cvt_pk_bf16_f32 v32, v32, v32
    v_and_b32 v32, 0xffff0000, v32
    v_add_f32 v33, v32, v32
    v_lshlrev_b32 v24, 16, v24
    v_mul_f32 v24, s26, v24
    v_exp_f32 v24, v24
    s_nop 0
    v_cvt_pk_bf16_f32 v24, v24, v24
    v_and_b32 v24, 0xffff0000, v24
    v_mul_f32 v24, v24, v32
    v_mul_f32 v24, s26, v24
    v_sub_f32 v24, 0, v24
    v_lshlrev_b32 v25, 16, v25
    v_mul_f32 v25, v25, v32
    v_mul_f32 v25, s27, v25
    v_lshlrev_b32 v26, 16, v26
    v_mul_f32 v26, v26, v33
    v_lshlrev_b32 v27, 16, v27
    v_mul_f32 v27, v27, v33
    v_lshlrev_b32 v28, 16, v28
    v_mul_f32 v28, s26, v28
    v_exp_f32 v28, v28
    s_nop 0
    v_cvt_pk_bf16_f32 v28, v28, v28
    v_and_b32 v28, 0xffff0000, v28
    v_mul_f32 v28, v28, v32
    v_mul_f32 v28, s26, v28
    v_sub_f32 v28, 0, v28
    v_lshlrev_b32 v29, 16, v29
    v_mul_f32 v29, v29, v32
    v_mul_f32 v29, s27, v29
    v_lshlrev_b32 v30, 16, v30
    v_mul_f32 v30, v30, v33
    v_lshlrev_b32 v31, 16, v31
    v_mul_f32 v31, v31, v33
    v_cvt_f32_u32 v47, v2
    v_mul_f32 v44, 0x41800000, v47
    v_and_b32 v5, 7, v2
    v_add_u32 v5, 8, v5
    v_cvt_f32_u32 v5, v5
    v_mul_f32 v45, 0x42000000, v5
    v_mul_f32 v6, 0x42800000, v5
    v_cmp_lt_u32 vcc, 7, v2
    s_nop 1
    v_cndmask_b32 v45, v45, v6, vcc
    v_add_f32 v5, 0x41000000, v47
    v_mul_f32 v46, 0x43000000, v5
    v_mov_b32 v48, 0
    v_mov_b32 v49, 0
    v_mov_b32 v50, 0
    v_mov_b32 v51, 0
    v_mov_b32 v52, 0
    v_mov_b32 v53, 0
    v_mov_b32 v54, 0
    v_mov_b32 v55, 0
    v_mov_b32 v56, 0
    v_mov_b32 v57, 0
    v_mov_b32 v58, 0
    v_mov_b32 v59, 0
    v_mov_b32 v60, 0
    v_mov_b32 v61, 0
    v_mov_b32 v62, 0
    v_mov_b32 v63, 0
    v_mov_b32_dpp v64, v24 row_newbcast:0 row_mask:0xf bank_mask:0xf
    v_mov_b32_dpp v65, v25 row_newbcast:0 row_mask:0xf bank_mask:0xf
    v_mov_b32_dpp v66, v26 row_newbcast:0 row_mask:0xf bank_mask:0xf
    v_mov_b32_dpp v67, v27 row_newbcast:0 row_mask:0xf bank_mask:0xf
    v_mul_f32 v82, v64, v47
    v_mul_f32 v83, v65, v47
    v_exp_f32 v82, v82
    v_fract_f32 v83, v83
    v_cos_f32 v74, v83
    v_sin_f32 v75, v83
    v_mul_f32 v74, v74, v82
    v_mul_f32 v75, v75, v82
    v_mul_f32 v84, v75, v75
    v_add_f32 v85, v74, v74
    v_fma_f32 v76, v74, v74, -v84
    v_mul_f32 v77, v85, v75
    v_mul_f32 v84, v77, v77
    v_add_f32 v85, v76, v76
    v_fma_f32 v78, v76, v76, -v84
    v_mul_f32 v79, v85, v77
    v_mul_f32 v84, v79, v79
    v_add_f32 v85, v78, v78
    v_fma_f32 v80, v78, v78, -v84
    v_mul_f32 v81, v85, v79
    v_mul_f32 v82, v64, v44
    v_mul_f32 v83, v65, v44
    v_exp_f32 v82, v82
    v_fract_f32 v83, v83
    v_cos_f32 v68, v83
    v_sin_f32 v69, v83
    v_mul_f32 v68, v68, v82
    v_mul_f32 v69, v69, v82
    v_mul_f32 v84, v67, v69
    v_mul_f32 v85, v67, v68
    v_fma_f32 v68, v66, v68, -v84
    v_fma_f32 v69, -v66, v69, -v85
    v_mul_f32 v82, v64, v45
    v_mul_f32 v83, v65, v45
    v_exp_f32 v82, v82
    v_fract_f32 v83, v83
    v_cos_f32 v70, v83
    v_sin_f32 v71, v83
    v_mul_f32 v70, v70, v82
    v_mul_f32 v71, v71, v82
    v_mul_f32 v84, v67, v71
    v_mul_f32 v85, v67, v70
    v_fma_f32 v70, v66, v70, -v84
    v_fma_f32 v71, -v66, v71, -v85
    v_mul_f32 v82, v64, v46
    v_mul_f32 v83, v65, v46
    v_exp_f32 v82, v82
    v_fract_f32 v83, v83
    v_cos_f32 v72, v83
    v_sin_f32 v73, v83
    v_mul_f32 v72, v72, v82
    v_mul_f32 v73, v73, v82
    v_mul_f32 v84, v67, v73
    v_mul_f32 v85, v67, v72
    v_fma_f32 v72, v66, v72, -v84
    v_fma_f32 v73, -v66, v73, -v85
    v_mfma_f32_16x16x4_f32 v[48:51], v68, v74, v[48:51]
    v_mfma_f32_16x16x4_f32 v[52:55], v70, v76, v[52:55]
    v_mfma_f32_16x16x4_f32 v[56:59], v70, v78, v[56:59]
    v_mfma_f32_16x16x4_f32 v[60:63], v72, v80, v[60:63]
    v_mfma_f32_16x16x4_f32 v[48:51], v69, v75, v[48:51]
    v_mfma_f32_16x16x4_f32 v[52:55], v71, v77, v[52:55]
    v_mfma_f32_16x16x4_f32 v[56:59], v71, v79, v[56:59]
    v_mfma_f32_16x16x4_f32 v[60:63], v73, v81, v[60:63]
    v_mov_b32_dpp v64, v24 row_newbcast:1 row_mask:0xf bank_mask:0xf
    v_mov_b32_dpp v65, v25 row_newbcast:1 row_mask:0xf bank_mask:0xf
    v_mov_b32_dpp v66, v26 row_newbcast:1 row_mask:0xf bank_mask:0xf
    v_mov_b32_dpp v67, v27 row_newbcast:1 row_mask:0xf bank_mask:0xf
    v_mul_f32 v82, v64, v47
    v_mul_f32 v83, v65, v47
    v_exp_f32 v82, v82
    v_fract_f32 v83, v83
    v_cos_f32 v74, v83
    v_sin_f32 v75, v83
    v_mul_f32 v74, v74, v82
    v_mul_f32 v75, v75, v82
    v_mul_f32 v84, v75, v75
    v_add_f32 v85, v74, v74
    v_fma_f32 v76, v74, v74, -v84
    v_mul_f32 v77, v85, v75
    v_mul_f32 v84, v77, v77
    v_add_f32 v85, v76, v76
    v_fma_f32 v78, v76, v76, -v84
    v_mul_f32 v79, v85, v77
    v_mul_f32 v84, v79, v79
    v_add_f32 v85, v78, v78
    v_fma_f32 v80, v78, v78, -v84
    v_mul_f32 v81, v85, v79
    v_mul_f32 v82, v64, v44
    v_mul_f32 v83, v65, v44
    v_exp_f32 v82, v82
    v_fract_f32 v83, v83
    v_cos_f32 v68, v83
    v_sin_f32 v69, v83
    v_mul_f32 v68, v68, v82
    v_mul_f32 v69, v69, v82
    v_mul_f32 v84, v67, v69
    v_mul_f32 v85, v67, v68
    v_fma_f32 v68, v66, v68, -v84
    v_fma_f32 v69, -v66, v69, -v85
    v_mul_f32 v82, v64, v45
    v_mul_f32 v83, v65, v45
    v_exp_f32 v82, v82
    v_fract_f32 v83, v83
    v_cos_f32 v70, v83
    v_sin_f32 v71, v83
    v_mul_f32 v70, v70, v82
    v_mul_f32 v71, v71, v82
    v_mul_f32 v84, v67, v71
    v_mul_f32 v85, v67, v70
    v_fma_f32 v70, v66, v70, -v84
    v_fma_f32 v71, -v66, v71, -v85
    v_mul_f32 v82, v64, v46
    v_mul_f32 v83, v65, v46
    v_exp_f32 v82, v82
    v_fract_f32 v83, v83
    v_cos_f32 v72, v83
    v_sin_f32 v73, v83
    v_mul_f32 v72, v72, v82
    v_mul_f32 v73, v73, v82
    v_mul_f32 v84, v67, v73
    v_mul_f32 v85, v67, v72
    v_fma_f32 v72, v66, v72, -v84
    v_fma_f32 v73, -v66, v73, -v85
    v_mfma_f32_16x16x4_f32 v[48:51], v68, v74, v[48:51]
    v_mfma_f32_16x16x4_f32 v[52:55], v70, v76, v[52:55]
    v_mfma_f32_16x16x4_f32 v[56:59], v70, v78, v[56:59]
    v_mfma_f32_16x16x4_f32 v[60:63], v72, v80, v[60:63]
    v_mfma_f32_16x16x4_f32 v[48:51], v69, v75, v[48:51]
    v_mfma_f32_16x16x4_f32 v[52:55], v71, v77, v[52:55]
    v_mfma_f32_16x16x4_f32 v[56:59], v71, v79, v[56:59]
    v_mfma_f32_16x16x4_f32 v[60:63], v73, v81, v[60:63]
    v_mov_b32_dpp v64, v24 row_newbcast:2 row_mask:0xf bank_mask:0xf
    v_mov_b32_dpp v65, v25 row_newbcast:2 row_mask:0xf bank_mask:0xf
    v_mov_b32_dpp v66, v26 row_newbcast:2 row_mask:0xf bank_mask:0xf
    v_mov_b32_dpp v67, v27 row_newbcast:2 row_mask:0xf bank_mask:0xf
    v_mul_f32 v82, v64, v47
    v_mul_f32 v83, v65, v47
    v_exp_f32 v82, v82
    v_fract_f32 v83, v83
    v_cos_f32 v74, v83
    v_sin_f32 v75, v83
    v_mul_f32 v74, v74, v82
    v_mul_f32 v75, v75, v82
    v_mul_f32 v84, v75, v75
    v_add_f32 v85, v74, v74
    v_fma_f32 v76, v74, v74, -v84
    v_mul_f32 v77, v85, v75
    v_mul_f32 v84, v77, v77
    v_add_f32 v85, v76, v76
    v_fma_f32 v78, v76, v76, -v84
    v_mul_f32 v79, v85, v77
    v_mul_f32 v84, v79, v79
    v_add_f32 v85, v78, v78
    v_fma_f32 v80, v78, v78, -v84
    v_mul_f32 v81, v85, v79
    v_mul_f32 v82, v64, v44
    v_mul_f32 v83, v65, v44
    v_exp_f32 v82, v82
    v_fract_f32 v83, v83
    v_cos_f32 v68, v83
    v_sin_f32 v69, v83
    v_mul_f32 v68, v68, v82
    v_mul_f32 v69, v69, v82
    v_mul_f32 v84, v67, v69
    v_mul_f32 v85, v67, v68
    v_fma_f32 v68, v66, v68, -v84
    v_fma_f32 v69, -v66, v69, -v85
    v_mul_f32 v82, v64, v45
    v_mul_f32 v83, v65, v45
    v_exp_f32 v82, v82
    v_fract_f32 v83, v83
    v_cos_f32 v70, v83
    v_sin_f32 v71, v83
    v_mul_f32 v70, v70, v82
    v_mul_f32 v71, v71, v82
    v_mul_f32 v84, v67, v71
    v_mul_f32 v85, v67, v70
    v_fma_f32 v70, v66, v70, -v84
    v_fma_f32 v71, -v66, v71, -v85
    v_mul_f32 v82, v64, v46
    v_mul_f32 v83, v65, v46
    v_exp_f32 v82, v82
    v_fract_f32 v83, v83
    v_cos_f32 v72, v83
    v_sin_f32 v73, v83
    v_mul_f32 v72, v72, v82
    v_mul_f32 v73, v73, v82
    v_mul_f32 v84, v67, v73
    v_mul_f32 v85, v67, v72
    v_fma_f32 v72, v66, v72, -v84
    v_fma_f32 v73, -v66, v73, -v85
    v_mfma_f32_16x16x4_f32 v[48:51], v68, v74, v[48:51]
    v_mfma_f32_16x16x4_f32 v[52:55], v70, v76, v[52:55]
    v_mfma_f32_16x16x4_f32 v[56:59], v70, v78, v[56:59]
    v_mfma_f32_16x16x4_f32 v[60:63], v72, v80, v[60:63]
    v_mfma_f32_16x16x4_f32 v[48:51], v69, v75, v[48:51]
    v_mfma_f32_16x16x4_f32 v[52:55], v71, v77, v[52:55]
    v_mfma_f32_16x16x4_f32 v[56:59], v71, v79, v[56:59]
    v_mfma_f32_16x16x4_f32 v[60:63], v73, v81, v[60:63]
    v_mov_b32_dpp v64, v24 row_newbcast:3 row_mask:0xf bank_mask:0xf
    v_mov_b32_dpp v65, v25 row_newbcast:3 row_mask:0xf bank_mask:0xf
    v_mov_b32_dpp v66, v26 row_newbcast:3 row_mask:0xf bank_mask:0xf
    v_mov_b32_dpp v67, v27 row_newbcast:3 row_mask:0xf bank_mask:0xf
    v_mul_f32 v82, v64, v47
    v_mul_f32 v83, v65, v47
    v_exp_f32 v82, v82
    v_fract_f32 v83, v83
    v_cos_f32 v74, v83
    v_sin_f32 v75, v83
    v_mul_f32 v74, v74, v82
    v_mul_f32 v75, v75, v82
    v_mul_f32 v84, v75, v75
    v_add_f32 v85, v74, v74
    v_fma_f32 v76, v74, v74, -v84
    v_mul_f32 v77, v85, v75
    v_mul_f32 v84, v77, v77
    v_add_f32 v85, v76, v76
    v_fma_f32 v78, v76, v76, -v84
    v_mul_f32 v79, v85, v77
    v_mul_f32 v84, v79, v79
    v_add_f32 v85, v78, v78
    v_fma_f32 v80, v78, v78, -v84
    v_mul_f32 v81, v85, v79
    v_mul_f32 v82, v64, v44
    v_mul_f32 v83, v65, v44
    v_exp_f32 v82, v82
    v_fract_f32 v83, v83
    v_cos_f32 v68, v83
    v_sin_f32 v69, v83
    v_mul_f32 v68, v68, v82
    v_mul_f32 v69, v69, v82
    v_mul_f32 v84, v67, v69
    v_mul_f32 v85, v67, v68
    v_fma_f32 v68, v66, v68, -v84
    v_fma_f32 v69, -v66, v69, -v85
    v_mul_f32 v82, v64, v45
    v_mul_f32 v83, v65, v45
    v_exp_f32 v82, v82
    v_fract_f32 v83, v83
    v_cos_f32 v70, v83
    v_sin_f32 v71, v83
    v_mul_f32 v70, v70, v82
    v_mul_f32 v71, v71, v82
    v_mul_f32 v84, v67, v71
    v_mul_f32 v85, v67, v70
    v_fma_f32 v70, v66, v70, -v84
    v_fma_f32 v71, -v66, v71, -v85
    v_mul_f32 v82, v64, v46
    v_mul_f32 v83, v65, v46
    v_exp_f32 v82, v82
    v_fract_f32 v83, v83
    v_cos_f32 v72, v83
    v_sin_f32 v73, v83
    v_mul_f32 v72, v72, v82
    v_mul_f32 v73, v73, v82
    v_mul_f32 v84, v67, v73
    v_mul_f32 v85, v67, v72
    v_fma_f32 v72, v66, v72, -v84
    v_fma_f32 v73, -v66, v73, -v85
    v_mfma_f32_16x16x4_f32 v[48:51], v68, v74, v[48:51]
    v_mfma_f32_16x16x4_f32 v[52:55], v70, v76, v[52:55]
    v_mfma_f32_16x16x4_f32 v[56:59], v70, v78, v[56:59]
    v_mfma_f32_16x16x4_f32 v[60:63], v72, v80, v[60:63]
    v_mfma_f32_16x16x4_f32 v[48:51], v69, v75, v[48:51]
    v_mfma_f32_16x16x4_f32 v[52:55], v71, v77, v[52:55]
    v_mfma_f32_16x16x4_f32 v[56:59], v71, v79, v[56:59]
    v_mfma_f32_16x16x4_f32 v[60:63], v73, v81, v[60:63]
    v_mov_b32_dpp v64, v24 row_newbcast:4 row_mask:0xf bank_mask:0xf
    v_mov_b32_dpp v65, v25 row_newbcast:4 row_mask:0xf bank_mask:0xf
    v_mov_b32_dpp v66, v26 row_newbcast:4 row_mask:0xf bank_mask:0xf
    v_mov_b32_dpp v67, v27 row_newbcast:4 row_mask:0xf bank_mask:0xf
    v_mul_f32 v82, v64, v47
    v_mul_f32 v83, v65, v47
    v_exp_f32 v82, v82
    v_fract_f32 v83, v83
    v_cos_f32 v74, v83
    v_sin_f32 v75, v83
    v_mul_f32 v74, v74, v82
    v_mul_f32 v75, v75, v82
    v_mul_f32 v84, v75, v75
    v_add_f32 v85, v74, v74
    v_fma_f32 v76, v74, v74, -v84
    v_mul_f32 v77, v85, v75
    v_mul_f32 v84, v77, v77
    v_add_f32 v85, v76, v76
    v_fma_f32 v78, v76, v76, -v84
    v_mul_f32 v79, v85, v77
    v_mul_f32 v84, v79, v79
    v_add_f32 v85, v78, v78
    v_fma_f32 v80, v78, v78, -v84
    v_mul_f32 v81, v85, v79
    v_mul_f32 v82, v64, v44
    v_mul_f32 v83, v65, v44
    v_exp_f32 v82, v82
    v_fract_f32 v83, v83
    v_cos_f32 v68, v83
    v_sin_f32 v69, v83
    v_mul_f32 v68, v68, v82
    v_mul_f32 v69, v69, v82
    v_mul_f32 v84, v67, v69
    v_mul_f32 v85, v67, v68
    v_fma_f32 v68, v66, v68, -v84
    v_fma_f32 v69, -v66, v69, -v85
    v_mul_f32 v82, v64, v45
    v_mul_f32 v83, v65, v45
    v_exp_f32 v82, v82
    v_fract_f32 v83, v83
    v_cos_f32 v70, v83
    v_sin_f32 v71, v83
    v_mul_f32 v70, v70, v82
    v_mul_f32 v71, v71, v82
    v_mul_f32 v84, v67, v71
    v_mul_f32 v85, v67, v70
    v_fma_f32 v70, v66, v70, -v84
    v_fma_f32 v71, -v66, v71, -v85
    v_mul_f32 v82, v64, v46
    v_mul_f32 v83, v65, v46
    v_exp_f32 v82, v82
    v_fract_f32 v83, v83
    v_cos_f32 v72, v83
    v_sin_f32 v73, v83
    v_mul_f32 v72, v72, v82
    v_mul_f32 v73, v73, v82
    v_mul_f32 v84, v67, v73
    v_mul_f32 v85, v67, v72
    v_fma_f32 v72, v66, v72, -v84
    v_fma_f32 v73, -v66, v73, -v85
    v_mfma_f32_16x16x4_f32 v[48:51], v68, v74, v[48:51]
    v_mfma_f32_16x16x4_f32 v[52:55], v70, v76, v[52:55]
    v_mfma_f32_16x16x4_f32 v[56:59], v70, v78, v[56:59]
    v_mfma_f32_16x16x4_f32 v[60:63], v72, v80, v[60:63]
    v_mfma_f32_16x16x4_f32 v[48:51], v69, v75, v[48:51]
    v_mfma_f32_16x16x4_f32 v[52:55], v71, v77, v[52:55]
    v_mfma_f32_16x16x4_f32 v[56:59], v71, v79, v[56:59]
    v_mfma_f32_16x16x4_f32 v[60:63], v73, v81, v[60:63]
    v_mov_b32_dpp v64, v24 row_newbcast:5 row_mask:0xf bank_mask:0xf
    v_mov_b32_dpp v65, v25 row_newbcast:5 row_mask:0xf bank_mask:0xf
    v_mov_b32_dpp v66, v26 row_newbcast:5 row_mask:0xf bank_mask:0xf
    v_mov_b32_dpp v67, v27 row_newbcast:5 row_mask:0xf bank_mask:0xf
    v_mul_f32 v82, v64, v47
    v_mul_f32 v83, v65, v47
    v_exp_f32 v82, v82
    v_fract_f32 v83, v83
    v_cos_f32 v74, v83
    v_sin_f32 v75, v83
    v_mul_f32 v74, v74, v82
    v_mul_f32 v75, v75, v82
    v_mul_f32 v84, v75, v75
    v_add_f32 v85, v74, v74
    v_fma_f32 v76, v74, v74, -v84
    v_mul_f32 v77, v85, v75
    v_mul_f32 v84, v77, v77
    v_add_f32 v85, v76, v76
    v_fma_f32 v78, v76, v76, -v84
    v_mul_f32 v79, v85, v77
    v_mul_f32 v84, v79, v79
    v_add_f32 v85, v78, v78
    v_fma_f32 v80, v78, v78, -v84
    v_mul_f32 v81, v85, v79
    v_mul_f32 v82, v64, v44
    v_mul_f32 v83, v65, v44
    v_exp_f32 v82, v82
    v_fract_f32 v83, v83
    v_cos_f32 v68, v83
    v_sin_f32 v69, v83
    v_mul_f32 v68, v68, v82
    v_mul_f32 v69, v69, v82
    v_mul_f32 v84, v67, v69
    v_mul_f32 v85, v67, v68
    v_fma_f32 v68, v66, v68, -v84
    v_fma_f32 v69, -v66, v69, -v85
    v_mul_f32 v82, v64, v45
    v_mul_f32 v83, v65, v45
    v_exp_f32 v82, v82
    v_fract_f32 v83, v83
    v_cos_f32 v70, v83
    v_sin_f32 v71, v83
    v_mul_f32 v70, v70, v82
    v_mul_f32 v71, v71, v82
    v_mul_f32 v84, v67, v71
    v_mul_f32 v85, v67, v70
    v_fma_f32 v70, v66, v70, -v84
    v_fma_f32 v71, -v66, v71, -v85
    v_mul_f32 v82, v64, v46
    v_mul_f32 v83, v65, v46
    v_exp_f32 v82, v82
    v_fract_f32 v83, v83
    v_cos_f32 v72, v83
    v_sin_f32 v73, v83
    v_mul_f32 v72, v72, v82
    v_mul_f32 v73, v73, v82
    v_mul_f32 v84, v67, v73
    v_mul_f32 v85, v67, v72
    v_fma_f32 v72, v66, v72, -v84
    v_fma_f32 v73, -v66, v73, -v85
    v_mfma_f32_16x16x4_f32 v[48:51], v68, v74, v[48:51]
    v_mfma_f32_16x16x4_f32 v[52:55], v70, v76, v[52:55]
    v_mfma_f32_16x16x4_f32 v[56:59], v70, v78, v[56:59]
    v_mfma_f32_16x16x4_f32 v[60:63], v72, v80, v[60:63]
    v_mfma_f32_16x16x4_f32 v[48:51], v69, v75, v[48:51]
    v_mfma_f32_16x16x4_f32 v[52:55], v71, v77, v[52:55]
    v_mfma_f32_16x16x4_f32 v[56:59], v71, v79, v[56:59]
    v_mfma_f32_16x16x4_f32 v[60:63], v73, v81, v[60:63]
    v_mov_b32_dpp v64, v24 row_newbcast:6 row_mask:0xf bank_mask:0xf
    v_mov_b32_dpp v65, v25 row_newbcast:6 row_mask:0xf bank_mask:0xf
    v_mov_b32_dpp v66, v26 row_newbcast:6 row_mask:0xf bank_mask:0xf
    v_mov_b32_dpp v67, v27 row_newbcast:6 row_mask:0xf bank_mask:0xf
    v_mul_f32 v82, v64, v47
    v_mul_f32 v83, v65, v47
    v_exp_f32 v82, v82
    v_fract_f32 v83, v83
    v_cos_f32 v74, v83
    v_sin_f32 v75, v83
    v_mul_f32 v74, v74, v82
    v_mul_f32 v75, v75, v82
    v_mul_f32 v84, v75, v75
    v_add_f32 v85, v74, v74
    v_fma_f32 v76, v74, v74, -v84
    v_mul_f32 v77, v85, v75
    v_mul_f32 v84, v77, v77
    v_add_f32 v85, v76, v76
    v_fma_f32 v78, v76, v76, -v84
    v_mul_f32 v79, v85, v77
    v_mul_f32 v84, v79, v79
    v_add_f32 v85, v78, v78
    v_fma_f32 v80, v78, v78, -v84
    v_mul_f32 v81, v85, v79
    v_mul_f32 v82, v64, v44
    v_mul_f32 v83, v65, v44
    v_exp_f32 v82, v82
    v_fract_f32 v83, v83
    v_cos_f32 v68, v83
    v_sin_f32 v69, v83
    v_mul_f32 v68, v68, v82
    v_mul_f32 v69, v69, v82
    v_mul_f32 v84, v67, v69
    v_mul_f32 v85, v67, v68
    v_fma_f32 v68, v66, v68, -v84
    v_fma_f32 v69, -v66, v69, -v85
    v_mul_f32 v82, v64, v45
    v_mul_f32 v83, v65, v45
    v_exp_f32 v82, v82
    v_fract_f32 v83, v83
    v_cos_f32 v70, v83
    v_sin_f32 v71, v83
    v_mul_f32 v70, v70, v82
    v_mul_f32 v71, v71, v82
    v_mul_f32 v84, v67, v71
    v_mul_f32 v85, v67, v70
    v_fma_f32 v70, v66, v70, -v84
    v_fma_f32 v71, -v66, v71, -v85
    v_mul_f32 v82, v64, v46
    v_mul_f32 v83, v65, v46
    v_exp_f32 v82, v82
    v_fract_f32 v83, v83
    v_cos_f32 v72, v83
    v_sin_f32 v73, v83
    v_mul_f32 v72, v72, v82
    v_mul_f32 v73, v73, v82
    v_mul_f32 v84, v67, v73
    v_mul_f32 v85, v67, v72
    v_fma_f32 v72, v66, v72, -v84
    v_fma_f32 v73, -v66, v73, -v85
    v_mfma_f32_16x16x4_f32 v[48:51], v68, v74, v[48:51]
    v_mfma_f32_16x16x4_f32 v[52:55], v70, v76, v[52:55]
    v_mfma_f32_16x16x4_f32 v[56:59], v70, v78, v[56:59]
    v_mfma_f32_16x16x4_f32 v[60:63], v72, v80, v[60:63]
    v_mfma_f32_16x16x4_f32 v[48:51], v69, v75, v[48:51]
    v_mfma_f32_16x16x4_f32 v[52:55], v71, v77, v[52:55]
    v_mfma_f32_16x16x4_f32 v[56:59], v71, v79, v[56:59]
    v_mfma_f32_16x16x4_f32 v[60:63], v73, v81, v[60:63]
    v_mov_b32_dpp v64, v24 row_newbcast:7 row_mask:0xf bank_mask:0xf
    v_mov_b32_dpp v65, v25 row_newbcast:7 row_mask:0xf bank_mask:0xf
    v_mov_b32_dpp v66, v26 row_newbcast:7 row_mask:0xf bank_mask:0xf
    v_mov_b32_dpp v67, v27 row_newbcast:7 row_mask:0xf bank_mask:0xf
    v_mul_f32 v82, v64, v47
    v_mul_f32 v83, v65, v47
    v_exp_f32 v82, v82
    v_fract_f32 v83, v83
    v_cos_f32 v74, v83
    v_sin_f32 v75, v83
    v_mul_f32 v74, v74, v82
    v_mul_f32 v75, v75, v82
    v_mul_f32 v84, v75, v75
    v_add_f32 v85, v74, v74
    v_fma_f32 v76, v74, v74, -v84
    v_mul_f32 v77, v85, v75
    v_mul_f32 v84, v77, v77
    v_add_f32 v85, v76, v76
    v_fma_f32 v78, v76, v76, -v84
    v_mul_f32 v79, v85, v77
    v_mul_f32 v84, v79, v79
    v_add_f32 v85, v78, v78
    v_fma_f32 v80, v78, v78, -v84
    v_mul_f32 v81, v85, v79
    v_mul_f32 v82, v64, v44
    v_mul_f32 v83, v65, v44
    v_exp_f32 v82, v82
    v_fract_f32 v83, v83
    v_cos_f32 v68, v83
    v_sin_f32 v69, v83
    v_mul_f32 v68, v68, v82
    v_mul_f32 v69, v69, v82
    v_mul_f32 v84, v67, v69
    v_mul_f32 v85, v67, v68
    v_fma_f32 v68, v66, v68, -v84
    v_fma_f32 v69, -v66, v69, -v85
    v_mul_f32 v82, v64, v45
    v_mul_f32 v83, v65, v45
    v_exp_f32 v82, v82
    v_fract_f32 v83, v83
    v_cos_f32 v70, v83
    v_sin_f32 v71, v83
    v_mul_f32 v70, v70, v82
    v_mul_f32 v71, v71, v82
    v_mul_f32 v84, v67, v71
    v_mul_f32 v85, v67, v70
    v_fma_f32 v70, v66, v70, -v84
    v_fma_f32 v71, -v66, v71, -v85
    v_mul_f32 v82, v64, v46
    v_mul_f32 v83, v65, v46
    v_exp_f32 v82, v82
    v_fract_f32 v83, v83
    v_cos_f32 v72, v83
    v_sin_f32 v73, v83
    v_mul_f32 v72, v72, v82
    v_mul_f32 v73, v73, v82
    v_mul_f32 v84, v67, v73
    v_mul_f32 v85, v67, v72
    v_fma_f32 v72, v66, v72, -v84
    v_fma_f32 v73, -v66, v73, -v85
    v_mfma_f32_16x16x4_f32 v[48:51], v68, v74, v[48:51]
    v_mfma_f32_16x16x4_f32 v[52:55], v70, v76, v[52:55]
    v_mfma_f32_16x16x4_f32 v[56:59], v70, v78, v[56:59]
    v_mfma_f32_16x16x4_f32 v[60:63], v72, v80, v[60:63]
    v_mfma_f32_16x16x4_f32 v[48:51], v69, v75, v[48:51]
    v_mfma_f32_16x16x4_f32 v[52:55], v71, v77, v[52:55]
    v_mfma_f32_16x16x4_f32 v[56:59], v71, v79, v[56:59]
    v_mfma_f32_16x16x4_f32 v[60:63], v73, v81, v[60:63]
    v_mov_b32_dpp v64, v24 row_newbcast:8 row_mask:0xf bank_mask:0xf
    v_mov_b32_dpp v65, v25 row_newbcast:8 row_mask:0xf bank_mask:0xf
    v_mov_b32_dpp v66, v26 row_newbcast:8 row_mask:0xf bank_mask:0xf
    v_mov_b32_dpp v67, v27 row_newbcast:8 row_mask:0xf bank_mask:0xf
    v_mul_f32 v82, v64, v47
    v_mul_f32 v83, v65, v47
    v_exp_f32 v82, v82
    v_fract_f32 v83, v83
    v_cos_f32 v74, v83
    v_sin_f32 v75, v83
    v_mul_f32 v74, v74, v82
    v_mul_f32 v75, v75, v82
    v_mul_f32 v84, v75, v75
    v_add_f32 v85, v74, v74
    v_fma_f32 v76, v74, v74, -v84
    v_mul_f32 v77, v85, v75
    v_mul_f32 v84, v77, v77
    v_add_f32 v85, v76, v76
    v_fma_f32 v78, v76, v76, -v84
    v_mul_f32 v79, v85, v77
    v_mul_f32 v84, v79, v79
    v_add_f32 v85, v78, v78
    v_fma_f32 v80, v78, v78, -v84
    v_mul_f32 v81, v85, v79
    v_mul_f32 v82, v64, v44
    v_mul_f32 v83, v65, v44
    v_exp_f32 v82, v82
    v_fract_f32 v83, v83
    v_cos_f32 v68, v83
    v_sin_f32 v69, v83
    v_mul_f32 v68, v68, v82
    v_mul_f32 v69, v69, v82
    v_mul_f32 v84, v67, v69
    v_mul_f32 v85, v67, v68
    v_fma_f32 v68, v66, v68, -v84
    v_fma_f32 v69, -v66, v69, -v85
    v_mul_f32 v82, v64, v45
    v_mul_f32 v83, v65, v45
    v_exp_f32 v82, v82
    v_fract_f32 v83, v83
    v_cos_f32 v70, v83
    v_sin_f32 v71, v83
    v_mul_f32 v70, v70, v82
    v_mul_f32 v71, v71, v82
    v_mul_f32 v84, v67, v71
    v_mul_f32 v85, v67, v70
    v_fma_f32 v70, v66, v70, -v84
    v_fma_f32 v71, -v66, v71, -v85
    v_mul_f32 v82, v64, v46
    v_mul_f32 v83, v65, v46
    v_exp_f32 v82, v82
    v_fract_f32 v83, v83
    v_cos_f32 v72, v83
    v_sin_f32 v73, v83
    v_mul_f32 v72, v72, v82
    v_mul_f32 v73, v73, v82
    v_mul_f32 v84, v67, v73
    v_mul_f32 v85, v67, v72
    v_fma_f32 v72, v66, v72, -v84
    v_fma_f32 v73, -v66, v73, -v85
    v_mfma_f32_16x16x4_f32 v[48:51], v68, v74, v[48:51]
    v_mfma_f32_16x16x4_f32 v[52:55], v70, v76, v[52:55]
    v_mfma_f32_16x16x4_f32 v[56:59], v70, v78, v[56:59]
    v_mfma_f32_16x16x4_f32 v[60:63], v72, v80, v[60:63]
    v_mfma_f32_16x16x4_f32 v[48:51], v69, v75, v[48:51]
    v_mfma_f32_16x16x4_f32 v[52:55], v71, v77, v[52:55]
    v_mfma_f32_16x16x4_f32 v[56:59], v71, v79, v[56:59]
    v_mfma_f32_16x16x4_f32 v[60:63], v73, v81, v[60:63]
    v_mov_b32_dpp v64, v24 row_newbcast:9 row_mask:0xf bank_mask:0xf
    v_mov_b32_dpp v65, v25 row_newbcast:9 row_mask:0xf bank_mask:0xf
    v_mov_b32_dpp v66, v26 row_newbcast:9 row_mask:0xf bank_mask:0xf
    v_mov_b32_dpp v67, v27 row_newbcast:9 row_mask:0xf bank_mask:0xf
    v_mul_f32 v82, v64, v47
    v_mul_f32 v83, v65, v47
    v_exp_f32 v82, v82
    v_fract_f32 v83, v83
    v_cos_f32 v74, v83
    v_sin_f32 v75, v83
    v_mul_f32 v74, v74, v82
    v_mul_f32 v75, v75, v82
    v_mul_f32 v84, v75, v75
    v_add_f32 v85, v74, v74
    v_fma_f32 v76, v74, v74, -v84
    v_mul_f32 v77, v85, v75
    v_mul_f32 v84, v77, v77
    v_add_f32 v85, v76, v76
    v_fma_f32 v78, v76, v76, -v84
    v_mul_f32 v79, v85, v77
    v_mul_f32 v84, v79, v79
    v_add_f32 v85, v78, v78
    v_fma_f32 v80, v78, v78, -v84
    v_mul_f32 v81, v85, v79
    v_mul_f32 v82, v64, v44
    v_mul_f32 v83, v65, v44
    v_exp_f32 v82, v82
    v_fract_f32 v83, v83
    v_cos_f32 v68, v83
    v_sin_f32 v69, v83
    v_mul_f32 v68, v68, v82
    v_mul_f32 v69, v69, v82
    v_mul_f32 v84, v67, v69
    v_mul_f32 v85, v67, v68
    v_fma_f32 v68, v66, v68, -v84
    v_fma_f32 v69, -v66, v69, -v85
    v_mul_f32 v82, v64, v45
    v_mul_f32 v83, v65, v45
    v_exp_f32 v82, v82
    v_fract_f32 v83, v83
    v_cos_f32 v70, v83
    v_sin_f32 v71, v83
    v_mul_f32 v70, v70, v82
    v_mul_f32 v71, v71, v82
    v_mul_f32 v84, v67, v71
    v_mul_f32 v85, v67, v70
    v_fma_f32 v70, v66, v70, -v84
    v_fma_f32 v71, -v66, v71, -v85
    v_mul_f32 v82, v64, v46
    v_mul_f32 v83, v65, v46
    v_exp_f32 v82, v82
    v_fract_f32 v83, v83
    v_cos_f32 v72, v83
    v_sin_f32 v73, v83
    v_mul_f32 v72, v72, v82
    v_mul_f32 v73, v73, v82
    v_mul_f32 v84, v67, v73
    v_mul_f32 v85, v67, v72
    v_fma_f32 v72, v66, v72, -v84
    v_fma_f32 v73, -v66, v73, -v85
    v_mfma_f32_16x16x4_f32 v[48:51], v68, v74, v[48:51]
    v_mfma_f32_16x16x4_f32 v[52:55], v70, v76, v[52:55]
    v_mfma_f32_16x16x4_f32 v[56:59], v70, v78, v[56:59]
    v_mfma_f32_16x16x4_f32 v[60:63], v72, v80, v[60:63]
    v_mfma_f32_16x16x4_f32 v[48:51], v69, v75, v[48:51]
    v_mfma_f32_16x16x4_f32 v[52:55], v71, v77, v[52:55]
    v_mfma_f32_16x16x4_f32 v[56:59], v71, v79, v[56:59]
    v_mfma_f32_16x16x4_f32 v[60:63], v73, v81, v[60:63]
    v_mov_b32_dpp v64, v24 row_newbcast:10 row_mask:0xf bank_mask:0xf
    v_mov_b32_dpp v65, v25 row_newbcast:10 row_mask:0xf bank_mask:0xf
    v_mov_b32_dpp v66, v26 row_newbcast:10 row_mask:0xf bank_mask:0xf
    v_mov_b32_dpp v67, v27 row_newbcast:10 row_mask:0xf bank_mask:0xf
    v_mul_f32 v82, v64, v47
    v_mul_f32 v83, v65, v47
    v_exp_f32 v82, v82
    v_fract_f32 v83, v83
    v_cos_f32 v74, v83
    v_sin_f32 v75, v83
    v_mul_f32 v74, v74, v82
    v_mul_f32 v75, v75, v82
    v_mul_f32 v84, v75, v75
    v_add_f32 v85, v74, v74
    v_fma_f32 v76, v74, v74, -v84
    v_mul_f32 v77, v85, v75
    v_mul_f32 v84, v77, v77
    v_add_f32 v85, v76, v76
    v_fma_f32 v78, v76, v76, -v84
    v_mul_f32 v79, v85, v77
    v_mul_f32 v84, v79, v79
    v_add_f32 v85, v78, v78
    v_fma_f32 v80, v78, v78, -v84
    v_mul_f32 v81, v85, v79
    v_mul_f32 v82, v64, v44
    v_mul_f32 v83, v65, v44
    v_exp_f32 v82, v82
    v_fract_f32 v83, v83
    v_cos_f32 v68, v83
    v_sin_f32 v69, v83
    v_mul_f32 v68, v68, v82
    v_mul_f32 v69, v69, v82
    v_mul_f32 v84, v67, v69
    v_mul_f32 v85, v67, v68
    v_fma_f32 v68, v66, v68, -v84
    v_fma_f32 v69, -v66, v69, -v85
    v_mul_f32 v82, v64, v45
    v_mul_f32 v83, v65, v45
    v_exp_f32 v82, v82
    v_fract_f32 v83, v83
    v_cos_f32 v70, v83
    v_sin_f32 v71, v83
    v_mul_f32 v70, v70, v82
    v_mul_f32 v71, v71, v82
    v_mul_f32 v84, v67, v71
    v_mul_f32 v85, v67, v70
    v_fma_f32 v70, v66, v70, -v84
    v_fma_f32 v71, -v66, v71, -v85
    v_mul_f32 v82, v64, v46
    v_mul_f32 v83, v65, v46
    v_exp_f32 v82, v82
    v_fract_f32 v83, v83
    v_cos_f32 v72, v83
    v_sin_f32 v73, v83
    v_mul_f32 v72, v72, v82
    v_mul_f32 v73, v73, v82
    v_mul_f32 v84, v67, v73
    v_mul_f32 v85, v67, v72
    v_fma_f32 v72, v66, v72, -v84
    v_fma_f32 v73, -v66, v73, -v85
    v_mfma_f32_16x16x4_f32 v[48:51], v68, v74, v[48:51]
    v_mfma_f32_16x16x4_f32 v[52:55], v70, v76, v[52:55]
    v_mfma_f32_16x16x4_f32 v[56:59], v70, v78, v[56:59]
    v_mfma_f32_16x16x4_f32 v[60:63], v72, v80, v[60:63]
    v_mfma_f32_16x16x4_f32 v[48:51], v69, v75, v[48:51]
    v_mfma_f32_16x16x4_f32 v[52:55], v71, v77, v[52:55]
    v_mfma_f32_16x16x4_f32 v[56:59], v71, v79, v[56:59]
    v_mfma_f32_16x16x4_f32 v[60:63], v73, v81, v[60:63]
    v_mov_b32_dpp v64, v24 row_newbcast:11 row_mask:0xf bank_mask:0xf
    v_mov_b32_dpp v65, v25 row_newbcast:11 row_mask:0xf bank_mask:0xf
    v_mov_b32_dpp v66, v26 row_newbcast:11 row_mask:0xf bank_mask:0xf
    v_mov_b32_dpp v67, v27 row_newbcast:11 row_mask:0xf bank_mask:0xf
    v_mul_f32 v82, v64, v47
    v_mul_f32 v83, v65, v47
    v_exp_f32 v82, v82
    v_fract_f32 v83, v83
    v_cos_f32 v74, v83
    v_sin_f32 v75, v83
    v_mul_f32 v74, v74, v82
    v_mul_f32 v75, v75, v82
    v_mul_f32 v84, v75, v75
    v_add_f32 v85, v74, v74
    v_fma_f32 v76, v74, v74, -v84
    v_mul_f32 v77, v85, v75
    v_mul_f32 v84, v77, v77
    v_add_f32 v85, v76, v76
    v_fma_f32 v78, v76, v76, -v84
    v_mul_f32 v79, v85, v77
    v_mul_f32 v84, v79, v79
    v_add_f32 v85, v78, v78
    v_fma_f32 v80, v78, v78, -v84
    v_mul_f32 v81, v85, v79
    v_mul_f32 v82, v64, v44
    v_mul_f32 v83, v65, v44
    v_exp_f32 v82, v82
    v_fract_f32 v83, v83
    v_cos_f32 v68, v83
    v_sin_f32 v69, v83
    v_mul_f32 v68, v68, v82
    v_mul_f32 v69, v69, v82
    v_mul_f32 v84, v67, v69
    v_mul_f32 v85, v67, v68
    v_fma_f32 v68, v66, v68, -v84
    v_fma_f32 v69, -v66, v69, -v85
    v_mul_f32 v82, v64, v45
    v_mul_f32 v83, v65, v45
    v_exp_f32 v82, v82
    v_fract_f32 v83, v83
    v_cos_f32 v70, v83
    v_sin_f32 v71, v83
    v_mul_f32 v70, v70, v82
    v_mul_f32 v71, v71, v82
    v_mul_f32 v84, v67, v71
    v_mul_f32 v85, v67, v70
    v_fma_f32 v70, v66, v70, -v84
    v_fma_f32 v71, -v66, v71, -v85
    v_mul_f32 v82, v64, v46
    v_mul_f32 v83, v65, v46
    v_exp_f32 v82, v82
    v_fract_f32 v83, v83
    v_cos_f32 v72, v83
    v_sin_f32 v73, v83
    v_mul_f32 v72, v72, v82
    v_mul_f32 v73, v73, v82
    v_mul_f32 v84, v67, v73
    v_mul_f32 v85, v67, v72
    v_fma_f32 v72, v66, v72, -v84
    v_fma_f32 v73, -v66, v73, -v85
    v_mfma_f32_16x16x4_f32 v[48:51], v68, v74, v[48:51]
    v_mfma_f32_16x16x4_f32 v[52:55], v70, v76, v[52:55]
    v_mfma_f32_16x16x4_f32 v[56:59], v70, v78, v[56:59]
    v_mfma_f32_16x16x4_f32 v[60:63], v72, v80, v[60:63]
    v_mfma_f32_16x16x4_f32 v[48:51], v69, v75, v[48:51]
    v_mfma_f32_16x16x4_f32 v[52:55], v71, v77, v[52:55]
    v_mfma_f32_16x16x4_f32 v[56:59], v71, v79, v[56:59]
    v_mfma_f32_16x16x4_f32 v[60:63], v73, v81, v[60:63]
    v_mov_b32_dpp v64, v24 row_newbcast:12 row_mask:0xf bank_mask:0xf
    v_mov_b32_dpp v65, v25 row_newbcast:12 row_mask:0xf bank_mask:0xf
    v_mov_b32_dpp v66, v26 row_newbcast:12 row_mask:0xf bank_mask:0xf
    v_mov_b32_dpp v67, v27 row_newbcast:12 row_mask:0xf bank_mask:0xf
    v_mul_f32 v82, v64, v47
    v_mul_f32 v83, v65, v47
    v_exp_f32 v82, v82
    v_fract_f32 v83, v83
    v_cos_f32 v74, v83
    v_sin_f32 v75, v83
    v_mul_f32 v74, v74, v82
    v_mul_f32 v75, v75, v82
    v_mul_f32 v84, v75, v75
    v_add_f32 v85, v74, v74
    v_fma_f32 v76, v74, v74, -v84
    v_mul_f32 v77, v85, v75
    v_mul_f32 v84, v77, v77
    v_add_f32 v85, v76, v76
    v_fma_f32 v78, v76, v76, -v84
    v_mul_f32 v79, v85, v77
    v_mul_f32 v84, v79, v79
    v_add_f32 v85, v78, v78
    v_fma_f32 v80, v78, v78, -v84
    v_mul_f32 v81, v85, v79
    v_mul_f32 v82, v64, v44
    v_mul_f32 v83, v65, v44
    v_exp_f32 v82, v82
    v_fract_f32 v83, v83
    v_cos_f32 v68, v83
    v_sin_f32 v69, v83
    v_mul_f32 v68, v68, v82
    v_mul_f32 v69, v69, v82
    v_mul_f32 v84, v67, v69
    v_mul_f32 v85, v67, v68
    v_fma_f32 v68, v66, v68, -v84
    v_fma_f32 v69, -v66, v69, -v85
    v_mul_f32 v82, v64, v45
    v_mul_f32 v83, v65, v45
    v_exp_f32 v82, v82
    v_fract_f32 v83, v83
    v_cos_f32 v70, v83
    v_sin_f32 v71, v83
    v_mul_f32 v70, v70, v82
    v_mul_f32 v71, v71, v82
    v_mul_f32 v84, v67, v71
    v_mul_f32 v85, v67, v70
    v_fma_f32 v70, v66, v70, -v84
    v_fma_f32 v71, -v66, v71, -v85
    v_mul_f32 v82, v64, v46
    v_mul_f32 v83, v65, v46
    v_exp_f32 v82, v82
    v_fract_f32 v83, v83
    v_cos_f32 v72, v83
    v_sin_f32 v73, v83
    v_mul_f32 v72, v72, v82
    v_mul_f32 v73, v73, v82
    v_mul_f32 v84, v67, v73
    v_mul_f32 v85, v67, v72
    v_fma_f32 v72, v66, v72, -v84
    v_fma_f32 v73, -v66, v73, -v85
    v_mfma_f32_16x16x4_f32 v[48:51], v68, v74, v[48:51]
    v_mfma_f32_16x16x4_f32 v[52:55], v70, v76, v[52:55]
    v_mfma_f32_16x16x4_f32 v[56:59], v70, v78, v[56:59]
    v_mfma_f32_16x16x4_f32 v[60:63], v72, v80, v[60:63]
    v_mfma_f32_16x16x4_f32 v[48:51], v69, v75, v[48:51]
    v_mfma_f32_16x16x4_f32 v[52:55], v71, v77, v[52:55]
    v_mfma_f32_16x16x4_f32 v[56:59], v71, v79, v[56:59]
    v_mfma_f32_16x16x4_f32 v[60:63], v73, v81, v[60:63]
    v_mov_b32_dpp v64, v24 row_newbcast:13 row_mask:0xf bank_mask:0xf
    v_mov_b32_dpp v65, v25 row_newbcast:13 row_mask:0xf bank_mask:0xf
    v_mov_b32_dpp v66, v26 row_newbcast:13 row_mask:0xf bank_mask:0xf
    v_mov_b32_dpp v67, v27 row_newbcast:13 row_mask:0xf bank_mask:0xf
    v_mul_f32 v82, v64, v47
    v_mul_f32 v83, v65, v47
    v_exp_f32 v82, v82
    v_fract_f32 v83, v83
    v_cos_f32 v74, v83
    v_sin_f32 v75, v83
    v_mul_f32 v74, v74, v82
    v_mul_f32 v75, v75, v82
    v_mul_f32 v84, v75, v75
    v_add_f32 v85, v74, v74
    v_fma_f32 v76, v74, v74, -v84
    v_mul_f32 v77, v85, v75
    v_mul_f32 v84, v77, v77
    v_add_f32 v85, v76, v76
    v_fma_f32 v78, v76, v76, -v84
    v_mul_f32 v79, v85, v77
    v_mul_f32 v84, v79, v79
    v_add_f32 v85, v78, v78
    v_fma_f32 v80, v78, v78, -v84
    v_mul_f32 v81, v85, v79
    v_mul_f32 v82, v64, v44
    v_mul_f32 v83, v65, v44
    v_exp_f32 v82, v82
    v_fract_f32 v83, v83
    v_cos_f32 v68, v83
    v_sin_f32 v69, v83
    v_mul_f32 v68, v68, v82
    v_mul_f32 v69, v69, v82
    v_mul_f32 v84, v67, v69
    v_mul_f32 v85, v67, v68
    v_fma_f32 v68, v66, v68, -v84
    v_fma_f32 v69, -v66, v69, -v85
    v_mul_f32 v82, v64, v45
    v_mul_f32 v83, v65, v45
    v_exp_f32 v82, v82
    v_fract_f32 v83, v83
    v_cos_f32 v70, v83
    v_sin_f32 v71, v83
    v_mul_f32 v70, v70, v82
    v_mul_f32 v71, v71, v82
    v_mul_f32 v84, v67, v71
    v_mul_f32 v85, v67, v70
    v_fma_f32 v70, v66, v70, -v84
    v_fma_f32 v71, -v66, v71, -v85
    v_mul_f32 v82, v64, v46
    v_mul_f32 v83, v65, v46
    v_exp_f32 v82, v82
    v_fract_f32 v83, v83
    v_cos_f32 v72, v83
    v_sin_f32 v73, v83
    v_mul_f32 v72, v72, v82
    v_mul_f32 v73, v73, v82
    v_mul_f32 v84, v67, v73
    v_mul_f32 v85, v67, v72
    v_fma_f32 v72, v66, v72, -v84
    v_fma_f32 v73, -v66, v73, -v85
    v_mfma_f32_16x16x4_f32 v[48:51], v68, v74, v[48:51]
    v_mfma_f32_16x16x4_f32 v[52:55], v70, v76, v[52:55]
    v_mfma_f32_16x16x4_f32 v[56:59], v70, v78, v[56:59]
    v_mfma_f32_16x16x4_f32 v[60:63], v72, v80, v[60:63]
    v_mfma_f32_16x16x4_f32 v[48:51], v69, v75, v[48:51]
    v_mfma_f32_16x16x4_f32 v[52:55], v71, v77, v[52:55]
    v_mfma_f32_16x16x4_f32 v[56:59], v71, v79, v[56:59]
    v_mfma_f32_16x16x4_f32 v[60:63], v73, v81, v[60:63]
    v_mov_b32_dpp v64, v24 row_newbcast:14 row_mask:0xf bank_mask:0xf
    v_mov_b32_dpp v65, v25 row_newbcast:14 row_mask:0xf bank_mask:0xf
    v_mov_b32_dpp v66, v26 row_newbcast:14 row_mask:0xf bank_mask:0xf
    v_mov_b32_dpp v67, v27 row_newbcast:14 row_mask:0xf bank_mask:0xf
    v_mul_f32 v82, v64, v47
    v_mul_f32 v83, v65, v47
    v_exp_f32 v82, v82
    v_fract_f32 v83, v83
    v_cos_f32 v74, v83
    v_sin_f32 v75, v83
    v_mul_f32 v74, v74, v82
    v_mul_f32 v75, v75, v82
    v_mul_f32 v84, v75, v75
    v_add_f32 v85, v74, v74
    v_fma_f32 v76, v74, v74, -v84
    v_mul_f32 v77, v85, v75
    v_mul_f32 v84, v77, v77
    v_add_f32 v85, v76, v76
    v_fma_f32 v78, v76, v76, -v84
    v_mul_f32 v79, v85, v77
    v_mul_f32 v84, v79, v79
    v_add_f32 v85, v78, v78
    v_fma_f32 v80, v78, v78, -v84
    v_mul_f32 v81, v85, v79
    v_mul_f32 v82, v64, v44
    v_mul_f32 v83, v65, v44
    v_exp_f32 v82, v82
    v_fract_f32 v83, v83
    v_cos_f32 v68, v83
    v_sin_f32 v69, v83
    v_mul_f32 v68, v68, v82
    v_mul_f32 v69, v69, v82
    v_mul_f32 v84, v67, v69
    v_mul_f32 v85, v67, v68
    v_fma_f32 v68, v66, v68, -v84
    v_fma_f32 v69, -v66, v69, -v85
    v_mul_f32 v82, v64, v45
    v_mul_f32 v83, v65, v45
    v_exp_f32 v82, v82
    v_fract_f32 v83, v83
    v_cos_f32 v70, v83
    v_sin_f32 v71, v83
    v_mul_f32 v70, v70, v82
    v_mul_f32 v71, v71, v82
    v_mul_f32 v84, v67, v71
    v_mul_f32 v85, v67, v70
    v_fma_f32 v70, v66, v70, -v84
    v_fma_f32 v71, -v66, v71, -v85
    v_mul_f32 v82, v64, v46
    v_mul_f32 v83, v65, v46
    v_exp_f32 v82, v82
    v_fract_f32 v83, v83
    v_cos_f32 v72, v83
    v_sin_f32 v73, v83
    v_mul_f32 v72, v72, v82
    v_mul_f32 v73, v73, v82
    v_mul_f32 v84, v67, v73
    v_mul_f32 v85, v67, v72
    v_fma_f32 v72, v66, v72, -v84
    v_fma_f32 v73, -v66, v73, -v85
    v_mfma_f32_16x16x4_f32 v[48:51], v68, v74, v[48:51]
    v_mfma_f32_16x16x4_f32 v[52:55], v70, v76, v[52:55]
    v_mfma_f32_16x16x4_f32 v[56:59], v70, v78, v[56:59]
    v_mfma_f32_16x16x4_f32 v[60:63], v72, v80, v[60:63]
    v_mfma_f32_16x16x4_f32 v[48:51], v69, v75, v[48:51]
    v_mfma_f32_16x16x4_f32 v[52:55], v71, v77, v[52:55]
    v_mfma_f32_16x16x4_f32 v[56:59], v71, v79, v[56:59]
    v_mfma_f32_16x16x4_f32 v[60:63], v73, v81, v[60:63]
    v_mov_b32_dpp v64, v24 row_newbcast:15 row_mask:0xf bank_mask:0xf
    v_mov_b32_dpp v65, v25 row_newbcast:15 row_mask:0xf bank_mask:0xf
    v_mov_b32_dpp v66, v26 row_newbcast:15 row_mask:0xf bank_mask:0xf
    v_mov_b32_dpp v67, v27 row_newbcast:15 row_mask:0xf bank_mask:0xf
    v_mul_f32 v82, v64, v47
    v_mul_f32 v83, v65, v47
    v_exp_f32 v82, v82
    v_fract_f32 v83, v83
    v_cos_f32 v74, v83
    v_sin_f32 v75, v83
    v_mul_f32 v74, v74, v82
    v_mul_f32 v75, v75, v82
    v_mul_f32 v84, v75, v75
    v_add_f32 v85, v74, v74
    v_fma_f32 v76, v74, v74, -v84
    v_mul_f32 v77, v85, v75
    v_mul_f32 v84, v77, v77
    v_add_f32 v85, v76, v76
    v_fma_f32 v78, v76, v76, -v84
    v_mul_f32 v79, v85, v77
    v_mul_f32 v84, v79, v79
    v_add_f32 v85, v78, v78
    v_fma_f32 v80, v78, v78, -v84
    v_mul_f32 v81, v85, v79
    v_mul_f32 v82, v64, v44
    v_mul_f32 v83, v65, v44
    v_exp_f32 v82, v82
    v_fract_f32 v83, v83
    v_cos_f32 v68, v83
    v_sin_f32 v69, v83
    v_mul_f32 v68, v68, v82
    v_mul_f32 v69, v69, v82
    v_mul_f32 v84, v67, v69
    v_mul_f32 v85, v67, v68
    v_fma_f32 v68, v66, v68, -v84
    v_fma_f32 v69, -v66, v69, -v85
    v_mul_f32 v82, v64, v45
    v_mul_f32 v83, v65, v45
    v_exp_f32 v82, v82
    v_fract_f32 v83, v83
    v_cos_f32 v70, v83
    v_sin_f32 v71, v83
    v_mul_f32 v70, v70, v82
    v_mul_f32 v71, v71, v82
    v_mul_f32 v84, v67, v71
    v_mul_f32 v85, v67, v70
    v_fma_f32 v70, v66, v70, -v84
    v_fma_f32 v71, -v66, v71, -v85
    v_mul_f32 v82, v64, v46
    v_mul_f32 v83, v65, v46
    v_exp_f32 v82, v82
    v_fract_f32 v83, v83
    v_cos_f32 v72, v83
    v_sin_f32 v73, v83
    v_mul_f32 v72, v72, v82
    v_mul_f32 v73, v73, v82
    v_mul_f32 v84, v67, v73
    v_mul_f32 v85, v67, v72
    v_fma_f32 v72, v66, v72, -v84
    v_fma_f32 v73, -v66, v73, -v85
    v_mfma_f32_16x16x4_f32 v[48:51], v68, v74, v[48:51]
    v_mfma_f32_16x16x4_f32 v[52:55], v70, v76, v[52:55]
    v_mfma_f32_16x16x4_f32 v[56:59], v70, v78, v[56:59]
    v_mfma_f32_16x16x4_f32 v[60:63], v72, v80, v[60:63]
    v_mfma_f32_16x16x4_f32 v[48:51], v69, v75, v[48:51]
    v_mfma_f32_16x16x4_f32 v[52:55], v71, v77, v[52:55]
    v_mfma_f32_16x16x4_f32 v[56:59], v71, v79, v[56:59]
    v_mfma_f32_16x16x4_f32 v[60:63], v73, v81, v[60:63]
    v_mov_b32_dpp v64, v28 row_newbcast:0 row_mask:0xf bank_mask:0xf
    v_mov_b32_dpp v65, v29 row_newbcast:0 row_mask:0xf bank_mask:0xf
    v_mov_b32_dpp v66, v30 row_newbcast:0 row_mask:0xf bank_mask:0xf
    v_mov_b32_dpp v67, v31 row_newbcast:0 row_mask:0xf bank_mask:0xf
    v_mul_f32 v82, v64, v47
    v_mul_f32 v83, v65, v47
    v_exp_f32 v82, v82
    v_fract_f32 v83, v83
    v_cos_f32 v74, v83
    v_sin_f32 v75, v83
    v_mul_f32 v74, v74, v82
    v_mul_f32 v75, v75, v82
    v_mul_f32 v84, v75, v75
    v_add_f32 v85, v74, v74
    v_fma_f32 v76, v74, v74, -v84
    v_mul_f32 v77, v85, v75
    v_mul_f32 v84, v77, v77
    v_add_f32 v85, v76, v76
    v_fma_f32 v78, v76, v76, -v84
    v_mul_f32 v79, v85, v77
    v_mul_f32 v84, v79, v79
    v_add_f32 v85, v78, v78
    v_fma_f32 v80, v78, v78, -v84
    v_mul_f32 v81, v85, v79
    v_mul_f32 v82, v64, v44
    v_mul_f32 v83, v65, v44
    v_exp_f32 v82, v82
    v_fract_f32 v83, v83
    v_cos_f32 v68, v83
    v_sin_f32 v69, v83
    v_mul_f32 v68, v68, v82
    v_mul_f32 v69, v69, v82
    v_mul_f32 v84, v67, v69
    v_mul_f32 v85, v67, v68
    v_fma_f32 v68, v66, v68, -v84
    v_fma_f32 v69, -v66, v69, -v85
    v_mul_f32 v82, v64, v45
    v_mul_f32 v83, v65, v45
    v_exp_f32 v82, v82
    v_fract_f32 v83, v83
    v_cos_f32 v70, v83
    v_sin_f32 v71, v83
    v_mul_f32 v70, v70, v82
    v_mul_f32 v71, v71, v82
    v_mul_f32 v84, v67, v71
    v_mul_f32 v85, v67, v70
    v_fma_f32 v70, v66, v70, -v84
    v_fma_f32 v71, -v66, v71, -v85
    v_mul_f32 v82, v64, v46
    v_mul_f32 v83, v65, v46
    v_exp_f32 v82, v82
    v_fract_f32 v83, v83
    v_cos_f32 v72, v83
    v_sin_f32 v73, v83
    v_mul_f32 v72, v72, v82
    v_mul_f32 v73, v73, v82
    v_mul_f32 v84, v67, v73
    v_mul_f32 v85, v67, v72
    v_fma_f32 v72, v66, v72, -v84
    v_fma_f32 v73, -v66, v73, -v85
    v_mfma_f32_16x16x4_f32 v[48:51], v68, v74, v[48:51]
    v_mfma_f32_16x16x4_f32 v[52:55], v70, v76, v[52:55]
    v_mfma_f32_16x16x4_f32 v[56:59], v70, v78, v[56:59]
    v_mfma_f32_16x16x4_f32 v[60:63], v72, v80, v[60:63]
    v_mfma_f32_16x16x4_f32 v[48:51], v69, v75, v[48:51]
    v_mfma_f32_16x16x4_f32 v[52:55], v71, v77, v[52:55]
    v_mfma_f32_16x16x4_f32 v[56:59], v71, v79, v[56:59]
    v_mfma_f32_16x16x4_f32 v[60:63], v73, v81, v[60:63]
    v_mov_b32_dpp v64, v28 row_newbcast:1 row_mask:0xf bank_mask:0xf
    v_mov_b32_dpp v65, v29 row_newbcast:1 row_mask:0xf bank_mask:0xf
    v_mov_b32_dpp v66, v30 row_newbcast:1 row_mask:0xf bank_mask:0xf
    v_mov_b32_dpp v67, v31 row_newbcast:1 row_mask:0xf bank_mask:0xf
    v_mul_f32 v82, v64, v47
    v_mul_f32 v83, v65, v47
    v_exp_f32 v82, v82
    v_fract_f32 v83, v83
    v_cos_f32 v74, v83
    v_sin_f32 v75, v83
    v_mul_f32 v74, v74, v82
    v_mul_f32 v75, v75, v82
    v_mul_f32 v84, v75, v75
    v_add_f32 v85, v74, v74
    v_fma_f32 v76, v74, v74, -v84
    v_mul_f32 v77, v85, v75
    v_mul_f32 v84, v77, v77
    v_add_f32 v85, v76, v76
    v_fma_f32 v78, v76, v76, -v84
    v_mul_f32 v79, v85, v77
    v_mul_f32 v84, v79, v79
    v_add_f32 v85, v78, v78
    v_fma_f32 v80, v78, v78, -v84
    v_mul_f32 v81, v85, v79
    v_mul_f32 v82, v64, v44
    v_mul_f32 v83, v65, v44
    v_exp_f32 v82, v82
    v_fract_f32 v83, v83
    v_cos_f32 v68, v83
    v_sin_f32 v69, v83
    v_mul_f32 v68, v68, v82
    v_mul_f32 v69, v69, v82
    v_mul_f32 v84, v67, v69
    v_mul_f32 v85, v67, v68
    v_fma_f32 v68, v66, v68, -v84
    v_fma_f32 v69, -v66, v69, -v85
    v_mul_f32 v82, v64, v45
    v_mul_f32 v83, v65, v45
    v_exp_f32 v82, v82
    v_fract_f32 v83, v83
    v_cos_f32 v70, v83
    v_sin_f32 v71, v83
    v_mul_f32 v70, v70, v82
    v_mul_f32 v71, v71, v82
    v_mul_f32 v84, v67, v71
    v_mul_f32 v85, v67, v70
    v_fma_f32 v70, v66, v70, -v84
    v_fma_f32 v71, -v66, v71, -v85
    v_mul_f32 v82, v64, v46
    v_mul_f32 v83, v65, v46
    v_exp_f32 v82, v82
    v_fract_f32 v83, v83
    v_cos_f32 v72, v83
    v_sin_f32 v73, v83
    v_mul_f32 v72, v72, v82
    v_mul_f32 v73, v73, v82
    v_mul_f32 v84, v67, v73
    v_mul_f32 v85, v67, v72
    v_fma_f32 v72, v66, v72, -v84
    v_fma_f32 v73, -v66, v73, -v85
    v_mfma_f32_16x16x4_f32 v[48:51], v68, v74, v[48:51]
    v_mfma_f32_16x16x4_f32 v[52:55], v70, v76, v[52:55]
    v_mfma_f32_16x16x4_f32 v[56:59], v70, v78, v[56:59]
    v_mfma_f32_16x16x4_f32 v[60:63], v72, v80, v[60:63]
    v_mfma_f32_16x16x4_f32 v[48:51], v69, v75, v[48:51]
    v_mfma_f32_16x16x4_f32 v[52:55], v71, v77, v[52:55]
    v_mfma_f32_16x16x4_f32 v[56:59], v71, v79, v[56:59]
    v_mfma_f32_16x16x4_f32 v[60:63], v73, v81, v[60:63]
    v_mov_b32_dpp v64, v28 row_newbcast:2 row_mask:0xf bank_mask:0xf
    v_mov_b32_dpp v65, v29 row_newbcast:2 row_mask:0xf bank_mask:0xf
    v_mov_b32_dpp v66, v30 row_newbcast:2 row_mask:0xf bank_mask:0xf
    v_mov_b32_dpp v67, v31 row_newbcast:2 row_mask:0xf bank_mask:0xf
    v_mul_f32 v82, v64, v47
    v_mul_f32 v83, v65, v47
    v_exp_f32 v82, v82
    v_fract_f32 v83, v83
    v_cos_f32 v74, v83
    v_sin_f32 v75, v83
    v_mul_f32 v74, v74, v82
    v_mul_f32 v75, v75, v82
    v_mul_f32 v84, v75, v75
    v_add_f32 v85, v74, v74
    v_fma_f32 v76, v74, v74, -v84
    v_mul_f32 v77, v85, v75
    v_mul_f32 v84, v77, v77
    v_add_f32 v85, v76, v76
    v_fma_f32 v78, v76, v76, -v84
    v_mul_f32 v79, v85, v77
    v_mul_f32 v84, v79, v79
    v_add_f32 v85, v78, v78
    v_fma_f32 v80, v78, v78, -v84
    v_mul_f32 v81, v85, v79
    v_mul_f32 v82, v64, v44
    v_mul_f32 v83, v65, v44
    v_exp_f32 v82, v82
    v_fract_f32 v83, v83
    v_cos_f32 v68, v83
    v_sin_f32 v69, v83
    v_mul_f32 v68, v68, v82
    v_mul_f32 v69, v69, v82
    v_mul_f32 v84, v67, v69
    v_mul_f32 v85, v67, v68
    v_fma_f32 v68, v66, v68, -v84
    v_fma_f32 v69, -v66, v69, -v85
    v_mul_f32 v82, v64, v45
    v_mul_f32 v83, v65, v45
    v_exp_f32 v82, v82
    v_fract_f32 v83, v83
    v_cos_f32 v70, v83
    v_sin_f32 v71, v83
    v_mul_f32 v70, v70, v82
    v_mul_f32 v71, v71, v82
    v_mul_f32 v84, v67, v71
    v_mul_f32 v85, v67, v70
    v_fma_f32 v70, v66, v70, -v84
    v_fma_f32 v71, -v66, v71, -v85
    v_mul_f32 v82, v64, v46
    v_mul_f32 v83, v65, v46
    v_exp_f32 v82, v82
    v_fract_f32 v83, v83
    v_cos_f32 v72, v83
    v_sin_f32 v73, v83
    v_mul_f32 v72, v72, v82
    v_mul_f32 v73, v73, v82
    v_mul_f32 v84, v67, v73
    v_mul_f32 v85, v67, v72
    v_fma_f32 v72, v66, v72, -v84
    v_fma_f32 v73, -v66, v73, -v85
    v_mfma_f32_16x16x4_f32 v[48:51], v68, v74, v[48:51]
    v_mfma_f32_16x16x4_f32 v[52:55], v70, v76, v[52:55]
    v_mfma_f32_16x16x4_f32 v[56:59], v70, v78, v[56:59]
    v_mfma_f32_16x16x4_f32 v[60:63], v72, v80, v[60:63]
    v_mfma_f32_16x16x4_f32 v[48:51], v69, v75, v[48:51]
    v_mfma_f32_16x16x4_f32 v[52:55], v71, v77, v[52:55]
    v_mfma_f32_16x16x4_f32 v[56:59], v71, v79, v[56:59]
    v_mfma_f32_16x16x4_f32 v[60:63], v73, v81, v[60:63]
    v_mov_b32_dpp v64, v28 row_newbcast:3 row_mask:0xf bank_mask:0xf
    v_mov_b32_dpp v65, v29 row_newbcast:3 row_mask:0xf bank_mask:0xf
    v_mov_b32_dpp v66, v30 row_newbcast:3 row_mask:0xf bank_mask:0xf
    v_mov_b32_dpp v67, v31 row_newbcast:3 row_mask:0xf bank_mask:0xf
    v_mul_f32 v82, v64, v47
    v_mul_f32 v83, v65, v47
    v_exp_f32 v82, v82
    v_fract_f32 v83, v83
    v_cos_f32 v74, v83
    v_sin_f32 v75, v83
    v_mul_f32 v74, v74, v82
    v_mul_f32 v75, v75, v82
    v_mul_f32 v84, v75, v75
    v_add_f32 v85, v74, v74
    v_fma_f32 v76, v74, v74, -v84
    v_mul_f32 v77, v85, v75
    v_mul_f32 v84, v77, v77
    v_add_f32 v85, v76, v76
    v_fma_f32 v78, v76, v76, -v84
    v_mul_f32 v79, v85, v77
    v_mul_f32 v84, v79, v79
    v_add_f32 v85, v78, v78
    v_fma_f32 v80, v78, v78, -v84
    v_mul_f32 v81, v85, v79
    v_mul_f32 v82, v64, v44
    v_mul_f32 v83, v65, v44
    v_exp_f32 v82, v82
    v_fract_f32 v83, v83
    v_cos_f32 v68, v83
    v_sin_f32 v69, v83
    v_mul_f32 v68, v68, v82
    v_mul_f32 v69, v69, v82
    v_mul_f32 v84, v67, v69
    v_mul_f32 v85, v67, v68
    v_fma_f32 v68, v66, v68, -v84
    v_fma_f32 v69, -v66, v69, -v85
    v_mul_f32 v82, v64, v45
    v_mul_f32 v83, v65, v45
    v_exp_f32 v82, v82
    v_fract_f32 v83, v83
    v_cos_f32 v70, v83
    v_sin_f32 v71, v83
    v_mul_f32 v70, v70, v82
    v_mul_f32 v71, v71, v82
    v_mul_f32 v84, v67, v71
    v_mul_f32 v85, v67, v70
    v_fma_f32 v70, v66, v70, -v84
    v_fma_f32 v71, -v66, v71, -v85
    v_mul_f32 v82, v64, v46
    v_mul_f32 v83, v65, v46
    v_exp_f32 v82, v82
    v_fract_f32 v83, v83
    v_cos_f32 v72, v83
    v_sin_f32 v73, v83
    v_mul_f32 v72, v72, v82
    v_mul_f32 v73, v73, v82
    v_mul_f32 v84, v67, v73
    v_mul_f32 v85, v67, v72
    v_fma_f32 v72, v66, v72, -v84
    v_fma_f32 v73, -v66, v73, -v85
    v_mfma_f32_16x16x4_f32 v[48:51], v68, v74, v[48:51]
    v_mfma_f32_16x16x4_f32 v[52:55], v70, v76, v[52:55]
    v_mfma_f32_16x16x4_f32 v[56:59], v70, v78, v[56:59]
    v_mfma_f32_16x16x4_f32 v[60:63], v72, v80, v[60:63]
    v_mfma_f32_16x16x4_f32 v[48:51], v69, v75, v[48:51]
    v_mfma_f32_16x16x4_f32 v[52:55], v71, v77, v[52:55]
    v_mfma_f32_16x16x4_f32 v[56:59], v71, v79, v[56:59]
    v_mfma_f32_16x16x4_f32 v[60:63], v73, v81, v[60:63]
    v_mov_b32_dpp v64, v28 row_newbcast:4 row_mask:0xf bank_mask:0xf
    v_mov_b32_dpp v65, v29 row_newbcast:4 row_mask:0xf bank_mask:0xf
    v_mov_b32_dpp v66, v30 row_newbcast:4 row_mask:0xf bank_mask:0xf
    v_mov_b32_dpp v67, v31 row_newbcast:4 row_mask:0xf bank_mask:0xf
    v_mul_f32 v82, v64, v47
    v_mul_f32 v83, v65, v47
    v_exp_f32 v82, v82
    v_fract_f32 v83, v83
    v_cos_f32 v74, v83
    v_sin_f32 v75, v83
    v_mul_f32 v74, v74, v82
    v_mul_f32 v75, v75, v82
    v_mul_f32 v84, v75, v75
    v_add_f32 v85, v74, v74
    v_fma_f32 v76, v74, v74, -v84
    v_mul_f32 v77, v85, v75
    v_mul_f32 v84, v77, v77
    v_add_f32 v85, v76, v76
    v_fma_f32 v78, v76, v76, -v84
    v_mul_f32 v79, v85, v77
    v_mul_f32 v84, v79, v79
    v_add_f32 v85, v78, v78
    v_fma_f32 v80, v78, v78, -v84
    v_mul_f32 v81, v85, v79
    v_mul_f32 v82, v64, v44
    v_mul_f32 v83, v65, v44
    v_exp_f32 v82, v82
    v_fract_f32 v83, v83
    v_cos_f32 v68, v83
    v_sin_f32 v69, v83
    v_mul_f32 v68, v68, v82
    v_mul_f32 v69, v69, v82
    v_mul_f32 v84, v67, v69
    v_mul_f32 v85, v67, v68
    v_fma_f32 v68, v66, v68, -v84
    v_fma_f32 v69, -v66, v69, -v85
    v_mul_f32 v82, v64, v45
    v_mul_f32 v83, v65, v45
    v_exp_f32 v82, v82
    v_fract_f32 v83, v83
    v_cos_f32 v70, v83
    v_sin_f32 v71, v83
    v_mul_f32 v70, v70, v82
    v_mul_f32 v71, v71, v82
    v_mul_f32 v84, v67, v71
    v_mul_f32 v85, v67, v70
    v_fma_f32 v70, v66, v70, -v84
    v_fma_f32 v71, -v66, v71, -v85
    v_mul_f32 v82, v64, v46
    v_mul_f32 v83, v65, v46
    v_exp_f32 v82, v82
    v_fract_f32 v83, v83
    v_cos_f32 v72, v83
    v_sin_f32 v73, v83
    v_mul_f32 v72, v72, v82
    v_mul_f32 v73, v73, v82
    v_mul_f32 v84, v67, v73
    v_mul_f32 v85, v67, v72
    v_fma_f32 v72, v66, v72, -v84
    v_fma_f32 v73, -v66, v73, -v85
    v_mfma_f32_16x16x4_f32 v[48:51], v68, v74, v[48:51]
    v_mfma_f32_16x16x4_f32 v[52:55], v70, v76, v[52:55]
    v_mfma_f32_16x16x4_f32 v[56:59], v70, v78, v[56:59]
    v_mfma_f32_16x16x4_f32 v[60:63], v72, v80, v[60:63]
    v_mfma_f32_16x16x4_f32 v[48:51], v69, v75, v[48:51]
    v_mfma_f32_16x16x4_f32 v[52:55], v71, v77, v[52:55]
    v_mfma_f32_16x16x4_f32 v[56:59], v71, v79, v[56:59]
    v_mfma_f32_16x16x4_f32 v[60:63], v73, v81, v[60:63]
    v_mov_b32_dpp v64, v28 row_newbcast:5 row_mask:0xf bank_mask:0xf
    v_mov_b32_dpp v65, v29 row_newbcast:5 row_mask:0xf bank_mask:0xf
    v_mov_b32_dpp v66, v30 row_newbcast:5 row_mask:0xf bank_mask:0xf
    v_mov_b32_dpp v67, v31 row_newbcast:5 row_mask:0xf bank_mask:0xf
    v_mul_f32 v82, v64, v47
    v_mul_f32 v83, v65, v47
    v_exp_f32 v82, v82
    v_fract_f32 v83, v83
    v_cos_f32 v74, v83
    v_sin_f32 v75, v83
    v_mul_f32 v74, v74, v82
    v_mul_f32 v75, v75, v82
    v_mul_f32 v84, v75, v75
    v_add_f32 v85, v74, v74
    v_fma_f32 v76, v74, v74, -v84
    v_mul_f32 v77, v85, v75
    v_mul_f32 v84, v77, v77
    v_add_f32 v85, v76, v76
    v_fma_f32 v78, v76, v76, -v84
    v_mul_f32 v79, v85, v77
    v_mul_f32 v84, v79, v79
    v_add_f32 v85, v78, v78
    v_fma_f32 v80, v78, v78, -v84
    v_mul_f32 v81, v85, v79
    v_mul_f32 v82, v64, v44
    v_mul_f32 v83, v65, v44
    v_exp_f32 v82, v82
    v_fract_f32 v83, v83
    v_cos_f32 v68, v83
    v_sin_f32 v69, v83
    v_mul_f32 v68, v68, v82
    v_mul_f32 v69, v69, v82
    v_mul_f32 v84, v67, v69
    v_mul_f32 v85, v67, v68
    v_fma_f32 v68, v66, v68, -v84
    v_fma_f32 v69, -v66, v69, -v85
    v_mul_f32 v82, v64, v45
    v_mul_f32 v83, v65, v45
    v_exp_f32 v82, v82
    v_fract_f32 v83, v83
    v_cos_f32 v70, v83
    v_sin_f32 v71, v83
    v_mul_f32 v70, v70, v82
    v_mul_f32 v71, v71, v82
    v_mul_f32 v84, v67, v71
    v_mul_f32 v85, v67, v70
    v_fma_f32 v70, v66, v70, -v84
    v_fma_f32 v71, -v66, v71, -v85
    v_mul_f32 v82, v64, v46
    v_mul_f32 v83, v65, v46
    v_exp_f32 v82, v82
    v_fract_f32 v83, v83
    v_cos_f32 v72, v83
    v_sin_f32 v73, v83
    v_mul_f32 v72, v72, v82
    v_mul_f32 v73, v73, v82
    v_mul_f32 v84, v67, v73
    v_mul_f32 v85, v67, v72
    v_fma_f32 v72, v66, v72, -v84
    v_fma_f32 v73, -v66, v73, -v85
    v_mfma_f32_16x16x4_f32 v[48:51], v68, v74, v[48:51]
    v_mfma_f32_16x16x4_f32 v[52:55], v70, v76, v[52:55]
    v_mfma_f32_16x16x4_f32 v[56:59], v70, v78, v[56:59]
    v_mfma_f32_16x16x4_f32 v[60:63], v72, v80, v[60:63]
    v_mfma_f32_16x16x4_f32 v[48:51], v69, v75, v[48:51]
    v_mfma_f32_16x16x4_f32 v[52:55], v71, v77, v[52:55]
    v_mfma_f32_16x16x4_f32 v[56:59], v71, v79, v[56:59]
    v_mfma_f32_16x16x4_f32 v[60:63], v73, v81, v[60:63]
    v_mov_b32_dpp v64, v28 row_newbcast:6 row_mask:0xf bank_mask:0xf
    v_mov_b32_dpp v65, v29 row_newbcast:6 row_mask:0xf bank_mask:0xf
    v_mov_b32_dpp v66, v30 row_newbcast:6 row_mask:0xf bank_mask:0xf
    v_mov_b32_dpp v67, v31 row_newbcast:6 row_mask:0xf bank_mask:0xf
    v_mul_f32 v82, v64, v47
    v_mul_f32 v83, v65, v47
    v_exp_f32 v82, v82
    v_fract_f32 v83, v83
    v_cos_f32 v74, v83
    v_sin_f32 v75, v83
    v_mul_f32 v74, v74, v82
    v_mul_f32 v75, v75, v82
    v_mul_f32 v84, v75, v75
    v_add_f32 v85, v74, v74
    v_fma_f32 v76, v74, v74, -v84
    v_mul_f32 v77, v85, v75
    v_mul_f32 v84, v77, v77
    v_add_f32 v85, v76, v76
    v_fma_f32 v78, v76, v76, -v84
    v_mul_f32 v79, v85, v77
    v_mul_f32 v84, v79, v79
    v_add_f32 v85, v78, v78
    v_fma_f32 v80, v78, v78, -v84
    v_mul_f32 v81, v85, v79
    v_mul_f32 v82, v64, v44
    v_mul_f32 v83, v65, v44
    v_exp_f32 v82, v82
    v_fract_f32 v83, v83
    v_cos_f32 v68, v83
    v_sin_f32 v69, v83
    v_mul_f32 v68, v68, v82
    v_mul_f32 v69, v69, v82
    v_mul_f32 v84, v67, v69
    v_mul_f32 v85, v67, v68
    v_fma_f32 v68, v66, v68, -v84
    v_fma_f32 v69, -v66, v69, -v85
    v_mul_f32 v82, v64, v45
    v_mul_f32 v83, v65, v45
    v_exp_f32 v82, v82
    v_fract_f32 v83, v83
    v_cos_f32 v70, v83
    v_sin_f32 v71, v83
    v_mul_f32 v70, v70, v82
    v_mul_f32 v71, v71, v82
    v_mul_f32 v84, v67, v71
    v_mul_f32 v85, v67, v70
    v_fma_f32 v70, v66, v70, -v84
    v_fma_f32 v71, -v66, v71, -v85
    v_mul_f32 v82, v64, v46
    v_mul_f32 v83, v65, v46
    v_exp_f32 v82, v82
    v_fract_f32 v83, v83
    v_cos_f32 v72, v83
    v_sin_f32 v73, v83
    v_mul_f32 v72, v72, v82
    v_mul_f32 v73, v73, v82
    v_mul_f32 v84, v67, v73
    v_mul_f32 v85, v67, v72
    v_fma_f32 v72, v66, v72, -v84
    v_fma_f32 v73, -v66, v73, -v85
    v_mfma_f32_16x16x4_f32 v[48:51], v68, v74, v[48:51]
    v_mfma_f32_16x16x4_f32 v[52:55], v70, v76, v[52:55]
    v_mfma_f32_16x16x4_f32 v[56:59], v70, v78, v[56:59]
    v_mfma_f32_16x16x4_f32 v[60:63], v72, v80, v[60:63]
    v_mfma_f32_16x16x4_f32 v[48:51], v69, v75, v[48:51]
    v_mfma_f32_16x16x4_f32 v[52:55], v71, v77, v[52:55]
    v_mfma_f32_16x16x4_f32 v[56:59], v71, v79, v[56:59]
    v_mfma_f32_16x16x4_f32 v[60:63], v73, v81, v[60:63]
    v_mov_b32_dpp v64, v28 row_newbcast:7 row_mask:0xf bank_mask:0xf
    v_mov_b32_dpp v65, v29 row_newbcast:7 row_mask:0xf bank_mask:0xf
    v_mov_b32_dpp v66, v30 row_newbcast:7 row_mask:0xf bank_mask:0xf
    v_mov_b32_dpp v67, v31 row_newbcast:7 row_mask:0xf bank_mask:0xf
    v_mul_f32 v82, v64, v47
    v_mul_f32 v83, v65, v47
    v_exp_f32 v82, v82
    v_fract_f32 v83, v83
    v_cos_f32 v74, v83
    v_sin_f32 v75, v83
    v_mul_f32 v74, v74, v82
    v_mul_f32 v75, v75, v82
    v_mul_f32 v84, v75, v75
    v_add_f32 v85, v74, v74
    v_fma_f32 v76, v74, v74, -v84
    v_mul_f32 v77, v85, v75
    v_mul_f32 v84, v77, v77
    v_add_f32 v85, v76, v76
    v_fma_f32 v78, v76, v76, -v84
    v_mul_f32 v79, v85, v77
    v_mul_f32 v84, v79, v79
    v_add_f32 v85, v78, v78
    v_fma_f32 v80, v78, v78, -v84
    v_mul_f32 v81, v85, v79
    v_mul_f32 v82, v64, v44
    v_mul_f32 v83, v65, v44
    v_exp_f32 v82, v82
    v_fract_f32 v83, v83
    v_cos_f32 v68, v83
    v_sin_f32 v69, v83
    v_mul_f32 v68, v68, v82
    v_mul_f32 v69, v69, v82
    v_mul_f32 v84, v67, v69
    v_mul_f32 v85, v67, v68
    v_fma_f32 v68, v66, v68, -v84
    v_fma_f32 v69, -v66, v69, -v85
    v_mul_f32 v82, v64, v45
    v_mul_f32 v83, v65, v45
    v_exp_f32 v82, v82
    v_fract_f32 v83, v83
    v_cos_f32 v70, v83
    v_sin_f32 v71, v83
    v_mul_f32 v70, v70, v82
    v_mul_f32 v71, v71, v82
    v_mul_f32 v84, v67, v71
    v_mul_f32 v85, v67, v70
    v_fma_f32 v70, v66, v70, -v84
    v_fma_f32 v71, -v66, v71, -v85
    v_mul_f32 v82, v64, v46
    v_mul_f32 v83, v65, v46
    v_exp_f32 v82, v82
    v_fract_f32 v83, v83
    v_cos_f32 v72, v83
    v_sin_f32 v73, v83
    v_mul_f32 v72, v72, v82
    v_mul_f32 v73, v73, v82
    v_mul_f32 v84, v67, v73
    v_mul_f32 v85, v67, v72
    v_fma_f32 v72, v66, v72, -v84
    v_fma_f32 v73, -v66, v73, -v85
    v_mfma_f32_16x16x4_f32 v[48:51], v68, v74, v[48:51]
    v_mfma_f32_16x16x4_f32 v[52:55], v70, v76, v[52:55]
    v_mfma_f32_16x16x4_f32 v[56:59], v70, v78, v[56:59]
    v_mfma_f32_16x16x4_f32 v[60:63], v72, v80, v[60:63]
    v_mfma_f32_16x16x4_f32 v[48:51], v69, v75, v[48:51]
    v_mfma_f32_16x16x4_f32 v[52:55], v71, v77, v[52:55]
    v_mfma_f32_16x16x4_f32 v[56:59], v71, v79, v[56:59]
    v_mfma_f32_16x16x4_f32 v[60:63], v73, v81, v[60:63]
    v_mov_b32_dpp v64, v28 row_newbcast:8 row_mask:0xf bank_mask:0xf
    v_mov_b32_dpp v65, v29 row_newbcast:8 row_mask:0xf bank_mask:0xf
    v_mov_b32_dpp v66, v30 row_newbcast:8 row_mask:0xf bank_mask:0xf
    v_mov_b32_dpp v67, v31 row_newbcast:8 row_mask:0xf bank_mask:0xf
    v_mul_f32 v82, v64, v47
    v_mul_f32 v83, v65, v47
    v_exp_f32 v82, v82
    v_fract_f32 v83, v83
    v_cos_f32 v74, v83
    v_sin_f32 v75, v83
    v_mul_f32 v74, v74, v82
    v_mul_f32 v75, v75, v82
    v_mul_f32 v84, v75, v75
    v_add_f32 v85, v74, v74
    v_fma_f32 v76, v74, v74, -v84
    v_mul_f32 v77, v85, v75
    v_mul_f32 v84, v77, v77
    v_add_f32 v85, v76, v76
    v_fma_f32 v78, v76, v76, -v84
    v_mul_f32 v79, v85, v77
    v_mul_f32 v84, v79, v79
    v_add_f32 v85, v78, v78
    v_fma_f32 v80, v78, v78, -v84
    v_mul_f32 v81, v85, v79
    v_mul_f32 v82, v64, v44
    v_mul_f32 v83, v65, v44
    v_exp_f32 v82, v82
    v_fract_f32 v83, v83
    v_cos_f32 v68, v83
    v_sin_f32 v69, v83
    v_mul_f32 v68, v68, v82
    v_mul_f32 v69, v69, v82
    v_mul_f32 v84, v67, v69
    v_mul_f32 v85, v67, v68
    v_fma_f32 v68, v66, v68, -v84
    v_fma_f32 v69, -v66, v69, -v85
    v_mul_f32 v82, v64, v45
    v_mul_f32 v83, v65, v45
    v_exp_f32 v82, v82
    v_fract_f32 v83, v83
    v_cos_f32 v70, v83
    v_sin_f32 v71, v83
    v_mul_f32 v70, v70, v82
    v_mul_f32 v71, v71, v82
    v_mul_f32 v84, v67, v71
    v_mul_f32 v85, v67, v70
    v_fma_f32 v70, v66, v70, -v84
    v_fma_f32 v71, -v66, v71, -v85
    v_mul_f32 v82, v64, v46
    v_mul_f32 v83, v65, v46
    v_exp_f32 v82, v82
    v_fract_f32 v83, v83
    v_cos_f32 v72, v83
    v_sin_f32 v73, v83
    v_mul_f32 v72, v72, v82
    v_mul_f32 v73, v73, v82
    v_mul_f32 v84, v67, v73
    v_mul_f32 v85, v67, v72
    v_fma_f32 v72, v66, v72, -v84
    v_fma_f32 v73, -v66, v73, -v85
    v_mfma_f32_16x16x4_f32 v[48:51], v68, v74, v[48:51]
    v_mfma_f32_16x16x4_f32 v[52:55], v70, v76, v[52:55]
    v_mfma_f32_16x16x4_f32 v[56:59], v70, v78, v[56:59]
    v_mfma_f32_16x16x4_f32 v[60:63], v72, v80, v[60:63]
    v_mfma_f32_16x16x4_f32 v[48:51], v69, v75, v[48:51]
    v_mfma_f32_16x16x4_f32 v[52:55], v71, v77, v[52:55]
    v_mfma_f32_16x16x4_f32 v[56:59], v71, v79, v[56:59]
    v_mfma_f32_16x16x4_f32 v[60:63], v73, v81, v[60:63]
    v_mov_b32_dpp v64, v28 row_newbcast:9 row_mask:0xf bank_mask:0xf
    v_mov_b32_dpp v65, v29 row_newbcast:9 row_mask:0xf bank_mask:0xf
    v_mov_b32_dpp v66, v30 row_newbcast:9 row_mask:0xf bank_mask:0xf
    v_mov_b32_dpp v67, v31 row_newbcast:9 row_mask:0xf bank_mask:0xf
    v_mul_f32 v82, v64, v47
    v_mul_f32 v83, v65, v47
    v_exp_f32 v82, v82
    v_fract_f32 v83, v83
    v_cos_f32 v74, v83
    v_sin_f32 v75, v83
    v_mul_f32 v74, v74, v82
    v_mul_f32 v75, v75, v82
    v_mul_f32 v84, v75, v75
    v_add_f32 v85, v74, v74
    v_fma_f32 v76, v74, v74, -v84
    v_mul_f32 v77, v85, v75
    v_mul_f32 v84, v77, v77
    v_add_f32 v85, v76, v76
    v_fma_f32 v78, v76, v76, -v84
    v_mul_f32 v79, v85, v77
    v_mul_f32 v84, v79, v79
    v_add_f32 v85, v78, v78
    v_fma_f32 v80, v78, v78, -v84
    v_mul_f32 v81, v85, v79
    v_mul_f32 v82, v64, v44
    v_mul_f32 v83, v65, v44
    v_exp_f32 v82, v82
    v_fract_f32 v83, v83
    v_cos_f32 v68, v83
    v_sin_f32 v69, v83
    v_mul_f32 v68, v68, v82
    v_mul_f32 v69, v69, v82
    v_mul_f32 v84, v67, v69
    v_mul_f32 v85, v67, v68
    v_fma_f32 v68, v66, v68, -v84
    v_fma_f32 v69, -v66, v69, -v85
    v_mul_f32 v82, v64, v45
    v_mul_f32 v83, v65, v45
    v_exp_f32 v82, v82
    v_fract_f32 v83, v83
    v_cos_f32 v70, v83
    v_sin_f32 v71, v83
    v_mul_f32 v70, v70, v82
    v_mul_f32 v71, v71, v82
    v_mul_f32 v84, v67, v71
    v_mul_f32 v85, v67, v70
    v_fma_f32 v70, v66, v70, -v84
    v_fma_f32 v71, -v66, v71, -v85
    v_mul_f32 v82, v64, v46
    v_mul_f32 v83, v65, v46
    v_exp_f32 v82, v82
    v_fract_f32 v83, v83
    v_cos_f32 v72, v83
    v_sin_f32 v73, v83
    v_mul_f32 v72, v72, v82
    v_mul_f32 v73, v73, v82
    v_mul_f32 v84, v67, v73
    v_mul_f32 v85, v67, v72
    v_fma_f32 v72, v66, v72, -v84
    v_fma_f32 v73, -v66, v73, -v85
    v_mfma_f32_16x16x4_f32 v[48:51], v68, v74, v[48:51]
    v_mfma_f32_16x16x4_f32 v[52:55], v70, v76, v[52:55]
    v_mfma_f32_16x16x4_f32 v[56:59], v70, v78, v[56:59]
    v_mfma_f32_16x16x4_f32 v[60:63], v72, v80, v[60:63]
    v_mfma_f32_16x16x4_f32 v[48:51], v69, v75, v[48:51]
    v_mfma_f32_16x16x4_f32 v[52:55], v71, v77, v[52:55]
    v_mfma_f32_16x16x4_f32 v[56:59], v71, v79, v[56:59]
    v_mfma_f32_16x16x4_f32 v[60:63], v73, v81, v[60:63]
    v_mov_b32_dpp v64, v28 row_newbcast:10 row_mask:0xf bank_mask:0xf
    v_mov_b32_dpp v65, v29 row_newbcast:10 row_mask:0xf bank_mask:0xf
    v_mov_b32_dpp v66, v30 row_newbcast:10 row_mask:0xf bank_mask:0xf
    v_mov_b32_dpp v67, v31 row_newbcast:10 row_mask:0xf bank_mask:0xf
    v_mul_f32 v82, v64, v47
    v_mul_f32 v83, v65, v47
    v_exp_f32 v82, v82
    v_fract_f32 v83, v83
    v_cos_f32 v74, v83
    v_sin_f32 v75, v83
    v_mul_f32 v74, v74, v82
    v_mul_f32 v75, v75, v82
    v_mul_f32 v84, v75, v75
    v_add_f32 v85, v74, v74
    v_fma_f32 v76, v74, v74, -v84
    v_mul_f32 v77, v85, v75
    v_mul_f32 v84, v77, v77
    v_add_f32 v85, v76, v76
    v_fma_f32 v78, v76, v76, -v84
    v_mul_f32 v79, v85, v77
    v_mul_f32 v84, v79, v79
    v_add_f32 v85, v78, v78
    v_fma_f32 v80, v78, v78, -v84
    v_mul_f32 v81, v85, v79
    v_mul_f32 v82, v64, v44
    v_mul_f32 v83, v65, v44
    v_exp_f32 v82, v82
    v_fract_f32 v83, v83
    v_cos_f32 v68, v83
    v_sin_f32 v69, v83
    v_mul_f32 v68, v68, v82
    v_mul_f32 v69, v69, v82
    v_mul_f32 v84, v67, v69
    v_mul_f32 v85, v67, v68
    v_fma_f32 v68, v66, v68, -v84
    v_fma_f32 v69, -v66, v69, -v85
    v_mul_f32 v82, v64, v45
    v_mul_f32 v83, v65, v45
    v_exp_f32 v82, v82
    v_fract_f32 v83, v83
    v_cos_f32 v70, v83
    v_sin_f32 v71, v83
    v_mul_f32 v70, v70, v82
    v_mul_f32 v71, v71, v82
    v_mul_f32 v84, v67, v71
    v_mul_f32 v85, v67, v70
    v_fma_f32 v70, v66, v70, -v84
    v_fma_f32 v71, -v66, v71, -v85
    v_mul_f32 v82, v64, v46
    v_mul_f32 v83, v65, v46
    v_exp_f32 v82, v82
    v_fract_f32 v83, v83
    v_cos_f32 v72, v83
    v_sin_f32 v73, v83
    v_mul_f32 v72, v72, v82
    v_mul_f32 v73, v73, v82
    v_mul_f32 v84, v67, v73
    v_mul_f32 v85, v67, v72
    v_fma_f32 v72, v66, v72, -v84
    v_fma_f32 v73, -v66, v73, -v85
    v_mfma_f32_16x16x4_f32 v[48:51], v68, v74, v[48:51]
    v_mfma_f32_16x16x4_f32 v[52:55], v70, v76, v[52:55]
    v_mfma_f32_16x16x4_f32 v[56:59], v70, v78, v[56:59]
    v_mfma_f32_16x16x4_f32 v[60:63], v72, v80, v[60:63]
    v_mfma_f32_16x16x4_f32 v[48:51], v69, v75, v[48:51]
    v_mfma_f32_16x16x4_f32 v[52:55], v71, v77, v[52:55]
    v_mfma_f32_16x16x4_f32 v[56:59], v71, v79, v[56:59]
    v_mfma_f32_16x16x4_f32 v[60:63], v73, v81, v[60:63]
    v_mov_b32_dpp v64, v28 row_newbcast:11 row_mask:0xf bank_mask:0xf
    v_mov_b32_dpp v65, v29 row_newbcast:11 row_mask:0xf bank_mask:0xf
    v_mov_b32_dpp v66, v30 row_newbcast:11 row_mask:0xf bank_mask:0xf
    v_mov_b32_dpp v67, v31 row_newbcast:11 row_mask:0xf bank_mask:0xf
    v_mul_f32 v82, v64, v47
    v_mul_f32 v83, v65, v47
    v_exp_f32 v82, v82
    v_fract_f32 v83, v83
    v_cos_f32 v74, v83
    v_sin_f32 v75, v83
    v_mul_f32 v74, v74, v82
    v_mul_f32 v75, v75, v82
    v_mul_f32 v84, v75, v75
    v_add_f32 v85, v74, v74
    v_fma_f32 v76, v74, v74, -v84
    v_mul_f32 v77, v85, v75
    v_mul_f32 v84, v77, v77
    v_add_f32 v85, v76, v76
    v_fma_f32 v78, v76, v76, -v84
    v_mul_f32 v79, v85, v77
    v_mul_f32 v84, v79, v79
    v_add_f32 v85, v78, v78
    v_fma_f32 v80, v78, v78, -v84
    v_mul_f32 v81, v85, v79
    v_mul_f32 v82, v64, v44
    v_mul_f32 v83, v65, v44
    v_exp_f32 v82, v82
    v_fract_f32 v83, v83
    v_cos_f32 v68, v83
    v_sin_f32 v69, v83
    v_mul_f32 v68, v68, v82
    v_mul_f32 v69, v69, v82
    v_mul_f32 v84, v67, v69
    v_mul_f32 v85, v67, v68
    v_fma_f32 v68, v66, v68, -v84
    v_fma_f32 v69, -v66, v69, -v85
    v_mul_f32 v82, v64, v45
    v_mul_f32 v83, v65, v45
    v_exp_f32 v82, v82
    v_fract_f32 v83, v83
    v_cos_f32 v70, v83
    v_sin_f32 v71, v83
    v_mul_f32 v70, v70, v82
    v_mul_f32 v71, v71, v82
    v_mul_f32 v84, v67, v71
    v_mul_f32 v85, v67, v70
    v_fma_f32 v70, v66, v70, -v84
    v_fma_f32 v71, -v66, v71, -v85
    v_mul_f32 v82, v64, v46
    v_mul_f32 v83, v65, v46
    v_exp_f32 v82, v82
    v_fract_f32 v83, v83
    v_cos_f32 v72, v83
    v_sin_f32 v73, v83
    v_mul_f32 v72, v72, v82
    v_mul_f32 v73, v73, v82
    v_mul_f32 v84, v67, v73
    v_mul_f32 v85, v67, v72
    v_fma_f32 v72, v66, v72, -v84
    v_fma_f32 v73, -v66, v73, -v85
    v_mfma_f32_16x16x4_f32 v[48:51], v68, v74, v[48:51]
    v_mfma_f32_16x16x4_f32 v[52:55], v70, v76, v[52:55]
    v_mfma_f32_16x16x4_f32 v[56:59], v70, v78, v[56:59]
    v_mfma_f32_16x16x4_f32 v[60:63], v72, v80, v[60:63]
    v_mfma_f32_16x16x4_f32 v[48:51], v69, v75, v[48:51]
    v_mfma_f32_16x16x4_f32 v[52:55], v71, v77, v[52:55]
    v_mfma_f32_16x16x4_f32 v[56:59], v71, v79, v[56:59]
    v_mfma_f32_16x16x4_f32 v[60:63], v73, v81, v[60:63]
    v_mov_b32_dpp v64, v28 row_newbcast:12 row_mask:0xf bank_mask:0xf
    v_mov_b32_dpp v65, v29 row_newbcast:12 row_mask:0xf bank_mask:0xf
    v_mov_b32_dpp v66, v30 row_newbcast:12 row_mask:0xf bank_mask:0xf
    v_mov_b32_dpp v67, v31 row_newbcast:12 row_mask:0xf bank_mask:0xf
    v_mul_f32 v82, v64, v47
    v_mul_f32 v83, v65, v47
    v_exp_f32 v82, v82
    v_fract_f32 v83, v83
    v_cos_f32 v74, v83
    v_sin_f32 v75, v83
    v_mul_f32 v74, v74, v82
    v_mul_f32 v75, v75, v82
    v_mul_f32 v84, v75, v75
    v_add_f32 v85, v74, v74
    v_fma_f32 v76, v74, v74, -v84
    v_mul_f32 v77, v85, v75
    v_mul_f32 v84, v77, v77
    v_add_f32 v85, v76, v76
    v_fma_f32 v78, v76, v76, -v84
    v_mul_f32 v79, v85, v77
    v_mul_f32 v84, v79, v79
    v_add_f32 v85, v78, v78
    v_fma_f32 v80, v78, v78, -v84
    v_mul_f32 v81, v85, v79
    v_mul_f32 v82, v64, v44
    v_mul_f32 v83, v65, v44
    v_exp_f32 v82, v82
    v_fract_f32 v83, v83
    v_cos_f32 v68, v83
    v_sin_f32 v69, v83
    v_mul_f32 v68, v68, v82
    v_mul_f32 v69, v69, v82
    v_mul_f32 v84, v67, v69
    v_mul_f32 v85, v67, v68
    v_fma_f32 v68, v66, v68, -v84
    v_fma_f32 v69, -v66, v69, -v85
    v_mul_f32 v82, v64, v45
    v_mul_f32 v83, v65, v45
    v_exp_f32 v82, v82
    v_fract_f32 v83, v83
    v_cos_f32 v70, v83
    v_sin_f32 v71, v83
    v_mul_f32 v70, v70, v82
    v_mul_f32 v71, v71, v82
    v_mul_f32 v84, v67, v71
    v_mul_f32 v85, v67, v70
    v_fma_f32 v70, v66, v70, -v84
    v_fma_f32 v71, -v66, v71, -v85
    v_mul_f32 v82, v64, v46
    v_mul_f32 v83, v65, v46
    v_exp_f32 v82, v82
    v_fract_f32 v83, v83
    v_cos_f32 v72, v83
    v_sin_f32 v73, v83
    v_mul_f32 v72, v72, v82
    v_mul_f32 v73, v73, v82
    v_mul_f32 v84, v67, v73
    v_mul_f32 v85, v67, v72
    v_fma_f32 v72, v66, v72, -v84
    v_fma_f32 v73, -v66, v73, -v85
    v_mfma_f32_16x16x4_f32 v[48:51], v68, v74, v[48:51]
    v_mfma_f32_16x16x4_f32 v[52:55], v70, v76, v[52:55]
    v_mfma_f32_16x16x4_f32 v[56:59], v70, v78, v[56:59]
    v_mfma_f32_16x16x4_f32 v[60:63], v72, v80, v[60:63]
    v_mfma_f32_16x16x4_f32 v[48:51], v69, v75, v[48:51]
    v_mfma_f32_16x16x4_f32 v[52:55], v71, v77, v[52:55]
    v_mfma_f32_16x16x4_f32 v[56:59], v71, v79, v[56:59]
    v_mfma_f32_16x16x4_f32 v[60:63], v73, v81, v[60:63]
    v_mov_b32_dpp v64, v28 row_newbcast:13 row_mask:0xf bank_mask:0xf
    v_mov_b32_dpp v65, v29 row_newbcast:13 row_mask:0xf bank_mask:0xf
    v_mov_b32_dpp v66, v30 row_newbcast:13 row_mask:0xf bank_mask:0xf
    v_mov_b32_dpp v67, v31 row_newbcast:13 row_mask:0xf bank_mask:0xf
    v_mul_f32 v82, v64, v47
    v_mul_f32 v83, v65, v47
    v_exp_f32 v82, v82
    v_fract_f32 v83, v83
    v_cos_f32 v74, v83
    v_sin_f32 v75, v83
    v_mul_f32 v74, v74, v82
    v_mul_f32 v75, v75, v82
    v_mul_f32 v84, v75, v75
    v_add_f32 v85, v74, v74
    v_fma_f32 v76, v74, v74, -v84
    v_mul_f32 v77, v85, v75
    v_mul_f32 v84, v77, v77
    v_add_f32 v85, v76, v76
    v_fma_f32 v78, v76, v76, -v84
    v_mul_f32 v79, v85, v77
    v_mul_f32 v84, v79, v79
    v_add_f32 v85, v78, v78
    v_fma_f32 v80, v78, v78, -v84
    v_mul_f32 v81, v85, v79
    v_mul_f32 v82, v64, v44
    v_mul_f32 v83, v65, v44
    v_exp_f32 v82, v82
    v_fract_f32 v83, v83
    v_cos_f32 v68, v83
    v_sin_f32 v69, v83
    v_mul_f32 v68, v68, v82
    v_mul_f32 v69, v69, v82
    v_mul_f32 v84, v67, v69
    v_mul_f32 v85, v67, v68
    v_fma_f32 v68, v66, v68, -v84
    v_fma_f32 v69, -v66, v69, -v85
    v_mul_f32 v82, v64, v45
    v_mul_f32 v83, v65, v45
    v_exp_f32 v82, v82
    v_fract_f32 v83, v83
    v_cos_f32 v70, v83
    v_sin_f32 v71, v83
    v_mul_f32 v70, v70, v82
    v_mul_f32 v71, v71, v82
    v_mul_f32 v84, v67, v71
    v_mul_f32 v85, v67, v70
    v_fma_f32 v70, v66, v70, -v84
    v_fma_f32 v71, -v66, v71, -v85
    v_mul_f32 v82, v64, v46
    v_mul_f32 v83, v65, v46
    v_exp_f32 v82, v82
    v_fract_f32 v83, v83
    v_cos_f32 v72, v83
    v_sin_f32 v73, v83
    v_mul_f32 v72, v72, v82
    v_mul_f32 v73, v73, v82
    v_mul_f32 v84, v67, v73
    v_mul_f32 v85, v67, v72
    v_fma_f32 v72, v66, v72, -v84
    v_fma_f32 v73, -v66, v73, -v85
    v_mfma_f32_16x16x4_f32 v[48:51], v68, v74, v[48:51]
    v_mfma_f32_16x16x4_f32 v[52:55], v70, v76, v[52:55]
    v_mfma_f32_16x16x4_f32 v[56:59], v70, v78, v[56:59]
    v_mfma_f32_16x16x4_f32 v[60:63], v72, v80, v[60:63]
    v_mfma_f32_16x16x4_f32 v[48:51], v69, v75, v[48:51]
    v_mfma_f32_16x16x4_f32 v[52:55], v71, v77, v[52:55]
    v_mfma_f32_16x16x4_f32 v[56:59], v71, v79, v[56:59]
    v_mfma_f32_16x16x4_f32 v[60:63], v73, v81, v[60:63]
    v_mov_b32_dpp v64, v28 row_newbcast:14 row_mask:0xf bank_mask:0xf
    v_mov_b32_dpp v65, v29 row_newbcast:14 row_mask:0xf bank_mask:0xf
    v_mov_b32_dpp v66, v30 row_newbcast:14 row_mask:0xf bank_mask:0xf
    v_mov_b32_dpp v67, v31 row_newbcast:14 row_mask:0xf bank_mask:0xf
    v_mul_f32 v82, v64, v47
    v_mul_f32 v83, v65, v47
    v_exp_f32 v82, v82
    v_fract_f32 v83, v83
    v_cos_f32 v74, v83
    v_sin_f32 v75, v83
    v_mul_f32 v74, v74, v82
    v_mul_f32 v75, v75, v82
    v_mul_f32 v84, v75, v75
    v_add_f32 v85, v74, v74
    v_fma_f32 v76, v74, v74, -v84
    v_mul_f32 v77, v85, v75
    v_mul_f32 v84, v77, v77
    v_add_f32 v85, v76, v76
    v_fma_f32 v78, v76, v76, -v84
    v_mul_f32 v79, v85, v77
    v_mul_f32 v84, v79, v79
    v_add_f32 v85, v78, v78
    v_fma_f32 v80, v78, v78, -v84
    v_mul_f32 v81, v85, v79
    v_mul_f32 v82, v64, v44
    v_mul_f32 v83, v65, v44
    v_exp_f32 v82, v82
    v_fract_f32 v83, v83
    v_cos_f32 v68, v83
    v_sin_f32 v69, v83
    v_mul_f32 v68, v68, v82
    v_mul_f32 v69, v69, v82
    v_mul_f32 v84, v67, v69
    v_mul_f32 v85, v67, v68
    v_fma_f32 v68, v66, v68, -v84
    v_fma_f32 v69, -v66, v69, -v85
    v_mul_f32 v82, v64, v45
    v_mul_f32 v83, v65, v45
    v_exp_f32 v82, v82
    v_fract_f32 v83, v83
    v_cos_f32 v70, v83
    v_sin_f32 v71, v83
    v_mul_f32 v70, v70, v82
    v_mul_f32 v71, v71, v82
    v_mul_f32 v84, v67, v71
    v_mul_f32 v85, v67, v70
    v_fma_f32 v70, v66, v70, -v84
    v_fma_f32 v71, -v66, v71, -v85
    v_mul_f32 v82, v64, v46
    v_mul_f32 v83, v65, v46
    v_exp_f32 v82, v82
    v_fract_f32 v83, v83
    v_cos_f32 v72, v83
    v_sin_f32 v73, v83
    v_mul_f32 v72, v72, v82
    v_mul_f32 v73, v73, v82
    v_mul_f32 v84, v67, v73
    v_mul_f32 v85, v67, v72
    v_fma_f32 v72, v66, v72, -v84
    v_fma_f32 v73, -v66, v73, -v85
    v_mfma_f32_16x16x4_f32 v[48:51], v68, v74, v[48:51]
    v_mfma_f32_16x16x4_f32 v[52:55], v70, v76, v[52:55]
    v_mfma_f32_16x16x4_f32 v[56:59], v70, v78, v[56:59]
    v_mfma_f32_16x16x4_f32 v[60:63], v72, v80, v[60:63]
    v_mfma_f32_16x16x4_f32 v[48:51], v69, v75, v[48:51]
    v_mfma_f32_16x16x4_f32 v[52:55], v71, v77, v[52:55]
    v_mfma_f32_16x16x4_f32 v[56:59], v71, v79, v[56:59]
    v_mfma_f32_16x16x4_f32 v[60:63], v73, v81, v[60:63]
    v_mov_b32_dpp v64, v28 row_newbcast:15 row_mask:0xf bank_mask:0xf
    v_mov_b32_dpp v65, v29 row_newbcast:15 row_mask:0xf bank_mask:0xf
    v_mov_b32_dpp v66, v30 row_newbcast:15 row_mask:0xf bank_mask:0xf
    v_mov_b32_dpp v67, v31 row_newbcast:15 row_mask:0xf bank_mask:0xf
    v_mul_f32 v82, v64, v47
    v_mul_f32 v83, v65, v47
    v_exp_f32 v82, v82
    v_fract_f32 v83, v83
    v_cos_f32 v74, v83
    v_sin_f32 v75, v83
    v_mul_f32 v74, v74, v82
    v_mul_f32 v75, v75, v82
    v_mul_f32 v84, v75, v75
    v_add_f32 v85, v74, v74
    v_fma_f32 v76, v74, v74, -v84
    v_mul_f32 v77, v85, v75
    v_mul_f32 v84, v77, v77
    v_add_f32 v85, v76, v76
    v_fma_f32 v78, v76, v76, -v84
    v_mul_f32 v79, v85, v77
    v_mul_f32 v84, v79, v79
    v_add_f32 v85, v78, v78
    v_fma_f32 v80, v78, v78, -v84
    v_mul_f32 v81, v85, v79
    v_mul_f32 v82, v64, v44
    v_mul_f32 v83, v65, v44
    v_exp_f32 v82, v82
    v_fract_f32 v83, v83
    v_cos_f32 v68, v83
    v_sin_f32 v69, v83
    v_mul_f32 v68, v68, v82
    v_mul_f32 v69, v69, v82
    v_mul_f32 v84, v67, v69
    v_mul_f32 v85, v67, v68
    v_fma_f32 v68, v66, v68, -v84
    v_fma_f32 v69, -v66, v69, -v85
    v_mul_f32 v82, v64, v45
    v_mul_f32 v83, v65, v45
    v_exp_f32 v82, v82
    v_fract_f32 v83, v83
    v_cos_f32 v70, v83
    v_sin_f32 v71, v83
    v_mul_f32 v70, v70, v82
    v_mul_f32 v71, v71, v82
    v_mul_f32 v84, v67, v71
    v_mul_f32 v85, v67, v70
    v_fma_f32 v70, v66, v70, -v84
    v_fma_f32 v71, -v66, v71, -v85
    v_mul_f32 v82, v64, v46
    v_mul_f32 v83, v65, v46
    v_exp_f32 v82, v82
    v_fract_f32 v83, v83
    v_cos_f32 v72, v83
    v_sin_f32 v73, v83
    v_mul_f32 v72, v72, v82
    v_mul_f32 v73, v73, v82
    v_mul_f32 v84, v67, v73
    v_mul_f32 v85, v67, v72
    v_fma_f32 v72, v66, v72, -v84
    v_fma_f32 v73, -v66, v73, -v85
    v_mfma_f32_16x16x4_f32 v[48:51], v68, v74, v[48:51]
    v_mfma_f32_16x16x4_f32 v[52:55], v70, v76, v[52:55]
    v_mfma_f32_16x16x4_f32 v[56:59], v70, v78, v[56:59]
    v_mfma_f32_16x16x4_f32 v[60:63], v72, v80, v[60:63]
    v_mfma_f32_16x16x4_f32 v[48:51], v69, v75, v[48:51]
    v_mfma_f32_16x16x4_f32 v[52:55], v71, v77, v[52:55]
    v_mfma_f32_16x16x4_f32 v[56:59], v71, v79, v[56:59]
    v_mfma_f32_16x16x4_f32 v[60:63], v73, v81, v[60:63]
    v_lshlrev_b32 v5, 8, v3
    v_lshl_add_u32 v5, v2, 2, v5
    v_add_u32 v5, v5, v4
    ds_write_b32 v5, v48 offset:4608
    ds_write_b32 v5, v49 offset:4672
    ds_write_b32 v5, v50 offset:4736
    ds_write_b32 v5, v51 offset:4800
    v_cmp_gt_u32 vcc, 2, v3
    s_nop 0
    s_mov_b64 exec, vcc
    ds_write_b32 v5, v52 offset:5632
    ds_write_b32 v5, v53 offset:5696
    ds_write_b32 v5, v54 offset:5760
    ds_write_b32 v5, v55 offset:5824
    ds_write_b32 v5, v60 offset:6656
    ds_write_b32 v5, v61 offset:6720
    ds_write_b32 v5, v62 offset:6784
    ds_write_b32 v5, v63 offset:6848
    s_not_b64 exec, exec
    ds_write_b32 v5, v56 offset:5632
    ds_write_b32 v5, v57 offset:5696
    ds_write_b32 v5, v58 offset:5760
    ds_write_b32 v5, v59 offset:5824
    s_mov_b32 exec_lo, 0
    s_mov_b32 exec_hi, 3
    v_cmp_eq_u32 vcc, 0, v2
    s_nop 1
    v_cndmask_b32 v6, 0, v60, vcc
    ds_write_b32 v5, v6 offset:6656
    s_mov_b64 exec, -1
    s_waitcnt lgkmcnt(0)
    v_lshlrev_b32 v7, 1, v1
    v_sub_u32 v7, 2065, v7
    v_lshl_add_u32 v64, v1, 2, v4
    v_mov_b32 v65, 641
    s_mov_b32 s25, 17
ss_exp:
    v_subrev_u32 v66, 0, v7
    v_cvt_f32_u32 v70, v66
    v_cvt_pk_bf16_f32 v70, v70, v70
    v_and_b32 v70, 0xffff, v70
    v_subrev_u32 v70, 0x4280, v70
    v_cmp_gt_u32 vcc, 256, v66
    s_nop 1
    v_cndmask_b32 v70, v70, v66, vcc
    v_cmp_gt_u32 vcc, 2048, v66
    s_nop 1
    v_cndmask_b32 v70, v65, v70, vcc
    v_lshl_add_u32 v70, v70, 2, v4
    ds_read_b32 v74, v70 offset:4608
    v_subrev_u32 v67, 1, v7
    v_cvt_f32_u32 v71, v67
    v_cvt_pk_bf16_f32 v71, v71, v71
    v_and_b32 v71, 0xffff, v71
    v_subrev_u32 v71, 0x4280, v71
    v_cmp_gt_u32 vcc, 256, v67
    s_nop 1
    v_cndmask_b32 v71, v71, v67, vcc
    v_cmp_gt_u32 vcc, 2048, v67
    s_nop 1
    v_cndmask_b32 v71, v65, v71, vcc
    v_lshl_add_u32 v71, v71, 2, v4
    ds_read_b32 v75, v71 offset:4608
    v_subrev_u32 v68, 2, v7
    v_cvt_f32_u32 v72, v68
    v_cvt_pk_bf16_f32 v72, v72, v72
    v_and_b32 v72, 0xffff, v72
    v_subrev_u32 v72, 0x4280, v72
    v_cmp_gt_u32 vcc, 256, v68
    s_nop 1
    v_cndmask_b32 v72, v72, v68, vcc
    v_cmp_gt_u32 vcc, 2048, v68
    s_nop 1
    v_cndmask_b32 v72, v65, v72, vcc
    v_lshl_add_u32 v72, v72, 2, v4
    ds_read_b32 v76, v72 offset:4608
    s_waitcnt lgkmcnt(0)
    v_cvt_pk_bf16_f32 v78, v75, v76
    v_cvt_pk_bf16_f32 v79, v74, v75
    ds_write_b32 v64, v78 offset:7424
    ds_write_b32 v64, v79 offset:11776
    v_subrev_u32 v7, 128, v7
    v_add_u32 v64, 256, v64
    s_sub_u32 s25, s25, 1
    s_cmp_lg_u32 s25, 0
    s_cbranch_scc1 ss_exp
    s_waitcnt lgkmcnt(0)
    s_barrier
    v_and_b32 v5, 1, v2
    v_mul_u32_u24 v64, 4352, v5
    v_sub_u32 v5, v5, v2
    v_lshl_add_u32 v5, v3, 3, v5
    v_lshl_add_u32 v64, v5, 1, v64
    v_add_u32 v64, 11520, v64
    v_add_u32 v64, v64, v4
    v_lshlrev_b32 v65, 5, v2
    v_lshl_add_u32 v65, v3, 4, v65
    v_add_u32 v65, 480, v65
    v_add_u32 v65, v65, v4
    v_mov_b32 v96, 0
    v_mov_b32 v97, 0
    v_mov_b32 v98, 0
    v_mov_b32 v99, 0
    v_mov_b32 v100, 0
    v_mov_b32 v101, 0
    v_mov_b32 v102, 0
    v_mov_b32 v103, 0
    v_mov_b32 v104, 0
    v_mov_b32 v105, 0
    v_mov_b32 v106, 0
    v_mov_b32 v107, 0
    v_mov_b32 v108, 0
    v_mov_b32 v109, 0
    v_mov_b32 v110, 0
    v_mov_b32 v111, 0
    v_mov_b32 v112, 0
    v_mov_b32 v113, 0
    v_mov_b32 v114, 0
    v_mov_b32 v115, 0
    v_mov_b32 v116, 0
    v_mov_b32 v117, 0
    v_mov_b32 v118, 0
    v_mov_b32 v119, 0
    v_mov_b32 v120, 0
    v_mov_b32 v121, 0
    v_mov_b32 v122, 0
    v_mov_b32 v123, 0
    v_mov_b32 v124, 0
    v_mov_b32 v125, 0
    v_mov_b32 v126, 0
    v_mov_b32 v127, 0
    s_mov_b32 s25, 8
ss_cv0:
    ds_read2_b32 v[68:69], v64 offset0:0 offset1:1
    ds_read2_b32 v[70:71], v64 offset0:2 offset1:3
    ds_read_b128 v[128:131], v65 offset:0
    ds_read_b128 v[132:135], v65 offset:512
    ds_read_b128 v[136:139], v65 offset:1024
    ds_read_b128 v[140:143], v65 offset:1536
    ds_read_b128 v[144:147], v65 offset:2048
    ds_read_b128 v[148:151], v65 offset:2560
    ds_read_b128 v[152:155], v65 offset:3072
    ds_read_b128 v[156:159], v65 offset:3584
    v_subrev_u32 v64, 64, v64
    v_subrev_u32 v65, 64, v65
    s_waitcnt lgkmcnt(7)
    v_mfma_f32_16x16x32_bf16 v[96:99], v[68:71], v[128:131], v[96:99]
    s_waitcnt lgkmcnt(6)
    v_mfma_f32_16x16x32_bf16 v[100:103], v[68:71], v[132:135], v[100:103]
    s_waitcnt lgkmcnt(5)
    v_mfma_f32_16x16x32_bf16 v[104:107], v[68:71], v[136:139], v[104:107]
    s_waitcnt lgkmcnt(4)
    v_mfma_f32_16x16x32_bf16 v[108:111], v[68:71], v[140:143], v[108:111]
    s_waitcnt lgkmcnt(3)
    v_mfma_f32_16x16x32_bf16 v[112:115], v[68:71], v[144:147], v[112:115]
    s_waitcnt lgkmcnt(2)
    v_mfma_f32_16x16x32_bf16 v[116:119], v[68:71], v[148:151], v[116:119]
    s_waitcnt lgkmcnt(1)
    v_mfma_f32_16x16x32_bf16 v[120:123], v[68:71], v[152:155], v[120:123]
    s_waitcnt lgkmcnt(0)
    v_mfma_f32_16x16x32_bf16 v[124:127], v[68:71], v[156:159], v[124:127]
    s_sub_u32 s25, s25, 1
    s_cmp_lg_u32 s25, 0
    s_cbranch_scc1 ss_cv0
    v_add_u32 v65, 512, v65
    s_mov_b32 s25, 8
ss_cv1:
    ds_read2_b32 v[68:69], v64 offset0:0 offset1:1
    ds_read2_b32 v[70:71], v64 offset0:2 offset1:3
    ds_read_b128 v[132:135], v65 offset:0
    ds_read_b128 v[136:139], v65 offset:512
    ds_read_b128 v[140:143], v65 offset:1024
    ds_read_b128 v[144:147], v65 offset:1536
    ds_read_b128 v[148:151], v65 offset:2048
    ds_read_b128 v[152:155], v65 offset:2560
    ds_read_b128 v[156:159], v65 offset:3072
    v_subrev_u32 v64, 64, v64
    v_subrev_u32 v65, 64, v65
    s_waitcnt lgkmcnt(6)
    v_mfma_f32_16x16x32_bf16 v[100:103], v[68:71], v[132:135], v[100:103]
    s_waitcnt lgkmcnt(5)
    v_mfma_f32_16x16x32_bf16 v[104:107], v[68:71], v[136:139], v[104:107]
    s_waitcnt lgkmcnt(4)
    v_mfma_f32_16x16x32_bf16 v[108:111], v[68:71], v[140:143], v[108:111]
    s_waitcnt lgkmcnt(3)
    v_mfma_f32_16x16x32_bf16 v[112:115], v[68:71], v[144:147], v[112:115]
    s_waitcnt lgkmcnt(2)
    v_mfma_f32_16x16x32_bf16 v[116:119], v[68:71], v[148:151], v[116:119]
    s_waitcnt lgkmcnt(1)
    v_mfma_f32_16x16x32_bf16 v[120:123], v[68:71], v[152:155], v[120:123]
    s_waitcnt lgkmcnt(0)
    v_mfma_f32_16x16x32_bf16 v[124:127], v[68:71], v[156:159], v[124:127]
    s_sub_u32 s25, s25, 1
    s_cmp_lg_u32 s25, 0
    s_cbranch_scc1 ss_cv1
    v_add_u32 v65, 512, v65
    s_mov_b32 s25, 8
ss_cv2:
    ds_read2_b32 v[68:69], v64 offset0:0 offset1:1
    ds_read2_b32 v[70:71], v64 offset0:2 offset1:3
    ds_read_b128 v[136:139], v65 offset:0
    ds_read_b128 v[140:143], v65 offset:512
    ds_read_b128 v[144:147], v65 offset:1024
    ds_read_b128 v[148:151], v65 offset:1536
    ds_read_b128 v[152:155], v65 offset:2048
    ds_read_b128 v[156:159], v65 offset:2560
    v_subrev_u32 v64, 64, v64
    v_subrev_u32 v65, 64, v65
    s_waitcnt lgkmcnt(5)
    v_mfma_f32_16x16x32_bf16 v[104:107], v[68:71], v[136:139], v[104:107]
    s_waitcnt lgkmcnt(4)
    v_mfma_f32_16x16x32_bf16 v[108:111], v[68:71], v[140:143], v[108:111]
    s_waitcnt lgkmcnt(3)
    v_mfma_f32_16x16x32_bf16 v[112:115], v[68:71], v[144:147], v[112:115]
    s_waitcnt lgkmcnt(2)
    v_mfma_f32_16x16x32_bf16 v[116:119], v[68:71], v[148:151], v[116:119]
    s_waitcnt lgkmcnt(1)
    v_mfma_f32_16x16x32_bf16 v[120:123], v[68:71], v[152:155], v[120:123]
    s_waitcnt lgkmcnt(0)
    v_mfma_f32_16x16x32_bf16 v[124:127], v[68:71], v[156:159], v[124:127]
    s_sub_u32 s25, s25, 1
    s_cmp_lg_u32 s25, 0
    s_cbranch_scc1 ss_cv2
    v_add_u32 v65, 512, v65
    s_mov_b32 s25, 8
ss_cv3:
    ds_read2_b32 v[68:69], v64 offset0:0 offset1:1
    ds_read2_b32 v[70:71], v64 offset0:2 offset1:3
    ds_read_b128 v[140:143], v65 offset:0
    ds_read_b128 v[144:147], v65 offset:512
    ds_read_b128 v[148:151], v65 offset:1024
    ds_read_b128 v[152:155], v65 offset:1536
    ds_read_b128 v[156:159], v65 offset:2048
    v_subrev_u32 v64, 64, v64
    v_subrev_u32 v65, 64, v65
    s_waitcnt lgkmcnt(4)
    v_mfma_f32_16x16x32_bf16 v[108:111], v[68:71], v[140:143], v[108:111]
    s_waitcnt lgkmcnt(3)
    v_mfma_f32_16x16x32_bf16 v[112:115], v[68:71], v[144:147], v[112:115]
    s_waitcnt lgkmcnt(2)
    v_mfma_f32_16x16x32_bf16 v[116:119], v[68:71], v[148:151], v[116:119]
    s_waitcnt lgkmcnt(1)
    v_mfma_f32_16x16x32_bf16 v[120:123], v[68:71], v[152:155], v[120:123]
    s_waitcnt lgkmcnt(0)
    v_mfma_f32_16x16x32_bf16 v[124:127], v[68:71], v[156:159], v[124:127]
    s_sub_u32 s25, s25, 1
    s_cmp_lg_u32 s25, 0
    s_cbranch_scc1 ss_cv3
    v_add_u32 v65, 512, v65
    s_mov_b32 s25, 8
ss_cv4:
    ds_read2_b32 v[68:69], v64 offset0:0 offset1:1
    ds_read2_b32 v[70:71], v64 offset0:2 offset1:3
    ds_read_b128 v[144:147], v65 offset:0
    ds_read_b128 v[148:151], v65 offset:512
    ds_read_b128 v[152:155], v65 offset:1024
    ds_read_b128 v[156:159], v65 offset:1536
    v_subrev_u32 v64, 64, v64
    v_subrev_u32 v65, 64, v65
    s_waitcnt lgkmcnt(3)
    v_mfma_f32_16x16x32_bf16 v[112:115], v[68:71], v[144:147], v[112:115]
    s_waitcnt lgkmcnt(2)
    v_mfma_f32_16x16x32_bf16 v[116:119], v[68:71], v[148:151], v[116:119]
    s_waitcnt lgkmcnt(1)
    v_mfma_f32_16x16x32_bf16 v[120:123], v[68:71], v[152:155], v[120:123]
    s_waitcnt lgkmcnt(0)
    v_mfma_f32_16x16x32_bf16 v[124:127], v[68:71], v[156:159], v[124:127]
    s_sub_u32 s25, s25, 1
    s_cmp_lg_u32 s25, 0
    s_cbranch_scc1 ss_cv4
    v_add_u32 v65, 512, v65
    s_mov_b32 s25, 8
ss_cv5:
    ds_read2_b32 v[68:69], v64 offset0:0 offset1:1
    ds_read2_b32 v[70:71], v64 offset0:2 offset1:3
    ds_read_b128 v[148:151], v65 offset:0
    ds_read_b128 v[152:155], v65 offset:512
    ds_read_b128 v[156:159], v65 offset:1024
    v_subrev_u32 v64, 64, v64
    v_subrev_u32 v65, 64, v65
    s_waitcnt lgkmcnt(2)
    v_mfma_f32_16x16x32_bf16 v[116:119], v[68:71], v[148:151], v[116:119]
    s_waitcnt lgkmcnt(1)
    v_mfma_f32_16x16x32_bf16 v[120:123], v[68:71], v[152:155], v[120:123]
    s_waitcnt lgkmcnt(0)
    v_mfma_f32_16x16x32_bf16 v[124:127], v[68:71], v[156:159], v[124:127]
    s_sub_u32 s25, s25, 1
    s_cmp_lg_u32 s25, 0
    s_cbranch_scc1 ss_cv5
    v_add_u32 v65, 512, v65
    s_mov_b32 s25, 8
ss_cv6:
    ds_read2_b32 v[68:69], v64 offset0:0 offset1:1
    ds_read2_b32 v[70:71], v64 offset0:2 offset1:3
    ds_read_b128 v[152:155], v65 offset:0
    ds_read_b128 v[156:159], v65 offset:512
    v_subrev_u32 v64, 64, v64
    v_subrev_u32 v65, 64, v65
    s_waitcnt lgkmcnt(1)
    v_mfma_f32_16x16x32_bf16 v[120:123], v[68:71], v[152:155], v[120:123]
    s_waitcnt lgkmcnt(0)
    v_mfma_f32_16x16x32_bf16 v[124:127], v[68:71], v[156:159], v[124:127]
    s_sub_u32 s25, s25, 1
    s_cmp_lg_u32 s25, 0
    s_cbranch_scc1 ss_cv6
    v_add_u32 v65, 512, v65
    s_mov_b32 s25, 8
ss_cv7:
    ds_read2_b32 v[68:69], v64 offset0:0 offset1:1
    ds_read2_b32 v[70:71], v64 offset0:2 offset1:3
    ds_read_b128 v[156:159], v65 offset:0
    v_subrev_u32 v64, 64, v64
    v_subrev_u32 v65, 64, v65
    s_waitcnt lgkmcnt(0)
    v_mfma_f32_16x16x32_bf16 v[124:127], v[68:71], v[156:159], v[124:127]
    s_sub_u32 s25, s25, 1
    s_cmp_lg_u32 s25, 0
    s_cbranch_scc1 ss_cv7
    v_add_u32 v65, 512, v65
    s_nop 3
    v_lshlrev_b32 v5, 6, v2
    v_lshl_add_u32 v5, v3, 4, v5
    v_add_u32 v5, v5, v4
    ds_write_b128 v5, v[96:99] offset:7424
    ds_write_b128 v5, v[100:103] offset:8448
    ds_write_b128 v5, v[104:107] offset:9472
    ds_write_b128 v5, v[108:111] offset:10496
    ds_write_b128 v5, v[112:115] offset:11520
    ds_write_b128 v5, v[116:119] offset:12544
    ds_write_b128 v5, v[120:123] offset:13568
    ds_write_b128 v5, v[124:127] offset:14592
    s_mov_b32 s12, s74
    s_mov_b32 s13, s75
    s_mov_b32 s14, 1152
    s_mov_b32 s15, 0x20000
    s_lshl_b32 s23, s20, 1
    buffer_load_dwordx2 v[24:25], off, s[12:15], s23
    s_waitcnt vmcnt(0) lgkmcnt(0)
    s_barrier
    v_lshlrev_b32 v26, 16, v24
    v_and_b32 v27, 0xffff0000, v24
    v_lshlrev_b32 v28, 16, v25
    v_and_b32 v29, 0xffff0000, v25
    v_lshlrev_b32 v5, 5, v0
    ds_read_b128 v[64:67], v5 offset:7424
    ds_read_b128 v[68:71], v5 offset:7440
    ds_read_b128 v[72:75], v5 offset:23808
    ds_read_b128 v[76:79], v5 offset:23824
    ds_read_b128 v[80:83], v5 offset:40192
    ds_read_b128 v[84:87], v5 offset:40208
    ds_read_b128 v[88:91], v5 offset:56576
    ds_read_b128 v[92:95], v5 offset:56592
    s_waitcnt lgkmcnt(0)
    v_mul_u32_u24 v5, 18432, v0
    s_lshl_b32 s22, s20, 1
    s_add_u32 s22, s22, 1152
    v_lshlrev_b32 v6, 16, v8
    v_fmac_f32 v64, v6, v26
    v_and_b32 v6, 0xffff0000, v8
    v_fmac_f32 v72, v6, v27
    v_lshlrev_b32 v6, 16, v9
    v_fmac_f32 v80, v6, v28
    v_and_b32 v6, 0xffff0000, v9
    v_fmac_f32 v88, v6, v29
    v_cvt_pk_bf16_f32 v8, v64, v72
    v_cvt_pk_bf16_f32 v9, v80, v88
    s_add_u32 s23, s22, 0
    buffer_store_dwordx2 v[8:9], v5, s[16:19], s23 offen
    v_lshlrev_b32 v6, 16, v10
    v_fmac_f32 v65, v6, v26
    v_and_b32 v6, 0xffff0000, v10
    v_fmac_f32 v73, v6, v27
    v_lshlrev_b32 v6, 16, v11
    v_fmac_f32 v81, v6, v28
    v_and_b32 v6, 0xffff0000, v11
    v_fmac_f32 v89, v6, v29
    v_cvt_pk_bf16_f32 v10, v65, v73
    v_cvt_pk_bf16_f32 v11, v81, v89
    s_add_u32 s23, s22, 2304
    buffer_store_dwordx2 v[10:11], v5, s[16:19], s23 offen
    v_lshlrev_b32 v6, 16, v12
    v_fmac_f32 v66, v6, v26
    v_and_b32 v6, 0xffff0000, v12
    v_fmac_f32 v74, v6, v27
    v_lshlrev_b32 v6, 16, v13
    v_fmac_f32 v82, v6, v28
    v_and_b32 v6, 0xffff0000, v13
    v_fmac_f32 v90, v6, v29
    v_cvt_pk_bf16_f32 v12, v66, v74
    v_cvt_pk_bf16_f32 v13, v82, v90
    s_add_u32 s23, s22, 4608
    buffer_store_dwordx2 v[12:13], v5, s[16:19], s23 offen
    v_lshlrev_b32 v6, 16, v14
    v_fmac_f32 v67, v6, v26
    v_and_b32 v6, 0xffff0000, v14
    v_fmac_f32 v75, v6, v27
    v_lshlrev_b32 v6, 16, v15
    v_fmac_f32 v83, v6, v28
    v_and_b32 v6, 0xffff0000, v15
    v_fmac_f32 v91, v6, v29
    v_cvt_pk_bf16_f32 v14, v67, v75
    v_cvt_pk_bf16_f32 v15, v83, v91
    s_add_u32 s23, s22, 6912
    buffer_store_dwordx2 v[14:15], v5, s[16:19], s23 offen
    v_lshlrev_b32 v6, 16, v16
    v_fmac_f32 v68, v6, v26
    v_and_b32 v6, 0xffff0000, v16
    v_fmac_f32 v76, v6, v27
    v_lshlrev_b32 v6, 16, v17
    v_fmac_f32 v84, v6, v28
    v_and_b32 v6, 0xffff0000, v17
    v_fmac_f32 v92, v6, v29
    v_cvt_pk_bf16_f32 v16, v68, v76
    v_cvt_pk_bf16_f32 v17, v84, v92
    s_add_u32 s23, s22, 9216
    buffer_store_dwordx2 v[16:17], v5, s[16:19], s23 offen
    v_lshlrev_b32 v6, 16, v18
    v_fmac_f32 v69, v6, v26
    v_and_b32 v6, 0xffff0000, v18
    v_fmac_f32 v77, v6, v27
    v_lshlrev_b32 v6, 16, v19
    v_fmac_f32 v85, v6, v28
    v_and_b32 v6, 0xffff0000, v19
    v_fmac_f32 v93, v6, v29
    v_cvt_pk_bf16_f32 v18, v69, v77
    v_cvt_pk_bf16_f32 v19, v85, v93
    s_add_u32 s23, s22, 11520
    buffer_store_dwordx2 v[18:19], v5, s[16:19], s23 offen
    v_lshlrev_b32 v6, 16, v20
    v_fmac_f32 v70, v6, v26
    v_and_b32 v6, 0xffff0000, v20
    v_fmac_f32 v78, v6, v27
    v_lshlrev_b32 v6, 16, v21
    v_fmac_f32 v86, v6, v28
    v_and_b32 v6, 0xffff0000, v21
    v_fmac_f32 v94, v6, v29
    v_cvt_pk_bf16_f32 v20, v70, v78
    v_cvt_pk_bf16_f32 v21, v86, v94
    s_add_u32 s23, s22, 13824
    buffer_store_dwordx2 v[20:21], v5, s[16:19], s23 offen
    v_lshlrev_b32 v6, 16, v22
    v_fmac_f32 v71, v6, v26
    v_and_b32 v6, 0xffff0000, v22
    v_fmac_f32 v79, v6, v27
    v_lshlrev_b32 v6, 16, v23
    v_fmac_f32 v87, v6, v28
    v_and_b32 v6, 0xffff0000, v23
    v_fmac_f32 v95, v6, v29
    v_cvt_pk_bf16_f32 v22, v71, v79
    v_cvt_pk_bf16_f32 v23, v87, v95
    s_add_u32 s23, s22, 16128
    buffer_store_dwordx2 v[22:23], v5, s[16:19], s23 offen
    s_branch L_ssm_next
L_phase2:
    v_and_b32 v1, 63, v0
    v_min_u32 v1, 6, v1
    v_lshlrev_b32 v2, 2, v1
    s_cmp_lg_u32 s32, 0
    v_mov_b32 v251, 163832
    s_cbranch_scc1 sw9
    buffer_load_dword v3, v2, s[96:99], 0 offen offset:32 sc1
    v_mov_b32 v4, 32
    s_waitcnt vmcnt(0)
    v_cmp_lt_u32 vcc, v3, v4
    s_nop 0
    s_ff1_i32_b64 s40, vcc
    v_mov_b32 v250, s40
    ds_write_b32 v251, v250
    s_waitcnt lgkmcnt(0)
sw9:
    s_barrier
    ds_read_b32 v252, v251
    s_waitcnt lgkmcnt(0)
    v_readfirstlane_b32 s33, v252
    s_barrier
    s_nop 1
    s_cmp_lt_u32 s33, 7
    s_cbranch_scc1 L_pool
    s_mov_b32 s88, 4194304
gn10:
    s_cmp_lg_u32 s95, 0
    s_cbranch_scc1 gn10x
    buffer_load_dword v250, off, s[96:99], 0 offset:64 sc1
    s_sub_u32 s88, s88, 1
    s_cbranch_scc1 gn10x
    s_waitcnt vmcnt(0)
    v_readfirstlane_b32 s95, v250
    s_nop 1
    s_branch gn10
gn10x:
    s_mov_b32 s40, 524288
mc2_w:
    buffer_load_dword v250, off, s[96:99], 0 offset:140 sc1
    s_waitcnt vmcnt(0)
    v_readfirstlane_b32 s41, v250
    s_nop 0
    s_cmp_lg_u32 s41, 0
    s_cbranch_scc1 mc2_known
    s_sub_u32 s40, s40, 1
    s_cbranch_scc1 mc2_force
    s_sleep 2
    s_branch mc2_w
mc2_force:
    v_mov_b32 v250, 2
    v_mov_b32 v251, 0
    s_mov_b64 exec, 1
    buffer_atomic_cmpswap v[250:251], off, s[96:99], 0 offset:140
    s_mov_b64 exec, -1
    s_waitcnt vmcnt(0)
    s_mov_b32 s40, 524288
    s_branch mc2_w
mc2_known:
    s_cmp_eq_u32 s41, 1
    s_cbranch_scc1 L_phase2b
    s_mov_b32 s37, 208
    v_mov_b32 v250, 1
    v_mov_b32 v251, 163832
    v_cmp_eq_u32 vcc, 0, v0
    s_nop 0
    s_and_saveexec_b64 s[38:39], vcc
    s_cbranch_execz tk11
    buffer_atomic_add v250, off, s[96:99], s37 sc0
    s_waitcnt vmcnt(0)
    ds_write_b32 v251, v250
    s_waitcnt lgkmcnt(0)
tk11:
    s_mov_b64 exec, -1
    s_barrier
    ds_read_b32 v252, v251
    s_waitcnt lgkmcnt(0)
    v_readfirstlane_b32 s12, v252
    s_barrier
    s_nop 3
    s_cmp_lt_u32 s12, 32
    s_cbranch_scc1 L_chain_safe
L_phase2b:
    s_mov_b32 s8, s76
    s_mov_b32 s9, s77
    s_mov_b32 s10, 4718592
    s_mov_b32 s11, 0x20000
    s_sub_u32 s33, s3, 1
    s_and_b32 s33, s33, 7
    s_cmp_eq_u32 s33, 7
    s_cbranch_scc1 L_p2scan
L_p2take:
    s_lshl_b32 s35, s33, 2
    s_add_u32 s35, s35, 160
    s_mov_b32 s37, s35
    v_mov_b32 v250, 1
    v_mov_b32 v251, 163832
    v_cmp_eq_u32 vcc, 0, v0
    s_nop 0
    s_and_saveexec_b64 s[38:39], vcc
    s_cbranch_execz tk12
    buffer_atomic_add v250, off, s[96:99], s37 sc0
    s_waitcnt vmcnt(0)
    ds_write_b32 v251, v250
    s_waitcnt lgkmcnt(0)
tk12:
    s_mov_b64 exec, -1
    s_barrier
    ds_read_b32 v252, v251
    s_waitcnt lgkmcnt(0)
    v_readfirstlane_b32 s34, v252
    s_barrier
    s_nop 3
    s_cmp_lt_u32 s33, 4
    s_cselect_b32 s36, 4, 6
    s_cmp_lt_u32 s34, s36
    s_cbranch_scc1 L_att0
    s_sub_u32 s34, s34, s36
    s_cmp_lt_u32 s34, 18
    s_cbranch_scc1 L_op_start
L_p2scan:
    v_and_b32 v1, 63, v0
    v_min_u32 v1, 6, v1
    v_lshlrev_b32 v2, 2, v1
    s_cmp_lg_u32 s32, 0
    v_mov_b32 v251, 163832
    s_cbranch_scc1 sw13
    buffer_load_dword v3, v2, s[96:99], 0 offen offset:160 sc1
    v_mov_b32 v4, 24
    v_cmp_gt_u32 vcc, 4, v1
    s_nop 1
    v_cndmask_b32 v4, v4, 22, vcc
    s_waitcnt vmcnt(0)
    v_cmp_lt_u32 vcc, v3, v4
    s_nop 0
    s_ff1_i32_b64 s40, vcc
    v_mov_b32 v250, s40
    ds_write_b32 v251, v250
    s_waitcnt lgkmcnt(0)
sw13:
    s_barrier
    ds_read_b32 v252, v251
    s_waitcnt lgkmcnt(0)
    v_readfirstlane_b32 s33, v252
    s_barrier
    s_nop 1
    s_cmp_lt_u32 s33, 7
    s_cbranch_scc1 L_p2take
    s_branch L_done
L_att0:
    s_mul_i32 s36, s34, 7
    s_mul_i32 s37, s34, 3
    s_add_u32 s37, s37, 12
    s_cmp_lt_u32 s34, 4
    s_cselect_b32 s34, s36, s37
    s_add_u32 s34, s34, s33
    s_cmp_ge_u32 s34, 32
    s_cbranch_scc1 L_done
L_att_next:
    s_lshr_b32 s16, s34, 3
    s_and_b32 s17, s34, 7
    s_lshl_b32 s17, s17, 2
    s_add_u32 s17, s17, s32
    s_lshr_b32 s36, s17, 1
    s_lshl_b32 s36, s36, 8
    s_add_u32 s36, s36, 125829120
    s_mul_i32 s37, s16, 43
    s_lshr_b32 s37, s37, 8
    s_mul_i32 s41, s37, 6
    s_sub_u32 s41, s16, s41
    v_and_b32 v1, 63, v0
    v_mul_u32_u24 v2, 6, v1
    v_add_u32 v2, s41, v2
    v_mov_b32 v4, s37
    s_and_b32 s41, s16, 7
    s_add_u32 s41, s41, 12
    s_lshr_b32 s37, s16, 3
    v_mov_b32 v5, s41
    v_mov_b32 v6, s37
    v_cmp_lt_u32 vcc, 1, v1
    s_nop 1
    v_cndmask_b32 v2, v2, v5, vcc
    v_cndmask_b32 v4, v4, v6, vcc
    v_lshlrev_b32 v2, 2, v2
    v_add3_u32 v4, v4, s95, 1
    s_mov_b32 s40, 4194304
L_aw1:
    buffer_load_dword v3, v2, s[4:7], s36 offen sc1
    s_sub_u32 s40, s40, 1
    s_cbranch_scc1 L_aw1_go
    s_waitcnt vmcnt(0)
    v_subrev_u32 v3, v4, v3
    v_cmp_lt_u32 vcc, 64, v3
    s_cbranch_vccz L_aw1_go
    s_sleep 4
    s_branch L_aw1
L_aw1_go:
    v_and_b32 v5, 63, v0
    v_lshlrev_b32 v1, 4, v5
    v_or_b32 v3, 128, v1
    v_lshrrev_b32 v4, 4, v5
    v_bfe_u32 v6, v5, 2, 2
    v_sub_u32 v4, v6, v4
    v_lshlrev_b32 v4, 3, v4
    v_and_b32 v6, 3, v5
    v_add_u32 v4, v4, v6
    v_mov_b32 v6, 0xf149f2ca
    s_mov_b32 s22, 0x3e0293ee
    s_lshl_b32 s18, s16, 5
    s_add_u32 s18, s18, s17
    s_lshl_b32 s19, s18, 13
    s_add_u32 s20, s19, 33554432
    buffer_load_dwordx4 v[8:11], v1, s[4:7], s20 offen offset:0 sc1
    s_add_u32 s20, s19, 33554432
    buffer_load_dwordx4 v[12:15], v1, s[4:7], s20 offen offset:1024 sc1
    s_add_u32 s20, s19, 33554432
    buffer_load_dwordx4 v[16:19], v1, s[4:7], s20 offen offset:2048 sc1
    s_add_u32 s20, s19, 33554432
    buffer_load_dwordx4 v[20:23], v1, s[4:7], s20 offen offset:3072 sc1
    s_add_u32 s20, s19, 33558528
    buffer_load_dwordx4 v[24:27], v1, s[4:7], s20 offen offset:0 sc1
    s_add_u32 s20, s19, 33558528
    buffer_load_dwordx4 v[28:31], v1, s[4:7], s20 offen offset:1024 sc1
    s_add_u32 s20, s19, 33558528
    buffer_load_dwordx4 v[32:35], v1, s[4:7], s20 offen offset:2048 sc1
    s_add_u32 s20, s19, 33558528
    buffer_load_dwordx4 v[36:39], v1, s[4:7], s20 offen offset:3072 sc1
    s_lshl_b32 s21, s18, 14
    s_add_u32 s20, s21, 0
    buffer_load_dwordx4 v[40:43], v1, s[4:7], s20 offen offset:0 sc1
    s_add_u32 s20, s21, 4096
    buffer_load_dwordx4 v[44:47], v1, s[4:7], s20 offen offset:0 sc1
    s_add_u32 s20, s21, 8192
    buffer_load_dwordx4 v[48:51], v1, s[4:7], s20 offen offset:0 sc1
    s_add_u32 s20, s21, 12288
    buffer_load_dwordx4 v[52:55], v1, s[4:7], s20 offen offset:0 sc1
    s_add_u32 s20, s21, 0
    buffer_load_dwordx4 v[56:59], v1, s[4:7], s20 offen offset:1024 sc1
    s_add_u32 s20, s21, 4096
    buffer_load_dwordx4 v[60:63], v1, s[4:7], s20 offen offset:1024 sc1
    s_add_u32 s20, s21, 8192
    buffer_load_dwordx4 v[64:67], v1, s[4:7], s20 offen offset:1024 sc1
    s_add_u32 s20, s21, 12288
    buffer_load_dwordx4 v[68:71], v1, s[4:7], s20 offen offset:1024 sc1
    s_add_u32 s20, s21, 0
    buffer_load_dwordx4 v[88:91], v1, s[4:7], s20 offen offset:2048 sc1
    s_add_u32 s20, s21, 4096
    buffer_load_dwordx4 v[92:95], v1, s[4:7], s20 offen offset:2048 sc1
    s_add_u32 s20, s21, 8192
    buffer_load_dwordx4 v[96:99], v1, s[4:7], s20 offen offset:2048 sc1
    s_add_u32 s20, s21, 12288
    buffer_load_dwordx4 v[100:103], v1, s[4:7], s20 offen offset:2048 sc1
    s_add_u32 s20, s21, 0
    buffer_load_dwordx4 v[104:107], v1, s[4:7], s20 offen offset:3072 sc1
    s_add_u32 s20, s21, 4096
    buffer_load_dwordx4 v[108:111], v1, s[4:7], s20 offen offset:3072 sc1
    s_add_u32 s20, s21, 8192
    buffer_load_dwordx4 v[112:115], v1, s[4:7], s20 offen offset:3072 sc1
    s_add_u32 s20, s21, 12288
    buffer_load_dwordx4 v[116:119], v1, s[4:7], s20 offen offset:3072 sc1
    v_mov_b32 v172, 0x3f803f80
    v_mov_b32 v173, 0x3f803f80
    v_mov_b32 v174, 0x3f803f80
    v_mov_b32 v175, 0x3f803f80
    v_mov_b32 v176, 0x3f003f00
    v_mov_b32 v177, 0x3f003f00
    s_waitcnt vmcnt(8)
    v_mfma_f32_16x16x32_bf16 v[136:139], v[40:43], v[8:11], 0
    v_mfma_f32_16x16x32_bf16 v[140:143], v[56:59], v[8:11], 0
    v_mfma_f32_16x16x32_bf16 v[148:151], v[40:43], v[24:27], 0
    v_mfma_f32_16x16x32_bf16 v[152:155], v[56:59], v[24:27], 0
    v_mfma_f32_16x16x32_bf16 v[136:139], v[44:47], v[12:15], v[136:139]
    v_mfma_f32_16x16x32_bf16 v[140:143], v[60:63], v[12:15], v[140:143]
    v_mfma_f32_16x16x32_bf16 v[148:151], v[44:47], v[28:31], v[148:151]
    v_mfma_f32_16x16x32_bf16 v[152:155], v[60:63], v[28:31], v[152:155]
    v_mfma_f32_16x16x32_bf16 v[136:139], v[48:51], v[16:19], v[136:139]
    v_mfma_f32_16x16x32_bf16 v[140:143], v[64:67], v[16:19], v[140:143]
    v_mfma_f32_16x16x32_bf16 v[148:151], v[48:51], v[32:35], v[148:151]
    v_mfma_f32_16x16x32_bf16 v[152:155], v[64:67], v[32:35], v[152:155]
    v_mfma_f32_16x16x32_bf16 v[136:139], v[52:55], v[20:23], v[136:139]
    v_mfma_f32_16x16x32_bf16 v[140:143], v[68:71], v[20:23], v[140:143]
    v_mfma_f32_16x16x32_bf16 v[148:151], v[52:55], v[36:39], v[148:151]
    v_mfma_f32_16x16x32_bf16 v[152:155], v[68:71], v[36:39], v[152:155]
    v_cmp_le_i32 vcc, 0, v4
    s_nop 1
    v_cndmask_b32 v136, v6, v136, vcc
    v_cmp_le_i32 vcc, 1, v4
    s_nop 1
    v_cndmask_b32 v137, v6, v137, vcc
    v_cmp_le_i32 vcc, 2, v4
    s_nop 1
    v_cndmask_b32 v138, v6, v138, vcc
    v_cmp_le_i32 vcc, 3, v4
    s_nop 1
    v_cndmask_b32 v139, v6, v139, vcc
    v_cmp_le_i32 vcc, 4, v4
    s_nop 1
    v_cndmask_b32 v140, v6, v140, vcc
    v_cmp_le_i32 vcc, 5, v4
    s_nop 1
    v_cndmask_b32 v141, v6, v141, vcc
    v_cmp_le_i32 vcc, 6, v4
    s_nop 1
    v_cndmask_b32 v142, v6, v142, vcc
    v_cmp_le_i32 vcc, 7, v4
    s_nop 1
    v_cndmask_b32 v143, v6, v143, vcc
    v_cmp_le_i32 vcc, -4, v4
    s_nop 1
    v_cndmask_b32 v148, v6, v148, vcc
    v_cmp_le_i32 vcc, -3, v4
    s_nop 1
    v_cndmask_b32 v149, v6, v149, vcc
    v_cmp_le_i32 vcc, -2, v4
    s_nop 1
    v_cndmask_b32 v150, v6, v150, vcc
    v_cmp_le_i32 vcc, -1, v4
    s_nop 1
    v_cndmask_b32 v151, v6, v151, vcc
    v_cmp_le_i32 vcc, 0, v4
    s_nop 1
    v_cndmask_b32 v152, v6, v152, vcc
    v_cmp_le_i32 vcc, 1, v4
    s_nop 1
    v_cndmask_b32 v153, v6, v153, vcc
    v_cmp_le_i32 vcc, 2, v4
    s_nop 1
    v_cndmask_b32 v154, v6, v154, vcc
    v_cmp_le_i32 vcc, 3, v4
    s_nop 1
    v_cndmask_b32 v155, v6, v155, vcc
    s_nop 1
    s_mov_b32 s88, 65536
cw14:
    buffer_load_dword v199, off, s[4:7], s36 offset:128 sc1
    s_waitcnt vmcnt(0)
    v_readfirstlane_b32 s42, v199
    s_nop 0
    s_sub_u32 s42, s42, s95
    s_cmp_gt_u32 s42, 64
    s_cselect_b32 s42, 0, s42
    s_add_u32 s42, s42, 2
    s_cmp_ge_u32 s42, s16
    s_cbranch_scc1 cw14x
    s_sub_u32 s88, s88, 1
    s_cbranch_scc1 cw14x
    s_sub_u32 s42, s16, s42
    s_min_u32 s42, s42, 6
cw14s:
    s_sleep 24
    s_sub_u32 s42, s42, 1
    s_cmp_lg_u32 s42, 0
    s_cbranch_scc1 cw14s
    s_branch cw14
cw14x:
    s_and_b32 s37, s16, 1
    s_lshl_b32 s37, s37, 2
    s_add_u32 s37, s37, s36
    s_add_u32 s37, s37, 128
    s_add_u32 s41, s16, s95
    s_add_u32 s41, s41, 1
    s_lshl_b32 s42, s17, 7
    s_add_u32 s42, s42, 125845504
    s_cmp_ge_u32 s16, 62
    s_cselect_b32 s37, s42, s37
    s_cselect_b32 s42, 12, 8
    v_lshlrev_b32 v198, 2, v0
    v_and_b32 v198, s42, v198
    s_mov_b32 s40, 4194304
L_aw2:
    buffer_load_dword v199, v198, s[4:7], s37 offen sc1
    s_sub_u32 s40, s40, 1
    s_cbranch_scc1 L_aw2_go
    s_waitcnt vmcnt(0)
    v_subrev_u32 v199, s41, v199
    v_cmp_lt_u32 vcc, 64, v199
    s_cbranch_vccz L_aw2_go
    s_sleep 3
    s_branch L_aw2
L_aw2_go:
    s_lshl_b32 s20, s18, 12
    s_add_u32 s20, s20, 71303168
    buffer_load_dwordx4 v[72:75], v3, s[4:7], s20 offen offset:0 sc1
    buffer_load_dwordx4 v[76:79], v3, s[4:7], s20 offen offset:1024 sc1
    buffer_load_dwordx4 v[80:83], v3, s[4:7], s20 offen offset:2048 sc1
    buffer_load_dwordx4 v[84:87], v3, s[4:7], s20 offen offset:3072 sc1
    s_lshl_b32 s20, s18, 12
    s_add_u32 s20, s20, 80740352
    buffer_load_dwordx4 v[120:123], v1, s[4:7], s20 offen offset:0 sc1
    buffer_load_dwordx4 v[124:127], v1, s[4:7], s20 offen offset:1024 sc1
    buffer_load_dwordx4 v[128:131], v1, s[4:7], s20 offen offset:2048 sc1
    buffer_load_dwordx4 v[132:135], v1, s[4:7], s20 offen offset:3072 sc1
    s_waitcnt vmcnt(4)
    v_mfma_f32_16x16x32_bf16 v[144:147], v[72:75], v[8:11], 0
    v_mfma_f32_16x16x32_bf16 v[156:159], v[72:75], v[24:27], 0
    v_mfma_f32_16x16x32_bf16 v[144:147], v[76:79], v[12:15], v[144:147]
    v_mfma_f32_16x16x32_bf16 v[156:159], v[76:79], v[28:31], v[156:159]
    v_mfma_f32_16x16x32_bf16 v[144:147], v[80:83], v[16:19], v[144:147]
    v_mfma_f32_16x16x32_bf16 v[156:159], v[80:83], v[32:35], v[156:159]
    v_mfma_f32_16x16x32_bf16 v[144:147], v[84:87], v[20:23], v[144:147]
    v_mfma_f32_16x16x32_bf16 v[156:159], v[84:87], v[36:39], v[156:159]
    v_max3_f32 v196, v136, v137, v138
    v_max3_f32 v197, v139, v140, v141
    v_max3_f32 v196, v196, v142, v143
    v_max3_f32 v197, v197, v144, v145
    v_max3_f32 v196, v196, v146, v147
    v_max_f32 v196, v196, v197
    v_mov_b32 v197, v196
    s_nop 1
    v_permlane32_swap_b32 v196, v197
    v_max_f32 v196, v196, v197
    v_mov_b32 v197, v196
    s_nop 1
    v_permlane16_swap_b32 v196, v197
    v_max_f32 v196, v196, v197
    v_mul_f32 v196, s22, v196
    v_sub_f32 v196, 0, v196
    v_fma_f32 v136, v136, s22, v196
    v_fma_f32 v137, v137, s22, v196
    v_fma_f32 v138, v138, s22, v196
    v_fma_f32 v139, v139, s22, v196
    v_fma_f32 v140, v140, s22, v196
    v_fma_f32 v141, v141, s22, v196
    v_fma_f32 v142, v142, s22, v196
    v_fma_f32 v143, v143, s22, v196
    v_fma_f32 v144, v144, s22, v196
    v_fma_f32 v145, v145, s22, v196
    v_fma_f32 v146, v146, s22, v196
    v_fma_f32 v147, v147, s22, v196
    v_exp_f32 v136, v136
    v_exp_f32 v137, v137
    v_exp_f32 v138, v138
    v_exp_f32 v139, v139
    v_exp_f32 v140, v140
    v_exp_f32 v141, v141
    v_exp_f32 v142, v142
    v_exp_f32 v143, v143
    v_exp_f32 v144, v144
    v_exp_f32 v145, v145
    v_exp_f32 v146, v146
    v_exp_f32 v147, v147
    v_cvt_pk_bf16_f32 v160, v136, v137
    v_cvt_pk_bf16_f32 v161, v138, v139
    v_cvt_pk_bf16_f32 v162, v140, v141
    v_cvt_pk_bf16_f32 v163, v142, v143
    v_cvt_pk_bf16_f32 v164, v144, v145
    v_cvt_pk_bf16_f32 v165, v146, v147
    v_max3_f32 v196, v148, v149, v150
    v_max3_f32 v197, v151, v152, v153
    v_max3_f32 v196, v196, v154, v155
    v_max3_f32 v197, v197, v156, v157
    v_max3_f32 v196, v196, v158, v159
    v_max_f32 v196, v196, v197
    v_mov_b32 v197, v196
    s_nop 1
    v_permlane32_swap_b32 v196, v197
    v_max_f32 v196, v196, v197
    v_mov_b32 v197, v196
    s_nop 1
    v_permlane16_swap_b32 v196, v197
    v_max_f32 v196, v196, v197
    v_mul_f32 v196, s22, v196
    v_sub_f32 v196, 0, v196
    v_fma_f32 v148, v148, s22, v196
    v_fma_f32 v149, v149, s22, v196
    v_fma_f32 v150, v150, s22, v196
    v_fma_f32 v151, v151, s22, v196
    v_fma_f32 v152, v152, s22, v196
    v_fma_f32 v153, v153, s22, v196
    v_fma_f32 v154, v154, s22, v196
    v_fma_f32 v155, v155, s22, v196
    v_fma_f32 v156, v156, s22, v196
    v_fma_f32 v157, v157, s22, v196
    v_fma_f32 v158, v158, s22, v196
    v_fma_f32 v159, v159, s22, v196
    v_exp_f32 v148, v148
    v_exp_f32 v149, v149
    v_exp_f32 v150, v150
    v_exp_f32 v151, v151
    v_exp_f32 v152, v152
    v_exp_f32 v153, v153
    v_exp_f32 v154, v154
    v_exp_f32 v155, v155
    v_exp_f32 v156, v156
    v_exp_f32 v157, v157
    v_exp_f32 v158, v158
    v_exp_f32 v159, v159
    v_cvt_pk_bf16_f32 v166, v148, v149
    v_cvt_pk_bf16_f32 v167, v150, v151
    v_cvt_pk_bf16_f32 v168, v152, v153
    v_cvt_pk_bf16_f32 v169, v154, v155
    v_cvt_pk_bf16_f32 v170, v156, v157
    v_cvt_pk_bf16_f32 v171, v158, v159
    v_mfma_f32_16x16x32_bf16 v[180:183], v[172:175], v[160:163], 0
    v_mfma_f32_16x16x32_bf16 v[184:187], v[172:175], v[166:169], 0
    v_mfma_f32_16x16x16_bf16 v[180:183], v[176:177], v[164:165], v[180:183]
    v_mfma_f32_16x16x16_bf16 v[184:187], v[176:177], v[170:171], v[184:187]
    s_nop 3
    v_rcp_f32 v180, v180
    s_nop 2
    v_rcp_f32 v184, v184
    s_waitcnt vmcnt(0)
    s_lshl_b32 s18, s16, 18
    s_lshl_b32 s19, s17, 12
    s_add_u32 s18, s18, s19
    s_add_u32 s18, s18, 50331648
    s_add_u32 s19, s18, 131072
    v_mfma_f32_16x16x32_bf16 v[8:11], v[88:91], v[160:163], 0
    v_mfma_f32_16x16x32_bf16 v[12:15], v[104:107], v[160:163], 0
    v_mfma_f32_16x16x32_bf16 v[16:19], v[88:91], v[166:169], 0
    v_mfma_f32_16x16x32_bf16 v[20:23], v[104:107], v[166:169], 0
    v_mfma_f32_16x16x32_bf16 v[24:27], v[92:95], v[160:163], 0
    v_mfma_f32_16x16x32_bf16 v[28:31], v[108:111], v[160:163], 0
    v_mfma_f32_16x16x32_bf16 v[32:35], v[92:95], v[166:169], 0
    v_mfma_f32_16x16x32_bf16 v[36:39], v[108:111], v[166:169], 0
    v_mfma_f32_16x16x32_bf16 v[40:43], v[96:99], v[160:163], 0
    v_mfma_f32_16x16x32_bf16 v[44:47], v[112:115], v[160:163], 0
    v_mfma_f32_16x16x32_bf16 v[48:51], v[96:99], v[166:169], 0
    v_mfma_f32_16x16x32_bf16 v[52:55], v[112:115], v[166:169], 0
    v_mfma_f32_16x16x32_bf16 v[56:59], v[100:103], v[160:163], 0
    v_mfma_f32_16x16x32_bf16 v[60:63], v[116:119], v[160:163], 0
    v_mfma_f32_16x16x32_bf16 v[64:67], v[100:103], v[166:169], 0
    v_mfma_f32_16x16x32_bf16 v[68:71], v[116:119], v[166:169], 0
    v_mfma_f32_16x16x16_bf16 v[8:11], v[120:121], v[164:165], v[8:11]
    v_mfma_f32_16x16x16_bf16 v[12:15], v[122:123], v[164:165], v[12:15]
    v_mfma_f32_16x16x16_bf16 v[16:19], v[120:121], v[170:171], v[16:19]
    v_mfma_f32_16x16x16_bf16 v[20:23], v[122:123], v[170:171], v[20:23]
    v_mfma_f32_16x16x16_bf16 v[24:27], v[124:125], v[164:165], v[24:27]
    v_mfma_f32_16x16x16_bf16 v[28:31], v[126:127], v[164:165], v[28:31]
    v_mfma_f32_16x16x16_bf16 v[32:35], v[124:125], v[170:171], v[32:35]
    v_mfma_f32_16x16x16_bf16 v[36:39], v[126:127], v[170:171], v[36:39]
    v_mfma_f32_16x16x16_bf16 v[40:43], v[128:129], v[164:165], v[40:43]
    v_mfma_f32_16x16x16_bf16 v[44:47], v[130:131], v[164:165], v[44:47]
    v_mfma_f32_16x16x16_bf16 v[48:51], v[128:129], v[170:171], v[48:51]
    v_mfma_f32_16x16x16_bf16 v[52:55], v[130:131], v[170:171], v[52:55]
    v_mfma_f32_16x16x16_bf16 v[56:59], v[132:133], v[164:165], v[56:59]
    v_mfma_f32_16x16x16_bf16 v[60:63], v[134:135], v[164:165], v[60:63]
    v_mfma_f32_16x16x16_bf16 v[64:67], v[132:133], v[170:171], v[64:67]
    v_mfma_f32_16x16x16_bf16 v[68:71], v[134:135], v[170:171], v[68:71]
    v_mul_f32 v8, v8, v180
    v_mul_f32 v12, v12, v180
    v_mul_f32 v9, v9, v180
    v_mul_f32 v13, v13, v180
    v_mul_f32 v10, v10, v180
    v_mul_f32 v14, v14, v180
    v_mul_f32 v11, v11, v180
    v_mul_f32 v15, v15, v180
    v_cvt_pk_bf16_f32 v8, v8, v9
    v_cvt_pk_bf16_f32 v9, v10, v11
    v_cvt_pk_bf16_f32 v10, v12, v13
    v_cvt_pk_bf16_f32 v11, v14, v15
    buffer_store_dwordx4 v[8:11], v1, s[4:7], s18 offen offset:0 sc1
    v_mul_f32 v16, v16, v184
    v_mul_f32 v20, v20, v184
    v_mul_f32 v17, v17, v184
    v_mul_f32 v21, v21, v184
    v_mul_f32 v18, v18, v184
    v_mul_f32 v22, v22, v184
    v_mul_f32 v19, v19, v184
    v_mul_f32 v23, v23, v184
    v_cvt_pk_bf16_f32 v16, v16, v17
    v_cvt_pk_bf16_f32 v17, v18, v19
    v_cvt_pk_bf16_f32 v18, v20, v21
    v_cvt_pk_bf16_f32 v19, v22, v23
    buffer_store_dwordx4 v[16:19], v1, s[4:7], s19 offen offset:0 sc1
    v_mul_f32 v24, v24, v180
    v_mul_f32 v28, v28, v180
    v_mul_f32 v25, v25, v180
    v_mul_f32 v29, v29, v180
    v_mul_f32 v26, v26, v180
    v_mul_f32 v30, v30, v180
    v_mul_f32 v27, v27, v180
    v_mul_f32 v31, v31, v180
    v_cvt_pk_bf16_f32 v24, v24, v25
    v_cvt_pk_bf16_f32 v25, v26, v27
    v_cvt_pk_bf16_f32 v26, v28, v29
    v_cvt_pk_bf16_f32 v27, v30, v31
    buffer_store_dwordx4 v[24:27], v1, s[4:7], s18 offen offset:1024 sc1
    v_mul_f32 v32, v32, v184
    v_mul_f32 v36, v36, v184
    v_mul_f32 v33, v33, v184
    v_mul_f32 v37, v37, v184
    v_mul_f32 v34, v34, v184
    v_mul_f32 v38, v38, v184
    v_mul_f32 v35, v35, v184
    v_mul_f32 v39, v39, v184
    v_cvt_pk_bf16_f32 v32, v32, v33
    v_cvt_pk_bf16_f32 v33, v34, v35
    v_cvt_pk_bf16_f32 v34, v36, v37
    v_cvt_pk_bf16_f32 v35, v38, v39
    buffer_store_dwordx4 v[32:35], v1, s[4:7], s19 offen offset:1024 sc1
    v_mul_f32 v40, v40, v180
    v_mul_f32 v44, v44, v180
    v_mul_f32 v41, v41, v180
    v_mul_f32 v45, v45, v180
    v_mul_f32 v42, v42, v180
    v_mul_f32 v46, v46, v180
    v_mul_f32 v43, v43, v180
    v_mul_f32 v47, v47, v180
    v_cvt_pk_bf16_f32 v40, v40, v41
    v_cvt_pk_bf16_f32 v41, v42, v43
    v_cvt_pk_bf16_f32 v42, v44, v45
    v_cvt_pk_bf16_f32 v43, v46, v47
    buffer_store_dwordx4 v[40:43], v1, s[4:7], s18 offen offset:2048 sc1
    v_mul_f32 v48, v48, v184
    v_mul_f32 v52, v52, v184
    v_mul_f32 v49, v49, v184
    v_mul_f32 v53, v53, v184
    v_mul_f32 v50, v50, v184
    v_mul_f32 v54, v54, v184
    v_mul_f32 v51, v51, v184
    v_mul_f32 v55, v55, v184
    v_cvt_pk_bf16_f32 v48, v48, v49
    v_cvt_pk_bf16_f32 v49, v50, v51
    v_cvt_pk_bf16_f32 v50, v52, v53
    v_cvt_pk_bf16_f32 v51, v54, v55
    buffer_store_dwordx4 v[48:51], v1, s[4:7], s19 offen offset:2048 sc1
    v_mul_f32 v56, v56, v180
    v_mul_f32 v60, v60, v180
    v_mul_f32 v57, v57, v180
    v_mul_f32 v61, v61, v180
    v_mul_f32 v58, v58, v180
    v_mul_f32 v62, v62, v180
    v_mul_f32 v59, v59, v180
    v_mul_f32 v63, v63, v180
    v_cvt_pk_bf16_f32 v56, v56, v57
    v_cvt_pk_bf16_f32 v57, v58, v59
    v_cvt_pk_bf16_f32 v58, v60, v61
    v_cvt_pk_bf16_f32 v59, v62, v63
    buffer_store_dwordx4 v[56:59], v1, s[4:7], s18 offen offset:3072 sc1
    v_mul_f32 v64, v64, v184
    v_mul_f32 v68, v68, v184
    v_mul_f32 v65, v65, v184
    v_mul_f32 v69, v69, v184
    v_mul_f32 v66, v66, v184
    v_mul_f32 v70, v70, v184
    v_mul_f32 v67, v67, v184
    v_mul_f32 v71, v71, v184
    v_cvt_pk_bf16_f32 v64, v64, v65
    v_cvt_pk_bf16_f32 v65, v66, v67
    v_cvt_pk_bf16_f32 v66, v68, v69
    v_cvt_pk_bf16_f32 v67, v70, v71
    buffer_store_dwordx4 v[64:67], v1, s[4:7], s19 offen offset:3072 sc1
    s_lshr_b32 s40, s34, 1
    s_lshl_b32 s40, s40, 7
    s_and_b32 s41, s17, 7
    s_lshl_b32 s41, s41, 2
    s_add_u32 s40, s40, s41
    s_add_u32 s40, s40, 125894656
    v_mov_b32 v250, s95
    s_waitcnt vmcnt(0)
    s_mov_b64 exec, 1
    buffer_store_dword v250, off, s[4:7], s40 sc1
    s_mov_b64 exec, -1
    s_add_u32 s34, s34, 32
    s_cmp_lt_u32 s34, 512
    s_cbranch_scc1 L_att_next
    s_branch L_done
L_op_start:
    s_mov_b32 s16, s33
    s_mov_b32 s33, s34
    v_and_b32 v2, 63, v0
    v_lshlrev_b32 v1, 4, v2
    v_lshrrev_b32 v5, 2, v2
    v_mul_u32_u24 v3, 1152, v5
    v_and_b32 v5, 3, v2
    v_lshl_add_u32 v3, v5, 4, v3
    s_lshl_b32 s21, s32, 12
    v_add_u32 v4, s21, v1
    s_mov_b64 s[12:13], s[58:59]
    s_mov_b32 s14, 4718592
    s_mov_b32 s15, 0x20000
    s_mul_i32 s19, s32, 1179648
    s_lshl_b32 s18, s33, 6
    s_add_u32 s19, s19, s18
    s_add_u32 s18, s19, 0
    s_add_u32 m0, s21, 0
    s_nop 0
    buffer_load_dwordx4 v3, s[12:15], s18 offen lds
    s_add_u32 m0, s21, 1024
    s_add_u32 s18, s18, 18432
    buffer_load_dwordx4 v3, s[12:15], s18 offen lds
    s_add_u32 m0, s21, 2048
    s_add_u32 s18, s18, 18432
    buffer_load_dwordx4 v3, s[12:15], s18 offen lds
    s_add_u32 m0, s21, 3072
    s_add_u32 s18, s18, 18432
    buffer_load_dwordx4 v3, s[12:15], s18 offen lds
    s_add_u32 s18, s19, 73728
    s_add_u32 m0, s21, 16384
    s_nop 0
    buffer_load_dwordx4 v3, s[12:15], s18 offen lds
    s_add_u32 m0, s21, 17408
    s_add_u32 s18, s18, 18432
    buffer_load_dwordx4 v3, s[12:15], s18 offen lds
    s_add_u32 m0, s21, 18432
    s_add_u32 s18, s18, 18432
    buffer_load_dwordx4 v3, s[12:15], s18 offen lds
    s_add_u32 m0, s21, 19456
    s_add_u32 s18, s18, 18432
    buffer_load_dwordx4 v3, s[12:15], s18 offen lds
    s_add_u32 s18, s19, 147456
    s_add_u32 m0, s21, 32768
    s_nop 0
    buffer_load_dwordx4 v3, s[12:15], s18 offen lds
    s_add_u32 m0, s21, 33792
    s_add_u32 s18, s18, 18432
    buffer_load_dwordx4 v3, s[12:15], s18 offen lds
    s_add_u32 m0, s21, 34816
    s_add_u32 s18, s18, 18432
    buffer_load_dwordx4 v3, s[12:15], s18 offen lds
    s_add_u32 m0, s21, 35840
    s_add_u32 s18, s18, 18432
    buffer_load_dwordx4 v3, s[12:15], s18 offen lds
    s_add_u32 s18, s19, 221184
    s_add_u32 m0, s21, 49152
    s_nop 0
    buffer_load_dwordx4 v3, s[12:15], s18 offen lds
    s_add_u32 m0, s21, 50176
    s_add_u32 s18, s18, 18432
    buffer_load_dwordx4 v3, s[12:15], s18 offen lds
    s_add_u32 m0, s21, 51200
    s_add_u32 s18, s18, 18432
    buffer_load_dwordx4 v3, s[12:15], s18 offen lds
    s_add_u32 m0, s21, 52224
    s_add_u32 s18, s18, 18432
    buffer_load_dwordx4 v3, s[12:15], s18 offen lds
    s_add_u32 s18, s19, 294912
    s_add_u32 m0, s21, 65536
    s_nop 0
    buffer_load_dwordx4 v3, s[12:15], s18 offen lds
    s_add_u32 m0, s21, 66560
    s_add_u32 s18, s18, 18432
    buffer_load_dwordx4 v3, s[12:15], s18 offen lds
    s_add_u32 m0, s21, 67584
    s_add_u32 s18, s18, 18432
    buffer_load_dwordx4 v3, s[12:15], s18 offen lds
    s_add_u32 m0, s21, 68608
    s_add_u32 s18, s18, 18432
    buffer_load_dwordx4 v3, s[12:15], s18 offen lds
    s_add_u32 s18, s19, 368640
    s_add_u32 m0, s21, 81920
    s_nop 0
    buffer_load_dwordx4 v3, s[12:15], s18 offen lds
    s_add_u32 m0, s21, 82944
    s_add_u32 s18, s18, 18432
    buffer_load_dwordx4 v3, s[12:15], s18 offen lds
    s_add_u32 m0, s21, 83968
    s_add_u32 s18, s18, 18432
    buffer_load_dwordx4 v3, s[12:15], s18 offen lds
    s_add_u32 m0, s21, 84992
    s_add_u32 s18, s18, 18432
    buffer_load_dwordx4 v3, s[12:15], s18 offen lds
    s_add_u32 s18, s19, 442368
    s_add_u32 m0, s21, 98304
    s_nop 0
    buffer_load_dwordx4 v3, s[12:15], s18 offen lds
    s_add_u32 m0, s21, 99328
    s_add_u32 s18, s18, 18432
    buffer_load_dwordx4 v3, s[12:15], s18 offen lds
    s_add_u32 m0, s21, 100352
    s_add_u32 s18, s18, 18432
    buffer_load_dwordx4 v3, s[12:15], s18 offen lds
    s_add_u32 m0, s21, 101376
    s_add_u32 s18, s18, 18432
    buffer_load_dwordx4 v3, s[12:15], s18 offen lds
    s_add_u32 s18, s19, 516096
    s_add_u32 m0, s21, 114688
    s_nop 0
    buffer_load_dwordx4 v3, s[12:15], s18 offen lds
    s_add_u32 m0, s21, 115712
    s_add_u32 s18, s18, 18432
    buffer_load_dwordx4 v3, s[12:15], s18 offen lds
    s_add_u32 m0, s21, 116736
    s_add_u32 s18, s18, 18432
    buffer_load_dwordx4 v3, s[12:15], s18 offen lds
    s_add_u32 m0, s21, 117760
    s_add_u32 s18, s18, 18432
    buffer_load_dwordx4 v3, s[12:15], s18 offen lds
    s_add_u32 s18, s19, 589824
    s_add_u32 m0, s21, 131072
    s_nop 0
    buffer_load_dwordx4 v3, s[12:15], s18 offen lds
    s_add_u32 m0, s21, 132096
    s_add_u32 s18, s18, 18432
    buffer_load_dwordx4 v3, s[12:15], s18 offen lds
    s_add_u32 m0, s21, 133120
    s_add_u32 s18, s18, 18432
    buffer_load_dwordx4 v3, s[12:15], s18 offen lds
    s_add_u32 m0, s21, 134144
    s_add_u32 s18, s18, 18432
    buffer_load_dwordx4 v3, s[12:15], s18 offen lds
    v_add_u32 v6, 0, v4
    v_xor_b32 v7, 32, v6
    s_waitcnt vmcnt(32)
    ds_read_b64_tr_b16 a[0:1], v6 offset:0
    ds_read_b64_tr_b16 a[2:3], v6 offset:1024
    ds_read_b64_tr_b16 a[4:5], v6 offset:8
    ds_read_b64_tr_b16 a[6:7], v6 offset:1032
    ds_read_b64_tr_b16 a[8:9], v6 offset:2048
    ds_read_b64_tr_b16 a[10:11], v6 offset:3072
    ds_read_b64_tr_b16 a[12:13], v6 offset:2056
    ds_read_b64_tr_b16 a[14:15], v6 offset:3080
    s_waitcnt lgkmcnt(0)
    s_add_u32 s18, s19, 663552
    s_add_u32 m0, s21, 0
    s_nop 0
    buffer_load_dwordx4 v3, s[12:15], s18 offen lds
    s_add_u32 m0, s21, 1024
    s_add_u32 s18, s18, 18432
    buffer_load_dwordx4 v3, s[12:15], s18 offen lds
    s_add_u32 m0, s21, 2048
    s_add_u32 s18, s18, 18432
    buffer_load_dwordx4 v3, s[12:15], s18 offen lds
    s_add_u32 m0, s21, 3072
    s_add_u32 s18, s18, 18432
    buffer_load_dwordx4 v3, s[12:15], s18 offen lds
    v_add_u32 v6, 16384, v4
    v_xor_b32 v7, 32, v6
    s_waitcnt vmcnt(32)
    ds_read_b64_tr_b16 a[16:17], v6 offset:0
    ds_read_b64_tr_b16 a[18:19], v6 offset:1024
    ds_read_b64_tr_b16 a[20:21], v6 offset:8
    ds_read_b64_tr_b16 a[22:23], v6 offset:1032
    ds_read_b64_tr_b16 a[24:25], v6 offset:2048
    ds_read_b64_tr_b16 a[26:27], v6 offset:3072
    ds_read_b64_tr_b16 a[28:29], v6 offset:2056
    ds_read_b64_tr_b16 a[30:31], v6 offset:3080
    s_waitcnt lgkmcnt(0)
    s_add_u32 s18, s19, 737280
    s_add_u32 m0, s21, 16384
    s_nop 0
    buffer_load_dwordx4 v3, s[12:15], s18 offen lds
    s_add_u32 m0, s21, 17408
    s_add_u32 s18, s18, 18432
    buffer_load_dwordx4 v3, s[12:15], s18 offen lds
    s_add_u32 m0, s21, 18432
    s_add_u32 s18, s18, 18432
    buffer_load_dwordx4 v3, s[12:15], s18 offen lds
    s_add_u32 m0, s21, 19456
    s_add_u32 s18, s18, 18432
    buffer_load_dwordx4 v3, s[12:15], s18 offen lds
    v_add_u32 v6, 32768, v4
    v_xor_b32 v7, 32, v6
    s_waitcnt vmcnt(32)
    ds_read_b64_tr_b16 a[32:33], v6 offset:0
    ds_read_b64_tr_b16 a[34:35], v6 offset:1024
    ds_read_b64_tr_b16 a[36:37], v6 offset:8
    ds_read_b64_tr_b16 a[38:39], v6 offset:1032
    ds_read_b64_tr_b16 a[40:41], v6 offset:2048
    ds_read_b64_tr_b16 a[42:43], v6 offset:3072
    ds_read_b64_tr_b16 a[44:45], v6 offset:2056
    ds_read_b64_tr_b16 a[46:47], v6 offset:3080
    s_waitcnt lgkmcnt(0)
    s_add_u32 s18, s19, 811008
    s_add_u32 m0, s21, 32768
    s_nop 0
    buffer_load_dwordx4 v3, s[12:15], s18 offen lds
    s_add_u32 m0, s21, 33792
    s_add_u32 s18, s18, 18432
    buffer_load_dwordx4 v3, s[12:15], s18 offen lds
    s_add_u32 m0, s21, 34816
    s_add_u32 s18, s18, 18432
    buffer_load_dwordx4 v3, s[12:15], s18 offen lds
    s_add_u32 m0, s21, 35840
    s_add_u32 s18, s18, 18432
    buffer_load_dwordx4 v3, s[12:15], s18 offen lds
    v_add_u32 v6, 49152, v4
    v_xor_b32 v7, 32, v6
    s_waitcnt vmcnt(32)
    ds_read_b64_tr_b16 a[48:49], v6 offset:0
    ds_read_b64_tr_b16 a[50:51], v6 offset:1024
    ds_read_b64_tr_b16 a[52:53], v6 offset:8
    ds_read_b64_tr_b16 a[54:55], v6 offset:1032
    ds_read_b64_tr_b16 a[56:57], v6 offset:2048
    ds_read_b64_tr_b16 a[58:59], v6 offset:3072
    ds_read_b64_tr_b16 a[60:61], v6 offset:2056
    ds_read_b64_tr_b16 a[62:63], v6 offset:3080
    s_waitcnt lgkmcnt(0)
    s_add_u32 s18, s19, 884736
    s_add_u32 m0, s21, 49152
    s_nop 0
    buffer_load_dwordx4 v3, s[12:15], s18 offen lds
    s_add_u32 m0, s21, 50176
    s_add_u32 s18, s18, 18432
    buffer_load_dwordx4 v3, s[12:15], s18 offen lds
    s_add_u32 m0, s21, 51200
    s_add_u32 s18, s18, 18432
    buffer_load_dwordx4 v3, s[12:15], s18 offen lds
    s_add_u32 m0, s21, 52224
    s_add_u32 s18, s18, 18432
    buffer_load_dwordx4 v3, s[12:15], s18 offen lds
    v_add_u32 v6, 65536, v4
    v_xor_b32 v7, 32, v6
    s_waitcnt vmcnt(32)
    ds_read_b64_tr_b16 a[64:65], v6 offset:0
    ds_read_b64_tr_b16 a[66:67], v6 offset:1024
    ds_read_b64_tr_b16 a[68:69], v6 offset:8
    ds_read_b64_tr_b16 a[70:71], v6 offset:1032
    ds_read_b64_tr_b16 a[72:73], v6 offset:2048
    ds_read_b64_tr_b16 a[74:75], v6 offset:3072
    ds_read_b64_tr_b16 a[76:77], v6 offset:2056
    ds_read_b64_tr_b16 a[78:79], v6 offset:3080
    s_waitcnt lgkmcnt(0)
    s_add_u32 s18, s19, 958464
    s_add_u32 m0, s21, 65536
    s_nop 0
    buffer_load_dwordx4 v3, s[12:15], s18 offen lds
    s_add_u32 m0, s21, 66560
    s_add_u32 s18, s18, 18432
    buffer_load_dwordx4 v3, s[12:15], s18 offen lds
    s_add_u32 m0, s21, 67584
    s_add_u32 s18, s18, 18432
    buffer_load_dwordx4 v3, s[12:15], s18 offen lds
    s_add_u32 m0, s21, 68608
    s_add_u32 s18, s18, 18432
    buffer_load_dwordx4 v3, s[12:15], s18 offen lds
    v_add_u32 v6, 81920, v4
    v_xor_b32 v7, 32, v6
    s_waitcnt vmcnt(32)
    ds_read_b64_tr_b16 a[80:81], v6 offset:0
    ds_read_b64_tr_b16 a[82:83], v6 offset:1024
    ds_read_b64_tr_b16 a[84:85], v6 offset:8
    ds_read_b64_tr_b16 a[86:87], v6 offset:1032
    ds_read_b64_tr_b16 a[88:89], v6 offset:2048
    ds_read_b64_tr_b16 a[90:91], v6 offset:3072
    ds_read_b64_tr_b16 a[92:93], v6 offset:2056
    ds_read_b64_tr_b16 a[94:95], v6 offset:3080
    s_waitcnt lgkmcnt(0)
    s_add_u32 s18, s19, 1032192
    s_add_u32 m0, s21, 81920
    s_nop 0
    buffer_load_dwordx4 v3, s[12:15], s18 offen lds
    s_add_u32 m0, s21, 82944
    s_add_u32 s18, s18, 18432
    buffer_load_dwordx4 v3, s[12:15], s18 offen lds
    s_add_u32 m0, s21, 83968
    s_add_u32 s18, s18, 18432
    buffer_load_dwordx4 v3, s[12:15], s18 offen lds
    s_add_u32 m0, s21, 84992
    s_add_u32 s18, s18, 18432
    buffer_load_dwordx4 v3, s[12:15], s18 offen lds
    v_add_u32 v6, 98304, v4
    v_xor_b32 v7, 32, v6
    s_waitcnt vmcnt(32)
    ds_read_b64_tr_b16 a[96:97], v6 offset:0
    ds_read_b64_tr_b16 a[98:99], v6 offset:1024
    ds_read_b64_tr_b16 a[100:101], v6 offset:8
    ds_read_b64_tr_b16 a[102:103], v6 offset:1032
    ds_read_b64_tr_b16 a[104:105], v6 offset:2048
    ds_read_b64_tr_b16 a[106:107], v6 offset:3072
    ds_read_b64_tr_b16 a[108:109], v6 offset:2056
    ds_read_b64_tr_b16 a[110:111], v6 offset:3080
    s_waitcnt lgkmcnt(0)
    s_add_u32 s18, s19, 1105920
    s_add_u32 m0, s21, 98304
    s_nop 0
    buffer_load_dwordx4 v3, s[12:15], s18 offen lds
    s_add_u32 m0, s21, 99328
    s_add_u32 s18, s18, 18432
    buffer_load_dwordx4 v3, s[12:15], s18 offen lds
    s_add_u32 m0, s21, 100352
    s_add_u32 s18, s18, 18432
    buffer_load_dwordx4 v3, s[12:15], s18 offen lds
    s_add_u32 m0, s21, 101376
    s_add_u32 s18, s18, 18432
    buffer_load_dwordx4 v3, s[12:15], s18 offen lds
    v_add_u32 v6, 114688, v4
    v_xor_b32 v7, 32, v6
    s_waitcnt vmcnt(32)
    ds_read_b64_tr_b16 a[112:113], v6 offset:0
    ds_read_b64_tr_b16 a[114:115], v6 offset:1024
    ds_read_b64_tr_b16 a[116:117], v6 offset:8
    ds_read_b64_tr_b16 a[118:119], v6 offset:1032
    ds_read_b64_tr_b16 a[120:121], v6 offset:2048
    ds_read_b64_tr_b16 a[122:123], v6 offset:3072
    ds_read_b64_tr_b16 a[124:125], v6 offset:2056
    ds_read_b64_tr_b16 a[126:127], v6 offset:3080
    s_waitcnt lgkmcnt(0)
    v_add_u32 v6, 131072, v4
    v_xor_b32 v7, 32, v6
    s_waitcnt vmcnt(28)
    ds_read_b64_tr_b16 a[128:129], v6 offset:0
    ds_read_b64_tr_b16 a[130:131], v6 offset:1024
    ds_read_b64_tr_b16 a[132:133], v6 offset:8
    ds_read_b64_tr_b16 a[134:135], v6 offset:1032
    ds_read_b64_tr_b16 a[136:137], v6 offset:2048
    ds_read_b64_tr_b16 a[138:139], v6 offset:3072
    ds_read_b64_tr_b16 a[140:141], v6 offset:2056
    ds_read_b64_tr_b16 a[142:143], v6 offset:3080
    s_waitcnt lgkmcnt(0)
    v_add_u32 v6, 0, v4
    v_xor_b32 v7, 32, v6
    s_waitcnt vmcnt(24)
    ds_read_b64_tr_b16 a[144:145], v6 offset:0
    ds_read_b64_tr_b16 a[146:147], v6 offset:1024
    ds_read_b64_tr_b16 a[148:149], v6 offset:8
    ds_read_b64_tr_b16 a[150:151], v6 offset:1032
    ds_read_b64_tr_b16 a[152:153], v6 offset:2048
    ds_read_b64_tr_b16 a[154:155], v6 offset:3072
    ds_read_b64_tr_b16 a[156:157], v6 offset:2056
    ds_read_b64_tr_b16 a[158:159], v6 offset:3080
    s_waitcnt lgkmcnt(0)
    v_add_u32 v6, 16384, v4
    v_xor_b32 v7, 32, v6
    s_waitcnt vmcnt(20)
    ds_read_b64_tr_b16 a[160:161], v6 offset:0
    ds_read_b64_tr_b16 a[162:163], v6 offset:1024
    ds_read_b64_tr_b16 a[164:165], v6 offset:8
    ds_read_b64_tr_b16 a[166:167], v6 offset:1032
    ds_read_b64_tr_b16 a[168:169], v6 offset:2048
    ds_read_b64_tr_b16 a[170:171], v6 offset:3072
    ds_read_b64_tr_b16 a[172:173], v6 offset:2056
    ds_read_b64_tr_b16 a[174:175], v6 offset:3080
    s_waitcnt lgkmcnt(0)
    v_add_u32 v6, 32768, v4
    v_xor_b32 v7, 32, v6
    s_waitcnt vmcnt(16)
    ds_read_b64_tr_b16 a[176:177], v6 offset:0
    ds_read_b64_tr_b16 a[178:179], v6 offset:1024
    ds_read_b64_tr_b16 a[180:181], v6 offset:8
    ds_read_b64_tr_b16 a[182:183], v6 offset:1032
    ds_read_b64_tr_b16 a[184:185], v6 offset:2048
    ds_read_b64_tr_b16 a[186:187], v6 offset:3072
    ds_read_b64_tr_b16 a[188:189], v6 offset:2056
    ds_read_b64_tr_b16 a[190:191], v6 offset:3080
    s_waitcnt lgkmcnt(0)
    v_add_u32 v6, 49152, v4
    v_xor_b32 v7, 32, v6
    s_waitcnt vmcnt(12)
    ds_read_b64_tr_b16 a[192:193], v6 offset:0
    ds_read_b64_tr_b16 a[194:195], v6 offset:1024
    ds_read_b64_tr_b16 a[196:197], v6 offset:8
    ds_read_b64_tr_b16 a[198:199], v6 offset:1032
    ds_read_b64_tr_b16 a[200:201], v6 offset:2048
    ds_read_b64_tr_b16 a[202:203], v6 offset:3072
    ds_read_b64_tr_b16 a[204:205], v6 offset:2056
    ds_read_b64_tr_b16 a[206:207], v6 offset:3080
    s_waitcnt lgkmcnt(0)
    v_add_u32 v6, 65536, v4
    v_xor_b32 v7, 32, v6
    s_waitcnt vmcnt(8)
    ds_read_b64_tr_b16 a[208:209], v6 offset:0
    ds_read_b64_tr_b16 a[210:211], v6 offset:1024
    ds_read_b64_tr_b16 a[212:213], v6 offset:8
    ds_read_b64_tr_b16 a[214:215], v6 offset:1032
    ds_read_b64_tr_b16 a[216:217], v6 offset:2048
    ds_read_b64_tr_b16 a[218:219], v6 offset:3072
    ds_read_b64_tr_b16 a[220:221], v6 offset:2056
    ds_read_b64_tr_b16 a[222:223], v6 offset:3080
    s_waitcnt lgkmcnt(0)
    v_add_u32 v6, 81920, v4
    v_xor_b32 v7, 32, v6
    s_waitcnt vmcnt(4)
    ds_read_b64_tr_b16 a[224:225], v6 offset:0
    ds_read_b64_tr_b16 a[226:227], v6 offset:1024
    ds_read_b64_tr_b16 a[228:229], v6 offset:8
    ds_read_b64_tr_b16 a[230:231], v6 offset:1032
    ds_read_b64_tr_b16 a[232:233], v6 offset:2048
    ds_read_b64_tr_b16 a[234:235], v6 offset:3072
    ds_read_b64_tr_b16 a[236:237], v6 offset:2056
    ds_read_b64_tr_b16 a[238:239], v6 offset:3080
    s_waitcnt lgkmcnt(0)
    v_add_u32 v6, 98304, v4
    v_xor_b32 v7, 32, v6
    s_waitcnt vmcnt(0)
    ds_read_b64_tr_b16 a[240:241], v6 offset:0
    ds_read_b64_tr_b16 a[242:243], v6 offset:1024
    ds_read_b64_tr_b16 a[244:245], v6 offset:8
    ds_read_b64_tr_b16 a[246:247], v6 offset:1032
    ds_read_b64_tr_b16 a[248:249], v6 offset:2048
    ds_read_b64_tr_b16 a[250:251], v6 offset:3072
    ds_read_b64_tr_b16 a[252:253], v6 offset:2056
    ds_read_b64_tr_b16 a[254:255], v6 offset:3080
    s_waitcnt lgkmcnt(0)
    s_barrier
L_op_seg:
    s_lshr_b32 s43, s16, 1
    s_add_u32 s43, s43, 1
    s_min_u32 s43, s43, 63
    s_and_b32 s36, s33, 15
    s_lshl_b32 s36, s36, 8
    s_add_u32 s36, s36, 125829120
    s_lshl_b32 s94, s33, 7
    s_add_u32 s94, s94, s16
    s_mov_b32 s88, 65536
cw15:
    buffer_load_dword v3, off, s[4:7], s36 offset:128 sc1
    s_waitcnt vmcnt(0)
    v_readfirstlane_b32 s42, v3
    s_nop 0
    s_sub_u32 s42, s42, s95
    s_cmp_gt_u32 s42, 64
    s_cselect_b32 s42, 0, s42
    s_add_u32 s42, s42, 2
    s_cmp_ge_u32 s42, s43
    s_cbranch_scc1 cw15x
    s_sub_u32 s88, s88, 1
    s_cbranch_scc1 cw15x
    s_sub_u32 s42, s43, s42
    s_min_u32 s42, s42, 6
cw15s:
    s_sleep 24
    s_sub_u32 s42, s42, 1
    s_cmp_lg_u32 s42, 0
    s_cbranch_scc1 cw15s
    s_branch cw15
cw15x:
    s_lshr_b32 s89, s16, 1
    s_lshl_b32 s89, s89, 2
    s_add_u32 s89, s89, s32
    s_lshl_b32 s89, s89, 7
    s_add_u32 s89, s89, 125894656
    v_mbcnt_lo_u32_b32 v2, -1, 0
    v_mbcnt_hi_u32_b32 v2, -1, v2
    v_min_u32 v2, 7, v2
    v_lshlrev_b32 v2, 2, v2
    s_mov_b32 s88, 4194304
fw16:
    buffer_load_dword v3, v2, s[4:7], s89 offen offset:0 sc1
    s_sub_u32 s88, s88, 1
    s_cbranch_scc1 fw16x
    s_waitcnt vmcnt(0)
    v_cmp_ne_u32 vcc, s95, v3
    s_cbranch_vccz fw16x
    s_sleep 4
    s_cmp_gt_u32 s88, 4194280
    s_cbranch_scc1 fw16
    s_sleep 40
    s_branch fw16
fw16x:
    s_lshl_b32 s18, s16, 17
    s_lshl_b32 s19, s32, 15
    s_add_u32 s18, s18, s19
    s_add_u32 s18, s18, 50331648
    buffer_load_dwordx4 v[32:35], v1, s[4:7], s18 offen offset:0 sc1
    buffer_load_dwordx4 v[36:39], v1, s[4:7], s18 offen offset:1024 sc1
    buffer_load_dwordx4 v[40:43], v1, s[4:7], s18 offen offset:2048 sc1
    buffer_load_dwordx4 v[44:47], v1, s[4:7], s18 offen offset:3072 sc1
    s_add_u32 s18, s18, 4096
    buffer_load_dwordx4 v[48:51], v1, s[4:7], s18 offen offset:0 sc1
    buffer_load_dwordx4 v[52:55], v1, s[4:7], s18 offen offset:1024 sc1
    buffer_load_dwordx4 v[56:59], v1, s[4:7], s18 offen offset:2048 sc1
    buffer_load_dwordx4 v[60:63], v1, s[4:7], s18 offen offset:3072 sc1
    s_add_u32 s18, s18, 4096
    buffer_load_dwordx4 v[64:67], v1, s[4:7], s18 offen offset:0 sc1
    buffer_load_dwordx4 v[68:71], v1, s[4:7], s18 offen offset:1024 sc1
    buffer_load_dwordx4 v[72:75], v1, s[4:7], s18 offen offset:2048 sc1
    buffer_load_dwordx4 v[76:79], v1, s[4:7], s18 offen offset:3072 sc1
    s_add_u32 s18, s18, 4096
    buffer_load_dwordx4 v[80:83], v1, s[4:7], s18 offen offset:0 sc1
    buffer_load_dwordx4 v[84:87], v1, s[4:7], s18 offen offset:1024 sc1
    buffer_load_dwordx4 v[88:91], v1, s[4:7], s18 offen offset:2048 sc1
    buffer_load_dwordx4 v[92:95], v1, s[4:7], s18 offen offset:3072 sc1
    s_add_u32 s18, s18, 4096
    buffer_load_dwordx4 v[96:99], v1, s[4:7], s18 offen offset:0 sc1
    buffer_load_dwordx4 v[100:103], v1, s[4:7], s18 offen offset:1024 sc1
    buffer_load_dwordx4 v[104:107], v1, s[4:7], s18 offen offset:2048 sc1
    buffer_load_dwordx4 v[108:111], v1, s[4:7], s18 offen offset:3072 sc1
    s_add_u32 s18, s18, 4096
    buffer_load_dwordx4 v[112:115], v1, s[4:7], s18 offen offset:0 sc1
    buffer_load_dwordx4 v[116:119], v1, s[4:7], s18 offen offset:1024 sc1
    buffer_load_dwordx4 v[120:123], v1, s[4:7], s18 offen offset:2048 sc1
    buffer_load_dwordx4 v[124:127], v1, s[4:7], s18 offen offset:3072 sc1
    s_add_u32 s18, s18, 4096
    buffer_load_dwordx4 v[128:131], v1, s[4:7], s18 offen offset:0 sc1
    buffer_load_dwordx4 v[132:135], v1, s[4:7], s18 offen offset:1024 sc1
    buffer_load_dwordx4 v[136:139], v1, s[4:7], s18 offen offset:2048 sc1
    buffer_load_dwordx4 v[140:143], v1, s[4:7], s18 offen offset:3072 sc1
    s_add_u32 s18, s18, 4096
    buffer_load_dwordx4 v[144:147], v1, s[4:7], s18 offen offset:0 sc1
    buffer_load_dwordx4 v[148:151], v1, s[4:7], s18 offen offset:1024 sc1
    buffer_load_dwordx4 v[152:155], v1, s[4:7], s18 offen offset:2048 sc1
    buffer_load_dwordx4 v[156:159], v1, s[4:7], s18 offen offset:3072 sc1
    v_lshlrev_b32 v2, 4, v0
    v_and_b32 v3, 3072, v2
    v_lshl_add_u32 v2, v3, 1, v1
    s_waitcnt vmcnt(31)
    v_mfma_f32_16x16x32_bf16 v[8:11], a[0:3], v[32:35], 0
    v_mfma_f32_16x16x32_bf16 v[12:15], a[4:7], v[32:35], 0
    s_waitcnt vmcnt(30)
    v_mfma_f32_16x16x32_bf16 v[8:11], a[8:11], v[36:39], v[8:11]
    v_mfma_f32_16x16x32_bf16 v[12:15], a[12:15], v[36:39], v[12:15]
    s_waitcnt vmcnt(29)
    v_mfma_f32_16x16x32_bf16 v[8:11], a[16:19], v[40:43], v[8:11]
    v_mfma_f32_16x16x32_bf16 v[12:15], a[20:23], v[40:43], v[12:15]
    s_waitcnt vmcnt(28)
    v_mfma_f32_16x16x32_bf16 v[8:11], a[24:27], v[44:47], v[8:11]
    v_mfma_f32_16x16x32_bf16 v[12:15], a[28:31], v[44:47], v[12:15]
    s_waitcnt vmcnt(27)
    v_mfma_f32_16x16x32_bf16 v[8:11], a[32:35], v[48:51], v[8:11]
    v_mfma_f32_16x16x32_bf16 v[12:15], a[36:39], v[48:51], v[12:15]
    s_waitcnt vmcnt(26)
    v_mfma_f32_16x16x32_bf16 v[8:11], a[40:43], v[52:55], v[8:11]
    v_mfma_f32_16x16x32_bf16 v[12:15], a[44:47], v[52:55], v[12:15]
    s_waitcnt vmcnt(25)
    v_mfma_f32_16x16x32_bf16 v[8:11], a[48:51], v[56:59], v[8:11]
    v_mfma_f32_16x16x32_bf16 v[12:15], a[52:55], v[56:59], v[12:15]
    s_waitcnt vmcnt(24)
    v_mfma_f32_16x16x32_bf16 v[8:11], a[56:59], v[60:63], v[8:11]
    v_mfma_f32_16x16x32_bf16 v[12:15], a[60:63], v[60:63], v[12:15]
    s_waitcnt vmcnt(23)
    v_mfma_f32_16x16x32_bf16 v[8:11], a[64:67], v[64:67], v[8:11]
    v_mfma_f32_16x16x32_bf16 v[12:15], a[68:71], v[64:67], v[12:15]
    s_waitcnt vmcnt(22)
    v_mfma_f32_16x16x32_bf16 v[8:11], a[72:75], v[68:71], v[8:11]
    v_mfma_f32_16x16x32_bf16 v[12:15], a[76:79], v[68:71], v[12:15]
    s_waitcnt vmcnt(21)
    v_mfma_f32_16x16x32_bf16 v[8:11], a[80:83], v[72:75], v[8:11]
    v_mfma_f32_16x16x32_bf16 v[12:15], a[84:87], v[72:75], v[12:15]
    s_waitcnt vmcnt(20)
    v_mfma_f32_16x16x32_bf16 v[8:11], a[88:91], v[76:79], v[8:11]
    v_mfma_f32_16x16x32_bf16 v[12:15], a[92:95], v[76:79], v[12:15]
    s_waitcnt vmcnt(19)
    v_mfma_f32_16x16x32_bf16 v[8:11], a[96:99], v[80:83], v[8:11]
    v_mfma_f32_16x16x32_bf16 v[12:15], a[100:103], v[80:83], v[12:15]
    s_waitcnt vmcnt(18)
    v_mfma_f32_16x16x32_bf16 v[8:11], a[104:107], v[84:87], v[8:11]
    v_mfma_f32_16x16x32_bf16 v[12:15], a[108:111], v[84:87], v[12:15]
    s_waitcnt vmcnt(17)
    v_mfma_f32_16x16x32_bf16 v[8:11], a[112:115], v[88:91], v[8:11]
    v_mfma_f32_16x16x32_bf16 v[12:15], a[116:119], v[88:91], v[12:15]
    s_waitcnt vmcnt(16)
    v_mfma_f32_16x16x32_bf16 v[8:11], a[120:123], v[92:95], v[8:11]
    v_mfma_f32_16x16x32_bf16 v[12:15], a[124:127], v[92:95], v[12:15]
    s_waitcnt vmcnt(15)
    v_mfma_f32_16x16x32_bf16 v[8:11], a[128:131], v[96:99], v[8:11]
    v_mfma_f32_16x16x32_bf16 v[12:15], a[132:135], v[96:99], v[12:15]
    s_waitcnt vmcnt(14)
    v_mfma_f32_16x16x32_bf16 v[8:11], a[136:139], v[100:103], v[8:11]
    v_mfma_f32_16x16x32_bf16 v[12:15], a[140:143], v[100:103], v[12:15]
    s_waitcnt vmcnt(13)
    v_mfma_f32_16x16x32_bf16 v[8:11], a[144:147], v[104:107], v[8:11]
    v_mfma_f32_16x16x32_bf16 v[12:15], a[148:151], v[104:107], v[12:15]
    s_waitcnt vmcnt(12)
    v_mfma_f32_16x16x32_bf16 v[8:11], a[152:155], v[108:111], v[8:11]
    v_mfma_f32_16x16x32_bf16 v[12:15], a[156:159], v[108:111], v[12:15]
    s_waitcnt vmcnt(11)
    v_mfma_f32_16x16x32_bf16 v[8:11], a[160:163], v[112:115], v[8:11]
    v_mfma_f32_16x16x32_bf16 v[12:15], a[164:167], v[112:115], v[12:15]
    s_waitcnt vmcnt(10)
    v_mfma_f32_16x16x32_bf16 v[8:11], a[168:171], v[116:119], v[8:11]
    v_mfma_f32_16x16x32_bf16 v[12:15], a[172:175], v[116:119], v[12:15]
    s_waitcnt vmcnt(9)
    v_mfma_f32_16x16x32_bf16 v[8:11], a[176:179], v[120:123], v[8:11]
    v_mfma_f32_16x16x32_bf16 v[12:15], a[180:183], v[120:123], v[12:15]
    s_waitcnt vmcnt(8)
    v_mfma_f32_16x16x32_bf16 v[8:11], a[184:187], v[124:127], v[8:11]
    v_mfma_f32_16x16x32_bf16 v[12:15], a[188:191], v[124:127], v[12:15]
    s_waitcnt vmcnt(7)
    v_mfma_f32_16x16x32_bf16 v[8:11], a[192:195], v[128:131], v[8:11]
    v_mfma_f32_16x16x32_bf16 v[12:15], a[196:199], v[128:131], v[12:15]
    s_waitcnt vmcnt(6)
    v_mfma_f32_16x16x32_bf16 v[8:11], a[200:203], v[132:135], v[8:11]
    v_mfma_f32_16x16x32_bf16 v[12:15], a[204:207], v[132:135], v[12:15]
    s_waitcnt vmcnt(5)
    v_mfma_f32_16x16x32_bf16 v[8:11], a[208:211], v[136:139], v[8:11]
    v_mfma_f32_16x16x32_bf16 v[12:15], a[212:215], v[136:139], v[12:15]
    s_waitcnt vmcnt(4)
    v_mfma_f32_16x16x32_bf16 v[8:11], a[216:219], v[140:143], v[8:11]
    v_mfma_f32_16x16x32_bf16 v[12:15], a[220:223], v[140:143], v[12:15]
    s_waitcnt vmcnt(3)
    v_mfma_f32_16x16x32_bf16 v[8:11], a[224:227], v[144:147], v[8:11]
    v_mfma_f32_16x16x32_bf16 v[12:15], a[228:231], v[144:147], v[12:15]
    s_waitcnt vmcnt(2)
    v_mfma_f32_16x16x32_bf16 v[8:11], a[232:235], v[148:151], v[8:11]
    v_mfma_f32_16x16x32_bf16 v[12:15], a[236:239], v[148:151], v[12:15]
    s_waitcnt vmcnt(1)
    v_mfma_f32_16x16x32_bf16 v[8:11], a[240:243], v[152:155], v[8:11]
    v_mfma_f32_16x16x32_bf16 v[12:15], a[244:247], v[152:155], v[12:15]
    s_waitcnt vmcnt(0)
    v_mfma_f32_16x16x32_bf16 v[8:11], a[248:251], v[156:159], v[8:11]
    v_mfma_f32_16x16x32_bf16 v[12:15], a[252:255], v[156:159], v[12:15]
    s_nop 3
    ds_write_b128 v2, v[8:11] offset:0
    s_nop 2
    ds_write_b128 v2, v[12:15] offset:1024
    s_waitcnt lgkmcnt(0)
    s_barrier
    s_cmp_lg_u32 s32, 0
    s_cbranch_scc1 os_skip
    ds_read_b128 v[40:43], v1 offset:2048
    ds_read_b128 v[44:47], v1 offset:3072
    ds_read_b128 v[48:51], v1 offset:4096
    ds_read_b128 v[52:55], v1 offset:5120
    ds_read_b128 v[56:59], v1 offset:6144
    ds_read_b128 v[60:63], v1 offset:7168
    v_lshrrev_b32 v3, 4, v1
    v_bfe_u32 v4, v3, 2, 2
    v_lshlrev_b32 v4, 3, v4
    v_and_b32 v2, 3, v3
    v_add_u32 v4, v4, v2
    v_mul_u32_u24 v4, 2304, v4
    v_lshrrev_b32 v3, 4, v3
    v_lshl_add_u32 v4, v3, 4, v4
    s_lshr_b32 s18, s16, 1
    s_lshl_b32 s18, s18, 3
    s_and_b32 s19, s16, 1
    s_add_u32 s18, s18, s19
    s_mul_i32 s18, s18, 9216
    s_lshl_b32 s19, s33, 6
    s_add_u32 s18, s18, s19
    s_waitcnt lgkmcnt(0)
    v_pk_add_f32 v[8:9], v[8:9], v[40:41]
    v_pk_add_f32 v[48:49], v[48:49], v[56:57]
    v_pk_add_f32 v[8:9], v[8:9], v[48:49]
    v_pk_add_f32 v[10:11], v[10:11], v[42:43]
    v_pk_add_f32 v[50:51], v[50:51], v[58:59]
    v_pk_add_f32 v[10:11], v[10:11], v[50:51]
    v_pk_add_f32 v[12:13], v[12:13], v[44:45]
    v_pk_add_f32 v[52:53], v[52:53], v[60:61]
    v_pk_add_f32 v[12:13], v[12:13], v[52:53]
    v_pk_add_f32 v[14:15], v[14:15], v[46:47]
    v_pk_add_f32 v[54:55], v[54:55], v[62:63]
    v_pk_add_f32 v[14:15], v[14:15], v[54:55]
    v_cvt_pk_bf16_f32 v32, v8, v9
    v_cvt_pk_bf16_f32 v33, v10, v11
    v_cvt_pk_bf16_f32 v34, v12, v13
    v_cvt_pk_bf16_f32 v35, v14, v15
    buffer_store_dwordx4 v[32:35], v4, s[8:11], s18 offen sc1
os_skip:
    s_nop 1
    s_add_u32 s16, s16, 7
    s_cmp_ge_u32 s16, 128
    s_cbranch_scc1 L_done
    s_barrier
    s_branch L_op_seg
L_done:
L_exit:
    s_endpgm
.section .rodata,"a"
.p2align 6
.amdhsa_kernel concat_heads__memory_aug_recurrent_mem_tr__ssm_conv_s4d__prompt_kernel
  .amdhsa_next_free_vgpr 512
  .amdhsa_next_free_sgpr 102
  .amdhsa_accum_offset 256
  .amdhsa_group_segment_fixed_size 0
  .amdhsa_kernarg_size 136
  .amdhsa_user_sgpr_count 2
  .amdhsa_user_sgpr_kernarg_segment_ptr 1
  .amdhsa_system_sgpr_workgroup_id_x 1
.end_amdhsa_kernel
.text
```

```asm
; @launch grid=(256,1,1) block=(256,1,1) lds=163840
.amdgcn_target "amdgcn-amd-amdhsa--gfx950"
.text
.globl concat_heads__memory_aug_recurrent_mem_tr__ssm_conv_s4d__prompt_kernel
.p2align 8
.type concat_heads__memory_aug_recurrent_mem_tr__ssm_conv_s4d__prompt_kernel,@function
concat_heads__memory_aug_recurrent_mem_tr__ssm_conv_s4d__prompt_kernel:
    s_cmp_ge_u32 s2, 256
    s_cbranch_scc1 L_exit
    s_load_dwordx4 s[84:87], s[0:1], 120
    s_load_dwordx16 s[48:63], s[0:1], 0
    v_lshrrev_b32 v1, 6, v0
    s_nop 0
    v_readfirstlane_b32 s32, v1
    s_getreg_b32 s3, hwreg(HW_REG_XCC_ID)
    s_and_b32 s3, s3, 15
    s_cmp_lg_u32 s32, 3
    s_cbranch_scc1 L_nowarm
    s_getpc_b64 s[44:45]
L_pcw:
    v_and_b32 v1, 63, v0
    v_lshlrev_b32 v1, 7, v1
    s_cmp_lg_u32 s3, 0
    s_cselect_b32 s33, L_helper-L_pcw, 0
    v_add_u32 v1, s33, v1
    v_min_u32 v2, L_exit-L_pcw, v1
    global_load_dword v240, v2, s[44:45]
    v_add_u32 v1, 8192, v1
    v_min_u32 v2, L_exit-L_pcw, v1
    global_load_dword v241, v2, s[44:45]
    v_add_u32 v1, 8192, v1
    s_cbranch_scc0 L_nowarm
    v_min_u32 v2, L_exit-L_pcw, v1
    global_load_dword v242, v2, s[44:45]
    v_add_u32 v1, 8192, v1
    v_min_u32 v2, L_exit-L_pcw, v1
    global_load_dword v243, v2, s[44:45]
    v_add_u32 v1, 8192, v1
    v_min_u32 v2, L_exit-L_pcw, v1
    global_load_dword v244, v2, s[44:45]
    v_add_u32 v1, 8192, v1
L_nowarm:
    s_waitcnt lgkmcnt(0)
    s_mov_b32 s4, s86
    s_mov_b32 s5, s87
    s_mov_b32 s6, 268435456
    s_mov_b32 s7, 0x20000
    s_mov_b32 s96, s84
    s_mov_b32 s97, s85
    s_mov_b32 s98, 256
    s_mov_b32 s99, 0x20000
    s_mov_b32 s95, 0
    s_cmp_lg_u32 s3, 0
    s_cbranch_scc1 L_helper
    s_mov_b32 s37, 128
    v_mov_b32 v250, 1
    v_mov_b32 v251, 163832
    v_cmp_eq_u32 vcc, 0, v0
    s_nop 0
    s_and_saveexec_b64 s[38:39], vcc
    s_cbranch_execz tk1m
    buffer_atomic_add v250, off, s[96:99], s37 sc0
tk1m:
    s_mov_b64 s[38:39], exec
    s_mov_b64 exec, -1
    v_lshrrev_b32 v54, 6, v0
    s_nop 0
    v_readfirstlane_b32 s13, v54
    v_and_b32 v57, 63, v0
    v_bfe_u32 v54, v57, 2, 1
    v_lshlrev_b32 v48, 13, v54
    v_bfe_u32 v54, v57, 3, 1
    v_lshl_add_u32 v48, v54, 15, v48
    v_bfe_u32 v54, v57, 4, 1
    v_lshl_add_u32 v48, v54, 14, v48
    v_bfe_u32 v54, v57, 5, 1
    v_lshl_add_u32 v48, v54, 16, v48
    v_lshrrev_b32 v55, 4, v57
    v_and_b32 v55, 2, v55
    v_xor_b32 v55, v55, v57
    v_and_b32 v55, 3, v55
    v_lshl_add_u32 v48, v55, 4, v48
    v_bfe_u32 v54, v57, 2, 1
    v_lshlrev_b32 v51, 6, v54
    v_bfe_u32 v54, v57, 3, 1
    v_lshl_add_u32 v51, v54, 9, v51
    v_bfe_u32 v54, v57, 4, 1
    v_lshl_add_u32 v51, v54, 7, v51
    v_bfe_u32 v54, v57, 5, 1
    v_lshl_add_u32 v51, v54, 12, v51
    v_bfe_u32 v54, v57, 0, 1
    v_lshl_add_u32 v51, v54, 3, v51
    v_bfe_u32 v54, v57, 1, 1
    v_lshl_add_u32 v51, v54, 4, v51
    v_bfe_u32 v54, v57, 3, 1
    v_lshl_add_u32 v51, v54, 5, v51
    v_lshrrev_b32 v55, 3, v57
    v_mul_u32_u24 v49, 1152, v55
    v_and_b32 v55, 7, v57
    v_lshl_add_u32 v49, v55, 4, v49
    v_bfe_u32 v54, v57, 4, 1
    v_lshlrev_b32 v52, 13, v54
    v_bfe_u32 v54, v57, 5, 1
    v_lshl_add_u32 v52, v54, 9, v52
    v_bfe_u32 v54, v57, 2, 1
    v_lshl_add_u32 v52, v54, 7, v52
    v_bfe_u32 v54, v57, 3, 1
    v_lshl_add_u32 v52, v54, 5, v52
    v_and_b32 v55, 3, v57
    v_lshl_add_u32 v52, v55, 3, v52
    v_lshrrev_b32 v55, 2, v57
    v_mul_u32_u24 v50, 1152, v55
    v_and_b32 v55, 3, v57
    v_lshl_add_u32 v50, v55, 4, v50
    v_bfe_u32 v54, v57, 4, 1
    v_lshlrev_b32 v53, 12, v54
    v_bfe_u32 v54, v57, 5, 1
    v_lshl_add_u32 v53, v54, 8, v53
    v_bfe_u32 v54, v57, 2, 1
    v_lshl_add_u32 v53, v54, 6, v53
    v_bfe_u32 v54, v57, 3, 1
    v_lshl_add_u32 v53, v54, 5, v53
    v_and_b32 v55, 3, v57
    v_lshl_add_u32 v53, v55, 3, v53
    s_lshl_b32 s66, s13, 10
    s_and_b32 s93, s13, 1
    s_lshl_b32 s93, s93, 14
    s_and_b32 s75, s13, 2
    s_lshl_b32 s75, s75, 19
    v_add_u32 v51, s66, v51
    v_add_u32 v52, s66, v52
    v_add_u32 v53, s66, v53
    v_mov_b32 v58, v48
    s_mov_b32 s10, 4718592
    s_mov_b32 s11, 0x20000
    s_mov_b64 exec, s[38:39]
    s_cbranch_execz tk1
    s_waitcnt vmcnt(0)
    ds_write_b32 v251, v250
    s_waitcnt lgkmcnt(0)
tk1:
    s_mov_b64 exec, -1
    s_barrier
    ds_read_b32 v252, v251
    s_waitcnt lgkmcnt(0)
    v_readfirstlane_b32 s12, v252
    s_barrier
    s_nop 3
    s_cmp_ge_u32 s12, 32
    s_cbranch_scc1 L_helper
L_chain:
    s_mov_b64 s[48:49], s[50:51]
    s_mov_b64 s[50:51], s[52:53]
    s_mov_b64 s[52:53], s[54:55]
    s_mov_b64 s[54:55], s[56:57]
    s_mov_b64 s[56:57], s[58:59]
    s_lshl_b32 s67, s12, 8
    s_lshl_b32 s40, s13, 6
    s_add_u32 s67, s67, s40
    s_mul_i32 s92, s12, 147456
    s_lshr_b32 s73, s50, 8
    s_add_u32 s73, s73, s12
    s_and_b32 s73, s73, 31
    s_bitcmp1_b32 0xa2222222, s73
    s_cselect_b32 s88, 1, 0
    s_mov_b32 s72, 0
    s_add_u32 s73, s73, 1
    s_lshr_b32 s73, s73, 2
    s_xor_b32 s94, s13, 0
    s_mul_i32 s94, s94, 36864
    s_add_u32 s94, s94, s92
    s_lshl_b32 s74, s13, 7
    s_add_u32 s94, s94, s74
    s_add_u32 s78, s94, 0
    s_mov_b64 s[8:9], s[56:57]
    v_mov_b32 v58, v49
    s_mov_b32 s79, 9216
    s_mov_b32 s81, 0
    s_add_u32 s80, s66, 114688
    s_mov_b32 s76, 0
    s_mov_b32 s77, 8192
    s_call_b64 s[82:83], cf_dma
    s_mov_b32 s77, 16384
    s_call_b64 s[82:83], cf_dma
    s_xor_b32 s94, s13, 1
    s_mul_i32 s94, s94, 36864
    s_add_u32 s94, s94, s92
    s_lshl_b32 s74, s13, 7
    s_add_u32 s94, s94, s74
    s_add_u32 s78, s94, 0
    s_add_u32 s80, s66, 81920
    s_mov_b32 s76, 0
    s_mov_b32 s77, 8192
    s_call_b64 s[82:83], cf_dma
    s_mov_b32 s77, 16384
    s_call_b64 s[82:83], cf_dma
    s_xor_b32 s94, s13, 2
    s_mul_i32 s94, s94, 36864
    s_add_u32 s94, s94, s92
    s_lshl_b32 s74, s13, 7
    s_add_u32 s94, s94, s74
    s_add_u32 s78, s94, 0
    s_add_u32 s80, s66, 16384
    s_mov_b32 s76, 0
    s_mov_b32 s77, 8192
    s_call_b64 s[82:83], cf_dma
    v_lshrrev_b32 v24, 6, v0
    v_lshlrev_b32 v61, 4, v0
    v_add_u32 v62, 57344, v61
    v_xor_b32 v63, 1024, v61
    v_add_u32 v63, 98304, v63
    v_xor_b32 v64, 2048, v61
    v_add_u32 v64, 98304, v64
    v_and_b32 v65, 1023, v61
    v_add_u32 v65, 98304, v65
    v_and_b32 v26, 15, v0
    v_bfe_u32 v27, v0, 4, 2
    v_mov_b32 v60, 0x4444
    v_mov_b32 v25, 0xeeee
    v_cmp_lt_u32 vcc, 7, v26
    s_nop 1
    v_cndmask_b32 v60, v60, v25, vcc
    s_mov_b32 s77, 16384
    s_call_b64 s[82:83], cf_dma
    v_and_b32 v67, 12, v26
    v_lshlrev_b32 v67, 3, v67
    v_and_b32 v25, 1, v26
    v_lshl_add_u32 v67, v25, 4, v67
    v_bfe_u32 v25, v26, 1, 1
    v_lshl_add_u32 v67, v25, 3, v67
    v_lshl_add_u32 v66, v27, 14, v67
    v_lshl_add_u32 v66, v24, 17, v66
    s_xor_b32 s94, s13, 3
    s_mul_i32 s94, s94, 36864
    s_add_u32 s94, s94, s92
    s_lshl_b32 s74, s13, 7
    s_add_u32 s94, s94, s74
    s_add_u32 s78, s94, 0
    s_add_u32 s80, s66, 0
    s_mov_b32 s76, 0
    s_mov_b32 s77, 8192
    s_call_b64 s[82:83], cf_dma
    v_and_b32 v67, 63, v67
    v_lshrrev_b32 v25, 1, v24
    v_lshl_add_u32 v67, v25, 18, v67
    v_lshl_add_u32 v67, v27, 16, v67
    v_lshrrev_b32 v25, 3, v26
    v_lshl_add_u32 v67, v25, 15, v67
    v_and_b32 v25, 1, v24
    v_lshl_add_u32 v67, v25, 6, v67
    s_mov_b32 s77, 16384
    s_call_b64 s[82:83], cf_dma
    v_and_b32 v25, 31, v0
    v_lshlrev_b32 v70, 4, v25
    v_lshlrev_b32 v28, 3, v25
    v_add_u32 v28, 108032, v28
    v_lshrrev_b32 v25, 1, v24
    v_lshl_add_u32 v70, v25, 9, v70
    v_and_b32 v25, 1, v24
    v_lshl_add_u32 v70, v25, 3, v70
    v_add_u32 v70, 109568, v70
    v_cmp_gt_u32 vcc, 2, v27
    s_nop 1
    v_cndmask_b32 v70, v70, v28, vcc
    v_xor_b32 v71, 2048, v63
    v_lshrrev_b32 v68, 4, v0
    v_lshlrev_b32 v68, 7, v68
    v_and_b32 v25, 7, v26
    v_lshl_add_u32 v68, v25, 4, v68
    v_add_u32 v68, 98304, v68
    v_xor_b32 v74, 512, v68
    v_xor_b32 v75, 1024, v68
    v_xor_b32 v76, 1536, v68
    v_lshrrev_b32 v25, 3, v26
    v_lshl_add_u32 v77, v25, 3, v68
    v_or_b32 v78, 512, v65
    v_lshlrev_b32 v79, 2, v61
    v_mov_b64 v[72:73], 0
    v_and_b32 v25, 1, v27
    v_lshlrev_b32 v69, 7, v25
    v_lshrrev_b32 v25, 1, v27
    v_lshl_add_u32 v69, v25, 3, v69
    v_and_b32 v25, 3, v26
    v_lshl_add_u32 v69, v25, 4, v69
    v_bfe_u32 v25, v26, 2, 1
    v_lshl_add_u32 v69, v25, 2, v69
    s_mov_b32 s32, 0x00ff00ff
    s_mov_b32 s33, 0x00ff00ff
    s_not_b64 s[34:35], s[32:33]
    s_lshr_b32 s31, s12, 1
    s_lshl_b32 s31, s31, 8
    s_and_b32 s40, s12, 1
    s_lshl_b32 s40, s40, 6
    s_add_u32 s31, s31, s40
    s_and_b32 s40, s13, 1
    s_lshl_b32 s40, s40, 12
    s_add_u32 s31, s31, s40
    s_lshl_b32 s19, s12, 14
    s_add_u32 s19, s19, 67076096
    s_add_u32 s41, s19, 8192
    s_add_u32 s19, s19, s40
    s_and_b32 s40, s12, 1
    s_lshl_b32 s40, s40, 2
    s_or_b32 s40, s40, s13
    s_cmp_eq_u32 s40, 5
    s_cselect_b32 s64, 0, s13
    s_cmp_lg_u32 s13, 1
    s_cbranch_scc1 cf_notx
    s_mov_b32 s32, 0xff
    s_mov_b32 s33, 0xff
    s_mov_b32 s19, s41
    s_lshr_b32 s31, s12, 3
    s_lshl_b32 s31, s31, 8
    s_and_b32 s40, s12, 2
    s_lshl_b32 s40, s40, 6
    s_add_u32 s31, s31, s40
    s_and_b32 s40, s12, 4
    s_lshl_b32 s40, s40, 4
    s_add_u32 s31, s31, s40
    s_add_u32 s31, s31, 8192
cf_notx:
    s_cmp_lg_u32 s13, 0
    s_cbranch_scc1 cf_notp
    s_min_u32 s40, s12, 23
    s_mul_i32 s40, s40, 384
    s_add_u32 s40, s40, 98304
    v_add_u32 v69, s40, v61
    v_mov_b32 v25, 108288
    v_cmp_lt_u32 vcc, 23, v0
    s_nop 1
    v_cndmask_b32 v69, v69, v25, vcc
cf_notp:
    s_nop 1
    v_mov_b32 v28, 1
    v_mov_b32 v29, 1
    v_mov_b32 v30, 1
    v_mov_b32 v31, 1
    s_lshl_b32 s40, s12, 14
    s_add_u32 s40, s40, 67174400
    s_add_u32 s41, s40, 0
    buffer_store_dwordx4 v[28:31], v61, s[4:7], s41 offen
    s_add_u32 s41, s40, 4096
    buffer_store_dwordx4 v[28:31], v61, s[4:7], s41 offen
    s_add_u32 s41, s40, 8192
    buffer_store_dwordx4 v[28:31], v61, s[4:7], s41 offen
    s_cmp_eq_u32 s64, 0
    s_cselect_b64 exec, 0, s[32:33]
    v_mov_b32 v27, -1
    s_add_u32 s41, s31, 67108864
    buffer_store_dword v27, v69, s[4:7], s41 offen
    s_add_u32 s41, s31, 67125248
    buffer_store_dword v27, v69, s[4:7], s41 offen
    s_add_u32 s41, s31, 67141632
    buffer_store_dword v27, v69, s[4:7], s41 offen
    s_add_u32 s41, s31, 67158016
    buffer_store_dword v27, v69, s[4:7], s41 offen
    s_mov_b64 exec, -1
    s_mov_b64 s[68:69], s[48:49]
    s_mov_b32 s70, 9216
    s_mov_b32 s71, 0x20000
    v_and_b32 v25, 7, v0
    v_mul_u32_u24 v25, 1152, v25
    v_lshrrev_b32 v26, 3, v0
    v_lshl_add_u32 v25, v26, 4, v25
    buffer_load_dwordx4 v[36:39], v25, s[68:71], 0 offen
    buffer_load_dwordx4 v[40:43], v25, s[68:71], 0 offen offset:512
    v_bfe_u32 v25, v0, 2, 3
    v_mul_u32_u24 v25, 1152, v25
    v_lshrrev_b32 v26, 5, v0
    v_lshl_add_u32 v25, v26, 4, v25
    v_and_b32 v26, 3, v0
    v_lshl_add_u32 v25, v26, 2, v25
    buffer_load_dword v44, v25, s[68:71], 0 offen offset:1024
    s_waitcnt vmcnt(15)
    v_add_u32 v55, 114688, v52
    ds_read_b64_tr_b16 v[160:161], v55 offset:0
    ds_read_b64_tr_b16 v[162:163], v55 offset:256
    ds_read_b64_tr_b16 v[164:165], v55 offset:4096
    ds_read_b64_tr_b16 v[166:167], v55 offset:4352
    s_xor_b32 s94, s13, 0
    s_mul_i32 s94, s94, 36864
    s_add_u32 s94, s94, s92
    s_lshl_b32 s74, s13, 7
    s_add_u32 s94, s94, s74
    s_add_u32 s78, s94, 512
    s_add_u32 s80, s66, 147456
    s_mov_b32 s76, 0
    s_mov_b32 s77, 8192
    s_call_b64 s[82:83], cf_dma
    ds_read_b64_tr_b16 v[192:193], v55 offset:64
    ds_read_b64_tr_b16 v[194:195], v55 offset:320
    ds_read_b64_tr_b16 v[196:197], v55 offset:4160
    ds_read_b64_tr_b16 v[198:199], v55 offset:4416
    s_mov_b32 s77, 16384
    s_call_b64 s[82:83], cf_dma
    s_waitcnt lgkmcnt(0)
    s_waitcnt vmcnt(15)
    v_add_u32 v55, 81920, v52
    ds_read_b64_tr_b16 v[168:169], v55 offset:0
    ds_read_b64_tr_b16 v[170:171], v55 offset:256
    ds_read_b64_tr_b16 v[172:173], v55 offset:4096
    ds_read_b64_tr_b16 v[174:175], v55 offset:4352
    s_xor_b32 s94, s13, 1
    s_mul_i32 s94, s94, 36864
    s_add_u32 s94, s94, s92
    s_lshl_b32 s74, s13, 7
    s_add_u32 s94, s94, s74
    s_add_u32 s78, s94, 512
    s_add_u32 s80, s66, 98304
    s_mov_b32 s76, 0
    s_mov_b32 s77, 8192
    s_call_b64 s[82:83], cf_dma
    ds_read_b64_tr_b16 v[200:201], v55 offset:64
    ds_read_b64_tr_b16 v[202:203], v55 offset:320
    ds_read_b64_tr_b16 v[204:205], v55 offset:4160
    ds_read_b64_tr_b16 v[206:207], v55 offset:4416
    s_mov_b32 s77, 16384
    s_call_b64 s[82:83], cf_dma
    s_waitcnt lgkmcnt(0)
    s_waitcnt vmcnt(15)
    v_add_u32 v55, 16384, v52
    ds_read_b64_tr_b16 v[176:177], v55 offset:0
    ds_read_b64_tr_b16 v[178:179], v55 offset:256
    ds_read_b64_tr_b16 v[180:181], v55 offset:4096
    ds_read_b64_tr_b16 v[182:183], v55 offset:4352
    s_add_u32 s78, s67, 4194304
    s_mov_b64 s[8:9], s[54:55]
    v_mov_b32 v58, v48
    s_mov_b32 s79, 131072
    s_add_u32 s80, s66, 32768
    s_mov_b32 s76, 0
    s_mov_b32 s77, 8192
    s_call_b64 s[82:83], cf_dma
    ds_read_b64_tr_b16 v[208:209], v55 offset:64
    ds_read_b64_tr_b16 v[210:211], v55 offset:320
    ds_read_b64_tr_b16 v[212:213], v55 offset:4160
    ds_read_b64_tr_b16 v[214:215], v55 offset:4416
    s_mov_b32 s77, 16384
    s_call_b64 s[82:83], cf_dma
    s_waitcnt lgkmcnt(0)
    s_waitcnt vmcnt(15)
    v_add_u32 v55, 0, v52
    ds_read_b64_tr_b16 v[184:185], v55 offset:0
    ds_read_b64_tr_b16 v[186:187], v55 offset:256
    ds_read_b64_tr_b16 v[188:189], v55 offset:4096
    ds_read_b64_tr_b16 v[190:191], v55 offset:4352
    s_xor_b32 s78, s75, 0
    s_add_u32 s78, s78, s67
    s_mov_b32 s81, s93
    s_add_u32 s80, s66, 114688
    s_mov_b32 s76, 0
    s_mov_b32 s77, 8192
    s_call_b64 s[82:83], cf_dma
    ds_read_b64_tr_b16 v[216:217], v55 offset:64
    ds_read_b64_tr_b16 v[218:219], v55 offset:320
    ds_read_b64_tr_b16 v[220:221], v55 offset:4160
    ds_read_b64_tr_b16 v[222:223], v55 offset:4416
    s_mov_b32 s77, 16384
    s_call_b64 s[82:83], cf_dma
    s_waitcnt lgkmcnt(0)
    s_waitcnt vmcnt(12)
    v_add_u32 v55, 147456, v52
    ds_read_b64_tr_b16 v[224:225], v55 offset:0
    ds_read_b64_tr_b16 v[226:227], v55 offset:256
    ds_read_b64_tr_b16 v[228:229], v55 offset:4096
    ds_read_b64_tr_b16 v[230:231], v55 offset:4352
    s_mov_b32 s77, 24576
    s_call_b64 s[82:83], cf_dma
    ds_read_b64_tr_b16 v[240:241], v55 offset:64
    ds_read_b64_tr_b16 v[242:243], v55 offset:320
    ds_read_b64_tr_b16 v[244:245], v55 offset:4160
    ds_read_b64_tr_b16 v[246:247], v55 offset:4416
    s_mov_b32 s77, 32768
    s_call_b64 s[82:83], cf_dma
    s_waitcnt lgkmcnt(0)
    v_min_u32 v36, -2, v36
    v_min_u32 v37, -2, v37
    v_min_u32 v38, -2, v38
    v_min_u32 v39, -2, v39
    v_min_u32 v40, -2, v40
    v_min_u32 v41, -2, v41
    v_min_u32 v42, -2, v42
    v_min_u32 v43, -2, v43
    v_min_u32 v44, -2, v44
    s_lshl_b32 s14, s12, 16
    s_add_u32 s14, s14, 92274688
    s_add_u32 s41, s14, 4096
    s_add_u32 s42, s14, 8192
    v_lshrrev_b32 v45, 2, v61
    buffer_store_dwordx4 v[36:39], v61, s[4:7], s14 offen
    buffer_store_dwordx4 v[40:43], v61, s[4:7], s41 offen
    buffer_store_dword v44, v45, s[4:7], s42 offen
    v_mov_b32 v46, 1
    s_mov_b64 exec, 1
    buffer_atomic_add v46, off, s[96:99], 0 offset:132 sc0
    s_mov_b64 exec, -1
    s_mov_b32 s44, 0x3e0293ee
    s_mov_b32 s45, s44
    s_mov_b32 s46, 0x42000000
    s_mov_b32 s60, 0x3f803f80
    s_mov_b32 s61, s60
    s_mov_b32 s62, 0x3e803e80
    s_mov_b32 s63, s62
    s_mov_b32 s28, 0
    s_lshl_b32 s24, s12, 14
    s_add_u32 s24, s24, 0
    s_add_u32 s47, s24, 33030144
    s_mul_i32 s40, s13, 3072
    s_add_u32 s23, s24, s40
    s_lshl_b32 s20, s12, 7
    s_add_u32 s20, s20, 67174400
    s_add_u32 s21, s20, 65536
    s_add_u32 s38, s20, 4096
    s_add_u32 s39, s21, 4096
    s_lshl_b32 s22, s12, 7
    s_add_u32 s22, s22, 67182592
    s_lshl_b32 s40, s12, 12
    s_add_u32 s25, s40, 79429632
    s_add_u32 s26, s40, 88866816
    s_lshl_b32 s65, s12, 9
    s_add_u32 s65, s65, 90177536
    s_lshl_b32 s40, s13, 5
    s_or_b32 s40, s40, s12
    s_cmp_lt_u32 s40, 24
    s_cselect_b32 s36, 0x1ffffff, 0
    s_mov_b32 s37, 0
    s_lshl_b32 s27, s12, 7
    s_add_u32 s27, s27, 125845504
    s_lshl_b32 s40, s13, 2
    s_add_u32 s27, s27, s40
    v_bfe_u32 v24, v61, 4, 4
    v_bfe_u32 v25, v61, 8, 1
    v_lshlrev_b32 v25, 2, v25
    v_sub_u32 v25, v24, v25
    v_mov_b32 v26, 0x3f80
    v_mov_b32 v27, 0x3f800000
    v_cmp_eq_u32 vcc, 0, v25
    s_nop 1
    v_cndmask_b32 v16, 0, v26, vcc
    v_cmp_eq_u32 vcc, 1, v25
    s_nop 1
    v_cndmask_b32 v16, v16, v27, vcc
    v_cmp_eq_u32 vcc, 0, v24
    s_nop 1
    v_cndmask_b32 v20, 0, v26, vcc
    v_cmp_eq_u32 vcc, 1, v24
    s_nop 1
    v_cndmask_b32 v20, v20, v27, vcc
    v_cmp_eq_u32 vcc, 2, v25
    s_nop 1
    v_cndmask_b32 v17, 0, v26, vcc
    v_cmp_eq_u32 vcc, 3, v25
    s_nop 1
    v_cndmask_b32 v17, v17, v27, vcc
    v_cmp_eq_u32 vcc, 2, v24
    s_nop 1
    v_cndmask_b32 v21, 0, v26, vcc
    v_cmp_eq_u32 vcc, 3, v24
    s_nop 1
    v_cndmask_b32 v21, v21, v27, vcc
    v_cmp_eq_u32 vcc, 8, v25
    s_nop 1
    v_cndmask_b32 v18, 0, v26, vcc
    v_cmp_eq_u32 vcc, 9, v25
    s_nop 1
    v_cndmask_b32 v18, v18, v27, vcc
    v_cmp_eq_u32 vcc, 4, v24
    s_nop 1
    v_cndmask_b32 v22, 0, v26, vcc
    v_cmp_eq_u32 vcc, 5, v24
    s_nop 1
    v_cndmask_b32 v22, v22, v27, vcc
    v_cmp_eq_u32 vcc, 10, v25
    s_nop 1
    v_cndmask_b32 v19, 0, v26, vcc
    v_cmp_eq_u32 vcc, 11, v25
    s_nop 1
    v_cndmask_b32 v19, v19, v27, vcc
    v_cmp_eq_u32 vcc, 6, v24
    s_nop 1
    v_cndmask_b32 v23, 0, v26, vcc
    v_cmp_eq_u32 vcc, 7, v24
    s_nop 1
    v_cndmask_b32 v23, v23, v27, vcc
    s_waitcnt vmcnt(13)
    v_add_u32 v55, 98304, v52
    ds_read_b64_tr_b16 v[232:233], v55 offset:0
    ds_read_b64_tr_b16 v[234:235], v55 offset:256
    ds_read_b64_tr_b16 v[236:237], v55 offset:4096
    ds_read_b64_tr_b16 v[238:239], v55 offset:4352
    s_xor_b32 s78, s75, 1048576
    s_add_u32 s78, s78, s67
    s_add_u32 s80, s66, 65536
    s_mov_b32 s76, 0
    s_mov_b32 s77, 8192
    s_call_b64 s[82:83], cf_dma
    ds_read_b64_tr_b16 v[248:249], v55 offset:64
    ds_read_b64_tr_b16 v[250:251], v55 offset:320
    ds_read_b64_tr_b16 v[252:253], v55 offset:4160
    ds_read_b64_tr_b16 v[254:255], v55 offset:4416
    s_mov_b32 s77, 16384
    s_call_b64 s[82:83], cf_dma
    s_waitcnt lgkmcnt(0)
    s_waitcnt vmcnt(13)
    v_add_u32 v55, 32768, v51
    v_xor_b32 v56, 32, v55
    ds_read_b64_tr_b16 v[144:145], v55 offset:0
    ds_read_b64_tr_b16 v[146:147], v55 offset:256
    ds_read_b64_tr_b16 v[148:149], v55 offset:8192
    ds_read_b64_tr_b16 v[150:151], v55 offset:8448
    s_mov_b32 s77, 24576
    s_call_b64 s[82:83], cf_dma
    ds_read_b64_tr_b16 v[152:153], v56 offset:0
    ds_read_b64_tr_b16 v[154:155], v56 offset:256
    ds_read_b64_tr_b16 v[156:157], v56 offset:8192
    ds_read_b64_tr_b16 v[158:159], v56 offset:8448
    s_mov_b32 s77, 32768
    s_call_b64 s[82:83], cf_dma
    s_waitcnt lgkmcnt(0)
    s_waitcnt vmcnt(9)
    v_add_u32 v55, 114688, v51
    v_xor_b32 v56, 32, v55
    ds_read_b64_tr_b16 a[192:193], v55 offset:0
    ds_read_b64_tr_b16 a[194:195], v55 offset:256
    ds_read_b64_tr_b16 a[196:197], v55 offset:8192
    ds_read_b64_tr_b16 a[198:199], v55 offset:8448
    s_xor_b32 s78, s75, 2097152
    s_add_u32 s78, s78, s67
    s_add_u32 s80, s66, 0
    s_mov_b32 s76, 0
    s_mov_b32 s77, 8192
    s_call_b64 s[82:83], cf_dma
    ds_read_b64_tr_b16 a[200:201], v56 offset:0
    ds_read_b64_tr_b16 a[202:203], v56 offset:256
    ds_read_b64_tr_b16 a[204:205], v56 offset:8192
    ds_read_b64_tr_b16 a[206:207], v56 offset:8448
    s_mov_b32 s77, 16384
    s_call_b64 s[82:83], cf_dma
    s_waitcnt lgkmcnt(0)
    v_add_u32 v55, 131072, v51
    v_xor_b32 v56, 32, v55
    ds_read_b64_tr_b16 a[208:209], v55 offset:0
    ds_read_b64_tr_b16 a[210:211], v55 offset:256
    ds_read_b64_tr_b16 a[212:213], v55 offset:8192
    ds_read_b64_tr_b16 a[214:215], v55 offset:8448
    s_mov_b32 s77, 24576
    s_call_b64 s[82:83], cf_dma
    ds_read_b64_tr_b16 a[216:217], v56 offset:0
    ds_read_b64_tr_b16 a[218:219], v56 offset:256
    ds_read_b64_tr_b16 a[220:221], v56 offset:8192
    ds_read_b64_tr_b16 a[222:223], v56 offset:8448
    s_mov_b32 s77, 32768
    s_call_b64 s[82:83], cf_dma
    s_waitcnt lgkmcnt(0)
    s_waitcnt vmcnt(8)
    v_add_u32 v55, 65536, v51
    v_xor_b32 v56, 32, v55
    ds_read_b64_tr_b16 a[224:225], v55 offset:0
    ds_read_b64_tr_b16 a[226:227], v55 offset:256
    ds_read_b64_tr_b16 a[228:229], v55 offset:8192
    ds_read_b64_tr_b16 a[230:231], v55 offset:8448
    s_cmp_eq_u32 s88, 0
    s_cbranch_scc1 cf_cpe658
    s_lshl_b32 s89, s73, 7
    s_add_u32 s89, s89, 125853696
    v_min_u32 v33, 11, v57
    v_lshlrev_b32 v33, 2, v33
    buffer_load_dword v34, off, s[96:99], 0 offset:64 sc1
    buffer_load_dword v35, v33, s[4:7], s89 offen sc1
cf_cpe658:
    s_xor_b32 s78, s75, 3145728
    s_add_u32 s78, s78, s67
    s_add_u32 s80, s66, 32768
    s_mov_b32 s76, 0
    s_mov_b32 s77, 8192
    s_call_b64 s[82:83], cf_dma
    ds_read_b64_tr_b16 a[232:233], v56 offset:0
    ds_read_b64_tr_b16 a[234:235], v56 offset:256
    ds_read_b64_tr_b16 a[236:237], v56 offset:8192
    ds_read_b64_tr_b16 a[238:239], v56 offset:8448
    s_mov_b32 s77, 16384
    s_call_b64 s[82:83], cf_dma
    s_waitcnt lgkmcnt(0)
    v_add_u32 v55, 81920, v51
    v_xor_b32 v56, 32, v55
    ds_read_b64_tr_b16 a[240:241], v55 offset:0
    ds_read_b64_tr_b16 a[242:243], v55 offset:256
    ds_read_b64_tr_b16 a[244:245], v55 offset:8192
    ds_read_b64_tr_b16 a[246:247], v55 offset:8448
    s_mov_b32 s77, 24576
    s_call_b64 s[82:83], cf_dma
    ds_read_b64_tr_b16 a[248:249], v56 offset:0
    ds_read_b64_tr_b16 a[250:251], v56 offset:256
    ds_read_b64_tr_b16 a[252:253], v56 offset:8192
    ds_read_b64_tr_b16 a[254:255], v56 offset:8448
    s_mov_b32 s77, 32768
    s_call_b64 s[82:83], cf_dma
    s_waitcnt lgkmcnt(0)
    v_readfirstlane_b32 s41, v46
    v_mov_b32 v36, 1
    v_mov_b32 v37, 0
    s_cmp_eq_u32 s41, 127
    s_cselect_b64 exec, 1, 0
    buffer_atomic_cmpswap v[36:37], off, s[96:99], 0 offset:140
    s_mov_b64 exec, -1
    s_waitcnt vmcnt(8)
    v_add_u32 v55, 0, v51
    v_xor_b32 v56, 32, v55
    ds_read_b64_tr_b16 v[80:81], v55 offset:0
    ds_read_b64_tr_b16 v[82:83], v55 offset:256
    ds_read_b64_tr_b16 v[84:85], v55 offset:8192
    ds_read_b64_tr_b16 v[86:87], v55 offset:8448
    s_cmp_eq_u32 s88, 0
    s_cbranch_scc1 cf_ncp709
    s_waitcnt vmcnt(8)
    v_max_u32 v34, 1, v34
    v_cmp_eq_u32 vcc, 1, v34
    s_cbranch_vccnz cf_ncp709
    v_cmp_ne_u32 vcc, v34, v35
    s_cbranch_vccnz cf_ncp709
    s_mov_b32 s88, 0
    s_mov_b32 s72, 5
    s_lshl_b32 s74, s73, 19
    s_add_u32 s74, s74, 96468992
    s_add_u32 s50, s4, s74
    s_addc_u32 s51, s5, 0
    s_add_u32 s52, s50, 147456
    s_addc_u32 s53, s51, 0
    s_lshl_b32 s67, s13, 6
    v_and_b32 v54, 63, v48
    v_lshrrev_b32 v48, 13, v48
    v_lshl_add_u32 v48, v48, 8, v54
cf_ncp709:
    s_cmp_eq_u32 s88, 0
    s_cbranch_scc1 cf_cpe730
    s_lshl_b32 s89, s73, 7
    s_add_u32 s89, s89, 125853696
    v_min_u32 v33, 11, v57
    v_lshlrev_b32 v33, 2, v33
    buffer_load_dword v34, off, s[96:99], 0 offset:64 sc1
    buffer_load_dword v35, v33, s[4:7], s89 offen sc1
cf_cpe730:
    s_xor_b32 s78, s75, 2097152
    s_lshr_b32 s78, s78, s72
    s_add_u32 s78, s78, s67
    s_mov_b64 s[8:9], s[52:53]
    v_mov_b32 v58, v48
    s_lshr_b32 s79, 131072, s72
    s_add_u32 s80, s66, 131072
    s_mov_b32 s76, 0
    s_mov_b32 s77, 8192
    s_call_b64 s[82:83], cf_dma
    ds_read_b64_tr_b16 v[88:89], v56 offset:0
    ds_read_b64_tr_b16 v[90:91], v56 offset:256
    ds_read_b64_tr_b16 v[92:93], v56 offset:8192
    ds_read_b64_tr_b16 v[94:95], v56 offset:8448
    s_mov_b32 s77, 16384
    s_call_b64 s[82:83], cf_dma
    s_waitcnt lgkmcnt(0)
    v_add_u32 v55, 16384, v51
    v_xor_b32 v56, 32, v55
    ds_read_b64_tr_b16 v[96:97], v55 offset:0
    ds_read_b64_tr_b16 v[98:99], v55 offset:256
    ds_read_b64_tr_b16 v[100:101], v55 offset:8192
    ds_read_b64_tr_b16 v[102:103], v55 offset:8448
    s_mov_b32 s77, 24576
    s_call_b64 s[82:83], cf_dma
    ds_read_b64_tr_b16 v[104:105], v56 offset:0
    ds_read_b64_tr_b16 v[106:107], v56 offset:256
    ds_read_b64_tr_b16 v[108:109], v56 offset:8192
    ds_read_b64_tr_b16 v[110:111], v56 offset:8448
    s_mov_b32 s77, 32768
    s_call_b64 s[82:83], cf_dma
    s_waitcnt lgkmcnt(0)
    s_waitcnt vmcnt(8)
    v_add_u32 v55, 32768, v51
    v_xor_b32 v56, 32, v55
    ds_read_b64_tr_b16 v[112:113], v55 offset:0
    ds_read_b64_tr_b16 v[114:115], v55 offset:256
    ds_read_b64_tr_b16 v[116:117], v55 offset:8192
    ds_read_b64_tr_b16 v[118:119], v55 offset:8448
    s_cmp_eq_u32 s88, 0
    s_cbranch_scc1 cf_ncp778
    s_waitcnt vmcnt(8)
    v_max_u32 v34, 1, v34
    v_cmp_eq_u32 vcc, 1, v34
    s_cbranch_vccnz cf_ncp778
    v_cmp_ne_u32 vcc, v34, v35
    s_cbranch_vccnz cf_ncp778
    s_mov_b32 s88, 0
    s_mov_b32 s72, 5
    s_lshl_b32 s74, s73, 19
    s_add_u32 s74, s74, 96468992
    s_add_u32 s50, s4, s74
    s_addc_u32 s51, s5, 0
    s_add_u32 s52, s50, 147456
    s_addc_u32 s53, s51, 0
    s_lshl_b32 s67, s13, 6
    v_and_b32 v54, 63, v48
    v_lshrrev_b32 v48, 13, v48
    v_lshl_add_u32 v48, v48, 8, v54
cf_ncp778:
    s_cmp_eq_u32 s88, 0
    s_cbranch_scc1 cf_cpe799
    s_lshl_b32 s89, s73, 7
    s_add_u32 s89, s89, 125853696
    v_min_u32 v33, 11, v57
    v_lshlrev_b32 v33, 2, v33
    buffer_load_dword v34, off, s[96:99], 0 offset:64 sc1
    buffer_load_dword v35, v33, s[4:7], s89 offen sc1
cf_cpe799:
    s_xor_b32 s78, s75, 3145728
    s_lshr_b32 s78, s78, s72
    s_add_u32 s78, s78, s67
    s_mov_b64 s[8:9], s[52:53]
    v_mov_b32 v58, v48
    s_lshr_b32 s79, 131072, s72
    s_add_u32 s80, s66, 65536
    s_mov_b32 s76, 0
    s_mov_b32 s77, 8192
    s_call_b64 s[82:83], cf_dma
    ds_read_b64_tr_b16 v[120:121], v56 offset:0
    ds_read_b64_tr_b16 v[122:123], v56 offset:256
    ds_read_b64_tr_b16 v[124:125], v56 offset:8192
    ds_read_b64_tr_b16 v[126:127], v56 offset:8448
    s_mov_b32 s77, 16384
    s_call_b64 s[82:83], cf_dma
    s_waitcnt lgkmcnt(0)
    v_add_u32 v55, 49152, v51
    v_xor_b32 v56, 32, v55
    ds_read_b64_tr_b16 v[128:129], v55 offset:0
    ds_read_b64_tr_b16 v[130:131], v55 offset:256
    ds_read_b64_tr_b16 v[132:133], v55 offset:8192
    ds_read_b64_tr_b16 v[134:135], v55 offset:8448
    s_mov_b32 s77, 24576
    s_call_b64 s[82:83], cf_dma
    ds_read_b64_tr_b16 v[136:137], v56 offset:0
    ds_read_b64_tr_b16 v[138:139], v56 offset:256
    ds_read_b64_tr_b16 v[140:141], v56 offset:8192
    ds_read_b64_tr_b16 v[142:143], v56 offset:8448
    s_mov_b32 s77, 32768
    s_call_b64 s[82:83], cf_dma
    s_waitcnt lgkmcnt(0)
    s_waitcnt vmcnt(8)
    v_add_u32 v55, 131072, v51
    v_xor_b32 v56, 32, v55
    ds_read_b64_tr_b16 a[128:129], v55 offset:0
    ds_read_b64_tr_b16 a[130:131], v55 offset:256
    ds_read_b64_tr_b16 a[132:133], v55 offset:8192
    ds_read_b64_tr_b16 a[134:135], v55 offset:8448
    s_cmp_eq_u32 s88, 0
    s_cbranch_scc1 cf_ncp847
    s_waitcnt vmcnt(8)
    v_max_u32 v34, 1, v34
    v_cmp_eq_u32 vcc, 1, v34
    s_cbranch_vccnz cf_ncp847
    v_cmp_ne_u32 vcc, v34, v35
    s_cbranch_vccnz cf_ncp847
    s_mov_b32 s88, 0
    s_mov_b32 s72, 5
    s_lshl_b32 s74, s73, 19
    s_add_u32 s74, s74, 96468992
    s_add_u32 s50, s4, s74
    s_addc_u32 s51, s5, 0
    s_add_u32 s52, s50, 147456
    s_addc_u32 s53, s51, 0
    s_lshl_b32 s67, s13, 6
    v_and_b32 v54, 63, v48
    v_lshrrev_b32 v48, 13, v48
    v_lshl_add_u32 v48, v48, 8, v54
cf_ncp847:
    s_cmp_eq_u32 s88, 0
    s_cbranch_scc1 cf_cpe868
    s_lshl_b32 s89, s73, 7
    s_add_u32 s89, s89, 125853696
    v_min_u32 v33, 11, v57
    v_lshlrev_b32 v33, 2, v33
    buffer_load_dword v34, off, s[96:99], 0 offset:64 sc1
    buffer_load_dword v35, v33, s[4:7], s89 offen sc1
cf_cpe868:
    s_xor_b32 s78, s75, 2097152
    s_lshr_b32 s78, s78, s72
    s_add_u32 s78, s78, s67
    s_mov_b64 s[8:9], s[50:51]
    v_mov_b32 v58, v48
    s_lshr_b32 s79, 131072, s72
    s_add_u32 s80, s66, 0
    s_mov_b32 s76, 0
    s_mov_b32 s77, 8192
    s_call_b64 s[82:83], cf_dma
    ds_read_b64_tr_b16 a[136:137], v56 offset:0
    ds_read_b64_tr_b16 a[138:139], v56 offset:256
    ds_read_b64_tr_b16 a[140:141], v56 offset:8192
    ds_read_b64_tr_b16 a[142:143], v56 offset:8448
    s_mov_b32 s77, 16384
    s_call_b64 s[82:83], cf_dma
    s_waitcnt lgkmcnt(0)
    v_add_u32 v55, 147456, v51
    v_xor_b32 v56, 32, v55
    ds_read_b64_tr_b16 a[144:145], v55 offset:0
    ds_read_b64_tr_b16 a[146:147], v55 offset:256
    ds_read_b64_tr_b16 a[148:149], v55 offset:8192
    ds_read_b64_tr_b16 a[150:151], v55 offset:8448
    s_mov_b32 s77, 24576
    s_call_b64 s[82:83], cf_dma
    ds_read_b64_tr_b16 a[152:153], v56 offset:0
    ds_read_b64_tr_b16 a[154:155], v56 offset:256
    ds_read_b64_tr_b16 a[156:157], v56 offset:8192
    ds_read_b64_tr_b16 a[158:159], v56 offset:8448
    s_mov_b32 s77, 32768
    s_call_b64 s[82:83], cf_dma
    s_waitcnt lgkmcnt(0)
    s_waitcnt vmcnt(8)
    v_add_u32 v55, 65536, v51
    v_xor_b32 v56, 32, v55
    ds_read_b64_tr_b16 a[160:161], v55 offset:0
    ds_read_b64_tr_b16 a[162:163], v55 offset:256
    ds_read_b64_tr_b16 a[164:165], v55 offset:8192
    ds_read_b64_tr_b16 a[166:167], v55 offset:8448
    s_cmp_eq_u32 s88, 0
    s_cbranch_scc1 cf_ncp916
    s_waitcnt vmcnt(8)
    v_max_u32 v34, 1, v34
    v_cmp_eq_u32 vcc, 1, v34
    s_cbranch_vccnz cf_ncp916
    v_cmp_ne_u32 vcc, v34, v35
    s_cbranch_vccnz cf_ncp916
    s_mov_b32 s88, 0
    s_mov_b32 s72, 5
    s_lshl_b32 s74, s73, 19
    s_add_u32 s74, s74, 96468992
    s_add_u32 s50, s4, s74
    s_addc_u32 s51, s5, 0
    s_add_u32 s52, s50, 147456
    s_addc_u32 s53, s51, 0
    s_lshl_b32 s67, s13, 6
    v_and_b32 v54, 63, v48
    v_lshrrev_b32 v48, 13, v48
    v_lshl_add_u32 v48, v48, 8, v54
cf_ncp916:
    s_cmp_eq_u32 s88, 0
    s_cbranch_scc1 cf_cpe937
    s_lshl_b32 s89, s73, 7
    s_add_u32 s89, s89, 125853696
    v_min_u32 v33, 11, v57
    v_lshlrev_b32 v33, 2, v33
    buffer_load_dword v34, off, s[96:99], 0 offset:64 sc1
    buffer_load_dword v35, v33, s[4:7], s89 offen sc1
cf_cpe937:
    s_xor_b32 s78, s75, 3145728
    s_lshr_b32 s78, s78, s72
    s_add_u32 s78, s78, s67
    s_mov_b64 s[8:9], s[50:51]
    v_mov_b32 v58, v48
    s_lshr_b32 s79, 131072, s72
    s_add_u32 s80, s66, 32768
    s_mov_b32 s76, 0
    s_mov_b32 s77, 8192
    s_call_b64 s[82:83], cf_dma
    ds_read_b64_tr_b16 a[168:169], v56 offset:0
    ds_read_b64_tr_b16 a[170:171], v56 offset:256
    ds_read_b64_tr_b16 a[172:173], v56 offset:8192
    ds_read_b64_tr_b16 a[174:175], v56 offset:8448
    s_mov_b32 s77, 16384
    s_call_b64 s[82:83], cf_dma
    s_waitcnt lgkmcnt(0)
    v_add_u32 v55, 81920, v51
    v_xor_b32 v56, 32, v55
    ds_read_b64_tr_b16 a[176:177], v55 offset:0
    ds_read_b64_tr_b16 a[178:179], v55 offset:256
    ds_read_b64_tr_b16 a[180:181], v55 offset:8192
    ds_read_b64_tr_b16 a[182:183], v55 offset:8448
    s_mov_b32 s77, 24576
    s_call_b64 s[82:83], cf_dma
    ds_read_b64_tr_b16 a[184:185], v56 offset:0
    ds_read_b64_tr_b16 a[186:187], v56 offset:256
    ds_read_b64_tr_b16 a[188:189], v56 offset:8192
    ds_read_b64_tr_b16 a[190:191], v56 offset:8448
    s_mov_b32 s77, 32768
    s_call_b64 s[82:83], cf_dma
    s_waitcnt lgkmcnt(0)
    s_waitcnt vmcnt(8)
    v_add_u32 v55, 0, v51
    v_xor_b32 v56, 32, v55
    ds_read_b64_tr_b16 a[48:49], v55 offset:0
    ds_read_b64_tr_b16 a[50:51], v55 offset:256
    ds_read_b64_tr_b16 a[52:53], v55 offset:8192
    ds_read_b64_tr_b16 a[54:55], v55 offset:8448
    s_lshr_b32 s78, 4194304, s72
    s_add_u32 s78, s78, s67
    s_mov_b32 s81, 0
    s_add_u32 s80, s66, 98304
    s_mov_b32 s76, 0
    s_mov_b32 s77, 8192
    s_call_b64 s[82:83], cf_dma
    ds_read_b64_tr_b16 a[56:57], v56 offset:0
    ds_read_b64_tr_b16 a[58:59], v56 offset:256
    ds_read_b64_tr_b16 a[60:61], v56 offset:8192
    ds_read_b64_tr_b16 a[62:63], v56 offset:8448
    s_mov_b32 s77, 16384
    s_call_b64 s[82:83], cf_dma
    s_waitcnt lgkmcnt(0)
    v_add_u32 v55, 16384, v51
    v_xor_b32 v56, 32, v55
    ds_read_b64_tr_b16 a[64:65], v55 offset:0
    ds_read_b64_tr_b16 a[66:67], v55 offset:256
    ds_read_b64_tr_b16 a[68:69], v55 offset:8192
    ds_read_b64_tr_b16 a[70:71], v55 offset:8448
    s_cmp_eq_u32 s88, 0
    s_cbranch_scc1 cf_ncp1005
    s_waitcnt vmcnt(12)
    v_max_u32 v34, 1, v34
    v_cmp_eq_u32 vcc, 1, v34
    s_cbranch_vccnz cf_ncp1005
    v_cmp_ne_u32 vcc, v34, v35
    s_cbranch_vccnz cf_ncp1005
    s_mov_b32 s88, 0
    s_mov_b32 s72, 5
    s_lshl_b32 s74, s73, 19
    s_add_u32 s74, s74, 96468992
    s_add_u32 s50, s4, s74
    s_addc_u32 s51, s5, 0
    s_add_u32 s52, s50, 147456
    s_addc_u32 s53, s51, 0
    s_lshl_b32 s67, s13, 6
    v_and_b32 v54, 63, v48
    v_lshrrev_b32 v48, 13, v48
    v_lshl_add_u32 v48, v48, 8, v54
cf_ncp1005:
    s_xor_b32 s78, s75, 1048576
    s_lshr_b32 s78, s78, s72
    s_add_u32 s78, s78, s67
    s_mov_b64 s[8:9], s[50:51]
    v_mov_b32 v58, v48
    s_lshr_b32 s79, 131072, s72
    s_mov_b32 s81, s93
    s_add_u32 s80, s66, 114688
    s_mov_b32 s76, 0
    s_mov_b32 s77, 8192
    s_call_b64 s[82:83], cf_dma
    ds_read_b64_tr_b16 a[72:73], v56 offset:0
    ds_read_b64_tr_b16 a[74:75], v56 offset:256
    ds_read_b64_tr_b16 a[76:77], v56 offset:8192
    ds_read_b64_tr_b16 a[78:79], v56 offset:8448
    s_mov_b32 s77, 16384
    s_call_b64 s[82:83], cf_dma
    s_waitcnt lgkmcnt(0)
    s_waitcnt vmcnt(8)
    v_add_u32 v55, 32768, v51
    v_xor_b32 v56, 32, v55
    ds_read_b64_tr_b16 a[80:81], v55 offset:0
    ds_read_b64_tr_b16 a[82:83], v55 offset:256
    ds_read_b64_tr_b16 a[84:85], v55 offset:8192
    ds_read_b64_tr_b16 a[86:87], v55 offset:8448
    s_mov_b32 s77, 24576
    s_call_b64 s[82:83], cf_dma
    ds_read_b64_tr_b16 a[88:89], v56 offset:0
    ds_read_b64_tr_b16 a[90:91], v56 offset:256
    ds_read_b64_tr_b16 a[92:93], v56 offset:8192
    ds_read_b64_tr_b16 a[94:95], v56 offset:8448
    s_mov_b32 s77, 32768
    s_call_b64 s[82:83], cf_dma
    s_waitcnt lgkmcnt(0)
    v_add_u32 v55, 49152, v51
    v_xor_b32 v56, 32, v55
    ds_read_b64_tr_b16 a[96:97], v55 offset:0
    ds_read_b64_tr_b16 a[98:99], v55 offset:256
    ds_read_b64_tr_b16 a[100:101], v55 offset:8192
    ds_read_b64_tr_b16 a[102:103], v55 offset:8448
    s_xor_b32 s78, s75, 0
    s_lshr_b32 s78, s78, s72
    s_add_u32 s78, s78, s67
    s_add_u32 s80, s66, 65536
    s_mov_b32 s76, 0
    s_mov_b32 s77, 8192
    s_call_b64 s[82:83], cf_dma
    ds_read_b64_tr_b16 a[104:105], v56 offset:0
    ds_read_b64_tr_b16 a[106:107], v56 offset:256
    ds_read_b64_tr_b16 a[108:109], v56 offset:8192
    ds_read_b64_tr_b16 a[110:111], v56 offset:8448
    s_mov_b32 s77, 16384
    s_call_b64 s[82:83], cf_dma
    s_waitcnt lgkmcnt(0)
    s_waitcnt vmcnt(12)
    v_add_u32 v55, 98304, v51
    v_xor_b32 v56, 32, v55
    ds_read_b64_tr_b16 a[112:113], v55 offset:0
    ds_read_b64_tr_b16 a[114:115], v55 offset:256
    ds_read_b64_tr_b16 a[116:117], v55 offset:8192
    ds_read_b64_tr_b16 a[118:119], v55 offset:8448
    s_mov_b32 s77, 24576
    s_call_b64 s[82:83], cf_dma
    ds_read_b64_tr_b16 a[120:121], v56 offset:0
    ds_read_b64_tr_b16 a[122:123], v56 offset:256
    ds_read_b64_tr_b16 a[124:125], v56 offset:8192
    ds_read_b64_tr_b16 a[126:127], v56 offset:8448
    s_mov_b32 s77, 32768
    s_call_b64 s[82:83], cf_dma
    s_waitcnt lgkmcnt(0)
    s_waitcnt vmcnt(8)
    v_add_u32 v55, 114688, v51
    v_xor_b32 v56, 32, v55
    ds_read_b64_tr_b16 a[16:17], v55 offset:0
    ds_read_b64_tr_b16 a[18:19], v55 offset:256
    ds_read_b64_tr_b16 a[20:21], v55 offset:8192
    ds_read_b64_tr_b16 a[22:23], v55 offset:8448
    s_xor_b32 s78, s75, 0
    s_lshr_b32 s78, s78, s72
    s_add_u32 s78, s78, s67
    s_mov_b64 s[8:9], s[52:53]
    s_add_u32 s80, s66, 0
    s_mov_b32 s76, 0
    s_mov_b32 s77, 8192
    s_call_b64 s[82:83], cf_dma
    ds_read_b64_tr_b16 a[24:25], v56 offset:0
    ds_read_b64_tr_b16 a[26:27], v56 offset:256
    ds_read_b64_tr_b16 a[28:29], v56 offset:8192
    ds_read_b64_tr_b16 a[30:31], v56 offset:8448
    s_mov_b32 s77, 16384
    s_call_b64 s[82:83], cf_dma
    s_waitcnt lgkmcnt(0)
    v_add_u32 v55, 131072, v51
    v_xor_b32 v56, 32, v55
    ds_read_b64_tr_b16 a[32:33], v55 offset:0
    ds_read_b64_tr_b16 a[34:35], v55 offset:256
    ds_read_b64_tr_b16 a[36:37], v55 offset:8192
    ds_read_b64_tr_b16 a[38:39], v55 offset:8448
    s_mov_b32 s77, 24576
    s_call_b64 s[82:83], cf_dma
    ds_read_b64_tr_b16 a[40:41], v56 offset:0
    ds_read_b64_tr_b16 a[42:43], v56 offset:256
    ds_read_b64_tr_b16 a[44:45], v56 offset:8192
    ds_read_b64_tr_b16 a[46:47], v56 offset:8448
    s_mov_b32 s77, 32768
    s_call_b64 s[82:83], cf_dma
    s_waitcnt lgkmcnt(0)
    s_waitcnt vmcnt(8)
    v_add_u32 v55, 65536, v51
    v_xor_b32 v56, 32, v55
    ds_read_b64_tr_b16 v[0:1], v55 offset:0
    ds_read_b64_tr_b16 v[2:3], v55 offset:256
    ds_read_b64_tr_b16 v[4:5], v55 offset:8192
    ds_read_b64_tr_b16 v[6:7], v55 offset:8448
    s_xor_b32 s78, s75, 1048576
    s_lshr_b32 s78, s78, s72
    s_add_u32 s78, s78, s67
    s_add_u32 s80, s66, 32768
    s_mov_b32 s76, 0
    s_mov_b32 s77, 8192
    s_call_b64 s[82:83], cf_dma
    ds_read_b64_tr_b16 v[8:9], v56 offset:0
    ds_read_b64_tr_b16 v[10:11], v56 offset:256
    ds_read_b64_tr_b16 v[12:13], v56 offset:8192
    ds_read_b64_tr_b16 v[14:15], v56 offset:8448
    s_mov_b32 s77, 16384
    s_call_b64 s[82:83], cf_dma
    s_waitcnt lgkmcnt(0)
    ds_write_b128 v62, v[0:3] offset:8192
    ds_write_b128 v62, v[4:7] offset:12288
    ds_write_b128 v62, v[8:11] offset:16384
    ds_write_b128 v62, v[12:15] offset:20480
    s_waitcnt lgkmcnt(0)
    v_add_u32 v55, 81920, v51
    v_xor_b32 v56, 32, v55
    ds_read_b64_tr_b16 a[0:1], v55 offset:0
    ds_read_b64_tr_b16 a[2:3], v55 offset:256
    ds_read_b64_tr_b16 a[4:5], v55 offset:8192
    ds_read_b64_tr_b16 a[6:7], v55 offset:8448
    s_mov_b32 s77, 24576
    s_call_b64 s[82:83], cf_dma
    ds_read_b64_tr_b16 a[8:9], v56 offset:0
    ds_read_b64_tr_b16 a[10:11], v56 offset:256
    ds_read_b64_tr_b16 a[12:13], v56 offset:8192
    ds_read_b64_tr_b16 a[14:15], v56 offset:8448
    s_mov_b32 s77, 32768
    s_call_b64 s[82:83], cf_dma
    s_waitcnt lgkmcnt(0)
    s_waitcnt vmcnt(8)
    v_add_u32 v55, 0, v51
    v_xor_b32 v56, 32, v55
    ds_read_b64_tr_b16 v[0:1], v55 offset:0
    ds_read_b64_tr_b16 v[2:3], v55 offset:256
    ds_read_b64_tr_b16 v[4:5], v55 offset:8192
    ds_read_b64_tr_b16 v[6:7], v55 offset:8448
    s_xor_b32 s94, s13, 0
    s_mul_i32 s94, s94, 36864
    s_add_u32 s94, s94, s92
    s_lshr_b32 s74, s13, 1
    s_lshl_b32 s74, s74, 6
    s_add_u32 s94, s94, s74
    s_add_u32 s78, s94, 1024
    s_mov_b64 s[8:9], s[56:57]
    v_mov_b32 v58, v50
    s_mov_b32 s79, 18432
    s_mov_b32 s81, 0
    s_add_u32 s80, s66, 147456
    s_mov_b32 s76, 0
    s_mov_b32 s77, 8192
    s_call_b64 s[82:83], cf_dma
    ds_read_b64_tr_b16 v[8:9], v56 offset:0
    ds_read_b64_tr_b16 v[10:11], v56 offset:256
    ds_read_b64_tr_b16 v[12:13], v56 offset:8192
    ds_read_b64_tr_b16 v[14:15], v56 offset:8448
    s_xor_b32 s94, s13, 2
    s_mul_i32 s94, s94, 36864
    s_add_u32 s94, s94, s92
    s_lshr_b32 s74, s13, 1
    s_lshl_b32 s74, s74, 6
    s_add_u32 s94, s94, s74
    s_add_u32 s78, s94, 1024
    s_mov_b32 s77, 16384
    s_call_b64 s[82:83], cf_dma
    s_waitcnt lgkmcnt(0)
    ds_write_b128 v61, v[0:3] offset:0
    ds_write_b128 v61, v[4:7] offset:4096
    ds_write_b128 v61, v[8:11] offset:8192
    ds_write_b128 v61, v[12:15] offset:12288
    s_waitcnt lgkmcnt(0)
    v_add_u32 v55, 16384, v51
    v_xor_b32 v56, 32, v55
    ds_read_b64_tr_b16 v[0:1], v55 offset:0
    ds_read_b64_tr_b16 v[2:3], v55 offset:256
    ds_read_b64_tr_b16 v[4:5], v55 offset:8192
    ds_read_b64_tr_b16 v[6:7], v55 offset:8448
    s_xor_b32 s94, s13, 3
    s_mul_i32 s94, s94, 36864
    s_add_u32 s94, s94, s92
    s_lshl_b32 s74, s13, 7
    s_add_u32 s94, s94, s74
    s_add_u32 s78, s94, 512
    v_mov_b32 v58, v49
    s_mov_b32 s79, 9216
    s_add_u32 s80, s66, 131072
    s_mov_b32 s76, 0
    s_mov_b32 s77, 8192
    s_call_b64 s[82:83], cf_dma
    ds_read_b64_tr_b16 v[8:9], v56 offset:0
    ds_read_b64_tr_b16 v[10:11], v56 offset:256
    ds_read_b64_tr_b16 v[12:13], v56 offset:8192
    ds_read_b64_tr_b16 v[14:15], v56 offset:8448
    s_mov_b32 s77, 16384
    s_call_b64 s[82:83], cf_dma
    s_waitcnt lgkmcnt(0)
    ds_write_b128 v61, v[0:3] offset:16384
    ds_write_b128 v61, v[4:7] offset:20480
    ds_write_b128 v61, v[8:11] offset:24576
    ds_write_b128 v61, v[12:15] offset:28672
    s_waitcnt lgkmcnt(0)
    s_waitcnt vmcnt(8)
    v_add_u32 v55, 32768, v51
    v_xor_b32 v56, 32, v55
    ds_read_b64_tr_b16 v[0:1], v55 offset:0
    ds_read_b64_tr_b16 v[2:3], v55 offset:256
    ds_read_b64_tr_b16 v[4:5], v55 offset:8192
    ds_read_b64_tr_b16 v[6:7], v55 offset:8448
    s_xor_b32 s94, s13, 2
    s_mul_i32 s94, s94, 36864
    s_add_u32 s94, s94, s92
    s_lshl_b32 s74, s13, 7
    s_add_u32 s94, s94, s74
    s_add_u32 s78, s94, 512
    s_add_u32 s80, s66, 114688
    s_mov_b32 s76, 0
    s_mov_b32 s77, 8192
    s_call_b64 s[82:83], cf_dma
    ds_read_b64_tr_b16 v[8:9], v56 offset:0
    ds_read_b64_tr_b16 v[10:11], v56 offset:256
    ds_read_b64_tr_b16 v[12:13], v56 offset:8192
    ds_read_b64_tr_b16 v[14:15], v56 offset:8448
    s_mov_b32 s77, 16384
    s_call_b64 s[82:83], cf_dma
    s_waitcnt lgkmcnt(0)
    ds_write_b128 v61, v[0:3] offset:32768
    ds_write_b128 v61, v[4:7] offset:36864
    ds_write_b128 v61, v[8:11] offset:40960
    ds_write_b128 v61, v[12:15] offset:45056
    s_waitcnt lgkmcnt(0)
    v_add_u32 v55, 49152, v51
    v_xor_b32 v56, 32, v55
    ds_read_b64_tr_b16 v[0:1], v55 offset:0
    ds_read_b64_tr_b16 v[2:3], v55 offset:256
    ds_read_b64_tr_b16 v[4:5], v55 offset:8192
    ds_read_b64_tr_b16 v[6:7], v55 offset:8448
    s_lshr_b32 s78, 4194304, s72
    s_add_u32 s78, s78, s67
    s_mov_b64 s[8:9], s[52:53]
    v_mov_b32 v58, v48
    s_lshr_b32 s79, 131072, s72
    s_add_u32 s80, s66, 81920
    s_mov_b32 s76, 0
    s_mov_b32 s77, 8192
    s_call_b64 s[82:83], cf_dma
    ds_read_b64_tr_b16 v[8:9], v56 offset:0
    ds_read_b64_tr_b16 v[10:11], v56 offset:256
    ds_read_b64_tr_b16 v[12:13], v56 offset:8192
    ds_read_b64_tr_b16 v[14:15], v56 offset:8448
    s_mov_b32 s77, 16384
    s_call_b64 s[82:83], cf_dma
    s_waitcnt lgkmcnt(0)
    ds_write_b128 v61, v[0:3] offset:49152
    ds_write_b128 v61, v[4:7] offset:53248
    ds_write_b128 v61, v[8:11] offset:57344
    ds_write_b128 v61, v[12:15] offset:61440
    s_waitcnt lgkmcnt(0)
    buffer_load_dword v38, off, s[96:99], 0 offset:140 sc1
    buffer_load_dword v39, off, s[96:99], 0 offset:64 sc1
    s_lshr_b32 s84, s12, 1
    s_lshl_b32 s84, s84, 8
    s_add_u32 s84, s84, 125829120
    v_bfe_u32 v40, v61, 4, 6
    v_min_u32 v40, 11, v40
    v_lshlrev_b32 v40, 2, v40
    buffer_load_dword v41, v40, s[4:7], s84 offen sc1
    s_waitcnt vmcnt(15)
    v_add_u32 v55, 147456, v53
    ds_read_b64_tr_b16 v[0:1], v55 offset:0
    ds_read_b64_tr_b16 v[2:3], v55 offset:128
    ds_read_b64_tr_b16 v[4:5], v55 offset:512
    ds_read_b64_tr_b16 v[6:7], v55 offset:640
    ds_read_b64_tr_b16 v[8:9], v55 offset:8192
    ds_read_b64_tr_b16 v[10:11], v55 offset:8320
    ds_read_b64_tr_b16 v[12:13], v55 offset:8704
    ds_read_b64_tr_b16 v[14:15], v55 offset:8832
    s_waitcnt lgkmcnt(0)
    s_barrier
    ds_write_b128 v63, v[0:3] offset:49152
    ds_write_b128 v63, v[4:7] offset:53248
    s_barrier
    ds_write_b128 v63, v[8:11] offset:57344
    ds_write_b128 v63, v[12:15] offset:61440
    s_waitcnt lgkmcnt(0)
    s_waitcnt vmcnt(11)
    v_add_u32 v55, 131072, v52
    ds_read_b64_tr_b16 v[0:1], v55 offset:0
    ds_read_b64_tr_b16 v[2:3], v55 offset:256
    ds_read_b64_tr_b16 v[4:5], v55 offset:4096
    ds_read_b64_tr_b16 v[6:7], v55 offset:4352
    ds_read_b64_tr_b16 v[8:9], v55 offset:64
    ds_read_b64_tr_b16 v[10:11], v55 offset:320
    ds_read_b64_tr_b16 v[12:13], v55 offset:4160
    ds_read_b64_tr_b16 v[14:15], v55 offset:4416
    s_waitcnt lgkmcnt(0)
    s_barrier
    ds_write_b128 v63, v[0:3] offset:32768
    ds_write_b128 v63, v[4:7] offset:36864
    s_barrier
    ds_write_b128 v63, v[8:11] offset:40960
    ds_write_b128 v63, v[12:15] offset:45056
    s_waitcnt lgkmcnt(0)
    s_waitcnt vmcnt(7)
    v_add_u32 v55, 114688, v52
    ds_read_b64_tr_b16 v[0:1], v55 offset:0
    ds_read_b64_tr_b16 v[2:3], v55 offset:256
    ds_read_b64_tr_b16 v[4:5], v55 offset:4096
    ds_read_b64_tr_b16 v[6:7], v55 offset:4352
    ds_read_b64_tr_b16 v[8:9], v55 offset:64
    ds_read_b64_tr_b16 v[10:11], v55 offset:320
    ds_read_b64_tr_b16 v[12:13], v55 offset:4160
    ds_read_b64_tr_b16 v[14:15], v55 offset:4416
    s_waitcnt lgkmcnt(0)
    s_barrier
    ds_write_b128 v63, v[0:3] offset:16384
    ds_write_b128 v63, v[4:7] offset:20480
    s_barrier
    ds_write_b128 v63, v[8:11] offset:24576
    ds_write_b128 v63, v[12:15] offset:28672
    s_waitcnt lgkmcnt(0)
    buffer_load_dword v30, v79, s[4:7], s14 offen sc1
    s_lshl_b32 s40, s12, 14
    s_add_u32 s40, s40, 67174400
    buffer_load_dword v30, v79, s[4:7], s40 offen sc1
    s_and_b32 s40, s12, 3
    s_lshl_b32 s40, s40, 14
    s_add_u32 s40, s40, 67108864
    buffer_load_dword v30, v79, s[4:7], s40 offen sc1
    s_waitcnt vmcnt(1)
    v_readfirstlane_b32 s95, v39
    v_readfirstlane_b32 s85, v38
    s_add_u32 s86, s95, 2
    s_waitcnt vmcnt(0)
    v_subrev_u32 v41, s86, v41
    v_cmp_lt_u32 s[86:87], 64, v41
    s_cmp_eq_u32 s95, 0
    s_cselect_b64 s[86:87], -1, s[86:87]
    s_cmp_lg_u64 s[86:87], 0
    s_cbranch_scc1 cf_nt
    s_add_u32 s40, s24, 524288
    buffer_load_dword v30, v79, s[4:7], s24 offen sc1
    buffer_load_dword v30, v79, s[4:7], s40 offen sc1
cf_nt:
    s_waitcnt vmcnt(3)
    v_add_u32 v55, 81920, v51
    v_xor_b32 v56, 32, v55
    ds_read_b64_tr_b16 v[0:1], v55 offset:0
    ds_read_b64_tr_b16 v[2:3], v55 offset:256
    ds_read_b64_tr_b16 v[4:5], v55 offset:8192
    ds_read_b64_tr_b16 v[6:7], v55 offset:8448
    ds_read_b64_tr_b16 v[8:9], v56 offset:0
    ds_read_b64_tr_b16 v[10:11], v56 offset:256
    ds_read_b64_tr_b16 v[12:13], v56 offset:8192
    ds_read_b64_tr_b16 v[14:15], v56 offset:8448
    s_waitcnt lgkmcnt(0)
    ds_write_b128 v62, v[0:3] offset:24576
    ds_write_b128 v62, v[4:7] offset:28672
    ds_write_b128 v62, v[8:11] offset:32768
    ds_write_b128 v62, v[12:15] offset:36864
    s_waitcnt lgkmcnt(0)
    s_barrier
    s_mov_b32 s88, 4194304
gn2:
    s_cmp_lg_u32 s95, 0
    s_cbranch_scc1 gn2x
    buffer_load_dword v24, off, s[96:99], 0 offset:64 sc1
    s_sub_u32 s88, s88, 1
    s_cbranch_scc1 gn2x
    s_waitcnt vmcnt(0)
    v_readfirstlane_b32 s95, v24
    s_nop 1
    s_branch gn2
gn2x:
    ds_write_b128 v78, v[16:19] offset:8704
    ds_write_b128 v65, v[20:23] offset:10240
    v_mov_b32 v44, s95
    v_mov_b32 v45, s95
    v_mov_b32 v46, s95
    v_mov_b32 v47, s95
    v_mov_b32 v48, 108288
    ds_write_b128 v48, v[44:47]
    s_waitcnt vmcnt(0) lgkmcnt(0)
    s_cmp_eq_u32 s85, 1
    s_cbranch_scc1 cf_run
    s_mov_b32 s40, 131072
cf_startpoll:
    buffer_load_dword v3, off, s[96:99], 0 offset:140 sc1
    s_waitcnt vmcnt(0)
    v_readfirstlane_b32 s85, v3
    s_nop 0
    s_cmp_eq_u32 s85, 1
    s_cbranch_scc1 cf_run
    s_cmp_eq_u32 s85, 2
    s_cbranch_scc1 cf_leave
    s_sleep 1
    s_sub_u32 s40, s40, 1
    s_cbranch_scc0 cf_startpoll
    v_mov_b32 v4, 2
    v_mov_b32 v5, 0
    s_mov_b64 exec, 1
    buffer_atomic_cmpswap v[4:5], off, s[96:99], 0 offset:140
    s_mov_b64 exec, -1
    s_mov_b32 s40, 1048576
    s_branch cf_startpoll
cf_leave:
    v_lshrrev_b32 v0, 4, v61
    s_mov_b32 s32, s13
    s_load_dwordx16 s[48:63], s[0:1], 0
    s_waitcnt lgkmcnt(0)
    s_branch L_helper
cf_run:
    s_cmp_eq_u64 s[86:87], 0
    s_cbranch_scc1 cf_kvok
    s_lshr_b32 s92, s12, 1
    s_lshl_b32 s92, s92, 8
    s_add_u32 s92, s92, 125829120
    v_bfe_u32 v2, v61, 4, 6
    v_min_u32 v2, 11, v2
    v_lshlrev_b32 v2, 2, v2
    s_add_u32 s93, s95, 2
    s_mov_b32 s94, 4194304
cf_kv0:
    buffer_load_dword v3, v2, s[4:7], s92 offen sc1
    s_sub_u32 s94, s94, 1
    s_cbranch_scc1 cf_kv0_go
    s_waitcnt vmcnt(0)
    v_subrev_u32 v3, s93, v3
    v_cmp_lt_u32 vcc, 64, v3
    s_cbranch_vccz cf_kv0_go
    s_sleep 2
    s_branch cf_kv0
cf_kv0_go:
    s_add_u32 s40, s24, 524288
    buffer_load_dword v30, v79, s[4:7], s24 offen sc1
    buffer_load_dword v30, v79, s[4:7], s40 offen sc1
    s_waitcnt vmcnt(0)
cf_kvok:
    s_mov_b32 m0, 108032
    s_add_u32 s24, s24, 1048576
    s_add_u32 s15, s14, 4096
    s_add_u32 s16, s14, 8192
    ds_read_b128 v[32:35], v62 offset:16384
    ds_read_b128 v[36:39], v62 offset:20480
    ds_read_b128 v[40:43], v61 offset:0
    ds_read_b128 v[44:47], v61 offset:4096
    ds_read_b128 v[48:51], v61 offset:8192
    ds_read_b128 v[52:55], v61 offset:12288
    s_mov_b32 s29, 1048576
    buffer_load_dwordx4 v[24:27], v61, s[4:7], s14 offen nt
.p2align 6
cf_loop:
    v_mov_b64 v[0:1], 0
    v_mov_b64 v[2:3], 0
    v_mov_b64 v[4:5], 0
    v_mov_b64 v[6:7], 0
    v_mov_b64 v[8:9], 0
    v_mov_b64 v[10:11], 0
    v_mov_b64 v[12:13], 0
    v_mov_b64 v[14:15], 0
cf_loop2:
    ds_read_b128 v[16:19], v62 offset:8192
    ds_read_b128 v[20:23], v62 offset:12288
    v_lshrrev_b32 v56, 2, v61
    v_add_u32 v58, 106496, v56
    s_mov_b32 s29, 1048576
    s_nop 13
    buffer_load_dwordx4 v[24:27], v61, s[4:7], s14 offen nt
    s_waitcnt lgkmcnt(0)
cf_chk0:
    s_waitcnt vmcnt(1)
cf_chk0b:
    v_max3_u32 v57, v24, v25, v26
    v_max_u32 v57, v57, v27
    v_cmp_eq_u32 vcc, -1, v57
    ds_write_b128 v62, v[24:27] offset:40960
    s_cbranch_vccnz cf_spin0
    v_smfmac_f32_16x16x64_bf16 v[0:3], v[24:27], v[16:23], v60
    buffer_load_dwordx4 v[28:31], v61, s[4:7], s15 offen nt
    buffer_load_dword v59, v56, s[4:7], s16 offen nt
    v_smfmac_f32_16x16x64_bf16 v[8:11], v[24:27], v[32:39], v60
    ds_read_b128 v[32:35], v61 offset:16384
    v_smfmac_f32_16x16x64_bf16 v[12:15], v[24:27], v[48:55], v60
    ds_read_b128 v[36:39], v61 offset:20480
    v_mfma_f32_16x16x16_bf16 v[16:19], v[72:73], v[72:73], 0
    s_waitcnt lgkmcnt(2)
    s_barrier
    ds_read_b128 v[48:51], v63 offset:0
    v_mfma_f32_16x16x16_bf16 v[20:23], v[72:73], v[72:73], 0
    ds_read_b128 v[52:55], v64 offset:0
    v_smfmac_f32_16x16x64_bf16 v[4:7], v[24:27], v[40:47], v60
    ds_read_b128 v[40:43], v61 offset:24576
    v_smfmac_f32_16x16x64_bf16 v[16:19], v[24:27], a[192:199], v60
    ds_read_b128 v[44:47], v61 offset:28672
    v_smfmac_f32_16x16x64_bf16 v[20:23], v[24:27], a[200:207], v60
    s_waitcnt lgkmcnt(3)
    v_smfmac_f32_16x16x64_bf16 v[0:3], v[48:51], a[0:7], v60
    s_add_u32 s18, s14, s31
    s_add_u32 s41, s14, 16384
    v_smfmac_f32_16x16x64_bf16 v[4:7], v[48:51], v[32:39], v60
    ds_read_b128 v[32:35], v61 offset:32768
    v_smfmac_f32_16x16x64_bf16 v[8:11], v[48:51], a[8:15], v60
    ds_read_b128 v[36:39], v61 offset:36864
    s_waitcnt lgkmcnt(2)
    v_smfmac_f32_16x16x64_bf16 v[12:15], v[48:51], v[40:47], v60
    ds_read_b128 v[40:43], v61 offset:40960
    v_smfmac_f32_16x16x64_bf16 v[0:3], v[52:55], a[16:23], v60
    ds_read_b128 v[44:47], v61 offset:45056
    v_smfmac_f32_16x16x64_bf16 v[8:11], v[52:55], a[24:31], v60
    ds_read_b128 v[48:51], v71 offset:0
    s_waitcnt lgkmcnt(3)
    v_smfmac_f32_16x16x64_bf16 v[4:7], v[52:55], v[32:39], v60
    s_waitcnt vmcnt(0)
    ds_write_b128 v62, v[28:31] offset:45056
    s_waitcnt lgkmcnt(2)
    v_smfmac_f32_16x16x64_bf16 v[12:15], v[52:55], v[40:47], v60
    ds_write_b32 v58, v59
    v_max3_u32 v57, v28, v29, v30
    s_waitcnt lgkmcnt(2)
    v_smfmac_f32_16x16x64_bf16 v[0:3], v[48:51], a[32:39], v60
    ds_read_b128 v[32:35], v61 offset:49152
    v_max3_u32 v57, v57, v31, v59
    v_smfmac_f32_16x16x64_bf16 v[8:11], v[48:51], a[40:47], v60
    ds_read_b128 v[36:39], v61 offset:53248
    v_cmp_eq_u32 vcc, -1, v57
    v_smfmac_f32_16x16x64_bf16 v[16:19], v[52:55], a[224:231], v60
    ds_read_b128 v[40:43], v61 offset:57344
    v_smfmac_f32_16x16x64_bf16 v[20:23], v[52:55], a[232:239], v60
    ds_read_b128 v[44:47], v61 offset:61440
    s_cbranch_vccnz cf_spin1
cf_go1:
    v_smfmac_f32_16x16x64_bf16 v[0:3], v[28:31], a[48:55], v60
    s_waitcnt lgkmcnt(4)
    s_barrier
    ds_read_b128 v[52:55], v63 offset:4096
    v_smfmac_f32_16x16x64_bf16 v[8:11], v[28:31], a[56:63], v60
    ds_read_b128 v[56:59], v71 offset:4096
    v_smfmac_f32_16x16x64_bf16 v[4:7], v[28:31], a[128:135], v60
    s_waitcnt lgkmcnt(2)
    v_smfmac_f32_16x16x64_bf16 v[4:7], v[48:51], v[32:39], v60
    buffer_load_dwordx4 v[32:35], v61, s[4:7], s23 offen offset:0 sc1
    v_smfmac_f32_16x16x64_bf16 v[12:15], v[48:51], v[40:47], v60
    ds_read_b128 v[48:51], v64 offset:4096
    v_smfmac_f32_16x16x64_bf16 v[12:15], v[28:31], a[136:143], v60
    ds_read_b128 v[24:27], v65 offset:8192
    s_and_b32 s41, s41, 65535
    s_add_u32 s41, s41, 67108864
    v_smfmac_f32_16x16x64_bf16 v[16:19], v[28:31], v[80:87], v60
    buffer_load_dwordx4 v[36:39], v61, s[4:7], s23 offen offset:1024 sc1
    v_smfmac_f32_16x16x64_bf16 v[20:23], v[28:31], v[88:95], v60
    s_add_u32 s17, s41, s31
    s_and_b32 s30, s28, 1
    s_waitcnt lgkmcnt(3)
    v_smfmac_f32_16x16x64_bf16 v[0:3], v[52:55], a[64:71], v60
    ds_read_b128 v[28:31], v78 offset:8704
    v_smfmac_f32_16x16x64_bf16 v[4:7], v[52:55], a[144:151], v60
    buffer_load_dwordx4 v[40:43], v61, s[4:7], s23 offen offset:2048 sc1
    v_smfmac_f32_16x16x64_bf16 v[8:11], v[52:55], a[72:79], v60
    v_smfmac_f32_16x16x64_bf16 v[12:15], v[52:55], a[152:159], v60
    v_smfmac_f32_16x16x64_bf16 v[16:19], v[52:55], v[96:103], v60
    buffer_load_dwordx4 v[44:47], v61, s[4:7], s23 offen offset:3072 sc1
    v_smfmac_f32_16x16x64_bf16 v[20:23], v[52:55], v[104:111], v60
    ds_read_b128 v[52:55], v62 offset:28672
    s_waitcnt lgkmcnt(3)
    v_smfmac_f32_16x16x64_bf16 v[0:3], v[48:51], a[80:87], v60
    v_smfmac_f32_16x16x64_bf16 v[4:7], v[48:51], a[160:167], v60
    v_smfmac_f32_16x16x64_bf16 v[8:11], v[48:51], a[88:95], v60
    v_smfmac_f32_16x16x64_bf16 v[12:15], v[48:51], a[168:175], v60
    v_smfmac_f32_16x16x64_bf16 v[16:19], v[48:51], v[112:119], v60
    buffer_load_dword v79, s[4:7], s24 offen sc1 lds
    v_smfmac_f32_16x16x64_bf16 v[20:23], v[48:51], v[120:127], v60
    ds_read_b128 v[48:51], v62 offset:24576
    v_smfmac_f32_16x16x64_bf16 v[0:3], v[56:59], a[96:103], v60
    s_cmp_ge_u32 s28, 62
    v_smfmac_f32_16x16x64_bf16 v[8:11], v[56:59], a[104:111], v60
    s_waitcnt lgkmcnt(3)
    v_smfmac_f32_16x16x64_bf16 v[0:3], v[24:27], a[112:119], v60
    v_smfmac_f32_16x16x64_bf16 v[8:11], v[24:27], a[120:127], v60
    v_smfmac_f32_16x16x64_bf16 v[4:7], v[56:59], a[176:183], v60
    s_waitcnt lgkmcnt(0)
    v_cvt_pk_bf16_f32 v0, v0, v1
    v_smfmac_f32_16x16x64_bf16 v[4:7], v[24:27], v[48:55], v60
    ds_read_b128 v[48:51], v62 offset:32768
    v_cvt_pk_bf16_f32 v8, v8, v9
    v_smfmac_f32_16x16x64_bf16 v[12:15], v[56:59], a[184:191], v60
    ds_read_b128 v[52:55], v62 offset:36864
    v_cvt_pk_bf16_f32 v9, v10, v11
    v_smfmac_f32_16x16x64_bf16 v[16:19], v[56:59], v[128:135], v60
    v_cvt_pk_bf16_f32 v1, v2, v3
    v_mfma_f32_16x16x16_bf16 v[8:11], v[8:9], v[28:29], 0
    v_cvt_pk_bf16_f32 v2, v4, v5
    v_cvt_pk_bf16_f32 v3, v6, v7
    v_smfmac_f32_16x16x64_bf16 v[20:23], v[56:59], v[136:143], v60
    s_mov_b64 exec, s[36:37]
    ds_read_b128 v[56:59], v69
    s_mov_b64 exec, -1
    v_mfma_f32_16x16x32_bf16 v[4:7], v[0:3], v[28:31], 0
    v_cvt_pk_bf16_f32 v2, v8, v9
    s_waitcnt lgkmcnt(1)
    v_smfmac_f32_16x16x64_bf16 v[12:15], v[24:27], v[48:55], v60
    ds_read_b128 v[48:51], v63 offset:0
    v_cvt_pk_bf16_f32 v3, v10, v11
    s_waitcnt vmcnt(3)
    v_cvt_pk_bf16_f32 v0, v4, v5
    v_cvt_pk_bf16_f32 v1, v6, v7
    s_nop 1
    v_mfma_f32_16x16x32_bf16 v[4:7], v[36:39], v[0:3], 0
    v_cvt_pk_bf16_f32 v12, v12, v13
    v_cvt_pk_bf16_f32 v13, v14, v15
    s_nop 1
    v_mfma_f32_16x16x16_bf16 v[12:15], v[12:13], v[30:31], 0
    ds_read_b128 v[52:55], v71 offset:0
    ds_read_b128 v[36:39], v63 offset:53248
    v_mfma_f32_16x16x32_bf16 v[28:31], v[32:35], v[0:3], 0
    s_waitcnt vmcnt(1)
    ds_read_b128 v[32:35], v63 offset:49152
    s_mov_b64 exec, s[34:35]
    s_nop 0
    v_cvt_pk_bf16_f32 v2, v12, v13
    v_cvt_pk_bf16_f32 v3, v14, v15
    s_mov_b64 exec, -1
    s_nop 0
    v_mfma_f32_16x16x32_bf16 v[8:11], v[0:3], v[0:3], 0
    v_mov_b32_dpp v28, v4 row_ror:8 row_mask:0xf bank_mask:0xc
    v_mov_b32_dpp v29, v5 row_ror:8 row_mask:0xf bank_mask:0xc
    v_mov_b32_dpp v30, v6 row_ror:8 row_mask:0xf bank_mask:0xc
    v_mov_b32_dpp v31, v7 row_ror:8 row_mask:0xf bank_mask:0xc
    v_smfmac_f32_16x16x64_bf16 v[16:19], v[24:27], v[144:151], v60
    ds_write_b128 v62, v[28:31] offset:53248
    v_mov_b32_dpp v8, v10 row_ror:8 row_mask:0xf bank_mask:0xc
    v_mov_b32_dpp v9, v11 row_ror:8 row_mask:0xf bank_mask:0xc
    v_smfmac_f32_16x16x64_bf16 v[20:23], v[24:27], v[152:159], v60
    ds_write_b64 v70, v[8:9]
    s_waitcnt lgkmcnt(5)
    v_smfmac_f32_16x16x64_bf16 v[16:19], v[48:51], a[208:215], v60
    s_mov_b64 exec, s[36:37]
    buffer_store_dwordx4 v[56:59], v61, s[4:7], s65 offen sc1
    s_mov_b64 exec, -1
    v_smfmac_f32_16x16x64_bf16 v[20:23], v[48:51], a[216:223], v60
    s_cbranch_scc1 cf_last
cf_back:
    s_waitcnt lgkmcnt(0)
    s_barrier
    ds_read_b128 v[56:59], v78 offset:10752
    v_smfmac_f32_16x16x64_bf16 v[16:19], v[52:55], a[240:247], v60
    ds_read_b128 v[12:15], v78 offset:11264
    ds_read_b128 v[4:7], v63 offset:12288
    v_smfmac_f32_16x16x64_bf16 v[20:23], v[52:55], a[248:255], v60
    ds_read_b128 v[8:11], v64 offset:12288
    ds_read_b128 v[0:3], v71 offset:12288
    v_mov_b64 v[24:25], s[62:63]
    v_mov_b64 v[26:27], s[60:61]
    v_cvt_pk_bf16_f32 v16, v16, v17
    v_cvt_pk_bf16_f32 v17, v18, v19
    v_pk_mul_f32 v[28:29], v[28:29], s[44:45]
    v_pk_mul_f32 v[30:31], v[30:31], s[44:45]
    s_waitcnt lgkmcnt(3)
    v_pk_add_f32 v[56:57], v[56:57], v[58:59]
    v_pk_add_f32 v[12:13], v[12:13], v[14:15]
    v_pk_add_f32 v[56:57], v[56:57], v[12:13]
    v_pk_mul_f32 v[56:57], v[56:57], s[44:45]
    v_exp_f32 v58, v56
    v_exp_f32 v59, v57
    s_waitcnt lgkmcnt(1)
    v_pk_fma_f32 v[28:29], v[4:5], s[44:45], v[28:29]
    v_pk_fma_f32 v[30:31], v[6:7], s[44:45], v[30:31]
    v_cvt_pk_bf16_f32 v6, v58, v59
    v_pk_fma_f32 v[28:29], v[8:9], s[44:45], v[28:29]
    v_pk_fma_f32 v[30:31], v[10:11], s[44:45], v[30:31]
    s_waitcnt lgkmcnt(0)
    v_pk_fma_f32 v[28:29], v[0:1], s[44:45], v[28:29]
    v_mov_b32_dpp v7, v6 row_ror:8 row_mask:0xf bank_mask:0xf
    v_pk_fma_f32 v[30:31], v[2:3], s[44:45], v[30:31]
    v_exp_f32 v0, v28
    v_mfma_f32_16x16x16_bf16 v[12:15], v[16:17], v[6:7], 0
    ds_read_b128 v[48:51], v63 offset:57344
    v_exp_f32 v1, v29
    v_cvt_pk_bf16_f32 v18, v20, v21
    v_exp_f32 v2, v30
    v_cvt_pk_bf16_f32 v19, v22, v23
    v_cvt_pk_bf16_f32 v8, v0, v1
    v_exp_f32 v3, v31
    v_mfma_f32_16x16x16_bf16 v[20:23], v[18:19], v[6:7], 0
    ds_read_b128 v[52:55], v63 offset:61440
    v_cvt_pk_bf16_f32 v9, v2, v3
    v_mov_b32_dpp v10, v8 row_ror:8 row_mask:0xf bank_mask:0xf
    v_max3_f32 v4, |v28|, |v29|, |v30|
    v_mov_b32_dpp v11, v9 row_ror:8 row_mask:0xf bank_mask:0xf
    v_mfma_f32_16x16x32_bf16 v[0:3], v[24:27], v[6:9], 0
    v_max3_f32 v4, v4, |v31|, |v56|
    v_max_f32_e64 v4, v4, |v57|
    v_mfma_f32_16x16x32_bf16 v[12:15], v[40:43], v[8:11], v[12:15]
    v_cmp_nge_f32 vcc, s46, v4
    v_mfma_f32_16x16x32_bf16 v[20:23], v[44:47], v[8:11], v[20:23]
    v_add_f32_dpp v0, v0, v0 row_ror:8 row_mask:0xf bank_mask:0xf
    v_rcp_f32 v0, v0
    s_cbranch_vccnz cf_guard
cf_norm:
    v_mfma_f32_16x16x16_bf16 v[28:31], v[72:73], v[72:73], 0
    v_mul_f32 v12, v12, v0
    v_mul_f32 v13, v13, v0
    v_mul_f32 v14, v14, v0
    v_mul_f32 v15, v15, v0
    v_mul_f32_dpp v12, v20, v0 row_ror:8 row_mask:0xf bank_mask:0xc
    v_mul_f32_dpp v13, v21, v0 row_ror:8 row_mask:0xf bank_mask:0xc
    v_mul_f32_dpp v14, v22, v0 row_ror:8 row_mask:0xf bank_mask:0xc
    v_mul_f32_dpp v15, v23, v0 row_ror:8 row_mask:0xf bank_mask:0xc
    v_cvt_pk_bf16_f32 v12, v12, v13
    v_cvt_pk_bf16_f32 v13, v14, v15
    v_mfma_f32_16x16x16_bf16 v[8:11], v[72:73], v[72:73], 0
    ds_write_b64 v77, v[12:13]
    v_mfma_f32_16x16x16_bf16 v[4:7], v[72:73], v[72:73], 0
    ds_read_b128 v[0:3], v68
    v_mfma_f32_16x16x16_bf16 v[16:19], v[72:73], v[72:73], 0
    ds_read_b128 v[40:43], v63 offset:16384
    v_mfma_f32_16x16x16_bf16 v[20:23], v[72:73], v[72:73], 0
    ds_read_b128 v[44:47], v63 offset:20480
    s_waitcnt lgkmcnt(3)
    s_barrier
    ds_read_b128 v[24:27], v74
    ds_read_b128 v[12:15], v75
    ds_read_b128 v[56:59], v76
    s_waitcnt lgkmcnt(5)
    v_smfmac_f32_16x16x64_bf16 v[28:31], v[0:3], v[160:167], v60
    v_smfmac_f32_16x16x64_bf16 v[8:11], v[0:3], v[192:199], v60
    v_smfmac_f32_16x16x64_bf16 v[4:7], v[0:3], v[32:39], v60
    ds_read_b128 v[32:35], v63 offset:32768
    v_smfmac_f32_16x16x64_bf16 v[16:19], v[0:3], v[224:231], v60
    ds_read_b128 v[36:39], v63 offset:36864
    s_waitcnt lgkmcnt(3)
    v_smfmac_f32_16x16x64_bf16 v[28:31], v[24:27], v[168:175], v60
    v_smfmac_f32_16x16x64_bf16 v[4:7], v[12:15], v[48:55], v60
    ds_read_b128 v[48:51], v63 offset:24576
    v_smfmac_f32_16x16x64_bf16 v[28:31], v[12:15], v[176:183], v60
    ds_read_b128 v[52:55], v63 offset:28672
    s_waitcnt lgkmcnt(4)
    v_smfmac_f32_16x16x64_bf16 v[28:31], v[56:59], v[184:191], v60
    v_cvt_pk_bf16_f32 v4, v4, v5
    v_smfmac_f32_16x16x64_bf16 v[16:19], v[12:15], v[40:47], v60
    ds_read_b128 v[40:43], v63 offset:40960
    v_and_or_b32 v4, v4, -2, s30
    v_smfmac_f32_16x16x64_bf16 v[8:11], v[24:27], v[200:207], v60
    ds_read_b128 v[44:47], v63 offset:45056
    v_cvt_pk_bf16_f32 v5, v6, v7
    v_smfmac_f32_16x16x64_bf16 v[8:11], v[12:15], v[208:215], v60
    buffer_store_dwordx2 v[4:5], v67, s[4:7], s22 offen
    v_cvt_pk_bf16_f32 v28, v28, v29
    v_smfmac_f32_16x16x64_bf16 v[8:11], v[56:59], v[216:223], v60
    v_and_or_b32 v28, v28, -2, s30
    v_smfmac_f32_16x16x64_bf16 v[16:19], v[24:27], v[232:239], v60
    v_cvt_pk_bf16_f32 v29, v30, v31
    s_waitcnt lgkmcnt(4)
    v_smfmac_f32_16x16x64_bf16 v[16:19], v[56:59], v[32:39], v60
    buffer_store_dwordx2 v[28:29], v66, s[4:7], s20 offen
    v_cvt_pk_bf16_f32 v8, v8, v9
    s_waitcnt lgkmcnt(0)
    v_smfmac_f32_16x16x64_bf16 v[20:23], v[0:3], v[240:247], v60
    v_and_or_b32 v8, v8, -2, s30
    v_smfmac_f32_16x16x64_bf16 v[20:23], v[24:27], v[248:255], v60
    v_cvt_pk_bf16_f32 v9, v10, v11
    v_smfmac_f32_16x16x64_bf16 v[20:23], v[12:15], v[48:55], v60
    buffer_store_dwordx2 v[8:9], v66, s[4:7], s21 offen
    v_cvt_pk_bf16_f32 v16, v16, v17
    v_smfmac_f32_16x16x64_bf16 v[20:23], v[56:59], v[40:47], v60
    v_and_or_b32 v16, v16, -2, s30
    v_cvt_pk_bf16_f32 v17, v18, v19
    buffer_store_dwordx2 v[16:17], v66, s[4:7], s38 offen
    s_cmp_lg_u32 s13, 2
    s_nop 1
    v_cvt_pk_bf16_f32 v20, v20, v21
    v_and_or_b32 v20, v20, -2, s30
    v_cvt_pk_bf16_f32 v21, v22, v23
    buffer_store_dwordx2 v[20:21], v66, s[4:7], s39 offen
    s_cbranch_scc1 cf_w013
    s_nop 15
    s_nop 15
    s_nop 15
    s_nop 15
    s_nop 7
    buffer_load_dwordx4 v[40:43], v65, s[4:7], s19 offen offset:0 nt
    buffer_load_dwordx4 v[44:47], v65, s[4:7], s19 offen offset:1024 nt
    buffer_load_dwordx4 v[48:51], v65, s[4:7], s19 offen offset:2048 nt
    buffer_load_dwordx4 v[52:55], v65, s[4:7], s19 offen offset:3072 nt
    ds_read_b128 v[56:59], v65 offset:10240
    s_add_u32 s28, s28, 1
    s_mov_b32 s14, s41
    s_add_u32 s23, s23, 524288
    s_add_u32 s24, s24, 524288
    s_min_u32 s24, s24, s47
    s_add_u32 s15, s14, 4096
    s_add_u32 s16, s14, 8192
    v_mov_b32 v21, -1
    s_add_u32 s65, s65, 12288
    s_mov_b32 s40, 1
    v_mov_b64 v[0:1], 0
    v_mov_b64 v[2:3], 0
    v_mov_b64 v[4:5], 0
    v_mov_b64 v[6:7], 0
    v_mov_b64 v[8:9], 0
    v_mov_b64 v[10:11], 0
    v_mov_b64 v[12:13], 0
    v_mov_b64 v[14:15], 0
cf_chkF:
    v_mov_b32 v20, 0
    s_waitcnt vmcnt(3)
    s_waitcnt lgkmcnt(0)
    v_mfma_f32_16x16x32_bf16 v[28:31], v[40:43], v[56:59], 0
    v_bitop3_b32 v20, v20, v40, s30 bitop3:0xf6
    v_bitop3_b32 v20, v20, v42, s30 bitop3:0xf6
    s_waitcnt vmcnt(2)
    v_mfma_f32_16x16x32_bf16 v[28:31], v[44:47], v[56:59], v[28:31]
    v_bitop3_b32 v20, v20, v44, s30 bitop3:0xf6
    v_bitop3_b32 v20, v20, v46, s30 bitop3:0xf6
    s_waitcnt vmcnt(1)
    v_mfma_f32_16x16x32_bf16 v[28:31], v[48:51], v[56:59], v[28:31]
    v_bitop3_b32 v20, v20, v48, s30 bitop3:0xf6
    v_bitop3_b32 v20, v20, v50, s30 bitop3:0xf6
    s_waitcnt vmcnt(0)
    v_mfma_f32_16x16x32_bf16 v[28:31], v[52:55], v[56:59], v[28:31]
    v_bitop3_b32 v20, v20, v52, s30 bitop3:0xf6
    v_bitop3_b32 v20, v20, v54, s30 bitop3:0xf6
    v_and_b32 v20, s40, v20
    v_cmp_ne_u32 vcc, 0, v20
    s_cbranch_vccnz cf_spinF
    v_permlane32_swap_b32 v28, v30
    v_permlane32_swap_b32 v29, v31
    v_add_f32 v28, v28, v30
    v_add_f32 v30, v29, v31
    v_cvt_pk_bf16_f32 v28, v28, v30
    s_mov_b64 exec, s[32:33]
    buffer_store_dword v28, v69, s[4:7], s17 offen
    buffer_store_dword v21, v69, s[4:7], s18 offen
    s_mov_b64 exec, -1
    ds_read_b128 v[32:35], v62 offset:16384
    ds_read_b128 v[36:39], v62 offset:20480
    ds_read_b128 v[40:43], v61 offset:0
    ds_read_b128 v[44:47], v61 offset:4096
    ds_read_b128 v[48:51], v61 offset:8192
    ds_read_b128 v[52:55], v61 offset:12288
    s_nop 14
    buffer_load_dwordx4 v[24:27], v61, s[4:7], s14 offen nt
    s_branch cf_loop2
cf_w013:
    ds_read_b128 v[56:59], v65 offset:10240
    ds_read_b128 v[32:35], v62 offset:16384
    ds_read_b128 v[36:39], v62 offset:20480
    ds_read_b128 v[40:43], v61 offset:0
    ds_read_b128 v[44:47], v61 offset:4096
    ds_read_b128 v[48:51], v61 offset:8192
    ds_read_b128 v[52:55], v61 offset:12288
    s_add_u32 s28, s28, 1
    s_mov_b32 s14, s41
    s_add_u32 s23, s23, 524288
    s_add_u32 s24, s24, 524288
    s_min_u32 s24, s24, s47
    s_add_u32 s15, s14, 4096
    s_add_u32 s16, s14, 8192
    v_mov_b32 v21, -1
    s_add_u32 s65, s65, 12288
    s_mov_b32 s40, 1
    s_cmp_eq_u32 s64, 0
    s_cbranch_scc1 cf_w0
    s_cmp_eq_u32 s13, 1
    s_nop 15
    s_nop 15
    s_nop 7
    s_cbranch_scc1 cf_sx
    s_nop 15
    s_nop 13
cf_sx:
    buffer_load_dwordx4 v[0:3], v65, s[4:7], s19 offen offset:0 nt
    buffer_load_dwordx4 v[4:7], v65, s[4:7], s19 offen offset:1024 nt
    buffer_load_dwordx4 v[8:11], v65, s[4:7], s19 offen offset:2048 nt
    buffer_load_dwordx4 v[12:15], v65, s[4:7], s19 offen offset:3072 nt
cf_chkG:
    v_mov_b32 v20, 0
    s_waitcnt vmcnt(3)
    s_waitcnt lgkmcnt(6)
    v_mfma_f32_16x16x32_bf16 v[28:31], v[0:3], v[56:59], 0
    v_bitop3_b32 v20, v20, v0, s30 bitop3:0xf6
    v_bitop3_b32 v20, v20, v2, s30 bitop3:0xf6
    s_waitcnt vmcnt(2)
    v_mfma_f32_16x16x32_bf16 v[28:31], v[4:7], v[56:59], v[28:31]
    v_bitop3_b32 v20, v20, v4, s30 bitop3:0xf6
    v_bitop3_b32 v20, v20, v6, s30 bitop3:0xf6
    s_waitcnt vmcnt(1)
    v_mfma_f32_16x16x32_bf16 v[28:31], v[8:11], v[56:59], v[28:31]
    v_bitop3_b32 v20, v20, v8, s30 bitop3:0xf6
    v_bitop3_b32 v20, v20, v10, s30 bitop3:0xf6
    s_waitcnt vmcnt(0)
    v_mfma_f32_16x16x32_bf16 v[28:31], v[12:15], v[56:59], v[28:31]
    v_bitop3_b32 v20, v20, v12, s30 bitop3:0xf6
    v_bitop3_b32 v20, v20, v14, s30 bitop3:0xf6
    v_and_b32 v20, s40, v20
    v_cmp_ne_u32 vcc, 0, v20
    s_cbranch_vccnz cf_spinG
    v_permlane32_swap_b32 v28, v30
    v_permlane32_swap_b32 v29, v31
    v_add_f32 v28, v28, v30
    v_add_f32 v30, v29, v31
    s_cmp_eq_u32 s13, 3
    s_cbranch_scc1 cf_w3
    v_mov_b32 v29, v28
    v_mov_b32 v31, v30
    s_nop 0
    v_permlane16_swap_b32 v28, v29
    v_permlane16_swap_b32 v30, v31
    v_add_f32 v28, v28, v29
    v_add_f32 v30, v30, v31
cf_w3:
    v_cvt_pk_bf16_f32 v28, v28, v30
    s_mov_b64 exec, s[32:33]
    buffer_store_dword v28, v69, s[4:7], s17 offen
    buffer_store_dword v21, v69, s[4:7], s18 offen
    s_mov_b64 exec, -1
    buffer_load_dwordx4 v[24:27], v61, s[4:7], s14 offen nt
    s_branch cf_loop
cf_w0:
    v_mov_b64 v[0:1], 0
    v_mov_b64 v[2:3], 0
    v_mov_b64 v[4:5], 0
    v_mov_b64 v[6:7], 0
    v_mov_b64 v[8:9], 0
    v_mov_b64 v[10:11], 0
    v_mov_b64 v[12:13], 0
    v_mov_b64 v[14:15], 0
    s_cmp_lg_u32 s28, 10
    s_cbranch_scc1 cf_nokv
    s_lshr_b32 s92, s12, 1
    s_lshl_b32 s92, s92, 8
    s_add_u32 s92, s92, 125829120
    v_bfe_u32 v28, v61, 4, 6
    v_min_u32 v28, 11, v28
    v_lshlrev_b32 v28, 2, v28
    s_add_u32 s93, s95, 63
    s_mov_b32 s94, 4194304
cf_kv1:
    buffer_load_dword v29, v28, s[4:7], s92 offen sc1
    s_sub_u32 s94, s94, 1
    s_cbranch_scc1 cf_kv1_go
    s_waitcnt vmcnt(0)
    v_subrev_u32 v29, s93, v29
    v_cmp_lt_u32 vcc, 64, v29
    s_cbranch_vccz cf_kv1_go
    s_sleep 2
    s_branch cf_kv1
cf_kv1_go:
cf_nokv:
    s_nop 15
    s_nop 15
    s_nop 15
    s_nop 15
    s_nop 15
    s_nop 15
    s_nop 15
    s_nop 15
    s_nop 15
    s_nop 15
    s_nop 7
    buffer_load_dwordx4 v[24:27], v61, s[4:7], s14 offen nt
    s_branch cf_loop2
cf_spinF:
    buffer_load_dwordx4 v[40:43], v65, s[4:7], s19 offen offset:0 nt
    buffer_load_dwordx4 v[44:47], v65, s[4:7], s19 offen offset:1024 nt
    buffer_load_dwordx4 v[48:51], v65, s[4:7], s19 offen offset:2048 nt
    buffer_load_dwordx4 v[52:55], v65, s[4:7], s19 offen offset:3072 nt
    s_sub_u32 s29, s29, 1
    s_cmp_lt_i32 s29, 0
    s_cselect_b32 s40, 0, 1
    s_branch cf_chkF
cf_spinG:
    buffer_load_dwordx4 v[0:3], v65, s[4:7], s19 offen offset:0 nt
    buffer_load_dwordx4 v[4:7], v65, s[4:7], s19 offen offset:1024 nt
    buffer_load_dwordx4 v[8:11], v65, s[4:7], s19 offen offset:2048 nt
    buffer_load_dwordx4 v[12:15], v65, s[4:7], s19 offen offset:3072 nt
    s_sub_u32 s29, s29, 1
    s_cmp_lt_i32 s29, 0
    s_cselect_b32 s40, 0, 1
    s_branch cf_chkG
cf_guard:
    s_cbranch_scc0 cf_guard2
    buffer_store_dwordx4 v[16:19], v61, s[4:7], s26 offen sc1
    s_add_u32 s26, s26, 131072
    s_add_u32 s40, s95, 63
    v_mov_b32 v5, s40
    s_mov_b64 exec, 1
    buffer_store_dword v5, off, s[4:7], s27 sc1
    s_mov_b64 exec, -1
cf_guard2:
    s_nop 7
    v_max3_f32 v6, v28, v29, v30
    v_max3_f32 v7, v31, v56, v57
    v_max_f32 v6, v6, v7
    s_nop 1
    v_max_f32_dpp v6, v6, v6 row_ror:8 row_mask:0xf bank_mask:0xf
    v_mov_b32 v7, v6
    s_nop 1
    v_permlane32_swap_b32 v6, v7
    v_max_f32 v6, v6, v7
    v_mov_b32 v7, v6
    s_nop 1
    v_permlane16_swap_b32 v6, v7
    v_max_f32 v6, v6, v7
    v_sub_f32 v28, v28, v6
    v_sub_f32 v29, v29, v6
    v_sub_f32 v30, v30, v6
    v_sub_f32 v31, v31, v6
    v_sub_f32 v56, v56, v6
    v_sub_f32 v57, v57, v6
    v_exp_f32 v58, v56
    v_exp_f32 v59, v57
    s_nop 0
    v_cvt_pk_bf16_f32 v6, v58, v59
    s_nop 1
    v_mov_b32_dpp v7, v6 row_ror:8 row_mask:0xf bank_mask:0xf
    v_exp_f32 v0, v28
    s_nop 0
    v_mfma_f32_16x16x16_bf16 v[12:15], v[16:17], v[6:7], 0
    v_exp_f32 v1, v29
    v_exp_f32 v2, v30
    v_cvt_pk_bf16_f32 v8, v0, v1
    v_exp_f32 v3, v31
    v_mfma_f32_16x16x16_bf16 v[20:23], v[18:19], v[6:7], 0
    v_cvt_pk_bf16_f32 v9, v2, v3
    v_mov_b32_dpp v10, v8 row_ror:8 row_mask:0xf bank_mask:0xf
    v_max3_f32 v4, |v28|, |v29|, |v30|
    v_mov_b32_dpp v11, v9 row_ror:8 row_mask:0xf bank_mask:0xf
    v_mfma_f32_16x16x32_bf16 v[0:3], v[24:27], v[6:9], 0
    v_max3_f32 v4, v4, |v31|, |v56|
    v_max_f32_e64 v4, v4, |v57|
    v_mfma_f32_16x16x32_bf16 v[12:15], v[40:43], v[8:11], v[12:15]
    v_cmp_nge_f32 vcc, s46, v4
    v_mfma_f32_16x16x32_bf16 v[20:23], v[44:47], v[8:11], v[20:23]
    v_add_f32_dpp v0, v0, v0 row_ror:8 row_mask:0xf bank_mask:0xf
    v_rcp_f32 v0, v0
    s_nop 4
    s_branch cf_norm
cf_spin0:
    buffer_load_dwordx4 v[24:27], v61, s[4:7], s14 offen nt
    s_sub_u32 s29, s29, 1
    s_cmp_lt_i32 s29, 0
    s_cbranch_scc0 cf_chk0
    s_waitcnt vmcnt(0)
    v_min_u32 v24, -2, v24
    v_min_u32 v25, -2, v25
    v_min_u32 v26, -2, v26
    v_min_u32 v27, -2, v27
    s_branch cf_chk0
cf_spin1:
    buffer_load_dwordx4 v[28:31], v61, s[4:7], s15 offen nt
    buffer_load_dword v59, v56, s[4:7], s16 offen nt
    s_sub_u32 s29, s29, 1
    s_cmp_lt_i32 s29, 0
    s_waitcnt vmcnt(0)
    v_max3_u32 v57, v28, v29, v30
    v_max3_u32 v57, v57, v31, v59
    v_cmp_eq_u32 vcc, -1, v57
    ds_write_b128 v62, v[28:31] offset:45056
    ds_write_b32 v58, v59
    s_waitcnt lgkmcnt(0)
    s_cbranch_scc1 cf_go1
    s_cbranch_vccnz cf_spin1
    s_branch cf_go1
cf_last:
    s_nop 1
    s_cmp_eq_u32 s28, 63
    s_cbranch_scc1 cf_last2
    s_mov_b64 exec, s[34:35]
    buffer_store_dwordx4 v[0:3], v61, s[4:7], s25 offen sc1
    s_mov_b64 exec, -1
    s_add_u32 s25, s25, 131072
    s_mov_b32 s46, 0xbf800000
    s_cmp_eq_u32 0, 0
    s_branch cf_back
cf_last2:
    s_waitcnt lgkmcnt(0)
    s_mov_b64 exec, s[34:35]
    buffer_store_dwordx4 v[0:3], v61, s[4:7], s25 offen sc1
    s_mov_b64 exec, -1
    s_add_u32 s40, s95, 64
    v_mov_b32 v40, s40
    v_smfmac_f32_16x16x64_bf16 v[16:19], v[52:55], a[240:247], v60
    v_smfmac_f32_16x16x64_bf16 v[20:23], v[52:55], a[248:255], v60
    s_nop 3
    v_cvt_pk_bf16_f32 v16, v16, v17
    v_cvt_pk_bf16_f32 v17, v18, v19
    s_nop 1
    v_cvt_pk_bf16_f32 v18, v20, v21
    v_cvt_pk_bf16_f32 v19, v22, v23
    buffer_store_dwordx4 v[16:19], v61, s[4:7], s26 offen sc1
    s_mov_b64 exec, 1
    buffer_store_dword v40, off, s[4:7], s27 sc1
    s_mov_b64 exec, -1
    s_endpgm
cf_dma:
    s_xor_b32 s74, s76, s81
    s_add_u32 m0, s74, s80
    s_add_u32 s76, s76, 4096
    buffer_load_dwordx4 v58, s[8:11], s78 offen lds
    s_add_u32 s78, s78, s79
    s_cmp_lt_u32 s76, s77
    s_cbranch_scc1 cf_dma
    s_setpc_b64 s[82:83]
L_chain_safe:
    s_mov_b64 s[48:49], s[50:51]
    s_mov_b64 s[50:51], s[52:53]
    s_mov_b64 s[52:53], s[54:55]
    s_mov_b64 s[54:55], s[56:57]
    s_mov_b64 s[56:57], s[58:59]
    v_lshrrev_b32 v54, 6, v0
    s_nop 0
    v_readfirstlane_b32 s13, v54
    v_and_b32 v57, 63, v0
    v_bfe_u32 v54, v57, 2, 1
    v_lshlrev_b32 v48, 13, v54
    v_bfe_u32 v54, v57, 3, 1
    v_lshl_add_u32 v48, v54, 15, v48
    v_bfe_u32 v54, v57, 4, 1
    v_lshl_add_u32 v48, v54, 14, v48
    v_bfe_u32 v54, v57, 5, 1
    v_lshl_add_u32 v48, v54, 16, v48
    v_lshrrev_b32 v55, 4, v57
    v_and_b32 v55, 2, v55
    v_xor_b32 v55, v55, v57
    v_and_b32 v55, 3, v55
    v_lshl_add_u32 v48, v55, 4, v48
    v_bfe_u32 v54, v57, 2, 1
    v_lshlrev_b32 v51, 6, v54
    v_bfe_u32 v54, v57, 3, 1
    v_lshl_add_u32 v51, v54, 9, v51
    v_bfe_u32 v54, v57, 4, 1
    v_lshl_add_u32 v51, v54, 7, v51
    v_bfe_u32 v54, v57, 5, 1
    v_lshl_add_u32 v51, v54, 12, v51
    v_bfe_u32 v54, v57, 0, 1
    v_lshl_add_u32 v51, v54, 3, v51
    v_bfe_u32 v54, v57, 1, 1
    v_lshl_add_u32 v51, v54, 4, v51
    v_bfe_u32 v54, v57, 3, 1
    v_lshl_add_u32 v51, v54, 5, v51
    v_lshrrev_b32 v55, 3, v57
    v_mul_u32_u24 v49, 1152, v55
    v_and_b32 v55, 7, v57
    v_lshl_add_u32 v49, v55, 4, v49
    v_bfe_u32 v54, v57, 4, 1
    v_lshlrev_b32 v52, 13, v54
    v_bfe_u32 v54, v57, 5, 1
    v_lshl_add_u32 v52, v54, 9, v52
    v_bfe_u32 v54, v57, 2, 1
    v_lshl_add_u32 v52, v54, 7, v52
    v_bfe_u32 v54, v57, 3, 1
    v_lshl_add_u32 v52, v54, 5, v52
    v_and_b32 v55, 3, v57
    v_lshl_add_u32 v52, v55, 3, v52
    v_lshrrev_b32 v55, 2, v57
    v_mul_u32_u24 v50, 1152, v55
    v_and_b32 v55, 3, v57
    v_lshl_add_u32 v50, v55, 4, v50
    v_bfe_u32 v54, v57, 4, 1
    v_lshlrev_b32 v53, 12, v54
    v_bfe_u32 v54, v57, 5, 1
    v_lshl_add_u32 v53, v54, 8, v53
    v_bfe_u32 v54, v57, 2, 1
    v_lshl_add_u32 v53, v54, 6, v53
    v_bfe_u32 v54, v57, 3, 1
    v_lshl_add_u32 v53, v54, 5, v53
    v_and_b32 v55, 3, v57
    v_lshl_add_u32 v53, v55, 3, v53
    s_lshl_b32 s66, s13, 10
    s_and_b32 s93, s13, 1
    s_lshl_b32 s93, s93, 14
    s_and_b32 s75, s13, 2
    s_lshl_b32 s75, s75, 19
    v_add_u32 v51, s66, v51
    v_add_u32 v52, s66, v52
    v_add_u32 v53, s66, v53
    v_mov_b32 v58, v48
    s_mov_b32 s10, 4718592
    s_mov_b32 s11, 0x20000
    s_lshl_b32 s67, s12, 8
    s_lshl_b32 s40, s13, 6
    s_add_u32 s67, s67, s40
    s_mul_i32 s92, s12, 147456
    s_lshr_b32 s73, s50, 8
    s_add_u32 s73, s73, s12
    s_and_b32 s73, s73, 31
    s_bitcmp1_b32 0xa2222222, s73
    s_cselect_b32 s88, 0, 0
    s_mov_b32 s72, 0
    s_add_u32 s73, s73, 1
    s_lshr_b32 s73, s73, 2
    s_xor_b32 s94, s13, 0
    s_mul_i32 s94, s94, 36864
    s_add_u32 s94, s94, s92
    s_lshl_b32 s74, s13, 7
    s_add_u32 s94, s94, s74
    s_add_u32 s78, s94, 0
    s_mov_b64 s[8:9], s[56:57]
    v_mov_b32 v58, v49
    s_mov_b32 s79, 9216
    s_mov_b32 s81, 0
    s_add_u32 s80, s66, 114688
    s_mov_b32 s76, 0
    s_mov_b32 s77, 8192
    s_call_b64 s[82:83], cs_dma
    s_mov_b32 s77, 16384
    s_call_b64 s[82:83], cs_dma
    s_xor_b32 s94, s13, 1
    s_mul_i32 s94, s94, 36864
    s_add_u32 s94, s94, s92
    s_lshl_b32 s74, s13, 7
    s_add_u32 s94, s94, s74
    s_add_u32 s78, s94, 0
    s_add_u32 s80, s66, 81920
    s_mov_b32 s76, 0
    s_mov_b32 s77, 8192
    s_call_b64 s[82:83], cs_dma
    s_mov_b32 s77, 16384
    s_call_b64 s[82:83], cs_dma
    s_xor_b32 s94, s13, 2
    s_mul_i32 s94, s94, 36864
    s_add_u32 s94, s94, s92
    s_lshl_b32 s74, s13, 7
    s_add_u32 s94, s94, s74
    s_add_u32 s78, s94, 0
    s_add_u32 s80, s66, 16384
    s_mov_b32 s76, 0
    s_mov_b32 s77, 8192
    s_call_b64 s[82:83], cs_dma
    v_lshrrev_b32 v24, 6, v0
    v_lshlrev_b32 v61, 4, v0
    v_add_u32 v62, 57344, v61
    v_xor_b32 v63, 1024, v61
    v_add_u32 v63, 98304, v63
    v_xor_b32 v64, 2048, v61
    v_add_u32 v64, 98304, v64
    v_and_b32 v65, 1023, v61
    v_add_u32 v65, 98304, v65
    v_and_b32 v26, 15, v0
    v_bfe_u32 v27, v0, 4, 2
    v_mov_b32 v60, 0x4444
    v_mov_b32 v25, 0xeeee
    v_cmp_lt_u32 vcc, 7, v26
    s_nop 1
    v_cndmask_b32 v60, v60, v25, vcc
    s_mov_b32 s77, 16384
    s_call_b64 s[82:83], cs_dma
    v_and_b32 v67, 12, v26
    v_lshlrev_b32 v67, 3, v67
    v_and_b32 v25, 1, v26
    v_lshl_add_u32 v67, v25, 4, v67
    v_bfe_u32 v25, v26, 1, 1
    v_lshl_add_u32 v67, v25, 3, v67
    v_lshl_add_u32 v66, v27, 14, v67
    v_lshl_add_u32 v66, v24, 17, v66
    s_xor_b32 s94, s13, 3
    s_mul_i32 s94, s94, 36864
    s_add_u32 s94, s94, s92
    s_lshl_b32 s74, s13, 7
    s_add_u32 s94, s94, s74
    s_add_u32 s78, s94, 0
    s_add_u32 s80, s66, 0
    s_mov_b32 s76, 0
    s_mov_b32 s77, 8192
    s_call_b64 s[82:83], cs_dma
    v_and_b32 v67, 63, v67
    v_lshrrev_b32 v25, 1, v24
    v_lshl_add_u32 v67, v25, 18, v67
    v_lshl_add_u32 v67, v27, 16, v67
    v_lshrrev_b32 v25, 3, v26
    v_lshl_add_u32 v67, v25, 15, v67
    v_and_b32 v25, 1, v24
    v_lshl_add_u32 v67, v25, 6, v67
    s_mov_b32 s77, 16384
    s_call_b64 s[82:83], cs_dma
    v_and_b32 v25, 31, v0
    v_lshlrev_b32 v70, 4, v25
    v_lshlrev_b32 v28, 3, v25
    v_add_u32 v28, 108032, v28
    v_lshrrev_b32 v25, 1, v24
    v_lshl_add_u32 v70, v25, 9, v70
    v_and_b32 v25, 1, v24
    v_lshl_add_u32 v70, v25, 3, v70
    v_add_u32 v70, 109568, v70
    v_cmp_gt_u32 vcc, 2, v27
    s_nop 1
    v_cndmask_b32 v70, v70, v28, vcc
    v_xor_b32 v71, 2048, v63
    v_lshrrev_b32 v68, 4, v0
    v_lshlrev_b32 v68, 7, v68
    v_and_b32 v25, 7, v26
    v_lshl_add_u32 v68, v25, 4, v68
    v_add_u32 v68, 98304, v68
    v_xor_b32 v74, 512, v68
    v_xor_b32 v75, 1024, v68
    v_xor_b32 v76, 1536, v68
    v_lshrrev_b32 v25, 3, v26
    v_lshl_add_u32 v77, v25, 3, v68
    v_or_b32 v78, 512, v65
    v_lshlrev_b32 v79, 2, v61
    v_mov_b64 v[72:73], 0
    v_and_b32 v25, 1, v27
    v_lshlrev_b32 v69, 7, v25
    v_lshrrev_b32 v25, 1, v27
    v_lshl_add_u32 v69, v25, 3, v69
    v_and_b32 v25, 3, v26
    v_lshl_add_u32 v69, v25, 4, v69
    v_bfe_u32 v25, v26, 2, 1
    v_lshl_add_u32 v69, v25, 2, v69
    s_mov_b32 s32, 0x00ff00ff
    s_mov_b32 s33, 0x00ff00ff
    s_not_b64 s[34:35], s[32:33]
    s_lshr_b32 s31, s12, 1
    s_lshl_b32 s31, s31, 8
    s_and_b32 s40, s12, 1
    s_lshl_b32 s40, s40, 6
    s_add_u32 s31, s31, s40
    s_and_b32 s40, s13, 1
    s_lshl_b32 s40, s40, 12
    s_add_u32 s31, s31, s40
    s_lshl_b32 s19, s12, 14
    s_add_u32 s19, s19, 68124672
    s_add_u32 s41, s19, 8192
    s_add_u32 s19, s19, s40
    s_and_b32 s40, s12, 1
    s_lshl_b32 s40, s40, 2
    s_or_b32 s40, s40, s13
    s_cmp_eq_u32 s40, 5
    s_cselect_b32 s64, 0, s13
    s_cmp_lg_u32 s13, 1
    s_cbranch_scc1 cs_notx
    s_mov_b32 s32, 0xff
    s_mov_b32 s33, 0xff
    s_mov_b32 s19, s41
    s_lshr_b32 s31, s12, 3
    s_lshl_b32 s31, s31, 8
    s_and_b32 s40, s12, 2
    s_lshl_b32 s40, s40, 6
    s_add_u32 s31, s31, s40
    s_and_b32 s40, s12, 4
    s_lshl_b32 s40, s40, 4
    s_add_u32 s31, s31, s40
    s_add_u32 s31, s31, 8192
cs_notx:
    s_cmp_lg_u32 s13, 0
    s_cbranch_scc1 cs_notp
    s_min_u32 s40, s12, 23
    s_mul_i32 s40, s40, 384
    s_add_u32 s40, s40, 98304
    v_add_u32 v69, s40, v61
    v_mov_b32 v25, 108288
    v_cmp_lt_u32 vcc, 23, v0
    s_nop 1
    v_cndmask_b32 v69, v69, v25, vcc
cs_notp:
    s_nop 1
    v_mov_b32 v28, 1
    v_mov_b32 v29, 1
    v_mov_b32 v30, 1
    v_mov_b32 v31, 1
    s_lshl_b32 s40, s12, 14
    s_add_u32 s40, s40, 68222976
    s_add_u32 s41, s40, 0
    buffer_store_dwordx4 v[28:31], v61, s[4:7], s41 offen sc1
    s_add_u32 s41, s40, 4096
    buffer_store_dwordx4 v[28:31], v61, s[4:7], s41 offen sc1
    s_add_u32 s41, s40, 8192
    buffer_store_dwordx4 v[28:31], v61, s[4:7], s41 offen sc1
    s_cmp_eq_u32 s64, 0
    s_cselect_b64 exec, 0, s[32:33]
    v_mov_b32 v27, -1
    s_add_u32 s41, s31, 68157440
    buffer_store_dword v27, v69, s[4:7], s41 offen sc1
    s_add_u32 s41, s31, 68173824
    buffer_store_dword v27, v69, s[4:7], s41 offen sc1
    s_add_u32 s41, s31, 68190208
    buffer_store_dword v27, v69, s[4:7], s41 offen sc1
    s_add_u32 s41, s31, 68206592
    buffer_store_dword v27, v69, s[4:7], s41 offen sc1
    s_mov_b64 exec, -1
    s_mov_b64 s[68:69], s[48:49]
    s_mov_b32 s70, 9216
    s_mov_b32 s71, 0x20000
    v_and_b32 v25, 7, v0
    v_mul_u32_u24 v25, 1152, v25
    v_lshrrev_b32 v26, 3, v0
    v_lshl_add_u32 v25, v26, 4, v25
    buffer_load_dwordx4 v[36:39], v25, s[68:71], 0 offen
    buffer_load_dwordx4 v[40:43], v25, s[68:71], 0 offen offset:512
    v_bfe_u32 v25, v0, 2, 3
    v_mul_u32_u24 v25, 1152, v25
    v_lshrrev_b32 v26, 5, v0
    v_lshl_add_u32 v25, v26, 4, v25
    v_and_b32 v26, 3, v0
    v_lshl_add_u32 v25, v26, 2, v25
    buffer_load_dword v44, v25, s[68:71], 0 offen offset:1024
    s_waitcnt vmcnt(15)
    v_add_u32 v55, 114688, v52
    ds_read_b64_tr_b16 v[160:161], v55 offset:0
    ds_read_b64_tr_b16 v[162:163], v55 offset:256
    ds_read_b64_tr_b16 v[164:165], v55 offset:4096
    ds_read_b64_tr_b16 v[166:167], v55 offset:4352
    s_xor_b32 s94, s13, 0
    s_mul_i32 s94, s94, 36864
    s_add_u32 s94, s94, s92
    s_lshl_b32 s74, s13, 7
    s_add_u32 s94, s94, s74
    s_add_u32 s78, s94, 512
    s_add_u32 s80, s66, 147456
    s_mov_b32 s76, 0
    s_mov_b32 s77, 8192
    s_call_b64 s[82:83], cs_dma
    ds_read_b64_tr_b16 v[192:193], v55 offset:64
    ds_read_b64_tr_b16 v[194:195], v55 offset:320
    ds_read_b64_tr_b16 v[196:197], v55 offset:4160
    ds_read_b64_tr_b16 v[198:199], v55 offset:4416
    s_mov_b32 s77, 16384
    s_call_b64 s[82:83], cs_dma
    s_waitcnt lgkmcnt(0)
    s_waitcnt vmcnt(15)
    v_add_u32 v55, 81920, v52
    ds_read_b64_tr_b16 v[168:169], v55 offset:0
    ds_read_b64_tr_b16 v[170:171], v55 offset:256
    ds_read_b64_tr_b16 v[172:173], v55 offset:4096
    ds_read_b64_tr_b16 v[174:175], v55 offset:4352
    s_xor_b32 s94, s13, 1
    s_mul_i32 s94, s94, 36864
    s_add_u32 s94, s94, s92
    s_lshl_b32 s74, s13, 7
    s_add_u32 s94, s94, s74
    s_add_u32 s78, s94, 512
    s_add_u32 s80, s66, 98304
    s_mov_b32 s76, 0
    s_mov_b32 s77, 8192
    s_call_b64 s[82:83], cs_dma
    ds_read_b64_tr_b16 v[200:201], v55 offset:64
    ds_read_b64_tr_b16 v[202:203], v55 offset:320
    ds_read_b64_tr_b16 v[204:205], v55 offset:4160
    ds_read_b64_tr_b16 v[206:207], v55 offset:4416
    s_mov_b32 s77, 16384
    s_call_b64 s[82:83], cs_dma
    s_waitcnt lgkmcnt(0)
    s_waitcnt vmcnt(15)
    v_add_u32 v55, 16384, v52
    ds_read_b64_tr_b16 v[176:177], v55 offset:0
    ds_read_b64_tr_b16 v[178:179], v55 offset:256
    ds_read_b64_tr_b16 v[180:181], v55 offset:4096
    ds_read_b64_tr_b16 v[182:183], v55 offset:4352
    s_add_u32 s78, s67, 4194304
    s_mov_b64 s[8:9], s[54:55]
    v_mov_b32 v58, v48
    s_mov_b32 s79, 131072
    s_add_u32 s80, s66, 32768
    s_mov_b32 s76, 0
    s_mov_b32 s77, 8192
    s_call_b64 s[82:83], cs_dma
    ds_read_b64_tr_b16 v[208:209], v55 offset:64
    ds_read_b64_tr_b16 v[210:211], v55 offset:320
    ds_read_b64_tr_b16 v[212:213], v55 offset:4160
    ds_read_b64_tr_b16 v[214:215], v55 offset:4416
    s_mov_b32 s77, 16384
    s_call_b64 s[82:83], cs_dma
    s_waitcnt lgkmcnt(0)
    s_waitcnt vmcnt(15)
    v_add_u32 v55, 0, v52
    ds_read_b64_tr_b16 v[184:185], v55 offset:0
    ds_read_b64_tr_b16 v[186:187], v55 offset:256
    ds_read_b64_tr_b16 v[188:189], v55 offset:4096
    ds_read_b64_tr_b16 v[190:191], v55 offset:4352
    s_xor_b32 s78, s75, 0
    s_add_u32 s78, s78, s67
    s_mov_b32 s81, s93
    s_add_u32 s80, s66, 114688
    s_mov_b32 s76, 0
    s_mov_b32 s77, 8192
    s_call_b64 s[82:83], cs_dma
    ds_read_b64_tr_b16 v[216:217], v55 offset:64
    ds_read_b64_tr_b16 v[218:219], v55 offset:320
    ds_read_b64_tr_b16 v[220:221], v55 offset:4160
    ds_read_b64_tr_b16 v[222:223], v55 offset:4416
    s_mov_b32 s77, 16384
    s_call_b64 s[82:83], cs_dma
    s_waitcnt lgkmcnt(0)
    s_waitcnt vmcnt(12)
    v_add_u32 v55, 147456, v52
    ds_read_b64_tr_b16 v[224:225], v55 offset:0
    ds_read_b64_tr_b16 v[226:227], v55 offset:256
    ds_read_b64_tr_b16 v[228:229], v55 offset:4096
    ds_read_b64_tr_b16 v[230:231], v55 offset:4352
    s_mov_b32 s77, 24576
    s_call_b64 s[82:83], cs_dma
    ds_read_b64_tr_b16 v[240:241], v55 offset:64
    ds_read_b64_tr_b16 v[242:243], v55 offset:320
    ds_read_b64_tr_b16 v[244:245], v55 offset:4160
    ds_read_b64_tr_b16 v[246:247], v55 offset:4416
    s_mov_b32 s77, 32768
    s_call_b64 s[82:83], cs_dma
    s_waitcnt lgkmcnt(0)
    v_min_u32 v36, -2, v36
    v_min_u32 v37, -2, v37
    v_min_u32 v38, -2, v38
    v_min_u32 v39, -2, v39
    v_min_u32 v40, -2, v40
    v_min_u32 v41, -2, v41
    v_min_u32 v42, -2, v42
    v_min_u32 v43, -2, v43
    v_min_u32 v44, -2, v44
    s_lshl_b32 s14, s12, 16
    s_add_u32 s14, s14, 92274688
    s_add_u32 s41, s14, 4096
    s_add_u32 s42, s14, 8192
    v_lshrrev_b32 v45, 2, v61
    buffer_store_dwordx4 v[36:39], v61, s[4:7], s14 offen sc1
    buffer_store_dwordx4 v[40:43], v61, s[4:7], s41 offen sc1
    buffer_store_dword v44, v45, s[4:7], s42 offen sc1
    v_mov_b32 v46, 1
    s_mov_b64 exec, 1
    buffer_atomic_add v46, off, s[96:99], 0 offset:212 sc0
    s_mov_b64 exec, -1
    s_mov_b32 s44, 0x3e0293ee
    s_mov_b32 s45, s44
    s_mov_b32 s46, 0x42000000
    s_mov_b32 s60, 0x3f803f80
    s_mov_b32 s61, s60
    s_mov_b32 s62, 0x3e803e80
    s_mov_b32 s63, s62
    s_mov_b32 s28, 0
    s_lshl_b32 s24, s12, 14
    s_add_u32 s24, s24, 0
    s_add_u32 s47, s24, 33030144
    s_mul_i32 s40, s13, 3072
    s_add_u32 s23, s24, s40
    s_lshl_b32 s20, s12, 7
    s_add_u32 s20, s20, 68222976
    s_add_u32 s21, s20, 65536
    s_add_u32 s38, s20, 4096
    s_add_u32 s39, s21, 4096
    s_lshl_b32 s22, s12, 7
    s_add_u32 s22, s22, 68231168
    s_lshl_b32 s40, s12, 12
    s_add_u32 s25, s40, 79429632
    s_add_u32 s26, s40, 88866816
    s_lshl_b32 s65, s12, 9
    s_add_u32 s65, s65, 90177536
    s_lshl_b32 s40, s13, 5
    s_or_b32 s40, s40, s12
    s_cmp_lt_u32 s40, 24
    s_cselect_b32 s36, 0x1ffffff, 0
    s_mov_b32 s37, 0
    s_lshl_b32 s27, s12, 7
    s_add_u32 s27, s27, 125845504
    s_lshl_b32 s40, s13, 2
    s_add_u32 s27, s27, s40
    v_bfe_u32 v24, v61, 4, 4
    v_bfe_u32 v25, v61, 8, 1
    v_lshlrev_b32 v25, 2, v25
    v_sub_u32 v25, v24, v25
    v_mov_b32 v26, 0x3f80
    v_mov_b32 v27, 0x3f800000
    v_cmp_eq_u32 vcc, 0, v25
    s_nop 1
    v_cndmask_b32 v16, 0, v26, vcc
    v_cmp_eq_u32 vcc, 1, v25
    s_nop 1
    v_cndmask_b32 v16, v16, v27, vcc
    v_cmp_eq_u32 vcc, 0, v24
    s_nop 1
    v_cndmask_b32 v20, 0, v26, vcc
    v_cmp_eq_u32 vcc, 1, v24
    s_nop 1
    v_cndmask_b32 v20, v20, v27, vcc
    v_cmp_eq_u32 vcc, 2, v25
    s_nop 1
    v_cndmask_b32 v17, 0, v26, vcc
    v_cmp_eq_u32 vcc, 3, v25
    s_nop 1
    v_cndmask_b32 v17, v17, v27, vcc
    v_cmp_eq_u32 vcc, 2, v24
    s_nop 1
    v_cndmask_b32 v21, 0, v26, vcc
    v_cmp_eq_u32 vcc, 3, v24
    s_nop 1
    v_cndmask_b32 v21, v21, v27, vcc
    v_cmp_eq_u32 vcc, 8, v25
    s_nop 1
    v_cndmask_b32 v18, 0, v26, vcc
    v_cmp_eq_u32 vcc, 9, v25
    s_nop 1
    v_cndmask_b32 v18, v18, v27, vcc
    v_cmp_eq_u32 vcc, 4, v24
    s_nop 1
    v_cndmask_b32 v22, 0, v26, vcc
    v_cmp_eq_u32 vcc, 5, v24
    s_nop 1
    v_cndmask_b32 v22, v22, v27, vcc
    v_cmp_eq_u32 vcc, 10, v25
    s_nop 1
    v_cndmask_b32 v19, 0, v26, vcc
    v_cmp_eq_u32 vcc, 11, v25
    s_nop 1
    v_cndmask_b32 v19, v19, v27, vcc
    v_cmp_eq_u32 vcc, 6, v24
    s_nop 1
    v_cndmask_b32 v23, 0, v26, vcc
    v_cmp_eq_u32 vcc, 7, v24
    s_nop 1
    v_cndmask_b32 v23, v23, v27, vcc
    s_waitcnt vmcnt(13)
    v_add_u32 v55, 98304, v52
    ds_read_b64_tr_b16 v[232:233], v55 offset:0
    ds_read_b64_tr_b16 v[234:235], v55 offset:256
    ds_read_b64_tr_b16 v[236:237], v55 offset:4096
    ds_read_b64_tr_b16 v[238:239], v55 offset:4352
    s_xor_b32 s78, s75, 1048576
    s_add_u32 s78, s78, s67
    s_add_u32 s80, s66, 65536
    s_mov_b32 s76, 0
    s_mov_b32 s77, 8192
    s_call_b64 s[82:83], cs_dma
    ds_read_b64_tr_b16 v[248:249], v55 offset:64
    ds_read_b64_tr_b16 v[250:251], v55 offset:320
    ds_read_b64_tr_b16 v[252:253], v55 offset:4160
    ds_read_b64_tr_b16 v[254:255], v55 offset:4416
    s_mov_b32 s77, 16384
    s_call_b64 s[82:83], cs_dma
    s_waitcnt lgkmcnt(0)
    s_waitcnt vmcnt(13)
    v_add_u32 v55, 32768, v51
    v_xor_b32 v56, 32, v55
    ds_read_b64_tr_b16 v[144:145], v55 offset:0
    ds_read_b64_tr_b16 v[146:147], v55 offset:256
    ds_read_b64_tr_b16 v[148:149], v55 offset:8192
    ds_read_b64_tr_b16 v[150:151], v55 offset:8448
    s_mov_b32 s77, 24576
    s_call_b64 s[82:83], cs_dma
    ds_read_b64_tr_b16 v[152:153], v56 offset:0
    ds_read_b64_tr_b16 v[154:155], v56 offset:256
    ds_read_b64_tr_b16 v[156:157], v56 offset:8192
    ds_read_b64_tr_b16 v[158:159], v56 offset:8448
    s_mov_b32 s77, 32768
    s_call_b64 s[82:83], cs_dma
    s_waitcnt lgkmcnt(0)
    s_waitcnt vmcnt(9)
    v_add_u32 v55, 114688, v51
    v_xor_b32 v56, 32, v55
    ds_read_b64_tr_b16 a[192:193], v55 offset:0
    ds_read_b64_tr_b16 a[194:195], v55 offset:256
    ds_read_b64_tr_b16 a[196:197], v55 offset:8192
    ds_read_b64_tr_b16 a[198:199], v55 offset:8448
    s_xor_b32 s78, s75, 2097152
    s_add_u32 s78, s78, s67
    s_add_u32 s80, s66, 0
    s_mov_b32 s76, 0
    s_mov_b32 s77, 8192
    s_call_b64 s[82:83], cs_dma
    ds_read_b64_tr_b16 a[200:201], v56 offset:0
    ds_read_b64_tr_b16 a[202:203], v56 offset:256
    ds_read_b64_tr_b16 a[204:205], v56 offset:8192
    ds_read_b64_tr_b16 a[206:207], v56 offset:8448
    s_mov_b32 s77, 16384
    s_call_b64 s[82:83], cs_dma
    s_waitcnt lgkmcnt(0)
    v_add_u32 v55, 131072, v51
    v_xor_b32 v56, 32, v55
    ds_read_b64_tr_b16 a[208:209], v55 offset:0
    ds_read_b64_tr_b16 a[210:211], v55 offset:256
    ds_read_b64_tr_b16 a[212:213], v55 offset:8192
    ds_read_b64_tr_b16 a[214:215], v55 offset:8448
    s_mov_b32 s77, 24576
    s_call_b64 s[82:83], cs_dma
    ds_read_b64_tr_b16 a[216:217], v56 offset:0
    ds_read_b64_tr_b16 a[218:219], v56 offset:256
    ds_read_b64_tr_b16 a[220:221], v56 offset:8192
    ds_read_b64_tr_b16 a[222:223], v56 offset:8448
    s_mov_b32 s77, 32768
    s_call_b64 s[82:83], cs_dma
    s_waitcnt lgkmcnt(0)
    s_waitcnt vmcnt(8)
    v_add_u32 v55, 65536, v51
    v_xor_b32 v56, 32, v55
    ds_read_b64_tr_b16 a[224:225], v55 offset:0
    ds_read_b64_tr_b16 a[226:227], v55 offset:256
    ds_read_b64_tr_b16 a[228:229], v55 offset:8192
    ds_read_b64_tr_b16 a[230:231], v55 offset:8448
    s_xor_b32 s78, s75, 3145728
    s_add_u32 s78, s78, s67
    s_add_u32 s80, s66, 32768
    s_mov_b32 s76, 0
    s_mov_b32 s77, 8192
    s_call_b64 s[82:83], cs_dma
    ds_read_b64_tr_b16 a[232:233], v56 offset:0
    ds_read_b64_tr_b16 a[234:235], v56 offset:256
    ds_read_b64_tr_b16 a[236:237], v56 offset:8192
    ds_read_b64_tr_b16 a[238:239], v56 offset:8448
    s_mov_b32 s77, 16384
    s_call_b64 s[82:83], cs_dma
    s_waitcnt lgkmcnt(0)
    v_add_u32 v55, 81920, v51
    v_xor_b32 v56, 32, v55
    ds_read_b64_tr_b16 a[240:241], v55 offset:0
    ds_read_b64_tr_b16 a[242:243], v55 offset:256
    ds_read_b64_tr_b16 a[244:245], v55 offset:8192
    ds_read_b64_tr_b16 a[246:247], v55 offset:8448
    s_mov_b32 s77, 24576
    s_call_b64 s[82:83], cs_dma
    ds_read_b64_tr_b16 a[248:249], v56 offset:0
    ds_read_b64_tr_b16 a[250:251], v56 offset:256
    ds_read_b64_tr_b16 a[252:253], v56 offset:8192
    ds_read_b64_tr_b16 a[254:255], v56 offset:8448
    s_mov_b32 s77, 32768
    s_call_b64 s[82:83], cs_dma
    s_waitcnt lgkmcnt(0)
    v_readfirstlane_b32 s41, v46
    v_mov_b32 v36, 1
    v_mov_b32 v37, 0
    s_cmp_eq_u32 s41, 127
    s_cselect_b64 exec, 1, 0
    buffer_atomic_cmpswap v[36:37], off, s[96:99], 0 offset:216
    s_mov_b64 exec, -1
    s_waitcnt vmcnt(8)
    v_add_u32 v55, 0, v51
    v_xor_b32 v56, 32, v55
    ds_read_b64_tr_b16 v[80:81], v55 offset:0
    ds_read_b64_tr_b16 v[82:83], v55 offset:256
    ds_read_b64_tr_b16 v[84:85], v55 offset:8192
    ds_read_b64_tr_b16 v[86:87], v55 offset:8448
    s_xor_b32 s78, s75, 2097152
    s_add_u32 s78, s78, s67
    s_mov_b64 s[8:9], s[52:53]
    s_add_u32 s80, s66, 131072
    s_mov_b32 s76, 0
    s_mov_b32 s77, 8192
    s_call_b64 s[82:83], cs_dma
    ds_read_b64_tr_b16 v[88:89], v56 offset:0
    ds_read_b64_tr_b16 v[90:91], v56 offset:256
    ds_read_b64_tr_b16 v[92:93], v56 offset:8192
    ds_read_b64_tr_b16 v[94:95], v56 offset:8448
    s_mov_b32 s77, 16384
    s_call_b64 s[82:83], cs_dma
    s_waitcnt lgkmcnt(0)
    v_add_u32 v55, 16384, v51
    v_xor_b32 v56, 32, v55
    ds_read_b64_tr_b16 v[96:97], v55 offset:0
    ds_read_b64_tr_b16 v[98:99], v55 offset:256
    ds_read_b64_tr_b16 v[100:101], v55 offset:8192
    ds_read_b64_tr_b16 v[102:103], v55 offset:8448
    s_mov_b32 s77, 24576
    s_call_b64 s[82:83], cs_dma
    ds_read_b64_tr_b16 v[104:105], v56 offset:0
    ds_read_b64_tr_b16 v[106:107], v56 offset:256
    ds_read_b64_tr_b16 v[108:109], v56 offset:8192
    ds_read_b64_tr_b16 v[110:111], v56 offset:8448
    s_mov_b32 s77, 32768
    s_call_b64 s[82:83], cs_dma
    s_waitcnt lgkmcnt(0)
    s_waitcnt vmcnt(8)
    v_add_u32 v55, 32768, v51
    v_xor_b32 v56, 32, v55
    ds_read_b64_tr_b16 v[112:113], v55 offset:0
    ds_read_b64_tr_b16 v[114:115], v55 offset:256
    ds_read_b64_tr_b16 v[116:117], v55 offset:8192
    ds_read_b64_tr_b16 v[118:119], v55 offset:8448
    s_xor_b32 s78, s75, 3145728
    s_add_u32 s78, s78, s67
    s_add_u32 s80, s66, 65536
    s_mov_b32 s76, 0
    s_mov_b32 s77, 8192
    s_call_b64 s[82:83], cs_dma
    ds_read_b64_tr_b16 v[120:121], v56 offset:0
    ds_read_b64_tr_b16 v[122:123], v56 offset:256
    ds_read_b64_tr_b16 v[124:125], v56 offset:8192
    ds_read_b64_tr_b16 v[126:127], v56 offset:8448
    s_mov_b32 s77, 16384
    s_call_b64 s[82:83], cs_dma
    s_waitcnt lgkmcnt(0)
    v_add_u32 v55, 49152, v51
    v_xor_b32 v56, 32, v55
    ds_read_b64_tr_b16 v[128:129], v55 offset:0
    ds_read_b64_tr_b16 v[130:131], v55 offset:256
    ds_read_b64_tr_b16 v[132:133], v55 offset:8192
    ds_read_b64_tr_b16 v[134:135], v55 offset:8448
    s_mov_b32 s77, 24576
    s_call_b64 s[82:83], cs_dma
    ds_read_b64_tr_b16 v[136:137], v56 offset:0
    ds_read_b64_tr_b16 v[138:139], v56 offset:256
    ds_read_b64_tr_b16 v[140:141], v56 offset:8192
    ds_read_b64_tr_b16 v[142:143], v56 offset:8448
    s_mov_b32 s77, 32768
    s_call_b64 s[82:83], cs_dma
    s_waitcnt lgkmcnt(0)
    s_waitcnt vmcnt(8)
    v_add_u32 v55, 131072, v51
    v_xor_b32 v56, 32, v55
    ds_read_b64_tr_b16 a[128:129], v55 offset:0
    ds_read_b64_tr_b16 a[130:131], v55 offset:256
    ds_read_b64_tr_b16 a[132:133], v55 offset:8192
    ds_read_b64_tr_b16 a[134:135], v55 offset:8448
    s_xor_b32 s78, s75, 2097152
    s_add_u32 s78, s78, s67
    s_mov_b64 s[8:9], s[50:51]
    s_add_u32 s80, s66, 0
    s_mov_b32 s76, 0
    s_mov_b32 s77, 8192
    s_call_b64 s[82:83], cs_dma
    ds_read_b64_tr_b16 a[136:137], v56 offset:0
    ds_read_b64_tr_b16 a[138:139], v56 offset:256
    ds_read_b64_tr_b16 a[140:141], v56 offset:8192
    ds_read_b64_tr_b16 a[142:143], v56 offset:8448
    s_mov_b32 s77, 16384
    s_call_b64 s[82:83], cs_dma
    s_waitcnt lgkmcnt(0)
    v_add_u32 v55, 147456, v51
    v_xor_b32 v56, 32, v55
    ds_read_b64_tr_b16 a[144:145], v55 offset:0
    ds_read_b64_tr_b16 a[146:147], v55 offset:256
    ds_read_b64_tr_b16 a[148:149], v55 offset:8192
    ds_read_b64_tr_b16 a[150:151], v55 offset:8448
    s_mov_b32 s77, 24576
    s_call_b64 s[82:83], cs_dma
    ds_read_b64_tr_b16 a[152:153], v56 offset:0
    ds_read_b64_tr_b16 a[154:155], v56 offset:256
    ds_read_b64_tr_b16 a[156:157], v56 offset:8192
    ds_read_b64_tr_b16 a[158:159], v56 offset:8448
    s_mov_b32 s77, 32768
    s_call_b64 s[82:83], cs_dma
    s_waitcnt lgkmcnt(0)
    s_waitcnt vmcnt(8)
    v_add_u32 v55, 65536, v51
    v_xor_b32 v56, 32, v55
    ds_read_b64_tr_b16 a[160:161], v55 offset:0
    ds_read_b64_tr_b16 a[162:163], v55 offset:256
    ds_read_b64_tr_b16 a[164:165], v55 offset:8192
    ds_read_b64_tr_b16 a[166:167], v55 offset:8448
    s_xor_b32 s78, s75, 3145728
    s_add_u32 s78, s78, s67
    s_add_u32 s80, s66, 32768
    s_mov_b32 s76, 0
    s_mov_b32 s77, 8192
    s_call_b64 s[82:83], cs_dma
    ds_read_b64_tr_b16 a[168:169], v56 offset:0
    ds_read_b64_tr_b16 a[170:171], v56 offset:256
    ds_read_b64_tr_b16 a[172:173], v56 offset:8192
    ds_read_b64_tr_b16 a[174:175], v56 offset:8448
    s_mov_b32 s77, 16384
    s_call_b64 s[82:83], cs_dma
    s_waitcnt lgkmcnt(0)
    v_add_u32 v55, 81920, v51
    v_xor_b32 v56, 32, v55
    ds_read_b64_tr_b16 a[176:177], v55 offset:0
    ds_read_b64_tr_b16 a[178:179], v55 offset:256
    ds_read_b64_tr_b16 a[180:181], v55 offset:8192
    ds_read_b64_tr_b16 a[182:183], v55 offset:8448
    s_mov_b32 s77, 24576
    s_call_b64 s[82:83], cs_dma
    ds_read_b64_tr_b16 a[184:185], v56 offset:0
    ds_read_b64_tr_b16 a[186:187], v56 offset:256
    ds_read_b64_tr_b16 a[188:189], v56 offset:8192
    ds_read_b64_tr_b16 a[190:191], v56 offset:8448
    s_mov_b32 s77, 32768
    s_call_b64 s[82:83], cs_dma
    s_waitcnt lgkmcnt(0)
    s_waitcnt vmcnt(8)
    v_add_u32 v55, 0, v51
    v_xor_b32 v56, 32, v55
    ds_read_b64_tr_b16 a[48:49], v55 offset:0
    ds_read_b64_tr_b16 a[50:51], v55 offset:256
    ds_read_b64_tr_b16 a[52:53], v55 offset:8192
    ds_read_b64_tr_b16 a[54:55], v55 offset:8448
    s_add_u32 s78, s67, 4194304
    s_mov_b32 s81, 0
    s_add_u32 s80, s66, 98304
    s_mov_b32 s76, 0
    s_mov_b32 s77, 8192
    s_call_b64 s[82:83], cs_dma
    ds_read_b64_tr_b16 a[56:57], v56 offset:0
    ds_read_b64_tr_b16 a[58:59], v56 offset:256
    ds_read_b64_tr_b16 a[60:61], v56 offset:8192
    ds_read_b64_tr_b16 a[62:63], v56 offset:8448
    s_mov_b32 s77, 16384
    s_call_b64 s[82:83], cs_dma
    s_waitcnt lgkmcnt(0)
    v_add_u32 v55, 16384, v51
    v_xor_b32 v56, 32, v55
    ds_read_b64_tr_b16 a[64:65], v55 offset:0
    ds_read_b64_tr_b16 a[66:67], v55 offset:256
    ds_read_b64_tr_b16 a[68:69], v55 offset:8192
    ds_read_b64_tr_b16 a[70:71], v55 offset:8448
    s_xor_b32 s78, s75, 1048576
    s_add_u32 s78, s78, s67
    s_mov_b32 s81, s93
    s_add_u32 s80, s66, 114688
    s_mov_b32 s76, 0
    s_mov_b32 s77, 8192
    s_call_b64 s[82:83], cs_dma
    ds_read_b64_tr_b16 a[72:73], v56 offset:0
    ds_read_b64_tr_b16 a[74:75], v56 offset:256
    ds_read_b64_tr_b16 a[76:77], v56 offset:8192
    ds_read_b64_tr_b16 a[78:79], v56 offset:8448
    s_mov_b32 s77, 16384
    s_call_b64 s[82:83], cs_dma
    s_waitcnt lgkmcnt(0)
    s_waitcnt vmcnt(8)
    v_add_u32 v55, 32768, v51
    v_xor_b32 v56, 32, v55
    ds_read_b64_tr_b16 a[80:81], v55 offset:0
    ds_read_b64_tr_b16 a[82:83], v55 offset:256
    ds_read_b64_tr_b16 a[84:85], v55 offset:8192
    ds_read_b64_tr_b16 a[86:87], v55 offset:8448
    s_mov_b32 s77, 24576
    s_call_b64 s[82:83], cs_dma
    ds_read_b64_tr_b16 a[88:89], v56 offset:0
    ds_read_b64_tr_b16 a[90:91], v56 offset:256
    ds_read_b64_tr_b16 a[92:93], v56 offset:8192
    ds_read_b64_tr_b16 a[94:95], v56 offset:8448
    s_mov_b32 s77, 32768
    s_call_b64 s[82:83], cs_dma
    s_waitcnt lgkmcnt(0)
    v_add_u32 v55, 49152, v51
    v_xor_b32 v56, 32, v55
    ds_read_b64_tr_b16 a[96:97], v55 offset:0
    ds_read_b64_tr_b16 a[98:99], v55 offset:256
    ds_read_b64_tr_b16 a[100:101], v55 offset:8192
    ds_read_b64_tr_b16 a[102:103], v55 offset:8448
    s_xor_b32 s78, s75, 0
    s_add_u32 s78, s78, s67
    s_add_u32 s80, s66, 65536
    s_mov_b32 s76, 0
    s_mov_b32 s77, 8192
    s_call_b64 s[82:83], cs_dma
    ds_read_b64_tr_b16 a[104:105], v56 offset:0
    ds_read_b64_tr_b16 a[106:107], v56 offset:256
    ds_read_b64_tr_b16 a[108:109], v56 offset:8192
    ds_read_b64_tr_b16 a[110:111], v56 offset:8448
    s_mov_b32 s77, 16384
    s_call_b64 s[82:83], cs_dma
    s_waitcnt lgkmcnt(0)
    s_waitcnt vmcnt(12)
    v_add_u32 v55, 98304, v51
    v_xor_b32 v56, 32, v55
    ds_read_b64_tr_b16 a[112:113], v55 offset:0
    ds_read_b64_tr_b16 a[114:115], v55 offset:256
    ds_read_b64_tr_b16 a[116:117], v55 offset:8192
    ds_read_b64_tr_b16 a[118:119], v55 offset:8448
    s_mov_b32 s77, 24576
    s_call_b64 s[82:83], cs_dma
    ds_read_b64_tr_b16 a[120:121], v56 offset:0
    ds_read_b64_tr_b16 a[122:123], v56 offset:256
    ds_read_b64_tr_b16 a[124:125], v56 offset:8192
    ds_read_b64_tr_b16 a[126:127], v56 offset:8448
    s_mov_b32 s77, 32768
    s_call_b64 s[82:83], cs_dma
    s_waitcnt lgkmcnt(0)
    s_waitcnt vmcnt(8)
    v_add_u32 v55, 114688, v51
    v_xor_b32 v56, 32, v55
    ds_read_b64_tr_b16 a[16:17], v55 offset:0
    ds_read_b64_tr_b16 a[18:19], v55 offset:256
    ds_read_b64_tr_b16 a[20:21], v55 offset:8192
    ds_read_b64_tr_b16 a[22:23], v55 offset:8448
    s_xor_b32 s78, s75, 0
    s_add_u32 s78, s78, s67
    s_mov_b64 s[8:9], s[52:53]
    s_add_u32 s80, s66, 0
    s_mov_b32 s76, 0
    s_mov_b32 s77, 8192
    s_call_b64 s[82:83], cs_dma
    ds_read_b64_tr_b16 a[24:25], v56 offset:0
    ds_read_b64_tr_b16 a[26:27], v56 offset:256
    ds_read_b64_tr_b16 a[28:29], v56 offset:8192
    ds_read_b64_tr_b16 a[30:31], v56 offset:8448
    s_mov_b32 s77, 16384
    s_call_b64 s[82:83], cs_dma
    s_waitcnt lgkmcnt(0)
    v_add_u32 v55, 131072, v51
    v_xor_b32 v56, 32, v55
    ds_read_b64_tr_b16 a[32:33], v55 offset:0
    ds_read_b64_tr_b16 a[34:35], v55 offset:256
    ds_read_b64_tr_b16 a[36:37], v55 offset:8192
    ds_read_b64_tr_b16 a[38:39], v55 offset:8448
    s_mov_b32 s77, 24576
    s_call_b64 s[82:83], cs_dma
    ds_read_b64_tr_b16 a[40:41], v56 offset:0
    ds_read_b64_tr_b16 a[42:43], v56 offset:256
    ds_read_b64_tr_b16 a[44:45], v56 offset:8192
    ds_read_b64_tr_b16 a[46:47], v56 offset:8448
    s_mov_b32 s77, 32768
    s_call_b64 s[82:83], cs_dma
    s_waitcnt lgkmcnt(0)
    s_waitcnt vmcnt(8)
    v_add_u32 v55, 65536, v51
    v_xor_b32 v56, 32, v55
    ds_read_b64_tr_b16 v[0:1], v55 offset:0
    ds_read_b64_tr_b16 v[2:3], v55 offset:256
    ds_read_b64_tr_b16 v[4:5], v55 offset:8192
    ds_read_b64_tr_b16 v[6:7], v55 offset:8448
    s_xor_b32 s78, s75, 1048576
    s_add_u32 s78, s78, s67
    s_add_u32 s80, s66, 32768
    s_mov_b32 s76, 0
    s_mov_b32 s77, 8192
    s_call_b64 s[82:83], cs_dma
    ds_read_b64_tr_b16 v[8:9], v56 offset:0
    ds_read_b64_tr_b16 v[10:11], v56 offset:256
    ds_read_b64_tr_b16 v[12:13], v56 offset:8192
    ds_read_b64_tr_b16 v[14:15], v56 offset:8448
    s_mov_b32 s77, 16384
    s_call_b64 s[82:83], cs_dma
    s_waitcnt lgkmcnt(0)
    ds_write_b128 v62, v[0:3] offset:8192
    ds_write_b128 v62, v[4:7] offset:12288
    ds_write_b128 v62, v[8:11] offset:16384
    ds_write_b128 v62, v[12:15] offset:20480
    s_waitcnt lgkmcnt(0)
    v_add_u32 v55, 81920, v51
    v_xor_b32 v56, 32, v55
    ds_read_b64_tr_b16 a[0:1], v55 offset:0
    ds_read_b64_tr_b16 a[2:3], v55 offset:256
    ds_read_b64_tr_b16 a[4:5], v55 offset:8192
    ds_read_b64_tr_b16 a[6:7], v55 offset:8448
    s_mov_b32 s77, 24576
    s_call_b64 s[82:83], cs_dma
    ds_read_b64_tr_b16 a[8:9], v56 offset:0
    ds_read_b64_tr_b16 a[10:11], v56 offset:256
    ds_read_b64_tr_b16 a[12:13], v56 offset:8192
    ds_read_b64_tr_b16 a[14:15], v56 offset:8448
    s_mov_b32 s77, 32768
    s_call_b64 s[82:83], cs_dma
    s_waitcnt lgkmcnt(0)
    s_waitcnt vmcnt(8)
    v_add_u32 v55, 0, v51
    v_xor_b32 v56, 32, v55
    ds_read_b64_tr_b16 v[0:1], v55 offset:0
    ds_read_b64_tr_b16 v[2:3], v55 offset:256
    ds_read_b64_tr_b16 v[4:5], v55 offset:8192
    ds_read_b64_tr_b16 v[6:7], v55 offset:8448
    s_xor_b32 s94, s13, 0
    s_mul_i32 s94, s94, 36864
    s_add_u32 s94, s94, s92
    s_lshr_b32 s74, s13, 1
    s_lshl_b32 s74, s74, 6
    s_add_u32 s94, s94, s74
    s_add_u32 s78, s94, 1024
    s_mov_b64 s[8:9], s[56:57]
    v_mov_b32 v58, v50
    s_mov_b32 s79, 18432
    s_mov_b32 s81, 0
    s_add_u32 s80, s66, 147456
    s_mov_b32 s76, 0
    s_mov_b32 s77, 8192
    s_call_b64 s[82:83], cs_dma
    ds_read_b64_tr_b16 v[8:9], v56 offset:0
    ds_read_b64_tr_b16 v[10:11], v56 offset:256
    ds_read_b64_tr_b16 v[12:13], v56 offset:8192
    ds_read_b64_tr_b16 v[14:15], v56 offset:8448
    s_xor_b32 s94, s13, 2
    s_mul_i32 s94, s94, 36864
    s_add_u32 s94, s94, s92
    s_lshr_b32 s74, s13, 1
    s_lshl_b32 s74, s74, 6
    s_add_u32 s94, s94, s74
    s_add_u32 s78, s94, 1024
    s_mov_b32 s77, 16384
    s_call_b64 s[82:83], cs_dma
    s_waitcnt lgkmcnt(0)
    ds_write_b128 v61, v[0:3] offset:0
    ds_write_b128 v61, v[4:7] offset:4096
    ds_write_b128 v61, v[8:11] offset:8192
    ds_write_b128 v61, v[12:15] offset:12288
    s_waitcnt lgkmcnt(0)
    v_add_u32 v55, 16384, v51
    v_xor_b32 v56, 32, v55
    ds_read_b64_tr_b16 v[0:1], v55 offset:0
    ds_read_b64_tr_b16 v[2:3], v55 offset:256
    ds_read_b64_tr_b16 v[4:5], v55 offset:8192
    ds_read_b64_tr_b16 v[6:7], v55 offset:8448
    s_xor_b32 s94, s13, 3
    s_mul_i32 s94, s94, 36864
    s_add_u32 s94, s94, s92
    s_lshl_b32 s74, s13, 7
    s_add_u32 s94, s94, s74
    s_add_u32 s78, s94, 512
    v_mov_b32 v58, v49
    s_mov_b32 s79, 9216
    s_add_u32 s80, s66, 131072
    s_mov_b32 s76, 0
    s_mov_b32 s77, 8192
    s_call_b64 s[82:83], cs_dma
    ds_read_b64_tr_b16 v[8:9], v56 offset:0
    ds_read_b64_tr_b16 v[10:11], v56 offset:256
    ds_read_b64_tr_b16 v[12:13], v56 offset:8192
    ds_read_b64_tr_b16 v[14:15], v56 offset:8448
    s_mov_b32 s77, 16384
    s_call_b64 s[82:83], cs_dma
    s_waitcnt lgkmcnt(0)
    ds_write_b128 v61, v[0:3] offset:16384
    ds_write_b128 v61, v[4:7] offset:20480
    ds_write_b128 v61, v[8:11] offset:24576
    ds_write_b128 v61, v[12:15] offset:28672
    s_waitcnt lgkmcnt(0)
    s_waitcnt vmcnt(8)
    v_add_u32 v55, 32768, v51
    v_xor_b32 v56, 32, v55
    ds_read_b64_tr_b16 v[0:1], v55 offset:0
    ds_read_b64_tr_b16 v[2:3], v55 offset:256
    ds_read_b64_tr_b16 v[4:5], v55 offset:8192
    ds_read_b64_tr_b16 v[6:7], v55 offset:8448
    s_xor_b32 s94, s13, 2
    s_mul_i32 s94, s94, 36864
    s_add_u32 s94, s94, s92
    s_lshl_b32 s74, s13, 7
    s_add_u32 s94, s94, s74
    s_add_u32 s78, s94, 512
    s_add_u32 s80, s66, 114688
    s_mov_b32 s76, 0
    s_mov_b32 s77, 8192
    s_call_b64 s[82:83], cs_dma
    ds_read_b64_tr_b16 v[8:9], v56 offset:0
    ds_read_b64_tr_b16 v[10:11], v56 offset:256
    ds_read_b64_tr_b16 v[12:13], v56 offset:8192
    ds_read_b64_tr_b16 v[14:15], v56 offset:8448
    s_mov_b32 s77, 16384
    s_call_b64 s[82:83], cs_dma
    s_waitcnt lgkmcnt(0)
    ds_write_b128 v61, v[0:3] offset:32768
    ds_write_b128 v61, v[4:7] offset:36864
    ds_write_b128 v61, v[8:11] offset:40960
    ds_write_b128 v61, v[12:15] offset:45056
    s_waitcnt lgkmcnt(0)
    v_add_u32 v55, 49152, v51
    v_xor_b32 v56, 32, v55
    ds_read_b64_tr_b16 v[0:1], v55 offset:0
    ds_read_b64_tr_b16 v[2:3], v55 offset:256
    ds_read_b64_tr_b16 v[4:5], v55 offset:8192
    ds_read_b64_tr_b16 v[6:7], v55 offset:8448
    s_add_u32 s78, s67, 4194304
    s_mov_b64 s[8:9], s[52:53]
    v_mov_b32 v58, v48
    s_mov_b32 s79, 131072
    s_add_u32 s80, s66, 81920
    s_mov_b32 s76, 0
    s_mov_b32 s77, 8192
    s_call_b64 s[82:83], cs_dma
    ds_read_b64_tr_b16 v[8:9], v56 offset:0
    ds_read_b64_tr_b16 v[10:11], v56 offset:256
    ds_read_b64_tr_b16 v[12:13], v56 offset:8192
    ds_read_b64_tr_b16 v[14:15], v56 offset:8448
    s_mov_b32 s77, 16384
    s_call_b64 s[82:83], cs_dma
    s_waitcnt lgkmcnt(0)
    ds_write_b128 v61, v[0:3] offset:49152
    ds_write_b128 v61, v[4:7] offset:53248
    ds_write_b128 v61, v[8:11] offset:57344
    ds_write_b128 v61, v[12:15] offset:61440
    s_waitcnt lgkmcnt(0)
    buffer_load_dword v38, off, s[96:99], 0 offset:216 sc1
    buffer_load_dword v39, off, s[96:99], 0 offset:64 sc1
    s_lshr_b32 s84, s12, 1
    s_lshl_b32 s84, s84, 8
    s_add_u32 s84, s84, 125829120
    v_bfe_u32 v40, v61, 4, 6
    v_min_u32 v40, 11, v40
    v_lshlrev_b32 v40, 2, v40
    buffer_load_dword v41, v40, s[4:7], s84 offen sc1
    s_waitcnt vmcnt(15)
    v_add_u32 v55, 147456, v53
    ds_read_b64_tr_b16 v[0:1], v55 offset:0
    ds_read_b64_tr_b16 v[2:3], v55 offset:128
    ds_read_b64_tr_b16 v[4:5], v55 offset:512
    ds_read_b64_tr_b16 v[6:7], v55 offset:640
    ds_read_b64_tr_b16 v[8:9], v55 offset:8192
    ds_read_b64_tr_b16 v[10:11], v55 offset:8320
    ds_read_b64_tr_b16 v[12:13], v55 offset:8704
    ds_read_b64_tr_b16 v[14:15], v55 offset:8832
    s_waitcnt lgkmcnt(0)
    s_barrier
    ds_write_b128 v63, v[0:3] offset:49152
    ds_write_b128 v63, v[4:7] offset:53248
    s_barrier
    ds_write_b128 v63, v[8:11] offset:57344
    ds_write_b128 v63, v[12:15] offset:61440
    s_waitcnt lgkmcnt(0)
    s_waitcnt vmcnt(11)
    v_add_u32 v55, 131072, v52
    ds_read_b64_tr_b16 v[0:1], v55 offset:0
    ds_read_b64_tr_b16 v[2:3], v55 offset:256
    ds_read_b64_tr_b16 v[4:5], v55 offset:4096
    ds_read_b64_tr_b16 v[6:7], v55 offset:4352
    ds_read_b64_tr_b16 v[8:9], v55 offset:64
    ds_read_b64_tr_b16 v[10:11], v55 offset:320
    ds_read_b64_tr_b16 v[12:13], v55 offset:4160
    ds_read_b64_tr_b16 v[14:15], v55 offset:4416
    s_waitcnt lgkmcnt(0)
    s_barrier
    ds_write_b128 v63, v[0:3] offset:32768
    ds_write_b128 v63, v[4:7] offset:36864
    s_barrier
    ds_write_b128 v63, v[8:11] offset:40960
    ds_write_b128 v63, v[12:15] offset:45056
    s_waitcnt lgkmcnt(0)
    s_waitcnt vmcnt(7)
    v_add_u32 v55, 114688, v52
    ds_read_b64_tr_b16 v[0:1], v55 offset:0
    ds_read_b64_tr_b16 v[2:3], v55 offset:256
    ds_read_b64_tr_b16 v[4:5], v55 offset:4096
    ds_read_b64_tr_b16 v[6:7], v55 offset:4352
    ds_read_b64_tr_b16 v[8:9], v55 offset:64
    ds_read_b64_tr_b16 v[10:11], v55 offset:320
    ds_read_b64_tr_b16 v[12:13], v55 offset:4160
    ds_read_b64_tr_b16 v[14:15], v55 offset:4416
    s_waitcnt lgkmcnt(0)
    s_barrier
    ds_write_b128 v63, v[0:3] offset:16384
    ds_write_b128 v63, v[4:7] offset:20480
    s_barrier
    ds_write_b128 v63, v[8:11] offset:24576
    ds_write_b128 v63, v[12:15] offset:28672
    s_waitcnt lgkmcnt(0)
    buffer_load_dword v30, v79, s[4:7], s14 offen sc1
    s_lshl_b32 s40, s12, 14
    s_add_u32 s40, s40, 68222976
    buffer_load_dword v30, v79, s[4:7], s40 offen sc1
    s_and_b32 s40, s12, 3
    s_lshl_b32 s40, s40, 14
    s_add_u32 s40, s40, 68157440
    buffer_load_dword v30, v79, s[4:7], s40 offen sc1
    s_waitcnt vmcnt(1)
    v_readfirstlane_b32 s95, v39
    v_readfirstlane_b32 s85, v38
    s_add_u32 s86, s95, 2
    s_waitcnt vmcnt(0)
    v_subrev_u32 v41, s86, v41
    v_cmp_lt_u32 s[86:87], 64, v41
    s_cmp_eq_u32 s95, 0
    s_cselect_b64 s[86:87], -1, s[86:87]
    s_cmp_lg_u64 s[86:87], 0
    s_cbranch_scc1 cs_nt
    s_add_u32 s40, s24, 524288
    buffer_load_dword v30, v79, s[4:7], s24 offen sc1
    buffer_load_dword v30, v79, s[4:7], s40 offen sc1
cs_nt:
    s_waitcnt vmcnt(3)
    v_add_u32 v55, 81920, v51
    v_xor_b32 v56, 32, v55
    ds_read_b64_tr_b16 v[0:1], v55 offset:0
    ds_read_b64_tr_b16 v[2:3], v55 offset:256
    ds_read_b64_tr_b16 v[4:5], v55 offset:8192
    ds_read_b64_tr_b16 v[6:7], v55 offset:8448
    ds_read_b64_tr_b16 v[8:9], v56 offset:0
    ds_read_b64_tr_b16 v[10:11], v56 offset:256
    ds_read_b64_tr_b16 v[12:13], v56 offset:8192
    ds_read_b64_tr_b16 v[14:15], v56 offset:8448
    s_waitcnt lgkmcnt(0)
    ds_write_b128 v62, v[0:3] offset:24576
    ds_write_b128 v62, v[4:7] offset:28672
    ds_write_b128 v62, v[8:11] offset:32768
    ds_write_b128 v62, v[12:15] offset:36864
    s_waitcnt lgkmcnt(0)
    s_barrier
    s_mov_b32 s88, 4194304
gn3:
    s_cmp_lg_u32 s95, 0
    s_cbranch_scc1 gn3x
    buffer_load_dword v24, off, s[96:99], 0 offset:64 sc1
    s_sub_u32 s88, s88, 1
    s_cbranch_scc1 gn3x
    s_waitcnt vmcnt(0)
    v_readfirstlane_b32 s95, v24
    s_nop 1
    s_branch gn3
gn3x:
    ds_write_b128 v78, v[16:19] offset:8704
    ds_write_b128 v65, v[20:23] offset:10240
    v_mov_b32 v44, s95
    v_mov_b32 v45, s95
    v_mov_b32 v46, s95
    v_mov_b32 v47, s95
    v_mov_b32 v48, 108288
    ds_write_b128 v48, v[44:47]
    s_waitcnt vmcnt(0) lgkmcnt(0)
    s_cmp_eq_u32 s85, 1
    s_cbranch_scc1 cs_run
    s_mov_b32 s40, 16777216
cs_startpoll:
    buffer_load_dword v3, off, s[96:99], 0 offset:216 sc1
    s_waitcnt vmcnt(0)
    v_readfirstlane_b32 s85, v3
    s_nop 0
    s_cmp_eq_u32 s85, 1
    s_cbranch_scc1 cs_run
    s_sleep 1
    s_sub_u32 s40, s40, 1
    s_cbranch_scc0 cs_startpoll
    s_endpgm
cs_run:
    s_cmp_eq_u64 s[86:87], 0
    s_cbranch_scc1 cs_kvok
    s_lshr_b32 s92, s12, 1
    s_lshl_b32 s92, s92, 8
    s_add_u32 s92, s92, 125829120
    v_bfe_u32 v2, v61, 4, 6
    v_min_u32 v2, 11, v2
    v_lshlrev_b32 v2, 2, v2
    s_add_u32 s93, s95, 2
    s_mov_b32 s94, 4194304
cs_kv0:
    buffer_load_dword v3, v2, s[4:7], s92 offen sc1
    s_sub_u32 s94, s94, 1
    s_cbranch_scc1 cs_kv0_go
    s_waitcnt vmcnt(0)
    v_subrev_u32 v3, s93, v3
    v_cmp_lt_u32 vcc, 64, v3
    s_cbranch_vccz cs_kv0_go
    s_sleep 2
    s_branch cs_kv0
cs_kv0_go:
    s_add_u32 s40, s24, 524288
    buffer_load_dword v30, v79, s[4:7], s24 offen sc1
    buffer_load_dword v30, v79, s[4:7], s40 offen sc1
    s_waitcnt vmcnt(0)
cs_kvok:
    s_mov_b32 m0, 108032
    s_add_u32 s24, s24, 1048576
    s_add_u32 s15, s14, 4096
    s_add_u32 s16, s14, 8192
    ds_read_b128 v[32:35], v62 offset:16384
    ds_read_b128 v[36:39], v62 offset:20480
    ds_read_b128 v[40:43], v61 offset:0
    ds_read_b128 v[44:47], v61 offset:4096
    ds_read_b128 v[48:51], v61 offset:8192
    ds_read_b128 v[52:55], v61 offset:12288
    s_mov_b32 s29, 1048576
    buffer_load_dwordx4 v[24:27], v61, s[4:7], s14 offen sc1
.p2align 6
cs_loop:
    v_mov_b64 v[0:1], 0
    v_mov_b64 v[2:3], 0
    v_mov_b64 v[4:5], 0
    v_mov_b64 v[6:7], 0
    v_mov_b64 v[8:9], 0
    v_mov_b64 v[10:11], 0
    v_mov_b64 v[12:13], 0
    v_mov_b64 v[14:15], 0
cs_loop2:
    ds_read_b128 v[16:19], v62 offset:8192
    ds_read_b128 v[20:23], v62 offset:12288
    v_lshrrev_b32 v56, 2, v61
    v_add_u32 v58, 106496, v56
    s_mov_b32 s29, 1048576
    s_waitcnt lgkmcnt(0)
cs_chk0:
    s_waitcnt vmcnt(0)
cs_chk0b:
    v_max3_u32 v57, v24, v25, v26
    v_max_u32 v57, v57, v27
    v_cmp_eq_u32 vcc, -1, v57
    ds_write_b128 v62, v[24:27] offset:40960
    s_cbranch_vccnz cs_spin0
    v_smfmac_f32_16x16x64_bf16 v[0:3], v[24:27], v[16:23], v60
    buffer_load_dwordx4 v[28:31], v61, s[4:7], s15 offen sc1
    buffer_load_dword v59, v56, s[4:7], s16 offen sc1
    v_smfmac_f32_16x16x64_bf16 v[8:11], v[24:27], v[32:39], v60
    ds_read_b128 v[32:35], v61 offset:16384
    v_smfmac_f32_16x16x64_bf16 v[12:15], v[24:27], v[48:55], v60
    ds_read_b128 v[36:39], v61 offset:20480
    v_mfma_f32_16x16x16_bf16 v[16:19], v[72:73], v[72:73], 0
    s_waitcnt lgkmcnt(2)
    s_barrier
    ds_read_b128 v[48:51], v63 offset:0
    v_mfma_f32_16x16x16_bf16 v[20:23], v[72:73], v[72:73], 0
    ds_read_b128 v[52:55], v64 offset:0
    v_smfmac_f32_16x16x64_bf16 v[4:7], v[24:27], v[40:47], v60
    ds_read_b128 v[40:43], v61 offset:24576
    v_smfmac_f32_16x16x64_bf16 v[16:19], v[24:27], a[192:199], v60
    ds_read_b128 v[44:47], v61 offset:28672
    v_smfmac_f32_16x16x64_bf16 v[20:23], v[24:27], a[200:207], v60
    s_waitcnt lgkmcnt(3)
    v_smfmac_f32_16x16x64_bf16 v[0:3], v[48:51], a[0:7], v60
    s_add_u32 s18, s14, s31
    s_add_u32 s41, s14, 16384
    v_smfmac_f32_16x16x64_bf16 v[4:7], v[48:51], v[32:39], v60
    ds_read_b128 v[32:35], v61 offset:32768
    v_smfmac_f32_16x16x64_bf16 v[8:11], v[48:51], a[8:15], v60
    ds_read_b128 v[36:39], v61 offset:36864
    s_waitcnt lgkmcnt(2)
    v_smfmac_f32_16x16x64_bf16 v[12:15], v[48:51], v[40:47], v60
    ds_read_b128 v[40:43], v61 offset:40960
    v_smfmac_f32_16x16x64_bf16 v[0:3], v[52:55], a[16:23], v60
    ds_read_b128 v[44:47], v61 offset:45056
    v_smfmac_f32_16x16x64_bf16 v[8:11], v[52:55], a[24:31], v60
    ds_read_b128 v[48:51], v71 offset:0
    s_waitcnt lgkmcnt(3)
    v_smfmac_f32_16x16x64_bf16 v[4:7], v[52:55], v[32:39], v60
    s_waitcnt vmcnt(0)
    ds_write_b128 v62, v[28:31] offset:45056
    s_waitcnt lgkmcnt(2)
    v_smfmac_f32_16x16x64_bf16 v[12:15], v[52:55], v[40:47], v60
    ds_write_b32 v58, v59
    v_max3_u32 v57, v28, v29, v30
    s_waitcnt lgkmcnt(2)
    v_smfmac_f32_16x16x64_bf16 v[0:3], v[48:51], a[32:39], v60
    ds_read_b128 v[32:35], v61 offset:49152
    v_max3_u32 v57, v57, v31, v59
    v_smfmac_f32_16x16x64_bf16 v[8:11], v[48:51], a[40:47], v60
    ds_read_b128 v[36:39], v61 offset:53248
    v_cmp_eq_u32 vcc, -1, v57
    v_smfmac_f32_16x16x64_bf16 v[16:19], v[52:55], a[224:231], v60
    ds_read_b128 v[40:43], v61 offset:57344
    v_smfmac_f32_16x16x64_bf16 v[20:23], v[52:55], a[232:239], v60
    ds_read_b128 v[44:47], v61 offset:61440
    s_cbranch_vccnz cs_spin1
cs_go1:
    v_smfmac_f32_16x16x64_bf16 v[0:3], v[28:31], a[48:55], v60
    s_waitcnt lgkmcnt(4)
    s_barrier
    ds_read_b128 v[52:55], v63 offset:4096
    v_smfmac_f32_16x16x64_bf16 v[8:11], v[28:31], a[56:63], v60
    ds_read_b128 v[56:59], v71 offset:4096
    v_smfmac_f32_16x16x64_bf16 v[4:7], v[28:31], a[128:135], v60
    s_waitcnt lgkmcnt(2)
    v_smfmac_f32_16x16x64_bf16 v[4:7], v[48:51], v[32:39], v60
    buffer_load_dwordx4 v[32:35], v61, s[4:7], s23 offen offset:0 sc1
    v_smfmac_f32_16x16x64_bf16 v[12:15], v[48:51], v[40:47], v60
    ds_read_b128 v[48:51], v64 offset:4096
    v_smfmac_f32_16x16x64_bf16 v[12:15], v[28:31], a[136:143], v60
    ds_read_b128 v[24:27], v65 offset:8192
    s_and_b32 s41, s41, 65535
    s_add_u32 s41, s41, 68157440
    v_smfmac_f32_16x16x64_bf16 v[16:19], v[28:31], v[80:87], v60
    buffer_load_dwordx4 v[36:39], v61, s[4:7], s23 offen offset:1024 sc1
    v_smfmac_f32_16x16x64_bf16 v[20:23], v[28:31], v[88:95], v60
    s_add_u32 s17, s41, s31
    s_and_b32 s30, s28, 1
    s_waitcnt lgkmcnt(3)
    v_smfmac_f32_16x16x64_bf16 v[0:3], v[52:55], a[64:71], v60
    ds_read_b128 v[28:31], v78 offset:8704
    v_smfmac_f32_16x16x64_bf16 v[4:7], v[52:55], a[144:151], v60
    buffer_load_dwordx4 v[40:43], v61, s[4:7], s23 offen offset:2048 sc1
    v_smfmac_f32_16x16x64_bf16 v[8:11], v[52:55], a[72:79], v60
    v_smfmac_f32_16x16x64_bf16 v[12:15], v[52:55], a[152:159], v60
    v_smfmac_f32_16x16x64_bf16 v[16:19], v[52:55], v[96:103], v60
    buffer_load_dwordx4 v[44:47], v61, s[4:7], s23 offen offset:3072 sc1
    v_smfmac_f32_16x16x64_bf16 v[20:23], v[52:55], v[104:111], v60
    ds_read_b128 v[52:55], v62 offset:28672
    s_waitcnt lgkmcnt(3)
    v_smfmac_f32_16x16x64_bf16 v[0:3], v[48:51], a[80:87], v60
    v_smfmac_f32_16x16x64_bf16 v[4:7], v[48:51], a[160:167], v60
    v_smfmac_f32_16x16x64_bf16 v[8:11], v[48:51], a[88:95], v60
    v_smfmac_f32_16x16x64_bf16 v[12:15], v[48:51], a[168:175], v60
    v_smfmac_f32_16x16x64_bf16 v[16:19], v[48:51], v[112:119], v60
    buffer_load_dword v79, s[4:7], s24 offen sc1 lds
    v_smfmac_f32_16x16x64_bf16 v[20:23], v[48:51], v[120:127], v60
    ds_read_b128 v[48:51], v62 offset:24576
    v_smfmac_f32_16x16x64_bf16 v[0:3], v[56:59], a[96:103], v60
    s_cmp_ge_u32 s28, 62
    v_smfmac_f32_16x16x64_bf16 v[8:11], v[56:59], a[104:111], v60
    s_waitcnt lgkmcnt(3)
    v_smfmac_f32_16x16x64_bf16 v[0:3], v[24:27], a[112:119], v60
    v_smfmac_f32_16x16x64_bf16 v[8:11], v[24:27], a[120:127], v60
    v_smfmac_f32_16x16x64_bf16 v[4:7], v[56:59], a[176:183], v60
    s_waitcnt lgkmcnt(0)
    v_cvt_pk_bf16_f32 v0, v0, v1
    v_smfmac_f32_16x16x64_bf16 v[4:7], v[24:27], v[48:55], v60
    ds_read_b128 v[48:51], v62 offset:32768
    v_cvt_pk_bf16_f32 v8, v8, v9
    v_smfmac_f32_16x16x64_bf16 v[12:15], v[56:59], a[184:191], v60
    ds_read_b128 v[52:55], v62 offset:36864
    v_cvt_pk_bf16_f32 v9, v10, v11
    v_smfmac_f32_16x16x64_bf16 v[16:19], v[56:59], v[128:135], v60
    v_cvt_pk_bf16_f32 v1, v2, v3
    v_mfma_f32_16x16x16_bf16 v[8:11], v[8:9], v[28:29], 0
    v_cvt_pk_bf16_f32 v2, v4, v5
    v_cvt_pk_bf16_f32 v3, v6, v7
    v_smfmac_f32_16x16x64_bf16 v[20:23], v[56:59], v[136:143], v60
    s_mov_b64 exec, s[36:37]
    ds_read_b128 v[56:59], v69
    s_mov_b64 exec, -1
    v_mfma_f32_16x16x32_bf16 v[4:7], v[0:3], v[28:31], 0
    v_cvt_pk_bf16_f32 v2, v8, v9
    s_waitcnt lgkmcnt(1)
    v_smfmac_f32_16x16x64_bf16 v[12:15], v[24:27], v[48:55], v60
    ds_read_b128 v[48:51], v63 offset:0
    v_cvt_pk_bf16_f32 v3, v10, v11
    s_waitcnt vmcnt(3)
    v_cvt_pk_bf16_f32 v0, v4, v5
    v_cvt_pk_bf16_f32 v1, v6, v7
    s_nop 1
    v_mfma_f32_16x16x32_bf16 v[4:7], v[36:39], v[0:3], 0
    v_cvt_pk_bf16_f32 v12, v12, v13
    v_cvt_pk_bf16_f32 v13, v14, v15
    s_nop 1
    v_mfma_f32_16x16x16_bf16 v[12:15], v[12:13], v[30:31], 0
    ds_read_b128 v[52:55], v71 offset:0
    ds_read_b128 v[36:39], v63 offset:53248
    v_mfma_f32_16x16x32_bf16 v[28:31], v[32:35], v[0:3], 0
    s_waitcnt vmcnt(1)
    ds_read_b128 v[32:35], v63 offset:49152
    s_mov_b64 exec, s[34:35]
    s_nop 0
    v_cvt_pk_bf16_f32 v2, v12, v13
    v_cvt_pk_bf16_f32 v3, v14, v15
    s_mov_b64 exec, -1
    s_nop 0
    v_mfma_f32_16x16x32_bf16 v[8:11], v[0:3], v[0:3], 0
    v_mov_b32_dpp v28, v4 row_ror:8 row_mask:0xf bank_mask:0xc
    v_mov_b32_dpp v29, v5 row_ror:8 row_mask:0xf bank_mask:0xc
    v_mov_b32_dpp v30, v6 row_ror:8 row_mask:0xf bank_mask:0xc
    v_mov_b32_dpp v31, v7 row_ror:8 row_mask:0xf bank_mask:0xc
    v_smfmac_f32_16x16x64_bf16 v[16:19], v[24:27], v[144:151], v60
    ds_write_b128 v62, v[28:31] offset:53248
    v_mov_b32_dpp v8, v10 row_ror:8 row_mask:0xf bank_mask:0xc
    v_mov_b32_dpp v9, v11 row_ror:8 row_mask:0xf bank_mask:0xc
    v_smfmac_f32_16x16x64_bf16 v[20:23], v[24:27], v[152:159], v60
    ds_write_b64 v70, v[8:9]
    s_waitcnt lgkmcnt(5)
    v_smfmac_f32_16x16x64_bf16 v[16:19], v[48:51], a[208:215], v60
    s_mov_b64 exec, s[36:37]
    s_cbranch_execz cs_np3558
    buffer_store_dwordx4 v[56:59], v61, s[4:7], s65 offen sc1
cs_np3558:
    s_mov_b64 exec, -1
    v_smfmac_f32_16x16x64_bf16 v[20:23], v[48:51], a[216:223], v60
    s_cbranch_scc1 cs_last
cs_back:
    s_waitcnt lgkmcnt(0)
    s_barrier
    ds_read_b128 v[56:59], v78 offset:10752
    v_smfmac_f32_16x16x64_bf16 v[16:19], v[52:55], a[240:247], v60
    ds_read_b128 v[12:15], v78 offset:11264
    ds_read_b128 v[4:7], v63 offset:12288
    v_smfmac_f32_16x16x64_bf16 v[20:23], v[52:55], a[248:255], v60
    ds_read_b128 v[8:11], v64 offset:12288
    ds_read_b128 v[0:3], v71 offset:12288
    v_mov_b64 v[24:25], s[62:63]
    v_mov_b64 v[26:27], s[60:61]
    v_cvt_pk_bf16_f32 v16, v16, v17
    v_cvt_pk_bf16_f32 v17, v18, v19
    v_pk_mul_f32 v[28:29], v[28:29], s[44:45]
    v_pk_mul_f32 v[30:31], v[30:31], s[44:45]
    s_waitcnt lgkmcnt(3)
    v_pk_add_f32 v[56:57], v[56:57], v[58:59]
    v_pk_add_f32 v[12:13], v[12:13], v[14:15]
    v_pk_add_f32 v[56:57], v[56:57], v[12:13]
    v_pk_mul_f32 v[56:57], v[56:57], s[44:45]
    v_exp_f32 v58, v56
    v_exp_f32 v59, v57
    s_waitcnt lgkmcnt(1)
    v_pk_fma_f32 v[28:29], v[4:5], s[44:45], v[28:29]
    v_pk_fma_f32 v[30:31], v[6:7], s[44:45], v[30:31]
    v_cvt_pk_bf16_f32 v6, v58, v59
    v_pk_fma_f32 v[28:29], v[8:9], s[44:45], v[28:29]
    v_pk_fma_f32 v[30:31], v[10:11], s[44:45], v[30:31]
    s_waitcnt lgkmcnt(0)
    v_pk_fma_f32 v[28:29], v[0:1], s[44:45], v[28:29]
    v_mov_b32_dpp v7, v6 row_ror:8 row_mask:0xf bank_mask:0xf
    v_pk_fma_f32 v[30:31], v[2:3], s[44:45], v[30:31]
    v_exp_f32 v0, v28
    v_mfma_f32_16x16x16_bf16 v[12:15], v[16:17], v[6:7], 0
    ds_read_b128 v[48:51], v63 offset:57344
    v_exp_f32 v1, v29
    v_cvt_pk_bf16_f32 v18, v20, v21
    v_exp_f32 v2, v30
    v_cvt_pk_bf16_f32 v19, v22, v23
    v_cvt_pk_bf16_f32 v8, v0, v1
    v_exp_f32 v3, v31
    v_mfma_f32_16x16x16_bf16 v[20:23], v[18:19], v[6:7], 0
    ds_read_b128 v[52:55], v63 offset:61440
    v_cvt_pk_bf16_f32 v9, v2, v3
    v_mov_b32_dpp v10, v8 row_ror:8 row_mask:0xf bank_mask:0xf
    v_max3_f32 v4, |v28|, |v29|, |v30|
    v_mov_b32_dpp v11, v9 row_ror:8 row_mask:0xf bank_mask:0xf
    v_mfma_f32_16x16x32_bf16 v[0:3], v[24:27], v[6:9], 0
    v_max3_f32 v4, v4, |v31|, |v56|
    v_max_f32_e64 v4, v4, |v57|
    v_mfma_f32_16x16x32_bf16 v[12:15], v[40:43], v[8:11], v[12:15]
    v_cmp_nge_f32 vcc, s46, v4
    v_mfma_f32_16x16x32_bf16 v[20:23], v[44:47], v[8:11], v[20:23]
    v_add_f32_dpp v0, v0, v0 row_ror:8 row_mask:0xf bank_mask:0xf
    v_rcp_f32 v0, v0
    s_cbranch_vccnz cs_guard
cs_norm:
    v_mfma_f32_16x16x16_bf16 v[28:31], v[72:73], v[72:73], 0
    v_mul_f32 v12, v12, v0
    v_mul_f32 v13, v13, v0
    v_mul_f32 v14, v14, v0
    v_mul_f32 v15, v15, v0
    v_mul_f32_dpp v12, v20, v0 row_ror:8 row_mask:0xf bank_mask:0xc
    v_mul_f32_dpp v13, v21, v0 row_ror:8 row_mask:0xf bank_mask:0xc
    v_mul_f32_dpp v14, v22, v0 row_ror:8 row_mask:0xf bank_mask:0xc
    v_mul_f32_dpp v15, v23, v0 row_ror:8 row_mask:0xf bank_mask:0xc
    v_cvt_pk_bf16_f32 v12, v12, v13
    v_cvt_pk_bf16_f32 v13, v14, v15
    v_mfma_f32_16x16x16_bf16 v[8:11], v[72:73], v[72:73], 0
    ds_write_b64 v77, v[12:13]
    v_mfma_f32_16x16x16_bf16 v[4:7], v[72:73], v[72:73], 0
    ds_read_b128 v[0:3], v68
    v_mfma_f32_16x16x16_bf16 v[16:19], v[72:73], v[72:73], 0
    ds_read_b128 v[40:43], v63 offset:16384
    v_mfma_f32_16x16x16_bf16 v[20:23], v[72:73], v[72:73], 0
    ds_read_b128 v[44:47], v63 offset:20480
    s_waitcnt lgkmcnt(3)
    s_barrier
    ds_read_b128 v[24:27], v74
    ds_read_b128 v[12:15], v75
    ds_read_b128 v[56:59], v76
    s_waitcnt lgkmcnt(5)
    v_smfmac_f32_16x16x64_bf16 v[28:31], v[0:3], v[160:167], v60
    v_smfmac_f32_16x16x64_bf16 v[8:11], v[0:3], v[192:199], v60
    v_smfmac_f32_16x16x64_bf16 v[4:7], v[0:3], v[32:39], v60
    ds_read_b128 v[32:35], v63 offset:32768
    v_smfmac_f32_16x16x64_bf16 v[16:19], v[0:3], v[224:231], v60
    ds_read_b128 v[36:39], v63 offset:36864
    s_waitcnt lgkmcnt(3)
    v_smfmac_f32_16x16x64_bf16 v[28:31], v[24:27], v[168:175], v60
    v_smfmac_f32_16x16x64_bf16 v[4:7], v[12:15], v[48:55], v60
    ds_read_b128 v[48:51], v63 offset:24576
    v_smfmac_f32_16x16x64_bf16 v[28:31], v[12:15], v[176:183], v60
    ds_read_b128 v[52:55], v63 offset:28672
    s_waitcnt lgkmcnt(4)
    v_smfmac_f32_16x16x64_bf16 v[28:31], v[56:59], v[184:191], v60
    v_cvt_pk_bf16_f32 v4, v4, v5
    v_smfmac_f32_16x16x64_bf16 v[16:19], v[12:15], v[40:47], v60
    ds_read_b128 v[40:43], v63 offset:40960
    v_and_or_b32 v4, v4, -2, s30
    v_smfmac_f32_16x16x64_bf16 v[8:11], v[24:27], v[200:207], v60
    ds_read_b128 v[44:47], v63 offset:45056
    v_cvt_pk_bf16_f32 v5, v6, v7
    v_smfmac_f32_16x16x64_bf16 v[8:11], v[12:15], v[208:215], v60
    buffer_store_dwordx2 v[4:5], v67, s[4:7], s22 offen sc1
    v_cvt_pk_bf16_f32 v28, v28, v29
    v_smfmac_f32_16x16x64_bf16 v[8:11], v[56:59], v[216:223], v60
    v_and_or_b32 v28, v28, -2, s30
    v_smfmac_f32_16x16x64_bf16 v[16:19], v[24:27], v[232:239], v60
    v_cvt_pk_bf16_f32 v29, v30, v31
    s_waitcnt lgkmcnt(4)
    v_smfmac_f32_16x16x64_bf16 v[16:19], v[56:59], v[32:39], v60
    buffer_store_dwordx2 v[28:29], v66, s[4:7], s20 offen sc1
    v_cvt_pk_bf16_f32 v8, v8, v9
    s_waitcnt lgkmcnt(0)
    v_smfmac_f32_16x16x64_bf16 v[20:23], v[0:3], v[240:247], v60
    v_and_or_b32 v8, v8, -2, s30
    v_smfmac_f32_16x16x64_bf16 v[20:23], v[24:27], v[248:255], v60
    v_cvt_pk_bf16_f32 v9, v10, v11
    v_smfmac_f32_16x16x64_bf16 v[20:23], v[12:15], v[48:55], v60
    buffer_store_dwordx2 v[8:9], v66, s[4:7], s21 offen sc1
    v_cvt_pk_bf16_f32 v16, v16, v17
    v_smfmac_f32_16x16x64_bf16 v[20:23], v[56:59], v[40:47], v60
    v_and_or_b32 v16, v16, -2, s30
    v_cvt_pk_bf16_f32 v17, v18, v19
    buffer_store_dwordx2 v[16:17], v66, s[4:7], s38 offen sc1
    s_cmp_lg_u32 s13, 2
    s_nop 1
    v_cvt_pk_bf16_f32 v20, v20, v21
    v_and_or_b32 v20, v20, -2, s30
    v_cvt_pk_bf16_f32 v21, v22, v23
    buffer_store_dwordx2 v[20:21], v66, s[4:7], s39 offen sc1
    s_cbranch_scc1 cs_w013
    s_nop 15
    s_nop 15
    s_nop 15
    s_nop 15
    s_nop 15
    s_nop 15
    s_nop 15
    s_nop 15
    s_nop 15
    s_nop 15
    s_nop 15
    s_nop 15
    s_nop 7
    buffer_load_dwordx4 v[40:43], v65, s[4:7], s19 offen offset:0 sc1
    buffer_load_dwordx4 v[44:47], v65, s[4:7], s19 offen offset:1024 sc1
    buffer_load_dwordx4 v[48:51], v65, s[4:7], s19 offen offset:2048 sc1
    buffer_load_dwordx4 v[52:55], v65, s[4:7], s19 offen offset:3072 sc1
    ds_read_b128 v[56:59], v65 offset:10240
    s_add_u32 s28, s28, 1
    s_mov_b32 s14, s41
    s_add_u32 s23, s23, 524288
    s_add_u32 s24, s24, 524288
    s_min_u32 s24, s24, s47
    s_add_u32 s15, s14, 4096
    s_add_u32 s16, s14, 8192
    v_mov_b32 v21, -1
    s_add_u32 s65, s65, 12288
    s_mov_b32 s40, 1
    v_mov_b64 v[0:1], 0
    v_mov_b64 v[2:3], 0
    v_mov_b64 v[4:5], 0
    v_mov_b64 v[6:7], 0
    v_mov_b64 v[8:9], 0
    v_mov_b64 v[10:11], 0
    v_mov_b64 v[12:13], 0
    v_mov_b64 v[14:15], 0
cs_chkF:
    v_mov_b32 v20, 0
    s_waitcnt vmcnt(3)
    s_waitcnt lgkmcnt(0)
    v_mfma_f32_16x16x32_bf16 v[28:31], v[40:43], v[56:59], 0
    v_bitop3_b32 v20, v20, v40, s30 bitop3:0xf6
    v_bitop3_b32 v20, v20, v42, s30 bitop3:0xf6
    s_waitcnt vmcnt(2)
    v_mfma_f32_16x16x32_bf16 v[28:31], v[44:47], v[56:59], v[28:31]
    v_bitop3_b32 v20, v20, v44, s30 bitop3:0xf6
    v_bitop3_b32 v20, v20, v46, s30 bitop3:0xf6
    s_waitcnt vmcnt(1)
    v_mfma_f32_16x16x32_bf16 v[28:31], v[48:51], v[56:59], v[28:31]
    v_bitop3_b32 v20, v20, v48, s30 bitop3:0xf6
    v_bitop3_b32 v20, v20, v50, s30 bitop3:0xf6
    s_waitcnt vmcnt(0)
    v_mfma_f32_16x16x32_bf16 v[28:31], v[52:55], v[56:59], v[28:31]
    v_bitop3_b32 v20, v20, v52, s30 bitop3:0xf6
    v_bitop3_b32 v20, v20, v54, s30 bitop3:0xf6
    v_and_b32 v20, s40, v20
    v_cmp_ne_u32 vcc, 0, v20
    s_cbranch_vccnz cs_spinF
    v_permlane32_swap_b32 v28, v30
    v_permlane32_swap_b32 v29, v31
    v_add_f32 v28, v28, v30
    v_add_f32 v30, v29, v31
    v_cvt_pk_bf16_f32 v28, v28, v30
    s_mov_b64 exec, s[32:33]
    buffer_store_dword v28, v69, s[4:7], s17 offen sc1
    buffer_store_dword v21, v69, s[4:7], s18 offen sc1
    s_mov_b64 exec, -1
    ds_read_b128 v[32:35], v62 offset:16384
    ds_read_b128 v[36:39], v62 offset:20480
    ds_read_b128 v[40:43], v61 offset:0
    ds_read_b128 v[44:47], v61 offset:4096
    ds_read_b128 v[48:51], v61 offset:8192
    ds_read_b128 v[52:55], v61 offset:12288
    s_nop 15
    s_nop 15
    s_nop 15
    s_nop 15
    s_nop 15
    s_nop 15
    s_nop 3
    buffer_load_dwordx4 v[24:27], v61, s[4:7], s14 offen sc1
    s_branch cs_loop2
cs_w013:
    ds_read_b128 v[56:59], v65 offset:10240
    ds_read_b128 v[32:35], v62 offset:16384
    ds_read_b128 v[36:39], v62 offset:20480
    ds_read_b128 v[40:43], v61 offset:0
    ds_read_b128 v[44:47], v61 offset:4096
    ds_read_b128 v[48:51], v61 offset:8192
    ds_read_b128 v[52:55], v61 offset:12288
    s_add_u32 s28, s28, 1
    s_mov_b32 s14, s41
    s_add_u32 s23, s23, 524288
    s_add_u32 s24, s24, 524288
    s_min_u32 s24, s24, s47
    s_add_u32 s15, s14, 4096
    s_add_u32 s16, s14, 8192
    v_mov_b32 v21, -1
    s_add_u32 s65, s65, 12288
    s_mov_b32 s40, 1
    s_cmp_eq_u32 s64, 0
    s_cbranch_scc1 cs_w0
    s_cmp_eq_u32 s13, 1
    s_cbranch_scc1 cs_sx
    s_nop 15
    s_nop 15
    s_nop 15
    s_nop 15
    s_nop 15
    s_nop 15
    s_nop 15
    s_nop 15
    s_nop 15
    s_nop 15
    s_nop 15
    s_nop 15
    s_nop 7
cs_sx:
    buffer_load_dwordx4 v[0:3], v65, s[4:7], s19 offen offset:0 sc1
    buffer_load_dwordx4 v[4:7], v65, s[4:7], s19 offen offset:1024 sc1
    buffer_load_dwordx4 v[8:11], v65, s[4:7], s19 offen offset:2048 sc1
    buffer_load_dwordx4 v[12:15], v65, s[4:7], s19 offen offset:3072 sc1
cs_chkG:
    v_mov_b32 v20, 0
    s_waitcnt vmcnt(3)
    s_waitcnt lgkmcnt(6)
    v_mfma_f32_16x16x32_bf16 v[28:31], v[0:3], v[56:59], 0
    v_bitop3_b32 v20, v20, v0, s30 bitop3:0xf6
    v_bitop3_b32 v20, v20, v2, s30 bitop3:0xf6
    s_waitcnt vmcnt(2)
    v_mfma_f32_16x16x32_bf16 v[28:31], v[4:7], v[56:59], v[28:31]
    v_bitop3_b32 v20, v20, v4, s30 bitop3:0xf6
    v_bitop3_b32 v20, v20, v6, s30 bitop3:0xf6
    s_waitcnt vmcnt(1)
    v_mfma_f32_16x16x32_bf16 v[28:31], v[8:11], v[56:59], v[28:31]
    v_bitop3_b32 v20, v20, v8, s30 bitop3:0xf6
    v_bitop3_b32 v20, v20, v10, s30 bitop3:0xf6
    s_waitcnt vmcnt(0)
    v_mfma_f32_16x16x32_bf16 v[28:31], v[12:15], v[56:59], v[28:31]
    v_bitop3_b32 v20, v20, v12, s30 bitop3:0xf6
    v_bitop3_b32 v20, v20, v14, s30 bitop3:0xf6
    v_and_b32 v20, s40, v20
    v_cmp_ne_u32 vcc, 0, v20
    s_cbranch_vccnz cs_spinG
    v_permlane32_swap_b32 v28, v30
    v_permlane32_swap_b32 v29, v31
    v_add_f32 v28, v28, v30
    v_add_f32 v30, v29, v31
    s_cmp_eq_u32 s13, 3
    s_cbranch_scc1 cs_w3
    v_mov_b32 v29, v28
    v_mov_b32 v31, v30
    s_nop 0
    v_permlane16_swap_b32 v28, v29
    v_permlane16_swap_b32 v30, v31
    v_add_f32 v28, v28, v29
    v_add_f32 v30, v30, v31
cs_w3:
    v_cvt_pk_bf16_f32 v28, v28, v30
    s_mov_b64 exec, s[32:33]
    buffer_store_dword v28, v69, s[4:7], s17 offen sc1
    buffer_store_dword v21, v69, s[4:7], s18 offen sc1
    s_mov_b64 exec, -1
    buffer_load_dwordx4 v[24:27], v61, s[4:7], s14 offen sc1
    s_branch cs_loop
cs_w0:
    v_mov_b64 v[0:1], 0
    v_mov_b64 v[2:3], 0
    v_mov_b64 v[4:5], 0
    v_mov_b64 v[6:7], 0
    v_mov_b64 v[8:9], 0
    v_mov_b64 v[10:11], 0
    v_mov_b64 v[12:13], 0
    v_mov_b64 v[14:15], 0
    s_cmp_lg_u32 s28, 10
    s_cbranch_scc1 cs_nokv
    s_lshr_b32 s92, s12, 1
    s_lshl_b32 s92, s92, 8
    s_add_u32 s92, s92, 125829120
    v_bfe_u32 v28, v61, 4, 6
    v_min_u32 v28, 11, v28
    v_lshlrev_b32 v28, 2, v28
    s_add_u32 s93, s95, 63
    s_mov_b32 s94, 4194304
cs_kv1:
    buffer_load_dword v29, v28, s[4:7], s92 offen sc1
    s_sub_u32 s94, s94, 1
    s_cbranch_scc1 cs_kv1_go
    s_waitcnt vmcnt(0)
    v_subrev_u32 v29, s93, v29
    v_cmp_lt_u32 vcc, 64, v29
    s_cbranch_vccz cs_kv1_go
    s_sleep 2
    s_branch cs_kv1
cs_kv1_go:
cs_nokv:
    s_nop 15
    s_nop 15
    s_nop 15
    s_nop 15
    s_nop 15
    s_nop 15
    s_nop 15
    s_nop 15
    s_nop 15
    s_nop 15
    s_nop 15
    s_nop 15
    s_nop 15
    s_nop 15
    s_nop 15
    s_nop 15
    s_nop 15
    s_nop 15
    s_nop 15
    s_nop 15
    s_nop 15
    s_nop 15
    s_nop 15
    s_nop 15
    s_nop 15
    buffer_load_dwordx4 v[24:27], v61, s[4:7], s14 offen sc1
    s_branch cs_loop2
cs_spinF:
    buffer_load_dwordx4 v[40:43], v65, s[4:7], s19 offen offset:0 sc1
    buffer_load_dwordx4 v[44:47], v65, s[4:7], s19 offen offset:1024 sc1
    buffer_load_dwordx4 v[48:51], v65, s[4:7], s19 offen offset:2048 sc1
    buffer_load_dwordx4 v[52:55], v65, s[4:7], s19 offen offset:3072 sc1
    s_sub_u32 s29, s29, 1
    s_cmp_lt_i32 s29, 0
    s_cselect_b32 s40, 0, 1
    s_branch cs_chkF
cs_spinG:
    buffer_load_dwordx4 v[0:3], v65, s[4:7], s19 offen offset:0 sc1
    buffer_load_dwordx4 v[4:7], v65, s[4:7], s19 offen offset:1024 sc1
    buffer_load_dwordx4 v[8:11], v65, s[4:7], s19 offen offset:2048 sc1
    buffer_load_dwordx4 v[12:15], v65, s[4:7], s19 offen offset:3072 sc1
    s_sub_u32 s29, s29, 1
    s_cmp_lt_i32 s29, 0
    s_cselect_b32 s40, 0, 1
    s_branch cs_chkG
cs_guard:
    s_cbranch_scc0 cs_guard2
    buffer_store_dwordx4 v[16:19], v61, s[4:7], s26 offen sc1
    s_add_u32 s26, s26, 131072
    s_add_u32 s40, s95, 63
    v_mov_b32 v5, s40
    s_mov_b64 exec, 1
    buffer_store_dword v5, off, s[4:7], s27 sc1
    s_mov_b64 exec, -1
cs_guard2:
    s_nop 7
    v_max3_f32 v6, v28, v29, v30
    v_max3_f32 v7, v31, v56, v57
    v_max_f32 v6, v6, v7
    s_nop 1
    v_max_f32_dpp v6, v6, v6 row_ror:8 row_mask:0xf bank_mask:0xf
    v_mov_b32 v7, v6
    s_nop 1
    v_permlane32_swap_b32 v6, v7
    v_max_f32 v6, v6, v7
    v_mov_b32 v7, v6
    s_nop 1
    v_permlane16_swap_b32 v6, v7
    v_max_f32 v6, v6, v7
    v_sub_f32 v28, v28, v6
    v_sub_f32 v29, v29, v6
    v_sub_f32 v30, v30, v6
    v_sub_f32 v31, v31, v6
    v_sub_f32 v56, v56, v6
    v_sub_f32 v57, v57, v6
    v_exp_f32 v58, v56
    v_exp_f32 v59, v57
    s_nop 0
    v_cvt_pk_bf16_f32 v6, v58, v59
    s_nop 1
    v_mov_b32_dpp v7, v6 row_ror:8 row_mask:0xf bank_mask:0xf
    v_exp_f32 v0, v28
    s_nop 0
    v_mfma_f32_16x16x16_bf16 v[12:15], v[16:17], v[6:7], 0
    v_exp_f32 v1, v29
    v_exp_f32 v2, v30
    v_cvt_pk_bf16_f32 v8, v0, v1
    v_exp_f32 v3, v31
    v_mfma_f32_16x16x16_bf16 v[20:23], v[18:19], v[6:7], 0
    v_cvt_pk_bf16_f32 v9, v2, v3
    v_mov_b32_dpp v10, v8 row_ror:8 row_mask:0xf bank_mask:0xf
    v_max3_f32 v4, |v28|, |v29|, |v30|
    v_mov_b32_dpp v11, v9 row_ror:8 row_mask:0xf bank_mask:0xf
    v_mfma_f32_16x16x32_bf16 v[0:3], v[24:27], v[6:9], 0
    v_max3_f32 v4, v4, |v31|, |v56|
    v_max_f32_e64 v4, v4, |v57|
    v_mfma_f32_16x16x32_bf16 v[12:15], v[40:43], v[8:11], v[12:15]
    v_cmp_nge_f32 vcc, s46, v4
    v_mfma_f32_16x16x32_bf16 v[20:23], v[44:47], v[8:11], v[20:23]
    v_add_f32_dpp v0, v0, v0 row_ror:8 row_mask:0xf bank_mask:0xf
    v_rcp_f32 v0, v0
    s_nop 4
    s_branch cs_norm
cs_spin0:
    buffer_load_dwordx4 v[24:27], v61, s[4:7], s14 offen sc1
    s_sub_u32 s29, s29, 1
    s_cmp_lt_i32 s29, 0
    s_cbranch_scc0 cs_chk0
    s_waitcnt vmcnt(0)
    v_min_u32 v24, -2, v24
    v_min_u32 v25, -2, v25
    v_min_u32 v26, -2, v26
    v_min_u32 v27, -2, v27
    s_branch cs_chk0
cs_spin1:
    buffer_load_dwordx4 v[28:31], v61, s[4:7], s15 offen sc1
    buffer_load_dword v59, v56, s[4:7], s16 offen sc1
    s_sub_u32 s29, s29, 1
    s_cmp_lt_i32 s29, 0
    s_waitcnt vmcnt(0)
    v_max3_u32 v57, v28, v29, v30
    v_max3_u32 v57, v57, v31, v59
    v_cmp_eq_u32 vcc, -1, v57
    ds_write_b128 v62, v[28:31] offset:45056
    ds_write_b32 v58, v59
    s_waitcnt lgkmcnt(0)
    s_cbranch_scc1 cs_go1
    s_cbranch_vccnz cs_spin1
    s_branch cs_go1
cs_last:
    s_nop 1
    s_cmp_eq_u32 s28, 63
    s_cbranch_scc1 cs_last2
    s_mov_b64 exec, s[34:35]
    buffer_store_dwordx4 v[0:3], v61, s[4:7], s25 offen sc1
    s_mov_b64 exec, -1
    s_add_u32 s25, s25, 131072
    s_mov_b32 s46, 0xbf800000
    s_cmp_eq_u32 0, 0
    s_branch cs_back
cs_last2:
    s_waitcnt lgkmcnt(0)
    s_mov_b64 exec, s[34:35]
    buffer_store_dwordx4 v[0:3], v61, s[4:7], s25 offen sc1
    s_mov_b64 exec, -1
    s_add_u32 s40, s95, 64
    v_mov_b32 v40, s40
    v_smfmac_f32_16x16x64_bf16 v[16:19], v[52:55], a[240:247], v60
    v_smfmac_f32_16x16x64_bf16 v[20:23], v[52:55], a[248:255], v60
    s_nop 3
    v_cvt_pk_bf16_f32 v16, v16, v17
    v_cvt_pk_bf16_f32 v17, v18, v19
    s_nop 1
    v_cvt_pk_bf16_f32 v18, v20, v21
    v_cvt_pk_bf16_f32 v19, v22, v23
    buffer_store_dwordx4 v[16:19], v61, s[4:7], s26 offen sc1
    s_mov_b64 exec, 1
    buffer_store_dword v40, off, s[4:7], s27 sc1
    s_mov_b64 exec, -1
    s_endpgm
cs_dma:
    s_xor_b32 s74, s76, s81
    s_add_u32 m0, s74, s80
    s_add_u32 s76, s76, 4096
    buffer_load_dwordx4 v58, s[8:11], s78 offen lds
    s_add_u32 s78, s78, s79
    s_cmp_lt_u32 s76, s77
    s_cbranch_scc1 cs_dma
    s_setpc_b64 s[82:83]
L_helper:
    s_load_dwordx16 s[64:79], s[0:1], 64
    s_sub_u32 s33, s3, 1
    s_and_b32 s33, s33, 7
L_pool:
    s_lshl_b32 s35, s33, 2
    s_add_u32 s35, s35, 32
    s_mov_b32 s37, s35
    v_mov_b32 v250, 1
    v_mov_b32 v251, 163832
    v_cmp_eq_u32 vcc, 0, v0
    s_nop 0
    s_and_saveexec_b64 s[38:39], vcc
    s_cbranch_execz tk4
    buffer_atomic_add v250, off, s[96:99], s37 sc0
    s_waitcnt vmcnt(0)
    ds_write_b32 v251, v250
    s_waitcnt lgkmcnt(0)
tk4:
    s_mov_b64 exec, -1
    s_barrier
    ds_read_b32 v252, v251
    s_waitcnt lgkmcnt(0)
    v_readfirstlane_b32 s34, v252
    s_barrier
    s_nop 3
    s_mov_b32 s36, s33
    s_or_b32 s33, s34, s32
    s_cmp_lg_u32 s33, 0
    s_cbranch_scc1 L_helper1
    s_memrealtime s[90:91]
    s_waitcnt lgkmcnt(0)
    s_lshl_b32 s90, s90, 8
    s_or_b32 s90, s90, 1
    v_mov_b32 v250, s90
    v_mov_b32 v251, 0
    s_mov_b64 exec, 1
    buffer_atomic_cmpswap v[250:251], off, s[96:99], 0 offset:64
    s_mov_b64 exec, -1
L_helper1:
    s_cmp_ge_u32 s34, 32
    s_cbranch_scc1 L_qkv_next
    s_cmp_ge_u32 s36, 7
    s_cbranch_scc1 L_qkv_next
    s_max_u32 s37, s36, 4
    s_sub_u32 s37, s37, 4
    s_mul_i32 s37, s37, 6
    s_lshl_b32 s38, s36, 1
    s_add_u32 s38, s38, s37
    s_cmp_lt_u32 s36, 4
    s_cselect_b32 s39, 2, 8
    s_mul_i32 s36, s36, 30
    s_sub_u32 s36, s36, s37
    s_cmp_lt_u32 s34, s39
    s_cbranch_scc1 L_copy
    s_add_u32 s36, s36, s34
    s_sub_u32 s36, s36, s39
    s_cmp_lg_u32 s95, 0
    s_cbranch_scc1 L_nowm
    s_mul_i32 s37, s36, 24576
    s_mov_b32 s14, 4718592
    s_mov_b32 s15, 0x20000
    s_mov_b32 m0, 155648
    v_lshlrev_b32 v1, 7, v0
    v_min_u32 v1, 24448, v1
    s_mov_b64 s[12:13], s[58:59]
    buffer_load_dword v1, s[12:15], s37 offen lds
    s_mov_b64 s[12:13], s[52:53]
    buffer_load_dword v1, s[12:15], s37 offen lds
L_nowm:
    s_mul_i32 s37, s36, 171
    s_lshr_b32 s37, s37, 10
    s_mul_i32 s38, s37, 6
    s_sub_u32 s36, s36, s38
    s_lshl_b32 s36, s36, 5
    s_add_u32 s36, s36, s37
    s_branch L_job
L_copy:
    s_add_u32 s36, s38, s34
    s_mul_i32 s36, s36, 11
    s_and_b32 s36, s36, 31
    s_cmp_ge_u32 s36, 27
    s_cbranch_scc1 L_qkv_next
    s_mul_i32 s33, s36, 57
    s_lshr_b32 s33, s33, 9
    s_mul_i32 s37, s33, 9
    s_sub_u32 s37, s36, s37
    s_lshl_b32 s36, s37, 2
    s_add_u32 s36, s36, 1
    s_min_u32 s36, s36, 31
    s_lshr_b32 s39, s52, 8
    s_sub_u32 s36, s36, s39
    s_and_b32 s36, s36, 31
    s_lshl_b32 s36, s36, 8
    s_mov_b32 s14, 4718592
    s_mov_b32 s15, 0x20000
    v_lshrrev_b32 v1, 4, v0
    v_lshlrev_b32 v1, 13, v1
    v_and_b32 v2, 15, v0
    v_lshl_add_u32 v1, v2, 4, v1
    v_lshlrev_b32 v2, 4, v0
    s_lshl_b32 s40, s33, 1
    s_mul_i32 s39, s40, 49152
    s_lshl_b32 s41, s37, 19
    s_add_u32 s39, s39, s41
    s_add_u32 s39, s39, 96468992
    s_add_u32 s41, s40, 0
    s_cmp_lt_u32 s41, 3
    s_cselect_b64 s[12:13], s[52:53], s[54:55]
    s_cselect_b32 s42, 0, 3
    s_sub_u32 s41, s41, s42
    s_mul_i32 s38, s41, 1572864
    s_add_u32 s38, s38, s36
    buffer_load_dwordx4 v[8:11], v1, s[12:15], s38 offen
    s_add_u32 s38, s38, 131072
    buffer_load_dwordx4 v[12:15], v1, s[12:15], s38 offen
    s_add_u32 s38, s38, 131072
    buffer_load_dwordx4 v[16:19], v1, s[12:15], s38 offen
    s_add_u32 s38, s38, 131072
    buffer_load_dwordx4 v[20:23], v1, s[12:15], s38 offen
    s_add_u32 s38, s38, 131072
    buffer_load_dwordx4 v[24:27], v1, s[12:15], s38 offen
    s_add_u32 s38, s38, 131072
    buffer_load_dwordx4 v[28:31], v1, s[12:15], s38 offen
    s_add_u32 s38, s38, 131072
    buffer_load_dwordx4 v[32:35], v1, s[12:15], s38 offen
    s_add_u32 s38, s38, 131072
    buffer_load_dwordx4 v[36:39], v1, s[12:15], s38 offen
    s_add_u32 s38, s38, 131072
    buffer_load_dwordx4 v[40:43], v1, s[12:15], s38 offen
    s_add_u32 s38, s38, 131072
    buffer_load_dwordx4 v[44:47], v1, s[12:15], s38 offen
    s_add_u32 s38, s38, 131072
    buffer_load_dwordx4 v[48:51], v1, s[12:15], s38 offen
    s_add_u32 s38, s38, 131072
    buffer_load_dwordx4 v[52:55], v1, s[12:15], s38 offen
    s_add_u32 s38, s38, 131072
    s_add_u32 s41, s40, 1
    s_cmp_lt_u32 s41, 3
    s_cselect_b64 s[12:13], s[52:53], s[54:55]
    s_cselect_b32 s42, 0, 3
    s_sub_u32 s41, s41, s42
    s_mul_i32 s38, s41, 1572864
    s_add_u32 s38, s38, s36
    buffer_load_dwordx4 v[56:59], v1, s[12:15], s38 offen
    s_add_u32 s38, s38, 131072
    buffer_load_dwordx4 v[60:63], v1, s[12:15], s38 offen
    s_add_u32 s38, s38, 131072
    buffer_load_dwordx4 v[64:67], v1, s[12:15], s38 offen
    s_add_u32 s38, s38, 131072
    buffer_load_dwordx4 v[68:71], v1, s[12:15], s38 offen
    s_add_u32 s38, s38, 131072
    buffer_load_dwordx4 v[72:75], v1, s[12:15], s38 offen
    s_add_u32 s38, s38, 131072
    buffer_load_dwordx4 v[76:79], v1, s[12:15], s38 offen
    s_add_u32 s38, s38, 131072
    buffer_load_dwordx4 v[80:83], v1, s[12:15], s38 offen
    s_add_u32 s38, s38, 131072
    buffer_load_dwordx4 v[84:87], v1, s[12:15], s38 offen
    s_add_u32 s38, s38, 131072
    buffer_load_dwordx4 v[88:91], v1, s[12:15], s38 offen
    s_add_u32 s38, s38, 131072
    buffer_load_dwordx4 v[92:95], v1, s[12:15], s38 offen
    s_add_u32 s38, s38, 131072
    buffer_load_dwordx4 v[96:99], v1, s[12:15], s38 offen
    s_add_u32 s38, s38, 131072
    buffer_load_dwordx4 v[100:103], v1, s[12:15], s38 offen
    s_add_u32 s38, s38, 131072
    buffer_load_dword v3, off, s[96:99], 0 offset:64 sc1
    s_waitcnt vmcnt(0)
    buffer_store_dwordx4 v[8:11], v2, s[4:7], s39 offen sc1
    s_add_u32 s39, s39, 4096
    buffer_store_dwordx4 v[12:15], v2, s[4:7], s39 offen sc1
    s_add_u32 s39, s39, 4096
    buffer_store_dwordx4 v[16:19], v2, s[4:7], s39 offen sc1
    s_add_u32 s39, s39, 4096
    buffer_store_dwordx4 v[20:23], v2, s[4:7], s39 offen sc1
    s_add_u32 s39, s39, 4096
    buffer_store_dwordx4 v[24:27], v2, s[4:7], s39 offen sc1
    s_add_u32 s39, s39, 4096
    buffer_store_dwordx4 v[28:31], v2, s[4:7], s39 offen sc1
    s_add_u32 s39, s39, 4096
    buffer_store_dwordx4 v[32:35], v2, s[4:7], s39 offen sc1
    s_add_u32 s39, s39, 4096
    buffer_store_dwordx4 v[36:39], v2, s[4:7], s39 offen sc1
    s_add_u32 s39, s39, 4096
    buffer_store_dwordx4 v[40:43], v2, s[4:7], s39 offen sc1
    s_add_u32 s39, s39, 4096
    buffer_store_dwordx4 v[44:47], v2, s[4:7], s39 offen sc1
    s_add_u32 s39, s39, 4096
    buffer_store_dwordx4 v[48:51], v2, s[4:7], s39 offen sc1
    s_add_u32 s39, s39, 4096
    buffer_store_dwordx4 v[52:55], v2, s[4:7], s39 offen sc1
    s_add_u32 s39, s39, 4096
    buffer_store_dwordx4 v[56:59], v2, s[4:7], s39 offen sc1
    s_add_u32 s39, s39, 4096
    buffer_store_dwordx4 v[60:63], v2, s[4:7], s39 offen sc1
    s_add_u32 s39, s39, 4096
    buffer_store_dwordx4 v[64:67], v2, s[4:7], s39 offen sc1
    s_add_u32 s39, s39, 4096
    buffer_store_dwordx4 v[68:71], v2, s[4:7], s39 offen sc1
    s_add_u32 s39, s39, 4096
    buffer_store_dwordx4 v[72:75], v2, s[4:7], s39 offen sc1
    s_add_u32 s39, s39, 4096
    buffer_store_dwordx4 v[76:79], v2, s[4:7], s39 offen sc1
    s_add_u32 s39, s39, 4096
    buffer_store_dwordx4 v[80:83], v2, s[4:7], s39 offen sc1
    s_add_u32 s39, s39, 4096
    buffer_store_dwordx4 v[84:87], v2, s[4:7], s39 offen sc1
    s_add_u32 s39, s39, 4096
    buffer_store_dwordx4 v[88:91], v2, s[4:7], s39 offen sc1
    s_add_u32 s39, s39, 4096
    buffer_store_dwordx4 v[92:95], v2, s[4:7], s39 offen sc1
    s_add_u32 s39, s39, 4096
    buffer_store_dwordx4 v[96:99], v2, s[4:7], s39 offen sc1
    s_add_u32 s39, s39, 4096
    buffer_store_dwordx4 v[100:103], v2, s[4:7], s39 offen sc1
    s_add_u32 s39, s39, 4096
    v_readfirstlane_b32 s95, v3
    s_nop 4
    s_mov_b32 s88, 4194304
gn5:
    s_cmp_lg_u32 s95, 0
    s_cbranch_scc1 gn5x
    buffer_load_dword v3, off, s[96:99], 0 offset:64 sc1
    s_sub_u32 s88, s88, 1
    s_cbranch_scc1 gn5x
    s_waitcnt vmcnt(0)
    v_readfirstlane_b32 s95, v3
    s_nop 1
    s_branch gn5
gn5x:
    s_lshl_b32 s37, s37, 7
    s_lshl_b32 s36, s33, 2
    s_add_u32 s36, s36, s32
    s_lshl_b32 s36, s36, 2
    s_add_u32 s37, s37, s36
    s_add_u32 s37, s37, 125853696
    v_mov_b32 v3, s95
    s_waitcnt vmcnt(0)
    s_mov_b64 exec, 1
    buffer_store_dword v3, off, s[4:7], s37 sc1
    s_mov_b64 exec, -1
L_qkv_next:
    s_mov_b32 s37, 4
    v_mov_b32 v250, 1
    v_mov_b32 v251, 163832
    v_cmp_eq_u32 vcc, 0, v0
    s_nop 0
    s_and_saveexec_b64 s[38:39], vcc
    s_cbranch_execz tk6
    buffer_atomic_add v250, off, s[96:99], s37 sc0
    s_waitcnt vmcnt(0)
    ds_write_b32 v251, v250
    s_waitcnt lgkmcnt(0)
tk6:
    s_mov_b64 exec, -1
    s_barrier
    ds_read_b32 v252, v251
    s_waitcnt lgkmcnt(0)
    v_readfirstlane_b32 s36, v252
    s_barrier
    s_nop 3
    s_add_u32 s36, s36, 192
    s_cmp_ge_u32 s36, 320
    s_cbranch_scc1 L_ssm_next
L_job:
    s_and_b32 s17, s36, 15
    s_lshl_b32 s17, s17, 1
    s_bfe_u32 s16, s36, 0x10004
    s_lshr_b32 s19, s36, 5
    s_mul_i32 s33, s16, 6
    s_add_u32 s33, s33, s19
    s_add_u32 s16, s16, 1
    s_lshr_b32 s37, s36, 4
    s_sub_u32 s38, s37, 12
    s_cmp_ge_u32 s36, 192
    s_cselect_b32 s16, 0, s16
    s_cselect_b32 s19, s38, s19
    s_cselect_b32 s33, s37, s33
    s_cselect_b32 s20, 8, 6
    v_lshrrev_b32 v4, 6, v0
    s_nop 0
    v_readfirstlane_b32 s18, v4
    v_lshlrev_b32 v7, 4, v0
    v_and_b32 v4, 63, v0
    v_lshrrev_b32 v6, 2, v4
    v_lshlrev_b32 v6, 13, v6
    v_lshrrev_b32 v5, 4, v4
    v_and_b32 v5, 2, v5
    v_xor_b32 v5, v5, v4
    v_and_b32 v5, 3, v5
    v_lshl_add_u32 v6, v5, 4, v6
    v_lshrrev_b32 v24, 4, v4
    v_lshlrev_b32 v24, 9, v24
    v_bfe_u32 v5, v4, 2, 2
    v_lshl_add_u32 v24, v5, 6, v24
    v_bfe_u32 v5, v4, 4, 1
    v_lshl_add_u32 v24, v5, 5, v24
    v_and_b32 v5, 3, v4
    v_lshl_add_u32 v24, v5, 3, v24
    s_lshl_b32 s31, s18, 12
    v_add_u32 v24, s31, v24
    s_cmp_eq_u32 s16, 1
    s_cselect_b64 s[12:13], s[54:55], s[52:53]
    s_cmp_eq_u32 s16, 2
    s_cselect_b64 s[12:13], s[56:57], s[12:13]
    s_mov_b32 s14, 4718592
    s_mov_b32 s15, 0x20000
    s_lshl_b32 s28, s17, 8
    s_lshl_b32 s21, s18, 6
    s_add_u32 s28, s28, s21
    s_add_u32 s21, s28, 0
    s_add_u32 m0, s31, 40960
    s_nop 0
    buffer_load_dwordx4 v6, s[12:15], s21 offen lds
    s_add_u32 m0, s31, 41984
    s_add_u32 s21, s21, 131072
    buffer_load_dwordx4 v6, s[12:15], s21 offen lds
    s_add_u32 m0, s31, 43008
    s_add_u32 s21, s21, 131072
    buffer_load_dwordx4 v6, s[12:15], s21 offen lds
    s_add_u32 m0, s31, 44032
    s_add_u32 s21, s21, 131072
    buffer_load_dwordx4 v6, s[12:15], s21 offen lds
    s_add_u32 s21, s28, 256
    s_add_u32 m0, s31, 57344
    s_nop 0
    buffer_load_dwordx4 v6, s[12:15], s21 offen lds
    s_add_u32 m0, s31, 58368
    s_add_u32 s21, s21, 131072
    buffer_load_dwordx4 v6, s[12:15], s21 offen lds
    s_add_u32 m0, s31, 59392
    s_add_u32 s21, s21, 131072
    buffer_load_dwordx4 v6, s[12:15], s21 offen lds
    s_add_u32 m0, s31, 60416
    s_add_u32 s21, s21, 131072
    buffer_load_dwordx4 v6, s[12:15], s21 offen lds
    s_add_u32 s21, s28, 524288
    s_add_u32 m0, s31, 73728
    s_nop 0
    buffer_load_dwordx4 v6, s[12:15], s21 offen lds
    s_add_u32 m0, s31, 74752
    s_add_u32 s21, s21, 131072
    buffer_load_dwordx4 v6, s[12:15], s21 offen lds
    s_add_u32 m0, s31, 75776
    s_add_u32 s21, s21, 131072
    buffer_load_dwordx4 v6, s[12:15], s21 offen lds
    s_add_u32 m0, s31, 76800
    s_add_u32 s21, s21, 131072
    buffer_load_dwordx4 v6, s[12:15], s21 offen lds
    s_add_u32 s21, s28, 524544
    s_add_u32 m0, s31, 90112
    s_nop 0
    buffer_load_dwordx4 v6, s[12:15], s21 offen lds
    s_add_u32 m0, s31, 91136
    s_add_u32 s21, s21, 131072
    buffer_load_dwordx4 v6, s[12:15], s21 offen lds
    s_add_u32 m0, s31, 92160
    s_add_u32 s21, s21, 131072
    buffer_load_dwordx4 v6, s[12:15], s21 offen lds
    s_add_u32 m0, s31, 93184
    s_add_u32 s21, s21, 131072
    buffer_load_dwordx4 v6, s[12:15], s21 offen lds
    s_add_u32 s21, s28, 1048576
    s_add_u32 m0, s31, 106496
    s_nop 0
    buffer_load_dwordx4 v6, s[12:15], s21 offen lds
    s_add_u32 m0, s31, 107520
    s_add_u32 s21, s21, 131072
    buffer_load_dwordx4 v6, s[12:15], s21 offen lds
    s_add_u32 m0, s31, 108544
    s_add_u32 s21, s21, 131072
    buffer_load_dwordx4 v6, s[12:15], s21 offen lds
    s_add_u32 m0, s31, 109568
    s_add_u32 s21, s21, 131072
    buffer_load_dwordx4 v6, s[12:15], s21 offen lds
    s_add_u32 s21, s28, 1048832
    s_add_u32 m0, s31, 122880
    s_nop 0
    buffer_load_dwordx4 v6, s[12:15], s21 offen lds
    s_add_u32 m0, s31, 123904
    s_add_u32 s21, s21, 131072
    buffer_load_dwordx4 v6, s[12:15], s21 offen lds
    s_add_u32 m0, s31, 124928
    s_add_u32 s21, s21, 131072
    buffer_load_dwordx4 v6, s[12:15], s21 offen lds
    s_add_u32 m0, s31, 125952
    s_add_u32 s21, s21, 131072
    buffer_load_dwordx4 v6, s[12:15], s21 offen lds
    s_add_u32 s21, s28, 1572864
    s_add_u32 m0, s31, 139264
    s_nop 0
    buffer_load_dwordx4 v6, s[12:15], s21 offen lds
    s_add_u32 m0, s31, 140288
    s_add_u32 s21, s21, 131072
    buffer_load_dwordx4 v6, s[12:15], s21 offen lds
    s_add_u32 m0, s31, 141312
    s_add_u32 s21, s21, 131072
    buffer_load_dwordx4 v6, s[12:15], s21 offen lds
    s_add_u32 m0, s31, 142336
    s_add_u32 s21, s21, 131072
    buffer_load_dwordx4 v6, s[12:15], s21 offen lds
    v_and_b32 v5, 15, v4
    v_lshrrev_b32 v3, 4, v4
    v_lshrrev_b32 v2, 2, v5
    v_xor_b32 v3, v3, v2
    v_lshl_add_u32 v3, v5, 2, v3
    v_lshlrev_b32 v1, 4, v3
    v_lshrrev_b32 v5, 2, v4
    v_lshrrev_b32 v3, 4, v4
    v_and_b32 v4, 3, v4
    v_xor_b32 v4, v4, v3
    v_lshlrev_b32 v3, 3, v3
    v_and_b32 v5, 3, v5
    v_add_u32 v3, v3, v5
    v_mul_u32_u24 v2, 1152, v3
    v_lshl_add_u32 v2, v4, 4, v2
    s_mov_b32 s8, s48
    s_mov_b32 s9, s49
    s_mov_b32 s10, 2359296
    s_mov_b32 s11, 0x20000
    s_lshr_b32 s22, s18, 1
    s_mul_i32 s24, s22, 4608
    s_and_b32 s22, s18, 1
    s_mul_i32 s23, s22, 576
    s_add_u32 s24, s24, s23
    s_mul_i32 s25, s18, 9216
    s_mul_i32 s22, s19, 36864
    s_add_u32 s24, s24, s22
    s_mul_i32 s42, s20, 36864
    s_mov_b32 s27, 0
    s_add_u32 s23, s27, s25
    s_add_u32 m0, s23, 0
    s_nop 0
    buffer_load_dwordx4 v2, s[8:11], s24 offen offset:0 lds
    s_add_u32 m0, s23, 960
    s_nop 0
    buffer_load_dwordx4 v2, s[8:11], s24 offen offset:64 lds
    s_add_u32 m0, s23, 1920
    s_nop 0
    buffer_load_dwordx4 v2, s[8:11], s24 offen offset:128 lds
    s_add_u32 m0, s23, 2880
    s_nop 0
    buffer_load_dwordx4 v2, s[8:11], s24 offen offset:192 lds
    s_add_u32 m0, s23, 3840
    s_nop 0
    buffer_load_dwordx4 v2, s[8:11], s24 offen offset:256 lds
    s_add_u32 m0, s23, 4800
    s_nop 0
    buffer_load_dwordx4 v2, s[8:11], s24 offen offset:320 lds
    s_add_u32 m0, s23, 5760
    s_nop 0
    buffer_load_dwordx4 v2, s[8:11], s24 offen offset:384 lds
    s_add_u32 m0, s23, 6720
    s_nop 0
    buffer_load_dwordx4 v2, s[8:11], s24 offen offset:448 lds
    s_add_u32 m0, s23, 7680
    s_nop 0
    buffer_load_dwordx4 v2, s[8:11], s24 offen offset:512 lds
    s_add_u32 s24, s24, s42
    s_lshl_b32 s22, s19, 5
    s_add_u32 s22, s22, s17
    s_lshl_b32 s26, s22, 14
    s_mul_i32 s23, s18, 3072
    s_add_u32 s26, s26, s23
    s_lshl_b32 s23, s16, 11
    s_add_u32 s26, s26, s23
    s_add_u32 s26, s26, -2048
    s_lshl_b32 s22, s22, 13
    s_add_u32 s22, s22, 33554432
    s_cmp_eq_u32 s16, 0
    s_cselect_b32 s26, s22, s26
    s_cselect_b32 s40, 4, 1
    s_cselect_b32 s43, 1, 2
    s_lshl_b32 s40, s40, 10
    s_lshl_b32 s43, s43, 13
    s_lshl_b32 s41, s43, 5
    s_mul_i32 s41, s41, s20
    s_lshl_b32 s29, s17, 7
    s_lshl_b32 s22, s33, 2
    s_add_u32 s29, s29, s22
    s_add_u32 s29, s29, 125829120
    v_add_u32 v25, 40960, v24
    v_xor_b32 v26, 32, v25
    s_waitcnt vmcnt(33)
    ds_read_b64_tr_b16 v[64:65], v25 offset:0
    ds_read_b64_tr_b16 v[66:67], v25 offset:256
    ds_read_b64_tr_b16 v[136:137], v26 offset:0
    ds_read_b64_tr_b16 v[138:139], v26 offset:256
    ds_read_b64_tr_b16 v[68:69], v25 offset:2048
    ds_read_b64_tr_b16 v[70:71], v25 offset:2304
    ds_read_b64_tr_b16 v[140:141], v26 offset:2048
    ds_read_b64_tr_b16 v[142:143], v26 offset:2304
    s_waitcnt lgkmcnt(0)
    s_add_u32 s21, s28, 1573120
    s_add_u32 m0, s31, 40960
    s_nop 0
    buffer_load_dwordx4 v6, s[12:15], s21 offen lds
    s_add_u32 m0, s31, 41984
    s_add_u32 s21, s21, 131072
    buffer_load_dwordx4 v6, s[12:15], s21 offen lds
    s_add_u32 m0, s31, 43008
    s_add_u32 s21, s21, 131072
    buffer_load_dwordx4 v6, s[12:15], s21 offen lds
    s_add_u32 m0, s31, 44032
    s_add_u32 s21, s21, 131072
    buffer_load_dwordx4 v6, s[12:15], s21 offen lds
    v_add_u32 v25, 57344, v24
    v_xor_b32 v26, 32, v25
    s_waitcnt vmcnt(33)
    ds_read_b64_tr_b16 a[0:1], v25 offset:0
    ds_read_b64_tr_b16 a[2:3], v25 offset:256
    ds_read_b64_tr_b16 a[72:73], v26 offset:0
    ds_read_b64_tr_b16 a[74:75], v26 offset:256
    ds_read_b64_tr_b16 a[4:5], v25 offset:2048
    ds_read_b64_tr_b16 a[6:7], v25 offset:2304
    ds_read_b64_tr_b16 a[76:77], v26 offset:2048
    ds_read_b64_tr_b16 a[78:79], v26 offset:2304
    s_waitcnt lgkmcnt(0)
    s_add_u32 s21, s28, 2097152
    s_add_u32 m0, s31, 57344
    s_nop 0
    buffer_load_dwordx4 v6, s[12:15], s21 offen lds
    s_add_u32 m0, s31, 58368
    s_add_u32 s21, s21, 131072
    buffer_load_dwordx4 v6, s[12:15], s21 offen lds
    s_add_u32 m0, s31, 59392
    s_add_u32 s21, s21, 131072
    buffer_load_dwordx4 v6, s[12:15], s21 offen lds
    s_add_u32 m0, s31, 60416
    s_add_u32 s21, s21, 131072
    buffer_load_dwordx4 v6, s[12:15], s21 offen lds
    v_add_u32 v25, 73728, v24
    v_xor_b32 v26, 32, v25
    s_waitcnt vmcnt(33)
    ds_read_b64_tr_b16 v[72:73], v25 offset:0
    ds_read_b64_tr_b16 v[74:75], v25 offset:256
    ds_read_b64_tr_b16 v[144:145], v26 offset:0
    ds_read_b64_tr_b16 v[146:147], v26 offset:256
    ds_read_b64_tr_b16 v[76:77], v25 offset:2048
    ds_read_b64_tr_b16 v[78:79], v25 offset:2304
    ds_read_b64_tr_b16 v[148:149], v26 offset:2048
    ds_read_b64_tr_b16 v[150:151], v26 offset:2304
    s_waitcnt lgkmcnt(0)
    s_add_u32 s21, s28, 2097408
    s_add_u32 m0, s31, 73728
    s_nop 0
    buffer_load_dwordx4 v6, s[12:15], s21 offen lds
    s_add_u32 m0, s31, 74752
    s_add_u32 s21, s21, 131072
    buffer_load_dwordx4 v6, s[12:15], s21 offen lds
    s_add_u32 m0, s31, 75776
    s_add_u32 s21, s21, 131072
    buffer_load_dwordx4 v6, s[12:15], s21 offen lds
    s_add_u32 m0, s31, 76800
    s_add_u32 s21, s21, 131072
    buffer_load_dwordx4 v6, s[12:15], s21 offen lds
    v_add_u32 v25, 90112, v24
    v_xor_b32 v26, 32, v25
    s_waitcnt vmcnt(33)
    ds_read_b64_tr_b16 a[8:9], v25 offset:0
    ds_read_b64_tr_b16 a[10:11], v25 offset:256
    ds_read_b64_tr_b16 a[80:81], v26 offset:0
    ds_read_b64_tr_b16 a[82:83], v26 offset:256
    ds_read_b64_tr_b16 a[12:13], v25 offset:2048
    ds_read_b64_tr_b16 a[14:15], v25 offset:2304
    ds_read_b64_tr_b16 a[84:85], v26 offset:2048
    ds_read_b64_tr_b16 a[86:87], v26 offset:2304
    s_waitcnt lgkmcnt(0)
    s_add_u32 s21, s28, 2621440
    s_add_u32 m0, s31, 90112
    s_nop 0
    buffer_load_dwordx4 v6, s[12:15], s21 offen lds
    s_add_u32 m0, s31, 91136
    s_add_u32 s21, s21, 131072
    buffer_load_dwordx4 v6, s[12:15], s21 offen lds
    s_add_u32 m0, s31, 92160
    s_add_u32 s21, s21, 131072
    buffer_load_dwordx4 v6, s[12:15], s21 offen lds
    s_add_u32 m0, s31, 93184
    s_add_u32 s21, s21, 131072
    buffer_load_dwordx4 v6, s[12:15], s21 offen lds
    v_add_u32 v25, 106496, v24
    v_xor_b32 v26, 32, v25
    s_waitcnt vmcnt(33)
    ds_read_b64_tr_b16 v[80:81], v25 offset:0
    ds_read_b64_tr_b16 v[82:83], v25 offset:256
    ds_read_b64_tr_b16 v[152:153], v26 offset:0
    ds_read_b64_tr_b16 v[154:155], v26 offset:256
    ds_read_b64_tr_b16 v[84:85], v25 offset:2048
    ds_read_b64_tr_b16 v[86:87], v25 offset:2304
    ds_read_b64_tr_b16 v[156:157], v26 offset:2048
    ds_read_b64_tr_b16 v[158:159], v26 offset:2304
    s_waitcnt lgkmcnt(0)
    s_add_u32 s21, s28, 2621696
    s_add_u32 m0, s31, 106496
    s_nop 0
    buffer_load_dwordx4 v6, s[12:15], s21 offen lds
    s_add_u32 m0, s31, 107520
    s_add_u32 s21, s21, 131072
    buffer_load_dwordx4 v6, s[12:15], s21 offen lds
    s_add_u32 m0, s31, 108544
    s_add_u32 s21, s21, 131072
    buffer_load_dwordx4 v6, s[12:15], s21 offen lds
    s_add_u32 m0, s31, 109568
    s_add_u32 s21, s21, 131072
    buffer_load_dwordx4 v6, s[12:15], s21 offen lds
    v_add_u32 v25, 122880, v24
    v_xor_b32 v26, 32, v25
    s_waitcnt vmcnt(33)
    ds_read_b64_tr_b16 a[16:17], v25 offset:0
    ds_read_b64_tr_b16 a[18:19], v25 offset:256
    ds_read_b64_tr_b16 a[88:89], v26 offset:0
    ds_read_b64_tr_b16 a[90:91], v26 offset:256
    ds_read_b64_tr_b16 a[20:21], v25 offset:2048
    ds_read_b64_tr_b16 a[22:23], v25 offset:2304
    ds_read_b64_tr_b16 a[92:93], v26 offset:2048
    ds_read_b64_tr_b16 a[94:95], v26 offset:2304
    s_waitcnt lgkmcnt(0)
    v_mov_b32 v28, s95
    s_cmp_lg_u32 s95, 0
    s_cbranch_scc1 L_ne
    buffer_load_dword v28, off, s[96:99], 0 offset:64 sc1
L_ne:
    s_add_u32 s21, s28, 3145728
    s_add_u32 m0, s31, 122880
    s_nop 0
    buffer_load_dwordx4 v6, s[12:15], s21 offen lds
    s_add_u32 m0, s31, 123904
    s_add_u32 s21, s21, 131072
    buffer_load_dwordx4 v6, s[12:15], s21 offen lds
    s_add_u32 m0, s31, 124928
    s_add_u32 s21, s21, 131072
    buffer_load_dwordx4 v6, s[12:15], s21 offen lds
    s_add_u32 m0, s31, 125952
    s_add_u32 s21, s21, 131072
    buffer_load_dwordx4 v6, s[12:15], s21 offen lds
    v_add_u32 v25, 139264, v24
    v_xor_b32 v26, 32, v25
    s_waitcnt vmcnt(33)
    ds_read_b64_tr_b16 v[88:89], v25 offset:0
    ds_read_b64_tr_b16 v[90:91], v25 offset:256
    ds_read_b64_tr_b16 v[160:161], v26 offset:0
    ds_read_b64_tr_b16 v[162:163], v26 offset:256
    ds_read_b64_tr_b16 v[92:93], v25 offset:2048
    ds_read_b64_tr_b16 v[94:95], v25 offset:2304
    ds_read_b64_tr_b16 v[164:165], v26 offset:2048
    ds_read_b64_tr_b16 v[166:167], v26 offset:2304
    s_waitcnt lgkmcnt(0)
    s_add_u32 s21, s28, 3145984
    s_add_u32 m0, s31, 139264
    s_nop 0
    buffer_load_dwordx4 v6, s[12:15], s21 offen lds
    s_add_u32 m0, s31, 140288
    s_add_u32 s21, s21, 131072
    buffer_load_dwordx4 v6, s[12:15], s21 offen lds
    s_add_u32 m0, s31, 141312
    s_add_u32 s21, s21, 131072
    buffer_load_dwordx4 v6, s[12:15], s21 offen lds
    s_add_u32 m0, s31, 142336
    s_add_u32 s21, s21, 131072
    buffer_load_dwordx4 v6, s[12:15], s21 offen lds
    v_add_u32 v25, 40960, v24
    v_xor_b32 v26, 32, v25
    s_waitcnt vmcnt(24)
    ds_read_b64_tr_b16 a[24:25], v25 offset:0
    ds_read_b64_tr_b16 a[26:27], v25 offset:256
    ds_read_b64_tr_b16 a[96:97], v26 offset:0
    ds_read_b64_tr_b16 a[98:99], v26 offset:256
    ds_read_b64_tr_b16 a[28:29], v25 offset:2048
    ds_read_b64_tr_b16 a[30:31], v25 offset:2304
    ds_read_b64_tr_b16 a[100:101], v26 offset:2048
    ds_read_b64_tr_b16 a[102:103], v26 offset:2304
    s_waitcnt lgkmcnt(0)
    s_add_u32 s21, s28, 3670016
    s_add_u32 m0, s31, 40960
    s_nop 0
    buffer_load_dwordx4 v6, s[12:15], s21 offen lds
    s_add_u32 m0, s31, 41984
    s_add_u32 s21, s21, 131072
    buffer_load_dwordx4 v6, s[12:15], s21 offen lds
    s_add_u32 m0, s31, 43008
    s_add_u32 s21, s21, 131072
    buffer_load_dwordx4 v6, s[12:15], s21 offen lds
    s_add_u32 m0, s31, 44032
    s_add_u32 s21, s21, 131072
    buffer_load_dwordx4 v6, s[12:15], s21 offen lds
    v_add_u32 v25, 57344, v24
    v_xor_b32 v26, 32, v25
    s_waitcnt vmcnt(24)
    ds_read_b64_tr_b16 v[96:97], v25 offset:0
    ds_read_b64_tr_b16 v[98:99], v25 offset:256
    ds_read_b64_tr_b16 v[168:169], v26 offset:0
    ds_read_b64_tr_b16 v[170:171], v26 offset:256
    ds_read_b64_tr_b16 v[100:101], v25 offset:2048
    ds_read_b64_tr_b16 v[102:103], v25 offset:2304
    ds_read_b64_tr_b16 v[172:173], v26 offset:2048
    ds_read_b64_tr_b16 v[174:175], v26 offset:2304
    s_waitcnt lgkmcnt(0)
    s_add_u32 s21, s28, 3670272
    s_add_u32 m0, s31, 57344
    s_nop 0
    buffer_load_dwordx4 v6, s[12:15], s21 offen lds
    s_add_u32 m0, s31, 58368
    s_add_u32 s21, s21, 131072
    buffer_load_dwordx4 v6, s[12:15], s21 offen lds
    s_add_u32 m0, s31, 59392
    s_add_u32 s21, s21, 131072
    buffer_load_dwordx4 v6, s[12:15], s21 offen lds
    s_add_u32 m0, s31, 60416
    s_add_u32 s21, s21, 131072
    buffer_load_dwordx4 v6, s[12:15], s21 offen lds
    v_add_u32 v25, 73728, v24
    v_xor_b32 v26, 32, v25
    s_waitcnt vmcnt(24)
    ds_read_b64_tr_b16 a[32:33], v25 offset:0
    ds_read_b64_tr_b16 a[34:35], v25 offset:256
    ds_read_b64_tr_b16 a[104:105], v26 offset:0
    ds_read_b64_tr_b16 a[106:107], v26 offset:256
    ds_read_b64_tr_b16 a[36:37], v25 offset:2048
    ds_read_b64_tr_b16 a[38:39], v25 offset:2304
    ds_read_b64_tr_b16 a[108:109], v26 offset:2048
    ds_read_b64_tr_b16 a[110:111], v26 offset:2304
    s_waitcnt lgkmcnt(0)
    s_add_u32 s21, s28, 4194304
    s_add_u32 m0, s31, 73728
    s_nop 0
    buffer_load_dwordx4 v6, s[12:15], s21 offen lds
    s_add_u32 m0, s31, 74752
    s_add_u32 s21, s21, 131072
    buffer_load_dwordx4 v6, s[12:15], s21 offen lds
    s_add_u32 m0, s31, 75776
    s_add_u32 s21, s21, 131072
    buffer_load_dwordx4 v6, s[12:15], s21 offen lds
    s_add_u32 m0, s31, 76800
    s_add_u32 s21, s21, 131072
    buffer_load_dwordx4 v6, s[12:15], s21 offen lds
    v_add_u32 v25, 90112, v24
    v_xor_b32 v26, 32, v25
    s_waitcnt vmcnt(24)
    ds_read_b64_tr_b16 v[104:105], v25 offset:0
    ds_read_b64_tr_b16 v[106:107], v25 offset:256
    ds_read_b64_tr_b16 v[176:177], v26 offset:0
    ds_read_b64_tr_b16 v[178:179], v26 offset:256
    ds_read_b64_tr_b16 v[108:109], v25 offset:2048
    ds_read_b64_tr_b16 v[110:111], v25 offset:2304
    ds_read_b64_tr_b16 v[180:181], v26 offset:2048
    ds_read_b64_tr_b16 v[182:183], v26 offset:2304
    s_waitcnt lgkmcnt(0)
    s_add_u32 s21, s28, 4194560
    s_add_u32 m0, s31, 90112
    s_nop 0
    buffer_load_dwordx4 v6, s[12:15], s21 offen lds
    s_add_u32 m0, s31, 91136
    s_add_u32 s21, s21, 131072
    buffer_load_dwordx4 v6, s[12:15], s21 offen lds
    s_add_u32 m0, s31, 92160
    s_add_u32 s21, s21, 131072
    buffer_load_dwordx4 v6, s[12:15], s21 offen lds
    s_add_u32 m0, s31, 93184
    s_add_u32 s21, s21, 131072
    buffer_load_dwordx4 v6, s[12:15], s21 offen lds
    v_add_u32 v25, 106496, v24
    v_xor_b32 v26, 32, v25
    s_waitcnt vmcnt(24)
    ds_read_b64_tr_b16 a[40:41], v25 offset:0
    ds_read_b64_tr_b16 a[42:43], v25 offset:256
    ds_read_b64_tr_b16 a[112:113], v26 offset:0
    ds_read_b64_tr_b16 a[114:115], v26 offset:256
    ds_read_b64_tr_b16 a[44:45], v25 offset:2048
    ds_read_b64_tr_b16 a[46:47], v25 offset:2304
    ds_read_b64_tr_b16 a[116:117], v26 offset:2048
    ds_read_b64_tr_b16 a[118:119], v26 offset:2304
    s_waitcnt lgkmcnt(0)
    v_add_u32 v25, 122880, v24
    v_xor_b32 v26, 32, v25
    s_waitcnt vmcnt(20)
    ds_read_b64_tr_b16 v[112:113], v25 offset:0
    ds_read_b64_tr_b16 v[114:115], v25 offset:256
    ds_read_b64_tr_b16 v[184:185], v26 offset:0
    ds_read_b64_tr_b16 v[186:187], v26 offset:256
    ds_read_b64_tr_b16 v[116:117], v25 offset:2048
    ds_read_b64_tr_b16 v[118:119], v25 offset:2304
    ds_read_b64_tr_b16 v[188:189], v26 offset:2048
    ds_read_b64_tr_b16 v[190:191], v26 offset:2304
    s_waitcnt lgkmcnt(0)
    v_add_u32 v25, 139264, v24
    v_xor_b32 v26, 32, v25
    s_waitcnt vmcnt(16)
    ds_read_b64_tr_b16 a[48:49], v25 offset:0
    ds_read_b64_tr_b16 a[50:51], v25 offset:256
    ds_read_b64_tr_b16 a[120:121], v26 offset:0
    ds_read_b64_tr_b16 a[122:123], v26 offset:256
    ds_read_b64_tr_b16 a[52:53], v25 offset:2048
    ds_read_b64_tr_b16 a[54:55], v25 offset:2304
    ds_read_b64_tr_b16 a[124:125], v26 offset:2048
    ds_read_b64_tr_b16 a[126:127], v26 offset:2304
    s_waitcnt lgkmcnt(0)
    v_add_u32 v25, 40960, v24
    v_xor_b32 v26, 32, v25
    s_waitcnt vmcnt(12)
    ds_read_b64_tr_b16 v[120:121], v25 offset:0
    ds_read_b64_tr_b16 v[122:123], v25 offset:256
    ds_read_b64_tr_b16 v[192:193], v26 offset:0
    ds_read_b64_tr_b16 v[194:195], v26 offset:256
    ds_read_b64_tr_b16 v[124:125], v25 offset:2048
    ds_read_b64_tr_b16 v[126:127], v25 offset:2304
    ds_read_b64_tr_b16 v[196:197], v26 offset:2048
    ds_read_b64_tr_b16 v[198:199], v26 offset:2304
    s_waitcnt lgkmcnt(0)
    v_add_u32 v25, 57344, v24
    v_xor_b32 v26, 32, v25
    s_waitcnt vmcnt(8)
    ds_read_b64_tr_b16 a[56:57], v25 offset:0
    ds_read_b64_tr_b16 a[58:59], v25 offset:256
    ds_read_b64_tr_b16 a[128:129], v26 offset:0
    ds_read_b64_tr_b16 a[130:131], v26 offset:256
    ds_read_b64_tr_b16 a[60:61], v25 offset:2048
    ds_read_b64_tr_b16 a[62:63], v25 offset:2304
    ds_read_b64_tr_b16 a[132:133], v26 offset:2048
    ds_read_b64_tr_b16 a[134:135], v26 offset:2304
    s_waitcnt lgkmcnt(0)
    v_add_u32 v25, 73728, v24
    v_xor_b32 v26, 32, v25
    s_waitcnt vmcnt(4)
    ds_read_b64_tr_b16 v[128:129], v25 offset:0
    ds_read_b64_tr_b16 v[130:131], v25 offset:256
    ds_read_b64_tr_b16 v[200:201], v26 offset:0
    ds_read_b64_tr_b16 v[202:203], v26 offset:256
    ds_read_b64_tr_b16 v[132:133], v25 offset:2048
    ds_read_b64_tr_b16 v[134:135], v25 offset:2304
    ds_read_b64_tr_b16 v[204:205], v26 offset:2048
    ds_read_b64_tr_b16 v[206:207], v26 offset:2304
    s_waitcnt lgkmcnt(0)
    v_add_u32 v25, 90112, v24
    v_xor_b32 v26, 32, v25
    s_waitcnt vmcnt(0)
    ds_read_b64_tr_b16 a[64:65], v25 offset:0
    ds_read_b64_tr_b16 a[66:67], v25 offset:256
    ds_read_b64_tr_b16 a[136:137], v26 offset:0
    ds_read_b64_tr_b16 a[138:139], v26 offset:256
    ds_read_b64_tr_b16 a[68:69], v25 offset:2048
    ds_read_b64_tr_b16 a[70:71], v25 offset:2304
    ds_read_b64_tr_b16 a[140:141], v26 offset:2048
    ds_read_b64_tr_b16 a[142:143], v26 offset:2304
    s_waitcnt lgkmcnt(0)
    s_lshr_b32 s21, s17, 3
    s_cmp_eq_u32 s21, 3
    s_cselect_b32 s21, 1, s33
    s_cmp_lg_u32 s21, 0
    s_cbranch_scc1 qk_noclr
    v_mov_b32 v8, -1
    v_mov_b32 v9, -1
    v_mov_b32 v10, -1
    v_mov_b32 v11, -1
    v_lshrrev_b32 v25, 6, v0
    v_mul_u32_u24 v25, 11264, v25
    v_add_u32 v25, v25, v7
    s_lshl_b32 s21, s17, 9
    s_add_u32 s21, s21, 90177536
    s_add_u32 s22, s21, 786432
qk_clr:
    buffer_store_dwordx4 v[8:11], v25, s[4:7], s21 offen sc1
    s_add_u32 s21, s21, 49152
    s_cmp_lt_u32 s21, s22
    s_cbranch_scc1 qk_clr
qk_noclr:
    s_and_b32 s21, s33, -2
    s_cmp_lg_u32 s21, 2
    s_cbranch_scc1 qk_noclr2
    v_mov_b32 v8, -1
    v_mov_b32 v9, -1
    v_mov_b32 v10, -1
    v_mov_b32 v11, -1
    s_add_u32 s21, s33, 60
    s_lshl_b32 s23, s17, 12
    s_lshl_b32 s22, s21, 17
    s_add_u32 s22, s22, s23
    s_add_u32 s22, s22, 71303168
    buffer_store_dwordx4 v[8:11], v7, s[4:7], s22 offen sc1
    s_add_u32 s22, s22, 4096
    buffer_store_dwordx4 v[8:11], v7, s[4:7], s22 offen sc1
    s_lshl_b32 s22, s21, 17
    s_add_u32 s22, s22, s23
    s_add_u32 s22, s22, 80740352
    buffer_store_dwordx4 v[8:11], v7, s[4:7], s22 offen sc1
    s_add_u32 s22, s22, 4096
    buffer_store_dwordx4 v[8:11], v7, s[4:7], s22 offen sc1
    s_lshl_b32 s22, s21, 18
    s_add_u32 s22, s22, s23
    s_add_u32 s22, s22, 50331648
    buffer_store_dwordx4 v[8:11], v7, s[4:7], s22 offen sc1
    s_add_u32 s22, s22, 4096
    buffer_store_dwordx4 v[8:11], v7, s[4:7], s22 offen sc1
    s_lshl_b32 s22, s21, 18
    s_add_u32 s22, s22, s23
    s_add_u32 s22, s22, 50462720
    buffer_store_dwordx4 v[8:11], v7, s[4:7], s22 offen sc1
    s_add_u32 s22, s22, 4096
    buffer_store_dwordx4 v[8:11], v7, s[4:7], s22 offen sc1
qk_noclr2:
    v_readfirstlane_b32 s95, v28
    s_nop 4
    s_mov_b32 s88, 4194304
gn7:
    s_cmp_lg_u32 s95, 0
    s_cbranch_scc1 gn7x
    buffer_load_dword v25, off, s[96:99], 0 offset:64 sc1
    s_sub_u32 s88, s88, 1
    s_cbranch_scc1 gn7x
    s_waitcnt vmcnt(0)
    v_readfirstlane_b32 s95, v25
    s_nop 1
    s_branch gn7
gn7x:
    s_barrier
    s_mov_b32 s27, 36864
    s_add_u32 s23, s27, s25
    s_add_u32 m0, s23, 0
    s_nop 0
    buffer_load_dwordx4 v2, s[8:11], s24 offen offset:0 lds
    s_add_u32 m0, s23, 960
    s_nop 0
    buffer_load_dwordx4 v2, s[8:11], s24 offen offset:64 lds
    s_add_u32 m0, s23, 1920
    s_nop 0
    buffer_load_dwordx4 v2, s[8:11], s24 offen offset:128 lds
    s_add_u32 m0, s23, 2880
    s_nop 0
    buffer_load_dwordx4 v2, s[8:11], s24 offen offset:192 lds
    s_add_u32 m0, s23, 3840
    s_nop 0
    buffer_load_dwordx4 v2, s[8:11], s24 offen offset:256 lds
    s_add_u32 m0, s23, 4800
    s_nop 0
    buffer_load_dwordx4 v2, s[8:11], s24 offen offset:320 lds
    s_add_u32 m0, s23, 5760
    s_nop 0
    buffer_load_dwordx4 v2, s[8:11], s24 offen offset:384 lds
    s_add_u32 m0, s23, 6720
    s_nop 0
    buffer_load_dwordx4 v2, s[8:11], s24 offen offset:448 lds
    s_add_u32 m0, s23, 7680
    s_nop 0
    buffer_load_dwordx4 v2, s[8:11], s24 offen offset:512 lds
    s_add_u32 s24, s24, s42
    s_mov_b32 s27, 0
    s_mov_b32 s30, s95
    s_cmp_eq_u32 s18, 0
    s_cselect_b32 s34, 1, 0
    s_mov_b32 s35, 0
    s_cmp_eq_u32 s16, 2
    s_cbranch_scc1 qk_vloop
qk_loop:
    s_barrier
    v_add_u32 v3, s27, v1
    ds_read_b128 v[32:35], v3 offset:0
    ds_read_b128 v[36:39], v3 offset:18432
    ds_read_b128 v[40:43], v3 offset:1024
    ds_read_b128 v[44:47], v3 offset:19456
    ds_read_b128 v[48:51], v3 offset:2048
    ds_read_b128 v[52:55], v3 offset:20480
    s_sub_u32 s22, s30, 1
    v_mov_b32 v4, s22
    s_mov_b64 exec, s[34:35]
    buffer_store_dword v4, off, s[4:7], s29 sc1
    s_mov_b64 exec, -1
    s_add_u32 s22, s27, 73728
    s_sub_u32 s21, s22, 110592
    s_cselect_b32 s22, s22, s21
    ds_read_b128 v[56:59], v3 offset:3072
    ds_read_b128 v[60:63], v3 offset:21504
    s_add_u32 s23, s22, s25
    s_add_u32 m0, s23, 0
    s_nop 0
    buffer_load_dwordx4 v2, s[8:11], s24 offen offset:0 lds
    s_waitcnt lgkmcnt(6)
    v_mfma_f32_16x16x32_bf16 v[208:211], v[64:67], v[32:35], 0
    v_mfma_f32_16x16x32_bf16 v[212:215], v[136:139], v[32:35], 0
    v_mfma_f32_16x16x32_bf16 v[216:219], v[64:67], v[36:39], 0
    v_mfma_f32_16x16x32_bf16 v[220:223], v[136:139], v[36:39], 0
    v_mfma_f32_16x16x32_bf16 v[224:227], a[0:3], v[32:35], 0
    v_mfma_f32_16x16x32_bf16 v[228:231], a[72:75], v[32:35], 0
    v_mfma_f32_16x16x32_bf16 v[232:235], a[0:3], v[36:39], 0
    v_mfma_f32_16x16x32_bf16 v[236:239], a[72:75], v[36:39], 0
    ds_read_b128 v[32:35], v3 offset:4096
    ds_read_b128 v[36:39], v3 offset:22528
    s_add_u32 m0, s23, 960
    s_nop 0
    buffer_load_dwordx4 v2, s[8:11], s24 offen offset:64 lds
    s_waitcnt lgkmcnt(6)
    v_mfma_f32_16x16x32_bf16 v[208:211], v[68:71], v[40:43], v[208:211]
    v_mfma_f32_16x16x32_bf16 v[212:215], v[140:143], v[40:43], v[212:215]
    v_mfma_f32_16x16x32_bf16 v[216:219], v[68:71], v[44:47], v[216:219]
    v_mfma_f32_16x16x32_bf16 v[220:223], v[140:143], v[44:47], v[220:223]
    v_mfma_f32_16x16x32_bf16 v[224:227], a[4:7], v[40:43], v[224:227]
    v_mfma_f32_16x16x32_bf16 v[228:231], a[76:79], v[40:43], v[228:231]
    v_mfma_f32_16x16x32_bf16 v[232:235], a[4:7], v[44:47], v[232:235]
    v_mfma_f32_16x16x32_bf16 v[236:239], a[76:79], v[44:47], v[236:239]
    ds_read_b128 v[40:43], v3 offset:5120
    ds_read_b128 v[44:47], v3 offset:23552
    s_add_u32 m0, s23, 1920
    s_nop 0
    buffer_load_dwordx4 v2, s[8:11], s24 offen offset:128 lds
    s_waitcnt lgkmcnt(6)
    v_mfma_f32_16x16x32_bf16 v[208:211], v[72:75], v[48:51], v[208:211]
    v_mfma_f32_16x16x32_bf16 v[212:215], v[144:147], v[48:51], v[212:215]
    v_mfma_f32_16x16x32_bf16 v[216:219], v[72:75], v[52:55], v[216:219]
    v_mfma_f32_16x16x32_bf16 v[220:223], v[144:147], v[52:55], v[220:223]
    v_mfma_f32_16x16x32_bf16 v[224:227], a[8:11], v[48:51], v[224:227]
    v_mfma_f32_16x16x32_bf16 v[228:231], a[80:83], v[48:51], v[228:231]
    v_mfma_f32_16x16x32_bf16 v[232:235], a[8:11], v[52:55], v[232:235]
    v_mfma_f32_16x16x32_bf16 v[236:239], a[80:83], v[52:55], v[236:239]
    ds_read_b128 v[48:51], v3 offset:6144
    ds_read_b128 v[52:55], v3 offset:24576
    s_add_u32 m0, s23, 2880
    s_nop 0
    buffer_load_dwordx4 v2, s[8:11], s24 offen offset:192 lds
    s_waitcnt lgkmcnt(6)
    v_mfma_f32_16x16x32_bf16 v[208:211], v[76:79], v[56:59], v[208:211]
    v_mfma_f32_16x16x32_bf16 v[212:215], v[148:151], v[56:59], v[212:215]
    v_mfma_f32_16x16x32_bf16 v[216:219], v[76:79], v[60:63], v[216:219]
    v_mfma_f32_16x16x32_bf16 v[220:223], v[148:151], v[60:63], v[220:223]
    v_mfma_f32_16x16x32_bf16 v[224:227], a[12:15], v[56:59], v[224:227]
    v_mfma_f32_16x16x32_bf16 v[228:231], a[84:87], v[56:59], v[228:231]
    v_mfma_f32_16x16x32_bf16 v[232:235], a[12:15], v[60:63], v[232:235]
    v_mfma_f32_16x16x32_bf16 v[236:239], a[84:87], v[60:63], v[236:239]
    ds_read_b128 v[56:59], v3 offset:7168
    ds_read_b128 v[60:63], v3 offset:25600
    s_add_u32 m0, s23, 3840
    s_nop 0
    buffer_load_dwordx4 v2, s[8:11], s24 offen offset:256 lds
    s_waitcnt lgkmcnt(6)
    v_mfma_f32_16x16x32_bf16 v[208:211], v[80:83], v[32:35], v[208:211]
    v_mfma_f32_16x16x32_bf16 v[212:215], v[152:155], v[32:35], v[212:215]
    v_mfma_f32_16x16x32_bf16 v[216:219], v[80:83], v[36:39], v[216:219]
    v_mfma_f32_16x16x32_bf16 v[220:223], v[152:155], v[36:39], v[220:223]
    v_mfma_f32_16x16x32_bf16 v[224:227], a[16:19], v[32:35], v[224:227]
    v_mfma_f32_16x16x32_bf16 v[228:231], a[88:91], v[32:35], v[228:231]
    v_mfma_f32_16x16x32_bf16 v[232:235], a[16:19], v[36:39], v[232:235]
    v_mfma_f32_16x16x32_bf16 v[236:239], a[88:91], v[36:39], v[236:239]
    ds_read_b128 v[32:35], v3 offset:8192
    ds_read_b128 v[36:39], v3 offset:26624
    s_add_u32 m0, s23, 4800
    s_nop 0
    buffer_load_dwordx4 v2, s[8:11], s24 offen offset:320 lds
    s_waitcnt lgkmcnt(6)
    v_mfma_f32_16x16x32_bf16 v[208:211], v[84:87], v[40:43], v[208:211]
    v_mfma_f32_16x16x32_bf16 v[212:215], v[156:159], v[40:43], v[212:215]
    v_mfma_f32_16x16x32_bf16 v[216:219], v[84:87], v[44:47], v[216:219]
    v_mfma_f32_16x16x32_bf16 v[220:223], v[156:159], v[44:47], v[220:223]
    v_mfma_f32_16x16x32_bf16 v[224:227], a[20:23], v[40:43], v[224:227]
    v_mfma_f32_16x16x32_bf16 v[228:231], a[92:95], v[40:43], v[228:231]
    v_mfma_f32_16x16x32_bf16 v[232:235], a[20:23], v[44:47], v[232:235]
    v_mfma_f32_16x16x32_bf16 v[236:239], a[92:95], v[44:47], v[236:239]
    ds_read_b128 v[40:43], v3 offset:9216
    ds_read_b128 v[44:47], v3 offset:27648
    s_add_u32 m0, s23, 5760
    s_nop 0
    buffer_load_dwordx4 v2, s[8:11], s24 offen offset:384 lds
    s_waitcnt lgkmcnt(6)
    v_mfma_f32_16x16x32_bf16 v[208:211], v[88:91], v[48:51], v[208:211]
    v_mfma_f32_16x16x32_bf16 v[212:215], v[160:163], v[48:51], v[212:215]
    v_mfma_f32_16x16x32_bf16 v[216:219], v[88:91], v[52:55], v[216:219]
    v_mfma_f32_16x16x32_bf16 v[220:223], v[160:163], v[52:55], v[220:223]
    v_mfma_f32_16x16x32_bf16 v[224:227], a[24:27], v[48:51], v[224:227]
    v_mfma_f32_16x16x32_bf16 v[228:231], a[96:99], v[48:51], v[228:231]
    v_mfma_f32_16x16x32_bf16 v[232:235], a[24:27], v[52:55], v[232:235]
    v_mfma_f32_16x16x32_bf16 v[236:239], a[96:99], v[52:55], v[236:239]
    ds_read_b128 v[48:51], v3 offset:10240
    ds_read_b128 v[52:55], v3 offset:28672
    s_add_u32 m0, s23, 6720
    s_nop 0
    buffer_load_dwordx4 v2, s[8:11], s24 offen offset:448 lds
    s_waitcnt lgkmcnt(6)
    v_mfma_f32_16x16x32_bf16 v[208:211], v[92:95], v[56:59], v[208:211]
    v_mfma_f32_16x16x32_bf16 v[212:215], v[164:167], v[56:59], v[212:215]
    v_mfma_f32_16x16x32_bf16 v[216:219], v[92:95], v[60:63], v[216:219]
    v_mfma_f32_16x16x32_bf16 v[220:223], v[164:167], v[60:63], v[220:223]
    v_mfma_f32_16x16x32_bf16 v[224:227], a[28:31], v[56:59], v[224:227]
    v_mfma_f32_16x16x32_bf16 v[228:231], a[100:103], v[56:59], v[228:231]
    v_mfma_f32_16x16x32_bf16 v[232:235], a[28:31], v[60:63], v[232:235]
    v_mfma_f32_16x16x32_bf16 v[236:239], a[100:103], v[60:63], v[236:239]
    ds_read_b128 v[56:59], v3 offset:11264
    ds_read_b128 v[60:63], v3 offset:29696
    s_add_u32 m0, s23, 7680
    s_nop 0
    buffer_load_dwordx4 v2, s[8:11], s24 offen offset:512 lds
    s_add_u32 s24, s24, s42
    s_waitcnt lgkmcnt(6)
    v_mfma_f32_16x16x32_bf16 v[208:211], v[96:99], v[32:35], v[208:211]
    v_mfma_f32_16x16x32_bf16 v[212:215], v[168:171], v[32:35], v[212:215]
    v_mfma_f32_16x16x32_bf16 v[216:219], v[96:99], v[36:39], v[216:219]
    v_mfma_f32_16x16x32_bf16 v[220:223], v[168:171], v[36:39], v[220:223]
    v_mfma_f32_16x16x32_bf16 v[224:227], a[32:35], v[32:35], v[224:227]
    v_mfma_f32_16x16x32_bf16 v[228:231], a[104:107], v[32:35], v[228:231]
    v_mfma_f32_16x16x32_bf16 v[232:235], a[32:35], v[36:39], v[232:235]
    v_mfma_f32_16x16x32_bf16 v[236:239], a[104:107], v[36:39], v[236:239]
    ds_read_b128 v[32:35], v3 offset:12288
    ds_read_b128 v[36:39], v3 offset:30720
    s_waitcnt lgkmcnt(6)
    v_mfma_f32_16x16x32_bf16 v[208:211], v[100:103], v[40:43], v[208:211]
    v_mfma_f32_16x16x32_bf16 v[212:215], v[172:175], v[40:43], v[212:215]
    v_mfma_f32_16x16x32_bf16 v[216:219], v[100:103], v[44:47], v[216:219]
    v_mfma_f32_16x16x32_bf16 v[220:223], v[172:175], v[44:47], v[220:223]
    v_mfma_f32_16x16x32_bf16 v[224:227], a[36:39], v[40:43], v[224:227]
    v_mfma_f32_16x16x32_bf16 v[228:231], a[108:111], v[40:43], v[228:231]
    v_mfma_f32_16x16x32_bf16 v[232:235], a[36:39], v[44:47], v[232:235]
    v_mfma_f32_16x16x32_bf16 v[236:239], a[108:111], v[44:47], v[236:239]
    ds_read_b128 v[40:43], v3 offset:13312
    ds_read_b128 v[44:47], v3 offset:31744
    s_waitcnt lgkmcnt(6)
    v_mfma_f32_16x16x32_bf16 v[208:211], v[104:107], v[48:51], v[208:211]
    v_mfma_f32_16x16x32_bf16 v[212:215], v[176:179], v[48:51], v[212:215]
    v_mfma_f32_16x16x32_bf16 v[216:219], v[104:107], v[52:55], v[216:219]
    v_mfma_f32_16x16x32_bf16 v[220:223], v[176:179], v[52:55], v[220:223]
    v_mfma_f32_16x16x32_bf16 v[224:227], a[40:43], v[48:51], v[224:227]
    v_mfma_f32_16x16x32_bf16 v[228:231], a[112:115], v[48:51], v[228:231]
    v_mfma_f32_16x16x32_bf16 v[232:235], a[40:43], v[52:55], v[232:235]
    v_mfma_f32_16x16x32_bf16 v[236:239], a[112:115], v[52:55], v[236:239]
    ds_read_b128 v[48:51], v3 offset:14336
    ds_read_b128 v[52:55], v3 offset:32768
    s_waitcnt lgkmcnt(6)
    v_mfma_f32_16x16x32_bf16 v[208:211], v[108:111], v[56:59], v[208:211]
    v_mfma_f32_16x16x32_bf16 v[212:215], v[180:183], v[56:59], v[212:215]
    v_mfma_f32_16x16x32_bf16 v[216:219], v[108:111], v[60:63], v[216:219]
    v_mfma_f32_16x16x32_bf16 v[220:223], v[180:183], v[60:63], v[220:223]
    v_mfma_f32_16x16x32_bf16 v[224:227], a[44:47], v[56:59], v[224:227]
    v_mfma_f32_16x16x32_bf16 v[228:231], a[116:119], v[56:59], v[228:231]
    v_mfma_f32_16x16x32_bf16 v[232:235], a[44:47], v[60:63], v[232:235]
    v_mfma_f32_16x16x32_bf16 v[236:239], a[116:119], v[60:63], v[236:239]
    ds_read_b128 v[56:59], v3 offset:15360
    ds_read_b128 v[60:63], v3 offset:33792
    s_waitcnt lgkmcnt(6)
    v_mfma_f32_16x16x32_bf16 v[208:211], v[112:115], v[32:35], v[208:211]
    v_mfma_f32_16x16x32_bf16 v[212:215], v[184:187], v[32:35], v[212:215]
    v_mfma_f32_16x16x32_bf16 v[216:219], v[112:115], v[36:39], v[216:219]
    v_mfma_f32_16x16x32_bf16 v[220:223], v[184:187], v[36:39], v[220:223]
    v_mfma_f32_16x16x32_bf16 v[224:227], a[48:51], v[32:35], v[224:227]
    v_mfma_f32_16x16x32_bf16 v[228:231], a[120:123], v[32:35], v[228:231]
    v_mfma_f32_16x16x32_bf16 v[232:235], a[48:51], v[36:39], v[232:235]
    v_mfma_f32_16x16x32_bf16 v[236:239], a[120:123], v[36:39], v[236:239]
    ds_read_b128 v[32:35], v3 offset:16384
    ds_read_b128 v[36:39], v3 offset:34816
    s_waitcnt lgkmcnt(6)
    v_mfma_f32_16x16x32_bf16 v[208:211], v[116:119], v[40:43], v[208:211]
    v_mfma_f32_16x16x32_bf16 v[212:215], v[188:191], v[40:43], v[212:215]
    v_mfma_f32_16x16x32_bf16 v[216:219], v[116:119], v[44:47], v[216:219]
    v_mfma_f32_16x16x32_bf16 v[220:223], v[188:191], v[44:47], v[220:223]
    v_mfma_f32_16x16x32_bf16 v[224:227], a[52:55], v[40:43], v[224:227]
    v_mfma_f32_16x16x32_bf16 v[228:231], a[124:127], v[40:43], v[228:231]
    v_mfma_f32_16x16x32_bf16 v[232:235], a[52:55], v[44:47], v[232:235]
    v_mfma_f32_16x16x32_bf16 v[236:239], a[124:127], v[44:47], v[236:239]
    ds_read_b128 v[40:43], v3 offset:17408
    ds_read_b128 v[44:47], v3 offset:35840
    s_waitcnt lgkmcnt(6)
    v_mfma_f32_16x16x32_bf16 v[208:211], v[120:123], v[48:51], v[208:211]
    v_mfma_f32_16x16x32_bf16 v[212:215], v[192:195], v[48:51], v[212:215]
    v_mfma_f32_16x16x32_bf16 v[216:219], v[120:123], v[52:55], v[216:219]
    v_mfma_f32_16x16x32_bf16 v[220:223], v[192:195], v[52:55], v[220:223]
    v_mfma_f32_16x16x32_bf16 v[224:227], a[56:59], v[48:51], v[224:227]
    v_mfma_f32_16x16x32_bf16 v[228:231], a[128:131], v[48:51], v[228:231]
    v_mfma_f32_16x16x32_bf16 v[232:235], a[56:59], v[52:55], v[232:235]
    v_mfma_f32_16x16x32_bf16 v[236:239], a[128:131], v[52:55], v[236:239]
    s_waitcnt lgkmcnt(4)
    v_mfma_f32_16x16x32_bf16 v[208:211], v[124:127], v[56:59], v[208:211]
    v_mfma_f32_16x16x32_bf16 v[212:215], v[196:199], v[56:59], v[212:215]
    v_mfma_f32_16x16x32_bf16 v[216:219], v[124:127], v[60:63], v[216:219]
    v_mfma_f32_16x16x32_bf16 v[220:223], v[196:199], v[60:63], v[220:223]
    v_mfma_f32_16x16x32_bf16 v[224:227], a[60:63], v[56:59], v[224:227]
    v_mfma_f32_16x16x32_bf16 v[228:231], a[132:135], v[56:59], v[228:231]
    v_mfma_f32_16x16x32_bf16 v[232:235], a[60:63], v[60:63], v[232:235]
    v_mfma_f32_16x16x32_bf16 v[236:239], a[132:135], v[60:63], v[236:239]
    s_waitcnt lgkmcnt(2)
    v_mfma_f32_16x16x32_bf16 v[208:211], v[128:131], v[32:35], v[208:211]
    v_mfma_f32_16x16x32_bf16 v[212:215], v[200:203], v[32:35], v[212:215]
    v_mfma_f32_16x16x32_bf16 v[216:219], v[128:131], v[36:39], v[216:219]
    v_mfma_f32_16x16x32_bf16 v[220:223], v[200:203], v[36:39], v[220:223]
    v_mfma_f32_16x16x32_bf16 v[224:227], a[64:67], v[32:35], v[224:227]
    v_mfma_f32_16x16x32_bf16 v[228:231], a[136:139], v[32:35], v[228:231]
    v_mfma_f32_16x16x32_bf16 v[232:235], a[64:67], v[36:39], v[232:235]
    v_mfma_f32_16x16x32_bf16 v[236:239], a[136:139], v[36:39], v[236:239]
    s_waitcnt lgkmcnt(0)
    v_mfma_f32_16x16x32_bf16 v[208:211], v[132:135], v[40:43], v[208:211]
    v_mfma_f32_16x16x32_bf16 v[212:215], v[204:207], v[40:43], v[212:215]
    v_mfma_f32_16x16x32_bf16 v[216:219], v[132:135], v[44:47], v[216:219]
    v_mfma_f32_16x16x32_bf16 v[220:223], v[204:207], v[44:47], v[220:223]
    v_mfma_f32_16x16x32_bf16 v[224:227], a[68:71], v[40:43], v[224:227]
    v_mfma_f32_16x16x32_bf16 v[228:231], a[140:143], v[40:43], v[228:231]
    v_mfma_f32_16x16x32_bf16 v[232:235], a[68:71], v[44:47], v[232:235]
    v_mfma_f32_16x16x32_bf16 v[236:239], a[140:143], v[44:47], v[236:239]
    s_waitcnt vmcnt(9)
    v_cvt_pk_bf16_f32 v8, v208, v209
    v_cvt_pk_bf16_f32 v9, v210, v211
    v_cvt_pk_bf16_f32 v10, v212, v213
    v_cvt_pk_bf16_f32 v11, v214, v215
    s_mov_b32 s28, s26
    buffer_store_dwordx4 v[8:11], v7, s[4:7], s28 offen sc1
    v_cvt_pk_bf16_f32 v12, v216, v217
    v_cvt_pk_bf16_f32 v13, v218, v219
    v_cvt_pk_bf16_f32 v14, v220, v221
    v_cvt_pk_bf16_f32 v15, v222, v223
    s_add_u32 s28, s28, s40
    buffer_store_dwordx4 v[12:15], v7, s[4:7], s28 offen sc1
    v_cvt_pk_bf16_f32 v16, v224, v225
    v_cvt_pk_bf16_f32 v17, v226, v227
    v_cvt_pk_bf16_f32 v18, v228, v229
    v_cvt_pk_bf16_f32 v19, v230, v231
    s_add_u32 s28, s26, s43
    buffer_store_dwordx4 v[16:19], v7, s[4:7], s28 offen sc1
    v_cvt_pk_bf16_f32 v20, v232, v233
    v_cvt_pk_bf16_f32 v21, v234, v235
    v_cvt_pk_bf16_f32 v22, v236, v237
    v_cvt_pk_bf16_f32 v23, v238, v239
    s_add_u32 s28, s28, s40
    buffer_store_dwordx4 v[20:23], v7, s[4:7], s28 offen sc1
    s_add_u32 s26, s26, s41
    s_add_u32 s27, s27, 36864
    s_cmp_eq_u32 s27, 110592
    s_cselect_b32 s27, 0, s27
    s_add_u32 s30, s30, 1
    s_add_u32 s19, s19, s20
    s_cmp_lt_u32 s19, 64
    s_cbranch_scc1 qk_loop
    s_branch qk_done
qk_vloop:
    s_barrier
    v_add_u32 v3, s27, v1
    ds_read_b128 v[32:35], v3 offset:0
    ds_read_b128 v[36:39], v3 offset:18432
    ds_read_b128 v[40:43], v3 offset:1024
    ds_read_b128 v[44:47], v3 offset:19456
    ds_read_b128 v[48:51], v3 offset:2048
    ds_read_b128 v[52:55], v3 offset:20480
    s_sub_u32 s22, s30, 1
    v_mov_b32 v4, s22
    s_mov_b64 exec, s[34:35]
    buffer_store_dword v4, off, s[4:7], s29 sc1
    s_mov_b64 exec, -1
    s_add_u32 s22, s27, 73728
    s_sub_u32 s21, s22, 110592
    s_cselect_b32 s22, s22, s21
    ds_read_b128 v[56:59], v3 offset:3072
    ds_read_b128 v[60:63], v3 offset:21504
    s_add_u32 s23, s22, s25
    s_add_u32 m0, s23, 0
    s_nop 0
    buffer_load_dwordx4 v2, s[8:11], s24 offen offset:0 lds
    s_waitcnt lgkmcnt(6)
    v_mfma_f32_16x16x32_bf16 v[208:211], v[32:35], v[64:67], 0
    v_mfma_f32_16x16x32_bf16 v[212:215], v[32:35], v[136:139], 0
    v_mfma_f32_16x16x32_bf16 v[216:219], v[36:39], v[64:67], 0
    v_mfma_f32_16x16x32_bf16 v[220:223], v[36:39], v[136:139], 0
    v_mfma_f32_16x16x32_bf16 v[224:227], v[32:35], a[0:3], 0
    v_mfma_f32_16x16x32_bf16 v[228:231], v[32:35], a[72:75], 0
    v_mfma_f32_16x16x32_bf16 v[232:235], v[36:39], a[0:3], 0
    v_mfma_f32_16x16x32_bf16 v[236:239], v[36:39], a[72:75], 0
    ds_read_b128 v[32:35], v3 offset:4096
    ds_read_b128 v[36:39], v3 offset:22528
    s_add_u32 m0, s23, 960
    s_nop 0
    buffer_load_dwordx4 v2, s[8:11], s24 offen offset:64 lds
    s_waitcnt lgkmcnt(6)
    v_mfma_f32_16x16x32_bf16 v[208:211], v[40:43], v[68:71], v[208:211]
    v_mfma_f32_16x16x32_bf16 v[212:215], v[40:43], v[140:143], v[212:215]
    v_mfma_f32_16x16x32_bf16 v[216:219], v[44:47], v[68:71], v[216:219]
    v_mfma_f32_16x16x32_bf16 v[220:223], v[44:47], v[140:143], v[220:223]
    v_mfma_f32_16x16x32_bf16 v[224:227], v[40:43], a[4:7], v[224:227]
    v_mfma_f32_16x16x32_bf16 v[228:231], v[40:43], a[76:79], v[228:231]
    v_mfma_f32_16x16x32_bf16 v[232:235], v[44:47], a[4:7], v[232:235]
    v_mfma_f32_16x16x32_bf16 v[236:239], v[44:47], a[76:79], v[236:239]
    ds_read_b128 v[40:43], v3 offset:5120
    ds_read_b128 v[44:47], v3 offset:23552
    s_add_u32 m0, s23, 1920
    s_nop 0
    buffer_load_dwordx4 v2, s[8:11], s24 offen offset:128 lds
    s_waitcnt lgkmcnt(6)
    v_mfma_f32_16x16x32_bf16 v[208:211], v[48:51], v[72:75], v[208:211]
    v_mfma_f32_16x16x32_bf16 v[212:215], v[48:51], v[144:147], v[212:215]
    v_mfma_f32_16x16x32_bf16 v[216:219], v[52:55], v[72:75], v[216:219]
    v_mfma_f32_16x16x32_bf16 v[220:223], v[52:55], v[144:147], v[220:223]
    v_mfma_f32_16x16x32_bf16 v[224:227], v[48:51], a[8:11], v[224:227]
    v_mfma_f32_16x16x32_bf16 v[228:231], v[48:51], a[80:83], v[228:231]
    v_mfma_f32_16x16x32_bf16 v[232:235], v[52:55], a[8:11], v[232:235]
    v_mfma_f32_16x16x32_bf16 v[236:239], v[52:55], a[80:83], v[236:239]
    ds_read_b128 v[48:51], v3 offset:6144
    ds_read_b128 v[52:55], v3 offset:24576
    s_add_u32 m0, s23, 2880
    s_nop 0
    buffer_load_dwordx4 v2, s[8:11], s24 offen offset:192 lds
    s_waitcnt lgkmcnt(6)
    v_mfma_f32_16x16x32_bf16 v[208:211], v[56:59], v[76:79], v[208:211]
    v_mfma_f32_16x16x32_bf16 v[212:215], v[56:59], v[148:151], v[212:215]
    v_mfma_f32_16x16x32_bf16 v[216:219], v[60:63], v[76:79], v[216:219]
    v_mfma_f32_16x16x32_bf16 v[220:223], v[60:63], v[148:151], v[220:223]
    v_mfma_f32_16x16x32_bf16 v[224:227], v[56:59], a[12:15], v[224:227]
    v_mfma_f32_16x16x32_bf16 v[228:231], v[56:59], a[84:87], v[228:231]
    v_mfma_f32_16x16x32_bf16 v[232:235], v[60:63], a[12:15], v[232:235]
    v_mfma_f32_16x16x32_bf16 v[236:239], v[60:63], a[84:87], v[236:239]
    ds_read_b128 v[56:59], v3 offset:7168
    ds_read_b128 v[60:63], v3 offset:25600
    s_add_u32 m0, s23, 3840
    s_nop 0
    buffer_load_dwordx4 v2, s[8:11], s24 offen offset:256 lds
    s_waitcnt lgkmcnt(6)
    v_mfma_f32_16x16x32_bf16 v[208:211], v[32:35], v[80:83], v[208:211]
    v_mfma_f32_16x16x32_bf16 v[212:215], v[32:35], v[152:155], v[212:215]
    v_mfma_f32_16x16x32_bf16 v[216:219], v[36:39], v[80:83], v[216:219]
    v_mfma_f32_16x16x32_bf16 v[220:223], v[36:39], v[152:155], v[220:223]
    v_mfma_f32_16x16x32_bf16 v[224:227], v[32:35], a[16:19], v[224:227]
    v_mfma_f32_16x16x32_bf16 v[228:231], v[32:35], a[88:91], v[228:231]
    v_mfma_f32_16x16x32_bf16 v[232:235], v[36:39], a[16:19], v[232:235]
    v_mfma_f32_16x16x32_bf16 v[236:239], v[36:39], a[88:91], v[236:239]
    ds_read_b128 v[32:35], v3 offset:8192
    ds_read_b128 v[36:39], v3 offset:26624
    s_add_u32 m0, s23, 4800
    s_nop 0
    buffer_load_dwordx4 v2, s[8:11], s24 offen offset:320 lds
    s_waitcnt lgkmcnt(6)
    v_mfma_f32_16x16x32_bf16 v[208:211], v[40:43], v[84:87], v[208:211]
    v_mfma_f32_16x16x32_bf16 v[212:215], v[40:43], v[156:159], v[212:215]
    v_mfma_f32_16x16x32_bf16 v[216:219], v[44:47], v[84:87], v[216:219]
    v_mfma_f32_16x16x32_bf16 v[220:223], v[44:47], v[156:159], v[220:223]
    v_mfma_f32_16x16x32_bf16 v[224:227], v[40:43], a[20:23], v[224:227]
    v_mfma_f32_16x16x32_bf16 v[228:231], v[40:43], a[92:95], v[228:231]
    v_mfma_f32_16x16x32_bf16 v[232:235], v[44:47], a[20:23], v[232:235]
    v_mfma_f32_16x16x32_bf16 v[236:239], v[44:47], a[92:95], v[236:239]
    ds_read_b128 v[40:43], v3 offset:9216
    ds_read_b128 v[44:47], v3 offset:27648
    s_add_u32 m0, s23, 5760
    s_nop 0
    buffer_load_dwordx4 v2, s[8:11], s24 offen offset:384 lds
    s_waitcnt lgkmcnt(6)
    v_mfma_f32_16x16x32_bf16 v[208:211], v[48:51], v[88:91], v[208:211]
    v_mfma_f32_16x16x32_bf16 v[212:215], v[48:51], v[160:163], v[212:215]
    v_mfma_f32_16x16x32_bf16 v[216:219], v[52:55], v[88:91], v[216:219]
    v_mfma_f32_16x16x32_bf16 v[220:223], v[52:55], v[160:163], v[220:223]
    v_mfma_f32_16x16x32_bf16 v[224:227], v[48:51], a[24:27], v[224:227]
    v_mfma_f32_16x16x32_bf16 v[228:231], v[48:51], a[96:99], v[228:231]
    v_mfma_f32_16x16x32_bf16 v[232:235], v[52:55], a[24:27], v[232:235]
    v_mfma_f32_16x16x32_bf16 v[236:239], v[52:55], a[96:99], v[236:239]
    ds_read_b128 v[48:51], v3 offset:10240
    ds_read_b128 v[52:55], v3 offset:28672
    s_add_u32 m0, s23, 6720
    s_nop 0
    buffer_load_dwordx4 v2, s[8:11], s24 offen offset:448 lds
    s_waitcnt lgkmcnt(6)
    v_mfma_f32_16x16x32_bf16 v[208:211], v[56:59], v[92:95], v[208:211]
    v_mfma_f32_16x16x32_bf16 v[212:215], v[56:59], v[164:167], v[212:215]
    v_mfma_f32_16x16x32_bf16 v[216:219], v[60:63], v[92:95], v[216:219]
    v_mfma_f32_16x16x32_bf16 v[220:223], v[60:63], v[164:167], v[220:223]
    v_mfma_f32_16x16x32_bf16 v[224:227], v[56:59], a[28:31], v[224:227]
    v_mfma_f32_16x16x32_bf16 v[228:231], v[56:59], a[100:103], v[228:231]
    v_mfma_f32_16x16x32_bf16 v[232:235], v[60:63], a[28:31], v[232:235]
    v_mfma_f32_16x16x32_bf16 v[236:239], v[60:63], a[100:103], v[236:239]
    ds_read_b128 v[56:59], v3 offset:11264
    ds_read_b128 v[60:63], v3 offset:29696
    s_add_u32 m0, s23, 7680
    s_nop 0
    buffer_load_dwordx4 v2, s[8:11], s24 offen offset:512 lds
    s_add_u32 s24, s24, s42
    s_waitcnt lgkmcnt(6)
    v_mfma_f32_16x16x32_bf16 v[208:211], v[32:35], v[96:99], v[208:211]
    v_mfma_f32_16x16x32_bf16 v[212:215], v[32:35], v[168:171], v[212:215]
    v_mfma_f32_16x16x32_bf16 v[216:219], v[36:39], v[96:99], v[216:219]
    v_mfma_f32_16x16x32_bf16 v[220:223], v[36:39], v[168:171], v[220:223]
    v_mfma_f32_16x16x32_bf16 v[224:227], v[32:35], a[32:35], v[224:227]
    v_mfma_f32_16x16x32_bf16 v[228:231], v[32:35], a[104:107], v[228:231]
    v_mfma_f32_16x16x32_bf16 v[232:235], v[36:39], a[32:35], v[232:235]
    v_mfma_f32_16x16x32_bf16 v[236:239], v[36:39], a[104:107], v[236:239]
    ds_read_b128 v[32:35], v3 offset:12288
    ds_read_b128 v[36:39], v3 offset:30720
    s_waitcnt lgkmcnt(6)
    v_mfma_f32_16x16x32_bf16 v[208:211], v[40:43], v[100:103], v[208:211]
    v_mfma_f32_16x16x32_bf16 v[212:215], v[40:43], v[172:175], v[212:215]
    v_mfma_f32_16x16x32_bf16 v[216:219], v[44:47], v[100:103], v[216:219]
    v_mfma_f32_16x16x32_bf16 v[220:223], v[44:47], v[172:175], v[220:223]
    v_mfma_f32_16x16x32_bf16 v[224:227], v[40:43], a[36:39], v[224:227]
    v_mfma_f32_16x16x32_bf16 v[228:231], v[40:43], a[108:111], v[228:231]
    v_mfma_f32_16x16x32_bf16 v[232:235], v[44:47], a[36:39], v[232:235]
    v_mfma_f32_16x16x32_bf16 v[236:239], v[44:47], a[108:111], v[236:239]
    ds_read_b128 v[40:43], v3 offset:13312
    ds_read_b128 v[44:47], v3 offset:31744
    s_waitcnt lgkmcnt(6)
    v_mfma_f32_16x16x32_bf16 v[208:211], v[48:51], v[104:107], v[208:211]
    v_mfma_f32_16x16x32_bf16 v[212:215], v[48:51], v[176:179], v[212:215]
    v_mfma_f32_16x16x32_bf16 v[216:219], v[52:55], v[104:107], v[216:219]
    v_mfma_f32_16x16x32_bf16 v[220:223], v[52:55], v[176:179], v[220:223]
    v_mfma_f32_16x16x32_bf16 v[224:227], v[48:51], a[40:43], v[224:227]
    v_mfma_f32_16x16x32_bf16 v[228:231], v[48:51], a[112:115], v[228:231]
    v_mfma_f32_16x16x32_bf16 v[232:235], v[52:55], a[40:43], v[232:235]
    v_mfma_f32_16x16x32_bf16 v[236:239], v[52:55], a[112:115], v[236:239]
    ds_read_b128 v[48:51], v3 offset:14336
    ds_read_b128 v[52:55], v3 offset:32768
    s_waitcnt lgkmcnt(6)
    v_mfma_f32_16x16x32_bf16 v[208:211], v[56:59], v[108:111], v[208:211]
    v_mfma_f32_16x16x32_bf16 v[212:215], v[56:59], v[180:183], v[212:215]
    v_mfma_f32_16x16x32_bf16 v[216:219], v[60:63], v[108:111], v[216:219]
    v_mfma_f32_16x16x32_bf16 v[220:223], v[60:63], v[180:183], v[220:223]
    v_mfma_f32_16x16x32_bf16 v[224:227], v[56:59], a[44:47], v[224:227]
    v_mfma_f32_16x16x32_bf16 v[228:231], v[56:59], a[116:119], v[228:231]
    v_mfma_f32_16x16x32_bf16 v[232:235], v[60:63], a[44:47], v[232:235]
    v_mfma_f32_16x16x32_bf16 v[236:239], v[60:63], a[116:119], v[236:239]
    ds_read_b128 v[56:59], v3 offset:15360
    ds_read_b128 v[60:63], v3 offset:33792
    s_waitcnt lgkmcnt(6)
    v_mfma_f32_16x16x32_bf16 v[208:211], v[32:35], v[112:115], v[208:211]
    v_mfma_f32_16x16x32_bf16 v[212:215], v[32:35], v[184:187], v[212:215]
    v_mfma_f32_16x16x32_bf16 v[216:219], v[36:39], v[112:115], v[216:219]
    v_mfma_f32_16x16x32_bf16 v[220:223], v[36:39], v[184:187], v[220:223]
    v_mfma_f32_16x16x32_bf16 v[224:227], v[32:35], a[48:51], v[224:227]
    v_mfma_f32_16x16x32_bf16 v[228:231], v[32:35], a[120:123], v[228:231]
    v_mfma_f32_16x16x32_bf16 v[232:235], v[36:39], a[48:51], v[232:235]
    v_mfma_f32_16x16x32_bf16 v[236:239], v[36:39], a[120:123], v[236:239]
    ds_read_b128 v[32:35], v3 offset:16384
    ds_read_b128 v[36:39], v3 offset:34816
    s_waitcnt lgkmcnt(6)
    v_mfma_f32_16x16x32_bf16 v[208:211], v[40:43], v[116:119], v[208:211]
    v_mfma_f32_16x16x32_bf16 v[212:215], v[40:43], v[188:191], v[212:215]
    v_mfma_f32_16x16x32_bf16 v[216:219], v[44:47], v[116:119], v[216:219]
    v_mfma_f32_16x16x32_bf16 v[220:223], v[44:47], v[188:191], v[220:223]
    v_mfma_f32_16x16x32_bf16 v[224:227], v[40:43], a[52:55], v[224:227]
    v_mfma_f32_16x16x32_bf16 v[228:231], v[40:43], a[124:127], v[228:231]
    v_mfma_f32_16x16x32_bf16 v[232:235], v[44:47], a[52:55], v[232:235]
    v_mfma_f32_16x16x32_bf16 v[236:239], v[44:47], a[124:127], v[236:239]
    ds_read_b128 v[40:43], v3 offset:17408
    ds_read_b128 v[44:47], v3 offset:35840
    s_waitcnt lgkmcnt(6)
    v_mfma_f32_16x16x32_bf16 v[208:211], v[48:51], v[120:123], v[208:211]
    v_mfma_f32_16x16x32_bf16 v[212:215], v[48:51], v[192:195], v[212:215]
    v_mfma_f32_16x16x32_bf16 v[216:219], v[52:55], v[120:123], v[216:219]
    v_mfma_f32_16x16x32_bf16 v[220:223], v[52:55], v[192:195], v[220:223]
    v_mfma_f32_16x16x32_bf16 v[224:227], v[48:51], a[56:59], v[224:227]
    v_mfma_f32_16x16x32_bf16 v[228:231], v[48:51], a[128:131], v[228:231]
    v_mfma_f32_16x16x32_bf16 v[232:235], v[52:55], a[56:59], v[232:235]
    v_mfma_f32_16x16x32_bf16 v[236:239], v[52:55], a[128:131], v[236:239]
    s_waitcnt lgkmcnt(4)
    v_mfma_f32_16x16x32_bf16 v[208:211], v[56:59], v[124:127], v[208:211]
    v_mfma_f32_16x16x32_bf16 v[212:215], v[56:59], v[196:199], v[212:215]
    v_mfma_f32_16x16x32_bf16 v[216:219], v[60:63], v[124:127], v[216:219]
    v_mfma_f32_16x16x32_bf16 v[220:223], v[60:63], v[196:199], v[220:223]
    v_mfma_f32_16x16x32_bf16 v[224:227], v[56:59], a[60:63], v[224:227]
    v_mfma_f32_16x16x32_bf16 v[228:231], v[56:59], a[132:135], v[228:231]
    v_mfma_f32_16x16x32_bf16 v[232:235], v[60:63], a[60:63], v[232:235]
    v_mfma_f32_16x16x32_bf16 v[236:239], v[60:63], a[132:135], v[236:239]
    s_waitcnt lgkmcnt(2)
    v_mfma_f32_16x16x32_bf16 v[208:211], v[32:35], v[128:131], v[208:211]
    v_mfma_f32_16x16x32_bf16 v[212:215], v[32:35], v[200:203], v[212:215]
    v_mfma_f32_16x16x32_bf16 v[216:219], v[36:39], v[128:131], v[216:219]
    v_mfma_f32_16x16x32_bf16 v[220:223], v[36:39], v[200:203], v[220:223]
    v_mfma_f32_16x16x32_bf16 v[224:227], v[32:35], a[64:67], v[224:227]
    v_mfma_f32_16x16x32_bf16 v[228:231], v[32:35], a[136:139], v[228:231]
    v_mfma_f32_16x16x32_bf16 v[232:235], v[36:39], a[64:67], v[232:235]
    v_mfma_f32_16x16x32_bf16 v[236:239], v[36:39], a[136:139], v[236:239]
    s_waitcnt lgkmcnt(0)
    v_mfma_f32_16x16x32_bf16 v[208:211], v[40:43], v[132:135], v[208:211]
    v_mfma_f32_16x16x32_bf16 v[212:215], v[40:43], v[204:207], v[212:215]
    v_mfma_f32_16x16x32_bf16 v[216:219], v[44:47], v[132:135], v[216:219]
    v_mfma_f32_16x16x32_bf16 v[220:223], v[44:47], v[204:207], v[220:223]
    v_mfma_f32_16x16x32_bf16 v[224:227], v[40:43], a[68:71], v[224:227]
    v_mfma_f32_16x16x32_bf16 v[228:231], v[40:43], a[140:143], v[228:231]
    v_mfma_f32_16x16x32_bf16 v[232:235], v[44:47], a[68:71], v[232:235]
    v_mfma_f32_16x16x32_bf16 v[236:239], v[44:47], a[140:143], v[236:239]
    s_waitcnt vmcnt(9)
    v_cvt_pk_bf16_f32 v8, v208, v209
    v_cvt_pk_bf16_f32 v9, v210, v211
    v_cvt_pk_bf16_f32 v10, v216, v217
    v_cvt_pk_bf16_f32 v11, v218, v219
    s_mov_b32 s28, s26
    buffer_store_dwordx4 v[8:11], v7, s[4:7], s28 offen sc1
    v_cvt_pk_bf16_f32 v12, v212, v213
    v_cvt_pk_bf16_f32 v13, v214, v215
    v_cvt_pk_bf16_f32 v14, v220, v221
    v_cvt_pk_bf16_f32 v15, v222, v223
    s_add_u32 s28, s28, s40
    buffer_store_dwordx4 v[12:15], v7, s[4:7], s28 offen sc1
    v_cvt_pk_bf16_f32 v16, v224, v225
    v_cvt_pk_bf16_f32 v17, v226, v227
    v_cvt_pk_bf16_f32 v18, v232, v233
    v_cvt_pk_bf16_f32 v19, v234, v235
    s_add_u32 s28, s26, s43
    buffer_store_dwordx4 v[16:19], v7, s[4:7], s28 offen sc1
    v_cvt_pk_bf16_f32 v20, v228, v229
    v_cvt_pk_bf16_f32 v21, v230, v231
    v_cvt_pk_bf16_f32 v22, v236, v237
    v_cvt_pk_bf16_f32 v23, v238, v239
    s_add_u32 s28, s28, s40
    buffer_store_dwordx4 v[20:23], v7, s[4:7], s28 offen sc1
    s_add_u32 s26, s26, s41
    s_add_u32 s27, s27, 36864
    s_cmp_eq_u32 s27, 110592
    s_cselect_b32 s27, 0, s27
    s_add_u32 s30, s30, 1
    s_add_u32 s19, s19, s20
    s_cmp_lt_u32 s19, 64
    s_cbranch_scc1 qk_vloop
qk_done:
    s_waitcnt vmcnt(0)
    s_barrier
    s_add_u32 s22, s95, 63
    v_mov_b32 v4, s22
    s_mov_b64 exec, s[34:35]
    buffer_store_dword v4, off, s[4:7], s29 sc1
    s_mov_b64 exec, -1
    s_cmp_ge_u32 s36, 64
    s_cbranch_scc1 L_qkv_next
    s_lshr_b32 s33, s36, 5
    v_and_b32 v4, 63, v0
    v_lshrrev_b32 v5, 4, v4
    v_add_u32 v1, 0, v5
    v_mul_u32_u24 v6, 11, v1
    v_lshrrev_b32 v6, 5, v6
    v_add_u32 v1, v1, v6
    v_lshlrev_b32 v1, 7, v1
    v_and_b32 v6, 7, v4
    v_lshl_add_u32 v1, v6, 4, v1
    v_add_u32 v2, 4, v5
    v_mul_u32_u24 v6, 11, v2
    v_lshrrev_b32 v6, 5, v6
    v_add_u32 v2, v2, v6
    v_lshlrev_b32 v2, 7, v2
    v_and_b32 v6, 7, v4
    v_lshl_add_u32 v2, v6, 4, v2
    v_add_u32 v3, 8, v5
    v_mul_u32_u24 v6, 11, v3
    v_lshrrev_b32 v6, 5, v6
    v_add_u32 v3, v3, v6
    v_lshlrev_b32 v3, 7, v3
    v_and_b32 v6, 7, v4
    v_lshl_add_u32 v3, v6, 4, v3
    v_min_u32 v6, 23, v4
    v_lshlrev_b32 v6, 9, v6
    s_mov_b32 s19, s33
    s_mul_i32 s24, s19, 12288
    s_add_u32 s24, s24, 90177536
    s_lshl_b32 s26, s19, 5
    s_add_u32 s26, s26, s17
    s_lshl_b32 s26, s26, 12
    s_mov_b32 s21, 71303168
    s_cmp_eq_u32 s16, 2
    s_cselect_b32 s21, 80740352, s21
    s_add_u32 s26, s26, s21
    s_lshl_b32 s29, s17, 7
    s_lshl_b32 s21, s16, 1
    s_add_u32 s21, s21, s33
    s_lshl_b32 s21, s21, 2
    s_add_u32 s29, s29, s21
    s_add_u32 s29, s29, 125829240
mk_loop:
    s_cmp_lg_u32 s18, 0
    s_cbranch_scc1 mk_go
    s_mov_b32 s23, s24
    s_mov_b32 s21, 4194304
mk_wait:
    buffer_load_dword v4, v6, s[4:7], s23 offen offset:384 sc1
    s_sub_u32 s21, s21, 1
    s_cbranch_scc1 mk_go
    s_waitcnt vmcnt(0)
    v_cmp_ne_u32 vcc, s95, v4
    s_cbranch_vccz mk_go
    s_sleep 4
    s_branch mk_wait
mk_go:
    s_barrier
    s_mov_b32 s30, 4096
mk_again:
    v_mov_b32 v5, 0
    s_add_u32 s23, s24, 0
    buffer_load_dwordx4 v[24:27], v1, s[4:7], s23 offen offset:0 sc1
    buffer_load_dwordx4 v[28:31], v2, s[4:7], s23 offen offset:0 sc1
    buffer_load_dwordx4 v[32:35], v3, s[4:7], s23 offen offset:0 sc1
    buffer_load_dwordx4 v[36:39], v1, s[4:7], s23 offen offset:2048 sc1
    buffer_load_dwordx4 v[40:43], v2, s[4:7], s23 offen offset:2048 sc1
    buffer_load_dwordx4 v[44:47], v3, s[4:7], s23 offen offset:2048 sc1
    s_add_u32 s23, s24, 4096
    buffer_load_dwordx4 v[48:51], v1, s[4:7], s23 offen offset:0 sc1
    buffer_load_dwordx4 v[52:55], v2, s[4:7], s23 offen offset:0 sc1
    buffer_load_dwordx4 v[56:59], v3, s[4:7], s23 offen offset:0 sc1
    buffer_load_dwordx4 v[60:63], v1, s[4:7], s23 offen offset:2048 sc1
    buffer_load_dwordx4 v[208:211], v2, s[4:7], s23 offen offset:2048 sc1
    buffer_load_dwordx4 v[212:215], v3, s[4:7], s23 offen offset:2048 sc1
    s_add_u32 s23, s24, 8192
    buffer_load_dwordx4 v[216:219], v1, s[4:7], s23 offen offset:0 sc1
    buffer_load_dwordx4 v[220:223], v2, s[4:7], s23 offen offset:0 sc1
    buffer_load_dwordx4 v[224:227], v3, s[4:7], s23 offen offset:0 sc1
    buffer_load_dwordx4 v[228:231], v1, s[4:7], s23 offen offset:2048 sc1
    buffer_load_dwordx4 v[232:235], v2, s[4:7], s23 offen offset:2048 sc1
    buffer_load_dwordx4 v[236:239], v3, s[4:7], s23 offen offset:2048 sc1
    s_add_u32 s22, s19, s95
    s_add_u32 s22, s22, 1
    s_cmp_eq_u32 s16, 2
    s_cbranch_scc1 mk_v
    s_waitcnt vmcnt(17)
    v_mfma_f32_16x16x32_bf16 v[8:11], v[64:67], v[24:27], 0
    v_mfma_f32_16x16x32_bf16 v[12:15], v[136:139], v[24:27], 0
    v_max3_u32 v5, v5, v24, v25
    v_mfma_f32_16x16x32_bf16 v[16:19], a[0:3], v[24:27], 0
    v_mfma_f32_16x16x32_bf16 v[20:23], a[72:75], v[24:27], 0
    v_max3_u32 v5, v5, v26, v27
    s_waitcnt vmcnt(16)
    v_mfma_f32_16x16x32_bf16 v[8:11], v[68:71], v[28:31], v[8:11]
    v_mfma_f32_16x16x32_bf16 v[12:15], v[140:143], v[28:31], v[12:15]
    v_max3_u32 v5, v5, v28, v29
    v_mfma_f32_16x16x32_bf16 v[16:19], a[4:7], v[28:31], v[16:19]
    v_mfma_f32_16x16x32_bf16 v[20:23], a[76:79], v[28:31], v[20:23]
    v_max3_u32 v5, v5, v30, v31
    s_waitcnt vmcnt(15)
    v_mfma_f32_16x16x32_bf16 v[8:11], v[72:75], v[32:35], v[8:11]
    v_mfma_f32_16x16x32_bf16 v[12:15], v[144:147], v[32:35], v[12:15]
    v_max3_u32 v5, v5, v32, v33
    v_mfma_f32_16x16x32_bf16 v[16:19], a[8:11], v[32:35], v[16:19]
    v_mfma_f32_16x16x32_bf16 v[20:23], a[80:83], v[32:35], v[20:23]
    v_max3_u32 v5, v5, v34, v35
    s_waitcnt vmcnt(14)
    v_mfma_f32_16x16x32_bf16 v[8:11], v[76:79], v[36:39], v[8:11]
    v_mfma_f32_16x16x32_bf16 v[12:15], v[148:151], v[36:39], v[12:15]
    v_max3_u32 v5, v5, v36, v37
    v_mfma_f32_16x16x32_bf16 v[16:19], a[12:15], v[36:39], v[16:19]
    v_mfma_f32_16x16x32_bf16 v[20:23], a[84:87], v[36:39], v[20:23]
    v_max3_u32 v5, v5, v38, v39
    s_waitcnt vmcnt(13)
    v_mfma_f32_16x16x32_bf16 v[8:11], v[80:83], v[40:43], v[8:11]
    v_mfma_f32_16x16x32_bf16 v[12:15], v[152:155], v[40:43], v[12:15]
    v_max3_u32 v5, v5, v40, v41
    v_mfma_f32_16x16x32_bf16 v[16:19], a[16:19], v[40:43], v[16:19]
    v_mfma_f32_16x16x32_bf16 v[20:23], a[88:91], v[40:43], v[20:23]
    v_max3_u32 v5, v5, v42, v43
    s_waitcnt vmcnt(12)
    v_mfma_f32_16x16x32_bf16 v[8:11], v[84:87], v[44:47], v[8:11]
    v_mfma_f32_16x16x32_bf16 v[12:15], v[156:159], v[44:47], v[12:15]
    v_max3_u32 v5, v5, v44, v45
    v_mfma_f32_16x16x32_bf16 v[16:19], a[20:23], v[44:47], v[16:19]
    v_mfma_f32_16x16x32_bf16 v[20:23], a[92:95], v[44:47], v[20:23]
    v_max3_u32 v5, v5, v46, v47
    s_waitcnt vmcnt(11)
    v_mfma_f32_16x16x32_bf16 v[8:11], v[88:91], v[48:51], v[8:11]
    v_mfma_f32_16x16x32_bf16 v[12:15], v[160:163], v[48:51], v[12:15]
    v_max3_u32 v5, v5, v48, v49
    v_mfma_f32_16x16x32_bf16 v[16:19], a[24:27], v[48:51], v[16:19]
    v_mfma_f32_16x16x32_bf16 v[20:23], a[96:99], v[48:51], v[20:23]
    v_max3_u32 v5, v5, v50, v51
    s_waitcnt vmcnt(10)
    v_mfma_f32_16x16x32_bf16 v[8:11], v[92:95], v[52:55], v[8:11]
    v_mfma_f32_16x16x32_bf16 v[12:15], v[164:167], v[52:55], v[12:15]
    v_max3_u32 v5, v5, v52, v53
    v_mfma_f32_16x16x32_bf16 v[16:19], a[28:31], v[52:55], v[16:19]
    v_mfma_f32_16x16x32_bf16 v[20:23], a[100:103], v[52:55], v[20:23]
    v_max3_u32 v5, v5, v54, v55
    s_waitcnt vmcnt(9)
    v_mfma_f32_16x16x32_bf16 v[8:11], v[96:99], v[56:59], v[8:11]
    v_mfma_f32_16x16x32_bf16 v[12:15], v[168:171], v[56:59], v[12:15]
    v_max3_u32 v5, v5, v56, v57
    v_mfma_f32_16x16x32_bf16 v[16:19], a[32:35], v[56:59], v[16:19]
    v_mfma_f32_16x16x32_bf16 v[20:23], a[104:107], v[56:59], v[20:23]
    v_max3_u32 v5, v5, v58, v59
    s_waitcnt vmcnt(8)
    v_mfma_f32_16x16x32_bf16 v[8:11], v[100:103], v[60:63], v[8:11]
    v_mfma_f32_16x16x32_bf16 v[12:15], v[172:175], v[60:63], v[12:15]
    v_max3_u32 v5, v5, v60, v61
    v_mfma_f32_16x16x32_bf16 v[16:19], a[36:39], v[60:63], v[16:19]
    v_mfma_f32_16x16x32_bf16 v[20:23], a[108:111], v[60:63], v[20:23]
    v_max3_u32 v5, v5, v62, v63
    s_waitcnt vmcnt(7)
    v_mfma_f32_16x16x32_bf16 v[8:11], v[104:107], v[208:211], v[8:11]
    v_mfma_f32_16x16x32_bf16 v[12:15], v[176:179], v[208:211], v[12:15]
    v_max3_u32 v5, v5, v208, v209
    v_mfma_f32_16x16x32_bf16 v[16:19], a[40:43], v[208:211], v[16:19]
    v_mfma_f32_16x16x32_bf16 v[20:23], a[112:115], v[208:211], v[20:23]
    v_max3_u32 v5, v5, v210, v211
    s_waitcnt vmcnt(6)
    v_mfma_f32_16x16x32_bf16 v[8:11], v[108:111], v[212:215], v[8:11]
    v_mfma_f32_16x16x32_bf16 v[12:15], v[180:183], v[212:215], v[12:15]
    v_max3_u32 v5, v5, v212, v213
    v_mfma_f32_16x16x32_bf16 v[16:19], a[44:47], v[212:215], v[16:19]
    v_mfma_f32_16x16x32_bf16 v[20:23], a[116:119], v[212:215], v[20:23]
    v_max3_u32 v5, v5, v214, v215
    s_waitcnt vmcnt(5)
    v_mfma_f32_16x16x32_bf16 v[8:11], v[112:115], v[216:219], v[8:11]
    v_mfma_f32_16x16x32_bf16 v[12:15], v[184:187], v[216:219], v[12:15]
    v_max3_u32 v5, v5, v216, v217
    v_mfma_f32_16x16x32_bf16 v[16:19], a[48:51], v[216:219], v[16:19]
    v_mfma_f32_16x16x32_bf16 v[20:23], a[120:123], v[216:219], v[20:23]
    v_max3_u32 v5, v5, v218, v219
    s_waitcnt vmcnt(4)
    v_mfma_f32_16x16x32_bf16 v[8:11], v[116:119], v[220:223], v[8:11]
    v_mfma_f32_16x16x32_bf16 v[12:15], v[188:191], v[220:223], v[12:15]
    v_max3_u32 v5, v5, v220, v221
    v_mfma_f32_16x16x32_bf16 v[16:19], a[52:55], v[220:223], v[16:19]
    v_mfma_f32_16x16x32_bf16 v[20:23], a[124:127], v[220:223], v[20:23]
    v_max3_u32 v5, v5, v222, v223
    s_waitcnt vmcnt(3)
    v_mfma_f32_16x16x32_bf16 v[8:11], v[120:123], v[224:227], v[8:11]
    v_mfma_f32_16x16x32_bf16 v[12:15], v[192:195], v[224:227], v[12:15]
    v_max3_u32 v5, v5, v224, v225
    v_mfma_f32_16x16x32_bf16 v[16:19], a[56:59], v[224:227], v[16:19]
    v_mfma_f32_16x16x32_bf16 v[20:23], a[128:131], v[224:227], v[20:23]
    v_max3_u32 v5, v5, v226, v227
    s_waitcnt vmcnt(2)
    v_mfma_f32_16x16x32_bf16 v[8:11], v[124:127], v[228:231], v[8:11]
    v_mfma_f32_16x16x32_bf16 v[12:15], v[196:199], v[228:231], v[12:15]
    v_max3_u32 v5, v5, v228, v229
    v_mfma_f32_16x16x32_bf16 v[16:19], a[60:63], v[228:231], v[16:19]
    v_mfma_f32_16x16x32_bf16 v[20:23], a[132:135], v[228:231], v[20:23]
    v_max3_u32 v5, v5, v230, v231
    s_waitcnt vmcnt(1)
    v_mfma_f32_16x16x32_bf16 v[8:11], v[128:131], v[232:235], v[8:11]
    v_mfma_f32_16x16x32_bf16 v[12:15], v[200:203], v[232:235], v[12:15]
    v_max3_u32 v5, v5, v232, v233
    v_mfma_f32_16x16x32_bf16 v[16:19], a[64:67], v[232:235], v[16:19]
    v_mfma_f32_16x16x32_bf16 v[20:23], a[136:139], v[232:235], v[20:23]
    v_max3_u32 v5, v5, v234, v235
    s_waitcnt vmcnt(0)
    v_mfma_f32_16x16x32_bf16 v[8:11], v[132:135], v[236:239], v[8:11]
    v_mfma_f32_16x16x32_bf16 v[12:15], v[204:207], v[236:239], v[12:15]
    v_max3_u32 v5, v5, v236, v237
    v_mfma_f32_16x16x32_bf16 v[16:19], a[68:71], v[236:239], v[16:19]
    v_mfma_f32_16x16x32_bf16 v[20:23], a[140:143], v[236:239], v[20:23]
    v_max3_u32 v5, v5, v238, v239
    s_nop 5
    s_branch mk_st
mk_v:
    s_waitcnt vmcnt(17)
    v_mfma_f32_16x16x32_bf16 v[8:11], v[24:27], v[64:67], 0
    v_mfma_f32_16x16x32_bf16 v[12:15], v[24:27], v[136:139], 0
    v_max3_u32 v5, v5, v24, v25
    v_mfma_f32_16x16x32_bf16 v[16:19], v[24:27], a[0:3], 0
    v_mfma_f32_16x16x32_bf16 v[20:23], v[24:27], a[72:75], 0
    v_max3_u32 v5, v5, v26, v27
    s_waitcnt vmcnt(16)
    v_mfma_f32_16x16x32_bf16 v[8:11], v[28:31], v[68:71], v[8:11]
    v_mfma_f32_16x16x32_bf16 v[12:15], v[28:31], v[140:143], v[12:15]
    v_max3_u32 v5, v5, v28, v29
    v_mfma_f32_16x16x32_bf16 v[16:19], v[28:31], a[4:7], v[16:19]
    v_mfma_f32_16x16x32_bf16 v[20:23], v[28:31], a[76:79], v[20:23]
    v_max3_u32 v5, v5, v30, v31
    s_waitcnt vmcnt(15)
    v_mfma_f32_16x16x32_bf16 v[8:11], v[32:35], v[72:75], v[8:11]
    v_mfma_f32_16x16x32_bf16 v[12:15], v[32:35], v[144:147], v[12:15]
    v_max3_u32 v5, v5, v32, v33
    v_mfma_f32_16x16x32_bf16 v[16:19], v[32:35], a[8:11], v[16:19]
    v_mfma_f32_16x16x32_bf16 v[20:23], v[32:35], a[80:83], v[20:23]
    v_max3_u32 v5, v5, v34, v35
    s_waitcnt vmcnt(14)
    v_mfma_f32_16x16x32_bf16 v[8:11], v[36:39], v[76:79], v[8:11]
    v_mfma_f32_16x16x32_bf16 v[12:15], v[36:39], v[148:151], v[12:15]
    v_max3_u32 v5, v5, v36, v37
    v_mfma_f32_16x16x32_bf16 v[16:19], v[36:39], a[12:15], v[16:19]
    v_mfma_f32_16x16x32_bf16 v[20:23], v[36:39], a[84:87], v[20:23]
    v_max3_u32 v5, v5, v38, v39
    s_waitcnt vmcnt(13)
    v_mfma_f32_16x16x32_bf16 v[8:11], v[40:43], v[80:83], v[8:11]
    v_mfma_f32_16x16x32_bf16 v[12:15], v[40:43], v[152:155], v[12:15]
    v_max3_u32 v5, v5, v40, v41
    v_mfma_f32_16x16x32_bf16 v[16:19], v[40:43], a[16:19], v[16:19]
    v_mfma_f32_16x16x32_bf16 v[20:23], v[40:43], a[88:91], v[20:23]
    v_max3_u32 v5, v5, v42, v43
    s_waitcnt vmcnt(12)
    v_mfma_f32_16x16x32_bf16 v[8:11], v[44:47], v[84:87], v[8:11]
    v_mfma_f32_16x16x32_bf16 v[12:15], v[44:47], v[156:159], v[12:15]
    v_max3_u32 v5, v5, v44, v45
    v_mfma_f32_16x16x32_bf16 v[16:19], v[44:47], a[20:23], v[16:19]
    v_mfma_f32_16x16x32_bf16 v[20:23], v[44:47], a[92:95], v[20:23]
    v_max3_u32 v5, v5, v46, v47
    s_waitcnt vmcnt(11)
    v_mfma_f32_16x16x32_bf16 v[8:11], v[48:51], v[88:91], v[8:11]
    v_mfma_f32_16x16x32_bf16 v[12:15], v[48:51], v[160:163], v[12:15]
    v_max3_u32 v5, v5, v48, v49
    v_mfma_f32_16x16x32_bf16 v[16:19], v[48:51], a[24:27], v[16:19]
    v_mfma_f32_16x16x32_bf16 v[20:23], v[48:51], a[96:99], v[20:23]
    v_max3_u32 v5, v5, v50, v51
    s_waitcnt vmcnt(10)
    v_mfma_f32_16x16x32_bf16 v[8:11], v[52:55], v[92:95], v[8:11]
    v_mfma_f32_16x16x32_bf16 v[12:15], v[52:55], v[164:167], v[12:15]
    v_max3_u32 v5, v5, v52, v53
    v_mfma_f32_16x16x32_bf16 v[16:19], v[52:55], a[28:31], v[16:19]
    v_mfma_f32_16x16x32_bf16 v[20:23], v[52:55], a[100:103], v[20:23]
    v_max3_u32 v5, v5, v54, v55
    s_waitcnt vmcnt(9)
    v_mfma_f32_16x16x32_bf16 v[8:11], v[56:59], v[96:99], v[8:11]
    v_mfma_f32_16x16x32_bf16 v[12:15], v[56:59], v[168:171], v[12:15]
    v_max3_u32 v5, v5, v56, v57
    v_mfma_f32_16x16x32_bf16 v[16:19], v[56:59], a[32:35], v[16:19]
    v_mfma_f32_16x16x32_bf16 v[20:23], v[56:59], a[104:107], v[20:23]
    v_max3_u32 v5, v5, v58, v59
    s_waitcnt vmcnt(8)
    v_mfma_f32_16x16x32_bf16 v[8:11], v[60:63], v[100:103], v[8:11]
    v_mfma_f32_16x16x32_bf16 v[12:15], v[60:63], v[172:175], v[12:15]
    v_max3_u32 v5, v5, v60, v61
    v_mfma_f32_16x16x32_bf16 v[16:19], v[60:63], a[36:39], v[16:19]
    v_mfma_f32_16x16x32_bf16 v[20:23], v[60:63], a[108:111], v[20:23]
    v_max3_u32 v5, v5, v62, v63
    s_waitcnt vmcnt(7)
    v_mfma_f32_16x16x32_bf16 v[8:11], v[208:211], v[104:107], v[8:11]
    v_mfma_f32_16x16x32_bf16 v[12:15], v[208:211], v[176:179], v[12:15]
    v_max3_u32 v5, v5, v208, v209
    v_mfma_f32_16x16x32_bf16 v[16:19], v[208:211], a[40:43], v[16:19]
    v_mfma_f32_16x16x32_bf16 v[20:23], v[208:211], a[112:115], v[20:23]
    v_max3_u32 v5, v5, v210, v211
    s_waitcnt vmcnt(6)
    v_mfma_f32_16x16x32_bf16 v[8:11], v[212:215], v[108:111], v[8:11]
    v_mfma_f32_16x16x32_bf16 v[12:15], v[212:215], v[180:183], v[12:15]
    v_max3_u32 v5, v5, v212, v213
    v_mfma_f32_16x16x32_bf16 v[16:19], v[212:215], a[44:47], v[16:19]
    v_mfma_f32_16x16x32_bf16 v[20:23], v[212:215], a[116:119], v[20:23]
    v_max3_u32 v5, v5, v214, v215
    s_waitcnt vmcnt(5)
    v_mfma_f32_16x16x32_bf16 v[8:11], v[216:219], v[112:115], v[8:11]
    v_mfma_f32_16x16x32_bf16 v[12:15], v[216:219], v[184:187], v[12:15]
    v_max3_u32 v5, v5, v216, v217
    v_mfma_f32_16x16x32_bf16 v[16:19], v[216:219], a[48:51], v[16:19]
    v_mfma_f32_16x16x32_bf16 v[20:23], v[216:219], a[120:123], v[20:23]
    v_max3_u32 v5, v5, v218, v219
    s_waitcnt vmcnt(4)
    v_mfma_f32_16x16x32_bf16 v[8:11], v[220:223], v[116:119], v[8:11]
    v_mfma_f32_16x16x32_bf16 v[12:15], v[220:223], v[188:191], v[12:15]
    v_max3_u32 v5, v5, v220, v221
    v_mfma_f32_16x16x32_bf16 v[16:19], v[220:223], a[52:55], v[16:19]
    v_mfma_f32_16x16x32_bf16 v[20:23], v[220:223], a[124:127], v[20:23]
    v_max3_u32 v5, v5, v222, v223
    s_waitcnt vmcnt(3)
    v_mfma_f32_16x16x32_bf16 v[8:11], v[224:227], v[120:123], v[8:11]
    v_mfma_f32_16x16x32_bf16 v[12:15], v[224:227], v[192:195], v[12:15]
    v_max3_u32 v5, v5, v224, v225
    v_mfma_f32_16x16x32_bf16 v[16:19], v[224:227], a[56:59], v[16:19]
    v_mfma_f32_16x16x32_bf16 v[20:23], v[224:227], a[128:131], v[20:23]
    v_max3_u32 v5, v5, v226, v227
    s_waitcnt vmcnt(2)
    v_mfma_f32_16x16x32_bf16 v[8:11], v[228:231], v[124:127], v[8:11]
    v_mfma_f32_16x16x32_bf16 v[12:15], v[228:231], v[196:199], v[12:15]
    v_max3_u32 v5, v5, v228, v229
    v_mfma_f32_16x16x32_bf16 v[16:19], v[228:231], a[60:63], v[16:19]
    v_mfma_f32_16x16x32_bf16 v[20:23], v[228:231], a[132:135], v[20:23]
    v_max3_u32 v5, v5, v230, v231
    s_waitcnt vmcnt(1)
    v_mfma_f32_16x16x32_bf16 v[8:11], v[232:235], v[128:131], v[8:11]
    v_mfma_f32_16x16x32_bf16 v[12:15], v[232:235], v[200:203], v[12:15]
    v_max3_u32 v5, v5, v232, v233
    v_mfma_f32_16x16x32_bf16 v[16:19], v[232:235], a[64:67], v[16:19]
    v_mfma_f32_16x16x32_bf16 v[20:23], v[232:235], a[136:139], v[20:23]
    v_max3_u32 v5, v5, v234, v235
    s_waitcnt vmcnt(0)
    v_mfma_f32_16x16x32_bf16 v[8:11], v[236:239], v[132:135], v[8:11]
    v_mfma_f32_16x16x32_bf16 v[12:15], v[236:239], v[204:207], v[12:15]
    v_max3_u32 v5, v5, v236, v237
    v_mfma_f32_16x16x32_bf16 v[16:19], v[236:239], a[68:71], v[16:19]
    v_mfma_f32_16x16x32_bf16 v[20:23], v[236:239], a[140:143], v[20:23]
    v_max3_u32 v5, v5, v238, v239
    v_pk_mul_f32 v[8:9], v[8:9], 0.5 op_sel_hi:[1,0]
    v_pk_mul_f32 v[10:11], v[10:11], 0.5 op_sel_hi:[1,0]
    v_pk_mul_f32 v[12:13], v[12:13], 0.5 op_sel_hi:[1,0]
    v_pk_mul_f32 v[14:15], v[14:15], 0.5 op_sel_hi:[1,0]
    v_pk_mul_f32 v[16:17], v[16:17], 0.5 op_sel_hi:[1,0]
    v_pk_mul_f32 v[18:19], v[18:19], 0.5 op_sel_hi:[1,0]
    v_pk_mul_f32 v[20:21], v[20:21], 0.5 op_sel_hi:[1,0]
    v_pk_mul_f32 v[22:23], v[22:23], 0.5 op_sel_hi:[1,0]
    s_nop 1
mk_st:
    v_cmp_eq_u32 vcc, -1, v5
    s_sub_u32 s30, s30, 1
    s_cbranch_scc1 mk_ok
    s_cbranch_vccnz mk_again
mk_ok:
    s_add_u32 s24, s24, 24576
    v_cvt_pk_bf16_f32 v24, v8, v9
    v_cvt_pk_bf16_f32 v25, v10, v11
    v_cvt_pk_bf16_f32 v26, v12, v13
    v_cvt_pk_bf16_f32 v27, v14, v15
    v_cvt_pk_bf16_f32 v28, v16, v17
    v_cvt_pk_bf16_f32 v29, v18, v19
    v_cvt_pk_bf16_f32 v30, v20, v21
    v_cvt_pk_bf16_f32 v31, v22, v23
    s_add_u32 s21, s26, 4096
    buffer_store_dwordx4 v[24:27], v7, s[4:7], s26 offen sc1
    buffer_store_dwordx4 v[28:31], v7, s[4:7], s21 offen sc1
    s_waitcnt vmcnt(0)
    s_barrier
    v_mov_b32 v4, s22
    s_mov_b64 exec, s[34:35]
    buffer_store_dword v4, off, s[4:7], s29 sc1
    s_mov_b64 exec, -1
    s_add_u32 s19, s19, 2
    s_add_u32 s26, s26, 262144
    s_cmp_lt_u32 s19, 62
    s_cbranch_scc1 mk_loop
    s_endpgm
L_ssm_next:
    s_mov_b32 s37, 8
    v_mov_b32 v250, 1
    v_mov_b32 v251, 163832
    v_cmp_eq_u32 vcc, 0, v0
    s_nop 0
    s_and_saveexec_b64 s[38:39], vcc
    s_cbranch_execz tk8
    buffer_atomic_add v250, off, s[96:99], s37 sc0
    s_waitcnt vmcnt(0)
    ds_write_b32 v251, v250
    s_waitcnt lgkmcnt(0)
tk8:
    s_mov_b64 exec, -1
    s_barrier
    ds_read_b32 v252, v251
    s_waitcnt lgkmcnt(0)
    v_readfirstlane_b32 s20, v252
    s_barrier
    s_nop 3
    s_cmp_ge_u32 s20, 144
    s_cbranch_scc1 L_phase2
    s_lshl_b32 s20, s20, 2
    v_lshrrev_b32 v5, 6, v0
    s_nop 0
    v_readfirstlane_b32 s21, v5
    v_and_b32 v1, 63, v0
    v_and_b32 v2, 15, v1
    v_lshrrev_b32 v3, 4, v1
    v_lshlrev_b32 v4, 14, v5
    s_mov_b32 s8, s62
    s_mov_b32 s9, s63
    s_mov_b32 s10, 2359296
    s_mov_b32 s11, 0x20000
    s_mov_b32 s16, s76
    s_mov_b32 s17, s77
    s_mov_b32 s18, 4718592
    s_mov_b32 s19, 0x20000
    v_mul_u32_u24 v5, 9216, v0
    s_lshl_b32 s22, s20, 1
    s_add_u32 s23, s22, 0
    buffer_load_dwordx2 v[8:9], v5, s[8:11], s23 offen
    s_add_u32 s23, s22, 1152
    buffer_load_dwordx2 v[10:11], v5, s[8:11], s23 offen
    s_add_u32 s23, s22, 2304
    buffer_load_dwordx2 v[12:13], v5, s[8:11], s23 offen
    s_add_u32 s23, s22, 3456
    buffer_load_dwordx2 v[14:15], v5, s[8:11], s23 offen
    s_add_u32 s23, s22, 4608
    buffer_load_dwordx2 v[16:17], v5, s[8:11], s23 offen
    s_add_u32 s23, s22, 5760
    buffer_load_dwordx2 v[18:19], v5, s[8:11], s23 offen
    s_add_u32 s23, s22, 6912
    buffer_load_dwordx2 v[20:21], v5, s[8:11], s23 offen
    s_add_u32 s23, s22, 8064
    buffer_load_dwordx2 v[22:23], v5, s[8:11], s23 offen
    s_add_u32 s22, s20, s21
    s_lshl_b32 s23, s22, 8
    v_lshlrev_b32 v6, 3, v2
    v_lshl_add_u32 v6, v3, 1, v6
    s_mov_b32 s12, s64
    s_mov_b32 s13, s65
    s_mov_b32 s14, 147456
    s_mov_b32 s15, 0x20000
    buffer_load_ushort v24, v6, s[12:15], s23 offen offset:0
    buffer_load_ushort v28, v6, s[12:15], s23 offen offset:128
    s_mov_b32 s12, s66
    s_mov_b32 s13, s67
    s_mov_b32 s14, 147456
    s_mov_b32 s15, 0x20000
    buffer_load_ushort v25, v6, s[12:15], s23 offen offset:0
    buffer_load_ushort v29, v6, s[12:15], s23 offen offset:128
    s_mov_b32 s12, s68
    s_mov_b32 s13, s69
    s_mov_b32 s14, 147456
    s_mov_b32 s15, 0x20000
    buffer_load_ushort v26, v6, s[12:15], s23 offen offset:0
    buffer_load_ushort v30, v6, s[12:15], s23 offen offset:128
    s_mov_b32 s12, s70
    s_mov_b32 s13, s71
    s_mov_b32 s14, 147456
    s_mov_b32 s15, 0x20000
    buffer_load_ushort v27, v6, s[12:15], s23 offen offset:0
    buffer_load_ushort v31, v6, s[12:15], s23 offen offset:128
    s_mov_b32 s12, s72
    s_mov_b32 s13, s73
    s_mov_b32 s14, 1152
    s_mov_b32 s15, 0x20000
    s_lshl_b32 s23, s22, 1
    buffer_load_ushort v32, off, s[12:15], s23
    s_mov_b32 s26, 0x3fb8aa3b
    s_mov_b32 s27, 0x3e22f983
    v_mov_b32 v34, 0
    v_mov_b32 v35, 0
    v_lshl_add_u32 v6, v1, 3, v4
    ds_write_b64 v6, v[34:35] offset:0
    s_waitcnt vmcnt(0)
    v_mov_b32 v36, 0x05040100
    v_mov_b32 v37, 0x07060302
    v_lshlrev_b32 v6, 4, v0
    v_perm_b32 v40, v10, v8, v36
    v_perm_b32 v41, v14, v12, v36
    v_perm_b32 v42, v18, v16, v36
    v_perm_b32 v43, v22, v20, v36
    ds_write_b128 v6, v[40:43] offset:512
    s_nop 1
    v_perm_b32 v40, v10, v8, v37
    v_perm_b32 v41, v14, v12, v37
    v_perm_b32 v42, v18, v16, v37
    v_perm_b32 v43, v22, v20, v37
    ds_write_b128 v6, v[40:43] offset:16896
    s_nop 1
    v_perm_b32 v40, v11, v9, v36
    v_perm_b32 v41, v15, v13, v36
    v_perm_b32 v42, v19, v17, v36
    v_perm_b32 v43, v23, v21, v36
    ds_write_b128 v6, v[40:43] offset:33280
    s_nop 1
    v_perm_b32 v40, v11, v9, v37
    v_perm_b32 v41, v15, v13, v37
    v_perm_b32 v42, v19, v17, v37
    v_perm_b32 v43, v23, v21, v37
    ds_write_b128 v6, v[40:43] offset:49664
    s_nop 1
    v_lshlrev_b32 v32, 16, v32
    v_mul_f32 v32, s26, v32
    v_exp_f32 v32, v32
    s_nop 0
    v_cvt_pk_bf16_f32 v32, v32, v32
    v_and_b32 v32, 0xffff0000, v32
    v_add_f32 v33, v32, v32
    v_lshlrev_b32 v24, 16, v24
    v_mul_f32 v24, s26, v24
    v_exp_f32 v24, v24
    s_nop 0
    v_cvt_pk_bf16_f32 v24, v24, v24
    v_and_b32 v24, 0xffff0000, v24
    v_mul_f32 v24, v24, v32
    v_mul_f32 v24, s26, v24
    v_sub_f32 v24, 0, v24
    v_lshlrev_b32 v25, 16, v25
    v_mul_f32 v25, v25, v32
    v_mul_f32 v25, s27, v25
    v_lshlrev_b32 v26, 16, v26
    v_mul_f32 v26, v26, v33
    v_lshlrev_b32 v27, 16, v27
    v_mul_f32 v27, v27, v33
    v_lshlrev_b32 v28, 16, v28
    v_mul_f32 v28, s26, v28
    v_exp_f32 v28, v28
    s_nop 0
    v_cvt_pk_bf16_f32 v28, v28, v28
    v_and_b32 v28, 0xffff0000, v28
    v_mul_f32 v28, v28, v32
    v_mul_f32 v28, s26, v28
    v_sub_f32 v28, 0, v28
    v_lshlrev_b32 v29, 16, v29
    v_mul_f32 v29, v29, v32
    v_mul_f32 v29, s27, v29
    v_lshlrev_b32 v30, 16, v30
    v_mul_f32 v30, v30, v33
    v_lshlrev_b32 v31, 16, v31
    v_mul_f32 v31, v31, v33
    v_cvt_f32_u32 v47, v2
    v_mul_f32 v44, 0x41800000, v47
    v_and_b32 v5, 7, v2
    v_add_u32 v5, 8, v5
    v_cvt_f32_u32 v5, v5
    v_mul_f32 v45, 0x42000000, v5
    v_mul_f32 v6, 0x42800000, v5
    v_cmp_lt_u32 vcc, 7, v2
    s_nop 1
    v_cndmask_b32 v45, v45, v6, vcc
    v_add_f32 v5, 0x41000000, v47
    v_mul_f32 v46, 0x43000000, v5
    v_mov_b32 v48, 0
    v_mov_b32 v49, 0
    v_mov_b32 v50, 0
    v_mov_b32 v51, 0
    v_mov_b32 v52, 0
    v_mov_b32 v53, 0
    v_mov_b32 v54, 0
    v_mov_b32 v55, 0
    v_mov_b32 v56, 0
    v_mov_b32 v57, 0
    v_mov_b32 v58, 0
    v_mov_b32 v59, 0
    v_mov_b32 v60, 0
    v_mov_b32 v61, 0
    v_mov_b32 v62, 0
    v_mov_b32 v63, 0
    v_mov_b32_dpp v64, v24 row_newbcast:0 row_mask:0xf bank_mask:0xf
    v_mov_b32_dpp v65, v25 row_newbcast:0 row_mask:0xf bank_mask:0xf
    v_mov_b32_dpp v66, v26 row_newbcast:0 row_mask:0xf bank_mask:0xf
    v_mov_b32_dpp v67, v27 row_newbcast:0 row_mask:0xf bank_mask:0xf
    v_mul_f32 v82, v64, v47
    v_mul_f32 v83, v65, v47
    v_exp_f32 v82, v82
    v_fract_f32 v83, v83
    v_cos_f32 v74, v83
    v_sin_f32 v75, v83
    v_mul_f32 v74, v74, v82
    v_mul_f32 v75, v75, v82
    v_mul_f32 v84, v75, v75
    v_add_f32 v85, v74, v74
    v_fma_f32 v76, v74, v74, -v84
    v_mul_f32 v77, v85, v75
    v_mul_f32 v84, v77, v77
    v_add_f32 v85, v76, v76
    v_fma_f32 v78, v76, v76, -v84
    v_mul_f32 v79, v85, v77
    v_mul_f32 v84, v79, v79
    v_add_f32 v85, v78, v78
    v_fma_f32 v80, v78, v78, -v84
    v_mul_f32 v81, v85, v79
    v_mul_f32 v82, v64, v44
    v_mul_f32 v83, v65, v44
    v_exp_f32 v82, v82
    v_fract_f32 v83, v83
    v_cos_f32 v68, v83
    v_sin_f32 v69, v83
    v_mul_f32 v68, v68, v82
    v_mul_f32 v69, v69, v82
    v_mul_f32 v84, v67, v69
    v_mul_f32 v85, v67, v68
    v_fma_f32 v68, v66, v68, -v84
    v_fma_f32 v69, -v66, v69, -v85
    v_mul_f32 v82, v64, v45
    v_mul_f32 v83, v65, v45
    v_exp_f32 v82, v82
    v_fract_f32 v83, v83
    v_cos_f32 v70, v83
    v_sin_f32 v71, v83
    v_mul_f32 v70, v70, v82
    v_mul_f32 v71, v71, v82
    v_mul_f32 v84, v67, v71
    v_mul_f32 v85, v67, v70
    v_fma_f32 v70, v66, v70, -v84
    v_fma_f32 v71, -v66, v71, -v85
    v_mul_f32 v82, v64, v46
    v_mul_f32 v83, v65, v46
    v_exp_f32 v82, v82
    v_fract_f32 v83, v83
    v_cos_f32 v72, v83
    v_sin_f32 v73, v83
    v_mul_f32 v72, v72, v82
    v_mul_f32 v73, v73, v82
    v_mul_f32 v84, v67, v73
    v_mul_f32 v85, v67, v72
    v_fma_f32 v72, v66, v72, -v84
    v_fma_f32 v73, -v66, v73, -v85
    v_mfma_f32_16x16x4_f32 v[48:51], v68, v74, v[48:51]
    v_mfma_f32_16x16x4_f32 v[52:55], v70, v76, v[52:55]
    v_mfma_f32_16x16x4_f32 v[56:59], v70, v78, v[56:59]
    v_mfma_f32_16x16x4_f32 v[60:63], v72, v80, v[60:63]
    v_mfma_f32_16x16x4_f32 v[48:51], v69, v75, v[48:51]
    v_mfma_f32_16x16x4_f32 v[52:55], v71, v77, v[52:55]
    v_mfma_f32_16x16x4_f32 v[56:59], v71, v79, v[56:59]
    v_mfma_f32_16x16x4_f32 v[60:63], v73, v81, v[60:63]
    v_mov_b32_dpp v64, v24 row_newbcast:1 row_mask:0xf bank_mask:0xf
    v_mov_b32_dpp v65, v25 row_newbcast:1 row_mask:0xf bank_mask:0xf
    v_mov_b32_dpp v66, v26 row_newbcast:1 row_mask:0xf bank_mask:0xf
    v_mov_b32_dpp v67, v27 row_newbcast:1 row_mask:0xf bank_mask:0xf
    v_mul_f32 v82, v64, v47
    v_mul_f32 v83, v65, v47
    v_exp_f32 v82, v82
    v_fract_f32 v83, v83
    v_cos_f32 v74, v83
    v_sin_f32 v75, v83
    v_mul_f32 v74, v74, v82
    v_mul_f32 v75, v75, v82
    v_mul_f32 v84, v75, v75
    v_add_f32 v85, v74, v74
    v_fma_f32 v76, v74, v74, -v84
    v_mul_f32 v77, v85, v75
    v_mul_f32 v84, v77, v77
    v_add_f32 v85, v76, v76
    v_fma_f32 v78, v76, v76, -v84
    v_mul_f32 v79, v85, v77
    v_mul_f32 v84, v79, v79
    v_add_f32 v85, v78, v78
    v_fma_f32 v80, v78, v78, -v84
    v_mul_f32 v81, v85, v79
    v_mul_f32 v82, v64, v44
    v_mul_f32 v83, v65, v44
    v_exp_f32 v82, v82
    v_fract_f32 v83, v83
    v_cos_f32 v68, v83
    v_sin_f32 v69, v83
    v_mul_f32 v68, v68, v82
    v_mul_f32 v69, v69, v82
    v_mul_f32 v84, v67, v69
    v_mul_f32 v85, v67, v68
    v_fma_f32 v68, v66, v68, -v84
    v_fma_f32 v69, -v66, v69, -v85
    v_mul_f32 v82, v64, v45
    v_mul_f32 v83, v65, v45
    v_exp_f32 v82, v82
    v_fract_f32 v83, v83
    v_cos_f32 v70, v83
    v_sin_f32 v71, v83
    v_mul_f32 v70, v70, v82
    v_mul_f32 v71, v71, v82
    v_mul_f32 v84, v67, v71
    v_mul_f32 v85, v67, v70
    v_fma_f32 v70, v66, v70, -v84
    v_fma_f32 v71, -v66, v71, -v85
    v_mul_f32 v82, v64, v46
    v_mul_f32 v83, v65, v46
    v_exp_f32 v82, v82
    v_fract_f32 v83, v83
    v_cos_f32 v72, v83
    v_sin_f32 v73, v83
    v_mul_f32 v72, v72, v82
    v_mul_f32 v73, v73, v82
    v_mul_f32 v84, v67, v73
    v_mul_f32 v85, v67, v72
    v_fma_f32 v72, v66, v72, -v84
    v_fma_f32 v73, -v66, v73, -v85
    v_mfma_f32_16x16x4_f32 v[48:51], v68, v74, v[48:51]
    v_mfma_f32_16x16x4_f32 v[52:55], v70, v76, v[52:55]
    v_mfma_f32_16x16x4_f32 v[56:59], v70, v78, v[56:59]
    v_mfma_f32_16x16x4_f32 v[60:63], v72, v80, v[60:63]
    v_mfma_f32_16x16x4_f32 v[48:51], v69, v75, v[48:51]
    v_mfma_f32_16x16x4_f32 v[52:55], v71, v77, v[52:55]
    v_mfma_f32_16x16x4_f32 v[56:59], v71, v79, v[56:59]
    v_mfma_f32_16x16x4_f32 v[60:63], v73, v81, v[60:63]
    v_mov_b32_dpp v64, v24 row_newbcast:2 row_mask:0xf bank_mask:0xf
    v_mov_b32_dpp v65, v25 row_newbcast:2 row_mask:0xf bank_mask:0xf
    v_mov_b32_dpp v66, v26 row_newbcast:2 row_mask:0xf bank_mask:0xf
    v_mov_b32_dpp v67, v27 row_newbcast:2 row_mask:0xf bank_mask:0xf
    v_mul_f32 v82, v64, v47
    v_mul_f32 v83, v65, v47
    v_exp_f32 v82, v82
    v_fract_f32 v83, v83
    v_cos_f32 v74, v83
    v_sin_f32 v75, v83
    v_mul_f32 v74, v74, v82
    v_mul_f32 v75, v75, v82
    v_mul_f32 v84, v75, v75
    v_add_f32 v85, v74, v74
    v_fma_f32 v76, v74, v74, -v84
    v_mul_f32 v77, v85, v75
    v_mul_f32 v84, v77, v77
    v_add_f32 v85, v76, v76
    v_fma_f32 v78, v76, v76, -v84
    v_mul_f32 v79, v85, v77
    v_mul_f32 v84, v79, v79
    v_add_f32 v85, v78, v78
    v_fma_f32 v80, v78, v78, -v84
    v_mul_f32 v81, v85, v79
    v_mul_f32 v82, v64, v44
    v_mul_f32 v83, v65, v44
    v_exp_f32 v82, v82
    v_fract_f32 v83, v83
    v_cos_f32 v68, v83
    v_sin_f32 v69, v83
    v_mul_f32 v68, v68, v82
    v_mul_f32 v69, v69, v82
    v_mul_f32 v84, v67, v69
    v_mul_f32 v85, v67, v68
    v_fma_f32 v68, v66, v68, -v84
    v_fma_f32 v69, -v66, v69, -v85
    v_mul_f32 v82, v64, v45
    v_mul_f32 v83, v65, v45
    v_exp_f32 v82, v82
    v_fract_f32 v83, v83
    v_cos_f32 v70, v83
    v_sin_f32 v71, v83
    v_mul_f32 v70, v70, v82
    v_mul_f32 v71, v71, v82
    v_mul_f32 v84, v67, v71
    v_mul_f32 v85, v67, v70
    v_fma_f32 v70, v66, v70, -v84
    v_fma_f32 v71, -v66, v71, -v85
    v_mul_f32 v82, v64, v46
    v_mul_f32 v83, v65, v46
    v_exp_f32 v82, v82
    v_fract_f32 v83, v83
    v_cos_f32 v72, v83
    v_sin_f32 v73, v83
    v_mul_f32 v72, v72, v82
    v_mul_f32 v73, v73, v82
    v_mul_f32 v84, v67, v73
    v_mul_f32 v85, v67, v72
    v_fma_f32 v72, v66, v72, -v84
    v_fma_f32 v73, -v66, v73, -v85
    v_mfma_f32_16x16x4_f32 v[48:51], v68, v74, v[48:51]
    v_mfma_f32_16x16x4_f32 v[52:55], v70, v76, v[52:55]
    v_mfma_f32_16x16x4_f32 v[56:59], v70, v78, v[56:59]
    v_mfma_f32_16x16x4_f32 v[60:63], v72, v80, v[60:63]
    v_mfma_f32_16x16x4_f32 v[48:51], v69, v75, v[48:51]
    v_mfma_f32_16x16x4_f32 v[52:55], v71, v77, v[52:55]
    v_mfma_f32_16x16x4_f32 v[56:59], v71, v79, v[56:59]
    v_mfma_f32_16x16x4_f32 v[60:63], v73, v81, v[60:63]
    v_mov_b32_dpp v64, v24 row_newbcast:3 row_mask:0xf bank_mask:0xf
    v_mov_b32_dpp v65, v25 row_newbcast:3 row_mask:0xf bank_mask:0xf
    v_mov_b32_dpp v66, v26 row_newbcast:3 row_mask:0xf bank_mask:0xf
    v_mov_b32_dpp v67, v27 row_newbcast:3 row_mask:0xf bank_mask:0xf
    v_mul_f32 v82, v64, v47
    v_mul_f32 v83, v65, v47
    v_exp_f32 v82, v82
    v_fract_f32 v83, v83
    v_cos_f32 v74, v83
    v_sin_f32 v75, v83
    v_mul_f32 v74, v74, v82
    v_mul_f32 v75, v75, v82
    v_mul_f32 v84, v75, v75
    v_add_f32 v85, v74, v74
    v_fma_f32 v76, v74, v74, -v84
    v_mul_f32 v77, v85, v75
    v_mul_f32 v84, v77, v77
    v_add_f32 v85, v76, v76
    v_fma_f32 v78, v76, v76, -v84
    v_mul_f32 v79, v85, v77
    v_mul_f32 v84, v79, v79
    v_add_f32 v85, v78, v78
    v_fma_f32 v80, v78, v78, -v84
    v_mul_f32 v81, v85, v79
    v_mul_f32 v82, v64, v44
    v_mul_f32 v83, v65, v44
    v_exp_f32 v82, v82
    v_fract_f32 v83, v83
    v_cos_f32 v68, v83
    v_sin_f32 v69, v83
    v_mul_f32 v68, v68, v82
    v_mul_f32 v69, v69, v82
    v_mul_f32 v84, v67, v69
    v_mul_f32 v85, v67, v68
    v_fma_f32 v68, v66, v68, -v84
    v_fma_f32 v69, -v66, v69, -v85
    v_mul_f32 v82, v64, v45
    v_mul_f32 v83, v65, v45
    v_exp_f32 v82, v82
    v_fract_f32 v83, v83
    v_cos_f32 v70, v83
    v_sin_f32 v71, v83
    v_mul_f32 v70, v70, v82
    v_mul_f32 v71, v71, v82
    v_mul_f32 v84, v67, v71
    v_mul_f32 v85, v67, v70
    v_fma_f32 v70, v66, v70, -v84
    v_fma_f32 v71, -v66, v71, -v85
    v_mul_f32 v82, v64, v46
    v_mul_f32 v83, v65, v46
    v_exp_f32 v82, v82
    v_fract_f32 v83, v83
    v_cos_f32 v72, v83
    v_sin_f32 v73, v83
    v_mul_f32 v72, v72, v82
    v_mul_f32 v73, v73, v82
    v_mul_f32 v84, v67, v73
    v_mul_f32 v85, v67, v72
    v_fma_f32 v72, v66, v72, -v84
    v_fma_f32 v73, -v66, v73, -v85
    v_mfma_f32_16x16x4_f32 v[48:51], v68, v74, v[48:51]
    v_mfma_f32_16x16x4_f32 v[52:55], v70, v76, v[52:55]
    v_mfma_f32_16x16x4_f32 v[56:59], v70, v78, v[56:59]
    v_mfma_f32_16x16x4_f32 v[60:63], v72, v80, v[60:63]
    v_mfma_f32_16x16x4_f32 v[48:51], v69, v75, v[48:51]
    v_mfma_f32_16x16x4_f32 v[52:55], v71, v77, v[52:55]
    v_mfma_f32_16x16x4_f32 v[56:59], v71, v79, v[56:59]
    v_mfma_f32_16x16x4_f32 v[60:63], v73, v81, v[60:63]
    v_mov_b32_dpp v64, v24 row_newbcast:4 row_mask:0xf bank_mask:0xf
    v_mov_b32_dpp v65, v25 row_newbcast:4 row_mask:0xf bank_mask:0xf
    v_mov_b32_dpp v66, v26 row_newbcast:4 row_mask:0xf bank_mask:0xf
    v_mov_b32_dpp v67, v27 row_newbcast:4 row_mask:0xf bank_mask:0xf
    v_mul_f32 v82, v64, v47
    v_mul_f32 v83, v65, v47
    v_exp_f32 v82, v82
    v_fract_f32 v83, v83
    v_cos_f32 v74, v83
    v_sin_f32 v75, v83
    v_mul_f32 v74, v74, v82
    v_mul_f32 v75, v75, v82
    v_mul_f32 v84, v75, v75
    v_add_f32 v85, v74, v74
    v_fma_f32 v76, v74, v74, -v84
    v_mul_f32 v77, v85, v75
    v_mul_f32 v84, v77, v77
    v_add_f32 v85, v76, v76
    v_fma_f32 v78, v76, v76, -v84
    v_mul_f32 v79, v85, v77
    v_mul_f32 v84, v79, v79
    v_add_f32 v85, v78, v78
    v_fma_f32 v80, v78, v78, -v84
    v_mul_f32 v81, v85, v79
    v_mul_f32 v82, v64, v44
    v_mul_f32 v83, v65, v44
    v_exp_f32 v82, v82
    v_fract_f32 v83, v83
    v_cos_f32 v68, v83
    v_sin_f32 v69, v83
    v_mul_f32 v68, v68, v82
    v_mul_f32 v69, v69, v82
    v_mul_f32 v84, v67, v69
    v_mul_f32 v85, v67, v68
    v_fma_f32 v68, v66, v68, -v84
    v_fma_f32 v69, -v66, v69, -v85
    v_mul_f32 v82, v64, v45
    v_mul_f32 v83, v65, v45
    v_exp_f32 v82, v82
    v_fract_f32 v83, v83
    v_cos_f32 v70, v83
    v_sin_f32 v71, v83
    v_mul_f32 v70, v70, v82
    v_mul_f32 v71, v71, v82
    v_mul_f32 v84, v67, v71
    v_mul_f32 v85, v67, v70
    v_fma_f32 v70, v66, v70, -v84
    v_fma_f32 v71, -v66, v71, -v85
    v_mul_f32 v82, v64, v46
    v_mul_f32 v83, v65, v46
    v_exp_f32 v82, v82
    v_fract_f32 v83, v83
    v_cos_f32 v72, v83
    v_sin_f32 v73, v83
    v_mul_f32 v72, v72, v82
    v_mul_f32 v73, v73, v82
    v_mul_f32 v84, v67, v73
    v_mul_f32 v85, v67, v72
    v_fma_f32 v72, v66, v72, -v84
    v_fma_f32 v73, -v66, v73, -v85
    v_mfma_f32_16x16x4_f32 v[48:51], v68, v74, v[48:51]
    v_mfma_f32_16x16x4_f32 v[52:55], v70, v76, v[52:55]
    v_mfma_f32_16x16x4_f32 v[56:59], v70, v78, v[56:59]
    v_mfma_f32_16x16x4_f32 v[60:63], v72, v80, v[60:63]
    v_mfma_f32_16x16x4_f32 v[48:51], v69, v75, v[48:51]
    v_mfma_f32_16x16x4_f32 v[52:55], v71, v77, v[52:55]
    v_mfma_f32_16x16x4_f32 v[56:59], v71, v79, v[56:59]
    v_mfma_f32_16x16x4_f32 v[60:63], v73, v81, v[60:63]
    v_mov_b32_dpp v64, v24 row_newbcast:5 row_mask:0xf bank_mask:0xf
    v_mov_b32_dpp v65, v25 row_newbcast:5 row_mask:0xf bank_mask:0xf
    v_mov_b32_dpp v66, v26 row_newbcast:5 row_mask:0xf bank_mask:0xf
    v_mov_b32_dpp v67, v27 row_newbcast:5 row_mask:0xf bank_mask:0xf
    v_mul_f32 v82, v64, v47
    v_mul_f32 v83, v65, v47
    v_exp_f32 v82, v82
    v_fract_f32 v83, v83
    v_cos_f32 v74, v83
    v_sin_f32 v75, v83
    v_mul_f32 v74, v74, v82
    v_mul_f32 v75, v75, v82
    v_mul_f32 v84, v75, v75
    v_add_f32 v85, v74, v74
    v_fma_f32 v76, v74, v74, -v84
    v_mul_f32 v77, v85, v75
    v_mul_f32 v84, v77, v77
    v_add_f32 v85, v76, v76
    v_fma_f32 v78, v76, v76, -v84
    v_mul_f32 v79, v85, v77
    v_mul_f32 v84, v79, v79
    v_add_f32 v85, v78, v78
    v_fma_f32 v80, v78, v78, -v84
    v_mul_f32 v81, v85, v79
    v_mul_f32 v82, v64, v44
    v_mul_f32 v83, v65, v44
    v_exp_f32 v82, v82
    v_fract_f32 v83, v83
    v_cos_f32 v68, v83
    v_sin_f32 v69, v83
    v_mul_f32 v68, v68, v82
    v_mul_f32 v69, v69, v82
    v_mul_f32 v84, v67, v69
    v_mul_f32 v85, v67, v68
    v_fma_f32 v68, v66, v68, -v84
    v_fma_f32 v69, -v66, v69, -v85
    v_mul_f32 v82, v64, v45
    v_mul_f32 v83, v65, v45
    v_exp_f32 v82, v82
    v_fract_f32 v83, v83
    v_cos_f32 v70, v83
    v_sin_f32 v71, v83
    v_mul_f32 v70, v70, v82
    v_mul_f32 v71, v71, v82
    v_mul_f32 v84, v67, v71
    v_mul_f32 v85, v67, v70
    v_fma_f32 v70, v66, v70, -v84
    v_fma_f32 v71, -v66, v71, -v85
    v_mul_f32 v82, v64, v46
    v_mul_f32 v83, v65, v46
    v_exp_f32 v82, v82
    v_fract_f32 v83, v83
    v_cos_f32 v72, v83
    v_sin_f32 v73, v83
    v_mul_f32 v72, v72, v82
    v_mul_f32 v73, v73, v82
    v_mul_f32 v84, v67, v73
    v_mul_f32 v85, v67, v72
    v_fma_f32 v72, v66, v72, -v84
    v_fma_f32 v73, -v66, v73, -v85
    v_mfma_f32_16x16x4_f32 v[48:51], v68, v74, v[48:51]
    v_mfma_f32_16x16x4_f32 v[52:55], v70, v76, v[52:55]
    v_mfma_f32_16x16x4_f32 v[56:59], v70, v78, v[56:59]
    v_mfma_f32_16x16x4_f32 v[60:63], v72, v80, v[60:63]
    v_mfma_f32_16x16x4_f32 v[48:51], v69, v75, v[48:51]
    v_mfma_f32_16x16x4_f32 v[52:55], v71, v77, v[52:55]
    v_mfma_f32_16x16x4_f32 v[56:59], v71, v79, v[56:59]
    v_mfma_f32_16x16x4_f32 v[60:63], v73, v81, v[60:63]
    v_mov_b32_dpp v64, v24 row_newbcast:6 row_mask:0xf bank_mask:0xf
    v_mov_b32_dpp v65, v25 row_newbcast:6 row_mask:0xf bank_mask:0xf
    v_mov_b32_dpp v66, v26 row_newbcast:6 row_mask:0xf bank_mask:0xf
    v_mov_b32_dpp v67, v27 row_newbcast:6 row_mask:0xf bank_mask:0xf
    v_mul_f32 v82, v64, v47
    v_mul_f32 v83, v65, v47
    v_exp_f32 v82, v82
    v_fract_f32 v83, v83
    v_cos_f32 v74, v83
    v_sin_f32 v75, v83
    v_mul_f32 v74, v74, v82
    v_mul_f32 v75, v75, v82
    v_mul_f32 v84, v75, v75
    v_add_f32 v85, v74, v74
    v_fma_f32 v76, v74, v74, -v84
    v_mul_f32 v77, v85, v75
    v_mul_f32 v84, v77, v77
    v_add_f32 v85, v76, v76
    v_fma_f32 v78, v76, v76, -v84
    v_mul_f32 v79, v85, v77
    v_mul_f32 v84, v79, v79
    v_add_f32 v85, v78, v78
    v_fma_f32 v80, v78, v78, -v84
    v_mul_f32 v81, v85, v79
    v_mul_f32 v82, v64, v44
    v_mul_f32 v83, v65, v44
    v_exp_f32 v82, v82
    v_fract_f32 v83, v83
    v_cos_f32 v68, v83
    v_sin_f32 v69, v83
    v_mul_f32 v68, v68, v82
    v_mul_f32 v69, v69, v82
    v_mul_f32 v84, v67, v69
    v_mul_f32 v85, v67, v68
    v_fma_f32 v68, v66, v68, -v84
    v_fma_f32 v69, -v66, v69, -v85
    v_mul_f32 v82, v64, v45
    v_mul_f32 v83, v65, v45
    v_exp_f32 v82, v82
    v_fract_f32 v83, v83
    v_cos_f32 v70, v83
    v_sin_f32 v71, v83
    v_mul_f32 v70, v70, v82
    v_mul_f32 v71, v71, v82
    v_mul_f32 v84, v67, v71
    v_mul_f32 v85, v67, v70
    v_fma_f32 v70, v66, v70, -v84
    v_fma_f32 v71, -v66, v71, -v85
    v_mul_f32 v82, v64, v46
    v_mul_f32 v83, v65, v46
    v_exp_f32 v82, v82
    v_fract_f32 v83, v83
    v_cos_f32 v72, v83
    v_sin_f32 v73, v83
    v_mul_f32 v72, v72, v82
    v_mul_f32 v73, v73, v82
    v_mul_f32 v84, v67, v73
    v_mul_f32 v85, v67, v72
    v_fma_f32 v72, v66, v72, -v84
    v_fma_f32 v73, -v66, v73, -v85
    v_mfma_f32_16x16x4_f32 v[48:51], v68, v74, v[48:51]
    v_mfma_f32_16x16x4_f32 v[52:55], v70, v76, v[52:55]
    v_mfma_f32_16x16x4_f32 v[56:59], v70, v78, v[56:59]
    v_mfma_f32_16x16x4_f32 v[60:63], v72, v80, v[60:63]
    v_mfma_f32_16x16x4_f32 v[48:51], v69, v75, v[48:51]
    v_mfma_f32_16x16x4_f32 v[52:55], v71, v77, v[52:55]
    v_mfma_f32_16x16x4_f32 v[56:59], v71, v79, v[56:59]
    v_mfma_f32_16x16x4_f32 v[60:63], v73, v81, v[60:63]
    v_mov_b32_dpp v64, v24 row_newbcast:7 row_mask:0xf bank_mask:0xf
    v_mov_b32_dpp v65, v25 row_newbcast:7 row_mask:0xf bank_mask:0xf
    v_mov_b32_dpp v66, v26 row_newbcast:7 row_mask:0xf bank_mask:0xf
    v_mov_b32_dpp v67, v27 row_newbcast:7 row_mask:0xf bank_mask:0xf
    v_mul_f32 v82, v64, v47
    v_mul_f32 v83, v65, v47
    v_exp_f32 v82, v82
    v_fract_f32 v83, v83
    v_cos_f32 v74, v83
    v_sin_f32 v75, v83
    v_mul_f32 v74, v74, v82
    v_mul_f32 v75, v75, v82
    v_mul_f32 v84, v75, v75
    v_add_f32 v85, v74, v74
    v_fma_f32 v76, v74, v74, -v84
    v_mul_f32 v77, v85, v75
    v_mul_f32 v84, v77, v77
    v_add_f32 v85, v76, v76
    v_fma_f32 v78, v76, v76, -v84
    v_mul_f32 v79, v85, v77
    v_mul_f32 v84, v79, v79
    v_add_f32 v85, v78, v78
    v_fma_f32 v80, v78, v78, -v84
    v_mul_f32 v81, v85, v79
    v_mul_f32 v82, v64, v44
    v_mul_f32 v83, v65, v44
    v_exp_f32 v82, v82
    v_fract_f32 v83, v83
    v_cos_f32 v68, v83
    v_sin_f32 v69, v83
    v_mul_f32 v68, v68, v82
    v_mul_f32 v69, v69, v82
    v_mul_f32 v84, v67, v69
    v_mul_f32 v85, v67, v68
    v_fma_f32 v68, v66, v68, -v84
    v_fma_f32 v69, -v66, v69, -v85
    v_mul_f32 v82, v64, v45
    v_mul_f32 v83, v65, v45
    v_exp_f32 v82, v82
    v_fract_f32 v83, v83
    v_cos_f32 v70, v83
    v_sin_f32 v71, v83
    v_mul_f32 v70, v70, v82
    v_mul_f32 v71, v71, v82
    v_mul_f32 v84, v67, v71
    v_mul_f32 v85, v67, v70
    v_fma_f32 v70, v66, v70, -v84
    v_fma_f32 v71, -v66, v71, -v85
    v_mul_f32 v82, v64, v46
    v_mul_f32 v83, v65, v46
    v_exp_f32 v82, v82
    v_fract_f32 v83, v83
    v_cos_f32 v72, v83
    v_sin_f32 v73, v83
    v_mul_f32 v72, v72, v82
    v_mul_f32 v73, v73, v82
    v_mul_f32 v84, v67, v73
    v_mul_f32 v85, v67, v72
    v_fma_f32 v72, v66, v72, -v84
    v_fma_f32 v73, -v66, v73, -v85
    v_mfma_f32_16x16x4_f32 v[48:51], v68, v74, v[48:51]
    v_mfma_f32_16x16x4_f32 v[52:55], v70, v76, v[52:55]
    v_mfma_f32_16x16x4_f32 v[56:59], v70, v78, v[56:59]
    v_mfma_f32_16x16x4_f32 v[60:63], v72, v80, v[60:63]
    v_mfma_f32_16x16x4_f32 v[48:51], v69, v75, v[48:51]
    v_mfma_f32_16x16x4_f32 v[52:55], v71, v77, v[52:55]
    v_mfma_f32_16x16x4_f32 v[56:59], v71, v79, v[56:59]
    v_mfma_f32_16x16x4_f32 v[60:63], v73, v81, v[60:63]
    v_mov_b32_dpp v64, v24 row_newbcast:8 row_mask:0xf bank_mask:0xf
    v_mov_b32_dpp v65, v25 row_newbcast:8 row_mask:0xf bank_mask:0xf
    v_mov_b32_dpp v66, v26 row_newbcast:8 row_mask:0xf bank_mask:0xf
    v_mov_b32_dpp v67, v27 row_newbcast:8 row_mask:0xf bank_mask:0xf
    v_mul_f32 v82, v64, v47
    v_mul_f32 v83, v65, v47
    v_exp_f32 v82, v82
    v_fract_f32 v83, v83
    v_cos_f32 v74, v83
    v_sin_f32 v75, v83
    v_mul_f32 v74, v74, v82
    v_mul_f32 v75, v75, v82
    v_mul_f32 v84, v75, v75
    v_add_f32 v85, v74, v74
    v_fma_f32 v76, v74, v74, -v84
    v_mul_f32 v77, v85, v75
    v_mul_f32 v84, v77, v77
    v_add_f32 v85, v76, v76
    v_fma_f32 v78, v76, v76, -v84
    v_mul_f32 v79, v85, v77
    v_mul_f32 v84, v79, v79
    v_add_f32 v85, v78, v78
    v_fma_f32 v80, v78, v78, -v84
    v_mul_f32 v81, v85, v79
    v_mul_f32 v82, v64, v44
    v_mul_f32 v83, v65, v44
    v_exp_f32 v82, v82
    v_fract_f32 v83, v83
    v_cos_f32 v68, v83
    v_sin_f32 v69, v83
    v_mul_f32 v68, v68, v82
    v_mul_f32 v69, v69, v82
    v_mul_f32 v84, v67, v69
    v_mul_f32 v85, v67, v68
    v_fma_f32 v68, v66, v68, -v84
    v_fma_f32 v69, -v66, v69, -v85
    v_mul_f32 v82, v64, v45
    v_mul_f32 v83, v65, v45
    v_exp_f32 v82, v82
    v_fract_f32 v83, v83
    v_cos_f32 v70, v83
    v_sin_f32 v71, v83
    v_mul_f32 v70, v70, v82
    v_mul_f32 v71, v71, v82
    v_mul_f32 v84, v67, v71
    v_mul_f32 v85, v67, v70
    v_fma_f32 v70, v66, v70, -v84
    v_fma_f32 v71, -v66, v71, -v85
    v_mul_f32 v82, v64, v46
    v_mul_f32 v83, v65, v46
    v_exp_f32 v82, v82
    v_fract_f32 v83, v83
    v_cos_f32 v72, v83
    v_sin_f32 v73, v83
    v_mul_f32 v72, v72, v82
    v_mul_f32 v73, v73, v82
    v_mul_f32 v84, v67, v73
    v_mul_f32 v85, v67, v72
    v_fma_f32 v72, v66, v72, -v84
    v_fma_f32 v73, -v66, v73, -v85
    v_mfma_f32_16x16x4_f32 v[48:51], v68, v74, v[48:51]
    v_mfma_f32_16x16x4_f32 v[52:55], v70, v76, v[52:55]
    v_mfma_f32_16x16x4_f32 v[56:59], v70, v78, v[56:59]
    v_mfma_f32_16x16x4_f32 v[60:63], v72, v80, v[60:63]
    v_mfma_f32_16x16x4_f32 v[48:51], v69, v75, v[48:51]
    v_mfma_f32_16x16x4_f32 v[52:55], v71, v77, v[52:55]
    v_mfma_f32_16x16x4_f32 v[56:59], v71, v79, v[56:59]
    v_mfma_f32_16x16x4_f32 v[60:63], v73, v81, v[60:63]
    v_mov_b32_dpp v64, v24 row_newbcast:9 row_mask:0xf bank_mask:0xf
    v_mov_b32_dpp v65, v25 row_newbcast:9 row_mask:0xf bank_mask:0xf
    v_mov_b32_dpp v66, v26 row_newbcast:9 row_mask:0xf bank_mask:0xf
    v_mov_b32_dpp v67, v27 row_newbcast:9 row_mask:0xf bank_mask:0xf
    v_mul_f32 v82, v64, v47
    v_mul_f32 v83, v65, v47
    v_exp_f32 v82, v82
    v_fract_f32 v83, v83
    v_cos_f32 v74, v83
    v_sin_f32 v75, v83
    v_mul_f32 v74, v74, v82
    v_mul_f32 v75, v75, v82
    v_mul_f32 v84, v75, v75
    v_add_f32 v85, v74, v74
    v_fma_f32 v76, v74, v74, -v84
    v_mul_f32 v77, v85, v75
    v_mul_f32 v84, v77, v77
    v_add_f32 v85, v76, v76
    v_fma_f32 v78, v76, v76, -v84
    v_mul_f32 v79, v85, v77
    v_mul_f32 v84, v79, v79
    v_add_f32 v85, v78, v78
    v_fma_f32 v80, v78, v78, -v84
    v_mul_f32 v81, v85, v79
    v_mul_f32 v82, v64, v44
    v_mul_f32 v83, v65, v44
    v_exp_f32 v82, v82
    v_fract_f32 v83, v83
    v_cos_f32 v68, v83
    v_sin_f32 v69, v83
    v_mul_f32 v68, v68, v82
    v_mul_f32 v69, v69, v82
    v_mul_f32 v84, v67, v69
    v_mul_f32 v85, v67, v68
    v_fma_f32 v68, v66, v68, -v84
    v_fma_f32 v69, -v66, v69, -v85
    v_mul_f32 v82, v64, v45
    v_mul_f32 v83, v65, v45
    v_exp_f32 v82, v82
    v_fract_f32 v83, v83
    v_cos_f32 v70, v83
    v_sin_f32 v71, v83
    v_mul_f32 v70, v70, v82
    v_mul_f32 v71, v71, v82
    v_mul_f32 v84, v67, v71
    v_mul_f32 v85, v67, v70
    v_fma_f32 v70, v66, v70, -v84
    v_fma_f32 v71, -v66, v71, -v85
    v_mul_f32 v82, v64, v46
    v_mul_f32 v83, v65, v46
    v_exp_f32 v82, v82
    v_fract_f32 v83, v83
    v_cos_f32 v72, v83
    v_sin_f32 v73, v83
    v_mul_f32 v72, v72, v82
    v_mul_f32 v73, v73, v82
    v_mul_f32 v84, v67, v73
    v_mul_f32 v85, v67, v72
    v_fma_f32 v72, v66, v72, -v84
    v_fma_f32 v73, -v66, v73, -v85
    v_mfma_f32_16x16x4_f32 v[48:51], v68, v74, v[48:51]
    v_mfma_f32_16x16x4_f32 v[52:55], v70, v76, v[52:55]
    v_mfma_f32_16x16x4_f32 v[56:59], v70, v78, v[56:59]
    v_mfma_f32_16x16x4_f32 v[60:63], v72, v80, v[60:63]
    v_mfma_f32_16x16x4_f32 v[48:51], v69, v75, v[48:51]
    v_mfma_f32_16x16x4_f32 v[52:55], v71, v77, v[52:55]
    v_mfma_f32_16x16x4_f32 v[56:59], v71, v79, v[56:59]
    v_mfma_f32_16x16x4_f32 v[60:63], v73, v81, v[60:63]
    v_mov_b32_dpp v64, v24 row_newbcast:10 row_mask:0xf bank_mask:0xf
    v_mov_b32_dpp v65, v25 row_newbcast:10 row_mask:0xf bank_mask:0xf
    v_mov_b32_dpp v66, v26 row_newbcast:10 row_mask:0xf bank_mask:0xf
    v_mov_b32_dpp v67, v27 row_newbcast:10 row_mask:0xf bank_mask:0xf
    v_mul_f32 v82, v64, v47
    v_mul_f32 v83, v65, v47
    v_exp_f32 v82, v82
    v_fract_f32 v83, v83
    v_cos_f32 v74, v83
    v_sin_f32 v75, v83
    v_mul_f32 v74, v74, v82
    v_mul_f32 v75, v75, v82
    v_mul_f32 v84, v75, v75
    v_add_f32 v85, v74, v74
    v_fma_f32 v76, v74, v74, -v84
    v_mul_f32 v77, v85, v75
    v_mul_f32 v84, v77, v77
    v_add_f32 v85, v76, v76
    v_fma_f32 v78, v76, v76, -v84
    v_mul_f32 v79, v85, v77
    v_mul_f32 v84, v79, v79
    v_add_f32 v85, v78, v78
    v_fma_f32 v80, v78, v78, -v84
    v_mul_f32 v81, v85, v79
    v_mul_f32 v82, v64, v44
    v_mul_f32 v83, v65, v44
    v_exp_f32 v82, v82
    v_fract_f32 v83, v83
    v_cos_f32 v68, v83
    v_sin_f32 v69, v83
    v_mul_f32 v68, v68, v82
    v_mul_f32 v69, v69, v82
    v_mul_f32 v84, v67, v69
    v_mul_f32 v85, v67, v68
    v_fma_f32 v68, v66, v68, -v84
    v_fma_f32 v69, -v66, v69, -v85
    v_mul_f32 v82, v64, v45
    v_mul_f32 v83, v65, v45
    v_exp_f32 v82, v82
    v_fract_f32 v83, v83
    v_cos_f32 v70, v83
    v_sin_f32 v71, v83
    v_mul_f32 v70, v70, v82
    v_mul_f32 v71, v71, v82
    v_mul_f32 v84, v67, v71
    v_mul_f32 v85, v67, v70
    v_fma_f32 v70, v66, v70, -v84
    v_fma_f32 v71, -v66, v71, -v85
    v_mul_f32 v82, v64, v46
    v_mul_f32 v83, v65, v46
    v_exp_f32 v82, v82
    v_fract_f32 v83, v83
    v_cos_f32 v72, v83
    v_sin_f32 v73, v83
    v_mul_f32 v72, v72, v82
    v_mul_f32 v73, v73, v82
    v_mul_f32 v84, v67, v73
    v_mul_f32 v85, v67, v72
    v_fma_f32 v72, v66, v72, -v84
    v_fma_f32 v73, -v66, v73, -v85
    v_mfma_f32_16x16x4_f32 v[48:51], v68, v74, v[48:51]
    v_mfma_f32_16x16x4_f32 v[52:55], v70, v76, v[52:55]
    v_mfma_f32_16x16x4_f32 v[56:59], v70, v78, v[56:59]
    v_mfma_f32_16x16x4_f32 v[60:63], v72, v80, v[60:63]
    v_mfma_f32_16x16x4_f32 v[48:51], v69, v75, v[48:51]
    v_mfma_f32_16x16x4_f32 v[52:55], v71, v77, v[52:55]
    v_mfma_f32_16x16x4_f32 v[56:59], v71, v79, v[56:59]
    v_mfma_f32_16x16x4_f32 v[60:63], v73, v81, v[60:63]
    v_mov_b32_dpp v64, v24 row_newbcast:11 row_mask:0xf bank_mask:0xf
    v_mov_b32_dpp v65, v25 row_newbcast:11 row_mask:0xf bank_mask:0xf
    v_mov_b32_dpp v66, v26 row_newbcast:11 row_mask:0xf bank_mask:0xf
    v_mov_b32_dpp v67, v27 row_newbcast:11 row_mask:0xf bank_mask:0xf
    v_mul_f32 v82, v64, v47
    v_mul_f32 v83, v65, v47
    v_exp_f32 v82, v82
    v_fract_f32 v83, v83
    v_cos_f32 v74, v83
    v_sin_f32 v75, v83
    v_mul_f32 v74, v74, v82
    v_mul_f32 v75, v75, v82
    v_mul_f32 v84, v75, v75
    v_add_f32 v85, v74, v74
    v_fma_f32 v76, v74, v74, -v84
    v_mul_f32 v77, v85, v75
    v_mul_f32 v84, v77, v77
    v_add_f32 v85, v76, v76
    v_fma_f32 v78, v76, v76, -v84
    v_mul_f32 v79, v85, v77
    v_mul_f32 v84, v79, v79
    v_add_f32 v85, v78, v78
    v_fma_f32 v80, v78, v78, -v84
    v_mul_f32 v81, v85, v79
    v_mul_f32 v82, v64, v44
    v_mul_f32 v83, v65, v44
    v_exp_f32 v82, v82
    v_fract_f32 v83, v83
    v_cos_f32 v68, v83
    v_sin_f32 v69, v83
    v_mul_f32 v68, v68, v82
    v_mul_f32 v69, v69, v82
    v_mul_f32 v84, v67, v69
    v_mul_f32 v85, v67, v68
    v_fma_f32 v68, v66, v68, -v84
    v_fma_f32 v69, -v66, v69, -v85
    v_mul_f32 v82, v64, v45
    v_mul_f32 v83, v65, v45
    v_exp_f32 v82, v82
    v_fract_f32 v83, v83
    v_cos_f32 v70, v83
    v_sin_f32 v71, v83
    v_mul_f32 v70, v70, v82
    v_mul_f32 v71, v71, v82
    v_mul_f32 v84, v67, v71
    v_mul_f32 v85, v67, v70
    v_fma_f32 v70, v66, v70, -v84
    v_fma_f32 v71, -v66, v71, -v85
    v_mul_f32 v82, v64, v46
    v_mul_f32 v83, v65, v46
    v_exp_f32 v82, v82
    v_fract_f32 v83, v83
    v_cos_f32 v72, v83
    v_sin_f32 v73, v83
    v_mul_f32 v72, v72, v82
    v_mul_f32 v73, v73, v82
    v_mul_f32 v84, v67, v73
    v_mul_f32 v85, v67, v72
    v_fma_f32 v72, v66, v72, -v84
    v_fma_f32 v73, -v66, v73, -v85
    v_mfma_f32_16x16x4_f32 v[48:51], v68, v74, v[48:51]
    v_mfma_f32_16x16x4_f32 v[52:55], v70, v76, v[52:55]
    v_mfma_f32_16x16x4_f32 v[56:59], v70, v78, v[56:59]
    v_mfma_f32_16x16x4_f32 v[60:63], v72, v80, v[60:63]
    v_mfma_f32_16x16x4_f32 v[48:51], v69, v75, v[48:51]
    v_mfma_f32_16x16x4_f32 v[52:55], v71, v77, v[52:55]
    v_mfma_f32_16x16x4_f32 v[56:59], v71, v79, v[56:59]
    v_mfma_f32_16x16x4_f32 v[60:63], v73, v81, v[60:63]
    v_mov_b32_dpp v64, v24 row_newbcast:12 row_mask:0xf bank_mask:0xf
    v_mov_b32_dpp v65, v25 row_newbcast:12 row_mask:0xf bank_mask:0xf
    v_mov_b32_dpp v66, v26 row_newbcast:12 row_mask:0xf bank_mask:0xf
    v_mov_b32_dpp v67, v27 row_newbcast:12 row_mask:0xf bank_mask:0xf
    v_mul_f32 v82, v64, v47
    v_mul_f32 v83, v65, v47
    v_exp_f32 v82, v82
    v_fract_f32 v83, v83
    v_cos_f32 v74, v83
    v_sin_f32 v75, v83
    v_mul_f32 v74, v74, v82
    v_mul_f32 v75, v75, v82
    v_mul_f32 v84, v75, v75
    v_add_f32 v85, v74, v74
    v_fma_f32 v76, v74, v74, -v84
    v_mul_f32 v77, v85, v75
    v_mul_f32 v84, v77, v77
    v_add_f32 v85, v76, v76
    v_fma_f32 v78, v76, v76, -v84
    v_mul_f32 v79, v85, v77
    v_mul_f32 v84, v79, v79
    v_add_f32 v85, v78, v78
    v_fma_f32 v80, v78, v78, -v84
    v_mul_f32 v81, v85, v79
    v_mul_f32 v82, v64, v44
    v_mul_f32 v83, v65, v44
    v_exp_f32 v82, v82
    v_fract_f32 v83, v83
    v_cos_f32 v68, v83
    v_sin_f32 v69, v83
    v_mul_f32 v68, v68, v82
    v_mul_f32 v69, v69, v82
    v_mul_f32 v84, v67, v69
    v_mul_f32 v85, v67, v68
    v_fma_f32 v68, v66, v68, -v84
    v_fma_f32 v69, -v66, v69, -v85
    v_mul_f32 v82, v64, v45
    v_mul_f32 v83, v65, v45
    v_exp_f32 v82, v82
    v_fract_f32 v83, v83
    v_cos_f32 v70, v83
    v_sin_f32 v71, v83
    v_mul_f32 v70, v70, v82
    v_mul_f32 v71, v71, v82
    v_mul_f32 v84, v67, v71
    v_mul_f32 v85, v67, v70
    v_fma_f32 v70, v66, v70, -v84
    v_fma_f32 v71, -v66, v71, -v85
    v_mul_f32 v82, v64, v46
    v_mul_f32 v83, v65, v46
    v_exp_f32 v82, v82
    v_fract_f32 v83, v83
    v_cos_f32 v72, v83
    v_sin_f32 v73, v83
    v_mul_f32 v72, v72, v82
    v_mul_f32 v73, v73, v82
    v_mul_f32 v84, v67, v73
    v_mul_f32 v85, v67, v72
    v_fma_f32 v72, v66, v72, -v84
    v_fma_f32 v73, -v66, v73, -v85
    v_mfma_f32_16x16x4_f32 v[48:51], v68, v74, v[48:51]
    v_mfma_f32_16x16x4_f32 v[52:55], v70, v76, v[52:55]
    v_mfma_f32_16x16x4_f32 v[56:59], v70, v78, v[56:59]
    v_mfma_f32_16x16x4_f32 v[60:63], v72, v80, v[60:63]
    v_mfma_f32_16x16x4_f32 v[48:51], v69, v75, v[48:51]
    v_mfma_f32_16x16x4_f32 v[52:55], v71, v77, v[52:55]
    v_mfma_f32_16x16x4_f32 v[56:59], v71, v79, v[56:59]
    v_mfma_f32_16x16x4_f32 v[60:63], v73, v81, v[60:63]
    v_mov_b32_dpp v64, v24 row_newbcast:13 row_mask:0xf bank_mask:0xf
    v_mov_b32_dpp v65, v25 row_newbcast:13 row_mask:0xf bank_mask:0xf
    v_mov_b32_dpp v66, v26 row_newbcast:13 row_mask:0xf bank_mask:0xf
    v_mov_b32_dpp v67, v27 row_newbcast:13 row_mask:0xf bank_mask:0xf
    v_mul_f32 v82, v64, v47
    v_mul_f32 v83, v65, v47
    v_exp_f32 v82, v82
    v_fract_f32 v83, v83
    v_cos_f32 v74, v83
    v_sin_f32 v75, v83
    v_mul_f32 v74, v74, v82
    v_mul_f32 v75, v75, v82
    v_mul_f32 v84, v75, v75
    v_add_f32 v85, v74, v74
    v_fma_f32 v76, v74, v74, -v84
    v_mul_f32 v77, v85, v75
    v_mul_f32 v84, v77, v77
    v_add_f32 v85, v76, v76
    v_fma_f32 v78, v76, v76, -v84
    v_mul_f32 v79, v85, v77
    v_mul_f32 v84, v79, v79
    v_add_f32 v85, v78, v78
    v_fma_f32 v80, v78, v78, -v84
    v_mul_f32 v81, v85, v79
    v_mul_f32 v82, v64, v44
    v_mul_f32 v83, v65, v44
    v_exp_f32 v82, v82
    v_fract_f32 v83, v83
    v_cos_f32 v68, v83
    v_sin_f32 v69, v83
    v_mul_f32 v68, v68, v82
    v_mul_f32 v69, v69, v82
    v_mul_f32 v84, v67, v69
    v_mul_f32 v85, v67, v68
    v_fma_f32 v68, v66, v68, -v84
    v_fma_f32 v69, -v66, v69, -v85
    v_mul_f32 v82, v64, v45
    v_mul_f32 v83, v65, v45
    v_exp_f32 v82, v82
    v_fract_f32 v83, v83
    v_cos_f32 v70, v83
    v_sin_f32 v71, v83
    v_mul_f32 v70, v70, v82
    v_mul_f32 v71, v71, v82
    v_mul_f32 v84, v67, v71
    v_mul_f32 v85, v67, v70
    v_fma_f32 v70, v66, v70, -v84
    v_fma_f32 v71, -v66, v71, -v85
    v_mul_f32 v82, v64, v46
    v_mul_f32 v83, v65, v46
    v_exp_f32 v82, v82
    v_fract_f32 v83, v83
    v_cos_f32 v72, v83
    v_sin_f32 v73, v83
    v_mul_f32 v72, v72, v82
    v_mul_f32 v73, v73, v82
    v_mul_f32 v84, v67, v73
    v_mul_f32 v85, v67, v72
    v_fma_f32 v72, v66, v72, -v84
    v_fma_f32 v73, -v66, v73, -v85
    v_mfma_f32_16x16x4_f32 v[48:51], v68, v74, v[48:51]
    v_mfma_f32_16x16x4_f32 v[52:55], v70, v76, v[52:55]
    v_mfma_f32_16x16x4_f32 v[56:59], v70, v78, v[56:59]
    v_mfma_f32_16x16x4_f32 v[60:63], v72, v80, v[60:63]
    v_mfma_f32_16x16x4_f32 v[48:51], v69, v75, v[48:51]
    v_mfma_f32_16x16x4_f32 v[52:55], v71, v77, v[52:55]
    v_mfma_f32_16x16x4_f32 v[56:59], v71, v79, v[56:59]
    v_mfma_f32_16x16x4_f32 v[60:63], v73, v81, v[60:63]
    v_mov_b32_dpp v64, v24 row_newbcast:14 row_mask:0xf bank_mask:0xf
    v_mov_b32_dpp v65, v25 row_newbcast:14 row_mask:0xf bank_mask:0xf
    v_mov_b32_dpp v66, v26 row_newbcast:14 row_mask:0xf bank_mask:0xf
    v_mov_b32_dpp v67, v27 row_newbcast:14 row_mask:0xf bank_mask:0xf
    v_mul_f32 v82, v64, v47
    v_mul_f32 v83, v65, v47
    v_exp_f32 v82, v82
    v_fract_f32 v83, v83
    v_cos_f32 v74, v83
    v_sin_f32 v75, v83
    v_mul_f32 v74, v74, v82
    v_mul_f32 v75, v75, v82
    v_mul_f32 v84, v75, v75
    v_add_f32 v85, v74, v74
    v_fma_f32 v76, v74, v74, -v84
    v_mul_f32 v77, v85, v75
    v_mul_f32 v84, v77, v77
    v_add_f32 v85, v76, v76
    v_fma_f32 v78, v76, v76, -v84
    v_mul_f32 v79, v85, v77
    v_mul_f32 v84, v79, v79
    v_add_f32 v85, v78, v78
    v_fma_f32 v80, v78, v78, -v84
    v_mul_f32 v81, v85, v79
    v_mul_f32 v82, v64, v44
    v_mul_f32 v83, v65, v44
    v_exp_f32 v82, v82
    v_fract_f32 v83, v83
    v_cos_f32 v68, v83
    v_sin_f32 v69, v83
    v_mul_f32 v68, v68, v82
    v_mul_f32 v69, v69, v82
    v_mul_f32 v84, v67, v69
    v_mul_f32 v85, v67, v68
    v_fma_f32 v68, v66, v68, -v84
    v_fma_f32 v69, -v66, v69, -v85
    v_mul_f32 v82, v64, v45
    v_mul_f32 v83, v65, v45
    v_exp_f32 v82, v82
    v_fract_f32 v83, v83
    v_cos_f32 v70, v83
    v_sin_f32 v71, v83
    v_mul_f32 v70, v70, v82
    v_mul_f32 v71, v71, v82
    v_mul_f32 v84, v67, v71
    v_mul_f32 v85, v67, v70
    v_fma_f32 v70, v66, v70, -v84
    v_fma_f32 v71, -v66, v71, -v85
    v_mul_f32 v82, v64, v46
    v_mul_f32 v83, v65, v46
    v_exp_f32 v82, v82
    v_fract_f32 v83, v83
    v_cos_f32 v72, v83
    v_sin_f32 v73, v83
    v_mul_f32 v72, v72, v82
    v_mul_f32 v73, v73, v82
    v_mul_f32 v84, v67, v73
    v_mul_f32 v85, v67, v72
    v_fma_f32 v72, v66, v72, -v84
    v_fma_f32 v73, -v66, v73, -v85
    v_mfma_f32_16x16x4_f32 v[48:51], v68, v74, v[48:51]
    v_mfma_f32_16x16x4_f32 v[52:55], v70, v76, v[52:55]
    v_mfma_f32_16x16x4_f32 v[56:59], v70, v78, v[56:59]
    v_mfma_f32_16x16x4_f32 v[60:63], v72, v80, v[60:63]
    v_mfma_f32_16x16x4_f32 v[48:51], v69, v75, v[48:51]
    v_mfma_f32_16x16x4_f32 v[52:55], v71, v77, v[52:55]
    v_mfma_f32_16x16x4_f32 v[56:59], v71, v79, v[56:59]
    v_mfma_f32_16x16x4_f32 v[60:63], v73, v81, v[60:63]
    v_mov_b32_dpp v64, v24 row_newbcast:15 row_mask:0xf bank_mask:0xf
    v_mov_b32_dpp v65, v25 row_newbcast:15 row_mask:0xf bank_mask:0xf
    v_mov_b32_dpp v66, v26 row_newbcast:15 row_mask:0xf bank_mask:0xf
    v_mov_b32_dpp v67, v27 row_newbcast:15 row_mask:0xf bank_mask:0xf
    v_mul_f32 v82, v64, v47
    v_mul_f32 v83, v65, v47
    v_exp_f32 v82, v82
    v_fract_f32 v83, v83
    v_cos_f32 v74, v83
    v_sin_f32 v75, v83
    v_mul_f32 v74, v74, v82
    v_mul_f32 v75, v75, v82
    v_mul_f32 v84, v75, v75
    v_add_f32 v85, v74, v74
    v_fma_f32 v76, v74, v74, -v84
    v_mul_f32 v77, v85, v75
    v_mul_f32 v84, v77, v77
    v_add_f32 v85, v76, v76
    v_fma_f32 v78, v76, v76, -v84
    v_mul_f32 v79, v85, v77
    v_mul_f32 v84, v79, v79
    v_add_f32 v85, v78, v78
    v_fma_f32 v80, v78, v78, -v84
    v_mul_f32 v81, v85, v79
    v_mul_f32 v82, v64, v44
    v_mul_f32 v83, v65, v44
    v_exp_f32 v82, v82
    v_fract_f32 v83, v83
    v_cos_f32 v68, v83
    v_sin_f32 v69, v83
    v_mul_f32 v68, v68, v82
    v_mul_f32 v69, v69, v82
    v_mul_f32 v84, v67, v69
    v_mul_f32 v85, v67, v68
    v_fma_f32 v68, v66, v68, -v84
    v_fma_f32 v69, -v66, v69, -v85
    v_mul_f32 v82, v64, v45
    v_mul_f32 v83, v65, v45
    v_exp_f32 v82, v82
    v_fract_f32 v83, v83
    v_cos_f32 v70, v83
    v_sin_f32 v71, v83
    v_mul_f32 v70, v70, v82
    v_mul_f32 v71, v71, v82
    v_mul_f32 v84, v67, v71
    v_mul_f32 v85, v67, v70
    v_fma_f32 v70, v66, v70, -v84
    v_fma_f32 v71, -v66, v71, -v85
    v_mul_f32 v82, v64, v46
    v_mul_f32 v83, v65, v46
    v_exp_f32 v82, v82
    v_fract_f32 v83, v83
    v_cos_f32 v72, v83
    v_sin_f32 v73, v83
    v_mul_f32 v72, v72, v82
    v_mul_f32 v73, v73, v82
    v_mul_f32 v84, v67, v73
    v_mul_f32 v85, v67, v72
    v_fma_f32 v72, v66, v72, -v84
    v_fma_f32 v73, -v66, v73, -v85
    v_mfma_f32_16x16x4_f32 v[48:51], v68, v74, v[48:51]
    v_mfma_f32_16x16x4_f32 v[52:55], v70, v76, v[52:55]
    v_mfma_f32_16x16x4_f32 v[56:59], v70, v78, v[56:59]
    v_mfma_f32_16x16x4_f32 v[60:63], v72, v80, v[60:63]
    v_mfma_f32_16x16x4_f32 v[48:51], v69, v75, v[48:51]
    v_mfma_f32_16x16x4_f32 v[52:55], v71, v77, v[52:55]
    v_mfma_f32_16x16x4_f32 v[56:59], v71, v79, v[56:59]
    v_mfma_f32_16x16x4_f32 v[60:63], v73, v81, v[60:63]
    v_mov_b32_dpp v64, v28 row_newbcast:0 row_mask:0xf bank_mask:0xf
    v_mov_b32_dpp v65, v29 row_newbcast:0 row_mask:0xf bank_mask:0xf
    v_mov_b32_dpp v66, v30 row_newbcast:0 row_mask:0xf bank_mask:0xf
    v_mov_b32_dpp v67, v31 row_newbcast:0 row_mask:0xf bank_mask:0xf
    v_mul_f32 v82, v64, v47
    v_mul_f32 v83, v65, v47
    v_exp_f32 v82, v82
    v_fract_f32 v83, v83
    v_cos_f32 v74, v83
    v_sin_f32 v75, v83
    v_mul_f32 v74, v74, v82
    v_mul_f32 v75, v75, v82
    v_mul_f32 v84, v75, v75
    v_add_f32 v85, v74, v74
    v_fma_f32 v76, v74, v74, -v84
    v_mul_f32 v77, v85, v75
    v_mul_f32 v84, v77, v77
    v_add_f32 v85, v76, v76
    v_fma_f32 v78, v76, v76, -v84
    v_mul_f32 v79, v85, v77
    v_mul_f32 v84, v79, v79
    v_add_f32 v85, v78, v78
    v_fma_f32 v80, v78, v78, -v84
    v_mul_f32 v81, v85, v79
    v_mul_f32 v82, v64, v44
    v_mul_f32 v83, v65, v44
    v_exp_f32 v82, v82
    v_fract_f32 v83, v83
    v_cos_f32 v68, v83
    v_sin_f32 v69, v83
    v_mul_f32 v68, v68, v82
    v_mul_f32 v69, v69, v82
    v_mul_f32 v84, v67, v69
    v_mul_f32 v85, v67, v68
    v_fma_f32 v68, v66, v68, -v84
    v_fma_f32 v69, -v66, v69, -v85
    v_mul_f32 v82, v64, v45
    v_mul_f32 v83, v65, v45
    v_exp_f32 v82, v82
    v_fract_f32 v83, v83
    v_cos_f32 v70, v83
    v_sin_f32 v71, v83
    v_mul_f32 v70, v70, v82
    v_mul_f32 v71, v71, v82
    v_mul_f32 v84, v67, v71
    v_mul_f32 v85, v67, v70
    v_fma_f32 v70, v66, v70, -v84
    v_fma_f32 v71, -v66, v71, -v85
    v_mul_f32 v82, v64, v46
    v_mul_f32 v83, v65, v46
    v_exp_f32 v82, v82
    v_fract_f32 v83, v83
    v_cos_f32 v72, v83
    v_sin_f32 v73, v83
    v_mul_f32 v72, v72, v82
    v_mul_f32 v73, v73, v82
    v_mul_f32 v84, v67, v73
    v_mul_f32 v85, v67, v72
    v_fma_f32 v72, v66, v72, -v84
    v_fma_f32 v73, -v66, v73, -v85
    v_mfma_f32_16x16x4_f32 v[48:51], v68, v74, v[48:51]
    v_mfma_f32_16x16x4_f32 v[52:55], v70, v76, v[52:55]
    v_mfma_f32_16x16x4_f32 v[56:59], v70, v78, v[56:59]
    v_mfma_f32_16x16x4_f32 v[60:63], v72, v80, v[60:63]
    v_mfma_f32_16x16x4_f32 v[48:51], v69, v75, v[48:51]
    v_mfma_f32_16x16x4_f32 v[52:55], v71, v77, v[52:55]
    v_mfma_f32_16x16x4_f32 v[56:59], v71, v79, v[56:59]
    v_mfma_f32_16x16x4_f32 v[60:63], v73, v81, v[60:63]
    v_mov_b32_dpp v64, v28 row_newbcast:1 row_mask:0xf bank_mask:0xf
    v_mov_b32_dpp v65, v29 row_newbcast:1 row_mask:0xf bank_mask:0xf
    v_mov_b32_dpp v66, v30 row_newbcast:1 row_mask:0xf bank_mask:0xf
    v_mov_b32_dpp v67, v31 row_newbcast:1 row_mask:0xf bank_mask:0xf
    v_mul_f32 v82, v64, v47
    v_mul_f32 v83, v65, v47
    v_exp_f32 v82, v82
    v_fract_f32 v83, v83
    v_cos_f32 v74, v83
    v_sin_f32 v75, v83
    v_mul_f32 v74, v74, v82
    v_mul_f32 v75, v75, v82
    v_mul_f32 v84, v75, v75
    v_add_f32 v85, v74, v74
    v_fma_f32 v76, v74, v74, -v84
    v_mul_f32 v77, v85, v75
    v_mul_f32 v84, v77, v77
    v_add_f32 v85, v76, v76
    v_fma_f32 v78, v76, v76, -v84
    v_mul_f32 v79, v85, v77
    v_mul_f32 v84, v79, v79
    v_add_f32 v85, v78, v78
    v_fma_f32 v80, v78, v78, -v84
    v_mul_f32 v81, v85, v79
    v_mul_f32 v82, v64, v44
    v_mul_f32 v83, v65, v44
    v_exp_f32 v82, v82
    v_fract_f32 v83, v83
    v_cos_f32 v68, v83
    v_sin_f32 v69, v83
    v_mul_f32 v68, v68, v82
    v_mul_f32 v69, v69, v82
    v_mul_f32 v84, v67, v69
    v_mul_f32 v85, v67, v68
    v_fma_f32 v68, v66, v68, -v84
    v_fma_f32 v69, -v66, v69, -v85
    v_mul_f32 v82, v64, v45
    v_mul_f32 v83, v65, v45
    v_exp_f32 v82, v82
    v_fract_f32 v83, v83
    v_cos_f32 v70, v83
    v_sin_f32 v71, v83
    v_mul_f32 v70, v70, v82
    v_mul_f32 v71, v71, v82
    v_mul_f32 v84, v67, v71
    v_mul_f32 v85, v67, v70
    v_fma_f32 v70, v66, v70, -v84
    v_fma_f32 v71, -v66, v71, -v85
    v_mul_f32 v82, v64, v46
    v_mul_f32 v83, v65, v46
    v_exp_f32 v82, v82
    v_fract_f32 v83, v83
    v_cos_f32 v72, v83
    v_sin_f32 v73, v83
    v_mul_f32 v72, v72, v82
    v_mul_f32 v73, v73, v82
    v_mul_f32 v84, v67, v73
    v_mul_f32 v85, v67, v72
    v_fma_f32 v72, v66, v72, -v84
    v_fma_f32 v73, -v66, v73, -v85
    v_mfma_f32_16x16x4_f32 v[48:51], v68, v74, v[48:51]
    v_mfma_f32_16x16x4_f32 v[52:55], v70, v76, v[52:55]
    v_mfma_f32_16x16x4_f32 v[56:59], v70, v78, v[56:59]
    v_mfma_f32_16x16x4_f32 v[60:63], v72, v80, v[60:63]
    v_mfma_f32_16x16x4_f32 v[48:51], v69, v75, v[48:51]
    v_mfma_f32_16x16x4_f32 v[52:55], v71, v77, v[52:55]
    v_mfma_f32_16x16x4_f32 v[56:59], v71, v79, v[56:59]
    v_mfma_f32_16x16x4_f32 v[60:63], v73, v81, v[60:63]
    v_mov_b32_dpp v64, v28 row_newbcast:2 row_mask:0xf bank_mask:0xf
    v_mov_b32_dpp v65, v29 row_newbcast:2 row_mask:0xf bank_mask:0xf
    v_mov_b32_dpp v66, v30 row_newbcast:2 row_mask:0xf bank_mask:0xf
    v_mov_b32_dpp v67, v31 row_newbcast:2 row_mask:0xf bank_mask:0xf
    v_mul_f32 v82, v64, v47
    v_mul_f32 v83, v65, v47
    v_exp_f32 v82, v82
    v_fract_f32 v83, v83
    v_cos_f32 v74, v83
    v_sin_f32 v75, v83
    v_mul_f32 v74, v74, v82
    v_mul_f32 v75, v75, v82
    v_mul_f32 v84, v75, v75
    v_add_f32 v85, v74, v74
    v_fma_f32 v76, v74, v74, -v84
    v_mul_f32 v77, v85, v75
    v_mul_f32 v84, v77, v77
    v_add_f32 v85, v76, v76
    v_fma_f32 v78, v76, v76, -v84
    v_mul_f32 v79, v85, v77
    v_mul_f32 v84, v79, v79
    v_add_f32 v85, v78, v78
    v_fma_f32 v80, v78, v78, -v84
    v_mul_f32 v81, v85, v79
    v_mul_f32 v82, v64, v44
    v_mul_f32 v83, v65, v44
    v_exp_f32 v82, v82
    v_fract_f32 v83, v83
    v_cos_f32 v68, v83
    v_sin_f32 v69, v83
    v_mul_f32 v68, v68, v82
    v_mul_f32 v69, v69, v82
    v_mul_f32 v84, v67, v69
    v_mul_f32 v85, v67, v68
    v_fma_f32 v68, v66, v68, -v84
    v_fma_f32 v69, -v66, v69, -v85
    v_mul_f32 v82, v64, v45
    v_mul_f32 v83, v65, v45
    v_exp_f32 v82, v82
    v_fract_f32 v83, v83
    v_cos_f32 v70, v83
    v_sin_f32 v71, v83
    v_mul_f32 v70, v70, v82
    v_mul_f32 v71, v71, v82
    v_mul_f32 v84, v67, v71
    v_mul_f32 v85, v67, v70
    v_fma_f32 v70, v66, v70, -v84
    v_fma_f32 v71, -v66, v71, -v85
    v_mul_f32 v82, v64, v46
    v_mul_f32 v83, v65, v46
    v_exp_f32 v82, v82
    v_fract_f32 v83, v83
    v_cos_f32 v72, v83
    v_sin_f32 v73, v83
    v_mul_f32 v72, v72, v82
    v_mul_f32 v73, v73, v82
    v_mul_f32 v84, v67, v73
    v_mul_f32 v85, v67, v72
    v_fma_f32 v72, v66, v72, -v84
    v_fma_f32 v73, -v66, v73, -v85
    v_mfma_f32_16x16x4_f32 v[48:51], v68, v74, v[48:51]
    v_mfma_f32_16x16x4_f32 v[52:55], v70, v76, v[52:55]
    v_mfma_f32_16x16x4_f32 v[56:59], v70, v78, v[56:59]
    v_mfma_f32_16x16x4_f32 v[60:63], v72, v80, v[60:63]
    v_mfma_f32_16x16x4_f32 v[48:51], v69, v75, v[48:51]
    v_mfma_f32_16x16x4_f32 v[52:55], v71, v77, v[52:55]
    v_mfma_f32_16x16x4_f32 v[56:59], v71, v79, v[56:59]
    v_mfma_f32_16x16x4_f32 v[60:63], v73, v81, v[60:63]
    v_mov_b32_dpp v64, v28 row_newbcast:3 row_mask:0xf bank_mask:0xf
    v_mov_b32_dpp v65, v29 row_newbcast:3 row_mask:0xf bank_mask:0xf
    v_mov_b32_dpp v66, v30 row_newbcast:3 row_mask:0xf bank_mask:0xf
    v_mov_b32_dpp v67, v31 row_newbcast:3 row_mask:0xf bank_mask:0xf
    v_mul_f32 v82, v64, v47
    v_mul_f32 v83, v65, v47
    v_exp_f32 v82, v82
    v_fract_f32 v83, v83
    v_cos_f32 v74, v83
    v_sin_f32 v75, v83
    v_mul_f32 v74, v74, v82
    v_mul_f32 v75, v75, v82
    v_mul_f32 v84, v75, v75
    v_add_f32 v85, v74, v74
    v_fma_f32 v76, v74, v74, -v84
    v_mul_f32 v77, v85, v75
    v_mul_f32 v84, v77, v77
    v_add_f32 v85, v76, v76
    v_fma_f32 v78, v76, v76, -v84
    v_mul_f32 v79, v85, v77
    v_mul_f32 v84, v79, v79
    v_add_f32 v85, v78, v78
    v_fma_f32 v80, v78, v78, -v84
    v_mul_f32 v81, v85, v79
    v_mul_f32 v82, v64, v44
    v_mul_f32 v83, v65, v44
    v_exp_f32 v82, v82
    v_fract_f32 v83, v83
    v_cos_f32 v68, v83
    v_sin_f32 v69, v83
    v_mul_f32 v68, v68, v82
    v_mul_f32 v69, v69, v82
    v_mul_f32 v84, v67, v69
    v_mul_f32 v85, v67, v68
    v_fma_f32 v68, v66, v68, -v84
    v_fma_f32 v69, -v66, v69, -v85
    v_mul_f32 v82, v64, v45
    v_mul_f32 v83, v65, v45
    v_exp_f32 v82, v82
    v_fract_f32 v83, v83
    v_cos_f32 v70, v83
    v_sin_f32 v71, v83
    v_mul_f32 v70, v70, v82
    v_mul_f32 v71, v71, v82
    v_mul_f32 v84, v67, v71
    v_mul_f32 v85, v67, v70
    v_fma_f32 v70, v66, v70, -v84
    v_fma_f32 v71, -v66, v71, -v85
    v_mul_f32 v82, v64, v46
    v_mul_f32 v83, v65, v46
    v_exp_f32 v82, v82
    v_fract_f32 v83, v83
    v_cos_f32 v72, v83
    v_sin_f32 v73, v83
    v_mul_f32 v72, v72, v82
    v_mul_f32 v73, v73, v82
    v_mul_f32 v84, v67, v73
    v_mul_f32 v85, v67, v72
    v_fma_f32 v72, v66, v72, -v84
    v_fma_f32 v73, -v66, v73, -v85
    v_mfma_f32_16x16x4_f32 v[48:51], v68, v74, v[48:51]
    v_mfma_f32_16x16x4_f32 v[52:55], v70, v76, v[52:55]
    v_mfma_f32_16x16x4_f32 v[56:59], v70, v78, v[56:59]
    v_mfma_f32_16x16x4_f32 v[60:63], v72, v80, v[60:63]
    v_mfma_f32_16x16x4_f32 v[48:51], v69, v75, v[48:51]
    v_mfma_f32_16x16x4_f32 v[52:55], v71, v77, v[52:55]
    v_mfma_f32_16x16x4_f32 v[56:59], v71, v79, v[56:59]
    v_mfma_f32_16x16x4_f32 v[60:63], v73, v81, v[60:63]
    v_mov_b32_dpp v64, v28 row_newbcast:4 row_mask:0xf bank_mask:0xf
    v_mov_b32_dpp v65, v29 row_newbcast:4 row_mask:0xf bank_mask:0xf
    v_mov_b32_dpp v66, v30 row_newbcast:4 row_mask:0xf bank_mask:0xf
    v_mov_b32_dpp v67, v31 row_newbcast:4 row_mask:0xf bank_mask:0xf
    v_mul_f32 v82, v64, v47
    v_mul_f32 v83, v65, v47
    v_exp_f32 v82, v82
    v_fract_f32 v83, v83
    v_cos_f32 v74, v83
    v_sin_f32 v75, v83
    v_mul_f32 v74, v74, v82
    v_mul_f32 v75, v75, v82
    v_mul_f32 v84, v75, v75
    v_add_f32 v85, v74, v74
    v_fma_f32 v76, v74, v74, -v84
    v_mul_f32 v77, v85, v75
    v_mul_f32 v84, v77, v77
    v_add_f32 v85, v76, v76
    v_fma_f32 v78, v76, v76, -v84
    v_mul_f32 v79, v85, v77
    v_mul_f32 v84, v79, v79
    v_add_f32 v85, v78, v78
    v_fma_f32 v80, v78, v78, -v84
    v_mul_f32 v81, v85, v79
    v_mul_f32 v82, v64, v44
    v_mul_f32 v83, v65, v44
    v_exp_f32 v82, v82
    v_fract_f32 v83, v83
    v_cos_f32 v68, v83
    v_sin_f32 v69, v83
    v_mul_f32 v68, v68, v82
    v_mul_f32 v69, v69, v82
    v_mul_f32 v84, v67, v69
    v_mul_f32 v85, v67, v68
    v_fma_f32 v68, v66, v68, -v84
    v_fma_f32 v69, -v66, v69, -v85
    v_mul_f32 v82, v64, v45
    v_mul_f32 v83, v65, v45
    v_exp_f32 v82, v82
    v_fract_f32 v83, v83
    v_cos_f32 v70, v83
    v_sin_f32 v71, v83
    v_mul_f32 v70, v70, v82
    v_mul_f32 v71, v71, v82
    v_mul_f32 v84, v67, v71
    v_mul_f32 v85, v67, v70
    v_fma_f32 v70, v66, v70, -v84
    v_fma_f32 v71, -v66, v71, -v85
    v_mul_f32 v82, v64, v46
    v_mul_f32 v83, v65, v46
    v_exp_f32 v82, v82
    v_fract_f32 v83, v83
    v_cos_f32 v72, v83
    v_sin_f32 v73, v83
    v_mul_f32 v72, v72, v82
    v_mul_f32 v73, v73, v82
    v_mul_f32 v84, v67, v73
    v_mul_f32 v85, v67, v72
    v_fma_f32 v72, v66, v72, -v84
    v_fma_f32 v73, -v66, v73, -v85
    v_mfma_f32_16x16x4_f32 v[48:51], v68, v74, v[48:51]
    v_mfma_f32_16x16x4_f32 v[52:55], v70, v76, v[52:55]
    v_mfma_f32_16x16x4_f32 v[56:59], v70, v78, v[56:59]
    v_mfma_f32_16x16x4_f32 v[60:63], v72, v80, v[60:63]
    v_mfma_f32_16x16x4_f32 v[48:51], v69, v75, v[48:51]
    v_mfma_f32_16x16x4_f32 v[52:55], v71, v77, v[52:55]
    v_mfma_f32_16x16x4_f32 v[56:59], v71, v79, v[56:59]
    v_mfma_f32_16x16x4_f32 v[60:63], v73, v81, v[60:63]
    v_mov_b32_dpp v64, v28 row_newbcast:5 row_mask:0xf bank_mask:0xf
    v_mov_b32_dpp v65, v29 row_newbcast:5 row_mask:0xf bank_mask:0xf
    v_mov_b32_dpp v66, v30 row_newbcast:5 row_mask:0xf bank_mask:0xf
    v_mov_b32_dpp v67, v31 row_newbcast:5 row_mask:0xf bank_mask:0xf
    v_mul_f32 v82, v64, v47
    v_mul_f32 v83, v65, v47
    v_exp_f32 v82, v82
    v_fract_f32 v83, v83
    v_cos_f32 v74, v83
    v_sin_f32 v75, v83
    v_mul_f32 v74, v74, v82
    v_mul_f32 v75, v75, v82
    v_mul_f32 v84, v75, v75
    v_add_f32 v85, v74, v74
    v_fma_f32 v76, v74, v74, -v84
    v_mul_f32 v77, v85, v75
    v_mul_f32 v84, v77, v77
    v_add_f32 v85, v76, v76
    v_fma_f32 v78, v76, v76, -v84
    v_mul_f32 v79, v85, v77
    v_mul_f32 v84, v79, v79
    v_add_f32 v85, v78, v78
    v_fma_f32 v80, v78, v78, -v84
    v_mul_f32 v81, v85, v79
    v_mul_f32 v82, v64, v44
    v_mul_f32 v83, v65, v44
    v_exp_f32 v82, v82
    v_fract_f32 v83, v83
    v_cos_f32 v68, v83
    v_sin_f32 v69, v83
    v_mul_f32 v68, v68, v82
    v_mul_f32 v69, v69, v82
    v_mul_f32 v84, v67, v69
    v_mul_f32 v85, v67, v68
    v_fma_f32 v68, v66, v68, -v84
    v_fma_f32 v69, -v66, v69, -v85
    v_mul_f32 v82, v64, v45
    v_mul_f32 v83, v65, v45
    v_exp_f32 v82, v82
    v_fract_f32 v83, v83
    v_cos_f32 v70, v83
    v_sin_f32 v71, v83
    v_mul_f32 v70, v70, v82
    v_mul_f32 v71, v71, v82
    v_mul_f32 v84, v67, v71
    v_mul_f32 v85, v67, v70
    v_fma_f32 v70, v66, v70, -v84
    v_fma_f32 v71, -v66, v71, -v85
    v_mul_f32 v82, v64, v46
    v_mul_f32 v83, v65, v46
    v_exp_f32 v82, v82
    v_fract_f32 v83, v83
    v_cos_f32 v72, v83
    v_sin_f32 v73, v83
    v_mul_f32 v72, v72, v82
    v_mul_f32 v73, v73, v82
    v_mul_f32 v84, v67, v73
    v_mul_f32 v85, v67, v72
    v_fma_f32 v72, v66, v72, -v84
    v_fma_f32 v73, -v66, v73, -v85
    v_mfma_f32_16x16x4_f32 v[48:51], v68, v74, v[48:51]
    v_mfma_f32_16x16x4_f32 v[52:55], v70, v76, v[52:55]
    v_mfma_f32_16x16x4_f32 v[56:59], v70, v78, v[56:59]
    v_mfma_f32_16x16x4_f32 v[60:63], v72, v80, v[60:63]
    v_mfma_f32_16x16x4_f32 v[48:51], v69, v75, v[48:51]
    v_mfma_f32_16x16x4_f32 v[52:55], v71, v77, v[52:55]
    v_mfma_f32_16x16x4_f32 v[56:59], v71, v79, v[56:59]
    v_mfma_f32_16x16x4_f32 v[60:63], v73, v81, v[60:63]
    v_mov_b32_dpp v64, v28 row_newbcast:6 row_mask:0xf bank_mask:0xf
    v_mov_b32_dpp v65, v29 row_newbcast:6 row_mask:0xf bank_mask:0xf
    v_mov_b32_dpp v66, v30 row_newbcast:6 row_mask:0xf bank_mask:0xf
    v_mov_b32_dpp v67, v31 row_newbcast:6 row_mask:0xf bank_mask:0xf
    v_mul_f32 v82, v64, v47
    v_mul_f32 v83, v65, v47
    v_exp_f32 v82, v82
    v_fract_f32 v83, v83
    v_cos_f32 v74, v83
    v_sin_f32 v75, v83
    v_mul_f32 v74, v74, v82
    v_mul_f32 v75, v75, v82
    v_mul_f32 v84, v75, v75
    v_add_f32 v85, v74, v74
    v_fma_f32 v76, v74, v74, -v84
    v_mul_f32 v77, v85, v75
    v_mul_f32 v84, v77, v77
    v_add_f32 v85, v76, v76
    v_fma_f32 v78, v76, v76, -v84
    v_mul_f32 v79, v85, v77
    v_mul_f32 v84, v79, v79
    v_add_f32 v85, v78, v78
    v_fma_f32 v80, v78, v78, -v84
    v_mul_f32 v81, v85, v79
    v_mul_f32 v82, v64, v44
    v_mul_f32 v83, v65, v44
    v_exp_f32 v82, v82
    v_fract_f32 v83, v83
    v_cos_f32 v68, v83
    v_sin_f32 v69, v83
    v_mul_f32 v68, v68, v82
    v_mul_f32 v69, v69, v82
    v_mul_f32 v84, v67, v69
    v_mul_f32 v85, v67, v68
    v_fma_f32 v68, v66, v68, -v84
    v_fma_f32 v69, -v66, v69, -v85
    v_mul_f32 v82, v64, v45
    v_mul_f32 v83, v65, v45
    v_exp_f32 v82, v82
    v_fract_f32 v83, v83
    v_cos_f32 v70, v83
    v_sin_f32 v71, v83
    v_mul_f32 v70, v70, v82
    v_mul_f32 v71, v71, v82
    v_mul_f32 v84, v67, v71
    v_mul_f32 v85, v67, v70
    v_fma_f32 v70, v66, v70, -v84
    v_fma_f32 v71, -v66, v71, -v85
    v_mul_f32 v82, v64, v46
    v_mul_f32 v83, v65, v46
    v_exp_f32 v82, v82
    v_fract_f32 v83, v83
    v_cos_f32 v72, v83
    v_sin_f32 v73, v83
    v_mul_f32 v72, v72, v82
    v_mul_f32 v73, v73, v82
    v_mul_f32 v84, v67, v73
    v_mul_f32 v85, v67, v72
    v_fma_f32 v72, v66, v72, -v84
    v_fma_f32 v73, -v66, v73, -v85
    v_mfma_f32_16x16x4_f32 v[48:51], v68, v74, v[48:51]
    v_mfma_f32_16x16x4_f32 v[52:55], v70, v76, v[52:55]
    v_mfma_f32_16x16x4_f32 v[56:59], v70, v78, v[56:59]
    v_mfma_f32_16x16x4_f32 v[60:63], v72, v80, v[60:63]
    v_mfma_f32_16x16x4_f32 v[48:51], v69, v75, v[48:51]
    v_mfma_f32_16x16x4_f32 v[52:55], v71, v77, v[52:55]
    v_mfma_f32_16x16x4_f32 v[56:59], v71, v79, v[56:59]
    v_mfma_f32_16x16x4_f32 v[60:63], v73, v81, v[60:63]
    v_mov_b32_dpp v64, v28 row_newbcast:7 row_mask:0xf bank_mask:0xf
    v_mov_b32_dpp v65, v29 row_newbcast:7 row_mask:0xf bank_mask:0xf
    v_mov_b32_dpp v66, v30 row_newbcast:7 row_mask:0xf bank_mask:0xf
    v_mov_b32_dpp v67, v31 row_newbcast:7 row_mask:0xf bank_mask:0xf
    v_mul_f32 v82, v64, v47
    v_mul_f32 v83, v65, v47
    v_exp_f32 v82, v82
    v_fract_f32 v83, v83
    v_cos_f32 v74, v83
    v_sin_f32 v75, v83
    v_mul_f32 v74, v74, v82
    v_mul_f32 v75, v75, v82
    v_mul_f32 v84, v75, v75
    v_add_f32 v85, v74, v74
    v_fma_f32 v76, v74, v74, -v84
    v_mul_f32 v77, v85, v75
    v_mul_f32 v84, v77, v77
    v_add_f32 v85, v76, v76
    v_fma_f32 v78, v76, v76, -v84
    v_mul_f32 v79, v85, v77
    v_mul_f32 v84, v79, v79
    v_add_f32 v85, v78, v78
    v_fma_f32 v80, v78, v78, -v84
    v_mul_f32 v81, v85, v79
    v_mul_f32 v82, v64, v44
    v_mul_f32 v83, v65, v44
    v_exp_f32 v82, v82
    v_fract_f32 v83, v83
    v_cos_f32 v68, v83
    v_sin_f32 v69, v83
    v_mul_f32 v68, v68, v82
    v_mul_f32 v69, v69, v82
    v_mul_f32 v84, v67, v69
    v_mul_f32 v85, v67, v68
    v_fma_f32 v68, v66, v68, -v84
    v_fma_f32 v69, -v66, v69, -v85
    v_mul_f32 v82, v64, v45
    v_mul_f32 v83, v65, v45
    v_exp_f32 v82, v82
    v_fract_f32 v83, v83
    v_cos_f32 v70, v83
    v_sin_f32 v71, v83
    v_mul_f32 v70, v70, v82
    v_mul_f32 v71, v71, v82
    v_mul_f32 v84, v67, v71
    v_mul_f32 v85, v67, v70
    v_fma_f32 v70, v66, v70, -v84
    v_fma_f32 v71, -v66, v71, -v85
    v_mul_f32 v82, v64, v46
    v_mul_f32 v83, v65, v46
    v_exp_f32 v82, v82
    v_fract_f32 v83, v83
    v_cos_f32 v72, v83
    v_sin_f32 v73, v83
    v_mul_f32 v72, v72, v82
    v_mul_f32 v73, v73, v82
    v_mul_f32 v84, v67, v73
    v_mul_f32 v85, v67, v72
    v_fma_f32 v72, v66, v72, -v84
    v_fma_f32 v73, -v66, v73, -v85
    v_mfma_f32_16x16x4_f32 v[48:51], v68, v74, v[48:51]
    v_mfma_f32_16x16x4_f32 v[52:55], v70, v76, v[52:55]
    v_mfma_f32_16x16x4_f32 v[56:59], v70, v78, v[56:59]
    v_mfma_f32_16x16x4_f32 v[60:63], v72, v80, v[60:63]
    v_mfma_f32_16x16x4_f32 v[48:51], v69, v75, v[48:51]
    v_mfma_f32_16x16x4_f32 v[52:55], v71, v77, v[52:55]
    v_mfma_f32_16x16x4_f32 v[56:59], v71, v79, v[56:59]
    v_mfma_f32_16x16x4_f32 v[60:63], v73, v81, v[60:63]
    v_mov_b32_dpp v64, v28 row_newbcast:8 row_mask:0xf bank_mask:0xf
    v_mov_b32_dpp v65, v29 row_newbcast:8 row_mask:0xf bank_mask:0xf
    v_mov_b32_dpp v66, v30 row_newbcast:8 row_mask:0xf bank_mask:0xf
    v_mov_b32_dpp v67, v31 row_newbcast:8 row_mask:0xf bank_mask:0xf
    v_mul_f32 v82, v64, v47
    v_mul_f32 v83, v65, v47
    v_exp_f32 v82, v82
    v_fract_f32 v83, v83
    v_cos_f32 v74, v83
    v_sin_f32 v75, v83
    v_mul_f32 v74, v74, v82
    v_mul_f32 v75, v75, v82
    v_mul_f32 v84, v75, v75
    v_add_f32 v85, v74, v74
    v_fma_f32 v76, v74, v74, -v84
    v_mul_f32 v77, v85, v75
    v_mul_f32 v84, v77, v77
    v_add_f32 v85, v76, v76
    v_fma_f32 v78, v76, v76, -v84
    v_mul_f32 v79, v85, v77
    v_mul_f32 v84, v79, v79
    v_add_f32 v85, v78, v78
    v_fma_f32 v80, v78, v78, -v84
    v_mul_f32 v81, v85, v79
    v_mul_f32 v82, v64, v44
    v_mul_f32 v83, v65, v44
    v_exp_f32 v82, v82
    v_fract_f32 v83, v83
    v_cos_f32 v68, v83
    v_sin_f32 v69, v83
    v_mul_f32 v68, v68, v82
    v_mul_f32 v69, v69, v82
    v_mul_f32 v84, v67, v69
    v_mul_f32 v85, v67, v68
    v_fma_f32 v68, v66, v68, -v84
    v_fma_f32 v69, -v66, v69, -v85
    v_mul_f32 v82, v64, v45
    v_mul_f32 v83, v65, v45
    v_exp_f32 v82, v82
    v_fract_f32 v83, v83
    v_cos_f32 v70, v83
    v_sin_f32 v71, v83
    v_mul_f32 v70, v70, v82
    v_mul_f32 v71, v71, v82
    v_mul_f32 v84, v67, v71
    v_mul_f32 v85, v67, v70
    v_fma_f32 v70, v66, v70, -v84
    v_fma_f32 v71, -v66, v71, -v85
    v_mul_f32 v82, v64, v46
    v_mul_f32 v83, v65, v46
    v_exp_f32 v82, v82
    v_fract_f32 v83, v83
    v_cos_f32 v72, v83
    v_sin_f32 v73, v83
    v_mul_f32 v72, v72, v82
    v_mul_f32 v73, v73, v82
    v_mul_f32 v84, v67, v73
    v_mul_f32 v85, v67, v72
    v_fma_f32 v72, v66, v72, -v84
    v_fma_f32 v73, -v66, v73, -v85
    v_mfma_f32_16x16x4_f32 v[48:51], v68, v74, v[48:51]
    v_mfma_f32_16x16x4_f32 v[52:55], v70, v76, v[52:55]
    v_mfma_f32_16x16x4_f32 v[56:59], v70, v78, v[56:59]
    v_mfma_f32_16x16x4_f32 v[60:63], v72, v80, v[60:63]
    v_mfma_f32_16x16x4_f32 v[48:51], v69, v75, v[48:51]
    v_mfma_f32_16x16x4_f32 v[52:55], v71, v77, v[52:55]
    v_mfma_f32_16x16x4_f32 v[56:59], v71, v79, v[56:59]
    v_mfma_f32_16x16x4_f32 v[60:63], v73, v81, v[60:63]
    v_mov_b32_dpp v64, v28 row_newbcast:9 row_mask:0xf bank_mask:0xf
    v_mov_b32_dpp v65, v29 row_newbcast:9 row_mask:0xf bank_mask:0xf
    v_mov_b32_dpp v66, v30 row_newbcast:9 row_mask:0xf bank_mask:0xf
    v_mov_b32_dpp v67, v31 row_newbcast:9 row_mask:0xf bank_mask:0xf
    v_mul_f32 v82, v64, v47
    v_mul_f32 v83, v65, v47
    v_exp_f32 v82, v82
    v_fract_f32 v83, v83
    v_cos_f32 v74, v83
    v_sin_f32 v75, v83
    v_mul_f32 v74, v74, v82
    v_mul_f32 v75, v75, v82
    v_mul_f32 v84, v75, v75
    v_add_f32 v85, v74, v74
    v_fma_f32 v76, v74, v74, -v84
    v_mul_f32 v77, v85, v75
    v_mul_f32 v84, v77, v77
    v_add_f32 v85, v76, v76
    v_fma_f32 v78, v76, v76, -v84
    v_mul_f32 v79, v85, v77
    v_mul_f32 v84, v79, v79
    v_add_f32 v85, v78, v78
    v_fma_f32 v80, v78, v78, -v84
    v_mul_f32 v81, v85, v79
    v_mul_f32 v82, v64, v44
    v_mul_f32 v83, v65, v44
    v_exp_f32 v82, v82
    v_fract_f32 v83, v83
    v_cos_f32 v68, v83
    v_sin_f32 v69, v83
    v_mul_f32 v68, v68, v82
    v_mul_f32 v69, v69, v82
    v_mul_f32 v84, v67, v69
    v_mul_f32 v85, v67, v68
    v_fma_f32 v68, v66, v68, -v84
    v_fma_f32 v69, -v66, v69, -v85
    v_mul_f32 v82, v64, v45
    v_mul_f32 v83, v65, v45
    v_exp_f32 v82, v82
    v_fract_f32 v83, v83
    v_cos_f32 v70, v83
    v_sin_f32 v71, v83
    v_mul_f32 v70, v70, v82
    v_mul_f32 v71, v71, v82
    v_mul_f32 v84, v67, v71
    v_mul_f32 v85, v67, v70
    v_fma_f32 v70, v66, v70, -v84
    v_fma_f32 v71, -v66, v71, -v85
    v_mul_f32 v82, v64, v46
    v_mul_f32 v83, v65, v46
    v_exp_f32 v82, v82
    v_fract_f32 v83, v83
    v_cos_f32 v72, v83
    v_sin_f32 v73, v83
    v_mul_f32 v72, v72, v82
    v_mul_f32 v73, v73, v82
    v_mul_f32 v84, v67, v73
    v_mul_f32 v85, v67, v72
    v_fma_f32 v72, v66, v72, -v84
    v_fma_f32 v73, -v66, v73, -v85
    v_mfma_f32_16x16x4_f32 v[48:51], v68, v74, v[48:51]
    v_mfma_f32_16x16x4_f32 v[52:55], v70, v76, v[52:55]
    v_mfma_f32_16x16x4_f32 v[56:59], v70, v78, v[56:59]
    v_mfma_f32_16x16x4_f32 v[60:63], v72, v80, v[60:63]
    v_mfma_f32_16x16x4_f32 v[48:51], v69, v75, v[48:51]
    v_mfma_f32_16x16x4_f32 v[52:55], v71, v77, v[52:55]
    v_mfma_f32_16x16x4_f32 v[56:59], v71, v79, v[56:59]
    v_mfma_f32_16x16x4_f32 v[60:63], v73, v81, v[60:63]
    v_mov_b32_dpp v64, v28 row_newbcast:10 row_mask:0xf bank_mask:0xf
    v_mov_b32_dpp v65, v29 row_newbcast:10 row_mask:0xf bank_mask:0xf
    v_mov_b32_dpp v66, v30 row_newbcast:10 row_mask:0xf bank_mask:0xf
    v_mov_b32_dpp v67, v31 row_newbcast:10 row_mask:0xf bank_mask:0xf
    v_mul_f32 v82, v64, v47
    v_mul_f32 v83, v65, v47
    v_exp_f32 v82, v82
    v_fract_f32 v83, v83
    v_cos_f32 v74, v83
    v_sin_f32 v75, v83
    v_mul_f32 v74, v74, v82
    v_mul_f32 v75, v75, v82
    v_mul_f32 v84, v75, v75
    v_add_f32 v85, v74, v74
    v_fma_f32 v76, v74, v74, -v84
    v_mul_f32 v77, v85, v75
    v_mul_f32 v84, v77, v77
    v_add_f32 v85, v76, v76
    v_fma_f32 v78, v76, v76, -v84
    v_mul_f32 v79, v85, v77
    v_mul_f32 v84, v79, v79
    v_add_f32 v85, v78, v78
    v_fma_f32 v80, v78, v78, -v84
    v_mul_f32 v81, v85, v79
    v_mul_f32 v82, v64, v44
    v_mul_f32 v83, v65, v44
    v_exp_f32 v82, v82
    v_fract_f32 v83, v83
    v_cos_f32 v68, v83
    v_sin_f32 v69, v83
    v_mul_f32 v68, v68, v82
    v_mul_f32 v69, v69, v82
    v_mul_f32 v84, v67, v69
    v_mul_f32 v85, v67, v68
    v_fma_f32 v68, v66, v68, -v84
    v_fma_f32 v69, -v66, v69, -v85
    v_mul_f32 v82, v64, v45
    v_mul_f32 v83, v65, v45
    v_exp_f32 v82, v82
    v_fract_f32 v83, v83
    v_cos_f32 v70, v83
    v_sin_f32 v71, v83
    v_mul_f32 v70, v70, v82
    v_mul_f32 v71, v71, v82
    v_mul_f32 v84, v67, v71
    v_mul_f32 v85, v67, v70
    v_fma_f32 v70, v66, v70, -v84
    v_fma_f32 v71, -v66, v71, -v85
    v_mul_f32 v82, v64, v46
    v_mul_f32 v83, v65, v46
    v_exp_f32 v82, v82
    v_fract_f32 v83, v83
    v_cos_f32 v72, v83
    v_sin_f32 v73, v83
    v_mul_f32 v72, v72, v82
    v_mul_f32 v73, v73, v82
    v_mul_f32 v84, v67, v73
    v_mul_f32 v85, v67, v72
    v_fma_f32 v72, v66, v72, -v84
    v_fma_f32 v73, -v66, v73, -v85
    v_mfma_f32_16x16x4_f32 v[48:51], v68, v74, v[48:51]
    v_mfma_f32_16x16x4_f32 v[52:55], v70, v76, v[52:55]
    v_mfma_f32_16x16x4_f32 v[56:59], v70, v78, v[56:59]
    v_mfma_f32_16x16x4_f32 v[60:63], v72, v80, v[60:63]
    v_mfma_f32_16x16x4_f32 v[48:51], v69, v75, v[48:51]
    v_mfma_f32_16x16x4_f32 v[52:55], v71, v77, v[52:55]
    v_mfma_f32_16x16x4_f32 v[56:59], v71, v79, v[56:59]
    v_mfma_f32_16x16x4_f32 v[60:63], v73, v81, v[60:63]
    v_mov_b32_dpp v64, v28 row_newbcast:11 row_mask:0xf bank_mask:0xf
    v_mov_b32_dpp v65, v29 row_newbcast:11 row_mask:0xf bank_mask:0xf
    v_mov_b32_dpp v66, v30 row_newbcast:11 row_mask:0xf bank_mask:0xf
    v_mov_b32_dpp v67, v31 row_newbcast:11 row_mask:0xf bank_mask:0xf
    v_mul_f32 v82, v64, v47
    v_mul_f32 v83, v65, v47
    v_exp_f32 v82, v82
    v_fract_f32 v83, v83
    v_cos_f32 v74, v83
    v_sin_f32 v75, v83
    v_mul_f32 v74, v74, v82
    v_mul_f32 v75, v75, v82
    v_mul_f32 v84, v75, v75
    v_add_f32 v85, v74, v74
    v_fma_f32 v76, v74, v74, -v84
    v_mul_f32 v77, v85, v75
    v_mul_f32 v84, v77, v77
    v_add_f32 v85, v76, v76
    v_fma_f32 v78, v76, v76, -v84
    v_mul_f32 v79, v85, v77
    v_mul_f32 v84, v79, v79
    v_add_f32 v85, v78, v78
    v_fma_f32 v80, v78, v78, -v84
    v_mul_f32 v81, v85, v79
    v_mul_f32 v82, v64, v44
    v_mul_f32 v83, v65, v44
    v_exp_f32 v82, v82
    v_fract_f32 v83, v83
    v_cos_f32 v68, v83
    v_sin_f32 v69, v83
    v_mul_f32 v68, v68, v82
    v_mul_f32 v69, v69, v82
    v_mul_f32 v84, v67, v69
    v_mul_f32 v85, v67, v68
    v_fma_f32 v68, v66, v68, -v84
    v_fma_f32 v69, -v66, v69, -v85
    v_mul_f32 v82, v64, v45
    v_mul_f32 v83, v65, v45
    v_exp_f32 v82, v82
    v_fract_f32 v83, v83
    v_cos_f32 v70, v83
    v_sin_f32 v71, v83
    v_mul_f32 v70, v70, v82
    v_mul_f32 v71, v71, v82
    v_mul_f32 v84, v67, v71
    v_mul_f32 v85, v67, v70
    v_fma_f32 v70, v66, v70, -v84
    v_fma_f32 v71, -v66, v71, -v85
    v_mul_f32 v82, v64, v46
    v_mul_f32 v83, v65, v46
    v_exp_f32 v82, v82
    v_fract_f32 v83, v83
    v_cos_f32 v72, v83
    v_sin_f32 v73, v83
    v_mul_f32 v72, v72, v82
    v_mul_f32 v73, v73, v82
    v_mul_f32 v84, v67, v73
    v_mul_f32 v85, v67, v72
    v_fma_f32 v72, v66, v72, -v84
    v_fma_f32 v73, -v66, v73, -v85
    v_mfma_f32_16x16x4_f32 v[48:51], v68, v74, v[48:51]
    v_mfma_f32_16x16x4_f32 v[52:55], v70, v76, v[52:55]
    v_mfma_f32_16x16x4_f32 v[56:59], v70, v78, v[56:59]
    v_mfma_f32_16x16x4_f32 v[60:63], v72, v80, v[60:63]
    v_mfma_f32_16x16x4_f32 v[48:51], v69, v75, v[48:51]
    v_mfma_f32_16x16x4_f32 v[52:55], v71, v77, v[52:55]
    v_mfma_f32_16x16x4_f32 v[56:59], v71, v79, v[56:59]
    v_mfma_f32_16x16x4_f32 v[60:63], v73, v81, v[60:63]
    v_mov_b32_dpp v64, v28 row_newbcast:12 row_mask:0xf bank_mask:0xf
    v_mov_b32_dpp v65, v29 row_newbcast:12 row_mask:0xf bank_mask:0xf
    v_mov_b32_dpp v66, v30 row_newbcast:12 row_mask:0xf bank_mask:0xf
    v_mov_b32_dpp v67, v31 row_newbcast:12 row_mask:0xf bank_mask:0xf
    v_mul_f32 v82, v64, v47
    v_mul_f32 v83, v65, v47
    v_exp_f32 v82, v82
    v_fract_f32 v83, v83
    v_cos_f32 v74, v83
    v_sin_f32 v75, v83
    v_mul_f32 v74, v74, v82
    v_mul_f32 v75, v75, v82
    v_mul_f32 v84, v75, v75
    v_add_f32 v85, v74, v74
    v_fma_f32 v76, v74, v74, -v84
    v_mul_f32 v77, v85, v75
    v_mul_f32 v84, v77, v77
    v_add_f32 v85, v76, v76
    v_fma_f32 v78, v76, v76, -v84
    v_mul_f32 v79, v85, v77
    v_mul_f32 v84, v79, v79
    v_add_f32 v85, v78, v78
    v_fma_f32 v80, v78, v78, -v84
    v_mul_f32 v81, v85, v79
    v_mul_f32 v82, v64, v44
    v_mul_f32 v83, v65, v44
    v_exp_f32 v82, v82
    v_fract_f32 v83, v83
    v_cos_f32 v68, v83
    v_sin_f32 v69, v83
    v_mul_f32 v68, v68, v82
    v_mul_f32 v69, v69, v82
    v_mul_f32 v84, v67, v69
    v_mul_f32 v85, v67, v68
    v_fma_f32 v68, v66, v68, -v84
    v_fma_f32 v69, -v66, v69, -v85
    v_mul_f32 v82, v64, v45
    v_mul_f32 v83, v65, v45
    v_exp_f32 v82, v82
    v_fract_f32 v83, v83
    v_cos_f32 v70, v83
    v_sin_f32 v71, v83
    v_mul_f32 v70, v70, v82
    v_mul_f32 v71, v71, v82
    v_mul_f32 v84, v67, v71
    v_mul_f32 v85, v67, v70
    v_fma_f32 v70, v66, v70, -v84
    v_fma_f32 v71, -v66, v71, -v85
    v_mul_f32 v82, v64, v46
    v_mul_f32 v83, v65, v46
    v_exp_f32 v82, v82
    v_fract_f32 v83, v83
    v_cos_f32 v72, v83
    v_sin_f32 v73, v83
    v_mul_f32 v72, v72, v82
    v_mul_f32 v73, v73, v82
    v_mul_f32 v84, v67, v73
    v_mul_f32 v85, v67, v72
    v_fma_f32 v72, v66, v72, -v84
    v_fma_f32 v73, -v66, v73, -v85
    v_mfma_f32_16x16x4_f32 v[48:51], v68, v74, v[48:51]
    v_mfma_f32_16x16x4_f32 v[52:55], v70, v76, v[52:55]
    v_mfma_f32_16x16x4_f32 v[56:59], v70, v78, v[56:59]
    v_mfma_f32_16x16x4_f32 v[60:63], v72, v80, v[60:63]
    v_mfma_f32_16x16x4_f32 v[48:51], v69, v75, v[48:51]
    v_mfma_f32_16x16x4_f32 v[52:55], v71, v77, v[52:55]
    v_mfma_f32_16x16x4_f32 v[56:59], v71, v79, v[56:59]
    v_mfma_f32_16x16x4_f32 v[60:63], v73, v81, v[60:63]
    v_mov_b32_dpp v64, v28 row_newbcast:13 row_mask:0xf bank_mask:0xf
    v_mov_b32_dpp v65, v29 row_newbcast:13 row_mask:0xf bank_mask:0xf
    v_mov_b32_dpp v66, v30 row_newbcast:13 row_mask:0xf bank_mask:0xf
    v_mov_b32_dpp v67, v31 row_newbcast:13 row_mask:0xf bank_mask:0xf
    v_mul_f32 v82, v64, v47
    v_mul_f32 v83, v65, v47
    v_exp_f32 v82, v82
    v_fract_f32 v83, v83
    v_cos_f32 v74, v83
    v_sin_f32 v75, v83
    v_mul_f32 v74, v74, v82
    v_mul_f32 v75, v75, v82
    v_mul_f32 v84, v75, v75
    v_add_f32 v85, v74, v74
    v_fma_f32 v76, v74, v74, -v84
    v_mul_f32 v77, v85, v75
    v_mul_f32 v84, v77, v77
    v_add_f32 v85, v76, v76
    v_fma_f32 v78, v76, v76, -v84
    v_mul_f32 v79, v85, v77
    v_mul_f32 v84, v79, v79
    v_add_f32 v85, v78, v78
    v_fma_f32 v80, v78, v78, -v84
    v_mul_f32 v81, v85, v79
    v_mul_f32 v82, v64, v44
    v_mul_f32 v83, v65, v44
    v_exp_f32 v82, v82
    v_fract_f32 v83, v83
    v_cos_f32 v68, v83
    v_sin_f32 v69, v83
    v_mul_f32 v68, v68, v82
    v_mul_f32 v69, v69, v82
    v_mul_f32 v84, v67, v69
    v_mul_f32 v85, v67, v68
    v_fma_f32 v68, v66, v68, -v84
    v_fma_f32 v69, -v66, v69, -v85
    v_mul_f32 v82, v64, v45
    v_mul_f32 v83, v65, v45
    v_exp_f32 v82, v82
    v_fract_f32 v83, v83
    v_cos_f32 v70, v83
    v_sin_f32 v71, v83
    v_mul_f32 v70, v70, v82
    v_mul_f32 v71, v71, v82
    v_mul_f32 v84, v67, v71
    v_mul_f32 v85, v67, v70
    v_fma_f32 v70, v66, v70, -v84
    v_fma_f32 v71, -v66, v71, -v85
    v_mul_f32 v82, v64, v46
    v_mul_f32 v83, v65, v46
    v_exp_f32 v82, v82
    v_fract_f32 v83, v83
    v_cos_f32 v72, v83
    v_sin_f32 v73, v83
    v_mul_f32 v72, v72, v82
    v_mul_f32 v73, v73, v82
    v_mul_f32 v84, v67, v73
    v_mul_f32 v85, v67, v72
    v_fma_f32 v72, v66, v72, -v84
    v_fma_f32 v73, -v66, v73, -v85
    v_mfma_f32_16x16x4_f32 v[48:51], v68, v74, v[48:51]
    v_mfma_f32_16x16x4_f32 v[52:55], v70, v76, v[52:55]
    v_mfma_f32_16x16x4_f32 v[56:59], v70, v78, v[56:59]
    v_mfma_f32_16x16x4_f32 v[60:63], v72, v80, v[60:63]
    v_mfma_f32_16x16x4_f32 v[48:51], v69, v75, v[48:51]
    v_mfma_f32_16x16x4_f32 v[52:55], v71, v77, v[52:55]
    v_mfma_f32_16x16x4_f32 v[56:59], v71, v79, v[56:59]
    v_mfma_f32_16x16x4_f32 v[60:63], v73, v81, v[60:63]
    v_mov_b32_dpp v64, v28 row_newbcast:14 row_mask:0xf bank_mask:0xf
    v_mov_b32_dpp v65, v29 row_newbcast:14 row_mask:0xf bank_mask:0xf
    v_mov_b32_dpp v66, v30 row_newbcast:14 row_mask:0xf bank_mask:0xf
    v_mov_b32_dpp v67, v31 row_newbcast:14 row_mask:0xf bank_mask:0xf
    v_mul_f32 v82, v64, v47
    v_mul_f32 v83, v65, v47
    v_exp_f32 v82, v82
    v_fract_f32 v83, v83
    v_cos_f32 v74, v83
    v_sin_f32 v75, v83
    v_mul_f32 v74, v74, v82
    v_mul_f32 v75, v75, v82
    v_mul_f32 v84, v75, v75
    v_add_f32 v85, v74, v74
    v_fma_f32 v76, v74, v74, -v84
    v_mul_f32 v77, v85, v75
    v_mul_f32 v84, v77, v77
    v_add_f32 v85, v76, v76
    v_fma_f32 v78, v76, v76, -v84
    v_mul_f32 v79, v85, v77
    v_mul_f32 v84, v79, v79
    v_add_f32 v85, v78, v78
    v_fma_f32 v80, v78, v78, -v84
    v_mul_f32 v81, v85, v79
    v_mul_f32 v82, v64, v44
    v_mul_f32 v83, v65, v44
    v_exp_f32 v82, v82
    v_fract_f32 v83, v83
    v_cos_f32 v68, v83
    v_sin_f32 v69, v83
    v_mul_f32 v68, v68, v82
    v_mul_f32 v69, v69, v82
    v_mul_f32 v84, v67, v69
    v_mul_f32 v85, v67, v68
    v_fma_f32 v68, v66, v68, -v84
    v_fma_f32 v69, -v66, v69, -v85
    v_mul_f32 v82, v64, v45
    v_mul_f32 v83, v65, v45
    v_exp_f32 v82, v82
    v_fract_f32 v83, v83
    v_cos_f32 v70, v83
    v_sin_f32 v71, v83
    v_mul_f32 v70, v70, v82
    v_mul_f32 v71, v71, v82
    v_mul_f32 v84, v67, v71
    v_mul_f32 v85, v67, v70
    v_fma_f32 v70, v66, v70, -v84
    v_fma_f32 v71, -v66, v71, -v85
    v_mul_f32 v82, v64, v46
    v_mul_f32 v83, v65, v46
    v_exp_f32 v82, v82
    v_fract_f32 v83, v83
    v_cos_f32 v72, v83
    v_sin_f32 v73, v83
    v_mul_f32 v72, v72, v82
    v_mul_f32 v73, v73, v82
    v_mul_f32 v84, v67, v73
    v_mul_f32 v85, v67, v72
    v_fma_f32 v72, v66, v72, -v84
    v_fma_f32 v73, -v66, v73, -v85
    v_mfma_f32_16x16x4_f32 v[48:51], v68, v74, v[48:51]
    v_mfma_f32_16x16x4_f32 v[52:55], v70, v76, v[52:55]
    v_mfma_f32_16x16x4_f32 v[56:59], v70, v78, v[56:59]
    v_mfma_f32_16x16x4_f32 v[60:63], v72, v80, v[60:63]
    v_mfma_f32_16x16x4_f32 v[48:51], v69, v75, v[48:51]
    v_mfma_f32_16x16x4_f32 v[52:55], v71, v77, v[52:55]
    v_mfma_f32_16x16x4_f32 v[56:59], v71, v79, v[56:59]
    v_mfma_f32_16x16x4_f32 v[60:63], v73, v81, v[60:63]
    v_mov_b32_dpp v64, v28 row_newbcast:15 row_mask:0xf bank_mask:0xf
    v_mov_b32_dpp v65, v29 row_newbcast:15 row_mask:0xf bank_mask:0xf
    v_mov_b32_dpp v66, v30 row_newbcast:15 row_mask:0xf bank_mask:0xf
    v_mov_b32_dpp v67, v31 row_newbcast:15 row_mask:0xf bank_mask:0xf
    v_mul_f32 v82, v64, v47
    v_mul_f32 v83, v65, v47
    v_exp_f32 v82, v82
    v_fract_f32 v83, v83
    v_cos_f32 v74, v83
    v_sin_f32 v75, v83
    v_mul_f32 v74, v74, v82
    v_mul_f32 v75, v75, v82
    v_mul_f32 v84, v75, v75
    v_add_f32 v85, v74, v74
    v_fma_f32 v76, v74, v74, -v84
    v_mul_f32 v77, v85, v75
    v_mul_f32 v84, v77, v77
    v_add_f32 v85, v76, v76
    v_fma_f32 v78, v76, v76, -v84
    v_mul_f32 v79, v85, v77
    v_mul_f32 v84, v79, v79
    v_add_f32 v85, v78, v78
    v_fma_f32 v80, v78, v78, -v84
    v_mul_f32 v81, v85, v79
    v_mul_f32 v82, v64, v44
    v_mul_f32 v83, v65, v44
    v_exp_f32 v82, v82
    v_fract_f32 v83, v83
    v_cos_f32 v68, v83
    v_sin_f32 v69, v83
    v_mul_f32 v68, v68, v82
    v_mul_f32 v69, v69, v82
    v_mul_f32 v84, v67, v69
    v_mul_f32 v85, v67, v68
    v_fma_f32 v68, v66, v68, -v84
    v_fma_f32 v69, -v66, v69, -v85
    v_mul_f32 v82, v64, v45
    v_mul_f32 v83, v65, v45
    v_exp_f32 v82, v82
    v_fract_f32 v83, v83
    v_cos_f32 v70, v83
    v_sin_f32 v71, v83
    v_mul_f32 v70, v70, v82
    v_mul_f32 v71, v71, v82
    v_mul_f32 v84, v67, v71
    v_mul_f32 v85, v67, v70
    v_fma_f32 v70, v66, v70, -v84
    v_fma_f32 v71, -v66, v71, -v85
    v_mul_f32 v82, v64, v46
    v_mul_f32 v83, v65, v46
    v_exp_f32 v82, v82
    v_fract_f32 v83, v83
    v_cos_f32 v72, v83
    v_sin_f32 v73, v83
    v_mul_f32 v72, v72, v82
    v_mul_f32 v73, v73, v82
    v_mul_f32 v84, v67, v73
    v_mul_f32 v85, v67, v72
    v_fma_f32 v72, v66, v72, -v84
    v_fma_f32 v73, -v66, v73, -v85
    v_mfma_f32_16x16x4_f32 v[48:51], v68, v74, v[48:51]
    v_mfma_f32_16x16x4_f32 v[52:55], v70, v76, v[52:55]
    v_mfma_f32_16x16x4_f32 v[56:59], v70, v78, v[56:59]
    v_mfma_f32_16x16x4_f32 v[60:63], v72, v80, v[60:63]
    v_mfma_f32_16x16x4_f32 v[48:51], v69, v75, v[48:51]
    v_mfma_f32_16x16x4_f32 v[52:55], v71, v77, v[52:55]
    v_mfma_f32_16x16x4_f32 v[56:59], v71, v79, v[56:59]
    v_mfma_f32_16x16x4_f32 v[60:63], v73, v81, v[60:63]
    v_lshlrev_b32 v5, 8, v3
    v_lshl_add_u32 v5, v2, 2, v5
    v_add_u32 v5, v5, v4
    ds_write_b32 v5, v48 offset:4608
    ds_write_b32 v5, v49 offset:4672
    ds_write_b32 v5, v50 offset:4736
    ds_write_b32 v5, v51 offset:4800
    v_cmp_gt_u32 vcc, 2, v3
    s_nop 0
    s_mov_b64 exec, vcc
    ds_write_b32 v5, v52 offset:5632
    ds_write_b32 v5, v53 offset:5696
    ds_write_b32 v5, v54 offset:5760
    ds_write_b32 v5, v55 offset:5824
    ds_write_b32 v5, v60 offset:6656
    ds_write_b32 v5, v61 offset:6720
    ds_write_b32 v5, v62 offset:6784
    ds_write_b32 v5, v63 offset:6848
    s_not_b64 exec, exec
    ds_write_b32 v5, v56 offset:5632
    ds_write_b32 v5, v57 offset:5696
    ds_write_b32 v5, v58 offset:5760
    ds_write_b32 v5, v59 offset:5824
    s_mov_b32 exec_lo, 0
    s_mov_b32 exec_hi, 3
    v_cmp_eq_u32 vcc, 0, v2
    s_nop 1
    v_cndmask_b32 v6, 0, v60, vcc
    ds_write_b32 v5, v6 offset:6656
    s_mov_b64 exec, -1
    s_waitcnt lgkmcnt(0)
    v_lshlrev_b32 v7, 1, v1
    v_sub_u32 v7, 2065, v7
    v_lshl_add_u32 v64, v1, 2, v4
    v_mov_b32 v65, 641
    s_mov_b32 s25, 17
ss_exp:
    v_subrev_u32 v66, 0, v7
    v_cvt_f32_u32 v70, v66
    v_cvt_pk_bf16_f32 v70, v70, v70
    v_and_b32 v70, 0xffff, v70
    v_subrev_u32 v70, 0x4280, v70
    v_cmp_gt_u32 vcc, 256, v66
    s_nop 1
    v_cndmask_b32 v70, v70, v66, vcc
    v_cmp_gt_u32 vcc, 2048, v66
    s_nop 1
    v_cndmask_b32 v70, v65, v70, vcc
    v_lshl_add_u32 v70, v70, 2, v4
    ds_read_b32 v74, v70 offset:4608
    v_subrev_u32 v67, 1, v7
    v_cvt_f32_u32 v71, v67
    v_cvt_pk_bf16_f32 v71, v71, v71
    v_and_b32 v71, 0xffff, v71
    v_subrev_u32 v71, 0x4280, v71
    v_cmp_gt_u32 vcc, 256, v67
    s_nop 1
    v_cndmask_b32 v71, v71, v67, vcc
    v_cmp_gt_u32 vcc, 2048, v67
    s_nop 1
    v_cndmask_b32 v71, v65, v71, vcc
    v_lshl_add_u32 v71, v71, 2, v4
    ds_read_b32 v75, v71 offset:4608
    v_subrev_u32 v68, 2, v7
    v_cvt_f32_u32 v72, v68
    v_cvt_pk_bf16_f32 v72, v72, v72
    v_and_b32 v72, 0xffff, v72
    v_subrev_u32 v72, 0x4280, v72
    v_cmp_gt_u32 vcc, 256, v68
    s_nop 1
    v_cndmask_b32 v72, v72, v68, vcc
    v_cmp_gt_u32 vcc, 2048, v68
    s_nop 1
    v_cndmask_b32 v72, v65, v72, vcc
    v_lshl_add_u32 v72, v72, 2, v4
    ds_read_b32 v76, v72 offset:4608
    s_waitcnt lgkmcnt(0)
    v_cvt_pk_bf16_f32 v78, v75, v76
    v_cvt_pk_bf16_f32 v79, v74, v75
    ds_write_b32 v64, v78 offset:7424
    ds_write_b32 v64, v79 offset:11776
    v_subrev_u32 v7, 128, v7
    v_add_u32 v64, 256, v64
    s_sub_u32 s25, s25, 1
    s_cmp_lg_u32 s25, 0
    s_cbranch_scc1 ss_exp
    s_waitcnt lgkmcnt(0)
    s_barrier
    v_and_b32 v5, 1, v2
    v_mul_u32_u24 v64, 4352, v5
    v_sub_u32 v5, v5, v2
    v_lshl_add_u32 v5, v3, 3, v5
    v_lshl_add_u32 v64, v5, 1, v64
    v_add_u32 v64, 11520, v64
    v_add_u32 v64, v64, v4
    v_lshlrev_b32 v65, 5, v2
    v_lshl_add_u32 v65, v3, 4, v65
    v_add_u32 v65, 480, v65
    v_add_u32 v65, v65, v4
    v_mov_b32 v96, 0
    v_mov_b32 v97, 0
    v_mov_b32 v98, 0
    v_mov_b32 v99, 0
    v_mov_b32 v100, 0
    v_mov_b32 v101, 0
    v_mov_b32 v102, 0
    v_mov_b32 v103, 0
    v_mov_b32 v104, 0
    v_mov_b32 v105, 0
    v_mov_b32 v106, 0
    v_mov_b32 v107, 0
    v_mov_b32 v108, 0
    v_mov_b32 v109, 0
    v_mov_b32 v110, 0
    v_mov_b32 v111, 0
    v_mov_b32 v112, 0
    v_mov_b32 v113, 0
    v_mov_b32 v114, 0
    v_mov_b32 v115, 0
    v_mov_b32 v116, 0
    v_mov_b32 v117, 0
    v_mov_b32 v118, 0
    v_mov_b32 v119, 0
    v_mov_b32 v120, 0
    v_mov_b32 v121, 0
    v_mov_b32 v122, 0
    v_mov_b32 v123, 0
    v_mov_b32 v124, 0
    v_mov_b32 v125, 0
    v_mov_b32 v126, 0
    v_mov_b32 v127, 0
    s_mov_b32 s25, 8
ss_cv0:
    ds_read2_b32 v[68:69], v64 offset0:0 offset1:1
    ds_read2_b32 v[70:71], v64 offset0:2 offset1:3
    ds_read_b128 v[128:131], v65 offset:0
    ds_read_b128 v[132:135], v65 offset:512
    ds_read_b128 v[136:139], v65 offset:1024
    ds_read_b128 v[140:143], v65 offset:1536
    ds_read_b128 v[144:147], v65 offset:2048
    ds_read_b128 v[148:151], v65 offset:2560
    ds_read_b128 v[152:155], v65 offset:3072
    ds_read_b128 v[156:159], v65 offset:3584
    v_subrev_u32 v64, 64, v64
    v_subrev_u32 v65, 64, v65
    s_waitcnt lgkmcnt(7)
    v_mfma_f32_16x16x32_bf16 v[96:99], v[68:71], v[128:131], v[96:99]
    s_waitcnt lgkmcnt(6)
    v_mfma_f32_16x16x32_bf16 v[100:103], v[68:71], v[132:135], v[100:103]
    s_waitcnt lgkmcnt(5)
    v_mfma_f32_16x16x32_bf16 v[104:107], v[68:71], v[136:139], v[104:107]
    s_waitcnt lgkmcnt(4)
    v_mfma_f32_16x16x32_bf16 v[108:111], v[68:71], v[140:143], v[108:111]
    s_waitcnt lgkmcnt(3)
    v_mfma_f32_16x16x32_bf16 v[112:115], v[68:71], v[144:147], v[112:115]
    s_waitcnt lgkmcnt(2)
    v_mfma_f32_16x16x32_bf16 v[116:119], v[68:71], v[148:151], v[116:119]
    s_waitcnt lgkmcnt(1)
    v_mfma_f32_16x16x32_bf16 v[120:123], v[68:71], v[152:155], v[120:123]
    s_waitcnt lgkmcnt(0)
    v_mfma_f32_16x16x32_bf16 v[124:127], v[68:71], v[156:159], v[124:127]
    s_sub_u32 s25, s25, 1
    s_cmp_lg_u32 s25, 0
    s_cbranch_scc1 ss_cv0
    v_add_u32 v65, 512, v65
    s_mov_b32 s25, 8
ss_cv1:
    ds_read2_b32 v[68:69], v64 offset0:0 offset1:1
    ds_read2_b32 v[70:71], v64 offset0:2 offset1:3
    ds_read_b128 v[132:135], v65 offset:0
    ds_read_b128 v[136:139], v65 offset:512
    ds_read_b128 v[140:143], v65 offset:1024
    ds_read_b128 v[144:147], v65 offset:1536
    ds_read_b128 v[148:151], v65 offset:2048
    ds_read_b128 v[152:155], v65 offset:2560
    ds_read_b128 v[156:159], v65 offset:3072
    v_subrev_u32 v64, 64, v64
    v_subrev_u32 v65, 64, v65
    s_waitcnt lgkmcnt(6)
    v_mfma_f32_16x16x32_bf16 v[100:103], v[68:71], v[132:135], v[100:103]
    s_waitcnt lgkmcnt(5)
    v_mfma_f32_16x16x32_bf16 v[104:107], v[68:71], v[136:139], v[104:107]
    s_waitcnt lgkmcnt(4)
    v_mfma_f32_16x16x32_bf16 v[108:111], v[68:71], v[140:143], v[108:111]
    s_waitcnt lgkmcnt(3)
    v_mfma_f32_16x16x32_bf16 v[112:115], v[68:71], v[144:147], v[112:115]
    s_waitcnt lgkmcnt(2)
    v_mfma_f32_16x16x32_bf16 v[116:119], v[68:71], v[148:151], v[116:119]
    s_waitcnt lgkmcnt(1)
    v_mfma_f32_16x16x32_bf16 v[120:123], v[68:71], v[152:155], v[120:123]
    s_waitcnt lgkmcnt(0)
    v_mfma_f32_16x16x32_bf16 v[124:127], v[68:71], v[156:159], v[124:127]
    s_sub_u32 s25, s25, 1
    s_cmp_lg_u32 s25, 0
    s_cbranch_scc1 ss_cv1
    v_add_u32 v65, 512, v65
    s_mov_b32 s25, 8
ss_cv2:
    ds_read2_b32 v[68:69], v64 offset0:0 offset1:1
    ds_read2_b32 v[70:71], v64 offset0:2 offset1:3
    ds_read_b128 v[136:139], v65 offset:0
    ds_read_b128 v[140:143], v65 offset:512
    ds_read_b128 v[144:147], v65 offset:1024
    ds_read_b128 v[148:151], v65 offset:1536
    ds_read_b128 v[152:155], v65 offset:2048
    ds_read_b128 v[156:159], v65 offset:2560
    v_subrev_u32 v64, 64, v64
    v_subrev_u32 v65, 64, v65
    s_waitcnt lgkmcnt(5)
    v_mfma_f32_16x16x32_bf16 v[104:107], v[68:71], v[136:139], v[104:107]
    s_waitcnt lgkmcnt(4)
    v_mfma_f32_16x16x32_bf16 v[108:111], v[68:71], v[140:143], v[108:111]
    s_waitcnt lgkmcnt(3)
    v_mfma_f32_16x16x32_bf16 v[112:115], v[68:71], v[144:147], v[112:115]
    s_waitcnt lgkmcnt(2)
    v_mfma_f32_16x16x32_bf16 v[116:119], v[68:71], v[148:151], v[116:119]
    s_waitcnt lgkmcnt(1)
    v_mfma_f32_16x16x32_bf16 v[120:123], v[68:71], v[152:155], v[120:123]
    s_waitcnt lgkmcnt(0)
    v_mfma_f32_16x16x32_bf16 v[124:127], v[68:71], v[156:159], v[124:127]
    s_sub_u32 s25, s25, 1
    s_cmp_lg_u32 s25, 0
    s_cbranch_scc1 ss_cv2
    v_add_u32 v65, 512, v65
    s_mov_b32 s25, 8
ss_cv3:
    ds_read2_b32 v[68:69], v64 offset0:0 offset1:1
    ds_read2_b32 v[70:71], v64 offset0:2 offset1:3
    ds_read_b128 v[140:143], v65 offset:0
    ds_read_b128 v[144:147], v65 offset:512
    ds_read_b128 v[148:151], v65 offset:1024
    ds_read_b128 v[152:155], v65 offset:1536
    ds_read_b128 v[156:159], v65 offset:2048
    v_subrev_u32 v64, 64, v64
    v_subrev_u32 v65, 64, v65
    s_waitcnt lgkmcnt(4)
    v_mfma_f32_16x16x32_bf16 v[108:111], v[68:71], v[140:143], v[108:111]
    s_waitcnt lgkmcnt(3)
    v_mfma_f32_16x16x32_bf16 v[112:115], v[68:71], v[144:147], v[112:115]
    s_waitcnt lgkmcnt(2)
    v_mfma_f32_16x16x32_bf16 v[116:119], v[68:71], v[148:151], v[116:119]
    s_waitcnt lgkmcnt(1)
    v_mfma_f32_16x16x32_bf16 v[120:123], v[68:71], v[152:155], v[120:123]
    s_waitcnt lgkmcnt(0)
    v_mfma_f32_16x16x32_bf16 v[124:127], v[68:71], v[156:159], v[124:127]
    s_sub_u32 s25, s25, 1
    s_cmp_lg_u32 s25, 0
    s_cbranch_scc1 ss_cv3
    v_add_u32 v65, 512, v65
    s_mov_b32 s25, 8
ss_cv4:
    ds_read2_b32 v[68:69], v64 offset0:0 offset1:1
    ds_read2_b32 v[70:71], v64 offset0:2 offset1:3
    ds_read_b128 v[144:147], v65 offset:0
    ds_read_b128 v[148:151], v65 offset:512
    ds_read_b128 v[152:155], v65 offset:1024
    ds_read_b128 v[156:159], v65 offset:1536
    v_subrev_u32 v64, 64, v64
    v_subrev_u32 v65, 64, v65
    s_waitcnt lgkmcnt(3)
    v_mfma_f32_16x16x32_bf16 v[112:115], v[68:71], v[144:147], v[112:115]
    s_waitcnt lgkmcnt(2)
    v_mfma_f32_16x16x32_bf16 v[116:119], v[68:71], v[148:151], v[116:119]
    s_waitcnt lgkmcnt(1)
    v_mfma_f32_16x16x32_bf16 v[120:123], v[68:71], v[152:155], v[120:123]
    s_waitcnt lgkmcnt(0)
    v_mfma_f32_16x16x32_bf16 v[124:127], v[68:71], v[156:159], v[124:127]
    s_sub_u32 s25, s25, 1
    s_cmp_lg_u32 s25, 0
    s_cbranch_scc1 ss_cv4
    v_add_u32 v65, 512, v65
    s_mov_b32 s25, 8
ss_cv5:
    ds_read2_b32 v[68:69], v64 offset0:0 offset1:1
    ds_read2_b32 v[70:71], v64 offset0:2 offset1:3
    ds_read_b128 v[148:151], v65 offset:0
    ds_read_b128 v[152:155], v65 offset:512
    ds_read_b128 v[156:159], v65 offset:1024
    v_subrev_u32 v64, 64, v64
    v_subrev_u32 v65, 64, v65
    s_waitcnt lgkmcnt(2)
    v_mfma_f32_16x16x32_bf16 v[116:119], v[68:71], v[148:151], v[116:119]
    s_waitcnt lgkmcnt(1)
    v_mfma_f32_16x16x32_bf16 v[120:123], v[68:71], v[152:155], v[120:123]
    s_waitcnt lgkmcnt(0)
    v_mfma_f32_16x16x32_bf16 v[124:127], v[68:71], v[156:159], v[124:127]
    s_sub_u32 s25, s25, 1
    s_cmp_lg_u32 s25, 0
    s_cbranch_scc1 ss_cv5
    v_add_u32 v65, 512, v65
    s_mov_b32 s25, 8
ss_cv6:
    ds_read2_b32 v[68:69], v64 offset0:0 offset1:1
    ds_read2_b32 v[70:71], v64 offset0:2 offset1:3
    ds_read_b128 v[152:155], v65 offset:0
    ds_read_b128 v[156:159], v65 offset:512
    v_subrev_u32 v64, 64, v64
    v_subrev_u32 v65, 64, v65
    s_waitcnt lgkmcnt(1)
    v_mfma_f32_16x16x32_bf16 v[120:123], v[68:71], v[152:155], v[120:123]
    s_waitcnt lgkmcnt(0)
    v_mfma_f32_16x16x32_bf16 v[124:127], v[68:71], v[156:159], v[124:127]
    s_sub_u32 s25, s25, 1
    s_cmp_lg_u32 s25, 0
    s_cbranch_scc1 ss_cv6
    v_add_u32 v65, 512, v65
    s_mov_b32 s25, 8
ss_cv7:
    ds_read2_b32 v[68:69], v64 offset0:0 offset1:1
    ds_read2_b32 v[70:71], v64 offset0:2 offset1:3
    ds_read_b128 v[156:159], v65 offset:0
    v_subrev_u32 v64, 64, v64
    v_subrev_u32 v65, 64, v65
    s_waitcnt lgkmcnt(0)
    v_mfma_f32_16x16x32_bf16 v[124:127], v[68:71], v[156:159], v[124:127]
    s_sub_u32 s25, s25, 1
    s_cmp_lg_u32 s25, 0
    s_cbranch_scc1 ss_cv7
    v_add_u32 v65, 512, v65
    s_nop 3
    v_lshlrev_b32 v5, 6, v2
    v_lshl_add_u32 v5, v3, 4, v5
    v_add_u32 v5, v5, v4
    ds_write_b128 v5, v[96:99] offset:7424
    ds_write_b128 v5, v[100:103] offset:8448
    ds_write_b128 v5, v[104:107] offset:9472
    ds_write_b128 v5, v[108:111] offset:10496
    ds_write_b128 v5, v[112:115] offset:11520
    ds_write_b128 v5, v[116:119] offset:12544
    ds_write_b128 v5, v[120:123] offset:13568
    ds_write_b128 v5, v[124:127] offset:14592
    s_mov_b32 s12, s74
    s_mov_b32 s13, s75
    s_mov_b32 s14, 1152
    s_mov_b32 s15, 0x20000
    s_lshl_b32 s23, s20, 1
    buffer_load_dwordx2 v[24:25], off, s[12:15], s23
    s_waitcnt vmcnt(0) lgkmcnt(0)
    s_barrier
    v_lshlrev_b32 v26, 16, v24
    v_and_b32 v27, 0xffff0000, v24
    v_lshlrev_b32 v28, 16, v25
    v_and_b32 v29, 0xffff0000, v25
    v_lshlrev_b32 v5, 5, v0
    ds_read_b128 v[64:67], v5 offset:7424
    ds_read_b128 v[68:71], v5 offset:7440
    ds_read_b128 v[72:75], v5 offset:23808
    ds_read_b128 v[76:79], v5 offset:23824
    ds_read_b128 v[80:83], v5 offset:40192
    ds_read_b128 v[84:87], v5 offset:40208
    ds_read_b128 v[88:91], v5 offset:56576
    ds_read_b128 v[92:95], v5 offset:56592
    s_waitcnt lgkmcnt(0)
    v_mul_u32_u24 v5, 18432, v0
    s_lshl_b32 s22, s20, 1
    s_add_u32 s22, s22, 1152
    v_lshlrev_b32 v6, 16, v8
    v_fmac_f32 v64, v6, v26
    v_and_b32 v6, 0xffff0000, v8
    v_fmac_f32 v72, v6, v27
    v_lshlrev_b32 v6, 16, v9
    v_fmac_f32 v80, v6, v28
    v_and_b32 v6, 0xffff0000, v9
    v_fmac_f32 v88, v6, v29
    v_cvt_pk_bf16_f32 v8, v64, v72
    v_cvt_pk_bf16_f32 v9, v80, v88
    s_add_u32 s23, s22, 0
    buffer_store_dwordx2 v[8:9], v5, s[16:19], s23 offen
    v_lshlrev_b32 v6, 16, v10
    v_fmac_f32 v65, v6, v26
    v_and_b32 v6, 0xffff0000, v10
    v_fmac_f32 v73, v6, v27
    v_lshlrev_b32 v6, 16, v11
    v_fmac_f32 v81, v6, v28
    v_and_b32 v6, 0xffff0000, v11
    v_fmac_f32 v89, v6, v29
    v_cvt_pk_bf16_f32 v10, v65, v73
    v_cvt_pk_bf16_f32 v11, v81, v89
    s_add_u32 s23, s22, 2304
    buffer_store_dwordx2 v[10:11], v5, s[16:19], s23 offen
    v_lshlrev_b32 v6, 16, v12
    v_fmac_f32 v66, v6, v26
    v_and_b32 v6, 0xffff0000, v12
    v_fmac_f32 v74, v6, v27
    v_lshlrev_b32 v6, 16, v13
    v_fmac_f32 v82, v6, v28
    v_and_b32 v6, 0xffff0000, v13
    v_fmac_f32 v90, v6, v29
    v_cvt_pk_bf16_f32 v12, v66, v74
    v_cvt_pk_bf16_f32 v13, v82, v90
    s_add_u32 s23, s22, 4608
    buffer_store_dwordx2 v[12:13], v5, s[16:19], s23 offen
    v_lshlrev_b32 v6, 16, v14
    v_fmac_f32 v67, v6, v26
    v_and_b32 v6, 0xffff0000, v14
    v_fmac_f32 v75, v6, v27
    v_lshlrev_b32 v6, 16, v15
    v_fmac_f32 v83, v6, v28
    v_and_b32 v6, 0xffff0000, v15
    v_fmac_f32 v91, v6, v29
    v_cvt_pk_bf16_f32 v14, v67, v75
    v_cvt_pk_bf16_f32 v15, v83, v91
    s_add_u32 s23, s22, 6912
    buffer_store_dwordx2 v[14:15], v5, s[16:19], s23 offen
    v_lshlrev_b32 v6, 16, v16
    v_fmac_f32 v68, v6, v26
    v_and_b32 v6, 0xffff0000, v16
    v_fmac_f32 v76, v6, v27
    v_lshlrev_b32 v6, 16, v17
    v_fmac_f32 v84, v6, v28
    v_and_b32 v6, 0xffff0000, v17
    v_fmac_f32 v92, v6, v29
    v_cvt_pk_bf16_f32 v16, v68, v76
    v_cvt_pk_bf16_f32 v17, v84, v92
    s_add_u32 s23, s22, 9216
    buffer_store_dwordx2 v[16:17], v5, s[16:19], s23 offen
    v_lshlrev_b32 v6, 16, v18
    v_fmac_f32 v69, v6, v26
    v_and_b32 v6, 0xffff0000, v18
    v_fmac_f32 v77, v6, v27
    v_lshlrev_b32 v6, 16, v19
    v_fmac_f32 v85, v6, v28
    v_and_b32 v6, 0xffff0000, v19
    v_fmac_f32 v93, v6, v29
    v_cvt_pk_bf16_f32 v18, v69, v77
    v_cvt_pk_bf16_f32 v19, v85, v93
    s_add_u32 s23, s22, 11520
    buffer_store_dwordx2 v[18:19], v5, s[16:19], s23 offen
    v_lshlrev_b32 v6, 16, v20
    v_fmac_f32 v70, v6, v26
    v_and_b32 v6, 0xffff0000, v20
    v_fmac_f32 v78, v6, v27
    v_lshlrev_b32 v6, 16, v21
    v_fmac_f32 v86, v6, v28
    v_and_b32 v6, 0xffff0000, v21
    v_fmac_f32 v94, v6, v29
    v_cvt_pk_bf16_f32 v20, v70, v78
    v_cvt_pk_bf16_f32 v21, v86, v94
    s_add_u32 s23, s22, 13824
    buffer_store_dwordx2 v[20:21], v5, s[16:19], s23 offen
    v_lshlrev_b32 v6, 16, v22
    v_fmac_f32 v71, v6, v26
    v_and_b32 v6, 0xffff0000, v22
    v_fmac_f32 v79, v6, v27
    v_lshlrev_b32 v6, 16, v23
    v_fmac_f32 v87, v6, v28
    v_and_b32 v6, 0xffff0000, v23
    v_fmac_f32 v95, v6, v29
    v_cvt_pk_bf16_f32 v22, v71, v79
    v_cvt_pk_bf16_f32 v23, v87, v95
    s_add_u32 s23, s22, 16128
    buffer_store_dwordx2 v[22:23], v5, s[16:19], s23 offen
    s_branch L_ssm_next
L_phase2:
    v_and_b32 v1, 63, v0
    v_min_u32 v1, 6, v1
    v_lshlrev_b32 v2, 2, v1
    s_cmp_lg_u32 s32, 0
    v_mov_b32 v251, 163832
    s_cbranch_scc1 sw9
    buffer_load_dword v3, v2, s[96:99], 0 offen offset:32 sc1
    v_mov_b32 v4, 32
    s_waitcnt vmcnt(0)
    v_cmp_lt_u32 vcc, v3, v4
    s_nop 0
    s_ff1_i32_b64 s40, vcc
    v_mov_b32 v250, s40
    ds_write_b32 v251, v250
    s_waitcnt lgkmcnt(0)
sw9:
    s_barrier
    ds_read_b32 v252, v251
    s_waitcnt lgkmcnt(0)
    v_readfirstlane_b32 s33, v252
    s_barrier
    s_nop 1
    s_cmp_lt_u32 s33, 7
    s_cbranch_scc1 L_pool
    s_mov_b32 s88, 4194304
gn10:
    s_cmp_lg_u32 s95, 0
    s_cbranch_scc1 gn10x
    buffer_load_dword v250, off, s[96:99], 0 offset:64 sc1
    s_sub_u32 s88, s88, 1
    s_cbranch_scc1 gn10x
    s_waitcnt vmcnt(0)
    v_readfirstlane_b32 s95, v250
    s_nop 1
    s_branch gn10
gn10x:
    s_mov_b32 s40, 524288
mc2_w:
    buffer_load_dword v250, off, s[96:99], 0 offset:140 sc1
    s_waitcnt vmcnt(0)
    v_readfirstlane_b32 s41, v250
    s_nop 0
    s_cmp_lg_u32 s41, 0
    s_cbranch_scc1 mc2_known
    s_sub_u32 s40, s40, 1
    s_cbranch_scc1 mc2_force
    s_sleep 2
    s_branch mc2_w
mc2_force:
    v_mov_b32 v250, 2
    v_mov_b32 v251, 0
    s_mov_b64 exec, 1
    buffer_atomic_cmpswap v[250:251], off, s[96:99], 0 offset:140
    s_mov_b64 exec, -1
    s_waitcnt vmcnt(0)
    s_mov_b32 s40, 524288
    s_branch mc2_w
mc2_known:
    s_cmp_eq_u32 s41, 1
    s_cbranch_scc1 L_phase2b
    s_mov_b32 s37, 208
    v_mov_b32 v250, 1
    v_mov_b32 v251, 163832
    v_cmp_eq_u32 vcc, 0, v0
    s_nop 0
    s_and_saveexec_b64 s[38:39], vcc
    s_cbranch_execz tk11
    buffer_atomic_add v250, off, s[96:99], s37 sc0
    s_waitcnt vmcnt(0)
    ds_write_b32 v251, v250
    s_waitcnt lgkmcnt(0)
tk11:
    s_mov_b64 exec, -1
    s_barrier
    ds_read_b32 v252, v251
    s_waitcnt lgkmcnt(0)
    v_readfirstlane_b32 s12, v252
    s_barrier
    s_nop 3
    s_cmp_lt_u32 s12, 32
    s_cbranch_scc1 L_chain_safe
L_phase2b:
    s_mov_b32 s8, s76
    s_mov_b32 s9, s77
    s_mov_b32 s10, 4718592
    s_mov_b32 s11, 0x20000
    s_sub_u32 s33, s3, 1
    s_and_b32 s33, s33, 7
    s_cmp_eq_u32 s33, 7
    s_cbranch_scc1 L_p2scan
L_p2take:
    s_lshl_b32 s35, s33, 2
    s_add_u32 s35, s35, 160
    s_mov_b32 s37, s35
    v_mov_b32 v250, 1
    v_mov_b32 v251, 163832
    v_cmp_eq_u32 vcc, 0, v0
    s_nop 0
    s_and_saveexec_b64 s[38:39], vcc
    s_cbranch_execz tk12
    buffer_atomic_add v250, off, s[96:99], s37 sc0
    s_waitcnt vmcnt(0)
    ds_write_b32 v251, v250
    s_waitcnt lgkmcnt(0)
tk12:
    s_mov_b64 exec, -1
    s_barrier
    ds_read_b32 v252, v251
    s_waitcnt lgkmcnt(0)
    v_readfirstlane_b32 s34, v252
    s_barrier
    s_nop 3
    s_cmp_lt_u32 s33, 4
    s_cselect_b32 s36, 4, 6
    s_cmp_lt_u32 s34, s36
    s_cbranch_scc1 L_att0
    s_sub_u32 s34, s34, s36
    s_cmp_lt_u32 s34, 18
    s_cbranch_scc1 L_op_start
L_p2scan:
    v_and_b32 v1, 63, v0
    v_min_u32 v1, 6, v1
    v_lshlrev_b32 v2, 2, v1
    s_cmp_lg_u32 s32, 0
    v_mov_b32 v251, 163832
    s_cbranch_scc1 sw13
    buffer_load_dword v3, v2, s[96:99], 0 offen offset:160 sc1
    v_mov_b32 v4, 24
    v_cmp_gt_u32 vcc, 4, v1
    s_nop 1
    v_cndmask_b32 v4, v4, 22, vcc
    s_waitcnt vmcnt(0)
    v_cmp_lt_u32 vcc, v3, v4
    s_nop 0
    s_ff1_i32_b64 s40, vcc
    v_mov_b32 v250, s40
    ds_write_b32 v251, v250
    s_waitcnt lgkmcnt(0)
sw13:
    s_barrier
    ds_read_b32 v252, v251
    s_waitcnt lgkmcnt(0)
    v_readfirstlane_b32 s33, v252
    s_barrier
    s_nop 1
    s_cmp_lt_u32 s33, 7
    s_cbranch_scc1 L_p2take
    s_branch L_done
L_att0:
    s_mul_i32 s36, s34, 7
    s_mul_i32 s37, s34, 3
    s_add_u32 s37, s37, 12
    s_cmp_lt_u32 s34, 4
    s_cselect_b32 s34, s36, s37
    s_add_u32 s34, s34, s33
    s_cmp_ge_u32 s34, 32
    s_cbranch_scc1 L_done
L_att_next:
    s_lshr_b32 s16, s34, 3
    s_and_b32 s17, s34, 7
    s_lshl_b32 s17, s17, 2
    s_add_u32 s17, s17, s32
    s_lshr_b32 s36, s17, 1
    s_lshl_b32 s36, s36, 8
    s_add_u32 s36, s36, 125829120
    s_mul_i32 s37, s16, 43
    s_lshr_b32 s37, s37, 8
    s_mul_i32 s41, s37, 6
    s_sub_u32 s41, s16, s41
    v_and_b32 v1, 63, v0
    v_mul_u32_u24 v2, 6, v1
    v_add_u32 v2, s41, v2
    v_mov_b32 v4, s37
    s_and_b32 s41, s16, 7
    s_add_u32 s41, s41, 12
    s_lshr_b32 s37, s16, 3
    v_mov_b32 v5, s41
    v_mov_b32 v6, s37
    v_cmp_lt_u32 vcc, 1, v1
    s_nop 1
    v_cndmask_b32 v2, v2, v5, vcc
    v_cndmask_b32 v4, v4, v6, vcc
    v_lshlrev_b32 v2, 2, v2
    v_add3_u32 v4, v4, s95, 1
    s_mov_b32 s40, 4194304
L_aw1:
    buffer_load_dword v3, v2, s[4:7], s36 offen sc1
    s_sub_u32 s40, s40, 1
    s_cbranch_scc1 L_aw1_go
    s_waitcnt vmcnt(0)
    v_subrev_u32 v3, v4, v3
    v_cmp_lt_u32 vcc, 64, v3
    s_cbranch_vccz L_aw1_go
    s_sleep 4
    s_branch L_aw1
L_aw1_go:
    v_and_b32 v5, 63, v0
    v_lshlrev_b32 v1, 4, v5
    v_or_b32 v3, 128, v1
    v_lshrrev_b32 v4, 4, v5
    v_bfe_u32 v6, v5, 2, 2
    v_sub_u32 v4, v6, v4
    v_lshlrev_b32 v4, 3, v4
    v_and_b32 v6, 3, v5
    v_add_u32 v4, v4, v6
    v_mov_b32 v6, 0xf149f2ca
    s_mov_b32 s22, 0x3e0293ee
    s_lshl_b32 s18, s16, 5
    s_add_u32 s18, s18, s17
    s_lshl_b32 s19, s18, 13
    s_add_u32 s20, s19, 33554432
    buffer_load_dwordx4 v[8:11], v1, s[4:7], s20 offen offset:0 sc1
    s_add_u32 s20, s19, 33554432
    buffer_load_dwordx4 v[12:15], v1, s[4:7], s20 offen offset:1024 sc1
    s_add_u32 s20, s19, 33554432
    buffer_load_dwordx4 v[16:19], v1, s[4:7], s20 offen offset:2048 sc1
    s_add_u32 s20, s19, 33554432
    buffer_load_dwordx4 v[20:23], v1, s[4:7], s20 offen offset:3072 sc1
    s_add_u32 s20, s19, 33558528
    buffer_load_dwordx4 v[24:27], v1, s[4:7], s20 offen offset:0 sc1
    s_add_u32 s20, s19, 33558528
    buffer_load_dwordx4 v[28:31], v1, s[4:7], s20 offen offset:1024 sc1
    s_add_u32 s20, s19, 33558528
    buffer_load_dwordx4 v[32:35], v1, s[4:7], s20 offen offset:2048 sc1
    s_add_u32 s20, s19, 33558528
    buffer_load_dwordx4 v[36:39], v1, s[4:7], s20 offen offset:3072 sc1
    s_lshl_b32 s21, s18, 14
    s_add_u32 s20, s21, 0
    buffer_load_dwordx4 v[40:43], v1, s[4:7], s20 offen offset:0 sc1
    s_add_u32 s20, s21, 4096
    buffer_load_dwordx4 v[44:47], v1, s[4:7], s20 offen offset:0 sc1
    s_add_u32 s20, s21, 8192
    buffer_load_dwordx4 v[48:51], v1, s[4:7], s20 offen offset:0 sc1
    s_add_u32 s20, s21, 12288
    buffer_load_dwordx4 v[52:55], v1, s[4:7], s20 offen offset:0 sc1
    s_add_u32 s20, s21, 0
    buffer_load_dwordx4 v[56:59], v1, s[4:7], s20 offen offset:1024 sc1
    s_add_u32 s20, s21, 4096
    buffer_load_dwordx4 v[60:63], v1, s[4:7], s20 offen offset:1024 sc1
    s_add_u32 s20, s21, 8192
    buffer_load_dwordx4 v[64:67], v1, s[4:7], s20 offen offset:1024 sc1
    s_add_u32 s20, s21, 12288
    buffer_load_dwordx4 v[68:71], v1, s[4:7], s20 offen offset:1024 sc1
    s_add_u32 s20, s21, 0
    buffer_load_dwordx4 v[88:91], v1, s[4:7], s20 offen offset:2048 sc1
    s_add_u32 s20, s21, 4096
    buffer_load_dwordx4 v[92:95], v1, s[4:7], s20 offen offset:2048 sc1
    s_add_u32 s20, s21, 8192
    buffer_load_dwordx4 v[96:99], v1, s[4:7], s20 offen offset:2048 sc1
    s_add_u32 s20, s21, 12288
    buffer_load_dwordx4 v[100:103], v1, s[4:7], s20 offen offset:2048 sc1
    s_add_u32 s20, s21, 0
    buffer_load_dwordx4 v[104:107], v1, s[4:7], s20 offen offset:3072 sc1
    s_add_u32 s20, s21, 4096
    buffer_load_dwordx4 v[108:111], v1, s[4:7], s20 offen offset:3072 sc1
    s_add_u32 s20, s21, 8192
    buffer_load_dwordx4 v[112:115], v1, s[4:7], s20 offen offset:3072 sc1
    s_add_u32 s20, s21, 12288
    buffer_load_dwordx4 v[116:119], v1, s[4:7], s20 offen offset:3072 sc1
    v_mov_b32 v172, 0x3f803f80
    v_mov_b32 v173, 0x3f803f80
    v_mov_b32 v174, 0x3f803f80
    v_mov_b32 v175, 0x3f803f80
    v_mov_b32 v176, 0x3f003f00
    v_mov_b32 v177, 0x3f003f00
    s_waitcnt vmcnt(8)
    v_mfma_f32_16x16x32_bf16 v[136:139], v[40:43], v[8:11], 0
    v_mfma_f32_16x16x32_bf16 v[140:143], v[56:59], v[8:11], 0
    v_mfma_f32_16x16x32_bf16 v[148:151], v[40:43], v[24:27], 0
    v_mfma_f32_16x16x32_bf16 v[152:155], v[56:59], v[24:27], 0
    v_mfma_f32_16x16x32_bf16 v[136:139], v[44:47], v[12:15], v[136:139]
    v_mfma_f32_16x16x32_bf16 v[140:143], v[60:63], v[12:15], v[140:143]
    v_mfma_f32_16x16x32_bf16 v[148:151], v[44:47], v[28:31], v[148:151]
    v_mfma_f32_16x16x32_bf16 v[152:155], v[60:63], v[28:31], v[152:155]
    v_mfma_f32_16x16x32_bf16 v[136:139], v[48:51], v[16:19], v[136:139]
    v_mfma_f32_16x16x32_bf16 v[140:143], v[64:67], v[16:19], v[140:143]
    v_mfma_f32_16x16x32_bf16 v[148:151], v[48:51], v[32:35], v[148:151]
    v_mfma_f32_16x16x32_bf16 v[152:155], v[64:67], v[32:35], v[152:155]
    v_mfma_f32_16x16x32_bf16 v[136:139], v[52:55], v[20:23], v[136:139]
    v_mfma_f32_16x16x32_bf16 v[140:143], v[68:71], v[20:23], v[140:143]
    v_mfma_f32_16x16x32_bf16 v[148:151], v[52:55], v[36:39], v[148:151]
    v_mfma_f32_16x16x32_bf16 v[152:155], v[68:71], v[36:39], v[152:155]
    v_cmp_le_i32 vcc, 0, v4
    s_nop 1
    v_cndmask_b32 v136, v6, v136, vcc
    v_cmp_le_i32 vcc, 1, v4
    s_nop 1
    v_cndmask_b32 v137, v6, v137, vcc
    v_cmp_le_i32 vcc, 2, v4
    s_nop 1
    v_cndmask_b32 v138, v6, v138, vcc
    v_cmp_le_i32 vcc, 3, v4
    s_nop 1
    v_cndmask_b32 v139, v6, v139, vcc
    v_cmp_le_i32 vcc, 4, v4
    s_nop 1
    v_cndmask_b32 v140, v6, v140, vcc
    v_cmp_le_i32 vcc, 5, v4
    s_nop 1
    v_cndmask_b32 v141, v6, v141, vcc
    v_cmp_le_i32 vcc, 6, v4
    s_nop 1
    v_cndmask_b32 v142, v6, v142, vcc
    v_cmp_le_i32 vcc, 7, v4
    s_nop 1
    v_cndmask_b32 v143, v6, v143, vcc
    v_cmp_le_i32 vcc, -4, v4
    s_nop 1
    v_cndmask_b32 v148, v6, v148, vcc
    v_cmp_le_i32 vcc, -3, v4
    s_nop 1
    v_cndmask_b32 v149, v6, v149, vcc
    v_cmp_le_i32 vcc, -2, v4
    s_nop 1
    v_cndmask_b32 v150, v6, v150, vcc
    v_cmp_le_i32 vcc, -1, v4
    s_nop 1
    v_cndmask_b32 v151, v6, v151, vcc
    v_cmp_le_i32 vcc, 0, v4
    s_nop 1
    v_cndmask_b32 v152, v6, v152, vcc
    v_cmp_le_i32 vcc, 1, v4
    s_nop 1
    v_cndmask_b32 v153, v6, v153, vcc
    v_cmp_le_i32 vcc, 2, v4
    s_nop 1
    v_cndmask_b32 v154, v6, v154, vcc
    v_cmp_le_i32 vcc, 3, v4
    s_nop 1
    v_cndmask_b32 v155, v6, v155, vcc
    s_nop 1
    s_mov_b32 s88, 65536
cw14:
    buffer_load_dword v199, off, s[4:7], s36 offset:128 sc1
    s_waitcnt vmcnt(0)
    v_readfirstlane_b32 s42, v199
    s_nop 0
    s_sub_u32 s42, s42, s95
    s_cmp_gt_u32 s42, 64
    s_cselect_b32 s42, 0, s42
    s_add_u32 s42, s42, 2
    s_cmp_ge_u32 s42, s16
    s_cbranch_scc1 cw14x
    s_sub_u32 s88, s88, 1
    s_cbranch_scc1 cw14x
    s_sub_u32 s42, s16, s42
    s_min_u32 s42, s42, 6
cw14s:
    s_sleep 24
    s_sub_u32 s42, s42, 1
    s_cmp_lg_u32 s42, 0
    s_cbranch_scc1 cw14s
    s_branch cw14
cw14x:
    s_and_b32 s37, s16, 1
    s_lshl_b32 s37, s37, 2
    s_add_u32 s37, s37, s36
    s_add_u32 s37, s37, 128
    s_add_u32 s41, s16, s95
    s_add_u32 s41, s41, 1
    s_lshl_b32 s42, s17, 7
    s_add_u32 s42, s42, 125845504
    s_cmp_ge_u32 s16, 62
    s_cselect_b32 s37, s42, s37
    s_cselect_b32 s42, 12, 8
    v_lshlrev_b32 v198, 2, v0
    v_and_b32 v198, s42, v198
    s_mov_b32 s40, 4194304
L_aw2:
    buffer_load_dword v199, v198, s[4:7], s37 offen sc1
    s_sub_u32 s40, s40, 1
    s_cbranch_scc1 L_aw2_go
    s_waitcnt vmcnt(0)
    v_subrev_u32 v199, s41, v199
    v_cmp_lt_u32 vcc, 64, v199
    s_cbranch_vccz L_aw2_go
    s_sleep 1
    s_branch L_aw2
L_aw2_go:
    s_mov_b32 s21, 4096
at_again:
    s_lshl_b32 s20, s18, 12
    s_add_u32 s20, s20, 71303168
    buffer_load_dwordx4 v[72:75], v3, s[4:7], s20 offen offset:0 sc1
    buffer_load_dwordx4 v[76:79], v3, s[4:7], s20 offen offset:1024 sc1
    buffer_load_dwordx4 v[80:83], v3, s[4:7], s20 offen offset:2048 sc1
    buffer_load_dwordx4 v[84:87], v3, s[4:7], s20 offen offset:3072 sc1
    s_lshl_b32 s20, s18, 12
    s_add_u32 s20, s20, 80740352
    buffer_load_dwordx4 v[120:123], v1, s[4:7], s20 offen offset:0 sc1
    buffer_load_dwordx4 v[124:127], v1, s[4:7], s20 offen offset:1024 sc1
    buffer_load_dwordx4 v[128:131], v1, s[4:7], s20 offen offset:2048 sc1
    buffer_load_dwordx4 v[132:135], v1, s[4:7], s20 offen offset:3072 sc1
    s_waitcnt vmcnt(4)
    v_mfma_f32_16x16x32_bf16 v[144:147], v[72:75], v[8:11], 0
    v_mfma_f32_16x16x32_bf16 v[156:159], v[72:75], v[24:27], 0
    v_mfma_f32_16x16x32_bf16 v[144:147], v[76:79], v[12:15], v[144:147]
    v_mfma_f32_16x16x32_bf16 v[156:159], v[76:79], v[28:31], v[156:159]
    v_mfma_f32_16x16x32_bf16 v[144:147], v[80:83], v[16:19], v[144:147]
    v_mfma_f32_16x16x32_bf16 v[156:159], v[80:83], v[32:35], v[156:159]
    v_mfma_f32_16x16x32_bf16 v[144:147], v[84:87], v[20:23], v[144:147]
    v_mfma_f32_16x16x32_bf16 v[156:159], v[84:87], v[36:39], v[156:159]
    v_max3_u32 v196, v72, v76, v80
    s_waitcnt vmcnt(0)
    v_max3_u32 v196, v196, v84, v120
    v_max3_u32 v196, v196, v124, v128
    v_max_u32 v196, v196, v132
    v_cmp_eq_u32 vcc, -1, v196
    s_sub_u32 s21, s21, 1
    s_nop 3
    s_cbranch_scc1 at_ok
    s_cbranch_vccnz at_again
at_ok:
    v_max3_f32 v196, v136, v137, v138
    v_max3_f32 v197, v139, v140, v141
    v_max3_f32 v196, v196, v142, v143
    v_max3_f32 v197, v197, v144, v145
    v_max3_f32 v196, v196, v146, v147
    v_max_f32 v196, v196, v197
    v_mov_b32 v197, v196
    s_nop 1
    v_permlane32_swap_b32 v196, v197
    v_max_f32 v196, v196, v197
    v_mov_b32 v197, v196
    s_nop 1
    v_permlane16_swap_b32 v196, v197
    v_max_f32 v196, v196, v197
    v_mul_f32 v196, s22, v196
    v_sub_f32 v196, 0, v196
    v_fma_f32 v136, v136, s22, v196
    v_fma_f32 v137, v137, s22, v196
    v_fma_f32 v138, v138, s22, v196
    v_fma_f32 v139, v139, s22, v196
    v_fma_f32 v140, v140, s22, v196
    v_fma_f32 v141, v141, s22, v196
    v_fma_f32 v142, v142, s22, v196
    v_fma_f32 v143, v143, s22, v196
    v_fma_f32 v144, v144, s22, v196
    v_fma_f32 v145, v145, s22, v196
    v_fma_f32 v146, v146, s22, v196
    v_fma_f32 v147, v147, s22, v196
    v_exp_f32 v136, v136
    v_exp_f32 v137, v137
    v_exp_f32 v138, v138
    v_exp_f32 v139, v139
    v_exp_f32 v140, v140
    v_exp_f32 v141, v141
    v_exp_f32 v142, v142
    v_exp_f32 v143, v143
    v_exp_f32 v144, v144
    v_exp_f32 v145, v145
    v_exp_f32 v146, v146
    v_exp_f32 v147, v147
    v_cvt_pk_bf16_f32 v160, v136, v137
    v_cvt_pk_bf16_f32 v161, v138, v139
    v_cvt_pk_bf16_f32 v162, v140, v141
    v_cvt_pk_bf16_f32 v163, v142, v143
    v_cvt_pk_bf16_f32 v164, v144, v145
    v_cvt_pk_bf16_f32 v165, v146, v147
    v_max3_f32 v196, v148, v149, v150
    v_max3_f32 v197, v151, v152, v153
    v_max3_f32 v196, v196, v154, v155
    v_max3_f32 v197, v197, v156, v157
    v_max3_f32 v196, v196, v158, v159
    v_max_f32 v196, v196, v197
    v_mov_b32 v197, v196
    s_nop 1
    v_permlane32_swap_b32 v196, v197
    v_max_f32 v196, v196, v197
    v_mov_b32 v197, v196
    s_nop 1
    v_permlane16_swap_b32 v196, v197
    v_max_f32 v196, v196, v197
    v_mul_f32 v196, s22, v196
    v_sub_f32 v196, 0, v196
    v_fma_f32 v148, v148, s22, v196
    v_fma_f32 v149, v149, s22, v196
    v_fma_f32 v150, v150, s22, v196
    v_fma_f32 v151, v151, s22, v196
    v_fma_f32 v152, v152, s22, v196
    v_fma_f32 v153, v153, s22, v196
    v_fma_f32 v154, v154, s22, v196
    v_fma_f32 v155, v155, s22, v196
    v_fma_f32 v156, v156, s22, v196
    v_fma_f32 v157, v157, s22, v196
    v_fma_f32 v158, v158, s22, v196
    v_fma_f32 v159, v159, s22, v196
    v_exp_f32 v148, v148
    v_exp_f32 v149, v149
    v_exp_f32 v150, v150
    v_exp_f32 v151, v151
    v_exp_f32 v152, v152
    v_exp_f32 v153, v153
    v_exp_f32 v154, v154
    v_exp_f32 v155, v155
    v_exp_f32 v156, v156
    v_exp_f32 v157, v157
    v_exp_f32 v158, v158
    v_exp_f32 v159, v159
    v_cvt_pk_bf16_f32 v166, v148, v149
    v_cvt_pk_bf16_f32 v167, v150, v151
    v_cvt_pk_bf16_f32 v168, v152, v153
    v_cvt_pk_bf16_f32 v169, v154, v155
    v_cvt_pk_bf16_f32 v170, v156, v157
    v_cvt_pk_bf16_f32 v171, v158, v159
    v_mfma_f32_16x16x32_bf16 v[180:183], v[172:175], v[160:163], 0
    v_mfma_f32_16x16x32_bf16 v[184:187], v[172:175], v[166:169], 0
    v_mfma_f32_16x16x16_bf16 v[180:183], v[176:177], v[164:165], v[180:183]
    v_mfma_f32_16x16x16_bf16 v[184:187], v[176:177], v[170:171], v[184:187]
    s_nop 3
    v_rcp_f32 v180, v180
    s_nop 2
    v_rcp_f32 v184, v184
    s_waitcnt vmcnt(0)
    s_lshl_b32 s18, s16, 18
    s_lshl_b32 s19, s17, 12
    s_add_u32 s18, s18, s19
    s_add_u32 s18, s18, 50331648
    s_add_u32 s19, s18, 131072
    v_mfma_f32_16x16x32_bf16 v[8:11], v[88:91], v[160:163], 0
    v_mfma_f32_16x16x32_bf16 v[12:15], v[104:107], v[160:163], 0
    v_mfma_f32_16x16x32_bf16 v[16:19], v[88:91], v[166:169], 0
    v_mfma_f32_16x16x32_bf16 v[20:23], v[104:107], v[166:169], 0
    v_mfma_f32_16x16x32_bf16 v[24:27], v[92:95], v[160:163], 0
    v_mfma_f32_16x16x32_bf16 v[28:31], v[108:111], v[160:163], 0
    v_mfma_f32_16x16x32_bf16 v[32:35], v[92:95], v[166:169], 0
    v_mfma_f32_16x16x32_bf16 v[36:39], v[108:111], v[166:169], 0
    v_mfma_f32_16x16x32_bf16 v[40:43], v[96:99], v[160:163], 0
    v_mfma_f32_16x16x32_bf16 v[44:47], v[112:115], v[160:163], 0
    v_mfma_f32_16x16x32_bf16 v[48:51], v[96:99], v[166:169], 0
    v_mfma_f32_16x16x32_bf16 v[52:55], v[112:115], v[166:169], 0
    v_mfma_f32_16x16x32_bf16 v[56:59], v[100:103], v[160:163], 0
    v_mfma_f32_16x16x32_bf16 v[60:63], v[116:119], v[160:163], 0
    v_mfma_f32_16x16x32_bf16 v[64:67], v[100:103], v[166:169], 0
    v_mfma_f32_16x16x32_bf16 v[68:71], v[116:119], v[166:169], 0
    v_mfma_f32_16x16x16_bf16 v[8:11], v[120:121], v[164:165], v[8:11]
    v_mfma_f32_16x16x16_bf16 v[12:15], v[122:123], v[164:165], v[12:15]
    v_mfma_f32_16x16x16_bf16 v[16:19], v[120:121], v[170:171], v[16:19]
    v_mfma_f32_16x16x16_bf16 v[20:23], v[122:123], v[170:171], v[20:23]
    v_mfma_f32_16x16x16_bf16 v[24:27], v[124:125], v[164:165], v[24:27]
    v_mfma_f32_16x16x16_bf16 v[28:31], v[126:127], v[164:165], v[28:31]
    v_mfma_f32_16x16x16_bf16 v[32:35], v[124:125], v[170:171], v[32:35]
    v_mfma_f32_16x16x16_bf16 v[36:39], v[126:127], v[170:171], v[36:39]
    v_mfma_f32_16x16x16_bf16 v[40:43], v[128:129], v[164:165], v[40:43]
    v_mfma_f32_16x16x16_bf16 v[44:47], v[130:131], v[164:165], v[44:47]
    v_mfma_f32_16x16x16_bf16 v[48:51], v[128:129], v[170:171], v[48:51]
    v_mfma_f32_16x16x16_bf16 v[52:55], v[130:131], v[170:171], v[52:55]
    v_mfma_f32_16x16x16_bf16 v[56:59], v[132:133], v[164:165], v[56:59]
    v_mfma_f32_16x16x16_bf16 v[60:63], v[134:135], v[164:165], v[60:63]
    v_mfma_f32_16x16x16_bf16 v[64:67], v[132:133], v[170:171], v[64:67]
    v_mfma_f32_16x16x16_bf16 v[68:71], v[134:135], v[170:171], v[68:71]
    v_mul_f32 v8, v8, v180
    v_mul_f32 v12, v12, v180
    v_mul_f32 v9, v9, v180
    v_mul_f32 v13, v13, v180
    v_mul_f32 v10, v10, v180
    v_mul_f32 v14, v14, v180
    v_mul_f32 v11, v11, v180
    v_mul_f32 v15, v15, v180
    v_cvt_pk_bf16_f32 v8, v8, v9
    v_cvt_pk_bf16_f32 v9, v10, v11
    v_cvt_pk_bf16_f32 v10, v12, v13
    v_cvt_pk_bf16_f32 v11, v14, v15
    buffer_store_dwordx4 v[8:11], v1, s[4:7], s18 offen offset:0 sc1
    v_mul_f32 v16, v16, v184
    v_mul_f32 v20, v20, v184
    v_mul_f32 v17, v17, v184
    v_mul_f32 v21, v21, v184
    v_mul_f32 v18, v18, v184
    v_mul_f32 v22, v22, v184
    v_mul_f32 v19, v19, v184
    v_mul_f32 v23, v23, v184
    v_cvt_pk_bf16_f32 v16, v16, v17
    v_cvt_pk_bf16_f32 v17, v18, v19
    v_cvt_pk_bf16_f32 v18, v20, v21
    v_cvt_pk_bf16_f32 v19, v22, v23
    buffer_store_dwordx4 v[16:19], v1, s[4:7], s19 offen offset:0 sc1
    v_mul_f32 v24, v24, v180
    v_mul_f32 v28, v28, v180
    v_mul_f32 v25, v25, v180
    v_mul_f32 v29, v29, v180
    v_mul_f32 v26, v26, v180
    v_mul_f32 v30, v30, v180
    v_mul_f32 v27, v27, v180
    v_mul_f32 v31, v31, v180
    v_cvt_pk_bf16_f32 v24, v24, v25
    v_cvt_pk_bf16_f32 v25, v26, v27
    v_cvt_pk_bf16_f32 v26, v28, v29
    v_cvt_pk_bf16_f32 v27, v30, v31
    buffer_store_dwordx4 v[24:27], v1, s[4:7], s18 offen offset:1024 sc1
    v_mul_f32 v32, v32, v184
    v_mul_f32 v36, v36, v184
    v_mul_f32 v33, v33, v184
    v_mul_f32 v37, v37, v184
    v_mul_f32 v34, v34, v184
    v_mul_f32 v38, v38, v184
    v_mul_f32 v35, v35, v184
    v_mul_f32 v39, v39, v184
    v_cvt_pk_bf16_f32 v32, v32, v33
    v_cvt_pk_bf16_f32 v33, v34, v35
    v_cvt_pk_bf16_f32 v34, v36, v37
    v_cvt_pk_bf16_f32 v35, v38, v39
    buffer_store_dwordx4 v[32:35], v1, s[4:7], s19 offen offset:1024 sc1
    v_mul_f32 v40, v40, v180
    v_mul_f32 v44, v44, v180
    v_mul_f32 v41, v41, v180
    v_mul_f32 v45, v45, v180
    v_mul_f32 v42, v42, v180
    v_mul_f32 v46, v46, v180
    v_mul_f32 v43, v43, v180
    v_mul_f32 v47, v47, v180
    v_cvt_pk_bf16_f32 v40, v40, v41
    v_cvt_pk_bf16_f32 v41, v42, v43
    v_cvt_pk_bf16_f32 v42, v44, v45
    v_cvt_pk_bf16_f32 v43, v46, v47
    buffer_store_dwordx4 v[40:43], v1, s[4:7], s18 offen offset:2048 sc1
    v_mul_f32 v48, v48, v184
    v_mul_f32 v52, v52, v184
    v_mul_f32 v49, v49, v184
    v_mul_f32 v53, v53, v184
    v_mul_f32 v50, v50, v184
    v_mul_f32 v54, v54, v184
    v_mul_f32 v51, v51, v184
    v_mul_f32 v55, v55, v184
    v_cvt_pk_bf16_f32 v48, v48, v49
    v_cvt_pk_bf16_f32 v49, v50, v51
    v_cvt_pk_bf16_f32 v50, v52, v53
    v_cvt_pk_bf16_f32 v51, v54, v55
    buffer_store_dwordx4 v[48:51], v1, s[4:7], s19 offen offset:2048 sc1
    v_mul_f32 v56, v56, v180
    v_mul_f32 v60, v60, v180
    v_mul_f32 v57, v57, v180
    v_mul_f32 v61, v61, v180
    v_mul_f32 v58, v58, v180
    v_mul_f32 v62, v62, v180
    v_mul_f32 v59, v59, v180
    v_mul_f32 v63, v63, v180
    v_cvt_pk_bf16_f32 v56, v56, v57
    v_cvt_pk_bf16_f32 v57, v58, v59
    v_cvt_pk_bf16_f32 v58, v60, v61
    v_cvt_pk_bf16_f32 v59, v62, v63
    buffer_store_dwordx4 v[56:59], v1, s[4:7], s18 offen offset:3072 sc1
    v_mul_f32 v64, v64, v184
    v_mul_f32 v68, v68, v184
    v_mul_f32 v65, v65, v184
    v_mul_f32 v69, v69, v184
    v_mul_f32 v66, v66, v184
    v_mul_f32 v70, v70, v184
    v_mul_f32 v67, v67, v184
    v_mul_f32 v71, v71, v184
    v_cvt_pk_bf16_f32 v64, v64, v65
    v_cvt_pk_bf16_f32 v65, v66, v67
    v_cvt_pk_bf16_f32 v66, v68, v69
    v_cvt_pk_bf16_f32 v67, v70, v71
    buffer_store_dwordx4 v[64:67], v1, s[4:7], s19 offen offset:3072 sc1
    s_lshr_b32 s40, s34, 1
    s_lshl_b32 s40, s40, 7
    s_and_b32 s41, s17, 7
    s_lshl_b32 s41, s41, 2
    s_add_u32 s40, s40, s41
    s_add_u32 s40, s40, 125894656
    v_mov_b32 v250, s95
    s_cmp_ge_u32 s16, 62
    s_cbranch_scc1 L_afl
    s_waitcnt vmcnt(0)
L_afl:
    s_mov_b64 exec, 1
    buffer_store_dword v250, off, s[4:7], s40 sc1
    s_mov_b64 exec, -1
    s_add_u32 s34, s34, 32
    s_cmp_lt_u32 s34, 512
    s_cbranch_scc1 L_att_next
    s_branch L_done
L_op_start:
    s_mov_b32 s16, s33
    s_mov_b32 s33, s34
    v_and_b32 v2, 63, v0
    v_lshlrev_b32 v1, 4, v2
    v_lshrrev_b32 v5, 2, v2
    v_mul_u32_u24 v3, 1152, v5
    v_and_b32 v5, 3, v2
    v_lshl_add_u32 v3, v5, 4, v3
    s_lshl_b32 s21, s32, 12
    v_add_u32 v4, s21, v1
    s_mov_b64 s[12:13], s[58:59]
    s_mov_b32 s14, 4718592
    s_mov_b32 s15, 0x20000
    s_mul_i32 s19, s32, 1179648
    s_lshl_b32 s18, s33, 6
    s_add_u32 s19, s19, s18
    s_add_u32 s18, s19, 0
    s_add_u32 m0, s21, 0
    s_nop 0
    buffer_load_dwordx4 v3, s[12:15], s18 offen lds
    s_add_u32 m0, s21, 1024
    s_add_u32 s18, s18, 18432
    buffer_load_dwordx4 v3, s[12:15], s18 offen lds
    s_add_u32 m0, s21, 2048
    s_add_u32 s18, s18, 18432
    buffer_load_dwordx4 v3, s[12:15], s18 offen lds
    s_add_u32 m0, s21, 3072
    s_add_u32 s18, s18, 18432
    buffer_load_dwordx4 v3, s[12:15], s18 offen lds
    s_add_u32 s18, s19, 73728
    s_add_u32 m0, s21, 16384
    s_nop 0
    buffer_load_dwordx4 v3, s[12:15], s18 offen lds
    s_add_u32 m0, s21, 17408
    s_add_u32 s18, s18, 18432
    buffer_load_dwordx4 v3, s[12:15], s18 offen lds
    s_add_u32 m0, s21, 18432
    s_add_u32 s18, s18, 18432
    buffer_load_dwordx4 v3, s[12:15], s18 offen lds
    s_add_u32 m0, s21, 19456
    s_add_u32 s18, s18, 18432
    buffer_load_dwordx4 v3, s[12:15], s18 offen lds
    s_add_u32 s18, s19, 147456
    s_add_u32 m0, s21, 32768
    s_nop 0
    buffer_load_dwordx4 v3, s[12:15], s18 offen lds
    s_add_u32 m0, s21, 33792
    s_add_u32 s18, s18, 18432
    buffer_load_dwordx4 v3, s[12:15], s18 offen lds
    s_add_u32 m0, s21, 34816
    s_add_u32 s18, s18, 18432
    buffer_load_dwordx4 v3, s[12:15], s18 offen lds
    s_add_u32 m0, s21, 35840
    s_add_u32 s18, s18, 18432
    buffer_load_dwordx4 v3, s[12:15], s18 offen lds
    s_add_u32 s18, s19, 221184
    s_add_u32 m0, s21, 49152
    s_nop 0
    buffer_load_dwordx4 v3, s[12:15], s18 offen lds
    s_add_u32 m0, s21, 50176
    s_add_u32 s18, s18, 18432
    buffer_load_dwordx4 v3, s[12:15], s18 offen lds
    s_add_u32 m0, s21, 51200
    s_add_u32 s18, s18, 18432
    buffer_load_dwordx4 v3, s[12:15], s18 offen lds
    s_add_u32 m0, s21, 52224
    s_add_u32 s18, s18, 18432
    buffer_load_dwordx4 v3, s[12:15], s18 offen lds
    s_add_u32 s18, s19, 294912
    s_add_u32 m0, s21, 65536
    s_nop 0
    buffer_load_dwordx4 v3, s[12:15], s18 offen lds
    s_add_u32 m0, s21, 66560
    s_add_u32 s18, s18, 18432
    buffer_load_dwordx4 v3, s[12:15], s18 offen lds
    s_add_u32 m0, s21, 67584
    s_add_u32 s18, s18, 18432
    buffer_load_dwordx4 v3, s[12:15], s18 offen lds
    s_add_u32 m0, s21, 68608
    s_add_u32 s18, s18, 18432
    buffer_load_dwordx4 v3, s[12:15], s18 offen lds
    s_add_u32 s18, s19, 368640
    s_add_u32 m0, s21, 81920
    s_nop 0
    buffer_load_dwordx4 v3, s[12:15], s18 offen lds
    s_add_u32 m0, s21, 82944
    s_add_u32 s18, s18, 18432
    buffer_load_dwordx4 v3, s[12:15], s18 offen lds
    s_add_u32 m0, s21, 83968
    s_add_u32 s18, s18, 18432
    buffer_load_dwordx4 v3, s[12:15], s18 offen lds
    s_add_u32 m0, s21, 84992
    s_add_u32 s18, s18, 18432
    buffer_load_dwordx4 v3, s[12:15], s18 offen lds
    s_add_u32 s18, s19, 442368
    s_add_u32 m0, s21, 98304
    s_nop 0
    buffer_load_dwordx4 v3, s[12:15], s18 offen lds
    s_add_u32 m0, s21, 99328
    s_add_u32 s18, s18, 18432
    buffer_load_dwordx4 v3, s[12:15], s18 offen lds
    s_add_u32 m0, s21, 100352
    s_add_u32 s18, s18, 18432
    buffer_load_dwordx4 v3, s[12:15], s18 offen lds
    s_add_u32 m0, s21, 101376
    s_add_u32 s18, s18, 18432
    buffer_load_dwordx4 v3, s[12:15], s18 offen lds
    s_add_u32 s18, s19, 516096
    s_add_u32 m0, s21, 114688
    s_nop 0
    buffer_load_dwordx4 v3, s[12:15], s18 offen lds
    s_add_u32 m0, s21, 115712
    s_add_u32 s18, s18, 18432
    buffer_load_dwordx4 v3, s[12:15], s18 offen lds
    s_add_u32 m0, s21, 116736
    s_add_u32 s18, s18, 18432
    buffer_load_dwordx4 v3, s[12:15], s18 offen lds
    s_add_u32 m0, s21, 117760
    s_add_u32 s18, s18, 18432
    buffer_load_dwordx4 v3, s[12:15], s18 offen lds
    s_add_u32 s18, s19, 589824
    s_add_u32 m0, s21, 131072
    s_nop 0
    buffer_load_dwordx4 v3, s[12:15], s18 offen lds
    s_add_u32 m0, s21, 132096
    s_add_u32 s18, s18, 18432
    buffer_load_dwordx4 v3, s[12:15], s18 offen lds
    s_add_u32 m0, s21, 133120
    s_add_u32 s18, s18, 18432
    buffer_load_dwordx4 v3, s[12:15], s18 offen lds
    s_add_u32 m0, s21, 134144
    s_add_u32 s18, s18, 18432
    buffer_load_dwordx4 v3, s[12:15], s18 offen lds
    v_add_u32 v6, 0, v4
    v_xor_b32 v7, 32, v6
    s_waitcnt vmcnt(32)
    ds_read_b64_tr_b16 a[0:1], v6 offset:0
    ds_read_b64_tr_b16 a[2:3], v6 offset:1024
    ds_read_b64_tr_b16 a[4:5], v6 offset:8
    ds_read_b64_tr_b16 a[6:7], v6 offset:1032
    ds_read_b64_tr_b16 a[8:9], v6 offset:2048
    ds_read_b64_tr_b16 a[10:11], v6 offset:3072
    ds_read_b64_tr_b16 a[12:13], v6 offset:2056
    ds_read_b64_tr_b16 a[14:15], v6 offset:3080
    s_waitcnt lgkmcnt(0)
    s_add_u32 s18, s19, 663552
    s_add_u32 m0, s21, 0
    s_nop 0
    buffer_load_dwordx4 v3, s[12:15], s18 offen lds
    s_add_u32 m0, s21, 1024
    s_add_u32 s18, s18, 18432
    buffer_load_dwordx4 v3, s[12:15], s18 offen lds
    s_add_u32 m0, s21, 2048
    s_add_u32 s18, s18, 18432
    buffer_load_dwordx4 v3, s[12:15], s18 offen lds
    s_add_u32 m0, s21, 3072
    s_add_u32 s18, s18, 18432
    buffer_load_dwordx4 v3, s[12:15], s18 offen lds
    v_add_u32 v6, 16384, v4
    v_xor_b32 v7, 32, v6
    s_waitcnt vmcnt(32)
    ds_read_b64_tr_b16 a[16:17], v6 offset:0
    ds_read_b64_tr_b16 a[18:19], v6 offset:1024
    ds_read_b64_tr_b16 a[20:21], v6 offset:8
    ds_read_b64_tr_b16 a[22:23], v6 offset:1032
    ds_read_b64_tr_b16 a[24:25], v6 offset:2048
    ds_read_b64_tr_b16 a[26:27], v6 offset:3072
    ds_read_b64_tr_b16 a[28:29], v6 offset:2056
    ds_read_b64_tr_b16 a[30:31], v6 offset:3080
    s_waitcnt lgkmcnt(0)
    s_add_u32 s18, s19, 737280
    s_add_u32 m0, s21, 16384
    s_nop 0
    buffer_load_dwordx4 v3, s[12:15], s18 offen lds
    s_add_u32 m0, s21, 17408
    s_add_u32 s18, s18, 18432
    buffer_load_dwordx4 v3, s[12:15], s18 offen lds
    s_add_u32 m0, s21, 18432
    s_add_u32 s18, s18, 18432
    buffer_load_dwordx4 v3, s[12:15], s18 offen lds
    s_add_u32 m0, s21, 19456
    s_add_u32 s18, s18, 18432
    buffer_load_dwordx4 v3, s[12:15], s18 offen lds
    v_add_u32 v6, 32768, v4
    v_xor_b32 v7, 32, v6
    s_waitcnt vmcnt(32)
    ds_read_b64_tr_b16 a[32:33], v6 offset:0
    ds_read_b64_tr_b16 a[34:35], v6 offset:1024
    ds_read_b64_tr_b16 a[36:37], v6 offset:8
    ds_read_b64_tr_b16 a[38:39], v6 offset:1032
    ds_read_b64_tr_b16 a[40:41], v6 offset:2048
    ds_read_b64_tr_b16 a[42:43], v6 offset:3072
    ds_read_b64_tr_b16 a[44:45], v6 offset:2056
    ds_read_b64_tr_b16 a[46:47], v6 offset:3080
    s_waitcnt lgkmcnt(0)
    s_add_u32 s18, s19, 811008
    s_add_u32 m0, s21, 32768
    s_nop 0
    buffer_load_dwordx4 v3, s[12:15], s18 offen lds
    s_add_u32 m0, s21, 33792
    s_add_u32 s18, s18, 18432
    buffer_load_dwordx4 v3, s[12:15], s18 offen lds
    s_add_u32 m0, s21, 34816
    s_add_u32 s18, s18, 18432
    buffer_load_dwordx4 v3, s[12:15], s18 offen lds
    s_add_u32 m0, s21, 35840
    s_add_u32 s18, s18, 18432
    buffer_load_dwordx4 v3, s[12:15], s18 offen lds
    v_add_u32 v6, 49152, v4
    v_xor_b32 v7, 32, v6
    s_waitcnt vmcnt(32)
    ds_read_b64_tr_b16 a[48:49], v6 offset:0
    ds_read_b64_tr_b16 a[50:51], v6 offset:1024
    ds_read_b64_tr_b16 a[52:53], v6 offset:8
    ds_read_b64_tr_b16 a[54:55], v6 offset:1032
    ds_read_b64_tr_b16 a[56:57], v6 offset:2048
    ds_read_b64_tr_b16 a[58:59], v6 offset:3072
    ds_read_b64_tr_b16 a[60:61], v6 offset:2056
    ds_read_b64_tr_b16 a[62:63], v6 offset:3080
    s_waitcnt lgkmcnt(0)
    s_add_u32 s18, s19, 884736
    s_add_u32 m0, s21, 49152
    s_nop 0
    buffer_load_dwordx4 v3, s[12:15], s18 offen lds
    s_add_u32 m0, s21, 50176
    s_add_u32 s18, s18, 18432
    buffer_load_dwordx4 v3, s[12:15], s18 offen lds
    s_add_u32 m0, s21, 51200
    s_add_u32 s18, s18, 18432
    buffer_load_dwordx4 v3, s[12:15], s18 offen lds
    s_add_u32 m0, s21, 52224
    s_add_u32 s18, s18, 18432
    buffer_load_dwordx4 v3, s[12:15], s18 offen lds
    v_add_u32 v6, 65536, v4
    v_xor_b32 v7, 32, v6
    s_waitcnt vmcnt(32)
    ds_read_b64_tr_b16 a[64:65], v6 offset:0
    ds_read_b64_tr_b16 a[66:67], v6 offset:1024
    ds_read_b64_tr_b16 a[68:69], v6 offset:8
    ds_read_b64_tr_b16 a[70:71], v6 offset:1032
    ds_read_b64_tr_b16 a[72:73], v6 offset:2048
    ds_read_b64_tr_b16 a[74:75], v6 offset:3072
    ds_read_b64_tr_b16 a[76:77], v6 offset:2056
    ds_read_b64_tr_b16 a[78:79], v6 offset:3080
    s_waitcnt lgkmcnt(0)
    s_add_u32 s18, s19, 958464
    s_add_u32 m0, s21, 65536
    s_nop 0
    buffer_load_dwordx4 v3, s[12:15], s18 offen lds
    s_add_u32 m0, s21, 66560
    s_add_u32 s18, s18, 18432
    buffer_load_dwordx4 v3, s[12:15], s18 offen lds
    s_add_u32 m0, s21, 67584
    s_add_u32 s18, s18, 18432
    buffer_load_dwordx4 v3, s[12:15], s18 offen lds
    s_add_u32 m0, s21, 68608
    s_add_u32 s18, s18, 18432
    buffer_load_dwordx4 v3, s[12:15], s18 offen lds
    v_add_u32 v6, 81920, v4
    v_xor_b32 v7, 32, v6
    s_waitcnt vmcnt(32)
    ds_read_b64_tr_b16 a[80:81], v6 offset:0
    ds_read_b64_tr_b16 a[82:83], v6 offset:1024
    ds_read_b64_tr_b16 a[84:85], v6 offset:8
    ds_read_b64_tr_b16 a[86:87], v6 offset:1032
    ds_read_b64_tr_b16 a[88:89], v6 offset:2048
    ds_read_b64_tr_b16 a[90:91], v6 offset:3072
    ds_read_b64_tr_b16 a[92:93], v6 offset:2056
    ds_read_b64_tr_b16 a[94:95], v6 offset:3080
    s_waitcnt lgkmcnt(0)
    s_add_u32 s18, s19, 1032192
    s_add_u32 m0, s21, 81920
    s_nop 0
    buffer_load_dwordx4 v3, s[12:15], s18 offen lds
    s_add_u32 m0, s21, 82944
    s_add_u32 s18, s18, 18432
    buffer_load_dwordx4 v3, s[12:15], s18 offen lds
    s_add_u32 m0, s21, 83968
    s_add_u32 s18, s18, 18432
    buffer_load_dwordx4 v3, s[12:15], s18 offen lds
    s_add_u32 m0, s21, 84992
    s_add_u32 s18, s18, 18432
    buffer_load_dwordx4 v3, s[12:15], s18 offen lds
    v_add_u32 v6, 98304, v4
    v_xor_b32 v7, 32, v6
    s_waitcnt vmcnt(32)
    ds_read_b64_tr_b16 a[96:97], v6 offset:0
    ds_read_b64_tr_b16 a[98:99], v6 offset:1024
    ds_read_b64_tr_b16 a[100:101], v6 offset:8
    ds_read_b64_tr_b16 a[102:103], v6 offset:1032
    ds_read_b64_tr_b16 a[104:105], v6 offset:2048
    ds_read_b64_tr_b16 a[106:107], v6 offset:3072
    ds_read_b64_tr_b16 a[108:109], v6 offset:2056
    ds_read_b64_tr_b16 a[110:111], v6 offset:3080
    s_waitcnt lgkmcnt(0)
    s_add_u32 s18, s19, 1105920
    s_add_u32 m0, s21, 98304
    s_nop 0
    buffer_load_dwordx4 v3, s[12:15], s18 offen lds
    s_add_u32 m0, s21, 99328
    s_add_u32 s18, s18, 18432
    buffer_load_dwordx4 v3, s[12:15], s18 offen lds
    s_add_u32 m0, s21, 100352
    s_add_u32 s18, s18, 18432
    buffer_load_dwordx4 v3, s[12:15], s18 offen lds
    s_add_u32 m0, s21, 101376
    s_add_u32 s18, s18, 18432
    buffer_load_dwordx4 v3, s[12:15], s18 offen lds
    v_add_u32 v6, 114688, v4
    v_xor_b32 v7, 32, v6
    s_waitcnt vmcnt(32)
    ds_read_b64_tr_b16 a[112:113], v6 offset:0
    ds_read_b64_tr_b16 a[114:115], v6 offset:1024
    ds_read_b64_tr_b16 a[116:117], v6 offset:8
    ds_read_b64_tr_b16 a[118:119], v6 offset:1032
    ds_read_b64_tr_b16 a[120:121], v6 offset:2048
    ds_read_b64_tr_b16 a[122:123], v6 offset:3072
    ds_read_b64_tr_b16 a[124:125], v6 offset:2056
    ds_read_b64_tr_b16 a[126:127], v6 offset:3080
    s_waitcnt lgkmcnt(0)
    v_add_u32 v6, 131072, v4
    v_xor_b32 v7, 32, v6
    s_waitcnt vmcnt(28)
    ds_read_b64_tr_b16 a[128:129], v6 offset:0
    ds_read_b64_tr_b16 a[130:131], v6 offset:1024
    ds_read_b64_tr_b16 a[132:133], v6 offset:8
    ds_read_b64_tr_b16 a[134:135], v6 offset:1032
    ds_read_b64_tr_b16 a[136:137], v6 offset:2048
    ds_read_b64_tr_b16 a[138:139], v6 offset:3072
    ds_read_b64_tr_b16 a[140:141], v6 offset:2056
    ds_read_b64_tr_b16 a[142:143], v6 offset:3080
    s_waitcnt lgkmcnt(0)
    v_add_u32 v6, 0, v4
    v_xor_b32 v7, 32, v6
    s_waitcnt vmcnt(24)
    ds_read_b64_tr_b16 a[144:145], v6 offset:0
    ds_read_b64_tr_b16 a[146:147], v6 offset:1024
    ds_read_b64_tr_b16 a[148:149], v6 offset:8
    ds_read_b64_tr_b16 a[150:151], v6 offset:1032
    ds_read_b64_tr_b16 a[152:153], v6 offset:2048
    ds_read_b64_tr_b16 a[154:155], v6 offset:3072
    ds_read_b64_tr_b16 a[156:157], v6 offset:2056
    ds_read_b64_tr_b16 a[158:159], v6 offset:3080
    s_waitcnt lgkmcnt(0)
    v_add_u32 v6, 16384, v4
    v_xor_b32 v7, 32, v6
    s_waitcnt vmcnt(20)
    ds_read_b64_tr_b16 a[160:161], v6 offset:0
    ds_read_b64_tr_b16 a[162:163], v6 offset:1024
    ds_read_b64_tr_b16 a[164:165], v6 offset:8
    ds_read_b64_tr_b16 a[166:167], v6 offset:1032
    ds_read_b64_tr_b16 a[168:169], v6 offset:2048
    ds_read_b64_tr_b16 a[170:171], v6 offset:3072
    ds_read_b64_tr_b16 a[172:173], v6 offset:2056
    ds_read_b64_tr_b16 a[174:175], v6 offset:3080
    s_waitcnt lgkmcnt(0)
    v_add_u32 v6, 32768, v4
    v_xor_b32 v7, 32, v6
    s_waitcnt vmcnt(16)
    ds_read_b64_tr_b16 a[176:177], v6 offset:0
    ds_read_b64_tr_b16 a[178:179], v6 offset:1024
    ds_read_b64_tr_b16 a[180:181], v6 offset:8
    ds_read_b64_tr_b16 a[182:183], v6 offset:1032
    ds_read_b64_tr_b16 a[184:185], v6 offset:2048
    ds_read_b64_tr_b16 a[186:187], v6 offset:3072
    ds_read_b64_tr_b16 a[188:189], v6 offset:2056
    ds_read_b64_tr_b16 a[190:191], v6 offset:3080
    s_waitcnt lgkmcnt(0)
    v_add_u32 v6, 49152, v4
    v_xor_b32 v7, 32, v6
    s_waitcnt vmcnt(12)
    ds_read_b64_tr_b16 a[192:193], v6 offset:0
    ds_read_b64_tr_b16 a[194:195], v6 offset:1024
    ds_read_b64_tr_b16 a[196:197], v6 offset:8
    ds_read_b64_tr_b16 a[198:199], v6 offset:1032
    ds_read_b64_tr_b16 a[200:201], v6 offset:2048
    ds_read_b64_tr_b16 a[202:203], v6 offset:3072
    ds_read_b64_tr_b16 a[204:205], v6 offset:2056
    ds_read_b64_tr_b16 a[206:207], v6 offset:3080
    s_waitcnt lgkmcnt(0)
    v_add_u32 v6, 65536, v4
    v_xor_b32 v7, 32, v6
    s_waitcnt vmcnt(8)
    ds_read_b64_tr_b16 a[208:209], v6 offset:0
    ds_read_b64_tr_b16 a[210:211], v6 offset:1024
    ds_read_b64_tr_b16 a[212:213], v6 offset:8
    ds_read_b64_tr_b16 a[214:215], v6 offset:1032
    ds_read_b64_tr_b16 a[216:217], v6 offset:2048
    ds_read_b64_tr_b16 a[218:219], v6 offset:3072
    ds_read_b64_tr_b16 a[220:221], v6 offset:2056
    ds_read_b64_tr_b16 a[222:223], v6 offset:3080
    s_waitcnt lgkmcnt(0)
    v_add_u32 v6, 81920, v4
    v_xor_b32 v7, 32, v6
    s_waitcnt vmcnt(4)
    ds_read_b64_tr_b16 a[224:225], v6 offset:0
    ds_read_b64_tr_b16 a[226:227], v6 offset:1024
    ds_read_b64_tr_b16 a[228:229], v6 offset:8
    ds_read_b64_tr_b16 a[230:231], v6 offset:1032
    ds_read_b64_tr_b16 a[232:233], v6 offset:2048
    ds_read_b64_tr_b16 a[234:235], v6 offset:3072
    ds_read_b64_tr_b16 a[236:237], v6 offset:2056
    ds_read_b64_tr_b16 a[238:239], v6 offset:3080
    s_waitcnt lgkmcnt(0)
    v_add_u32 v6, 98304, v4
    v_xor_b32 v7, 32, v6
    s_waitcnt vmcnt(0)
    ds_read_b64_tr_b16 a[240:241], v6 offset:0
    ds_read_b64_tr_b16 a[242:243], v6 offset:1024
    ds_read_b64_tr_b16 a[244:245], v6 offset:8
    ds_read_b64_tr_b16 a[246:247], v6 offset:1032
    ds_read_b64_tr_b16 a[248:249], v6 offset:2048
    ds_read_b64_tr_b16 a[250:251], v6 offset:3072
    ds_read_b64_tr_b16 a[252:253], v6 offset:2056
    ds_read_b64_tr_b16 a[254:255], v6 offset:3080
    s_waitcnt lgkmcnt(0)
    s_barrier
L_op_seg:
    s_lshr_b32 s43, s16, 1
    s_add_u32 s43, s43, 1
    s_min_u32 s43, s43, 63
    s_and_b32 s36, s33, 15
    s_lshl_b32 s36, s36, 8
    s_add_u32 s36, s36, 125829120
    s_lshl_b32 s94, s33, 7
    s_add_u32 s94, s94, s16
    s_cmp_ge_u32 s16, 120
    s_cbranch_scc1 L_nocw
    s_mov_b32 s88, 65536
cw15:
    buffer_load_dword v3, off, s[4:7], s36 offset:128 sc1
    s_waitcnt vmcnt(0)
    v_readfirstlane_b32 s42, v3
    s_nop 0
    s_sub_u32 s42, s42, s95
    s_cmp_gt_u32 s42, 64
    s_cselect_b32 s42, 0, s42
    s_add_u32 s42, s42, 2
    s_cmp_ge_u32 s42, s43
    s_cbranch_scc1 cw15x
    s_sub_u32 s88, s88, 1
    s_cbranch_scc1 cw15x
    s_sub_u32 s42, s43, s42
    s_min_u32 s42, s42, 6
cw15s:
    s_sleep 24
    s_sub_u32 s42, s42, 1
    s_cmp_lg_u32 s42, 0
    s_cbranch_scc1 cw15s
    s_branch cw15
cw15x:
L_nocw:
    s_lshr_b32 s89, s16, 1
    s_lshl_b32 s89, s89, 2
    s_add_u32 s89, s89, s32
    s_lshl_b32 s89, s89, 7
    s_add_u32 s89, s89, 125894656
    v_mbcnt_lo_u32_b32 v2, -1, 0
    v_mbcnt_hi_u32_b32 v2, -1, v2
    v_min_u32 v2, 7, v2
    v_lshlrev_b32 v2, 2, v2
    s_mov_b32 s88, 4194304
fw16:
    buffer_load_dword v3, v2, s[4:7], s89 offen offset:0 sc1
    s_sub_u32 s88, s88, 1
    s_cbranch_scc1 fw16x
    s_waitcnt vmcnt(0)
    v_cmp_ne_u32 vcc, s95, v3
    s_cbranch_vccz fw16x
    s_sleep 2
    s_cmp_gt_u32 s88, 4194256
    s_cbranch_scc1 fw16
    s_sleep 40
    s_branch fw16
fw16x:
    s_mov_b32 s21, 4096
os_again:
    s_lshl_b32 s18, s16, 17
    s_lshl_b32 s19, s32, 15
    s_add_u32 s18, s18, s19
    s_add_u32 s18, s18, 50331648
    buffer_load_dwordx4 v[32:35], v1, s[4:7], s18 offen offset:0 sc1
    buffer_load_dwordx4 v[36:39], v1, s[4:7], s18 offen offset:1024 sc1
    buffer_load_dwordx4 v[40:43], v1, s[4:7], s18 offen offset:2048 sc1
    buffer_load_dwordx4 v[44:47], v1, s[4:7], s18 offen offset:3072 sc1
    s_add_u32 s18, s18, 4096
    buffer_load_dwordx4 v[48:51], v1, s[4:7], s18 offen offset:0 sc1
    buffer_load_dwordx4 v[52:55], v1, s[4:7], s18 offen offset:1024 sc1
    buffer_load_dwordx4 v[56:59], v1, s[4:7], s18 offen offset:2048 sc1
    buffer_load_dwordx4 v[60:63], v1, s[4:7], s18 offen offset:3072 sc1
    s_add_u32 s18, s18, 4096
    buffer_load_dwordx4 v[64:67], v1, s[4:7], s18 offen offset:0 sc1
    buffer_load_dwordx4 v[68:71], v1, s[4:7], s18 offen offset:1024 sc1
    buffer_load_dwordx4 v[72:75], v1, s[4:7], s18 offen offset:2048 sc1
    buffer_load_dwordx4 v[76:79], v1, s[4:7], s18 offen offset:3072 sc1
    s_add_u32 s18, s18, 4096
    buffer_load_dwordx4 v[80:83], v1, s[4:7], s18 offen offset:0 sc1
    buffer_load_dwordx4 v[84:87], v1, s[4:7], s18 offen offset:1024 sc1
    buffer_load_dwordx4 v[88:91], v1, s[4:7], s18 offen offset:2048 sc1
    buffer_load_dwordx4 v[92:95], v1, s[4:7], s18 offen offset:3072 sc1
    s_add_u32 s18, s18, 4096
    buffer_load_dwordx4 v[96:99], v1, s[4:7], s18 offen offset:0 sc1
    buffer_load_dwordx4 v[100:103], v1, s[4:7], s18 offen offset:1024 sc1
    buffer_load_dwordx4 v[104:107], v1, s[4:7], s18 offen offset:2048 sc1
    buffer_load_dwordx4 v[108:111], v1, s[4:7], s18 offen offset:3072 sc1
    s_add_u32 s18, s18, 4096
    buffer_load_dwordx4 v[112:115], v1, s[4:7], s18 offen offset:0 sc1
    buffer_load_dwordx4 v[116:119], v1, s[4:7], s18 offen offset:1024 sc1
    buffer_load_dwordx4 v[120:123], v1, s[4:7], s18 offen offset:2048 sc1
    buffer_load_dwordx4 v[124:127], v1, s[4:7], s18 offen offset:3072 sc1
    s_add_u32 s18, s18, 4096
    buffer_load_dwordx4 v[128:131], v1, s[4:7], s18 offen offset:0 sc1
    buffer_load_dwordx4 v[132:135], v1, s[4:7], s18 offen offset:1024 sc1
    buffer_load_dwordx4 v[136:139], v1, s[4:7], s18 offen offset:2048 sc1
    buffer_load_dwordx4 v[140:143], v1, s[4:7], s18 offen offset:3072 sc1
    s_add_u32 s18, s18, 4096
    buffer_load_dwordx4 v[144:147], v1, s[4:7], s18 offen offset:0 sc1
    buffer_load_dwordx4 v[148:151], v1, s[4:7], s18 offen offset:1024 sc1
    buffer_load_dwordx4 v[152:155], v1, s[4:7], s18 offen offset:2048 sc1
    buffer_load_dwordx4 v[156:159], v1, s[4:7], s18 offen offset:3072 sc1
    v_lshlrev_b32 v2, 4, v0
    v_and_b32 v3, 3072, v2
    v_lshl_add_u32 v2, v3, 1, v1
    s_waitcnt vmcnt(31)
    v_mfma_f32_16x16x32_bf16 v[8:11], a[0:3], v[32:35], 0
    v_mfma_f32_16x16x32_bf16 v[12:15], a[4:7], v[32:35], 0
    v_mov_b32 v4, v32
    s_waitcnt vmcnt(30)
    v_mfma_f32_16x16x32_bf16 v[8:11], a[8:11], v[36:39], v[8:11]
    v_mfma_f32_16x16x32_bf16 v[12:15], a[12:15], v[36:39], v[12:15]
    v_max_u32 v4, v4, v36
    s_waitcnt vmcnt(29)
    v_mfma_f32_16x16x32_bf16 v[8:11], a[16:19], v[40:43], v[8:11]
    v_mfma_f32_16x16x32_bf16 v[12:15], a[20:23], v[40:43], v[12:15]
    v_max_u32 v4, v4, v40
    s_waitcnt vmcnt(28)
    v_mfma_f32_16x16x32_bf16 v[8:11], a[24:27], v[44:47], v[8:11]
    v_mfma_f32_16x16x32_bf16 v[12:15], a[28:31], v[44:47], v[12:15]
    v_max_u32 v4, v4, v44
    s_waitcnt vmcnt(27)
    v_mfma_f32_16x16x32_bf16 v[8:11], a[32:35], v[48:51], v[8:11]
    v_mfma_f32_16x16x32_bf16 v[12:15], a[36:39], v[48:51], v[12:15]
    v_max_u32 v4, v4, v48
    s_waitcnt vmcnt(26)
    v_mfma_f32_16x16x32_bf16 v[8:11], a[40:43], v[52:55], v[8:11]
    v_mfma_f32_16x16x32_bf16 v[12:15], a[44:47], v[52:55], v[12:15]
    v_max_u32 v4, v4, v52
    s_waitcnt vmcnt(25)
    v_mfma_f32_16x16x32_bf16 v[8:11], a[48:51], v[56:59], v[8:11]
    v_mfma_f32_16x16x32_bf16 v[12:15], a[52:55], v[56:59], v[12:15]
    v_max_u32 v4, v4, v56
    s_waitcnt vmcnt(24)
    v_mfma_f32_16x16x32_bf16 v[8:11], a[56:59], v[60:63], v[8:11]
    v_mfma_f32_16x16x32_bf16 v[12:15], a[60:63], v[60:63], v[12:15]
    v_max_u32 v4, v4, v60
    s_waitcnt vmcnt(23)
    v_mfma_f32_16x16x32_bf16 v[8:11], a[64:67], v[64:67], v[8:11]
    v_mfma_f32_16x16x32_bf16 v[12:15], a[68:71], v[64:67], v[12:15]
    v_max_u32 v4, v4, v64
    s_waitcnt vmcnt(22)
    v_mfma_f32_16x16x32_bf16 v[8:11], a[72:75], v[68:71], v[8:11]
    v_mfma_f32_16x16x32_bf16 v[12:15], a[76:79], v[68:71], v[12:15]
    v_max_u32 v4, v4, v68
    s_waitcnt vmcnt(21)
    v_mfma_f32_16x16x32_bf16 v[8:11], a[80:83], v[72:75], v[8:11]
    v_mfma_f32_16x16x32_bf16 v[12:15], a[84:87], v[72:75], v[12:15]
    v_max_u32 v4, v4, v72
    s_waitcnt vmcnt(20)
    v_mfma_f32_16x16x32_bf16 v[8:11], a[88:91], v[76:79], v[8:11]
    v_mfma_f32_16x16x32_bf16 v[12:15], a[92:95], v[76:79], v[12:15]
    v_max_u32 v4, v4, v76
    s_waitcnt vmcnt(19)
    v_mfma_f32_16x16x32_bf16 v[8:11], a[96:99], v[80:83], v[8:11]
    v_mfma_f32_16x16x32_bf16 v[12:15], a[100:103], v[80:83], v[12:15]
    v_max_u32 v4, v4, v80
    s_waitcnt vmcnt(18)
    v_mfma_f32_16x16x32_bf16 v[8:11], a[104:107], v[84:87], v[8:11]
    v_mfma_f32_16x16x32_bf16 v[12:15], a[108:111], v[84:87], v[12:15]
    v_max_u32 v4, v4, v84
    s_waitcnt vmcnt(17)
    v_mfma_f32_16x16x32_bf16 v[8:11], a[112:115], v[88:91], v[8:11]
    v_mfma_f32_16x16x32_bf16 v[12:15], a[116:119], v[88:91], v[12:15]
    v_max_u32 v4, v4, v88
    s_waitcnt vmcnt(16)
    v_mfma_f32_16x16x32_bf16 v[8:11], a[120:123], v[92:95], v[8:11]
    v_mfma_f32_16x16x32_bf16 v[12:15], a[124:127], v[92:95], v[12:15]
    v_max_u32 v4, v4, v92
    s_waitcnt vmcnt(15)
    v_mfma_f32_16x16x32_bf16 v[8:11], a[128:131], v[96:99], v[8:11]
    v_mfma_f32_16x16x32_bf16 v[12:15], a[132:135], v[96:99], v[12:15]
    v_max_u32 v4, v4, v96
    s_waitcnt vmcnt(14)
    v_mfma_f32_16x16x32_bf16 v[8:11], a[136:139], v[100:103], v[8:11]
    v_mfma_f32_16x16x32_bf16 v[12:15], a[140:143], v[100:103], v[12:15]
    v_max_u32 v4, v4, v100
    s_waitcnt vmcnt(13)
    v_mfma_f32_16x16x32_bf16 v[8:11], a[144:147], v[104:107], v[8:11]
    v_mfma_f32_16x16x32_bf16 v[12:15], a[148:151], v[104:107], v[12:15]
    v_max_u32 v4, v4, v104
    s_waitcnt vmcnt(12)
    v_mfma_f32_16x16x32_bf16 v[8:11], a[152:155], v[108:111], v[8:11]
    v_mfma_f32_16x16x32_bf16 v[12:15], a[156:159], v[108:111], v[12:15]
    v_max_u32 v4, v4, v108
    s_waitcnt vmcnt(11)
    v_mfma_f32_16x16x32_bf16 v[8:11], a[160:163], v[112:115], v[8:11]
    v_mfma_f32_16x16x32_bf16 v[12:15], a[164:167], v[112:115], v[12:15]
    v_max_u32 v4, v4, v112
    s_waitcnt vmcnt(10)
    v_mfma_f32_16x16x32_bf16 v[8:11], a[168:171], v[116:119], v[8:11]
    v_mfma_f32_16x16x32_bf16 v[12:15], a[172:175], v[116:119], v[12:15]
    v_max_u32 v4, v4, v116
    s_waitcnt vmcnt(9)
    v_mfma_f32_16x16x32_bf16 v[8:11], a[176:179], v[120:123], v[8:11]
    v_mfma_f32_16x16x32_bf16 v[12:15], a[180:183], v[120:123], v[12:15]
    v_max_u32 v4, v4, v120
    s_waitcnt vmcnt(8)
    v_mfma_f32_16x16x32_bf16 v[8:11], a[184:187], v[124:127], v[8:11]
    v_mfma_f32_16x16x32_bf16 v[12:15], a[188:191], v[124:127], v[12:15]
    v_max_u32 v4, v4, v124
    s_waitcnt vmcnt(7)
    v_mfma_f32_16x16x32_bf16 v[8:11], a[192:195], v[128:131], v[8:11]
    v_mfma_f32_16x16x32_bf16 v[12:15], a[196:199], v[128:131], v[12:15]
    v_max_u32 v4, v4, v128
    s_waitcnt vmcnt(6)
    v_mfma_f32_16x16x32_bf16 v[8:11], a[200:203], v[132:135], v[8:11]
    v_mfma_f32_16x16x32_bf16 v[12:15], a[204:207], v[132:135], v[12:15]
    v_max_u32 v4, v4, v132
    s_waitcnt vmcnt(5)
    v_mfma_f32_16x16x32_bf16 v[8:11], a[208:211], v[136:139], v[8:11]
    v_mfma_f32_16x16x32_bf16 v[12:15], a[212:215], v[136:139], v[12:15]
    v_max_u32 v4, v4, v136
    s_waitcnt vmcnt(4)
    v_mfma_f32_16x16x32_bf16 v[8:11], a[216:219], v[140:143], v[8:11]
    v_mfma_f32_16x16x32_bf16 v[12:15], a[220:223], v[140:143], v[12:15]
    v_max_u32 v4, v4, v140
    s_waitcnt vmcnt(3)
    v_mfma_f32_16x16x32_bf16 v[8:11], a[224:227], v[144:147], v[8:11]
    v_mfma_f32_16x16x32_bf16 v[12:15], a[228:231], v[144:147], v[12:15]
    v_max_u32 v4, v4, v144
    s_waitcnt vmcnt(2)
    v_mfma_f32_16x16x32_bf16 v[8:11], a[232:235], v[148:151], v[8:11]
    v_mfma_f32_16x16x32_bf16 v[12:15], a[236:239], v[148:151], v[12:15]
    v_max_u32 v4, v4, v148
    s_waitcnt vmcnt(1)
    v_mfma_f32_16x16x32_bf16 v[8:11], a[240:243], v[152:155], v[8:11]
    v_mfma_f32_16x16x32_bf16 v[12:15], a[244:247], v[152:155], v[12:15]
    v_max_u32 v4, v4, v152
    s_waitcnt vmcnt(0)
    v_mfma_f32_16x16x32_bf16 v[8:11], a[248:251], v[156:159], v[8:11]
    v_mfma_f32_16x16x32_bf16 v[12:15], a[252:255], v[156:159], v[12:15]
    v_max_u32 v4, v4, v156
    v_cmp_eq_u32 vcc, -1, v4
    s_sub_u32 s21, s21, 1
    s_nop 3
    s_cbranch_scc1 os_ok
    s_cbranch_vccnz os_again
os_ok:
    ds_write_b128 v2, v[8:11] offset:0
    ds_write_b128 v2, v[12:15] offset:1024
    s_waitcnt lgkmcnt(0)
    s_barrier
    s_cmp_lg_u32 s32, 0
    s_cbranch_scc1 os_skip
    ds_read_b128 v[40:43], v1 offset:2048
    ds_read_b128 v[44:47], v1 offset:3072
    ds_read_b128 v[48:51], v1 offset:4096
    ds_read_b128 v[52:55], v1 offset:5120
    ds_read_b128 v[56:59], v1 offset:6144
    ds_read_b128 v[60:63], v1 offset:7168
    v_lshrrev_b32 v3, 4, v1
    v_bfe_u32 v4, v3, 2, 2
    v_lshlrev_b32 v4, 3, v4
    v_and_b32 v2, 3, v3
    v_add_u32 v4, v4, v2
    v_mul_u32_u24 v4, 2304, v4
    v_lshrrev_b32 v3, 4, v3
    v_lshl_add_u32 v4, v3, 4, v4
    s_lshr_b32 s18, s16, 1
    s_lshl_b32 s18, s18, 3
    s_and_b32 s19, s16, 1
    s_add_u32 s18, s18, s19
    s_mul_i32 s18, s18, 9216
    s_lshl_b32 s19, s33, 6
    s_add_u32 s18, s18, s19
    s_waitcnt lgkmcnt(0)
    v_pk_add_f32 v[8:9], v[8:9], v[40:41]
    v_pk_add_f32 v[48:49], v[48:49], v[56:57]
    v_pk_add_f32 v[8:9], v[8:9], v[48:49]
    v_pk_add_f32 v[10:11], v[10:11], v[42:43]
    v_pk_add_f32 v[50:51], v[50:51], v[58:59]
    v_pk_add_f32 v[10:11], v[10:11], v[50:51]
    v_pk_add_f32 v[12:13], v[12:13], v[44:45]
    v_pk_add_f32 v[52:53], v[52:53], v[60:61]
    v_pk_add_f32 v[12:13], v[12:13], v[52:53]
    v_pk_add_f32 v[14:15], v[14:15], v[46:47]
    v_pk_add_f32 v[54:55], v[54:55], v[62:63]
    v_pk_add_f32 v[14:15], v[14:15], v[54:55]
    v_cvt_pk_bf16_f32 v32, v8, v9
    v_cvt_pk_bf16_f32 v33, v10, v11
    v_cvt_pk_bf16_f32 v34, v12, v13
    v_cvt_pk_bf16_f32 v35, v14, v15
    buffer_store_dwordx4 v[32:35], v4, s[8:11], s18 offen sc1
os_skip:
    s_nop 1
    s_add_u32 s16, s16, 7
    s_cmp_ge_u32 s16, 128
    s_cbranch_scc1 L_done
    s_barrier
    s_branch L_op_seg
L_done:
L_exit:
    s_endpgm
.section .rodata,"a"
.p2align 6
.amdhsa_kernel concat_heads__memory_aug_recurrent_mem_tr__ssm_conv_s4d__prompt_kernel
  .amdhsa_next_free_vgpr 512
  .amdhsa_next_free_sgpr 102
  .amdhsa_accum_offset 256
  .amdhsa_group_segment_fixed_size 0
  .amdhsa_kernarg_size 136
  .amdhsa_user_sgpr_count 2
  .amdhsa_user_sgpr_kernarg_segment_ptr 1
  .amdhsa_system_sgpr_workgroup_id_x 1
.end_amdhsa_kernel
.text
```

```asm
; @launch grid=(256,1,1) block=(256,1,1) lds=163840
.amdgcn_target "amdgcn-amd-amdhsa--gfx950"
.text
.globl concat_heads__memory_aug_recurrent_mem_tr__ssm_conv_s4d__prompt_kernel
.p2align 8
.type concat_heads__memory_aug_recurrent_mem_tr__ssm_conv_s4d__prompt_kernel,@function
concat_heads__memory_aug_recurrent_mem_tr__ssm_conv_s4d__prompt_kernel:
    s_cmp_ge_u32 s2, 256
    s_cbranch_scc1 L_exit
    s_load_dwordx4 s[84:87], s[0:1], 120
    s_load_dwordx16 s[48:63], s[0:1], 0
    v_lshrrev_b32 v1, 6, v0
    s_nop 0
    v_readfirstlane_b32 s32, v1
    s_getreg_b32 s3, hwreg(HW_REG_XCC_ID)
    s_and_b32 s3, s3, 15
    s_cmp_lg_u32 s32, 3
    s_cbranch_scc1 L_nowarm
    s_getpc_b64 s[44:45]
L_pcw:
    v_and_b32 v1, 63, v0
    v_lshlrev_b32 v1, 7, v1
    s_cmp_lg_u32 s3, 0
    s_cselect_b32 s33, L_helper-L_pcw, 0
    v_add_u32 v1, s33, v1
    v_min_u32 v2, L_exit-L_pcw, v1
    global_load_dword v240, v2, s[44:45]
    v_add_u32 v1, 8192, v1
    v_min_u32 v2, L_exit-L_pcw, v1
    global_load_dword v241, v2, s[44:45]
    v_add_u32 v1, 8192, v1
    s_cbranch_scc0 L_nowarm
    v_min_u32 v2, L_exit-L_pcw, v1
    global_load_dword v242, v2, s[44:45]
    v_add_u32 v1, 8192, v1
    v_min_u32 v2, L_exit-L_pcw, v1
    global_load_dword v243, v2, s[44:45]
    v_add_u32 v1, 8192, v1
    v_min_u32 v2, L_exit-L_pcw, v1
    global_load_dword v244, v2, s[44:45]
    v_add_u32 v1, 8192, v1
L_nowarm:
    s_waitcnt lgkmcnt(0)
    s_mov_b32 s4, s86
    s_mov_b32 s5, s87
    s_mov_b32 s6, 268435456
    s_mov_b32 s7, 0x20000
    s_mov_b32 s96, s84
    s_mov_b32 s97, s85
    s_mov_b32 s98, 256
    s_mov_b32 s99, 0x20000
    s_mov_b32 s95, 0
    s_cmp_lg_u32 s3, 0
    s_cbranch_scc1 L_helper
    s_mov_b32 s37, 128
    v_mov_b32 v250, 1
    v_mov_b32 v251, 163832
    v_cmp_eq_u32 vcc, 0, v0
    s_nop 0
    s_and_saveexec_b64 s[38:39], vcc
    s_cbranch_execz tk1m
    buffer_atomic_add v250, off, s[96:99], s37 sc0
tk1m:
    s_mov_b64 s[38:39], exec
    s_mov_b64 exec, -1
    v_lshrrev_b32 v54, 6, v0
    s_nop 0
    v_readfirstlane_b32 s13, v54
    v_and_b32 v57, 63, v0
    v_bfe_u32 v54, v57, 2, 1
    v_lshlrev_b32 v48, 13, v54
    v_bfe_u32 v54, v57, 3, 1
    v_lshl_add_u32 v48, v54, 15, v48
    v_bfe_u32 v54, v57, 4, 1
    v_lshl_add_u32 v48, v54, 14, v48
    v_bfe_u32 v54, v57, 5, 1
    v_lshl_add_u32 v48, v54, 16, v48
    v_lshrrev_b32 v55, 4, v57
    v_and_b32 v55, 2, v55
    v_xor_b32 v55, v55, v57
    v_and_b32 v55, 3, v55
    v_lshl_add_u32 v48, v55, 4, v48
    v_bfe_u32 v54, v57, 2, 1
    v_lshlrev_b32 v51, 6, v54
    v_bfe_u32 v54, v57, 3, 1
    v_lshl_add_u32 v51, v54, 9, v51
    v_bfe_u32 v54, v57, 4, 1
    v_lshl_add_u32 v51, v54, 7, v51
    v_bfe_u32 v54, v57, 5, 1
    v_lshl_add_u32 v51, v54, 12, v51
    v_bfe_u32 v54, v57, 0, 1
    v_lshl_add_u32 v51, v54, 3, v51
    v_bfe_u32 v54, v57, 1, 1
    v_lshl_add_u32 v51, v54, 4, v51
    v_bfe_u32 v54, v57, 3, 1
    v_lshl_add_u32 v51, v54, 5, v51
    v_lshrrev_b32 v55, 3, v57
    v_mul_u32_u24 v49, 1152, v55
    v_and_b32 v55, 7, v57
    v_lshl_add_u32 v49, v55, 4, v49
    v_bfe_u32 v54, v57, 4, 1
    v_lshlrev_b32 v52, 13, v54
    v_bfe_u32 v54, v57, 5, 1
    v_lshl_add_u32 v52, v54, 9, v52
    v_bfe_u32 v54, v57, 2, 1
    v_lshl_add_u32 v52, v54, 7, v52
    v_bfe_u32 v54, v57, 3, 1
    v_lshl_add_u32 v52, v54, 5, v52
    v_and_b32 v55, 3, v57
    v_lshl_add_u32 v52, v55, 3, v52
    v_lshrrev_b32 v55, 2, v57
    v_mul_u32_u24 v50, 1152, v55
    v_and_b32 v55, 3, v57
    v_lshl_add_u32 v50, v55, 4, v50
    v_bfe_u32 v54, v57, 4, 1
    v_lshlrev_b32 v53, 12, v54
    v_bfe_u32 v54, v57, 5, 1
    v_lshl_add_u32 v53, v54, 8, v53
    v_bfe_u32 v54, v57, 2, 1
    v_lshl_add_u32 v53, v54, 6, v53
    v_bfe_u32 v54, v57, 3, 1
    v_lshl_add_u32 v53, v54, 5, v53
    v_and_b32 v55, 3, v57
    v_lshl_add_u32 v53, v55, 3, v53
    s_lshl_b32 s66, s13, 10
    s_and_b32 s93, s13, 1
    s_lshl_b32 s93, s93, 14
    s_and_b32 s75, s13, 2
    s_lshl_b32 s75, s75, 19
    v_add_u32 v51, s66, v51
    v_add_u32 v52, s66, v52
    v_add_u32 v53, s66, v53
    v_mov_b32 v58, v48
    s_mov_b32 s10, 4718592
    s_mov_b32 s11, 0x20000
    s_mov_b64 exec, s[38:39]
    s_cbranch_execz tk1
    s_waitcnt vmcnt(0)
    ds_write_b32 v251, v250
    s_waitcnt lgkmcnt(0)
tk1:
    s_mov_b64 exec, -1
    s_barrier
    ds_read_b32 v252, v251
    s_waitcnt lgkmcnt(0)
    v_readfirstlane_b32 s12, v252
    s_barrier
    s_nop 3
    s_cmp_ge_u32 s12, 32
    s_cbranch_scc1 L_helper
L_chain:
    s_mov_b64 s[48:49], s[50:51]
    s_mov_b64 s[50:51], s[52:53]
    s_mov_b64 s[52:53], s[54:55]
    s_mov_b64 s[54:55], s[56:57]
    s_mov_b64 s[56:57], s[58:59]
    s_lshl_b32 s67, s12, 8
    s_lshl_b32 s40, s13, 6
    s_add_u32 s67, s67, s40
    s_mul_i32 s92, s12, 147456
    s_lshr_b32 s73, s50, 8
    s_add_u32 s73, s73, s12
    s_and_b32 s73, s73, 31
    s_bitcmp1_b32 0xa2222222, s73
    s_cselect_b32 s88, 1, 0
    s_mov_b32 s72, 0
    s_add_u32 s73, s73, 1
    s_lshr_b32 s73, s73, 2
    s_xor_b32 s94, s13, 0
    s_mul_i32 s94, s94, 36864
    s_add_u32 s94, s94, s92
    s_lshl_b32 s74, s13, 7
    s_add_u32 s94, s94, s74
    s_add_u32 s78, s94, 0
    s_mov_b64 s[8:9], s[56:57]
    v_mov_b32 v58, v49
    s_mov_b32 s79, 9216
    s_mov_b32 s81, 0
    s_add_u32 s80, s66, 114688
    s_mov_b32 s76, 0
    s_mov_b32 s77, 8192
    s_call_b64 s[82:83], cf_dma
    s_mov_b32 s77, 16384
    s_call_b64 s[82:83], cf_dma
    s_xor_b32 s94, s13, 1
    s_mul_i32 s94, s94, 36864
    s_add_u32 s94, s94, s92
    s_lshl_b32 s74, s13, 7
    s_add_u32 s94, s94, s74
    s_add_u32 s78, s94, 0
    s_add_u32 s80, s66, 81920
    s_mov_b32 s76, 0
    s_mov_b32 s77, 8192
    s_call_b64 s[82:83], cf_dma
    s_mov_b32 s77, 16384
    s_call_b64 s[82:83], cf_dma
    s_xor_b32 s94, s13, 2
    s_mul_i32 s94, s94, 36864
    s_add_u32 s94, s94, s92
    s_lshl_b32 s74, s13, 7
    s_add_u32 s94, s94, s74
    s_add_u32 s78, s94, 0
    s_add_u32 s80, s66, 16384
    s_mov_b32 s76, 0
    s_mov_b32 s77, 8192
    s_call_b64 s[82:83], cf_dma
    s_mov_b32 s77, 16384
    s_call_b64 s[82:83], cf_dma
    s_xor_b32 s94, s13, 3
    s_mul_i32 s94, s94, 36864
    s_add_u32 s94, s94, s92
    s_lshl_b32 s74, s13, 7
    s_add_u32 s94, s94, s74
    s_add_u32 s78, s94, 0
    s_add_u32 s80, s66, 0
    s_mov_b32 s76, 0
    s_mov_b32 s77, 8192
    s_call_b64 s[82:83], cf_dma
    s_mov_b32 s77, 16384
    s_call_b64 s[82:83], cf_dma
    v_lshrrev_b32 v24, 6, v0
    v_lshlrev_b32 v61, 4, v0
    v_add_u32 v62, 57344, v61
    v_xor_b32 v63, 1024, v61
    v_add_u32 v63, 98304, v63
    v_xor_b32 v64, 2048, v61
    v_add_u32 v64, 98304, v64
    v_and_b32 v65, 1023, v61
    v_add_u32 v65, 98304, v65
    v_and_b32 v26, 15, v0
    v_bfe_u32 v27, v0, 4, 2
    v_mov_b32 v60, 0x4444
    v_mov_b32 v25, 0xeeee
    v_cmp_lt_u32 vcc, 7, v26
    s_nop 1
    v_cndmask_b32 v60, v60, v25, vcc
    s_nop 1
    v_and_b32 v67, 12, v26
    v_lshlrev_b32 v67, 3, v67
    v_and_b32 v25, 1, v26
    v_lshl_add_u32 v67, v25, 4, v67
    v_bfe_u32 v25, v26, 1, 1
    v_lshl_add_u32 v67, v25, 3, v67
    v_lshl_add_u32 v66, v27, 14, v67
    v_lshl_add_u32 v66, v24, 17, v66
    s_nop 1
    v_and_b32 v67, 63, v67
    v_lshrrev_b32 v25, 1, v24
    v_lshl_add_u32 v67, v25, 18, v67
    v_lshl_add_u32 v67, v27, 16, v67
    v_lshrrev_b32 v25, 3, v26
    v_lshl_add_u32 v67, v25, 15, v67
    v_and_b32 v25, 1, v24
    v_lshl_add_u32 v67, v25, 6, v67
    s_nop 1
    s_waitcnt vmcnt(12)
    v_add_u32 v55, 114688, v52
    ds_read_b64_tr_b16 v[160:161], v55 offset:0
    ds_read_b64_tr_b16 v[162:163], v55 offset:256
    ds_read_b64_tr_b16 v[164:165], v55 offset:4096
    ds_read_b64_tr_b16 v[166:167], v55 offset:4352
    s_xor_b32 s94, s13, 0
    s_mul_i32 s94, s94, 36864
    s_add_u32 s94, s94, s92
    s_lshl_b32 s74, s13, 7
    s_add_u32 s94, s94, s74
    s_add_u32 s78, s94, 512
    s_add_u32 s80, s66, 147456
    s_mov_b32 s76, 0
    s_mov_b32 s77, 8192
    s_call_b64 s[82:83], cf_dma
    ds_read_b64_tr_b16 v[192:193], v55 offset:64
    ds_read_b64_tr_b16 v[194:195], v55 offset:320
    ds_read_b64_tr_b16 v[196:197], v55 offset:4160
    ds_read_b64_tr_b16 v[198:199], v55 offset:4416
    s_mov_b32 s77, 16384
    s_call_b64 s[82:83], cf_dma
    v_and_b32 v25, 31, v0
    v_lshlrev_b32 v70, 4, v25
    v_lshlrev_b32 v28, 3, v25
    v_add_u32 v28, 108032, v28
    v_lshrrev_b32 v25, 1, v24
    v_lshl_add_u32 v70, v25, 9, v70
    v_and_b32 v25, 1, v24
    v_lshl_add_u32 v70, v25, 3, v70
    v_add_u32 v70, 109568, v70
    v_cmp_gt_u32 vcc, 2, v27
    s_nop 1
    v_cndmask_b32 v70, v70, v28, vcc
    s_nop 1
    s_waitcnt lgkmcnt(0)
    s_waitcnt vmcnt(12)
    v_add_u32 v55, 81920, v52
    ds_read_b64_tr_b16 v[168:169], v55 offset:0
    ds_read_b64_tr_b16 v[170:171], v55 offset:256
    ds_read_b64_tr_b16 v[172:173], v55 offset:4096
    ds_read_b64_tr_b16 v[174:175], v55 offset:4352
    s_xor_b32 s94, s13, 1
    s_mul_i32 s94, s94, 36864
    s_add_u32 s94, s94, s92
    s_lshl_b32 s74, s13, 7
    s_add_u32 s94, s94, s74
    s_add_u32 s78, s94, 512
    s_add_u32 s80, s66, 98304
    s_mov_b32 s76, 0
    s_mov_b32 s77, 8192
    s_call_b64 s[82:83], cf_dma
    ds_read_b64_tr_b16 v[200:201], v55 offset:64
    ds_read_b64_tr_b16 v[202:203], v55 offset:320
    ds_read_b64_tr_b16 v[204:205], v55 offset:4160
    ds_read_b64_tr_b16 v[206:207], v55 offset:4416
    s_mov_b32 s77, 16384
    s_call_b64 s[82:83], cf_dma
    v_xor_b32 v71, 2048, v63
    v_lshrrev_b32 v68, 4, v0
    v_lshlrev_b32 v68, 7, v68
    v_and_b32 v25, 7, v26
    v_lshl_add_u32 v68, v25, 4, v68
    v_add_u32 v68, 98304, v68
    v_xor_b32 v74, 512, v68
    v_xor_b32 v75, 1024, v68
    v_xor_b32 v76, 1536, v68
    v_lshrrev_b32 v25, 3, v26
    v_lshl_add_u32 v77, v25, 3, v68
    v_or_b32 v78, 512, v65
    v_lshlrev_b32 v79, 2, v61
    v_mov_b64 v[72:73], 0
    v_and_b32 v25, 1, v27
    v_lshlrev_b32 v69, 7, v25
    v_lshrrev_b32 v25, 1, v27
    v_lshl_add_u32 v69, v25, 3, v69
    v_and_b32 v25, 3, v26
    v_lshl_add_u32 v69, v25, 4, v69
    v_bfe_u32 v25, v26, 2, 1
    v_lshl_add_u32 v69, v25, 2, v69
    s_nop 1
    s_waitcnt lgkmcnt(0)
    s_waitcnt vmcnt(12)
    v_add_u32 v55, 16384, v52
    ds_read_b64_tr_b16 v[176:177], v55 offset:0
    ds_read_b64_tr_b16 v[178:179], v55 offset:256
    ds_read_b64_tr_b16 v[180:181], v55 offset:4096
    ds_read_b64_tr_b16 v[182:183], v55 offset:4352
    s_add_u32 s78, s67, 4194304
    s_mov_b64 s[8:9], s[54:55]
    v_mov_b32 v58, v48
    s_mov_b32 s79, 131072
    s_add_u32 s80, s66, 32768
    s_mov_b32 s76, 0
    s_mov_b32 s77, 8192
    s_call_b64 s[82:83], cf_dma
    ds_read_b64_tr_b16 v[208:209], v55 offset:64
    ds_read_b64_tr_b16 v[210:211], v55 offset:320
    ds_read_b64_tr_b16 v[212:213], v55 offset:4160
    ds_read_b64_tr_b16 v[214:215], v55 offset:4416
    s_mov_b32 s77, 16384
    s_call_b64 s[82:83], cf_dma
    s_mov_b32 s32, 0x00ff00ff
    s_mov_b32 s33, 0x00ff00ff
    s_not_b64 s[34:35], s[32:33]
    s_lshr_b32 s31, s12, 1
    s_lshl_b32 s31, s31, 8
    s_and_b32 s40, s12, 1
    s_lshl_b32 s40, s40, 6
    s_add_u32 s31, s31, s40
    s_and_b32 s40, s13, 1
    s_lshl_b32 s40, s40, 12
    s_add_u32 s31, s31, s40
    s_lshl_b32 s19, s12, 14
    s_add_u32 s19, s19, 67076096
    s_add_u32 s41, s19, 8192
    s_add_u32 s19, s19, s40
    s_and_b32 s40, s12, 1
    s_lshl_b32 s40, s40, 2
    s_or_b32 s40, s40, s13
    s_cmp_eq_u32 s40, 5
    s_cselect_b32 s64, 0, s13
    s_cmp_lg_u32 s13, 1
    s_cbranch_scc1 cf_notx
    s_mov_b32 s32, 0xff
    s_mov_b32 s33, 0xff
    s_mov_b32 s19, s41
    s_lshr_b32 s31, s12, 3
    s_lshl_b32 s31, s31, 8
    s_and_b32 s40, s12, 2
    s_lshl_b32 s40, s40, 6
    s_add_u32 s31, s31, s40
    s_and_b32 s40, s12, 4
    s_lshl_b32 s40, s40, 4
    s_add_u32 s31, s31, s40
    s_add_u32 s31, s31, 8192
cf_notx:
    s_cmp_lg_u32 s13, 0
    s_cbranch_scc1 cf_notp
    s_min_u32 s40, s12, 23
    s_mul_i32 s40, s40, 384
    s_add_u32 s40, s40, 98304
    v_add_u32 v69, s40, v61
    v_mov_b32 v25, 108288
    v_cmp_lt_u32 vcc, 23, v0
    s_nop 1
    v_cndmask_b32 v69, v69, v25, vcc
cf_notp:
    s_nop 1
    s_waitcnt lgkmcnt(0)
    s_waitcnt vmcnt(12)
    v_add_u32 v55, 0, v52
    ds_read_b64_tr_b16 v[184:185], v55 offset:0
    ds_read_b64_tr_b16 v[186:187], v55 offset:256
    ds_read_b64_tr_b16 v[188:189], v55 offset:4096
    ds_read_b64_tr_b16 v[190:191], v55 offset:4352
    s_xor_b32 s78, s75, 0
    s_add_u32 s78, s78, s67
    s_mov_b32 s81, s93
    s_add_u32 s80, s66, 114688
    s_mov_b32 s76, 0
    s_mov_b32 s77, 8192
    s_call_b64 s[82:83], cf_dma
    ds_read_b64_tr_b16 v[216:217], v55 offset:64
    ds_read_b64_tr_b16 v[218:219], v55 offset:320
    ds_read_b64_tr_b16 v[220:221], v55 offset:4160
    ds_read_b64_tr_b16 v[222:223], v55 offset:4416
    s_mov_b32 s77, 16384
    s_call_b64 s[82:83], cf_dma
    v_mov_b32 v28, 1
    v_mov_b32 v29, 1
    v_mov_b32 v30, 1
    v_mov_b32 v31, 1
    s_lshl_b32 s40, s12, 14
    s_add_u32 s40, s40, 67174400
    s_add_u32 s41, s40, 0
    buffer_store_dwordx4 v[28:31], v61, s[4:7], s41 offen
    s_add_u32 s41, s40, 4096
    buffer_store_dwordx4 v[28:31], v61, s[4:7], s41 offen
    s_add_u32 s41, s40, 8192
    buffer_store_dwordx4 v[28:31], v61, s[4:7], s41 offen
    s_cmp_eq_u32 s64, 0
    s_cselect_b64 exec, 0, s[32:33]
    v_mov_b32 v27, -1
    s_add_u32 s41, s31, 67108864
    buffer_store_dword v27, v69, s[4:7], s41 offen
    s_add_u32 s41, s31, 67125248
    buffer_store_dword v27, v69, s[4:7], s41 offen
    s_add_u32 s41, s31, 67141632
    buffer_store_dword v27, v69, s[4:7], s41 offen
    s_add_u32 s41, s31, 67158016
    buffer_store_dword v27, v69, s[4:7], s41 offen
    s_mov_b64 exec, -1
    s_waitcnt lgkmcnt(0)
    s_waitcnt vmcnt(12)
    v_add_u32 v55, 147456, v52
    ds_read_b64_tr_b16 v[224:225], v55 offset:0
    ds_read_b64_tr_b16 v[226:227], v55 offset:256
    ds_read_b64_tr_b16 v[228:229], v55 offset:4096
    ds_read_b64_tr_b16 v[230:231], v55 offset:4352
    s_mov_b32 s77, 24576
    s_call_b64 s[82:83], cf_dma
    ds_read_b64_tr_b16 v[240:241], v55 offset:64
    ds_read_b64_tr_b16 v[242:243], v55 offset:320
    ds_read_b64_tr_b16 v[244:245], v55 offset:4160
    ds_read_b64_tr_b16 v[246:247], v55 offset:4416
    s_mov_b32 s77, 32768
    s_call_b64 s[82:83], cf_dma
    s_mov_b64 s[68:69], s[48:49]
    s_mov_b32 s70, 9216
    s_mov_b32 s71, 0x20000
    v_and_b32 v25, 7, v0
    v_mul_u32_u24 v25, 1152, v25
    v_lshrrev_b32 v26, 3, v0
    v_lshl_add_u32 v25, v26, 4, v25
    buffer_load_dwordx4 v[36:39], v25, s[68:71], 0 offen
    buffer_load_dwordx4 v[40:43], v25, s[68:71], 0 offen offset:512
    v_bfe_u32 v25, v0, 2, 3
    v_mul_u32_u24 v25, 1152, v25
    v_lshrrev_b32 v26, 5, v0
    v_lshl_add_u32 v25, v26, 4, v25
    v_and_b32 v26, 3, v0
    v_lshl_add_u32 v25, v26, 2, v25
    buffer_load_dword v44, v25, s[68:71], 0 offen offset:1024
    s_nop 0
    s_waitcnt lgkmcnt(0)
    s_waitcnt vmcnt(15)
    v_add_u32 v55, 98304, v52
    ds_read_b64_tr_b16 v[232:233], v55 offset:0
    ds_read_b64_tr_b16 v[234:235], v55 offset:256
    ds_read_b64_tr_b16 v[236:237], v55 offset:4096
    ds_read_b64_tr_b16 v[238:239], v55 offset:4352
    s_xor_b32 s78, s75, 1048576
    s_add_u32 s78, s78, s67
    s_add_u32 s80, s66, 65536
    s_mov_b32 s76, 0
    s_mov_b32 s77, 8192
    s_call_b64 s[82:83], cf_dma
    ds_read_b64_tr_b16 v[248:249], v55 offset:64
    ds_read_b64_tr_b16 v[250:251], v55 offset:320
    ds_read_b64_tr_b16 v[252:253], v55 offset:4160
    ds_read_b64_tr_b16 v[254:255], v55 offset:4416
    s_mov_b32 s77, 16384
    s_call_b64 s[82:83], cf_dma
    s_mov_b32 s44, 0x3e0293ee
    s_mov_b32 s45, s44
    s_mov_b32 s46, 0x42000000
    s_mov_b32 s60, 0x3f803f80
    s_mov_b32 s61, s60
    s_mov_b32 s62, 0x3e803e80
    s_mov_b32 s63, s62
    s_mov_b32 s28, 0
    s_lshl_b32 s24, s12, 14
    s_add_u32 s24, s24, 0
    s_add_u32 s47, s24, 33030144
    s_mul_i32 s40, s13, 3072
    s_add_u32 s23, s24, s40
    s_lshl_b32 s20, s12, 7
    s_add_u32 s20, s20, 67174400
    s_add_u32 s21, s20, 65536
    s_add_u32 s38, s20, 4096
    s_add_u32 s39, s21, 4096
    s_lshl_b32 s22, s12, 7
    s_add_u32 s22, s22, 67182592
    s_waitcnt lgkmcnt(0)
    s_waitcnt vmcnt(15)
    v_add_u32 v55, 32768, v51
    v_xor_b32 v56, 32, v55
    ds_read_b64_tr_b16 v[144:145], v55 offset:0
    ds_read_b64_tr_b16 v[146:147], v55 offset:256
    ds_read_b64_tr_b16 v[148:149], v55 offset:8192
    ds_read_b64_tr_b16 v[150:151], v55 offset:8448
    s_mov_b32 s77, 24576
    s_call_b64 s[82:83], cf_dma
    ds_read_b64_tr_b16 v[152:153], v56 offset:0
    ds_read_b64_tr_b16 v[154:155], v56 offset:256
    ds_read_b64_tr_b16 v[156:157], v56 offset:8192
    ds_read_b64_tr_b16 v[158:159], v56 offset:8448
    s_mov_b32 s77, 32768
    s_call_b64 s[82:83], cf_dma
    s_lshl_b32 s40, s12, 12
    s_add_u32 s25, s40, 79429632
    s_add_u32 s26, s40, 88866816
    s_lshl_b32 s65, s12, 9
    s_add_u32 s65, s65, 90177536
    s_lshl_b32 s40, s13, 5
    s_or_b32 s40, s40, s12
    s_cmp_lt_u32 s40, 24
    s_cselect_b32 s36, 0x1ffffff, 0
    s_mov_b32 s37, 0
    s_lshl_b32 s27, s12, 7
    s_add_u32 s27, s27, 125845504
    s_lshl_b32 s40, s13, 2
    s_add_u32 s27, s27, s40
    v_bfe_u32 v28, v61, 4, 4
    v_bfe_u32 v29, v61, 8, 1
    v_lshlrev_b32 v29, 2, v29
    v_sub_u32 v29, v28, v29
    v_mov_b32 v31, 0x3f80
    v_mov_b32 v32, 0x3f800000
    s_nop 1
    s_waitcnt lgkmcnt(0)
    s_waitcnt vmcnt(11)
    v_add_u32 v55, 114688, v51
    v_xor_b32 v56, 32, v55
    ds_read_b64_tr_b16 a[192:193], v55 offset:0
    ds_read_b64_tr_b16 a[194:195], v55 offset:256
    ds_read_b64_tr_b16 a[196:197], v55 offset:8192
    ds_read_b64_tr_b16 a[198:199], v55 offset:8448
    s_xor_b32 s78, s75, 2097152
    s_add_u32 s78, s78, s67
    s_add_u32 s80, s66, 0
    s_mov_b32 s76, 0
    s_mov_b32 s77, 8192
    s_call_b64 s[82:83], cf_dma
    ds_read_b64_tr_b16 a[200:201], v56 offset:0
    ds_read_b64_tr_b16 a[202:203], v56 offset:256
    ds_read_b64_tr_b16 a[204:205], v56 offset:8192
    ds_read_b64_tr_b16 a[206:207], v56 offset:8448
    s_mov_b32 s77, 16384
    s_call_b64 s[82:83], cf_dma
    v_cmp_eq_u32 vcc, 0, v29
    s_nop 1
    v_cndmask_b32 v16, 0, v31, vcc
    v_cmp_eq_u32 vcc, 1, v29
    s_nop 1
    v_cndmask_b32 v16, v16, v32, vcc
    v_cmp_eq_u32 vcc, 0, v28
    s_nop 1
    v_cndmask_b32 v20, 0, v31, vcc
    v_cmp_eq_u32 vcc, 1, v28
    s_nop 1
    v_cndmask_b32 v20, v20, v32, vcc
    s_nop 1
    s_waitcnt lgkmcnt(0)
    v_add_u32 v55, 131072, v51
    v_xor_b32 v56, 32, v55
    ds_read_b64_tr_b16 a[208:209], v55 offset:0
    ds_read_b64_tr_b16 a[210:211], v55 offset:256
    ds_read_b64_tr_b16 a[212:213], v55 offset:8192
    ds_read_b64_tr_b16 a[214:215], v55 offset:8448
    s_mov_b32 s77, 24576
    s_call_b64 s[82:83], cf_dma
    ds_read_b64_tr_b16 a[216:217], v56 offset:0
    ds_read_b64_tr_b16 a[218:219], v56 offset:256
    ds_read_b64_tr_b16 a[220:221], v56 offset:8192
    ds_read_b64_tr_b16 a[222:223], v56 offset:8448
    s_mov_b32 s77, 32768
    s_call_b64 s[82:83], cf_dma
    v_cmp_eq_u32 vcc, 2, v29
    s_nop 1
    v_cndmask_b32 v17, 0, v31, vcc
    v_cmp_eq_u32 vcc, 3, v29
    s_nop 1
    v_cndmask_b32 v17, v17, v32, vcc
    v_cmp_eq_u32 vcc, 2, v28
    s_nop 1
    v_cndmask_b32 v21, 0, v31, vcc
    v_cmp_eq_u32 vcc, 3, v28
    s_nop 1
    v_cndmask_b32 v21, v21, v32, vcc
    s_nop 1
    s_waitcnt lgkmcnt(0)
    s_waitcnt vmcnt(8)
    v_add_u32 v55, 65536, v51
    v_xor_b32 v56, 32, v55
    ds_read_b64_tr_b16 a[224:225], v55 offset:0
    ds_read_b64_tr_b16 a[226:227], v55 offset:256
    ds_read_b64_tr_b16 a[228:229], v55 offset:8192
    ds_read_b64_tr_b16 a[230:231], v55 offset:8448
    s_cmp_eq_u32 s88, 0
    s_cbranch_scc1 cf_cpe622
    s_lshl_b32 s89, s73, 7
    s_add_u32 s89, s89, 125853696
    v_min_u32 v33, 11, v57
    v_lshlrev_b32 v33, 2, v33
    buffer_load_dword v34, off, s[96:99], 0 offset:64 sc1
    buffer_load_dword v35, v33, s[4:7], s89 offen sc1
cf_cpe622:
    s_xor_b32 s78, s75, 3145728
    s_add_u32 s78, s78, s67
    s_add_u32 s80, s66, 32768
    s_mov_b32 s76, 0
    s_mov_b32 s77, 8192
    s_call_b64 s[82:83], cf_dma
    ds_read_b64_tr_b16 a[232:233], v56 offset:0
    ds_read_b64_tr_b16 a[234:235], v56 offset:256
    ds_read_b64_tr_b16 a[236:237], v56 offset:8192
    ds_read_b64_tr_b16 a[238:239], v56 offset:8448
    s_mov_b32 s77, 16384
    s_call_b64 s[82:83], cf_dma
    v_cmp_eq_u32 vcc, 8, v29
    s_nop 1
    v_cndmask_b32 v18, 0, v31, vcc
    v_cmp_eq_u32 vcc, 9, v29
    s_nop 1
    v_cndmask_b32 v18, v18, v32, vcc
    v_cmp_eq_u32 vcc, 4, v28
    s_nop 1
    v_cndmask_b32 v22, 0, v31, vcc
    v_cmp_eq_u32 vcc, 5, v28
    s_nop 1
    v_cndmask_b32 v22, v22, v32, vcc
    s_nop 1
    s_waitcnt lgkmcnt(0)
    v_add_u32 v55, 81920, v51
    v_xor_b32 v56, 32, v55
    ds_read_b64_tr_b16 a[240:241], v55 offset:0
    ds_read_b64_tr_b16 a[242:243], v55 offset:256
    ds_read_b64_tr_b16 a[244:245], v55 offset:8192
    ds_read_b64_tr_b16 a[246:247], v55 offset:8448
    s_mov_b32 s77, 24576
    s_call_b64 s[82:83], cf_dma
    ds_read_b64_tr_b16 a[248:249], v56 offset:0
    ds_read_b64_tr_b16 a[250:251], v56 offset:256
    ds_read_b64_tr_b16 a[252:253], v56 offset:8192
    ds_read_b64_tr_b16 a[254:255], v56 offset:8448
    s_mov_b32 s77, 32768
    s_call_b64 s[82:83], cf_dma
    v_cmp_eq_u32 vcc, 10, v29
    s_nop 1
    v_cndmask_b32 v19, 0, v31, vcc
    v_cmp_eq_u32 vcc, 11, v29
    s_nop 1
    v_cndmask_b32 v19, v19, v32, vcc
    v_cmp_eq_u32 vcc, 6, v28
    s_nop 1
    v_cndmask_b32 v23, 0, v31, vcc
    v_cmp_eq_u32 vcc, 7, v28
    s_nop 1
    v_cndmask_b32 v23, v23, v32, vcc
    s_nop 1
    s_waitcnt lgkmcnt(0)
    s_waitcnt vmcnt(8)
    v_add_u32 v55, 0, v51
    v_xor_b32 v56, 32, v55
    ds_read_b64_tr_b16 v[80:81], v55 offset:0
    ds_read_b64_tr_b16 v[82:83], v55 offset:256
    ds_read_b64_tr_b16 v[84:85], v55 offset:8192
    ds_read_b64_tr_b16 v[86:87], v55 offset:8448
    s_cmp_eq_u32 s88, 0
    s_cbranch_scc1 cf_ncp692
    s_waitcnt vmcnt(8)
    v_max_u32 v34, 1, v34
    v_cmp_eq_u32 vcc, 1, v34
    s_cbranch_vccnz cf_ncp692
    v_cmp_ne_u32 vcc, v34, v35
    s_cbranch_vccnz cf_ncp692
    s_mov_b32 s88, 0
    s_mov_b32 s72, 5
    s_lshl_b32 s74, s73, 19
    s_add_u32 s74, s74, 96468992
    s_add_u32 s50, s4, s74
    s_addc_u32 s51, s5, 0
    s_add_u32 s52, s50, 147456
    s_addc_u32 s53, s51, 0
    s_lshl_b32 s67, s13, 6
    v_and_b32 v54, 63, v48
    v_lshrrev_b32 v48, 13, v48
    v_lshl_add_u32 v48, v48, 8, v54
cf_ncp692:
    s_cmp_eq_u32 s88, 0
    s_cbranch_scc1 cf_cpe713
    s_lshl_b32 s89, s73, 7
    s_add_u32 s89, s89, 125853696
    v_min_u32 v33, 11, v57
    v_lshlrev_b32 v33, 2, v33
    buffer_load_dword v34, off, s[96:99], 0 offset:64 sc1
    buffer_load_dword v35, v33, s[4:7], s89 offen sc1
cf_cpe713:
    s_xor_b32 s78, s75, 2097152
    s_lshr_b32 s78, s78, s72
    s_add_u32 s78, s78, s67
    s_mov_b64 s[8:9], s[52:53]
    v_mov_b32 v58, v48
    s_lshr_b32 s79, 131072, s72
    s_add_u32 s80, s66, 131072
    s_mov_b32 s76, 0
    s_mov_b32 s77, 8192
    s_call_b64 s[82:83], cf_dma
    ds_read_b64_tr_b16 v[88:89], v56 offset:0
    ds_read_b64_tr_b16 v[90:91], v56 offset:256
    ds_read_b64_tr_b16 v[92:93], v56 offset:8192
    ds_read_b64_tr_b16 v[94:95], v56 offset:8448
    s_mov_b32 s77, 16384
    s_call_b64 s[82:83], cf_dma
    v_mov_b32 v46, 1
    s_mov_b64 exec, 1
    buffer_atomic_add v46, off, s[96:99], 0 offset:132 sc0
    s_mov_b64 exec, -1
    s_waitcnt lgkmcnt(0)
    v_add_u32 v55, 16384, v51
    v_xor_b32 v56, 32, v55
    ds_read_b64_tr_b16 v[96:97], v55 offset:0
    ds_read_b64_tr_b16 v[98:99], v55 offset:256
    ds_read_b64_tr_b16 v[100:101], v55 offset:8192
    ds_read_b64_tr_b16 v[102:103], v55 offset:8448
    s_mov_b32 s77, 24576
    s_call_b64 s[82:83], cf_dma
    ds_read_b64_tr_b16 v[104:105], v56 offset:0
    ds_read_b64_tr_b16 v[106:107], v56 offset:256
    ds_read_b64_tr_b16 v[108:109], v56 offset:8192
    ds_read_b64_tr_b16 v[110:111], v56 offset:8448
    s_mov_b32 s77, 32768
    s_call_b64 s[82:83], cf_dma
    s_waitcnt lgkmcnt(0)
    s_waitcnt vmcnt(9)
    v_add_u32 v55, 32768, v51
    v_xor_b32 v56, 32, v55
    ds_read_b64_tr_b16 v[112:113], v55 offset:0
    ds_read_b64_tr_b16 v[114:115], v55 offset:256
    ds_read_b64_tr_b16 v[116:117], v55 offset:8192
    ds_read_b64_tr_b16 v[118:119], v55 offset:8448
    s_cmp_eq_u32 s88, 0
    s_cbranch_scc1 cf_ncp765
    s_waitcnt vmcnt(9)
    v_max_u32 v34, 1, v34
    v_cmp_eq_u32 vcc, 1, v34
    s_cbranch_vccnz cf_ncp765
    v_cmp_ne_u32 vcc, v34, v35
    s_cbranch_vccnz cf_ncp765
    s_mov_b32 s88, 0
    s_mov_b32 s72, 5
    s_lshl_b32 s74, s73, 19
    s_add_u32 s74, s74, 96468992
    s_add_u32 s50, s4, s74
    s_addc_u32 s51, s5, 0
    s_add_u32 s52, s50, 147456
    s_addc_u32 s53, s51, 0
    s_lshl_b32 s67, s13, 6
    v_and_b32 v54, 63, v48
    v_lshrrev_b32 v48, 13, v48
    v_lshl_add_u32 v48, v48, 8, v54
cf_ncp765:
    s_cmp_eq_u32 s88, 0
    s_cbranch_scc1 cf_cpe786
    s_lshl_b32 s89, s73, 7
    s_add_u32 s89, s89, 125853696
    v_min_u32 v33, 11, v57
    v_lshlrev_b32 v33, 2, v33
    buffer_load_dword v34, off, s[96:99], 0 offset:64 sc1
    buffer_load_dword v35, v33, s[4:7], s89 offen sc1
cf_cpe786:
    s_xor_b32 s78, s75, 3145728
    s_lshr_b32 s78, s78, s72
    s_add_u32 s78, s78, s67
    s_mov_b64 s[8:9], s[52:53]
    v_mov_b32 v58, v48
    s_lshr_b32 s79, 131072, s72
    s_add_u32 s80, s66, 65536
    s_mov_b32 s76, 0
    s_mov_b32 s77, 8192
    s_call_b64 s[82:83], cf_dma
    ds_read_b64_tr_b16 v[120:121], v56 offset:0
    ds_read_b64_tr_b16 v[122:123], v56 offset:256
    ds_read_b64_tr_b16 v[124:125], v56 offset:8192
    ds_read_b64_tr_b16 v[126:127], v56 offset:8448
    s_mov_b32 s77, 16384
    s_call_b64 s[82:83], cf_dma
    s_waitcnt lgkmcnt(0)
    v_add_u32 v55, 49152, v51
    v_xor_b32 v56, 32, v55
    ds_read_b64_tr_b16 v[128:129], v55 offset:0
    ds_read_b64_tr_b16 v[130:131], v55 offset:256
    ds_read_b64_tr_b16 v[132:133], v55 offset:8192
    ds_read_b64_tr_b16 v[134:135], v55 offset:8448
    s_mov_b32 s77, 24576
    s_call_b64 s[82:83], cf_dma
    ds_read_b64_tr_b16 v[136:137], v56 offset:0
    ds_read_b64_tr_b16 v[138:139], v56 offset:256
    ds_read_b64_tr_b16 v[140:141], v56 offset:8192
    ds_read_b64_tr_b16 v[142:143], v56 offset:8448
    s_mov_b32 s77, 32768
    s_call_b64 s[82:83], cf_dma
    s_waitcnt lgkmcnt(0)
    s_waitcnt vmcnt(8)
    v_add_u32 v55, 131072, v51
    v_xor_b32 v56, 32, v55
    ds_read_b64_tr_b16 a[128:129], v55 offset:0
    ds_read_b64_tr_b16 a[130:131], v55 offset:256
    ds_read_b64_tr_b16 a[132:133], v55 offset:8192
    ds_read_b64_tr_b16 a[134:135], v55 offset:8448
    s_cmp_eq_u32 s88, 0
    s_cbranch_scc1 cf_ncp834
    s_waitcnt vmcnt(8)
    v_max_u32 v34, 1, v34
    v_cmp_eq_u32 vcc, 1, v34
    s_cbranch_vccnz cf_ncp834
    v_cmp_ne_u32 vcc, v34, v35
    s_cbranch_vccnz cf_ncp834
    s_mov_b32 s88, 0
    s_mov_b32 s72, 5
    s_lshl_b32 s74, s73, 19
    s_add_u32 s74, s74, 96468992
    s_add_u32 s50, s4, s74
    s_addc_u32 s51, s5, 0
    s_add_u32 s52, s50, 147456
    s_addc_u32 s53, s51, 0
    s_lshl_b32 s67, s13, 6
    v_and_b32 v54, 63, v48
    v_lshrrev_b32 v48, 13, v48
    v_lshl_add_u32 v48, v48, 8, v54
cf_ncp834:
    s_cmp_eq_u32 s88, 0
    s_cbranch_scc1 cf_cpe855
    s_lshl_b32 s89, s73, 7
    s_add_u32 s89, s89, 125853696
    v_min_u32 v33, 11, v57
    v_lshlrev_b32 v33, 2, v33
    buffer_load_dword v34, off, s[96:99], 0 offset:64 sc1
    buffer_load_dword v35, v33, s[4:7], s89 offen sc1
cf_cpe855:
    s_xor_b32 s78, s75, 2097152
    s_lshr_b32 s78, s78, s72
    s_add_u32 s78, s78, s67
    s_mov_b64 s[8:9], s[50:51]
    v_mov_b32 v58, v48
    s_lshr_b32 s79, 131072, s72
    s_add_u32 s80, s66, 0
    s_mov_b32 s76, 0
    s_mov_b32 s77, 8192
    s_call_b64 s[82:83], cf_dma
    ds_read_b64_tr_b16 a[136:137], v56 offset:0
    ds_read_b64_tr_b16 a[138:139], v56 offset:256
    ds_read_b64_tr_b16 a[140:141], v56 offset:8192
    ds_read_b64_tr_b16 a[142:143], v56 offset:8448
    s_mov_b32 s77, 16384
    s_call_b64 s[82:83], cf_dma
    s_waitcnt lgkmcnt(0)
    v_add_u32 v55, 147456, v51
    v_xor_b32 v56, 32, v55
    ds_read_b64_tr_b16 a[144:145], v55 offset:0
    ds_read_b64_tr_b16 a[146:147], v55 offset:256
    ds_read_b64_tr_b16 a[148:149], v55 offset:8192
    ds_read_b64_tr_b16 a[150:151], v55 offset:8448
    s_mov_b32 s77, 24576
    s_call_b64 s[82:83], cf_dma
    ds_read_b64_tr_b16 a[152:153], v56 offset:0
    ds_read_b64_tr_b16 a[154:155], v56 offset:256
    ds_read_b64_tr_b16 a[156:157], v56 offset:8192
    ds_read_b64_tr_b16 a[158:159], v56 offset:8448
    s_mov_b32 s77, 32768
    s_call_b64 s[82:83], cf_dma
    s_waitcnt lgkmcnt(0)
    s_waitcnt vmcnt(8)
    v_add_u32 v55, 65536, v51
    v_xor_b32 v56, 32, v55
    ds_read_b64_tr_b16 a[160:161], v55 offset:0
    ds_read_b64_tr_b16 a[162:163], v55 offset:256
    ds_read_b64_tr_b16 a[164:165], v55 offset:8192
    ds_read_b64_tr_b16 a[166:167], v55 offset:8448
    s_cmp_eq_u32 s88, 0
    s_cbranch_scc1 cf_ncp903
    s_waitcnt vmcnt(8)
    v_max_u32 v34, 1, v34
    v_cmp_eq_u32 vcc, 1, v34
    s_cbranch_vccnz cf_ncp903
    v_cmp_ne_u32 vcc, v34, v35
    s_cbranch_vccnz cf_ncp903
    s_mov_b32 s88, 0
    s_mov_b32 s72, 5
    s_lshl_b32 s74, s73, 19
    s_add_u32 s74, s74, 96468992
    s_add_u32 s50, s4, s74
    s_addc_u32 s51, s5, 0
    s_add_u32 s52, s50, 147456
    s_addc_u32 s53, s51, 0
    s_lshl_b32 s67, s13, 6
    v_and_b32 v54, 63, v48
    v_lshrrev_b32 v48, 13, v48
    v_lshl_add_u32 v48, v48, 8, v54
cf_ncp903:
    s_cmp_eq_u32 s88, 0
    s_cbranch_scc1 cf_cpe924
    s_lshl_b32 s89, s73, 7
    s_add_u32 s89, s89, 125853696
    v_min_u32 v33, 11, v57
    v_lshlrev_b32 v33, 2, v33
    buffer_load_dword v34, off, s[96:99], 0 offset:64 sc1
    buffer_load_dword v35, v33, s[4:7], s89 offen sc1
cf_cpe924:
    s_xor_b32 s78, s75, 3145728
    s_lshr_b32 s78, s78, s72
    s_add_u32 s78, s78, s67
    s_mov_b64 s[8:9], s[50:51]
    v_mov_b32 v58, v48
    s_lshr_b32 s79, 131072, s72
    s_add_u32 s80, s66, 32768
    s_mov_b32 s76, 0
    s_mov_b32 s77, 8192
    s_call_b64 s[82:83], cf_dma
    ds_read_b64_tr_b16 a[168:169], v56 offset:0
    ds_read_b64_tr_b16 a[170:171], v56 offset:256
    ds_read_b64_tr_b16 a[172:173], v56 offset:8192
    ds_read_b64_tr_b16 a[174:175], v56 offset:8448
    s_mov_b32 s77, 16384
    s_call_b64 s[82:83], cf_dma
    v_readfirstlane_b32 s41, v46
    v_mov_b32 v46, 1
    v_mov_b32 v47, 0
    s_cmp_eq_u32 s41, 127
    s_cselect_b64 exec, 1, 0
    buffer_atomic_cmpswap v[46:47], off, s[96:99], 0 offset:140
    s_mov_b64 exec, -1
    s_waitcnt lgkmcnt(0)
    v_add_u32 v55, 81920, v51
    v_xor_b32 v56, 32, v55
    ds_read_b64_tr_b16 a[176:177], v55 offset:0
    ds_read_b64_tr_b16 a[178:179], v55 offset:256
    ds_read_b64_tr_b16 a[180:181], v55 offset:8192
    ds_read_b64_tr_b16 a[182:183], v55 offset:8448
    s_mov_b32 s77, 24576
    s_call_b64 s[82:83], cf_dma
    ds_read_b64_tr_b16 a[184:185], v56 offset:0
    ds_read_b64_tr_b16 a[186:187], v56 offset:256
    ds_read_b64_tr_b16 a[188:189], v56 offset:8192
    ds_read_b64_tr_b16 a[190:191], v56 offset:8448
    s_mov_b32 s77, 32768
    s_call_b64 s[82:83], cf_dma
    s_waitcnt lgkmcnt(0)
    s_waitcnt vmcnt(8)
    v_add_u32 v55, 0, v51
    v_xor_b32 v56, 32, v55
    ds_read_b64_tr_b16 a[48:49], v55 offset:0
    ds_read_b64_tr_b16 a[50:51], v55 offset:256
    ds_read_b64_tr_b16 a[52:53], v55 offset:8192
    ds_read_b64_tr_b16 a[54:55], v55 offset:8448
    s_lshr_b32 s78, 4194304, s72
    s_add_u32 s78, s78, s67
    s_mov_b32 s81, 0
    s_add_u32 s80, s66, 98304
    s_mov_b32 s76, 0
    s_mov_b32 s77, 8192
    s_call_b64 s[82:83], cf_dma
    ds_read_b64_tr_b16 a[56:57], v56 offset:0
    ds_read_b64_tr_b16 a[58:59], v56 offset:256
    ds_read_b64_tr_b16 a[60:61], v56 offset:8192
    ds_read_b64_tr_b16 a[62:63], v56 offset:8448
    s_mov_b32 s77, 16384
    s_call_b64 s[82:83], cf_dma
    s_waitcnt lgkmcnt(0)
    v_add_u32 v55, 16384, v51
    v_xor_b32 v56, 32, v55
    ds_read_b64_tr_b16 a[64:65], v55 offset:0
    ds_read_b64_tr_b16 a[66:67], v55 offset:256
    ds_read_b64_tr_b16 a[68:69], v55 offset:8192
    ds_read_b64_tr_b16 a[70:71], v55 offset:8448
    s_cmp_eq_u32 s88, 0
    s_cbranch_scc1 cf_ncp999
    s_waitcnt vmcnt(12)
    v_max_u32 v34, 1, v34
    v_cmp_eq_u32 vcc, 1, v34
    s_cbranch_vccnz cf_ncp999
    v_cmp_ne_u32 vcc, v34, v35
    s_cbranch_vccnz cf_ncp999
    s_mov_b32 s88, 0
    s_mov_b32 s72, 5
    s_lshl_b32 s74, s73, 19
    s_add_u32 s74, s74, 96468992
    s_add_u32 s50, s4, s74
    s_addc_u32 s51, s5, 0
    s_add_u32 s52, s50, 147456
    s_addc_u32 s53, s51, 0
    s_lshl_b32 s67, s13, 6
    v_and_b32 v54, 63, v48
    v_lshrrev_b32 v48, 13, v48
    v_lshl_add_u32 v48, v48, 8, v54
cf_ncp999:
    s_xor_b32 s78, s75, 1048576
    s_lshr_b32 s78, s78, s72
    s_add_u32 s78, s78, s67
    s_mov_b64 s[8:9], s[50:51]
    v_mov_b32 v58, v48
    s_lshr_b32 s79, 131072, s72
    s_mov_b32 s81, s93
    s_add_u32 s80, s66, 114688
    s_mov_b32 s76, 0
    s_mov_b32 s77, 8192
    s_call_b64 s[82:83], cf_dma
    ds_read_b64_tr_b16 a[72:73], v56 offset:0
    ds_read_b64_tr_b16 a[74:75], v56 offset:256
    ds_read_b64_tr_b16 a[76:77], v56 offset:8192
    ds_read_b64_tr_b16 a[78:79], v56 offset:8448
    s_mov_b32 s77, 16384
    s_call_b64 s[82:83], cf_dma
    s_waitcnt lgkmcnt(0)
    s_waitcnt vmcnt(8)
    v_add_u32 v55, 32768, v51
    v_xor_b32 v56, 32, v55
    ds_read_b64_tr_b16 a[80:81], v55 offset:0
    ds_read_b64_tr_b16 a[82:83], v55 offset:256
    ds_read_b64_tr_b16 a[84:85], v55 offset:8192
    ds_read_b64_tr_b16 a[86:87], v55 offset:8448
    s_mov_b32 s77, 24576
    s_call_b64 s[82:83], cf_dma
    ds_read_b64_tr_b16 a[88:89], v56 offset:0
    ds_read_b64_tr_b16 a[90:91], v56 offset:256
    ds_read_b64_tr_b16 a[92:93], v56 offset:8192
    ds_read_b64_tr_b16 a[94:95], v56 offset:8448
    s_mov_b32 s77, 32768
    s_call_b64 s[82:83], cf_dma
    s_waitcnt lgkmcnt(0)
    v_add_u32 v55, 49152, v51
    v_xor_b32 v56, 32, v55
    ds_read_b64_tr_b16 a[96:97], v55 offset:0
    ds_read_b64_tr_b16 a[98:99], v55 offset:256
    ds_read_b64_tr_b16 a[100:101], v55 offset:8192
    ds_read_b64_tr_b16 a[102:103], v55 offset:8448
    s_xor_b32 s78, s75, 0
    s_lshr_b32 s78, s78, s72
    s_add_u32 s78, s78, s67
    s_add_u32 s80, s66, 65536
    s_mov_b32 s76, 0
    s_mov_b32 s77, 8192
    s_call_b64 s[82:83], cf_dma
    ds_read_b64_tr_b16 a[104:105], v56 offset:0
    ds_read_b64_tr_b16 a[106:107], v56 offset:256
    ds_read_b64_tr_b16 a[108:109], v56 offset:8192
    ds_read_b64_tr_b16 a[110:111], v56 offset:8448
    s_mov_b32 s77, 16384
    s_call_b64 s[82:83], cf_dma
    s_waitcnt lgkmcnt(0)
    s_waitcnt vmcnt(12)
    v_add_u32 v55, 98304, v51
    v_xor_b32 v56, 32, v55
    ds_read_b64_tr_b16 a[112:113], v55 offset:0
    ds_read_b64_tr_b16 a[114:115], v55 offset:256
    ds_read_b64_tr_b16 a[116:117], v55 offset:8192
    ds_read_b64_tr_b16 a[118:119], v55 offset:8448
    s_mov_b32 s77, 24576
    s_call_b64 s[82:83], cf_dma
    ds_read_b64_tr_b16 a[120:121], v56 offset:0
    ds_read_b64_tr_b16 a[122:123], v56 offset:256
    ds_read_b64_tr_b16 a[124:125], v56 offset:8192
    ds_read_b64_tr_b16 a[126:127], v56 offset:8448
    s_mov_b32 s77, 32768
    s_call_b64 s[82:83], cf_dma
    s_waitcnt lgkmcnt(0)
    s_waitcnt vmcnt(8)
    v_add_u32 v55, 114688, v51
    v_xor_b32 v56, 32, v55
    ds_read_b64_tr_b16 a[16:17], v55 offset:0
    ds_read_b64_tr_b16 a[18:19], v55 offset:256
    ds_read_b64_tr_b16 a[20:21], v55 offset:8192
    ds_read_b64_tr_b16 a[22:23], v55 offset:8448
    s_xor_b32 s78, s75, 0
    s_lshr_b32 s78, s78, s72
    s_add_u32 s78, s78, s67
    s_mov_b64 s[8:9], s[52:53]
    s_add_u32 s80, s66, 0
    s_mov_b32 s76, 0
    s_mov_b32 s77, 8192
    s_call_b64 s[82:83], cf_dma
    ds_read_b64_tr_b16 a[24:25], v56 offset:0
    ds_read_b64_tr_b16 a[26:27], v56 offset:256
    ds_read_b64_tr_b16 a[28:29], v56 offset:8192
    ds_read_b64_tr_b16 a[30:31], v56 offset:8448
    s_mov_b32 s77, 16384
    s_call_b64 s[82:83], cf_dma
    s_waitcnt lgkmcnt(0)
    v_add_u32 v55, 131072, v51
    v_xor_b32 v56, 32, v55
    ds_read_b64_tr_b16 a[32:33], v55 offset:0
    ds_read_b64_tr_b16 a[34:35], v55 offset:256
    ds_read_b64_tr_b16 a[36:37], v55 offset:8192
    ds_read_b64_tr_b16 a[38:39], v55 offset:8448
    s_mov_b32 s77, 24576
    s_call_b64 s[82:83], cf_dma
    ds_read_b64_tr_b16 a[40:41], v56 offset:0
    ds_read_b64_tr_b16 a[42:43], v56 offset:256
    ds_read_b64_tr_b16 a[44:45], v56 offset:8192
    ds_read_b64_tr_b16 a[46:47], v56 offset:8448
    s_mov_b32 s77, 32768
    s_call_b64 s[82:83], cf_dma
    s_waitcnt lgkmcnt(0)
    s_waitcnt vmcnt(8)
    v_add_u32 v55, 65536, v51
    v_xor_b32 v56, 32, v55
    ds_read_b64_tr_b16 v[0:1], v55 offset:0
    ds_read_b64_tr_b16 v[2:3], v55 offset:256
    ds_read_b64_tr_b16 v[4:5], v55 offset:8192
    ds_read_b64_tr_b16 v[6:7], v55 offset:8448
    s_xor_b32 s78, s75, 1048576
    s_lshr_b32 s78, s78, s72
    s_add_u32 s78, s78, s67
    s_add_u32 s80, s66, 32768
    s_mov_b32 s76, 0
    s_mov_b32 s77, 8192
    s_call_b64 s[82:83], cf_dma
    ds_read_b64_tr_b16 v[8:9], v56 offset:0
    ds_read_b64_tr_b16 v[10:11], v56 offset:256
    ds_read_b64_tr_b16 v[12:13], v56 offset:8192
    ds_read_b64_tr_b16 v[14:15], v56 offset:8448
    s_mov_b32 s77, 16384
    s_call_b64 s[82:83], cf_dma
    s_waitcnt lgkmcnt(0)
    ds_write_b128 v62, v[0:3] offset:8192
    ds_write_b128 v62, v[4:7] offset:12288
    ds_write_b128 v62, v[8:11] offset:16384
    ds_write_b128 v62, v[12:15] offset:20480
    s_waitcnt lgkmcnt(0)
    v_add_u32 v55, 81920, v51
    v_xor_b32 v56, 32, v55
    ds_read_b64_tr_b16 a[0:1], v55 offset:0
    ds_read_b64_tr_b16 a[2:3], v55 offset:256
    ds_read_b64_tr_b16 a[4:5], v55 offset:8192
    ds_read_b64_tr_b16 a[6:7], v55 offset:8448
    s_mov_b32 s77, 24576
    s_call_b64 s[82:83], cf_dma
    ds_read_b64_tr_b16 a[8:9], v56 offset:0
    ds_read_b64_tr_b16 a[10:11], v56 offset:256
    ds_read_b64_tr_b16 a[12:13], v56 offset:8192
    ds_read_b64_tr_b16 a[14:15], v56 offset:8448
    s_mov_b32 s77, 32768
    s_call_b64 s[82:83], cf_dma
    s_waitcnt lgkmcnt(0)
    s_waitcnt vmcnt(8)
    v_add_u32 v55, 0, v51
    v_xor_b32 v56, 32, v55
    ds_read_b64_tr_b16 v[0:1], v55 offset:0
    ds_read_b64_tr_b16 v[2:3], v55 offset:256
    ds_read_b64_tr_b16 v[4:5], v55 offset:8192
    ds_read_b64_tr_b16 v[6:7], v55 offset:8448
    s_xor_b32 s94, s13, 0
    s_mul_i32 s94, s94, 36864
    s_add_u32 s94, s94, s92
    s_lshr_b32 s74, s13, 1
    s_lshl_b32 s74, s74, 6
    s_add_u32 s94, s94, s74
    s_add_u32 s78, s94, 1024
    s_mov_b64 s[8:9], s[56:57]
    v_mov_b32 v58, v50
    s_mov_b32 s79, 18432
    s_mov_b32 s81, 0
    s_add_u32 s80, s66, 147456
    s_mov_b32 s76, 0
    s_mov_b32 s77, 8192
    s_call_b64 s[82:83], cf_dma
    ds_read_b64_tr_b16 v[8:9], v56 offset:0
    ds_read_b64_tr_b16 v[10:11], v56 offset:256
    ds_read_b64_tr_b16 v[12:13], v56 offset:8192
    ds_read_b64_tr_b16 v[14:15], v56 offset:8448
    s_xor_b32 s94, s13, 2
    s_mul_i32 s94, s94, 36864
    s_add_u32 s94, s94, s92
    s_lshr_b32 s74, s13, 1
    s_lshl_b32 s74, s74, 6
    s_add_u32 s94, s94, s74
    s_add_u32 s78, s94, 1024
    s_mov_b32 s77, 16384
    s_call_b64 s[82:83], cf_dma
    s_waitcnt lgkmcnt(0)
    ds_write_b128 v61, v[0:3] offset:0
    ds_write_b128 v61, v[4:7] offset:4096
    ds_write_b128 v61, v[8:11] offset:8192
    ds_write_b128 v61, v[12:15] offset:12288
    s_waitcnt lgkmcnt(0)
    v_add_u32 v55, 16384, v51
    v_xor_b32 v56, 32, v55
    ds_read_b64_tr_b16 v[0:1], v55 offset:0
    ds_read_b64_tr_b16 v[2:3], v55 offset:256
    ds_read_b64_tr_b16 v[4:5], v55 offset:8192
    ds_read_b64_tr_b16 v[6:7], v55 offset:8448
    s_xor_b32 s94, s13, 3
    s_mul_i32 s94, s94, 36864
    s_add_u32 s94, s94, s92
    s_lshl_b32 s74, s13, 7
    s_add_u32 s94, s94, s74
    s_add_u32 s78, s94, 512
    v_mov_b32 v58, v49
    s_mov_b32 s79, 9216
    s_add_u32 s80, s66, 131072
    s_mov_b32 s76, 0
    s_mov_b32 s77, 8192
    s_call_b64 s[82:83], cf_dma
    ds_read_b64_tr_b16 v[8:9], v56 offset:0
    ds_read_b64_tr_b16 v[10:11], v56 offset:256
    ds_read_b64_tr_b16 v[12:13], v56 offset:8192
    ds_read_b64_tr_b16 v[14:15], v56 offset:8448
    s_mov_b32 s77, 16384
    s_call_b64 s[82:83], cf_dma
    s_waitcnt lgkmcnt(0)
    ds_write_b128 v61, v[0:3] offset:16384
    ds_write_b128 v61, v[4:7] offset:20480
    ds_write_b128 v61, v[8:11] offset:24576
    ds_write_b128 v61, v[12:15] offset:28672
    s_waitcnt lgkmcnt(0)
    s_waitcnt vmcnt(8)
    v_add_u32 v55, 32768, v51
    v_xor_b32 v56, 32, v55
    ds_read_b64_tr_b16 v[0:1], v55 offset:0
    ds_read_b64_tr_b16 v[2:3], v55 offset:256
    ds_read_b64_tr_b16 v[4:5], v55 offset:8192
    ds_read_b64_tr_b16 v[6:7], v55 offset:8448
    s_xor_b32 s94, s13, 2
    s_mul_i32 s94, s94, 36864
    s_add_u32 s94, s94, s92
    s_lshl_b32 s74, s13, 7
    s_add_u32 s94, s94, s74
    s_add_u32 s78, s94, 512
    s_add_u32 s80, s66, 114688
    s_mov_b32 s76, 0
    s_mov_b32 s77, 8192
    s_call_b64 s[82:83], cf_dma
    ds_read_b64_tr_b16 v[8:9], v56 offset:0
    ds_read_b64_tr_b16 v[10:11], v56 offset:256
    ds_read_b64_tr_b16 v[12:13], v56 offset:8192
    ds_read_b64_tr_b16 v[14:15], v56 offset:8448
    s_mov_b32 s77, 16384
    s_call_b64 s[82:83], cf_dma
    s_waitcnt lgkmcnt(0)
    ds_write_b128 v61, v[0:3] offset:32768
    ds_write_b128 v61, v[4:7] offset:36864
    ds_write_b128 v61, v[8:11] offset:40960
    ds_write_b128 v61, v[12:15] offset:45056
    s_waitcnt lgkmcnt(0)
    v_add_u32 v55, 49152, v51
    v_xor_b32 v56, 32, v55
    ds_read_b64_tr_b16 v[0:1], v55 offset:0
    ds_read_b64_tr_b16 v[2:3], v55 offset:256
    ds_read_b64_tr_b16 v[4:5], v55 offset:8192
    ds_read_b64_tr_b16 v[6:7], v55 offset:8448
    s_lshr_b32 s78, 4194304, s72
    s_add_u32 s78, s78, s67
    s_mov_b64 s[8:9], s[52:53]
    v_mov_b32 v58, v48
    s_lshr_b32 s79, 131072, s72
    s_add_u32 s80, s66, 81920
    s_mov_b32 s76, 0
    s_mov_b32 s77, 8192
    s_call_b64 s[82:83], cf_dma
    ds_read_b64_tr_b16 v[8:9], v56 offset:0
    ds_read_b64_tr_b16 v[10:11], v56 offset:256
    ds_read_b64_tr_b16 v[12:13], v56 offset:8192
    ds_read_b64_tr_b16 v[14:15], v56 offset:8448
    s_mov_b32 s77, 16384
    s_call_b64 s[82:83], cf_dma
    s_waitcnt lgkmcnt(0)
    ds_write_b128 v61, v[0:3] offset:49152
    ds_write_b128 v61, v[4:7] offset:53248
    ds_write_b128 v61, v[8:11] offset:57344
    ds_write_b128 v61, v[12:15] offset:61440
    s_waitcnt lgkmcnt(0)
    buffer_load_dword v24, off, s[96:99], 0 offset:140 sc1
    buffer_load_dword v25, off, s[96:99], 0 offset:64 sc1
    s_lshr_b32 s84, s12, 1
    s_lshl_b32 s84, s84, 8
    s_add_u32 s84, s84, 125829120
    v_bfe_u32 v26, v61, 4, 6
    v_min_u32 v26, 11, v26
    v_lshlrev_b32 v26, 2, v26
    buffer_load_dword v27, v26, s[4:7], s84 offen sc1
    s_waitcnt vmcnt(15)
    v_add_u32 v55, 147456, v53
    ds_read_b64_tr_b16 v[0:1], v55 offset:0
    ds_read_b64_tr_b16 v[2:3], v55 offset:128
    ds_read_b64_tr_b16 v[4:5], v55 offset:512
    ds_read_b64_tr_b16 v[6:7], v55 offset:640
    ds_read_b64_tr_b16 v[8:9], v55 offset:8192
    ds_read_b64_tr_b16 v[10:11], v55 offset:8320
    ds_read_b64_tr_b16 v[12:13], v55 offset:8704
    ds_read_b64_tr_b16 v[14:15], v55 offset:8832
    s_waitcnt lgkmcnt(0)
    s_barrier
    ds_write_b128 v63, v[0:3] offset:49152
    ds_write_b128 v63, v[4:7] offset:53248
    s_barrier
    ds_write_b128 v63, v[8:11] offset:57344
    ds_write_b128 v63, v[12:15] offset:61440
    s_waitcnt lgkmcnt(0)
    v_lshlrev_b32 v45, 3, v61
    s_lshl_b32 s40, s12, 14
    s_add_u32 s40, s40, 65536
    s_lshl_b32 s41, s12, 11
    s_sub_u32 s41, s41, 12288
    v_add_u32 v30, s40, v45
    v_add_u32 v45, s41, v45
    v_cmp_gt_u32 vcc, 1536, v61
    s_nop 1
    v_cndmask_b32 v45, v45, v30, vcc
    s_lshl_b32 s40, s12, 16
    s_add_u32 s40, s40, 25151488
    v_lshlrev_b32 v30, 3, v61
    v_add_u32 v30, s40, v30
    v_cmp_gt_u32 vcc, 1792, v61
    s_nop 1
    v_cndmask_b32 v45, v30, v45, vcc
    v_cmp_gt_u32 vcc, 2944, v61
    s_mov_b32 s40, 67108864
    s_mov_b64 exec, vcc
    buffer_load_dword v30, v45, s[4:7], s40 offen sc1
    s_mov_b64 exec, -1
    s_waitcnt vmcnt(11)
    v_add_u32 v55, 131072, v52
    ds_read_b64_tr_b16 v[0:1], v55 offset:0
    ds_read_b64_tr_b16 v[2:3], v55 offset:256
    ds_read_b64_tr_b16 v[4:5], v55 offset:4096
    ds_read_b64_tr_b16 v[6:7], v55 offset:4352
    ds_read_b64_tr_b16 v[8:9], v55 offset:64
    ds_read_b64_tr_b16 v[10:11], v55 offset:320
    ds_read_b64_tr_b16 v[12:13], v55 offset:4160
    ds_read_b64_tr_b16 v[14:15], v55 offset:4416
    s_waitcnt lgkmcnt(0)
    s_barrier
    ds_write_b128 v63, v[0:3] offset:32768
    ds_write_b128 v63, v[4:7] offset:36864
    s_barrier
    ds_write_b128 v63, v[8:11] offset:40960
    ds_write_b128 v63, v[12:15] offset:45056
    s_waitcnt lgkmcnt(0)
    s_waitcnt vmcnt(7)
    v_add_u32 v55, 114688, v52
    ds_read_b64_tr_b16 v[0:1], v55 offset:0
    ds_read_b64_tr_b16 v[2:3], v55 offset:256
    ds_read_b64_tr_b16 v[4:5], v55 offset:4096
    ds_read_b64_tr_b16 v[6:7], v55 offset:4352
    ds_read_b64_tr_b16 v[8:9], v55 offset:64
    ds_read_b64_tr_b16 v[10:11], v55 offset:320
    ds_read_b64_tr_b16 v[12:13], v55 offset:4160
    ds_read_b64_tr_b16 v[14:15], v55 offset:4416
    s_waitcnt lgkmcnt(0)
    s_barrier
    ds_write_b128 v63, v[0:3] offset:16384
    ds_write_b128 v63, v[4:7] offset:20480
    s_barrier
    ds_write_b128 v63, v[8:11] offset:24576
    ds_write_b128 v63, v[12:15] offset:28672
    s_waitcnt lgkmcnt(0)
    v_min_u32 v36, -2, v36
    v_min_u32 v37, -2, v37
    v_min_u32 v38, -2, v38
    v_min_u32 v39, -2, v39
    v_min_u32 v40, -2, v40
    v_min_u32 v41, -2, v41
    v_min_u32 v42, -2, v42
    v_min_u32 v43, -2, v43
    v_min_u32 v44, -2, v44
    s_lshl_b32 s14, s12, 16
    s_add_u32 s14, s14, 92274688
    s_add_u32 s41, s14, 4096
    s_add_u32 s42, s14, 8192
    v_lshrrev_b32 v45, 2, v61
    buffer_store_dwordx4 v[36:39], v61, s[4:7], s14 offen
    buffer_store_dwordx4 v[40:43], v61, s[4:7], s41 offen
    buffer_store_dword v44, v45, s[4:7], s42 offen
    s_waitcnt vmcnt(1)
    v_readfirstlane_b32 s95, v25
    v_readfirstlane_b32 s85, v24
    s_add_u32 s86, s95, 2
    s_waitcnt vmcnt(0)
    v_subrev_u32 v27, s86, v27
    v_cmp_lt_u32 s[86:87], 64, v27
    s_cmp_eq_u32 s95, 0
    s_cselect_b64 s[86:87], -1, s[86:87]
    s_cmp_lg_u64 s[86:87], 0
    s_cbranch_scc1 cf_nt
    s_add_u32 s40, s24, 524288
    buffer_load_dword v30, v79, s[4:7], s24 offen sc1
    buffer_load_dword v30, v79, s[4:7], s40 offen sc1
cf_nt:
    s_waitcnt vmcnt(3)
    v_add_u32 v55, 81920, v51
    v_xor_b32 v56, 32, v55
    ds_read_b64_tr_b16 v[0:1], v55 offset:0
    ds_read_b64_tr_b16 v[2:3], v55 offset:256
    ds_read_b64_tr_b16 v[4:5], v55 offset:8192
    ds_read_b64_tr_b16 v[6:7], v55 offset:8448
    ds_read_b64_tr_b16 v[8:9], v56 offset:0
    ds_read_b64_tr_b16 v[10:11], v56 offset:256
    ds_read_b64_tr_b16 v[12:13], v56 offset:8192
    ds_read_b64_tr_b16 v[14:15], v56 offset:8448
    s_waitcnt lgkmcnt(0)
    ds_write_b128 v62, v[0:3] offset:24576
    ds_write_b128 v62, v[4:7] offset:28672
    ds_write_b128 v62, v[8:11] offset:32768
    ds_write_b128 v62, v[12:15] offset:36864
    s_waitcnt lgkmcnt(0)
    s_barrier
    s_mov_b32 s88, 4194304
gn2:
    s_cmp_lg_u32 s95, 0
    s_cbranch_scc1 gn2x
    buffer_load_dword v27, off, s[96:99], 0 offset:64 sc1
    s_sub_u32 s88, s88, 1
    s_cbranch_scc1 gn2x
    s_waitcnt vmcnt(0)
    v_readfirstlane_b32 s95, v27
    s_nop 1
    s_branch gn2
gn2x:
    ds_write_b128 v78, v[16:19] offset:8704
    ds_write_b128 v65, v[20:23] offset:10240
    v_mov_b32 v44, s95
    v_mov_b32 v45, s95
    v_mov_b32 v46, s95
    v_mov_b32 v47, s95
    v_mov_b32 v48, 108288
    ds_write_b128 v48, v[44:47]
    s_waitcnt vmcnt(0) lgkmcnt(0)
    s_cmp_eq_u32 s85, 1
    s_cbranch_scc1 cf_run
    s_mov_b32 s40, 131072
cf_startpoll:
    buffer_load_dword v3, off, s[96:99], 0 offset:140 sc1
    s_waitcnt vmcnt(0)
    v_readfirstlane_b32 s85, v3
    s_nop 0
    s_cmp_eq_u32 s85, 1
    s_cbranch_scc1 cf_run
    s_cmp_eq_u32 s85, 2
    s_cbranch_scc1 cf_leave
    s_sleep 1
    s_sub_u32 s40, s40, 1
    s_cbranch_scc0 cf_startpoll
    v_mov_b32 v4, 2
    v_mov_b32 v5, 0
    s_mov_b64 exec, 1
    buffer_atomic_cmpswap v[4:5], off, s[96:99], 0 offset:140
    s_mov_b64 exec, -1
    s_mov_b32 s40, 1048576
    s_branch cf_startpoll
cf_leave:
    v_lshrrev_b32 v0, 4, v61
    s_mov_b32 s32, s13
    s_load_dwordx16 s[48:63], s[0:1], 0
    s_waitcnt lgkmcnt(0)
    s_branch L_helper
cf_run:
    s_cmp_eq_u64 s[86:87], 0
    s_cbranch_scc1 cf_kvok
    s_lshr_b32 s92, s12, 1
    s_lshl_b32 s92, s92, 8
    s_add_u32 s92, s92, 125829120
    v_bfe_u32 v2, v61, 4, 6
    v_min_u32 v2, 11, v2
    v_lshlrev_b32 v2, 2, v2
    s_add_u32 s93, s95, 2
    s_mov_b32 s94, 4194304
cf_kv0:
    buffer_load_dword v3, v2, s[4:7], s92 offen sc1
    s_sub_u32 s94, s94, 1
    s_cbranch_scc1 cf_kv0_go
    s_waitcnt vmcnt(0)
    v_subrev_u32 v3, s93, v3
    v_cmp_lt_u32 vcc, 64, v3
    s_cbranch_vccz cf_kv0_go
    s_sleep 2
    s_branch cf_kv0
cf_kv0_go:
    s_add_u32 s40, s24, 524288
    buffer_load_dword v30, v79, s[4:7], s24 offen sc1
    buffer_load_dword v30, v79, s[4:7], s40 offen sc1
    s_waitcnt vmcnt(0)
cf_kvok:
    s_mov_b32 m0, 108032
    s_add_u32 s24, s24, 1048576
    s_add_u32 s15, s14, 4096
    s_add_u32 s16, s14, 8192
    ds_read_b128 v[32:35], v62 offset:16384
    ds_read_b128 v[36:39], v62 offset:20480
    ds_read_b128 v[40:43], v61 offset:0
    ds_read_b128 v[44:47], v61 offset:4096
    ds_read_b128 v[48:51], v61 offset:8192
    ds_read_b128 v[52:55], v61 offset:12288
    s_mov_b32 s29, 1048576
    buffer_load_dwordx4 v[24:27], v61, s[4:7], s14 offen nt
.p2align 6
cf_loop:
    v_mov_b64 v[0:1], 0
    v_mov_b64 v[2:3], 0
    v_mov_b64 v[4:5], 0
    v_mov_b64 v[6:7], 0
    v_mov_b64 v[8:9], 0
    v_mov_b64 v[10:11], 0
    v_mov_b64 v[12:13], 0
    v_mov_b64 v[14:15], 0
cf_loop2:
    ds_read_b128 v[16:19], v62 offset:8192
    ds_read_b128 v[20:23], v62 offset:12288
    v_lshrrev_b32 v56, 2, v61
    v_add_u32 v58, 106496, v56
    s_mov_b32 s29, 1048576
    s_nop 13
    buffer_load_dwordx4 v[24:27], v61, s[4:7], s14 offen nt
    s_waitcnt lgkmcnt(0)
cf_chk0:
    s_waitcnt vmcnt(1)
cf_chk0b:
    v_max3_u32 v57, v24, v25, v26
    v_max_u32 v57, v57, v27
    v_cmp_eq_u32 vcc, -1, v57
    ds_write_b128 v62, v[24:27] offset:40960
    s_cbranch_vccnz cf_spin0
    v_smfmac_f32_16x16x64_bf16 v[0:3], v[24:27], v[16:23], v60
    buffer_load_dwordx4 v[28:31], v61, s[4:7], s15 offen nt
    buffer_load_dword v59, v56, s[4:7], s16 offen nt
    v_smfmac_f32_16x16x64_bf16 v[8:11], v[24:27], v[32:39], v60
    ds_read_b128 v[32:35], v61 offset:16384
    v_smfmac_f32_16x16x64_bf16 v[12:15], v[24:27], v[48:55], v60
    ds_read_b128 v[36:39], v61 offset:20480
    v_mfma_f32_16x16x16_bf16 v[16:19], v[72:73], v[72:73], 0
    s_waitcnt lgkmcnt(2)
    s_barrier
    ds_read_b128 v[48:51], v63 offset:0
    v_mfma_f32_16x16x16_bf16 v[20:23], v[72:73], v[72:73], 0
    ds_read_b128 v[52:55], v64 offset:0
    v_smfmac_f32_16x16x64_bf16 v[4:7], v[24:27], v[40:47], v60
    ds_read_b128 v[40:43], v61 offset:24576
    v_smfmac_f32_16x16x64_bf16 v[16:19], v[24:27], a[192:199], v60
    ds_read_b128 v[44:47], v61 offset:28672
    v_smfmac_f32_16x16x64_bf16 v[20:23], v[24:27], a[200:207], v60
    s_waitcnt lgkmcnt(3)
    v_smfmac_f32_16x16x64_bf16 v[0:3], v[48:51], a[0:7], v60
    s_add_u32 s18, s14, s31
    s_add_u32 s41, s14, 16384
    v_smfmac_f32_16x16x64_bf16 v[4:7], v[48:51], v[32:39], v60
    ds_read_b128 v[32:35], v61 offset:32768
    v_smfmac_f32_16x16x64_bf16 v[8:11], v[48:51], a[8:15], v60
    ds_read_b128 v[36:39], v61 offset:36864
    s_waitcnt lgkmcnt(2)
    v_smfmac_f32_16x16x64_bf16 v[12:15], v[48:51], v[40:47], v60
    ds_read_b128 v[40:43], v61 offset:40960
    v_smfmac_f32_16x16x64_bf16 v[0:3], v[52:55], a[16:23], v60
    ds_read_b128 v[44:47], v61 offset:45056
    v_smfmac_f32_16x16x64_bf16 v[8:11], v[52:55], a[24:31], v60
    ds_read_b128 v[48:51], v71 offset:0
    s_waitcnt lgkmcnt(3)
    v_smfmac_f32_16x16x64_bf16 v[4:7], v[52:55], v[32:39], v60
    s_waitcnt vmcnt(0)
    ds_write_b128 v62, v[28:31] offset:45056
    s_waitcnt lgkmcnt(2)
    v_smfmac_f32_16x16x64_bf16 v[12:15], v[52:55], v[40:47], v60
    ds_write_b32 v58, v59
    v_max3_u32 v57, v28, v29, v30
    s_waitcnt lgkmcnt(2)
    v_smfmac_f32_16x16x64_bf16 v[0:3], v[48:51], a[32:39], v60
    ds_read_b128 v[32:35], v61 offset:49152
    v_max3_u32 v57, v57, v31, v59
    v_smfmac_f32_16x16x64_bf16 v[8:11], v[48:51], a[40:47], v60
    ds_read_b128 v[36:39], v61 offset:53248
    v_cmp_eq_u32 vcc, -1, v57
    v_smfmac_f32_16x16x64_bf16 v[16:19], v[52:55], a[224:231], v60
    ds_read_b128 v[40:43], v61 offset:57344
    v_smfmac_f32_16x16x64_bf16 v[20:23], v[52:55], a[232:239], v60
    ds_read_b128 v[44:47], v61 offset:61440
    s_cbranch_vccnz cf_spin1
cf_go1:
    v_smfmac_f32_16x16x64_bf16 v[0:3], v[28:31], a[48:55], v60
    s_waitcnt lgkmcnt(4)
    s_barrier
    ds_read_b128 v[52:55], v63 offset:4096
    v_smfmac_f32_16x16x64_bf16 v[8:11], v[28:31], a[56:63], v60
    ds_read_b128 v[56:59], v71 offset:4096
    v_smfmac_f32_16x16x64_bf16 v[4:7], v[28:31], a[128:135], v60
    s_waitcnt lgkmcnt(2)
    v_smfmac_f32_16x16x64_bf16 v[4:7], v[48:51], v[32:39], v60
    buffer_load_dwordx4 v[32:35], v61, s[4:7], s23 offen offset:0 sc1
    v_smfmac_f32_16x16x64_bf16 v[12:15], v[48:51], v[40:47], v60
    ds_read_b128 v[48:51], v64 offset:4096
    v_smfmac_f32_16x16x64_bf16 v[12:15], v[28:31], a[136:143], v60
    ds_read_b128 v[24:27], v65 offset:8192
    s_and_b32 s41, s41, 65535
    s_add_u32 s41, s41, 67108864
    v_smfmac_f32_16x16x64_bf16 v[16:19], v[28:31], v[80:87], v60
    buffer_load_dwordx4 v[36:39], v61, s[4:7], s23 offen offset:1024 sc1
    v_smfmac_f32_16x16x64_bf16 v[20:23], v[28:31], v[88:95], v60
    s_add_u32 s17, s41, s31
    s_and_b32 s30, s28, 1
    s_waitcnt lgkmcnt(3)
    v_smfmac_f32_16x16x64_bf16 v[0:3], v[52:55], a[64:71], v60
    ds_read_b128 v[28:31], v78 offset:8704
    v_smfmac_f32_16x16x64_bf16 v[4:7], v[52:55], a[144:151], v60
    buffer_load_dwordx4 v[40:43], v61, s[4:7], s23 offen offset:2048 sc1
    v_smfmac_f32_16x16x64_bf16 v[8:11], v[52:55], a[72:79], v60
    v_smfmac_f32_16x16x64_bf16 v[12:15], v[52:55], a[152:159], v60
    v_smfmac_f32_16x16x64_bf16 v[16:19], v[52:55], v[96:103], v60
    buffer_load_dwordx4 v[44:47], v61, s[4:7], s23 offen offset:3072 sc1
    v_smfmac_f32_16x16x64_bf16 v[20:23], v[52:55], v[104:111], v60
    ds_read_b128 v[52:55], v62 offset:28672
    s_waitcnt lgkmcnt(3)
    v_smfmac_f32_16x16x64_bf16 v[0:3], v[48:51], a[80:87], v60
    v_smfmac_f32_16x16x64_bf16 v[4:7], v[48:51], a[160:167], v60
    v_smfmac_f32_16x16x64_bf16 v[8:11], v[48:51], a[88:95], v60
    v_smfmac_f32_16x16x64_bf16 v[12:15], v[48:51], a[168:175], v60
    v_smfmac_f32_16x16x64_bf16 v[16:19], v[48:51], v[112:119], v60
    buffer_load_dword v79, s[4:7], s24 offen sc1 lds
    v_smfmac_f32_16x16x64_bf16 v[20:23], v[48:51], v[120:127], v60
    ds_read_b128 v[48:51], v62 offset:24576
    v_smfmac_f32_16x16x64_bf16 v[0:3], v[56:59], a[96:103], v60
    s_cmp_ge_u32 s28, 62
    v_smfmac_f32_16x16x64_bf16 v[8:11], v[56:59], a[104:111], v60
    s_waitcnt lgkmcnt(3)
    v_smfmac_f32_16x16x64_bf16 v[0:3], v[24:27], a[112:119], v60
    v_smfmac_f32_16x16x64_bf16 v[8:11], v[24:27], a[120:127], v60
    v_smfmac_f32_16x16x64_bf16 v[4:7], v[56:59], a[176:183], v60
    s_waitcnt lgkmcnt(0)
    v_cvt_pk_bf16_f32 v0, v0, v1
    v_smfmac_f32_16x16x64_bf16 v[4:7], v[24:27], v[48:55], v60
    ds_read_b128 v[48:51], v62 offset:32768
    v_cvt_pk_bf16_f32 v8, v8, v9
    v_smfmac_f32_16x16x64_bf16 v[12:15], v[56:59], a[184:191], v60
    ds_read_b128 v[52:55], v62 offset:36864
    v_cvt_pk_bf16_f32 v9, v10, v11
    v_smfmac_f32_16x16x64_bf16 v[16:19], v[56:59], v[128:135], v60
    v_cvt_pk_bf16_f32 v1, v2, v3
    v_mfma_f32_16x16x16_bf16 v[8:11], v[8:9], v[28:29], 0
    v_cvt_pk_bf16_f32 v2, v4, v5
    v_cvt_pk_bf16_f32 v3, v6, v7
    v_smfmac_f32_16x16x64_bf16 v[20:23], v[56:59], v[136:143], v60
    s_mov_b64 exec, s[36:37]
    ds_read_b128 v[56:59], v69
    s_mov_b64 exec, -1
    v_mfma_f32_16x16x32_bf16 v[4:7], v[0:3], v[28:31], 0
    v_cvt_pk_bf16_f32 v2, v8, v9
    s_waitcnt lgkmcnt(1)
    v_smfmac_f32_16x16x64_bf16 v[12:15], v[24:27], v[48:55], v60
    ds_read_b128 v[48:51], v63 offset:0
    v_cvt_pk_bf16_f32 v3, v10, v11
    s_waitcnt vmcnt(3)
    v_cvt_pk_bf16_f32 v0, v4, v5
    v_cvt_pk_bf16_f32 v1, v6, v7
    s_nop 1
    v_mfma_f32_16x16x32_bf16 v[4:7], v[36:39], v[0:3], 0
    v_cvt_pk_bf16_f32 v12, v12, v13
    v_cvt_pk_bf16_f32 v13, v14, v15
    s_nop 1
    v_mfma_f32_16x16x16_bf16 v[12:15], v[12:13], v[30:31], 0
    ds_read_b128 v[52:55], v71 offset:0
    ds_read_b128 v[36:39], v63 offset:53248
    v_mfma_f32_16x16x32_bf16 v[28:31], v[32:35], v[0:3], 0
    s_waitcnt vmcnt(1)
    ds_read_b128 v[32:35], v63 offset:49152
    s_mov_b64 exec, s[34:35]
    s_nop 0
    v_cvt_pk_bf16_f32 v2, v12, v13
    v_cvt_pk_bf16_f32 v3, v14, v15
    s_mov_b64 exec, -1
    s_nop 0
    v_mfma_f32_16x16x32_bf16 v[8:11], v[0:3], v[0:3], 0
    v_mov_b32_dpp v28, v4 row_ror:8 row_mask:0xf bank_mask:0xc
    v_mov_b32_dpp v29, v5 row_ror:8 row_mask:0xf bank_mask:0xc
    v_mov_b32_dpp v30, v6 row_ror:8 row_mask:0xf bank_mask:0xc
    v_mov_b32_dpp v31, v7 row_ror:8 row_mask:0xf bank_mask:0xc
    v_smfmac_f32_16x16x64_bf16 v[16:19], v[24:27], v[144:151], v60
    ds_write_b128 v62, v[28:31] offset:53248
    v_mov_b32_dpp v8, v10 row_ror:8 row_mask:0xf bank_mask:0xc
    v_mov_b32_dpp v9, v11 row_ror:8 row_mask:0xf bank_mask:0xc
    v_smfmac_f32_16x16x64_bf16 v[20:23], v[24:27], v[152:159], v60
    ds_write_b64 v70, v[8:9]
    s_waitcnt lgkmcnt(5)
    v_smfmac_f32_16x16x64_bf16 v[16:19], v[48:51], a[208:215], v60
    s_mov_b64 exec, s[36:37]
    buffer_store_dwordx4 v[56:59], v61, s[4:7], s65 offen sc1
    s_mov_b64 exec, -1
    v_smfmac_f32_16x16x64_bf16 v[20:23], v[48:51], a[216:223], v60
    s_cbranch_scc1 cf_last
cf_back:
    s_waitcnt lgkmcnt(0)
    s_barrier
    ds_read_b128 v[56:59], v78 offset:10752
    v_smfmac_f32_16x16x64_bf16 v[16:19], v[52:55], a[240:247], v60
    ds_read_b128 v[12:15], v78 offset:11264
    ds_read_b128 v[4:7], v63 offset:12288
    v_smfmac_f32_16x16x64_bf16 v[20:23], v[52:55], a[248:255], v60
    ds_read_b128 v[8:11], v64 offset:12288
    ds_read_b128 v[0:3], v71 offset:12288
    v_mov_b64 v[24:25], s[62:63]
    v_mov_b64 v[26:27], s[60:61]
    v_cvt_pk_bf16_f32 v16, v16, v17
    v_cvt_pk_bf16_f32 v17, v18, v19
    v_pk_mul_f32 v[28:29], v[28:29], s[44:45]
    v_pk_mul_f32 v[30:31], v[30:31], s[44:45]
    s_waitcnt lgkmcnt(3)
    v_pk_add_f32 v[56:57], v[56:57], v[58:59]
    v_pk_add_f32 v[12:13], v[12:13], v[14:15]
    v_pk_add_f32 v[56:57], v[56:57], v[12:13]
    v_pk_mul_f32 v[56:57], v[56:57], s[44:45]
    v_exp_f32 v58, v56
    v_exp_f32 v59, v57
    s_waitcnt lgkmcnt(1)
    v_pk_fma_f32 v[28:29], v[4:5], s[44:45], v[28:29]
    v_pk_fma_f32 v[30:31], v[6:7], s[44:45], v[30:31]
    v_cvt_pk_bf16_f32 v6, v58, v59
    v_pk_fma_f32 v[28:29], v[8:9], s[44:45], v[28:29]
    v_pk_fma_f32 v[30:31], v[10:11], s[44:45], v[30:31]
    s_waitcnt lgkmcnt(0)
    v_pk_fma_f32 v[28:29], v[0:1], s[44:45], v[28:29]
    v_mov_b32_dpp v7, v6 row_ror:8 row_mask:0xf bank_mask:0xf
    v_pk_fma_f32 v[30:31], v[2:3], s[44:45], v[30:31]
    v_exp_f32 v0, v28
    v_mfma_f32_16x16x16_bf16 v[12:15], v[16:17], v[6:7], 0
    ds_read_b128 v[48:51], v63 offset:57344
    v_exp_f32 v1, v29
    v_cvt_pk_bf16_f32 v18, v20, v21
    v_exp_f32 v2, v30
    v_cvt_pk_bf16_f32 v19, v22, v23
    v_cvt_pk_bf16_f32 v8, v0, v1
    v_exp_f32 v3, v31
    v_mfma_f32_16x16x16_bf16 v[20:23], v[18:19], v[6:7], 0
    ds_read_b128 v[52:55], v63 offset:61440
    v_cvt_pk_bf16_f32 v9, v2, v3
    v_mov_b32_dpp v10, v8 row_ror:8 row_mask:0xf bank_mask:0xf
    v_max3_f32 v4, |v28|, |v29|, |v30|
    v_mov_b32_dpp v11, v9 row_ror:8 row_mask:0xf bank_mask:0xf
    v_mfma_f32_16x16x32_bf16 v[0:3], v[24:27], v[6:9], 0
    v_max3_f32 v4, v4, |v31|, |v56|
    v_max_f32_e64 v4, v4, |v57|
    v_mfma_f32_16x16x32_bf16 v[12:15], v[40:43], v[8:11], v[12:15]
    v_cmp_nge_f32 vcc, s46, v4
    v_mfma_f32_16x16x32_bf16 v[20:23], v[44:47], v[8:11], v[20:23]
    v_add_f32_dpp v0, v0, v0 row_ror:8 row_mask:0xf bank_mask:0xf
    v_rcp_f32 v0, v0
    s_cbranch_vccnz cf_guard
cf_norm:
    v_mfma_f32_16x16x16_bf16 v[28:31], v[72:73], v[72:73], 0
    v_mul_f32 v12, v12, v0
    v_mul_f32 v13, v13, v0
    v_mul_f32 v14, v14, v0
    v_mul_f32 v15, v15, v0
    v_mul_f32_dpp v12, v20, v0 row_ror:8 row_mask:0xf bank_mask:0xc
    v_mul_f32_dpp v13, v21, v0 row_ror:8 row_mask:0xf bank_mask:0xc
    v_mul_f32_dpp v14, v22, v0 row_ror:8 row_mask:0xf bank_mask:0xc
    v_mul_f32_dpp v15, v23, v0 row_ror:8 row_mask:0xf bank_mask:0xc
    v_cvt_pk_bf16_f32 v12, v12, v13
    v_cvt_pk_bf16_f32 v13, v14, v15
    v_mfma_f32_16x16x16_bf16 v[8:11], v[72:73], v[72:73], 0
    ds_write_b64 v77, v[12:13]
    v_mfma_f32_16x16x16_bf16 v[4:7], v[72:73], v[72:73], 0
    ds_read_b128 v[0:3], v68
    v_mfma_f32_16x16x16_bf16 v[16:19], v[72:73], v[72:73], 0
    ds_read_b128 v[40:43], v63 offset:16384
    v_mfma_f32_16x16x16_bf16 v[20:23], v[72:73], v[72:73], 0
    ds_read_b128 v[44:47], v63 offset:20480
    s_waitcnt lgkmcnt(3)
    s_barrier
    ds_read_b128 v[24:27], v74
    ds_read_b128 v[12:15], v75
    ds_read_b128 v[56:59], v76
    s_waitcnt lgkmcnt(5)
    v_smfmac_f32_16x16x64_bf16 v[28:31], v[0:3], v[160:167], v60
    v_smfmac_f32_16x16x64_bf16 v[8:11], v[0:3], v[192:199], v60
    v_smfmac_f32_16x16x64_bf16 v[4:7], v[0:3], v[32:39], v60
    ds_read_b128 v[32:35], v63 offset:32768
    v_smfmac_f32_16x16x64_bf16 v[16:19], v[0:3], v[224:231], v60
    ds_read_b128 v[36:39], v63 offset:36864
    s_waitcnt lgkmcnt(3)
    v_smfmac_f32_16x16x64_bf16 v[28:31], v[24:27], v[168:175], v60
    v_smfmac_f32_16x16x64_bf16 v[4:7], v[12:15], v[48:55], v60
    ds_read_b128 v[48:51], v63 offset:24576
    v_smfmac_f32_16x16x64_bf16 v[28:31], v[12:15], v[176:183], v60
    ds_read_b128 v[52:55], v63 offset:28672
    s_waitcnt lgkmcnt(4)
    v_smfmac_f32_16x16x64_bf16 v[28:31], v[56:59], v[184:191], v60
    v_cvt_pk_bf16_f32 v4, v4, v5
    v_smfmac_f32_16x16x64_bf16 v[16:19], v[12:15], v[40:47], v60
    ds_read_b128 v[40:43], v63 offset:40960
    v_and_or_b32 v4, v4, -2, s30
    v_smfmac_f32_16x16x64_bf16 v[8:11], v[24:27], v[200:207], v60
    ds_read_b128 v[44:47], v63 offset:45056
    v_cvt_pk_bf16_f32 v5, v6, v7
    v_smfmac_f32_16x16x64_bf16 v[8:11], v[12:15], v[208:215], v60
    buffer_store_dwordx2 v[4:5], v67, s[4:7], s22 offen
    v_cvt_pk_bf16_f32 v28, v28, v29
    v_smfmac_f32_16x16x64_bf16 v[8:11], v[56:59], v[216:223], v60
    v_and_or_b32 v28, v28, -2, s30
    v_smfmac_f32_16x16x64_bf16 v[16:19], v[24:27], v[232:239], v60
    v_cvt_pk_bf16_f32 v29, v30, v31
    s_waitcnt lgkmcnt(4)
    v_smfmac_f32_16x16x64_bf16 v[16:19], v[56:59], v[32:39], v60
    buffer_store_dwordx2 v[28:29], v66, s[4:7], s20 offen
    v_cvt_pk_bf16_f32 v8, v8, v9
    s_waitcnt lgkmcnt(0)
    v_smfmac_f32_16x16x64_bf16 v[20:23], v[0:3], v[240:247], v60
    v_and_or_b32 v8, v8, -2, s30
    v_smfmac_f32_16x16x64_bf16 v[20:23], v[24:27], v[248:255], v60
    v_cvt_pk_bf16_f32 v9, v10, v11
    v_smfmac_f32_16x16x64_bf16 v[20:23], v[12:15], v[48:55], v60
    buffer_store_dwordx2 v[8:9], v66, s[4:7], s21 offen
    v_cvt_pk_bf16_f32 v16, v16, v17
    v_smfmac_f32_16x16x64_bf16 v[20:23], v[56:59], v[40:47], v60
    v_and_or_b32 v16, v16, -2, s30
    v_cvt_pk_bf16_f32 v17, v18, v19
    buffer_store_dwordx2 v[16:17], v66, s[4:7], s38 offen
    s_cmp_lg_u32 s13, 2
    s_nop 1
    v_cvt_pk_bf16_f32 v20, v20, v21
    v_and_or_b32 v20, v20, -2, s30
    v_cvt_pk_bf16_f32 v21, v22, v23
    buffer_store_dwordx2 v[20:21], v66, s[4:7], s39 offen
    s_cbranch_scc1 cf_w013
    s_nop 15
    s_nop 15
    s_nop 15
    s_nop 15
    s_nop 7
    buffer_load_dwordx4 v[40:43], v65, s[4:7], s19 offen offset:0 nt
    buffer_load_dwordx4 v[44:47], v65, s[4:7], s19 offen offset:1024 nt
    buffer_load_dwordx4 v[48:51], v65, s[4:7], s19 offen offset:2048 nt
    buffer_load_dwordx4 v[52:55], v65, s[4:7], s19 offen offset:3072 nt
    ds_read_b128 v[56:59], v65 offset:10240
    s_add_u32 s28, s28, 1
    s_mov_b32 s14, s41
    s_add_u32 s23, s23, 524288
    s_add_u32 s24, s24, 524288
    s_min_u32 s24, s24, s47
    s_add_u32 s15, s14, 4096
    s_add_u32 s16, s14, 8192
    v_mov_b32 v21, -1
    s_add_u32 s65, s65, 12288
    s_mov_b32 s40, 1
    v_mov_b64 v[0:1], 0
    v_mov_b64 v[2:3], 0
    v_mov_b64 v[4:5], 0
    v_mov_b64 v[6:7], 0
    v_mov_b64 v[8:9], 0
    v_mov_b64 v[10:11], 0
    v_mov_b64 v[12:13], 0
    v_mov_b64 v[14:15], 0
cf_chkF:
    v_mov_b32 v20, 0
    s_waitcnt vmcnt(3)
    s_waitcnt lgkmcnt(0)
    v_mfma_f32_16x16x32_bf16 v[28:31], v[40:43], v[56:59], 0
    v_bitop3_b32 v20, v20, v40, s30 bitop3:0xf6
    v_bitop3_b32 v20, v20, v42, s30 bitop3:0xf6
    s_waitcnt vmcnt(2)
    v_mfma_f32_16x16x32_bf16 v[28:31], v[44:47], v[56:59], v[28:31]
    v_bitop3_b32 v20, v20, v44, s30 bitop3:0xf6
    v_bitop3_b32 v20, v20, v46, s30 bitop3:0xf6
    s_waitcnt vmcnt(1)
    v_mfma_f32_16x16x32_bf16 v[28:31], v[48:51], v[56:59], v[28:31]
    v_bitop3_b32 v20, v20, v48, s30 bitop3:0xf6
    v_bitop3_b32 v20, v20, v50, s30 bitop3:0xf6
    s_waitcnt vmcnt(0)
    v_mfma_f32_16x16x32_bf16 v[28:31], v[52:55], v[56:59], v[28:31]
    v_bitop3_b32 v20, v20, v52, s30 bitop3:0xf6
    v_bitop3_b32 v20, v20, v54, s30 bitop3:0xf6
    v_and_b32 v20, s40, v20
    v_cmp_ne_u32 vcc, 0, v20
    s_cbranch_vccnz cf_spinF
    v_permlane32_swap_b32 v28, v30
    v_permlane32_swap_b32 v29, v31
    v_add_f32 v28, v28, v30
    v_add_f32 v30, v29, v31
    v_cvt_pk_bf16_f32 v28, v28, v30
    s_mov_b64 exec, s[32:33]
    buffer_store_dword v28, v69, s[4:7], s17 offen
    buffer_store_dword v21, v69, s[4:7], s18 offen
    s_mov_b64 exec, -1
    ds_read_b128 v[32:35], v62 offset:16384
    ds_read_b128 v[36:39], v62 offset:20480
    ds_read_b128 v[40:43], v61 offset:0
    ds_read_b128 v[44:47], v61 offset:4096
    ds_read_b128 v[48:51], v61 offset:8192
    ds_read_b128 v[52:55], v61 offset:12288
    s_nop 14
    buffer_load_dwordx4 v[24:27], v61, s[4:7], s14 offen nt
    s_branch cf_loop2
cf_w013:
    ds_read_b128 v[56:59], v65 offset:10240
    ds_read_b128 v[32:35], v62 offset:16384
    ds_read_b128 v[36:39], v62 offset:20480
    ds_read_b128 v[40:43], v61 offset:0
    ds_read_b128 v[44:47], v61 offset:4096
    ds_read_b128 v[48:51], v61 offset:8192
    ds_read_b128 v[52:55], v61 offset:12288
    s_add_u32 s28, s28, 1
    s_mov_b32 s14, s41
    s_add_u32 s23, s23, 524288
    s_add_u32 s24, s24, 524288
    s_min_u32 s24, s24, s47
    s_add_u32 s15, s14, 4096
    s_add_u32 s16, s14, 8192
    v_mov_b32 v21, -1
    s_add_u32 s65, s65, 12288
    s_mov_b32 s40, 1
    s_cmp_eq_u32 s64, 0
    s_cbranch_scc1 cf_w0
    s_cmp_eq_u32 s13, 1
    s_nop 15
    s_nop 15
    s_nop 7
    s_cbranch_scc1 cf_sx
    s_nop 15
    s_nop 13
cf_sx:
    buffer_load_dwordx4 v[0:3], v65, s[4:7], s19 offen offset:0 nt
    buffer_load_dwordx4 v[4:7], v65, s[4:7], s19 offen offset:1024 nt
    buffer_load_dwordx4 v[8:11], v65, s[4:7], s19 offen offset:2048 nt
    buffer_load_dwordx4 v[12:15], v65, s[4:7], s19 offen offset:3072 nt
cf_chkG:
    v_mov_b32 v20, 0
    s_waitcnt vmcnt(3)
    s_waitcnt lgkmcnt(6)
    v_mfma_f32_16x16x32_bf16 v[28:31], v[0:3], v[56:59], 0
    v_bitop3_b32 v20, v20, v0, s30 bitop3:0xf6
    v_bitop3_b32 v20, v20, v2, s30 bitop3:0xf6
    s_waitcnt vmcnt(2)
    v_mfma_f32_16x16x32_bf16 v[28:31], v[4:7], v[56:59], v[28:31]
    v_bitop3_b32 v20, v20, v4, s30 bitop3:0xf6
    v_bitop3_b32 v20, v20, v6, s30 bitop3:0xf6
    s_waitcnt vmcnt(1)
    v_mfma_f32_16x16x32_bf16 v[28:31], v[8:11], v[56:59], v[28:31]
    v_bitop3_b32 v20, v20, v8, s30 bitop3:0xf6
    v_bitop3_b32 v20, v20, v10, s30 bitop3:0xf6
    s_waitcnt vmcnt(0)
    v_mfma_f32_16x16x32_bf16 v[28:31], v[12:15], v[56:59], v[28:31]
    v_bitop3_b32 v20, v20, v12, s30 bitop3:0xf6
    v_bitop3_b32 v20, v20, v14, s30 bitop3:0xf6
    v_and_b32 v20, s40, v20
    v_cmp_ne_u32 vcc, 0, v20
    s_cbranch_vccnz cf_spinG
    v_permlane32_swap_b32 v28, v30
    v_permlane32_swap_b32 v29, v31
    v_add_f32 v28, v28, v30
    v_add_f32 v30, v29, v31
    s_cmp_eq_u32 s13, 3
    s_cbranch_scc1 cf_w3
    v_mov_b32 v29, v28
    v_mov_b32 v31, v30
    s_nop 0
    v_permlane16_swap_b32 v28, v29
    v_permlane16_swap_b32 v30, v31
    v_add_f32 v28, v28, v29
    v_add_f32 v30, v30, v31
cf_w3:
    v_cvt_pk_bf16_f32 v28, v28, v30
    s_mov_b64 exec, s[32:33]
    buffer_store_dword v28, v69, s[4:7], s17 offen
    buffer_store_dword v21, v69, s[4:7], s18 offen
    s_mov_b64 exec, -1
    buffer_load_dwordx4 v[24:27], v61, s[4:7], s14 offen nt
    s_branch cf_loop
cf_w0:
    v_mov_b64 v[0:1], 0
    v_mov_b64 v[2:3], 0
    v_mov_b64 v[4:5], 0
    v_mov_b64 v[6:7], 0
    v_mov_b64 v[8:9], 0
    v_mov_b64 v[10:11], 0
    v_mov_b64 v[12:13], 0
    v_mov_b64 v[14:15], 0
    s_cmp_lg_u32 s28, 10
    s_cbranch_scc1 cf_nokv
    s_lshr_b32 s92, s12, 1
    s_lshl_b32 s92, s92, 8
    s_add_u32 s92, s92, 125833216
    v_bfe_u32 v28, v61, 4, 6
    v_min_u32 v28, 11, v28
    v_lshlrev_b32 v28, 2, v28
    s_add_u32 s93, s95, 63
    s_mov_b32 s94, 4194304
cf_kv1:
    buffer_load_dword v29, v28, s[4:7], s92 offen sc1
    s_sub_u32 s94, s94, 1
    s_cbranch_scc1 cf_kv1_go
    s_waitcnt vmcnt(0)
    v_subrev_u32 v29, s93, v29
    v_cmp_lt_u32 vcc, 64, v29
    s_cbranch_vccz cf_kv1_go
    s_sleep 2
    s_branch cf_kv1
cf_kv1_go:
cf_nokv:
    s_nop 15
    s_nop 15
    s_nop 15
    s_nop 15
    s_nop 15
    s_nop 15
    s_nop 15
    s_nop 15
    s_nop 15
    s_nop 15
    s_nop 7
    buffer_load_dwordx4 v[24:27], v61, s[4:7], s14 offen nt
    s_branch cf_loop2
cf_spinF:
    buffer_load_dwordx4 v[40:43], v65, s[4:7], s19 offen offset:0 nt
    buffer_load_dwordx4 v[44:47], v65, s[4:7], s19 offen offset:1024 nt
    buffer_load_dwordx4 v[48:51], v65, s[4:7], s19 offen offset:2048 nt
    buffer_load_dwordx4 v[52:55], v65, s[4:7], s19 offen offset:3072 nt
    s_sub_u32 s29, s29, 1
    s_cmp_lt_i32 s29, 0
    s_cselect_b32 s40, 0, 1
    s_branch cf_chkF
cf_spinG:
    buffer_load_dwordx4 v[0:3], v65, s[4:7], s19 offen offset:0 nt
    buffer_load_dwordx4 v[4:7], v65, s[4:7], s19 offen offset:1024 nt
    buffer_load_dwordx4 v[8:11], v65, s[4:7], s19 offen offset:2048 nt
    buffer_load_dwordx4 v[12:15], v65, s[4:7], s19 offen offset:3072 nt
    s_sub_u32 s29, s29, 1
    s_cmp_lt_i32 s29, 0
    s_cselect_b32 s40, 0, 1
    s_branch cf_chkG
cf_guard:
    s_cbranch_scc0 cf_guard2
    buffer_store_dwordx4 v[16:19], v61, s[4:7], s26 offen sc1
    s_add_u32 s26, s26, 131072
    s_add_u32 s40, s95, 63
    v_mov_b32 v5, s40
    s_mov_b64 exec, 1
    buffer_store_dword v5, off, s[4:7], s27 sc1
    s_mov_b64 exec, -1
cf_guard2:
    s_nop 7
    v_max3_f32 v6, v28, v29, v30
    v_max3_f32 v7, v31, v56, v57
    v_max_f32 v6, v6, v7
    s_nop 1
    v_max_f32_dpp v6, v6, v6 row_ror:8 row_mask:0xf bank_mask:0xf
    v_mov_b32 v7, v6
    s_nop 1
    v_permlane32_swap_b32 v6, v7
    v_max_f32 v6, v6, v7
    v_mov_b32 v7, v6
    s_nop 1
    v_permlane16_swap_b32 v6, v7
    v_max_f32 v6, v6, v7
    v_sub_f32 v28, v28, v6
    v_sub_f32 v29, v29, v6
    v_sub_f32 v30, v30, v6
    v_sub_f32 v31, v31, v6
    v_sub_f32 v56, v56, v6
    v_sub_f32 v57, v57, v6
    v_exp_f32 v58, v56
    v_exp_f32 v59, v57
    s_nop 0
    v_cvt_pk_bf16_f32 v6, v58, v59
    s_nop 1
    v_mov_b32_dpp v7, v6 row_ror:8 row_mask:0xf bank_mask:0xf
    v_exp_f32 v0, v28
    s_nop 0
    v_mfma_f32_16x16x16_bf16 v[12:15], v[16:17], v[6:7], 0
    v_exp_f32 v1, v29
    v_exp_f32 v2, v30
    v_cvt_pk_bf16_f32 v8, v0, v1
    v_exp_f32 v3, v31
    v_mfma_f32_16x16x16_bf16 v[20:23], v[18:19], v[6:7], 0
    v_cvt_pk_bf16_f32 v9, v2, v3
    v_mov_b32_dpp v10, v8 row_ror:8 row_mask:0xf bank_mask:0xf
    v_max3_f32 v4, |v28|, |v29|, |v30|
    v_mov_b32_dpp v11, v9 row_ror:8 row_mask:0xf bank_mask:0xf
    v_mfma_f32_16x16x32_bf16 v[0:3], v[24:27], v[6:9], 0
    v_max3_f32 v4, v4, |v31|, |v56|
    v_max_f32_e64 v4, v4, |v57|
    v_mfma_f32_16x16x32_bf16 v[12:15], v[40:43], v[8:11], v[12:15]
    v_cmp_nge_f32 vcc, s46, v4
    v_mfma_f32_16x16x32_bf16 v[20:23], v[44:47], v[8:11], v[20:23]
    v_add_f32_dpp v0, v0, v0 row_ror:8 row_mask:0xf bank_mask:0xf
    v_rcp_f32 v0, v0
    s_nop 4
    s_branch cf_norm
cf_spin0:
    buffer_load_dwordx4 v[24:27], v61, s[4:7], s14 offen nt
    s_sub_u32 s29, s29, 1
    s_cmp_lt_i32 s29, 0
    s_cbranch_scc0 cf_chk0
    s_waitcnt vmcnt(0)
    v_min_u32 v24, -2, v24
    v_min_u32 v25, -2, v25
    v_min_u32 v26, -2, v26
    v_min_u32 v27, -2, v27
    s_branch cf_chk0
cf_spin1:
    buffer_load_dwordx4 v[28:31], v61, s[4:7], s15 offen nt
    buffer_load_dword v59, v56, s[4:7], s16 offen nt
    s_sub_u32 s29, s29, 1
    s_cmp_lt_i32 s29, 0
    s_waitcnt vmcnt(0)
    v_max3_u32 v57, v28, v29, v30
    v_max3_u32 v57, v57, v31, v59
    v_cmp_eq_u32 vcc, -1, v57
    ds_write_b128 v62, v[28:31] offset:45056
    ds_write_b32 v58, v59
    s_waitcnt lgkmcnt(0)
    s_cbranch_scc1 cf_go1
    s_cbranch_vccnz cf_spin1
    s_branch cf_go1
cf_last:
    s_nop 1
    s_cmp_eq_u32 s28, 63
    s_cbranch_scc1 cf_last2
    s_mov_b64 exec, s[34:35]
    buffer_store_dwordx4 v[0:3], v61, s[4:7], s25 offen sc1
    s_mov_b64 exec, -1
    s_add_u32 s25, s25, 131072
    s_mov_b32 s46, 0xbf800000
    s_cmp_eq_u32 0, 0
    s_branch cf_back
cf_last2:
    s_waitcnt lgkmcnt(0)
    s_mov_b64 exec, s[34:35]
    buffer_store_dwordx4 v[0:3], v61, s[4:7], s25 offen sc1
    s_mov_b64 exec, -1
    s_add_u32 s40, s95, 64
    v_mov_b32 v40, s40
    v_smfmac_f32_16x16x64_bf16 v[16:19], v[52:55], a[240:247], v60
    v_smfmac_f32_16x16x64_bf16 v[20:23], v[52:55], a[248:255], v60
    s_nop 3
    v_cvt_pk_bf16_f32 v16, v16, v17
    v_cvt_pk_bf16_f32 v17, v18, v19
    s_nop 1
    v_cvt_pk_bf16_f32 v18, v20, v21
    v_cvt_pk_bf16_f32 v19, v22, v23
    buffer_store_dwordx4 v[16:19], v61, s[4:7], s26 offen sc1
    s_mov_b64 exec, 1
    buffer_store_dword v40, off, s[4:7], s27 sc1
    s_mov_b64 exec, -1
    s_endpgm
cf_dma:
    s_xor_b32 s74, s76, s81
    s_add_u32 m0, s74, s80
    s_add_u32 s76, s76, 4096
    buffer_load_dwordx4 v58, s[8:11], s78 offen lds
    s_add_u32 s78, s78, s79
    s_cmp_lt_u32 s76, s77
    s_cbranch_scc1 cf_dma
    s_setpc_b64 s[82:83]
L_chain_safe:
    s_mov_b64 s[48:49], s[50:51]
    s_mov_b64 s[50:51], s[52:53]
    s_mov_b64 s[52:53], s[54:55]
    s_mov_b64 s[54:55], s[56:57]
    s_mov_b64 s[56:57], s[58:59]
    v_lshrrev_b32 v54, 6, v0
    s_nop 0
    v_readfirstlane_b32 s13, v54
    v_and_b32 v57, 63, v0
    v_bfe_u32 v54, v57, 2, 1
    v_lshlrev_b32 v48, 13, v54
    v_bfe_u32 v54, v57, 3, 1
    v_lshl_add_u32 v48, v54, 15, v48
    v_bfe_u32 v54, v57, 4, 1
    v_lshl_add_u32 v48, v54, 14, v48
    v_bfe_u32 v54, v57, 5, 1
    v_lshl_add_u32 v48, v54, 16, v48
    v_lshrrev_b32 v55, 4, v57
    v_and_b32 v55, 2, v55
    v_xor_b32 v55, v55, v57
    v_and_b32 v55, 3, v55
    v_lshl_add_u32 v48, v55, 4, v48
    v_bfe_u32 v54, v57, 2, 1
    v_lshlrev_b32 v51, 6, v54
    v_bfe_u32 v54, v57, 3, 1
    v_lshl_add_u32 v51, v54, 9, v51
    v_bfe_u32 v54, v57, 4, 1
    v_lshl_add_u32 v51, v54, 7, v51
    v_bfe_u32 v54, v57, 5, 1
    v_lshl_add_u32 v51, v54, 12, v51
    v_bfe_u32 v54, v57, 0, 1
    v_lshl_add_u32 v51, v54, 3, v51
    v_bfe_u32 v54, v57, 1, 1
    v_lshl_add_u32 v51, v54, 4, v51
    v_bfe_u32 v54, v57, 3, 1
    v_lshl_add_u32 v51, v54, 5, v51
    v_lshrrev_b32 v55, 3, v57
    v_mul_u32_u24 v49, 1152, v55
    v_and_b32 v55, 7, v57
    v_lshl_add_u32 v49, v55, 4, v49
    v_bfe_u32 v54, v57, 4, 1
    v_lshlrev_b32 v52, 13, v54
    v_bfe_u32 v54, v57, 5, 1
    v_lshl_add_u32 v52, v54, 9, v52
    v_bfe_u32 v54, v57, 2, 1
    v_lshl_add_u32 v52, v54, 7, v52
    v_bfe_u32 v54, v57, 3, 1
    v_lshl_add_u32 v52, v54, 5, v52
    v_and_b32 v55, 3, v57
    v_lshl_add_u32 v52, v55, 3, v52
    v_lshrrev_b32 v55, 2, v57
    v_mul_u32_u24 v50, 1152, v55
    v_and_b32 v55, 3, v57
    v_lshl_add_u32 v50, v55, 4, v50
    v_bfe_u32 v54, v57, 4, 1
    v_lshlrev_b32 v53, 12, v54
    v_bfe_u32 v54, v57, 5, 1
    v_lshl_add_u32 v53, v54, 8, v53
    v_bfe_u32 v54, v57, 2, 1
    v_lshl_add_u32 v53, v54, 6, v53
    v_bfe_u32 v54, v57, 3, 1
    v_lshl_add_u32 v53, v54, 5, v53
    v_and_b32 v55, 3, v57
    v_lshl_add_u32 v53, v55, 3, v53
    s_lshl_b32 s66, s13, 10
    s_and_b32 s93, s13, 1
    s_lshl_b32 s93, s93, 14
    s_and_b32 s75, s13, 2
    s_lshl_b32 s75, s75, 19
    v_add_u32 v51, s66, v51
    v_add_u32 v52, s66, v52
    v_add_u32 v53, s66, v53
    v_mov_b32 v58, v48
    s_mov_b32 s10, 4718592
    s_mov_b32 s11, 0x20000
    s_lshl_b32 s67, s12, 8
    s_lshl_b32 s40, s13, 6
    s_add_u32 s67, s67, s40
    s_mul_i32 s92, s12, 147456
    s_lshr_b32 s73, s50, 8
    s_add_u32 s73, s73, s12
    s_and_b32 s73, s73, 31
    s_bitcmp1_b32 0xa2222222, s73
    s_cselect_b32 s88, 0, 0
    s_mov_b32 s72, 0
    s_add_u32 s73, s73, 1
    s_lshr_b32 s73, s73, 2
    s_xor_b32 s94, s13, 0
    s_mul_i32 s94, s94, 36864
    s_add_u32 s94, s94, s92
    s_lshl_b32 s74, s13, 7
    s_add_u32 s94, s94, s74
    s_add_u32 s78, s94, 0
    s_mov_b64 s[8:9], s[56:57]
    v_mov_b32 v58, v49
    s_mov_b32 s79, 9216
    s_mov_b32 s81, 0
    s_add_u32 s80, s66, 114688
    s_mov_b32 s76, 0
    s_mov_b32 s77, 8192
    s_call_b64 s[82:83], cs_dma
    s_mov_b32 s77, 16384
    s_call_b64 s[82:83], cs_dma
    s_xor_b32 s94, s13, 1
    s_mul_i32 s94, s94, 36864
    s_add_u32 s94, s94, s92
    s_lshl_b32 s74, s13, 7
    s_add_u32 s94, s94, s74
    s_add_u32 s78, s94, 0
    s_add_u32 s80, s66, 81920
    s_mov_b32 s76, 0
    s_mov_b32 s77, 8192
    s_call_b64 s[82:83], cs_dma
    s_mov_b32 s77, 16384
    s_call_b64 s[82:83], cs_dma
    s_xor_b32 s94, s13, 2
    s_mul_i32 s94, s94, 36864
    s_add_u32 s94, s94, s92
    s_lshl_b32 s74, s13, 7
    s_add_u32 s94, s94, s74
    s_add_u32 s78, s94, 0
    s_add_u32 s80, s66, 16384
    s_mov_b32 s76, 0
    s_mov_b32 s77, 8192
    s_call_b64 s[82:83], cs_dma
    s_mov_b32 s77, 16384
    s_call_b64 s[82:83], cs_dma
    s_xor_b32 s94, s13, 3
    s_mul_i32 s94, s94, 36864
    s_add_u32 s94, s94, s92
    s_lshl_b32 s74, s13, 7
    s_add_u32 s94, s94, s74
    s_add_u32 s78, s94, 0
    s_add_u32 s80, s66, 0
    s_mov_b32 s76, 0
    s_mov_b32 s77, 8192
    s_call_b64 s[82:83], cs_dma
    s_mov_b32 s77, 16384
    s_call_b64 s[82:83], cs_dma
    v_lshrrev_b32 v24, 6, v0
    v_lshlrev_b32 v61, 4, v0
    v_add_u32 v62, 57344, v61
    v_xor_b32 v63, 1024, v61
    v_add_u32 v63, 98304, v63
    v_xor_b32 v64, 2048, v61
    v_add_u32 v64, 98304, v64
    v_and_b32 v65, 1023, v61
    v_add_u32 v65, 98304, v65
    v_and_b32 v26, 15, v0
    v_bfe_u32 v27, v0, 4, 2
    v_mov_b32 v60, 0x4444
    v_mov_b32 v25, 0xeeee
    v_cmp_lt_u32 vcc, 7, v26
    s_nop 1
    v_cndmask_b32 v60, v60, v25, vcc
    s_nop 1
    v_and_b32 v67, 12, v26
    v_lshlrev_b32 v67, 3, v67
    v_and_b32 v25, 1, v26
    v_lshl_add_u32 v67, v25, 4, v67
    v_bfe_u32 v25, v26, 1, 1
    v_lshl_add_u32 v67, v25, 3, v67
    v_lshl_add_u32 v66, v27, 14, v67
    v_lshl_add_u32 v66, v24, 17, v66
    s_nop 1
    v_and_b32 v67, 63, v67
    v_lshrrev_b32 v25, 1, v24
    v_lshl_add_u32 v67, v25, 18, v67
    v_lshl_add_u32 v67, v27, 16, v67
    v_lshrrev_b32 v25, 3, v26
    v_lshl_add_u32 v67, v25, 15, v67
    v_and_b32 v25, 1, v24
    v_lshl_add_u32 v67, v25, 6, v67
    s_nop 1
    s_waitcnt vmcnt(12)
    v_add_u32 v55, 114688, v52
    ds_read_b64_tr_b16 v[160:161], v55 offset:0
    ds_read_b64_tr_b16 v[162:163], v55 offset:256
    ds_read_b64_tr_b16 v[164:165], v55 offset:4096
    ds_read_b64_tr_b16 v[166:167], v55 offset:4352
    s_xor_b32 s94, s13, 0
    s_mul_i32 s94, s94, 36864
    s_add_u32 s94, s94, s92
    s_lshl_b32 s74, s13, 7
    s_add_u32 s94, s94, s74
    s_add_u32 s78, s94, 512
    s_add_u32 s80, s66, 147456
    s_mov_b32 s76, 0
    s_mov_b32 s77, 8192
    s_call_b64 s[82:83], cs_dma
    ds_read_b64_tr_b16 v[192:193], v55 offset:64
    ds_read_b64_tr_b16 v[194:195], v55 offset:320
    ds_read_b64_tr_b16 v[196:197], v55 offset:4160
    ds_read_b64_tr_b16 v[198:199], v55 offset:4416
    s_mov_b32 s77, 16384
    s_call_b64 s[82:83], cs_dma
    v_and_b32 v25, 31, v0
    v_lshlrev_b32 v70, 4, v25
    v_lshlrev_b32 v28, 3, v25
    v_add_u32 v28, 108032, v28
    v_lshrrev_b32 v25, 1, v24
    v_lshl_add_u32 v70, v25, 9, v70
    v_and_b32 v25, 1, v24
    v_lshl_add_u32 v70, v25, 3, v70
    v_add_u32 v70, 109568, v70
    v_cmp_gt_u32 vcc, 2, v27
    s_nop 1
    v_cndmask_b32 v70, v70, v28, vcc
    s_nop 1
    s_waitcnt lgkmcnt(0)
    s_waitcnt vmcnt(12)
    v_add_u32 v55, 81920, v52
    ds_read_b64_tr_b16 v[168:169], v55 offset:0
    ds_read_b64_tr_b16 v[170:171], v55 offset:256
    ds_read_b64_tr_b16 v[172:173], v55 offset:4096
    ds_read_b64_tr_b16 v[174:175], v55 offset:4352
    s_xor_b32 s94, s13, 1
    s_mul_i32 s94, s94, 36864
    s_add_u32 s94, s94, s92
    s_lshl_b32 s74, s13, 7
    s_add_u32 s94, s94, s74
    s_add_u32 s78, s94, 512
    s_add_u32 s80, s66, 98304
    s_mov_b32 s76, 0
    s_mov_b32 s77, 8192
    s_call_b64 s[82:83], cs_dma
    ds_read_b64_tr_b16 v[200:201], v55 offset:64
    ds_read_b64_tr_b16 v[202:203], v55 offset:320
    ds_read_b64_tr_b16 v[204:205], v55 offset:4160
    ds_read_b64_tr_b16 v[206:207], v55 offset:4416
    s_mov_b32 s77, 16384
    s_call_b64 s[82:83], cs_dma
    v_xor_b32 v71, 2048, v63
    v_lshrrev_b32 v68, 4, v0
    v_lshlrev_b32 v68, 7, v68
    v_and_b32 v25, 7, v26
    v_lshl_add_u32 v68, v25, 4, v68
    v_add_u32 v68, 98304, v68
    v_xor_b32 v74, 512, v68
    v_xor_b32 v75, 1024, v68
    v_xor_b32 v76, 1536, v68
    v_lshrrev_b32 v25, 3, v26
    v_lshl_add_u32 v77, v25, 3, v68
    v_or_b32 v78, 512, v65
    v_lshlrev_b32 v79, 2, v61
    v_mov_b64 v[72:73], 0
    v_and_b32 v25, 1, v27
    v_lshlrev_b32 v69, 7, v25
    v_lshrrev_b32 v25, 1, v27
    v_lshl_add_u32 v69, v25, 3, v69
    v_and_b32 v25, 3, v26
    v_lshl_add_u32 v69, v25, 4, v69
    v_bfe_u32 v25, v26, 2, 1
    v_lshl_add_u32 v69, v25, 2, v69
    s_nop 1
    s_waitcnt lgkmcnt(0)
    s_waitcnt vmcnt(12)
    v_add_u32 v55, 16384, v52
    ds_read_b64_tr_b16 v[176:177], v55 offset:0
    ds_read_b64_tr_b16 v[178:179], v55 offset:256
    ds_read_b64_tr_b16 v[180:181], v55 offset:4096
    ds_read_b64_tr_b16 v[182:183], v55 offset:4352
    s_add_u32 s78, s67, 4194304
    s_mov_b64 s[8:9], s[54:55]
    v_mov_b32 v58, v48
    s_mov_b32 s79, 131072
    s_add_u32 s80, s66, 32768
    s_mov_b32 s76, 0
    s_mov_b32 s77, 8192
    s_call_b64 s[82:83], cs_dma
    ds_read_b64_tr_b16 v[208:209], v55 offset:64
    ds_read_b64_tr_b16 v[210:211], v55 offset:320
    ds_read_b64_tr_b16 v[212:213], v55 offset:4160
    ds_read_b64_tr_b16 v[214:215], v55 offset:4416
    s_mov_b32 s77, 16384
    s_call_b64 s[82:83], cs_dma
    s_mov_b32 s32, 0x00ff00ff
    s_mov_b32 s33, 0x00ff00ff
    s_not_b64 s[34:35], s[32:33]
    s_lshr_b32 s31, s12, 1
    s_lshl_b32 s31, s31, 8
    s_and_b32 s40, s12, 1
    s_lshl_b32 s40, s40, 6
    s_add_u32 s31, s31, s40
    s_and_b32 s40, s13, 1
    s_lshl_b32 s40, s40, 12
    s_add_u32 s31, s31, s40
    s_lshl_b32 s19, s12, 14
    s_add_u32 s19, s19, 68124672
    s_add_u32 s41, s19, 8192
    s_add_u32 s19, s19, s40
    s_and_b32 s40, s12, 1
    s_lshl_b32 s40, s40, 2
    s_or_b32 s40, s40, s13
    s_cmp_eq_u32 s40, 5
    s_cselect_b32 s64, 0, s13
    s_cmp_lg_u32 s13, 1
    s_cbranch_scc1 cs_notx
    s_mov_b32 s32, 0xff
    s_mov_b32 s33, 0xff
    s_mov_b32 s19, s41
    s_lshr_b32 s31, s12, 3
    s_lshl_b32 s31, s31, 8
    s_and_b32 s40, s12, 2
    s_lshl_b32 s40, s40, 6
    s_add_u32 s31, s31, s40
    s_and_b32 s40, s12, 4
    s_lshl_b32 s40, s40, 4
    s_add_u32 s31, s31, s40
    s_add_u32 s31, s31, 8192
cs_notx:
    s_cmp_lg_u32 s13, 0
    s_cbranch_scc1 cs_notp
    s_min_u32 s40, s12, 23
    s_mul_i32 s40, s40, 384
    s_add_u32 s40, s40, 98304
    v_add_u32 v69, s40, v61
    v_mov_b32 v25, 108288
    v_cmp_lt_u32 vcc, 23, v0
    s_nop 1
    v_cndmask_b32 v69, v69, v25, vcc
cs_notp:
    s_nop 1
    s_waitcnt lgkmcnt(0)
    s_waitcnt vmcnt(12)
    v_add_u32 v55, 0, v52
    ds_read_b64_tr_b16 v[184:185], v55 offset:0
    ds_read_b64_tr_b16 v[186:187], v55 offset:256
    ds_read_b64_tr_b16 v[188:189], v55 offset:4096
    ds_read_b64_tr_b16 v[190:191], v55 offset:4352
    s_xor_b32 s78, s75, 0
    s_add_u32 s78, s78, s67
    s_mov_b32 s81, s93
    s_add_u32 s80, s66, 114688
    s_mov_b32 s76, 0
    s_mov_b32 s77, 8192
    s_call_b64 s[82:83], cs_dma
    ds_read_b64_tr_b16 v[216:217], v55 offset:64
    ds_read_b64_tr_b16 v[218:219], v55 offset:320
    ds_read_b64_tr_b16 v[220:221], v55 offset:4160
    ds_read_b64_tr_b16 v[222:223], v55 offset:4416
    s_mov_b32 s77, 16384
    s_call_b64 s[82:83], cs_dma
    v_mov_b32 v28, 1
    v_mov_b32 v29, 1
    v_mov_b32 v30, 1
    v_mov_b32 v31, 1
    s_lshl_b32 s40, s12, 14
    s_add_u32 s40, s40, 68222976
    s_add_u32 s41, s40, 0
    buffer_store_dwordx4 v[28:31], v61, s[4:7], s41 offen sc1
    s_add_u32 s41, s40, 4096
    buffer_store_dwordx4 v[28:31], v61, s[4:7], s41 offen sc1
    s_add_u32 s41, s40, 8192
    buffer_store_dwordx4 v[28:31], v61, s[4:7], s41 offen sc1
    s_cmp_eq_u32 s64, 0
    s_cselect_b64 exec, 0, s[32:33]
    v_mov_b32 v27, -1
    s_add_u32 s41, s31, 68157440
    buffer_store_dword v27, v69, s[4:7], s41 offen sc1
    s_add_u32 s41, s31, 68173824
    buffer_store_dword v27, v69, s[4:7], s41 offen sc1
    s_add_u32 s41, s31, 68190208
    buffer_store_dword v27, v69, s[4:7], s41 offen sc1
    s_add_u32 s41, s31, 68206592
    buffer_store_dword v27, v69, s[4:7], s41 offen sc1
    s_mov_b64 exec, -1
    s_waitcnt lgkmcnt(0)
    s_waitcnt vmcnt(12)
    v_add_u32 v55, 147456, v52
    ds_read_b64_tr_b16 v[224:225], v55 offset:0
    ds_read_b64_tr_b16 v[226:227], v55 offset:256
    ds_read_b64_tr_b16 v[228:229], v55 offset:4096
    ds_read_b64_tr_b16 v[230:231], v55 offset:4352
    s_mov_b32 s77, 24576
    s_call_b64 s[82:83], cs_dma
    ds_read_b64_tr_b16 v[240:241], v55 offset:64
    ds_read_b64_tr_b16 v[242:243], v55 offset:320
    ds_read_b64_tr_b16 v[244:245], v55 offset:4160
    ds_read_b64_tr_b16 v[246:247], v55 offset:4416
    s_mov_b32 s77, 32768
    s_call_b64 s[82:83], cs_dma
    s_mov_b64 s[68:69], s[48:49]
    s_mov_b32 s70, 9216
    s_mov_b32 s71, 0x20000
    v_and_b32 v25, 7, v0
    v_mul_u32_u24 v25, 1152, v25
    v_lshrrev_b32 v26, 3, v0
    v_lshl_add_u32 v25, v26, 4, v25
    buffer_load_dwordx4 v[36:39], v25, s[68:71], 0 offen
    buffer_load_dwordx4 v[40:43], v25, s[68:71], 0 offen offset:512
    v_bfe_u32 v25, v0, 2, 3
    v_mul_u32_u24 v25, 1152, v25
    v_lshrrev_b32 v26, 5, v0
    v_lshl_add_u32 v25, v26, 4, v25
    v_and_b32 v26, 3, v0
    v_lshl_add_u32 v25, v26, 2, v25
    buffer_load_dword v44, v25, s[68:71], 0 offen offset:1024
    s_nop 0
    s_waitcnt lgkmcnt(0)
    s_waitcnt vmcnt(15)
    v_add_u32 v55, 98304, v52
    ds_read_b64_tr_b16 v[232:233], v55 offset:0
    ds_read_b64_tr_b16 v[234:235], v55 offset:256
    ds_read_b64_tr_b16 v[236:237], v55 offset:4096
    ds_read_b64_tr_b16 v[238:239], v55 offset:4352
    s_xor_b32 s78, s75, 1048576
    s_add_u32 s78, s78, s67
    s_add_u32 s80, s66, 65536
    s_mov_b32 s76, 0
    s_mov_b32 s77, 8192
    s_call_b64 s[82:83], cs_dma
    ds_read_b64_tr_b16 v[248:249], v55 offset:64
    ds_read_b64_tr_b16 v[250:251], v55 offset:320
    ds_read_b64_tr_b16 v[252:253], v55 offset:4160
    ds_read_b64_tr_b16 v[254:255], v55 offset:4416
    s_mov_b32 s77, 16384
    s_call_b64 s[82:83], cs_dma
    s_mov_b32 s44, 0x3e0293ee
    s_mov_b32 s45, s44
    s_mov_b32 s46, 0x42000000
    s_mov_b32 s60, 0x3f803f80
    s_mov_b32 s61, s60
    s_mov_b32 s62, 0x3e803e80
    s_mov_b32 s63, s62
    s_mov_b32 s28, 0
    s_lshl_b32 s24, s12, 14
    s_add_u32 s24, s24, 0
    s_add_u32 s47, s24, 33030144
    s_mul_i32 s40, s13, 3072
    s_add_u32 s23, s24, s40
    s_lshl_b32 s20, s12, 7
    s_add_u32 s20, s20, 68222976
    s_add_u32 s21, s20, 65536
    s_add_u32 s38, s20, 4096
    s_add_u32 s39, s21, 4096
    s_lshl_b32 s22, s12, 7
    s_add_u32 s22, s22, 68231168
    s_waitcnt lgkmcnt(0)
    s_waitcnt vmcnt(15)
    v_add_u32 v55, 32768, v51
    v_xor_b32 v56, 32, v55
    ds_read_b64_tr_b16 v[144:145], v55 offset:0
    ds_read_b64_tr_b16 v[146:147], v55 offset:256
    ds_read_b64_tr_b16 v[148:149], v55 offset:8192
    ds_read_b64_tr_b16 v[150:151], v55 offset:8448
    s_mov_b32 s77, 24576
    s_call_b64 s[82:83], cs_dma
    ds_read_b64_tr_b16 v[152:153], v56 offset:0
    ds_read_b64_tr_b16 v[154:155], v56 offset:256
    ds_read_b64_tr_b16 v[156:157], v56 offset:8192
    ds_read_b64_tr_b16 v[158:159], v56 offset:8448
    s_mov_b32 s77, 32768
    s_call_b64 s[82:83], cs_dma
    s_lshl_b32 s40, s12, 12
    s_add_u32 s25, s40, 79429632
    s_add_u32 s26, s40, 88866816
    s_lshl_b32 s65, s12, 9
    s_add_u32 s65, s65, 90177536
    s_lshl_b32 s40, s13, 5
    s_or_b32 s40, s40, s12
    s_cmp_lt_u32 s40, 24
    s_cselect_b32 s36, 0x1ffffff, 0
    s_mov_b32 s37, 0
    s_lshl_b32 s27, s12, 7
    s_add_u32 s27, s27, 125845504
    s_lshl_b32 s40, s13, 2
    s_add_u32 s27, s27, s40
    v_bfe_u32 v28, v61, 4, 4
    v_bfe_u32 v29, v61, 8, 1
    v_lshlrev_b32 v29, 2, v29
    v_sub_u32 v29, v28, v29
    v_mov_b32 v31, 0x3f80
    v_mov_b32 v32, 0x3f800000
    s_nop 1
    s_waitcnt lgkmcnt(0)
    s_waitcnt vmcnt(11)
    v_add_u32 v55, 114688, v51
    v_xor_b32 v56, 32, v55
    ds_read_b64_tr_b16 a[192:193], v55 offset:0
    ds_read_b64_tr_b16 a[194:195], v55 offset:256
    ds_read_b64_tr_b16 a[196:197], v55 offset:8192
    ds_read_b64_tr_b16 a[198:199], v55 offset:8448
    s_xor_b32 s78, s75, 2097152
    s_add_u32 s78, s78, s67
    s_add_u32 s80, s66, 0
    s_mov_b32 s76, 0
    s_mov_b32 s77, 8192
    s_call_b64 s[82:83], cs_dma
    ds_read_b64_tr_b16 a[200:201], v56 offset:0
    ds_read_b64_tr_b16 a[202:203], v56 offset:256
    ds_read_b64_tr_b16 a[204:205], v56 offset:8192
    ds_read_b64_tr_b16 a[206:207], v56 offset:8448
    s_mov_b32 s77, 16384
    s_call_b64 s[82:83], cs_dma
    v_cmp_eq_u32 vcc, 0, v29
    s_nop 1
    v_cndmask_b32 v16, 0, v31, vcc
    v_cmp_eq_u32 vcc, 1, v29
    s_nop 1
    v_cndmask_b32 v16, v16, v32, vcc
    v_cmp_eq_u32 vcc, 0, v28
    s_nop 1
    v_cndmask_b32 v20, 0, v31, vcc
    v_cmp_eq_u32 vcc, 1, v28
    s_nop 1
    v_cndmask_b32 v20, v20, v32, vcc
    s_nop 1
    s_waitcnt lgkmcnt(0)
    v_add_u32 v55, 131072, v51
    v_xor_b32 v56, 32, v55
    ds_read_b64_tr_b16 a[208:209], v55 offset:0
    ds_read_b64_tr_b16 a[210:211], v55 offset:256
    ds_read_b64_tr_b16 a[212:213], v55 offset:8192
    ds_read_b64_tr_b16 a[214:215], v55 offset:8448
    s_mov_b32 s77, 24576
    s_call_b64 s[82:83], cs_dma
    ds_read_b64_tr_b16 a[216:217], v56 offset:0
    ds_read_b64_tr_b16 a[218:219], v56 offset:256
    ds_read_b64_tr_b16 a[220:221], v56 offset:8192
    ds_read_b64_tr_b16 a[222:223], v56 offset:8448
    s_mov_b32 s77, 32768
    s_call_b64 s[82:83], cs_dma
    v_cmp_eq_u32 vcc, 2, v29
    s_nop 1
    v_cndmask_b32 v17, 0, v31, vcc
    v_cmp_eq_u32 vcc, 3, v29
    s_nop 1
    v_cndmask_b32 v17, v17, v32, vcc
    v_cmp_eq_u32 vcc, 2, v28
    s_nop 1
    v_cndmask_b32 v21, 0, v31, vcc
    v_cmp_eq_u32 vcc, 3, v28
    s_nop 1
    v_cndmask_b32 v21, v21, v32, vcc
    s_nop 1
    s_waitcnt lgkmcnt(0)
    s_waitcnt vmcnt(8)
    v_add_u32 v55, 65536, v51
    v_xor_b32 v56, 32, v55
    ds_read_b64_tr_b16 a[224:225], v55 offset:0
    ds_read_b64_tr_b16 a[226:227], v55 offset:256
    ds_read_b64_tr_b16 a[228:229], v55 offset:8192
    ds_read_b64_tr_b16 a[230:231], v55 offset:8448
    s_xor_b32 s78, s75, 3145728
    s_add_u32 s78, s78, s67
    s_add_u32 s80, s66, 32768
    s_mov_b32 s76, 0
    s_mov_b32 s77, 8192
    s_call_b64 s[82:83], cs_dma
    ds_read_b64_tr_b16 a[232:233], v56 offset:0
    ds_read_b64_tr_b16 a[234:235], v56 offset:256
    ds_read_b64_tr_b16 a[236:237], v56 offset:8192
    ds_read_b64_tr_b16 a[238:239], v56 offset:8448
    s_mov_b32 s77, 16384
    s_call_b64 s[82:83], cs_dma
    v_cmp_eq_u32 vcc, 8, v29
    s_nop 1
    v_cndmask_b32 v18, 0, v31, vcc
    v_cmp_eq_u32 vcc, 9, v29
    s_nop 1
    v_cndmask_b32 v18, v18, v32, vcc
    v_cmp_eq_u32 vcc, 4, v28
    s_nop 1
    v_cndmask_b32 v22, 0, v31, vcc
    v_cmp_eq_u32 vcc, 5, v28
    s_nop 1
    v_cndmask_b32 v22, v22, v32, vcc
    s_nop 1
    s_waitcnt lgkmcnt(0)
    v_add_u32 v55, 81920, v51
    v_xor_b32 v56, 32, v55
    ds_read_b64_tr_b16 a[240:241], v55 offset:0
    ds_read_b64_tr_b16 a[242:243], v55 offset:256
    ds_read_b64_tr_b16 a[244:245], v55 offset:8192
    ds_read_b64_tr_b16 a[246:247], v55 offset:8448
    s_mov_b32 s77, 24576
    s_call_b64 s[82:83], cs_dma
    ds_read_b64_tr_b16 a[248:249], v56 offset:0
    ds_read_b64_tr_b16 a[250:251], v56 offset:256
    ds_read_b64_tr_b16 a[252:253], v56 offset:8192
    ds_read_b64_tr_b16 a[254:255], v56 offset:8448
    s_mov_b32 s77, 32768
    s_call_b64 s[82:83], cs_dma
    v_cmp_eq_u32 vcc, 10, v29
    s_nop 1
    v_cndmask_b32 v19, 0, v31, vcc
    v_cmp_eq_u32 vcc, 11, v29
    s_nop 1
    v_cndmask_b32 v19, v19, v32, vcc
    v_cmp_eq_u32 vcc, 6, v28
    s_nop 1
    v_cndmask_b32 v23, 0, v31, vcc
    v_cmp_eq_u32 vcc, 7, v28
    s_nop 1
    v_cndmask_b32 v23, v23, v32, vcc
    s_nop 1
    s_waitcnt lgkmcnt(0)
    s_waitcnt vmcnt(8)
    v_add_u32 v55, 0, v51
    v_xor_b32 v56, 32, v55
    ds_read_b64_tr_b16 v[80:81], v55 offset:0
    ds_read_b64_tr_b16 v[82:83], v55 offset:256
    ds_read_b64_tr_b16 v[84:85], v55 offset:8192
    ds_read_b64_tr_b16 v[86:87], v55 offset:8448
    s_xor_b32 s78, s75, 2097152
    s_add_u32 s78, s78, s67
    s_mov_b64 s[8:9], s[52:53]
    s_add_u32 s80, s66, 131072
    s_mov_b32 s76, 0
    s_mov_b32 s77, 8192
    s_call_b64 s[82:83], cs_dma
    ds_read_b64_tr_b16 v[88:89], v56 offset:0
    ds_read_b64_tr_b16 v[90:91], v56 offset:256
    ds_read_b64_tr_b16 v[92:93], v56 offset:8192
    ds_read_b64_tr_b16 v[94:95], v56 offset:8448
    s_mov_b32 s77, 16384
    s_call_b64 s[82:83], cs_dma
    v_mov_b32 v46, 1
    s_mov_b64 exec, 1
    buffer_atomic_add v46, off, s[96:99], 0 offset:212 sc0
    s_mov_b64 exec, -1
    s_waitcnt lgkmcnt(0)
    v_add_u32 v55, 16384, v51
    v_xor_b32 v56, 32, v55
    ds_read_b64_tr_b16 v[96:97], v55 offset:0
    ds_read_b64_tr_b16 v[98:99], v55 offset:256
    ds_read_b64_tr_b16 v[100:101], v55 offset:8192
    ds_read_b64_tr_b16 v[102:103], v55 offset:8448
    s_mov_b32 s77, 24576
    s_call_b64 s[82:83], cs_dma
    ds_read_b64_tr_b16 v[104:105], v56 offset:0
    ds_read_b64_tr_b16 v[106:107], v56 offset:256
    ds_read_b64_tr_b16 v[108:109], v56 offset:8192
    ds_read_b64_tr_b16 v[110:111], v56 offset:8448
    s_mov_b32 s77, 32768
    s_call_b64 s[82:83], cs_dma
    s_waitcnt lgkmcnt(0)
    s_waitcnt vmcnt(9)
    v_add_u32 v55, 32768, v51
    v_xor_b32 v56, 32, v55
    ds_read_b64_tr_b16 v[112:113], v55 offset:0
    ds_read_b64_tr_b16 v[114:115], v55 offset:256
    ds_read_b64_tr_b16 v[116:117], v55 offset:8192
    ds_read_b64_tr_b16 v[118:119], v55 offset:8448
    s_xor_b32 s78, s75, 3145728
    s_add_u32 s78, s78, s67
    s_add_u32 s80, s66, 65536
    s_mov_b32 s76, 0
    s_mov_b32 s77, 8192
    s_call_b64 s[82:83], cs_dma
    ds_read_b64_tr_b16 v[120:121], v56 offset:0
    ds_read_b64_tr_b16 v[122:123], v56 offset:256
    ds_read_b64_tr_b16 v[124:125], v56 offset:8192
    ds_read_b64_tr_b16 v[126:127], v56 offset:8448
    s_mov_b32 s77, 16384
    s_call_b64 s[82:83], cs_dma
    s_waitcnt lgkmcnt(0)
    v_add_u32 v55, 49152, v51
    v_xor_b32 v56, 32, v55
    ds_read_b64_tr_b16 v[128:129], v55 offset:0
    ds_read_b64_tr_b16 v[130:131], v55 offset:256
    ds_read_b64_tr_b16 v[132:133], v55 offset:8192
    ds_read_b64_tr_b16 v[134:135], v55 offset:8448
    s_mov_b32 s77, 24576
    s_call_b64 s[82:83], cs_dma
    ds_read_b64_tr_b16 v[136:137], v56 offset:0
    ds_read_b64_tr_b16 v[138:139], v56 offset:256
    ds_read_b64_tr_b16 v[140:141], v56 offset:8192
    ds_read_b64_tr_b16 v[142:143], v56 offset:8448
    s_mov_b32 s77, 32768
    s_call_b64 s[82:83], cs_dma
    s_waitcnt lgkmcnt(0)
    s_waitcnt vmcnt(8)
    v_add_u32 v55, 131072, v51
    v_xor_b32 v56, 32, v55
    ds_read_b64_tr_b16 a[128:129], v55 offset:0
    ds_read_b64_tr_b16 a[130:131], v55 offset:256
    ds_read_b64_tr_b16 a[132:133], v55 offset:8192
    ds_read_b64_tr_b16 a[134:135], v55 offset:8448
    s_xor_b32 s78, s75, 2097152
    s_add_u32 s78, s78, s67
    s_mov_b64 s[8:9], s[50:51]
    s_add_u32 s80, s66, 0
    s_mov_b32 s76, 0
    s_mov_b32 s77, 8192
    s_call_b64 s[82:83], cs_dma
    ds_read_b64_tr_b16 a[136:137], v56 offset:0
    ds_read_b64_tr_b16 a[138:139], v56 offset:256
    ds_read_b64_tr_b16 a[140:141], v56 offset:8192
    ds_read_b64_tr_b16 a[142:143], v56 offset:8448
    s_mov_b32 s77, 16384
    s_call_b64 s[82:83], cs_dma
    s_waitcnt lgkmcnt(0)
    v_add_u32 v55, 147456, v51
    v_xor_b32 v56, 32, v55
    ds_read_b64_tr_b16 a[144:145], v55 offset:0
    ds_read_b64_tr_b16 a[146:147], v55 offset:256
    ds_read_b64_tr_b16 a[148:149], v55 offset:8192
    ds_read_b64_tr_b16 a[150:151], v55 offset:8448
    s_mov_b32 s77, 24576
    s_call_b64 s[82:83], cs_dma
    ds_read_b64_tr_b16 a[152:153], v56 offset:0
    ds_read_b64_tr_b16 a[154:155], v56 offset:256
    ds_read_b64_tr_b16 a[156:157], v56 offset:8192
    ds_read_b64_tr_b16 a[158:159], v56 offset:8448
    s_mov_b32 s77, 32768
    s_call_b64 s[82:83], cs_dma
    s_waitcnt lgkmcnt(0)
    s_waitcnt vmcnt(8)
    v_add_u32 v55, 65536, v51
    v_xor_b32 v56, 32, v55
    ds_read_b64_tr_b16 a[160:161], v55 offset:0
    ds_read_b64_tr_b16 a[162:163], v55 offset:256
    ds_read_b64_tr_b16 a[164:165], v55 offset:8192
    ds_read_b64_tr_b16 a[166:167], v55 offset:8448
    s_xor_b32 s78, s75, 3145728
    s_add_u32 s78, s78, s67
    s_add_u32 s80, s66, 32768
    s_mov_b32 s76, 0
    s_mov_b32 s77, 8192
    s_call_b64 s[82:83], cs_dma
    ds_read_b64_tr_b16 a[168:169], v56 offset:0
    ds_read_b64_tr_b16 a[170:171], v56 offset:256
    ds_read_b64_tr_b16 a[172:173], v56 offset:8192
    ds_read_b64_tr_b16 a[174:175], v56 offset:8448
    s_mov_b32 s77, 16384
    s_call_b64 s[82:83], cs_dma
    v_readfirstlane_b32 s41, v46
    v_mov_b32 v46, 1
    v_mov_b32 v47, 0
    s_cmp_eq_u32 s41, 127
    s_cselect_b64 exec, 1, 0
    buffer_atomic_cmpswap v[46:47], off, s[96:99], 0 offset:216
    s_mov_b64 exec, -1
    s_waitcnt lgkmcnt(0)
    v_add_u32 v55, 81920, v51
    v_xor_b32 v56, 32, v55
    ds_read_b64_tr_b16 a[176:177], v55 offset:0
    ds_read_b64_tr_b16 a[178:179], v55 offset:256
    ds_read_b64_tr_b16 a[180:181], v55 offset:8192
    ds_read_b64_tr_b16 a[182:183], v55 offset:8448
    s_mov_b32 s77, 24576
    s_call_b64 s[82:83], cs_dma
    ds_read_b64_tr_b16 a[184:185], v56 offset:0
    ds_read_b64_tr_b16 a[186:187], v56 offset:256
    ds_read_b64_tr_b16 a[188:189], v56 offset:8192
    ds_read_b64_tr_b16 a[190:191], v56 offset:8448
    s_mov_b32 s77, 32768
    s_call_b64 s[82:83], cs_dma
    s_waitcnt lgkmcnt(0)
    s_waitcnt vmcnt(8)
    v_add_u32 v55, 0, v51
    v_xor_b32 v56, 32, v55
    ds_read_b64_tr_b16 a[48:49], v55 offset:0
    ds_read_b64_tr_b16 a[50:51], v55 offset:256
    ds_read_b64_tr_b16 a[52:53], v55 offset:8192
    ds_read_b64_tr_b16 a[54:55], v55 offset:8448
    s_add_u32 s78, s67, 4194304
    s_mov_b32 s81, 0
    s_add_u32 s80, s66, 98304
    s_mov_b32 s76, 0
    s_mov_b32 s77, 8192
    s_call_b64 s[82:83], cs_dma
    ds_read_b64_tr_b16 a[56:57], v56 offset:0
    ds_read_b64_tr_b16 a[58:59], v56 offset:256
    ds_read_b64_tr_b16 a[60:61], v56 offset:8192
    ds_read_b64_tr_b16 a[62:63], v56 offset:8448
    s_mov_b32 s77, 16384
    s_call_b64 s[82:83], cs_dma
    s_waitcnt lgkmcnt(0)
    v_add_u32 v55, 16384, v51
    v_xor_b32 v56, 32, v55
    ds_read_b64_tr_b16 a[64:65], v55 offset:0
    ds_read_b64_tr_b16 a[66:67], v55 offset:256
    ds_read_b64_tr_b16 a[68:69], v55 offset:8192
    ds_read_b64_tr_b16 a[70:71], v55 offset:8448
    s_xor_b32 s78, s75, 1048576
    s_add_u32 s78, s78, s67
    s_mov_b32 s81, s93
    s_add_u32 s80, s66, 114688
    s_mov_b32 s76, 0
    s_mov_b32 s77, 8192
    s_call_b64 s[82:83], cs_dma
    ds_read_b64_tr_b16 a[72:73], v56 offset:0
    ds_read_b64_tr_b16 a[74:75], v56 offset:256
    ds_read_b64_tr_b16 a[76:77], v56 offset:8192
    ds_read_b64_tr_b16 a[78:79], v56 offset:8448
    s_mov_b32 s77, 16384
    s_call_b64 s[82:83], cs_dma
    s_waitcnt lgkmcnt(0)
    s_waitcnt vmcnt(8)
    v_add_u32 v55, 32768, v51
    v_xor_b32 v56, 32, v55
    ds_read_b64_tr_b16 a[80:81], v55 offset:0
    ds_read_b64_tr_b16 a[82:83], v55 offset:256
    ds_read_b64_tr_b16 a[84:85], v55 offset:8192
    ds_read_b64_tr_b16 a[86:87], v55 offset:8448
    s_mov_b32 s77, 24576
    s_call_b64 s[82:83], cs_dma
    ds_read_b64_tr_b16 a[88:89], v56 offset:0
    ds_read_b64_tr_b16 a[90:91], v56 offset:256
    ds_read_b64_tr_b16 a[92:93], v56 offset:8192
    ds_read_b64_tr_b16 a[94:95], v56 offset:8448
    s_mov_b32 s77, 32768
    s_call_b64 s[82:83], cs_dma
    s_waitcnt lgkmcnt(0)
    v_add_u32 v55, 49152, v51
    v_xor_b32 v56, 32, v55
    ds_read_b64_tr_b16 a[96:97], v55 offset:0
    ds_read_b64_tr_b16 a[98:99], v55 offset:256
    ds_read_b64_tr_b16 a[100:101], v55 offset:8192
    ds_read_b64_tr_b16 a[102:103], v55 offset:8448
    s_xor_b32 s78, s75, 0
    s_add_u32 s78, s78, s67
    s_add_u32 s80, s66, 65536
    s_mov_b32 s76, 0
    s_mov_b32 s77, 8192
    s_call_b64 s[82:83], cs_dma
    ds_read_b64_tr_b16 a[104:105], v56 offset:0
    ds_read_b64_tr_b16 a[106:107], v56 offset:256
    ds_read_b64_tr_b16 a[108:109], v56 offset:8192
    ds_read_b64_tr_b16 a[110:111], v56 offset:8448
    s_mov_b32 s77, 16384
    s_call_b64 s[82:83], cs_dma
    s_waitcnt lgkmcnt(0)
    s_waitcnt vmcnt(12)
    v_add_u32 v55, 98304, v51
    v_xor_b32 v56, 32, v55
    ds_read_b64_tr_b16 a[112:113], v55 offset:0
    ds_read_b64_tr_b16 a[114:115], v55 offset:256
    ds_read_b64_tr_b16 a[116:117], v55 offset:8192
    ds_read_b64_tr_b16 a[118:119], v55 offset:8448
    s_mov_b32 s77, 24576
    s_call_b64 s[82:83], cs_dma
    ds_read_b64_tr_b16 a[120:121], v56 offset:0
    ds_read_b64_tr_b16 a[122:123], v56 offset:256
    ds_read_b64_tr_b16 a[124:125], v56 offset:8192
    ds_read_b64_tr_b16 a[126:127], v56 offset:8448
    s_mov_b32 s77, 32768
    s_call_b64 s[82:83], cs_dma
    s_waitcnt lgkmcnt(0)
    s_waitcnt vmcnt(8)
    v_add_u32 v55, 114688, v51
    v_xor_b32 v56, 32, v55
    ds_read_b64_tr_b16 a[16:17], v55 offset:0
    ds_read_b64_tr_b16 a[18:19], v55 offset:256
    ds_read_b64_tr_b16 a[20:21], v55 offset:8192
    ds_read_b64_tr_b16 a[22:23], v55 offset:8448
    s_xor_b32 s78, s75, 0
    s_add_u32 s78, s78, s67
    s_mov_b64 s[8:9], s[52:53]
    s_add_u32 s80, s66, 0
    s_mov_b32 s76, 0
    s_mov_b32 s77, 8192
    s_call_b64 s[82:83], cs_dma
    ds_read_b64_tr_b16 a[24:25], v56 offset:0
    ds_read_b64_tr_b16 a[26:27], v56 offset:256
    ds_read_b64_tr_b16 a[28:29], v56 offset:8192
    ds_read_b64_tr_b16 a[30:31], v56 offset:8448
    s_mov_b32 s77, 16384
    s_call_b64 s[82:83], cs_dma
    s_waitcnt lgkmcnt(0)
    v_add_u32 v55, 131072, v51
    v_xor_b32 v56, 32, v55
    ds_read_b64_tr_b16 a[32:33], v55 offset:0
    ds_read_b64_tr_b16 a[34:35], v55 offset:256
    ds_read_b64_tr_b16 a[36:37], v55 offset:8192
    ds_read_b64_tr_b16 a[38:39], v55 offset:8448
    s_mov_b32 s77, 24576
    s_call_b64 s[82:83], cs_dma
    ds_read_b64_tr_b16 a[40:41], v56 offset:0
    ds_read_b64_tr_b16 a[42:43], v56 offset:256
    ds_read_b64_tr_b16 a[44:45], v56 offset:8192
    ds_read_b64_tr_b16 a[46:47], v56 offset:8448
    s_mov_b32 s77, 32768
    s_call_b64 s[82:83], cs_dma
    s_waitcnt lgkmcnt(0)
    s_waitcnt vmcnt(8)
    v_add_u32 v55, 65536, v51
    v_xor_b32 v56, 32, v55
    ds_read_b64_tr_b16 v[0:1], v55 offset:0
    ds_read_b64_tr_b16 v[2:3], v55 offset:256
    ds_read_b64_tr_b16 v[4:5], v55 offset:8192
    ds_read_b64_tr_b16 v[6:7], v55 offset:8448
    s_xor_b32 s78, s75, 1048576
    s_add_u32 s78, s78, s67
    s_add_u32 s80, s66, 32768
    s_mov_b32 s76, 0
    s_mov_b32 s77, 8192
    s_call_b64 s[82:83], cs_dma
    ds_read_b64_tr_b16 v[8:9], v56 offset:0
    ds_read_b64_tr_b16 v[10:11], v56 offset:256
    ds_read_b64_tr_b16 v[12:13], v56 offset:8192
    ds_read_b64_tr_b16 v[14:15], v56 offset:8448
    s_mov_b32 s77, 16384
    s_call_b64 s[82:83], cs_dma
    s_waitcnt lgkmcnt(0)
    ds_write_b128 v62, v[0:3] offset:8192
    ds_write_b128 v62, v[4:7] offset:12288
    ds_write_b128 v62, v[8:11] offset:16384
    ds_write_b128 v62, v[12:15] offset:20480
    s_waitcnt lgkmcnt(0)
    v_add_u32 v55, 81920, v51
    v_xor_b32 v56, 32, v55
    ds_read_b64_tr_b16 a[0:1], v55 offset:0
    ds_read_b64_tr_b16 a[2:3], v55 offset:256
    ds_read_b64_tr_b16 a[4:5], v55 offset:8192
    ds_read_b64_tr_b16 a[6:7], v55 offset:8448
    s_mov_b32 s77, 24576
    s_call_b64 s[82:83], cs_dma
    ds_read_b64_tr_b16 a[8:9], v56 offset:0
    ds_read_b64_tr_b16 a[10:11], v56 offset:256
    ds_read_b64_tr_b16 a[12:13], v56 offset:8192
    ds_read_b64_tr_b16 a[14:15], v56 offset:8448
    s_mov_b32 s77, 32768
    s_call_b64 s[82:83], cs_dma
    s_waitcnt lgkmcnt(0)
    s_waitcnt vmcnt(8)
    v_add_u32 v55, 0, v51
    v_xor_b32 v56, 32, v55
    ds_read_b64_tr_b16 v[0:1], v55 offset:0
    ds_read_b64_tr_b16 v[2:3], v55 offset:256
    ds_read_b64_tr_b16 v[4:5], v55 offset:8192
    ds_read_b64_tr_b16 v[6:7], v55 offset:8448
    s_xor_b32 s94, s13, 0
    s_mul_i32 s94, s94, 36864
    s_add_u32 s94, s94, s92
    s_lshr_b32 s74, s13, 1
    s_lshl_b32 s74, s74, 6
    s_add_u32 s94, s94, s74
    s_add_u32 s78, s94, 1024
    s_mov_b64 s[8:9], s[56:57]
    v_mov_b32 v58, v50
    s_mov_b32 s79, 18432
    s_mov_b32 s81, 0
    s_add_u32 s80, s66, 147456
    s_mov_b32 s76, 0
    s_mov_b32 s77, 8192
    s_call_b64 s[82:83], cs_dma
    ds_read_b64_tr_b16 v[8:9], v56 offset:0
    ds_read_b64_tr_b16 v[10:11], v56 offset:256
    ds_read_b64_tr_b16 v[12:13], v56 offset:8192
    ds_read_b64_tr_b16 v[14:15], v56 offset:8448
    s_xor_b32 s94, s13, 2
    s_mul_i32 s94, s94, 36864
    s_add_u32 s94, s94, s92
    s_lshr_b32 s74, s13, 1
    s_lshl_b32 s74, s74, 6
    s_add_u32 s94, s94, s74
    s_add_u32 s78, s94, 1024
    s_mov_b32 s77, 16384
    s_call_b64 s[82:83], cs_dma
    s_waitcnt lgkmcnt(0)
    ds_write_b128 v61, v[0:3] offset:0
    ds_write_b128 v61, v[4:7] offset:4096
    ds_write_b128 v61, v[8:11] offset:8192
    ds_write_b128 v61, v[12:15] offset:12288
    s_waitcnt lgkmcnt(0)
    v_add_u32 v55, 16384, v51
    v_xor_b32 v56, 32, v55
    ds_read_b64_tr_b16 v[0:1], v55 offset:0
    ds_read_b64_tr_b16 v[2:3], v55 offset:256
    ds_read_b64_tr_b16 v[4:5], v55 offset:8192
    ds_read_b64_tr_b16 v[6:7], v55 offset:8448
    s_xor_b32 s94, s13, 3
    s_mul_i32 s94, s94, 36864
    s_add_u32 s94, s94, s92
    s_lshl_b32 s74, s13, 7
    s_add_u32 s94, s94, s74
    s_add_u32 s78, s94, 512
    v_mov_b32 v58, v49
    s_mov_b32 s79, 9216
    s_add_u32 s80, s66, 131072
    s_mov_b32 s76, 0
    s_mov_b32 s77, 8192
    s_call_b64 s[82:83], cs_dma
    ds_read_b64_tr_b16 v[8:9], v56 offset:0
    ds_read_b64_tr_b16 v[10:11], v56 offset:256
    ds_read_b64_tr_b16 v[12:13], v56 offset:8192
    ds_read_b64_tr_b16 v[14:15], v56 offset:8448
    s_mov_b32 s77, 16384
    s_call_b64 s[82:83], cs_dma
    s_waitcnt lgkmcnt(0)
    ds_write_b128 v61, v[0:3] offset:16384
    ds_write_b128 v61, v[4:7] offset:20480
    ds_write_b128 v61, v[8:11] offset:24576
    ds_write_b128 v61, v[12:15] offset:28672
    s_waitcnt lgkmcnt(0)
    s_waitcnt vmcnt(8)
    v_add_u32 v55, 32768, v51
    v_xor_b32 v56, 32, v55
    ds_read_b64_tr_b16 v[0:1], v55 offset:0
    ds_read_b64_tr_b16 v[2:3], v55 offset:256
    ds_read_b64_tr_b16 v[4:5], v55 offset:8192
    ds_read_b64_tr_b16 v[6:7], v55 offset:8448
    s_xor_b32 s94, s13, 2
    s_mul_i32 s94, s94, 36864
    s_add_u32 s94, s94, s92
    s_lshl_b32 s74, s13, 7
    s_add_u32 s94, s94, s74
    s_add_u32 s78, s94, 512
    s_add_u32 s80, s66, 114688
    s_mov_b32 s76, 0
    s_mov_b32 s77, 8192
    s_call_b64 s[82:83], cs_dma
    ds_read_b64_tr_b16 v[8:9], v56 offset:0
    ds_read_b64_tr_b16 v[10:11], v56 offset:256
    ds_read_b64_tr_b16 v[12:13], v56 offset:8192
    ds_read_b64_tr_b16 v[14:15], v56 offset:8448
    s_mov_b32 s77, 16384
    s_call_b64 s[82:83], cs_dma
    s_waitcnt lgkmcnt(0)
    ds_write_b128 v61, v[0:3] offset:32768
    ds_write_b128 v61, v[4:7] offset:36864
    ds_write_b128 v61, v[8:11] offset:40960
    ds_write_b128 v61, v[12:15] offset:45056
    s_waitcnt lgkmcnt(0)
    v_add_u32 v55, 49152, v51
    v_xor_b32 v56, 32, v55
    ds_read_b64_tr_b16 v[0:1], v55 offset:0
    ds_read_b64_tr_b16 v[2:3], v55 offset:256
    ds_read_b64_tr_b16 v[4:5], v55 offset:8192
    ds_read_b64_tr_b16 v[6:7], v55 offset:8448
    s_add_u32 s78, s67, 4194304
    s_mov_b64 s[8:9], s[52:53]
    v_mov_b32 v58, v48
    s_mov_b32 s79, 131072
    s_add_u32 s80, s66, 81920
    s_mov_b32 s76, 0
    s_mov_b32 s77, 8192
    s_call_b64 s[82:83], cs_dma
    ds_read_b64_tr_b16 v[8:9], v56 offset:0
    ds_read_b64_tr_b16 v[10:11], v56 offset:256
    ds_read_b64_tr_b16 v[12:13], v56 offset:8192
    ds_read_b64_tr_b16 v[14:15], v56 offset:8448
    s_mov_b32 s77, 16384
    s_call_b64 s[82:83], cs_dma
    s_waitcnt lgkmcnt(0)
    ds_write_b128 v61, v[0:3] offset:49152
    ds_write_b128 v61, v[4:7] offset:53248
    ds_write_b128 v61, v[8:11] offset:57344
    ds_write_b128 v61, v[12:15] offset:61440
    s_waitcnt lgkmcnt(0)
    buffer_load_dword v24, off, s[96:99], 0 offset:216 sc1
    buffer_load_dword v25, off, s[96:99], 0 offset:64 sc1
    s_lshr_b32 s84, s12, 1
    s_lshl_b32 s84, s84, 8
    s_add_u32 s84, s84, 125829120
    v_bfe_u32 v26, v61, 4, 6
    v_min_u32 v26, 11, v26
    v_lshlrev_b32 v26, 2, v26
    buffer_load_dword v27, v26, s[4:7], s84 offen sc1
    s_waitcnt vmcnt(15)
    v_add_u32 v55, 147456, v53
    ds_read_b64_tr_b16 v[0:1], v55 offset:0
    ds_read_b64_tr_b16 v[2:3], v55 offset:128
    ds_read_b64_tr_b16 v[4:5], v55 offset:512
    ds_read_b64_tr_b16 v[6:7], v55 offset:640
    ds_read_b64_tr_b16 v[8:9], v55 offset:8192
    ds_read_b64_tr_b16 v[10:11], v55 offset:8320
    ds_read_b64_tr_b16 v[12:13], v55 offset:8704
    ds_read_b64_tr_b16 v[14:15], v55 offset:8832
    s_waitcnt lgkmcnt(0)
    s_barrier
    ds_write_b128 v63, v[0:3] offset:49152
    ds_write_b128 v63, v[4:7] offset:53248
    s_barrier
    ds_write_b128 v63, v[8:11] offset:57344
    ds_write_b128 v63, v[12:15] offset:61440
    s_waitcnt lgkmcnt(0)
    v_lshlrev_b32 v45, 3, v61
    s_lshl_b32 s40, s12, 14
    s_add_u32 s40, s40, 65536
    s_lshl_b32 s41, s12, 11
    s_sub_u32 s41, s41, 12288
    v_add_u32 v30, s40, v45
    v_add_u32 v45, s41, v45
    v_cmp_gt_u32 vcc, 1536, v61
    s_nop 1
    v_cndmask_b32 v45, v45, v30, vcc
    s_lshl_b32 s40, s12, 16
    s_add_u32 s40, s40, 24102912
    v_lshlrev_b32 v30, 3, v61
    v_add_u32 v30, s40, v30
    v_cmp_gt_u32 vcc, 1792, v61
    s_nop 1
    v_cndmask_b32 v45, v30, v45, vcc
    v_cmp_gt_u32 vcc, 2944, v61
    s_mov_b32 s40, 68157440
    s_mov_b64 exec, vcc
    buffer_load_dword v30, v45, s[4:7], s40 offen sc1
    s_mov_b64 exec, -1
    s_waitcnt vmcnt(11)
    v_add_u32 v55, 131072, v52
    ds_read_b64_tr_b16 v[0:1], v55 offset:0
    ds_read_b64_tr_b16 v[2:3], v55 offset:256
    ds_read_b64_tr_b16 v[4:5], v55 offset:4096
    ds_read_b64_tr_b16 v[6:7], v55 offset:4352
    ds_read_b64_tr_b16 v[8:9], v55 offset:64
    ds_read_b64_tr_b16 v[10:11], v55 offset:320
    ds_read_b64_tr_b16 v[12:13], v55 offset:4160
    ds_read_b64_tr_b16 v[14:15], v55 offset:4416
    s_waitcnt lgkmcnt(0)
    s_barrier
    ds_write_b128 v63, v[0:3] offset:32768
    ds_write_b128 v63, v[4:7] offset:36864
    s_barrier
    ds_write_b128 v63, v[8:11] offset:40960
    ds_write_b128 v63, v[12:15] offset:45056
    s_waitcnt lgkmcnt(0)
    s_waitcnt vmcnt(7)
    v_add_u32 v55, 114688, v52
    ds_read_b64_tr_b16 v[0:1], v55 offset:0
    ds_read_b64_tr_b16 v[2:3], v55 offset:256
    ds_read_b64_tr_b16 v[4:5], v55 offset:4096
    ds_read_b64_tr_b16 v[6:7], v55 offset:4352
    ds_read_b64_tr_b16 v[8:9], v55 offset:64
    ds_read_b64_tr_b16 v[10:11], v55 offset:320
    ds_read_b64_tr_b16 v[12:13], v55 offset:4160
    ds_read_b64_tr_b16 v[14:15], v55 offset:4416
    s_waitcnt lgkmcnt(0)
    s_barrier
    ds_write_b128 v63, v[0:3] offset:16384
    ds_write_b128 v63, v[4:7] offset:20480
    s_barrier
    ds_write_b128 v63, v[8:11] offset:24576
    ds_write_b128 v63, v[12:15] offset:28672
    s_waitcnt lgkmcnt(0)
    v_min_u32 v36, -2, v36
    v_min_u32 v37, -2, v37
    v_min_u32 v38, -2, v38
    v_min_u32 v39, -2, v39
    v_min_u32 v40, -2, v40
    v_min_u32 v41, -2, v41
    v_min_u32 v42, -2, v42
    v_min_u32 v43, -2, v43
    v_min_u32 v44, -2, v44
    s_lshl_b32 s14, s12, 16
    s_add_u32 s14, s14, 92274688
    s_add_u32 s41, s14, 4096
    s_add_u32 s42, s14, 8192
    v_lshrrev_b32 v45, 2, v61
    buffer_store_dwordx4 v[36:39], v61, s[4:7], s14 offen sc1
    buffer_store_dwordx4 v[40:43], v61, s[4:7], s41 offen sc1
    buffer_store_dword v44, v45, s[4:7], s42 offen sc1
    s_waitcnt vmcnt(1)
    v_readfirstlane_b32 s95, v25
    v_readfirstlane_b32 s85, v24
    s_add_u32 s86, s95, 2
    s_waitcnt vmcnt(0)
    v_subrev_u32 v27, s86, v27
    v_cmp_lt_u32 s[86:87], 64, v27
    s_cmp_eq_u32 s95, 0
    s_cselect_b64 s[86:87], -1, s[86:87]
    s_cmp_lg_u64 s[86:87], 0
    s_cbranch_scc1 cs_nt
    s_add_u32 s40, s24, 524288
    buffer_load_dword v30, v79, s[4:7], s24 offen sc1
    buffer_load_dword v30, v79, s[4:7], s40 offen sc1
cs_nt:
    s_waitcnt vmcnt(3)
    v_add_u32 v55, 81920, v51
    v_xor_b32 v56, 32, v55
    ds_read_b64_tr_b16 v[0:1], v55 offset:0
    ds_read_b64_tr_b16 v[2:3], v55 offset:256
    ds_read_b64_tr_b16 v[4:5], v55 offset:8192
    ds_read_b64_tr_b16 v[6:7], v55 offset:8448
    ds_read_b64_tr_b16 v[8:9], v56 offset:0
    ds_read_b64_tr_b16 v[10:11], v56 offset:256
    ds_read_b64_tr_b16 v[12:13], v56 offset:8192
    ds_read_b64_tr_b16 v[14:15], v56 offset:8448
    s_waitcnt lgkmcnt(0)
    ds_write_b128 v62, v[0:3] offset:24576
    ds_write_b128 v62, v[4:7] offset:28672
    ds_write_b128 v62, v[8:11] offset:32768
    ds_write_b128 v62, v[12:15] offset:36864
    s_waitcnt lgkmcnt(0)
    s_barrier
    s_mov_b32 s88, 4194304
gn3:
    s_cmp_lg_u32 s95, 0
    s_cbranch_scc1 gn3x
    buffer_load_dword v27, off, s[96:99], 0 offset:64 sc1
    s_sub_u32 s88, s88, 1
    s_cbranch_scc1 gn3x
    s_waitcnt vmcnt(0)
    v_readfirstlane_b32 s95, v27
    s_nop 1
    s_branch gn3
gn3x:
    ds_write_b128 v78, v[16:19] offset:8704
    ds_write_b128 v65, v[20:23] offset:10240
    v_mov_b32 v44, s95
    v_mov_b32 v45, s95
    v_mov_b32 v46, s95
    v_mov_b32 v47, s95
    v_mov_b32 v48, 108288
    ds_write_b128 v48, v[44:47]
    s_waitcnt vmcnt(0) lgkmcnt(0)
    s_cmp_eq_u32 s85, 1
    s_cbranch_scc1 cs_run
    s_mov_b32 s40, 16777216
cs_startpoll:
    buffer_load_dword v3, off, s[96:99], 0 offset:216 sc1
    s_waitcnt vmcnt(0)
    v_readfirstlane_b32 s85, v3
    s_nop 0
    s_cmp_eq_u32 s85, 1
    s_cbranch_scc1 cs_run
    s_sleep 1
    s_sub_u32 s40, s40, 1
    s_cbranch_scc0 cs_startpoll
    s_endpgm
cs_run:
    s_cmp_eq_u64 s[86:87], 0
    s_cbranch_scc1 cs_kvok
    s_lshr_b32 s92, s12, 1
    s_lshl_b32 s92, s92, 8
    s_add_u32 s92, s92, 125829120
    v_bfe_u32 v2, v61, 4, 6
    v_min_u32 v2, 11, v2
    v_lshlrev_b32 v2, 2, v2
    s_add_u32 s93, s95, 2
    s_mov_b32 s94, 4194304
cs_kv0:
    buffer_load_dword v3, v2, s[4:7], s92 offen sc1
    s_sub_u32 s94, s94, 1
    s_cbranch_scc1 cs_kv0_go
    s_waitcnt vmcnt(0)
    v_subrev_u32 v3, s93, v3
    v_cmp_lt_u32 vcc, 64, v3
    s_cbranch_vccz cs_kv0_go
    s_sleep 2
    s_branch cs_kv0
cs_kv0_go:
    s_add_u32 s40, s24, 524288
    buffer_load_dword v30, v79, s[4:7], s24 offen sc1
    buffer_load_dword v30, v79, s[4:7], s40 offen sc1
    s_waitcnt vmcnt(0)
cs_kvok:
    s_mov_b32 m0, 108032
    s_add_u32 s24, s24, 1048576
    s_add_u32 s15, s14, 4096
    s_add_u32 s16, s14, 8192
    ds_read_b128 v[32:35], v62 offset:16384
    ds_read_b128 v[36:39], v62 offset:20480
    ds_read_b128 v[40:43], v61 offset:0
    ds_read_b128 v[44:47], v61 offset:4096
    ds_read_b128 v[48:51], v61 offset:8192
    ds_read_b128 v[52:55], v61 offset:12288
    s_mov_b32 s29, 1048576
    buffer_load_dwordx4 v[24:27], v61, s[4:7], s14 offen sc1
.p2align 6
cs_loop:
    v_mov_b64 v[0:1], 0
    v_mov_b64 v[2:3], 0
    v_mov_b64 v[4:5], 0
    v_mov_b64 v[6:7], 0
    v_mov_b64 v[8:9], 0
    v_mov_b64 v[10:11], 0
    v_mov_b64 v[12:13], 0
    v_mov_b64 v[14:15], 0
cs_loop2:
    ds_read_b128 v[16:19], v62 offset:8192
    ds_read_b128 v[20:23], v62 offset:12288
    v_lshrrev_b32 v56, 2, v61
    v_add_u32 v58, 106496, v56
    s_mov_b32 s29, 1048576
    s_waitcnt lgkmcnt(0)
cs_chk0:
    s_waitcnt vmcnt(0)
cs_chk0b:
    v_max3_u32 v57, v24, v25, v26
    v_max_u32 v57, v57, v27
    v_cmp_eq_u32 vcc, -1, v57
    ds_write_b128 v62, v[24:27] offset:40960
    s_cbranch_vccnz cs_spin0
    v_smfmac_f32_16x16x64_bf16 v[0:3], v[24:27], v[16:23], v60
    buffer_load_dwordx4 v[28:31], v61, s[4:7], s15 offen sc1
    buffer_load_dword v59, v56, s[4:7], s16 offen sc1
    v_smfmac_f32_16x16x64_bf16 v[8:11], v[24:27], v[32:39], v60
    ds_read_b128 v[32:35], v61 offset:16384
    v_smfmac_f32_16x16x64_bf16 v[12:15], v[24:27], v[48:55], v60
    ds_read_b128 v[36:39], v61 offset:20480
    v_mfma_f32_16x16x16_bf16 v[16:19], v[72:73], v[72:73], 0
    s_waitcnt lgkmcnt(2)
    s_barrier
    ds_read_b128 v[48:51], v63 offset:0
    v_mfma_f32_16x16x16_bf16 v[20:23], v[72:73], v[72:73], 0
    ds_read_b128 v[52:55], v64 offset:0
    v_smfmac_f32_16x16x64_bf16 v[4:7], v[24:27], v[40:47], v60
    ds_read_b128 v[40:43], v61 offset:24576
    v_smfmac_f32_16x16x64_bf16 v[16:19], v[24:27], a[192:199], v60
    ds_read_b128 v[44:47], v61 offset:28672
    v_smfmac_f32_16x16x64_bf16 v[20:23], v[24:27], a[200:207], v60
    s_waitcnt lgkmcnt(3)
    v_smfmac_f32_16x16x64_bf16 v[0:3], v[48:51], a[0:7], v60
    s_add_u32 s18, s14, s31
    s_add_u32 s41, s14, 16384
    v_smfmac_f32_16x16x64_bf16 v[4:7], v[48:51], v[32:39], v60
    ds_read_b128 v[32:35], v61 offset:32768
    v_smfmac_f32_16x16x64_bf16 v[8:11], v[48:51], a[8:15], v60
    ds_read_b128 v[36:39], v61 offset:36864
    s_waitcnt lgkmcnt(2)
    v_smfmac_f32_16x16x64_bf16 v[12:15], v[48:51], v[40:47], v60
    ds_read_b128 v[40:43], v61 offset:40960
    v_smfmac_f32_16x16x64_bf16 v[0:3], v[52:55], a[16:23], v60
    ds_read_b128 v[44:47], v61 offset:45056
    v_smfmac_f32_16x16x64_bf16 v[8:11], v[52:55], a[24:31], v60
    ds_read_b128 v[48:51], v71 offset:0
    s_waitcnt lgkmcnt(3)
    v_smfmac_f32_16x16x64_bf16 v[4:7], v[52:55], v[32:39], v60
    s_waitcnt vmcnt(0)
    ds_write_b128 v62, v[28:31] offset:45056
    s_waitcnt lgkmcnt(2)
    v_smfmac_f32_16x16x64_bf16 v[12:15], v[52:55], v[40:47], v60
    ds_write_b32 v58, v59
    v_max3_u32 v57, v28, v29, v30
    s_waitcnt lgkmcnt(2)
    v_smfmac_f32_16x16x64_bf16 v[0:3], v[48:51], a[32:39], v60
    ds_read_b128 v[32:35], v61 offset:49152
    v_max3_u32 v57, v57, v31, v59
    v_smfmac_f32_16x16x64_bf16 v[8:11], v[48:51], a[40:47], v60
    ds_read_b128 v[36:39], v61 offset:53248
    v_cmp_eq_u32 vcc, -1, v57
    v_smfmac_f32_16x16x64_bf16 v[16:19], v[52:55], a[224:231], v60
    ds_read_b128 v[40:43], v61 offset:57344
    v_smfmac_f32_16x16x64_bf16 v[20:23], v[52:55], a[232:239], v60
    ds_read_b128 v[44:47], v61 offset:61440
    s_cbranch_vccnz cs_spin1
cs_go1:
    v_smfmac_f32_16x16x64_bf16 v[0:3], v[28:31], a[48:55], v60
    s_waitcnt lgkmcnt(4)
    s_barrier
    ds_read_b128 v[52:55], v63 offset:4096
    v_smfmac_f32_16x16x64_bf16 v[8:11], v[28:31], a[56:63], v60
    ds_read_b128 v[56:59], v71 offset:4096
    v_smfmac_f32_16x16x64_bf16 v[4:7], v[28:31], a[128:135], v60
    s_waitcnt lgkmcnt(2)
    v_smfmac_f32_16x16x64_bf16 v[4:7], v[48:51], v[32:39], v60
    buffer_load_dwordx4 v[32:35], v61, s[4:7], s23 offen offset:0 sc1
    v_smfmac_f32_16x16x64_bf16 v[12:15], v[48:51], v[40:47], v60
    ds_read_b128 v[48:51], v64 offset:4096
    v_smfmac_f32_16x16x64_bf16 v[12:15], v[28:31], a[136:143], v60
    ds_read_b128 v[24:27], v65 offset:8192
    s_and_b32 s41, s41, 65535
    s_add_u32 s41, s41, 68157440
    v_smfmac_f32_16x16x64_bf16 v[16:19], v[28:31], v[80:87], v60
    buffer_load_dwordx4 v[36:39], v61, s[4:7], s23 offen offset:1024 sc1
    v_smfmac_f32_16x16x64_bf16 v[20:23], v[28:31], v[88:95], v60
    s_add_u32 s17, s41, s31
    s_and_b32 s30, s28, 1
    s_waitcnt lgkmcnt(3)
    v_smfmac_f32_16x16x64_bf16 v[0:3], v[52:55], a[64:71], v60
    ds_read_b128 v[28:31], v78 offset:8704
    v_smfmac_f32_16x16x64_bf16 v[4:7], v[52:55], a[144:151], v60
    buffer_load_dwordx4 v[40:43], v61, s[4:7], s23 offen offset:2048 sc1
    v_smfmac_f32_16x16x64_bf16 v[8:11], v[52:55], a[72:79], v60
    v_smfmac_f32_16x16x64_bf16 v[12:15], v[52:55], a[152:159], v60
    v_smfmac_f32_16x16x64_bf16 v[16:19], v[52:55], v[96:103], v60
    buffer_load_dwordx4 v[44:47], v61, s[4:7], s23 offen offset:3072 sc1
    v_smfmac_f32_16x16x64_bf16 v[20:23], v[52:55], v[104:111], v60
    ds_read_b128 v[52:55], v62 offset:28672
    s_waitcnt lgkmcnt(3)
    v_smfmac_f32_16x16x64_bf16 v[0:3], v[48:51], a[80:87], v60
    v_smfmac_f32_16x16x64_bf16 v[4:7], v[48:51], a[160:167], v60
    v_smfmac_f32_16x16x64_bf16 v[8:11], v[48:51], a[88:95], v60
    v_smfmac_f32_16x16x64_bf16 v[12:15], v[48:51], a[168:175], v60
    v_smfmac_f32_16x16x64_bf16 v[16:19], v[48:51], v[112:119], v60
    buffer_load_dword v79, s[4:7], s24 offen sc1 lds
    v_smfmac_f32_16x16x64_bf16 v[20:23], v[48:51], v[120:127], v60
    ds_read_b128 v[48:51], v62 offset:24576
    v_smfmac_f32_16x16x64_bf16 v[0:3], v[56:59], a[96:103], v60
    s_cmp_ge_u32 s28, 62
    v_smfmac_f32_16x16x64_bf16 v[8:11], v[56:59], a[104:111], v60
    s_waitcnt lgkmcnt(3)
    v_smfmac_f32_16x16x64_bf16 v[0:3], v[24:27], a[112:119], v60
    v_smfmac_f32_16x16x64_bf16 v[8:11], v[24:27], a[120:127], v60
    v_smfmac_f32_16x16x64_bf16 v[4:7], v[56:59], a[176:183], v60
    s_waitcnt lgkmcnt(0)
    v_cvt_pk_bf16_f32 v0, v0, v1
    v_smfmac_f32_16x16x64_bf16 v[4:7], v[24:27], v[48:55], v60
    ds_read_b128 v[48:51], v62 offset:32768
    v_cvt_pk_bf16_f32 v8, v8, v9
    v_smfmac_f32_16x16x64_bf16 v[12:15], v[56:59], a[184:191], v60
    ds_read_b128 v[52:55], v62 offset:36864
    v_cvt_pk_bf16_f32 v9, v10, v11
    v_smfmac_f32_16x16x64_bf16 v[16:19], v[56:59], v[128:135], v60
    v_cvt_pk_bf16_f32 v1, v2, v3
    v_mfma_f32_16x16x16_bf16 v[8:11], v[8:9], v[28:29], 0
    v_cvt_pk_bf16_f32 v2, v4, v5
    v_cvt_pk_bf16_f32 v3, v6, v7
    v_smfmac_f32_16x16x64_bf16 v[20:23], v[56:59], v[136:143], v60
    s_mov_b64 exec, s[36:37]
    ds_read_b128 v[56:59], v69
    s_mov_b64 exec, -1
    v_mfma_f32_16x16x32_bf16 v[4:7], v[0:3], v[28:31], 0
    v_cvt_pk_bf16_f32 v2, v8, v9
    s_waitcnt lgkmcnt(1)
    v_smfmac_f32_16x16x64_bf16 v[12:15], v[24:27], v[48:55], v60
    ds_read_b128 v[48:51], v63 offset:0
    v_cvt_pk_bf16_f32 v3, v10, v11
    s_waitcnt vmcnt(3)
    v_cvt_pk_bf16_f32 v0, v4, v5
    v_cvt_pk_bf16_f32 v1, v6, v7
    s_nop 1
    v_mfma_f32_16x16x32_bf16 v[4:7], v[36:39], v[0:3], 0
    v_cvt_pk_bf16_f32 v12, v12, v13
    v_cvt_pk_bf16_f32 v13, v14, v15
    s_nop 1
    v_mfma_f32_16x16x16_bf16 v[12:15], v[12:13], v[30:31], 0
    ds_read_b128 v[52:55], v71 offset:0
    ds_read_b128 v[36:39], v63 offset:53248
    v_mfma_f32_16x16x32_bf16 v[28:31], v[32:35], v[0:3], 0
    s_waitcnt vmcnt(1)
    ds_read_b128 v[32:35], v63 offset:49152
    s_mov_b64 exec, s[34:35]
    s_nop 0
    v_cvt_pk_bf16_f32 v2, v12, v13
    v_cvt_pk_bf16_f32 v3, v14, v15
    s_mov_b64 exec, -1
    s_nop 0
    v_mfma_f32_16x16x32_bf16 v[8:11], v[0:3], v[0:3], 0
    v_mov_b32_dpp v28, v4 row_ror:8 row_mask:0xf bank_mask:0xc
    v_mov_b32_dpp v29, v5 row_ror:8 row_mask:0xf bank_mask:0xc
    v_mov_b32_dpp v30, v6 row_ror:8 row_mask:0xf bank_mask:0xc
    v_mov_b32_dpp v31, v7 row_ror:8 row_mask:0xf bank_mask:0xc
    v_smfmac_f32_16x16x64_bf16 v[16:19], v[24:27], v[144:151], v60
    ds_write_b128 v62, v[28:31] offset:53248
    v_mov_b32_dpp v8, v10 row_ror:8 row_mask:0xf bank_mask:0xc
    v_mov_b32_dpp v9, v11 row_ror:8 row_mask:0xf bank_mask:0xc
    v_smfmac_f32_16x16x64_bf16 v[20:23], v[24:27], v[152:159], v60
    ds_write_b64 v70, v[8:9]
    s_waitcnt lgkmcnt(5)
    v_smfmac_f32_16x16x64_bf16 v[16:19], v[48:51], a[208:215], v60
    s_mov_b64 exec, s[36:37]
    s_cbranch_execz cs_np3608
    buffer_store_dwordx4 v[56:59], v61, s[4:7], s65 offen sc1
cs_np3608:
    s_mov_b64 exec, -1
    v_smfmac_f32_16x16x64_bf16 v[20:23], v[48:51], a[216:223], v60
    s_cbranch_scc1 cs_last
cs_back:
    s_waitcnt lgkmcnt(0)
    s_barrier
    ds_read_b128 v[56:59], v78 offset:10752
    v_smfmac_f32_16x16x64_bf16 v[16:19], v[52:55], a[240:247], v60
    ds_read_b128 v[12:15], v78 offset:11264
    ds_read_b128 v[4:7], v63 offset:12288
    v_smfmac_f32_16x16x64_bf16 v[20:23], v[52:55], a[248:255], v60
    ds_read_b128 v[8:11], v64 offset:12288
    ds_read_b128 v[0:3], v71 offset:12288
    v_mov_b64 v[24:25], s[62:63]
    v_mov_b64 v[26:27], s[60:61]
    v_cvt_pk_bf16_f32 v16, v16, v17
    v_cvt_pk_bf16_f32 v17, v18, v19
    v_pk_mul_f32 v[28:29], v[28:29], s[44:45]
    v_pk_mul_f32 v[30:31], v[30:31], s[44:45]
    s_waitcnt lgkmcnt(3)
    v_pk_add_f32 v[56:57], v[56:57], v[58:59]
    v_pk_add_f32 v[12:13], v[12:13], v[14:15]
    v_pk_add_f32 v[56:57], v[56:57], v[12:13]
    v_pk_mul_f32 v[56:57], v[56:57], s[44:45]
    v_exp_f32 v58, v56
    v_exp_f32 v59, v57
    s_waitcnt lgkmcnt(1)
    v_pk_fma_f32 v[28:29], v[4:5], s[44:45], v[28:29]
    v_pk_fma_f32 v[30:31], v[6:7], s[44:45], v[30:31]
    v_cvt_pk_bf16_f32 v6, v58, v59
    v_pk_fma_f32 v[28:29], v[8:9], s[44:45], v[28:29]
    v_pk_fma_f32 v[30:31], v[10:11], s[44:45], v[30:31]
    s_waitcnt lgkmcnt(0)
    v_pk_fma_f32 v[28:29], v[0:1], s[44:45], v[28:29]
    v_mov_b32_dpp v7, v6 row_ror:8 row_mask:0xf bank_mask:0xf
    v_pk_fma_f32 v[30:31], v[2:3], s[44:45], v[30:31]
    v_exp_f32 v0, v28
    v_mfma_f32_16x16x16_bf16 v[12:15], v[16:17], v[6:7], 0
    ds_read_b128 v[48:51], v63 offset:57344
    v_exp_f32 v1, v29
    v_cvt_pk_bf16_f32 v18, v20, v21
    v_exp_f32 v2, v30
    v_cvt_pk_bf16_f32 v19, v22, v23
    v_cvt_pk_bf16_f32 v8, v0, v1
    v_exp_f32 v3, v31
    v_mfma_f32_16x16x16_bf16 v[20:23], v[18:19], v[6:7], 0
    ds_read_b128 v[52:55], v63 offset:61440
    v_cvt_pk_bf16_f32 v9, v2, v3
    v_mov_b32_dpp v10, v8 row_ror:8 row_mask:0xf bank_mask:0xf
    v_max3_f32 v4, |v28|, |v29|, |v30|
    v_mov_b32_dpp v11, v9 row_ror:8 row_mask:0xf bank_mask:0xf
    v_mfma_f32_16x16x32_bf16 v[0:3], v[24:27], v[6:9], 0
    v_max3_f32 v4, v4, |v31|, |v56|
    v_max_f32_e64 v4, v4, |v57|
    v_mfma_f32_16x16x32_bf16 v[12:15], v[40:43], v[8:11], v[12:15]
    v_cmp_nge_f32 vcc, s46, v4
    v_mfma_f32_16x16x32_bf16 v[20:23], v[44:47], v[8:11], v[20:23]
    v_add_f32_dpp v0, v0, v0 row_ror:8 row_mask:0xf bank_mask:0xf
    v_rcp_f32 v0, v0
    s_cbranch_vccnz cs_guard
cs_norm:
    v_mfma_f32_16x16x16_bf16 v[28:31], v[72:73], v[72:73], 0
    v_mul_f32 v12, v12, v0
    v_mul_f32 v13, v13, v0
    v_mul_f32 v14, v14, v0
    v_mul_f32 v15, v15, v0
    v_mul_f32_dpp v12, v20, v0 row_ror:8 row_mask:0xf bank_mask:0xc
    v_mul_f32_dpp v13, v21, v0 row_ror:8 row_mask:0xf bank_mask:0xc
    v_mul_f32_dpp v14, v22, v0 row_ror:8 row_mask:0xf bank_mask:0xc
    v_mul_f32_dpp v15, v23, v0 row_ror:8 row_mask:0xf bank_mask:0xc
    v_cvt_pk_bf16_f32 v12, v12, v13
    v_cvt_pk_bf16_f32 v13, v14, v15
    v_mfma_f32_16x16x16_bf16 v[8:11], v[72:73], v[72:73], 0
    ds_write_b64 v77, v[12:13]
    v_mfma_f32_16x16x16_bf16 v[4:7], v[72:73], v[72:73], 0
    ds_read_b128 v[0:3], v68
    v_mfma_f32_16x16x16_bf16 v[16:19], v[72:73], v[72:73], 0
    ds_read_b128 v[40:43], v63 offset:16384
    v_mfma_f32_16x16x16_bf16 v[20:23], v[72:73], v[72:73], 0
    ds_read_b128 v[44:47], v63 offset:20480
    s_waitcnt lgkmcnt(3)
    s_barrier
    ds_read_b128 v[24:27], v74
    ds_read_b128 v[12:15], v75
    ds_read_b128 v[56:59], v76
    s_waitcnt lgkmcnt(5)
    v_smfmac_f32_16x16x64_bf16 v[28:31], v[0:3], v[160:167], v60
    v_smfmac_f32_16x16x64_bf16 v[8:11], v[0:3], v[192:199], v60
    v_smfmac_f32_16x16x64_bf16 v[4:7], v[0:3], v[32:39], v60
    ds_read_b128 v[32:35], v63 offset:32768
    v_smfmac_f32_16x16x64_bf16 v[16:19], v[0:3], v[224:231], v60
    ds_read_b128 v[36:39], v63 offset:36864
    s_waitcnt lgkmcnt(3)
    v_smfmac_f32_16x16x64_bf16 v[28:31], v[24:27], v[168:175], v60
    v_smfmac_f32_16x16x64_bf16 v[4:7], v[12:15], v[48:55], v60
    ds_read_b128 v[48:51], v63 offset:24576
    v_smfmac_f32_16x16x64_bf16 v[28:31], v[12:15], v[176:183], v60
    ds_read_b128 v[52:55], v63 offset:28672
    s_waitcnt lgkmcnt(4)
    v_smfmac_f32_16x16x64_bf16 v[28:31], v[56:59], v[184:191], v60
    v_cvt_pk_bf16_f32 v4, v4, v5
    v_smfmac_f32_16x16x64_bf16 v[16:19], v[12:15], v[40:47], v60
    ds_read_b128 v[40:43], v63 offset:40960
    v_and_or_b32 v4, v4, -2, s30
    v_smfmac_f32_16x16x64_bf16 v[8:11], v[24:27], v[200:207], v60
    ds_read_b128 v[44:47], v63 offset:45056
    v_cvt_pk_bf16_f32 v5, v6, v7
    v_smfmac_f32_16x16x64_bf16 v[8:11], v[12:15], v[208:215], v60
    buffer_store_dwordx2 v[4:5], v67, s[4:7], s22 offen sc1
    v_cvt_pk_bf16_f32 v28, v28, v29
    v_smfmac_f32_16x16x64_bf16 v[8:11], v[56:59], v[216:223], v60
    v_and_or_b32 v28, v28, -2, s30
    v_smfmac_f32_16x16x64_bf16 v[16:19], v[24:27], v[232:239], v60
    v_cvt_pk_bf16_f32 v29, v30, v31
    s_waitcnt lgkmcnt(4)
    v_smfmac_f32_16x16x64_bf16 v[16:19], v[56:59], v[32:39], v60
    buffer_store_dwordx2 v[28:29], v66, s[4:7], s20 offen sc1
    v_cvt_pk_bf16_f32 v8, v8, v9
    s_waitcnt lgkmcnt(0)
    v_smfmac_f32_16x16x64_bf16 v[20:23], v[0:3], v[240:247], v60
    v_and_or_b32 v8, v8, -2, s30
    v_smfmac_f32_16x16x64_bf16 v[20:23], v[24:27], v[248:255], v60
    v_cvt_pk_bf16_f32 v9, v10, v11
    v_smfmac_f32_16x16x64_bf16 v[20:23], v[12:15], v[48:55], v60
    buffer_store_dwordx2 v[8:9], v66, s[4:7], s21 offen sc1
    v_cvt_pk_bf16_f32 v16, v16, v17
    v_smfmac_f32_16x16x64_bf16 v[20:23], v[56:59], v[40:47], v60
    v_and_or_b32 v16, v16, -2, s30
    v_cvt_pk_bf16_f32 v17, v18, v19
    buffer_store_dwordx2 v[16:17], v66, s[4:7], s38 offen sc1
    s_cmp_lg_u32 s13, 2
    s_nop 1
    v_cvt_pk_bf16_f32 v20, v20, v21
    v_and_or_b32 v20, v20, -2, s30
    v_cvt_pk_bf16_f32 v21, v22, v23
    buffer_store_dwordx2 v[20:21], v66, s[4:7], s39 offen sc1
    s_cbranch_scc1 cs_w013
    s_nop 15
    s_nop 15
    s_nop 15
    s_nop 15
    s_nop 15
    s_nop 15
    s_nop 15
    s_nop 15
    s_nop 15
    s_nop 15
    s_nop 15
    s_nop 15
    s_nop 7
    buffer_load_dwordx4 v[40:43], v65, s[4:7], s19 offen offset:0 sc1
    buffer_load_dwordx4 v[44:47], v65, s[4:7], s19 offen offset:1024 sc1
    buffer_load_dwordx4 v[48:51], v65, s[4:7], s19 offen offset:2048 sc1
    buffer_load_dwordx4 v[52:55], v65, s[4:7], s19 offen offset:3072 sc1
    ds_read_b128 v[56:59], v65 offset:10240
    s_add_u32 s28, s28, 1
    s_mov_b32 s14, s41
    s_add_u32 s23, s23, 524288
    s_add_u32 s24, s24, 524288
    s_min_u32 s24, s24, s47
    s_add_u32 s15, s14, 4096
    s_add_u32 s16, s14, 8192
    v_mov_b32 v21, -1
    s_add_u32 s65, s65, 12288
    s_mov_b32 s40, 1
    v_mov_b64 v[0:1], 0
    v_mov_b64 v[2:3], 0
    v_mov_b64 v[4:5], 0
    v_mov_b64 v[6:7], 0
    v_mov_b64 v[8:9], 0
    v_mov_b64 v[10:11], 0
    v_mov_b64 v[12:13], 0
    v_mov_b64 v[14:15], 0
cs_chkF:
    v_mov_b32 v20, 0
    s_waitcnt vmcnt(3)
    s_waitcnt lgkmcnt(0)
    v_mfma_f32_16x16x32_bf16 v[28:31], v[40:43], v[56:59], 0
    v_bitop3_b32 v20, v20, v40, s30 bitop3:0xf6
    v_bitop3_b32 v20, v20, v42, s30 bitop3:0xf6
    s_waitcnt vmcnt(2)
    v_mfma_f32_16x16x32_bf16 v[28:31], v[44:47], v[56:59], v[28:31]
    v_bitop3_b32 v20, v20, v44, s30 bitop3:0xf6
    v_bitop3_b32 v20, v20, v46, s30 bitop3:0xf6
    s_waitcnt vmcnt(1)
    v_mfma_f32_16x16x32_bf16 v[28:31], v[48:51], v[56:59], v[28:31]
    v_bitop3_b32 v20, v20, v48, s30 bitop3:0xf6
    v_bitop3_b32 v20, v20, v50, s30 bitop3:0xf6
    s_waitcnt vmcnt(0)
    v_mfma_f32_16x16x32_bf16 v[28:31], v[52:55], v[56:59], v[28:31]
    v_bitop3_b32 v20, v20, v52, s30 bitop3:0xf6
    v_bitop3_b32 v20, v20, v54, s30 bitop3:0xf6
    v_and_b32 v20, s40, v20
    v_cmp_ne_u32 vcc, 0, v20
    s_cbranch_vccnz cs_spinF
    v_permlane32_swap_b32 v28, v30
    v_permlane32_swap_b32 v29, v31
    v_add_f32 v28, v28, v30
    v_add_f32 v30, v29, v31
    v_cvt_pk_bf16_f32 v28, v28, v30
    s_mov_b64 exec, s[32:33]
    buffer_store_dword v28, v69, s[4:7], s17 offen sc1
    buffer_store_dword v21, v69, s[4:7], s18 offen sc1
    s_mov_b64 exec, -1
    ds_read_b128 v[32:35], v62 offset:16384
    ds_read_b128 v[36:39], v62 offset:20480
    ds_read_b128 v[40:43], v61 offset:0
    ds_read_b128 v[44:47], v61 offset:4096
    ds_read_b128 v[48:51], v61 offset:8192
    ds_read_b128 v[52:55], v61 offset:12288
    s_nop 15
    s_nop 15
    s_nop 15
    s_nop 15
    s_nop 15
    s_nop 15
    s_nop 3
    buffer_load_dwordx4 v[24:27], v61, s[4:7], s14 offen sc1
    s_branch cs_loop2
cs_w013:
    ds_read_b128 v[56:59], v65 offset:10240
    ds_read_b128 v[32:35], v62 offset:16384
    ds_read_b128 v[36:39], v62 offset:20480
    ds_read_b128 v[40:43], v61 offset:0
    ds_read_b128 v[44:47], v61 offset:4096
    ds_read_b128 v[48:51], v61 offset:8192
    ds_read_b128 v[52:55], v61 offset:12288
    s_add_u32 s28, s28, 1
    s_mov_b32 s14, s41
    s_add_u32 s23, s23, 524288
    s_add_u32 s24, s24, 524288
    s_min_u32 s24, s24, s47
    s_add_u32 s15, s14, 4096
    s_add_u32 s16, s14, 8192
    v_mov_b32 v21, -1
    s_add_u32 s65, s65, 12288
    s_mov_b32 s40, 1
    s_cmp_eq_u32 s64, 0
    s_cbranch_scc1 cs_w0
    s_cmp_eq_u32 s13, 1
    s_cbranch_scc1 cs_sx
    s_nop 15
    s_nop 15
    s_nop 15
    s_nop 15
    s_nop 15
    s_nop 15
    s_nop 15
    s_nop 15
    s_nop 15
    s_nop 15
    s_nop 15
    s_nop 15
    s_nop 7
cs_sx:
    buffer_load_dwordx4 v[0:3], v65, s[4:7], s19 offen offset:0 sc1
    buffer_load_dwordx4 v[4:7], v65, s[4:7], s19 offen offset:1024 sc1
    buffer_load_dwordx4 v[8:11], v65, s[4:7], s19 offen offset:2048 sc1
    buffer_load_dwordx4 v[12:15], v65, s[4:7], s19 offen offset:3072 sc1
cs_chkG:
    v_mov_b32 v20, 0
    s_waitcnt vmcnt(3)
    s_waitcnt lgkmcnt(6)
    v_mfma_f32_16x16x32_bf16 v[28:31], v[0:3], v[56:59], 0
    v_bitop3_b32 v20, v20, v0, s30 bitop3:0xf6
    v_bitop3_b32 v20, v20, v2, s30 bitop3:0xf6
    s_waitcnt vmcnt(2)
    v_mfma_f32_16x16x32_bf16 v[28:31], v[4:7], v[56:59], v[28:31]
    v_bitop3_b32 v20, v20, v4, s30 bitop3:0xf6
    v_bitop3_b32 v20, v20, v6, s30 bitop3:0xf6
    s_waitcnt vmcnt(1)
    v_mfma_f32_16x16x32_bf16 v[28:31], v[8:11], v[56:59], v[28:31]
    v_bitop3_b32 v20, v20, v8, s30 bitop3:0xf6
    v_bitop3_b32 v20, v20, v10, s30 bitop3:0xf6
    s_waitcnt vmcnt(0)
    v_mfma_f32_16x16x32_bf16 v[28:31], v[12:15], v[56:59], v[28:31]
    v_bitop3_b32 v20, v20, v12, s30 bitop3:0xf6
    v_bitop3_b32 v20, v20, v14, s30 bitop3:0xf6
    v_and_b32 v20, s40, v20
    v_cmp_ne_u32 vcc, 0, v20
    s_cbranch_vccnz cs_spinG
    v_permlane32_swap_b32 v28, v30
    v_permlane32_swap_b32 v29, v31
    v_add_f32 v28, v28, v30
    v_add_f32 v30, v29, v31
    s_cmp_eq_u32 s13, 3
    s_cbranch_scc1 cs_w3
    v_mov_b32 v29, v28
    v_mov_b32 v31, v30
    s_nop 0
    v_permlane16_swap_b32 v28, v29
    v_permlane16_swap_b32 v30, v31
    v_add_f32 v28, v28, v29
    v_add_f32 v30, v30, v31
cs_w3:
    v_cvt_pk_bf16_f32 v28, v28, v30
    s_mov_b64 exec, s[32:33]
    buffer_store_dword v28, v69, s[4:7], s17 offen sc1
    buffer_store_dword v21, v69, s[4:7], s18 offen sc1
    s_mov_b64 exec, -1
    buffer_load_dwordx4 v[24:27], v61, s[4:7], s14 offen sc1
    s_branch cs_loop
cs_w0:
    v_mov_b64 v[0:1], 0
    v_mov_b64 v[2:3], 0
    v_mov_b64 v[4:5], 0
    v_mov_b64 v[6:7], 0
    v_mov_b64 v[8:9], 0
    v_mov_b64 v[10:11], 0
    v_mov_b64 v[12:13], 0
    v_mov_b64 v[14:15], 0
    s_cmp_lg_u32 s28, 10
    s_cbranch_scc1 cs_nokv
    s_lshr_b32 s92, s12, 1
    s_lshl_b32 s92, s92, 8
    s_add_u32 s92, s92, 125833216
    v_bfe_u32 v28, v61, 4, 6
    v_min_u32 v28, 11, v28
    v_lshlrev_b32 v28, 2, v28
    s_add_u32 s93, s95, 63
    s_mov_b32 s94, 4194304
cs_kv1:
    buffer_load_dword v29, v28, s[4:7], s92 offen sc1
    s_sub_u32 s94, s94, 1
    s_cbranch_scc1 cs_kv1_go
    s_waitcnt vmcnt(0)
    v_subrev_u32 v29, s93, v29
    v_cmp_lt_u32 vcc, 64, v29
    s_cbranch_vccz cs_kv1_go
    s_sleep 2
    s_branch cs_kv1
cs_kv1_go:
cs_nokv:
    s_nop 15
    s_nop 15
    s_nop 15
    s_nop 15
    s_nop 15
    s_nop 15
    s_nop 15
    s_nop 15
    s_nop 15
    s_nop 15
    s_nop 15
    s_nop 15
    s_nop 15
    s_nop 15
    s_nop 15
    s_nop 15
    s_nop 15
    s_nop 15
    s_nop 15
    s_nop 15
    s_nop 15
    s_nop 15
    s_nop 15
    s_nop 15
    s_nop 15
    buffer_load_dwordx4 v[24:27], v61, s[4:7], s14 offen sc1
    s_branch cs_loop2
cs_spinF:
    buffer_load_dwordx4 v[40:43], v65, s[4:7], s19 offen offset:0 sc1
    buffer_load_dwordx4 v[44:47], v65, s[4:7], s19 offen offset:1024 sc1
    buffer_load_dwordx4 v[48:51], v65, s[4:7], s19 offen offset:2048 sc1
    buffer_load_dwordx4 v[52:55], v65, s[4:7], s19 offen offset:3072 sc1
    s_sub_u32 s29, s29, 1
    s_cmp_lt_i32 s29, 0
    s_cselect_b32 s40, 0, 1
    s_branch cs_chkF
cs_spinG:
    buffer_load_dwordx4 v[0:3], v65, s[4:7], s19 offen offset:0 sc1
    buffer_load_dwordx4 v[4:7], v65, s[4:7], s19 offen offset:1024 sc1
    buffer_load_dwordx4 v[8:11], v65, s[4:7], s19 offen offset:2048 sc1
    buffer_load_dwordx4 v[12:15], v65, s[4:7], s19 offen offset:3072 sc1
    s_sub_u32 s29, s29, 1
    s_cmp_lt_i32 s29, 0
    s_cselect_b32 s40, 0, 1
    s_branch cs_chkG
cs_guard:
    s_cbranch_scc0 cs_guard2
    buffer_store_dwordx4 v[16:19], v61, s[4:7], s26 offen sc1
    s_add_u32 s26, s26, 131072
    s_add_u32 s40, s95, 63
    v_mov_b32 v5, s40
    s_mov_b64 exec, 1
    buffer_store_dword v5, off, s[4:7], s27 sc1
    s_mov_b64 exec, -1
cs_guard2:
    s_nop 7
    v_max3_f32 v6, v28, v29, v30
    v_max3_f32 v7, v31, v56, v57
    v_max_f32 v6, v6, v7
    s_nop 1
    v_max_f32_dpp v6, v6, v6 row_ror:8 row_mask:0xf bank_mask:0xf
    v_mov_b32 v7, v6
    s_nop 1
    v_permlane32_swap_b32 v6, v7
    v_max_f32 v6, v6, v7
    v_mov_b32 v7, v6
    s_nop 1
    v_permlane16_swap_b32 v6, v7
    v_max_f32 v6, v6, v7
    v_sub_f32 v28, v28, v6
    v_sub_f32 v29, v29, v6
    v_sub_f32 v30, v30, v6
    v_sub_f32 v31, v31, v6
    v_sub_f32 v56, v56, v6
    v_sub_f32 v57, v57, v6
    v_exp_f32 v58, v56
    v_exp_f32 v59, v57
    s_nop 0
    v_cvt_pk_bf16_f32 v6, v58, v59
    s_nop 1
    v_mov_b32_dpp v7, v6 row_ror:8 row_mask:0xf bank_mask:0xf
    v_exp_f32 v0, v28
    s_nop 0
    v_mfma_f32_16x16x16_bf16 v[12:15], v[16:17], v[6:7], 0
    v_exp_f32 v1, v29
    v_exp_f32 v2, v30
    v_cvt_pk_bf16_f32 v8, v0, v1
    v_exp_f32 v3, v31
    v_mfma_f32_16x16x16_bf16 v[20:23], v[18:19], v[6:7], 0
    v_cvt_pk_bf16_f32 v9, v2, v3
    v_mov_b32_dpp v10, v8 row_ror:8 row_mask:0xf bank_mask:0xf
    v_max3_f32 v4, |v28|, |v29|, |v30|
    v_mov_b32_dpp v11, v9 row_ror:8 row_mask:0xf bank_mask:0xf
    v_mfma_f32_16x16x32_bf16 v[0:3], v[24:27], v[6:9], 0
    v_max3_f32 v4, v4, |v31|, |v56|
    v_max_f32_e64 v4, v4, |v57|
    v_mfma_f32_16x16x32_bf16 v[12:15], v[40:43], v[8:11], v[12:15]
    v_cmp_nge_f32 vcc, s46, v4
    v_mfma_f32_16x16x32_bf16 v[20:23], v[44:47], v[8:11], v[20:23]
    v_add_f32_dpp v0, v0, v0 row_ror:8 row_mask:0xf bank_mask:0xf
    v_rcp_f32 v0, v0
    s_nop 4
    s_branch cs_norm
cs_spin0:
    buffer_load_dwordx4 v[24:27], v61, s[4:7], s14 offen sc1
    s_sub_u32 s29, s29, 1
    s_cmp_lt_i32 s29, 0
    s_cbranch_scc0 cs_chk0
    s_waitcnt vmcnt(0)
    v_min_u32 v24, -2, v24
    v_min_u32 v25, -2, v25
    v_min_u32 v26, -2, v26
    v_min_u32 v27, -2, v27
    s_branch cs_chk0
cs_spin1:
    buffer_load_dwordx4 v[28:31], v61, s[4:7], s15 offen sc1
    buffer_load_dword v59, v56, s[4:7], s16 offen sc1
    s_sub_u32 s29, s29, 1
    s_cmp_lt_i32 s29, 0
    s_waitcnt vmcnt(0)
    v_max3_u32 v57, v28, v29, v30
    v_max3_u32 v57, v57, v31, v59
    v_cmp_eq_u32 vcc, -1, v57
    ds_write_b128 v62, v[28:31] offset:45056
    ds_write_b32 v58, v59
    s_waitcnt lgkmcnt(0)
    s_cbranch_scc1 cs_go1
    s_cbranch_vccnz cs_spin1
    s_branch cs_go1
cs_last:
    s_nop 1
    s_cmp_eq_u32 s28, 63
    s_cbranch_scc1 cs_last2
    s_mov_b64 exec, s[34:35]
    buffer_store_dwordx4 v[0:3], v61, s[4:7], s25 offen sc1
    s_mov_b64 exec, -1
    s_add_u32 s25, s25, 131072
    s_mov_b32 s46, 0xbf800000
    s_cmp_eq_u32 0, 0
    s_branch cs_back
cs_last2:
    s_waitcnt lgkmcnt(0)
    s_mov_b64 exec, s[34:35]
    buffer_store_dwordx4 v[0:3], v61, s[4:7], s25 offen sc1
    s_mov_b64 exec, -1
    s_add_u32 s40, s95, 64
    v_mov_b32 v40, s40
    v_smfmac_f32_16x16x64_bf16 v[16:19], v[52:55], a[240:247], v60
    v_smfmac_f32_16x16x64_bf16 v[20:23], v[52:55], a[248:255], v60
    s_nop 3
    v_cvt_pk_bf16_f32 v16, v16, v17
    v_cvt_pk_bf16_f32 v17, v18, v19
    s_nop 1
    v_cvt_pk_bf16_f32 v18, v20, v21
    v_cvt_pk_bf16_f32 v19, v22, v23
    buffer_store_dwordx4 v[16:19], v61, s[4:7], s26 offen sc1
    s_mov_b64 exec, 1
    buffer_store_dword v40, off, s[4:7], s27 sc1
    s_mov_b64 exec, -1
    s_endpgm
cs_dma:
    s_xor_b32 s74, s76, s81
    s_add_u32 m0, s74, s80
    s_add_u32 s76, s76, 4096
    buffer_load_dwordx4 v58, s[8:11], s78 offen lds
    s_add_u32 s78, s78, s79
    s_cmp_lt_u32 s76, s77
    s_cbranch_scc1 cs_dma
    s_setpc_b64 s[82:83]
L_helper:
    s_load_dwordx16 s[64:79], s[0:1], 64
    s_sub_u32 s33, s3, 1
    s_and_b32 s33, s33, 7
L_pool:
    s_lshl_b32 s35, s33, 2
    s_add_u32 s35, s35, 32
    s_mov_b32 s37, s35
    v_mov_b32 v250, 1
    v_mov_b32 v251, 163832
    v_cmp_eq_u32 vcc, 0, v0
    s_nop 0
    s_and_saveexec_b64 s[38:39], vcc
    s_cbranch_execz tk4
    buffer_atomic_add v250, off, s[96:99], s37 sc0
    s_waitcnt vmcnt(0)
    ds_write_b32 v251, v250
    s_waitcnt lgkmcnt(0)
tk4:
    s_mov_b64 exec, -1
    s_barrier
    ds_read_b32 v252, v251
    s_waitcnt lgkmcnt(0)
    v_readfirstlane_b32 s34, v252
    s_barrier
    s_nop 3
    s_mov_b32 s36, s33
    s_or_b32 s33, s34, s32
    s_cmp_lg_u32 s33, 0
    s_cbranch_scc1 L_helper1
    s_memrealtime s[90:91]
    s_waitcnt lgkmcnt(0)
    s_lshl_b32 s90, s90, 8
    s_or_b32 s90, s90, 1
    v_mov_b32 v250, s90
    v_mov_b32 v251, 0
    s_mov_b64 exec, 1
    buffer_atomic_cmpswap v[250:251], off, s[96:99], 0 offset:64
    s_mov_b64 exec, -1
L_helper1:
    s_cmp_ge_u32 s34, 32
    s_cbranch_scc1 L_qkv_next
    s_cmp_ge_u32 s36, 7
    s_cbranch_scc1 L_qkv_next
    s_max_u32 s37, s36, 4
    s_sub_u32 s37, s37, 4
    s_mul_i32 s37, s37, 6
    s_lshl_b32 s38, s36, 1
    s_add_u32 s38, s38, s37
    s_cmp_lt_u32 s36, 4
    s_cselect_b32 s39, 2, 8
    s_mul_i32 s36, s36, 30
    s_sub_u32 s36, s36, s37
    s_cmp_lt_u32 s34, s39
    s_cbranch_scc1 L_copy
    s_add_u32 s36, s36, s34
    s_sub_u32 s36, s36, s39
    s_mul_i32 s37, s36, 171
    s_lshr_b32 s37, s37, 10
    s_mul_i32 s38, s37, 6
    s_sub_u32 s36, s36, s38
    s_lshl_b32 s36, s36, 5
    s_add_u32 s36, s36, s37
    s_branch L_job
L_copy:
    s_add_u32 s36, s38, s34
    s_mul_i32 s36, s36, 11
    s_and_b32 s36, s36, 31
    s_cmp_ge_u32 s36, 27
    s_cbranch_scc1 L_qkv_next
    s_mul_i32 s33, s36, 57
    s_lshr_b32 s33, s33, 9
    s_mul_i32 s37, s33, 9
    s_sub_u32 s37, s36, s37
    s_lshl_b32 s36, s37, 2
    s_add_u32 s36, s36, 1
    s_min_u32 s36, s36, 31
    s_lshr_b32 s39, s52, 8
    s_sub_u32 s36, s36, s39
    s_and_b32 s36, s36, 31
    s_lshl_b32 s36, s36, 8
    s_mov_b32 s14, 4718592
    s_mov_b32 s15, 0x20000
    v_lshrrev_b32 v1, 4, v0
    v_lshlrev_b32 v1, 13, v1
    v_and_b32 v2, 15, v0
    v_lshl_add_u32 v1, v2, 4, v1
    v_lshlrev_b32 v2, 4, v0
    s_mul_i32 s40, s33, 2
    s_mul_i32 s39, s40, 49152
    s_lshl_b32 s41, s37, 19
    s_add_u32 s39, s39, s41
    s_add_u32 s39, s39, 96468992
    s_add_u32 s41, s40, 0
    s_cmp_lt_u32 s41, 3
    s_cselect_b64 s[12:13], s[52:53], s[54:55]
    s_cselect_b32 s42, 0, 3
    s_cmp_ge_u32 s41, 6
    s_cselect_b64 s[12:13], s[56:57], s[12:13]
    s_cselect_b32 s42, 6, s42
    s_sub_u32 s41, s41, s42
    s_mul_i32 s38, s41, 1572864
    s_add_u32 s38, s38, s36
    buffer_load_dwordx4 v[8:11], v1, s[12:15], s38 offen
    s_add_u32 s38, s38, 131072
    buffer_load_dwordx4 v[12:15], v1, s[12:15], s38 offen
    s_add_u32 s38, s38, 131072
    buffer_load_dwordx4 v[16:19], v1, s[12:15], s38 offen
    s_add_u32 s38, s38, 131072
    buffer_load_dwordx4 v[20:23], v1, s[12:15], s38 offen
    s_add_u32 s38, s38, 131072
    buffer_load_dwordx4 v[24:27], v1, s[12:15], s38 offen
    s_add_u32 s38, s38, 131072
    buffer_load_dwordx4 v[28:31], v1, s[12:15], s38 offen
    s_add_u32 s38, s38, 131072
    buffer_load_dwordx4 v[32:35], v1, s[12:15], s38 offen
    s_add_u32 s38, s38, 131072
    buffer_load_dwordx4 v[36:39], v1, s[12:15], s38 offen
    s_add_u32 s38, s38, 131072
    buffer_load_dwordx4 v[40:43], v1, s[12:15], s38 offen
    s_add_u32 s38, s38, 131072
    buffer_load_dwordx4 v[44:47], v1, s[12:15], s38 offen
    s_add_u32 s38, s38, 131072
    buffer_load_dwordx4 v[48:51], v1, s[12:15], s38 offen
    s_add_u32 s38, s38, 131072
    buffer_load_dwordx4 v[52:55], v1, s[12:15], s38 offen
    s_add_u32 s38, s38, 131072
    s_add_u32 s41, s40, 1
    s_cmp_lt_u32 s41, 3
    s_cselect_b64 s[12:13], s[52:53], s[54:55]
    s_cselect_b32 s42, 0, 3
    s_cmp_ge_u32 s41, 6
    s_cselect_b64 s[12:13], s[56:57], s[12:13]
    s_cselect_b32 s42, 6, s42
    s_sub_u32 s41, s41, s42
    s_mul_i32 s38, s41, 1572864
    s_add_u32 s38, s38, s36
    buffer_load_dwordx4 v[56:59], v1, s[12:15], s38 offen
    s_add_u32 s38, s38, 131072
    buffer_load_dwordx4 v[60:63], v1, s[12:15], s38 offen
    s_add_u32 s38, s38, 131072
    buffer_load_dwordx4 v[64:67], v1, s[12:15], s38 offen
    s_add_u32 s38, s38, 131072
    buffer_load_dwordx4 v[68:71], v1, s[12:15], s38 offen
    s_add_u32 s38, s38, 131072
    buffer_load_dwordx4 v[72:75], v1, s[12:15], s38 offen
    s_add_u32 s38, s38, 131072
    buffer_load_dwordx4 v[76:79], v1, s[12:15], s38 offen
    s_add_u32 s38, s38, 131072
    buffer_load_dwordx4 v[80:83], v1, s[12:15], s38 offen
    s_add_u32 s38, s38, 131072
    buffer_load_dwordx4 v[84:87], v1, s[12:15], s38 offen
    s_add_u32 s38, s38, 131072
    buffer_load_dwordx4 v[88:91], v1, s[12:15], s38 offen
    s_add_u32 s38, s38, 131072
    buffer_load_dwordx4 v[92:95], v1, s[12:15], s38 offen
    s_add_u32 s38, s38, 131072
    buffer_load_dwordx4 v[96:99], v1, s[12:15], s38 offen
    s_add_u32 s38, s38, 131072
    buffer_load_dwordx4 v[100:103], v1, s[12:15], s38 offen
    s_add_u32 s38, s38, 131072
    buffer_load_dword v3, off, s[96:99], 0 offset:64 sc1
    s_waitcnt vmcnt(0)
    buffer_store_dwordx4 v[8:11], v2, s[4:7], s39 offen sc1
    s_add_u32 s39, s39, 4096
    buffer_store_dwordx4 v[12:15], v2, s[4:7], s39 offen sc1
    s_add_u32 s39, s39, 4096
    buffer_store_dwordx4 v[16:19], v2, s[4:7], s39 offen sc1
    s_add_u32 s39, s39, 4096
    buffer_store_dwordx4 v[20:23], v2, s[4:7], s39 offen sc1
    s_add_u32 s39, s39, 4096
    buffer_store_dwordx4 v[24:27], v2, s[4:7], s39 offen sc1
    s_add_u32 s39, s39, 4096
    buffer_store_dwordx4 v[28:31], v2, s[4:7], s39 offen sc1
    s_add_u32 s39, s39, 4096
    buffer_store_dwordx4 v[32:35], v2, s[4:7], s39 offen sc1
    s_add_u32 s39, s39, 4096
    buffer_store_dwordx4 v[36:39], v2, s[4:7], s39 offen sc1
    s_add_u32 s39, s39, 4096
    buffer_store_dwordx4 v[40:43], v2, s[4:7], s39 offen sc1
    s_add_u32 s39, s39, 4096
    buffer_store_dwordx4 v[44:47], v2, s[4:7], s39 offen sc1
    s_add_u32 s39, s39, 4096
    buffer_store_dwordx4 v[48:51], v2, s[4:7], s39 offen sc1
    s_add_u32 s39, s39, 4096
    buffer_store_dwordx4 v[52:55], v2, s[4:7], s39 offen sc1
    s_add_u32 s39, s39, 4096
    buffer_store_dwordx4 v[56:59], v2, s[4:7], s39 offen sc1
    s_add_u32 s39, s39, 4096
    buffer_store_dwordx4 v[60:63], v2, s[4:7], s39 offen sc1
    s_add_u32 s39, s39, 4096
    buffer_store_dwordx4 v[64:67], v2, s[4:7], s39 offen sc1
    s_add_u32 s39, s39, 4096
    buffer_store_dwordx4 v[68:71], v2, s[4:7], s39 offen sc1
    s_add_u32 s39, s39, 4096
    buffer_store_dwordx4 v[72:75], v2, s[4:7], s39 offen sc1
    s_add_u32 s39, s39, 4096
    buffer_store_dwordx4 v[76:79], v2, s[4:7], s39 offen sc1
    s_add_u32 s39, s39, 4096
    buffer_store_dwordx4 v[80:83], v2, s[4:7], s39 offen sc1
    s_add_u32 s39, s39, 4096
    buffer_store_dwordx4 v[84:87], v2, s[4:7], s39 offen sc1
    s_add_u32 s39, s39, 4096
    buffer_store_dwordx4 v[88:91], v2, s[4:7], s39 offen sc1
    s_add_u32 s39, s39, 4096
    buffer_store_dwordx4 v[92:95], v2, s[4:7], s39 offen sc1
    s_add_u32 s39, s39, 4096
    buffer_store_dwordx4 v[96:99], v2, s[4:7], s39 offen sc1
    s_add_u32 s39, s39, 4096
    buffer_store_dwordx4 v[100:103], v2, s[4:7], s39 offen sc1
    s_add_u32 s39, s39, 4096
    v_readfirstlane_b32 s95, v3
    s_nop 4
    s_mov_b32 s88, 4194304
gn5:
    s_cmp_lg_u32 s95, 0
    s_cbranch_scc1 gn5x
    buffer_load_dword v3, off, s[96:99], 0 offset:64 sc1
    s_sub_u32 s88, s88, 1
    s_cbranch_scc1 gn5x
    s_waitcnt vmcnt(0)
    v_readfirstlane_b32 s95, v3
    s_nop 1
    s_branch gn5
gn5x:
    s_lshl_b32 s37, s37, 7
    s_lshl_b32 s36, s33, 2
    s_add_u32 s36, s36, s32
    s_lshl_b32 s36, s36, 2
    s_add_u32 s37, s37, s36
    s_add_u32 s37, s37, 125853696
    v_mov_b32 v3, s95
    s_waitcnt vmcnt(0)
    s_mov_b64 exec, 1
    buffer_store_dword v3, off, s[4:7], s37 sc1
    s_mov_b64 exec, -1
L_qkv_next:
    s_mov_b32 s37, 4
    v_mov_b32 v250, 1
    v_mov_b32 v251, 163832
    v_cmp_eq_u32 vcc, 0, v0
    s_nop 0
    s_and_saveexec_b64 s[38:39], vcc
    s_cbranch_execz tk6
    buffer_atomic_add v250, off, s[96:99], s37 sc0
    s_waitcnt vmcnt(0)
    ds_write_b32 v251, v250
    s_waitcnt lgkmcnt(0)
tk6:
    s_mov_b64 exec, -1
    s_barrier
    ds_read_b32 v252, v251
    s_waitcnt lgkmcnt(0)
    v_readfirstlane_b32 s36, v252
    s_barrier
    s_nop 3
    s_add_u32 s36, s36, 192
    s_cmp_ge_u32 s36, 320
    s_cbranch_scc1 L_ssm_next
L_job:
    s_and_b32 s17, s36, 15
    s_lshl_b32 s17, s17, 1
    s_bfe_u32 s16, s36, 0x10004
    s_lshr_b32 s19, s36, 5
    s_mul_i32 s33, s16, 6
    s_add_u32 s33, s33, s19
    s_add_u32 s16, s16, 1
    s_lshr_b32 s37, s36, 4
    s_sub_u32 s38, s37, 12
    s_cmp_ge_u32 s36, 192
    s_cselect_b32 s16, 0, s16
    s_cselect_b32 s19, s38, s19
    s_cselect_b32 s33, s37, s33
    s_cselect_b32 s20, 8, 6
    v_lshrrev_b32 v4, 6, v0
    s_nop 0
    v_readfirstlane_b32 s18, v4
    v_lshlrev_b32 v7, 4, v0
    v_and_b32 v4, 63, v0
    v_lshrrev_b32 v6, 2, v4
    v_lshlrev_b32 v6, 13, v6
    v_lshrrev_b32 v5, 4, v4
    v_and_b32 v5, 2, v5
    v_xor_b32 v5, v5, v4
    v_and_b32 v5, 3, v5
    v_lshl_add_u32 v6, v5, 4, v6
    v_lshrrev_b32 v24, 4, v4
    v_lshlrev_b32 v24, 9, v24
    v_bfe_u32 v5, v4, 2, 2
    v_lshl_add_u32 v24, v5, 6, v24
    v_bfe_u32 v5, v4, 4, 1
    v_lshl_add_u32 v24, v5, 5, v24
    v_and_b32 v5, 3, v4
    v_lshl_add_u32 v24, v5, 3, v24
    s_lshl_b32 s31, s18, 12
    v_add_u32 v24, s31, v24
    s_cmp_eq_u32 s16, 1
    s_cselect_b64 s[12:13], s[54:55], s[52:53]
    s_cmp_eq_u32 s16, 2
    s_cselect_b64 s[12:13], s[56:57], s[12:13]
    s_mov_b32 s14, 4718592
    s_mov_b32 s15, 0x20000
    s_lshl_b32 s28, s17, 8
    s_lshl_b32 s21, s18, 6
    s_add_u32 s28, s28, s21
    s_add_u32 s21, s28, 0
    s_add_u32 m0, s31, 40960
    s_nop 0
    buffer_load_dwordx4 v6, s[12:15], s21 offen lds
    s_add_u32 m0, s31, 41984
    s_add_u32 s21, s21, 131072
    buffer_load_dwordx4 v6, s[12:15], s21 offen lds
    s_add_u32 m0, s31, 43008
    s_add_u32 s21, s21, 131072
    buffer_load_dwordx4 v6, s[12:15], s21 offen lds
    s_add_u32 m0, s31, 44032
    s_add_u32 s21, s21, 131072
    buffer_load_dwordx4 v6, s[12:15], s21 offen lds
    s_add_u32 s21, s28, 256
    s_add_u32 m0, s31, 57344
    s_nop 0
    buffer_load_dwordx4 v6, s[12:15], s21 offen lds
    s_add_u32 m0, s31, 58368
    s_add_u32 s21, s21, 131072
    buffer_load_dwordx4 v6, s[12:15], s21 offen lds
    s_add_u32 m0, s31, 59392
    s_add_u32 s21, s21, 131072
    buffer_load_dwordx4 v6, s[12:15], s21 offen lds
    s_add_u32 m0, s31, 60416
    s_add_u32 s21, s21, 131072
    buffer_load_dwordx4 v6, s[12:15], s21 offen lds
    s_add_u32 s21, s28, 524288
    s_add_u32 m0, s31, 73728
    s_nop 0
    buffer_load_dwordx4 v6, s[12:15], s21 offen lds
    s_add_u32 m0, s31, 74752
    s_add_u32 s21, s21, 131072
    buffer_load_dwordx4 v6, s[12:15], s21 offen lds
    s_add_u32 m0, s31, 75776
    s_add_u32 s21, s21, 131072
    buffer_load_dwordx4 v6, s[12:15], s21 offen lds
    s_add_u32 m0, s31, 76800
    s_add_u32 s21, s21, 131072
    buffer_load_dwordx4 v6, s[12:15], s21 offen lds
    s_add_u32 s21, s28, 524544
    s_add_u32 m0, s31, 90112
    s_nop 0
    buffer_load_dwordx4 v6, s[12:15], s21 offen lds
    s_add_u32 m0, s31, 91136
    s_add_u32 s21, s21, 131072
    buffer_load_dwordx4 v6, s[12:15], s21 offen lds
    s_add_u32 m0, s31, 92160
    s_add_u32 s21, s21, 131072
    buffer_load_dwordx4 v6, s[12:15], s21 offen lds
    s_add_u32 m0, s31, 93184
    s_add_u32 s21, s21, 131072
    buffer_load_dwordx4 v6, s[12:15], s21 offen lds
    s_add_u32 s21, s28, 1048576
    s_add_u32 m0, s31, 106496
    s_nop 0
    buffer_load_dwordx4 v6, s[12:15], s21 offen lds
    s_add_u32 m0, s31, 107520
    s_add_u32 s21, s21, 131072
    buffer_load_dwordx4 v6, s[12:15], s21 offen lds
    s_add_u32 m0, s31, 108544
    s_add_u32 s21, s21, 131072
    buffer_load_dwordx4 v6, s[12:15], s21 offen lds
    s_add_u32 m0, s31, 109568
    s_add_u32 s21, s21, 131072
    buffer_load_dwordx4 v6, s[12:15], s21 offen lds
    s_add_u32 s21, s28, 1048832
    s_add_u32 m0, s31, 122880
    s_nop 0
    buffer_load_dwordx4 v6, s[12:15], s21 offen lds
    s_add_u32 m0, s31, 123904
    s_add_u32 s21, s21, 131072
    buffer_load_dwordx4 v6, s[12:15], s21 offen lds
    s_add_u32 m0, s31, 124928
    s_add_u32 s21, s21, 131072
    buffer_load_dwordx4 v6, s[12:15], s21 offen lds
    s_add_u32 m0, s31, 125952
    s_add_u32 s21, s21, 131072
    buffer_load_dwordx4 v6, s[12:15], s21 offen lds
    s_add_u32 s21, s28, 1572864
    s_add_u32 m0, s31, 139264
    s_nop 0
    buffer_load_dwordx4 v6, s[12:15], s21 offen lds
    s_add_u32 m0, s31, 140288
    s_add_u32 s21, s21, 131072
    buffer_load_dwordx4 v6, s[12:15], s21 offen lds
    s_add_u32 m0, s31, 141312
    s_add_u32 s21, s21, 131072
    buffer_load_dwordx4 v6, s[12:15], s21 offen lds
    s_add_u32 m0, s31, 142336
    s_add_u32 s21, s21, 131072
    buffer_load_dwordx4 v6, s[12:15], s21 offen lds
    v_and_b32 v5, 15, v4
    v_lshrrev_b32 v3, 4, v4
    v_lshrrev_b32 v2, 2, v5
    v_xor_b32 v3, v3, v2
    v_lshl_add_u32 v3, v5, 2, v3
    v_lshlrev_b32 v1, 4, v3
    v_lshrrev_b32 v5, 2, v4
    v_lshrrev_b32 v3, 4, v4
    v_and_b32 v4, 3, v4
    v_xor_b32 v4, v4, v3
    v_lshlrev_b32 v3, 3, v3
    v_and_b32 v5, 3, v5
    v_add_u32 v3, v3, v5
    v_mul_u32_u24 v2, 1152, v3
    v_lshl_add_u32 v2, v4, 4, v2
    s_mov_b32 s8, s48
    s_mov_b32 s9, s49
    s_mov_b32 s10, 2359296
    s_mov_b32 s11, 0x20000
    s_lshr_b32 s22, s18, 1
    s_mul_i32 s24, s22, 4608
    s_and_b32 s22, s18, 1
    s_mul_i32 s23, s22, 576
    s_add_u32 s24, s24, s23
    s_mul_i32 s25, s18, 9216
    s_mul_i32 s22, s19, 36864
    s_add_u32 s24, s24, s22
    s_mul_i32 s42, s20, 36864
    s_mov_b32 s27, 0
    s_add_u32 s23, s27, s25
    s_add_u32 m0, s23, 0
    s_nop 0
    buffer_load_dwordx4 v2, s[8:11], s24 offen offset:0 lds
    s_add_u32 m0, s23, 960
    s_nop 0
    buffer_load_dwordx4 v2, s[8:11], s24 offen offset:64 lds
    s_add_u32 m0, s23, 1920
    s_nop 0
    buffer_load_dwordx4 v2, s[8:11], s24 offen offset:128 lds
    s_add_u32 m0, s23, 2880
    s_nop 0
    buffer_load_dwordx4 v2, s[8:11], s24 offen offset:192 lds
    s_add_u32 m0, s23, 3840
    s_nop 0
    buffer_load_dwordx4 v2, s[8:11], s24 offen offset:256 lds
    s_add_u32 m0, s23, 4800
    s_nop 0
    buffer_load_dwordx4 v2, s[8:11], s24 offen offset:320 lds
    s_add_u32 m0, s23, 5760
    s_nop 0
    buffer_load_dwordx4 v2, s[8:11], s24 offen offset:384 lds
    s_add_u32 m0, s23, 6720
    s_nop 0
    buffer_load_dwordx4 v2, s[8:11], s24 offen offset:448 lds
    s_add_u32 m0, s23, 7680
    s_nop 0
    buffer_load_dwordx4 v2, s[8:11], s24 offen offset:512 lds
    s_add_u32 s24, s24, s42
    s_lshl_b32 s22, s19, 5
    s_add_u32 s22, s22, s17
    s_lshl_b32 s26, s22, 14
    s_mul_i32 s23, s18, 3072
    s_add_u32 s26, s26, s23
    s_lshl_b32 s23, s16, 11
    s_add_u32 s26, s26, s23
    s_add_u32 s26, s26, -2048
    s_lshl_b32 s22, s22, 13
    s_add_u32 s22, s22, 33554432
    s_cmp_eq_u32 s16, 0
    s_cselect_b32 s26, s22, s26
    s_cselect_b32 s40, 4, 1
    s_cselect_b32 s43, 1, 2
    s_lshl_b32 s40, s40, 10
    s_lshl_b32 s43, s43, 13
    s_lshl_b32 s41, s43, 5
    s_mul_i32 s41, s41, s20
    s_lshl_b32 s29, s17, 7
    s_lshl_b32 s22, s33, 2
    s_add_u32 s29, s29, s22
    s_add_u32 s29, s29, 125829120
    v_add_u32 v25, 40960, v24
    v_xor_b32 v26, 32, v25
    s_waitcnt vmcnt(33)
    ds_read_b64_tr_b16 v[64:65], v25 offset:0
    ds_read_b64_tr_b16 v[66:67], v25 offset:256
    ds_read_b64_tr_b16 v[136:137], v26 offset:0
    ds_read_b64_tr_b16 v[138:139], v26 offset:256
    ds_read_b64_tr_b16 v[68:69], v25 offset:2048
    ds_read_b64_tr_b16 v[70:71], v25 offset:2304
    ds_read_b64_tr_b16 v[140:141], v26 offset:2048
    ds_read_b64_tr_b16 v[142:143], v26 offset:2304
    s_waitcnt lgkmcnt(0)
    s_add_u32 s21, s28, 1573120
    s_add_u32 m0, s31, 40960
    s_nop 0
    buffer_load_dwordx4 v6, s[12:15], s21 offen lds
    s_add_u32 m0, s31, 41984
    s_add_u32 s21, s21, 131072
    buffer_load_dwordx4 v6, s[12:15], s21 offen lds
    s_add_u32 m0, s31, 43008
    s_add_u32 s21, s21, 131072
    buffer_load_dwordx4 v6, s[12:15], s21 offen lds
    s_add_u32 m0, s31, 44032
    s_add_u32 s21, s21, 131072
    buffer_load_dwordx4 v6, s[12:15], s21 offen lds
    v_add_u32 v25, 57344, v24
    v_xor_b32 v26, 32, v25
    s_waitcnt vmcnt(33)
    ds_read_b64_tr_b16 a[0:1], v25 offset:0
    ds_read_b64_tr_b16 a[2:3], v25 offset:256
    ds_read_b64_tr_b16 a[72:73], v26 offset:0
    ds_read_b64_tr_b16 a[74:75], v26 offset:256
    ds_read_b64_tr_b16 a[4:5], v25 offset:2048
    ds_read_b64_tr_b16 a[6:7], v25 offset:2304
    ds_read_b64_tr_b16 a[76:77], v26 offset:2048
    ds_read_b64_tr_b16 a[78:79], v26 offset:2304
    s_waitcnt lgkmcnt(0)
    s_add_u32 s21, s28, 2097152
    s_add_u32 m0, s31, 57344
    s_nop 0
    buffer_load_dwordx4 v6, s[12:15], s21 offen lds
    s_add_u32 m0, s31, 58368
    s_add_u32 s21, s21, 131072
    buffer_load_dwordx4 v6, s[12:15], s21 offen lds
    s_add_u32 m0, s31, 59392
    s_add_u32 s21, s21, 131072
    buffer_load_dwordx4 v6, s[12:15], s21 offen lds
    s_add_u32 m0, s31, 60416
    s_add_u32 s21, s21, 131072
    buffer_load_dwordx4 v6, s[12:15], s21 offen lds
    v_add_u32 v25, 73728, v24
    v_xor_b32 v26, 32, v25
    s_waitcnt vmcnt(33)
    ds_read_b64_tr_b16 v[72:73], v25 offset:0
    ds_read_b64_tr_b16 v[74:75], v25 offset:256
    ds_read_b64_tr_b16 v[144:145], v26 offset:0
    ds_read_b64_tr_b16 v[146:147], v26 offset:256
    ds_read_b64_tr_b16 v[76:77], v25 offset:2048
    ds_read_b64_tr_b16 v[78:79], v25 offset:2304
    ds_read_b64_tr_b16 v[148:149], v26 offset:2048
    ds_read_b64_tr_b16 v[150:151], v26 offset:2304
    s_waitcnt lgkmcnt(0)
    s_add_u32 s21, s28, 2097408
    s_add_u32 m0, s31, 73728
    s_nop 0
    buffer_load_dwordx4 v6, s[12:15], s21 offen lds
    s_add_u32 m0, s31, 74752
    s_add_u32 s21, s21, 131072
    buffer_load_dwordx4 v6, s[12:15], s21 offen lds
    s_add_u32 m0, s31, 75776
    s_add_u32 s21, s21, 131072
    buffer_load_dwordx4 v6, s[12:15], s21 offen lds
    s_add_u32 m0, s31, 76800
    s_add_u32 s21, s21, 131072
    buffer_load_dwordx4 v6, s[12:15], s21 offen lds
    v_add_u32 v25, 90112, v24
    v_xor_b32 v26, 32, v25
    s_waitcnt vmcnt(33)
    ds_read_b64_tr_b16 a[8:9], v25 offset:0
    ds_read_b64_tr_b16 a[10:11], v25 offset:256
    ds_read_b64_tr_b16 a[80:81], v26 offset:0
    ds_read_b64_tr_b16 a[82:83], v26 offset:256
    ds_read_b64_tr_b16 a[12:13], v25 offset:2048
    ds_read_b64_tr_b16 a[14:15], v25 offset:2304
    ds_read_b64_tr_b16 a[84:85], v26 offset:2048
    ds_read_b64_tr_b16 a[86:87], v26 offset:2304
    s_waitcnt lgkmcnt(0)
    s_add_u32 s21, s28, 2621440
    s_add_u32 m0, s31, 90112
    s_nop 0
    buffer_load_dwordx4 v6, s[12:15], s21 offen lds
    s_add_u32 m0, s31, 91136
    s_add_u32 s21, s21, 131072
    buffer_load_dwordx4 v6, s[12:15], s21 offen lds
    s_add_u32 m0, s31, 92160
    s_add_u32 s21, s21, 131072
    buffer_load_dwordx4 v6, s[12:15], s21 offen lds
    s_add_u32 m0, s31, 93184
    s_add_u32 s21, s21, 131072
    buffer_load_dwordx4 v6, s[12:15], s21 offen lds
    v_add_u32 v25, 106496, v24
    v_xor_b32 v26, 32, v25
    s_waitcnt vmcnt(33)
    ds_read_b64_tr_b16 v[80:81], v25 offset:0
    ds_read_b64_tr_b16 v[82:83], v25 offset:256
    ds_read_b64_tr_b16 v[152:153], v26 offset:0
    ds_read_b64_tr_b16 v[154:155], v26 offset:256
    ds_read_b64_tr_b16 v[84:85], v25 offset:2048
    ds_read_b64_tr_b16 v[86:87], v25 offset:2304
    ds_read_b64_tr_b16 v[156:157], v26 offset:2048
    ds_read_b64_tr_b16 v[158:159], v26 offset:2304
    s_waitcnt lgkmcnt(0)
    s_add_u32 s21, s28, 2621696
    s_add_u32 m0, s31, 106496
    s_nop 0
    buffer_load_dwordx4 v6, s[12:15], s21 offen lds
    s_add_u32 m0, s31, 107520
    s_add_u32 s21, s21, 131072
    buffer_load_dwordx4 v6, s[12:15], s21 offen lds
    s_add_u32 m0, s31, 108544
    s_add_u32 s21, s21, 131072
    buffer_load_dwordx4 v6, s[12:15], s21 offen lds
    s_add_u32 m0, s31, 109568
    s_add_u32 s21, s21, 131072
    buffer_load_dwordx4 v6, s[12:15], s21 offen lds
    v_add_u32 v25, 122880, v24
    v_xor_b32 v26, 32, v25
    s_waitcnt vmcnt(33)
    ds_read_b64_tr_b16 a[16:17], v25 offset:0
    ds_read_b64_tr_b16 a[18:19], v25 offset:256
    ds_read_b64_tr_b16 a[88:89], v26 offset:0
    ds_read_b64_tr_b16 a[90:91], v26 offset:256
    ds_read_b64_tr_b16 a[20:21], v25 offset:2048
    ds_read_b64_tr_b16 a[22:23], v25 offset:2304
    ds_read_b64_tr_b16 a[92:93], v26 offset:2048
    ds_read_b64_tr_b16 a[94:95], v26 offset:2304
    s_waitcnt lgkmcnt(0)
    s_add_u32 s21, s28, 3145728
    s_add_u32 m0, s31, 122880
    s_nop 0
    buffer_load_dwordx4 v6, s[12:15], s21 offen lds
    s_add_u32 m0, s31, 123904
    s_add_u32 s21, s21, 131072
    buffer_load_dwordx4 v6, s[12:15], s21 offen lds
    s_add_u32 m0, s31, 124928
    s_add_u32 s21, s21, 131072
    buffer_load_dwordx4 v6, s[12:15], s21 offen lds
    s_add_u32 m0, s31, 125952
    s_add_u32 s21, s21, 131072
    buffer_load_dwordx4 v6, s[12:15], s21 offen lds
    v_add_u32 v25, 139264, v24
    v_xor_b32 v26, 32, v25
    s_waitcnt vmcnt(33)
    ds_read_b64_tr_b16 v[88:89], v25 offset:0
    ds_read_b64_tr_b16 v[90:91], v25 offset:256
    ds_read_b64_tr_b16 v[160:161], v26 offset:0
    ds_read_b64_tr_b16 v[162:163], v26 offset:256
    ds_read_b64_tr_b16 v[92:93], v25 offset:2048
    ds_read_b64_tr_b16 v[94:95], v25 offset:2304
    ds_read_b64_tr_b16 v[164:165], v26 offset:2048
    ds_read_b64_tr_b16 v[166:167], v26 offset:2304
    s_waitcnt lgkmcnt(0)
    s_add_u32 s21, s28, 3145984
    s_add_u32 m0, s31, 139264
    s_nop 0
    buffer_load_dwordx4 v6, s[12:15], s21 offen lds
    s_add_u32 m0, s31, 140288
    s_add_u32 s21, s21, 131072
    buffer_load_dwordx4 v6, s[12:15], s21 offen lds
    s_add_u32 m0, s31, 141312
    s_add_u32 s21, s21, 131072
    buffer_load_dwordx4 v6, s[12:15], s21 offen lds
    s_add_u32 m0, s31, 142336
    s_add_u32 s21, s21, 131072
    buffer_load_dwordx4 v6, s[12:15], s21 offen lds
    v_add_u32 v25, 40960, v24
    v_xor_b32 v26, 32, v25
    s_waitcnt vmcnt(24)
    ds_read_b64_tr_b16 a[24:25], v25 offset:0
    ds_read_b64_tr_b16 a[26:27], v25 offset:256
    ds_read_b64_tr_b16 a[96:97], v26 offset:0
    ds_read_b64_tr_b16 a[98:99], v26 offset:256
    ds_read_b64_tr_b16 a[28:29], v25 offset:2048
    ds_read_b64_tr_b16 a[30:31], v25 offset:2304
    ds_read_b64_tr_b16 a[100:101], v26 offset:2048
    ds_read_b64_tr_b16 a[102:103], v26 offset:2304
    s_waitcnt lgkmcnt(0)
    s_add_u32 s21, s28, 3670016
    s_add_u32 m0, s31, 40960
    s_nop 0
    buffer_load_dwordx4 v6, s[12:15], s21 offen lds
    s_add_u32 m0, s31, 41984
    s_add_u32 s21, s21, 131072
    buffer_load_dwordx4 v6, s[12:15], s21 offen lds
    s_add_u32 m0, s31, 43008
    s_add_u32 s21, s21, 131072
    buffer_load_dwordx4 v6, s[12:15], s21 offen lds
    s_add_u32 m0, s31, 44032
    s_add_u32 s21, s21, 131072
    buffer_load_dwordx4 v6, s[12:15], s21 offen lds
    v_add_u32 v25, 57344, v24
    v_xor_b32 v26, 32, v25
    s_waitcnt vmcnt(24)
    ds_read_b64_tr_b16 v[96:97], v25 offset:0
    ds_read_b64_tr_b16 v[98:99], v25 offset:256
    ds_read_b64_tr_b16 v[168:169], v26 offset:0
    ds_read_b64_tr_b16 v[170:171], v26 offset:256
    ds_read_b64_tr_b16 v[100:101], v25 offset:2048
    ds_read_b64_tr_b16 v[102:103], v25 offset:2304
    ds_read_b64_tr_b16 v[172:173], v26 offset:2048
    ds_read_b64_tr_b16 v[174:175], v26 offset:2304
    s_waitcnt lgkmcnt(0)
    s_add_u32 s21, s28, 3670272
    s_add_u32 m0, s31, 57344
    s_nop 0
    buffer_load_dwordx4 v6, s[12:15], s21 offen lds
    s_add_u32 m0, s31, 58368
    s_add_u32 s21, s21, 131072
    buffer_load_dwordx4 v6, s[12:15], s21 offen lds
    s_add_u32 m0, s31, 59392
    s_add_u32 s21, s21, 131072
    buffer_load_dwordx4 v6, s[12:15], s21 offen lds
    s_add_u32 m0, s31, 60416
    s_add_u32 s21, s21, 131072
    buffer_load_dwordx4 v6, s[12:15], s21 offen lds
    v_add_u32 v25, 73728, v24
    v_xor_b32 v26, 32, v25
    s_waitcnt vmcnt(24)
    ds_read_b64_tr_b16 a[32:33], v25 offset:0
    ds_read_b64_tr_b16 a[34:35], v25 offset:256
    ds_read_b64_tr_b16 a[104:105], v26 offset:0
    ds_read_b64_tr_b16 a[106:107], v26 offset:256
    ds_read_b64_tr_b16 a[36:37], v25 offset:2048
    ds_read_b64_tr_b16 a[38:39], v25 offset:2304
    ds_read_b64_tr_b16 a[108:109], v26 offset:2048
    ds_read_b64_tr_b16 a[110:111], v26 offset:2304
    s_waitcnt lgkmcnt(0)
    s_add_u32 s21, s28, 4194304
    s_add_u32 m0, s31, 73728
    s_nop 0
    buffer_load_dwordx4 v6, s[12:15], s21 offen lds
    s_add_u32 m0, s31, 74752
    s_add_u32 s21, s21, 131072
    buffer_load_dwordx4 v6, s[12:15], s21 offen lds
    s_add_u32 m0, s31, 75776
    s_add_u32 s21, s21, 131072
    buffer_load_dwordx4 v6, s[12:15], s21 offen lds
    s_add_u32 m0, s31, 76800
    s_add_u32 s21, s21, 131072
    buffer_load_dwordx4 v6, s[12:15], s21 offen lds
    v_add_u32 v25, 90112, v24
    v_xor_b32 v26, 32, v25
    s_waitcnt vmcnt(24)
    ds_read_b64_tr_b16 v[104:105], v25 offset:0
    ds_read_b64_tr_b16 v[106:107], v25 offset:256
    ds_read_b64_tr_b16 v[176:177], v26 offset:0
    ds_read_b64_tr_b16 v[178:179], v26 offset:256
    ds_read_b64_tr_b16 v[108:109], v25 offset:2048
    ds_read_b64_tr_b16 v[110:111], v25 offset:2304
    ds_read_b64_tr_b16 v[180:181], v26 offset:2048
    ds_read_b64_tr_b16 v[182:183], v26 offset:2304
    s_waitcnt lgkmcnt(0)
    v_mov_b32 v28, s95
    s_cmp_lg_u32 s95, 0
    s_cbranch_scc1 L_ne
    buffer_load_dword v28, off, s[96:99], 0 offset:64 sc1
    s_cmp_ge_u32 s36, 192
    s_cbranch_scc1 L_ne
    s_mul_i32 s37, s36, 24576
    s_mov_b32 s46, 4718592
    s_mov_b32 s47, 0x20000
    v_lshlrev_b32 v29, 7, v0
    v_min_u32 v29, 24448, v29
    s_mov_b64 s[44:45], s[58:59]
    buffer_load_dword v30, v29, s[44:47], s37 offen
    s_mov_b64 s[44:45], s[52:53]
    buffer_load_dword v30, v29, s[44:47], s37 offen
L_ne:
    s_add_u32 s21, s28, 4194560
    s_add_u32 m0, s31, 90112
    s_nop 0
    buffer_load_dwordx4 v6, s[12:15], s21 offen lds
    s_add_u32 m0, s31, 91136
    s_add_u32 s21, s21, 131072
    buffer_load_dwordx4 v6, s[12:15], s21 offen lds
    s_add_u32 m0, s31, 92160
    s_add_u32 s21, s21, 131072
    buffer_load_dwordx4 v6, s[12:15], s21 offen lds
    s_add_u32 m0, s31, 93184
    s_add_u32 s21, s21, 131072
    buffer_load_dwordx4 v6, s[12:15], s21 offen lds
    v_add_u32 v25, 106496, v24
    v_xor_b32 v26, 32, v25
    s_waitcnt vmcnt(24)
    ds_read_b64_tr_b16 a[40:41], v25 offset:0
    ds_read_b64_tr_b16 a[42:43], v25 offset:256
    ds_read_b64_tr_b16 a[112:113], v26 offset:0
    ds_read_b64_tr_b16 a[114:115], v26 offset:256
    ds_read_b64_tr_b16 a[44:45], v25 offset:2048
    ds_read_b64_tr_b16 a[46:47], v25 offset:2304
    ds_read_b64_tr_b16 a[116:117], v26 offset:2048
    ds_read_b64_tr_b16 a[118:119], v26 offset:2304
    s_waitcnt lgkmcnt(0)
    v_add_u32 v25, 122880, v24
    v_xor_b32 v26, 32, v25
    s_waitcnt vmcnt(20)
    ds_read_b64_tr_b16 v[112:113], v25 offset:0
    ds_read_b64_tr_b16 v[114:115], v25 offset:256
    ds_read_b64_tr_b16 v[184:185], v26 offset:0
    ds_read_b64_tr_b16 v[186:187], v26 offset:256
    ds_read_b64_tr_b16 v[116:117], v25 offset:2048
    ds_read_b64_tr_b16 v[118:119], v25 offset:2304
    ds_read_b64_tr_b16 v[188:189], v26 offset:2048
    ds_read_b64_tr_b16 v[190:191], v26 offset:2304
    s_waitcnt lgkmcnt(0)
    v_add_u32 v25, 139264, v24
    v_xor_b32 v26, 32, v25
    s_waitcnt vmcnt(16)
    ds_read_b64_tr_b16 a[48:49], v25 offset:0
    ds_read_b64_tr_b16 a[50:51], v25 offset:256
    ds_read_b64_tr_b16 a[120:121], v26 offset:0
    ds_read_b64_tr_b16 a[122:123], v26 offset:256
    ds_read_b64_tr_b16 a[52:53], v25 offset:2048
    ds_read_b64_tr_b16 a[54:55], v25 offset:2304
    ds_read_b64_tr_b16 a[124:125], v26 offset:2048
    ds_read_b64_tr_b16 a[126:127], v26 offset:2304
    s_waitcnt lgkmcnt(0)
    v_add_u32 v25, 40960, v24
    v_xor_b32 v26, 32, v25
    s_waitcnt vmcnt(12)
    ds_read_b64_tr_b16 v[120:121], v25 offset:0
    ds_read_b64_tr_b16 v[122:123], v25 offset:256
    ds_read_b64_tr_b16 v[192:193], v26 offset:0
    ds_read_b64_tr_b16 v[194:195], v26 offset:256
    ds_read_b64_tr_b16 v[124:125], v25 offset:2048
    ds_read_b64_tr_b16 v[126:127], v25 offset:2304
    ds_read_b64_tr_b16 v[196:197], v26 offset:2048
    ds_read_b64_tr_b16 v[198:199], v26 offset:2304
    s_waitcnt lgkmcnt(0)
    v_add_u32 v25, 57344, v24
    v_xor_b32 v26, 32, v25
    s_waitcnt vmcnt(8)
    ds_read_b64_tr_b16 a[56:57], v25 offset:0
    ds_read_b64_tr_b16 a[58:59], v25 offset:256
    ds_read_b64_tr_b16 a[128:129], v26 offset:0
    ds_read_b64_tr_b16 a[130:131], v26 offset:256
    ds_read_b64_tr_b16 a[60:61], v25 offset:2048
    ds_read_b64_tr_b16 a[62:63], v25 offset:2304
    ds_read_b64_tr_b16 a[132:133], v26 offset:2048
    ds_read_b64_tr_b16 a[134:135], v26 offset:2304
    s_waitcnt lgkmcnt(0)
    v_add_u32 v25, 73728, v24
    v_xor_b32 v26, 32, v25
    s_waitcnt vmcnt(4)
    ds_read_b64_tr_b16 v[128:129], v25 offset:0
    ds_read_b64_tr_b16 v[130:131], v25 offset:256
    ds_read_b64_tr_b16 v[200:201], v26 offset:0
    ds_read_b64_tr_b16 v[202:203], v26 offset:256
    ds_read_b64_tr_b16 v[132:133], v25 offset:2048
    ds_read_b64_tr_b16 v[134:135], v25 offset:2304
    ds_read_b64_tr_b16 v[204:205], v26 offset:2048
    ds_read_b64_tr_b16 v[206:207], v26 offset:2304
    s_waitcnt lgkmcnt(0)
    v_add_u32 v25, 90112, v24
    v_xor_b32 v26, 32, v25
    s_waitcnt vmcnt(0)
    ds_read_b64_tr_b16 a[64:65], v25 offset:0
    ds_read_b64_tr_b16 a[66:67], v25 offset:256
    ds_read_b64_tr_b16 a[136:137], v26 offset:0
    ds_read_b64_tr_b16 a[138:139], v26 offset:256
    ds_read_b64_tr_b16 a[68:69], v25 offset:2048
    ds_read_b64_tr_b16 a[70:71], v25 offset:2304
    ds_read_b64_tr_b16 a[140:141], v26 offset:2048
    ds_read_b64_tr_b16 a[142:143], v26 offset:2304
    s_waitcnt lgkmcnt(0)
    s_lshr_b32 s21, s17, 3
    s_cmp_eq_u32 s21, 3
    s_cselect_b32 s21, 1, s33
    s_cmp_lg_u32 s21, 0
    s_cbranch_scc1 qk_noclr
    v_mov_b32 v8, -1
    v_mov_b32 v9, -1
    v_mov_b32 v10, -1
    v_mov_b32 v11, -1
    v_lshrrev_b32 v25, 6, v0
    v_mul_u32_u24 v25, 11264, v25
    v_add_u32 v25, v25, v7
    s_lshl_b32 s21, s17, 9
    s_add_u32 s21, s21, 90177536
    s_add_u32 s22, s21, 786432
qk_clr:
    buffer_store_dwordx4 v[8:11], v25, s[4:7], s21 offen sc1
    s_add_u32 s21, s21, 49152
    s_cmp_lt_u32 s21, s22
    s_cbranch_scc1 qk_clr
qk_noclr:
    s_and_b32 s21, s33, -2
    s_cmp_lg_u32 s21, 2
    s_cbranch_scc1 qk_noclr2
    v_mov_b32 v8, -1
    v_mov_b32 v9, -1
    v_mov_b32 v10, -1
    v_mov_b32 v11, -1
    s_add_u32 s21, s33, 60
    s_lshl_b32 s23, s17, 12
    s_lshl_b32 s22, s21, 17
    s_add_u32 s22, s22, s23
    s_add_u32 s22, s22, 71303168
    buffer_store_dwordx4 v[8:11], v7, s[4:7], s22 offen sc1
    s_add_u32 s22, s22, 4096
    buffer_store_dwordx4 v[8:11], v7, s[4:7], s22 offen sc1
    s_lshl_b32 s22, s21, 17
    s_add_u32 s22, s22, s23
    s_add_u32 s22, s22, 80740352
    buffer_store_dwordx4 v[8:11], v7, s[4:7], s22 offen sc1
    s_add_u32 s22, s22, 4096
    buffer_store_dwordx4 v[8:11], v7, s[4:7], s22 offen sc1
    s_lshl_b32 s22, s21, 18
    s_add_u32 s22, s22, s23
    s_add_u32 s22, s22, 50331648
    buffer_store_dwordx4 v[8:11], v7, s[4:7], s22 offen sc1
    s_add_u32 s22, s22, 4096
    buffer_store_dwordx4 v[8:11], v7, s[4:7], s22 offen sc1
    s_lshl_b32 s22, s21, 18
    s_add_u32 s22, s22, s23
    s_add_u32 s22, s22, 50462720
    buffer_store_dwordx4 v[8:11], v7, s[4:7], s22 offen sc1
    s_add_u32 s22, s22, 4096
    buffer_store_dwordx4 v[8:11], v7, s[4:7], s22 offen sc1
qk_noclr2:
    v_readfirstlane_b32 s95, v28
    s_nop 4
    s_mov_b32 s88, 4194304
gn7:
    s_cmp_lg_u32 s95, 0
    s_cbranch_scc1 gn7x
    buffer_load_dword v25, off, s[96:99], 0 offset:64 sc1
    s_sub_u32 s88, s88, 1
    s_cbranch_scc1 gn7x
    s_waitcnt vmcnt(0)
    v_readfirstlane_b32 s95, v25
    s_nop 1
    s_branch gn7
gn7x:
    s_barrier
    s_mov_b32 s27, 36864
    s_add_u32 s23, s27, s25
    s_add_u32 m0, s23, 0
    s_nop 0
    buffer_load_dwordx4 v2, s[8:11], s24 offen offset:0 lds
    s_add_u32 m0, s23, 960
    s_nop 0
    buffer_load_dwordx4 v2, s[8:11], s24 offen offset:64 lds
    s_add_u32 m0, s23, 1920
    s_nop 0
    buffer_load_dwordx4 v2, s[8:11], s24 offen offset:128 lds
    s_add_u32 m0, s23, 2880
    s_nop 0
    buffer_load_dwordx4 v2, s[8:11], s24 offen offset:192 lds
    s_add_u32 m0, s23, 3840
    s_nop 0
    buffer_load_dwordx4 v2, s[8:11], s24 offen offset:256 lds
    s_add_u32 m0, s23, 4800
    s_nop 0
    buffer_load_dwordx4 v2, s[8:11], s24 offen offset:320 lds
    s_add_u32 m0, s23, 5760
    s_nop 0
    buffer_load_dwordx4 v2, s[8:11], s24 offen offset:384 lds
    s_add_u32 m0, s23, 6720
    s_nop 0
    buffer_load_dwordx4 v2, s[8:11], s24 offen offset:448 lds
    s_add_u32 m0, s23, 7680
    s_nop 0
    buffer_load_dwordx4 v2, s[8:11], s24 offen offset:512 lds
    s_add_u32 s24, s24, s42
    s_mov_b32 s27, 0
    s_mov_b32 s30, s95
    s_cmp_eq_u32 s18, 0
    s_cselect_b32 s34, 1, 0
    s_mov_b32 s35, 0
    s_mov_b32 s31, 0x80000000
    v_mov_b32 v3, v1
    ds_read_b128 v[32:35], v3 offset:0
    ds_read_b128 v[36:39], v3 offset:18432
    ds_read_b128 v[40:43], v3 offset:1024
    ds_read_b128 v[44:47], v3 offset:19456
    s_cmp_eq_u32 s16, 2
    s_cbranch_scc1 qk_vloop
qk_loop:
    s_add_u32 s22, s27, 73728
    s_sub_u32 s21, s22, 147456
    s_cselect_b32 s22, s22, s21
    s_add_u32 s27, s27, 36864
    s_cmp_eq_u32 s27, 147456
    s_cselect_b32 s27, 0, s27
    s_waitcnt lgkmcnt(2)
    v_cvt_pk_bf16_f32 v8, v208, v209
    v_cvt_pk_bf16_f32 v9, v210, v211
    v_mfma_f32_16x16x32_bf16 v[208:211], v[64:67], v[32:35], 0
    ds_read_b128 v[48:51], v3 offset:2048
    ds_read_b128 v[52:55], v3 offset:20480
    v_cvt_pk_bf16_f32 v10, v212, v213
    v_cvt_pk_bf16_f32 v11, v214, v215
    v_mfma_f32_16x16x32_bf16 v[212:215], v[136:139], v[32:35], 0
    v_cvt_pk_bf16_f32 v12, v216, v217
    v_cvt_pk_bf16_f32 v13, v218, v219
    v_mfma_f32_16x16x32_bf16 v[216:219], v[64:67], v[36:39], 0
    v_cvt_pk_bf16_f32 v14, v220, v221
    v_cvt_pk_bf16_f32 v15, v222, v223
    v_mfma_f32_16x16x32_bf16 v[220:223], v[136:139], v[36:39], 0
    v_cvt_pk_bf16_f32 v16, v224, v225
    v_cvt_pk_bf16_f32 v17, v226, v227
    v_mfma_f32_16x16x32_bf16 v[224:227], a[0:3], v[32:35], 0
    v_cvt_pk_bf16_f32 v18, v228, v229
    v_cvt_pk_bf16_f32 v19, v230, v231
    v_mfma_f32_16x16x32_bf16 v[228:231], a[72:75], v[32:35], 0
    v_cvt_pk_bf16_f32 v20, v232, v233
    v_cvt_pk_bf16_f32 v21, v234, v235
    v_mfma_f32_16x16x32_bf16 v[232:235], a[0:3], v[36:39], 0
    v_cvt_pk_bf16_f32 v22, v236, v237
    v_cvt_pk_bf16_f32 v23, v238, v239
    v_mfma_f32_16x16x32_bf16 v[236:239], a[72:75], v[36:39], 0
    s_waitcnt lgkmcnt(2)
    v_mfma_f32_16x16x32_bf16 v[208:211], v[68:71], v[40:43], v[208:211]
    ds_read_b128 v[32:35], v3 offset:3072
    ds_read_b128 v[36:39], v3 offset:21504
    v_mfma_f32_16x16x32_bf16 v[212:215], v[140:143], v[40:43], v[212:215]
    v_mfma_f32_16x16x32_bf16 v[216:219], v[68:71], v[44:47], v[216:219]
    s_mov_b32 s28, s31
    buffer_store_dwordx4 v[8:11], v7, s[4:7], s28 offen sc1
    v_mfma_f32_16x16x32_bf16 v[220:223], v[140:143], v[44:47], v[220:223]
    v_mfma_f32_16x16x32_bf16 v[224:227], a[4:7], v[40:43], v[224:227]
    v_mfma_f32_16x16x32_bf16 v[228:231], a[76:79], v[40:43], v[228:231]
    v_mfma_f32_16x16x32_bf16 v[232:235], a[4:7], v[44:47], v[232:235]
    v_mfma_f32_16x16x32_bf16 v[236:239], a[76:79], v[44:47], v[236:239]
    s_waitcnt lgkmcnt(2)
    v_mfma_f32_16x16x32_bf16 v[208:211], v[72:75], v[48:51], v[208:211]
    ds_read_b128 v[40:43], v3 offset:4096
    ds_read_b128 v[44:47], v3 offset:22528
    v_mfma_f32_16x16x32_bf16 v[212:215], v[144:147], v[48:51], v[212:215]
    v_mfma_f32_16x16x32_bf16 v[216:219], v[72:75], v[52:55], v[216:219]
    s_add_u32 s28, s28, s40
    buffer_store_dwordx4 v[12:15], v7, s[4:7], s28 offen sc1
    v_mfma_f32_16x16x32_bf16 v[220:223], v[144:147], v[52:55], v[220:223]
    v_mfma_f32_16x16x32_bf16 v[224:227], a[8:11], v[48:51], v[224:227]
    v_mfma_f32_16x16x32_bf16 v[228:231], a[80:83], v[48:51], v[228:231]
    v_mfma_f32_16x16x32_bf16 v[232:235], a[8:11], v[52:55], v[232:235]
    v_mfma_f32_16x16x32_bf16 v[236:239], a[80:83], v[52:55], v[236:239]
    s_waitcnt lgkmcnt(2)
    v_mfma_f32_16x16x32_bf16 v[208:211], v[76:79], v[32:35], v[208:211]
    ds_read_b128 v[48:51], v3 offset:5120
    ds_read_b128 v[52:55], v3 offset:23552
    v_mfma_f32_16x16x32_bf16 v[212:215], v[148:151], v[32:35], v[212:215]
    v_mfma_f32_16x16x32_bf16 v[216:219], v[76:79], v[36:39], v[216:219]
    s_add_u32 s28, s31, s43
    buffer_store_dwordx4 v[16:19], v7, s[4:7], s28 offen sc1
    v_mfma_f32_16x16x32_bf16 v[220:223], v[148:151], v[36:39], v[220:223]
    v_mfma_f32_16x16x32_bf16 v[224:227], a[12:15], v[32:35], v[224:227]
    v_mfma_f32_16x16x32_bf16 v[228:231], a[84:87], v[32:35], v[228:231]
    v_mfma_f32_16x16x32_bf16 v[232:235], a[12:15], v[36:39], v[232:235]
    v_mfma_f32_16x16x32_bf16 v[236:239], a[84:87], v[36:39], v[236:239]
    s_waitcnt lgkmcnt(2)
    v_mfma_f32_16x16x32_bf16 v[208:211], v[80:83], v[40:43], v[208:211]
    ds_read_b128 v[32:35], v3 offset:6144
    ds_read_b128 v[36:39], v3 offset:24576
    v_mfma_f32_16x16x32_bf16 v[212:215], v[152:155], v[40:43], v[212:215]
    v_mfma_f32_16x16x32_bf16 v[216:219], v[80:83], v[44:47], v[216:219]
    s_add_u32 s28, s28, s40
    buffer_store_dwordx4 v[20:23], v7, s[4:7], s28 offen sc1
    v_mfma_f32_16x16x32_bf16 v[220:223], v[152:155], v[44:47], v[220:223]
    v_mfma_f32_16x16x32_bf16 v[224:227], a[16:19], v[40:43], v[224:227]
    v_mfma_f32_16x16x32_bf16 v[228:231], a[88:91], v[40:43], v[228:231]
    v_mfma_f32_16x16x32_bf16 v[232:235], a[16:19], v[44:47], v[232:235]
    v_mfma_f32_16x16x32_bf16 v[236:239], a[88:91], v[44:47], v[236:239]
    s_waitcnt lgkmcnt(2)
    v_mfma_f32_16x16x32_bf16 v[208:211], v[84:87], v[48:51], v[208:211]
    ds_read_b128 v[40:43], v3 offset:7168
    ds_read_b128 v[44:47], v3 offset:25600
    v_mfma_f32_16x16x32_bf16 v[212:215], v[156:159], v[48:51], v[212:215]
    v_mfma_f32_16x16x32_bf16 v[216:219], v[84:87], v[52:55], v[216:219]
    s_add_u32 s23, s22, s25
    s_add_u32 m0, s23, 0
    s_nop 0
    buffer_load_dwordx4 v2, s[8:11], s24 offen offset:0 lds
    v_mfma_f32_16x16x32_bf16 v[220:223], v[156:159], v[52:55], v[220:223]
    v_mfma_f32_16x16x32_bf16 v[224:227], a[20:23], v[48:51], v[224:227]
    v_mfma_f32_16x16x32_bf16 v[228:231], a[92:95], v[48:51], v[228:231]
    v_mfma_f32_16x16x32_bf16 v[232:235], a[20:23], v[52:55], v[232:235]
    v_mfma_f32_16x16x32_bf16 v[236:239], a[92:95], v[52:55], v[236:239]
    s_waitcnt lgkmcnt(2)
    v_mfma_f32_16x16x32_bf16 v[208:211], v[88:91], v[32:35], v[208:211]
    ds_read_b128 v[48:51], v3 offset:8192
    ds_read_b128 v[52:55], v3 offset:26624
    v_mfma_f32_16x16x32_bf16 v[212:215], v[160:163], v[32:35], v[212:215]
    v_mfma_f32_16x16x32_bf16 v[216:219], v[88:91], v[36:39], v[216:219]
    s_add_u32 m0, s23, 960
    s_nop 0
    buffer_load_dwordx4 v2, s[8:11], s24 offen offset:64 lds
    v_mfma_f32_16x16x32_bf16 v[220:223], v[160:163], v[36:39], v[220:223]
    v_mfma_f32_16x16x32_bf16 v[224:227], a[24:27], v[32:35], v[224:227]
    v_mfma_f32_16x16x32_bf16 v[228:231], a[96:99], v[32:35], v[228:231]
    v_mfma_f32_16x16x32_bf16 v[232:235], a[24:27], v[36:39], v[232:235]
    v_mfma_f32_16x16x32_bf16 v[236:239], a[96:99], v[36:39], v[236:239]
    s_waitcnt lgkmcnt(2)
    v_mfma_f32_16x16x32_bf16 v[208:211], v[92:95], v[40:43], v[208:211]
    ds_read_b128 v[32:35], v3 offset:9216
    ds_read_b128 v[36:39], v3 offset:27648
    v_mfma_f32_16x16x32_bf16 v[212:215], v[164:167], v[40:43], v[212:215]
    v_mfma_f32_16x16x32_bf16 v[216:219], v[92:95], v[44:47], v[216:219]
    s_add_u32 m0, s23, 1920
    s_nop 0
    buffer_load_dwordx4 v2, s[8:11], s24 offen offset:128 lds
    v_mfma_f32_16x16x32_bf16 v[220:223], v[164:167], v[44:47], v[220:223]
    v_mfma_f32_16x16x32_bf16 v[224:227], a[28:31], v[40:43], v[224:227]
    v_mfma_f32_16x16x32_bf16 v[228:231], a[100:103], v[40:43], v[228:231]
    v_mfma_f32_16x16x32_bf16 v[232:235], a[28:31], v[44:47], v[232:235]
    v_mfma_f32_16x16x32_bf16 v[236:239], a[100:103], v[44:47], v[236:239]
    s_waitcnt lgkmcnt(2)
    v_mfma_f32_16x16x32_bf16 v[208:211], v[96:99], v[48:51], v[208:211]
    ds_read_b128 v[40:43], v3 offset:10240
    ds_read_b128 v[44:47], v3 offset:28672
    v_mfma_f32_16x16x32_bf16 v[212:215], v[168:171], v[48:51], v[212:215]
    v_mfma_f32_16x16x32_bf16 v[216:219], v[96:99], v[52:55], v[216:219]
    s_add_u32 m0, s23, 2880
    s_nop 0
    buffer_load_dwordx4 v2, s[8:11], s24 offen offset:192 lds
    v_mfma_f32_16x16x32_bf16 v[220:223], v[168:171], v[52:55], v[220:223]
    v_mfma_f32_16x16x32_bf16 v[224:227], a[32:35], v[48:51], v[224:227]
    v_mfma_f32_16x16x32_bf16 v[228:231], a[104:107], v[48:51], v[228:231]
    v_mfma_f32_16x16x32_bf16 v[232:235], a[32:35], v[52:55], v[232:235]
    v_mfma_f32_16x16x32_bf16 v[236:239], a[104:107], v[52:55], v[236:239]
    s_waitcnt lgkmcnt(2)
    v_mfma_f32_16x16x32_bf16 v[208:211], v[100:103], v[32:35], v[208:211]
    ds_read_b128 v[48:51], v3 offset:11264
    ds_read_b128 v[52:55], v3 offset:29696
    v_mfma_f32_16x16x32_bf16 v[212:215], v[172:175], v[32:35], v[212:215]
    v_mfma_f32_16x16x32_bf16 v[216:219], v[100:103], v[36:39], v[216:219]
    s_add_u32 m0, s23, 3840
    s_nop 0
    buffer_load_dwordx4 v2, s[8:11], s24 offen offset:256 lds
    v_mfma_f32_16x16x32_bf16 v[220:223], v[172:175], v[36:39], v[220:223]
    v_mfma_f32_16x16x32_bf16 v[224:227], a[36:39], v[32:35], v[224:227]
    v_mfma_f32_16x16x32_bf16 v[228:231], a[108:111], v[32:35], v[228:231]
    v_mfma_f32_16x16x32_bf16 v[232:235], a[36:39], v[36:39], v[232:235]
    v_mfma_f32_16x16x32_bf16 v[236:239], a[108:111], v[36:39], v[236:239]
    s_waitcnt lgkmcnt(2)
    v_mfma_f32_16x16x32_bf16 v[208:211], v[104:107], v[40:43], v[208:211]
    ds_read_b128 v[32:35], v3 offset:12288
    ds_read_b128 v[36:39], v3 offset:30720
    v_mfma_f32_16x16x32_bf16 v[212:215], v[176:179], v[40:43], v[212:215]
    v_mfma_f32_16x16x32_bf16 v[216:219], v[104:107], v[44:47], v[216:219]
    s_add_u32 m0, s23, 4800
    s_nop 0
    buffer_load_dwordx4 v2, s[8:11], s24 offen offset:320 lds
    v_mfma_f32_16x16x32_bf16 v[220:223], v[176:179], v[44:47], v[220:223]
    v_mfma_f32_16x16x32_bf16 v[224:227], a[40:43], v[40:43], v[224:227]
    v_mfma_f32_16x16x32_bf16 v[228:231], a[112:115], v[40:43], v[228:231]
    v_mfma_f32_16x16x32_bf16 v[232:235], a[40:43], v[44:47], v[232:235]
    v_mfma_f32_16x16x32_bf16 v[236:239], a[112:115], v[44:47], v[236:239]
    s_waitcnt lgkmcnt(2)
    v_mfma_f32_16x16x32_bf16 v[208:211], v[108:111], v[48:51], v[208:211]
    ds_read_b128 v[40:43], v3 offset:13312
    ds_read_b128 v[44:47], v3 offset:31744
    v_mfma_f32_16x16x32_bf16 v[212:215], v[180:183], v[48:51], v[212:215]
    v_mfma_f32_16x16x32_bf16 v[216:219], v[108:111], v[52:55], v[216:219]
    s_add_u32 m0, s23, 5760
    s_nop 0
    buffer_load_dwordx4 v2, s[8:11], s24 offen offset:384 lds
    v_mfma_f32_16x16x32_bf16 v[220:223], v[180:183], v[52:55], v[220:223]
    v_mfma_f32_16x16x32_bf16 v[224:227], a[44:47], v[48:51], v[224:227]
    v_mfma_f32_16x16x32_bf16 v[228:231], a[116:119], v[48:51], v[228:231]
    v_mfma_f32_16x16x32_bf16 v[232:235], a[44:47], v[52:55], v[232:235]
    v_mfma_f32_16x16x32_bf16 v[236:239], a[116:119], v[52:55], v[236:239]
    s_waitcnt lgkmcnt(2)
    v_mfma_f32_16x16x32_bf16 v[208:211], v[112:115], v[32:35], v[208:211]
    ds_read_b128 v[48:51], v3 offset:14336
    ds_read_b128 v[52:55], v3 offset:32768
    v_mfma_f32_16x16x32_bf16 v[212:215], v[184:187], v[32:35], v[212:215]
    v_mfma_f32_16x16x32_bf16 v[216:219], v[112:115], v[36:39], v[216:219]
    s_add_u32 m0, s23, 6720
    s_nop 0
    buffer_load_dwordx4 v2, s[8:11], s24 offen offset:448 lds
    v_mfma_f32_16x16x32_bf16 v[220:223], v[184:187], v[36:39], v[220:223]
    v_mfma_f32_16x16x32_bf16 v[224:227], a[48:51], v[32:35], v[224:227]
    v_mfma_f32_16x16x32_bf16 v[228:231], a[120:123], v[32:35], v[228:231]
    v_mfma_f32_16x16x32_bf16 v[232:235], a[48:51], v[36:39], v[232:235]
    v_mfma_f32_16x16x32_bf16 v[236:239], a[120:123], v[36:39], v[236:239]
    s_waitcnt lgkmcnt(2)
    v_mfma_f32_16x16x32_bf16 v[208:211], v[116:119], v[40:43], v[208:211]
    ds_read_b128 v[32:35], v3 offset:15360
    ds_read_b128 v[36:39], v3 offset:33792
    v_mfma_f32_16x16x32_bf16 v[212:215], v[188:191], v[40:43], v[212:215]
    v_mfma_f32_16x16x32_bf16 v[216:219], v[116:119], v[44:47], v[216:219]
    s_add_u32 m0, s23, 7680
    s_nop 0
    buffer_load_dwordx4 v2, s[8:11], s24 offen offset:512 lds
    s_add_u32 s24, s24, s42
    v_mfma_f32_16x16x32_bf16 v[220:223], v[188:191], v[44:47], v[220:223]
    v_mfma_f32_16x16x32_bf16 v[224:227], a[52:55], v[40:43], v[224:227]
    v_mfma_f32_16x16x32_bf16 v[228:231], a[124:127], v[40:43], v[228:231]
    v_mfma_f32_16x16x32_bf16 v[232:235], a[52:55], v[44:47], v[232:235]
    v_mfma_f32_16x16x32_bf16 v[236:239], a[124:127], v[44:47], v[236:239]
    s_waitcnt lgkmcnt(2)
    v_mfma_f32_16x16x32_bf16 v[208:211], v[120:123], v[48:51], v[208:211]
    ds_read_b128 v[40:43], v3 offset:16384
    ds_read_b128 v[44:47], v3 offset:34816
    v_mfma_f32_16x16x32_bf16 v[212:215], v[192:195], v[48:51], v[212:215]
    v_mfma_f32_16x16x32_bf16 v[216:219], v[120:123], v[52:55], v[216:219]
    v_add_u32 v24, s27, v1
    v_mfma_f32_16x16x32_bf16 v[220:223], v[192:195], v[52:55], v[220:223]
    v_mfma_f32_16x16x32_bf16 v[224:227], a[56:59], v[48:51], v[224:227]
    v_mfma_f32_16x16x32_bf16 v[228:231], a[128:131], v[48:51], v[228:231]
    v_mfma_f32_16x16x32_bf16 v[232:235], a[56:59], v[52:55], v[232:235]
    v_mfma_f32_16x16x32_bf16 v[236:239], a[128:131], v[52:55], v[236:239]
    s_waitcnt lgkmcnt(2)
    v_mfma_f32_16x16x32_bf16 v[208:211], v[124:127], v[32:35], v[208:211]
    ds_read_b128 v[48:51], v3 offset:17408
    ds_read_b128 v[52:55], v3 offset:35840
    v_mfma_f32_16x16x32_bf16 v[212:215], v[196:199], v[32:35], v[212:215]
    v_mfma_f32_16x16x32_bf16 v[216:219], v[124:127], v[36:39], v[216:219]
    v_mfma_f32_16x16x32_bf16 v[220:223], v[196:199], v[36:39], v[220:223]
    v_mfma_f32_16x16x32_bf16 v[224:227], a[60:63], v[32:35], v[224:227]
    v_mfma_f32_16x16x32_bf16 v[228:231], a[132:135], v[32:35], v[228:231]
    s_waitcnt vmcnt(9)
    s_barrier
    v_mfma_f32_16x16x32_bf16 v[232:235], a[60:63], v[36:39], v[232:235]
    v_mfma_f32_16x16x32_bf16 v[236:239], a[132:135], v[36:39], v[236:239]
    s_waitcnt lgkmcnt(2)
    v_mfma_f32_16x16x32_bf16 v[208:211], v[128:131], v[40:43], v[208:211]
    ds_read_b128 v[32:35], v24 offset:0
    ds_read_b128 v[36:39], v24 offset:18432
    v_mfma_f32_16x16x32_bf16 v[212:215], v[200:203], v[40:43], v[212:215]
    v_mfma_f32_16x16x32_bf16 v[216:219], v[128:131], v[44:47], v[216:219]
    v_mov_b32 v4, s30
    s_mov_b64 exec, s[34:35]
    buffer_store_dword v4, off, s[4:7], s29 sc1
    s_mov_b64 exec, -1
    v_mfma_f32_16x16x32_bf16 v[220:223], v[200:203], v[44:47], v[220:223]
    v_mfma_f32_16x16x32_bf16 v[224:227], a[64:67], v[40:43], v[224:227]
    v_mfma_f32_16x16x32_bf16 v[228:231], a[136:139], v[40:43], v[228:231]
    v_mfma_f32_16x16x32_bf16 v[232:235], a[64:67], v[44:47], v[232:235]
    v_mfma_f32_16x16x32_bf16 v[236:239], a[136:139], v[44:47], v[236:239]
    s_waitcnt lgkmcnt(2)
    v_mfma_f32_16x16x32_bf16 v[208:211], v[132:135], v[48:51], v[208:211]
    ds_read_b128 v[40:43], v24 offset:1024
    ds_read_b128 v[44:47], v24 offset:19456
    v_mfma_f32_16x16x32_bf16 v[212:215], v[204:207], v[48:51], v[212:215]
    v_mfma_f32_16x16x32_bf16 v[216:219], v[132:135], v[52:55], v[216:219]
    v_mfma_f32_16x16x32_bf16 v[220:223], v[204:207], v[52:55], v[220:223]
    v_mfma_f32_16x16x32_bf16 v[224:227], a[68:71], v[48:51], v[224:227]
    v_mfma_f32_16x16x32_bf16 v[228:231], a[140:143], v[48:51], v[228:231]
    v_mfma_f32_16x16x32_bf16 v[232:235], a[68:71], v[52:55], v[232:235]
    v_mfma_f32_16x16x32_bf16 v[236:239], a[140:143], v[52:55], v[236:239]
    v_mov_b32 v3, v24
    s_mov_b32 s31, s26
    s_add_u32 s26, s26, s41
    s_add_u32 s30, s30, 1
    s_add_u32 s19, s19, s20
    s_cmp_lt_u32 s19, 64
    s_cbranch_scc1 qk_loop
    v_cvt_pk_bf16_f32 v8, v208, v209
    v_cvt_pk_bf16_f32 v9, v210, v211
    v_cvt_pk_bf16_f32 v10, v212, v213
    v_cvt_pk_bf16_f32 v11, v214, v215
    v_cvt_pk_bf16_f32 v12, v216, v217
    v_cvt_pk_bf16_f32 v13, v218, v219
    v_cvt_pk_bf16_f32 v14, v220, v221
    v_cvt_pk_bf16_f32 v15, v222, v223
    v_cvt_pk_bf16_f32 v16, v224, v225
    v_cvt_pk_bf16_f32 v17, v226, v227
    v_cvt_pk_bf16_f32 v18, v228, v229
    v_cvt_pk_bf16_f32 v19, v230, v231
    v_cvt_pk_bf16_f32 v20, v232, v233
    v_cvt_pk_bf16_f32 v21, v234, v235
    v_cvt_pk_bf16_f32 v22, v236, v237
    v_cvt_pk_bf16_f32 v23, v238, v239
    s_branch qk_done
    s_nop 0
qk_vloop:
    s_add_u32 s22, s27, 73728
    s_sub_u32 s21, s22, 147456
    s_cselect_b32 s22, s22, s21
    s_add_u32 s27, s27, 36864
    s_cmp_eq_u32 s27, 147456
    s_cselect_b32 s27, 0, s27
    s_waitcnt lgkmcnt(2)
    v_cvt_pk_bf16_f32 v8, v208, v209
    v_cvt_pk_bf16_f32 v9, v210, v211
    v_mfma_f32_16x16x32_bf16 v[208:211], v[32:35], v[64:67], 0
    ds_read_b128 v[48:51], v3 offset:2048
    ds_read_b128 v[52:55], v3 offset:20480
    v_cvt_pk_bf16_f32 v12, v212, v213
    v_cvt_pk_bf16_f32 v13, v214, v215
    v_mfma_f32_16x16x32_bf16 v[212:215], v[32:35], v[136:139], 0
    v_cvt_pk_bf16_f32 v10, v216, v217
    v_cvt_pk_bf16_f32 v11, v218, v219
    v_mfma_f32_16x16x32_bf16 v[216:219], v[36:39], v[64:67], 0
    v_cvt_pk_bf16_f32 v14, v220, v221
    v_cvt_pk_bf16_f32 v15, v222, v223
    v_mfma_f32_16x16x32_bf16 v[220:223], v[36:39], v[136:139], 0
    v_cvt_pk_bf16_f32 v16, v224, v225
    v_cvt_pk_bf16_f32 v17, v226, v227
    v_mfma_f32_16x16x32_bf16 v[224:227], v[32:35], a[0:3], 0
    v_cvt_pk_bf16_f32 v20, v228, v229
    v_cvt_pk_bf16_f32 v21, v230, v231
    v_mfma_f32_16x16x32_bf16 v[228:231], v[32:35], a[72:75], 0
    v_cvt_pk_bf16_f32 v18, v232, v233
    v_cvt_pk_bf16_f32 v19, v234, v235
    v_mfma_f32_16x16x32_bf16 v[232:235], v[36:39], a[0:3], 0
    v_cvt_pk_bf16_f32 v22, v236, v237
    v_cvt_pk_bf16_f32 v23, v238, v239
    v_mfma_f32_16x16x32_bf16 v[236:239], v[36:39], a[72:75], 0
    s_waitcnt lgkmcnt(2)
    v_mfma_f32_16x16x32_bf16 v[208:211], v[40:43], v[68:71], v[208:211]
    ds_read_b128 v[32:35], v3 offset:3072
    ds_read_b128 v[36:39], v3 offset:21504
    v_mfma_f32_16x16x32_bf16 v[212:215], v[40:43], v[140:143], v[212:215]
    v_mfma_f32_16x16x32_bf16 v[216:219], v[44:47], v[68:71], v[216:219]
    s_mov_b32 s28, s31
    buffer_store_dwordx4 v[8:11], v7, s[4:7], s28 offen sc1
    v_mfma_f32_16x16x32_bf16 v[220:223], v[44:47], v[140:143], v[220:223]
    v_mfma_f32_16x16x32_bf16 v[224:227], v[40:43], a[4:7], v[224:227]
    v_mfma_f32_16x16x32_bf16 v[228:231], v[40:43], a[76:79], v[228:231]
    v_mfma_f32_16x16x32_bf16 v[232:235], v[44:47], a[4:7], v[232:235]
    v_mfma_f32_16x16x32_bf16 v[236:239], v[44:47], a[76:79], v[236:239]
    s_waitcnt lgkmcnt(2)
    v_mfma_f32_16x16x32_bf16 v[208:211], v[48:51], v[72:75], v[208:211]
    ds_read_b128 v[40:43], v3 offset:4096
    ds_read_b128 v[44:47], v3 offset:22528
    v_mfma_f32_16x16x32_bf16 v[212:215], v[48:51], v[144:147], v[212:215]
    v_mfma_f32_16x16x32_bf16 v[216:219], v[52:55], v[72:75], v[216:219]
    s_add_u32 s28, s28, s40
    buffer_store_dwordx4 v[12:15], v7, s[4:7], s28 offen sc1
    v_mfma_f32_16x16x32_bf16 v[220:223], v[52:55], v[144:147], v[220:223]
    v_mfma_f32_16x16x32_bf16 v[224:227], v[48:51], a[8:11], v[224:227]
    v_mfma_f32_16x16x32_bf16 v[228:231], v[48:51], a[80:83], v[228:231]
    v_mfma_f32_16x16x32_bf16 v[232:235], v[52:55], a[8:11], v[232:235]
    v_mfma_f32_16x16x32_bf16 v[236:239], v[52:55], a[80:83], v[236:239]
    s_waitcnt lgkmcnt(2)
    v_mfma_f32_16x16x32_bf16 v[208:211], v[32:35], v[76:79], v[208:211]
    ds_read_b128 v[48:51], v3 offset:5120
    ds_read_b128 v[52:55], v3 offset:23552
    v_mfma_f32_16x16x32_bf16 v[212:215], v[32:35], v[148:151], v[212:215]
    v_mfma_f32_16x16x32_bf16 v[216:219], v[36:39], v[76:79], v[216:219]
    s_add_u32 s28, s31, s43
    buffer_store_dwordx4 v[16:19], v7, s[4:7], s28 offen sc1
    v_mfma_f32_16x16x32_bf16 v[220:223], v[36:39], v[148:151], v[220:223]
    v_mfma_f32_16x16x32_bf16 v[224:227], v[32:35], a[12:15], v[224:227]
    v_mfma_f32_16x16x32_bf16 v[228:231], v[32:35], a[84:87], v[228:231]
    v_mfma_f32_16x16x32_bf16 v[232:235], v[36:39], a[12:15], v[232:235]
    v_mfma_f32_16x16x32_bf16 v[236:239], v[36:39], a[84:87], v[236:239]
    s_waitcnt lgkmcnt(2)
    v_mfma_f32_16x16x32_bf16 v[208:211], v[40:43], v[80:83], v[208:211]
    ds_read_b128 v[32:35], v3 offset:6144
    ds_read_b128 v[36:39], v3 offset:24576
    v_mfma_f32_16x16x32_bf16 v[212:215], v[40:43], v[152:155], v[212:215]
    v_mfma_f32_16x16x32_bf16 v[216:219], v[44:47], v[80:83], v[216:219]
    s_add_u32 s28, s28, s40
    buffer_store_dwordx4 v[20:23], v7, s[4:7], s28 offen sc1
    v_mfma_f32_16x16x32_bf16 v[220:223], v[44:47], v[152:155], v[220:223]
    v_mfma_f32_16x16x32_bf16 v[224:227], v[40:43], a[16:19], v[224:227]
    v_mfma_f32_16x16x32_bf16 v[228:231], v[40:43], a[88:91], v[228:231]
    v_mfma_f32_16x16x32_bf16 v[232:235], v[44:47], a[16:19], v[232:235]
    v_mfma_f32_16x16x32_bf16 v[236:239], v[44:47], a[88:91], v[236:239]
    s_waitcnt lgkmcnt(2)
    v_mfma_f32_16x16x32_bf16 v[208:211], v[48:51], v[84:87], v[208:211]
    ds_read_b128 v[40:43], v3 offset:7168
    ds_read_b128 v[44:47], v3 offset:25600
    v_mfma_f32_16x16x32_bf16 v[212:215], v[48:51], v[156:159], v[212:215]
    v_mfma_f32_16x16x32_bf16 v[216:219], v[52:55], v[84:87], v[216:219]
    s_add_u32 s23, s22, s25
    s_add_u32 m0, s23, 0
    s_nop 0
    buffer_load_dwordx4 v2, s[8:11], s24 offen offset:0 lds
    v_mfma_f32_16x16x32_bf16 v[220:223], v[52:55], v[156:159], v[220:223]
    v_mfma_f32_16x16x32_bf16 v[224:227], v[48:51], a[20:23], v[224:227]
    v_mfma_f32_16x16x32_bf16 v[228:231], v[48:51], a[92:95], v[228:231]
    v_mfma_f32_16x16x32_bf16 v[232:235], v[52:55], a[20:23], v[232:235]
    v_mfma_f32_16x16x32_bf16 v[236:239], v[52:55], a[92:95], v[236:239]
    s_waitcnt lgkmcnt(2)
    v_mfma_f32_16x16x32_bf16 v[208:211], v[32:35], v[88:91], v[208:211]
    ds_read_b128 v[48:51], v3 offset:8192
    ds_read_b128 v[52:55], v3 offset:26624
    v_mfma_f32_16x16x32_bf16 v[212:215], v[32:35], v[160:163], v[212:215]
    v_mfma_f32_16x16x32_bf16 v[216:219], v[36:39], v[88:91], v[216:219]
    s_add_u32 m0, s23, 960
    s_nop 0
    buffer_load_dwordx4 v2, s[8:11], s24 offen offset:64 lds
    v_mfma_f32_16x16x32_bf16 v[220:223], v[36:39], v[160:163], v[220:223]
    v_mfma_f32_16x16x32_bf16 v[224:227], v[32:35], a[24:27], v[224:227]
    v_mfma_f32_16x16x32_bf16 v[228:231], v[32:35], a[96:99], v[228:231]
    v_mfma_f32_16x16x32_bf16 v[232:235], v[36:39], a[24:27], v[232:235]
    v_mfma_f32_16x16x32_bf16 v[236:239], v[36:39], a[96:99], v[236:239]
    s_waitcnt lgkmcnt(2)
    v_mfma_f32_16x16x32_bf16 v[208:211], v[40:43], v[92:95], v[208:211]
    ds_read_b128 v[32:35], v3 offset:9216
    ds_read_b128 v[36:39], v3 offset:27648
    v_mfma_f32_16x16x32_bf16 v[212:215], v[40:43], v[164:167], v[212:215]
    v_mfma_f32_16x16x32_bf16 v[216:219], v[44:47], v[92:95], v[216:219]
    s_add_u32 m0, s23, 1920
    s_nop 0
    buffer_load_dwordx4 v2, s[8:11], s24 offen offset:128 lds
    v_mfma_f32_16x16x32_bf16 v[220:223], v[44:47], v[164:167], v[220:223]
    v_mfma_f32_16x16x32_bf16 v[224:227], v[40:43], a[28:31], v[224:227]
    v_mfma_f32_16x16x32_bf16 v[228:231], v[40:43], a[100:103], v[228:231]
    v_mfma_f32_16x16x32_bf16 v[232:235], v[44:47], a[28:31], v[232:235]
    v_mfma_f32_16x16x32_bf16 v[236:239], v[44:47], a[100:103], v[236:239]
    s_waitcnt lgkmcnt(2)
    v_mfma_f32_16x16x32_bf16 v[208:211], v[48:51], v[96:99], v[208:211]
    ds_read_b128 v[40:43], v3 offset:10240
    ds_read_b128 v[44:47], v3 offset:28672
    v_mfma_f32_16x16x32_bf16 v[212:215], v[48:51], v[168:171], v[212:215]
    v_mfma_f32_16x16x32_bf16 v[216:219], v[52:55], v[96:99], v[216:219]
    s_add_u32 m0, s23, 2880
    s_nop 0
    buffer_load_dwordx4 v2, s[8:11], s24 offen offset:192 lds
    v_mfma_f32_16x16x32_bf16 v[220:223], v[52:55], v[168:171], v[220:223]
    v_mfma_f32_16x16x32_bf16 v[224:227], v[48:51], a[32:35], v[224:227]
    v_mfma_f32_16x16x32_bf16 v[228:231], v[48:51], a[104:107], v[228:231]
    v_mfma_f32_16x16x32_bf16 v[232:235], v[52:55], a[32:35], v[232:235]
    v_mfma_f32_16x16x32_bf16 v[236:239], v[52:55], a[104:107], v[236:239]
    s_waitcnt lgkmcnt(2)
    v_mfma_f32_16x16x32_bf16 v[208:211], v[32:35], v[100:103], v[208:211]
    ds_read_b128 v[48:51], v3 offset:11264
    ds_read_b128 v[52:55], v3 offset:29696
    v_mfma_f32_16x16x32_bf16 v[212:215], v[32:35], v[172:175], v[212:215]
    v_mfma_f32_16x16x32_bf16 v[216:219], v[36:39], v[100:103], v[216:219]
    s_add_u32 m0, s23, 3840
    s_nop 0
    buffer_load_dwordx4 v2, s[8:11], s24 offen offset:256 lds
    v_mfma_f32_16x16x32_bf16 v[220:223], v[36:39], v[172:175], v[220:223]
    v_mfma_f32_16x16x32_bf16 v[224:227], v[32:35], a[36:39], v[224:227]
    v_mfma_f32_16x16x32_bf16 v[228:231], v[32:35], a[108:111], v[228:231]
    v_mfma_f32_16x16x32_bf16 v[232:235], v[36:39], a[36:39], v[232:235]
    v_mfma_f32_16x16x32_bf16 v[236:239], v[36:39], a[108:111], v[236:239]
    s_waitcnt lgkmcnt(2)
    v_mfma_f32_16x16x32_bf16 v[208:211], v[40:43], v[104:107], v[208:211]
    ds_read_b128 v[32:35], v3 offset:12288
    ds_read_b128 v[36:39], v3 offset:30720
    v_mfma_f32_16x16x32_bf16 v[212:215], v[40:43], v[176:179], v[212:215]
    v_mfma_f32_16x16x32_bf16 v[216:219], v[44:47], v[104:107], v[216:219]
    s_add_u32 m0, s23, 4800
    s_nop 0
    buffer_load_dwordx4 v2, s[8:11], s24 offen offset:320 lds
    v_mfma_f32_16x16x32_bf16 v[220:223], v[44:47], v[176:179], v[220:223]
    v_mfma_f32_16x16x32_bf16 v[224:227], v[40:43], a[40:43], v[224:227]
    v_mfma_f32_16x16x32_bf16 v[228:231], v[40:43], a[112:115], v[228:231]
    v_mfma_f32_16x16x32_bf16 v[232:235], v[44:47], a[40:43], v[232:235]
    v_mfma_f32_16x16x32_bf16 v[236:239], v[44:47], a[112:115], v[236:239]
    s_waitcnt lgkmcnt(2)
    v_mfma_f32_16x16x32_bf16 v[208:211], v[48:51], v[108:111], v[208:211]
    ds_read_b128 v[40:43], v3 offset:13312
    ds_read_b128 v[44:47], v3 offset:31744
    v_mfma_f32_16x16x32_bf16 v[212:215], v[48:51], v[180:183], v[212:215]
    v_mfma_f32_16x16x32_bf16 v[216:219], v[52:55], v[108:111], v[216:219]
    s_add_u32 m0, s23, 5760
    s_nop 0
    buffer_load_dwordx4 v2, s[8:11], s24 offen offset:384 lds
    v_mfma_f32_16x16x32_bf16 v[220:223], v[52:55], v[180:183], v[220:223]
    v_mfma_f32_16x16x32_bf16 v[224:227], v[48:51], a[44:47], v[224:227]
    v_mfma_f32_16x16x32_bf16 v[228:231], v[48:51], a[116:119], v[228:231]
    v_mfma_f32_16x16x32_bf16 v[232:235], v[52:55], a[44:47], v[232:235]
    v_mfma_f32_16x16x32_bf16 v[236:239], v[52:55], a[116:119], v[236:239]
    s_waitcnt lgkmcnt(2)
    v_mfma_f32_16x16x32_bf16 v[208:211], v[32:35], v[112:115], v[208:211]
    ds_read_b128 v[48:51], v3 offset:14336
    ds_read_b128 v[52:55], v3 offset:32768
    v_mfma_f32_16x16x32_bf16 v[212:215], v[32:35], v[184:187], v[212:215]
    v_mfma_f32_16x16x32_bf16 v[216:219], v[36:39], v[112:115], v[216:219]
    s_add_u32 m0, s23, 6720
    s_nop 0
    buffer_load_dwordx4 v2, s[8:11], s24 offen offset:448 lds
    v_mfma_f32_16x16x32_bf16 v[220:223], v[36:39], v[184:187], v[220:223]
    v_mfma_f32_16x16x32_bf16 v[224:227], v[32:35], a[48:51], v[224:227]
    v_mfma_f32_16x16x32_bf16 v[228:231], v[32:35], a[120:123], v[228:231]
    v_mfma_f32_16x16x32_bf16 v[232:235], v[36:39], a[48:51], v[232:235]
    v_mfma_f32_16x16x32_bf16 v[236:239], v[36:39], a[120:123], v[236:239]
    s_waitcnt lgkmcnt(2)
    v_mfma_f32_16x16x32_bf16 v[208:211], v[40:43], v[116:119], v[208:211]
    ds_read_b128 v[32:35], v3 offset:15360
    ds_read_b128 v[36:39], v3 offset:33792
    v_mfma_f32_16x16x32_bf16 v[212:215], v[40:43], v[188:191], v[212:215]
    v_mfma_f32_16x16x32_bf16 v[216:219], v[44:47], v[116:119], v[216:219]
    s_add_u32 m0, s23, 7680
    s_nop 0
    buffer_load_dwordx4 v2, s[8:11], s24 offen offset:512 lds
    s_add_u32 s24, s24, s42
    v_mfma_f32_16x16x32_bf16 v[220:223], v[44:47], v[188:191], v[220:223]
    v_mfma_f32_16x16x32_bf16 v[224:227], v[40:43], a[52:55], v[224:227]
    v_mfma_f32_16x16x32_bf16 v[228:231], v[40:43], a[124:127], v[228:231]
    v_mfma_f32_16x16x32_bf16 v[232:235], v[44:47], a[52:55], v[232:235]
    v_mfma_f32_16x16x32_bf16 v[236:239], v[44:47], a[124:127], v[236:239]
    s_waitcnt lgkmcnt(2)
    v_mfma_f32_16x16x32_bf16 v[208:211], v[48:51], v[120:123], v[208:211]
    ds_read_b128 v[40:43], v3 offset:16384
    ds_read_b128 v[44:47], v3 offset:34816
    v_mfma_f32_16x16x32_bf16 v[212:215], v[48:51], v[192:195], v[212:215]
    v_mfma_f32_16x16x32_bf16 v[216:219], v[52:55], v[120:123], v[216:219]
    v_add_u32 v24, s27, v1
    v_mfma_f32_16x16x32_bf16 v[220:223], v[52:55], v[192:195], v[220:223]
    v_mfma_f32_16x16x32_bf16 v[224:227], v[48:51], a[56:59], v[224:227]
    v_mfma_f32_16x16x32_bf16 v[228:231], v[48:51], a[128:131], v[228:231]
    v_mfma_f32_16x16x32_bf16 v[232:235], v[52:55], a[56:59], v[232:235]
    v_mfma_f32_16x16x32_bf16 v[236:239], v[52:55], a[128:131], v[236:239]
    s_waitcnt lgkmcnt(2)
    v_mfma_f32_16x16x32_bf16 v[208:211], v[32:35], v[124:127], v[208:211]
    ds_read_b128 v[48:51], v3 offset:17408
    ds_read_b128 v[52:55], v3 offset:35840
    v_mfma_f32_16x16x32_bf16 v[212:215], v[32:35], v[196:199], v[212:215]
    v_mfma_f32_16x16x32_bf16 v[216:219], v[36:39], v[124:127], v[216:219]
    v_mfma_f32_16x16x32_bf16 v[220:223], v[36:39], v[196:199], v[220:223]
    v_mfma_f32_16x16x32_bf16 v[224:227], v[32:35], a[60:63], v[224:227]
    v_mfma_f32_16x16x32_bf16 v[228:231], v[32:35], a[132:135], v[228:231]
    s_waitcnt vmcnt(9)
    s_barrier
    v_mfma_f32_16x16x32_bf16 v[232:235], v[36:39], a[60:63], v[232:235]
    v_mfma_f32_16x16x32_bf16 v[236:239], v[36:39], a[132:135], v[236:239]
    s_waitcnt lgkmcnt(2)
    v_mfma_f32_16x16x32_bf16 v[208:211], v[40:43], v[128:131], v[208:211]
    ds_read_b128 v[32:35], v24 offset:0
    ds_read_b128 v[36:39], v24 offset:18432
    v_mfma_f32_16x16x32_bf16 v[212:215], v[40:43], v[200:203], v[212:215]
    v_mfma_f32_16x16x32_bf16 v[216:219], v[44:47], v[128:131], v[216:219]
    v_mov_b32 v4, s30
    s_mov_b64 exec, s[34:35]
    buffer_store_dword v4, off, s[4:7], s29 sc1
    s_mov_b64 exec, -1
    v_mfma_f32_16x16x32_bf16 v[220:223], v[44:47], v[200:203], v[220:223]
    v_mfma_f32_16x16x32_bf16 v[224:227], v[40:43], a[64:67], v[224:227]
    v_mfma_f32_16x16x32_bf16 v[228:231], v[40:43], a[136:139], v[228:231]
    v_mfma_f32_16x16x32_bf16 v[232:235], v[44:47], a[64:67], v[232:235]
    v_mfma_f32_16x16x32_bf16 v[236:239], v[44:47], a[136:139], v[236:239]
    s_waitcnt lgkmcnt(2)
    v_mfma_f32_16x16x32_bf16 v[208:211], v[48:51], v[132:135], v[208:211]
    ds_read_b128 v[40:43], v24 offset:1024
    ds_read_b128 v[44:47], v24 offset:19456
    v_mfma_f32_16x16x32_bf16 v[212:215], v[48:51], v[204:207], v[212:215]
    v_mfma_f32_16x16x32_bf16 v[216:219], v[52:55], v[132:135], v[216:219]
    v_mfma_f32_16x16x32_bf16 v[220:223], v[52:55], v[204:207], v[220:223]
    v_mfma_f32_16x16x32_bf16 v[224:227], v[48:51], a[68:71], v[224:227]
    v_mfma_f32_16x16x32_bf16 v[228:231], v[48:51], a[140:143], v[228:231]
    v_mfma_f32_16x16x32_bf16 v[232:235], v[52:55], a[68:71], v[232:235]
    v_mfma_f32_16x16x32_bf16 v[236:239], v[52:55], a[140:143], v[236:239]
    v_mov_b32 v3, v24
    s_mov_b32 s31, s26
    s_add_u32 s26, s26, s41
    s_add_u32 s30, s30, 1
    s_add_u32 s19, s19, s20
    s_cmp_lt_u32 s19, 64
    s_cbranch_scc1 qk_vloop
    v_cvt_pk_bf16_f32 v8, v208, v209
    v_cvt_pk_bf16_f32 v9, v210, v211
    v_cvt_pk_bf16_f32 v12, v212, v213
    v_cvt_pk_bf16_f32 v13, v214, v215
    v_cvt_pk_bf16_f32 v10, v216, v217
    v_cvt_pk_bf16_f32 v11, v218, v219
    v_cvt_pk_bf16_f32 v14, v220, v221
    v_cvt_pk_bf16_f32 v15, v222, v223
    v_cvt_pk_bf16_f32 v16, v224, v225
    v_cvt_pk_bf16_f32 v17, v226, v227
    v_cvt_pk_bf16_f32 v20, v228, v229
    v_cvt_pk_bf16_f32 v21, v230, v231
    v_cvt_pk_bf16_f32 v18, v232, v233
    v_cvt_pk_bf16_f32 v19, v234, v235
    v_cvt_pk_bf16_f32 v22, v236, v237
    v_cvt_pk_bf16_f32 v23, v238, v239
qk_done:
    s_mov_b32 s28, s31
    buffer_store_dwordx4 v[8:11], v7, s[4:7], s28 offen sc1
    s_add_u32 s28, s28, s40
    buffer_store_dwordx4 v[12:15], v7, s[4:7], s28 offen sc1
    s_add_u32 s28, s31, s43
    buffer_store_dwordx4 v[16:19], v7, s[4:7], s28 offen sc1
    s_add_u32 s28, s28, s40
    buffer_store_dwordx4 v[20:23], v7, s[4:7], s28 offen sc1
    s_waitcnt vmcnt(0) lgkmcnt(0)
    s_barrier
    s_add_u32 s22, s95, 63
    v_mov_b32 v4, s22
    s_mov_b64 exec, s[34:35]
    buffer_store_dword v4, off, s[4:7], s29 sc1
    s_mov_b64 exec, -1
    s_cmp_eq_u32 s16, 0
    s_cbranch_scc1 qk_nq
    s_add_u32 s29, s29, 4096
    v_mov_b32 v4, s22
    s_mov_b64 exec, s[34:35]
    buffer_store_dword v4, off, s[4:7], s29 sc1
    s_mov_b64 exec, -1
qk_nq:
    s_cmp_ge_u32 s36, 64
    s_cbranch_scc1 L_qkv_next
    s_lshr_b32 s33, s36, 5
    v_and_b32 v4, 63, v0
    v_lshrrev_b32 v5, 4, v4
    v_add_u32 v1, 0, v5
    v_mul_u32_u24 v6, 11, v1
    v_lshrrev_b32 v6, 5, v6
    v_add_u32 v1, v1, v6
    v_lshlrev_b32 v1, 7, v1
    v_and_b32 v6, 7, v4
    v_lshl_add_u32 v1, v6, 4, v1
    v_add_u32 v2, 4, v5
    v_mul_u32_u24 v6, 11, v2
    v_lshrrev_b32 v6, 5, v6
    v_add_u32 v2, v2, v6
    v_lshlrev_b32 v2, 7, v2
    v_and_b32 v6, 7, v4
    v_lshl_add_u32 v2, v6, 4, v2
    v_add_u32 v3, 8, v5
    v_mul_u32_u24 v6, 11, v3
    v_lshrrev_b32 v6, 5, v6
    v_add_u32 v3, v3, v6
    v_lshlrev_b32 v3, 7, v3
    v_and_b32 v6, 7, v4
    v_lshl_add_u32 v3, v6, 4, v3
    v_min_u32 v6, 23, v4
    v_lshlrev_b32 v6, 9, v6
    s_mov_b32 s19, s33
    s_mul_i32 s24, s19, 12288
    s_add_u32 s24, s24, 90177536
    s_lshl_b32 s26, s19, 5
    s_add_u32 s26, s26, s17
    s_lshl_b32 s26, s26, 12
    s_mov_b32 s21, 71303168
    s_cmp_eq_u32 s16, 2
    s_cselect_b32 s21, 80740352, s21
    s_add_u32 s26, s26, s21
    s_lshl_b32 s29, s17, 7
    s_lshl_b32 s21, s16, 1
    s_add_u32 s21, s21, s33
    s_lshl_b32 s21, s21, 2
    s_add_u32 s29, s29, s21
    s_add_u32 s29, s29, 125829240
mk_loop:
    s_cmp_lg_u32 s18, 0
    s_cbranch_scc1 mk_go
    s_mov_b32 s23, s24
    s_mov_b32 s21, 4194304
mk_wait:
    buffer_load_dword v4, v6, s[4:7], s23 offen offset:384 sc1
    s_sub_u32 s21, s21, 1
    s_cbranch_scc1 mk_go
    s_waitcnt vmcnt(0)
    v_cmp_ne_u32 vcc, s95, v4
    s_cbranch_vccz mk_go
    s_sleep 4
    s_branch mk_wait
mk_go:
    s_barrier
    s_mov_b32 s30, 4096
mk_again:
    v_mov_b32 v5, 0
    s_add_u32 s23, s24, 0
    buffer_load_dwordx4 v[24:27], v1, s[4:7], s23 offen offset:0 sc1
    buffer_load_dwordx4 v[28:31], v2, s[4:7], s23 offen offset:0 sc1
    buffer_load_dwordx4 v[32:35], v3, s[4:7], s23 offen offset:0 sc1
    buffer_load_dwordx4 v[36:39], v1, s[4:7], s23 offen offset:2048 sc1
    buffer_load_dwordx4 v[40:43], v2, s[4:7], s23 offen offset:2048 sc1
    buffer_load_dwordx4 v[44:47], v3, s[4:7], s23 offen offset:2048 sc1
    s_add_u32 s23, s24, 4096
    buffer_load_dwordx4 v[48:51], v1, s[4:7], s23 offen offset:0 sc1
    buffer_load_dwordx4 v[52:55], v2, s[4:7], s23 offen offset:0 sc1
    buffer_load_dwordx4 v[56:59], v3, s[4:7], s23 offen offset:0 sc1
    buffer_load_dwordx4 v[60:63], v1, s[4:7], s23 offen offset:2048 sc1
    buffer_load_dwordx4 v[208:211], v2, s[4:7], s23 offen offset:2048 sc1
    buffer_load_dwordx4 v[212:215], v3, s[4:7], s23 offen offset:2048 sc1
    s_add_u32 s23, s24, 8192
    buffer_load_dwordx4 v[216:219], v1, s[4:7], s23 offen offset:0 sc1
    buffer_load_dwordx4 v[220:223], v2, s[4:7], s23 offen offset:0 sc1
    buffer_load_dwordx4 v[224:227], v3, s[4:7], s23 offen offset:0 sc1
    buffer_load_dwordx4 v[228:231], v1, s[4:7], s23 offen offset:2048 sc1
    buffer_load_dwordx4 v[232:235], v2, s[4:7], s23 offen offset:2048 sc1
    buffer_load_dwordx4 v[236:239], v3, s[4:7], s23 offen offset:2048 sc1
    s_add_u32 s22, s19, s95
    s_add_u32 s22, s22, 1
    s_cmp_eq_u32 s16, 2
    s_cbranch_scc1 mk_v
    s_waitcnt vmcnt(17)
    v_mfma_f32_16x16x32_bf16 v[8:11], v[64:67], v[24:27], 0
    v_mfma_f32_16x16x32_bf16 v[12:15], v[136:139], v[24:27], 0
    v_max3_u32 v5, v5, v24, v25
    v_mfma_f32_16x16x32_bf16 v[16:19], a[0:3], v[24:27], 0
    v_mfma_f32_16x16x32_bf16 v[20:23], a[72:75], v[24:27], 0
    v_max3_u32 v5, v5, v26, v27
    s_waitcnt vmcnt(16)
    v_mfma_f32_16x16x32_bf16 v[8:11], v[68:71], v[28:31], v[8:11]
    v_mfma_f32_16x16x32_bf16 v[12:15], v[140:143], v[28:31], v[12:15]
    v_max3_u32 v5, v5, v28, v29
    v_mfma_f32_16x16x32_bf16 v[16:19], a[4:7], v[28:31], v[16:19]
    v_mfma_f32_16x16x32_bf16 v[20:23], a[76:79], v[28:31], v[20:23]
    v_max3_u32 v5, v5, v30, v31
    s_waitcnt vmcnt(15)
    v_mfma_f32_16x16x32_bf16 v[8:11], v[72:75], v[32:35], v[8:11]
    v_mfma_f32_16x16x32_bf16 v[12:15], v[144:147], v[32:35], v[12:15]
    v_max3_u32 v5, v5, v32, v33
    v_mfma_f32_16x16x32_bf16 v[16:19], a[8:11], v[32:35], v[16:19]
    v_mfma_f32_16x16x32_bf16 v[20:23], a[80:83], v[32:35], v[20:23]
    v_max3_u32 v5, v5, v34, v35
    s_waitcnt vmcnt(14)
    v_mfma_f32_16x16x32_bf16 v[8:11], v[76:79], v[36:39], v[8:11]
    v_mfma_f32_16x16x32_bf16 v[12:15], v[148:151], v[36:39], v[12:15]
    v_max3_u32 v5, v5, v36, v37
    v_mfma_f32_16x16x32_bf16 v[16:19], a[12:15], v[36:39], v[16:19]
    v_mfma_f32_16x16x32_bf16 v[20:23], a[84:87], v[36:39], v[20:23]
    v_max3_u32 v5, v5, v38, v39
    s_waitcnt vmcnt(13)
    v_mfma_f32_16x16x32_bf16 v[8:11], v[80:83], v[40:43], v[8:11]
    v_mfma_f32_16x16x32_bf16 v[12:15], v[152:155], v[40:43], v[12:15]
    v_max3_u32 v5, v5, v40, v41
    v_mfma_f32_16x16x32_bf16 v[16:19], a[16:19], v[40:43], v[16:19]
    v_mfma_f32_16x16x32_bf16 v[20:23], a[88:91], v[40:43], v[20:23]
    v_max3_u32 v5, v5, v42, v43
    s_waitcnt vmcnt(12)
    v_mfma_f32_16x16x32_bf16 v[8:11], v[84:87], v[44:47], v[8:11]
    v_mfma_f32_16x16x32_bf16 v[12:15], v[156:159], v[44:47], v[12:15]
    v_max3_u32 v5, v5, v44, v45
    v_mfma_f32_16x16x32_bf16 v[16:19], a[20:23], v[44:47], v[16:19]
    v_mfma_f32_16x16x32_bf16 v[20:23], a[92:95], v[44:47], v[20:23]
    v_max3_u32 v5, v5, v46, v47
    s_waitcnt vmcnt(11)
    v_mfma_f32_16x16x32_bf16 v[8:11], v[88:91], v[48:51], v[8:11]
    v_mfma_f32_16x16x32_bf16 v[12:15], v[160:163], v[48:51], v[12:15]
    v_max3_u32 v5, v5, v48, v49
    v_mfma_f32_16x16x32_bf16 v[16:19], a[24:27], v[48:51], v[16:19]
    v_mfma_f32_16x16x32_bf16 v[20:23], a[96:99], v[48:51], v[20:23]
    v_max3_u32 v5, v5, v50, v51
    s_waitcnt vmcnt(10)
    v_mfma_f32_16x16x32_bf16 v[8:11], v[92:95], v[52:55], v[8:11]
    v_mfma_f32_16x16x32_bf16 v[12:15], v[164:167], v[52:55], v[12:15]
    v_max3_u32 v5, v5, v52, v53
    v_mfma_f32_16x16x32_bf16 v[16:19], a[28:31], v[52:55], v[16:19]
    v_mfma_f32_16x16x32_bf16 v[20:23], a[100:103], v[52:55], v[20:23]
    v_max3_u32 v5, v5, v54, v55
    s_waitcnt vmcnt(9)
    v_mfma_f32_16x16x32_bf16 v[8:11], v[96:99], v[56:59], v[8:11]
    v_mfma_f32_16x16x32_bf16 v[12:15], v[168:171], v[56:59], v[12:15]
    v_max3_u32 v5, v5, v56, v57
    v_mfma_f32_16x16x32_bf16 v[16:19], a[32:35], v[56:59], v[16:19]
    v_mfma_f32_16x16x32_bf16 v[20:23], a[104:107], v[56:59], v[20:23]
    v_max3_u32 v5, v5, v58, v59
    s_waitcnt vmcnt(8)
    v_mfma_f32_16x16x32_bf16 v[8:11], v[100:103], v[60:63], v[8:11]
    v_mfma_f32_16x16x32_bf16 v[12:15], v[172:175], v[60:63], v[12:15]
    v_max3_u32 v5, v5, v60, v61
    v_mfma_f32_16x16x32_bf16 v[16:19], a[36:39], v[60:63], v[16:19]
    v_mfma_f32_16x16x32_bf16 v[20:23], a[108:111], v[60:63], v[20:23]
    v_max3_u32 v5, v5, v62, v63
    s_waitcnt vmcnt(7)
    v_mfma_f32_16x16x32_bf16 v[8:11], v[104:107], v[208:211], v[8:11]
    v_mfma_f32_16x16x32_bf16 v[12:15], v[176:179], v[208:211], v[12:15]
    v_max3_u32 v5, v5, v208, v209
    v_mfma_f32_16x16x32_bf16 v[16:19], a[40:43], v[208:211], v[16:19]
    v_mfma_f32_16x16x32_bf16 v[20:23], a[112:115], v[208:211], v[20:23]
    v_max3_u32 v5, v5, v210, v211
    s_waitcnt vmcnt(6)
    v_mfma_f32_16x16x32_bf16 v[8:11], v[108:111], v[212:215], v[8:11]
    v_mfma_f32_16x16x32_bf16 v[12:15], v[180:183], v[212:215], v[12:15]
    v_max3_u32 v5, v5, v212, v213
    v_mfma_f32_16x16x32_bf16 v[16:19], a[44:47], v[212:215], v[16:19]
    v_mfma_f32_16x16x32_bf16 v[20:23], a[116:119], v[212:215], v[20:23]
    v_max3_u32 v5, v5, v214, v215
    s_waitcnt vmcnt(5)
    v_mfma_f32_16x16x32_bf16 v[8:11], v[112:115], v[216:219], v[8:11]
    v_mfma_f32_16x16x32_bf16 v[12:15], v[184:187], v[216:219], v[12:15]
    v_max3_u32 v5, v5, v216, v217
    v_mfma_f32_16x16x32_bf16 v[16:19], a[48:51], v[216:219], v[16:19]
    v_mfma_f32_16x16x32_bf16 v[20:23], a[120:123], v[216:219], v[20:23]
    v_max3_u32 v5, v5, v218, v219
    s_waitcnt vmcnt(4)
    v_mfma_f32_16x16x32_bf16 v[8:11], v[116:119], v[220:223], v[8:11]
    v_mfma_f32_16x16x32_bf16 v[12:15], v[188:191], v[220:223], v[12:15]
    v_max3_u32 v5, v5, v220, v221
    v_mfma_f32_16x16x32_bf16 v[16:19], a[52:55], v[220:223], v[16:19]
    v_mfma_f32_16x16x32_bf16 v[20:23], a[124:127], v[220:223], v[20:23]
    v_max3_u32 v5, v5, v222, v223
    s_waitcnt vmcnt(3)
    v_mfma_f32_16x16x32_bf16 v[8:11], v[120:123], v[224:227], v[8:11]
    v_mfma_f32_16x16x32_bf16 v[12:15], v[192:195], v[224:227], v[12:15]
    v_max3_u32 v5, v5, v224, v225
    v_mfma_f32_16x16x32_bf16 v[16:19], a[56:59], v[224:227], v[16:19]
    v_mfma_f32_16x16x32_bf16 v[20:23], a[128:131], v[224:227], v[20:23]
    v_max3_u32 v5, v5, v226, v227
    s_waitcnt vmcnt(2)
    v_mfma_f32_16x16x32_bf16 v[8:11], v[124:127], v[228:231], v[8:11]
    v_mfma_f32_16x16x32_bf16 v[12:15], v[196:199], v[228:231], v[12:15]
    v_max3_u32 v5, v5, v228, v229
    v_mfma_f32_16x16x32_bf16 v[16:19], a[60:63], v[228:231], v[16:19]
    v_mfma_f32_16x16x32_bf16 v[20:23], a[132:135], v[228:231], v[20:23]
    v_max3_u32 v5, v5, v230, v231
    s_waitcnt vmcnt(1)
    v_mfma_f32_16x16x32_bf16 v[8:11], v[128:131], v[232:235], v[8:11]
    v_mfma_f32_16x16x32_bf16 v[12:15], v[200:203], v[232:235], v[12:15]
    v_max3_u32 v5, v5, v232, v233
    v_mfma_f32_16x16x32_bf16 v[16:19], a[64:67], v[232:235], v[16:19]
    v_mfma_f32_16x16x32_bf16 v[20:23], a[136:139], v[232:235], v[20:23]
    v_max3_u32 v5, v5, v234, v235
    s_waitcnt vmcnt(0)
    v_mfma_f32_16x16x32_bf16 v[8:11], v[132:135], v[236:239], v[8:11]
    v_mfma_f32_16x16x32_bf16 v[12:15], v[204:207], v[236:239], v[12:15]
    v_max3_u32 v5, v5, v236, v237
    v_mfma_f32_16x16x32_bf16 v[16:19], a[68:71], v[236:239], v[16:19]
    v_mfma_f32_16x16x32_bf16 v[20:23], a[140:143], v[236:239], v[20:23]
    v_max3_u32 v5, v5, v238, v239
    s_nop 5
    s_branch mk_st
mk_v:
    s_waitcnt vmcnt(17)
    v_mfma_f32_16x16x32_bf16 v[8:11], v[24:27], v[64:67], 0
    v_mfma_f32_16x16x32_bf16 v[12:15], v[24:27], v[136:139], 0
    v_max3_u32 v5, v5, v24, v25
    v_mfma_f32_16x16x32_bf16 v[16:19], v[24:27], a[0:3], 0
    v_mfma_f32_16x16x32_bf16 v[20:23], v[24:27], a[72:75], 0
    v_max3_u32 v5, v5, v26, v27
    s_waitcnt vmcnt(16)
    v_mfma_f32_16x16x32_bf16 v[8:11], v[28:31], v[68:71], v[8:11]
    v_mfma_f32_16x16x32_bf16 v[12:15], v[28:31], v[140:143], v[12:15]
    v_max3_u32 v5, v5, v28, v29
    v_mfma_f32_16x16x32_bf16 v[16:19], v[28:31], a[4:7], v[16:19]
    v_mfma_f32_16x16x32_bf16 v[20:23], v[28:31], a[76:79], v[20:23]
    v_max3_u32 v5, v5, v30, v31
    s_waitcnt vmcnt(15)
    v_mfma_f32_16x16x32_bf16 v[8:11], v[32:35], v[72:75], v[8:11]
    v_mfma_f32_16x16x32_bf16 v[12:15], v[32:35], v[144:147], v[12:15]
    v_max3_u32 v5, v5, v32, v33
    v_mfma_f32_16x16x32_bf16 v[16:19], v[32:35], a[8:11], v[16:19]
    v_mfma_f32_16x16x32_bf16 v[20:23], v[32:35], a[80:83], v[20:23]
    v_max3_u32 v5, v5, v34, v35
    s_waitcnt vmcnt(14)
    v_mfma_f32_16x16x32_bf16 v[8:11], v[36:39], v[76:79], v[8:11]
    v_mfma_f32_16x16x32_bf16 v[12:15], v[36:39], v[148:151], v[12:15]
    v_max3_u32 v5, v5, v36, v37
    v_mfma_f32_16x16x32_bf16 v[16:19], v[36:39], a[12:15], v[16:19]
    v_mfma_f32_16x16x32_bf16 v[20:23], v[36:39], a[84:87], v[20:23]
    v_max3_u32 v5, v5, v38, v39
    s_waitcnt vmcnt(13)
    v_mfma_f32_16x16x32_bf16 v[8:11], v[40:43], v[80:83], v[8:11]
    v_mfma_f32_16x16x32_bf16 v[12:15], v[40:43], v[152:155], v[12:15]
    v_max3_u32 v5, v5, v40, v41
    v_mfma_f32_16x16x32_bf16 v[16:19], v[40:43], a[16:19], v[16:19]
    v_mfma_f32_16x16x32_bf16 v[20:23], v[40:43], a[88:91], v[20:23]
    v_max3_u32 v5, v5, v42, v43
    s_waitcnt vmcnt(12)
    v_mfma_f32_16x16x32_bf16 v[8:11], v[44:47], v[84:87], v[8:11]
    v_mfma_f32_16x16x32_bf16 v[12:15], v[44:47], v[156:159], v[12:15]
    v_max3_u32 v5, v5, v44, v45
    v_mfma_f32_16x16x32_bf16 v[16:19], v[44:47], a[20:23], v[16:19]
    v_mfma_f32_16x16x32_bf16 v[20:23], v[44:47], a[92:95], v[20:23]
    v_max3_u32 v5, v5, v46, v47
    s_waitcnt vmcnt(11)
    v_mfma_f32_16x16x32_bf16 v[8:11], v[48:51], v[88:91], v[8:11]
    v_mfma_f32_16x16x32_bf16 v[12:15], v[48:51], v[160:163], v[12:15]
    v_max3_u32 v5, v5, v48, v49
    v_mfma_f32_16x16x32_bf16 v[16:19], v[48:51], a[24:27], v[16:19]
    v_mfma_f32_16x16x32_bf16 v[20:23], v[48:51], a[96:99], v[20:23]
    v_max3_u32 v5, v5, v50, v51
    s_waitcnt vmcnt(10)
    v_mfma_f32_16x16x32_bf16 v[8:11], v[52:55], v[92:95], v[8:11]
    v_mfma_f32_16x16x32_bf16 v[12:15], v[52:55], v[164:167], v[12:15]
    v_max3_u32 v5, v5, v52, v53
    v_mfma_f32_16x16x32_bf16 v[16:19], v[52:55], a[28:31], v[16:19]
    v_mfma_f32_16x16x32_bf16 v[20:23], v[52:55], a[100:103], v[20:23]
    v_max3_u32 v5, v5, v54, v55
    s_waitcnt vmcnt(9)
    v_mfma_f32_16x16x32_bf16 v[8:11], v[56:59], v[96:99], v[8:11]
    v_mfma_f32_16x16x32_bf16 v[12:15], v[56:59], v[168:171], v[12:15]
    v_max3_u32 v5, v5, v56, v57
    v_mfma_f32_16x16x32_bf16 v[16:19], v[56:59], a[32:35], v[16:19]
    v_mfma_f32_16x16x32_bf16 v[20:23], v[56:59], a[104:107], v[20:23]
    v_max3_u32 v5, v5, v58, v59
    s_waitcnt vmcnt(8)
    v_mfma_f32_16x16x32_bf16 v[8:11], v[60:63], v[100:103], v[8:11]
    v_mfma_f32_16x16x32_bf16 v[12:15], v[60:63], v[172:175], v[12:15]
    v_max3_u32 v5, v5, v60, v61
    v_mfma_f32_16x16x32_bf16 v[16:19], v[60:63], a[36:39], v[16:19]
    v_mfma_f32_16x16x32_bf16 v[20:23], v[60:63], a[108:111], v[20:23]
    v_max3_u32 v5, v5, v62, v63
    s_waitcnt vmcnt(7)
    v_mfma_f32_16x16x32_bf16 v[8:11], v[208:211], v[104:107], v[8:11]
    v_mfma_f32_16x16x32_bf16 v[12:15], v[208:211], v[176:179], v[12:15]
    v_max3_u32 v5, v5, v208, v209
    v_mfma_f32_16x16x32_bf16 v[16:19], v[208:211], a[40:43], v[16:19]
    v_mfma_f32_16x16x32_bf16 v[20:23], v[208:211], a[112:115], v[20:23]
    v_max3_u32 v5, v5, v210, v211
    s_waitcnt vmcnt(6)
    v_mfma_f32_16x16x32_bf16 v[8:11], v[212:215], v[108:111], v[8:11]
    v_mfma_f32_16x16x32_bf16 v[12:15], v[212:215], v[180:183], v[12:15]
    v_max3_u32 v5, v5, v212, v213
    v_mfma_f32_16x16x32_bf16 v[16:19], v[212:215], a[44:47], v[16:19]
    v_mfma_f32_16x16x32_bf16 v[20:23], v[212:215], a[116:119], v[20:23]
    v_max3_u32 v5, v5, v214, v215
    s_waitcnt vmcnt(5)
    v_mfma_f32_16x16x32_bf16 v[8:11], v[216:219], v[112:115], v[8:11]
    v_mfma_f32_16x16x32_bf16 v[12:15], v[216:219], v[184:187], v[12:15]
    v_max3_u32 v5, v5, v216, v217
    v_mfma_f32_16x16x32_bf16 v[16:19], v[216:219], a[48:51], v[16:19]
    v_mfma_f32_16x16x32_bf16 v[20:23], v[216:219], a[120:123], v[20:23]
    v_max3_u32 v5, v5, v218, v219
    s_waitcnt vmcnt(4)
    v_mfma_f32_16x16x32_bf16 v[8:11], v[220:223], v[116:119], v[8:11]
    v_mfma_f32_16x16x32_bf16 v[12:15], v[220:223], v[188:191], v[12:15]
    v_max3_u32 v5, v5, v220, v221
    v_mfma_f32_16x16x32_bf16 v[16:19], v[220:223], a[52:55], v[16:19]
    v_mfma_f32_16x16x32_bf16 v[20:23], v[220:223], a[124:127], v[20:23]
    v_max3_u32 v5, v5, v222, v223
    s_waitcnt vmcnt(3)
    v_mfma_f32_16x16x32_bf16 v[8:11], v[224:227], v[120:123], v[8:11]
    v_mfma_f32_16x16x32_bf16 v[12:15], v[224:227], v[192:195], v[12:15]
    v_max3_u32 v5, v5, v224, v225
    v_mfma_f32_16x16x32_bf16 v[16:19], v[224:227], a[56:59], v[16:19]
    v_mfma_f32_16x16x32_bf16 v[20:23], v[224:227], a[128:131], v[20:23]
    v_max3_u32 v5, v5, v226, v227
    s_waitcnt vmcnt(2)
    v_mfma_f32_16x16x32_bf16 v[8:11], v[228:231], v[124:127], v[8:11]
    v_mfma_f32_16x16x32_bf16 v[12:15], v[228:231], v[196:199], v[12:15]
    v_max3_u32 v5, v5, v228, v229
    v_mfma_f32_16x16x32_bf16 v[16:19], v[228:231], a[60:63], v[16:19]
    v_mfma_f32_16x16x32_bf16 v[20:23], v[228:231], a[132:135], v[20:23]
    v_max3_u32 v5, v5, v230, v231
    s_waitcnt vmcnt(1)
    v_mfma_f32_16x16x32_bf16 v[8:11], v[232:235], v[128:131], v[8:11]
    v_mfma_f32_16x16x32_bf16 v[12:15], v[232:235], v[200:203], v[12:15]
    v_max3_u32 v5, v5, v232, v233
    v_mfma_f32_16x16x32_bf16 v[16:19], v[232:235], a[64:67], v[16:19]
    v_mfma_f32_16x16x32_bf16 v[20:23], v[232:235], a[136:139], v[20:23]
    v_max3_u32 v5, v5, v234, v235
    s_waitcnt vmcnt(0)
    v_mfma_f32_16x16x32_bf16 v[8:11], v[236:239], v[132:135], v[8:11]
    v_mfma_f32_16x16x32_bf16 v[12:15], v[236:239], v[204:207], v[12:15]
    v_max3_u32 v5, v5, v236, v237
    v_mfma_f32_16x16x32_bf16 v[16:19], v[236:239], a[68:71], v[16:19]
    v_mfma_f32_16x16x32_bf16 v[20:23], v[236:239], a[140:143], v[20:23]
    v_max3_u32 v5, v5, v238, v239
    v_pk_mul_f32 v[8:9], v[8:9], 0.5 op_sel_hi:[1,0]
    v_pk_mul_f32 v[10:11], v[10:11], 0.5 op_sel_hi:[1,0]
    v_pk_mul_f32 v[12:13], v[12:13], 0.5 op_sel_hi:[1,0]
    v_pk_mul_f32 v[14:15], v[14:15], 0.5 op_sel_hi:[1,0]
    v_pk_mul_f32 v[16:17], v[16:17], 0.5 op_sel_hi:[1,0]
    v_pk_mul_f32 v[18:19], v[18:19], 0.5 op_sel_hi:[1,0]
    v_pk_mul_f32 v[20:21], v[20:21], 0.5 op_sel_hi:[1,0]
    v_pk_mul_f32 v[22:23], v[22:23], 0.5 op_sel_hi:[1,0]
    s_nop 1
mk_st:
    v_cmp_eq_u32 vcc, -1, v5
    s_sub_u32 s30, s30, 1
    s_cbranch_scc1 mk_ok
    s_cbranch_vccnz mk_again
mk_ok:
    s_add_u32 s24, s24, 24576
    v_cvt_pk_bf16_f32 v24, v8, v9
    v_cvt_pk_bf16_f32 v25, v10, v11
    v_cvt_pk_bf16_f32 v26, v12, v13
    v_cvt_pk_bf16_f32 v27, v14, v15
    v_cvt_pk_bf16_f32 v28, v16, v17
    v_cvt_pk_bf16_f32 v29, v18, v19
    v_cvt_pk_bf16_f32 v30, v20, v21
    v_cvt_pk_bf16_f32 v31, v22, v23
    s_add_u32 s21, s26, 4096
    buffer_store_dwordx4 v[24:27], v7, s[4:7], s26 offen sc1
    buffer_store_dwordx4 v[28:31], v7, s[4:7], s21 offen sc1
    s_waitcnt vmcnt(0)
    s_barrier
    v_mov_b32 v4, s22
    s_mov_b64 exec, s[34:35]
    buffer_store_dword v4, off, s[4:7], s29 sc1
    s_mov_b64 exec, -1
    s_add_u32 s19, s19, 2
    s_add_u32 s26, s26, 262144
    s_cmp_lt_u32 s19, 62
    s_cbranch_scc1 mk_loop
    s_endpgm
L_ssm_next:
    s_mov_b32 s37, 8
    v_mov_b32 v250, 1
    v_mov_b32 v251, 163832
    v_cmp_eq_u32 vcc, 0, v0
    s_nop 0
    s_and_saveexec_b64 s[38:39], vcc
    s_cbranch_execz tk8
    buffer_atomic_add v250, off, s[96:99], s37 sc0
    s_waitcnt vmcnt(0)
    ds_write_b32 v251, v250
    s_waitcnt lgkmcnt(0)
tk8:
    s_mov_b64 exec, -1
    s_barrier
    ds_read_b32 v252, v251
    s_waitcnt lgkmcnt(0)
    v_readfirstlane_b32 s20, v252
    s_barrier
    s_nop 3
    s_cmp_ge_u32 s20, 144
    s_cbranch_scc1 L_phase2
    s_lshl_b32 s20, s20, 2
    v_lshrrev_b32 v5, 6, v0
    s_nop 0
    v_readfirstlane_b32 s21, v5
    v_and_b32 v1, 63, v0
    v_and_b32 v2, 15, v1
    v_lshrrev_b32 v3, 4, v1
    v_lshlrev_b32 v4, 14, v5
    s_mov_b32 s8, s62
    s_mov_b32 s9, s63
    s_mov_b32 s10, 2359296
    s_mov_b32 s11, 0x20000
    s_mov_b32 s16, s76
    s_mov_b32 s17, s77
    s_mov_b32 s18, 4718592
    s_mov_b32 s19, 0x20000
    v_mul_u32_u24 v5, 9216, v0
    s_lshl_b32 s22, s20, 1
    s_add_u32 s23, s22, 0
    buffer_load_dwordx2 v[8:9], v5, s[8:11], s23 offen
    s_add_u32 s23, s22, 1152
    buffer_load_dwordx2 v[10:11], v5, s[8:11], s23 offen
    s_add_u32 s23, s22, 2304
    buffer_load_dwordx2 v[12:13], v5, s[8:11], s23 offen
    s_add_u32 s23, s22, 3456
    buffer_load_dwordx2 v[14:15], v5, s[8:11], s23 offen
    s_add_u32 s23, s22, 4608
    buffer_load_dwordx2 v[16:17], v5, s[8:11], s23 offen
    s_add_u32 s23, s22, 5760
    buffer_load_dwordx2 v[18:19], v5, s[8:11], s23 offen
    s_add_u32 s23, s22, 6912
    buffer_load_dwordx2 v[20:21], v5, s[8:11], s23 offen
    s_add_u32 s23, s22, 8064
    buffer_load_dwordx2 v[22:23], v5, s[8:11], s23 offen
    s_add_u32 s22, s20, s21
    s_lshl_b32 s23, s22, 8
    v_lshlrev_b32 v6, 3, v2
    v_lshl_add_u32 v6, v3, 1, v6
    s_mov_b32 s12, s64
    s_mov_b32 s13, s65
    s_mov_b32 s14, 147456
    s_mov_b32 s15, 0x20000
    buffer_load_ushort v24, v6, s[12:15], s23 offen offset:0
    buffer_load_ushort v28, v6, s[12:15], s23 offen offset:128
    s_mov_b32 s12, s66
    s_mov_b32 s13, s67
    s_mov_b32 s14, 147456
    s_mov_b32 s15, 0x20000
    buffer_load_ushort v25, v6, s[12:15], s23 offen offset:0
    buffer_load_ushort v29, v6, s[12:15], s23 offen offset:128
    s_mov_b32 s12, s68
    s_mov_b32 s13, s69
    s_mov_b32 s14, 147456
    s_mov_b32 s15, 0x20000
    buffer_load_ushort v26, v6, s[12:15], s23 offen offset:0
    buffer_load_ushort v30, v6, s[12:15], s23 offen offset:128
    s_mov_b32 s12, s70
    s_mov_b32 s13, s71
    s_mov_b32 s14, 147456
    s_mov_b32 s15, 0x20000
    buffer_load_ushort v27, v6, s[12:15], s23 offen offset:0
    buffer_load_ushort v31, v6, s[12:15], s23 offen offset:128
    s_mov_b32 s12, s72
    s_mov_b32 s13, s73
    s_mov_b32 s14, 1152
    s_mov_b32 s15, 0x20000
    s_lshl_b32 s23, s22, 1
    buffer_load_ushort v32, off, s[12:15], s23
    s_mov_b32 s26, 0x3fb8aa3b
    s_mov_b32 s27, 0x3e22f983
    v_mov_b32 v34, 0
    v_mov_b32 v35, 0
    v_lshl_add_u32 v6, v1, 3, v4
    ds_write_b64 v6, v[34:35] offset:0
    s_waitcnt vmcnt(0)
    v_mov_b32 v36, 0x05040100
    v_mov_b32 v37, 0x07060302
    v_lshlrev_b32 v6, 4, v0
    v_perm_b32 v40, v10, v8, v36
    v_perm_b32 v41, v14, v12, v36
    v_perm_b32 v42, v18, v16, v36
    v_perm_b32 v43, v22, v20, v36
    ds_write_b128 v6, v[40:43] offset:512
    s_nop 1
    v_perm_b32 v40, v10, v8, v37
    v_perm_b32 v41, v14, v12, v37
    v_perm_b32 v42, v18, v16, v37
    v_perm_b32 v43, v22, v20, v37
    ds_write_b128 v6, v[40:43] offset:16896
    s_nop 1
    v_perm_b32 v40, v11, v9, v36
    v_perm_b32 v41, v15, v13, v36
    v_perm_b32 v42, v19, v17, v36
    v_perm_b32 v43, v23, v21, v36
    ds_write_b128 v6, v[40:43] offset:33280
    s_nop 1
    v_perm_b32 v40, v11, v9, v37
    v_perm_b32 v41, v15, v13, v37
    v_perm_b32 v42, v19, v17, v37
    v_perm_b32 v43, v23, v21, v37
    ds_write_b128 v6, v[40:43] offset:49664
    s_nop 1
    v_lshlrev_b32 v32, 16, v32
    v_mul_f32 v32, s26, v32
    v_exp_f32 v32, v32
    s_nop 0
    v_cvt_pk_bf16_f32 v32, v32, v32
    v_and_b32 v32, 0xffff0000, v32
    v_add_f32 v33, v32, v32
    v_lshlrev_b32 v24, 16, v24
    v_mul_f32 v24, s26, v24
    v_exp_f32 v24, v24
    s_nop 0
    v_cvt_pk_bf16_f32 v24, v24, v24
    v_and_b32 v24, 0xffff0000, v24
    v_mul_f32 v24, v24, v32
    v_mul_f32 v24, s26, v24
    v_sub_f32 v24, 0, v24
    v_lshlrev_b32 v25, 16, v25
    v_mul_f32 v25, v25, v32
    v_mul_f32 v25, s27, v25
    v_lshlrev_b32 v26, 16, v26
    v_mul_f32 v26, v26, v33
    v_lshlrev_b32 v27, 16, v27
    v_mul_f32 v27, v27, v33
    v_lshlrev_b32 v28, 16, v28
    v_mul_f32 v28, s26, v28
    v_exp_f32 v28, v28
    s_nop 0
    v_cvt_pk_bf16_f32 v28, v28, v28
    v_and_b32 v28, 0xffff0000, v28
    v_mul_f32 v28, v28, v32
    v_mul_f32 v28, s26, v28
    v_sub_f32 v28, 0, v28
    v_lshlrev_b32 v29, 16, v29
    v_mul_f32 v29, v29, v32
    v_mul_f32 v29, s27, v29
    v_lshlrev_b32 v30, 16, v30
    v_mul_f32 v30, v30, v33
    v_lshlrev_b32 v31, 16, v31
    v_mul_f32 v31, v31, v33
    v_cvt_f32_u32 v47, v2
    v_mul_f32 v44, 0x41800000, v47
    v_and_b32 v5, 7, v2
    v_add_u32 v5, 8, v5
    v_cvt_f32_u32 v5, v5
    v_mul_f32 v45, 0x42000000, v5
    v_mul_f32 v6, 0x42800000, v5
    v_cmp_lt_u32 vcc, 7, v2
    s_nop 1
    v_cndmask_b32 v45, v45, v6, vcc
    v_add_f32 v5, 0x41000000, v47
    v_mul_f32 v46, 0x43000000, v5
    v_mov_b32 v48, 0
    v_mov_b32 v49, 0
    v_mov_b32 v50, 0
    v_mov_b32 v51, 0
    v_mov_b32 v52, 0
    v_mov_b32 v53, 0
    v_mov_b32 v54, 0
    v_mov_b32 v55, 0
    v_mov_b32 v56, 0
    v_mov_b32 v57, 0
    v_mov_b32 v58, 0
    v_mov_b32 v59, 0
    v_mov_b32 v60, 0
    v_mov_b32 v61, 0
    v_mov_b32 v62, 0
    v_mov_b32 v63, 0
    v_mov_b32_dpp v64, v24 row_newbcast:0 row_mask:0xf bank_mask:0xf
    v_mov_b32_dpp v65, v25 row_newbcast:0 row_mask:0xf bank_mask:0xf
    v_mov_b32_dpp v66, v26 row_newbcast:0 row_mask:0xf bank_mask:0xf
    v_mov_b32_dpp v67, v27 row_newbcast:0 row_mask:0xf bank_mask:0xf
    v_mul_f32 v82, v64, v47
    v_mul_f32 v83, v65, v47
    v_exp_f32 v82, v82
    v_fract_f32 v83, v83
    v_cos_f32 v74, v83
    v_sin_f32 v75, v83
    v_mul_f32 v74, v74, v82
    v_mul_f32 v75, v75, v82
    v_mul_f32 v84, v75, v75
    v_add_f32 v85, v74, v74
    v_fma_f32 v76, v74, v74, -v84
    v_mul_f32 v77, v85, v75
    v_mul_f32 v84, v77, v77
    v_add_f32 v85, v76, v76
    v_fma_f32 v78, v76, v76, -v84
    v_mul_f32 v79, v85, v77
    v_mul_f32 v84, v79, v79
    v_add_f32 v85, v78, v78
    v_fma_f32 v80, v78, v78, -v84
    v_mul_f32 v81, v85, v79
    v_mul_f32 v82, v64, v44
    v_mul_f32 v83, v65, v44
    v_exp_f32 v82, v82
    v_fract_f32 v83, v83
    v_cos_f32 v68, v83
    v_sin_f32 v69, v83
    v_mul_f32 v68, v68, v82
    v_mul_f32 v69, v69, v82
    v_mul_f32 v84, v67, v69
    v_mul_f32 v85, v67, v68
    v_fma_f32 v68, v66, v68, -v84
    v_fma_f32 v69, -v66, v69, -v85
    v_mul_f32 v82, v64, v45
    v_mul_f32 v83, v65, v45
    v_exp_f32 v82, v82
    v_fract_f32 v83, v83
    v_cos_f32 v70, v83
    v_sin_f32 v71, v83
    v_mul_f32 v70, v70, v82
    v_mul_f32 v71, v71, v82
    v_mul_f32 v84, v67, v71
    v_mul_f32 v85, v67, v70
    v_fma_f32 v70, v66, v70, -v84
    v_fma_f32 v71, -v66, v71, -v85
    v_mul_f32 v82, v64, v46
    v_mul_f32 v83, v65, v46
    v_exp_f32 v82, v82
    v_fract_f32 v83, v83
    v_cos_f32 v72, v83
    v_sin_f32 v73, v83
    v_mul_f32 v72, v72, v82
    v_mul_f32 v73, v73, v82
    v_mul_f32 v84, v67, v73
    v_mul_f32 v85, v67, v72
    v_fma_f32 v72, v66, v72, -v84
    v_fma_f32 v73, -v66, v73, -v85
    v_mfma_f32_16x16x4_f32 v[48:51], v68, v74, v[48:51]
    v_mfma_f32_16x16x4_f32 v[52:55], v70, v76, v[52:55]
    v_mfma_f32_16x16x4_f32 v[56:59], v70, v78, v[56:59]
    v_mfma_f32_16x16x4_f32 v[60:63], v72, v80, v[60:63]
    v_mfma_f32_16x16x4_f32 v[48:51], v69, v75, v[48:51]
    v_mfma_f32_16x16x4_f32 v[52:55], v71, v77, v[52:55]
    v_mfma_f32_16x16x4_f32 v[56:59], v71, v79, v[56:59]
    v_mfma_f32_16x16x4_f32 v[60:63], v73, v81, v[60:63]
    v_mov_b32_dpp v64, v24 row_newbcast:1 row_mask:0xf bank_mask:0xf
    v_mov_b32_dpp v65, v25 row_newbcast:1 row_mask:0xf bank_mask:0xf
    v_mov_b32_dpp v66, v26 row_newbcast:1 row_mask:0xf bank_mask:0xf
    v_mov_b32_dpp v67, v27 row_newbcast:1 row_mask:0xf bank_mask:0xf
    v_mul_f32 v82, v64, v47
    v_mul_f32 v83, v65, v47
    v_exp_f32 v82, v82
    v_fract_f32 v83, v83
    v_cos_f32 v74, v83
    v_sin_f32 v75, v83
    v_mul_f32 v74, v74, v82
    v_mul_f32 v75, v75, v82
    v_mul_f32 v84, v75, v75
    v_add_f32 v85, v74, v74
    v_fma_f32 v76, v74, v74, -v84
    v_mul_f32 v77, v85, v75
    v_mul_f32 v84, v77, v77
    v_add_f32 v85, v76, v76
    v_fma_f32 v78, v76, v76, -v84
    v_mul_f32 v79, v85, v77
    v_mul_f32 v84, v79, v79
    v_add_f32 v85, v78, v78
    v_fma_f32 v80, v78, v78, -v84
    v_mul_f32 v81, v85, v79
    v_mul_f32 v82, v64, v44
    v_mul_f32 v83, v65, v44
    v_exp_f32 v82, v82
    v_fract_f32 v83, v83
    v_cos_f32 v68, v83
    v_sin_f32 v69, v83
    v_mul_f32 v68, v68, v82
    v_mul_f32 v69, v69, v82
    v_mul_f32 v84, v67, v69
    v_mul_f32 v85, v67, v68
    v_fma_f32 v68, v66, v68, -v84
    v_fma_f32 v69, -v66, v69, -v85
    v_mul_f32 v82, v64, v45
    v_mul_f32 v83, v65, v45
    v_exp_f32 v82, v82
    v_fract_f32 v83, v83
    v_cos_f32 v70, v83
    v_sin_f32 v71, v83
    v_mul_f32 v70, v70, v82
    v_mul_f32 v71, v71, v82
    v_mul_f32 v84, v67, v71
    v_mul_f32 v85, v67, v70
    v_fma_f32 v70, v66, v70, -v84
    v_fma_f32 v71, -v66, v71, -v85
    v_mul_f32 v82, v64, v46
    v_mul_f32 v83, v65, v46
    v_exp_f32 v82, v82
    v_fract_f32 v83, v83
    v_cos_f32 v72, v83
    v_sin_f32 v73, v83
    v_mul_f32 v72, v72, v82
    v_mul_f32 v73, v73, v82
    v_mul_f32 v84, v67, v73
    v_mul_f32 v85, v67, v72
    v_fma_f32 v72, v66, v72, -v84
    v_fma_f32 v73, -v66, v73, -v85
    v_mfma_f32_16x16x4_f32 v[48:51], v68, v74, v[48:51]
    v_mfma_f32_16x16x4_f32 v[52:55], v70, v76, v[52:55]
    v_mfma_f32_16x16x4_f32 v[56:59], v70, v78, v[56:59]
    v_mfma_f32_16x16x4_f32 v[60:63], v72, v80, v[60:63]
    v_mfma_f32_16x16x4_f32 v[48:51], v69, v75, v[48:51]
    v_mfma_f32_16x16x4_f32 v[52:55], v71, v77, v[52:55]
    v_mfma_f32_16x16x4_f32 v[56:59], v71, v79, v[56:59]
    v_mfma_f32_16x16x4_f32 v[60:63], v73, v81, v[60:63]
    v_mov_b32_dpp v64, v24 row_newbcast:2 row_mask:0xf bank_mask:0xf
    v_mov_b32_dpp v65, v25 row_newbcast:2 row_mask:0xf bank_mask:0xf
    v_mov_b32_dpp v66, v26 row_newbcast:2 row_mask:0xf bank_mask:0xf
    v_mov_b32_dpp v67, v27 row_newbcast:2 row_mask:0xf bank_mask:0xf
    v_mul_f32 v82, v64, v47
    v_mul_f32 v83, v65, v47
    v_exp_f32 v82, v82
    v_fract_f32 v83, v83
    v_cos_f32 v74, v83
    v_sin_f32 v75, v83
    v_mul_f32 v74, v74, v82
    v_mul_f32 v75, v75, v82
    v_mul_f32 v84, v75, v75
    v_add_f32 v85, v74, v74
    v_fma_f32 v76, v74, v74, -v84
    v_mul_f32 v77, v85, v75
    v_mul_f32 v84, v77, v77
    v_add_f32 v85, v76, v76
    v_fma_f32 v78, v76, v76, -v84
    v_mul_f32 v79, v85, v77
    v_mul_f32 v84, v79, v79
    v_add_f32 v85, v78, v78
    v_fma_f32 v80, v78, v78, -v84
    v_mul_f32 v81, v85, v79
    v_mul_f32 v82, v64, v44
    v_mul_f32 v83, v65, v44
    v_exp_f32 v82, v82
    v_fract_f32 v83, v83
    v_cos_f32 v68, v83
    v_sin_f32 v69, v83
    v_mul_f32 v68, v68, v82
    v_mul_f32 v69, v69, v82
    v_mul_f32 v84, v67, v69
    v_mul_f32 v85, v67, v68
    v_fma_f32 v68, v66, v68, -v84
    v_fma_f32 v69, -v66, v69, -v85
    v_mul_f32 v82, v64, v45
    v_mul_f32 v83, v65, v45
    v_exp_f32 v82, v82
    v_fract_f32 v83, v83
    v_cos_f32 v70, v83
    v_sin_f32 v71, v83
    v_mul_f32 v70, v70, v82
    v_mul_f32 v71, v71, v82
    v_mul_f32 v84, v67, v71
    v_mul_f32 v85, v67, v70
    v_fma_f32 v70, v66, v70, -v84
    v_fma_f32 v71, -v66, v71, -v85
    v_mul_f32 v82, v64, v46
    v_mul_f32 v83, v65, v46
    v_exp_f32 v82, v82
    v_fract_f32 v83, v83
    v_cos_f32 v72, v83
    v_sin_f32 v73, v83
    v_mul_f32 v72, v72, v82
    v_mul_f32 v73, v73, v82
    v_mul_f32 v84, v67, v73
    v_mul_f32 v85, v67, v72
    v_fma_f32 v72, v66, v72, -v84
    v_fma_f32 v73, -v66, v73, -v85
    v_mfma_f32_16x16x4_f32 v[48:51], v68, v74, v[48:51]
    v_mfma_f32_16x16x4_f32 v[52:55], v70, v76, v[52:55]
    v_mfma_f32_16x16x4_f32 v[56:59], v70, v78, v[56:59]
    v_mfma_f32_16x16x4_f32 v[60:63], v72, v80, v[60:63]
    v_mfma_f32_16x16x4_f32 v[48:51], v69, v75, v[48:51]
    v_mfma_f32_16x16x4_f32 v[52:55], v71, v77, v[52:55]
    v_mfma_f32_16x16x4_f32 v[56:59], v71, v79, v[56:59]
    v_mfma_f32_16x16x4_f32 v[60:63], v73, v81, v[60:63]
    v_mov_b32_dpp v64, v24 row_newbcast:3 row_mask:0xf bank_mask:0xf
    v_mov_b32_dpp v65, v25 row_newbcast:3 row_mask:0xf bank_mask:0xf
    v_mov_b32_dpp v66, v26 row_newbcast:3 row_mask:0xf bank_mask:0xf
    v_mov_b32_dpp v67, v27 row_newbcast:3 row_mask:0xf bank_mask:0xf
    v_mul_f32 v82, v64, v47
    v_mul_f32 v83, v65, v47
    v_exp_f32 v82, v82
    v_fract_f32 v83, v83
    v_cos_f32 v74, v83
    v_sin_f32 v75, v83
    v_mul_f32 v74, v74, v82
    v_mul_f32 v75, v75, v82
    v_mul_f32 v84, v75, v75
    v_add_f32 v85, v74, v74
    v_fma_f32 v76, v74, v74, -v84
    v_mul_f32 v77, v85, v75
    v_mul_f32 v84, v77, v77
    v_add_f32 v85, v76, v76
    v_fma_f32 v78, v76, v76, -v84
    v_mul_f32 v79, v85, v77
    v_mul_f32 v84, v79, v79
    v_add_f32 v85, v78, v78
    v_fma_f32 v80, v78, v78, -v84
    v_mul_f32 v81, v85, v79
    v_mul_f32 v82, v64, v44
    v_mul_f32 v83, v65, v44
    v_exp_f32 v82, v82
    v_fract_f32 v83, v83
    v_cos_f32 v68, v83
    v_sin_f32 v69, v83
    v_mul_f32 v68, v68, v82
    v_mul_f32 v69, v69, v82
    v_mul_f32 v84, v67, v69
    v_mul_f32 v85, v67, v68
    v_fma_f32 v68, v66, v68, -v84
    v_fma_f32 v69, -v66, v69, -v85
    v_mul_f32 v82, v64, v45
    v_mul_f32 v83, v65, v45
    v_exp_f32 v82, v82
    v_fract_f32 v83, v83
    v_cos_f32 v70, v83
    v_sin_f32 v71, v83
    v_mul_f32 v70, v70, v82
    v_mul_f32 v71, v71, v82
    v_mul_f32 v84, v67, v71
    v_mul_f32 v85, v67, v70
    v_fma_f32 v70, v66, v70, -v84
    v_fma_f32 v71, -v66, v71, -v85
    v_mul_f32 v82, v64, v46
    v_mul_f32 v83, v65, v46
    v_exp_f32 v82, v82
    v_fract_f32 v83, v83
    v_cos_f32 v72, v83
    v_sin_f32 v73, v83
    v_mul_f32 v72, v72, v82
    v_mul_f32 v73, v73, v82
    v_mul_f32 v84, v67, v73
    v_mul_f32 v85, v67, v72
    v_fma_f32 v72, v66, v72, -v84
    v_fma_f32 v73, -v66, v73, -v85
    v_mfma_f32_16x16x4_f32 v[48:51], v68, v74, v[48:51]
    v_mfma_f32_16x16x4_f32 v[52:55], v70, v76, v[52:55]
    v_mfma_f32_16x16x4_f32 v[56:59], v70, v78, v[56:59]
    v_mfma_f32_16x16x4_f32 v[60:63], v72, v80, v[60:63]
    v_mfma_f32_16x16x4_f32 v[48:51], v69, v75, v[48:51]
    v_mfma_f32_16x16x4_f32 v[52:55], v71, v77, v[52:55]
    v_mfma_f32_16x16x4_f32 v[56:59], v71, v79, v[56:59]
    v_mfma_f32_16x16x4_f32 v[60:63], v73, v81, v[60:63]
    v_mov_b32_dpp v64, v24 row_newbcast:4 row_mask:0xf bank_mask:0xf
    v_mov_b32_dpp v65, v25 row_newbcast:4 row_mask:0xf bank_mask:0xf
    v_mov_b32_dpp v66, v26 row_newbcast:4 row_mask:0xf bank_mask:0xf
    v_mov_b32_dpp v67, v27 row_newbcast:4 row_mask:0xf bank_mask:0xf
    v_mul_f32 v82, v64, v47
    v_mul_f32 v83, v65, v47
    v_exp_f32 v82, v82
    v_fract_f32 v83, v83
    v_cos_f32 v74, v83
    v_sin_f32 v75, v83
    v_mul_f32 v74, v74, v82
    v_mul_f32 v75, v75, v82
    v_mul_f32 v84, v75, v75
    v_add_f32 v85, v74, v74
    v_fma_f32 v76, v74, v74, -v84
    v_mul_f32 v77, v85, v75
    v_mul_f32 v84, v77, v77
    v_add_f32 v85, v76, v76
    v_fma_f32 v78, v76, v76, -v84
    v_mul_f32 v79, v85, v77
    v_mul_f32 v84, v79, v79
    v_add_f32 v85, v78, v78
    v_fma_f32 v80, v78, v78, -v84
    v_mul_f32 v81, v85, v79
    v_mul_f32 v82, v64, v44
    v_mul_f32 v83, v65, v44
    v_exp_f32 v82, v82
    v_fract_f32 v83, v83
    v_cos_f32 v68, v83
    v_sin_f32 v69, v83
    v_mul_f32 v68, v68, v82
    v_mul_f32 v69, v69, v82
    v_mul_f32 v84, v67, v69
    v_mul_f32 v85, v67, v68
    v_fma_f32 v68, v66, v68, -v84
    v_fma_f32 v69, -v66, v69, -v85
    v_mul_f32 v82, v64, v45
    v_mul_f32 v83, v65, v45
    v_exp_f32 v82, v82
    v_fract_f32 v83, v83
    v_cos_f32 v70, v83
    v_sin_f32 v71, v83
    v_mul_f32 v70, v70, v82
    v_mul_f32 v71, v71, v82
    v_mul_f32 v84, v67, v71
    v_mul_f32 v85, v67, v70
    v_fma_f32 v70, v66, v70, -v84
    v_fma_f32 v71, -v66, v71, -v85
    v_mul_f32 v82, v64, v46
    v_mul_f32 v83, v65, v46
    v_exp_f32 v82, v82
    v_fract_f32 v83, v83
    v_cos_f32 v72, v83
    v_sin_f32 v73, v83
    v_mul_f32 v72, v72, v82
    v_mul_f32 v73, v73, v82
    v_mul_f32 v84, v67, v73
    v_mul_f32 v85, v67, v72
    v_fma_f32 v72, v66, v72, -v84
    v_fma_f32 v73, -v66, v73, -v85
    v_mfma_f32_16x16x4_f32 v[48:51], v68, v74, v[48:51]
    v_mfma_f32_16x16x4_f32 v[52:55], v70, v76, v[52:55]
    v_mfma_f32_16x16x4_f32 v[56:59], v70, v78, v[56:59]
    v_mfma_f32_16x16x4_f32 v[60:63], v72, v80, v[60:63]
    v_mfma_f32_16x16x4_f32 v[48:51], v69, v75, v[48:51]
    v_mfma_f32_16x16x4_f32 v[52:55], v71, v77, v[52:55]
    v_mfma_f32_16x16x4_f32 v[56:59], v71, v79, v[56:59]
    v_mfma_f32_16x16x4_f32 v[60:63], v73, v81, v[60:63]
    v_mov_b32_dpp v64, v24 row_newbcast:5 row_mask:0xf bank_mask:0xf
    v_mov_b32_dpp v65, v25 row_newbcast:5 row_mask:0xf bank_mask:0xf
    v_mov_b32_dpp v66, v26 row_newbcast:5 row_mask:0xf bank_mask:0xf
    v_mov_b32_dpp v67, v27 row_newbcast:5 row_mask:0xf bank_mask:0xf
    v_mul_f32 v82, v64, v47
    v_mul_f32 v83, v65, v47
    v_exp_f32 v82, v82
    v_fract_f32 v83, v83
    v_cos_f32 v74, v83
    v_sin_f32 v75, v83
    v_mul_f32 v74, v74, v82
    v_mul_f32 v75, v75, v82
    v_mul_f32 v84, v75, v75
    v_add_f32 v85, v74, v74
    v_fma_f32 v76, v74, v74, -v84
    v_mul_f32 v77, v85, v75
    v_mul_f32 v84, v77, v77
    v_add_f32 v85, v76, v76
    v_fma_f32 v78, v76, v76, -v84
    v_mul_f32 v79, v85, v77
    v_mul_f32 v84, v79, v79
    v_add_f32 v85, v78, v78
    v_fma_f32 v80, v78, v78, -v84
    v_mul_f32 v81, v85, v79
    v_mul_f32 v82, v64, v44
    v_mul_f32 v83, v65, v44
    v_exp_f32 v82, v82
    v_fract_f32 v83, v83
    v_cos_f32 v68, v83
    v_sin_f32 v69, v83
    v_mul_f32 v68, v68, v82
    v_mul_f32 v69, v69, v82
    v_mul_f32 v84, v67, v69
    v_mul_f32 v85, v67, v68
    v_fma_f32 v68, v66, v68, -v84
    v_fma_f32 v69, -v66, v69, -v85
    v_mul_f32 v82, v64, v45
    v_mul_f32 v83, v65, v45
    v_exp_f32 v82, v82
    v_fract_f32 v83, v83
    v_cos_f32 v70, v83
    v_sin_f32 v71, v83
    v_mul_f32 v70, v70, v82
    v_mul_f32 v71, v71, v82
    v_mul_f32 v84, v67, v71
    v_mul_f32 v85, v67, v70
    v_fma_f32 v70, v66, v70, -v84
    v_fma_f32 v71, -v66, v71, -v85
    v_mul_f32 v82, v64, v46
    v_mul_f32 v83, v65, v46
    v_exp_f32 v82, v82
    v_fract_f32 v83, v83
    v_cos_f32 v72, v83
    v_sin_f32 v73, v83
    v_mul_f32 v72, v72, v82
    v_mul_f32 v73, v73, v82
    v_mul_f32 v84, v67, v73
    v_mul_f32 v85, v67, v72
    v_fma_f32 v72, v66, v72, -v84
    v_fma_f32 v73, -v66, v73, -v85
    v_mfma_f32_16x16x4_f32 v[48:51], v68, v74, v[48:51]
    v_mfma_f32_16x16x4_f32 v[52:55], v70, v76, v[52:55]
    v_mfma_f32_16x16x4_f32 v[56:59], v70, v78, v[56:59]
    v_mfma_f32_16x16x4_f32 v[60:63], v72, v80, v[60:63]
    v_mfma_f32_16x16x4_f32 v[48:51], v69, v75, v[48:51]
    v_mfma_f32_16x16x4_f32 v[52:55], v71, v77, v[52:55]
    v_mfma_f32_16x16x4_f32 v[56:59], v71, v79, v[56:59]
    v_mfma_f32_16x16x4_f32 v[60:63], v73, v81, v[60:63]
    v_mov_b32_dpp v64, v24 row_newbcast:6 row_mask:0xf bank_mask:0xf
    v_mov_b32_dpp v65, v25 row_newbcast:6 row_mask:0xf bank_mask:0xf
    v_mov_b32_dpp v66, v26 row_newbcast:6 row_mask:0xf bank_mask:0xf
    v_mov_b32_dpp v67, v27 row_newbcast:6 row_mask:0xf bank_mask:0xf
    v_mul_f32 v82, v64, v47
    v_mul_f32 v83, v65, v47
    v_exp_f32 v82, v82
    v_fract_f32 v83, v83
    v_cos_f32 v74, v83
    v_sin_f32 v75, v83
    v_mul_f32 v74, v74, v82
    v_mul_f32 v75, v75, v82
    v_mul_f32 v84, v75, v75
    v_add_f32 v85, v74, v74
    v_fma_f32 v76, v74, v74, -v84
    v_mul_f32 v77, v85, v75
    v_mul_f32 v84, v77, v77
    v_add_f32 v85, v76, v76
    v_fma_f32 v78, v76, v76, -v84
    v_mul_f32 v79, v85, v77
    v_mul_f32 v84, v79, v79
    v_add_f32 v85, v78, v78
    v_fma_f32 v80, v78, v78, -v84
    v_mul_f32 v81, v85, v79
    v_mul_f32 v82, v64, v44
    v_mul_f32 v83, v65, v44
    v_exp_f32 v82, v82
    v_fract_f32 v83, v83
    v_cos_f32 v68, v83
    v_sin_f32 v69, v83
    v_mul_f32 v68, v68, v82
    v_mul_f32 v69, v69, v82
    v_mul_f32 v84, v67, v69
    v_mul_f32 v85, v67, v68
    v_fma_f32 v68, v66, v68, -v84
    v_fma_f32 v69, -v66, v69, -v85
    v_mul_f32 v82, v64, v45
    v_mul_f32 v83, v65, v45
    v_exp_f32 v82, v82
    v_fract_f32 v83, v83
    v_cos_f32 v70, v83
    v_sin_f32 v71, v83
    v_mul_f32 v70, v70, v82
    v_mul_f32 v71, v71, v82
    v_mul_f32 v84, v67, v71
    v_mul_f32 v85, v67, v70
    v_fma_f32 v70, v66, v70, -v84
    v_fma_f32 v71, -v66, v71, -v85
    v_mul_f32 v82, v64, v46
    v_mul_f32 v83, v65, v46
    v_exp_f32 v82, v82
    v_fract_f32 v83, v83
    v_cos_f32 v72, v83
    v_sin_f32 v73, v83
    v_mul_f32 v72, v72, v82
    v_mul_f32 v73, v73, v82
    v_mul_f32 v84, v67, v73
    v_mul_f32 v85, v67, v72
    v_fma_f32 v72, v66, v72, -v84
    v_fma_f32 v73, -v66, v73, -v85
    v_mfma_f32_16x16x4_f32 v[48:51], v68, v74, v[48:51]
    v_mfma_f32_16x16x4_f32 v[52:55], v70, v76, v[52:55]
    v_mfma_f32_16x16x4_f32 v[56:59], v70, v78, v[56:59]
    v_mfma_f32_16x16x4_f32 v[60:63], v72, v80, v[60:63]
    v_mfma_f32_16x16x4_f32 v[48:51], v69, v75, v[48:51]
    v_mfma_f32_16x16x4_f32 v[52:55], v71, v77, v[52:55]
    v_mfma_f32_16x16x4_f32 v[56:59], v71, v79, v[56:59]
    v_mfma_f32_16x16x4_f32 v[60:63], v73, v81, v[60:63]
    v_mov_b32_dpp v64, v24 row_newbcast:7 row_mask:0xf bank_mask:0xf
    v_mov_b32_dpp v65, v25 row_newbcast:7 row_mask:0xf bank_mask:0xf
    v_mov_b32_dpp v66, v26 row_newbcast:7 row_mask:0xf bank_mask:0xf
    v_mov_b32_dpp v67, v27 row_newbcast:7 row_mask:0xf bank_mask:0xf
    v_mul_f32 v82, v64, v47
    v_mul_f32 v83, v65, v47
    v_exp_f32 v82, v82
    v_fract_f32 v83, v83
    v_cos_f32 v74, v83
    v_sin_f32 v75, v83
    v_mul_f32 v74, v74, v82
    v_mul_f32 v75, v75, v82
    v_mul_f32 v84, v75, v75
    v_add_f32 v85, v74, v74
    v_fma_f32 v76, v74, v74, -v84
    v_mul_f32 v77, v85, v75
    v_mul_f32 v84, v77, v77
    v_add_f32 v85, v76, v76
    v_fma_f32 v78, v76, v76, -v84
    v_mul_f32 v79, v85, v77
    v_mul_f32 v84, v79, v79
    v_add_f32 v85, v78, v78
    v_fma_f32 v80, v78, v78, -v84
    v_mul_f32 v81, v85, v79
    v_mul_f32 v82, v64, v44
    v_mul_f32 v83, v65, v44
    v_exp_f32 v82, v82
    v_fract_f32 v83, v83
    v_cos_f32 v68, v83
    v_sin_f32 v69, v83
    v_mul_f32 v68, v68, v82
    v_mul_f32 v69, v69, v82
    v_mul_f32 v84, v67, v69
    v_mul_f32 v85, v67, v68
    v_fma_f32 v68, v66, v68, -v84
    v_fma_f32 v69, -v66, v69, -v85
    v_mul_f32 v82, v64, v45
    v_mul_f32 v83, v65, v45
    v_exp_f32 v82, v82
    v_fract_f32 v83, v83
    v_cos_f32 v70, v83
    v_sin_f32 v71, v83
    v_mul_f32 v70, v70, v82
    v_mul_f32 v71, v71, v82
    v_mul_f32 v84, v67, v71
    v_mul_f32 v85, v67, v70
    v_fma_f32 v70, v66, v70, -v84
    v_fma_f32 v71, -v66, v71, -v85
    v_mul_f32 v82, v64, v46
    v_mul_f32 v83, v65, v46
    v_exp_f32 v82, v82
    v_fract_f32 v83, v83
    v_cos_f32 v72, v83
    v_sin_f32 v73, v83
    v_mul_f32 v72, v72, v82
    v_mul_f32 v73, v73, v82
    v_mul_f32 v84, v67, v73
    v_mul_f32 v85, v67, v72
    v_fma_f32 v72, v66, v72, -v84
    v_fma_f32 v73, -v66, v73, -v85
    v_mfma_f32_16x16x4_f32 v[48:51], v68, v74, v[48:51]
    v_mfma_f32_16x16x4_f32 v[52:55], v70, v76, v[52:55]
    v_mfma_f32_16x16x4_f32 v[56:59], v70, v78, v[56:59]
    v_mfma_f32_16x16x4_f32 v[60:63], v72, v80, v[60:63]
    v_mfma_f32_16x16x4_f32 v[48:51], v69, v75, v[48:51]
    v_mfma_f32_16x16x4_f32 v[52:55], v71, v77, v[52:55]
    v_mfma_f32_16x16x4_f32 v[56:59], v71, v79, v[56:59]
    v_mfma_f32_16x16x4_f32 v[60:63], v73, v81, v[60:63]
    v_mov_b32_dpp v64, v24 row_newbcast:8 row_mask:0xf bank_mask:0xf
    v_mov_b32_dpp v65, v25 row_newbcast:8 row_mask:0xf bank_mask:0xf
    v_mov_b32_dpp v66, v26 row_newbcast:8 row_mask:0xf bank_mask:0xf
    v_mov_b32_dpp v67, v27 row_newbcast:8 row_mask:0xf bank_mask:0xf
    v_mul_f32 v82, v64, v47
    v_mul_f32 v83, v65, v47
    v_exp_f32 v82, v82
    v_fract_f32 v83, v83
    v_cos_f32 v74, v83
    v_sin_f32 v75, v83
    v_mul_f32 v74, v74, v82
    v_mul_f32 v75, v75, v82
    v_mul_f32 v84, v75, v75
    v_add_f32 v85, v74, v74
    v_fma_f32 v76, v74, v74, -v84
    v_mul_f32 v77, v85, v75
    v_mul_f32 v84, v77, v77
    v_add_f32 v85, v76, v76
    v_fma_f32 v78, v76, v76, -v84
    v_mul_f32 v79, v85, v77
    v_mul_f32 v84, v79, v79
    v_add_f32 v85, v78, v78
    v_fma_f32 v80, v78, v78, -v84
    v_mul_f32 v81, v85, v79
    v_mul_f32 v82, v64, v44
    v_mul_f32 v83, v65, v44
    v_exp_f32 v82, v82
    v_fract_f32 v83, v83
    v_cos_f32 v68, v83
    v_sin_f32 v69, v83
    v_mul_f32 v68, v68, v82
    v_mul_f32 v69, v69, v82
    v_mul_f32 v84, v67, v69
    v_mul_f32 v85, v67, v68
    v_fma_f32 v68, v66, v68, -v84
    v_fma_f32 v69, -v66, v69, -v85
    v_mul_f32 v82, v64, v45
    v_mul_f32 v83, v65, v45
    v_exp_f32 v82, v82
    v_fract_f32 v83, v83
    v_cos_f32 v70, v83
    v_sin_f32 v71, v83
    v_mul_f32 v70, v70, v82
    v_mul_f32 v71, v71, v82
    v_mul_f32 v84, v67, v71
    v_mul_f32 v85, v67, v70
    v_fma_f32 v70, v66, v70, -v84
    v_fma_f32 v71, -v66, v71, -v85
    v_mul_f32 v82, v64, v46
    v_mul_f32 v83, v65, v46
    v_exp_f32 v82, v82
    v_fract_f32 v83, v83
    v_cos_f32 v72, v83
    v_sin_f32 v73, v83
    v_mul_f32 v72, v72, v82
    v_mul_f32 v73, v73, v82
    v_mul_f32 v84, v67, v73
    v_mul_f32 v85, v67, v72
    v_fma_f32 v72, v66, v72, -v84
    v_fma_f32 v73, -v66, v73, -v85
    v_mfma_f32_16x16x4_f32 v[48:51], v68, v74, v[48:51]
    v_mfma_f32_16x16x4_f32 v[52:55], v70, v76, v[52:55]
    v_mfma_f32_16x16x4_f32 v[56:59], v70, v78, v[56:59]
    v_mfma_f32_16x16x4_f32 v[60:63], v72, v80, v[60:63]
    v_mfma_f32_16x16x4_f32 v[48:51], v69, v75, v[48:51]
    v_mfma_f32_16x16x4_f32 v[52:55], v71, v77, v[52:55]
    v_mfma_f32_16x16x4_f32 v[56:59], v71, v79, v[56:59]
    v_mfma_f32_16x16x4_f32 v[60:63], v73, v81, v[60:63]
    v_mov_b32_dpp v64, v24 row_newbcast:9 row_mask:0xf bank_mask:0xf
    v_mov_b32_dpp v65, v25 row_newbcast:9 row_mask:0xf bank_mask:0xf
    v_mov_b32_dpp v66, v26 row_newbcast:9 row_mask:0xf bank_mask:0xf
    v_mov_b32_dpp v67, v27 row_newbcast:9 row_mask:0xf bank_mask:0xf
    v_mul_f32 v82, v64, v47
    v_mul_f32 v83, v65, v47
    v_exp_f32 v82, v82
    v_fract_f32 v83, v83
    v_cos_f32 v74, v83
    v_sin_f32 v75, v83
    v_mul_f32 v74, v74, v82
    v_mul_f32 v75, v75, v82
    v_mul_f32 v84, v75, v75
    v_add_f32 v85, v74, v74
    v_fma_f32 v76, v74, v74, -v84
    v_mul_f32 v77, v85, v75
    v_mul_f32 v84, v77, v77
    v_add_f32 v85, v76, v76
    v_fma_f32 v78, v76, v76, -v84
    v_mul_f32 v79, v85, v77
    v_mul_f32 v84, v79, v79
    v_add_f32 v85, v78, v78
    v_fma_f32 v80, v78, v78, -v84
    v_mul_f32 v81, v85, v79
    v_mul_f32 v82, v64, v44
    v_mul_f32 v83, v65, v44
    v_exp_f32 v82, v82
    v_fract_f32 v83, v83
    v_cos_f32 v68, v83
    v_sin_f32 v69, v83
    v_mul_f32 v68, v68, v82
    v_mul_f32 v69, v69, v82
    v_mul_f32 v84, v67, v69
    v_mul_f32 v85, v67, v68
    v_fma_f32 v68, v66, v68, -v84
    v_fma_f32 v69, -v66, v69, -v85
    v_mul_f32 v82, v64, v45
    v_mul_f32 v83, v65, v45
    v_exp_f32 v82, v82
    v_fract_f32 v83, v83
    v_cos_f32 v70, v83
    v_sin_f32 v71, v83
    v_mul_f32 v70, v70, v82
    v_mul_f32 v71, v71, v82
    v_mul_f32 v84, v67, v71
    v_mul_f32 v85, v67, v70
    v_fma_f32 v70, v66, v70, -v84
    v_fma_f32 v71, -v66, v71, -v85
    v_mul_f32 v82, v64, v46
    v_mul_f32 v83, v65, v46
    v_exp_f32 v82, v82
    v_fract_f32 v83, v83
    v_cos_f32 v72, v83
    v_sin_f32 v73, v83
    v_mul_f32 v72, v72, v82
    v_mul_f32 v73, v73, v82
    v_mul_f32 v84, v67, v73
    v_mul_f32 v85, v67, v72
    v_fma_f32 v72, v66, v72, -v84
    v_fma_f32 v73, -v66, v73, -v85
    v_mfma_f32_16x16x4_f32 v[48:51], v68, v74, v[48:51]
    v_mfma_f32_16x16x4_f32 v[52:55], v70, v76, v[52:55]
    v_mfma_f32_16x16x4_f32 v[56:59], v70, v78, v[56:59]
    v_mfma_f32_16x16x4_f32 v[60:63], v72, v80, v[60:63]
    v_mfma_f32_16x16x4_f32 v[48:51], v69, v75, v[48:51]
    v_mfma_f32_16x16x4_f32 v[52:55], v71, v77, v[52:55]
    v_mfma_f32_16x16x4_f32 v[56:59], v71, v79, v[56:59]
    v_mfma_f32_16x16x4_f32 v[60:63], v73, v81, v[60:63]
    v_mov_b32_dpp v64, v24 row_newbcast:10 row_mask:0xf bank_mask:0xf
    v_mov_b32_dpp v65, v25 row_newbcast:10 row_mask:0xf bank_mask:0xf
    v_mov_b32_dpp v66, v26 row_newbcast:10 row_mask:0xf bank_mask:0xf
    v_mov_b32_dpp v67, v27 row_newbcast:10 row_mask:0xf bank_mask:0xf
    v_mul_f32 v82, v64, v47
    v_mul_f32 v83, v65, v47
    v_exp_f32 v82, v82
    v_fract_f32 v83, v83
    v_cos_f32 v74, v83
    v_sin_f32 v75, v83
    v_mul_f32 v74, v74, v82
    v_mul_f32 v75, v75, v82
    v_mul_f32 v84, v75, v75
    v_add_f32 v85, v74, v74
    v_fma_f32 v76, v74, v74, -v84
    v_mul_f32 v77, v85, v75
    v_mul_f32 v84, v77, v77
    v_add_f32 v85, v76, v76
    v_fma_f32 v78, v76, v76, -v84
    v_mul_f32 v79, v85, v77
    v_mul_f32 v84, v79, v79
    v_add_f32 v85, v78, v78
    v_fma_f32 v80, v78, v78, -v84
    v_mul_f32 v81, v85, v79
    v_mul_f32 v82, v64, v44
    v_mul_f32 v83, v65, v44
    v_exp_f32 v82, v82
    v_fract_f32 v83, v83
    v_cos_f32 v68, v83
    v_sin_f32 v69, v83
    v_mul_f32 v68, v68, v82
    v_mul_f32 v69, v69, v82
    v_mul_f32 v84, v67, v69
    v_mul_f32 v85, v67, v68
    v_fma_f32 v68, v66, v68, -v84
    v_fma_f32 v69, -v66, v69, -v85
    v_mul_f32 v82, v64, v45
    v_mul_f32 v83, v65, v45
    v_exp_f32 v82, v82
    v_fract_f32 v83, v83
    v_cos_f32 v70, v83
    v_sin_f32 v71, v83
    v_mul_f32 v70, v70, v82
    v_mul_f32 v71, v71, v82
    v_mul_f32 v84, v67, v71
    v_mul_f32 v85, v67, v70
    v_fma_f32 v70, v66, v70, -v84
    v_fma_f32 v71, -v66, v71, -v85
    v_mul_f32 v82, v64, v46
    v_mul_f32 v83, v65, v46
    v_exp_f32 v82, v82
    v_fract_f32 v83, v83
    v_cos_f32 v72, v83
    v_sin_f32 v73, v83
    v_mul_f32 v72, v72, v82
    v_mul_f32 v73, v73, v82
    v_mul_f32 v84, v67, v73
    v_mul_f32 v85, v67, v72
    v_fma_f32 v72, v66, v72, -v84
    v_fma_f32 v73, -v66, v73, -v85
    v_mfma_f32_16x16x4_f32 v[48:51], v68, v74, v[48:51]
    v_mfma_f32_16x16x4_f32 v[52:55], v70, v76, v[52:55]
    v_mfma_f32_16x16x4_f32 v[56:59], v70, v78, v[56:59]
    v_mfma_f32_16x16x4_f32 v[60:63], v72, v80, v[60:63]
    v_mfma_f32_16x16x4_f32 v[48:51], v69, v75, v[48:51]
    v_mfma_f32_16x16x4_f32 v[52:55], v71, v77, v[52:55]
    v_mfma_f32_16x16x4_f32 v[56:59], v71, v79, v[56:59]
    v_mfma_f32_16x16x4_f32 v[60:63], v73, v81, v[60:63]
    v_mov_b32_dpp v64, v24 row_newbcast:11 row_mask:0xf bank_mask:0xf
    v_mov_b32_dpp v65, v25 row_newbcast:11 row_mask:0xf bank_mask:0xf
    v_mov_b32_dpp v66, v26 row_newbcast:11 row_mask:0xf bank_mask:0xf
    v_mov_b32_dpp v67, v27 row_newbcast:11 row_mask:0xf bank_mask:0xf
    v_mul_f32 v82, v64, v47
    v_mul_f32 v83, v65, v47
    v_exp_f32 v82, v82
    v_fract_f32 v83, v83
    v_cos_f32 v74, v83
    v_sin_f32 v75, v83
    v_mul_f32 v74, v74, v82
    v_mul_f32 v75, v75, v82
    v_mul_f32 v84, v75, v75
    v_add_f32 v85, v74, v74
    v_fma_f32 v76, v74, v74, -v84
    v_mul_f32 v77, v85, v75
    v_mul_f32 v84, v77, v77
    v_add_f32 v85, v76, v76
    v_fma_f32 v78, v76, v76, -v84
    v_mul_f32 v79, v85, v77
    v_mul_f32 v84, v79, v79
    v_add_f32 v85, v78, v78
    v_fma_f32 v80, v78, v78, -v84
    v_mul_f32 v81, v85, v79
    v_mul_f32 v82, v64, v44
    v_mul_f32 v83, v65, v44
    v_exp_f32 v82, v82
    v_fract_f32 v83, v83
    v_cos_f32 v68, v83
    v_sin_f32 v69, v83
    v_mul_f32 v68, v68, v82
    v_mul_f32 v69, v69, v82
    v_mul_f32 v84, v67, v69
    v_mul_f32 v85, v67, v68
    v_fma_f32 v68, v66, v68, -v84
    v_fma_f32 v69, -v66, v69, -v85
    v_mul_f32 v82, v64, v45
    v_mul_f32 v83, v65, v45
    v_exp_f32 v82, v82
    v_fract_f32 v83, v83
    v_cos_f32 v70, v83
    v_sin_f32 v71, v83
    v_mul_f32 v70, v70, v82
    v_mul_f32 v71, v71, v82
    v_mul_f32 v84, v67, v71
    v_mul_f32 v85, v67, v70
    v_fma_f32 v70, v66, v70, -v84
    v_fma_f32 v71, -v66, v71, -v85
    v_mul_f32 v82, v64, v46
    v_mul_f32 v83, v65, v46
    v_exp_f32 v82, v82
    v_fract_f32 v83, v83
    v_cos_f32 v72, v83
    v_sin_f32 v73, v83
    v_mul_f32 v72, v72, v82
    v_mul_f32 v73, v73, v82
    v_mul_f32 v84, v67, v73
    v_mul_f32 v85, v67, v72
    v_fma_f32 v72, v66, v72, -v84
    v_fma_f32 v73, -v66, v73, -v85
    v_mfma_f32_16x16x4_f32 v[48:51], v68, v74, v[48:51]
    v_mfma_f32_16x16x4_f32 v[52:55], v70, v76, v[52:55]
    v_mfma_f32_16x16x4_f32 v[56:59], v70, v78, v[56:59]
    v_mfma_f32_16x16x4_f32 v[60:63], v72, v80, v[60:63]
    v_mfma_f32_16x16x4_f32 v[48:51], v69, v75, v[48:51]
    v_mfma_f32_16x16x4_f32 v[52:55], v71, v77, v[52:55]
    v_mfma_f32_16x16x4_f32 v[56:59], v71, v79, v[56:59]
    v_mfma_f32_16x16x4_f32 v[60:63], v73, v81, v[60:63]
    v_mov_b32_dpp v64, v24 row_newbcast:12 row_mask:0xf bank_mask:0xf
    v_mov_b32_dpp v65, v25 row_newbcast:12 row_mask:0xf bank_mask:0xf
    v_mov_b32_dpp v66, v26 row_newbcast:12 row_mask:0xf bank_mask:0xf
    v_mov_b32_dpp v67, v27 row_newbcast:12 row_mask:0xf bank_mask:0xf
    v_mul_f32 v82, v64, v47
    v_mul_f32 v83, v65, v47
    v_exp_f32 v82, v82
    v_fract_f32 v83, v83
    v_cos_f32 v74, v83
    v_sin_f32 v75, v83
    v_mul_f32 v74, v74, v82
    v_mul_f32 v75, v75, v82
    v_mul_f32 v84, v75, v75
    v_add_f32 v85, v74, v74
    v_fma_f32 v76, v74, v74, -v84
    v_mul_f32 v77, v85, v75
    v_mul_f32 v84, v77, v77
    v_add_f32 v85, v76, v76
    v_fma_f32 v78, v76, v76, -v84
    v_mul_f32 v79, v85, v77
    v_mul_f32 v84, v79, v79
    v_add_f32 v85, v78, v78
    v_fma_f32 v80, v78, v78, -v84
    v_mul_f32 v81, v85, v79
    v_mul_f32 v82, v64, v44
    v_mul_f32 v83, v65, v44
    v_exp_f32 v82, v82
    v_fract_f32 v83, v83
    v_cos_f32 v68, v83
    v_sin_f32 v69, v83
    v_mul_f32 v68, v68, v82
    v_mul_f32 v69, v69, v82
    v_mul_f32 v84, v67, v69
    v_mul_f32 v85, v67, v68
    v_fma_f32 v68, v66, v68, -v84
    v_fma_f32 v69, -v66, v69, -v85
    v_mul_f32 v82, v64, v45
    v_mul_f32 v83, v65, v45
    v_exp_f32 v82, v82
    v_fract_f32 v83, v83
    v_cos_f32 v70, v83
    v_sin_f32 v71, v83
    v_mul_f32 v70, v70, v82
    v_mul_f32 v71, v71, v82
    v_mul_f32 v84, v67, v71
    v_mul_f32 v85, v67, v70
    v_fma_f32 v70, v66, v70, -v84
    v_fma_f32 v71, -v66, v71, -v85
    v_mul_f32 v82, v64, v46
    v_mul_f32 v83, v65, v46
    v_exp_f32 v82, v82
    v_fract_f32 v83, v83
    v_cos_f32 v72, v83
    v_sin_f32 v73, v83
    v_mul_f32 v72, v72, v82
    v_mul_f32 v73, v73, v82
    v_mul_f32 v84, v67, v73
    v_mul_f32 v85, v67, v72
    v_fma_f32 v72, v66, v72, -v84
    v_fma_f32 v73, -v66, v73, -v85
    v_mfma_f32_16x16x4_f32 v[48:51], v68, v74, v[48:51]
    v_mfma_f32_16x16x4_f32 v[52:55], v70, v76, v[52:55]
    v_mfma_f32_16x16x4_f32 v[56:59], v70, v78, v[56:59]
    v_mfma_f32_16x16x4_f32 v[60:63], v72, v80, v[60:63]
    v_mfma_f32_16x16x4_f32 v[48:51], v69, v75, v[48:51]
    v_mfma_f32_16x16x4_f32 v[52:55], v71, v77, v[52:55]
    v_mfma_f32_16x16x4_f32 v[56:59], v71, v79, v[56:59]
    v_mfma_f32_16x16x4_f32 v[60:63], v73, v81, v[60:63]
    v_mov_b32_dpp v64, v24 row_newbcast:13 row_mask:0xf bank_mask:0xf
    v_mov_b32_dpp v65, v25 row_newbcast:13 row_mask:0xf bank_mask:0xf
    v_mov_b32_dpp v66, v26 row_newbcast:13 row_mask:0xf bank_mask:0xf
    v_mov_b32_dpp v67, v27 row_newbcast:13 row_mask:0xf bank_mask:0xf
    v_mul_f32 v82, v64, v47
    v_mul_f32 v83, v65, v47
    v_exp_f32 v82, v82
    v_fract_f32 v83, v83
    v_cos_f32 v74, v83
    v_sin_f32 v75, v83
    v_mul_f32 v74, v74, v82
    v_mul_f32 v75, v75, v82
    v_mul_f32 v84, v75, v75
    v_add_f32 v85, v74, v74
    v_fma_f32 v76, v74, v74, -v84
    v_mul_f32 v77, v85, v75
    v_mul_f32 v84, v77, v77
    v_add_f32 v85, v76, v76
    v_fma_f32 v78, v76, v76, -v84
    v_mul_f32 v79, v85, v77
    v_mul_f32 v84, v79, v79
    v_add_f32 v85, v78, v78
    v_fma_f32 v80, v78, v78, -v84
    v_mul_f32 v81, v85, v79
    v_mul_f32 v82, v64, v44
    v_mul_f32 v83, v65, v44
    v_exp_f32 v82, v82
    v_fract_f32 v83, v83
    v_cos_f32 v68, v83
    v_sin_f32 v69, v83
    v_mul_f32 v68, v68, v82
    v_mul_f32 v69, v69, v82
    v_mul_f32 v84, v67, v69
    v_mul_f32 v85, v67, v68
    v_fma_f32 v68, v66, v68, -v84
    v_fma_f32 v69, -v66, v69, -v85
    v_mul_f32 v82, v64, v45
    v_mul_f32 v83, v65, v45
    v_exp_f32 v82, v82
    v_fract_f32 v83, v83
    v_cos_f32 v70, v83
    v_sin_f32 v71, v83
    v_mul_f32 v70, v70, v82
    v_mul_f32 v71, v71, v82
    v_mul_f32 v84, v67, v71
    v_mul_f32 v85, v67, v70
    v_fma_f32 v70, v66, v70, -v84
    v_fma_f32 v71, -v66, v71, -v85
    v_mul_f32 v82, v64, v46
    v_mul_f32 v83, v65, v46
    v_exp_f32 v82, v82
    v_fract_f32 v83, v83
    v_cos_f32 v72, v83
    v_sin_f32 v73, v83
    v_mul_f32 v72, v72, v82
    v_mul_f32 v73, v73, v82
    v_mul_f32 v84, v67, v73
    v_mul_f32 v85, v67, v72
    v_fma_f32 v72, v66, v72, -v84
    v_fma_f32 v73, -v66, v73, -v85
    v_mfma_f32_16x16x4_f32 v[48:51], v68, v74, v[48:51]
    v_mfma_f32_16x16x4_f32 v[52:55], v70, v76, v[52:55]
    v_mfma_f32_16x16x4_f32 v[56:59], v70, v78, v[56:59]
    v_mfma_f32_16x16x4_f32 v[60:63], v72, v80, v[60:63]
    v_mfma_f32_16x16x4_f32 v[48:51], v69, v75, v[48:51]
    v_mfma_f32_16x16x4_f32 v[52:55], v71, v77, v[52:55]
    v_mfma_f32_16x16x4_f32 v[56:59], v71, v79, v[56:59]
    v_mfma_f32_16x16x4_f32 v[60:63], v73, v81, v[60:63]
    v_mov_b32_dpp v64, v24 row_newbcast:14 row_mask:0xf bank_mask:0xf
    v_mov_b32_dpp v65, v25 row_newbcast:14 row_mask:0xf bank_mask:0xf
    v_mov_b32_dpp v66, v26 row_newbcast:14 row_mask:0xf bank_mask:0xf
    v_mov_b32_dpp v67, v27 row_newbcast:14 row_mask:0xf bank_mask:0xf
    v_mul_f32 v82, v64, v47
    v_mul_f32 v83, v65, v47
    v_exp_f32 v82, v82
    v_fract_f32 v83, v83
    v_cos_f32 v74, v83
    v_sin_f32 v75, v83
    v_mul_f32 v74, v74, v82
    v_mul_f32 v75, v75, v82
    v_mul_f32 v84, v75, v75
    v_add_f32 v85, v74, v74
    v_fma_f32 v76, v74, v74, -v84
    v_mul_f32 v77, v85, v75
    v_mul_f32 v84, v77, v77
    v_add_f32 v85, v76, v76
    v_fma_f32 v78, v76, v76, -v84
    v_mul_f32 v79, v85, v77
    v_mul_f32 v84, v79, v79
    v_add_f32 v85, v78, v78
    v_fma_f32 v80, v78, v78, -v84
    v_mul_f32 v81, v85, v79
    v_mul_f32 v82, v64, v44
    v_mul_f32 v83, v65, v44
    v_exp_f32 v82, v82
    v_fract_f32 v83, v83
    v_cos_f32 v68, v83
    v_sin_f32 v69, v83
    v_mul_f32 v68, v68, v82
    v_mul_f32 v69, v69, v82
    v_mul_f32 v84, v67, v69
    v_mul_f32 v85, v67, v68
    v_fma_f32 v68, v66, v68, -v84
    v_fma_f32 v69, -v66, v69, -v85
    v_mul_f32 v82, v64, v45
    v_mul_f32 v83, v65, v45
    v_exp_f32 v82, v82
    v_fract_f32 v83, v83
    v_cos_f32 v70, v83
    v_sin_f32 v71, v83
    v_mul_f32 v70, v70, v82
    v_mul_f32 v71, v71, v82
    v_mul_f32 v84, v67, v71
    v_mul_f32 v85, v67, v70
    v_fma_f32 v70, v66, v70, -v84
    v_fma_f32 v71, -v66, v71, -v85
    v_mul_f32 v82, v64, v46
    v_mul_f32 v83, v65, v46
    v_exp_f32 v82, v82
    v_fract_f32 v83, v83
    v_cos_f32 v72, v83
    v_sin_f32 v73, v83
    v_mul_f32 v72, v72, v82
    v_mul_f32 v73, v73, v82
    v_mul_f32 v84, v67, v73
    v_mul_f32 v85, v67, v72
    v_fma_f32 v72, v66, v72, -v84
    v_fma_f32 v73, -v66, v73, -v85
    v_mfma_f32_16x16x4_f32 v[48:51], v68, v74, v[48:51]
    v_mfma_f32_16x16x4_f32 v[52:55], v70, v76, v[52:55]
    v_mfma_f32_16x16x4_f32 v[56:59], v70, v78, v[56:59]
    v_mfma_f32_16x16x4_f32 v[60:63], v72, v80, v[60:63]
    v_mfma_f32_16x16x4_f32 v[48:51], v69, v75, v[48:51]
    v_mfma_f32_16x16x4_f32 v[52:55], v71, v77, v[52:55]
    v_mfma_f32_16x16x4_f32 v[56:59], v71, v79, v[56:59]
    v_mfma_f32_16x16x4_f32 v[60:63], v73, v81, v[60:63]
    v_mov_b32_dpp v64, v24 row_newbcast:15 row_mask:0xf bank_mask:0xf
    v_mov_b32_dpp v65, v25 row_newbcast:15 row_mask:0xf bank_mask:0xf
    v_mov_b32_dpp v66, v26 row_newbcast:15 row_mask:0xf bank_mask:0xf
    v_mov_b32_dpp v67, v27 row_newbcast:15 row_mask:0xf bank_mask:0xf
    v_mul_f32 v82, v64, v47
    v_mul_f32 v83, v65, v47
    v_exp_f32 v82, v82
    v_fract_f32 v83, v83
    v_cos_f32 v74, v83
    v_sin_f32 v75, v83
    v_mul_f32 v74, v74, v82
    v_mul_f32 v75, v75, v82
    v_mul_f32 v84, v75, v75
    v_add_f32 v85, v74, v74
    v_fma_f32 v76, v74, v74, -v84
    v_mul_f32 v77, v85, v75
    v_mul_f32 v84, v77, v77
    v_add_f32 v85, v76, v76
    v_fma_f32 v78, v76, v76, -v84
    v_mul_f32 v79, v85, v77
    v_mul_f32 v84, v79, v79
    v_add_f32 v85, v78, v78
    v_fma_f32 v80, v78, v78, -v84
    v_mul_f32 v81, v85, v79
    v_mul_f32 v82, v64, v44
    v_mul_f32 v83, v65, v44
    v_exp_f32 v82, v82
    v_fract_f32 v83, v83
    v_cos_f32 v68, v83
    v_sin_f32 v69, v83
    v_mul_f32 v68, v68, v82
    v_mul_f32 v69, v69, v82
    v_mul_f32 v84, v67, v69
    v_mul_f32 v85, v67, v68
    v_fma_f32 v68, v66, v68, -v84
    v_fma_f32 v69, -v66, v69, -v85
    v_mul_f32 v82, v64, v45
    v_mul_f32 v83, v65, v45
    v_exp_f32 v82, v82
    v_fract_f32 v83, v83
    v_cos_f32 v70, v83
    v_sin_f32 v71, v83
    v_mul_f32 v70, v70, v82
    v_mul_f32 v71, v71, v82
    v_mul_f32 v84, v67, v71
    v_mul_f32 v85, v67, v70
    v_fma_f32 v70, v66, v70, -v84
    v_fma_f32 v71, -v66, v71, -v85
    v_mul_f32 v82, v64, v46
    v_mul_f32 v83, v65, v46
    v_exp_f32 v82, v82
    v_fract_f32 v83, v83
    v_cos_f32 v72, v83
    v_sin_f32 v73, v83
    v_mul_f32 v72, v72, v82
    v_mul_f32 v73, v73, v82
    v_mul_f32 v84, v67, v73
    v_mul_f32 v85, v67, v72
    v_fma_f32 v72, v66, v72, -v84
    v_fma_f32 v73, -v66, v73, -v85
    v_mfma_f32_16x16x4_f32 v[48:51], v68, v74, v[48:51]
    v_mfma_f32_16x16x4_f32 v[52:55], v70, v76, v[52:55]
    v_mfma_f32_16x16x4_f32 v[56:59], v70, v78, v[56:59]
    v_mfma_f32_16x16x4_f32 v[60:63], v72, v80, v[60:63]
    v_mfma_f32_16x16x4_f32 v[48:51], v69, v75, v[48:51]
    v_mfma_f32_16x16x4_f32 v[52:55], v71, v77, v[52:55]
    v_mfma_f32_16x16x4_f32 v[56:59], v71, v79, v[56:59]
    v_mfma_f32_16x16x4_f32 v[60:63], v73, v81, v[60:63]
    v_mov_b32_dpp v64, v28 row_newbcast:0 row_mask:0xf bank_mask:0xf
    v_mov_b32_dpp v65, v29 row_newbcast:0 row_mask:0xf bank_mask:0xf
    v_mov_b32_dpp v66, v30 row_newbcast:0 row_mask:0xf bank_mask:0xf
    v_mov_b32_dpp v67, v31 row_newbcast:0 row_mask:0xf bank_mask:0xf
    v_mul_f32 v82, v64, v47
    v_mul_f32 v83, v65, v47
    v_exp_f32 v82, v82
    v_fract_f32 v83, v83
    v_cos_f32 v74, v83
    v_sin_f32 v75, v83
    v_mul_f32 v74, v74, v82
    v_mul_f32 v75, v75, v82
    v_mul_f32 v84, v75, v75
    v_add_f32 v85, v74, v74
    v_fma_f32 v76, v74, v74, -v84
    v_mul_f32 v77, v85, v75
    v_mul_f32 v84, v77, v77
    v_add_f32 v85, v76, v76
    v_fma_f32 v78, v76, v76, -v84
    v_mul_f32 v79, v85, v77
    v_mul_f32 v84, v79, v79
    v_add_f32 v85, v78, v78
    v_fma_f32 v80, v78, v78, -v84
    v_mul_f32 v81, v85, v79
    v_mul_f32 v82, v64, v44
    v_mul_f32 v83, v65, v44
    v_exp_f32 v82, v82
    v_fract_f32 v83, v83
    v_cos_f32 v68, v83
    v_sin_f32 v69, v83
    v_mul_f32 v68, v68, v82
    v_mul_f32 v69, v69, v82
    v_mul_f32 v84, v67, v69
    v_mul_f32 v85, v67, v68
    v_fma_f32 v68, v66, v68, -v84
    v_fma_f32 v69, -v66, v69, -v85
    v_mul_f32 v82, v64, v45
    v_mul_f32 v83, v65, v45
    v_exp_f32 v82, v82
    v_fract_f32 v83, v83
    v_cos_f32 v70, v83
    v_sin_f32 v71, v83
    v_mul_f32 v70, v70, v82
    v_mul_f32 v71, v71, v82
    v_mul_f32 v84, v67, v71
    v_mul_f32 v85, v67, v70
    v_fma_f32 v70, v66, v70, -v84
    v_fma_f32 v71, -v66, v71, -v85
    v_mul_f32 v82, v64, v46
    v_mul_f32 v83, v65, v46
    v_exp_f32 v82, v82
    v_fract_f32 v83, v83
    v_cos_f32 v72, v83
    v_sin_f32 v73, v83
    v_mul_f32 v72, v72, v82
    v_mul_f32 v73, v73, v82
    v_mul_f32 v84, v67, v73
    v_mul_f32 v85, v67, v72
    v_fma_f32 v72, v66, v72, -v84
    v_fma_f32 v73, -v66, v73, -v85
    v_mfma_f32_16x16x4_f32 v[48:51], v68, v74, v[48:51]
    v_mfma_f32_16x16x4_f32 v[52:55], v70, v76, v[52:55]
    v_mfma_f32_16x16x4_f32 v[56:59], v70, v78, v[56:59]
    v_mfma_f32_16x16x4_f32 v[60:63], v72, v80, v[60:63]
    v_mfma_f32_16x16x4_f32 v[48:51], v69, v75, v[48:51]
    v_mfma_f32_16x16x4_f32 v[52:55], v71, v77, v[52:55]
    v_mfma_f32_16x16x4_f32 v[56:59], v71, v79, v[56:59]
    v_mfma_f32_16x16x4_f32 v[60:63], v73, v81, v[60:63]
    v_mov_b32_dpp v64, v28 row_newbcast:1 row_mask:0xf bank_mask:0xf
    v_mov_b32_dpp v65, v29 row_newbcast:1 row_mask:0xf bank_mask:0xf
    v_mov_b32_dpp v66, v30 row_newbcast:1 row_mask:0xf bank_mask:0xf
    v_mov_b32_dpp v67, v31 row_newbcast:1 row_mask:0xf bank_mask:0xf
    v_mul_f32 v82, v64, v47
    v_mul_f32 v83, v65, v47
    v_exp_f32 v82, v82
    v_fract_f32 v83, v83
    v_cos_f32 v74, v83
    v_sin_f32 v75, v83
    v_mul_f32 v74, v74, v82
    v_mul_f32 v75, v75, v82
    v_mul_f32 v84, v75, v75
    v_add_f32 v85, v74, v74
    v_fma_f32 v76, v74, v74, -v84
    v_mul_f32 v77, v85, v75
    v_mul_f32 v84, v77, v77
    v_add_f32 v85, v76, v76
    v_fma_f32 v78, v76, v76, -v84
    v_mul_f32 v79, v85, v77
    v_mul_f32 v84, v79, v79
    v_add_f32 v85, v78, v78
    v_fma_f32 v80, v78, v78, -v84
    v_mul_f32 v81, v85, v79
    v_mul_f32 v82, v64, v44
    v_mul_f32 v83, v65, v44
    v_exp_f32 v82, v82
    v_fract_f32 v83, v83
    v_cos_f32 v68, v83
    v_sin_f32 v69, v83
    v_mul_f32 v68, v68, v82
    v_mul_f32 v69, v69, v82
    v_mul_f32 v84, v67, v69
    v_mul_f32 v85, v67, v68
    v_fma_f32 v68, v66, v68, -v84
    v_fma_f32 v69, -v66, v69, -v85
    v_mul_f32 v82, v64, v45
    v_mul_f32 v83, v65, v45
    v_exp_f32 v82, v82
    v_fract_f32 v83, v83
    v_cos_f32 v70, v83
    v_sin_f32 v71, v83
    v_mul_f32 v70, v70, v82
    v_mul_f32 v71, v71, v82
    v_mul_f32 v84, v67, v71
    v_mul_f32 v85, v67, v70
    v_fma_f32 v70, v66, v70, -v84
    v_fma_f32 v71, -v66, v71, -v85
    v_mul_f32 v82, v64, v46
    v_mul_f32 v83, v65, v46
    v_exp_f32 v82, v82
    v_fract_f32 v83, v83
    v_cos_f32 v72, v83
    v_sin_f32 v73, v83
    v_mul_f32 v72, v72, v82
    v_mul_f32 v73, v73, v82
    v_mul_f32 v84, v67, v73
    v_mul_f32 v85, v67, v72
    v_fma_f32 v72, v66, v72, -v84
    v_fma_f32 v73, -v66, v73, -v85
    v_mfma_f32_16x16x4_f32 v[48:51], v68, v74, v[48:51]
    v_mfma_f32_16x16x4_f32 v[52:55], v70, v76, v[52:55]
    v_mfma_f32_16x16x4_f32 v[56:59], v70, v78, v[56:59]
    v_mfma_f32_16x16x4_f32 v[60:63], v72, v80, v[60:63]
    v_mfma_f32_16x16x4_f32 v[48:51], v69, v75, v[48:51]
    v_mfma_f32_16x16x4_f32 v[52:55], v71, v77, v[52:55]
    v_mfma_f32_16x16x4_f32 v[56:59], v71, v79, v[56:59]
    v_mfma_f32_16x16x4_f32 v[60:63], v73, v81, v[60:63]
    v_mov_b32_dpp v64, v28 row_newbcast:2 row_mask:0xf bank_mask:0xf
    v_mov_b32_dpp v65, v29 row_newbcast:2 row_mask:0xf bank_mask:0xf
    v_mov_b32_dpp v66, v30 row_newbcast:2 row_mask:0xf bank_mask:0xf
    v_mov_b32_dpp v67, v31 row_newbcast:2 row_mask:0xf bank_mask:0xf
    v_mul_f32 v82, v64, v47
    v_mul_f32 v83, v65, v47
    v_exp_f32 v82, v82
    v_fract_f32 v83, v83
    v_cos_f32 v74, v83
    v_sin_f32 v75, v83
    v_mul_f32 v74, v74, v82
    v_mul_f32 v75, v75, v82
    v_mul_f32 v84, v75, v75
    v_add_f32 v85, v74, v74
    v_fma_f32 v76, v74, v74, -v84
    v_mul_f32 v77, v85, v75
    v_mul_f32 v84, v77, v77
    v_add_f32 v85, v76, v76
    v_fma_f32 v78, v76, v76, -v84
    v_mul_f32 v79, v85, v77
    v_mul_f32 v84, v79, v79
    v_add_f32 v85, v78, v78
    v_fma_f32 v80, v78, v78, -v84
    v_mul_f32 v81, v85, v79
    v_mul_f32 v82, v64, v44
    v_mul_f32 v83, v65, v44
    v_exp_f32 v82, v82
    v_fract_f32 v83, v83
    v_cos_f32 v68, v83
    v_sin_f32 v69, v83
    v_mul_f32 v68, v68, v82
    v_mul_f32 v69, v69, v82
    v_mul_f32 v84, v67, v69
    v_mul_f32 v85, v67, v68
    v_fma_f32 v68, v66, v68, -v84
    v_fma_f32 v69, -v66, v69, -v85
    v_mul_f32 v82, v64, v45
    v_mul_f32 v83, v65, v45
    v_exp_f32 v82, v82
    v_fract_f32 v83, v83
    v_cos_f32 v70, v83
    v_sin_f32 v71, v83
    v_mul_f32 v70, v70, v82
    v_mul_f32 v71, v71, v82
    v_mul_f32 v84, v67, v71
    v_mul_f32 v85, v67, v70
    v_fma_f32 v70, v66, v70, -v84
    v_fma_f32 v71, -v66, v71, -v85
    v_mul_f32 v82, v64, v46
    v_mul_f32 v83, v65, v46
    v_exp_f32 v82, v82
    v_fract_f32 v83, v83
    v_cos_f32 v72, v83
    v_sin_f32 v73, v83
    v_mul_f32 v72, v72, v82
    v_mul_f32 v73, v73, v82
    v_mul_f32 v84, v67, v73
    v_mul_f32 v85, v67, v72
    v_fma_f32 v72, v66, v72, -v84
    v_fma_f32 v73, -v66, v73, -v85
    v_mfma_f32_16x16x4_f32 v[48:51], v68, v74, v[48:51]
    v_mfma_f32_16x16x4_f32 v[52:55], v70, v76, v[52:55]
    v_mfma_f32_16x16x4_f32 v[56:59], v70, v78, v[56:59]
    v_mfma_f32_16x16x4_f32 v[60:63], v72, v80, v[60:63]
    v_mfma_f32_16x16x4_f32 v[48:51], v69, v75, v[48:51]
    v_mfma_f32_16x16x4_f32 v[52:55], v71, v77, v[52:55]
    v_mfma_f32_16x16x4_f32 v[56:59], v71, v79, v[56:59]
    v_mfma_f32_16x16x4_f32 v[60:63], v73, v81, v[60:63]
    v_mov_b32_dpp v64, v28 row_newbcast:3 row_mask:0xf bank_mask:0xf
    v_mov_b32_dpp v65, v29 row_newbcast:3 row_mask:0xf bank_mask:0xf
    v_mov_b32_dpp v66, v30 row_newbcast:3 row_mask:0xf bank_mask:0xf
    v_mov_b32_dpp v67, v31 row_newbcast:3 row_mask:0xf bank_mask:0xf
    v_mul_f32 v82, v64, v47
    v_mul_f32 v83, v65, v47
    v_exp_f32 v82, v82
    v_fract_f32 v83, v83
    v_cos_f32 v74, v83
    v_sin_f32 v75, v83
    v_mul_f32 v74, v74, v82
    v_mul_f32 v75, v75, v82
    v_mul_f32 v84, v75, v75
    v_add_f32 v85, v74, v74
    v_fma_f32 v76, v74, v74, -v84
    v_mul_f32 v77, v85, v75
    v_mul_f32 v84, v77, v77
    v_add_f32 v85, v76, v76
    v_fma_f32 v78, v76, v76, -v84
    v_mul_f32 v79, v85, v77
    v_mul_f32 v84, v79, v79
    v_add_f32 v85, v78, v78
    v_fma_f32 v80, v78, v78, -v84
    v_mul_f32 v81, v85, v79
    v_mul_f32 v82, v64, v44
    v_mul_f32 v83, v65, v44
    v_exp_f32 v82, v82
    v_fract_f32 v83, v83
    v_cos_f32 v68, v83
    v_sin_f32 v69, v83
    v_mul_f32 v68, v68, v82
    v_mul_f32 v69, v69, v82
    v_mul_f32 v84, v67, v69
    v_mul_f32 v85, v67, v68
    v_fma_f32 v68, v66, v68, -v84
    v_fma_f32 v69, -v66, v69, -v85
    v_mul_f32 v82, v64, v45
    v_mul_f32 v83, v65, v45
    v_exp_f32 v82, v82
    v_fract_f32 v83, v83
    v_cos_f32 v70, v83
    v_sin_f32 v71, v83
    v_mul_f32 v70, v70, v82
    v_mul_f32 v71, v71, v82
    v_mul_f32 v84, v67, v71
    v_mul_f32 v85, v67, v70
    v_fma_f32 v70, v66, v70, -v84
    v_fma_f32 v71, -v66, v71, -v85
    v_mul_f32 v82, v64, v46
    v_mul_f32 v83, v65, v46
    v_exp_f32 v82, v82
    v_fract_f32 v83, v83
    v_cos_f32 v72, v83
    v_sin_f32 v73, v83
    v_mul_f32 v72, v72, v82
    v_mul_f32 v73, v73, v82
    v_mul_f32 v84, v67, v73
    v_mul_f32 v85, v67, v72
    v_fma_f32 v72, v66, v72, -v84
    v_fma_f32 v73, -v66, v73, -v85
    v_mfma_f32_16x16x4_f32 v[48:51], v68, v74, v[48:51]
    v_mfma_f32_16x16x4_f32 v[52:55], v70, v76, v[52:55]
    v_mfma_f32_16x16x4_f32 v[56:59], v70, v78, v[56:59]
    v_mfma_f32_16x16x4_f32 v[60:63], v72, v80, v[60:63]
    v_mfma_f32_16x16x4_f32 v[48:51], v69, v75, v[48:51]
    v_mfma_f32_16x16x4_f32 v[52:55], v71, v77, v[52:55]
    v_mfma_f32_16x16x4_f32 v[56:59], v71, v79, v[56:59]
    v_mfma_f32_16x16x4_f32 v[60:63], v73, v81, v[60:63]
    v_mov_b32_dpp v64, v28 row_newbcast:4 row_mask:0xf bank_mask:0xf
    v_mov_b32_dpp v65, v29 row_newbcast:4 row_mask:0xf bank_mask:0xf
    v_mov_b32_dpp v66, v30 row_newbcast:4 row_mask:0xf bank_mask:0xf
    v_mov_b32_dpp v67, v31 row_newbcast:4 row_mask:0xf bank_mask:0xf
    v_mul_f32 v82, v64, v47
    v_mul_f32 v83, v65, v47
    v_exp_f32 v82, v82
    v_fract_f32 v83, v83
    v_cos_f32 v74, v83
    v_sin_f32 v75, v83
    v_mul_f32 v74, v74, v82
    v_mul_f32 v75, v75, v82
    v_mul_f32 v84, v75, v75
    v_add_f32 v85, v74, v74
    v_fma_f32 v76, v74, v74, -v84
    v_mul_f32 v77, v85, v75
    v_mul_f32 v84, v77, v77
    v_add_f32 v85, v76, v76
    v_fma_f32 v78, v76, v76, -v84
    v_mul_f32 v79, v85, v77
    v_mul_f32 v84, v79, v79
    v_add_f32 v85, v78, v78
    v_fma_f32 v80, v78, v78, -v84
    v_mul_f32 v81, v85, v79
    v_mul_f32 v82, v64, v44
    v_mul_f32 v83, v65, v44
    v_exp_f32 v82, v82
    v_fract_f32 v83, v83
    v_cos_f32 v68, v83
    v_sin_f32 v69, v83
    v_mul_f32 v68, v68, v82
    v_mul_f32 v69, v69, v82
    v_mul_f32 v84, v67, v69
    v_mul_f32 v85, v67, v68
    v_fma_f32 v68, v66, v68, -v84
    v_fma_f32 v69, -v66, v69, -v85
    v_mul_f32 v82, v64, v45
    v_mul_f32 v83, v65, v45
    v_exp_f32 v82, v82
    v_fract_f32 v83, v83
    v_cos_f32 v70, v83
    v_sin_f32 v71, v83
    v_mul_f32 v70, v70, v82
    v_mul_f32 v71, v71, v82
    v_mul_f32 v84, v67, v71
    v_mul_f32 v85, v67, v70
    v_fma_f32 v70, v66, v70, -v84
    v_fma_f32 v71, -v66, v71, -v85
    v_mul_f32 v82, v64, v46
    v_mul_f32 v83, v65, v46
    v_exp_f32 v82, v82
    v_fract_f32 v83, v83
    v_cos_f32 v72, v83
    v_sin_f32 v73, v83
    v_mul_f32 v72, v72, v82
    v_mul_f32 v73, v73, v82
    v_mul_f32 v84, v67, v73
    v_mul_f32 v85, v67, v72
    v_fma_f32 v72, v66, v72, -v84
    v_fma_f32 v73, -v66, v73, -v85
    v_mfma_f32_16x16x4_f32 v[48:51], v68, v74, v[48:51]
    v_mfma_f32_16x16x4_f32 v[52:55], v70, v76, v[52:55]
    v_mfma_f32_16x16x4_f32 v[56:59], v70, v78, v[56:59]
    v_mfma_f32_16x16x4_f32 v[60:63], v72, v80, v[60:63]
    v_mfma_f32_16x16x4_f32 v[48:51], v69, v75, v[48:51]
    v_mfma_f32_16x16x4_f32 v[52:55], v71, v77, v[52:55]
    v_mfma_f32_16x16x4_f32 v[56:59], v71, v79, v[56:59]
    v_mfma_f32_16x16x4_f32 v[60:63], v73, v81, v[60:63]
    v_mov_b32_dpp v64, v28 row_newbcast:5 row_mask:0xf bank_mask:0xf
    v_mov_b32_dpp v65, v29 row_newbcast:5 row_mask:0xf bank_mask:0xf
    v_mov_b32_dpp v66, v30 row_newbcast:5 row_mask:0xf bank_mask:0xf
    v_mov_b32_dpp v67, v31 row_newbcast:5 row_mask:0xf bank_mask:0xf
    v_mul_f32 v82, v64, v47
    v_mul_f32 v83, v65, v47
    v_exp_f32 v82, v82
    v_fract_f32 v83, v83
    v_cos_f32 v74, v83
    v_sin_f32 v75, v83
    v_mul_f32 v74, v74, v82
    v_mul_f32 v75, v75, v82
    v_mul_f32 v84, v75, v75
    v_add_f32 v85, v74, v74
    v_fma_f32 v76, v74, v74, -v84
    v_mul_f32 v77, v85, v75
    v_mul_f32 v84, v77, v77
    v_add_f32 v85, v76, v76
    v_fma_f32 v78, v76, v76, -v84
    v_mul_f32 v79, v85, v77
    v_mul_f32 v84, v79, v79
    v_add_f32 v85, v78, v78
    v_fma_f32 v80, v78, v78, -v84
    v_mul_f32 v81, v85, v79
    v_mul_f32 v82, v64, v44
    v_mul_f32 v83, v65, v44
    v_exp_f32 v82, v82
    v_fract_f32 v83, v83
    v_cos_f32 v68, v83
    v_sin_f32 v69, v83
    v_mul_f32 v68, v68, v82
    v_mul_f32 v69, v69, v82
    v_mul_f32 v84, v67, v69
    v_mul_f32 v85, v67, v68
    v_fma_f32 v68, v66, v68, -v84
    v_fma_f32 v69, -v66, v69, -v85
    v_mul_f32 v82, v64, v45
    v_mul_f32 v83, v65, v45
    v_exp_f32 v82, v82
    v_fract_f32 v83, v83
    v_cos_f32 v70, v83
    v_sin_f32 v71, v83
    v_mul_f32 v70, v70, v82
    v_mul_f32 v71, v71, v82
    v_mul_f32 v84, v67, v71
    v_mul_f32 v85, v67, v70
    v_fma_f32 v70, v66, v70, -v84
    v_fma_f32 v71, -v66, v71, -v85
    v_mul_f32 v82, v64, v46
    v_mul_f32 v83, v65, v46
    v_exp_f32 v82, v82
    v_fract_f32 v83, v83
    v_cos_f32 v72, v83
    v_sin_f32 v73, v83
    v_mul_f32 v72, v72, v82
    v_mul_f32 v73, v73, v82
    v_mul_f32 v84, v67, v73
    v_mul_f32 v85, v67, v72
    v_fma_f32 v72, v66, v72, -v84
    v_fma_f32 v73, -v66, v73, -v85
    v_mfma_f32_16x16x4_f32 v[48:51], v68, v74, v[48:51]
    v_mfma_f32_16x16x4_f32 v[52:55], v70, v76, v[52:55]
    v_mfma_f32_16x16x4_f32 v[56:59], v70, v78, v[56:59]
    v_mfma_f32_16x16x4_f32 v[60:63], v72, v80, v[60:63]
    v_mfma_f32_16x16x4_f32 v[48:51], v69, v75, v[48:51]
    v_mfma_f32_16x16x4_f32 v[52:55], v71, v77, v[52:55]
    v_mfma_f32_16x16x4_f32 v[56:59], v71, v79, v[56:59]
    v_mfma_f32_16x16x4_f32 v[60:63], v73, v81, v[60:63]
    v_mov_b32_dpp v64, v28 row_newbcast:6 row_mask:0xf bank_mask:0xf
    v_mov_b32_dpp v65, v29 row_newbcast:6 row_mask:0xf bank_mask:0xf
    v_mov_b32_dpp v66, v30 row_newbcast:6 row_mask:0xf bank_mask:0xf
    v_mov_b32_dpp v67, v31 row_newbcast:6 row_mask:0xf bank_mask:0xf
    v_mul_f32 v82, v64, v47
    v_mul_f32 v83, v65, v47
    v_exp_f32 v82, v82
    v_fract_f32 v83, v83
    v_cos_f32 v74, v83
    v_sin_f32 v75, v83
    v_mul_f32 v74, v74, v82
    v_mul_f32 v75, v75, v82
    v_mul_f32 v84, v75, v75
    v_add_f32 v85, v74, v74
    v_fma_f32 v76, v74, v74, -v84
    v_mul_f32 v77, v85, v75
    v_mul_f32 v84, v77, v77
    v_add_f32 v85, v76, v76
    v_fma_f32 v78, v76, v76, -v84
    v_mul_f32 v79, v85, v77
    v_mul_f32 v84, v79, v79
    v_add_f32 v85, v78, v78
    v_fma_f32 v80, v78, v78, -v84
    v_mul_f32 v81, v85, v79
    v_mul_f32 v82, v64, v44
    v_mul_f32 v83, v65, v44
    v_exp_f32 v82, v82
    v_fract_f32 v83, v83
    v_cos_f32 v68, v83
    v_sin_f32 v69, v83
    v_mul_f32 v68, v68, v82
    v_mul_f32 v69, v69, v82
    v_mul_f32 v84, v67, v69
    v_mul_f32 v85, v67, v68
    v_fma_f32 v68, v66, v68, -v84
    v_fma_f32 v69, -v66, v69, -v85
    v_mul_f32 v82, v64, v45
    v_mul_f32 v83, v65, v45
    v_exp_f32 v82, v82
    v_fract_f32 v83, v83
    v_cos_f32 v70, v83
    v_sin_f32 v71, v83
    v_mul_f32 v70, v70, v82
    v_mul_f32 v71, v71, v82
    v_mul_f32 v84, v67, v71
    v_mul_f32 v85, v67, v70
    v_fma_f32 v70, v66, v70, -v84
    v_fma_f32 v71, -v66, v71, -v85
    v_mul_f32 v82, v64, v46
    v_mul_f32 v83, v65, v46
    v_exp_f32 v82, v82
    v_fract_f32 v83, v83
    v_cos_f32 v72, v83
    v_sin_f32 v73, v83
    v_mul_f32 v72, v72, v82
    v_mul_f32 v73, v73, v82
    v_mul_f32 v84, v67, v73
    v_mul_f32 v85, v67, v72
    v_fma_f32 v72, v66, v72, -v84
    v_fma_f32 v73, -v66, v73, -v85
    v_mfma_f32_16x16x4_f32 v[48:51], v68, v74, v[48:51]
    v_mfma_f32_16x16x4_f32 v[52:55], v70, v76, v[52:55]
    v_mfma_f32_16x16x4_f32 v[56:59], v70, v78, v[56:59]
    v_mfma_f32_16x16x4_f32 v[60:63], v72, v80, v[60:63]
    v_mfma_f32_16x16x4_f32 v[48:51], v69, v75, v[48:51]
    v_mfma_f32_16x16x4_f32 v[52:55], v71, v77, v[52:55]
    v_mfma_f32_16x16x4_f32 v[56:59], v71, v79, v[56:59]
    v_mfma_f32_16x16x4_f32 v[60:63], v73, v81, v[60:63]
    v_mov_b32_dpp v64, v28 row_newbcast:7 row_mask:0xf bank_mask:0xf
    v_mov_b32_dpp v65, v29 row_newbcast:7 row_mask:0xf bank_mask:0xf
    v_mov_b32_dpp v66, v30 row_newbcast:7 row_mask:0xf bank_mask:0xf
    v_mov_b32_dpp v67, v31 row_newbcast:7 row_mask:0xf bank_mask:0xf
    v_mul_f32 v82, v64, v47
    v_mul_f32 v83, v65, v47
    v_exp_f32 v82, v82
    v_fract_f32 v83, v83
    v_cos_f32 v74, v83
    v_sin_f32 v75, v83
    v_mul_f32 v74, v74, v82
    v_mul_f32 v75, v75, v82
    v_mul_f32 v84, v75, v75
    v_add_f32 v85, v74, v74
    v_fma_f32 v76, v74, v74, -v84
    v_mul_f32 v77, v85, v75
    v_mul_f32 v84, v77, v77
    v_add_f32 v85, v76, v76
    v_fma_f32 v78, v76, v76, -v84
    v_mul_f32 v79, v85, v77
    v_mul_f32 v84, v79, v79
    v_add_f32 v85, v78, v78
    v_fma_f32 v80, v78, v78, -v84
    v_mul_f32 v81, v85, v79
    v_mul_f32 v82, v64, v44
    v_mul_f32 v83, v65, v44
    v_exp_f32 v82, v82
    v_fract_f32 v83, v83
    v_cos_f32 v68, v83
    v_sin_f32 v69, v83
    v_mul_f32 v68, v68, v82
    v_mul_f32 v69, v69, v82
    v_mul_f32 v84, v67, v69
    v_mul_f32 v85, v67, v68
    v_fma_f32 v68, v66, v68, -v84
    v_fma_f32 v69, -v66, v69, -v85
    v_mul_f32 v82, v64, v45
    v_mul_f32 v83, v65, v45
    v_exp_f32 v82, v82
    v_fract_f32 v83, v83
    v_cos_f32 v70, v83
    v_sin_f32 v71, v83
    v_mul_f32 v70, v70, v82
    v_mul_f32 v71, v71, v82
    v_mul_f32 v84, v67, v71
    v_mul_f32 v85, v67, v70
    v_fma_f32 v70, v66, v70, -v84
    v_fma_f32 v71, -v66, v71, -v85
    v_mul_f32 v82, v64, v46
    v_mul_f32 v83, v65, v46
    v_exp_f32 v82, v82
    v_fract_f32 v83, v83
    v_cos_f32 v72, v83
    v_sin_f32 v73, v83
    v_mul_f32 v72, v72, v82
    v_mul_f32 v73, v73, v82
    v_mul_f32 v84, v67, v73
    v_mul_f32 v85, v67, v72
    v_fma_f32 v72, v66, v72, -v84
    v_fma_f32 v73, -v66, v73, -v85
    v_mfma_f32_16x16x4_f32 v[48:51], v68, v74, v[48:51]
    v_mfma_f32_16x16x4_f32 v[52:55], v70, v76, v[52:55]
    v_mfma_f32_16x16x4_f32 v[56:59], v70, v78, v[56:59]
    v_mfma_f32_16x16x4_f32 v[60:63], v72, v80, v[60:63]
    v_mfma_f32_16x16x4_f32 v[48:51], v69, v75, v[48:51]
    v_mfma_f32_16x16x4_f32 v[52:55], v71, v77, v[52:55]
    v_mfma_f32_16x16x4_f32 v[56:59], v71, v79, v[56:59]
    v_mfma_f32_16x16x4_f32 v[60:63], v73, v81, v[60:63]
    v_mov_b32_dpp v64, v28 row_newbcast:8 row_mask:0xf bank_mask:0xf
    v_mov_b32_dpp v65, v29 row_newbcast:8 row_mask:0xf bank_mask:0xf
    v_mov_b32_dpp v66, v30 row_newbcast:8 row_mask:0xf bank_mask:0xf
    v_mov_b32_dpp v67, v31 row_newbcast:8 row_mask:0xf bank_mask:0xf
    v_mul_f32 v82, v64, v47
    v_mul_f32 v83, v65, v47
    v_exp_f32 v82, v82
    v_fract_f32 v83, v83
    v_cos_f32 v74, v83
    v_sin_f32 v75, v83
    v_mul_f32 v74, v74, v82
    v_mul_f32 v75, v75, v82
    v_mul_f32 v84, v75, v75
    v_add_f32 v85, v74, v74
    v_fma_f32 v76, v74, v74, -v84
    v_mul_f32 v77, v85, v75
    v_mul_f32 v84, v77, v77
    v_add_f32 v85, v76, v76
    v_fma_f32 v78, v76, v76, -v84
    v_mul_f32 v79, v85, v77
    v_mul_f32 v84, v79, v79
    v_add_f32 v85, v78, v78
    v_fma_f32 v80, v78, v78, -v84
    v_mul_f32 v81, v85, v79
    v_mul_f32 v82, v64, v44
    v_mul_f32 v83, v65, v44
    v_exp_f32 v82, v82
    v_fract_f32 v83, v83
    v_cos_f32 v68, v83
    v_sin_f32 v69, v83
    v_mul_f32 v68, v68, v82
    v_mul_f32 v69, v69, v82
    v_mul_f32 v84, v67, v69
    v_mul_f32 v85, v67, v68
    v_fma_f32 v68, v66, v68, -v84
    v_fma_f32 v69, -v66, v69, -v85
    v_mul_f32 v82, v64, v45
    v_mul_f32 v83, v65, v45
    v_exp_f32 v82, v82
    v_fract_f32 v83, v83
    v_cos_f32 v70, v83
    v_sin_f32 v71, v83
    v_mul_f32 v70, v70, v82
    v_mul_f32 v71, v71, v82
    v_mul_f32 v84, v67, v71
    v_mul_f32 v85, v67, v70
    v_fma_f32 v70, v66, v70, -v84
    v_fma_f32 v71, -v66, v71, -v85
    v_mul_f32 v82, v64, v46
    v_mul_f32 v83, v65, v46
    v_exp_f32 v82, v82
    v_fract_f32 v83, v83
    v_cos_f32 v72, v83
    v_sin_f32 v73, v83
    v_mul_f32 v72, v72, v82
    v_mul_f32 v73, v73, v82
    v_mul_f32 v84, v67, v73
    v_mul_f32 v85, v67, v72
    v_fma_f32 v72, v66, v72, -v84
    v_fma_f32 v73, -v66, v73, -v85
    v_mfma_f32_16x16x4_f32 v[48:51], v68, v74, v[48:51]
    v_mfma_f32_16x16x4_f32 v[52:55], v70, v76, v[52:55]
    v_mfma_f32_16x16x4_f32 v[56:59], v70, v78, v[56:59]
    v_mfma_f32_16x16x4_f32 v[60:63], v72, v80, v[60:63]
    v_mfma_f32_16x16x4_f32 v[48:51], v69, v75, v[48:51]
    v_mfma_f32_16x16x4_f32 v[52:55], v71, v77, v[52:55]
    v_mfma_f32_16x16x4_f32 v[56:59], v71, v79, v[56:59]
    v_mfma_f32_16x16x4_f32 v[60:63], v73, v81, v[60:63]
    v_mov_b32_dpp v64, v28 row_newbcast:9 row_mask:0xf bank_mask:0xf
    v_mov_b32_dpp v65, v29 row_newbcast:9 row_mask:0xf bank_mask:0xf
    v_mov_b32_dpp v66, v30 row_newbcast:9 row_mask:0xf bank_mask:0xf
    v_mov_b32_dpp v67, v31 row_newbcast:9 row_mask:0xf bank_mask:0xf
    v_mul_f32 v82, v64, v47
    v_mul_f32 v83, v65, v47
    v_exp_f32 v82, v82
    v_fract_f32 v83, v83
    v_cos_f32 v74, v83
    v_sin_f32 v75, v83
    v_mul_f32 v74, v74, v82
    v_mul_f32 v75, v75, v82
    v_mul_f32 v84, v75, v75
    v_add_f32 v85, v74, v74
    v_fma_f32 v76, v74, v74, -v84
    v_mul_f32 v77, v85, v75
    v_mul_f32 v84, v77, v77
    v_add_f32 v85, v76, v76
    v_fma_f32 v78, v76, v76, -v84
    v_mul_f32 v79, v85, v77
    v_mul_f32 v84, v79, v79
    v_add_f32 v85, v78, v78
    v_fma_f32 v80, v78, v78, -v84
    v_mul_f32 v81, v85, v79
    v_mul_f32 v82, v64, v44
    v_mul_f32 v83, v65, v44
    v_exp_f32 v82, v82
    v_fract_f32 v83, v83
    v_cos_f32 v68, v83
    v_sin_f32 v69, v83
    v_mul_f32 v68, v68, v82
    v_mul_f32 v69, v69, v82
    v_mul_f32 v84, v67, v69
    v_mul_f32 v85, v67, v68
    v_fma_f32 v68, v66, v68, -v84
    v_fma_f32 v69, -v66, v69, -v85
    v_mul_f32 v82, v64, v45
    v_mul_f32 v83, v65, v45
    v_exp_f32 v82, v82
    v_fract_f32 v83, v83
    v_cos_f32 v70, v83
    v_sin_f32 v71, v83
    v_mul_f32 v70, v70, v82
    v_mul_f32 v71, v71, v82
    v_mul_f32 v84, v67, v71
    v_mul_f32 v85, v67, v70
    v_fma_f32 v70, v66, v70, -v84
    v_fma_f32 v71, -v66, v71, -v85
    v_mul_f32 v82, v64, v46
    v_mul_f32 v83, v65, v46
    v_exp_f32 v82, v82
    v_fract_f32 v83, v83
    v_cos_f32 v72, v83
    v_sin_f32 v73, v83
    v_mul_f32 v72, v72, v82
    v_mul_f32 v73, v73, v82
    v_mul_f32 v84, v67, v73
    v_mul_f32 v85, v67, v72
    v_fma_f32 v72, v66, v72, -v84
    v_fma_f32 v73, -v66, v73, -v85
    v_mfma_f32_16x16x4_f32 v[48:51], v68, v74, v[48:51]
    v_mfma_f32_16x16x4_f32 v[52:55], v70, v76, v[52:55]
    v_mfma_f32_16x16x4_f32 v[56:59], v70, v78, v[56:59]
    v_mfma_f32_16x16x4_f32 v[60:63], v72, v80, v[60:63]
    v_mfma_f32_16x16x4_f32 v[48:51], v69, v75, v[48:51]
    v_mfma_f32_16x16x4_f32 v[52:55], v71, v77, v[52:55]
    v_mfma_f32_16x16x4_f32 v[56:59], v71, v79, v[56:59]
    v_mfma_f32_16x16x4_f32 v[60:63], v73, v81, v[60:63]
    v_mov_b32_dpp v64, v28 row_newbcast:10 row_mask:0xf bank_mask:0xf
    v_mov_b32_dpp v65, v29 row_newbcast:10 row_mask:0xf bank_mask:0xf
    v_mov_b32_dpp v66, v30 row_newbcast:10 row_mask:0xf bank_mask:0xf
    v_mov_b32_dpp v67, v31 row_newbcast:10 row_mask:0xf bank_mask:0xf
    v_mul_f32 v82, v64, v47
    v_mul_f32 v83, v65, v47
    v_exp_f32 v82, v82
    v_fract_f32 v83, v83
    v_cos_f32 v74, v83
    v_sin_f32 v75, v83
    v_mul_f32 v74, v74, v82
    v_mul_f32 v75, v75, v82
    v_mul_f32 v84, v75, v75
    v_add_f32 v85, v74, v74
    v_fma_f32 v76, v74, v74, -v84
    v_mul_f32 v77, v85, v75
    v_mul_f32 v84, v77, v77
    v_add_f32 v85, v76, v76
    v_fma_f32 v78, v76, v76, -v84
    v_mul_f32 v79, v85, v77
    v_mul_f32 v84, v79, v79
    v_add_f32 v85, v78, v78
    v_fma_f32 v80, v78, v78, -v84
    v_mul_f32 v81, v85, v79
    v_mul_f32 v82, v64, v44
    v_mul_f32 v83, v65, v44
    v_exp_f32 v82, v82
    v_fract_f32 v83, v83
    v_cos_f32 v68, v83
    v_sin_f32 v69, v83
    v_mul_f32 v68, v68, v82
    v_mul_f32 v69, v69, v82
    v_mul_f32 v84, v67, v69
    v_mul_f32 v85, v67, v68
    v_fma_f32 v68, v66, v68, -v84
    v_fma_f32 v69, -v66, v69, -v85
    v_mul_f32 v82, v64, v45
    v_mul_f32 v83, v65, v45
    v_exp_f32 v82, v82
    v_fract_f32 v83, v83
    v_cos_f32 v70, v83
    v_sin_f32 v71, v83
    v_mul_f32 v70, v70, v82
    v_mul_f32 v71, v71, v82
    v_mul_f32 v84, v67, v71
    v_mul_f32 v85, v67, v70
    v_fma_f32 v70, v66, v70, -v84
    v_fma_f32 v71, -v66, v71, -v85
    v_mul_f32 v82, v64, v46
    v_mul_f32 v83, v65, v46
    v_exp_f32 v82, v82
    v_fract_f32 v83, v83
    v_cos_f32 v72, v83
    v_sin_f32 v73, v83
    v_mul_f32 v72, v72, v82
    v_mul_f32 v73, v73, v82
    v_mul_f32 v84, v67, v73
    v_mul_f32 v85, v67, v72
    v_fma_f32 v72, v66, v72, -v84
    v_fma_f32 v73, -v66, v73, -v85
    v_mfma_f32_16x16x4_f32 v[48:51], v68, v74, v[48:51]
    v_mfma_f32_16x16x4_f32 v[52:55], v70, v76, v[52:55]
    v_mfma_f32_16x16x4_f32 v[56:59], v70, v78, v[56:59]
    v_mfma_f32_16x16x4_f32 v[60:63], v72, v80, v[60:63]
    v_mfma_f32_16x16x4_f32 v[48:51], v69, v75, v[48:51]
    v_mfma_f32_16x16x4_f32 v[52:55], v71, v77, v[52:55]
    v_mfma_f32_16x16x4_f32 v[56:59], v71, v79, v[56:59]
    v_mfma_f32_16x16x4_f32 v[60:63], v73, v81, v[60:63]
    v_mov_b32_dpp v64, v28 row_newbcast:11 row_mask:0xf bank_mask:0xf
    v_mov_b32_dpp v65, v29 row_newbcast:11 row_mask:0xf bank_mask:0xf
    v_mov_b32_dpp v66, v30 row_newbcast:11 row_mask:0xf bank_mask:0xf
    v_mov_b32_dpp v67, v31 row_newbcast:11 row_mask:0xf bank_mask:0xf
    v_mul_f32 v82, v64, v47
    v_mul_f32 v83, v65, v47
    v_exp_f32 v82, v82
    v_fract_f32 v83, v83
    v_cos_f32 v74, v83
    v_sin_f32 v75, v83
    v_mul_f32 v74, v74, v82
    v_mul_f32 v75, v75, v82
    v_mul_f32 v84, v75, v75
    v_add_f32 v85, v74, v74
    v_fma_f32 v76, v74, v74, -v84
    v_mul_f32 v77, v85, v75
    v_mul_f32 v84, v77, v77
    v_add_f32 v85, v76, v76
    v_fma_f32 v78, v76, v76, -v84
    v_mul_f32 v79, v85, v77
    v_mul_f32 v84, v79, v79
    v_add_f32 v85, v78, v78
    v_fma_f32 v80, v78, v78, -v84
    v_mul_f32 v81, v85, v79
    v_mul_f32 v82, v64, v44
    v_mul_f32 v83, v65, v44
    v_exp_f32 v82, v82
    v_fract_f32 v83, v83
    v_cos_f32 v68, v83
    v_sin_f32 v69, v83
    v_mul_f32 v68, v68, v82
    v_mul_f32 v69, v69, v82
    v_mul_f32 v84, v67, v69
    v_mul_f32 v85, v67, v68
    v_fma_f32 v68, v66, v68, -v84
    v_fma_f32 v69, -v66, v69, -v85
    v_mul_f32 v82, v64, v45
    v_mul_f32 v83, v65, v45
    v_exp_f32 v82, v82
    v_fract_f32 v83, v83
    v_cos_f32 v70, v83
    v_sin_f32 v71, v83
    v_mul_f32 v70, v70, v82
    v_mul_f32 v71, v71, v82
    v_mul_f32 v84, v67, v71
    v_mul_f32 v85, v67, v70
    v_fma_f32 v70, v66, v70, -v84
    v_fma_f32 v71, -v66, v71, -v85
    v_mul_f32 v82, v64, v46
    v_mul_f32 v83, v65, v46
    v_exp_f32 v82, v82
    v_fract_f32 v83, v83
    v_cos_f32 v72, v83
    v_sin_f32 v73, v83
    v_mul_f32 v72, v72, v82
    v_mul_f32 v73, v73, v82
    v_mul_f32 v84, v67, v73
    v_mul_f32 v85, v67, v72
    v_fma_f32 v72, v66, v72, -v84
    v_fma_f32 v73, -v66, v73, -v85
    v_mfma_f32_16x16x4_f32 v[48:51], v68, v74, v[48:51]
    v_mfma_f32_16x16x4_f32 v[52:55], v70, v76, v[52:55]
    v_mfma_f32_16x16x4_f32 v[56:59], v70, v78, v[56:59]
    v_mfma_f32_16x16x4_f32 v[60:63], v72, v80, v[60:63]
    v_mfma_f32_16x16x4_f32 v[48:51], v69, v75, v[48:51]
    v_mfma_f32_16x16x4_f32 v[52:55], v71, v77, v[52:55]
    v_mfma_f32_16x16x4_f32 v[56:59], v71, v79, v[56:59]
    v_mfma_f32_16x16x4_f32 v[60:63], v73, v81, v[60:63]
    v_mov_b32_dpp v64, v28 row_newbcast:12 row_mask:0xf bank_mask:0xf
    v_mov_b32_dpp v65, v29 row_newbcast:12 row_mask:0xf bank_mask:0xf
    v_mov_b32_dpp v66, v30 row_newbcast:12 row_mask:0xf bank_mask:0xf
    v_mov_b32_dpp v67, v31 row_newbcast:12 row_mask:0xf bank_mask:0xf
    v_mul_f32 v82, v64, v47
    v_mul_f32 v83, v65, v47
    v_exp_f32 v82, v82
    v_fract_f32 v83, v83
    v_cos_f32 v74, v83
    v_sin_f32 v75, v83
    v_mul_f32 v74, v74, v82
    v_mul_f32 v75, v75, v82
    v_mul_f32 v84, v75, v75
    v_add_f32 v85, v74, v74
    v_fma_f32 v76, v74, v74, -v84
    v_mul_f32 v77, v85, v75
    v_mul_f32 v84, v77, v77
    v_add_f32 v85, v76, v76
    v_fma_f32 v78, v76, v76, -v84
    v_mul_f32 v79, v85, v77
    v_mul_f32 v84, v79, v79
    v_add_f32 v85, v78, v78
    v_fma_f32 v80, v78, v78, -v84
    v_mul_f32 v81, v85, v79
    v_mul_f32 v82, v64, v44
    v_mul_f32 v83, v65, v44
    v_exp_f32 v82, v82
    v_fract_f32 v83, v83
    v_cos_f32 v68, v83
    v_sin_f32 v69, v83
    v_mul_f32 v68, v68, v82
    v_mul_f32 v69, v69, v82
    v_mul_f32 v84, v67, v69
    v_mul_f32 v85, v67, v68
    v_fma_f32 v68, v66, v68, -v84
    v_fma_f32 v69, -v66, v69, -v85
    v_mul_f32 v82, v64, v45
    v_mul_f32 v83, v65, v45
    v_exp_f32 v82, v82
    v_fract_f32 v83, v83
    v_cos_f32 v70, v83
    v_sin_f32 v71, v83
    v_mul_f32 v70, v70, v82
    v_mul_f32 v71, v71, v82
    v_mul_f32 v84, v67, v71
    v_mul_f32 v85, v67, v70
    v_fma_f32 v70, v66, v70, -v84
    v_fma_f32 v71, -v66, v71, -v85
    v_mul_f32 v82, v64, v46
    v_mul_f32 v83, v65, v46
    v_exp_f32 v82, v82
    v_fract_f32 v83, v83
    v_cos_f32 v72, v83
    v_sin_f32 v73, v83
    v_mul_f32 v72, v72, v82
    v_mul_f32 v73, v73, v82
    v_mul_f32 v84, v67, v73
    v_mul_f32 v85, v67, v72
    v_fma_f32 v72, v66, v72, -v84
    v_fma_f32 v73, -v66, v73, -v85
    v_mfma_f32_16x16x4_f32 v[48:51], v68, v74, v[48:51]
    v_mfma_f32_16x16x4_f32 v[52:55], v70, v76, v[52:55]
    v_mfma_f32_16x16x4_f32 v[56:59], v70, v78, v[56:59]
    v_mfma_f32_16x16x4_f32 v[60:63], v72, v80, v[60:63]
    v_mfma_f32_16x16x4_f32 v[48:51], v69, v75, v[48:51]
    v_mfma_f32_16x16x4_f32 v[52:55], v71, v77, v[52:55]
    v_mfma_f32_16x16x4_f32 v[56:59], v71, v79, v[56:59]
    v_mfma_f32_16x16x4_f32 v[60:63], v73, v81, v[60:63]
    v_mov_b32_dpp v64, v28 row_newbcast:13 row_mask:0xf bank_mask:0xf
    v_mov_b32_dpp v65, v29 row_newbcast:13 row_mask:0xf bank_mask:0xf
    v_mov_b32_dpp v66, v30 row_newbcast:13 row_mask:0xf bank_mask:0xf
    v_mov_b32_dpp v67, v31 row_newbcast:13 row_mask:0xf bank_mask:0xf
    v_mul_f32 v82, v64, v47
    v_mul_f32 v83, v65, v47
    v_exp_f32 v82, v82
    v_fract_f32 v83, v83
    v_cos_f32 v74, v83
    v_sin_f32 v75, v83
    v_mul_f32 v74, v74, v82
    v_mul_f32 v75, v75, v82
    v_mul_f32 v84, v75, v75
    v_add_f32 v85, v74, v74
    v_fma_f32 v76, v74, v74, -v84
    v_mul_f32 v77, v85, v75
    v_mul_f32 v84, v77, v77
    v_add_f32 v85, v76, v76
    v_fma_f32 v78, v76, v76, -v84
    v_mul_f32 v79, v85, v77
    v_mul_f32 v84, v79, v79
    v_add_f32 v85, v78, v78
    v_fma_f32 v80, v78, v78, -v84
    v_mul_f32 v81, v85, v79
    v_mul_f32 v82, v64, v44
    v_mul_f32 v83, v65, v44
    v_exp_f32 v82, v82
    v_fract_f32 v83, v83
    v_cos_f32 v68, v83
    v_sin_f32 v69, v83
    v_mul_f32 v68, v68, v82
    v_mul_f32 v69, v69, v82
    v_mul_f32 v84, v67, v69
    v_mul_f32 v85, v67, v68
    v_fma_f32 v68, v66, v68, -v84
    v_fma_f32 v69, -v66, v69, -v85
    v_mul_f32 v82, v64, v45
    v_mul_f32 v83, v65, v45
    v_exp_f32 v82, v82
    v_fract_f32 v83, v83
    v_cos_f32 v70, v83
    v_sin_f32 v71, v83
    v_mul_f32 v70, v70, v82
    v_mul_f32 v71, v71, v82
    v_mul_f32 v84, v67, v71
    v_mul_f32 v85, v67, v70
    v_fma_f32 v70, v66, v70, -v84
    v_fma_f32 v71, -v66, v71, -v85
    v_mul_f32 v82, v64, v46
    v_mul_f32 v83, v65, v46
    v_exp_f32 v82, v82
    v_fract_f32 v83, v83
    v_cos_f32 v72, v83
    v_sin_f32 v73, v83
    v_mul_f32 v72, v72, v82
    v_mul_f32 v73, v73, v82
    v_mul_f32 v84, v67, v73
    v_mul_f32 v85, v67, v72
    v_fma_f32 v72, v66, v72, -v84
    v_fma_f32 v73, -v66, v73, -v85
    v_mfma_f32_16x16x4_f32 v[48:51], v68, v74, v[48:51]
    v_mfma_f32_16x16x4_f32 v[52:55], v70, v76, v[52:55]
    v_mfma_f32_16x16x4_f32 v[56:59], v70, v78, v[56:59]
    v_mfma_f32_16x16x4_f32 v[60:63], v72, v80, v[60:63]
    v_mfma_f32_16x16x4_f32 v[48:51], v69, v75, v[48:51]
    v_mfma_f32_16x16x4_f32 v[52:55], v71, v77, v[52:55]
    v_mfma_f32_16x16x4_f32 v[56:59], v71, v79, v[56:59]
    v_mfma_f32_16x16x4_f32 v[60:63], v73, v81, v[60:63]
    v_mov_b32_dpp v64, v28 row_newbcast:14 row_mask:0xf bank_mask:0xf
    v_mov_b32_dpp v65, v29 row_newbcast:14 row_mask:0xf bank_mask:0xf
    v_mov_b32_dpp v66, v30 row_newbcast:14 row_mask:0xf bank_mask:0xf
    v_mov_b32_dpp v67, v31 row_newbcast:14 row_mask:0xf bank_mask:0xf
    v_mul_f32 v82, v64, v47
    v_mul_f32 v83, v65, v47
    v_exp_f32 v82, v82
    v_fract_f32 v83, v83
    v_cos_f32 v74, v83
    v_sin_f32 v75, v83
    v_mul_f32 v74, v74, v82
    v_mul_f32 v75, v75, v82
    v_mul_f32 v84, v75, v75
    v_add_f32 v85, v74, v74
    v_fma_f32 v76, v74, v74, -v84
    v_mul_f32 v77, v85, v75
    v_mul_f32 v84, v77, v77
    v_add_f32 v85, v76, v76
    v_fma_f32 v78, v76, v76, -v84
    v_mul_f32 v79, v85, v77
    v_mul_f32 v84, v79, v79
    v_add_f32 v85, v78, v78
    v_fma_f32 v80, v78, v78, -v84
    v_mul_f32 v81, v85, v79
    v_mul_f32 v82, v64, v44
    v_mul_f32 v83, v65, v44
    v_exp_f32 v82, v82
    v_fract_f32 v83, v83
    v_cos_f32 v68, v83
    v_sin_f32 v69, v83
    v_mul_f32 v68, v68, v82
    v_mul_f32 v69, v69, v82
    v_mul_f32 v84, v67, v69
    v_mul_f32 v85, v67, v68
    v_fma_f32 v68, v66, v68, -v84
    v_fma_f32 v69, -v66, v69, -v85
    v_mul_f32 v82, v64, v45
    v_mul_f32 v83, v65, v45
    v_exp_f32 v82, v82
    v_fract_f32 v83, v83
    v_cos_f32 v70, v83
    v_sin_f32 v71, v83
    v_mul_f32 v70, v70, v82
    v_mul_f32 v71, v71, v82
    v_mul_f32 v84, v67, v71
    v_mul_f32 v85, v67, v70
    v_fma_f32 v70, v66, v70, -v84
    v_fma_f32 v71, -v66, v71, -v85
    v_mul_f32 v82, v64, v46
    v_mul_f32 v83, v65, v46
    v_exp_f32 v82, v82
    v_fract_f32 v83, v83
    v_cos_f32 v72, v83
    v_sin_f32 v73, v83
    v_mul_f32 v72, v72, v82
    v_mul_f32 v73, v73, v82
    v_mul_f32 v84, v67, v73
    v_mul_f32 v85, v67, v72
    v_fma_f32 v72, v66, v72, -v84
    v_fma_f32 v73, -v66, v73, -v85
    v_mfma_f32_16x16x4_f32 v[48:51], v68, v74, v[48:51]
    v_mfma_f32_16x16x4_f32 v[52:55], v70, v76, v[52:55]
    v_mfma_f32_16x16x4_f32 v[56:59], v70, v78, v[56:59]
    v_mfma_f32_16x16x4_f32 v[60:63], v72, v80, v[60:63]
    v_mfma_f32_16x16x4_f32 v[48:51], v69, v75, v[48:51]
    v_mfma_f32_16x16x4_f32 v[52:55], v71, v77, v[52:55]
    v_mfma_f32_16x16x4_f32 v[56:59], v71, v79, v[56:59]
    v_mfma_f32_16x16x4_f32 v[60:63], v73, v81, v[60:63]
    v_mov_b32_dpp v64, v28 row_newbcast:15 row_mask:0xf bank_mask:0xf
    v_mov_b32_dpp v65, v29 row_newbcast:15 row_mask:0xf bank_mask:0xf
    v_mov_b32_dpp v66, v30 row_newbcast:15 row_mask:0xf bank_mask:0xf
    v_mov_b32_dpp v67, v31 row_newbcast:15 row_mask:0xf bank_mask:0xf
    v_mul_f32 v82, v64, v47
    v_mul_f32 v83, v65, v47
    v_exp_f32 v82, v82
    v_fract_f32 v83, v83
    v_cos_f32 v74, v83
    v_sin_f32 v75, v83
    v_mul_f32 v74, v74, v82
    v_mul_f32 v75, v75, v82
    v_mul_f32 v84, v75, v75
    v_add_f32 v85, v74, v74
    v_fma_f32 v76, v74, v74, -v84
    v_mul_f32 v77, v85, v75
    v_mul_f32 v84, v77, v77
    v_add_f32 v85, v76, v76
    v_fma_f32 v78, v76, v76, -v84
    v_mul_f32 v79, v85, v77
    v_mul_f32 v84, v79, v79
    v_add_f32 v85, v78, v78
    v_fma_f32 v80, v78, v78, -v84
    v_mul_f32 v81, v85, v79
    v_mul_f32 v82, v64, v44
    v_mul_f32 v83, v65, v44
    v_exp_f32 v82, v82
    v_fract_f32 v83, v83
    v_cos_f32 v68, v83
    v_sin_f32 v69, v83
    v_mul_f32 v68, v68, v82
    v_mul_f32 v69, v69, v82
    v_mul_f32 v84, v67, v69
    v_mul_f32 v85, v67, v68
    v_fma_f32 v68, v66, v68, -v84
    v_fma_f32 v69, -v66, v69, -v85
    v_mul_f32 v82, v64, v45
    v_mul_f32 v83, v65, v45
    v_exp_f32 v82, v82
    v_fract_f32 v83, v83
    v_cos_f32 v70, v83
    v_sin_f32 v71, v83
    v_mul_f32 v70, v70, v82
    v_mul_f32 v71, v71, v82
    v_mul_f32 v84, v67, v71
    v_mul_f32 v85, v67, v70
    v_fma_f32 v70, v66, v70, -v84
    v_fma_f32 v71, -v66, v71, -v85
    v_mul_f32 v82, v64, v46
    v_mul_f32 v83, v65, v46
    v_exp_f32 v82, v82
    v_fract_f32 v83, v83
    v_cos_f32 v72, v83
    v_sin_f32 v73, v83
    v_mul_f32 v72, v72, v82
    v_mul_f32 v73, v73, v82
    v_mul_f32 v84, v67, v73
    v_mul_f32 v85, v67, v72
    v_fma_f32 v72, v66, v72, -v84
    v_fma_f32 v73, -v66, v73, -v85
    v_mfma_f32_16x16x4_f32 v[48:51], v68, v74, v[48:51]
    v_mfma_f32_16x16x4_f32 v[52:55], v70, v76, v[52:55]
    v_mfma_f32_16x16x4_f32 v[56:59], v70, v78, v[56:59]
    v_mfma_f32_16x16x4_f32 v[60:63], v72, v80, v[60:63]
    v_mfma_f32_16x16x4_f32 v[48:51], v69, v75, v[48:51]
    v_mfma_f32_16x16x4_f32 v[52:55], v71, v77, v[52:55]
    v_mfma_f32_16x16x4_f32 v[56:59], v71, v79, v[56:59]
    v_mfma_f32_16x16x4_f32 v[60:63], v73, v81, v[60:63]
    v_lshlrev_b32 v5, 8, v3
    v_lshl_add_u32 v5, v2, 2, v5
    v_add_u32 v5, v5, v4
    ds_write_b32 v5, v48 offset:4608
    ds_write_b32 v5, v49 offset:4672
    ds_write_b32 v5, v50 offset:4736
    ds_write_b32 v5, v51 offset:4800
    v_cmp_gt_u32 vcc, 2, v3
    s_nop 0
    s_mov_b64 exec, vcc
    ds_write_b32 v5, v52 offset:5632
    ds_write_b32 v5, v53 offset:5696
    ds_write_b32 v5, v54 offset:5760
    ds_write_b32 v5, v55 offset:5824
    ds_write_b32 v5, v60 offset:6656
    ds_write_b32 v5, v61 offset:6720
    ds_write_b32 v5, v62 offset:6784
    ds_write_b32 v5, v63 offset:6848
    s_not_b64 exec, exec
    ds_write_b32 v5, v56 offset:5632
    ds_write_b32 v5, v57 offset:5696
    ds_write_b32 v5, v58 offset:5760
    ds_write_b32 v5, v59 offset:5824
    s_mov_b32 exec_lo, 0
    s_mov_b32 exec_hi, 3
    v_cmp_eq_u32 vcc, 0, v2
    s_nop 1
    v_cndmask_b32 v6, 0, v60, vcc
    ds_write_b32 v5, v6 offset:6656
    s_mov_b64 exec, -1
    s_waitcnt lgkmcnt(0)
    v_lshlrev_b32 v7, 1, v1
    v_sub_u32 v7, 2065, v7
    v_lshl_add_u32 v64, v1, 2, v4
    v_mov_b32 v65, 641
    s_mov_b32 s25, 17
ss_exp:
    v_subrev_u32 v66, 0, v7
    v_cvt_f32_u32 v70, v66
    v_cvt_pk_bf16_f32 v70, v70, v70
    v_and_b32 v70, 0xffff, v70
    v_subrev_u32 v70, 0x4280, v70
    v_cmp_gt_u32 vcc, 256, v66
    s_nop 1
    v_cndmask_b32 v70, v70, v66, vcc
    v_cmp_gt_u32 vcc, 2048, v66
    s_nop 1
    v_cndmask_b32 v70, v65, v70, vcc
    v_lshl_add_u32 v70, v70, 2, v4
    ds_read_b32 v74, v70 offset:4608
    v_subrev_u32 v67, 1, v7
    v_cvt_f32_u32 v71, v67
    v_cvt_pk_bf16_f32 v71, v71, v71
    v_and_b32 v71, 0xffff, v71
    v_subrev_u32 v71, 0x4280, v71
    v_cmp_gt_u32 vcc, 256, v67
    s_nop 1
    v_cndmask_b32 v71, v71, v67, vcc
    v_cmp_gt_u32 vcc, 2048, v67
    s_nop 1
    v_cndmask_b32 v71, v65, v71, vcc
    v_lshl_add_u32 v71, v71, 2, v4
    ds_read_b32 v75, v71 offset:4608
    v_subrev_u32 v68, 2, v7
    v_cvt_f32_u32 v72, v68
    v_cvt_pk_bf16_f32 v72, v72, v72
    v_and_b32 v72, 0xffff, v72
    v_subrev_u32 v72, 0x4280, v72
    v_cmp_gt_u32 vcc, 256, v68
    s_nop 1
    v_cndmask_b32 v72, v72, v68, vcc
    v_cmp_gt_u32 vcc, 2048, v68
    s_nop 1
    v_cndmask_b32 v72, v65, v72, vcc
    v_lshl_add_u32 v72, v72, 2, v4
    ds_read_b32 v76, v72 offset:4608
    s_waitcnt lgkmcnt(0)
    v_cvt_pk_bf16_f32 v78, v75, v76
    v_cvt_pk_bf16_f32 v79, v74, v75
    ds_write_b32 v64, v78 offset:7424
    ds_write_b32 v64, v79 offset:11776
    v_subrev_u32 v7, 128, v7
    v_add_u32 v64, 256, v64
    s_sub_u32 s25, s25, 1
    s_cmp_lg_u32 s25, 0
    s_cbranch_scc1 ss_exp
    s_waitcnt lgkmcnt(0)
    s_barrier
    v_and_b32 v5, 1, v2
    v_mul_u32_u24 v64, 4352, v5
    v_sub_u32 v5, v5, v2
    v_lshl_add_u32 v5, v3, 3, v5
    v_lshl_add_u32 v64, v5, 1, v64
    v_add_u32 v64, 11520, v64
    v_add_u32 v64, v64, v4
    v_lshlrev_b32 v65, 5, v2
    v_lshl_add_u32 v65, v3, 4, v65
    v_add_u32 v65, 480, v65
    v_add_u32 v65, v65, v4
    v_mov_b32 v96, 0
    v_mov_b32 v97, 0
    v_mov_b32 v98, 0
    v_mov_b32 v99, 0
    v_mov_b32 v100, 0
    v_mov_b32 v101, 0
    v_mov_b32 v102, 0
    v_mov_b32 v103, 0
    v_mov_b32 v104, 0
    v_mov_b32 v105, 0
    v_mov_b32 v106, 0
    v_mov_b32 v107, 0
    v_mov_b32 v108, 0
    v_mov_b32 v109, 0
    v_mov_b32 v110, 0
    v_mov_b32 v111, 0
    v_mov_b32 v112, 0
    v_mov_b32 v113, 0
    v_mov_b32 v114, 0
    v_mov_b32 v115, 0
    v_mov_b32 v116, 0
    v_mov_b32 v117, 0
    v_mov_b32 v118, 0
    v_mov_b32 v119, 0
    v_mov_b32 v120, 0
    v_mov_b32 v121, 0
    v_mov_b32 v122, 0
    v_mov_b32 v123, 0
    v_mov_b32 v124, 0
    v_mov_b32 v125, 0
    v_mov_b32 v126, 0
    v_mov_b32 v127, 0
    s_mov_b32 s25, 8
ss_cv0:
    ds_read2_b32 v[68:69], v64 offset0:0 offset1:1
    ds_read2_b32 v[70:71], v64 offset0:2 offset1:3
    ds_read_b128 v[128:131], v65 offset:0
    ds_read_b128 v[132:135], v65 offset:512
    ds_read_b128 v[136:139], v65 offset:1024
    ds_read_b128 v[140:143], v65 offset:1536
    ds_read_b128 v[144:147], v65 offset:2048
    ds_read_b128 v[148:151], v65 offset:2560
    ds_read_b128 v[152:155], v65 offset:3072
    ds_read_b128 v[156:159], v65 offset:3584
    v_subrev_u32 v64, 64, v64
    v_subrev_u32 v65, 64, v65
    s_waitcnt lgkmcnt(7)
    v_mfma_f32_16x16x32_bf16 v[96:99], v[68:71], v[128:131], v[96:99]
    s_waitcnt lgkmcnt(6)
    v_mfma_f32_16x16x32_bf16 v[100:103], v[68:71], v[132:135], v[100:103]
    s_waitcnt lgkmcnt(5)
    v_mfma_f32_16x16x32_bf16 v[104:107], v[68:71], v[136:139], v[104:107]
    s_waitcnt lgkmcnt(4)
    v_mfma_f32_16x16x32_bf16 v[108:111], v[68:71], v[140:143], v[108:111]
    s_waitcnt lgkmcnt(3)
    v_mfma_f32_16x16x32_bf16 v[112:115], v[68:71], v[144:147], v[112:115]
    s_waitcnt lgkmcnt(2)
    v_mfma_f32_16x16x32_bf16 v[116:119], v[68:71], v[148:151], v[116:119]
    s_waitcnt lgkmcnt(1)
    v_mfma_f32_16x16x32_bf16 v[120:123], v[68:71], v[152:155], v[120:123]
    s_waitcnt lgkmcnt(0)
    v_mfma_f32_16x16x32_bf16 v[124:127], v[68:71], v[156:159], v[124:127]
    s_sub_u32 s25, s25, 1
    s_cmp_lg_u32 s25, 0
    s_cbranch_scc1 ss_cv0
    v_add_u32 v65, 512, v65
    s_mov_b32 s25, 8
ss_cv1:
    ds_read2_b32 v[68:69], v64 offset0:0 offset1:1
    ds_read2_b32 v[70:71], v64 offset0:2 offset1:3
    ds_read_b128 v[132:135], v65 offset:0
    ds_read_b128 v[136:139], v65 offset:512
    ds_read_b128 v[140:143], v65 offset:1024
    ds_read_b128 v[144:147], v65 offset:1536
    ds_read_b128 v[148:151], v65 offset:2048
    ds_read_b128 v[152:155], v65 offset:2560
    ds_read_b128 v[156:159], v65 offset:3072
    v_subrev_u32 v64, 64, v64
    v_subrev_u32 v65, 64, v65
    s_waitcnt lgkmcnt(6)
    v_mfma_f32_16x16x32_bf16 v[100:103], v[68:71], v[132:135], v[100:103]
    s_waitcnt lgkmcnt(5)
    v_mfma_f32_16x16x32_bf16 v[104:107], v[68:71], v[136:139], v[104:107]
    s_waitcnt lgkmcnt(4)
    v_mfma_f32_16x16x32_bf16 v[108:111], v[68:71], v[140:143], v[108:111]
    s_waitcnt lgkmcnt(3)
    v_mfma_f32_16x16x32_bf16 v[112:115], v[68:71], v[144:147], v[112:115]
    s_waitcnt lgkmcnt(2)
    v_mfma_f32_16x16x32_bf16 v[116:119], v[68:71], v[148:151], v[116:119]
    s_waitcnt lgkmcnt(1)
    v_mfma_f32_16x16x32_bf16 v[120:123], v[68:71], v[152:155], v[120:123]
    s_waitcnt lgkmcnt(0)
    v_mfma_f32_16x16x32_bf16 v[124:127], v[68:71], v[156:159], v[124:127]
    s_sub_u32 s25, s25, 1
    s_cmp_lg_u32 s25, 0
    s_cbranch_scc1 ss_cv1
    v_add_u32 v65, 512, v65
    s_mov_b32 s25, 8
ss_cv2:
    ds_read2_b32 v[68:69], v64 offset0:0 offset1:1
    ds_read2_b32 v[70:71], v64 offset0:2 offset1:3
    ds_read_b128 v[136:139], v65 offset:0
    ds_read_b128 v[140:143], v65 offset:512
    ds_read_b128 v[144:147], v65 offset:1024
    ds_read_b128 v[148:151], v65 offset:1536
    ds_read_b128 v[152:155], v65 offset:2048
    ds_read_b128 v[156:159], v65 offset:2560
    v_subrev_u32 v64, 64, v64
    v_subrev_u32 v65, 64, v65
    s_waitcnt lgkmcnt(5)
    v_mfma_f32_16x16x32_bf16 v[104:107], v[68:71], v[136:139], v[104:107]
    s_waitcnt lgkmcnt(4)
    v_mfma_f32_16x16x32_bf16 v[108:111], v[68:71], v[140:143], v[108:111]
    s_waitcnt lgkmcnt(3)
    v_mfma_f32_16x16x32_bf16 v[112:115], v[68:71], v[144:147], v[112:115]
    s_waitcnt lgkmcnt(2)
    v_mfma_f32_16x16x32_bf16 v[116:119], v[68:71], v[148:151], v[116:119]
    s_waitcnt lgkmcnt(1)
    v_mfma_f32_16x16x32_bf16 v[120:123], v[68:71], v[152:155], v[120:123]
    s_waitcnt lgkmcnt(0)
    v_mfma_f32_16x16x32_bf16 v[124:127], v[68:71], v[156:159], v[124:127]
    s_sub_u32 s25, s25, 1
    s_cmp_lg_u32 s25, 0
    s_cbranch_scc1 ss_cv2
    v_add_u32 v65, 512, v65
    s_mov_b32 s25, 8
ss_cv3:
    ds_read2_b32 v[68:69], v64 offset0:0 offset1:1
    ds_read2_b32 v[70:71], v64 offset0:2 offset1:3
    ds_read_b128 v[140:143], v65 offset:0
    ds_read_b128 v[144:147], v65 offset:512
    ds_read_b128 v[148:151], v65 offset:1024
    ds_read_b128 v[152:155], v65 offset:1536
    ds_read_b128 v[156:159], v65 offset:2048
    v_subrev_u32 v64, 64, v64
    v_subrev_u32 v65, 64, v65
    s_waitcnt lgkmcnt(4)
    v_mfma_f32_16x16x32_bf16 v[108:111], v[68:71], v[140:143], v[108:111]
    s_waitcnt lgkmcnt(3)
    v_mfma_f32_16x16x32_bf16 v[112:115], v[68:71], v[144:147], v[112:115]
    s_waitcnt lgkmcnt(2)
    v_mfma_f32_16x16x32_bf16 v[116:119], v[68:71], v[148:151], v[116:119]
    s_waitcnt lgkmcnt(1)
    v_mfma_f32_16x16x32_bf16 v[120:123], v[68:71], v[152:155], v[120:123]
    s_waitcnt lgkmcnt(0)
    v_mfma_f32_16x16x32_bf16 v[124:127], v[68:71], v[156:159], v[124:127]
    s_sub_u32 s25, s25, 1
    s_cmp_lg_u32 s25, 0
    s_cbranch_scc1 ss_cv3
    v_add_u32 v65, 512, v65
    s_mov_b32 s25, 8
ss_cv4:
    ds_read2_b32 v[68:69], v64 offset0:0 offset1:1
    ds_read2_b32 v[70:71], v64 offset0:2 offset1:3
    ds_read_b128 v[144:147], v65 offset:0
    ds_read_b128 v[148:151], v65 offset:512
    ds_read_b128 v[152:155], v65 offset:1024
    ds_read_b128 v[156:159], v65 offset:1536
    v_subrev_u32 v64, 64, v64
    v_subrev_u32 v65, 64, v65
    s_waitcnt lgkmcnt(3)
    v_mfma_f32_16x16x32_bf16 v[112:115], v[68:71], v[144:147], v[112:115]
    s_waitcnt lgkmcnt(2)
    v_mfma_f32_16x16x32_bf16 v[116:119], v[68:71], v[148:151], v[116:119]
    s_waitcnt lgkmcnt(1)
    v_mfma_f32_16x16x32_bf16 v[120:123], v[68:71], v[152:155], v[120:123]
    s_waitcnt lgkmcnt(0)
    v_mfma_f32_16x16x32_bf16 v[124:127], v[68:71], v[156:159], v[124:127]
    s_sub_u32 s25, s25, 1
    s_cmp_lg_u32 s25, 0
    s_cbranch_scc1 ss_cv4
    v_add_u32 v65, 512, v65
    s_mov_b32 s25, 8
ss_cv5:
    ds_read2_b32 v[68:69], v64 offset0:0 offset1:1
    ds_read2_b32 v[70:71], v64 offset0:2 offset1:3
    ds_read_b128 v[148:151], v65 offset:0
    ds_read_b128 v[152:155], v65 offset:512
    ds_read_b128 v[156:159], v65 offset:1024
    v_subrev_u32 v64, 64, v64
    v_subrev_u32 v65, 64, v65
    s_waitcnt lgkmcnt(2)
    v_mfma_f32_16x16x32_bf16 v[116:119], v[68:71], v[148:151], v[116:119]
    s_waitcnt lgkmcnt(1)
    v_mfma_f32_16x16x32_bf16 v[120:123], v[68:71], v[152:155], v[120:123]
    s_waitcnt lgkmcnt(0)
    v_mfma_f32_16x16x32_bf16 v[124:127], v[68:71], v[156:159], v[124:127]
    s_sub_u32 s25, s25, 1
    s_cmp_lg_u32 s25, 0
    s_cbranch_scc1 ss_cv5
    v_add_u32 v65, 512, v65
    s_mov_b32 s25, 8
ss_cv6:
    ds_read2_b32 v[68:69], v64 offset0:0 offset1:1
    ds_read2_b32 v[70:71], v64 offset0:2 offset1:3
    ds_read_b128 v[152:155], v65 offset:0
    ds_read_b128 v[156:159], v65 offset:512
    v_subrev_u32 v64, 64, v64
    v_subrev_u32 v65, 64, v65
    s_waitcnt lgkmcnt(1)
    v_mfma_f32_16x16x32_bf16 v[120:123], v[68:71], v[152:155], v[120:123]
    s_waitcnt lgkmcnt(0)
    v_mfma_f32_16x16x32_bf16 v[124:127], v[68:71], v[156:159], v[124:127]
    s_sub_u32 s25, s25, 1
    s_cmp_lg_u32 s25, 0
    s_cbranch_scc1 ss_cv6
    v_add_u32 v65, 512, v65
    s_mov_b32 s25, 8
ss_cv7:
    ds_read2_b32 v[68:69], v64 offset0:0 offset1:1
    ds_read2_b32 v[70:71], v64 offset0:2 offset1:3
    ds_read_b128 v[156:159], v65 offset:0
    v_subrev_u32 v64, 64, v64
    v_subrev_u32 v65, 64, v65
    s_waitcnt lgkmcnt(0)
    v_mfma_f32_16x16x32_bf16 v[124:127], v[68:71], v[156:159], v[124:127]
    s_sub_u32 s25, s25, 1
    s_cmp_lg_u32 s25, 0
    s_cbranch_scc1 ss_cv7
    v_add_u32 v65, 512, v65
    s_nop 3
    v_lshlrev_b32 v5, 6, v2
    v_lshl_add_u32 v5, v3, 4, v5
    v_add_u32 v5, v5, v4
    ds_write_b128 v5, v[96:99] offset:7424
    ds_write_b128 v5, v[100:103] offset:8448
    ds_write_b128 v5, v[104:107] offset:9472
    ds_write_b128 v5, v[108:111] offset:10496
    ds_write_b128 v5, v[112:115] offset:11520
    ds_write_b128 v5, v[116:119] offset:12544
    ds_write_b128 v5, v[120:123] offset:13568
    ds_write_b128 v5, v[124:127] offset:14592
    s_mov_b32 s12, s74
    s_mov_b32 s13, s75
    s_mov_b32 s14, 1152
    s_mov_b32 s15, 0x20000
    s_lshl_b32 s23, s20, 1
    buffer_load_dwordx2 v[24:25], off, s[12:15], s23
    s_waitcnt vmcnt(0) lgkmcnt(0)
    s_barrier
    v_lshlrev_b32 v26, 16, v24
    v_and_b32 v27, 0xffff0000, v24
    v_lshlrev_b32 v28, 16, v25
    v_and_b32 v29, 0xffff0000, v25
    v_lshlrev_b32 v5, 5, v0
    ds_read_b128 v[64:67], v5 offset:7424
    ds_read_b128 v[68:71], v5 offset:7440
    ds_read_b128 v[72:75], v5 offset:23808
    ds_read_b128 v[76:79], v5 offset:23824
    ds_read_b128 v[80:83], v5 offset:40192
    ds_read_b128 v[84:87], v5 offset:40208
    ds_read_b128 v[88:91], v5 offset:56576
    ds_read_b128 v[92:95], v5 offset:56592
    s_waitcnt lgkmcnt(0)
    v_mul_u32_u24 v5, 18432, v0
    s_lshl_b32 s22, s20, 1
    s_add_u32 s22, s22, 1152
    v_lshlrev_b32 v6, 16, v8
    v_fmac_f32 v64, v6, v26
    v_and_b32 v6, 0xffff0000, v8
    v_fmac_f32 v72, v6, v27
    v_lshlrev_b32 v6, 16, v9
    v_fmac_f32 v80, v6, v28
    v_and_b32 v6, 0xffff0000, v9
    v_fmac_f32 v88, v6, v29
    v_cvt_pk_bf16_f32 v8, v64, v72
    v_cvt_pk_bf16_f32 v9, v80, v88
    s_add_u32 s23, s22, 0
    buffer_store_dwordx2 v[8:9], v5, s[16:19], s23 offen
    v_lshlrev_b32 v6, 16, v10
    v_fmac_f32 v65, v6, v26
    v_and_b32 v6, 0xffff0000, v10
    v_fmac_f32 v73, v6, v27
    v_lshlrev_b32 v6, 16, v11
    v_fmac_f32 v81, v6, v28
    v_and_b32 v6, 0xffff0000, v11
    v_fmac_f32 v89, v6, v29
    v_cvt_pk_bf16_f32 v10, v65, v73
    v_cvt_pk_bf16_f32 v11, v81, v89
    s_add_u32 s23, s22, 2304
    buffer_store_dwordx2 v[10:11], v5, s[16:19], s23 offen
    v_lshlrev_b32 v6, 16, v12
    v_fmac_f32 v66, v6, v26
    v_and_b32 v6, 0xffff0000, v12
    v_fmac_f32 v74, v6, v27
    v_lshlrev_b32 v6, 16, v13
    v_fmac_f32 v82, v6, v28
    v_and_b32 v6, 0xffff0000, v13
    v_fmac_f32 v90, v6, v29
    v_cvt_pk_bf16_f32 v12, v66, v74
    v_cvt_pk_bf16_f32 v13, v82, v90
    s_add_u32 s23, s22, 4608
    buffer_store_dwordx2 v[12:13], v5, s[16:19], s23 offen
    v_lshlrev_b32 v6, 16, v14
    v_fmac_f32 v67, v6, v26
    v_and_b32 v6, 0xffff0000, v14
    v_fmac_f32 v75, v6, v27
    v_lshlrev_b32 v6, 16, v15
    v_fmac_f32 v83, v6, v28
    v_and_b32 v6, 0xffff0000, v15
    v_fmac_f32 v91, v6, v29
    v_cvt_pk_bf16_f32 v14, v67, v75
    v_cvt_pk_bf16_f32 v15, v83, v91
    s_add_u32 s23, s22, 6912
    buffer_store_dwordx2 v[14:15], v5, s[16:19], s23 offen
    v_lshlrev_b32 v6, 16, v16
    v_fmac_f32 v68, v6, v26
    v_and_b32 v6, 0xffff0000, v16
    v_fmac_f32 v76, v6, v27
    v_lshlrev_b32 v6, 16, v17
    v_fmac_f32 v84, v6, v28
    v_and_b32 v6, 0xffff0000, v17
    v_fmac_f32 v92, v6, v29
    v_cvt_pk_bf16_f32 v16, v68, v76
    v_cvt_pk_bf16_f32 v17, v84, v92
    s_add_u32 s23, s22, 9216
    buffer_store_dwordx2 v[16:17], v5, s[16:19], s23 offen
    v_lshlrev_b32 v6, 16, v18
    v_fmac_f32 v69, v6, v26
    v_and_b32 v6, 0xffff0000, v18
    v_fmac_f32 v77, v6, v27
    v_lshlrev_b32 v6, 16, v19
    v_fmac_f32 v85, v6, v28
    v_and_b32 v6, 0xffff0000, v19
    v_fmac_f32 v93, v6, v29
    v_cvt_pk_bf16_f32 v18, v69, v77
    v_cvt_pk_bf16_f32 v19, v85, v93
    s_add_u32 s23, s22, 11520
    buffer_store_dwordx2 v[18:19], v5, s[16:19], s23 offen
    v_lshlrev_b32 v6, 16, v20
    v_fmac_f32 v70, v6, v26
    v_and_b32 v6, 0xffff0000, v20
    v_fmac_f32 v78, v6, v27
    v_lshlrev_b32 v6, 16, v21
    v_fmac_f32 v86, v6, v28
    v_and_b32 v6, 0xffff0000, v21
    v_fmac_f32 v94, v6, v29
    v_cvt_pk_bf16_f32 v20, v70, v78
    v_cvt_pk_bf16_f32 v21, v86, v94
    s_add_u32 s23, s22, 13824
    buffer_store_dwordx2 v[20:21], v5, s[16:19], s23 offen
    v_lshlrev_b32 v6, 16, v22
    v_fmac_f32 v71, v6, v26
    v_and_b32 v6, 0xffff0000, v22
    v_fmac_f32 v79, v6, v27
    v_lshlrev_b32 v6, 16, v23
    v_fmac_f32 v87, v6, v28
    v_and_b32 v6, 0xffff0000, v23
    v_fmac_f32 v95, v6, v29
    v_cvt_pk_bf16_f32 v22, v71, v79
    v_cvt_pk_bf16_f32 v23, v87, v95
    s_add_u32 s23, s22, 16128
    buffer_store_dwordx2 v[22:23], v5, s[16:19], s23 offen
    s_branch L_ssm_next
L_phase2:
    v_and_b32 v1, 63, v0
    v_min_u32 v1, 6, v1
    v_lshlrev_b32 v2, 2, v1
    s_cmp_lg_u32 s32, 0
    v_mov_b32 v251, 163832
    s_cbranch_scc1 sw9
    buffer_load_dword v3, v2, s[96:99], 0 offen offset:32 sc1
    v_mov_b32 v4, 32
    s_waitcnt vmcnt(0)
    v_cmp_lt_u32 vcc, v3, v4
    s_nop 0
    s_ff1_i32_b64 s40, vcc
    v_mov_b32 v250, s40
    ds_write_b32 v251, v250
    s_waitcnt lgkmcnt(0)
sw9:
    s_barrier
    ds_read_b32 v252, v251
    s_waitcnt lgkmcnt(0)
    v_readfirstlane_b32 s33, v252
    s_barrier
    s_nop 1
    s_cmp_lt_u32 s33, 7
    s_cbranch_scc1 L_pool
    s_mov_b32 s88, 4194304
gn10:
    s_cmp_lg_u32 s95, 0
    s_cbranch_scc1 gn10x
    buffer_load_dword v250, off, s[96:99], 0 offset:64 sc1
    s_sub_u32 s88, s88, 1
    s_cbranch_scc1 gn10x
    s_waitcnt vmcnt(0)
    v_readfirstlane_b32 s95, v250
    s_nop 1
    s_branch gn10
gn10x:
    s_mov_b32 s40, 524288
mc2_w:
    buffer_load_dword v250, off, s[96:99], 0 offset:140 sc1
    s_waitcnt vmcnt(0)
    v_readfirstlane_b32 s41, v250
    s_nop 0
    s_cmp_lg_u32 s41, 0
    s_cbranch_scc1 mc2_known
    s_sub_u32 s40, s40, 1
    s_cbranch_scc1 mc2_force
    s_sleep 2
    s_branch mc2_w
mc2_force:
    v_mov_b32 v250, 2
    v_mov_b32 v251, 0
    s_mov_b64 exec, 1
    buffer_atomic_cmpswap v[250:251], off, s[96:99], 0 offset:140
    s_mov_b64 exec, -1
    s_waitcnt vmcnt(0)
    s_mov_b32 s40, 524288
    s_branch mc2_w
mc2_known:
    s_cmp_eq_u32 s41, 1
    s_cbranch_scc1 L_phase2b
    s_mov_b32 s37, 208
    v_mov_b32 v250, 1
    v_mov_b32 v251, 163832
    v_cmp_eq_u32 vcc, 0, v0
    s_nop 0
    s_and_saveexec_b64 s[38:39], vcc
    s_cbranch_execz tk11
    buffer_atomic_add v250, off, s[96:99], s37 sc0
    s_waitcnt vmcnt(0)
    ds_write_b32 v251, v250
    s_waitcnt lgkmcnt(0)
tk11:
    s_mov_b64 exec, -1
    s_barrier
    ds_read_b32 v252, v251
    s_waitcnt lgkmcnt(0)
    v_readfirstlane_b32 s12, v252
    s_barrier
    s_nop 3
    s_cmp_lt_u32 s12, 32
    s_cbranch_scc1 L_chain_safe
L_phase2b:
    s_mov_b32 s8, s76
    s_mov_b32 s9, s77
    s_mov_b32 s10, 4718592
    s_mov_b32 s11, 0x20000
    s_sub_u32 s33, s3, 1
    s_and_b32 s33, s33, 7
    s_cmp_eq_u32 s33, 7
    s_cbranch_scc1 L_p2scan
L_p2take:
    s_lshl_b32 s35, s33, 2
    s_add_u32 s35, s35, 160
    s_mov_b32 s37, s35
    v_mov_b32 v250, 1
    v_mov_b32 v251, 163832
    v_cmp_eq_u32 vcc, 0, v0
    s_nop 0
    s_and_saveexec_b64 s[38:39], vcc
    s_cbranch_execz tk12
    buffer_atomic_add v250, off, s[96:99], s37 sc0
    s_waitcnt vmcnt(0)
    ds_write_b32 v251, v250
    s_waitcnt lgkmcnt(0)
tk12:
    s_mov_b64 exec, -1
    s_barrier
    ds_read_b32 v252, v251
    s_waitcnt lgkmcnt(0)
    v_readfirstlane_b32 s34, v252
    s_barrier
    s_nop 3
    s_cmp_lt_u32 s33, 4
    s_cselect_b32 s36, 4, 6
    s_cmp_lt_u32 s34, s36
    s_cbranch_scc1 L_att0
    s_sub_u32 s34, s34, s36
    s_cmp_lt_u32 s34, 18
    s_cbranch_scc1 L_op_start
L_p2scan:
    v_and_b32 v1, 63, v0
    v_min_u32 v1, 6, v1
    v_lshlrev_b32 v2, 2, v1
    s_cmp_lg_u32 s32, 0
    v_mov_b32 v251, 163832
    s_cbranch_scc1 sw13
    buffer_load_dword v3, v2, s[96:99], 0 offen offset:160 sc1
    v_mov_b32 v4, 24
    v_cmp_gt_u32 vcc, 4, v1
    s_nop 1
    v_cndmask_b32 v4, v4, 22, vcc
    s_waitcnt vmcnt(0)
    v_cmp_lt_u32 vcc, v3, v4
    s_nop 0
    s_ff1_i32_b64 s40, vcc
    v_mov_b32 v250, s40
    ds_write_b32 v251, v250
    s_waitcnt lgkmcnt(0)
sw13:
    s_barrier
    ds_read_b32 v252, v251
    s_waitcnt lgkmcnt(0)
    v_readfirstlane_b32 s33, v252
    s_barrier
    s_nop 1
    s_cmp_lt_u32 s33, 7
    s_cbranch_scc1 L_p2take
    s_branch L_done
L_att0:
    s_mul_i32 s36, s34, 7
    s_mul_i32 s37, s34, 3
    s_add_u32 s37, s37, 12
    s_cmp_lt_u32 s34, 4
    s_cselect_b32 s34, s36, s37
    s_add_u32 s34, s34, s33
    s_cmp_ge_u32 s34, 32
    s_cbranch_scc1 L_done
L_att_next:
    s_lshr_b32 s16, s34, 3
    s_and_b32 s17, s34, 7
    s_lshl_b32 s17, s17, 2
    s_add_u32 s17, s17, s32
    s_lshr_b32 s36, s17, 1
    s_lshl_b32 s36, s36, 8
    s_add_u32 s36, s36, 125829120
    s_mul_i32 s37, s16, 43
    s_lshr_b32 s37, s37, 8
    s_mul_i32 s41, s37, 6
    s_sub_u32 s41, s16, s41
    v_and_b32 v1, 63, v0
    v_mul_u32_u24 v2, 6, v1
    v_add_u32 v2, s41, v2
    v_mov_b32 v4, s37
    s_and_b32 s41, s16, 7
    s_add_u32 s41, s41, 12
    s_lshr_b32 s37, s16, 3
    v_mov_b32 v5, s41
    v_mov_b32 v6, s37
    v_cmp_lt_u32 vcc, 1, v1
    s_nop 1
    v_cndmask_b32 v2, v2, v5, vcc
    v_cndmask_b32 v4, v4, v6, vcc
    v_lshlrev_b32 v2, 2, v2
    v_add3_u32 v4, v4, s95, 1
    s_mov_b32 s40, 4194304
L_aw1:
    buffer_load_dword v3, v2, s[4:7], s36 offen sc1
    s_sub_u32 s40, s40, 1
    s_cbranch_scc1 L_aw1_go
    s_waitcnt vmcnt(0)
    v_subrev_u32 v3, v4, v3
    v_cmp_lt_u32 vcc, 64, v3
    s_cbranch_vccz L_aw1_go
    s_sleep 4
    s_branch L_aw1
L_aw1_go:
    v_and_b32 v5, 63, v0
    v_lshlrev_b32 v1, 4, v5
    v_or_b32 v3, 128, v1
    v_lshrrev_b32 v4, 4, v5
    v_bfe_u32 v6, v5, 2, 2
    v_sub_u32 v4, v6, v4
    v_lshlrev_b32 v4, 3, v4
    v_and_b32 v6, 3, v5
    v_add_u32 v4, v4, v6
    v_mov_b32 v6, 0xf149f2ca
    s_mov_b32 s22, 0x3e0293ee
    s_lshl_b32 s18, s16, 5
    s_add_u32 s18, s18, s17
    s_lshl_b32 s19, s18, 13
    s_add_u32 s20, s19, 33554432
    buffer_load_dwordx4 v[8:11], v1, s[4:7], s20 offen offset:0 sc1
    s_add_u32 s20, s19, 33554432
    buffer_load_dwordx4 v[12:15], v1, s[4:7], s20 offen offset:1024 sc1
    s_add_u32 s20, s19, 33554432
    buffer_load_dwordx4 v[16:19], v1, s[4:7], s20 offen offset:2048 sc1
    s_add_u32 s20, s19, 33554432
    buffer_load_dwordx4 v[20:23], v1, s[4:7], s20 offen offset:3072 sc1
    s_add_u32 s20, s19, 33558528
    buffer_load_dwordx4 v[24:27], v1, s[4:7], s20 offen offset:0 sc1
    s_add_u32 s20, s19, 33558528
    buffer_load_dwordx4 v[28:31], v1, s[4:7], s20 offen offset:1024 sc1
    s_add_u32 s20, s19, 33558528
    buffer_load_dwordx4 v[32:35], v1, s[4:7], s20 offen offset:2048 sc1
    s_add_u32 s20, s19, 33558528
    buffer_load_dwordx4 v[36:39], v1, s[4:7], s20 offen offset:3072 sc1
    s_lshl_b32 s21, s18, 14
    s_add_u32 s20, s21, 0
    buffer_load_dwordx4 v[40:43], v1, s[4:7], s20 offen offset:0 sc1
    s_add_u32 s20, s21, 4096
    buffer_load_dwordx4 v[44:47], v1, s[4:7], s20 offen offset:0 sc1
    s_add_u32 s20, s21, 8192
    buffer_load_dwordx4 v[48:51], v1, s[4:7], s20 offen offset:0 sc1
    s_add_u32 s20, s21, 12288
    buffer_load_dwordx4 v[52:55], v1, s[4:7], s20 offen offset:0 sc1
    s_add_u32 s20, s21, 0
    buffer_load_dwordx4 v[56:59], v1, s[4:7], s20 offen offset:1024 sc1
    s_add_u32 s20, s21, 4096
    buffer_load_dwordx4 v[60:63], v1, s[4:7], s20 offen offset:1024 sc1
    s_add_u32 s20, s21, 8192
    buffer_load_dwordx4 v[64:67], v1, s[4:7], s20 offen offset:1024 sc1
    s_add_u32 s20, s21, 12288
    buffer_load_dwordx4 v[68:71], v1, s[4:7], s20 offen offset:1024 sc1
    s_add_u32 s20, s21, 0
    buffer_load_dwordx4 v[88:91], v1, s[4:7], s20 offen offset:2048 sc1
    s_add_u32 s20, s21, 4096
    buffer_load_dwordx4 v[92:95], v1, s[4:7], s20 offen offset:2048 sc1
    s_add_u32 s20, s21, 8192
    buffer_load_dwordx4 v[96:99], v1, s[4:7], s20 offen offset:2048 sc1
    s_add_u32 s20, s21, 12288
    buffer_load_dwordx4 v[100:103], v1, s[4:7], s20 offen offset:2048 sc1
    s_add_u32 s20, s21, 0
    buffer_load_dwordx4 v[104:107], v1, s[4:7], s20 offen offset:3072 sc1
    s_add_u32 s20, s21, 4096
    buffer_load_dwordx4 v[108:111], v1, s[4:7], s20 offen offset:3072 sc1
    s_add_u32 s20, s21, 8192
    buffer_load_dwordx4 v[112:115], v1, s[4:7], s20 offen offset:3072 sc1
    s_add_u32 s20, s21, 12288
    buffer_load_dwordx4 v[116:119], v1, s[4:7], s20 offen offset:3072 sc1
    v_mov_b32 v172, 0x3f803f80
    v_mov_b32 v173, 0x3f803f80
    v_mov_b32 v174, 0x3f803f80
    v_mov_b32 v175, 0x3f803f80
    v_mov_b32 v176, 0x3f003f00
    v_mov_b32 v177, 0x3f003f00
    s_waitcnt vmcnt(8)
    v_mfma_f32_16x16x32_bf16 v[136:139], v[40:43], v[8:11], 0
    v_mfma_f32_16x16x32_bf16 v[140:143], v[56:59], v[8:11], 0
    v_mfma_f32_16x16x32_bf16 v[148:151], v[40:43], v[24:27], 0
    v_mfma_f32_16x16x32_bf16 v[152:155], v[56:59], v[24:27], 0
    v_mfma_f32_16x16x32_bf16 v[136:139], v[44:47], v[12:15], v[136:139]
    v_mfma_f32_16x16x32_bf16 v[140:143], v[60:63], v[12:15], v[140:143]
    v_mfma_f32_16x16x32_bf16 v[148:151], v[44:47], v[28:31], v[148:151]
    v_mfma_f32_16x16x32_bf16 v[152:155], v[60:63], v[28:31], v[152:155]
    v_mfma_f32_16x16x32_bf16 v[136:139], v[48:51], v[16:19], v[136:139]
    v_mfma_f32_16x16x32_bf16 v[140:143], v[64:67], v[16:19], v[140:143]
    v_mfma_f32_16x16x32_bf16 v[148:151], v[48:51], v[32:35], v[148:151]
    v_mfma_f32_16x16x32_bf16 v[152:155], v[64:67], v[32:35], v[152:155]
    v_mfma_f32_16x16x32_bf16 v[136:139], v[52:55], v[20:23], v[136:139]
    v_mfma_f32_16x16x32_bf16 v[140:143], v[68:71], v[20:23], v[140:143]
    v_mfma_f32_16x16x32_bf16 v[148:151], v[52:55], v[36:39], v[148:151]
    v_mfma_f32_16x16x32_bf16 v[152:155], v[68:71], v[36:39], v[152:155]
    v_cmp_le_i32 vcc, 0, v4
    s_nop 1
    v_cndmask_b32 v136, v6, v136, vcc
    v_cmp_le_i32 vcc, 1, v4
    s_nop 1
    v_cndmask_b32 v137, v6, v137, vcc
    v_cmp_le_i32 vcc, 2, v4
    s_nop 1
    v_cndmask_b32 v138, v6, v138, vcc
    v_cmp_le_i32 vcc, 3, v4
    s_nop 1
    v_cndmask_b32 v139, v6, v139, vcc
    v_cmp_le_i32 vcc, 4, v4
    s_nop 1
    v_cndmask_b32 v140, v6, v140, vcc
    v_cmp_le_i32 vcc, 5, v4
    s_nop 1
    v_cndmask_b32 v141, v6, v141, vcc
    v_cmp_le_i32 vcc, 6, v4
    s_nop 1
    v_cndmask_b32 v142, v6, v142, vcc
    v_cmp_le_i32 vcc, 7, v4
    s_nop 1
    v_cndmask_b32 v143, v6, v143, vcc
    v_cmp_le_i32 vcc, -4, v4
    s_nop 1
    v_cndmask_b32 v148, v6, v148, vcc
    v_cmp_le_i32 vcc, -3, v4
    s_nop 1
    v_cndmask_b32 v149, v6, v149, vcc
    v_cmp_le_i32 vcc, -2, v4
    s_nop 1
    v_cndmask_b32 v150, v6, v150, vcc
    v_cmp_le_i32 vcc, -1, v4
    s_nop 1
    v_cndmask_b32 v151, v6, v151, vcc
    v_cmp_le_i32 vcc, 0, v4
    s_nop 1
    v_cndmask_b32 v152, v6, v152, vcc
    v_cmp_le_i32 vcc, 1, v4
    s_nop 1
    v_cndmask_b32 v153, v6, v153, vcc
    v_cmp_le_i32 vcc, 2, v4
    s_nop 1
    v_cndmask_b32 v154, v6, v154, vcc
    v_cmp_le_i32 vcc, 3, v4
    s_nop 1
    v_cndmask_b32 v155, v6, v155, vcc
    s_nop 1
    s_mov_b32 s88, 65536
cw14:
    buffer_load_dword v199, off, s[4:7], s36 offset:128 sc1
    s_waitcnt vmcnt(0)
    v_readfirstlane_b32 s42, v199
    s_nop 0
    s_sub_u32 s42, s42, s95
    s_cmp_gt_u32 s42, 64
    s_cselect_b32 s42, 0, s42
    s_add_u32 s42, s42, 2
    s_cmp_ge_u32 s42, s16
    s_cbranch_scc1 cw14x
    s_sub_u32 s88, s88, 1
    s_cbranch_scc1 cw14x
    s_sub_u32 s42, s16, s42
    s_min_u32 s42, s42, 6
cw14s:
    s_sleep 24
    s_sub_u32 s42, s42, 1
    s_cmp_lg_u32 s42, 0
    s_cbranch_scc1 cw14s
    s_branch cw14
cw14x:
    s_and_b32 s37, s16, 1
    s_lshl_b32 s37, s37, 2
    s_add_u32 s37, s37, s36
    s_add_u32 s37, s37, 128
    s_add_u32 s41, s16, s95
    s_add_u32 s41, s41, 1
    s_lshl_b32 s42, s17, 7
    s_add_u32 s42, s42, 125845504
    s_cmp_ge_u32 s16, 62
    s_cselect_b32 s37, s42, s37
    s_cselect_b32 s42, 12, 8
    v_lshlrev_b32 v198, 2, v0
    v_and_b32 v198, s42, v198
    s_mov_b32 s40, 4194304
L_aw2:
    buffer_load_dword v199, v198, s[4:7], s37 offen sc1
    s_sub_u32 s40, s40, 1
    s_cbranch_scc1 L_aw2_go
    s_waitcnt vmcnt(0)
    v_subrev_u32 v199, s41, v199
    v_cmp_lt_u32 vcc, 64, v199
    s_cbranch_vccz L_aw2_go
    s_sleep 1
    s_branch L_aw2
L_aw2_go:
    s_mov_b32 s21, 4096
at_again:
    s_lshl_b32 s20, s18, 12
    s_add_u32 s20, s20, 71303168
    buffer_load_dwordx4 v[72:75], v3, s[4:7], s20 offen offset:0 sc1
    buffer_load_dwordx4 v[76:79], v3, s[4:7], s20 offen offset:1024 sc1
    buffer_load_dwordx4 v[80:83], v3, s[4:7], s20 offen offset:2048 sc1
    buffer_load_dwordx4 v[84:87], v3, s[4:7], s20 offen offset:3072 sc1
    s_lshl_b32 s20, s18, 12
    s_add_u32 s20, s20, 80740352
    buffer_load_dwordx4 v[120:123], v1, s[4:7], s20 offen offset:0 sc1
    buffer_load_dwordx4 v[124:127], v1, s[4:7], s20 offen offset:1024 sc1
    buffer_load_dwordx4 v[128:131], v1, s[4:7], s20 offen offset:2048 sc1
    buffer_load_dwordx4 v[132:135], v1, s[4:7], s20 offen offset:3072 sc1
    s_waitcnt vmcnt(4)
    v_mfma_f32_16x16x32_bf16 v[144:147], v[72:75], v[8:11], 0
    v_mfma_f32_16x16x32_bf16 v[156:159], v[72:75], v[24:27], 0
    v_mfma_f32_16x16x32_bf16 v[144:147], v[76:79], v[12:15], v[144:147]
    v_mfma_f32_16x16x32_bf16 v[156:159], v[76:79], v[28:31], v[156:159]
    v_mfma_f32_16x16x32_bf16 v[144:147], v[80:83], v[16:19], v[144:147]
    v_mfma_f32_16x16x32_bf16 v[156:159], v[80:83], v[32:35], v[156:159]
    v_mfma_f32_16x16x32_bf16 v[144:147], v[84:87], v[20:23], v[144:147]
    v_mfma_f32_16x16x32_bf16 v[156:159], v[84:87], v[36:39], v[156:159]
    v_max3_u32 v196, v72, v76, v80
    s_waitcnt vmcnt(0)
    v_max3_u32 v196, v196, v84, v120
    v_max3_u32 v196, v196, v124, v128
    v_max_u32 v196, v196, v132
    v_cmp_eq_u32 vcc, -1, v196
    s_sub_u32 s21, s21, 1
    s_nop 3
    s_cbranch_scc1 at_ok
    s_cbranch_vccnz at_again
at_ok:
    v_max3_f32 v196, v136, v137, v138
    v_max3_f32 v197, v139, v140, v141
    v_max3_f32 v196, v196, v142, v143
    v_max3_f32 v197, v197, v144, v145
    v_max3_f32 v196, v196, v146, v147
    v_max_f32 v196, v196, v197
    v_mov_b32 v197, v196
    s_nop 1
    v_permlane32_swap_b32 v196, v197
    v_max_f32 v196, v196, v197
    v_mov_b32 v197, v196
    s_nop 1
    v_permlane16_swap_b32 v196, v197
    v_max_f32 v196, v196, v197
    v_mul_f32 v196, s22, v196
    v_sub_f32 v196, 0, v196
    v_fma_f32 v136, v136, s22, v196
    v_fma_f32 v137, v137, s22, v196
    v_fma_f32 v138, v138, s22, v196
    v_fma_f32 v139, v139, s22, v196
    v_fma_f32 v140, v140, s22, v196
    v_fma_f32 v141, v141, s22, v196
    v_fma_f32 v142, v142, s22, v196
    v_fma_f32 v143, v143, s22, v196
    v_fma_f32 v144, v144, s22, v196
    v_fma_f32 v145, v145, s22, v196
    v_fma_f32 v146, v146, s22, v196
    v_fma_f32 v147, v147, s22, v196
    v_exp_f32 v136, v136
    v_exp_f32 v137, v137
    v_exp_f32 v138, v138
    v_exp_f32 v139, v139
    v_exp_f32 v140, v140
    v_exp_f32 v141, v141
    v_exp_f32 v142, v142
    v_exp_f32 v143, v143
    v_exp_f32 v144, v144
    v_exp_f32 v145, v145
    v_exp_f32 v146, v146
    v_exp_f32 v147, v147
    v_cvt_pk_bf16_f32 v160, v136, v137
    v_cvt_pk_bf16_f32 v161, v138, v139
    v_cvt_pk_bf16_f32 v162, v140, v141
    v_cvt_pk_bf16_f32 v163, v142, v143
    v_cvt_pk_bf16_f32 v164, v144, v145
    v_cvt_pk_bf16_f32 v165, v146, v147
    v_max3_f32 v196, v148, v149, v150
    v_max3_f32 v197, v151, v152, v153
    v_max3_f32 v196, v196, v154, v155
    v_max3_f32 v197, v197, v156, v157
    v_max3_f32 v196, v196, v158, v159
    v_max_f32 v196, v196, v197
    v_mov_b32 v197, v196
    s_nop 1
    v_permlane32_swap_b32 v196, v197
    v_max_f32 v196, v196, v197
    v_mov_b32 v197, v196
    s_nop 1
    v_permlane16_swap_b32 v196, v197
    v_max_f32 v196, v196, v197
    v_mul_f32 v196, s22, v196
    v_sub_f32 v196, 0, v196
    v_fma_f32 v148, v148, s22, v196
    v_fma_f32 v149, v149, s22, v196
    v_fma_f32 v150, v150, s22, v196
    v_fma_f32 v151, v151, s22, v196
    v_fma_f32 v152, v152, s22, v196
    v_fma_f32 v153, v153, s22, v196
    v_fma_f32 v154, v154, s22, v196
    v_fma_f32 v155, v155, s22, v196
    v_fma_f32 v156, v156, s22, v196
    v_fma_f32 v157, v157, s22, v196
    v_fma_f32 v158, v158, s22, v196
    v_fma_f32 v159, v159, s22, v196
    v_exp_f32 v148, v148
    v_exp_f32 v149, v149
    v_exp_f32 v150, v150
    v_exp_f32 v151, v151
    v_exp_f32 v152, v152
    v_exp_f32 v153, v153
    v_exp_f32 v154, v154
    v_exp_f32 v155, v155
    v_exp_f32 v156, v156
    v_exp_f32 v157, v157
    v_exp_f32 v158, v158
    v_exp_f32 v159, v159
    v_cvt_pk_bf16_f32 v166, v148, v149
    v_cvt_pk_bf16_f32 v167, v150, v151
    v_cvt_pk_bf16_f32 v168, v152, v153
    v_cvt_pk_bf16_f32 v169, v154, v155
    v_cvt_pk_bf16_f32 v170, v156, v157
    v_cvt_pk_bf16_f32 v171, v158, v159
    v_mfma_f32_16x16x32_bf16 v[180:183], v[172:175], v[160:163], 0
    v_mfma_f32_16x16x32_bf16 v[184:187], v[172:175], v[166:169], 0
    v_mfma_f32_16x16x16_bf16 v[180:183], v[176:177], v[164:165], v[180:183]
    v_mfma_f32_16x16x16_bf16 v[184:187], v[176:177], v[170:171], v[184:187]
    s_nop 3
    v_rcp_f32 v180, v180
    s_nop 2
    v_rcp_f32 v184, v184
    s_waitcnt vmcnt(0)
    s_lshl_b32 s18, s16, 18
    s_lshl_b32 s19, s17, 12
    s_add_u32 s18, s18, s19
    s_add_u32 s18, s18, 50331648
    s_add_u32 s19, s18, 131072
    v_mfma_f32_16x16x32_bf16 v[8:11], v[88:91], v[160:163], 0
    v_mfma_f32_16x16x32_bf16 v[12:15], v[104:107], v[160:163], 0
    v_mfma_f32_16x16x32_bf16 v[16:19], v[88:91], v[166:169], 0
    v_mfma_f32_16x16x32_bf16 v[20:23], v[104:107], v[166:169], 0
    v_mfma_f32_16x16x32_bf16 v[24:27], v[92:95], v[160:163], 0
    v_mfma_f32_16x16x32_bf16 v[28:31], v[108:111], v[160:163], 0
    v_mfma_f32_16x16x32_bf16 v[32:35], v[92:95], v[166:169], 0
    v_mfma_f32_16x16x32_bf16 v[36:39], v[108:111], v[166:169], 0
    v_mfma_f32_16x16x32_bf16 v[40:43], v[96:99], v[160:163], 0
    v_mfma_f32_16x16x32_bf16 v[44:47], v[112:115], v[160:163], 0
    v_mfma_f32_16x16x32_bf16 v[48:51], v[96:99], v[166:169], 0
    v_mfma_f32_16x16x32_bf16 v[52:55], v[112:115], v[166:169], 0
    v_mfma_f32_16x16x32_bf16 v[56:59], v[100:103], v[160:163], 0
    v_mfma_f32_16x16x32_bf16 v[60:63], v[116:119], v[160:163], 0
    v_mfma_f32_16x16x32_bf16 v[64:67], v[100:103], v[166:169], 0
    v_mfma_f32_16x16x32_bf16 v[68:71], v[116:119], v[166:169], 0
    v_mfma_f32_16x16x16_bf16 v[8:11], v[120:121], v[164:165], v[8:11]
    v_mfma_f32_16x16x16_bf16 v[12:15], v[122:123], v[164:165], v[12:15]
    v_mfma_f32_16x16x16_bf16 v[16:19], v[120:121], v[170:171], v[16:19]
    v_mfma_f32_16x16x16_bf16 v[20:23], v[122:123], v[170:171], v[20:23]
    v_mfma_f32_16x16x16_bf16 v[24:27], v[124:125], v[164:165], v[24:27]
    v_mfma_f32_16x16x16_bf16 v[28:31], v[126:127], v[164:165], v[28:31]
    v_mfma_f32_16x16x16_bf16 v[32:35], v[124:125], v[170:171], v[32:35]
    v_mfma_f32_16x16x16_bf16 v[36:39], v[126:127], v[170:171], v[36:39]
    v_mfma_f32_16x16x16_bf16 v[40:43], v[128:129], v[164:165], v[40:43]
    v_mfma_f32_16x16x16_bf16 v[44:47], v[130:131], v[164:165], v[44:47]
    v_mfma_f32_16x16x16_bf16 v[48:51], v[128:129], v[170:171], v[48:51]
    v_mfma_f32_16x16x16_bf16 v[52:55], v[130:131], v[170:171], v[52:55]
    v_mfma_f32_16x16x16_bf16 v[56:59], v[132:133], v[164:165], v[56:59]
    v_mfma_f32_16x16x16_bf16 v[60:63], v[134:135], v[164:165], v[60:63]
    v_mfma_f32_16x16x16_bf16 v[64:67], v[132:133], v[170:171], v[64:67]
    v_mfma_f32_16x16x16_bf16 v[68:71], v[134:135], v[170:171], v[68:71]
    v_mul_f32 v8, v8, v180
    v_mul_f32 v12, v12, v180
    v_mul_f32 v9, v9, v180
    v_mul_f32 v13, v13, v180
    v_mul_f32 v10, v10, v180
    v_mul_f32 v14, v14, v180
    v_mul_f32 v11, v11, v180
    v_mul_f32 v15, v15, v180
    v_cvt_pk_bf16_f32 v8, v8, v9
    v_cvt_pk_bf16_f32 v9, v10, v11
    v_cvt_pk_bf16_f32 v10, v12, v13
    v_cvt_pk_bf16_f32 v11, v14, v15
    buffer_store_dwordx4 v[8:11], v1, s[4:7], s18 offen offset:0 sc1
    v_mul_f32 v16, v16, v184
    v_mul_f32 v20, v20, v184
    v_mul_f32 v17, v17, v184
    v_mul_f32 v21, v21, v184
    v_mul_f32 v18, v18, v184
    v_mul_f32 v22, v22, v184
    v_mul_f32 v19, v19, v184
    v_mul_f32 v23, v23, v184
    v_cvt_pk_bf16_f32 v16, v16, v17
    v_cvt_pk_bf16_f32 v17, v18, v19
    v_cvt_pk_bf16_f32 v18, v20, v21
    v_cvt_pk_bf16_f32 v19, v22, v23
    buffer_store_dwordx4 v[16:19], v1, s[4:7], s19 offen offset:0 sc1
    v_mul_f32 v24, v24, v180
    v_mul_f32 v28, v28, v180
    v_mul_f32 v25, v25, v180
    v_mul_f32 v29, v29, v180
    v_mul_f32 v26, v26, v180
    v_mul_f32 v30, v30, v180
    v_mul_f32 v27, v27, v180
    v_mul_f32 v31, v31, v180
    v_cvt_pk_bf16_f32 v24, v24, v25
    v_cvt_pk_bf16_f32 v25, v26, v27
    v_cvt_pk_bf16_f32 v26, v28, v29
    v_cvt_pk_bf16_f32 v27, v30, v31
    buffer_store_dwordx4 v[24:27], v1, s[4:7], s18 offen offset:1024 sc1
    v_mul_f32 v32, v32, v184
    v_mul_f32 v36, v36, v184
    v_mul_f32 v33, v33, v184
    v_mul_f32 v37, v37, v184
    v_mul_f32 v34, v34, v184
    v_mul_f32 v38, v38, v184
    v_mul_f32 v35, v35, v184
    v_mul_f32 v39, v39, v184
    v_cvt_pk_bf16_f32 v32, v32, v33
    v_cvt_pk_bf16_f32 v33, v34, v35
    v_cvt_pk_bf16_f32 v34, v36, v37
    v_cvt_pk_bf16_f32 v35, v38, v39
    buffer_store_dwordx4 v[32:35], v1, s[4:7], s19 offen offset:1024 sc1
    v_mul_f32 v40, v40, v180
    v_mul_f32 v44, v44, v180
    v_mul_f32 v41, v41, v180
    v_mul_f32 v45, v45, v180
    v_mul_f32 v42, v42, v180
    v_mul_f32 v46, v46, v180
    v_mul_f32 v43, v43, v180
    v_mul_f32 v47, v47, v180
    v_cvt_pk_bf16_f32 v40, v40, v41
    v_cvt_pk_bf16_f32 v41, v42, v43
    v_cvt_pk_bf16_f32 v42, v44, v45
    v_cvt_pk_bf16_f32 v43, v46, v47
    buffer_store_dwordx4 v[40:43], v1, s[4:7], s18 offen offset:2048 sc1
    v_mul_f32 v48, v48, v184
    v_mul_f32 v52, v52, v184
    v_mul_f32 v49, v49, v184
    v_mul_f32 v53, v53, v184
    v_mul_f32 v50, v50, v184
    v_mul_f32 v54, v54, v184
    v_mul_f32 v51, v51, v184
    v_mul_f32 v55, v55, v184
    v_cvt_pk_bf16_f32 v48, v48, v49
    v_cvt_pk_bf16_f32 v49, v50, v51
    v_cvt_pk_bf16_f32 v50, v52, v53
    v_cvt_pk_bf16_f32 v51, v54, v55
    buffer_store_dwordx4 v[48:51], v1, s[4:7], s19 offen offset:2048 sc1
    v_mul_f32 v56, v56, v180
    v_mul_f32 v60, v60, v180
    v_mul_f32 v57, v57, v180
    v_mul_f32 v61, v61, v180
    v_mul_f32 v58, v58, v180
    v_mul_f32 v62, v62, v180
    v_mul_f32 v59, v59, v180
    v_mul_f32 v63, v63, v180
    v_cvt_pk_bf16_f32 v56, v56, v57
    v_cvt_pk_bf16_f32 v57, v58, v59
    v_cvt_pk_bf16_f32 v58, v60, v61
    v_cvt_pk_bf16_f32 v59, v62, v63
    buffer_store_dwordx4 v[56:59], v1, s[4:7], s18 offen offset:3072 sc1
    v_mul_f32 v64, v64, v184
    v_mul_f32 v68, v68, v184
    v_mul_f32 v65, v65, v184
    v_mul_f32 v69, v69, v184
    v_mul_f32 v66, v66, v184
    v_mul_f32 v70, v70, v184
    v_mul_f32 v67, v67, v184
    v_mul_f32 v71, v71, v184
    v_cvt_pk_bf16_f32 v64, v64, v65
    v_cvt_pk_bf16_f32 v65, v66, v67
    v_cvt_pk_bf16_f32 v66, v68, v69
    v_cvt_pk_bf16_f32 v67, v70, v71
    buffer_store_dwordx4 v[64:67], v1, s[4:7], s19 offen offset:3072 sc1
    s_lshr_b32 s40, s34, 1
    s_lshl_b32 s40, s40, 7
    s_and_b32 s41, s17, 7
    s_lshl_b32 s41, s41, 2
    s_add_u32 s40, s40, s41
    s_add_u32 s40, s40, 125894656
    v_mov_b32 v250, s95
    s_cmp_ge_u32 s16, 62
    s_cbranch_scc1 L_afl
    s_waitcnt vmcnt(0)
L_afl:
    s_mov_b64 exec, 1
    buffer_store_dword v250, off, s[4:7], s40 sc1
    s_mov_b64 exec, -1
    s_add_u32 s34, s34, 32
    s_cmp_lt_u32 s34, 512
    s_cbranch_scc1 L_att_next
    s_branch L_done
L_op_start:
    s_mov_b32 s16, s33
    s_mov_b32 s33, s34
    v_and_b32 v2, 63, v0
    v_lshlrev_b32 v1, 4, v2
    v_lshrrev_b32 v5, 2, v2
    v_mul_u32_u24 v3, 1152, v5
    v_and_b32 v5, 3, v2
    v_lshl_add_u32 v3, v5, 4, v3
    s_lshl_b32 s21, s32, 12
    v_add_u32 v4, s21, v1
    s_mov_b64 s[12:13], s[58:59]
    s_mov_b32 s14, 4718592
    s_mov_b32 s15, 0x20000
    s_mul_i32 s19, s32, 1179648
    s_lshl_b32 s18, s33, 6
    s_add_u32 s19, s19, s18
    s_add_u32 s18, s19, 0
    s_add_u32 m0, s21, 0
    s_nop 0
    buffer_load_dwordx4 v3, s[12:15], s18 offen lds
    s_add_u32 m0, s21, 1024
    s_add_u32 s18, s18, 18432
    buffer_load_dwordx4 v3, s[12:15], s18 offen lds
    s_add_u32 m0, s21, 2048
    s_add_u32 s18, s18, 18432
    buffer_load_dwordx4 v3, s[12:15], s18 offen lds
    s_add_u32 m0, s21, 3072
    s_add_u32 s18, s18, 18432
    buffer_load_dwordx4 v3, s[12:15], s18 offen lds
    s_add_u32 s18, s19, 73728
    s_add_u32 m0, s21, 16384
    s_nop 0
    buffer_load_dwordx4 v3, s[12:15], s18 offen lds
    s_add_u32 m0, s21, 17408
    s_add_u32 s18, s18, 18432
    buffer_load_dwordx4 v3, s[12:15], s18 offen lds
    s_add_u32 m0, s21, 18432
    s_add_u32 s18, s18, 18432
    buffer_load_dwordx4 v3, s[12:15], s18 offen lds
    s_add_u32 m0, s21, 19456
    s_add_u32 s18, s18, 18432
    buffer_load_dwordx4 v3, s[12:15], s18 offen lds
    s_add_u32 s18, s19, 147456
    s_add_u32 m0, s21, 32768
    s_nop 0
    buffer_load_dwordx4 v3, s[12:15], s18 offen lds
    s_add_u32 m0, s21, 33792
    s_add_u32 s18, s18, 18432
    buffer_load_dwordx4 v3, s[12:15], s18 offen lds
    s_add_u32 m0, s21, 34816
    s_add_u32 s18, s18, 18432
    buffer_load_dwordx4 v3, s[12:15], s18 offen lds
    s_add_u32 m0, s21, 35840
    s_add_u32 s18, s18, 18432
    buffer_load_dwordx4 v3, s[12:15], s18 offen lds
    s_add_u32 s18, s19, 221184
    s_add_u32 m0, s21, 49152
    s_nop 0
    buffer_load_dwordx4 v3, s[12:15], s18 offen lds
    s_add_u32 m0, s21, 50176
    s_add_u32 s18, s18, 18432
    buffer_load_dwordx4 v3, s[12:15], s18 offen lds
    s_add_u32 m0, s21, 51200
    s_add_u32 s18, s18, 18432
    buffer_load_dwordx4 v3, s[12:15], s18 offen lds
    s_add_u32 m0, s21, 52224
    s_add_u32 s18, s18, 18432
    buffer_load_dwordx4 v3, s[12:15], s18 offen lds
    s_add_u32 s18, s19, 294912
    s_add_u32 m0, s21, 65536
    s_nop 0
    buffer_load_dwordx4 v3, s[12:15], s18 offen lds
    s_add_u32 m0, s21, 66560
    s_add_u32 s18, s18, 18432
    buffer_load_dwordx4 v3, s[12:15], s18 offen lds
    s_add_u32 m0, s21, 67584
    s_add_u32 s18, s18, 18432
    buffer_load_dwordx4 v3, s[12:15], s18 offen lds
    s_add_u32 m0, s21, 68608
    s_add_u32 s18, s18, 18432
    buffer_load_dwordx4 v3, s[12:15], s18 offen lds
    s_add_u32 s18, s19, 368640
    s_add_u32 m0, s21, 81920
    s_nop 0
    buffer_load_dwordx4 v3, s[12:15], s18 offen lds
    s_add_u32 m0, s21, 82944
    s_add_u32 s18, s18, 18432
    buffer_load_dwordx4 v3, s[12:15], s18 offen lds
    s_add_u32 m0, s21, 83968
    s_add_u32 s18, s18, 18432
    buffer_load_dwordx4 v3, s[12:15], s18 offen lds
    s_add_u32 m0, s21, 84992
    s_add_u32 s18, s18, 18432
    buffer_load_dwordx4 v3, s[12:15], s18 offen lds
    s_add_u32 s18, s19, 442368
    s_add_u32 m0, s21, 98304
    s_nop 0
    buffer_load_dwordx4 v3, s[12:15], s18 offen lds
    s_add_u32 m0, s21, 99328
    s_add_u32 s18, s18, 18432
    buffer_load_dwordx4 v3, s[12:15], s18 offen lds
    s_add_u32 m0, s21, 100352
    s_add_u32 s18, s18, 18432
    buffer_load_dwordx4 v3, s[12:15], s18 offen lds
    s_add_u32 m0, s21, 101376
    s_add_u32 s18, s18, 18432
    buffer_load_dwordx4 v3, s[12:15], s18 offen lds
    s_add_u32 s18, s19, 516096
    s_add_u32 m0, s21, 114688
    s_nop 0
    buffer_load_dwordx4 v3, s[12:15], s18 offen lds
    s_add_u32 m0, s21, 115712
    s_add_u32 s18, s18, 18432
    buffer_load_dwordx4 v3, s[12:15], s18 offen lds
    s_add_u32 m0, s21, 116736
    s_add_u32 s18, s18, 18432
    buffer_load_dwordx4 v3, s[12:15], s18 offen lds
    s_add_u32 m0, s21, 117760
    s_add_u32 s18, s18, 18432
    buffer_load_dwordx4 v3, s[12:15], s18 offen lds
    s_add_u32 s18, s19, 589824
    s_add_u32 m0, s21, 131072
    s_nop 0
    buffer_load_dwordx4 v3, s[12:15], s18 offen lds
    s_add_u32 m0, s21, 132096
    s_add_u32 s18, s18, 18432
    buffer_load_dwordx4 v3, s[12:15], s18 offen lds
    s_add_u32 m0, s21, 133120
    s_add_u32 s18, s18, 18432
    buffer_load_dwordx4 v3, s[12:15], s18 offen lds
    s_add_u32 m0, s21, 134144
    s_add_u32 s18, s18, 18432
    buffer_load_dwordx4 v3, s[12:15], s18 offen lds
    v_add_u32 v6, 0, v4
    v_xor_b32 v7, 32, v6
    s_waitcnt vmcnt(32)
    ds_read_b64_tr_b16 a[0:1], v6 offset:0
    ds_read_b64_tr_b16 a[2:3], v6 offset:1024
    ds_read_b64_tr_b16 a[4:5], v6 offset:8
    ds_read_b64_tr_b16 a[6:7], v6 offset:1032
    ds_read_b64_tr_b16 a[8:9], v6 offset:2048
    ds_read_b64_tr_b16 a[10:11], v6 offset:3072
    ds_read_b64_tr_b16 a[12:13], v6 offset:2056
    ds_read_b64_tr_b16 a[14:15], v6 offset:3080
    s_waitcnt lgkmcnt(0)
    s_add_u32 s18, s19, 663552
    s_add_u32 m0, s21, 0
    s_nop 0
    buffer_load_dwordx4 v3, s[12:15], s18 offen lds
    s_add_u32 m0, s21, 1024
    s_add_u32 s18, s18, 18432
    buffer_load_dwordx4 v3, s[12:15], s18 offen lds
    s_add_u32 m0, s21, 2048
    s_add_u32 s18, s18, 18432
    buffer_load_dwordx4 v3, s[12:15], s18 offen lds
    s_add_u32 m0, s21, 3072
    s_add_u32 s18, s18, 18432
    buffer_load_dwordx4 v3, s[12:15], s18 offen lds
    v_add_u32 v6, 16384, v4
    v_xor_b32 v7, 32, v6
    s_waitcnt vmcnt(32)
    ds_read_b64_tr_b16 a[16:17], v6 offset:0
    ds_read_b64_tr_b16 a[18:19], v6 offset:1024
    ds_read_b64_tr_b16 a[20:21], v6 offset:8
    ds_read_b64_tr_b16 a[22:23], v6 offset:1032
    ds_read_b64_tr_b16 a[24:25], v6 offset:2048
    ds_read_b64_tr_b16 a[26:27], v6 offset:3072
    ds_read_b64_tr_b16 a[28:29], v6 offset:2056
    ds_read_b64_tr_b16 a[30:31], v6 offset:3080
    s_waitcnt lgkmcnt(0)
    s_add_u32 s18, s19, 737280
    s_add_u32 m0, s21, 16384
    s_nop 0
    buffer_load_dwordx4 v3, s[12:15], s18 offen lds
    s_add_u32 m0, s21, 17408
    s_add_u32 s18, s18, 18432
    buffer_load_dwordx4 v3, s[12:15], s18 offen lds
    s_add_u32 m0, s21, 18432
    s_add_u32 s18, s18, 18432
    buffer_load_dwordx4 v3, s[12:15], s18 offen lds
    s_add_u32 m0, s21, 19456
    s_add_u32 s18, s18, 18432
    buffer_load_dwordx4 v3, s[12:15], s18 offen lds
    v_add_u32 v6, 32768, v4
    v_xor_b32 v7, 32, v6
    s_waitcnt vmcnt(32)
    ds_read_b64_tr_b16 a[32:33], v6 offset:0
    ds_read_b64_tr_b16 a[34:35], v6 offset:1024
    ds_read_b64_tr_b16 a[36:37], v6 offset:8
    ds_read_b64_tr_b16 a[38:39], v6 offset:1032
    ds_read_b64_tr_b16 a[40:41], v6 offset:2048
    ds_read_b64_tr_b16 a[42:43], v6 offset:3072
    ds_read_b64_tr_b16 a[44:45], v6 offset:2056
    ds_read_b64_tr_b16 a[46:47], v6 offset:3080
    s_waitcnt lgkmcnt(0)
    s_add_u32 s18, s19, 811008
    s_add_u32 m0, s21, 32768
    s_nop 0
    buffer_load_dwordx4 v3, s[12:15], s18 offen lds
    s_add_u32 m0, s21, 33792
    s_add_u32 s18, s18, 18432
    buffer_load_dwordx4 v3, s[12:15], s18 offen lds
    s_add_u32 m0, s21, 34816
    s_add_u32 s18, s18, 18432
    buffer_load_dwordx4 v3, s[12:15], s18 offen lds
    s_add_u32 m0, s21, 35840
    s_add_u32 s18, s18, 18432
    buffer_load_dwordx4 v3, s[12:15], s18 offen lds
    v_add_u32 v6, 49152, v4
    v_xor_b32 v7, 32, v6
    s_waitcnt vmcnt(32)
    ds_read_b64_tr_b16 a[48:49], v6 offset:0
    ds_read_b64_tr_b16 a[50:51], v6 offset:1024
    ds_read_b64_tr_b16 a[52:53], v6 offset:8
    ds_read_b64_tr_b16 a[54:55], v6 offset:1032
    ds_read_b64_tr_b16 a[56:57], v6 offset:2048
    ds_read_b64_tr_b16 a[58:59], v6 offset:3072
    ds_read_b64_tr_b16 a[60:61], v6 offset:2056
    ds_read_b64_tr_b16 a[62:63], v6 offset:3080
    s_waitcnt lgkmcnt(0)
    s_add_u32 s18, s19, 884736
    s_add_u32 m0, s21, 49152
    s_nop 0
    buffer_load_dwordx4 v3, s[12:15], s18 offen lds
    s_add_u32 m0, s21, 50176
    s_add_u32 s18, s18, 18432
    buffer_load_dwordx4 v3, s[12:15], s18 offen lds
    s_add_u32 m0, s21, 51200
    s_add_u32 s18, s18, 18432
    buffer_load_dwordx4 v3, s[12:15], s18 offen lds
    s_add_u32 m0, s21, 52224
    s_add_u32 s18, s18, 18432
    buffer_load_dwordx4 v3, s[12:15], s18 offen lds
    v_add_u32 v6, 65536, v4
    v_xor_b32 v7, 32, v6
    s_waitcnt vmcnt(32)
    ds_read_b64_tr_b16 a[64:65], v6 offset:0
    ds_read_b64_tr_b16 a[66:67], v6 offset:1024
    ds_read_b64_tr_b16 a[68:69], v6 offset:8
    ds_read_b64_tr_b16 a[70:71], v6 offset:1032
    ds_read_b64_tr_b16 a[72:73], v6 offset:2048
    ds_read_b64_tr_b16 a[74:75], v6 offset:3072
    ds_read_b64_tr_b16 a[76:77], v6 offset:2056
    ds_read_b64_tr_b16 a[78:79], v6 offset:3080
    s_waitcnt lgkmcnt(0)
    s_add_u32 s18, s19, 958464
    s_add_u32 m0, s21, 65536
    s_nop 0
    buffer_load_dwordx4 v3, s[12:15], s18 offen lds
    s_add_u32 m0, s21, 66560
    s_add_u32 s18, s18, 18432
    buffer_load_dwordx4 v3, s[12:15], s18 offen lds
    s_add_u32 m0, s21, 67584
    s_add_u32 s18, s18, 18432
    buffer_load_dwordx4 v3, s[12:15], s18 offen lds
    s_add_u32 m0, s21, 68608
    s_add_u32 s18, s18, 18432
    buffer_load_dwordx4 v3, s[12:15], s18 offen lds
    v_add_u32 v6, 81920, v4
    v_xor_b32 v7, 32, v6
    s_waitcnt vmcnt(32)
    ds_read_b64_tr_b16 a[80:81], v6 offset:0
    ds_read_b64_tr_b16 a[82:83], v6 offset:1024
    ds_read_b64_tr_b16 a[84:85], v6 offset:8
    ds_read_b64_tr_b16 a[86:87], v6 offset:1032
    ds_read_b64_tr_b16 a[88:89], v6 offset:2048
    ds_read_b64_tr_b16 a[90:91], v6 offset:3072
    ds_read_b64_tr_b16 a[92:93], v6 offset:2056
    ds_read_b64_tr_b16 a[94:95], v6 offset:3080
    s_waitcnt lgkmcnt(0)
    s_add_u32 s18, s19, 1032192
    s_add_u32 m0, s21, 81920
    s_nop 0
    buffer_load_dwordx4 v3, s[12:15], s18 offen lds
    s_add_u32 m0, s21, 82944
    s_add_u32 s18, s18, 18432
    buffer_load_dwordx4 v3, s[12:15], s18 offen lds
    s_add_u32 m0, s21, 83968
    s_add_u32 s18, s18, 18432
    buffer_load_dwordx4 v3, s[12:15], s18 offen lds
    s_add_u32 m0, s21, 84992
    s_add_u32 s18, s18, 18432
    buffer_load_dwordx4 v3, s[12:15], s18 offen lds
    v_add_u32 v6, 98304, v4
    v_xor_b32 v7, 32, v6
    s_waitcnt vmcnt(32)
    ds_read_b64_tr_b16 a[96:97], v6 offset:0
    ds_read_b64_tr_b16 a[98:99], v6 offset:1024
    ds_read_b64_tr_b16 a[100:101], v6 offset:8
    ds_read_b64_tr_b16 a[102:103], v6 offset:1032
    ds_read_b64_tr_b16 a[104:105], v6 offset:2048
    ds_read_b64_tr_b16 a[106:107], v6 offset:3072
    ds_read_b64_tr_b16 a[108:109], v6 offset:2056
    ds_read_b64_tr_b16 a[110:111], v6 offset:3080
    s_waitcnt lgkmcnt(0)
    s_add_u32 s18, s19, 1105920
    s_add_u32 m0, s21, 98304
    s_nop 0
    buffer_load_dwordx4 v3, s[12:15], s18 offen lds
    s_add_u32 m0, s21, 99328
    s_add_u32 s18, s18, 18432
    buffer_load_dwordx4 v3, s[12:15], s18 offen lds
    s_add_u32 m0, s21, 100352
    s_add_u32 s18, s18, 18432
    buffer_load_dwordx4 v3, s[12:15], s18 offen lds
    s_add_u32 m0, s21, 101376
    s_add_u32 s18, s18, 18432
    buffer_load_dwordx4 v3, s[12:15], s18 offen lds
    v_add_u32 v6, 114688, v4
    v_xor_b32 v7, 32, v6
    s_waitcnt vmcnt(32)
    ds_read_b64_tr_b16 a[112:113], v6 offset:0
    ds_read_b64_tr_b16 a[114:115], v6 offset:1024
    ds_read_b64_tr_b16 a[116:117], v6 offset:8
    ds_read_b64_tr_b16 a[118:119], v6 offset:1032
    ds_read_b64_tr_b16 a[120:121], v6 offset:2048
    ds_read_b64_tr_b16 a[122:123], v6 offset:3072
    ds_read_b64_tr_b16 a[124:125], v6 offset:2056
    ds_read_b64_tr_b16 a[126:127], v6 offset:3080
    s_waitcnt lgkmcnt(0)
    v_add_u32 v6, 131072, v4
    v_xor_b32 v7, 32, v6
    s_waitcnt vmcnt(28)
    ds_read_b64_tr_b16 a[128:129], v6 offset:0
    ds_read_b64_tr_b16 a[130:131], v6 offset:1024
    ds_read_b64_tr_b16 a[132:133], v6 offset:8
    ds_read_b64_tr_b16 a[134:135], v6 offset:1032
    ds_read_b64_tr_b16 a[136:137], v6 offset:2048
    ds_read_b64_tr_b16 a[138:139], v6 offset:3072
    ds_read_b64_tr_b16 a[140:141], v6 offset:2056
    ds_read_b64_tr_b16 a[142:143], v6 offset:3080
    s_waitcnt lgkmcnt(0)
    v_add_u32 v6, 0, v4
    v_xor_b32 v7, 32, v6
    s_waitcnt vmcnt(24)
    ds_read_b64_tr_b16 a[144:145], v6 offset:0
    ds_read_b64_tr_b16 a[146:147], v6 offset:1024
    ds_read_b64_tr_b16 a[148:149], v6 offset:8
    ds_read_b64_tr_b16 a[150:151], v6 offset:1032
    ds_read_b64_tr_b16 a[152:153], v6 offset:2048
    ds_read_b64_tr_b16 a[154:155], v6 offset:3072
    ds_read_b64_tr_b16 a[156:157], v6 offset:2056
    ds_read_b64_tr_b16 a[158:159], v6 offset:3080
    s_waitcnt lgkmcnt(0)
    v_add_u32 v6, 16384, v4
    v_xor_b32 v7, 32, v6
    s_waitcnt vmcnt(20)
    ds_read_b64_tr_b16 a[160:161], v6 offset:0
    ds_read_b64_tr_b16 a[162:163], v6 offset:1024
    ds_read_b64_tr_b16 a[164:165], v6 offset:8
    ds_read_b64_tr_b16 a[166:167], v6 offset:1032
    ds_read_b64_tr_b16 a[168:169], v6 offset:2048
    ds_read_b64_tr_b16 a[170:171], v6 offset:3072
    ds_read_b64_tr_b16 a[172:173], v6 offset:2056
    ds_read_b64_tr_b16 a[174:175], v6 offset:3080
    s_waitcnt lgkmcnt(0)
    v_add_u32 v6, 32768, v4
    v_xor_b32 v7, 32, v6
    s_waitcnt vmcnt(16)
    ds_read_b64_tr_b16 a[176:177], v6 offset:0
    ds_read_b64_tr_b16 a[178:179], v6 offset:1024
    ds_read_b64_tr_b16 a[180:181], v6 offset:8
    ds_read_b64_tr_b16 a[182:183], v6 offset:1032
    ds_read_b64_tr_b16 a[184:185], v6 offset:2048
    ds_read_b64_tr_b16 a[186:187], v6 offset:3072
    ds_read_b64_tr_b16 a[188:189], v6 offset:2056
    ds_read_b64_tr_b16 a[190:191], v6 offset:3080
    s_waitcnt lgkmcnt(0)
    v_add_u32 v6, 49152, v4
    v_xor_b32 v7, 32, v6
    s_waitcnt vmcnt(12)
    ds_read_b64_tr_b16 a[192:193], v6 offset:0
    ds_read_b64_tr_b16 a[194:195], v6 offset:1024
    ds_read_b64_tr_b16 a[196:197], v6 offset:8
    ds_read_b64_tr_b16 a[198:199], v6 offset:1032
    ds_read_b64_tr_b16 a[200:201], v6 offset:2048
    ds_read_b64_tr_b16 a[202:203], v6 offset:3072
    ds_read_b64_tr_b16 a[204:205], v6 offset:2056
    ds_read_b64_tr_b16 a[206:207], v6 offset:3080
    s_waitcnt lgkmcnt(0)
    v_add_u32 v6, 65536, v4
    v_xor_b32 v7, 32, v6
    s_waitcnt vmcnt(8)
    ds_read_b64_tr_b16 a[208:209], v6 offset:0
    ds_read_b64_tr_b16 a[210:211], v6 offset:1024
    ds_read_b64_tr_b16 a[212:213], v6 offset:8
    ds_read_b64_tr_b16 a[214:215], v6 offset:1032
    ds_read_b64_tr_b16 a[216:217], v6 offset:2048
    ds_read_b64_tr_b16 a[218:219], v6 offset:3072
    ds_read_b64_tr_b16 a[220:221], v6 offset:2056
    ds_read_b64_tr_b16 a[222:223], v6 offset:3080
    s_waitcnt lgkmcnt(0)
    v_add_u32 v6, 81920, v4
    v_xor_b32 v7, 32, v6
    s_waitcnt vmcnt(4)
    ds_read_b64_tr_b16 a[224:225], v6 offset:0
    ds_read_b64_tr_b16 a[226:227], v6 offset:1024
    ds_read_b64_tr_b16 a[228:229], v6 offset:8
    ds_read_b64_tr_b16 a[230:231], v6 offset:1032
    ds_read_b64_tr_b16 a[232:233], v6 offset:2048
    ds_read_b64_tr_b16 a[234:235], v6 offset:3072
    ds_read_b64_tr_b16 a[236:237], v6 offset:2056
    ds_read_b64_tr_b16 a[238:239], v6 offset:3080
    s_waitcnt lgkmcnt(0)
    v_add_u32 v6, 98304, v4
    v_xor_b32 v7, 32, v6
    s_waitcnt vmcnt(0)
    ds_read_b64_tr_b16 a[240:241], v6 offset:0
    ds_read_b64_tr_b16 a[242:243], v6 offset:1024
    ds_read_b64_tr_b16 a[244:245], v6 offset:8
    ds_read_b64_tr_b16 a[246:247], v6 offset:1032
    ds_read_b64_tr_b16 a[248:249], v6 offset:2048
    ds_read_b64_tr_b16 a[250:251], v6 offset:3072
    ds_read_b64_tr_b16 a[252:253], v6 offset:2056
    ds_read_b64_tr_b16 a[254:255], v6 offset:3080
    s_waitcnt lgkmcnt(0)
    s_barrier
L_op_seg:
    s_lshr_b32 s43, s16, 1
    s_add_u32 s43, s43, 1
    s_min_u32 s43, s43, 63
    s_and_b32 s36, s33, 15
    s_lshl_b32 s36, s36, 8
    s_add_u32 s36, s36, 125829120
    s_lshl_b32 s94, s33, 7
    s_add_u32 s94, s94, s16
    s_cmp_ge_u32 s16, 120
    s_cbranch_scc1 L_nocw
    s_mov_b32 s88, 65536
cw15:
    buffer_load_dword v3, off, s[4:7], s36 offset:128 sc1
    s_waitcnt vmcnt(0)
    v_readfirstlane_b32 s42, v3
    s_nop 0
    s_sub_u32 s42, s42, s95
    s_cmp_gt_u32 s42, 64
    s_cselect_b32 s42, 0, s42
    s_add_u32 s42, s42, 2
    s_cmp_ge_u32 s42, s43
    s_cbranch_scc1 cw15x
    s_sub_u32 s88, s88, 1
    s_cbranch_scc1 cw15x
    s_sub_u32 s42, s43, s42
    s_min_u32 s42, s42, 6
cw15s:
    s_sleep 24
    s_sub_u32 s42, s42, 1
    s_cmp_lg_u32 s42, 0
    s_cbranch_scc1 cw15s
    s_branch cw15
cw15x:
L_nocw:
    s_lshr_b32 s89, s16, 1
    s_lshl_b32 s89, s89, 2
    s_add_u32 s89, s89, s32
    s_lshl_b32 s89, s89, 7
    s_add_u32 s89, s89, 125894656
    v_mbcnt_lo_u32_b32 v2, -1, 0
    v_mbcnt_hi_u32_b32 v2, -1, v2
    v_min_u32 v2, 7, v2
    v_lshlrev_b32 v2, 2, v2
    s_mov_b32 s88, 4194304
fw16:
    buffer_load_dword v3, v2, s[4:7], s89 offen offset:0 sc1
    s_sub_u32 s88, s88, 1
    s_cbranch_scc1 fw16x
    s_waitcnt vmcnt(0)
    v_cmp_ne_u32 vcc, s95, v3
    s_cbranch_vccz fw16x
    s_sleep 2
    s_cmp_gt_u32 s88, 4194256
    s_cbranch_scc1 fw16
    s_sleep 40
    s_branch fw16
fw16x:
    s_mov_b32 s21, 4096
os_again:
    s_lshl_b32 s18, s16, 17
    s_lshl_b32 s19, s32, 15
    s_add_u32 s18, s18, s19
    s_add_u32 s18, s18, 50331648
    buffer_load_dwordx4 v[32:35], v1, s[4:7], s18 offen offset:0 sc1
    buffer_load_dwordx4 v[36:39], v1, s[4:7], s18 offen offset:1024 sc1
    buffer_load_dwordx4 v[40:43], v1, s[4:7], s18 offen offset:2048 sc1
    buffer_load_dwordx4 v[44:47], v1, s[4:7], s18 offen offset:3072 sc1
    s_add_u32 s18, s18, 4096
    buffer_load_dwordx4 v[48:51], v1, s[4:7], s18 offen offset:0 sc1
    buffer_load_dwordx4 v[52:55], v1, s[4:7], s18 offen offset:1024 sc1
    buffer_load_dwordx4 v[56:59], v1, s[4:7], s18 offen offset:2048 sc1
    buffer_load_dwordx4 v[60:63], v1, s[4:7], s18 offen offset:3072 sc1
    s_add_u32 s18, s18, 4096
    buffer_load_dwordx4 v[64:67], v1, s[4:7], s18 offen offset:0 sc1
    buffer_load_dwordx4 v[68:71], v1, s[4:7], s18 offen offset:1024 sc1
    buffer_load_dwordx4 v[72:75], v1, s[4:7], s18 offen offset:2048 sc1
    buffer_load_dwordx4 v[76:79], v1, s[4:7], s18 offen offset:3072 sc1
    s_add_u32 s18, s18, 4096
    buffer_load_dwordx4 v[80:83], v1, s[4:7], s18 offen offset:0 sc1
    buffer_load_dwordx4 v[84:87], v1, s[4:7], s18 offen offset:1024 sc1
    buffer_load_dwordx4 v[88:91], v1, s[4:7], s18 offen offset:2048 sc1
    buffer_load_dwordx4 v[92:95], v1, s[4:7], s18 offen offset:3072 sc1
    s_add_u32 s18, s18, 4096
    buffer_load_dwordx4 v[96:99], v1, s[4:7], s18 offen offset:0 sc1
    buffer_load_dwordx4 v[100:103], v1, s[4:7], s18 offen offset:1024 sc1
    buffer_load_dwordx4 v[104:107], v1, s[4:7], s18 offen offset:2048 sc1
    buffer_load_dwordx4 v[108:111], v1, s[4:7], s18 offen offset:3072 sc1
    s_add_u32 s18, s18, 4096
    buffer_load_dwordx4 v[112:115], v1, s[4:7], s18 offen offset:0 sc1
    buffer_load_dwordx4 v[116:119], v1, s[4:7], s18 offen offset:1024 sc1
    buffer_load_dwordx4 v[120:123], v1, s[4:7], s18 offen offset:2048 sc1
    buffer_load_dwordx4 v[124:127], v1, s[4:7], s18 offen offset:3072 sc1
    s_add_u32 s18, s18, 4096
    buffer_load_dwordx4 v[128:131], v1, s[4:7], s18 offen offset:0 sc1
    buffer_load_dwordx4 v[132:135], v1, s[4:7], s18 offen offset:1024 sc1
    buffer_load_dwordx4 v[136:139], v1, s[4:7], s18 offen offset:2048 sc1
    buffer_load_dwordx4 v[140:143], v1, s[4:7], s18 offen offset:3072 sc1
    s_add_u32 s18, s18, 4096
    buffer_load_dwordx4 v[144:147], v1, s[4:7], s18 offen offset:0 sc1
    buffer_load_dwordx4 v[148:151], v1, s[4:7], s18 offen offset:1024 sc1
    buffer_load_dwordx4 v[152:155], v1, s[4:7], s18 offen offset:2048 sc1
    buffer_load_dwordx4 v[156:159], v1, s[4:7], s18 offen offset:3072 sc1
    v_lshlrev_b32 v2, 4, v0
    v_and_b32 v3, 3072, v2
    v_lshl_add_u32 v2, v3, 1, v1
    s_waitcnt vmcnt(31)
    v_mfma_f32_16x16x32_bf16 v[8:11], a[0:3], v[32:35], 0
    v_mfma_f32_16x16x32_bf16 v[12:15], a[4:7], v[32:35], 0
    v_mov_b32 v4, v32
    s_waitcnt vmcnt(30)
    v_mfma_f32_16x16x32_bf16 v[8:11], a[8:11], v[36:39], v[8:11]
    v_mfma_f32_16x16x32_bf16 v[12:15], a[12:15], v[36:39], v[12:15]
    v_max_u32 v4, v4, v36
    s_waitcnt vmcnt(29)
    v_mfma_f32_16x16x32_bf16 v[8:11], a[16:19], v[40:43], v[8:11]
    v_mfma_f32_16x16x32_bf16 v[12:15], a[20:23], v[40:43], v[12:15]
    v_max_u32 v4, v4, v40
    s_waitcnt vmcnt(28)
    v_mfma_f32_16x16x32_bf16 v[8:11], a[24:27], v[44:47], v[8:11]
    v_mfma_f32_16x16x32_bf16 v[12:15], a[28:31], v[44:47], v[12:15]
    v_max_u32 v4, v4, v44
    s_waitcnt vmcnt(27)
    v_mfma_f32_16x16x32_bf16 v[8:11], a[32:35], v[48:51], v[8:11]
    v_mfma_f32_16x16x32_bf16 v[12:15], a[36:39], v[48:51], v[12:15]
    v_max_u32 v4, v4, v48
    s_waitcnt vmcnt(26)
    v_mfma_f32_16x16x32_bf16 v[8:11], a[40:43], v[52:55], v[8:11]
    v_mfma_f32_16x16x32_bf16 v[12:15], a[44:47], v[52:55], v[12:15]
    v_max_u32 v4, v4, v52
    s_waitcnt vmcnt(25)
    v_mfma_f32_16x16x32_bf16 v[8:11], a[48:51], v[56:59], v[8:11]
    v_mfma_f32_16x16x32_bf16 v[12:15], a[52:55], v[56:59], v[12:15]
    v_max_u32 v4, v4, v56
    s_waitcnt vmcnt(24)
    v_mfma_f32_16x16x32_bf16 v[8:11], a[56:59], v[60:63], v[8:11]
    v_mfma_f32_16x16x32_bf16 v[12:15], a[60:63], v[60:63], v[12:15]
    v_max_u32 v4, v4, v60
    s_waitcnt vmcnt(23)
    v_mfma_f32_16x16x32_bf16 v[8:11], a[64:67], v[64:67], v[8:11]
    v_mfma_f32_16x16x32_bf16 v[12:15], a[68:71], v[64:67], v[12:15]
    v_max_u32 v4, v4, v64
    s_waitcnt vmcnt(22)
    v_mfma_f32_16x16x32_bf16 v[8:11], a[72:75], v[68:71], v[8:11]
    v_mfma_f32_16x16x32_bf16 v[12:15], a[76:79], v[68:71], v[12:15]
    v_max_u32 v4, v4, v68
    s_waitcnt vmcnt(21)
    v_mfma_f32_16x16x32_bf16 v[8:11], a[80:83], v[72:75], v[8:11]
    v_mfma_f32_16x16x32_bf16 v[12:15], a[84:87], v[72:75], v[12:15]
    v_max_u32 v4, v4, v72
    s_waitcnt vmcnt(20)
    v_mfma_f32_16x16x32_bf16 v[8:11], a[88:91], v[76:79], v[8:11]
    v_mfma_f32_16x16x32_bf16 v[12:15], a[92:95], v[76:79], v[12:15]
    v_max_u32 v4, v4, v76
    s_waitcnt vmcnt(19)
    v_mfma_f32_16x16x32_bf16 v[8:11], a[96:99], v[80:83], v[8:11]
    v_mfma_f32_16x16x32_bf16 v[12:15], a[100:103], v[80:83], v[12:15]
    v_max_u32 v4, v4, v80
    s_waitcnt vmcnt(18)
    v_mfma_f32_16x16x32_bf16 v[8:11], a[104:107], v[84:87], v[8:11]
    v_mfma_f32_16x16x32_bf16 v[12:15], a[108:111], v[84:87], v[12:15]
    v_max_u32 v4, v4, v84
    s_waitcnt vmcnt(17)
    v_mfma_f32_16x16x32_bf16 v[8:11], a[112:115], v[88:91], v[8:11]
    v_mfma_f32_16x16x32_bf16 v[12:15], a[116:119], v[88:91], v[12:15]
    v_max_u32 v4, v4, v88
    s_waitcnt vmcnt(16)
    v_mfma_f32_16x16x32_bf16 v[8:11], a[120:123], v[92:95], v[8:11]
    v_mfma_f32_16x16x32_bf16 v[12:15], a[124:127], v[92:95], v[12:15]
    v_max_u32 v4, v4, v92
    s_waitcnt vmcnt(15)
    v_mfma_f32_16x16x32_bf16 v[8:11], a[128:131], v[96:99], v[8:11]
    v_mfma_f32_16x16x32_bf16 v[12:15], a[132:135], v[96:99], v[12:15]
    v_max_u32 v4, v4, v96
    s_waitcnt vmcnt(14)
    v_mfma_f32_16x16x32_bf16 v[8:11], a[136:139], v[100:103], v[8:11]
    v_mfma_f32_16x16x32_bf16 v[12:15], a[140:143], v[100:103], v[12:15]
    v_max_u32 v4, v4, v100
    s_waitcnt vmcnt(13)
    v_mfma_f32_16x16x32_bf16 v[8:11], a[144:147], v[104:107], v[8:11]
    v_mfma_f32_16x16x32_bf16 v[12:15], a[148:151], v[104:107], v[12:15]
    v_max_u32 v4, v4, v104
    s_waitcnt vmcnt(12)
    v_mfma_f32_16x16x32_bf16 v[8:11], a[152:155], v[108:111], v[8:11]
    v_mfma_f32_16x16x32_bf16 v[12:15], a[156:159], v[108:111], v[12:15]
    v_max_u32 v4, v4, v108
    s_waitcnt vmcnt(11)
    v_mfma_f32_16x16x32_bf16 v[8:11], a[160:163], v[112:115], v[8:11]
    v_mfma_f32_16x16x32_bf16 v[12:15], a[164:167], v[112:115], v[12:15]
    v_max_u32 v4, v4, v112
    s_waitcnt vmcnt(10)
    v_mfma_f32_16x16x32_bf16 v[8:11], a[168:171], v[116:119], v[8:11]
    v_mfma_f32_16x16x32_bf16 v[12:15], a[172:175], v[116:119], v[12:15]
    v_max_u32 v4, v4, v116
    s_waitcnt vmcnt(9)
    v_mfma_f32_16x16x32_bf16 v[8:11], a[176:179], v[120:123], v[8:11]
    v_mfma_f32_16x16x32_bf16 v[12:15], a[180:183], v[120:123], v[12:15]
    v_max_u32 v4, v4, v120
    s_waitcnt vmcnt(8)
    v_mfma_f32_16x16x32_bf16 v[8:11], a[184:187], v[124:127], v[8:11]
    v_mfma_f32_16x16x32_bf16 v[12:15], a[188:191], v[124:127], v[12:15]
    v_max_u32 v4, v4, v124
    s_waitcnt vmcnt(7)
    v_mfma_f32_16x16x32_bf16 v[8:11], a[192:195], v[128:131], v[8:11]
    v_mfma_f32_16x16x32_bf16 v[12:15], a[196:199], v[128:131], v[12:15]
    v_max_u32 v4, v4, v128
    s_waitcnt vmcnt(6)
    v_mfma_f32_16x16x32_bf16 v[8:11], a[200:203], v[132:135], v[8:11]
    v_mfma_f32_16x16x32_bf16 v[12:15], a[204:207], v[132:135], v[12:15]
    v_max_u32 v4, v4, v132
    s_waitcnt vmcnt(5)
    v_mfma_f32_16x16x32_bf16 v[8:11], a[208:211], v[136:139], v[8:11]
    v_mfma_f32_16x16x32_bf16 v[12:15], a[212:215], v[136:139], v[12:15]
    v_max_u32 v4, v4, v136
    s_waitcnt vmcnt(4)
    v_mfma_f32_16x16x32_bf16 v[8:11], a[216:219], v[140:143], v[8:11]
    v_mfma_f32_16x16x32_bf16 v[12:15], a[220:223], v[140:143], v[12:15]
    v_max_u32 v4, v4, v140
    s_waitcnt vmcnt(3)
    v_mfma_f32_16x16x32_bf16 v[8:11], a[224:227], v[144:147], v[8:11]
    v_mfma_f32_16x16x32_bf16 v[12:15], a[228:231], v[144:147], v[12:15]
    v_max_u32 v4, v4, v144
    s_waitcnt vmcnt(2)
    v_mfma_f32_16x16x32_bf16 v[8:11], a[232:235], v[148:151], v[8:11]
    v_mfma_f32_16x16x32_bf16 v[12:15], a[236:239], v[148:151], v[12:15]
    v_max_u32 v4, v4, v148
    s_waitcnt vmcnt(1)
    v_mfma_f32_16x16x32_bf16 v[8:11], a[240:243], v[152:155], v[8:11]
    v_mfma_f32_16x16x32_bf16 v[12:15], a[244:247], v[152:155], v[12:15]
    v_max_u32 v4, v4, v152
    s_waitcnt vmcnt(0)
    v_mfma_f32_16x16x32_bf16 v[8:11], a[248:251], v[156:159], v[8:11]
    v_mfma_f32_16x16x32_bf16 v[12:15], a[252:255], v[156:159], v[12:15]
    v_max_u32 v4, v4, v156
    v_cmp_eq_u32 vcc, -1, v4
    s_sub_u32 s21, s21, 1
    s_nop 3
    s_cbranch_scc1 os_ok
    s_cbranch_vccnz os_again
os_ok:
    ds_write_b128 v2, v[8:11] offset:0
    ds_write_b128 v2, v[12:15] offset:1024
    s_waitcnt lgkmcnt(0)
    s_barrier
    s_cmp_lg_u32 s32, 0
    s_cbranch_scc1 os_skip
    ds_read_b128 v[40:43], v1 offset:2048
    ds_read_b128 v[44:47], v1 offset:3072
    ds_read_b128 v[48:51], v1 offset:4096
    ds_read_b128 v[52:55], v1 offset:5120
    ds_read_b128 v[56:59], v1 offset:6144
    ds_read_b128 v[60:63], v1 offset:7168
    v_lshrrev_b32 v3, 4, v1
    v_bfe_u32 v4, v3, 2, 2
    v_lshlrev_b32 v4, 3, v4
    v_and_b32 v2, 3, v3
    v_add_u32 v4, v4, v2
    v_mul_u32_u24 v4, 2304, v4
    v_lshrrev_b32 v3, 4, v3
    v_lshl_add_u32 v4, v3, 4, v4
    s_lshr_b32 s18, s16, 1
    s_lshl_b32 s18, s18, 3
    s_and_b32 s19, s16, 1
    s_add_u32 s18, s18, s19
    s_mul_i32 s18, s18, 9216
    s_lshl_b32 s19, s33, 6
    s_add_u32 s18, s18, s19
    s_waitcnt lgkmcnt(0)
    v_pk_add_f32 v[8:9], v[8:9], v[40:41]
    v_pk_add_f32 v[48:49], v[48:49], v[56:57]
    v_pk_add_f32 v[8:9], v[8:9], v[48:49]
    v_pk_add_f32 v[10:11], v[10:11], v[42:43]
    v_pk_add_f32 v[50:51], v[50:51], v[58:59]
    v_pk_add_f32 v[10:11], v[10:11], v[50:51]
    v_pk_add_f32 v[12:13], v[12:13], v[44:45]
    v_pk_add_f32 v[52:53], v[52:53], v[60:61]
    v_pk_add_f32 v[12:13], v[12:13], v[52:53]
    v_pk_add_f32 v[14:15], v[14:15], v[46:47]
    v_pk_add_f32 v[54:55], v[54:55], v[62:63]
    v_pk_add_f32 v[14:15], v[14:15], v[54:55]
    v_cvt_pk_bf16_f32 v32, v8, v9
    v_cvt_pk_bf16_f32 v33, v10, v11
    v_cvt_pk_bf16_f32 v34, v12, v13
    v_cvt_pk_bf16_f32 v35, v14, v15
    buffer_store_dwordx4 v[32:35], v4, s[8:11], s18 offen sc1
os_skip:
    s_nop 1
    s_add_u32 s16, s16, 7
    s_cmp_ge_u32 s16, 128
    s_cbranch_scc1 L_done
    s_barrier
    s_branch L_op_seg
L_done:
L_exit:
    s_endpgm
.section .rodata,"a"
.p2align 6
.amdhsa_kernel concat_heads__memory_aug_recurrent_mem_tr__ssm_conv_s4d__prompt_kernel
  .amdhsa_next_free_vgpr 512
  .amdhsa_next_free_sgpr 102
  .amdhsa_accum_offset 256
  .amdhsa_group_segment_fixed_size 0
  .amdhsa_kernarg_size 136
  .amdhsa_user_sgpr_count 2
  .amdhsa_user_sgpr_kernarg_segment_ptr 1
  .amdhsa_system_sgpr_workgroup_id_x 1
.end_amdhsa_kernel
.text
```

```asm
; @launch grid=(256,1,1) block=(256,1,1) lds=163840
.amdgcn_target "amdgcn-amd-amdhsa--gfx950"
.text
.globl concat_heads__memory_aug_recurrent_mem_tr__ssm_conv_s4d__prompt_kernel
.p2align 8
.type concat_heads__memory_aug_recurrent_mem_tr__ssm_conv_s4d__prompt_kernel,@function
concat_heads__memory_aug_recurrent_mem_tr__ssm_conv_s4d__prompt_kernel:
    s_cmp_ge_u32 s2, 256
    s_cbranch_scc1 L_exit
    s_load_dwordx4 s[84:87], s[0:1], 120
    s_load_dwordx16 s[48:63], s[0:1], 0
    v_lshrrev_b32 v1, 6, v0
    s_nop 0
    v_readfirstlane_b32 s32, v1
    s_getreg_b32 s3, hwreg(HW_REG_XCC_ID)
    s_and_b32 s3, s3, 15
    s_cmp_lg_u32 s32, 3
    s_cbranch_scc1 L_nowarm
    s_getpc_b64 s[44:45]
L_pcw:
    v_and_b32 v1, 63, v0
    v_lshlrev_b32 v1, 7, v1
    s_cmp_lg_u32 s3, 0
    s_cselect_b32 s33, L_helper-L_pcw, 0
    v_add_u32 v1, s33, v1
    v_min_u32 v2, L_exit-L_pcw, v1
    global_load_dword v240, v2, s[44:45]
    v_add_u32 v1, 8192, v1
    v_min_u32 v2, L_exit-L_pcw, v1
    global_load_dword v241, v2, s[44:45]
    v_add_u32 v1, 8192, v1
    s_cbranch_scc0 L_nowarm
    v_min_u32 v2, L_exit-L_pcw, v1
    global_load_dword v242, v2, s[44:45]
    v_add_u32 v1, 8192, v1
    v_min_u32 v2, L_exit-L_pcw, v1
    global_load_dword v243, v2, s[44:45]
    v_add_u32 v1, 8192, v1
    v_min_u32 v2, L_exit-L_pcw, v1
    global_load_dword v244, v2, s[44:45]
    v_add_u32 v1, 8192, v1
L_nowarm:
    s_waitcnt lgkmcnt(0)
    s_mov_b32 s4, s86
    s_mov_b32 s5, s87
    s_mov_b32 s6, 268435456
    s_mov_b32 s7, 0x20000
    s_mov_b32 s96, s84
    s_mov_b32 s97, s85
    s_mov_b32 s98, 256
    s_mov_b32 s99, 0x20000
    s_mov_b32 s95, 0
    s_cmp_lg_u32 s3, 0
    s_cbranch_scc1 L_helper
    s_mov_b32 s37, 128
    v_mov_b32 v250, 1
    v_mov_b32 v251, 163832
    v_cmp_eq_u32 vcc, 0, v0
    s_nop 0
    s_and_saveexec_b64 s[38:39], vcc
    s_cbranch_execz tk1m
    buffer_atomic_add v250, off, s[96:99], s37 sc0
tk1m:
    s_mov_b64 s[38:39], exec
    s_mov_b64 exec, -1
    v_lshrrev_b32 v54, 6, v0
    s_nop 0
    v_readfirstlane_b32 s13, v54
    v_and_b32 v57, 63, v0
    v_bfe_u32 v54, v57, 2, 1
    v_lshlrev_b32 v48, 13, v54
    v_bfe_u32 v54, v57, 3, 1
    v_lshl_add_u32 v48, v54, 15, v48
    v_bfe_u32 v54, v57, 4, 1
    v_lshl_add_u32 v48, v54, 14, v48
    v_bfe_u32 v54, v57, 5, 1
    v_lshl_add_u32 v48, v54, 16, v48
    v_lshrrev_b32 v55, 4, v57
    v_and_b32 v55, 2, v55
    v_xor_b32 v55, v55, v57
    v_and_b32 v55, 3, v55
    v_lshl_add_u32 v48, v55, 4, v48
    v_bfe_u32 v54, v57, 2, 1
    v_lshlrev_b32 v51, 6, v54
    v_bfe_u32 v54, v57, 3, 1
    v_lshl_add_u32 v51, v54, 9, v51
    v_bfe_u32 v54, v57, 4, 1
    v_lshl_add_u32 v51, v54, 7, v51
    v_bfe_u32 v54, v57, 5, 1
    v_lshl_add_u32 v51, v54, 12, v51
    v_bfe_u32 v54, v57, 0, 1
    v_lshl_add_u32 v51, v54, 3, v51
    v_bfe_u32 v54, v57, 1, 1
    v_lshl_add_u32 v51, v54, 4, v51
    v_bfe_u32 v54, v57, 3, 1
    v_lshl_add_u32 v51, v54, 5, v51
    v_lshrrev_b32 v55, 3, v57
    v_mul_u32_u24 v49, 1152, v55
    v_and_b32 v55, 7, v57
    v_lshl_add_u32 v49, v55, 4, v49
    v_bfe_u32 v54, v57, 4, 1
    v_lshlrev_b32 v52, 13, v54
    v_bfe_u32 v54, v57, 5, 1
    v_lshl_add_u32 v52, v54, 9, v52
    v_bfe_u32 v54, v57, 2, 1
    v_lshl_add_u32 v52, v54, 7, v52
    v_bfe_u32 v54, v57, 3, 1
    v_lshl_add_u32 v52, v54, 5, v52
    v_and_b32 v55, 3, v57
    v_lshl_add_u32 v52, v55, 3, v52
    v_lshrrev_b32 v55, 2, v57
    v_mul_u32_u24 v50, 1152, v55
    v_and_b32 v55, 3, v57
    v_lshl_add_u32 v50, v55, 4, v50
    v_bfe_u32 v54, v57, 4, 1
    v_lshlrev_b32 v53, 12, v54
    v_bfe_u32 v54, v57, 5, 1
    v_lshl_add_u32 v53, v54, 8, v53
    v_bfe_u32 v54, v57, 2, 1
    v_lshl_add_u32 v53, v54, 6, v53
    v_bfe_u32 v54, v57, 3, 1
    v_lshl_add_u32 v53, v54, 5, v53
    v_and_b32 v55, 3, v57
    v_lshl_add_u32 v53, v55, 3, v53
    s_lshl_b32 s66, s13, 10
    s_and_b32 s93, s13, 1
    s_lshl_b32 s93, s93, 14
    s_and_b32 s75, s13, 2
    s_lshl_b32 s75, s75, 19
    v_add_u32 v51, s66, v51
    v_add_u32 v52, s66, v52
    v_add_u32 v53, s66, v53
    v_mov_b32 v58, v48
    s_mov_b32 s10, 4718592
    s_mov_b32 s11, 0x20000
    s_mov_b64 exec, s[38:39]
    s_cbranch_execz tk1
    s_waitcnt vmcnt(0)
    ds_write_b32 v251, v250
    s_waitcnt lgkmcnt(0)
tk1:
    s_mov_b64 exec, -1
    s_barrier
    ds_read_b32 v252, v251
    s_waitcnt lgkmcnt(0)
    v_readfirstlane_b32 s12, v252
    s_barrier
    s_nop 3
    s_cmp_ge_u32 s12, 32
    s_cbranch_scc1 L_helper
L_chain:
    s_mov_b64 s[48:49], s[50:51]
    s_mov_b64 s[50:51], s[52:53]
    s_mov_b64 s[52:53], s[54:55]
    s_mov_b64 s[54:55], s[56:57]
    s_mov_b64 s[56:57], s[58:59]
    s_lshl_b32 s67, s12, 8
    s_lshl_b32 s40, s13, 6
    s_add_u32 s67, s67, s40
    s_mul_i32 s92, s12, 147456
    s_lshr_b32 s73, s50, 8
    s_add_u32 s73, s73, s12
    s_and_b32 s73, s73, 31
    s_bitcmp1_b32 0xa2222222, s73
    s_cselect_b32 s88, 1, 0
    s_mov_b32 s72, 0
    s_add_u32 s73, s73, 1
    s_lshr_b32 s73, s73, 2
    s_xor_b32 s94, s13, 0
    s_mul_i32 s94, s94, 36864
    s_add_u32 s94, s94, s92
    s_lshl_b32 s74, s13, 7
    s_add_u32 s94, s94, s74
    s_add_u32 s78, s94, 0
    s_mov_b64 s[8:9], s[56:57]
    v_mov_b32 v58, v49
    s_mov_b32 s79, 9216
    s_mov_b32 s81, 0
    s_add_u32 s80, s66, 114688
    s_mov_b32 s76, 0
    s_mov_b32 s77, 8192
    s_call_b64 s[82:83], cf_dma
    s_mov_b32 s77, 16384
    s_call_b64 s[82:83], cf_dma
    s_xor_b32 s94, s13, 1
    s_mul_i32 s94, s94, 36864
    s_add_u32 s94, s94, s92
    s_lshl_b32 s74, s13, 7
    s_add_u32 s94, s94, s74
    s_add_u32 s78, s94, 0
    s_add_u32 s80, s66, 81920
    s_mov_b32 s76, 0
    s_mov_b32 s77, 8192
    s_call_b64 s[82:83], cf_dma
    s_mov_b32 s77, 16384
    s_call_b64 s[82:83], cf_dma
    s_xor_b32 s94, s13, 2
    s_mul_i32 s94, s94, 36864
    s_add_u32 s94, s94, s92
    s_lshl_b32 s74, s13, 7
    s_add_u32 s94, s94, s74
    s_add_u32 s78, s94, 0
    s_add_u32 s80, s66, 16384
    s_mov_b32 s76, 0
    s_mov_b32 s77, 8192
    s_call_b64 s[82:83], cf_dma
    s_mov_b32 s77, 16384
    s_call_b64 s[82:83], cf_dma
    s_xor_b32 s94, s13, 3
    s_mul_i32 s94, s94, 36864
    s_add_u32 s94, s94, s92
    s_lshl_b32 s74, s13, 7
    s_add_u32 s94, s94, s74
    s_add_u32 s78, s94, 0
    s_add_u32 s80, s66, 0
    s_mov_b32 s76, 0
    s_mov_b32 s77, 8192
    s_call_b64 s[82:83], cf_dma
    s_mov_b32 s77, 16384
    s_call_b64 s[82:83], cf_dma
    v_lshrrev_b32 v24, 6, v0
    v_lshlrev_b32 v61, 4, v0
    v_add_u32 v62, 57344, v61
    v_xor_b32 v63, 1024, v61
    v_add_u32 v63, 98304, v63
    v_xor_b32 v64, 2048, v61
    v_add_u32 v64, 98304, v64
    v_and_b32 v65, 1023, v61
    v_add_u32 v65, 98304, v65
    v_and_b32 v26, 15, v0
    v_bfe_u32 v27, v0, 4, 2
    v_mov_b32 v60, 0x4444
    v_mov_b32 v25, 0xeeee
    v_cmp_lt_u32 vcc, 7, v26
    s_nop 1
    v_cndmask_b32 v60, v60, v25, vcc
    s_nop 1
    v_and_b32 v67, 12, v26
    v_lshlrev_b32 v67, 3, v67
    v_and_b32 v25, 1, v26
    v_lshl_add_u32 v67, v25, 4, v67
    v_bfe_u32 v25, v26, 1, 1
    v_lshl_add_u32 v67, v25, 3, v67
    v_lshl_add_u32 v66, v27, 14, v67
    v_lshl_add_u32 v66, v24, 17, v66
    s_nop 1
    v_and_b32 v67, 63, v67
    v_lshrrev_b32 v25, 1, v24
    v_lshl_add_u32 v67, v25, 18, v67
    v_lshl_add_u32 v67, v27, 16, v67
    v_lshrrev_b32 v25, 3, v26
    v_lshl_add_u32 v67, v25, 15, v67
    v_and_b32 v25, 1, v24
    v_lshl_add_u32 v67, v25, 6, v67
    s_nop 1
    s_waitcnt vmcnt(12)
    v_add_u32 v55, 114688, v52
    ds_read_b64_tr_b16 v[160:161], v55 offset:0
    ds_read_b64_tr_b16 v[162:163], v55 offset:256
    ds_read_b64_tr_b16 v[164:165], v55 offset:4096
    ds_read_b64_tr_b16 v[166:167], v55 offset:4352
    s_xor_b32 s94, s13, 0
    s_mul_i32 s94, s94, 36864
    s_add_u32 s94, s94, s92
    s_lshl_b32 s74, s13, 7
    s_add_u32 s94, s94, s74
    s_add_u32 s78, s94, 512
    s_add_u32 s80, s66, 147456
    s_mov_b32 s76, 0
    s_mov_b32 s77, 8192
    s_call_b64 s[82:83], cf_dma
    ds_read_b64_tr_b16 v[192:193], v55 offset:64
    ds_read_b64_tr_b16 v[194:195], v55 offset:320
    ds_read_b64_tr_b16 v[196:197], v55 offset:4160
    ds_read_b64_tr_b16 v[198:199], v55 offset:4416
    s_mov_b32 s77, 16384
    s_call_b64 s[82:83], cf_dma
    v_and_b32 v25, 31, v0
    v_lshlrev_b32 v70, 4, v25
    v_lshlrev_b32 v28, 3, v25
    v_add_u32 v28, 108032, v28
    v_lshrrev_b32 v25, 1, v24
    v_lshl_add_u32 v70, v25, 9, v70
    v_and_b32 v25, 1, v24
    v_lshl_add_u32 v70, v25, 3, v70
    v_add_u32 v70, 109568, v70
    v_cmp_gt_u32 vcc, 2, v27
    s_nop 1
    v_cndmask_b32 v70, v70, v28, vcc
    s_nop 1
    s_waitcnt lgkmcnt(0)
    s_waitcnt vmcnt(12)
    v_add_u32 v55, 81920, v52
    ds_read_b64_tr_b16 v[168:169], v55 offset:0
    ds_read_b64_tr_b16 v[170:171], v55 offset:256
    ds_read_b64_tr_b16 v[172:173], v55 offset:4096
    ds_read_b64_tr_b16 v[174:175], v55 offset:4352
    s_xor_b32 s94, s13, 1
    s_mul_i32 s94, s94, 36864
    s_add_u32 s94, s94, s92
    s_lshl_b32 s74, s13, 7
    s_add_u32 s94, s94, s74
    s_add_u32 s78, s94, 512
    s_add_u32 s80, s66, 98304
    s_mov_b32 s76, 0
    s_mov_b32 s77, 8192
    s_call_b64 s[82:83], cf_dma
    ds_read_b64_tr_b16 v[200:201], v55 offset:64
    ds_read_b64_tr_b16 v[202:203], v55 offset:320
    ds_read_b64_tr_b16 v[204:205], v55 offset:4160
    ds_read_b64_tr_b16 v[206:207], v55 offset:4416
    s_mov_b32 s77, 16384
    s_call_b64 s[82:83], cf_dma
    v_xor_b32 v71, 2048, v63
    v_lshrrev_b32 v68, 4, v0
    v_lshlrev_b32 v68, 7, v68
    v_and_b32 v25, 7, v26
    v_lshl_add_u32 v68, v25, 4, v68
    v_add_u32 v68, 98304, v68
    v_xor_b32 v74, 512, v68
    v_xor_b32 v75, 1024, v68
    v_xor_b32 v76, 1536, v68
    v_lshrrev_b32 v25, 3, v26
    v_lshl_add_u32 v77, v25, 3, v68
    v_or_b32 v78, 512, v65
    v_lshlrev_b32 v79, 2, v61
    v_mov_b64 v[72:73], 0
    v_and_b32 v25, 1, v27
    v_lshlrev_b32 v69, 7, v25
    v_lshrrev_b32 v25, 1, v27
    v_lshl_add_u32 v69, v25, 3, v69
    v_and_b32 v25, 3, v26
    v_lshl_add_u32 v69, v25, 4, v69
    v_bfe_u32 v25, v26, 2, 1
    v_lshl_add_u32 v69, v25, 2, v69
    s_nop 1
    s_waitcnt lgkmcnt(0)
    s_waitcnt vmcnt(12)
    v_add_u32 v55, 16384, v52
    ds_read_b64_tr_b16 v[176:177], v55 offset:0
    ds_read_b64_tr_b16 v[178:179], v55 offset:256
    ds_read_b64_tr_b16 v[180:181], v55 offset:4096
    ds_read_b64_tr_b16 v[182:183], v55 offset:4352
    s_add_u32 s78, s67, 4194304
    s_mov_b64 s[8:9], s[54:55]
    v_mov_b32 v58, v48
    s_mov_b32 s79, 131072
    s_add_u32 s80, s66, 32768
    s_mov_b32 s76, 0
    s_mov_b32 s77, 8192
    s_call_b64 s[82:83], cf_dma
    ds_read_b64_tr_b16 v[208:209], v55 offset:64
    ds_read_b64_tr_b16 v[210:211], v55 offset:320
    ds_read_b64_tr_b16 v[212:213], v55 offset:4160
    ds_read_b64_tr_b16 v[214:215], v55 offset:4416
    s_mov_b32 s77, 16384
    s_call_b64 s[82:83], cf_dma
    s_mov_b32 s32, 0x00ff00ff
    s_mov_b32 s33, 0x00ff00ff
    s_not_b64 s[34:35], s[32:33]
    s_lshr_b32 s31, s12, 1
    s_lshl_b32 s31, s31, 8
    s_and_b32 s40, s12, 1
    s_lshl_b32 s40, s40, 6
    s_add_u32 s31, s31, s40
    s_and_b32 s40, s13, 1
    s_lshl_b32 s40, s40, 12
    s_add_u32 s31, s31, s40
    s_lshl_b32 s19, s12, 14
    s_add_u32 s19, s19, 67076096
    s_add_u32 s41, s19, 8192
    s_add_u32 s19, s19, s40
    s_and_b32 s40, s12, 1
    s_lshl_b32 s40, s40, 2
    s_or_b32 s40, s40, s13
    s_cmp_eq_u32 s40, 5
    s_cselect_b32 s64, 0, s13
    s_cmp_lg_u32 s13, 1
    s_cbranch_scc1 cf_notx
    s_mov_b32 s32, 0xff
    s_mov_b32 s33, 0xff
    s_mov_b32 s19, s41
    s_lshr_b32 s31, s12, 3
    s_lshl_b32 s31, s31, 8
    s_and_b32 s40, s12, 2
    s_lshl_b32 s40, s40, 6
    s_add_u32 s31, s31, s40
    s_and_b32 s40, s12, 4
    s_lshl_b32 s40, s40, 4
    s_add_u32 s31, s31, s40
    s_add_u32 s31, s31, 8192
cf_notx:
    s_cmp_lg_u32 s13, 0
    s_cbranch_scc1 cf_notp
    s_min_u32 s40, s12, 23
    s_mul_i32 s40, s40, 384
    s_add_u32 s40, s40, 98304
    v_add_u32 v69, s40, v61
    v_mov_b32 v25, 108288
    v_cmp_lt_u32 vcc, 23, v0
    s_nop 1
    v_cndmask_b32 v69, v69, v25, vcc
cf_notp:
    s_nop 1
    s_waitcnt lgkmcnt(0)
    s_waitcnt vmcnt(12)
    v_add_u32 v55, 0, v52
    ds_read_b64_tr_b16 v[184:185], v55 offset:0
    ds_read_b64_tr_b16 v[186:187], v55 offset:256
    ds_read_b64_tr_b16 v[188:189], v55 offset:4096
    ds_read_b64_tr_b16 v[190:191], v55 offset:4352
    s_xor_b32 s78, s75, 0
    s_add_u32 s78, s78, s67
    s_mov_b32 s81, s93
    s_add_u32 s80, s66, 114688
    s_mov_b32 s76, 0
    s_mov_b32 s77, 8192
    s_call_b64 s[82:83], cf_dma
    ds_read_b64_tr_b16 v[216:217], v55 offset:64
    ds_read_b64_tr_b16 v[218:219], v55 offset:320
    ds_read_b64_tr_b16 v[220:221], v55 offset:4160
    ds_read_b64_tr_b16 v[222:223], v55 offset:4416
    s_mov_b32 s77, 16384
    s_call_b64 s[82:83], cf_dma
    v_mov_b32 v28, 1
    v_mov_b32 v29, 1
    v_mov_b32 v30, 1
    v_mov_b32 v31, 1
    s_lshl_b32 s40, s12, 14
    s_add_u32 s40, s40, 67174400
    s_add_u32 s41, s40, 0
    buffer_store_dwordx4 v[28:31], v61, s[4:7], s41 offen
    s_add_u32 s41, s40, 4096
    buffer_store_dwordx4 v[28:31], v61, s[4:7], s41 offen
    s_add_u32 s41, s40, 8192
    buffer_store_dwordx4 v[28:31], v61, s[4:7], s41 offen
    s_cmp_eq_u32 s64, 0
    s_cselect_b64 exec, 0, s[32:33]
    v_mov_b32 v27, -1
    s_add_u32 s41, s31, 67108864
    buffer_store_dword v27, v69, s[4:7], s41 offen
    s_add_u32 s41, s31, 67125248
    buffer_store_dword v27, v69, s[4:7], s41 offen
    s_add_u32 s41, s31, 67141632
    buffer_store_dword v27, v69, s[4:7], s41 offen
    s_add_u32 s41, s31, 67158016
    buffer_store_dword v27, v69, s[4:7], s41 offen
    s_mov_b64 exec, -1
    s_waitcnt lgkmcnt(0)
    s_waitcnt vmcnt(12)
    v_add_u32 v55, 147456, v52
    ds_read_b64_tr_b16 v[224:225], v55 offset:0
    ds_read_b64_tr_b16 v[226:227], v55 offset:256
    ds_read_b64_tr_b16 v[228:229], v55 offset:4096
    ds_read_b64_tr_b16 v[230:231], v55 offset:4352
    s_mov_b32 s77, 24576
    s_call_b64 s[82:83], cf_dma
    ds_read_b64_tr_b16 v[240:241], v55 offset:64
    ds_read_b64_tr_b16 v[242:243], v55 offset:320
    ds_read_b64_tr_b16 v[244:245], v55 offset:4160
    ds_read_b64_tr_b16 v[246:247], v55 offset:4416
    s_mov_b32 s77, 32768
    s_call_b64 s[82:83], cf_dma
    s_mov_b64 s[68:69], s[48:49]
    s_mov_b32 s70, 9216
    s_mov_b32 s71, 0x20000
    v_and_b32 v25, 7, v0
    v_mul_u32_u24 v25, 1152, v25
    v_lshrrev_b32 v26, 3, v0
    v_lshl_add_u32 v25, v26, 4, v25
    buffer_load_dwordx4 v[36:39], v25, s[68:71], 0 offen
    buffer_load_dwordx4 v[40:43], v25, s[68:71], 0 offen offset:512
    v_bfe_u32 v25, v0, 2, 3
    v_mul_u32_u24 v25, 1152, v25
    v_lshrrev_b32 v26, 5, v0
    v_lshl_add_u32 v25, v26, 4, v25
    v_and_b32 v26, 3, v0
    v_lshl_add_u32 v25, v26, 2, v25
    buffer_load_dword v44, v25, s[68:71], 0 offen offset:1024
    s_nop 0
    s_waitcnt lgkmcnt(0)
    s_waitcnt vmcnt(15)
    v_add_u32 v55, 98304, v52
    ds_read_b64_tr_b16 v[232:233], v55 offset:0
    ds_read_b64_tr_b16 v[234:235], v55 offset:256
    ds_read_b64_tr_b16 v[236:237], v55 offset:4096
    ds_read_b64_tr_b16 v[238:239], v55 offset:4352
    s_xor_b32 s78, s75, 1048576
    s_add_u32 s78, s78, s67
    s_add_u32 s80, s66, 65536
    s_mov_b32 s76, 0
    s_mov_b32 s77, 8192
    s_call_b64 s[82:83], cf_dma
    ds_read_b64_tr_b16 v[248:249], v55 offset:64
    ds_read_b64_tr_b16 v[250:251], v55 offset:320
    ds_read_b64_tr_b16 v[252:253], v55 offset:4160
    ds_read_b64_tr_b16 v[254:255], v55 offset:4416
    s_mov_b32 s77, 16384
    s_call_b64 s[82:83], cf_dma
    s_mov_b32 s44, 0x3e0293ee
    s_mov_b32 s45, s44
    s_mov_b32 s46, 0x42000000
    s_mov_b32 s60, 0x3f803f80
    s_mov_b32 s61, s60
    s_mov_b32 s62, 0x3e803e80
    s_mov_b32 s63, s62
    s_mov_b32 s28, 0
    s_lshl_b32 s58, s13, 10
    s_add_u32 s58, s58, 102400
    s_lshl_b32 s59, s13, 8
    s_add_u32 s59, s59, 106496
    s_lshl_b32 s24, s12, 14
    s_add_u32 s24, s24, 0
    s_add_u32 s47, s24, 33030144
    s_mul_i32 s40, s13, 3072
    s_add_u32 s23, s24, s40
    s_lshl_b32 s20, s12, 7
    s_add_u32 s20, s20, 67174400
    s_add_u32 s21, s20, 65536
    s_add_u32 s38, s20, 4096
    s_add_u32 s39, s21, 4096
    s_lshl_b32 s22, s12, 7
    s_add_u32 s22, s22, 67182592
    s_waitcnt lgkmcnt(0)
    s_waitcnt vmcnt(15)
    v_add_u32 v55, 32768, v51
    v_xor_b32 v56, 32, v55
    ds_read_b64_tr_b16 v[144:145], v55 offset:0
    ds_read_b64_tr_b16 v[146:147], v55 offset:256
    ds_read_b64_tr_b16 v[148:149], v55 offset:8192
    ds_read_b64_tr_b16 v[150:151], v55 offset:8448
    s_mov_b32 s77, 24576
    s_call_b64 s[82:83], cf_dma
    ds_read_b64_tr_b16 v[152:153], v56 offset:0
    ds_read_b64_tr_b16 v[154:155], v56 offset:256
    ds_read_b64_tr_b16 v[156:157], v56 offset:8192
    ds_read_b64_tr_b16 v[158:159], v56 offset:8448
    s_mov_b32 s77, 32768
    s_call_b64 s[82:83], cf_dma
    s_lshl_b32 s40, s12, 12
    s_add_u32 s25, s40, 79429632
    s_add_u32 s26, s40, 88866816
    s_lshl_b32 s65, s12, 9
    s_add_u32 s65, s65, 90177536
    s_lshl_b32 s40, s13, 5
    s_or_b32 s40, s40, s12
    s_cmp_lt_u32 s40, 24
    s_cselect_b32 s36, 0x1ffffff, 0
    s_mov_b32 s37, 0
    s_lshl_b32 s27, s12, 7
    s_add_u32 s27, s27, 125845504
    s_lshl_b32 s40, s13, 2
    s_add_u32 s27, s27, s40
    v_bfe_u32 v28, v61, 4, 4
    v_bfe_u32 v29, v61, 8, 1
    v_lshlrev_b32 v29, 2, v29
    v_sub_u32 v29, v28, v29
    v_mov_b32 v31, 0x3f80
    v_mov_b32 v32, 0x3f800000
    s_nop 1
    s_waitcnt lgkmcnt(0)
    s_waitcnt vmcnt(11)
    v_add_u32 v55, 114688, v51
    v_xor_b32 v56, 32, v55
    ds_read_b64_tr_b16 a[192:193], v55 offset:0
    ds_read_b64_tr_b16 a[194:195], v55 offset:256
    ds_read_b64_tr_b16 a[196:197], v55 offset:8192
    ds_read_b64_tr_b16 a[198:199], v55 offset:8448
    s_xor_b32 s78, s75, 2097152
    s_add_u32 s78, s78, s67
    s_add_u32 s80, s66, 0
    s_mov_b32 s76, 0
    s_mov_b32 s77, 8192
    s_call_b64 s[82:83], cf_dma
    ds_read_b64_tr_b16 a[200:201], v56 offset:0
    ds_read_b64_tr_b16 a[202:203], v56 offset:256
    ds_read_b64_tr_b16 a[204:205], v56 offset:8192
    ds_read_b64_tr_b16 a[206:207], v56 offset:8448
    s_mov_b32 s77, 16384
    s_call_b64 s[82:83], cf_dma
    v_cmp_eq_u32 vcc, 0, v29
    s_nop 1
    v_cndmask_b32 v16, 0, v31, vcc
    v_cmp_eq_u32 vcc, 1, v29
    s_nop 1
    v_cndmask_b32 v16, v16, v32, vcc
    v_cmp_eq_u32 vcc, 0, v28
    s_nop 1
    v_cndmask_b32 v20, 0, v31, vcc
    v_cmp_eq_u32 vcc, 1, v28
    s_nop 1
    v_cndmask_b32 v20, v20, v32, vcc
    s_nop 1
    s_waitcnt lgkmcnt(0)
    v_add_u32 v55, 131072, v51
    v_xor_b32 v56, 32, v55
    ds_read_b64_tr_b16 a[208:209], v55 offset:0
    ds_read_b64_tr_b16 a[210:211], v55 offset:256
    ds_read_b64_tr_b16 a[212:213], v55 offset:8192
    ds_read_b64_tr_b16 a[214:215], v55 offset:8448
    s_mov_b32 s77, 24576
    s_call_b64 s[82:83], cf_dma
    ds_read_b64_tr_b16 a[216:217], v56 offset:0
    ds_read_b64_tr_b16 a[218:219], v56 offset:256
    ds_read_b64_tr_b16 a[220:221], v56 offset:8192
    ds_read_b64_tr_b16 a[222:223], v56 offset:8448
    s_mov_b32 s77, 32768
    s_call_b64 s[82:83], cf_dma
    v_cmp_eq_u32 vcc, 2, v29
    s_nop 1
    v_cndmask_b32 v17, 0, v31, vcc
    v_cmp_eq_u32 vcc, 3, v29
    s_nop 1
    v_cndmask_b32 v17, v17, v32, vcc
    v_cmp_eq_u32 vcc, 2, v28
    s_nop 1
    v_cndmask_b32 v21, 0, v31, vcc
    v_cmp_eq_u32 vcc, 3, v28
    s_nop 1
    v_cndmask_b32 v21, v21, v32, vcc
    s_nop 1
    s_waitcnt lgkmcnt(0)
    s_waitcnt vmcnt(8)
    v_add_u32 v55, 65536, v51
    v_xor_b32 v56, 32, v55
    ds_read_b64_tr_b16 a[224:225], v55 offset:0
    ds_read_b64_tr_b16 a[226:227], v55 offset:256
    ds_read_b64_tr_b16 a[228:229], v55 offset:8192
    ds_read_b64_tr_b16 a[230:231], v55 offset:8448
    s_cmp_eq_u32 s88, 0
    s_cbranch_scc1 cf_cpe626
    s_lshl_b32 s89, s73, 7
    s_add_u32 s89, s89, 125853696
    v_min_u32 v33, 11, v57
    v_lshlrev_b32 v33, 2, v33
    buffer_load_dword v34, off, s[96:99], 0 offset:64 sc1
    buffer_load_dword v35, v33, s[4:7], s89 offen sc1
cf_cpe626:
    s_xor_b32 s78, s75, 3145728
    s_add_u32 s78, s78, s67
    s_add_u32 s80, s66, 32768
    s_mov_b32 s76, 0
    s_mov_b32 s77, 8192
    s_call_b64 s[82:83], cf_dma
    ds_read_b64_tr_b16 a[232:233], v56 offset:0
    ds_read_b64_tr_b16 a[234:235], v56 offset:256
    ds_read_b64_tr_b16 a[236:237], v56 offset:8192
    ds_read_b64_tr_b16 a[238:239], v56 offset:8448
    s_mov_b32 s77, 16384
    s_call_b64 s[82:83], cf_dma
    v_cmp_eq_u32 vcc, 8, v29
    s_nop 1
    v_cndmask_b32 v18, 0, v31, vcc
    v_cmp_eq_u32 vcc, 9, v29
    s_nop 1
    v_cndmask_b32 v18, v18, v32, vcc
    v_cmp_eq_u32 vcc, 4, v28
    s_nop 1
    v_cndmask_b32 v22, 0, v31, vcc
    v_cmp_eq_u32 vcc, 5, v28
    s_nop 1
    v_cndmask_b32 v22, v22, v32, vcc
    s_nop 1
    s_waitcnt lgkmcnt(0)
    v_add_u32 v55, 81920, v51
    v_xor_b32 v56, 32, v55
    ds_read_b64_tr_b16 a[240:241], v55 offset:0
    ds_read_b64_tr_b16 a[242:243], v55 offset:256
    ds_read_b64_tr_b16 a[244:245], v55 offset:8192
    ds_read_b64_tr_b16 a[246:247], v55 offset:8448
    s_mov_b32 s77, 24576
    s_call_b64 s[82:83], cf_dma
    ds_read_b64_tr_b16 a[248:249], v56 offset:0
    ds_read_b64_tr_b16 a[250:251], v56 offset:256
    ds_read_b64_tr_b16 a[252:253], v56 offset:8192
    ds_read_b64_tr_b16 a[254:255], v56 offset:8448
    s_mov_b32 s77, 32768
    s_call_b64 s[82:83], cf_dma
    v_cmp_eq_u32 vcc, 10, v29
    s_nop 1
    v_cndmask_b32 v19, 0, v31, vcc
    v_cmp_eq_u32 vcc, 11, v29
    s_nop 1
    v_cndmask_b32 v19, v19, v32, vcc
    v_cmp_eq_u32 vcc, 6, v28
    s_nop 1
    v_cndmask_b32 v23, 0, v31, vcc
    v_cmp_eq_u32 vcc, 7, v28
    s_nop 1
    v_cndmask_b32 v23, v23, v32, vcc
    s_nop 1
    s_waitcnt lgkmcnt(0)
    s_waitcnt vmcnt(8)
    v_add_u32 v55, 0, v51
    v_xor_b32 v56, 32, v55
    ds_read_b64_tr_b16 v[80:81], v55 offset:0
    ds_read_b64_tr_b16 v[82:83], v55 offset:256
    ds_read_b64_tr_b16 v[84:85], v55 offset:8192
    ds_read_b64_tr_b16 v[86:87], v55 offset:8448
    s_cmp_eq_u32 s88, 0
    s_cbranch_scc1 cf_ncp696
    s_waitcnt vmcnt(8)
    v_max_u32 v34, 1, v34
    v_cmp_eq_u32 vcc, 1, v34
    s_cbranch_vccnz cf_ncp696
    v_cmp_ne_u32 vcc, v34, v35
    s_cbranch_vccnz cf_ncp696
    s_mov_b32 s88, 0
    s_mov_b32 s72, 5
    s_lshl_b32 s74, s73, 19
    s_add_u32 s74, s74, 96468992
    s_add_u32 s50, s4, s74
    s_addc_u32 s51, s5, 0
    s_add_u32 s52, s50, 147456
    s_addc_u32 s53, s51, 0
    s_lshl_b32 s67, s13, 6
    v_and_b32 v54, 63, v48
    v_lshrrev_b32 v48, 13, v48
    v_lshl_add_u32 v48, v48, 8, v54
cf_ncp696:
    s_cmp_eq_u32 s88, 0
    s_cbranch_scc1 cf_cpe717
    s_lshl_b32 s89, s73, 7
    s_add_u32 s89, s89, 125853696
    v_min_u32 v33, 11, v57
    v_lshlrev_b32 v33, 2, v33
    buffer_load_dword v34, off, s[96:99], 0 offset:64 sc1
    buffer_load_dword v35, v33, s[4:7], s89 offen sc1
cf_cpe717:
    s_xor_b32 s78, s75, 2097152
    s_lshr_b32 s78, s78, s72
    s_add_u32 s78, s78, s67
    s_mov_b64 s[8:9], s[52:53]
    v_mov_b32 v58, v48
    s_lshr_b32 s79, 131072, s72
    s_add_u32 s80, s66, 131072
    s_mov_b32 s76, 0
    s_mov_b32 s77, 8192
    s_call_b64 s[82:83], cf_dma
    ds_read_b64_tr_b16 v[88:89], v56 offset:0
    ds_read_b64_tr_b16 v[90:91], v56 offset:256
    ds_read_b64_tr_b16 v[92:93], v56 offset:8192
    ds_read_b64_tr_b16 v[94:95], v56 offset:8448
    s_mov_b32 s77, 16384
    s_call_b64 s[82:83], cf_dma
    v_mov_b32 v46, 1
    s_mov_b64 exec, 1
    buffer_atomic_add v46, off, s[96:99], 0 offset:132 sc0
    s_mov_b64 exec, -1
    s_waitcnt lgkmcnt(0)
    v_add_u32 v55, 16384, v51
    v_xor_b32 v56, 32, v55
    ds_read_b64_tr_b16 v[96:97], v55 offset:0
    ds_read_b64_tr_b16 v[98:99], v55 offset:256
    ds_read_b64_tr_b16 v[100:101], v55 offset:8192
    ds_read_b64_tr_b16 v[102:103], v55 offset:8448
    s_mov_b32 s77, 24576
    s_call_b64 s[82:83], cf_dma
    ds_read_b64_tr_b16 v[104:105], v56 offset:0
    ds_read_b64_tr_b16 v[106:107], v56 offset:256
    ds_read_b64_tr_b16 v[108:109], v56 offset:8192
    ds_read_b64_tr_b16 v[110:111], v56 offset:8448
    s_mov_b32 s77, 32768
    s_call_b64 s[82:83], cf_dma
    s_waitcnt lgkmcnt(0)
    s_waitcnt vmcnt(9)
    v_add_u32 v55, 32768, v51
    v_xor_b32 v56, 32, v55
    ds_read_b64_tr_b16 v[112:113], v55 offset:0
    ds_read_b64_tr_b16 v[114:115], v55 offset:256
    ds_read_b64_tr_b16 v[116:117], v55 offset:8192
    ds_read_b64_tr_b16 v[118:119], v55 offset:8448
    s_cmp_eq_u32 s88, 0
    s_cbranch_scc1 cf_ncp769
    s_waitcnt vmcnt(9)
    v_max_u32 v34, 1, v34
    v_cmp_eq_u32 vcc, 1, v34
    s_cbranch_vccnz cf_ncp769
    v_cmp_ne_u32 vcc, v34, v35
    s_cbranch_vccnz cf_ncp769
    s_mov_b32 s88, 0
    s_mov_b32 s72, 5
    s_lshl_b32 s74, s73, 19
    s_add_u32 s74, s74, 96468992
    s_add_u32 s50, s4, s74
    s_addc_u32 s51, s5, 0
    s_add_u32 s52, s50, 147456
    s_addc_u32 s53, s51, 0
    s_lshl_b32 s67, s13, 6
    v_and_b32 v54, 63, v48
    v_lshrrev_b32 v48, 13, v48
    v_lshl_add_u32 v48, v48, 8, v54
cf_ncp769:
    s_cmp_eq_u32 s88, 0
    s_cbranch_scc1 cf_cpe790
    s_lshl_b32 s89, s73, 7
    s_add_u32 s89, s89, 125853696
    v_min_u32 v33, 11, v57
    v_lshlrev_b32 v33, 2, v33
    buffer_load_dword v34, off, s[96:99], 0 offset:64 sc1
    buffer_load_dword v35, v33, s[4:7], s89 offen sc1
cf_cpe790:
    s_xor_b32 s78, s75, 3145728
    s_lshr_b32 s78, s78, s72
    s_add_u32 s78, s78, s67
    s_mov_b64 s[8:9], s[52:53]
    v_mov_b32 v58, v48
    s_lshr_b32 s79, 131072, s72
    s_add_u32 s80, s66, 65536
    s_mov_b32 s76, 0
    s_mov_b32 s77, 8192
    s_call_b64 s[82:83], cf_dma
    ds_read_b64_tr_b16 v[120:121], v56 offset:0
    ds_read_b64_tr_b16 v[122:123], v56 offset:256
    ds_read_b64_tr_b16 v[124:125], v56 offset:8192
    ds_read_b64_tr_b16 v[126:127], v56 offset:8448
    s_mov_b32 s77, 16384
    s_call_b64 s[82:83], cf_dma
    s_waitcnt lgkmcnt(0)
    v_add_u32 v55, 49152, v51
    v_xor_b32 v56, 32, v55
    ds_read_b64_tr_b16 v[128:129], v55 offset:0
    ds_read_b64_tr_b16 v[130:131], v55 offset:256
    ds_read_b64_tr_b16 v[132:133], v55 offset:8192
    ds_read_b64_tr_b16 v[134:135], v55 offset:8448
    s_mov_b32 s77, 24576
    s_call_b64 s[82:83], cf_dma
    ds_read_b64_tr_b16 v[136:137], v56 offset:0
    ds_read_b64_tr_b16 v[138:139], v56 offset:256
    ds_read_b64_tr_b16 v[140:141], v56 offset:8192
    ds_read_b64_tr_b16 v[142:143], v56 offset:8448
    s_mov_b32 s77, 32768
    s_call_b64 s[82:83], cf_dma
    s_waitcnt lgkmcnt(0)
    s_waitcnt vmcnt(8)
    v_add_u32 v55, 131072, v51
    v_xor_b32 v56, 32, v55
    ds_read_b64_tr_b16 a[128:129], v55 offset:0
    ds_read_b64_tr_b16 a[130:131], v55 offset:256
    ds_read_b64_tr_b16 a[132:133], v55 offset:8192
    ds_read_b64_tr_b16 a[134:135], v55 offset:8448
    s_cmp_eq_u32 s88, 0
    s_cbranch_scc1 cf_ncp838
    s_waitcnt vmcnt(8)
    v_max_u32 v34, 1, v34
    v_cmp_eq_u32 vcc, 1, v34
    s_cbranch_vccnz cf_ncp838
    v_cmp_ne_u32 vcc, v34, v35
    s_cbranch_vccnz cf_ncp838
    s_mov_b32 s88, 0
    s_mov_b32 s72, 5
    s_lshl_b32 s74, s73, 19
    s_add_u32 s74, s74, 96468992
    s_add_u32 s50, s4, s74
    s_addc_u32 s51, s5, 0
    s_add_u32 s52, s50, 147456
    s_addc_u32 s53, s51, 0
    s_lshl_b32 s67, s13, 6
    v_and_b32 v54, 63, v48
    v_lshrrev_b32 v48, 13, v48
    v_lshl_add_u32 v48, v48, 8, v54
cf_ncp838:
    s_cmp_eq_u32 s88, 0
    s_cbranch_scc1 cf_cpe859
    s_lshl_b32 s89, s73, 7
    s_add_u32 s89, s89, 125853696
    v_min_u32 v33, 11, v57
    v_lshlrev_b32 v33, 2, v33
    buffer_load_dword v34, off, s[96:99], 0 offset:64 sc1
    buffer_load_dword v35, v33, s[4:7], s89 offen sc1
cf_cpe859:
    s_xor_b32 s78, s75, 2097152
    s_lshr_b32 s78, s78, s72
    s_add_u32 s78, s78, s67
    s_mov_b64 s[8:9], s[50:51]
    v_mov_b32 v58, v48
    s_lshr_b32 s79, 131072, s72
    s_add_u32 s80, s66, 0
    s_mov_b32 s76, 0
    s_mov_b32 s77, 8192
    s_call_b64 s[82:83], cf_dma
    ds_read_b64_tr_b16 a[136:137], v56 offset:0
    ds_read_b64_tr_b16 a[138:139], v56 offset:256
    ds_read_b64_tr_b16 a[140:141], v56 offset:8192
    ds_read_b64_tr_b16 a[142:143], v56 offset:8448
    s_mov_b32 s77, 16384
    s_call_b64 s[82:83], cf_dma
    s_waitcnt lgkmcnt(0)
    v_add_u32 v55, 147456, v51
    v_xor_b32 v56, 32, v55
    ds_read_b64_tr_b16 a[144:145], v55 offset:0
    ds_read_b64_tr_b16 a[146:147], v55 offset:256
    ds_read_b64_tr_b16 a[148:149], v55 offset:8192
    ds_read_b64_tr_b16 a[150:151], v55 offset:8448
    s_mov_b32 s77, 24576
    s_call_b64 s[82:83], cf_dma
    ds_read_b64_tr_b16 a[152:153], v56 offset:0
    ds_read_b64_tr_b16 a[154:155], v56 offset:256
    ds_read_b64_tr_b16 a[156:157], v56 offset:8192
    ds_read_b64_tr_b16 a[158:159], v56 offset:8448
    s_mov_b32 s77, 32768
    s_call_b64 s[82:83], cf_dma
    s_waitcnt lgkmcnt(0)
    s_waitcnt vmcnt(8)
    v_add_u32 v55, 65536, v51
    v_xor_b32 v56, 32, v55
    ds_read_b64_tr_b16 a[160:161], v55 offset:0
    ds_read_b64_tr_b16 a[162:163], v55 offset:256
    ds_read_b64_tr_b16 a[164:165], v55 offset:8192
    ds_read_b64_tr_b16 a[166:167], v55 offset:8448
    s_cmp_eq_u32 s88, 0
    s_cbranch_scc1 cf_ncp907
    s_waitcnt vmcnt(8)
    v_max_u32 v34, 1, v34
    v_cmp_eq_u32 vcc, 1, v34
    s_cbranch_vccnz cf_ncp907
    v_cmp_ne_u32 vcc, v34, v35
    s_cbranch_vccnz cf_ncp907
    s_mov_b32 s88, 0
    s_mov_b32 s72, 5
    s_lshl_b32 s74, s73, 19
    s_add_u32 s74, s74, 96468992
    s_add_u32 s50, s4, s74
    s_addc_u32 s51, s5, 0
    s_add_u32 s52, s50, 147456
    s_addc_u32 s53, s51, 0
    s_lshl_b32 s67, s13, 6
    v_and_b32 v54, 63, v48
    v_lshrrev_b32 v48, 13, v48
    v_lshl_add_u32 v48, v48, 8, v54
cf_ncp907:
    s_cmp_eq_u32 s88, 0
    s_cbranch_scc1 cf_cpe928
    s_lshl_b32 s89, s73, 7
    s_add_u32 s89, s89, 125853696
    v_min_u32 v33, 11, v57
    v_lshlrev_b32 v33, 2, v33
    buffer_load_dword v34, off, s[96:99], 0 offset:64 sc1
    buffer_load_dword v35, v33, s[4:7], s89 offen sc1
cf_cpe928:
    s_xor_b32 s78, s75, 3145728
    s_lshr_b32 s78, s78, s72
    s_add_u32 s78, s78, s67
    s_mov_b64 s[8:9], s[50:51]
    v_mov_b32 v58, v48
    s_lshr_b32 s79, 131072, s72
    s_add_u32 s80, s66, 32768
    s_mov_b32 s76, 0
    s_mov_b32 s77, 8192
    s_call_b64 s[82:83], cf_dma
    ds_read_b64_tr_b16 a[168:169], v56 offset:0
    ds_read_b64_tr_b16 a[170:171], v56 offset:256
    ds_read_b64_tr_b16 a[172:173], v56 offset:8192
    ds_read_b64_tr_b16 a[174:175], v56 offset:8448
    s_mov_b32 s77, 16384
    s_call_b64 s[82:83], cf_dma
    v_readfirstlane_b32 s41, v46
    v_mov_b32 v46, 1
    v_mov_b32 v47, 0
    s_cmp_eq_u32 s41, 127
    s_cselect_b64 exec, 1, 0
    buffer_atomic_cmpswap v[46:47], off, s[96:99], 0 offset:140
    s_mov_b64 exec, -1
    s_waitcnt lgkmcnt(0)
    v_add_u32 v55, 81920, v51
    v_xor_b32 v56, 32, v55
    ds_read_b64_tr_b16 a[176:177], v55 offset:0
    ds_read_b64_tr_b16 a[178:179], v55 offset:256
    ds_read_b64_tr_b16 a[180:181], v55 offset:8192
    ds_read_b64_tr_b16 a[182:183], v55 offset:8448
    s_mov_b32 s77, 24576
    s_call_b64 s[82:83], cf_dma
    ds_read_b64_tr_b16 a[184:185], v56 offset:0
    ds_read_b64_tr_b16 a[186:187], v56 offset:256
    ds_read_b64_tr_b16 a[188:189], v56 offset:8192
    ds_read_b64_tr_b16 a[190:191], v56 offset:8448
    s_mov_b32 s77, 32768
    s_call_b64 s[82:83], cf_dma
    s_waitcnt lgkmcnt(0)
    s_waitcnt vmcnt(8)
    v_add_u32 v55, 0, v51
    v_xor_b32 v56, 32, v55
    ds_read_b64_tr_b16 a[48:49], v55 offset:0
    ds_read_b64_tr_b16 a[50:51], v55 offset:256
    ds_read_b64_tr_b16 a[52:53], v55 offset:8192
    ds_read_b64_tr_b16 a[54:55], v55 offset:8448
    s_lshr_b32 s78, 4194304, s72
    s_add_u32 s78, s78, s67
    s_mov_b32 s81, 0
    s_add_u32 s80, s66, 98304
    s_mov_b32 s76, 0
    s_mov_b32 s77, 8192
    s_call_b64 s[82:83], cf_dma
    ds_read_b64_tr_b16 a[56:57], v56 offset:0
    ds_read_b64_tr_b16 a[58:59], v56 offset:256
    ds_read_b64_tr_b16 a[60:61], v56 offset:8192
    ds_read_b64_tr_b16 a[62:63], v56 offset:8448
    s_mov_b32 s77, 16384
    s_call_b64 s[82:83], cf_dma
    s_waitcnt lgkmcnt(0)
    v_add_u32 v55, 16384, v51
    v_xor_b32 v56, 32, v55
    ds_read_b64_tr_b16 a[64:65], v55 offset:0
    ds_read_b64_tr_b16 a[66:67], v55 offset:256
    ds_read_b64_tr_b16 a[68:69], v55 offset:8192
    ds_read_b64_tr_b16 a[70:71], v55 offset:8448
    s_cmp_eq_u32 s88, 0
    s_cbranch_scc1 cf_ncp1003
    s_waitcnt vmcnt(12)
    v_max_u32 v34, 1, v34
    v_cmp_eq_u32 vcc, 1, v34
    s_cbranch_vccnz cf_ncp1003
    v_cmp_ne_u32 vcc, v34, v35
    s_cbranch_vccnz cf_ncp1003
    s_mov_b32 s88, 0
    s_mov_b32 s72, 5
    s_lshl_b32 s74, s73, 19
    s_add_u32 s74, s74, 96468992
    s_add_u32 s50, s4, s74
    s_addc_u32 s51, s5, 0
    s_add_u32 s52, s50, 147456
    s_addc_u32 s53, s51, 0
    s_lshl_b32 s67, s13, 6
    v_and_b32 v54, 63, v48
    v_lshrrev_b32 v48, 13, v48
    v_lshl_add_u32 v48, v48, 8, v54
cf_ncp1003:
    s_xor_b32 s78, s75, 1048576
    s_lshr_b32 s78, s78, s72
    s_add_u32 s78, s78, s67
    s_mov_b64 s[8:9], s[50:51]
    v_mov_b32 v58, v48
    s_lshr_b32 s79, 131072, s72
    s_mov_b32 s81, s93
    s_add_u32 s80, s66, 114688
    s_mov_b32 s76, 0
    s_mov_b32 s77, 8192
    s_call_b64 s[82:83], cf_dma
    ds_read_b64_tr_b16 a[72:73], v56 offset:0
    ds_read_b64_tr_b16 a[74:75], v56 offset:256
    ds_read_b64_tr_b16 a[76:77], v56 offset:8192
    ds_read_b64_tr_b16 a[78:79], v56 offset:8448
    s_mov_b32 s77, 16384
    s_call_b64 s[82:83], cf_dma
    s_waitcnt lgkmcnt(0)
    s_waitcnt vmcnt(8)
    v_add_u32 v55, 32768, v51
    v_xor_b32 v56, 32, v55
    ds_read_b64_tr_b16 a[80:81], v55 offset:0
    ds_read_b64_tr_b16 a[82:83], v55 offset:256
    ds_read_b64_tr_b16 a[84:85], v55 offset:8192
    ds_read_b64_tr_b16 a[86:87], v55 offset:8448
    s_mov_b32 s77, 24576
    s_call_b64 s[82:83], cf_dma
    ds_read_b64_tr_b16 a[88:89], v56 offset:0
    ds_read_b64_tr_b16 a[90:91], v56 offset:256
    ds_read_b64_tr_b16 a[92:93], v56 offset:8192
    ds_read_b64_tr_b16 a[94:95], v56 offset:8448
    s_mov_b32 s77, 32768
    s_call_b64 s[82:83], cf_dma
    s_waitcnt lgkmcnt(0)
    v_add_u32 v55, 49152, v51
    v_xor_b32 v56, 32, v55
    ds_read_b64_tr_b16 a[96:97], v55 offset:0
    ds_read_b64_tr_b16 a[98:99], v55 offset:256
    ds_read_b64_tr_b16 a[100:101], v55 offset:8192
    ds_read_b64_tr_b16 a[102:103], v55 offset:8448
    s_xor_b32 s78, s75, 0
    s_lshr_b32 s78, s78, s72
    s_add_u32 s78, s78, s67
    s_add_u32 s80, s66, 65536
    s_mov_b32 s76, 0
    s_mov_b32 s77, 8192
    s_call_b64 s[82:83], cf_dma
    ds_read_b64_tr_b16 a[104:105], v56 offset:0
    ds_read_b64_tr_b16 a[106:107], v56 offset:256
    ds_read_b64_tr_b16 a[108:109], v56 offset:8192
    ds_read_b64_tr_b16 a[110:111], v56 offset:8448
    s_mov_b32 s77, 16384
    s_call_b64 s[82:83], cf_dma
    s_waitcnt lgkmcnt(0)
    s_waitcnt vmcnt(12)
    v_add_u32 v55, 98304, v51
    v_xor_b32 v56, 32, v55
    ds_read_b64_tr_b16 a[112:113], v55 offset:0
    ds_read_b64_tr_b16 a[114:115], v55 offset:256
    ds_read_b64_tr_b16 a[116:117], v55 offset:8192
    ds_read_b64_tr_b16 a[118:119], v55 offset:8448
    s_mov_b32 s77, 24576
    s_call_b64 s[82:83], cf_dma
    ds_read_b64_tr_b16 a[120:121], v56 offset:0
    ds_read_b64_tr_b16 a[122:123], v56 offset:256
    ds_read_b64_tr_b16 a[124:125], v56 offset:8192
    ds_read_b64_tr_b16 a[126:127], v56 offset:8448
    s_mov_b32 s77, 32768
    s_call_b64 s[82:83], cf_dma
    s_waitcnt lgkmcnt(0)
    s_waitcnt vmcnt(8)
    v_add_u32 v55, 114688, v51
    v_xor_b32 v56, 32, v55
    ds_read_b64_tr_b16 a[16:17], v55 offset:0
    ds_read_b64_tr_b16 a[18:19], v55 offset:256
    ds_read_b64_tr_b16 a[20:21], v55 offset:8192
    ds_read_b64_tr_b16 a[22:23], v55 offset:8448
    s_xor_b32 s78, s75, 0
    s_lshr_b32 s78, s78, s72
    s_add_u32 s78, s78, s67
    s_mov_b64 s[8:9], s[52:53]
    s_add_u32 s80, s66, 0
    s_mov_b32 s76, 0
    s_mov_b32 s77, 8192
    s_call_b64 s[82:83], cf_dma
    ds_read_b64_tr_b16 a[24:25], v56 offset:0
    ds_read_b64_tr_b16 a[26:27], v56 offset:256
    ds_read_b64_tr_b16 a[28:29], v56 offset:8192
    ds_read_b64_tr_b16 a[30:31], v56 offset:8448
    s_mov_b32 s77, 16384
    s_call_b64 s[82:83], cf_dma
    s_waitcnt lgkmcnt(0)
    v_add_u32 v55, 131072, v51
    v_xor_b32 v56, 32, v55
    ds_read_b64_tr_b16 a[32:33], v55 offset:0
    ds_read_b64_tr_b16 a[34:35], v55 offset:256
    ds_read_b64_tr_b16 a[36:37], v55 offset:8192
    ds_read_b64_tr_b16 a[38:39], v55 offset:8448
    s_mov_b32 s77, 24576
    s_call_b64 s[82:83], cf_dma
    ds_read_b64_tr_b16 a[40:41], v56 offset:0
    ds_read_b64_tr_b16 a[42:43], v56 offset:256
    ds_read_b64_tr_b16 a[44:45], v56 offset:8192
    ds_read_b64_tr_b16 a[46:47], v56 offset:8448
    s_mov_b32 s77, 32768
    s_call_b64 s[82:83], cf_dma
    s_waitcnt lgkmcnt(0)
    s_waitcnt vmcnt(8)
    v_add_u32 v55, 65536, v51
    v_xor_b32 v56, 32, v55
    ds_read_b64_tr_b16 v[0:1], v55 offset:0
    ds_read_b64_tr_b16 v[2:3], v55 offset:256
    ds_read_b64_tr_b16 v[4:5], v55 offset:8192
    ds_read_b64_tr_b16 v[6:7], v55 offset:8448
    s_xor_b32 s78, s75, 1048576
    s_lshr_b32 s78, s78, s72
    s_add_u32 s78, s78, s67
    s_add_u32 s80, s66, 32768
    s_mov_b32 s76, 0
    s_mov_b32 s77, 8192
    s_call_b64 s[82:83], cf_dma
    ds_read_b64_tr_b16 v[8:9], v56 offset:0
    ds_read_b64_tr_b16 v[10:11], v56 offset:256
    ds_read_b64_tr_b16 v[12:13], v56 offset:8192
    ds_read_b64_tr_b16 v[14:15], v56 offset:8448
    s_mov_b32 s77, 16384
    s_call_b64 s[82:83], cf_dma
    s_waitcnt lgkmcnt(0)
    ds_write_b128 v62, v[0:3] offset:8192
    ds_write_b128 v62, v[4:7] offset:12288
    ds_write_b128 v62, v[8:11] offset:16384
    ds_write_b128 v62, v[12:15] offset:20480
    s_waitcnt lgkmcnt(0)
    v_add_u32 v55, 81920, v51
    v_xor_b32 v56, 32, v55
    ds_read_b64_tr_b16 a[0:1], v55 offset:0
    ds_read_b64_tr_b16 a[2:3], v55 offset:256
    ds_read_b64_tr_b16 a[4:5], v55 offset:8192
    ds_read_b64_tr_b16 a[6:7], v55 offset:8448
    s_mov_b32 s77, 24576
    s_call_b64 s[82:83], cf_dma
    ds_read_b64_tr_b16 a[8:9], v56 offset:0
    ds_read_b64_tr_b16 a[10:11], v56 offset:256
    ds_read_b64_tr_b16 a[12:13], v56 offset:8192
    ds_read_b64_tr_b16 a[14:15], v56 offset:8448
    s_mov_b32 s77, 32768
    s_call_b64 s[82:83], cf_dma
    s_waitcnt lgkmcnt(0)
    s_waitcnt vmcnt(8)
    v_add_u32 v55, 0, v51
    v_xor_b32 v56, 32, v55
    ds_read_b64_tr_b16 v[0:1], v55 offset:0
    ds_read_b64_tr_b16 v[2:3], v55 offset:256
    ds_read_b64_tr_b16 v[4:5], v55 offset:8192
    ds_read_b64_tr_b16 v[6:7], v55 offset:8448
    s_xor_b32 s94, s13, 0
    s_mul_i32 s94, s94, 36864
    s_add_u32 s94, s94, s92
    s_lshr_b32 s74, s13, 1
    s_lshl_b32 s74, s74, 6
    s_add_u32 s94, s94, s74
    s_add_u32 s78, s94, 1024
    s_mov_b64 s[8:9], s[56:57]
    v_mov_b32 v58, v50
    s_mov_b32 s79, 18432
    s_mov_b32 s81, 0
    s_add_u32 s80, s66, 147456
    s_mov_b32 s76, 0
    s_mov_b32 s77, 8192
    s_call_b64 s[82:83], cf_dma
    ds_read_b64_tr_b16 v[8:9], v56 offset:0
    ds_read_b64_tr_b16 v[10:11], v56 offset:256
    ds_read_b64_tr_b16 v[12:13], v56 offset:8192
    ds_read_b64_tr_b16 v[14:15], v56 offset:8448
    s_xor_b32 s94, s13, 2
    s_mul_i32 s94, s94, 36864
    s_add_u32 s94, s94, s92
    s_lshr_b32 s74, s13, 1
    s_lshl_b32 s74, s74, 6
    s_add_u32 s94, s94, s74
    s_add_u32 s78, s94, 1024
    s_mov_b32 s77, 16384
    s_call_b64 s[82:83], cf_dma
    s_waitcnt lgkmcnt(0)
    ds_write_b128 v61, v[0:3] offset:0
    ds_write_b128 v61, v[4:7] offset:4096
    ds_write_b128 v61, v[8:11] offset:8192
    ds_write_b128 v61, v[12:15] offset:12288
    s_waitcnt lgkmcnt(0)
    v_add_u32 v55, 16384, v51
    v_xor_b32 v56, 32, v55
    ds_read_b64_tr_b16 v[0:1], v55 offset:0
    ds_read_b64_tr_b16 v[2:3], v55 offset:256
    ds_read_b64_tr_b16 v[4:5], v55 offset:8192
    ds_read_b64_tr_b16 v[6:7], v55 offset:8448
    s_xor_b32 s94, s13, 3
    s_mul_i32 s94, s94, 36864
    s_add_u32 s94, s94, s92
    s_lshl_b32 s74, s13, 7
    s_add_u32 s94, s94, s74
    s_add_u32 s78, s94, 512
    v_mov_b32 v58, v49
    s_mov_b32 s79, 9216
    s_add_u32 s80, s66, 131072
    s_mov_b32 s76, 0
    s_mov_b32 s77, 8192
    s_call_b64 s[82:83], cf_dma
    ds_read_b64_tr_b16 v[8:9], v56 offset:0
    ds_read_b64_tr_b16 v[10:11], v56 offset:256
    ds_read_b64_tr_b16 v[12:13], v56 offset:8192
    ds_read_b64_tr_b16 v[14:15], v56 offset:8448
    s_mov_b32 s77, 16384
    s_call_b64 s[82:83], cf_dma
    s_waitcnt lgkmcnt(0)
    ds_write_b128 v61, v[0:3] offset:16384
    ds_write_b128 v61, v[4:7] offset:20480
    ds_write_b128 v61, v[8:11] offset:24576
    ds_write_b128 v61, v[12:15] offset:28672
    s_waitcnt lgkmcnt(0)
    s_waitcnt vmcnt(8)
    v_add_u32 v55, 32768, v51
    v_xor_b32 v56, 32, v55
    ds_read_b64_tr_b16 v[0:1], v55 offset:0
    ds_read_b64_tr_b16 v[2:3], v55 offset:256
    ds_read_b64_tr_b16 v[4:5], v55 offset:8192
    ds_read_b64_tr_b16 v[6:7], v55 offset:8448
    s_xor_b32 s94, s13, 2
    s_mul_i32 s94, s94, 36864
    s_add_u32 s94, s94, s92
    s_lshl_b32 s74, s13, 7
    s_add_u32 s94, s94, s74
    s_add_u32 s78, s94, 512
    s_add_u32 s80, s66, 114688
    s_mov_b32 s76, 0
    s_mov_b32 s77, 8192
    s_call_b64 s[82:83], cf_dma
    ds_read_b64_tr_b16 v[8:9], v56 offset:0
    ds_read_b64_tr_b16 v[10:11], v56 offset:256
    ds_read_b64_tr_b16 v[12:13], v56 offset:8192
    ds_read_b64_tr_b16 v[14:15], v56 offset:8448
    s_mov_b32 s77, 16384
    s_call_b64 s[82:83], cf_dma
    s_waitcnt lgkmcnt(0)
    ds_write_b128 v61, v[0:3] offset:32768
    ds_write_b128 v61, v[4:7] offset:36864
    ds_write_b128 v61, v[8:11] offset:40960
    ds_write_b128 v61, v[12:15] offset:45056
    s_waitcnt lgkmcnt(0)
    v_add_u32 v55, 49152, v51
    v_xor_b32 v56, 32, v55
    ds_read_b64_tr_b16 v[0:1], v55 offset:0
    ds_read_b64_tr_b16 v[2:3], v55 offset:256
    ds_read_b64_tr_b16 v[4:5], v55 offset:8192
    ds_read_b64_tr_b16 v[6:7], v55 offset:8448
    s_lshr_b32 s78, 4194304, s72
    s_add_u32 s78, s78, s67
    s_mov_b64 s[8:9], s[52:53]
    v_mov_b32 v58, v48
    s_lshr_b32 s79, 131072, s72
    s_add_u32 s80, s66, 81920
    s_mov_b32 s76, 0
    s_mov_b32 s77, 8192
    s_call_b64 s[82:83], cf_dma
    ds_read_b64_tr_b16 v[8:9], v56 offset:0
    ds_read_b64_tr_b16 v[10:11], v56 offset:256
    ds_read_b64_tr_b16 v[12:13], v56 offset:8192
    ds_read_b64_tr_b16 v[14:15], v56 offset:8448
    s_mov_b32 s77, 16384
    s_call_b64 s[82:83], cf_dma
    s_waitcnt lgkmcnt(0)
    ds_write_b128 v61, v[0:3] offset:49152
    ds_write_b128 v61, v[4:7] offset:53248
    ds_write_b128 v61, v[8:11] offset:57344
    ds_write_b128 v61, v[12:15] offset:61440
    s_waitcnt lgkmcnt(0)
    buffer_load_dword v24, off, s[96:99], 0 offset:140 sc1
    buffer_load_dword v25, off, s[96:99], 0 offset:64 sc1
    s_lshr_b32 s84, s12, 1
    s_lshl_b32 s84, s84, 8
    s_add_u32 s84, s84, 125829120
    v_bfe_u32 v26, v61, 4, 6
    v_min_u32 v26, 11, v26
    v_lshlrev_b32 v26, 2, v26
    buffer_load_dword v27, v26, s[4:7], s84 offen sc1
    s_waitcnt vmcnt(15)
    v_add_u32 v55, 147456, v53
    ds_read_b64_tr_b16 v[0:1], v55 offset:0
    ds_read_b64_tr_b16 v[2:3], v55 offset:128
    ds_read_b64_tr_b16 v[4:5], v55 offset:512
    ds_read_b64_tr_b16 v[6:7], v55 offset:640
    ds_read_b64_tr_b16 v[8:9], v55 offset:8192
    ds_read_b64_tr_b16 v[10:11], v55 offset:8320
    ds_read_b64_tr_b16 v[12:13], v55 offset:8704
    ds_read_b64_tr_b16 v[14:15], v55 offset:8832
    s_waitcnt lgkmcnt(0)
    s_barrier
    ds_write_b128 v63, v[0:3] offset:49152
    ds_write_b128 v63, v[4:7] offset:53248
    s_barrier
    ds_write_b128 v63, v[8:11] offset:57344
    ds_write_b128 v63, v[12:15] offset:61440
    s_waitcnt lgkmcnt(0)
    v_lshlrev_b32 v45, 3, v61
    s_lshl_b32 s40, s12, 14
    s_add_u32 s40, s40, 65536
    s_lshl_b32 s41, s12, 11
    s_sub_u32 s41, s41, 12288
    v_add_u32 v30, s40, v45
    v_add_u32 v45, s41, v45
    v_cmp_gt_u32 vcc, 1536, v61
    s_nop 1
    v_cndmask_b32 v45, v45, v30, vcc
    s_lshl_b32 s40, s12, 16
    s_add_u32 s40, s40, 25151488
    v_lshlrev_b32 v30, 3, v61
    v_add_u32 v30, s40, v30
    v_cmp_gt_u32 vcc, 1792, v61
    s_nop 1
    v_cndmask_b32 v45, v30, v45, vcc
    v_cmp_gt_u32 vcc, 2944, v61
    s_mov_b32 s40, 67108864
    s_mov_b64 exec, vcc
    buffer_load_dword v30, v45, s[4:7], s40 offen sc1
    s_mov_b64 exec, -1
    s_waitcnt vmcnt(11)
    v_add_u32 v55, 131072, v52
    ds_read_b64_tr_b16 v[0:1], v55 offset:0
    ds_read_b64_tr_b16 v[2:3], v55 offset:256
    ds_read_b64_tr_b16 v[4:5], v55 offset:4096
    ds_read_b64_tr_b16 v[6:7], v55 offset:4352
    ds_read_b64_tr_b16 v[8:9], v55 offset:64
    ds_read_b64_tr_b16 v[10:11], v55 offset:320
    ds_read_b64_tr_b16 v[12:13], v55 offset:4160
    ds_read_b64_tr_b16 v[14:15], v55 offset:4416
    s_waitcnt lgkmcnt(0)
    s_barrier
    ds_write_b128 v63, v[0:3] offset:32768
    ds_write_b128 v63, v[4:7] offset:36864
    s_barrier
    ds_write_b128 v63, v[8:11] offset:40960
    ds_write_b128 v63, v[12:15] offset:45056
    s_waitcnt lgkmcnt(0)
    s_waitcnt vmcnt(7)
    v_add_u32 v55, 114688, v52
    ds_read_b64_tr_b16 v[0:1], v55 offset:0
    ds_read_b64_tr_b16 v[2:3], v55 offset:256
    ds_read_b64_tr_b16 v[4:5], v55 offset:4096
    ds_read_b64_tr_b16 v[6:7], v55 offset:4352
    ds_read_b64_tr_b16 v[8:9], v55 offset:64
    ds_read_b64_tr_b16 v[10:11], v55 offset:320
    ds_read_b64_tr_b16 v[12:13], v55 offset:4160
    ds_read_b64_tr_b16 v[14:15], v55 offset:4416
    s_waitcnt lgkmcnt(0)
    s_barrier
    ds_write_b128 v63, v[0:3] offset:16384
    ds_write_b128 v63, v[4:7] offset:20480
    s_barrier
    ds_write_b128 v63, v[8:11] offset:24576
    ds_write_b128 v63, v[12:15] offset:28672
    s_waitcnt lgkmcnt(0)
    v_min_u32 v36, -2, v36
    v_min_u32 v37, -2, v37
    v_min_u32 v38, -2, v38
    v_min_u32 v39, -2, v39
    v_min_u32 v40, -2, v40
    v_min_u32 v41, -2, v41
    v_min_u32 v42, -2, v42
    v_min_u32 v43, -2, v43
    v_min_u32 v44, -2, v44
    s_lshl_b32 s14, s12, 16
    s_add_u32 s14, s14, 92274688
    s_add_u32 s41, s14, 4096
    s_add_u32 s42, s14, 8192
    v_lshrrev_b32 v45, 2, v61
    buffer_store_dwordx4 v[36:39], v61, s[4:7], s14 offen
    buffer_store_dwordx4 v[40:43], v61, s[4:7], s41 offen
    buffer_store_dword v44, v45, s[4:7], s42 offen
    s_waitcnt vmcnt(1)
    v_readfirstlane_b32 s95, v25
    v_readfirstlane_b32 s85, v24
    s_add_u32 s86, s95, 2
    s_waitcnt vmcnt(0)
    v_subrev_u32 v27, s86, v27
    v_cmp_lt_u32 s[86:87], 64, v27
    s_cmp_eq_u32 s95, 0
    s_cselect_b64 s[86:87], -1, s[86:87]
    s_cmp_lg_u64 s[86:87], 0
    s_cbranch_scc1 cf_nt
    s_add_u32 s40, s24, 524288
    buffer_load_dword v30, v79, s[4:7], s24 offen sc1
    buffer_load_dword v30, v79, s[4:7], s40 offen sc1
cf_nt:
    s_waitcnt vmcnt(3)
    v_add_u32 v55, 81920, v51
    v_xor_b32 v56, 32, v55
    ds_read_b64_tr_b16 v[0:1], v55 offset:0
    ds_read_b64_tr_b16 v[2:3], v55 offset:256
    ds_read_b64_tr_b16 v[4:5], v55 offset:8192
    ds_read_b64_tr_b16 v[6:7], v55 offset:8448
    ds_read_b64_tr_b16 v[8:9], v56 offset:0
    ds_read_b64_tr_b16 v[10:11], v56 offset:256
    ds_read_b64_tr_b16 v[12:13], v56 offset:8192
    ds_read_b64_tr_b16 v[14:15], v56 offset:8448
    s_waitcnt lgkmcnt(0)
    ds_write_b128 v62, v[0:3] offset:24576
    ds_write_b128 v62, v[4:7] offset:28672
    ds_write_b128 v62, v[8:11] offset:32768
    ds_write_b128 v62, v[12:15] offset:36864
    s_waitcnt lgkmcnt(0)
    s_barrier
    s_mov_b32 s88, 4194304
gn2:
    s_cmp_lg_u32 s95, 0
    s_cbranch_scc1 gn2x
    buffer_load_dword v27, off, s[96:99], 0 offset:64 sc1
    s_sub_u32 s88, s88, 1
    s_cbranch_scc1 gn2x
    s_waitcnt vmcnt(0)
    v_readfirstlane_b32 s95, v27
    s_nop 1
    s_branch gn2
gn2x:
    ds_write_b128 v78, v[16:19] offset:8704
    ds_write_b128 v65, v[20:23] offset:10240
    v_mov_b32 v44, s95
    v_mov_b32 v45, s95
    v_mov_b32 v46, s95
    v_mov_b32 v47, s95
    v_mov_b32 v48, 108288
    ds_write_b128 v48, v[44:47]
    s_waitcnt vmcnt(0) lgkmcnt(0)
    s_cmp_eq_u32 s85, 1
    s_cbranch_scc1 cf_run
    s_mov_b32 s40, 131072
cf_startpoll:
    buffer_load_dword v3, off, s[96:99], 0 offset:140 sc1
    s_waitcnt vmcnt(0)
    v_readfirstlane_b32 s85, v3
    s_nop 0
    s_cmp_eq_u32 s85, 1
    s_cbranch_scc1 cf_run
    s_cmp_eq_u32 s85, 2
    s_cbranch_scc1 cf_leave
    s_sleep 1
    s_sub_u32 s40, s40, 1
    s_cbranch_scc0 cf_startpoll
    v_mov_b32 v4, 2
    v_mov_b32 v5, 0
    s_mov_b64 exec, 1
    buffer_atomic_cmpswap v[4:5], off, s[96:99], 0 offset:140
    s_mov_b64 exec, -1
    s_mov_b32 s40, 1048576
    s_branch cf_startpoll
cf_leave:
    v_lshrrev_b32 v0, 4, v61
    s_mov_b32 s32, s13
    s_load_dwordx16 s[48:63], s[0:1], 0
    s_waitcnt lgkmcnt(0)
    s_branch L_helper
cf_run:
    s_cmp_eq_u64 s[86:87], 0
    s_cbranch_scc1 cf_kvok
    s_lshr_b32 s92, s12, 1
    s_lshl_b32 s92, s92, 8
    s_add_u32 s92, s92, 125829120
    v_bfe_u32 v2, v61, 4, 6
    v_min_u32 v2, 11, v2
    v_lshlrev_b32 v2, 2, v2
    s_add_u32 s93, s95, 2
    s_mov_b32 s94, 4194304
cf_kv0:
    buffer_load_dword v3, v2, s[4:7], s92 offen sc1
    s_sub_u32 s94, s94, 1
    s_cbranch_scc1 cf_kv0_go
    s_waitcnt vmcnt(0)
    v_subrev_u32 v3, s93, v3
    v_cmp_lt_u32 vcc, 64, v3
    s_cbranch_vccz cf_kv0_go
    s_sleep 2
    s_branch cf_kv0
cf_kv0_go:
    s_add_u32 s40, s24, 524288
    buffer_load_dword v30, v79, s[4:7], s24 offen sc1
    buffer_load_dword v30, v79, s[4:7], s40 offen sc1
    s_waitcnt vmcnt(0)
cf_kvok:
    s_mov_b32 m0, 108032
    s_add_u32 s24, s24, 1048576
    s_add_u32 s15, s14, 4096
    s_add_u32 s16, s14, 8192
    ds_read_b128 v[32:35], v62 offset:16384
    ds_read_b128 v[36:39], v62 offset:20480
    ds_read_b128 v[40:43], v61 offset:0
    ds_read_b128 v[44:47], v61 offset:4096
    ds_read_b128 v[48:51], v61 offset:8192
    ds_read_b128 v[52:55], v61 offset:12288
    s_mov_b32 s29, 1048576
    buffer_load_dwordx4 v[24:27], v61, s[4:7], s14 offen nt
.p2align 6
cf_loop:
    v_mov_b64 v[0:1], 0
    v_mov_b64 v[2:3], 0
    v_mov_b64 v[4:5], 0
    v_mov_b64 v[6:7], 0
    v_mov_b64 v[8:9], 0
    v_mov_b64 v[10:11], 0
    v_mov_b64 v[12:13], 0
    v_mov_b64 v[14:15], 0
cf_loop2:
    ds_read_b128 v[16:19], v62 offset:8192
    ds_read_b128 v[20:23], v62 offset:12288
    v_lshrrev_b32 v56, 2, v61
    v_add_u32 v58, 106496, v56
    s_mov_b32 s29, 1048576
    s_nop 13
    buffer_load_dwordx4 v[24:27], v61, s[4:7], s14 offen nt
    s_waitcnt lgkmcnt(0)
cf_chk0:
    s_waitcnt vmcnt(1)
cf_chk0b:
    v_max3_u32 v57, v24, v25, v26
    v_max_u32 v57, v57, v27
    v_cmp_eq_u32 vcc, -1, v57
    ds_write_b128 v62, v[24:27] offset:40960
    s_cbranch_vccnz cf_spin0
    v_smfmac_f32_16x16x64_bf16 v[0:3], v[24:27], v[16:23], v60
    s_mov_b32 m0, s58
    s_nop 0
    buffer_load_dwordx4 v61, s[4:7], s15 offen nt lds
    v_smfmac_f32_16x16x64_bf16 v[8:11], v[24:27], v[32:39], v60
    s_mov_b32 m0, s59
    s_nop 0
    buffer_load_dword v56, s[4:7], s16 offen nt lds
    v_smfmac_f32_16x16x64_bf16 v[12:15], v[24:27], v[48:55], v60
    ds_read_b128 v[32:35], v61 offset:16384
    v_mfma_f32_16x16x16_bf16 v[16:19], v[72:73], v[72:73], 0
    ds_read_b128 v[36:39], v61 offset:20480
    s_waitcnt lgkmcnt(2)
    s_barrier
    ds_read_b128 v[48:51], v63 offset:0
    v_mfma_f32_16x16x16_bf16 v[20:23], v[72:73], v[72:73], 0
    ds_read_b128 v[52:55], v64 offset:0
    v_smfmac_f32_16x16x64_bf16 v[4:7], v[24:27], v[40:47], v60
    ds_read_b128 v[40:43], v61 offset:24576
    v_smfmac_f32_16x16x64_bf16 v[16:19], v[24:27], a[192:199], v60
    ds_read_b128 v[44:47], v61 offset:28672
    v_smfmac_f32_16x16x64_bf16 v[20:23], v[24:27], a[200:207], v60
    s_mov_b32 m0, 108032
    s_waitcnt lgkmcnt(3)
    v_smfmac_f32_16x16x64_bf16 v[0:3], v[48:51], a[0:7], v60
    s_add_u32 s18, s14, s31
    s_add_u32 s41, s14, 16384
    v_smfmac_f32_16x16x64_bf16 v[4:7], v[48:51], v[32:39], v60
    ds_read_b128 v[32:35], v61 offset:32768
    v_smfmac_f32_16x16x64_bf16 v[8:11], v[48:51], a[8:15], v60
    ds_read_b128 v[36:39], v61 offset:36864
    s_waitcnt lgkmcnt(2)
    v_smfmac_f32_16x16x64_bf16 v[12:15], v[48:51], v[40:47], v60
    ds_read_b128 v[40:43], v61 offset:40960
    v_smfmac_f32_16x16x64_bf16 v[16:19], v[48:51], a[208:215], v60
    ds_read_b128 v[44:47], v61 offset:45056
    v_smfmac_f32_16x16x64_bf16 v[20:23], v[48:51], a[216:223], v60
    ds_read_b128 v[48:51], v71 offset:0
    v_smfmac_f32_16x16x64_bf16 v[0:3], v[52:55], a[16:23], v60
    s_waitcnt vmcnt(0)
    ds_read_b128 v[28:31], v62 offset:45056
    s_waitcnt lgkmcnt(4)
    v_smfmac_f32_16x16x64_bf16 v[4:7], v[52:55], v[32:39], v60
    ds_read_b32 v59, v58
    buffer_load_dwordx4 v[24:27], v61, s[4:7], s23 offen offset:0 sc1
    v_smfmac_f32_16x16x64_bf16 v[8:11], v[52:55], a[24:31], v60
    ds_read_b128 v[32:35], v61 offset:49152
    s_waitcnt lgkmcnt(4)
    v_smfmac_f32_16x16x64_bf16 v[12:15], v[52:55], v[40:47], v60
    ds_read_b128 v[36:39], v61 offset:53248
    v_smfmac_f32_16x16x64_bf16 v[16:19], v[52:55], a[224:231], v60
    ds_read_b128 v[40:43], v61 offset:57344
    v_smfmac_f32_16x16x64_bf16 v[20:23], v[52:55], a[232:239], v60
    ds_read_b128 v[44:47], v61 offset:61440
    s_waitcnt lgkmcnt(4)
    v_smfmac_f32_16x16x64_bf16 v[0:3], v[48:51], a[32:39], v60
    v_max3_u32 v57, v28, v29, v30
    v_smfmac_f32_16x16x64_bf16 v[8:11], v[48:51], a[40:47], v60
    v_max3_u32 v57, v57, v31, v59
    s_waitcnt lgkmcnt(2)
    v_smfmac_f32_16x16x64_bf16 v[4:7], v[48:51], v[32:39], v60
    buffer_load_dwordx4 v[32:35], v61, s[4:7], s23 offen offset:1024 sc1
    v_cmp_eq_u32 vcc, -1, v57
    v_smfmac_f32_16x16x64_bf16 v[16:19], v[48:51], a[240:247], v60
    v_smfmac_f32_16x16x64_bf16 v[20:23], v[48:51], a[248:255], v60
    s_cbranch_vccnz cf_spin1
cf_go1:
    s_barrier
    ds_read_b128 v[52:55], v63 offset:4096
    s_waitcnt lgkmcnt(1)
    v_smfmac_f32_16x16x64_bf16 v[12:15], v[48:51], v[40:47], v60
    ds_read_b128 v[48:51], v64 offset:4096
    v_smfmac_f32_16x16x64_bf16 v[0:3], v[28:31], a[48:55], v60
    buffer_load_dwordx4 v[40:43], v61, s[4:7], s23 offen offset:2048 sc1
    v_smfmac_f32_16x16x64_bf16 v[8:11], v[28:31], a[56:63], v60
    ds_read_b128 v[56:59], v71 offset:4096
    s_and_b32 s41, s41, 65535
    v_smfmac_f32_16x16x64_bf16 v[4:7], v[28:31], a[128:135], v60
    ds_read_b128 v[36:39], v65 offset:8192
    s_add_u32 s41, s41, 67108864
    v_smfmac_f32_16x16x64_bf16 v[12:15], v[28:31], a[136:143], v60
    s_add_u32 s17, s41, s31
    s_and_b32 s30, s28, 1
    s_waitcnt lgkmcnt(3)
    v_smfmac_f32_16x16x64_bf16 v[0:3], v[52:55], a[64:71], v60
    buffer_load_dwordx4 v[44:47], v61, s[4:7], s23 offen offset:3072 sc1
    v_smfmac_f32_16x16x64_bf16 v[4:7], v[52:55], a[144:151], v60
    ds_read_b128 v[28:31], v78 offset:8704
    v_smfmac_f32_16x16x64_bf16 v[8:11], v[52:55], a[72:79], v60
    v_smfmac_f32_16x16x64_bf16 v[12:15], v[52:55], a[152:159], v60
    ds_read_b128 v[52:55], v62 offset:28672
    s_waitcnt lgkmcnt(4)
    v_smfmac_f32_16x16x64_bf16 v[0:3], v[48:51], a[80:87], v60
    v_smfmac_f32_16x16x64_bf16 v[4:7], v[48:51], a[160:167], v60
    v_smfmac_f32_16x16x64_bf16 v[8:11], v[48:51], a[88:95], v60
    buffer_load_dword v79, s[4:7], s24 offen sc1 lds
    v_smfmac_f32_16x16x64_bf16 v[12:15], v[48:51], a[168:175], v60
    v_smfmac_f32_16x16x64_bf16 v[16:19], v[48:51], v[112:119], v60
    v_smfmac_f32_16x16x64_bf16 v[20:23], v[48:51], v[120:127], v60
    ds_read_b128 v[48:51], v62 offset:24576
    s_waitcnt lgkmcnt(4)
    v_smfmac_f32_16x16x64_bf16 v[0:3], v[56:59], a[96:103], v60
    s_cmp_ge_u32 s28, 62
    v_smfmac_f32_16x16x64_bf16 v[8:11], v[56:59], a[104:111], v60
    s_waitcnt lgkmcnt(3)
    v_smfmac_f32_16x16x64_bf16 v[0:3], v[36:39], a[112:119], v60
    v_smfmac_f32_16x16x64_bf16 v[8:11], v[36:39], a[120:127], v60
    v_smfmac_f32_16x16x64_bf16 v[4:7], v[56:59], a[176:183], v60
    s_waitcnt lgkmcnt(0)
    v_cvt_pk_bf16_f32 v0, v0, v1
    v_smfmac_f32_16x16x64_bf16 v[4:7], v[36:39], v[48:55], v60
    ds_read_b128 v[48:51], v62 offset:32768
    v_cvt_pk_bf16_f32 v8, v8, v9
    v_smfmac_f32_16x16x64_bf16 v[12:15], v[56:59], a[184:191], v60
    ds_read_b128 v[52:55], v62 offset:36864
    v_cvt_pk_bf16_f32 v9, v10, v11
    v_smfmac_f32_16x16x64_bf16 v[16:19], v[56:59], v[128:135], v60
    v_cvt_pk_bf16_f32 v1, v2, v3
    v_mfma_f32_16x16x16_bf16 v[8:11], v[8:9], v[28:29], 0
    v_cvt_pk_bf16_f32 v2, v4, v5
    v_cvt_pk_bf16_f32 v3, v6, v7
    v_smfmac_f32_16x16x64_bf16 v[20:23], v[56:59], v[136:143], v60
    s_mov_b64 exec, s[36:37]
    ds_read_b128 v[56:59], v69
    s_mov_b64 exec, -1
    v_mfma_f32_16x16x32_bf16 v[4:7], v[0:3], v[28:31], 0
    v_cvt_pk_bf16_f32 v2, v8, v9
    s_waitcnt lgkmcnt(1)
    v_smfmac_f32_16x16x64_bf16 v[12:15], v[36:39], v[48:55], v60
    ds_read_b128 v[48:51], v63 offset:4096
    v_cvt_pk_bf16_f32 v3, v10, v11
    s_waitcnt vmcnt(3)
    v_cvt_pk_bf16_f32 v0, v4, v5
    v_cvt_pk_bf16_f32 v1, v6, v7
    s_nop 1
    v_mfma_f32_16x16x32_bf16 v[4:7], v[32:35], v[0:3], 0
    v_cvt_pk_bf16_f32 v12, v12, v13
    v_cvt_pk_bf16_f32 v13, v14, v15
    s_nop 1
    v_mfma_f32_16x16x16_bf16 v[12:15], v[12:13], v[30:31], 0
    ds_read_b128 v[52:55], v62 offset:45056
    ds_read_b128 v[32:35], v63 offset:49152
    v_mfma_f32_16x16x32_bf16 v[28:31], v[24:27], v[0:3], 0
    s_waitcnt vmcnt(1)
    s_mov_b64 exec, s[34:35]
    s_nop 1
    v_cvt_pk_bf16_f32 v2, v12, v13
    v_cvt_pk_bf16_f32 v3, v14, v15
    s_mov_b64 exec, -1
    s_nop 0
    v_mfma_f32_16x16x32_bf16 v[8:11], v[0:3], v[0:3], 0
    v_mov_b32_dpp v28, v4 row_ror:8 row_mask:0xf bank_mask:0xc
    v_mov_b32_dpp v29, v5 row_ror:8 row_mask:0xf bank_mask:0xc
    v_mov_b32_dpp v30, v6 row_ror:8 row_mask:0xf bank_mask:0xc
    v_mov_b32_dpp v31, v7 row_ror:8 row_mask:0xf bank_mask:0xc
    v_smfmac_f32_16x16x64_bf16 v[16:19], v[36:39], v[144:151], v60
    ds_write_b128 v62, v[28:31] offset:53248
    v_mov_b32_dpp v8, v10 row_ror:8 row_mask:0xf bank_mask:0xc
    v_mov_b32_dpp v9, v11 row_ror:8 row_mask:0xf bank_mask:0xc
    v_smfmac_f32_16x16x64_bf16 v[20:23], v[36:39], v[152:159], v60
    ds_write_b64 v70, v[8:9]
    s_waitcnt lgkmcnt(4)
    v_smfmac_f32_16x16x64_bf16 v[16:19], v[48:51], v[96:103], v60
    s_mov_b64 exec, s[36:37]
    buffer_store_dwordx4 v[56:59], v61, s[4:7], s65 offen sc1
    s_mov_b64 exec, -1
    v_smfmac_f32_16x16x64_bf16 v[20:23], v[48:51], v[104:111], v60
    s_cbranch_scc1 cf_last
cf_back:
    s_waitcnt lgkmcnt(0)
    s_barrier
    ds_read_b128 v[56:59], v78 offset:10752
    v_smfmac_f32_16x16x64_bf16 v[16:19], v[52:55], v[80:87], v60
    ds_read_b128 v[12:15], v78 offset:11264
    ds_read_b128 v[4:7], v63 offset:12288
    v_smfmac_f32_16x16x64_bf16 v[20:23], v[52:55], v[88:95], v60
    ds_read_b128 v[8:11], v64 offset:12288
    ds_read_b128 v[0:3], v71 offset:12288
    v_mov_b64 v[24:25], s[62:63]
    v_mov_b64 v[26:27], s[60:61]
    v_cvt_pk_bf16_f32 v16, v16, v17
    v_cvt_pk_bf16_f32 v17, v18, v19
    v_pk_mul_f32 v[28:29], v[28:29], s[44:45]
    v_pk_mul_f32 v[30:31], v[30:31], s[44:45]
    s_waitcnt lgkmcnt(3)
    v_pk_add_f32 v[56:57], v[56:57], v[58:59]
    v_pk_add_f32 v[12:13], v[12:13], v[14:15]
    v_pk_add_f32 v[56:57], v[56:57], v[12:13]
    v_pk_mul_f32 v[56:57], v[56:57], s[44:45]
    v_exp_f32 v58, v56
    v_exp_f32 v59, v57
    s_waitcnt lgkmcnt(1)
    v_pk_fma_f32 v[28:29], v[4:5], s[44:45], v[28:29]
    v_pk_fma_f32 v[30:31], v[6:7], s[44:45], v[30:31]
    v_cvt_pk_bf16_f32 v6, v58, v59
    v_pk_fma_f32 v[28:29], v[8:9], s[44:45], v[28:29]
    v_pk_fma_f32 v[30:31], v[10:11], s[44:45], v[30:31]
    s_waitcnt lgkmcnt(0)
    v_pk_fma_f32 v[28:29], v[0:1], s[44:45], v[28:29]
    v_mov_b32_dpp v7, v6 row_ror:8 row_mask:0xf bank_mask:0xf
    v_pk_fma_f32 v[30:31], v[2:3], s[44:45], v[30:31]
    v_exp_f32 v0, v28
    v_mfma_f32_16x16x16_bf16 v[12:15], v[16:17], v[6:7], 0
    ds_read_b128 v[48:51], v63 offset:57344
    v_exp_f32 v1, v29
    v_cvt_pk_bf16_f32 v18, v20, v21
    v_exp_f32 v2, v30
    v_cvt_pk_bf16_f32 v19, v22, v23
    v_cvt_pk_bf16_f32 v8, v0, v1
    v_exp_f32 v3, v31
    v_mfma_f32_16x16x16_bf16 v[20:23], v[18:19], v[6:7], 0
    ds_read_b128 v[52:55], v63 offset:61440
    v_cvt_pk_bf16_f32 v9, v2, v3
    v_mov_b32_dpp v10, v8 row_ror:8 row_mask:0xf bank_mask:0xf
    v_max3_f32 v4, |v28|, |v29|, |v30|
    v_mov_b32_dpp v11, v9 row_ror:8 row_mask:0xf bank_mask:0xf
    v_mfma_f32_16x16x32_bf16 v[0:3], v[24:27], v[6:9], 0
    ds_read_b128 v[36:39], v63 offset:53248
    v_max3_f32 v4, v4, |v31|, |v56|
    v_max_f32_e64 v4, v4, |v57|
    v_mfma_f32_16x16x32_bf16 v[12:15], v[40:43], v[8:11], v[12:15]
    v_cmp_nge_f32 vcc, s46, v4
    v_mfma_f32_16x16x32_bf16 v[20:23], v[44:47], v[8:11], v[20:23]
    v_add_f32_dpp v0, v0, v0 row_ror:8 row_mask:0xf bank_mask:0xf
    v_rcp_f32 v0, v0
    s_cbranch_vccnz cf_guard
cf_norm:
    v_mfma_f32_16x16x16_bf16 v[28:31], v[72:73], v[72:73], 0
    v_mul_f32 v12, v12, v0
    v_mul_f32 v13, v13, v0
    v_mul_f32 v14, v14, v0
    v_mul_f32 v15, v15, v0
    v_mul_f32_dpp v12, v20, v0 row_ror:8 row_mask:0xf bank_mask:0xc
    v_mul_f32_dpp v13, v21, v0 row_ror:8 row_mask:0xf bank_mask:0xc
    v_mul_f32_dpp v14, v22, v0 row_ror:8 row_mask:0xf bank_mask:0xc
    v_mul_f32_dpp v15, v23, v0 row_ror:8 row_mask:0xf bank_mask:0xc
    v_cvt_pk_bf16_f32 v12, v12, v13
    v_cvt_pk_bf16_f32 v13, v14, v15
    v_mfma_f32_16x16x16_bf16 v[8:11], v[72:73], v[72:73], 0
    ds_write_b64 v77, v[12:13]
    v_mfma_f32_16x16x16_bf16 v[4:7], v[72:73], v[72:73], 0
    ds_read_b128 v[0:3], v68
    v_mfma_f32_16x16x16_bf16 v[16:19], v[72:73], v[72:73], 0
    ds_read_b128 v[40:43], v63 offset:16384
    v_mfma_f32_16x16x16_bf16 v[20:23], v[72:73], v[72:73], 0
    ds_read_b128 v[44:47], v63 offset:20480
    s_waitcnt lgkmcnt(3)
    s_barrier
    ds_read_b128 v[24:27], v74
    ds_read_b128 v[12:15], v75
    ds_read_b128 v[56:59], v76
    s_waitcnt lgkmcnt(5)
    v_smfmac_f32_16x16x64_bf16 v[28:31], v[0:3], v[160:167], v60
    v_smfmac_f32_16x16x64_bf16 v[8:11], v[0:3], v[192:199], v60
    v_smfmac_f32_16x16x64_bf16 v[4:7], v[0:3], v[32:39], v60
    ds_read_b128 v[32:35], v63 offset:32768
    v_smfmac_f32_16x16x64_bf16 v[16:19], v[0:3], v[224:231], v60
    ds_read_b128 v[36:39], v63 offset:36864
    s_waitcnt lgkmcnt(3)
    v_smfmac_f32_16x16x64_bf16 v[28:31], v[24:27], v[168:175], v60
    v_smfmac_f32_16x16x64_bf16 v[4:7], v[12:15], v[48:55], v60
    ds_read_b128 v[48:51], v63 offset:24576
    v_smfmac_f32_16x16x64_bf16 v[28:31], v[12:15], v[176:183], v60
    ds_read_b128 v[52:55], v63 offset:28672
    s_waitcnt lgkmcnt(4)
    v_smfmac_f32_16x16x64_bf16 v[28:31], v[56:59], v[184:191], v60
    v_cvt_pk_bf16_f32 v4, v4, v5
    v_smfmac_f32_16x16x64_bf16 v[16:19], v[12:15], v[40:47], v60
    ds_read_b128 v[40:43], v63 offset:40960
    v_and_or_b32 v4, v4, -2, s30
    v_smfmac_f32_16x16x64_bf16 v[8:11], v[24:27], v[200:207], v60
    ds_read_b128 v[44:47], v63 offset:45056
    v_cvt_pk_bf16_f32 v5, v6, v7
    v_smfmac_f32_16x16x64_bf16 v[8:11], v[12:15], v[208:215], v60
    buffer_store_dwordx2 v[4:5], v67, s[4:7], s22 offen
    v_cvt_pk_bf16_f32 v28, v28, v29
    v_smfmac_f32_16x16x64_bf16 v[8:11], v[56:59], v[216:223], v60
    v_and_or_b32 v28, v28, -2, s30
    v_smfmac_f32_16x16x64_bf16 v[16:19], v[24:27], v[232:239], v60
    v_cvt_pk_bf16_f32 v29, v30, v31
    s_waitcnt lgkmcnt(4)
    v_smfmac_f32_16x16x64_bf16 v[16:19], v[56:59], v[32:39], v60
    buffer_store_dwordx2 v[28:29], v66, s[4:7], s20 offen
    v_cvt_pk_bf16_f32 v8, v8, v9
    s_waitcnt lgkmcnt(0)
    v_smfmac_f32_16x16x64_bf16 v[20:23], v[0:3], v[240:247], v60
    v_and_or_b32 v8, v8, -2, s30
    v_smfmac_f32_16x16x64_bf16 v[20:23], v[24:27], v[248:255], v60
    v_cvt_pk_bf16_f32 v9, v10, v11
    v_smfmac_f32_16x16x64_bf16 v[20:23], v[12:15], v[48:55], v60
    buffer_store_dwordx2 v[8:9], v66, s[4:7], s21 offen
    v_cvt_pk_bf16_f32 v16, v16, v17
    v_smfmac_f32_16x16x64_bf16 v[20:23], v[56:59], v[40:47], v60
    v_and_or_b32 v16, v16, -2, s30
    v_cvt_pk_bf16_f32 v17, v18, v19
    buffer_store_dwordx2 v[16:17], v66, s[4:7], s38 offen
    s_cmp_lg_u32 s13, 2
    s_nop 1
    v_cvt_pk_bf16_f32 v20, v20, v21
    v_and_or_b32 v20, v20, -2, s30
    v_cvt_pk_bf16_f32 v21, v22, v23
    buffer_store_dwordx2 v[20:21], v66, s[4:7], s39 offen
    s_cbranch_scc1 cf_w013
    s_nop 15
    s_nop 15
    s_nop 15
    s_nop 15
    s_nop 5
    buffer_load_dwordx4 v[40:43], v65, s[4:7], s19 offen offset:0 nt
    buffer_load_dwordx4 v[44:47], v65, s[4:7], s19 offen offset:1024 nt
    buffer_load_dwordx4 v[48:51], v65, s[4:7], s19 offen offset:2048 nt
    buffer_load_dwordx4 v[52:55], v65, s[4:7], s19 offen offset:3072 nt
    ds_read_b128 v[56:59], v65 offset:10240
    s_add_u32 s28, s28, 1
    s_mov_b32 s14, s41
    s_add_u32 s23, s23, 524288
    s_add_u32 s24, s24, 524288
    s_min_u32 s24, s24, s47
    s_add_u32 s15, s14, 4096
    s_add_u32 s16, s14, 8192
    v_mov_b32 v21, -1
    s_add_u32 s65, s65, 12288
    s_mov_b32 s40, 1
    v_mov_b64 v[0:1], 0
    v_mov_b64 v[2:3], 0
    v_mov_b64 v[4:5], 0
    v_mov_b64 v[6:7], 0
    v_mov_b64 v[8:9], 0
    v_mov_b64 v[10:11], 0
    v_mov_b64 v[12:13], 0
    v_mov_b64 v[14:15], 0
cf_chkF:
    v_mov_b32 v20, 0
    s_waitcnt vmcnt(3)
    s_waitcnt lgkmcnt(0)
    v_mfma_f32_16x16x32_bf16 v[28:31], v[40:43], v[56:59], 0
    v_bitop3_b32 v20, v20, v40, s30 bitop3:0xf6
    v_bitop3_b32 v20, v20, v42, s30 bitop3:0xf6
    s_waitcnt vmcnt(2)
    v_mfma_f32_16x16x32_bf16 v[28:31], v[44:47], v[56:59], v[28:31]
    v_bitop3_b32 v20, v20, v44, s30 bitop3:0xf6
    v_bitop3_b32 v20, v20, v46, s30 bitop3:0xf6
    s_waitcnt vmcnt(1)
    v_mfma_f32_16x16x32_bf16 v[28:31], v[48:51], v[56:59], v[28:31]
    v_bitop3_b32 v20, v20, v48, s30 bitop3:0xf6
    v_bitop3_b32 v20, v20, v50, s30 bitop3:0xf6
    s_waitcnt vmcnt(0)
    v_mfma_f32_16x16x32_bf16 v[28:31], v[52:55], v[56:59], v[28:31]
    v_bitop3_b32 v20, v20, v52, s30 bitop3:0xf6
    v_bitop3_b32 v20, v20, v54, s30 bitop3:0xf6
    v_and_b32 v20, s40, v20
    v_cmp_ne_u32 vcc, 0, v20
    s_cbranch_vccnz cf_spinF
    v_permlane32_swap_b32 v28, v30
    v_permlane32_swap_b32 v29, v31
    v_add_f32 v28, v28, v30
    v_add_f32 v30, v29, v31
    v_cvt_pk_bf16_f32 v28, v28, v30
    s_mov_b64 exec, s[32:33]
    buffer_store_dword v28, v69, s[4:7], s17 offen
    buffer_store_dword v21, v69, s[4:7], s18 offen
    s_mov_b64 exec, -1
    ds_read_b128 v[32:35], v62 offset:16384
    ds_read_b128 v[36:39], v62 offset:20480
    ds_read_b128 v[40:43], v61 offset:0
    ds_read_b128 v[44:47], v61 offset:4096
    ds_read_b128 v[48:51], v61 offset:8192
    ds_read_b128 v[52:55], v61 offset:12288
    s_nop 14
    buffer_load_dwordx4 v[24:27], v61, s[4:7], s14 offen nt
    s_branch cf_loop2
cf_w013:
    ds_read_b128 v[56:59], v65 offset:10240
    ds_read_b128 v[32:35], v62 offset:16384
    ds_read_b128 v[36:39], v62 offset:20480
    ds_read_b128 v[40:43], v61 offset:0
    ds_read_b128 v[44:47], v61 offset:4096
    ds_read_b128 v[48:51], v61 offset:8192
    ds_read_b128 v[52:55], v61 offset:12288
    s_add_u32 s28, s28, 1
    s_mov_b32 s14, s41
    s_add_u32 s23, s23, 524288
    s_add_u32 s24, s24, 524288
    s_min_u32 s24, s24, s47
    s_add_u32 s15, s14, 4096
    s_add_u32 s16, s14, 8192
    v_mov_b32 v21, -1
    s_add_u32 s65, s65, 12288
    s_mov_b32 s40, 1
    s_cmp_eq_u32 s64, 0
    s_cbranch_scc1 cf_w0
    s_cmp_eq_u32 s13, 1
    s_nop 15
    s_nop 15
    s_nop 7
    s_cbranch_scc1 cf_sx
    s_nop 15
    s_nop 11
cf_sx:
    buffer_load_dwordx4 v[0:3], v65, s[4:7], s19 offen offset:0 nt
    buffer_load_dwordx4 v[4:7], v65, s[4:7], s19 offen offset:1024 nt
    buffer_load_dwordx4 v[8:11], v65, s[4:7], s19 offen offset:2048 nt
    buffer_load_dwordx4 v[12:15], v65, s[4:7], s19 offen offset:3072 nt
cf_chkG:
    v_mov_b32 v20, 0
    s_waitcnt vmcnt(3)
    s_waitcnt lgkmcnt(6)
    v_mfma_f32_16x16x32_bf16 v[28:31], v[0:3], v[56:59], 0
    v_bitop3_b32 v20, v20, v0, s30 bitop3:0xf6
    v_bitop3_b32 v20, v20, v2, s30 bitop3:0xf6
    s_waitcnt vmcnt(2)
    v_mfma_f32_16x16x32_bf16 v[28:31], v[4:7], v[56:59], v[28:31]
    v_bitop3_b32 v20, v20, v4, s30 bitop3:0xf6
    v_bitop3_b32 v20, v20, v6, s30 bitop3:0xf6
    s_waitcnt vmcnt(1)
    v_mfma_f32_16x16x32_bf16 v[28:31], v[8:11], v[56:59], v[28:31]
    v_bitop3_b32 v20, v20, v8, s30 bitop3:0xf6
    v_bitop3_b32 v20, v20, v10, s30 bitop3:0xf6
    s_waitcnt vmcnt(0)
    v_mfma_f32_16x16x32_bf16 v[28:31], v[12:15], v[56:59], v[28:31]
    v_bitop3_b32 v20, v20, v12, s30 bitop3:0xf6
    v_bitop3_b32 v20, v20, v14, s30 bitop3:0xf6
    v_and_b32 v20, s40, v20
    v_cmp_ne_u32 vcc, 0, v20
    s_cbranch_vccnz cf_spinG
    v_permlane32_swap_b32 v28, v30
    v_permlane32_swap_b32 v29, v31
    v_add_f32 v28, v28, v30
    v_add_f32 v30, v29, v31
    s_cmp_eq_u32 s13, 3
    s_cbranch_scc1 cf_w3
    v_mov_b32 v29, v28
    v_mov_b32 v31, v30
    s_nop 0
    v_permlane16_swap_b32 v28, v29
    v_permlane16_swap_b32 v30, v31
    v_add_f32 v28, v28, v29
    v_add_f32 v30, v30, v31
cf_w3:
    v_cvt_pk_bf16_f32 v28, v28, v30
    s_mov_b64 exec, s[32:33]
    buffer_store_dword v28, v69, s[4:7], s17 offen
    buffer_store_dword v21, v69, s[4:7], s18 offen
    s_mov_b64 exec, -1
    buffer_load_dwordx4 v[24:27], v61, s[4:7], s14 offen nt
    s_branch cf_loop
cf_w0:
    v_mov_b64 v[0:1], 0
    v_mov_b64 v[2:3], 0
    v_mov_b64 v[4:5], 0
    v_mov_b64 v[6:7], 0
    v_mov_b64 v[8:9], 0
    v_mov_b64 v[10:11], 0
    v_mov_b64 v[12:13], 0
    v_mov_b64 v[14:15], 0
    s_cmp_lg_u32 s28, 10
    s_cbranch_scc1 cf_nokv
    s_lshr_b32 s92, s12, 1
    s_lshl_b32 s92, s92, 8
    s_add_u32 s92, s92, 125833216
    v_bfe_u32 v28, v61, 4, 6
    v_min_u32 v28, 11, v28
    v_lshlrev_b32 v28, 2, v28
    s_add_u32 s93, s95, 63
    s_mov_b32 s94, 4194304
cf_kv1:
    buffer_load_dword v29, v28, s[4:7], s92 offen sc1
    s_sub_u32 s94, s94, 1
    s_cbranch_scc1 cf_kv1_go
    s_waitcnt vmcnt(0)
    v_subrev_u32 v29, s93, v29
    v_cmp_lt_u32 vcc, 64, v29
    s_cbranch_vccz cf_kv1_go
    s_sleep 2
    s_branch cf_kv1
cf_kv1_go:
cf_nokv:
    s_nop 15
    s_nop 15
    s_nop 15
    s_nop 15
    s_nop 15
    s_nop 15
    s_nop 15
    s_nop 15
    s_nop 15
    s_nop 15
    s_nop 3
    buffer_load_dwordx4 v[24:27], v61, s[4:7], s14 offen nt
    s_branch cf_loop2
cf_spinF:
    buffer_load_dwordx4 v[40:43], v65, s[4:7], s19 offen offset:0 nt
    buffer_load_dwordx4 v[44:47], v65, s[4:7], s19 offen offset:1024 nt
    buffer_load_dwordx4 v[48:51], v65, s[4:7], s19 offen offset:2048 nt
    buffer_load_dwordx4 v[52:55], v65, s[4:7], s19 offen offset:3072 nt
    s_sub_u32 s29, s29, 1
    s_cmp_lt_i32 s29, 0
    s_cselect_b32 s40, 0, 1
    s_branch cf_chkF
cf_spinG:
    buffer_load_dwordx4 v[0:3], v65, s[4:7], s19 offen offset:0 nt
    buffer_load_dwordx4 v[4:7], v65, s[4:7], s19 offen offset:1024 nt
    buffer_load_dwordx4 v[8:11], v65, s[4:7], s19 offen offset:2048 nt
    buffer_load_dwordx4 v[12:15], v65, s[4:7], s19 offen offset:3072 nt
    s_sub_u32 s29, s29, 1
    s_cmp_lt_i32 s29, 0
    s_cselect_b32 s40, 0, 1
    s_branch cf_chkG
cf_guard:
    s_cbranch_scc0 cf_guard2
    buffer_store_dwordx4 v[16:19], v61, s[4:7], s26 offen sc1
    s_add_u32 s26, s26, 131072
    s_add_u32 s40, s95, 63
    v_mov_b32 v5, s40
    s_mov_b64 exec, 1
    buffer_store_dword v5, off, s[4:7], s27 sc1
    s_mov_b64 exec, -1
cf_guard2:
    s_nop 7
    v_max3_f32 v6, v28, v29, v30
    v_max3_f32 v7, v31, v56, v57
    v_max_f32 v6, v6, v7
    s_nop 1
    v_max_f32_dpp v6, v6, v6 row_ror:8 row_mask:0xf bank_mask:0xf
    v_mov_b32 v7, v6
    s_nop 1
    v_permlane32_swap_b32 v6, v7
    v_max_f32 v6, v6, v7
    v_mov_b32 v7, v6
    s_nop 1
    v_permlane16_swap_b32 v6, v7
    v_max_f32 v6, v6, v7
    v_sub_f32 v28, v28, v6
    v_sub_f32 v29, v29, v6
    v_sub_f32 v30, v30, v6
    v_sub_f32 v31, v31, v6
    v_sub_f32 v56, v56, v6
    v_sub_f32 v57, v57, v6
    v_exp_f32 v58, v56
    v_exp_f32 v59, v57
    s_nop 0
    v_cvt_pk_bf16_f32 v6, v58, v59
    s_nop 1
    v_mov_b32_dpp v7, v6 row_ror:8 row_mask:0xf bank_mask:0xf
    v_exp_f32 v0, v28
    s_nop 0
    v_mfma_f32_16x16x16_bf16 v[12:15], v[16:17], v[6:7], 0
    v_exp_f32 v1, v29
    v_exp_f32 v2, v30
    v_cvt_pk_bf16_f32 v8, v0, v1
    v_exp_f32 v3, v31
    v_mfma_f32_16x16x16_bf16 v[20:23], v[18:19], v[6:7], 0
    v_cvt_pk_bf16_f32 v9, v2, v3
    v_mov_b32_dpp v10, v8 row_ror:8 row_mask:0xf bank_mask:0xf
    v_max3_f32 v4, |v28|, |v29|, |v30|
    v_mov_b32_dpp v11, v9 row_ror:8 row_mask:0xf bank_mask:0xf
    v_mfma_f32_16x16x32_bf16 v[0:3], v[24:27], v[6:9], 0
    v_max3_f32 v4, v4, |v31|, |v56|
    v_max_f32_e64 v4, v4, |v57|
    v_mfma_f32_16x16x32_bf16 v[12:15], v[40:43], v[8:11], v[12:15]
    v_cmp_nge_f32 vcc, s46, v4
    v_mfma_f32_16x16x32_bf16 v[20:23], v[44:47], v[8:11], v[20:23]
    v_add_f32_dpp v0, v0, v0 row_ror:8 row_mask:0xf bank_mask:0xf
    v_rcp_f32 v0, v0
    s_nop 4
    s_branch cf_norm
cf_spin0:
    buffer_load_dwordx4 v[24:27], v61, s[4:7], s14 offen nt
    s_sub_u32 s29, s29, 1
    s_cmp_lt_i32 s29, 0
    s_cbranch_scc0 cf_chk0
    s_waitcnt vmcnt(0)
    v_min_u32 v24, -2, v24
    v_min_u32 v25, -2, v25
    v_min_u32 v26, -2, v26
    v_min_u32 v27, -2, v27
    s_branch cf_chk0
cf_spin1:
    s_mov_b32 m0, s58
    s_nop 0
    buffer_load_dwordx4 v61, s[4:7], s15 offen nt lds
    s_mov_b32 m0, s59
    s_nop 0
    buffer_load_dword v56, s[4:7], s16 offen nt lds
    s_mov_b32 m0, 108032
    s_sub_u32 s29, s29, 1
    s_cmp_lt_i32 s29, 0
    s_waitcnt vmcnt(0)
    ds_read_b128 v[28:31], v62 offset:45056
    ds_read_b32 v59, v58
    s_waitcnt lgkmcnt(0)
    v_max3_u32 v57, v28, v29, v30
    v_max3_u32 v57, v57, v31, v59
    v_cmp_eq_u32 vcc, -1, v57
    s_cbranch_scc1 cf_go1
    s_cbranch_vccnz cf_spin1
    s_branch cf_go1
cf_last:
    s_nop 1
    s_cmp_eq_u32 s28, 63
    s_cbranch_scc1 cf_last2
    s_mov_b64 exec, s[34:35]
    buffer_store_dwordx4 v[0:3], v61, s[4:7], s25 offen sc1
    s_mov_b64 exec, -1
    s_add_u32 s25, s25, 131072
    s_mov_b32 s46, 0xbf800000
    s_cmp_eq_u32 0, 0
    s_branch cf_back
cf_last2:
    s_waitcnt lgkmcnt(0)
    s_mov_b64 exec, s[34:35]
    buffer_store_dwordx4 v[0:3], v61, s[4:7], s25 offen sc1
    s_mov_b64 exec, -1
    s_add_u32 s40, s95, 64
    v_mov_b32 v40, s40
    v_smfmac_f32_16x16x64_bf16 v[16:19], v[52:55], v[80:87], v60
    v_smfmac_f32_16x16x64_bf16 v[20:23], v[52:55], v[88:95], v60
    s_nop 3
    v_cvt_pk_bf16_f32 v16, v16, v17
    v_cvt_pk_bf16_f32 v17, v18, v19
    s_nop 1
    v_cvt_pk_bf16_f32 v18, v20, v21
    v_cvt_pk_bf16_f32 v19, v22, v23
    buffer_store_dwordx4 v[16:19], v61, s[4:7], s26 offen sc1
    s_mov_b64 exec, 1
    buffer_store_dword v40, off, s[4:7], s27 sc1
    s_mov_b64 exec, -1
    s_endpgm
cf_dma:
    s_xor_b32 s74, s76, s81
    s_add_u32 m0, s74, s80
    s_add_u32 s76, s76, 4096
    buffer_load_dwordx4 v58, s[8:11], s78 offen lds
    s_add_u32 s78, s78, s79
    s_cmp_lt_u32 s76, s77
    s_cbranch_scc1 cf_dma
    s_setpc_b64 s[82:83]
L_chain_safe:
    s_mov_b64 s[48:49], s[50:51]
    s_mov_b64 s[50:51], s[52:53]
    s_mov_b64 s[52:53], s[54:55]
    s_mov_b64 s[54:55], s[56:57]
    s_mov_b64 s[56:57], s[58:59]
    v_lshrrev_b32 v54, 6, v0
    s_nop 0
    v_readfirstlane_b32 s13, v54
    v_and_b32 v57, 63, v0
    v_bfe_u32 v54, v57, 2, 1
    v_lshlrev_b32 v48, 13, v54
    v_bfe_u32 v54, v57, 3, 1
    v_lshl_add_u32 v48, v54, 15, v48
    v_bfe_u32 v54, v57, 4, 1
    v_lshl_add_u32 v48, v54, 14, v48
    v_bfe_u32 v54, v57, 5, 1
    v_lshl_add_u32 v48, v54, 16, v48
    v_lshrrev_b32 v55, 4, v57
    v_and_b32 v55, 2, v55
    v_xor_b32 v55, v55, v57
    v_and_b32 v55, 3, v55
    v_lshl_add_u32 v48, v55, 4, v48
    v_bfe_u32 v54, v57, 2, 1
    v_lshlrev_b32 v51, 6, v54
    v_bfe_u32 v54, v57, 3, 1
    v_lshl_add_u32 v51, v54, 9, v51
    v_bfe_u32 v54, v57, 4, 1
    v_lshl_add_u32 v51, v54, 7, v51
    v_bfe_u32 v54, v57, 5, 1
    v_lshl_add_u32 v51, v54, 12, v51
    v_bfe_u32 v54, v57, 0, 1
    v_lshl_add_u32 v51, v54, 3, v51
    v_bfe_u32 v54, v57, 1, 1
    v_lshl_add_u32 v51, v54, 4, v51
    v_bfe_u32 v54, v57, 3, 1
    v_lshl_add_u32 v51, v54, 5, v51
    v_lshrrev_b32 v55, 3, v57
    v_mul_u32_u24 v49, 1152, v55
    v_and_b32 v55, 7, v57
    v_lshl_add_u32 v49, v55, 4, v49
    v_bfe_u32 v54, v57, 4, 1
    v_lshlrev_b32 v52, 13, v54
    v_bfe_u32 v54, v57, 5, 1
    v_lshl_add_u32 v52, v54, 9, v52
    v_bfe_u32 v54, v57, 2, 1
    v_lshl_add_u32 v52, v54, 7, v52
    v_bfe_u32 v54, v57, 3, 1
    v_lshl_add_u32 v52, v54, 5, v52
    v_and_b32 v55, 3, v57
    v_lshl_add_u32 v52, v55, 3, v52
    v_lshrrev_b32 v55, 2, v57
    v_mul_u32_u24 v50, 1152, v55
    v_and_b32 v55, 3, v57
    v_lshl_add_u32 v50, v55, 4, v50
    v_bfe_u32 v54, v57, 4, 1
    v_lshlrev_b32 v53, 12, v54
    v_bfe_u32 v54, v57, 5, 1
    v_lshl_add_u32 v53, v54, 8, v53
    v_bfe_u32 v54, v57, 2, 1
    v_lshl_add_u32 v53, v54, 6, v53
    v_bfe_u32 v54, v57, 3, 1
    v_lshl_add_u32 v53, v54, 5, v53
    v_and_b32 v55, 3, v57
    v_lshl_add_u32 v53, v55, 3, v53
    s_lshl_b32 s66, s13, 10
    s_and_b32 s93, s13, 1
    s_lshl_b32 s93, s93, 14
    s_and_b32 s75, s13, 2
    s_lshl_b32 s75, s75, 19
    v_add_u32 v51, s66, v51
    v_add_u32 v52, s66, v52
    v_add_u32 v53, s66, v53
    v_mov_b32 v58, v48
    s_mov_b32 s10, 4718592
    s_mov_b32 s11, 0x20000
    s_lshl_b32 s67, s12, 8
    s_lshl_b32 s40, s13, 6
    s_add_u32 s67, s67, s40
    s_mul_i32 s92, s12, 147456
    s_lshr_b32 s73, s50, 8
    s_add_u32 s73, s73, s12
    s_and_b32 s73, s73, 31
    s_bitcmp1_b32 0xa2222222, s73
    s_cselect_b32 s88, 0, 0
    s_mov_b32 s72, 0
    s_add_u32 s73, s73, 1
    s_lshr_b32 s73, s73, 2
    s_xor_b32 s94, s13, 0
    s_mul_i32 s94, s94, 36864
    s_add_u32 s94, s94, s92
    s_lshl_b32 s74, s13, 7
    s_add_u32 s94, s94, s74
    s_add_u32 s78, s94, 0
    s_mov_b64 s[8:9], s[56:57]
    v_mov_b32 v58, v49
    s_mov_b32 s79, 9216
    s_mov_b32 s81, 0
    s_add_u32 s80, s66, 114688
    s_mov_b32 s76, 0
    s_mov_b32 s77, 8192
    s_call_b64 s[82:83], cs_dma
    s_mov_b32 s77, 16384
    s_call_b64 s[82:83], cs_dma
    s_xor_b32 s94, s13, 1
    s_mul_i32 s94, s94, 36864
    s_add_u32 s94, s94, s92
    s_lshl_b32 s74, s13, 7
    s_add_u32 s94, s94, s74
    s_add_u32 s78, s94, 0
    s_add_u32 s80, s66, 81920
    s_mov_b32 s76, 0
    s_mov_b32 s77, 8192
    s_call_b64 s[82:83], cs_dma
    s_mov_b32 s77, 16384
    s_call_b64 s[82:83], cs_dma
    s_xor_b32 s94, s13, 2
    s_mul_i32 s94, s94, 36864
    s_add_u32 s94, s94, s92
    s_lshl_b32 s74, s13, 7
    s_add_u32 s94, s94, s74
    s_add_u32 s78, s94, 0
    s_add_u32 s80, s66, 16384
    s_mov_b32 s76, 0
    s_mov_b32 s77, 8192
    s_call_b64 s[82:83], cs_dma
    s_mov_b32 s77, 16384
    s_call_b64 s[82:83], cs_dma
    s_xor_b32 s94, s13, 3
    s_mul_i32 s94, s94, 36864
    s_add_u32 s94, s94, s92
    s_lshl_b32 s74, s13, 7
    s_add_u32 s94, s94, s74
    s_add_u32 s78, s94, 0
    s_add_u32 s80, s66, 0
    s_mov_b32 s76, 0
    s_mov_b32 s77, 8192
    s_call_b64 s[82:83], cs_dma
    s_mov_b32 s77, 16384
    s_call_b64 s[82:83], cs_dma
    v_lshrrev_b32 v24, 6, v0
    v_lshlrev_b32 v61, 4, v0
    v_add_u32 v62, 57344, v61
    v_xor_b32 v63, 1024, v61
    v_add_u32 v63, 98304, v63
    v_xor_b32 v64, 2048, v61
    v_add_u32 v64, 98304, v64
    v_and_b32 v65, 1023, v61
    v_add_u32 v65, 98304, v65
    v_and_b32 v26, 15, v0
    v_bfe_u32 v27, v0, 4, 2
    v_mov_b32 v60, 0x4444
    v_mov_b32 v25, 0xeeee
    v_cmp_lt_u32 vcc, 7, v26
    s_nop 1
    v_cndmask_b32 v60, v60, v25, vcc
    s_nop 1
    v_and_b32 v67, 12, v26
    v_lshlrev_b32 v67, 3, v67
    v_and_b32 v25, 1, v26
    v_lshl_add_u32 v67, v25, 4, v67
    v_bfe_u32 v25, v26, 1, 1
    v_lshl_add_u32 v67, v25, 3, v67
    v_lshl_add_u32 v66, v27, 14, v67
    v_lshl_add_u32 v66, v24, 17, v66
    s_nop 1
    v_and_b32 v67, 63, v67
    v_lshrrev_b32 v25, 1, v24
    v_lshl_add_u32 v67, v25, 18, v67
    v_lshl_add_u32 v67, v27, 16, v67
    v_lshrrev_b32 v25, 3, v26
    v_lshl_add_u32 v67, v25, 15, v67
    v_and_b32 v25, 1, v24
    v_lshl_add_u32 v67, v25, 6, v67
    s_nop 1
    s_waitcnt vmcnt(12)
    v_add_u32 v55, 114688, v52
    ds_read_b64_tr_b16 v[160:161], v55 offset:0
    ds_read_b64_tr_b16 v[162:163], v55 offset:256
    ds_read_b64_tr_b16 v[164:165], v55 offset:4096
    ds_read_b64_tr_b16 v[166:167], v55 offset:4352
    s_xor_b32 s94, s13, 0
    s_mul_i32 s94, s94, 36864
    s_add_u32 s94, s94, s92
    s_lshl_b32 s74, s13, 7
    s_add_u32 s94, s94, s74
    s_add_u32 s78, s94, 512
    s_add_u32 s80, s66, 147456
    s_mov_b32 s76, 0
    s_mov_b32 s77, 8192
    s_call_b64 s[82:83], cs_dma
    ds_read_b64_tr_b16 v[192:193], v55 offset:64
    ds_read_b64_tr_b16 v[194:195], v55 offset:320
    ds_read_b64_tr_b16 v[196:197], v55 offset:4160
    ds_read_b64_tr_b16 v[198:199], v55 offset:4416
    s_mov_b32 s77, 16384
    s_call_b64 s[82:83], cs_dma
    v_and_b32 v25, 31, v0
    v_lshlrev_b32 v70, 4, v25
    v_lshlrev_b32 v28, 3, v25
    v_add_u32 v28, 108032, v28
    v_lshrrev_b32 v25, 1, v24
    v_lshl_add_u32 v70, v25, 9, v70
    v_and_b32 v25, 1, v24
    v_lshl_add_u32 v70, v25, 3, v70
    v_add_u32 v70, 109568, v70
    v_cmp_gt_u32 vcc, 2, v27
    s_nop 1
    v_cndmask_b32 v70, v70, v28, vcc
    s_nop 1
    s_waitcnt lgkmcnt(0)
    s_waitcnt vmcnt(12)
    v_add_u32 v55, 81920, v52
    ds_read_b64_tr_b16 v[168:169], v55 offset:0
    ds_read_b64_tr_b16 v[170:171], v55 offset:256
    ds_read_b64_tr_b16 v[172:173], v55 offset:4096
    ds_read_b64_tr_b16 v[174:175], v55 offset:4352
    s_xor_b32 s94, s13, 1
    s_mul_i32 s94, s94, 36864
    s_add_u32 s94, s94, s92
    s_lshl_b32 s74, s13, 7
    s_add_u32 s94, s94, s74
    s_add_u32 s78, s94, 512
    s_add_u32 s80, s66, 98304
    s_mov_b32 s76, 0
    s_mov_b32 s77, 8192
    s_call_b64 s[82:83], cs_dma
    ds_read_b64_tr_b16 v[200:201], v55 offset:64
    ds_read_b64_tr_b16 v[202:203], v55 offset:320
    ds_read_b64_tr_b16 v[204:205], v55 offset:4160
    ds_read_b64_tr_b16 v[206:207], v55 offset:4416
    s_mov_b32 s77, 16384
    s_call_b64 s[82:83], cs_dma
    v_xor_b32 v71, 2048, v63
    v_lshrrev_b32 v68, 4, v0
    v_lshlrev_b32 v68, 7, v68
    v_and_b32 v25, 7, v26
    v_lshl_add_u32 v68, v25, 4, v68
    v_add_u32 v68, 98304, v68
    v_xor_b32 v74, 512, v68
    v_xor_b32 v75, 1024, v68
    v_xor_b32 v76, 1536, v68
    v_lshrrev_b32 v25, 3, v26
    v_lshl_add_u32 v77, v25, 3, v68
    v_or_b32 v78, 512, v65
    v_lshlrev_b32 v79, 2, v61
    v_mov_b64 v[72:73], 0
    v_and_b32 v25, 1, v27
    v_lshlrev_b32 v69, 7, v25
    v_lshrrev_b32 v25, 1, v27
    v_lshl_add_u32 v69, v25, 3, v69
    v_and_b32 v25, 3, v26
    v_lshl_add_u32 v69, v25, 4, v69
    v_bfe_u32 v25, v26, 2, 1
    v_lshl_add_u32 v69, v25, 2, v69
    s_nop 1
    s_waitcnt lgkmcnt(0)
    s_waitcnt vmcnt(12)
    v_add_u32 v55, 16384, v52
    ds_read_b64_tr_b16 v[176:177], v55 offset:0
    ds_read_b64_tr_b16 v[178:179], v55 offset:256
    ds_read_b64_tr_b16 v[180:181], v55 offset:4096
    ds_read_b64_tr_b16 v[182:183], v55 offset:4352
    s_add_u32 s78, s67, 4194304
    s_mov_b64 s[8:9], s[54:55]
    v_mov_b32 v58, v48
    s_mov_b32 s79, 131072
    s_add_u32 s80, s66, 32768
    s_mov_b32 s76, 0
    s_mov_b32 s77, 8192
    s_call_b64 s[82:83], cs_dma
    ds_read_b64_tr_b16 v[208:209], v55 offset:64
    ds_read_b64_tr_b16 v[210:211], v55 offset:320
    ds_read_b64_tr_b16 v[212:213], v55 offset:4160
    ds_read_b64_tr_b16 v[214:215], v55 offset:4416
    s_mov_b32 s77, 16384
    s_call_b64 s[82:83], cs_dma
    s_mov_b32 s32, 0x00ff00ff
    s_mov_b32 s33, 0x00ff00ff
    s_not_b64 s[34:35], s[32:33]
    s_lshr_b32 s31, s12, 1
    s_lshl_b32 s31, s31, 8
    s_and_b32 s40, s12, 1
    s_lshl_b32 s40, s40, 6
    s_add_u32 s31, s31, s40
    s_and_b32 s40, s13, 1
    s_lshl_b32 s40, s40, 12
    s_add_u32 s31, s31, s40
    s_lshl_b32 s19, s12, 14
    s_add_u32 s19, s19, 68124672
    s_add_u32 s41, s19, 8192
    s_add_u32 s19, s19, s40
    s_and_b32 s40, s12, 1
    s_lshl_b32 s40, s40, 2
    s_or_b32 s40, s40, s13
    s_cmp_eq_u32 s40, 5
    s_cselect_b32 s64, 0, s13
    s_cmp_lg_u32 s13, 1
    s_cbranch_scc1 cs_notx
    s_mov_b32 s32, 0xff
    s_mov_b32 s33, 0xff
    s_mov_b32 s19, s41
    s_lshr_b32 s31, s12, 3
    s_lshl_b32 s31, s31, 8
    s_and_b32 s40, s12, 2
    s_lshl_b32 s40, s40, 6
    s_add_u32 s31, s31, s40
    s_and_b32 s40, s12, 4
    s_lshl_b32 s40, s40, 4
    s_add_u32 s31, s31, s40
    s_add_u32 s31, s31, 8192
cs_notx:
    s_cmp_lg_u32 s13, 0
    s_cbranch_scc1 cs_notp
    s_min_u32 s40, s12, 23
    s_mul_i32 s40, s40, 384
    s_add_u32 s40, s40, 98304
    v_add_u32 v69, s40, v61
    v_mov_b32 v25, 108288
    v_cmp_lt_u32 vcc, 23, v0
    s_nop 1
    v_cndmask_b32 v69, v69, v25, vcc
cs_notp:
    s_nop 1
    s_waitcnt lgkmcnt(0)
    s_waitcnt vmcnt(12)
    v_add_u32 v55, 0, v52
    ds_read_b64_tr_b16 v[184:185], v55 offset:0
    ds_read_b64_tr_b16 v[186:187], v55 offset:256
    ds_read_b64_tr_b16 v[188:189], v55 offset:4096
    ds_read_b64_tr_b16 v[190:191], v55 offset:4352
    s_xor_b32 s78, s75, 0
    s_add_u32 s78, s78, s67
    s_mov_b32 s81, s93
    s_add_u32 s80, s66, 114688
    s_mov_b32 s76, 0
    s_mov_b32 s77, 8192
    s_call_b64 s[82:83], cs_dma
    ds_read_b64_tr_b16 v[216:217], v55 offset:64
    ds_read_b64_tr_b16 v[218:219], v55 offset:320
    ds_read_b64_tr_b16 v[220:221], v55 offset:4160
    ds_read_b64_tr_b16 v[222:223], v55 offset:4416
    s_mov_b32 s77, 16384
    s_call_b64 s[82:83], cs_dma
    v_mov_b32 v28, 1
    v_mov_b32 v29, 1
    v_mov_b32 v30, 1
    v_mov_b32 v31, 1
    s_lshl_b32 s40, s12, 14
    s_add_u32 s40, s40, 68222976
    s_add_u32 s41, s40, 0
    buffer_store_dwordx4 v[28:31], v61, s[4:7], s41 offen sc1
    s_add_u32 s41, s40, 4096
    buffer_store_dwordx4 v[28:31], v61, s[4:7], s41 offen sc1
    s_add_u32 s41, s40, 8192
    buffer_store_dwordx4 v[28:31], v61, s[4:7], s41 offen sc1
    s_cmp_eq_u32 s64, 0
    s_cselect_b64 exec, 0, s[32:33]
    v_mov_b32 v27, -1
    s_add_u32 s41, s31, 68157440
    buffer_store_dword v27, v69, s[4:7], s41 offen sc1
    s_add_u32 s41, s31, 68173824
    buffer_store_dword v27, v69, s[4:7], s41 offen sc1
    s_add_u32 s41, s31, 68190208
    buffer_store_dword v27, v69, s[4:7], s41 offen sc1
    s_add_u32 s41, s31, 68206592
    buffer_store_dword v27, v69, s[4:7], s41 offen sc1
    s_mov_b64 exec, -1
    s_waitcnt lgkmcnt(0)
    s_waitcnt vmcnt(12)
    v_add_u32 v55, 147456, v52
    ds_read_b64_tr_b16 v[224:225], v55 offset:0
    ds_read_b64_tr_b16 v[226:227], v55 offset:256
    ds_read_b64_tr_b16 v[228:229], v55 offset:4096
    ds_read_b64_tr_b16 v[230:231], v55 offset:4352
    s_mov_b32 s77, 24576
    s_call_b64 s[82:83], cs_dma
    ds_read_b64_tr_b16 v[240:241], v55 offset:64
    ds_read_b64_tr_b16 v[242:243], v55 offset:320
    ds_read_b64_tr_b16 v[244:245], v55 offset:4160
    ds_read_b64_tr_b16 v[246:247], v55 offset:4416
    s_mov_b32 s77, 32768
    s_call_b64 s[82:83], cs_dma
    s_mov_b64 s[68:69], s[48:49]
    s_mov_b32 s70, 9216
    s_mov_b32 s71, 0x20000
    v_and_b32 v25, 7, v0
    v_mul_u32_u24 v25, 1152, v25
    v_lshrrev_b32 v26, 3, v0
    v_lshl_add_u32 v25, v26, 4, v25
    buffer_load_dwordx4 v[36:39], v25, s[68:71], 0 offen
    buffer_load_dwordx4 v[40:43], v25, s[68:71], 0 offen offset:512
    v_bfe_u32 v25, v0, 2, 3
    v_mul_u32_u24 v25, 1152, v25
    v_lshrrev_b32 v26, 5, v0
    v_lshl_add_u32 v25, v26, 4, v25
    v_and_b32 v26, 3, v0
    v_lshl_add_u32 v25, v26, 2, v25
    buffer_load_dword v44, v25, s[68:71], 0 offen offset:1024
    s_nop 0
    s_waitcnt lgkmcnt(0)
    s_waitcnt vmcnt(15)
    v_add_u32 v55, 98304, v52
    ds_read_b64_tr_b16 v[232:233], v55 offset:0
    ds_read_b64_tr_b16 v[234:235], v55 offset:256
    ds_read_b64_tr_b16 v[236:237], v55 offset:4096
    ds_read_b64_tr_b16 v[238:239], v55 offset:4352
    s_xor_b32 s78, s75, 1048576
    s_add_u32 s78, s78, s67
    s_add_u32 s80, s66, 65536
    s_mov_b32 s76, 0
    s_mov_b32 s77, 8192
    s_call_b64 s[82:83], cs_dma
    ds_read_b64_tr_b16 v[248:249], v55 offset:64
    ds_read_b64_tr_b16 v[250:251], v55 offset:320
    ds_read_b64_tr_b16 v[252:253], v55 offset:4160
    ds_read_b64_tr_b16 v[254:255], v55 offset:4416
    s_mov_b32 s77, 16384
    s_call_b64 s[82:83], cs_dma
    s_mov_b32 s44, 0x3e0293ee
    s_mov_b32 s45, s44
    s_mov_b32 s46, 0x42000000
    s_mov_b32 s60, 0x3f803f80
    s_mov_b32 s61, s60
    s_mov_b32 s62, 0x3e803e80
    s_mov_b32 s63, s62
    s_mov_b32 s28, 0
    s_lshl_b32 s58, s13, 10
    s_add_u32 s58, s58, 102400
    s_lshl_b32 s59, s13, 8
    s_add_u32 s59, s59, 106496
    s_lshl_b32 s24, s12, 14
    s_add_u32 s24, s24, 0
    s_add_u32 s47, s24, 33030144
    s_mul_i32 s40, s13, 3072
    s_add_u32 s23, s24, s40
    s_lshl_b32 s20, s12, 7
    s_add_u32 s20, s20, 68222976
    s_add_u32 s21, s20, 65536
    s_add_u32 s38, s20, 4096
    s_add_u32 s39, s21, 4096
    s_lshl_b32 s22, s12, 7
    s_add_u32 s22, s22, 68231168
    s_waitcnt lgkmcnt(0)
    s_waitcnt vmcnt(15)
    v_add_u32 v55, 32768, v51
    v_xor_b32 v56, 32, v55
    ds_read_b64_tr_b16 v[144:145], v55 offset:0
    ds_read_b64_tr_b16 v[146:147], v55 offset:256
    ds_read_b64_tr_b16 v[148:149], v55 offset:8192
    ds_read_b64_tr_b16 v[150:151], v55 offset:8448
    s_mov_b32 s77, 24576
    s_call_b64 s[82:83], cs_dma
    ds_read_b64_tr_b16 v[152:153], v56 offset:0
    ds_read_b64_tr_b16 v[154:155], v56 offset:256
    ds_read_b64_tr_b16 v[156:157], v56 offset:8192
    ds_read_b64_tr_b16 v[158:159], v56 offset:8448
    s_mov_b32 s77, 32768
    s_call_b64 s[82:83], cs_dma
    s_lshl_b32 s40, s12, 12
    s_add_u32 s25, s40, 79429632
    s_add_u32 s26, s40, 88866816
    s_lshl_b32 s65, s12, 9
    s_add_u32 s65, s65, 90177536
    s_lshl_b32 s40, s13, 5
    s_or_b32 s40, s40, s12
    s_cmp_lt_u32 s40, 24
    s_cselect_b32 s36, 0x1ffffff, 0
    s_mov_b32 s37, 0
    s_lshl_b32 s27, s12, 7
    s_add_u32 s27, s27, 125845504
    s_lshl_b32 s40, s13, 2
    s_add_u32 s27, s27, s40
    v_bfe_u32 v28, v61, 4, 4
    v_bfe_u32 v29, v61, 8, 1
    v_lshlrev_b32 v29, 2, v29
    v_sub_u32 v29, v28, v29
    v_mov_b32 v31, 0x3f80
    v_mov_b32 v32, 0x3f800000
    s_nop 1
    s_waitcnt lgkmcnt(0)
    s_waitcnt vmcnt(11)
    v_add_u32 v55, 114688, v51
    v_xor_b32 v56, 32, v55
    ds_read_b64_tr_b16 a[192:193], v55 offset:0
    ds_read_b64_tr_b16 a[194:195], v55 offset:256
    ds_read_b64_tr_b16 a[196:197], v55 offset:8192
    ds_read_b64_tr_b16 a[198:199], v55 offset:8448
    s_xor_b32 s78, s75, 2097152
    s_add_u32 s78, s78, s67
    s_add_u32 s80, s66, 0
    s_mov_b32 s76, 0
    s_mov_b32 s77, 8192
    s_call_b64 s[82:83], cs_dma
    ds_read_b64_tr_b16 a[200:201], v56 offset:0
    ds_read_b64_tr_b16 a[202:203], v56 offset:256
    ds_read_b64_tr_b16 a[204:205], v56 offset:8192
    ds_read_b64_tr_b16 a[206:207], v56 offset:8448
    s_mov_b32 s77, 16384
    s_call_b64 s[82:83], cs_dma
    v_cmp_eq_u32 vcc, 0, v29
    s_nop 1
    v_cndmask_b32 v16, 0, v31, vcc
    v_cmp_eq_u32 vcc, 1, v29
    s_nop 1
    v_cndmask_b32 v16, v16, v32, vcc
    v_cmp_eq_u32 vcc, 0, v28
    s_nop 1
    v_cndmask_b32 v20, 0, v31, vcc
    v_cmp_eq_u32 vcc, 1, v28
    s_nop 1
    v_cndmask_b32 v20, v20, v32, vcc
    s_nop 1
    s_waitcnt lgkmcnt(0)
    v_add_u32 v55, 131072, v51
    v_xor_b32 v56, 32, v55
    ds_read_b64_tr_b16 a[208:209], v55 offset:0
    ds_read_b64_tr_b16 a[210:211], v55 offset:256
    ds_read_b64_tr_b16 a[212:213], v55 offset:8192
    ds_read_b64_tr_b16 a[214:215], v55 offset:8448
    s_mov_b32 s77, 24576
    s_call_b64 s[82:83], cs_dma
    ds_read_b64_tr_b16 a[216:217], v56 offset:0
    ds_read_b64_tr_b16 a[218:219], v56 offset:256
    ds_read_b64_tr_b16 a[220:221], v56 offset:8192
    ds_read_b64_tr_b16 a[222:223], v56 offset:8448
    s_mov_b32 s77, 32768
    s_call_b64 s[82:83], cs_dma
    v_cmp_eq_u32 vcc, 2, v29
    s_nop 1
    v_cndmask_b32 v17, 0, v31, vcc
    v_cmp_eq_u32 vcc, 3, v29
    s_nop 1
    v_cndmask_b32 v17, v17, v32, vcc
    v_cmp_eq_u32 vcc, 2, v28
    s_nop 1
    v_cndmask_b32 v21, 0, v31, vcc
    v_cmp_eq_u32 vcc, 3, v28
    s_nop 1
    v_cndmask_b32 v21, v21, v32, vcc
    s_nop 1
    s_waitcnt lgkmcnt(0)
    s_waitcnt vmcnt(8)
    v_add_u32 v55, 65536, v51
    v_xor_b32 v56, 32, v55
    ds_read_b64_tr_b16 a[224:225], v55 offset:0
    ds_read_b64_tr_b16 a[226:227], v55 offset:256
    ds_read_b64_tr_b16 a[228:229], v55 offset:8192
    ds_read_b64_tr_b16 a[230:231], v55 offset:8448
    s_xor_b32 s78, s75, 3145728
    s_add_u32 s78, s78, s67
    s_add_u32 s80, s66, 32768
    s_mov_b32 s76, 0
    s_mov_b32 s77, 8192
    s_call_b64 s[82:83], cs_dma
    ds_read_b64_tr_b16 a[232:233], v56 offset:0
    ds_read_b64_tr_b16 a[234:235], v56 offset:256
    ds_read_b64_tr_b16 a[236:237], v56 offset:8192
    ds_read_b64_tr_b16 a[238:239], v56 offset:8448
    s_mov_b32 s77, 16384
    s_call_b64 s[82:83], cs_dma
    v_cmp_eq_u32 vcc, 8, v29
    s_nop 1
    v_cndmask_b32 v18, 0, v31, vcc
    v_cmp_eq_u32 vcc, 9, v29
    s_nop 1
    v_cndmask_b32 v18, v18, v32, vcc
    v_cmp_eq_u32 vcc, 4, v28
    s_nop 1
    v_cndmask_b32 v22, 0, v31, vcc
    v_cmp_eq_u32 vcc, 5, v28
    s_nop 1
    v_cndmask_b32 v22, v22, v32, vcc
    s_nop 1
    s_waitcnt lgkmcnt(0)
    v_add_u32 v55, 81920, v51
    v_xor_b32 v56, 32, v55
    ds_read_b64_tr_b16 a[240:241], v55 offset:0
    ds_read_b64_tr_b16 a[242:243], v55 offset:256
    ds_read_b64_tr_b16 a[244:245], v55 offset:8192
    ds_read_b64_tr_b16 a[246:247], v55 offset:8448
    s_mov_b32 s77, 24576
    s_call_b64 s[82:83], cs_dma
    ds_read_b64_tr_b16 a[248:249], v56 offset:0
    ds_read_b64_tr_b16 a[250:251], v56 offset:256
    ds_read_b64_tr_b16 a[252:253], v56 offset:8192
    ds_read_b64_tr_b16 a[254:255], v56 offset:8448
    s_mov_b32 s77, 32768
    s_call_b64 s[82:83], cs_dma
    v_cmp_eq_u32 vcc, 10, v29
    s_nop 1
    v_cndmask_b32 v19, 0, v31, vcc
    v_cmp_eq_u32 vcc, 11, v29
    s_nop 1
    v_cndmask_b32 v19, v19, v32, vcc
    v_cmp_eq_u32 vcc, 6, v28
    s_nop 1
    v_cndmask_b32 v23, 0, v31, vcc
    v_cmp_eq_u32 vcc, 7, v28
    s_nop 1
    v_cndmask_b32 v23, v23, v32, vcc
    s_nop 1
    s_waitcnt lgkmcnt(0)
    s_waitcnt vmcnt(8)
    v_add_u32 v55, 0, v51
    v_xor_b32 v56, 32, v55
    ds_read_b64_tr_b16 v[80:81], v55 offset:0
    ds_read_b64_tr_b16 v[82:83], v55 offset:256
    ds_read_b64_tr_b16 v[84:85], v55 offset:8192
    ds_read_b64_tr_b16 v[86:87], v55 offset:8448
    s_xor_b32 s78, s75, 2097152
    s_add_u32 s78, s78, s67
    s_mov_b64 s[8:9], s[52:53]
    s_add_u32 s80, s66, 131072
    s_mov_b32 s76, 0
    s_mov_b32 s77, 8192
    s_call_b64 s[82:83], cs_dma
    ds_read_b64_tr_b16 v[88:89], v56 offset:0
    ds_read_b64_tr_b16 v[90:91], v56 offset:256
    ds_read_b64_tr_b16 v[92:93], v56 offset:8192
    ds_read_b64_tr_b16 v[94:95], v56 offset:8448
    s_mov_b32 s77, 16384
    s_call_b64 s[82:83], cs_dma
    v_mov_b32 v46, 1
    s_mov_b64 exec, 1
    buffer_atomic_add v46, off, s[96:99], 0 offset:212 sc0
    s_mov_b64 exec, -1
    s_waitcnt lgkmcnt(0)
    v_add_u32 v55, 16384, v51
    v_xor_b32 v56, 32, v55
    ds_read_b64_tr_b16 v[96:97], v55 offset:0
    ds_read_b64_tr_b16 v[98:99], v55 offset:256
    ds_read_b64_tr_b16 v[100:101], v55 offset:8192
    ds_read_b64_tr_b16 v[102:103], v55 offset:8448
    s_mov_b32 s77, 24576
    s_call_b64 s[82:83], cs_dma
    ds_read_b64_tr_b16 v[104:105], v56 offset:0
    ds_read_b64_tr_b16 v[106:107], v56 offset:256
    ds_read_b64_tr_b16 v[108:109], v56 offset:8192
    ds_read_b64_tr_b16 v[110:111], v56 offset:8448
    s_mov_b32 s77, 32768
    s_call_b64 s[82:83], cs_dma
    s_waitcnt lgkmcnt(0)
    s_waitcnt vmcnt(9)
    v_add_u32 v55, 32768, v51
    v_xor_b32 v56, 32, v55
    ds_read_b64_tr_b16 v[112:113], v55 offset:0
    ds_read_b64_tr_b16 v[114:115], v55 offset:256
    ds_read_b64_tr_b16 v[116:117], v55 offset:8192
    ds_read_b64_tr_b16 v[118:119], v55 offset:8448
    s_xor_b32 s78, s75, 3145728
    s_add_u32 s78, s78, s67
    s_add_u32 s80, s66, 65536
    s_mov_b32 s76, 0
    s_mov_b32 s77, 8192
    s_call_b64 s[82:83], cs_dma
    ds_read_b64_tr_b16 v[120:121], v56 offset:0
    ds_read_b64_tr_b16 v[122:123], v56 offset:256
    ds_read_b64_tr_b16 v[124:125], v56 offset:8192
    ds_read_b64_tr_b16 v[126:127], v56 offset:8448
    s_mov_b32 s77, 16384
    s_call_b64 s[82:83], cs_dma
    s_waitcnt lgkmcnt(0)
    v_add_u32 v55, 49152, v51
    v_xor_b32 v56, 32, v55
    ds_read_b64_tr_b16 v[128:129], v55 offset:0
    ds_read_b64_tr_b16 v[130:131], v55 offset:256
    ds_read_b64_tr_b16 v[132:133], v55 offset:8192
    ds_read_b64_tr_b16 v[134:135], v55 offset:8448
    s_mov_b32 s77, 24576
    s_call_b64 s[82:83], cs_dma
    ds_read_b64_tr_b16 v[136:137], v56 offset:0
    ds_read_b64_tr_b16 v[138:139], v56 offset:256
    ds_read_b64_tr_b16 v[140:141], v56 offset:8192
    ds_read_b64_tr_b16 v[142:143], v56 offset:8448
    s_mov_b32 s77, 32768
    s_call_b64 s[82:83], cs_dma
    s_waitcnt lgkmcnt(0)
    s_waitcnt vmcnt(8)
    v_add_u32 v55, 131072, v51
    v_xor_b32 v56, 32, v55
    ds_read_b64_tr_b16 a[128:129], v55 offset:0
    ds_read_b64_tr_b16 a[130:131], v55 offset:256
    ds_read_b64_tr_b16 a[132:133], v55 offset:8192
    ds_read_b64_tr_b16 a[134:135], v55 offset:8448
    s_xor_b32 s78, s75, 2097152
    s_add_u32 s78, s78, s67
    s_mov_b64 s[8:9], s[50:51]
    s_add_u32 s80, s66, 0
    s_mov_b32 s76, 0
    s_mov_b32 s77, 8192
    s_call_b64 s[82:83], cs_dma
    ds_read_b64_tr_b16 a[136:137], v56 offset:0
    ds_read_b64_tr_b16 a[138:139], v56 offset:256
    ds_read_b64_tr_b16 a[140:141], v56 offset:8192
    ds_read_b64_tr_b16 a[142:143], v56 offset:8448
    s_mov_b32 s77, 16384
    s_call_b64 s[82:83], cs_dma
    s_waitcnt lgkmcnt(0)
    v_add_u32 v55, 147456, v51
    v_xor_b32 v56, 32, v55
    ds_read_b64_tr_b16 a[144:145], v55 offset:0
    ds_read_b64_tr_b16 a[146:147], v55 offset:256
    ds_read_b64_tr_b16 a[148:149], v55 offset:8192
    ds_read_b64_tr_b16 a[150:151], v55 offset:8448
    s_mov_b32 s77, 24576
    s_call_b64 s[82:83], cs_dma
    ds_read_b64_tr_b16 a[152:153], v56 offset:0
    ds_read_b64_tr_b16 a[154:155], v56 offset:256
    ds_read_b64_tr_b16 a[156:157], v56 offset:8192
    ds_read_b64_tr_b16 a[158:159], v56 offset:8448
    s_mov_b32 s77, 32768
    s_call_b64 s[82:83], cs_dma
    s_waitcnt lgkmcnt(0)
    s_waitcnt vmcnt(8)
    v_add_u32 v55, 65536, v51
    v_xor_b32 v56, 32, v55
    ds_read_b64_tr_b16 a[160:161], v55 offset:0
    ds_read_b64_tr_b16 a[162:163], v55 offset:256
    ds_read_b64_tr_b16 a[164:165], v55 offset:8192
    ds_read_b64_tr_b16 a[166:167], v55 offset:8448
    s_xor_b32 s78, s75, 3145728
    s_add_u32 s78, s78, s67
    s_add_u32 s80, s66, 32768
    s_mov_b32 s76, 0
    s_mov_b32 s77, 8192
    s_call_b64 s[82:83], cs_dma
    ds_read_b64_tr_b16 a[168:169], v56 offset:0
    ds_read_b64_tr_b16 a[170:171], v56 offset:256
    ds_read_b64_tr_b16 a[172:173], v56 offset:8192
    ds_read_b64_tr_b16 a[174:175], v56 offset:8448
    s_mov_b32 s77, 16384
    s_call_b64 s[82:83], cs_dma
    v_readfirstlane_b32 s41, v46
    v_mov_b32 v46, 1
    v_mov_b32 v47, 0
    s_cmp_eq_u32 s41, 127
    s_cselect_b64 exec, 1, 0
    buffer_atomic_cmpswap v[46:47], off, s[96:99], 0 offset:216
    s_mov_b64 exec, -1
    s_waitcnt lgkmcnt(0)
    v_add_u32 v55, 81920, v51
    v_xor_b32 v56, 32, v55
    ds_read_b64_tr_b16 a[176:177], v55 offset:0
    ds_read_b64_tr_b16 a[178:179], v55 offset:256
    ds_read_b64_tr_b16 a[180:181], v55 offset:8192
    ds_read_b64_tr_b16 a[182:183], v55 offset:8448
    s_mov_b32 s77, 24576
    s_call_b64 s[82:83], cs_dma
    ds_read_b64_tr_b16 a[184:185], v56 offset:0
    ds_read_b64_tr_b16 a[186:187], v56 offset:256
    ds_read_b64_tr_b16 a[188:189], v56 offset:8192
    ds_read_b64_tr_b16 a[190:191], v56 offset:8448
    s_mov_b32 s77, 32768
    s_call_b64 s[82:83], cs_dma
    s_waitcnt lgkmcnt(0)
    s_waitcnt vmcnt(8)
    v_add_u32 v55, 0, v51
    v_xor_b32 v56, 32, v55
    ds_read_b64_tr_b16 a[48:49], v55 offset:0
    ds_read_b64_tr_b16 a[50:51], v55 offset:256
    ds_read_b64_tr_b16 a[52:53], v55 offset:8192
    ds_read_b64_tr_b16 a[54:55], v55 offset:8448
    s_add_u32 s78, s67, 4194304
    s_mov_b32 s81, 0
    s_add_u32 s80, s66, 98304
    s_mov_b32 s76, 0
    s_mov_b32 s77, 8192
    s_call_b64 s[82:83], cs_dma
    ds_read_b64_tr_b16 a[56:57], v56 offset:0
    ds_read_b64_tr_b16 a[58:59], v56 offset:256
    ds_read_b64_tr_b16 a[60:61], v56 offset:8192
    ds_read_b64_tr_b16 a[62:63], v56 offset:8448
    s_mov_b32 s77, 16384
    s_call_b64 s[82:83], cs_dma
    s_waitcnt lgkmcnt(0)
    v_add_u32 v55, 16384, v51
    v_xor_b32 v56, 32, v55
    ds_read_b64_tr_b16 a[64:65], v55 offset:0
    ds_read_b64_tr_b16 a[66:67], v55 offset:256
    ds_read_b64_tr_b16 a[68:69], v55 offset:8192
    ds_read_b64_tr_b16 a[70:71], v55 offset:8448
    s_xor_b32 s78, s75, 1048576
    s_add_u32 s78, s78, s67
    s_mov_b32 s81, s93
    s_add_u32 s80, s66, 114688
    s_mov_b32 s76, 0
    s_mov_b32 s77, 8192
    s_call_b64 s[82:83], cs_dma
    ds_read_b64_tr_b16 a[72:73], v56 offset:0
    ds_read_b64_tr_b16 a[74:75], v56 offset:256
    ds_read_b64_tr_b16 a[76:77], v56 offset:8192
    ds_read_b64_tr_b16 a[78:79], v56 offset:8448
    s_mov_b32 s77, 16384
    s_call_b64 s[82:83], cs_dma
    s_waitcnt lgkmcnt(0)
    s_waitcnt vmcnt(8)
    v_add_u32 v55, 32768, v51
    v_xor_b32 v56, 32, v55
    ds_read_b64_tr_b16 a[80:81], v55 offset:0
    ds_read_b64_tr_b16 a[82:83], v55 offset:256
    ds_read_b64_tr_b16 a[84:85], v55 offset:8192
    ds_read_b64_tr_b16 a[86:87], v55 offset:8448
    s_mov_b32 s77, 24576
    s_call_b64 s[82:83], cs_dma
    ds_read_b64_tr_b16 a[88:89], v56 offset:0
    ds_read_b64_tr_b16 a[90:91], v56 offset:256
    ds_read_b64_tr_b16 a[92:93], v56 offset:8192
    ds_read_b64_tr_b16 a[94:95], v56 offset:8448
    s_mov_b32 s77, 32768
    s_call_b64 s[82:83], cs_dma
    s_waitcnt lgkmcnt(0)
    v_add_u32 v55, 49152, v51
    v_xor_b32 v56, 32, v55
    ds_read_b64_tr_b16 a[96:97], v55 offset:0
    ds_read_b64_tr_b16 a[98:99], v55 offset:256
    ds_read_b64_tr_b16 a[100:101], v55 offset:8192
    ds_read_b64_tr_b16 a[102:103], v55 offset:8448
    s_xor_b32 s78, s75, 0
    s_add_u32 s78, s78, s67
    s_add_u32 s80, s66, 65536
    s_mov_b32 s76, 0
    s_mov_b32 s77, 8192
    s_call_b64 s[82:83], cs_dma
    ds_read_b64_tr_b16 a[104:105], v56 offset:0
    ds_read_b64_tr_b16 a[106:107], v56 offset:256
    ds_read_b64_tr_b16 a[108:109], v56 offset:8192
    ds_read_b64_tr_b16 a[110:111], v56 offset:8448
    s_mov_b32 s77, 16384
    s_call_b64 s[82:83], cs_dma
    s_waitcnt lgkmcnt(0)
    s_waitcnt vmcnt(12)
    v_add_u32 v55, 98304, v51
    v_xor_b32 v56, 32, v55
    ds_read_b64_tr_b16 a[112:113], v55 offset:0
    ds_read_b64_tr_b16 a[114:115], v55 offset:256
    ds_read_b64_tr_b16 a[116:117], v55 offset:8192
    ds_read_b64_tr_b16 a[118:119], v55 offset:8448
    s_mov_b32 s77, 24576
    s_call_b64 s[82:83], cs_dma
    ds_read_b64_tr_b16 a[120:121], v56 offset:0
    ds_read_b64_tr_b16 a[122:123], v56 offset:256
    ds_read_b64_tr_b16 a[124:125], v56 offset:8192
    ds_read_b64_tr_b16 a[126:127], v56 offset:8448
    s_mov_b32 s77, 32768
    s_call_b64 s[82:83], cs_dma
    s_waitcnt lgkmcnt(0)
    s_waitcnt vmcnt(8)
    v_add_u32 v55, 114688, v51
    v_xor_b32 v56, 32, v55
    ds_read_b64_tr_b16 a[16:17], v55 offset:0
    ds_read_b64_tr_b16 a[18:19], v55 offset:256
    ds_read_b64_tr_b16 a[20:21], v55 offset:8192
    ds_read_b64_tr_b16 a[22:23], v55 offset:8448
    s_xor_b32 s78, s75, 0
    s_add_u32 s78, s78, s67
    s_mov_b64 s[8:9], s[52:53]
    s_add_u32 s80, s66, 0
    s_mov_b32 s76, 0
    s_mov_b32 s77, 8192
    s_call_b64 s[82:83], cs_dma
    ds_read_b64_tr_b16 a[24:25], v56 offset:0
    ds_read_b64_tr_b16 a[26:27], v56 offset:256
    ds_read_b64_tr_b16 a[28:29], v56 offset:8192
    ds_read_b64_tr_b16 a[30:31], v56 offset:8448
    s_mov_b32 s77, 16384
    s_call_b64 s[82:83], cs_dma
    s_waitcnt lgkmcnt(0)
    v_add_u32 v55, 131072, v51
    v_xor_b32 v56, 32, v55
    ds_read_b64_tr_b16 a[32:33], v55 offset:0
    ds_read_b64_tr_b16 a[34:35], v55 offset:256
    ds_read_b64_tr_b16 a[36:37], v55 offset:8192
    ds_read_b64_tr_b16 a[38:39], v55 offset:8448
    s_mov_b32 s77, 24576
    s_call_b64 s[82:83], cs_dma
    ds_read_b64_tr_b16 a[40:41], v56 offset:0
    ds_read_b64_tr_b16 a[42:43], v56 offset:256
    ds_read_b64_tr_b16 a[44:45], v56 offset:8192
    ds_read_b64_tr_b16 a[46:47], v56 offset:8448
    s_mov_b32 s77, 32768
    s_call_b64 s[82:83], cs_dma
    s_waitcnt lgkmcnt(0)
    s_waitcnt vmcnt(8)
    v_add_u32 v55, 65536, v51
    v_xor_b32 v56, 32, v55
    ds_read_b64_tr_b16 v[0:1], v55 offset:0
    ds_read_b64_tr_b16 v[2:3], v55 offset:256
    ds_read_b64_tr_b16 v[4:5], v55 offset:8192
    ds_read_b64_tr_b16 v[6:7], v55 offset:8448
    s_xor_b32 s78, s75, 1048576
    s_add_u32 s78, s78, s67
    s_add_u32 s80, s66, 32768
    s_mov_b32 s76, 0
    s_mov_b32 s77, 8192
    s_call_b64 s[82:83], cs_dma
    ds_read_b64_tr_b16 v[8:9], v56 offset:0
    ds_read_b64_tr_b16 v[10:11], v56 offset:256
    ds_read_b64_tr_b16 v[12:13], v56 offset:8192
    ds_read_b64_tr_b16 v[14:15], v56 offset:8448
    s_mov_b32 s77, 16384
    s_call_b64 s[82:83], cs_dma
    s_waitcnt lgkmcnt(0)
    ds_write_b128 v62, v[0:3] offset:8192
    ds_write_b128 v62, v[4:7] offset:12288
    ds_write_b128 v62, v[8:11] offset:16384
    ds_write_b128 v62, v[12:15] offset:20480
    s_waitcnt lgkmcnt(0)
    v_add_u32 v55, 81920, v51
    v_xor_b32 v56, 32, v55
    ds_read_b64_tr_b16 a[0:1], v55 offset:0
    ds_read_b64_tr_b16 a[2:3], v55 offset:256
    ds_read_b64_tr_b16 a[4:5], v55 offset:8192
    ds_read_b64_tr_b16 a[6:7], v55 offset:8448
    s_mov_b32 s77, 24576
    s_call_b64 s[82:83], cs_dma
    ds_read_b64_tr_b16 a[8:9], v56 offset:0
    ds_read_b64_tr_b16 a[10:11], v56 offset:256
    ds_read_b64_tr_b16 a[12:13], v56 offset:8192
    ds_read_b64_tr_b16 a[14:15], v56 offset:8448
    s_mov_b32 s77, 32768
    s_call_b64 s[82:83], cs_dma
    s_waitcnt lgkmcnt(0)
    s_waitcnt vmcnt(8)
    v_add_u32 v55, 0, v51
    v_xor_b32 v56, 32, v55
    ds_read_b64_tr_b16 v[0:1], v55 offset:0
    ds_read_b64_tr_b16 v[2:3], v55 offset:256
    ds_read_b64_tr_b16 v[4:5], v55 offset:8192
    ds_read_b64_tr_b16 v[6:7], v55 offset:8448
    s_xor_b32 s94, s13, 0
    s_mul_i32 s94, s94, 36864
    s_add_u32 s94, s94, s92
    s_lshr_b32 s74, s13, 1
    s_lshl_b32 s74, s74, 6
    s_add_u32 s94, s94, s74
    s_add_u32 s78, s94, 1024
    s_mov_b64 s[8:9], s[56:57]
    v_mov_b32 v58, v50
    s_mov_b32 s79, 18432
    s_mov_b32 s81, 0
    s_add_u32 s80, s66, 147456
    s_mov_b32 s76, 0
    s_mov_b32 s77, 8192
    s_call_b64 s[82:83], cs_dma
    ds_read_b64_tr_b16 v[8:9], v56 offset:0
    ds_read_b64_tr_b16 v[10:11], v56 offset:256
    ds_read_b64_tr_b16 v[12:13], v56 offset:8192
    ds_read_b64_tr_b16 v[14:15], v56 offset:8448
    s_xor_b32 s94, s13, 2
    s_mul_i32 s94, s94, 36864
    s_add_u32 s94, s94, s92
    s_lshr_b32 s74, s13, 1
    s_lshl_b32 s74, s74, 6
    s_add_u32 s94, s94, s74
    s_add_u32 s78, s94, 1024
    s_mov_b32 s77, 16384
    s_call_b64 s[82:83], cs_dma
    s_waitcnt lgkmcnt(0)
    ds_write_b128 v61, v[0:3] offset:0
    ds_write_b128 v61, v[4:7] offset:4096
    ds_write_b128 v61, v[8:11] offset:8192
    ds_write_b128 v61, v[12:15] offset:12288
    s_waitcnt lgkmcnt(0)
    v_add_u32 v55, 16384, v51
    v_xor_b32 v56, 32, v55
    ds_read_b64_tr_b16 v[0:1], v55 offset:0
    ds_read_b64_tr_b16 v[2:3], v55 offset:256
    ds_read_b64_tr_b16 v[4:5], v55 offset:8192
    ds_read_b64_tr_b16 v[6:7], v55 offset:8448
    s_xor_b32 s94, s13, 3
    s_mul_i32 s94, s94, 36864
    s_add_u32 s94, s94, s92
    s_lshl_b32 s74, s13, 7
    s_add_u32 s94, s94, s74
    s_add_u32 s78, s94, 512
    v_mov_b32 v58, v49
    s_mov_b32 s79, 9216
    s_add_u32 s80, s66, 131072
    s_mov_b32 s76, 0
    s_mov_b32 s77, 8192
    s_call_b64 s[82:83], cs_dma
    ds_read_b64_tr_b16 v[8:9], v56 offset:0
    ds_read_b64_tr_b16 v[10:11], v56 offset:256
    ds_read_b64_tr_b16 v[12:13], v56 offset:8192
    ds_read_b64_tr_b16 v[14:15], v56 offset:8448
    s_mov_b32 s77, 16384
    s_call_b64 s[82:83], cs_dma
    s_waitcnt lgkmcnt(0)
    ds_write_b128 v61, v[0:3] offset:16384
    ds_write_b128 v61, v[4:7] offset:20480
    ds_write_b128 v61, v[8:11] offset:24576
    ds_write_b128 v61, v[12:15] offset:28672
    s_waitcnt lgkmcnt(0)
    s_waitcnt vmcnt(8)
    v_add_u32 v55, 32768, v51
    v_xor_b32 v56, 32, v55
    ds_read_b64_tr_b16 v[0:1], v55 offset:0
    ds_read_b64_tr_b16 v[2:3], v55 offset:256
    ds_read_b64_tr_b16 v[4:5], v55 offset:8192
    ds_read_b64_tr_b16 v[6:7], v55 offset:8448
    s_xor_b32 s94, s13, 2
    s_mul_i32 s94, s94, 36864
    s_add_u32 s94, s94, s92
    s_lshl_b32 s74, s13, 7
    s_add_u32 s94, s94, s74
    s_add_u32 s78, s94, 512
    s_add_u32 s80, s66, 114688
    s_mov_b32 s76, 0
    s_mov_b32 s77, 8192
    s_call_b64 s[82:83], cs_dma
    ds_read_b64_tr_b16 v[8:9], v56 offset:0
    ds_read_b64_tr_b16 v[10:11], v56 offset:256
    ds_read_b64_tr_b16 v[12:13], v56 offset:8192
    ds_read_b64_tr_b16 v[14:15], v56 offset:8448
    s_mov_b32 s77, 16384
    s_call_b64 s[82:83], cs_dma
    s_waitcnt lgkmcnt(0)
    ds_write_b128 v61, v[0:3] offset:32768
    ds_write_b128 v61, v[4:7] offset:36864
    ds_write_b128 v61, v[8:11] offset:40960
    ds_write_b128 v61, v[12:15] offset:45056
    s_waitcnt lgkmcnt(0)
    v_add_u32 v55, 49152, v51
    v_xor_b32 v56, 32, v55
    ds_read_b64_tr_b16 v[0:1], v55 offset:0
    ds_read_b64_tr_b16 v[2:3], v55 offset:256
    ds_read_b64_tr_b16 v[4:5], v55 offset:8192
    ds_read_b64_tr_b16 v[6:7], v55 offset:8448
    s_add_u32 s78, s67, 4194304
    s_mov_b64 s[8:9], s[52:53]
    v_mov_b32 v58, v48
    s_mov_b32 s79, 131072
    s_add_u32 s80, s66, 81920
    s_mov_b32 s76, 0
    s_mov_b32 s77, 8192
    s_call_b64 s[82:83], cs_dma
    ds_read_b64_tr_b16 v[8:9], v56 offset:0
    ds_read_b64_tr_b16 v[10:11], v56 offset:256
    ds_read_b64_tr_b16 v[12:13], v56 offset:8192
    ds_read_b64_tr_b16 v[14:15], v56 offset:8448
    s_mov_b32 s77, 16384
    s_call_b64 s[82:83], cs_dma
    s_waitcnt lgkmcnt(0)
    ds_write_b128 v61, v[0:3] offset:49152
    ds_write_b128 v61, v[4:7] offset:53248
    ds_write_b128 v61, v[8:11] offset:57344
    ds_write_b128 v61, v[12:15] offset:61440
    s_waitcnt lgkmcnt(0)
    buffer_load_dword v24, off, s[96:99], 0 offset:216 sc1
    buffer_load_dword v25, off, s[96:99], 0 offset:64 sc1
    s_lshr_b32 s84, s12, 1
    s_lshl_b32 s84, s84, 8
    s_add_u32 s84, s84, 125829120
    v_bfe_u32 v26, v61, 4, 6
    v_min_u32 v26, 11, v26
    v_lshlrev_b32 v26, 2, v26
    buffer_load_dword v27, v26, s[4:7], s84 offen sc1
    s_waitcnt vmcnt(15)
    v_add_u32 v55, 147456, v53
    ds_read_b64_tr_b16 v[0:1], v55 offset:0
    ds_read_b64_tr_b16 v[2:3], v55 offset:128
    ds_read_b64_tr_b16 v[4:5], v55 offset:512
    ds_read_b64_tr_b16 v[6:7], v55 offset:640
    ds_read_b64_tr_b16 v[8:9], v55 offset:8192
    ds_read_b64_tr_b16 v[10:11], v55 offset:8320
    ds_read_b64_tr_b16 v[12:13], v55 offset:8704
    ds_read_b64_tr_b16 v[14:15], v55 offset:8832
    s_waitcnt lgkmcnt(0)
    s_barrier
    ds_write_b128 v63, v[0:3] offset:49152
    ds_write_b128 v63, v[4:7] offset:53248
    s_barrier
    ds_write_b128 v63, v[8:11] offset:57344
    ds_write_b128 v63, v[12:15] offset:61440
    s_waitcnt lgkmcnt(0)
    v_lshlrev_b32 v45, 3, v61
    s_lshl_b32 s40, s12, 14
    s_add_u32 s40, s40, 65536
    s_lshl_b32 s41, s12, 11
    s_sub_u32 s41, s41, 12288
    v_add_u32 v30, s40, v45
    v_add_u32 v45, s41, v45
    v_cmp_gt_u32 vcc, 1536, v61
    s_nop 1
    v_cndmask_b32 v45, v45, v30, vcc
    s_lshl_b32 s40, s12, 16
    s_add_u32 s40, s40, 24102912
    v_lshlrev_b32 v30, 3, v61
    v_add_u32 v30, s40, v30
    v_cmp_gt_u32 vcc, 1792, v61
    s_nop 1
    v_cndmask_b32 v45, v30, v45, vcc
    v_cmp_gt_u32 vcc, 2944, v61
    s_mov_b32 s40, 68157440
    s_mov_b64 exec, vcc
    buffer_load_dword v30, v45, s[4:7], s40 offen sc1
    s_mov_b64 exec, -1
    s_waitcnt vmcnt(11)
    v_add_u32 v55, 131072, v52
    ds_read_b64_tr_b16 v[0:1], v55 offset:0
    ds_read_b64_tr_b16 v[2:3], v55 offset:256
    ds_read_b64_tr_b16 v[4:5], v55 offset:4096
    ds_read_b64_tr_b16 v[6:7], v55 offset:4352
    ds_read_b64_tr_b16 v[8:9], v55 offset:64
    ds_read_b64_tr_b16 v[10:11], v55 offset:320
    ds_read_b64_tr_b16 v[12:13], v55 offset:4160
    ds_read_b64_tr_b16 v[14:15], v55 offset:4416
    s_waitcnt lgkmcnt(0)
    s_barrier
    ds_write_b128 v63, v[0:3] offset:32768
    ds_write_b128 v63, v[4:7] offset:36864
    s_barrier
    ds_write_b128 v63, v[8:11] offset:40960
    ds_write_b128 v63, v[12:15] offset:45056
    s_waitcnt lgkmcnt(0)
    s_waitcnt vmcnt(7)
    v_add_u32 v55, 114688, v52
    ds_read_b64_tr_b16 v[0:1], v55 offset:0
    ds_read_b64_tr_b16 v[2:3], v55 offset:256
    ds_read_b64_tr_b16 v[4:5], v55 offset:4096
    ds_read_b64_tr_b16 v[6:7], v55 offset:4352
    ds_read_b64_tr_b16 v[8:9], v55 offset:64
    ds_read_b64_tr_b16 v[10:11], v55 offset:320
    ds_read_b64_tr_b16 v[12:13], v55 offset:4160
    ds_read_b64_tr_b16 v[14:15], v55 offset:4416
    s_waitcnt lgkmcnt(0)
    s_barrier
    ds_write_b128 v63, v[0:3] offset:16384
    ds_write_b128 v63, v[4:7] offset:20480
    s_barrier
    ds_write_b128 v63, v[8:11] offset:24576
    ds_write_b128 v63, v[12:15] offset:28672
    s_waitcnt lgkmcnt(0)
    v_min_u32 v36, -2, v36
    v_min_u32 v37, -2, v37
    v_min_u32 v38, -2, v38
    v_min_u32 v39, -2, v39
    v_min_u32 v40, -2, v40
    v_min_u32 v41, -2, v41
    v_min_u32 v42, -2, v42
    v_min_u32 v43, -2, v43
    v_min_u32 v44, -2, v44
    s_lshl_b32 s14, s12, 16
    s_add_u32 s14, s14, 92274688
    s_add_u32 s41, s14, 4096
    s_add_u32 s42, s14, 8192
    v_lshrrev_b32 v45, 2, v61
    buffer_store_dwordx4 v[36:39], v61, s[4:7], s14 offen sc1
    buffer_store_dwordx4 v[40:43], v61, s[4:7], s41 offen sc1
    buffer_store_dword v44, v45, s[4:7], s42 offen sc1
    s_waitcnt vmcnt(1)
    v_readfirstlane_b32 s95, v25
    v_readfirstlane_b32 s85, v24
    s_add_u32 s86, s95, 2
    s_waitcnt vmcnt(0)
    v_subrev_u32 v27, s86, v27
    v_cmp_lt_u32 s[86:87], 64, v27
    s_cmp_eq_u32 s95, 0
    s_cselect_b64 s[86:87], -1, s[86:87]
    s_cmp_lg_u64 s[86:87], 0
    s_cbranch_scc1 cs_nt
    s_add_u32 s40, s24, 524288
    buffer_load_dword v30, v79, s[4:7], s24 offen sc1
    buffer_load_dword v30, v79, s[4:7], s40 offen sc1
cs_nt:
    s_waitcnt vmcnt(3)
    v_add_u32 v55, 81920, v51
    v_xor_b32 v56, 32, v55
    ds_read_b64_tr_b16 v[0:1], v55 offset:0
    ds_read_b64_tr_b16 v[2:3], v55 offset:256
    ds_read_b64_tr_b16 v[4:5], v55 offset:8192
    ds_read_b64_tr_b16 v[6:7], v55 offset:8448
    ds_read_b64_tr_b16 v[8:9], v56 offset:0
    ds_read_b64_tr_b16 v[10:11], v56 offset:256
    ds_read_b64_tr_b16 v[12:13], v56 offset:8192
    ds_read_b64_tr_b16 v[14:15], v56 offset:8448
    s_waitcnt lgkmcnt(0)
    ds_write_b128 v62, v[0:3] offset:24576
    ds_write_b128 v62, v[4:7] offset:28672
    ds_write_b128 v62, v[8:11] offset:32768
    ds_write_b128 v62, v[12:15] offset:36864
    s_waitcnt lgkmcnt(0)
    s_barrier
    s_mov_b32 s88, 4194304
gn3:
    s_cmp_lg_u32 s95, 0
    s_cbranch_scc1 gn3x
    buffer_load_dword v27, off, s[96:99], 0 offset:64 sc1
    s_sub_u32 s88, s88, 1
    s_cbranch_scc1 gn3x
    s_waitcnt vmcnt(0)
    v_readfirstlane_b32 s95, v27
    s_nop 1
    s_branch gn3
gn3x:
    ds_write_b128 v78, v[16:19] offset:8704
    ds_write_b128 v65, v[20:23] offset:10240
    v_mov_b32 v44, s95
    v_mov_b32 v45, s95
    v_mov_b32 v46, s95
    v_mov_b32 v47, s95
    v_mov_b32 v48, 108288
    ds_write_b128 v48, v[44:47]
    s_waitcnt vmcnt(0) lgkmcnt(0)
    s_cmp_eq_u32 s85, 1
    s_cbranch_scc1 cs_run
    s_mov_b32 s40, 16777216
cs_startpoll:
    buffer_load_dword v3, off, s[96:99], 0 offset:216 sc1
    s_waitcnt vmcnt(0)
    v_readfirstlane_b32 s85, v3
    s_nop 0
    s_cmp_eq_u32 s85, 1
    s_cbranch_scc1 cs_run
    s_sleep 1
    s_sub_u32 s40, s40, 1
    s_cbranch_scc0 cs_startpoll
    s_endpgm
cs_run:
    s_cmp_eq_u64 s[86:87], 0
    s_cbranch_scc1 cs_kvok
    s_lshr_b32 s92, s12, 1
    s_lshl_b32 s92, s92, 8
    s_add_u32 s92, s92, 125829120
    v_bfe_u32 v2, v61, 4, 6
    v_min_u32 v2, 11, v2
    v_lshlrev_b32 v2, 2, v2
    s_add_u32 s93, s95, 2
    s_mov_b32 s94, 4194304
cs_kv0:
    buffer_load_dword v3, v2, s[4:7], s92 offen sc1
    s_sub_u32 s94, s94, 1
    s_cbranch_scc1 cs_kv0_go
    s_waitcnt vmcnt(0)
    v_subrev_u32 v3, s93, v3
    v_cmp_lt_u32 vcc, 64, v3
    s_cbranch_vccz cs_kv0_go
    s_sleep 2
    s_branch cs_kv0
cs_kv0_go:
    s_add_u32 s40, s24, 524288
    buffer_load_dword v30, v79, s[4:7], s24 offen sc1
    buffer_load_dword v30, v79, s[4:7], s40 offen sc1
    s_waitcnt vmcnt(0)
cs_kvok:
    s_mov_b32 m0, 108032
    s_add_u32 s24, s24, 1048576
    s_add_u32 s15, s14, 4096
    s_add_u32 s16, s14, 8192
    ds_read_b128 v[32:35], v62 offset:16384
    ds_read_b128 v[36:39], v62 offset:20480
    ds_read_b128 v[40:43], v61 offset:0
    ds_read_b128 v[44:47], v61 offset:4096
    ds_read_b128 v[48:51], v61 offset:8192
    ds_read_b128 v[52:55], v61 offset:12288
    s_mov_b32 s29, 1048576
    buffer_load_dwordx4 v[24:27], v61, s[4:7], s14 offen sc1
.p2align 6
cs_loop:
    v_mov_b64 v[0:1], 0
    v_mov_b64 v[2:3], 0
    v_mov_b64 v[4:5], 0
    v_mov_b64 v[6:7], 0
    v_mov_b64 v[8:9], 0
    v_mov_b64 v[10:11], 0
    v_mov_b64 v[12:13], 0
    v_mov_b64 v[14:15], 0
cs_loop2:
    ds_read_b128 v[16:19], v62 offset:8192
    ds_read_b128 v[20:23], v62 offset:12288
    v_lshrrev_b32 v56, 2, v61
    v_add_u32 v58, 106496, v56
    s_mov_b32 s29, 1048576
    s_waitcnt lgkmcnt(0)
cs_chk0:
    s_waitcnt vmcnt(0)
cs_chk0b:
    v_max3_u32 v57, v24, v25, v26
    v_max_u32 v57, v57, v27
    v_cmp_eq_u32 vcc, -1, v57
    ds_write_b128 v62, v[24:27] offset:40960
    s_cbranch_vccnz cs_spin0
    v_smfmac_f32_16x16x64_bf16 v[0:3], v[24:27], v[16:23], v60
    buffer_load_dwordx4 v[28:31], v61, s[4:7], s15 offen sc1
    buffer_load_dword v59, v56, s[4:7], s16 offen sc1
    v_smfmac_f32_16x16x64_bf16 v[8:11], v[24:27], v[32:39], v60
    ds_read_b128 v[32:35], v61 offset:16384
    v_smfmac_f32_16x16x64_bf16 v[12:15], v[24:27], v[48:55], v60
    ds_read_b128 v[36:39], v61 offset:20480
    v_mfma_f32_16x16x16_bf16 v[16:19], v[72:73], v[72:73], 0
    s_waitcnt lgkmcnt(2)
    s_barrier
    ds_read_b128 v[48:51], v63 offset:0
    v_mfma_f32_16x16x16_bf16 v[20:23], v[72:73], v[72:73], 0
    ds_read_b128 v[52:55], v64 offset:0
    v_smfmac_f32_16x16x64_bf16 v[4:7], v[24:27], v[40:47], v60
    ds_read_b128 v[40:43], v61 offset:24576
    v_smfmac_f32_16x16x64_bf16 v[16:19], v[24:27], a[192:199], v60
    ds_read_b128 v[44:47], v61 offset:28672
    v_smfmac_f32_16x16x64_bf16 v[20:23], v[24:27], a[200:207], v60
    s_waitcnt lgkmcnt(3)
    v_smfmac_f32_16x16x64_bf16 v[0:3], v[48:51], a[0:7], v60
    s_add_u32 s18, s14, s31
    s_add_u32 s41, s14, 16384
    v_smfmac_f32_16x16x64_bf16 v[4:7], v[48:51], v[32:39], v60
    ds_read_b128 v[32:35], v61 offset:32768
    v_smfmac_f32_16x16x64_bf16 v[8:11], v[48:51], a[8:15], v60
    ds_read_b128 v[36:39], v61 offset:36864
    s_waitcnt lgkmcnt(2)
    v_smfmac_f32_16x16x64_bf16 v[12:15], v[48:51], v[40:47], v60
    ds_read_b128 v[40:43], v61 offset:40960
    v_smfmac_f32_16x16x64_bf16 v[0:3], v[52:55], a[16:23], v60
    ds_read_b128 v[44:47], v61 offset:45056
    v_smfmac_f32_16x16x64_bf16 v[8:11], v[52:55], a[24:31], v60
    ds_read_b128 v[48:51], v71 offset:0
    s_waitcnt lgkmcnt(3)
    v_smfmac_f32_16x16x64_bf16 v[4:7], v[52:55], v[32:39], v60
    s_waitcnt vmcnt(0)
    ds_write_b128 v62, v[28:31] offset:45056
    s_waitcnt lgkmcnt(2)
    v_smfmac_f32_16x16x64_bf16 v[12:15], v[52:55], v[40:47], v60
    ds_write_b32 v58, v59
    v_max3_u32 v57, v28, v29, v30
    s_waitcnt lgkmcnt(2)
    v_smfmac_f32_16x16x64_bf16 v[0:3], v[48:51], a[32:39], v60
    ds_read_b128 v[32:35], v61 offset:49152
    v_max3_u32 v57, v57, v31, v59
    v_smfmac_f32_16x16x64_bf16 v[8:11], v[48:51], a[40:47], v60
    ds_read_b128 v[36:39], v61 offset:53248
    v_cmp_eq_u32 vcc, -1, v57
    v_smfmac_f32_16x16x64_bf16 v[16:19], v[52:55], a[224:231], v60
    ds_read_b128 v[40:43], v61 offset:57344
    v_smfmac_f32_16x16x64_bf16 v[20:23], v[52:55], a[232:239], v60
    ds_read_b128 v[44:47], v61 offset:61440
    s_cbranch_vccnz cs_spin1
cs_go1:
    v_smfmac_f32_16x16x64_bf16 v[0:3], v[28:31], a[48:55], v60
    s_waitcnt lgkmcnt(4)
    s_barrier
    ds_read_b128 v[52:55], v63 offset:4096
    v_smfmac_f32_16x16x64_bf16 v[8:11], v[28:31], a[56:63], v60
    ds_read_b128 v[56:59], v71 offset:4096
    v_smfmac_f32_16x16x64_bf16 v[4:7], v[28:31], a[128:135], v60
    s_waitcnt lgkmcnt(2)
    v_smfmac_f32_16x16x64_bf16 v[4:7], v[48:51], v[32:39], v60
    buffer_load_dwordx4 v[32:35], v61, s[4:7], s23 offen offset:0 sc1
    v_smfmac_f32_16x16x64_bf16 v[12:15], v[48:51], v[40:47], v60
    ds_read_b128 v[48:51], v64 offset:4096
    v_smfmac_f32_16x16x64_bf16 v[12:15], v[28:31], a[136:143], v60
    ds_read_b128 v[24:27], v65 offset:8192
    s_and_b32 s41, s41, 65535
    s_add_u32 s41, s41, 68157440
    v_smfmac_f32_16x16x64_bf16 v[16:19], v[28:31], v[80:87], v60
    buffer_load_dwordx4 v[36:39], v61, s[4:7], s23 offen offset:1024 sc1
    v_smfmac_f32_16x16x64_bf16 v[20:23], v[28:31], v[88:95], v60
    s_add_u32 s17, s41, s31
    s_and_b32 s30, s28, 1
    s_waitcnt lgkmcnt(3)
    v_smfmac_f32_16x16x64_bf16 v[0:3], v[52:55], a[64:71], v60
    ds_read_b128 v[28:31], v78 offset:8704
    v_smfmac_f32_16x16x64_bf16 v[4:7], v[52:55], a[144:151], v60
    buffer_load_dwordx4 v[40:43], v61, s[4:7], s23 offen offset:2048 sc1
    v_smfmac_f32_16x16x64_bf16 v[8:11], v[52:55], a[72:79], v60
    v_smfmac_f32_16x16x64_bf16 v[12:15], v[52:55], a[152:159], v60
    v_smfmac_f32_16x16x64_bf16 v[16:19], v[52:55], v[96:103], v60
    buffer_load_dwordx4 v[44:47], v61, s[4:7], s23 offen offset:3072 sc1
    v_smfmac_f32_16x16x64_bf16 v[20:23], v[52:55], v[104:111], v60
    ds_read_b128 v[52:55], v62 offset:28672
    s_waitcnt lgkmcnt(3)
    v_smfmac_f32_16x16x64_bf16 v[0:3], v[48:51], a[80:87], v60
    v_smfmac_f32_16x16x64_bf16 v[4:7], v[48:51], a[160:167], v60
    v_smfmac_f32_16x16x64_bf16 v[8:11], v[48:51], a[88:95], v60
    v_smfmac_f32_16x16x64_bf16 v[12:15], v[48:51], a[168:175], v60
    v_smfmac_f32_16x16x64_bf16 v[16:19], v[48:51], v[112:119], v60
    buffer_load_dword v79, s[4:7], s24 offen sc1 lds
    v_smfmac_f32_16x16x64_bf16 v[20:23], v[48:51], v[120:127], v60
    ds_read_b128 v[48:51], v62 offset:24576
    v_smfmac_f32_16x16x64_bf16 v[0:3], v[56:59], a[96:103], v60
    s_cmp_ge_u32 s28, 62
    v_smfmac_f32_16x16x64_bf16 v[8:11], v[56:59], a[104:111], v60
    s_waitcnt lgkmcnt(3)
    v_smfmac_f32_16x16x64_bf16 v[0:3], v[24:27], a[112:119], v60
    v_smfmac_f32_16x16x64_bf16 v[8:11], v[24:27], a[120:127], v60
    v_smfmac_f32_16x16x64_bf16 v[4:7], v[56:59], a[176:183], v60
    s_waitcnt lgkmcnt(0)
    v_cvt_pk_bf16_f32 v0, v0, v1
    v_smfmac_f32_16x16x64_bf16 v[4:7], v[24:27], v[48:55], v60
    ds_read_b128 v[48:51], v62 offset:32768
    v_cvt_pk_bf16_f32 v8, v8, v9
    v_smfmac_f32_16x16x64_bf16 v[12:15], v[56:59], a[184:191], v60
    ds_read_b128 v[52:55], v62 offset:36864
    v_cvt_pk_bf16_f32 v9, v10, v11
    v_smfmac_f32_16x16x64_bf16 v[16:19], v[56:59], v[128:135], v60
    v_cvt_pk_bf16_f32 v1, v2, v3
    v_mfma_f32_16x16x16_bf16 v[8:11], v[8:9], v[28:29], 0
    v_cvt_pk_bf16_f32 v2, v4, v5
    v_cvt_pk_bf16_f32 v3, v6, v7
    v_smfmac_f32_16x16x64_bf16 v[20:23], v[56:59], v[136:143], v60
    s_mov_b64 exec, s[36:37]
    ds_read_b128 v[56:59], v69
    s_mov_b64 exec, -1
    v_mfma_f32_16x16x32_bf16 v[4:7], v[0:3], v[28:31], 0
    v_cvt_pk_bf16_f32 v2, v8, v9
    s_waitcnt lgkmcnt(1)
    v_smfmac_f32_16x16x64_bf16 v[12:15], v[24:27], v[48:55], v60
    ds_read_b128 v[48:51], v63 offset:0
    v_cvt_pk_bf16_f32 v3, v10, v11
    s_waitcnt vmcnt(3)
    v_cvt_pk_bf16_f32 v0, v4, v5
    v_cvt_pk_bf16_f32 v1, v6, v7
    s_nop 1
    v_mfma_f32_16x16x32_bf16 v[4:7], v[36:39], v[0:3], 0
    v_cvt_pk_bf16_f32 v12, v12, v13
    v_cvt_pk_bf16_f32 v13, v14, v15
    s_nop 1
    v_mfma_f32_16x16x16_bf16 v[12:15], v[12:13], v[30:31], 0
    ds_read_b128 v[52:55], v71 offset:0
    ds_read_b128 v[36:39], v63 offset:53248
    v_mfma_f32_16x16x32_bf16 v[28:31], v[32:35], v[0:3], 0
    s_waitcnt vmcnt(1)
    ds_read_b128 v[32:35], v63 offset:49152
    s_mov_b64 exec, s[34:35]
    s_nop 0
    v_cvt_pk_bf16_f32 v2, v12, v13
    v_cvt_pk_bf16_f32 v3, v14, v15
    s_mov_b64 exec, -1
    s_nop 0
    v_mfma_f32_16x16x32_bf16 v[8:11], v[0:3], v[0:3], 0
    v_mov_b32_dpp v28, v4 row_ror:8 row_mask:0xf bank_mask:0xc
    v_mov_b32_dpp v29, v5 row_ror:8 row_mask:0xf bank_mask:0xc
    v_mov_b32_dpp v30, v6 row_ror:8 row_mask:0xf bank_mask:0xc
    v_mov_b32_dpp v31, v7 row_ror:8 row_mask:0xf bank_mask:0xc
    v_smfmac_f32_16x16x64_bf16 v[16:19], v[24:27], v[144:151], v60
    ds_write_b128 v62, v[28:31] offset:53248
    v_mov_b32_dpp v8, v10 row_ror:8 row_mask:0xf bank_mask:0xc
    v_mov_b32_dpp v9, v11 row_ror:8 row_mask:0xf bank_mask:0xc
    v_smfmac_f32_16x16x64_bf16 v[20:23], v[24:27], v[152:159], v60
    ds_write_b64 v70, v[8:9]
    s_waitcnt lgkmcnt(5)
    v_smfmac_f32_16x16x64_bf16 v[16:19], v[48:51], a[208:215], v60
    s_mov_b64 exec, s[36:37]
    s_cbranch_execz cs_np3627
    buffer_store_dwordx4 v[56:59], v61, s[4:7], s65 offen sc1
cs_np3627:
    s_mov_b64 exec, -1
    v_smfmac_f32_16x16x64_bf16 v[20:23], v[48:51], a[216:223], v60
    s_cbranch_scc1 cs_last
cs_back:
    s_waitcnt lgkmcnt(0)
    s_barrier
    ds_read_b128 v[56:59], v78 offset:10752
    v_smfmac_f32_16x16x64_bf16 v[16:19], v[52:55], a[240:247], v60
    ds_read_b128 v[12:15], v78 offset:11264
    ds_read_b128 v[4:7], v63 offset:12288
    v_smfmac_f32_16x16x64_bf16 v[20:23], v[52:55], a[248:255], v60
    ds_read_b128 v[8:11], v64 offset:12288
    ds_read_b128 v[0:3], v71 offset:12288
    v_mov_b64 v[24:25], s[62:63]
    v_mov_b64 v[26:27], s[60:61]
    v_cvt_pk_bf16_f32 v16, v16, v17
    v_cvt_pk_bf16_f32 v17, v18, v19
    v_pk_mul_f32 v[28:29], v[28:29], s[44:45]
    v_pk_mul_f32 v[30:31], v[30:31], s[44:45]
    s_waitcnt lgkmcnt(3)
    v_pk_add_f32 v[56:57], v[56:57], v[58:59]
    v_pk_add_f32 v[12:13], v[12:13], v[14:15]
    v_pk_add_f32 v[56:57], v[56:57], v[12:13]
    v_pk_mul_f32 v[56:57], v[56:57], s[44:45]
    v_exp_f32 v58, v56
    v_exp_f32 v59, v57
    s_waitcnt lgkmcnt(1)
    v_pk_fma_f32 v[28:29], v[4:5], s[44:45], v[28:29]
    v_pk_fma_f32 v[30:31], v[6:7], s[44:45], v[30:31]
    v_cvt_pk_bf16_f32 v6, v58, v59
    v_pk_fma_f32 v[28:29], v[8:9], s[44:45], v[28:29]
    v_pk_fma_f32 v[30:31], v[10:11], s[44:45], v[30:31]
    s_waitcnt lgkmcnt(0)
    v_pk_fma_f32 v[28:29], v[0:1], s[44:45], v[28:29]
    v_mov_b32_dpp v7, v6 row_ror:8 row_mask:0xf bank_mask:0xf
    v_pk_fma_f32 v[30:31], v[2:3], s[44:45], v[30:31]
    v_exp_f32 v0, v28
    v_mfma_f32_16x16x16_bf16 v[12:15], v[16:17], v[6:7], 0
    ds_read_b128 v[48:51], v63 offset:57344
    v_exp_f32 v1, v29
    v_cvt_pk_bf16_f32 v18, v20, v21
    v_exp_f32 v2, v30
    v_cvt_pk_bf16_f32 v19, v22, v23
    v_cvt_pk_bf16_f32 v8, v0, v1
    v_exp_f32 v3, v31
    v_mfma_f32_16x16x16_bf16 v[20:23], v[18:19], v[6:7], 0
    ds_read_b128 v[52:55], v63 offset:61440
    v_cvt_pk_bf16_f32 v9, v2, v3
    v_mov_b32_dpp v10, v8 row_ror:8 row_mask:0xf bank_mask:0xf
    v_max3_f32 v4, |v28|, |v29|, |v30|
    v_mov_b32_dpp v11, v9 row_ror:8 row_mask:0xf bank_mask:0xf
    v_mfma_f32_16x16x32_bf16 v[0:3], v[24:27], v[6:9], 0
    v_max3_f32 v4, v4, |v31|, |v56|
    v_max_f32_e64 v4, v4, |v57|
    v_mfma_f32_16x16x32_bf16 v[12:15], v[40:43], v[8:11], v[12:15]
    v_cmp_nge_f32 vcc, s46, v4
    v_mfma_f32_16x16x32_bf16 v[20:23], v[44:47], v[8:11], v[20:23]
    v_add_f32_dpp v0, v0, v0 row_ror:8 row_mask:0xf bank_mask:0xf
    v_rcp_f32 v0, v0
    s_cbranch_vccnz cs_guard
cs_norm:
    v_mfma_f32_16x16x16_bf16 v[28:31], v[72:73], v[72:73], 0
    v_mul_f32 v12, v12, v0
    v_mul_f32 v13, v13, v0
    v_mul_f32 v14, v14, v0
    v_mul_f32 v15, v15, v0
    v_mul_f32_dpp v12, v20, v0 row_ror:8 row_mask:0xf bank_mask:0xc
    v_mul_f32_dpp v13, v21, v0 row_ror:8 row_mask:0xf bank_mask:0xc
    v_mul_f32_dpp v14, v22, v0 row_ror:8 row_mask:0xf bank_mask:0xc
    v_mul_f32_dpp v15, v23, v0 row_ror:8 row_mask:0xf bank_mask:0xc
    v_cvt_pk_bf16_f32 v12, v12, v13
    v_cvt_pk_bf16_f32 v13, v14, v15
    v_mfma_f32_16x16x16_bf16 v[8:11], v[72:73], v[72:73], 0
    ds_write_b64 v77, v[12:13]
    v_mfma_f32_16x16x16_bf16 v[4:7], v[72:73], v[72:73], 0
    ds_read_b128 v[0:3], v68
    v_mfma_f32_16x16x16_bf16 v[16:19], v[72:73], v[72:73], 0
    ds_read_b128 v[40:43], v63 offset:16384
    v_mfma_f32_16x16x16_bf16 v[20:23], v[72:73], v[72:73], 0
    ds_read_b128 v[44:47], v63 offset:20480
    s_waitcnt lgkmcnt(3)
    s_barrier
    ds_read_b128 v[24:27], v74
    ds_read_b128 v[12:15], v75
    ds_read_b128 v[56:59], v76
    s_waitcnt lgkmcnt(5)
    v_smfmac_f32_16x16x64_bf16 v[28:31], v[0:3], v[160:167], v60
    v_smfmac_f32_16x16x64_bf16 v[8:11], v[0:3], v[192:199], v60
    v_smfmac_f32_16x16x64_bf16 v[4:7], v[0:3], v[32:39], v60
    ds_read_b128 v[32:35], v63 offset:32768
    v_smfmac_f32_16x16x64_bf16 v[16:19], v[0:3], v[224:231], v60
    ds_read_b128 v[36:39], v63 offset:36864
    s_waitcnt lgkmcnt(3)
    v_smfmac_f32_16x16x64_bf16 v[28:31], v[24:27], v[168:175], v60
    v_smfmac_f32_16x16x64_bf16 v[4:7], v[12:15], v[48:55], v60
    ds_read_b128 v[48:51], v63 offset:24576
    v_smfmac_f32_16x16x64_bf16 v[28:31], v[12:15], v[176:183], v60
    ds_read_b128 v[52:55], v63 offset:28672
    s_waitcnt lgkmcnt(4)
    v_smfmac_f32_16x16x64_bf16 v[28:31], v[56:59], v[184:191], v60
    v_cvt_pk_bf16_f32 v4, v4, v5
    v_smfmac_f32_16x16x64_bf16 v[16:19], v[12:15], v[40:47], v60
    ds_read_b128 v[40:43], v63 offset:40960
    v_and_or_b32 v4, v4, -2, s30
    v_smfmac_f32_16x16x64_bf16 v[8:11], v[24:27], v[200:207], v60
    ds_read_b128 v[44:47], v63 offset:45056
    v_cvt_pk_bf16_f32 v5, v6, v7
    v_smfmac_f32_16x16x64_bf16 v[8:11], v[12:15], v[208:215], v60
    buffer_store_dwordx2 v[4:5], v67, s[4:7], s22 offen sc1
    v_cvt_pk_bf16_f32 v28, v28, v29
    v_smfmac_f32_16x16x64_bf16 v[8:11], v[56:59], v[216:223], v60
    v_and_or_b32 v28, v28, -2, s30
    v_smfmac_f32_16x16x64_bf16 v[16:19], v[24:27], v[232:239], v60
    v_cvt_pk_bf16_f32 v29, v30, v31
    s_waitcnt lgkmcnt(4)
    v_smfmac_f32_16x16x64_bf16 v[16:19], v[56:59], v[32:39], v60
    buffer_store_dwordx2 v[28:29], v66, s[4:7], s20 offen sc1
    v_cvt_pk_bf16_f32 v8, v8, v9
    s_waitcnt lgkmcnt(0)
    v_smfmac_f32_16x16x64_bf16 v[20:23], v[0:3], v[240:247], v60
    v_and_or_b32 v8, v8, -2, s30
    v_smfmac_f32_16x16x64_bf16 v[20:23], v[24:27], v[248:255], v60
    v_cvt_pk_bf16_f32 v9, v10, v11
    v_smfmac_f32_16x16x64_bf16 v[20:23], v[12:15], v[48:55], v60
    buffer_store_dwordx2 v[8:9], v66, s[4:7], s21 offen sc1
    v_cvt_pk_bf16_f32 v16, v16, v17
    v_smfmac_f32_16x16x64_bf16 v[20:23], v[56:59], v[40:47], v60
    v_and_or_b32 v16, v16, -2, s30
    v_cvt_pk_bf16_f32 v17, v18, v19
    buffer_store_dwordx2 v[16:17], v66, s[4:7], s38 offen sc1
    s_cmp_lg_u32 s13, 2
    s_nop 1
    v_cvt_pk_bf16_f32 v20, v20, v21
    v_and_or_b32 v20, v20, -2, s30
    v_cvt_pk_bf16_f32 v21, v22, v23
    buffer_store_dwordx2 v[20:21], v66, s[4:7], s39 offen sc1
    s_cbranch_scc1 cs_w013
    s_nop 15
    s_nop 15
    s_nop 15
    s_nop 15
    s_nop 15
    s_nop 15
    s_nop 15
    s_nop 15
    s_nop 15
    s_nop 15
    s_nop 15
    s_nop 15
    s_nop 7
    buffer_load_dwordx4 v[40:43], v65, s[4:7], s19 offen offset:0 sc1
    buffer_load_dwordx4 v[44:47], v65, s[4:7], s19 offen offset:1024 sc1
    buffer_load_dwordx4 v[48:51], v65, s[4:7], s19 offen offset:2048 sc1
    buffer_load_dwordx4 v[52:55], v65, s[4:7], s19 offen offset:3072 sc1
    ds_read_b128 v[56:59], v65 offset:10240
    s_add_u32 s28, s28, 1
    s_mov_b32 s14, s41
    s_add_u32 s23, s23, 524288
    s_add_u32 s24, s24, 524288
    s_min_u32 s24, s24, s47
    s_add_u32 s15, s14, 4096
    s_add_u32 s16, s14, 8192
    v_mov_b32 v21, -1
    s_add_u32 s65, s65, 12288
    s_mov_b32 s40, 1
    v_mov_b64 v[0:1], 0
    v_mov_b64 v[2:3], 0
    v_mov_b64 v[4:5], 0
    v_mov_b64 v[6:7], 0
    v_mov_b64 v[8:9], 0
    v_mov_b64 v[10:11], 0
    v_mov_b64 v[12:13], 0
    v_mov_b64 v[14:15], 0
cs_chkF:
    v_mov_b32 v20, 0
    s_waitcnt vmcnt(3)
    s_waitcnt lgkmcnt(0)
    v_mfma_f32_16x16x32_bf16 v[28:31], v[40:43], v[56:59], 0
    v_bitop3_b32 v20, v20, v40, s30 bitop3:0xf6
    v_bitop3_b32 v20, v20, v42, s30 bitop3:0xf6
    s_waitcnt vmcnt(2)
    v_mfma_f32_16x16x32_bf16 v[28:31], v[44:47], v[56:59], v[28:31]
    v_bitop3_b32 v20, v20, v44, s30 bitop3:0xf6
    v_bitop3_b32 v20, v20, v46, s30 bitop3:0xf6
    s_waitcnt vmcnt(1)
    v_mfma_f32_16x16x32_bf16 v[28:31], v[48:51], v[56:59], v[28:31]
    v_bitop3_b32 v20, v20, v48, s30 bitop3:0xf6
    v_bitop3_b32 v20, v20, v50, s30 bitop3:0xf6
    s_waitcnt vmcnt(0)
    v_mfma_f32_16x16x32_bf16 v[28:31], v[52:55], v[56:59], v[28:31]
    v_bitop3_b32 v20, v20, v52, s30 bitop3:0xf6
    v_bitop3_b32 v20, v20, v54, s30 bitop3:0xf6
    v_and_b32 v20, s40, v20
    v_cmp_ne_u32 vcc, 0, v20
    s_cbranch_vccnz cs_spinF
    v_permlane32_swap_b32 v28, v30
    v_permlane32_swap_b32 v29, v31
    v_add_f32 v28, v28, v30
    v_add_f32 v30, v29, v31
    v_cvt_pk_bf16_f32 v28, v28, v30
    s_mov_b64 exec, s[32:33]
    buffer_store_dword v28, v69, s[4:7], s17 offen sc1
    buffer_store_dword v21, v69, s[4:7], s18 offen sc1
    s_mov_b64 exec, -1
    ds_read_b128 v[32:35], v62 offset:16384
    ds_read_b128 v[36:39], v62 offset:20480
    ds_read_b128 v[40:43], v61 offset:0
    ds_read_b128 v[44:47], v61 offset:4096
    ds_read_b128 v[48:51], v61 offset:8192
    ds_read_b128 v[52:55], v61 offset:12288
    s_nop 15
    s_nop 15
    s_nop 15
    s_nop 15
    s_nop 15
    s_nop 15
    s_nop 3
    buffer_load_dwordx4 v[24:27], v61, s[4:7], s14 offen sc1
    s_branch cs_loop2
cs_w013:
    ds_read_b128 v[56:59], v65 offset:10240
    ds_read_b128 v[32:35], v62 offset:16384
    ds_read_b128 v[36:39], v62 offset:20480
    ds_read_b128 v[40:43], v61 offset:0
    ds_read_b128 v[44:47], v61 offset:4096
    ds_read_b128 v[48:51], v61 offset:8192
    ds_read_b128 v[52:55], v61 offset:12288
    s_add_u32 s28, s28, 1
    s_mov_b32 s14, s41
    s_add_u32 s23, s23, 524288
    s_add_u32 s24, s24, 524288
    s_min_u32 s24, s24, s47
    s_add_u32 s15, s14, 4096
    s_add_u32 s16, s14, 8192
    v_mov_b32 v21, -1
    s_add_u32 s65, s65, 12288
    s_mov_b32 s40, 1
    s_cmp_eq_u32 s64, 0
    s_cbranch_scc1 cs_w0
    s_cmp_eq_u32 s13, 1
    s_cbranch_scc1 cs_sx
    s_nop 15
    s_nop 15
    s_nop 15
    s_nop 15
    s_nop 15
    s_nop 15
    s_nop 15
    s_nop 15
    s_nop 15
    s_nop 15
    s_nop 15
    s_nop 15
    s_nop 7
cs_sx:
    buffer_load_dwordx4 v[0:3], v65, s[4:7], s19 offen offset:0 sc1
    buffer_load_dwordx4 v[4:7], v65, s[4:7], s19 offen offset:1024 sc1
    buffer_load_dwordx4 v[8:11], v65, s[4:7], s19 offen offset:2048 sc1
    buffer_load_dwordx4 v[12:15], v65, s[4:7], s19 offen offset:3072 sc1
cs_chkG:
    v_mov_b32 v20, 0
    s_waitcnt vmcnt(3)
    s_waitcnt lgkmcnt(6)
    v_mfma_f32_16x16x32_bf16 v[28:31], v[0:3], v[56:59], 0
    v_bitop3_b32 v20, v20, v0, s30 bitop3:0xf6
    v_bitop3_b32 v20, v20, v2, s30 bitop3:0xf6
    s_waitcnt vmcnt(2)
    v_mfma_f32_16x16x32_bf16 v[28:31], v[4:7], v[56:59], v[28:31]
    v_bitop3_b32 v20, v20, v4, s30 bitop3:0xf6
    v_bitop3_b32 v20, v20, v6, s30 bitop3:0xf6
    s_waitcnt vmcnt(1)
    v_mfma_f32_16x16x32_bf16 v[28:31], v[8:11], v[56:59], v[28:31]
    v_bitop3_b32 v20, v20, v8, s30 bitop3:0xf6
    v_bitop3_b32 v20, v20, v10, s30 bitop3:0xf6
    s_waitcnt vmcnt(0)
    v_mfma_f32_16x16x32_bf16 v[28:31], v[12:15], v[56:59], v[28:31]
    v_bitop3_b32 v20, v20, v12, s30 bitop3:0xf6
    v_bitop3_b32 v20, v20, v14, s30 bitop3:0xf6
    v_and_b32 v20, s40, v20
    v_cmp_ne_u32 vcc, 0, v20
    s_cbranch_vccnz cs_spinG
    v_permlane32_swap_b32 v28, v30
    v_permlane32_swap_b32 v29, v31
    v_add_f32 v28, v28, v30
    v_add_f32 v30, v29, v31
    s_cmp_eq_u32 s13, 3
    s_cbranch_scc1 cs_w3
    v_mov_b32 v29, v28
    v_mov_b32 v31, v30
    s_nop 0
    v_permlane16_swap_b32 v28, v29
    v_permlane16_swap_b32 v30, v31
    v_add_f32 v28, v28, v29
    v_add_f32 v30, v30, v31
cs_w3:
    v_cvt_pk_bf16_f32 v28, v28, v30
    s_mov_b64 exec, s[32:33]
    buffer_store_dword v28, v69, s[4:7], s17 offen sc1
    buffer_store_dword v21, v69, s[4:7], s18 offen sc1
    s_mov_b64 exec, -1
    buffer_load_dwordx4 v[24:27], v61, s[4:7], s14 offen sc1
    s_branch cs_loop
cs_w0:
    v_mov_b64 v[0:1], 0
    v_mov_b64 v[2:3], 0
    v_mov_b64 v[4:5], 0
    v_mov_b64 v[6:7], 0
    v_mov_b64 v[8:9], 0
    v_mov_b64 v[10:11], 0
    v_mov_b64 v[12:13], 0
    v_mov_b64 v[14:15], 0
    s_cmp_lg_u32 s28, 10
    s_cbranch_scc1 cs_nokv
    s_lshr_b32 s92, s12, 1
    s_lshl_b32 s92, s92, 8
    s_add_u32 s92, s92, 125833216
    v_bfe_u32 v28, v61, 4, 6
    v_min_u32 v28, 11, v28
    v_lshlrev_b32 v28, 2, v28
    s_add_u32 s93, s95, 63
    s_mov_b32 s94, 4194304
cs_kv1:
    buffer_load_dword v29, v28, s[4:7], s92 offen sc1
    s_sub_u32 s94, s94, 1
    s_cbranch_scc1 cs_kv1_go
    s_waitcnt vmcnt(0)
    v_subrev_u32 v29, s93, v29
    v_cmp_lt_u32 vcc, 64, v29
    s_cbranch_vccz cs_kv1_go
    s_sleep 2
    s_branch cs_kv1
cs_kv1_go:
cs_nokv:
    s_nop 15
    s_nop 15
    s_nop 15
    s_nop 15
    s_nop 15
    s_nop 15
    s_nop 15
    s_nop 15
    s_nop 15
    s_nop 15
    s_nop 15
    s_nop 15
    s_nop 15
    s_nop 15
    s_nop 15
    s_nop 15
    s_nop 15
    s_nop 15
    s_nop 15
    s_nop 15
    s_nop 15
    s_nop 15
    s_nop 15
    s_nop 15
    s_nop 15
    buffer_load_dwordx4 v[24:27], v61, s[4:7], s14 offen sc1
    s_branch cs_loop2
cs_spinF:
    buffer_load_dwordx4 v[40:43], v65, s[4:7], s19 offen offset:0 sc1
    buffer_load_dwordx4 v[44:47], v65, s[4:7], s19 offen offset:1024 sc1
    buffer_load_dwordx4 v[48:51], v65, s[4:7], s19 offen offset:2048 sc1
    buffer_load_dwordx4 v[52:55], v65, s[4:7], s19 offen offset:3072 sc1
    s_sub_u32 s29, s29, 1
    s_cmp_lt_i32 s29, 0
    s_cselect_b32 s40, 0, 1
    s_branch cs_chkF
cs_spinG:
    buffer_load_dwordx4 v[0:3], v65, s[4:7], s19 offen offset:0 sc1
    buffer_load_dwordx4 v[4:7], v65, s[4:7], s19 offen offset:1024 sc1
    buffer_load_dwordx4 v[8:11], v65, s[4:7], s19 offen offset:2048 sc1
    buffer_load_dwordx4 v[12:15], v65, s[4:7], s19 offen offset:3072 sc1
    s_sub_u32 s29, s29, 1
    s_cmp_lt_i32 s29, 0
    s_cselect_b32 s40, 0, 1
    s_branch cs_chkG
cs_guard:
    s_cbranch_scc0 cs_guard2
    buffer_store_dwordx4 v[16:19], v61, s[4:7], s26 offen sc1
    s_add_u32 s26, s26, 131072
    s_add_u32 s40, s95, 63
    v_mov_b32 v5, s40
    s_mov_b64 exec, 1
    buffer_store_dword v5, off, s[4:7], s27 sc1
    s_mov_b64 exec, -1
cs_guard2:
    s_nop 7
    v_max3_f32 v6, v28, v29, v30
    v_max3_f32 v7, v31, v56, v57
    v_max_f32 v6, v6, v7
    s_nop 1
    v_max_f32_dpp v6, v6, v6 row_ror:8 row_mask:0xf bank_mask:0xf
    v_mov_b32 v7, v6
    s_nop 1
    v_permlane32_swap_b32 v6, v7
    v_max_f32 v6, v6, v7
    v_mov_b32 v7, v6
    s_nop 1
    v_permlane16_swap_b32 v6, v7
    v_max_f32 v6, v6, v7
    v_sub_f32 v28, v28, v6
    v_sub_f32 v29, v29, v6
    v_sub_f32 v30, v30, v6
    v_sub_f32 v31, v31, v6
    v_sub_f32 v56, v56, v6
    v_sub_f32 v57, v57, v6
    v_exp_f32 v58, v56
    v_exp_f32 v59, v57
    s_nop 0
    v_cvt_pk_bf16_f32 v6, v58, v59
    s_nop 1
    v_mov_b32_dpp v7, v6 row_ror:8 row_mask:0xf bank_mask:0xf
    v_exp_f32 v0, v28
    s_nop 0
    v_mfma_f32_16x16x16_bf16 v[12:15], v[16:17], v[6:7], 0
    v_exp_f32 v1, v29
    v_exp_f32 v2, v30
    v_cvt_pk_bf16_f32 v8, v0, v1
    v_exp_f32 v3, v31
    v_mfma_f32_16x16x16_bf16 v[20:23], v[18:19], v[6:7], 0
    v_cvt_pk_bf16_f32 v9, v2, v3
    v_mov_b32_dpp v10, v8 row_ror:8 row_mask:0xf bank_mask:0xf
    v_max3_f32 v4, |v28|, |v29|, |v30|
    v_mov_b32_dpp v11, v9 row_ror:8 row_mask:0xf bank_mask:0xf
    v_mfma_f32_16x16x32_bf16 v[0:3], v[24:27], v[6:9], 0
    v_max3_f32 v4, v4, |v31|, |v56|
    v_max_f32_e64 v4, v4, |v57|
    v_mfma_f32_16x16x32_bf16 v[12:15], v[40:43], v[8:11], v[12:15]
    v_cmp_nge_f32 vcc, s46, v4
    v_mfma_f32_16x16x32_bf16 v[20:23], v[44:47], v[8:11], v[20:23]
    v_add_f32_dpp v0, v0, v0 row_ror:8 row_mask:0xf bank_mask:0xf
    v_rcp_f32 v0, v0
    s_nop 4
    s_branch cs_norm
cs_spin0:
    buffer_load_dwordx4 v[24:27], v61, s[4:7], s14 offen sc1
    s_sub_u32 s29, s29, 1
    s_cmp_lt_i32 s29, 0
    s_cbranch_scc0 cs_chk0
    s_waitcnt vmcnt(0)
    v_min_u32 v24, -2, v24
    v_min_u32 v25, -2, v25
    v_min_u32 v26, -2, v26
    v_min_u32 v27, -2, v27
    s_branch cs_chk0
cs_spin1:
    buffer_load_dwordx4 v[28:31], v61, s[4:7], s15 offen sc1
    buffer_load_dword v59, v56, s[4:7], s16 offen sc1
    s_sub_u32 s29, s29, 1
    s_cmp_lt_i32 s29, 0
    s_waitcnt vmcnt(0)
    v_max3_u32 v57, v28, v29, v30
    v_max3_u32 v57, v57, v31, v59
    v_cmp_eq_u32 vcc, -1, v57
    ds_write_b128 v62, v[28:31] offset:45056
    ds_write_b32 v58, v59
    s_waitcnt lgkmcnt(0)
    s_cbranch_scc1 cs_go1
    s_cbranch_vccnz cs_spin1
    s_branch cs_go1
cs_last:
    s_nop 1
    s_cmp_eq_u32 s28, 63
    s_cbranch_scc1 cs_last2
    s_mov_b64 exec, s[34:35]
    buffer_store_dwordx4 v[0:3], v61, s[4:7], s25 offen sc1
    s_mov_b64 exec, -1
    s_add_u32 s25, s25, 131072
    s_mov_b32 s46, 0xbf800000
    s_cmp_eq_u32 0, 0
    s_branch cs_back
cs_last2:
    s_waitcnt lgkmcnt(0)
    s_mov_b64 exec, s[34:35]
    buffer_store_dwordx4 v[0:3], v61, s[4:7], s25 offen sc1
    s_mov_b64 exec, -1
    s_add_u32 s40, s95, 64
    v_mov_b32 v40, s40
    v_smfmac_f32_16x16x64_bf16 v[16:19], v[52:55], a[240:247], v60
    v_smfmac_f32_16x16x64_bf16 v[20:23], v[52:55], a[248:255], v60
    s_nop 3
    v_cvt_pk_bf16_f32 v16, v16, v17
    v_cvt_pk_bf16_f32 v17, v18, v19
    s_nop 1
    v_cvt_pk_bf16_f32 v18, v20, v21
    v_cvt_pk_bf16_f32 v19, v22, v23
    buffer_store_dwordx4 v[16:19], v61, s[4:7], s26 offen sc1
    s_mov_b64 exec, 1
    buffer_store_dword v40, off, s[4:7], s27 sc1
    s_mov_b64 exec, -1
    s_endpgm
cs_dma:
    s_xor_b32 s74, s76, s81
    s_add_u32 m0, s74, s80
    s_add_u32 s76, s76, 4096
    buffer_load_dwordx4 v58, s[8:11], s78 offen lds
    s_add_u32 s78, s78, s79
    s_cmp_lt_u32 s76, s77
    s_cbranch_scc1 cs_dma
    s_setpc_b64 s[82:83]
L_helper:
    s_load_dwordx16 s[64:79], s[0:1], 64
    s_sub_u32 s33, s3, 1
    s_and_b32 s33, s33, 7
L_pool:
    s_lshl_b32 s35, s33, 2
    s_add_u32 s35, s35, 32
    s_mov_b32 s37, s35
    v_mov_b32 v250, 1
    v_mov_b32 v251, 163832
    v_cmp_eq_u32 vcc, 0, v0
    s_nop 0
    s_and_saveexec_b64 s[38:39], vcc
    s_cbranch_execz tk4
    buffer_atomic_add v250, off, s[96:99], s37 sc0
    s_waitcnt vmcnt(0)
    ds_write_b32 v251, v250
    s_waitcnt lgkmcnt(0)
tk4:
    s_mov_b64 exec, -1
    s_barrier
    ds_read_b32 v252, v251
    s_waitcnt lgkmcnt(0)
    v_readfirstlane_b32 s34, v252
    s_barrier
    s_nop 3
    s_mov_b32 s36, s33
    s_or_b32 s33, s34, s32
    s_cmp_lg_u32 s33, 0
    s_cbranch_scc1 L_helper1
    s_memrealtime s[90:91]
    s_waitcnt lgkmcnt(0)
    s_lshl_b32 s90, s90, 8
    s_or_b32 s90, s90, 1
    v_mov_b32 v250, s90
    v_mov_b32 v251, 0
    s_mov_b64 exec, 1
    buffer_atomic_cmpswap v[250:251], off, s[96:99], 0 offset:64
    s_mov_b64 exec, -1
L_helper1:
    s_cmp_ge_u32 s34, 32
    s_cbranch_scc1 L_qkv_next
    s_cmp_ge_u32 s36, 7
    s_cbranch_scc1 L_qkv_next
    s_max_u32 s37, s36, 4
    s_sub_u32 s37, s37, 4
    s_mul_i32 s37, s37, 6
    s_lshl_b32 s38, s36, 1
    s_add_u32 s38, s38, s37
    s_cmp_lt_u32 s36, 4
    s_cselect_b32 s39, 2, 8
    s_mul_i32 s36, s36, 30
    s_sub_u32 s36, s36, s37
    s_cmp_lt_u32 s34, s39
    s_cbranch_scc1 L_copy
    s_add_u32 s36, s36, s34
    s_sub_u32 s36, s36, s39
    s_mul_i32 s37, s36, 171
    s_lshr_b32 s37, s37, 10
    s_mul_i32 s38, s37, 6
    s_sub_u32 s36, s36, s38
    s_lshl_b32 s36, s36, 5
    s_add_u32 s36, s36, s37
    s_branch L_job
L_copy:
    s_add_u32 s36, s38, s34
    s_mul_i32 s36, s36, 11
    s_and_b32 s36, s36, 31
    s_cmp_ge_u32 s36, 27
    s_cbranch_scc1 L_qkv_next
    s_mul_i32 s33, s36, 57
    s_lshr_b32 s33, s33, 9
    s_mul_i32 s37, s33, 9
    s_sub_u32 s37, s36, s37
    s_lshl_b32 s36, s37, 2
    s_add_u32 s36, s36, 1
    s_min_u32 s36, s36, 31
    s_lshr_b32 s39, s52, 8
    s_sub_u32 s36, s36, s39
    s_and_b32 s36, s36, 31
    s_lshl_b32 s36, s36, 8
    s_mov_b32 s14, 4718592
    s_mov_b32 s15, 0x20000
    v_lshrrev_b32 v1, 4, v0
    v_lshlrev_b32 v1, 13, v1
    v_and_b32 v2, 15, v0
    v_lshl_add_u32 v1, v2, 4, v1
    v_lshlrev_b32 v2, 4, v0
    s_mul_i32 s40, s33, 2
    s_mul_i32 s39, s40, 49152
    s_lshl_b32 s41, s37, 19
    s_add_u32 s39, s39, s41
    s_add_u32 s39, s39, 96468992
    s_add_u32 s41, s40, 0
    s_cmp_lt_u32 s41, 3
    s_cselect_b64 s[12:13], s[52:53], s[54:55]
    s_cselect_b32 s42, 0, 3
    s_cmp_ge_u32 s41, 6
    s_cselect_b64 s[12:13], s[56:57], s[12:13]
    s_cselect_b32 s42, 6, s42
    s_sub_u32 s41, s41, s42
    s_mul_i32 s38, s41, 1572864
    s_add_u32 s38, s38, s36
    buffer_load_dwordx4 v[8:11], v1, s[12:15], s38 offen
    s_add_u32 s38, s38, 131072
    buffer_load_dwordx4 v[12:15], v1, s[12:15], s38 offen
    s_add_u32 s38, s38, 131072
    buffer_load_dwordx4 v[16:19], v1, s[12:15], s38 offen
    s_add_u32 s38, s38, 131072
    buffer_load_dwordx4 v[20:23], v1, s[12:15], s38 offen
    s_add_u32 s38, s38, 131072
    buffer_load_dwordx4 v[24:27], v1, s[12:15], s38 offen
    s_add_u32 s38, s38, 131072
    buffer_load_dwordx4 v[28:31], v1, s[12:15], s38 offen
    s_add_u32 s38, s38, 131072
    buffer_load_dwordx4 v[32:35], v1, s[12:15], s38 offen
    s_add_u32 s38, s38, 131072
    buffer_load_dwordx4 v[36:39], v1, s[12:15], s38 offen
    s_add_u32 s38, s38, 131072
    buffer_load_dwordx4 v[40:43], v1, s[12:15], s38 offen
    s_add_u32 s38, s38, 131072
    buffer_load_dwordx4 v[44:47], v1, s[12:15], s38 offen
    s_add_u32 s38, s38, 131072
    buffer_load_dwordx4 v[48:51], v1, s[12:15], s38 offen
    s_add_u32 s38, s38, 131072
    buffer_load_dwordx4 v[52:55], v1, s[12:15], s38 offen
    s_add_u32 s38, s38, 131072
    s_add_u32 s41, s40, 1
    s_cmp_lt_u32 s41, 3
    s_cselect_b64 s[12:13], s[52:53], s[54:55]
    s_cselect_b32 s42, 0, 3
    s_cmp_ge_u32 s41, 6
    s_cselect_b64 s[12:13], s[56:57], s[12:13]
    s_cselect_b32 s42, 6, s42
    s_sub_u32 s41, s41, s42
    s_mul_i32 s38, s41, 1572864
    s_add_u32 s38, s38, s36
    buffer_load_dwordx4 v[56:59], v1, s[12:15], s38 offen
    s_add_u32 s38, s38, 131072
    buffer_load_dwordx4 v[60:63], v1, s[12:15], s38 offen
    s_add_u32 s38, s38, 131072
    buffer_load_dwordx4 v[64:67], v1, s[12:15], s38 offen
    s_add_u32 s38, s38, 131072
    buffer_load_dwordx4 v[68:71], v1, s[12:15], s38 offen
    s_add_u32 s38, s38, 131072
    buffer_load_dwordx4 v[72:75], v1, s[12:15], s38 offen
    s_add_u32 s38, s38, 131072
    buffer_load_dwordx4 v[76:79], v1, s[12:15], s38 offen
    s_add_u32 s38, s38, 131072
    buffer_load_dwordx4 v[80:83], v1, s[12:15], s38 offen
    s_add_u32 s38, s38, 131072
    buffer_load_dwordx4 v[84:87], v1, s[12:15], s38 offen
    s_add_u32 s38, s38, 131072
    buffer_load_dwordx4 v[88:91], v1, s[12:15], s38 offen
    s_add_u32 s38, s38, 131072
    buffer_load_dwordx4 v[92:95], v1, s[12:15], s38 offen
    s_add_u32 s38, s38, 131072
    buffer_load_dwordx4 v[96:99], v1, s[12:15], s38 offen
    s_add_u32 s38, s38, 131072
    buffer_load_dwordx4 v[100:103], v1, s[12:15], s38 offen
    s_add_u32 s38, s38, 131072
    buffer_load_dword v3, off, s[96:99], 0 offset:64 sc1
    s_waitcnt vmcnt(0)
    buffer_store_dwordx4 v[8:11], v2, s[4:7], s39 offen sc1
    s_add_u32 s39, s39, 4096
    buffer_store_dwordx4 v[12:15], v2, s[4:7], s39 offen sc1
    s_add_u32 s39, s39, 4096
    buffer_store_dwordx4 v[16:19], v2, s[4:7], s39 offen sc1
    s_add_u32 s39, s39, 4096
    buffer_store_dwordx4 v[20:23], v2, s[4:7], s39 offen sc1
    s_add_u32 s39, s39, 4096
    buffer_store_dwordx4 v[24:27], v2, s[4:7], s39 offen sc1
    s_add_u32 s39, s39, 4096
    buffer_store_dwordx4 v[28:31], v2, s[4:7], s39 offen sc1
    s_add_u32 s39, s39, 4096
    buffer_store_dwordx4 v[32:35], v2, s[4:7], s39 offen sc1
    s_add_u32 s39, s39, 4096
    buffer_store_dwordx4 v[36:39], v2, s[4:7], s39 offen sc1
    s_add_u32 s39, s39, 4096
    buffer_store_dwordx4 v[40:43], v2, s[4:7], s39 offen sc1
    s_add_u32 s39, s39, 4096
    buffer_store_dwordx4 v[44:47], v2, s[4:7], s39 offen sc1
    s_add_u32 s39, s39, 4096
    buffer_store_dwordx4 v[48:51], v2, s[4:7], s39 offen sc1
    s_add_u32 s39, s39, 4096
    buffer_store_dwordx4 v[52:55], v2, s[4:7], s39 offen sc1
    s_add_u32 s39, s39, 4096
    buffer_store_dwordx4 v[56:59], v2, s[4:7], s39 offen sc1
    s_add_u32 s39, s39, 4096
    buffer_store_dwordx4 v[60:63], v2, s[4:7], s39 offen sc1
    s_add_u32 s39, s39, 4096
    buffer_store_dwordx4 v[64:67], v2, s[4:7], s39 offen sc1
    s_add_u32 s39, s39, 4096
    buffer_store_dwordx4 v[68:71], v2, s[4:7], s39 offen sc1
    s_add_u32 s39, s39, 4096
    buffer_store_dwordx4 v[72:75], v2, s[4:7], s39 offen sc1
    s_add_u32 s39, s39, 4096
    buffer_store_dwordx4 v[76:79], v2, s[4:7], s39 offen sc1
    s_add_u32 s39, s39, 4096
    buffer_store_dwordx4 v[80:83], v2, s[4:7], s39 offen sc1
    s_add_u32 s39, s39, 4096
    buffer_store_dwordx4 v[84:87], v2, s[4:7], s39 offen sc1
    s_add_u32 s39, s39, 4096
    buffer_store_dwordx4 v[88:91], v2, s[4:7], s39 offen sc1
    s_add_u32 s39, s39, 4096
    buffer_store_dwordx4 v[92:95], v2, s[4:7], s39 offen sc1
    s_add_u32 s39, s39, 4096
    buffer_store_dwordx4 v[96:99], v2, s[4:7], s39 offen sc1
    s_add_u32 s39, s39, 4096
    buffer_store_dwordx4 v[100:103], v2, s[4:7], s39 offen sc1
    s_add_u32 s39, s39, 4096
    v_readfirstlane_b32 s95, v3
    s_nop 4
    s_mov_b32 s88, 4194304
gn5:
    s_cmp_lg_u32 s95, 0
    s_cbranch_scc1 gn5x
    buffer_load_dword v3, off, s[96:99], 0 offset:64 sc1
    s_sub_u32 s88, s88, 1
    s_cbranch_scc1 gn5x
    s_waitcnt vmcnt(0)
    v_readfirstlane_b32 s95, v3
    s_nop 1
    s_branch gn5
gn5x:
    s_lshl_b32 s37, s37, 7
    s_lshl_b32 s36, s33, 2
    s_add_u32 s36, s36, s32
    s_lshl_b32 s36, s36, 2
    s_add_u32 s37, s37, s36
    s_add_u32 s37, s37, 125853696
    v_mov_b32 v3, s95
    s_waitcnt vmcnt(0)
    s_mov_b64 exec, 1
    buffer_store_dword v3, off, s[4:7], s37 sc1
    s_mov_b64 exec, -1
L_qkv_next:
    s_mov_b32 s37, 4
    v_mov_b32 v250, 1
    v_mov_b32 v251, 163832
    v_cmp_eq_u32 vcc, 0, v0
    s_nop 0
    s_and_saveexec_b64 s[38:39], vcc
    s_cbranch_execz tk6
    buffer_atomic_add v250, off, s[96:99], s37 sc0
    s_waitcnt vmcnt(0)
    ds_write_b32 v251, v250
    s_waitcnt lgkmcnt(0)
tk6:
    s_mov_b64 exec, -1
    s_barrier
    ds_read_b32 v252, v251
    s_waitcnt lgkmcnt(0)
    v_readfirstlane_b32 s36, v252
    s_barrier
    s_nop 3
    s_add_u32 s36, s36, 192
    s_cmp_ge_u32 s36, 320
    s_cbranch_scc1 L_ssm_next
L_job:
    s_and_b32 s17, s36, 15
    s_lshl_b32 s17, s17, 1
    s_bfe_u32 s16, s36, 0x10004
    s_lshr_b32 s19, s36, 5
    s_mul_i32 s33, s16, 6
    s_add_u32 s33, s33, s19
    s_add_u32 s16, s16, 1
    s_lshr_b32 s37, s36, 4
    s_sub_u32 s38, s37, 12
    s_cmp_ge_u32 s36, 192
    s_cselect_b32 s16, 0, s16
    s_cselect_b32 s19, s38, s19
    s_cselect_b32 s33, s37, s33
    s_cselect_b32 s20, 8, 6
    v_lshrrev_b32 v4, 6, v0
    s_nop 0
    v_readfirstlane_b32 s18, v4
    v_lshlrev_b32 v7, 4, v0
    v_and_b32 v4, 63, v0
    v_lshrrev_b32 v6, 2, v4
    v_lshlrev_b32 v6, 13, v6
    v_lshrrev_b32 v5, 4, v4
    v_and_b32 v5, 2, v5
    v_xor_b32 v5, v5, v4
    v_and_b32 v5, 3, v5
    v_lshl_add_u32 v6, v5, 4, v6
    v_lshrrev_b32 v24, 4, v4
    v_lshlrev_b32 v24, 9, v24
    v_bfe_u32 v5, v4, 2, 2
    v_lshl_add_u32 v24, v5, 6, v24
    v_bfe_u32 v5, v4, 4, 1
    v_lshl_add_u32 v24, v5, 5, v24
    v_and_b32 v5, 3, v4
    v_lshl_add_u32 v24, v5, 3, v24
    s_lshl_b32 s31, s18, 12
    v_add_u32 v24, s31, v24
    s_cmp_eq_u32 s16, 1
    s_cselect_b64 s[12:13], s[54:55], s[52:53]
    s_cmp_eq_u32 s16, 2
    s_cselect_b64 s[12:13], s[56:57], s[12:13]
    s_mov_b32 s14, 4718592
    s_mov_b32 s15, 0x20000
    s_lshl_b32 s28, s17, 8
    s_lshl_b32 s21, s18, 6
    s_add_u32 s28, s28, s21
    s_add_u32 s21, s28, 0
    s_add_u32 m0, s31, 40960
    s_nop 0
    buffer_load_dwordx4 v6, s[12:15], s21 offen lds
    s_add_u32 m0, s31, 41984
    s_add_u32 s21, s21, 131072
    buffer_load_dwordx4 v6, s[12:15], s21 offen lds
    s_add_u32 m0, s31, 43008
    s_add_u32 s21, s21, 131072
    buffer_load_dwordx4 v6, s[12:15], s21 offen lds
    s_add_u32 m0, s31, 44032
    s_add_u32 s21, s21, 131072
    buffer_load_dwordx4 v6, s[12:15], s21 offen lds
    s_add_u32 s21, s28, 256
    s_add_u32 m0, s31, 57344
    s_nop 0
    buffer_load_dwordx4 v6, s[12:15], s21 offen lds
    s_add_u32 m0, s31, 58368
    s_add_u32 s21, s21, 131072
    buffer_load_dwordx4 v6, s[12:15], s21 offen lds
    s_add_u32 m0, s31, 59392
    s_add_u32 s21, s21, 131072
    buffer_load_dwordx4 v6, s[12:15], s21 offen lds
    s_add_u32 m0, s31, 60416
    s_add_u32 s21, s21, 131072
    buffer_load_dwordx4 v6, s[12:15], s21 offen lds
    s_add_u32 s21, s28, 524288
    s_add_u32 m0, s31, 73728
    s_nop 0
    buffer_load_dwordx4 v6, s[12:15], s21 offen lds
    s_add_u32 m0, s31, 74752
    s_add_u32 s21, s21, 131072
    buffer_load_dwordx4 v6, s[12:15], s21 offen lds
    s_add_u32 m0, s31, 75776
    s_add_u32 s21, s21, 131072
    buffer_load_dwordx4 v6, s[12:15], s21 offen lds
    s_add_u32 m0, s31, 76800
    s_add_u32 s21, s21, 131072
    buffer_load_dwordx4 v6, s[12:15], s21 offen lds
    s_add_u32 s21, s28, 524544
    s_add_u32 m0, s31, 90112
    s_nop 0
    buffer_load_dwordx4 v6, s[12:15], s21 offen lds
    s_add_u32 m0, s31, 91136
    s_add_u32 s21, s21, 131072
    buffer_load_dwordx4 v6, s[12:15], s21 offen lds
    s_add_u32 m0, s31, 92160
    s_add_u32 s21, s21, 131072
    buffer_load_dwordx4 v6, s[12:15], s21 offen lds
    s_add_u32 m0, s31, 93184
    s_add_u32 s21, s21, 131072
    buffer_load_dwordx4 v6, s[12:15], s21 offen lds
    s_add_u32 s21, s28, 1048576
    s_add_u32 m0, s31, 106496
    s_nop 0
    buffer_load_dwordx4 v6, s[12:15], s21 offen lds
    s_add_u32 m0, s31, 107520
    s_add_u32 s21, s21, 131072
    buffer_load_dwordx4 v6, s[12:15], s21 offen lds
    s_add_u32 m0, s31, 108544
    s_add_u32 s21, s21, 131072
    buffer_load_dwordx4 v6, s[12:15], s21 offen lds
    s_add_u32 m0, s31, 109568
    s_add_u32 s21, s21, 131072
    buffer_load_dwordx4 v6, s[12:15], s21 offen lds
    s_add_u32 s21, s28, 1048832
    s_add_u32 m0, s31, 122880
    s_nop 0
    buffer_load_dwordx4 v6, s[12:15], s21 offen lds
    s_add_u32 m0, s31, 123904
    s_add_u32 s21, s21, 131072
    buffer_load_dwordx4 v6, s[12:15], s21 offen lds
    s_add_u32 m0, s31, 124928
    s_add_u32 s21, s21, 131072
    buffer_load_dwordx4 v6, s[12:15], s21 offen lds
    s_add_u32 m0, s31, 125952
    s_add_u32 s21, s21, 131072
    buffer_load_dwordx4 v6, s[12:15], s21 offen lds
    s_add_u32 s21, s28, 1572864
    s_add_u32 m0, s31, 139264
    s_nop 0
    buffer_load_dwordx4 v6, s[12:15], s21 offen lds
    s_add_u32 m0, s31, 140288
    s_add_u32 s21, s21, 131072
    buffer_load_dwordx4 v6, s[12:15], s21 offen lds
    s_add_u32 m0, s31, 141312
    s_add_u32 s21, s21, 131072
    buffer_load_dwordx4 v6, s[12:15], s21 offen lds
    s_add_u32 m0, s31, 142336
    s_add_u32 s21, s21, 131072
    buffer_load_dwordx4 v6, s[12:15], s21 offen lds
    v_and_b32 v5, 15, v4
    v_lshrrev_b32 v3, 4, v4
    v_lshrrev_b32 v2, 2, v5
    v_xor_b32 v3, v3, v2
    v_lshl_add_u32 v3, v5, 2, v3
    v_lshlrev_b32 v1, 4, v3
    v_lshrrev_b32 v5, 2, v4
    v_lshrrev_b32 v3, 4, v4
    v_and_b32 v4, 3, v4
    v_xor_b32 v4, v4, v3
    v_lshlrev_b32 v3, 3, v3
    v_and_b32 v5, 3, v5
    v_add_u32 v3, v3, v5
    v_mul_u32_u24 v2, 1152, v3
    v_lshl_add_u32 v2, v4, 4, v2
    s_mov_b32 s8, s48
    s_mov_b32 s9, s49
    s_mov_b32 s10, 2359296
    s_mov_b32 s11, 0x20000
    s_lshr_b32 s22, s18, 1
    s_mul_i32 s24, s22, 4608
    s_and_b32 s22, s18, 1
    s_mul_i32 s23, s22, 576
    s_add_u32 s24, s24, s23
    s_mul_i32 s25, s18, 9216
    s_mul_i32 s22, s19, 36864
    s_add_u32 s24, s24, s22
    s_mul_i32 s42, s20, 36864
    s_mov_b32 s27, 0
    s_add_u32 s23, s27, s25
    s_add_u32 m0, s23, 0
    s_nop 0
    buffer_load_dwordx4 v2, s[8:11], s24 offen offset:0 lds
    s_add_u32 m0, s23, 960
    s_nop 0
    buffer_load_dwordx4 v2, s[8:11], s24 offen offset:64 lds
    s_add_u32 m0, s23, 1920
    s_nop 0
    buffer_load_dwordx4 v2, s[8:11], s24 offen offset:128 lds
    s_add_u32 m0, s23, 2880
    s_nop 0
    buffer_load_dwordx4 v2, s[8:11], s24 offen offset:192 lds
    s_add_u32 m0, s23, 3840
    s_nop 0
    buffer_load_dwordx4 v2, s[8:11], s24 offen offset:256 lds
    s_add_u32 m0, s23, 4800
    s_nop 0
    buffer_load_dwordx4 v2, s[8:11], s24 offen offset:320 lds
    s_add_u32 m0, s23, 5760
    s_nop 0
    buffer_load_dwordx4 v2, s[8:11], s24 offen offset:384 lds
    s_add_u32 m0, s23, 6720
    s_nop 0
    buffer_load_dwordx4 v2, s[8:11], s24 offen offset:448 lds
    s_add_u32 m0, s23, 7680
    s_nop 0
    buffer_load_dwordx4 v2, s[8:11], s24 offen offset:512 lds
    s_add_u32 s24, s24, s42
    s_lshl_b32 s22, s19, 5
    s_add_u32 s22, s22, s17
    s_lshl_b32 s26, s22, 14
    s_mul_i32 s23, s18, 3072
    s_add_u32 s26, s26, s23
    s_lshl_b32 s23, s16, 11
    s_add_u32 s26, s26, s23
    s_add_u32 s26, s26, -2048
    s_lshl_b32 s22, s22, 13
    s_add_u32 s22, s22, 33554432
    s_cmp_eq_u32 s16, 0
    s_cselect_b32 s26, s22, s26
    s_cselect_b32 s40, 4, 1
    s_cselect_b32 s43, 1, 2
    s_lshl_b32 s40, s40, 10
    s_lshl_b32 s43, s43, 13
    s_lshl_b32 s41, s43, 5
    s_mul_i32 s41, s41, s20
    s_lshl_b32 s29, s17, 7
    s_lshl_b32 s22, s33, 2
    s_add_u32 s29, s29, s22
    s_add_u32 s29, s29, 125829120
    v_add_u32 v25, 40960, v24
    v_xor_b32 v26, 32, v25
    s_waitcnt vmcnt(33)
    ds_read_b64_tr_b16 v[64:65], v25 offset:0
    ds_read_b64_tr_b16 v[66:67], v25 offset:256
    ds_read_b64_tr_b16 v[136:137], v26 offset:0
    ds_read_b64_tr_b16 v[138:139], v26 offset:256
    ds_read_b64_tr_b16 v[68:69], v25 offset:2048
    ds_read_b64_tr_b16 v[70:71], v25 offset:2304
    ds_read_b64_tr_b16 v[140:141], v26 offset:2048
    ds_read_b64_tr_b16 v[142:143], v26 offset:2304
    s_waitcnt lgkmcnt(0)
    s_add_u32 s21, s28, 1573120
    s_add_u32 m0, s31, 40960
    s_nop 0
    buffer_load_dwordx4 v6, s[12:15], s21 offen lds
    s_add_u32 m0, s31, 41984
    s_add_u32 s21, s21, 131072
    buffer_load_dwordx4 v6, s[12:15], s21 offen lds
    s_add_u32 m0, s31, 43008
    s_add_u32 s21, s21, 131072
    buffer_load_dwordx4 v6, s[12:15], s21 offen lds
    s_add_u32 m0, s31, 44032
    s_add_u32 s21, s21, 131072
    buffer_load_dwordx4 v6, s[12:15], s21 offen lds
    v_add_u32 v25, 57344, v24
    v_xor_b32 v26, 32, v25
    s_waitcnt vmcnt(33)
    ds_read_b64_tr_b16 a[0:1], v25 offset:0
    ds_read_b64_tr_b16 a[2:3], v25 offset:256
    ds_read_b64_tr_b16 a[72:73], v26 offset:0
    ds_read_b64_tr_b16 a[74:75], v26 offset:256
    ds_read_b64_tr_b16 a[4:5], v25 offset:2048
    ds_read_b64_tr_b16 a[6:7], v25 offset:2304
    ds_read_b64_tr_b16 a[76:77], v26 offset:2048
    ds_read_b64_tr_b16 a[78:79], v26 offset:2304
    s_waitcnt lgkmcnt(0)
    s_add_u32 s21, s28, 2097152
    s_add_u32 m0, s31, 57344
    s_nop 0
    buffer_load_dwordx4 v6, s[12:15], s21 offen lds
    s_add_u32 m0, s31, 58368
    s_add_u32 s21, s21, 131072
    buffer_load_dwordx4 v6, s[12:15], s21 offen lds
    s_add_u32 m0, s31, 59392
    s_add_u32 s21, s21, 131072
    buffer_load_dwordx4 v6, s[12:15], s21 offen lds
    s_add_u32 m0, s31, 60416
    s_add_u32 s21, s21, 131072
    buffer_load_dwordx4 v6, s[12:15], s21 offen lds
    v_add_u32 v25, 73728, v24
    v_xor_b32 v26, 32, v25
    s_waitcnt vmcnt(33)
    ds_read_b64_tr_b16 v[72:73], v25 offset:0
    ds_read_b64_tr_b16 v[74:75], v25 offset:256
    ds_read_b64_tr_b16 v[144:145], v26 offset:0
    ds_read_b64_tr_b16 v[146:147], v26 offset:256
    ds_read_b64_tr_b16 v[76:77], v25 offset:2048
    ds_read_b64_tr_b16 v[78:79], v25 offset:2304
    ds_read_b64_tr_b16 v[148:149], v26 offset:2048
    ds_read_b64_tr_b16 v[150:151], v26 offset:2304
    s_waitcnt lgkmcnt(0)
    s_add_u32 s21, s28, 2097408
    s_add_u32 m0, s31, 73728
    s_nop 0
    buffer_load_dwordx4 v6, s[12:15], s21 offen lds
    s_add_u32 m0, s31, 74752
    s_add_u32 s21, s21, 131072
    buffer_load_dwordx4 v6, s[12:15], s21 offen lds
    s_add_u32 m0, s31, 75776
    s_add_u32 s21, s21, 131072
    buffer_load_dwordx4 v6, s[12:15], s21 offen lds
    s_add_u32 m0, s31, 76800
    s_add_u32 s21, s21, 131072
    buffer_load_dwordx4 v6, s[12:15], s21 offen lds
    v_add_u32 v25, 90112, v24
    v_xor_b32 v26, 32, v25
    s_waitcnt vmcnt(33)
    ds_read_b64_tr_b16 a[8:9], v25 offset:0
    ds_read_b64_tr_b16 a[10:11], v25 offset:256
    ds_read_b64_tr_b16 a[80:81], v26 offset:0
    ds_read_b64_tr_b16 a[82:83], v26 offset:256
    ds_read_b64_tr_b16 a[12:13], v25 offset:2048
    ds_read_b64_tr_b16 a[14:15], v25 offset:2304
    ds_read_b64_tr_b16 a[84:85], v26 offset:2048
    ds_read_b64_tr_b16 a[86:87], v26 offset:2304
    s_waitcnt lgkmcnt(0)
    s_add_u32 s21, s28, 2621440
    s_add_u32 m0, s31, 90112
    s_nop 0
    buffer_load_dwordx4 v6, s[12:15], s21 offen lds
    s_add_u32 m0, s31, 91136
    s_add_u32 s21, s21, 131072
    buffer_load_dwordx4 v6, s[12:15], s21 offen lds
    s_add_u32 m0, s31, 92160
    s_add_u32 s21, s21, 131072
    buffer_load_dwordx4 v6, s[12:15], s21 offen lds
    s_add_u32 m0, s31, 93184
    s_add_u32 s21, s21, 131072
    buffer_load_dwordx4 v6, s[12:15], s21 offen lds
    v_add_u32 v25, 106496, v24
    v_xor_b32 v26, 32, v25
    s_waitcnt vmcnt(33)
    ds_read_b64_tr_b16 v[80:81], v25 offset:0
    ds_read_b64_tr_b16 v[82:83], v25 offset:256
    ds_read_b64_tr_b16 v[152:153], v26 offset:0
    ds_read_b64_tr_b16 v[154:155], v26 offset:256
    ds_read_b64_tr_b16 v[84:85], v25 offset:2048
    ds_read_b64_tr_b16 v[86:87], v25 offset:2304
    ds_read_b64_tr_b16 v[156:157], v26 offset:2048
    ds_read_b64_tr_b16 v[158:159], v26 offset:2304
    s_waitcnt lgkmcnt(0)
    s_add_u32 s21, s28, 2621696
    s_add_u32 m0, s31, 106496
    s_nop 0
    buffer_load_dwordx4 v6, s[12:15], s21 offen lds
    s_add_u32 m0, s31, 107520
    s_add_u32 s21, s21, 131072
    buffer_load_dwordx4 v6, s[12:15], s21 offen lds
    s_add_u32 m0, s31, 108544
    s_add_u32 s21, s21, 131072
    buffer_load_dwordx4 v6, s[12:15], s21 offen lds
    s_add_u32 m0, s31, 109568
    s_add_u32 s21, s21, 131072
    buffer_load_dwordx4 v6, s[12:15], s21 offen lds
    v_add_u32 v25, 122880, v24
    v_xor_b32 v26, 32, v25
    s_waitcnt vmcnt(33)
    ds_read_b64_tr_b16 a[16:17], v25 offset:0
    ds_read_b64_tr_b16 a[18:19], v25 offset:256
    ds_read_b64_tr_b16 a[88:89], v26 offset:0
    ds_read_b64_tr_b16 a[90:91], v26 offset:256
    ds_read_b64_tr_b16 a[20:21], v25 offset:2048
    ds_read_b64_tr_b16 a[22:23], v25 offset:2304
    ds_read_b64_tr_b16 a[92:93], v26 offset:2048
    ds_read_b64_tr_b16 a[94:95], v26 offset:2304
    s_waitcnt lgkmcnt(0)
    s_add_u32 s21, s28, 3145728
    s_add_u32 m0, s31, 122880
    s_nop 0
    buffer_load_dwordx4 v6, s[12:15], s21 offen lds
    s_add_u32 m0, s31, 123904
    s_add_u32 s21, s21, 131072
    buffer_load_dwordx4 v6, s[12:15], s21 offen lds
    s_add_u32 m0, s31, 124928
    s_add_u32 s21, s21, 131072
    buffer_load_dwordx4 v6, s[12:15], s21 offen lds
    s_add_u32 m0, s31, 125952
    s_add_u32 s21, s21, 131072
    buffer_load_dwordx4 v6, s[12:15], s21 offen lds
    v_add_u32 v25, 139264, v24
    v_xor_b32 v26, 32, v25
    s_waitcnt vmcnt(33)
    ds_read_b64_tr_b16 v[88:89], v25 offset:0
    ds_read_b64_tr_b16 v[90:91], v25 offset:256
    ds_read_b64_tr_b16 v[160:161], v26 offset:0
    ds_read_b64_tr_b16 v[162:163], v26 offset:256
    ds_read_b64_tr_b16 v[92:93], v25 offset:2048
    ds_read_b64_tr_b16 v[94:95], v25 offset:2304
    ds_read_b64_tr_b16 v[164:165], v26 offset:2048
    ds_read_b64_tr_b16 v[166:167], v26 offset:2304
    s_waitcnt lgkmcnt(0)
    s_add_u32 s21, s28, 3145984
    s_add_u32 m0, s31, 139264
    s_nop 0
    buffer_load_dwordx4 v6, s[12:15], s21 offen lds
    s_add_u32 m0, s31, 140288
    s_add_u32 s21, s21, 131072
    buffer_load_dwordx4 v6, s[12:15], s21 offen lds
    s_add_u32 m0, s31, 141312
    s_add_u32 s21, s21, 131072
    buffer_load_dwordx4 v6, s[12:15], s21 offen lds
    s_add_u32 m0, s31, 142336
    s_add_u32 s21, s21, 131072
    buffer_load_dwordx4 v6, s[12:15], s21 offen lds
    v_add_u32 v25, 40960, v24
    v_xor_b32 v26, 32, v25
    s_waitcnt vmcnt(24)
    ds_read_b64_tr_b16 a[24:25], v25 offset:0
    ds_read_b64_tr_b16 a[26:27], v25 offset:256
    ds_read_b64_tr_b16 a[96:97], v26 offset:0
    ds_read_b64_tr_b16 a[98:99], v26 offset:256
    ds_read_b64_tr_b16 a[28:29], v25 offset:2048
    ds_read_b64_tr_b16 a[30:31], v25 offset:2304
    ds_read_b64_tr_b16 a[100:101], v26 offset:2048
    ds_read_b64_tr_b16 a[102:103], v26 offset:2304
    s_waitcnt lgkmcnt(0)
    s_add_u32 s21, s28, 3670016
    s_add_u32 m0, s31, 40960
    s_nop 0
    buffer_load_dwordx4 v6, s[12:15], s21 offen lds
    s_add_u32 m0, s31, 41984
    s_add_u32 s21, s21, 131072
    buffer_load_dwordx4 v6, s[12:15], s21 offen lds
    s_add_u32 m0, s31, 43008
    s_add_u32 s21, s21, 131072
    buffer_load_dwordx4 v6, s[12:15], s21 offen lds
    s_add_u32 m0, s31, 44032
    s_add_u32 s21, s21, 131072
    buffer_load_dwordx4 v6, s[12:15], s21 offen lds
    v_add_u32 v25, 57344, v24
    v_xor_b32 v26, 32, v25
    s_waitcnt vmcnt(24)
    ds_read_b64_tr_b16 v[96:97], v25 offset:0
    ds_read_b64_tr_b16 v[98:99], v25 offset:256
    ds_read_b64_tr_b16 v[168:169], v26 offset:0
    ds_read_b64_tr_b16 v[170:171], v26 offset:256
    ds_read_b64_tr_b16 v[100:101], v25 offset:2048
    ds_read_b64_tr_b16 v[102:103], v25 offset:2304
    ds_read_b64_tr_b16 v[172:173], v26 offset:2048
    ds_read_b64_tr_b16 v[174:175], v26 offset:2304
    s_waitcnt lgkmcnt(0)
    s_add_u32 s21, s28, 3670272
    s_add_u32 m0, s31, 57344
    s_nop 0
    buffer_load_dwordx4 v6, s[12:15], s21 offen lds
    s_add_u32 m0, s31, 58368
    s_add_u32 s21, s21, 131072
    buffer_load_dwordx4 v6, s[12:15], s21 offen lds
    s_add_u32 m0, s31, 59392
    s_add_u32 s21, s21, 131072
    buffer_load_dwordx4 v6, s[12:15], s21 offen lds
    s_add_u32 m0, s31, 60416
    s_add_u32 s21, s21, 131072
    buffer_load_dwordx4 v6, s[12:15], s21 offen lds
    v_add_u32 v25, 73728, v24
    v_xor_b32 v26, 32, v25
    s_waitcnt vmcnt(24)
    ds_read_b64_tr_b16 a[32:33], v25 offset:0
    ds_read_b64_tr_b16 a[34:35], v25 offset:256
    ds_read_b64_tr_b16 a[104:105], v26 offset:0
    ds_read_b64_tr_b16 a[106:107], v26 offset:256
    ds_read_b64_tr_b16 a[36:37], v25 offset:2048
    ds_read_b64_tr_b16 a[38:39], v25 offset:2304
    ds_read_b64_tr_b16 a[108:109], v26 offset:2048
    ds_read_b64_tr_b16 a[110:111], v26 offset:2304
    s_waitcnt lgkmcnt(0)
    s_add_u32 s21, s28, 4194304
    s_add_u32 m0, s31, 73728
    s_nop 0
    buffer_load_dwordx4 v6, s[12:15], s21 offen lds
    s_add_u32 m0, s31, 74752
    s_add_u32 s21, s21, 131072
    buffer_load_dwordx4 v6, s[12:15], s21 offen lds
    s_add_u32 m0, s31, 75776
    s_add_u32 s21, s21, 131072
    buffer_load_dwordx4 v6, s[12:15], s21 offen lds
    s_add_u32 m0, s31, 76800
    s_add_u32 s21, s21, 131072
    buffer_load_dwordx4 v6, s[12:15], s21 offen lds
    v_add_u32 v25, 90112, v24
    v_xor_b32 v26, 32, v25
    s_waitcnt vmcnt(24)
    ds_read_b64_tr_b16 v[104:105], v25 offset:0
    ds_read_b64_tr_b16 v[106:107], v25 offset:256
    ds_read_b64_tr_b16 v[176:177], v26 offset:0
    ds_read_b64_tr_b16 v[178:179], v26 offset:256
    ds_read_b64_tr_b16 v[108:109], v25 offset:2048
    ds_read_b64_tr_b16 v[110:111], v25 offset:2304
    ds_read_b64_tr_b16 v[180:181], v26 offset:2048
    ds_read_b64_tr_b16 v[182:183], v26 offset:2304
    s_waitcnt lgkmcnt(0)
    v_mov_b32 v28, s95
    s_cmp_lg_u32 s95, 0
    s_cbranch_scc1 L_ne
    buffer_load_dword v28, off, s[96:99], 0 offset:64 sc1
    s_cmp_ge_u32 s36, 192
    s_cbranch_scc1 L_ne
    s_mul_i32 s37, s36, 24576
    s_mov_b32 s46, 4718592
    s_mov_b32 s47, 0x20000
    v_lshlrev_b32 v29, 7, v0
    v_min_u32 v29, 24448, v29
    s_mov_b64 s[44:45], s[58:59]
    buffer_load_dword v30, v29, s[44:47], s37 offen
    s_mov_b64 s[44:45], s[52:53]
    buffer_load_dword v30, v29, s[44:47], s37 offen
L_ne:
    s_add_u32 s21, s28, 4194560
    s_add_u32 m0, s31, 90112
    s_nop 0
    buffer_load_dwordx4 v6, s[12:15], s21 offen lds
    s_add_u32 m0, s31, 91136
    s_add_u32 s21, s21, 131072
    buffer_load_dwordx4 v6, s[12:15], s21 offen lds
    s_add_u32 m0, s31, 92160
    s_add_u32 s21, s21, 131072
    buffer_load_dwordx4 v6, s[12:15], s21 offen lds
    s_add_u32 m0, s31, 93184
    s_add_u32 s21, s21, 131072
    buffer_load_dwordx4 v6, s[12:15], s21 offen lds
    v_add_u32 v25, 106496, v24
    v_xor_b32 v26, 32, v25
    s_waitcnt vmcnt(24)
    ds_read_b64_tr_b16 a[40:41], v25 offset:0
    ds_read_b64_tr_b16 a[42:43], v25 offset:256
    ds_read_b64_tr_b16 a[112:113], v26 offset:0
    ds_read_b64_tr_b16 a[114:115], v26 offset:256
    ds_read_b64_tr_b16 a[44:45], v25 offset:2048
    ds_read_b64_tr_b16 a[46:47], v25 offset:2304
    ds_read_b64_tr_b16 a[116:117], v26 offset:2048
    ds_read_b64_tr_b16 a[118:119], v26 offset:2304
    s_waitcnt lgkmcnt(0)
    v_add_u32 v25, 122880, v24
    v_xor_b32 v26, 32, v25
    s_waitcnt vmcnt(20)
    ds_read_b64_tr_b16 v[112:113], v25 offset:0
    ds_read_b64_tr_b16 v[114:115], v25 offset:256
    ds_read_b64_tr_b16 v[184:185], v26 offset:0
    ds_read_b64_tr_b16 v[186:187], v26 offset:256
    ds_read_b64_tr_b16 v[116:117], v25 offset:2048
    ds_read_b64_tr_b16 v[118:119], v25 offset:2304
    ds_read_b64_tr_b16 v[188:189], v26 offset:2048
    ds_read_b64_tr_b16 v[190:191], v26 offset:2304
    s_waitcnt lgkmcnt(0)
    v_add_u32 v25, 139264, v24
    v_xor_b32 v26, 32, v25
    s_waitcnt vmcnt(16)
    ds_read_b64_tr_b16 a[48:49], v25 offset:0
    ds_read_b64_tr_b16 a[50:51], v25 offset:256
    ds_read_b64_tr_b16 a[120:121], v26 offset:0
    ds_read_b64_tr_b16 a[122:123], v26 offset:256
    ds_read_b64_tr_b16 a[52:53], v25 offset:2048
    ds_read_b64_tr_b16 a[54:55], v25 offset:2304
    ds_read_b64_tr_b16 a[124:125], v26 offset:2048
    ds_read_b64_tr_b16 a[126:127], v26 offset:2304
    s_waitcnt lgkmcnt(0)
    v_add_u32 v25, 40960, v24
    v_xor_b32 v26, 32, v25
    s_waitcnt vmcnt(12)
    ds_read_b64_tr_b16 v[120:121], v25 offset:0
    ds_read_b64_tr_b16 v[122:123], v25 offset:256
    ds_read_b64_tr_b16 v[192:193], v26 offset:0
    ds_read_b64_tr_b16 v[194:195], v26 offset:256
    ds_read_b64_tr_b16 v[124:125], v25 offset:2048
    ds_read_b64_tr_b16 v[126:127], v25 offset:2304
    ds_read_b64_tr_b16 v[196:197], v26 offset:2048
    ds_read_b64_tr_b16 v[198:199], v26 offset:2304
    s_waitcnt lgkmcnt(0)
    v_add_u32 v25, 57344, v24
    v_xor_b32 v26, 32, v25
    s_waitcnt vmcnt(8)
    ds_read_b64_tr_b16 a[56:57], v25 offset:0
    ds_read_b64_tr_b16 a[58:59], v25 offset:256
    ds_read_b64_tr_b16 a[128:129], v26 offset:0
    ds_read_b64_tr_b16 a[130:131], v26 offset:256
    ds_read_b64_tr_b16 a[60:61], v25 offset:2048
    ds_read_b64_tr_b16 a[62:63], v25 offset:2304
    ds_read_b64_tr_b16 a[132:133], v26 offset:2048
    ds_read_b64_tr_b16 a[134:135], v26 offset:2304
    s_waitcnt lgkmcnt(0)
    v_add_u32 v25, 73728, v24
    v_xor_b32 v26, 32, v25
    s_waitcnt vmcnt(4)
    ds_read_b64_tr_b16 v[128:129], v25 offset:0
    ds_read_b64_tr_b16 v[130:131], v25 offset:256
    ds_read_b64_tr_b16 v[200:201], v26 offset:0
    ds_read_b64_tr_b16 v[202:203], v26 offset:256
    ds_read_b64_tr_b16 v[132:133], v25 offset:2048
    ds_read_b64_tr_b16 v[134:135], v25 offset:2304
    ds_read_b64_tr_b16 v[204:205], v26 offset:2048
    ds_read_b64_tr_b16 v[206:207], v26 offset:2304
    s_waitcnt lgkmcnt(0)
    v_add_u32 v25, 90112, v24
    v_xor_b32 v26, 32, v25
    s_waitcnt vmcnt(0)
    ds_read_b64_tr_b16 a[64:65], v25 offset:0
    ds_read_b64_tr_b16 a[66:67], v25 offset:256
    ds_read_b64_tr_b16 a[136:137], v26 offset:0
    ds_read_b64_tr_b16 a[138:139], v26 offset:256
    ds_read_b64_tr_b16 a[68:69], v25 offset:2048
    ds_read_b64_tr_b16 a[70:71], v25 offset:2304
    ds_read_b64_tr_b16 a[140:141], v26 offset:2048
    ds_read_b64_tr_b16 a[142:143], v26 offset:2304
    s_waitcnt lgkmcnt(0)
    s_lshr_b32 s21, s17, 3
    s_cmp_eq_u32 s21, 3
    s_cselect_b32 s21, 1, s33
    s_cmp_lg_u32 s21, 0
    s_cbranch_scc1 qk_noclr
    v_mov_b32 v8, -1
    v_mov_b32 v9, -1
    v_mov_b32 v10, -1
    v_mov_b32 v11, -1
    v_lshrrev_b32 v25, 6, v0
    v_mul_u32_u24 v25, 11264, v25
    v_add_u32 v25, v25, v7
    s_lshl_b32 s21, s17, 9
    s_add_u32 s21, s21, 90177536
    s_add_u32 s22, s21, 786432
qk_clr:
    buffer_store_dwordx4 v[8:11], v25, s[4:7], s21 offen sc1
    s_add_u32 s21, s21, 49152
    s_cmp_lt_u32 s21, s22
    s_cbranch_scc1 qk_clr
qk_noclr:
    s_and_b32 s21, s33, -2
    s_cmp_lg_u32 s21, 2
    s_cbranch_scc1 qk_noclr2
    v_mov_b32 v8, -1
    v_mov_b32 v9, -1
    v_mov_b32 v10, -1
    v_mov_b32 v11, -1
    s_add_u32 s21, s33, 60
    s_lshl_b32 s23, s17, 12
    s_lshl_b32 s22, s21, 17
    s_add_u32 s22, s22, s23
    s_add_u32 s22, s22, 71303168
    buffer_store_dwordx4 v[8:11], v7, s[4:7], s22 offen sc1
    s_add_u32 s22, s22, 4096
    buffer_store_dwordx4 v[8:11], v7, s[4:7], s22 offen sc1
    s_lshl_b32 s22, s21, 17
    s_add_u32 s22, s22, s23
    s_add_u32 s22, s22, 80740352
    buffer_store_dwordx4 v[8:11], v7, s[4:7], s22 offen sc1
    s_add_u32 s22, s22, 4096
    buffer_store_dwordx4 v[8:11], v7, s[4:7], s22 offen sc1
    s_lshl_b32 s22, s21, 18
    s_add_u32 s22, s22, s23
    s_add_u32 s22, s22, 50331648
    buffer_store_dwordx4 v[8:11], v7, s[4:7], s22 offen sc1
    s_add_u32 s22, s22, 4096
    buffer_store_dwordx4 v[8:11], v7, s[4:7], s22 offen sc1
    s_lshl_b32 s22, s21, 18
    s_add_u32 s22, s22, s23
    s_add_u32 s22, s22, 50462720
    buffer_store_dwordx4 v[8:11], v7, s[4:7], s22 offen sc1
    s_add_u32 s22, s22, 4096
    buffer_store_dwordx4 v[8:11], v7, s[4:7], s22 offen sc1
qk_noclr2:
    v_readfirstlane_b32 s95, v28
    s_nop 4
    s_mov_b32 s88, 4194304
gn7:
    s_cmp_lg_u32 s95, 0
    s_cbranch_scc1 gn7x
    buffer_load_dword v25, off, s[96:99], 0 offset:64 sc1
    s_sub_u32 s88, s88, 1
    s_cbranch_scc1 gn7x
    s_waitcnt vmcnt(0)
    v_readfirstlane_b32 s95, v25
    s_nop 1
    s_branch gn7
gn7x:
    s_barrier
    s_mov_b32 s27, 36864
    s_add_u32 s23, s27, s25
    s_add_u32 m0, s23, 0
    s_nop 0
    buffer_load_dwordx4 v2, s[8:11], s24 offen offset:0 lds
    s_add_u32 m0, s23, 960
    s_nop 0
    buffer_load_dwordx4 v2, s[8:11], s24 offen offset:64 lds
    s_add_u32 m0, s23, 1920
    s_nop 0
    buffer_load_dwordx4 v2, s[8:11], s24 offen offset:128 lds
    s_add_u32 m0, s23, 2880
    s_nop 0
    buffer_load_dwordx4 v2, s[8:11], s24 offen offset:192 lds
    s_add_u32 m0, s23, 3840
    s_nop 0
    buffer_load_dwordx4 v2, s[8:11], s24 offen offset:256 lds
    s_add_u32 m0, s23, 4800
    s_nop 0
    buffer_load_dwordx4 v2, s[8:11], s24 offen offset:320 lds
    s_add_u32 m0, s23, 5760
    s_nop 0
    buffer_load_dwordx4 v2, s[8:11], s24 offen offset:384 lds
    s_add_u32 m0, s23, 6720
    s_nop 0
    buffer_load_dwordx4 v2, s[8:11], s24 offen offset:448 lds
    s_add_u32 m0, s23, 7680
    s_nop 0
    buffer_load_dwordx4 v2, s[8:11], s24 offen offset:512 lds
    s_add_u32 s24, s24, s42
    s_mov_b32 s27, 0
    s_mov_b32 s30, s95
    s_cmp_eq_u32 s18, 0
    s_cselect_b32 s34, 1, 0
    s_mov_b32 s35, 0
    s_mov_b32 s31, 0x80000000
    v_mov_b32 v3, v1
    ds_read_b128 v[32:35], v3 offset:0
    ds_read_b128 v[36:39], v3 offset:18432
    ds_read_b128 v[40:43], v3 offset:1024
    ds_read_b128 v[44:47], v3 offset:19456
    s_cmp_eq_u32 s16, 2
    s_cbranch_scc1 qk_vloop
qk_loop:
    s_add_u32 s22, s27, 73728
    s_sub_u32 s21, s22, 147456
    s_cselect_b32 s22, s22, s21
    s_add_u32 s27, s27, 36864
    s_cmp_eq_u32 s27, 147456
    s_cselect_b32 s27, 0, s27
    s_waitcnt lgkmcnt(2)
    v_cvt_pk_bf16_f32 v8, v208, v209
    v_cvt_pk_bf16_f32 v9, v210, v211
    v_mfma_f32_16x16x32_bf16 v[208:211], v[64:67], v[32:35], 0
    ds_read_b128 v[48:51], v3 offset:2048
    ds_read_b128 v[52:55], v3 offset:20480
    v_cvt_pk_bf16_f32 v10, v212, v213
    v_cvt_pk_bf16_f32 v11, v214, v215
    v_mfma_f32_16x16x32_bf16 v[212:215], v[136:139], v[32:35], 0
    v_cvt_pk_bf16_f32 v12, v216, v217
    v_cvt_pk_bf16_f32 v13, v218, v219
    v_mfma_f32_16x16x32_bf16 v[216:219], v[64:67], v[36:39], 0
    v_cvt_pk_bf16_f32 v14, v220, v221
    v_cvt_pk_bf16_f32 v15, v222, v223
    v_mfma_f32_16x16x32_bf16 v[220:223], v[136:139], v[36:39], 0
    v_cvt_pk_bf16_f32 v16, v224, v225
    v_cvt_pk_bf16_f32 v17, v226, v227
    v_mfma_f32_16x16x32_bf16 v[224:227], a[0:3], v[32:35], 0
    v_cvt_pk_bf16_f32 v18, v228, v229
    v_cvt_pk_bf16_f32 v19, v230, v231
    v_mfma_f32_16x16x32_bf16 v[228:231], a[72:75], v[32:35], 0
    v_cvt_pk_bf16_f32 v20, v232, v233
    v_cvt_pk_bf16_f32 v21, v234, v235
    v_mfma_f32_16x16x32_bf16 v[232:235], a[0:3], v[36:39], 0
    v_cvt_pk_bf16_f32 v22, v236, v237
    v_cvt_pk_bf16_f32 v23, v238, v239
    v_mfma_f32_16x16x32_bf16 v[236:239], a[72:75], v[36:39], 0
    s_waitcnt lgkmcnt(2)
    v_mfma_f32_16x16x32_bf16 v[208:211], v[68:71], v[40:43], v[208:211]
    ds_read_b128 v[32:35], v3 offset:3072
    ds_read_b128 v[36:39], v3 offset:21504
    v_mfma_f32_16x16x32_bf16 v[212:215], v[140:143], v[40:43], v[212:215]
    v_mfma_f32_16x16x32_bf16 v[216:219], v[68:71], v[44:47], v[216:219]
    s_mov_b32 s28, s31
    buffer_store_dwordx4 v[8:11], v7, s[4:7], s28 offen sc1
    v_mfma_f32_16x16x32_bf16 v[220:223], v[140:143], v[44:47], v[220:223]
    v_mfma_f32_16x16x32_bf16 v[224:227], a[4:7], v[40:43], v[224:227]
    v_mfma_f32_16x16x32_bf16 v[228:231], a[76:79], v[40:43], v[228:231]
    v_mfma_f32_16x16x32_bf16 v[232:235], a[4:7], v[44:47], v[232:235]
    v_mfma_f32_16x16x32_bf16 v[236:239], a[76:79], v[44:47], v[236:239]
    s_waitcnt lgkmcnt(2)
    v_mfma_f32_16x16x32_bf16 v[208:211], v[72:75], v[48:51], v[208:211]
    ds_read_b128 v[40:43], v3 offset:4096
    ds_read_b128 v[44:47], v3 offset:22528
    v_mfma_f32_16x16x32_bf16 v[212:215], v[144:147], v[48:51], v[212:215]
    v_mfma_f32_16x16x32_bf16 v[216:219], v[72:75], v[52:55], v[216:219]
    s_add_u32 s28, s28, s40
    buffer_store_dwordx4 v[12:15], v7, s[4:7], s28 offen sc1
    v_mfma_f32_16x16x32_bf16 v[220:223], v[144:147], v[52:55], v[220:223]
    v_mfma_f32_16x16x32_bf16 v[224:227], a[8:11], v[48:51], v[224:227]
    v_mfma_f32_16x16x32_bf16 v[228:231], a[80:83], v[48:51], v[228:231]
    v_mfma_f32_16x16x32_bf16 v[232:235], a[8:11], v[52:55], v[232:235]
    v_mfma_f32_16x16x32_bf16 v[236:239], a[80:83], v[52:55], v[236:239]
    s_waitcnt lgkmcnt(2)
    v_mfma_f32_16x16x32_bf16 v[208:211], v[76:79], v[32:35], v[208:211]
    ds_read_b128 v[48:51], v3 offset:5120
    ds_read_b128 v[52:55], v3 offset:23552
    v_mfma_f32_16x16x32_bf16 v[212:215], v[148:151], v[32:35], v[212:215]
    v_mfma_f32_16x16x32_bf16 v[216:219], v[76:79], v[36:39], v[216:219]
    s_add_u32 s28, s31, s43
    buffer_store_dwordx4 v[16:19], v7, s[4:7], s28 offen sc1
    v_mfma_f32_16x16x32_bf16 v[220:223], v[148:151], v[36:39], v[220:223]
    v_mfma_f32_16x16x32_bf16 v[224:227], a[12:15], v[32:35], v[224:227]
    v_mfma_f32_16x16x32_bf16 v[228:231], a[84:87], v[32:35], v[228:231]
    v_mfma_f32_16x16x32_bf16 v[232:235], a[12:15], v[36:39], v[232:235]
    v_mfma_f32_16x16x32_bf16 v[236:239], a[84:87], v[36:39], v[236:239]
    s_waitcnt lgkmcnt(2)
    v_mfma_f32_16x16x32_bf16 v[208:211], v[80:83], v[40:43], v[208:211]
    ds_read_b128 v[32:35], v3 offset:6144
    ds_read_b128 v[36:39], v3 offset:24576
    v_mfma_f32_16x16x32_bf16 v[212:215], v[152:155], v[40:43], v[212:215]
    v_mfma_f32_16x16x32_bf16 v[216:219], v[80:83], v[44:47], v[216:219]
    s_add_u32 s28, s28, s40
    buffer_store_dwordx4 v[20:23], v7, s[4:7], s28 offen sc1
    v_mfma_f32_16x16x32_bf16 v[220:223], v[152:155], v[44:47], v[220:223]
    v_mfma_f32_16x16x32_bf16 v[224:227], a[16:19], v[40:43], v[224:227]
    v_mfma_f32_16x16x32_bf16 v[228:231], a[88:91], v[40:43], v[228:231]
    v_mfma_f32_16x16x32_bf16 v[232:235], a[16:19], v[44:47], v[232:235]
    v_mfma_f32_16x16x32_bf16 v[236:239], a[88:91], v[44:47], v[236:239]
    s_waitcnt lgkmcnt(2)
    v_mfma_f32_16x16x32_bf16 v[208:211], v[84:87], v[48:51], v[208:211]
    ds_read_b128 v[40:43], v3 offset:7168
    ds_read_b128 v[44:47], v3 offset:25600
    v_mfma_f32_16x16x32_bf16 v[212:215], v[156:159], v[48:51], v[212:215]
    v_mfma_f32_16x16x32_bf16 v[216:219], v[84:87], v[52:55], v[216:219]
    s_add_u32 s23, s22, s25
    s_add_u32 m0, s23, 0
    s_nop 0
    buffer_load_dwordx4 v2, s[8:11], s24 offen offset:0 lds
    v_mfma_f32_16x16x32_bf16 v[220:223], v[156:159], v[52:55], v[220:223]
    v_mfma_f32_16x16x32_bf16 v[224:227], a[20:23], v[48:51], v[224:227]
    v_mfma_f32_16x16x32_bf16 v[228:231], a[92:95], v[48:51], v[228:231]
    v_mfma_f32_16x16x32_bf16 v[232:235], a[20:23], v[52:55], v[232:235]
    v_mfma_f32_16x16x32_bf16 v[236:239], a[92:95], v[52:55], v[236:239]
    s_waitcnt lgkmcnt(2)
    v_mfma_f32_16x16x32_bf16 v[208:211], v[88:91], v[32:35], v[208:211]
    ds_read_b128 v[48:51], v3 offset:8192
    ds_read_b128 v[52:55], v3 offset:26624
    v_mfma_f32_16x16x32_bf16 v[212:215], v[160:163], v[32:35], v[212:215]
    v_mfma_f32_16x16x32_bf16 v[216:219], v[88:91], v[36:39], v[216:219]
    s_add_u32 m0, s23, 960
    s_nop 0
    buffer_load_dwordx4 v2, s[8:11], s24 offen offset:64 lds
    v_mfma_f32_16x16x32_bf16 v[220:223], v[160:163], v[36:39], v[220:223]
    v_mfma_f32_16x16x32_bf16 v[224:227], a[24:27], v[32:35], v[224:227]
    v_mfma_f32_16x16x32_bf16 v[228:231], a[96:99], v[32:35], v[228:231]
    v_mfma_f32_16x16x32_bf16 v[232:235], a[24:27], v[36:39], v[232:235]
    v_mfma_f32_16x16x32_bf16 v[236:239], a[96:99], v[36:39], v[236:239]
    s_waitcnt lgkmcnt(2)
    v_mfma_f32_16x16x32_bf16 v[208:211], v[92:95], v[40:43], v[208:211]
    ds_read_b128 v[32:35], v3 offset:9216
    ds_read_b128 v[36:39], v3 offset:27648
    v_mfma_f32_16x16x32_bf16 v[212:215], v[164:167], v[40:43], v[212:215]
    v_mfma_f32_16x16x32_bf16 v[216:219], v[92:95], v[44:47], v[216:219]
    s_add_u32 m0, s23, 1920
    s_nop 0
    buffer_load_dwordx4 v2, s[8:11], s24 offen offset:128 lds
    v_mfma_f32_16x16x32_bf16 v[220:223], v[164:167], v[44:47], v[220:223]
    v_mfma_f32_16x16x32_bf16 v[224:227], a[28:31], v[40:43], v[224:227]
    v_mfma_f32_16x16x32_bf16 v[228:231], a[100:103], v[40:43], v[228:231]
    v_mfma_f32_16x16x32_bf16 v[232:235], a[28:31], v[44:47], v[232:235]
    v_mfma_f32_16x16x32_bf16 v[236:239], a[100:103], v[44:47], v[236:239]
    s_waitcnt lgkmcnt(2)
    v_mfma_f32_16x16x32_bf16 v[208:211], v[96:99], v[48:51], v[208:211]
    ds_read_b128 v[40:43], v3 offset:10240
    ds_read_b128 v[44:47], v3 offset:28672
    v_mfma_f32_16x16x32_bf16 v[212:215], v[168:171], v[48:51], v[212:215]
    v_mfma_f32_16x16x32_bf16 v[216:219], v[96:99], v[52:55], v[216:219]
    s_add_u32 m0, s23, 2880
    s_nop 0
    buffer_load_dwordx4 v2, s[8:11], s24 offen offset:192 lds
    v_mfma_f32_16x16x32_bf16 v[220:223], v[168:171], v[52:55], v[220:223]
    v_mfma_f32_16x16x32_bf16 v[224:227], a[32:35], v[48:51], v[224:227]
    v_mfma_f32_16x16x32_bf16 v[228:231], a[104:107], v[48:51], v[228:231]
    v_mfma_f32_16x16x32_bf16 v[232:235], a[32:35], v[52:55], v[232:235]
    v_mfma_f32_16x16x32_bf16 v[236:239], a[104:107], v[52:55], v[236:239]
    s_waitcnt lgkmcnt(2)
    v_mfma_f32_16x16x32_bf16 v[208:211], v[100:103], v[32:35], v[208:211]
    ds_read_b128 v[48:51], v3 offset:11264
    ds_read_b128 v[52:55], v3 offset:29696
    v_mfma_f32_16x16x32_bf16 v[212:215], v[172:175], v[32:35], v[212:215]
    v_mfma_f32_16x16x32_bf16 v[216:219], v[100:103], v[36:39], v[216:219]
    s_add_u32 m0, s23, 3840
    s_nop 0
    buffer_load_dwordx4 v2, s[8:11], s24 offen offset:256 lds
    v_mfma_f32_16x16x32_bf16 v[220:223], v[172:175], v[36:39], v[220:223]
    v_mfma_f32_16x16x32_bf16 v[224:227], a[36:39], v[32:35], v[224:227]
    v_mfma_f32_16x16x32_bf16 v[228:231], a[108:111], v[32:35], v[228:231]
    v_mfma_f32_16x16x32_bf16 v[232:235], a[36:39], v[36:39], v[232:235]
    v_mfma_f32_16x16x32_bf16 v[236:239], a[108:111], v[36:39], v[236:239]
    s_waitcnt lgkmcnt(2)
    v_mfma_f32_16x16x32_bf16 v[208:211], v[104:107], v[40:43], v[208:211]
    ds_read_b128 v[32:35], v3 offset:12288
    ds_read_b128 v[36:39], v3 offset:30720
    v_mfma_f32_16x16x32_bf16 v[212:215], v[176:179], v[40:43], v[212:215]
    v_mfma_f32_16x16x32_bf16 v[216:219], v[104:107], v[44:47], v[216:219]
    s_add_u32 m0, s23, 4800
    s_nop 0
    buffer_load_dwordx4 v2, s[8:11], s24 offen offset:320 lds
    v_mfma_f32_16x16x32_bf16 v[220:223], v[176:179], v[44:47], v[220:223]
    v_mfma_f32_16x16x32_bf16 v[224:227], a[40:43], v[40:43], v[224:227]
    v_mfma_f32_16x16x32_bf16 v[228:231], a[112:115], v[40:43], v[228:231]
    v_mfma_f32_16x16x32_bf16 v[232:235], a[40:43], v[44:47], v[232:235]
    v_mfma_f32_16x16x32_bf16 v[236:239], a[112:115], v[44:47], v[236:239]
    s_waitcnt lgkmcnt(2)
    v_mfma_f32_16x16x32_bf16 v[208:211], v[108:111], v[48:51], v[208:211]
    ds_read_b128 v[40:43], v3 offset:13312
    ds_read_b128 v[44:47], v3 offset:31744
    v_mfma_f32_16x16x32_bf16 v[212:215], v[180:183], v[48:51], v[212:215]
    v_mfma_f32_16x16x32_bf16 v[216:219], v[108:111], v[52:55], v[216:219]
    s_add_u32 m0, s23, 5760
    s_nop 0
    buffer_load_dwordx4 v2, s[8:11], s24 offen offset:384 lds
    v_mfma_f32_16x16x32_bf16 v[220:223], v[180:183], v[52:55], v[220:223]
    v_mfma_f32_16x16x32_bf16 v[224:227], a[44:47], v[48:51], v[224:227]
    v_mfma_f32_16x16x32_bf16 v[228:231], a[116:119], v[48:51], v[228:231]
    v_mfma_f32_16x16x32_bf16 v[232:235], a[44:47], v[52:55], v[232:235]
    v_mfma_f32_16x16x32_bf16 v[236:239], a[116:119], v[52:55], v[236:239]
    s_waitcnt lgkmcnt(2)
    v_mfma_f32_16x16x32_bf16 v[208:211], v[112:115], v[32:35], v[208:211]
    ds_read_b128 v[48:51], v3 offset:14336
    ds_read_b128 v[52:55], v3 offset:32768
    v_mfma_f32_16x16x32_bf16 v[212:215], v[184:187], v[32:35], v[212:215]
    v_mfma_f32_16x16x32_bf16 v[216:219], v[112:115], v[36:39], v[216:219]
    s_add_u32 m0, s23, 6720
    s_nop 0
    buffer_load_dwordx4 v2, s[8:11], s24 offen offset:448 lds
    v_mfma_f32_16x16x32_bf16 v[220:223], v[184:187], v[36:39], v[220:223]
    v_mfma_f32_16x16x32_bf16 v[224:227], a[48:51], v[32:35], v[224:227]
    v_mfma_f32_16x16x32_bf16 v[228:231], a[120:123], v[32:35], v[228:231]
    v_mfma_f32_16x16x32_bf16 v[232:235], a[48:51], v[36:39], v[232:235]
    v_mfma_f32_16x16x32_bf16 v[236:239], a[120:123], v[36:39], v[236:239]
    s_waitcnt lgkmcnt(2)
    v_mfma_f32_16x16x32_bf16 v[208:211], v[116:119], v[40:43], v[208:211]
    ds_read_b128 v[32:35], v3 offset:15360
    ds_read_b128 v[36:39], v3 offset:33792
    v_mfma_f32_16x16x32_bf16 v[212:215], v[188:191], v[40:43], v[212:215]
    v_mfma_f32_16x16x32_bf16 v[216:219], v[116:119], v[44:47], v[216:219]
    s_add_u32 m0, s23, 7680
    s_nop 0
    buffer_load_dwordx4 v2, s[8:11], s24 offen offset:512 lds
    s_add_u32 s24, s24, s42
    v_mfma_f32_16x16x32_bf16 v[220:223], v[188:191], v[44:47], v[220:223]
    v_mfma_f32_16x16x32_bf16 v[224:227], a[52:55], v[40:43], v[224:227]
    v_mfma_f32_16x16x32_bf16 v[228:231], a[124:127], v[40:43], v[228:231]
    v_mfma_f32_16x16x32_bf16 v[232:235], a[52:55], v[44:47], v[232:235]
    v_mfma_f32_16x16x32_bf16 v[236:239], a[124:127], v[44:47], v[236:239]
    s_waitcnt lgkmcnt(2)
    v_mfma_f32_16x16x32_bf16 v[208:211], v[120:123], v[48:51], v[208:211]
    ds_read_b128 v[40:43], v3 offset:16384
    ds_read_b128 v[44:47], v3 offset:34816
    v_mfma_f32_16x16x32_bf16 v[212:215], v[192:195], v[48:51], v[212:215]
    v_mfma_f32_16x16x32_bf16 v[216:219], v[120:123], v[52:55], v[216:219]
    v_add_u32 v24, s27, v1
    v_mfma_f32_16x16x32_bf16 v[220:223], v[192:195], v[52:55], v[220:223]
    v_mfma_f32_16x16x32_bf16 v[224:227], a[56:59], v[48:51], v[224:227]
    v_mfma_f32_16x16x32_bf16 v[228:231], a[128:131], v[48:51], v[228:231]
    v_mfma_f32_16x16x32_bf16 v[232:235], a[56:59], v[52:55], v[232:235]
    v_mfma_f32_16x16x32_bf16 v[236:239], a[128:131], v[52:55], v[236:239]
    s_waitcnt lgkmcnt(2)
    v_mfma_f32_16x16x32_bf16 v[208:211], v[124:127], v[32:35], v[208:211]
    ds_read_b128 v[48:51], v3 offset:17408
    ds_read_b128 v[52:55], v3 offset:35840
    v_mfma_f32_16x16x32_bf16 v[212:215], v[196:199], v[32:35], v[212:215]
    v_mfma_f32_16x16x32_bf16 v[216:219], v[124:127], v[36:39], v[216:219]
    v_mfma_f32_16x16x32_bf16 v[220:223], v[196:199], v[36:39], v[220:223]
    v_mfma_f32_16x16x32_bf16 v[224:227], a[60:63], v[32:35], v[224:227]
    v_mfma_f32_16x16x32_bf16 v[228:231], a[132:135], v[32:35], v[228:231]
    s_waitcnt vmcnt(9)
    s_barrier
    v_mfma_f32_16x16x32_bf16 v[232:235], a[60:63], v[36:39], v[232:235]
    v_mfma_f32_16x16x32_bf16 v[236:239], a[132:135], v[36:39], v[236:239]
    s_waitcnt lgkmcnt(2)
    v_mfma_f32_16x16x32_bf16 v[208:211], v[128:131], v[40:43], v[208:211]
    ds_read_b128 v[32:35], v24 offset:0
    ds_read_b128 v[36:39], v24 offset:18432
    v_mfma_f32_16x16x32_bf16 v[212:215], v[200:203], v[40:43], v[212:215]
    v_mfma_f32_16x16x32_bf16 v[216:219], v[128:131], v[44:47], v[216:219]
    v_mov_b32 v4, s30
    s_mov_b64 exec, s[34:35]
    buffer_store_dword v4, off, s[4:7], s29 sc1
    s_mov_b64 exec, -1
    v_mfma_f32_16x16x32_bf16 v[220:223], v[200:203], v[44:47], v[220:223]
    v_mfma_f32_16x16x32_bf16 v[224:227], a[64:67], v[40:43], v[224:227]
    v_mfma_f32_16x16x32_bf16 v[228:231], a[136:139], v[40:43], v[228:231]
    v_mfma_f32_16x16x32_bf16 v[232:235], a[64:67], v[44:47], v[232:235]
    v_mfma_f32_16x16x32_bf16 v[236:239], a[136:139], v[44:47], v[236:239]
    s_waitcnt lgkmcnt(2)
    v_mfma_f32_16x16x32_bf16 v[208:211], v[132:135], v[48:51], v[208:211]
    ds_read_b128 v[40:43], v24 offset:1024
    ds_read_b128 v[44:47], v24 offset:19456
    v_mfma_f32_16x16x32_bf16 v[212:215], v[204:207], v[48:51], v[212:215]
    v_mfma_f32_16x16x32_bf16 v[216:219], v[132:135], v[52:55], v[216:219]
    v_mfma_f32_16x16x32_bf16 v[220:223], v[204:207], v[52:55], v[220:223]
    v_mfma_f32_16x16x32_bf16 v[224:227], a[68:71], v[48:51], v[224:227]
    v_mfma_f32_16x16x32_bf16 v[228:231], a[140:143], v[48:51], v[228:231]
    v_mfma_f32_16x16x32_bf16 v[232:235], a[68:71], v[52:55], v[232:235]
    v_mfma_f32_16x16x32_bf16 v[236:239], a[140:143], v[52:55], v[236:239]
    v_mov_b32 v3, v24
    s_mov_b32 s31, s26
    s_add_u32 s26, s26, s41
    s_add_u32 s30, s30, 1
    s_add_u32 s19, s19, s20
    s_cmp_lt_u32 s19, 64
    s_cbranch_scc1 qk_loop
    v_cvt_pk_bf16_f32 v8, v208, v209
    v_cvt_pk_bf16_f32 v9, v210, v211
    v_cvt_pk_bf16_f32 v10, v212, v213
    v_cvt_pk_bf16_f32 v11, v214, v215
    v_cvt_pk_bf16_f32 v12, v216, v217
    v_cvt_pk_bf16_f32 v13, v218, v219
    v_cvt_pk_bf16_f32 v14, v220, v221
    v_cvt_pk_bf16_f32 v15, v222, v223
    v_cvt_pk_bf16_f32 v16, v224, v225
    v_cvt_pk_bf16_f32 v17, v226, v227
    v_cvt_pk_bf16_f32 v18, v228, v229
    v_cvt_pk_bf16_f32 v19, v230, v231
    v_cvt_pk_bf16_f32 v20, v232, v233
    v_cvt_pk_bf16_f32 v21, v234, v235
    v_cvt_pk_bf16_f32 v22, v236, v237
    v_cvt_pk_bf16_f32 v23, v238, v239
    s_branch qk_done
    s_nop 0
qk_vloop:
    s_add_u32 s22, s27, 73728
    s_sub_u32 s21, s22, 147456
    s_cselect_b32 s22, s22, s21
    s_add_u32 s27, s27, 36864
    s_cmp_eq_u32 s27, 147456
    s_cselect_b32 s27, 0, s27
    s_waitcnt lgkmcnt(2)
    v_cvt_pk_bf16_f32 v8, v208, v209
    v_cvt_pk_bf16_f32 v9, v210, v211
    v_mfma_f32_16x16x32_bf16 v[208:211], v[32:35], v[64:67], 0
    ds_read_b128 v[48:51], v3 offset:2048
    ds_read_b128 v[52:55], v3 offset:20480
    v_cvt_pk_bf16_f32 v12, v212, v213
    v_cvt_pk_bf16_f32 v13, v214, v215
    v_mfma_f32_16x16x32_bf16 v[212:215], v[32:35], v[136:139], 0
    v_cvt_pk_bf16_f32 v10, v216, v217
    v_cvt_pk_bf16_f32 v11, v218, v219
    v_mfma_f32_16x16x32_bf16 v[216:219], v[36:39], v[64:67], 0
    v_cvt_pk_bf16_f32 v14, v220, v221
    v_cvt_pk_bf16_f32 v15, v222, v223
    v_mfma_f32_16x16x32_bf16 v[220:223], v[36:39], v[136:139], 0
    v_cvt_pk_bf16_f32 v16, v224, v225
    v_cvt_pk_bf16_f32 v17, v226, v227
    v_mfma_f32_16x16x32_bf16 v[224:227], v[32:35], a[0:3], 0
    v_cvt_pk_bf16_f32 v20, v228, v229
    v_cvt_pk_bf16_f32 v21, v230, v231
    v_mfma_f32_16x16x32_bf16 v[228:231], v[32:35], a[72:75], 0
    v_cvt_pk_bf16_f32 v18, v232, v233
    v_cvt_pk_bf16_f32 v19, v234, v235
    v_mfma_f32_16x16x32_bf16 v[232:235], v[36:39], a[0:3], 0
    v_cvt_pk_bf16_f32 v22, v236, v237
    v_cvt_pk_bf16_f32 v23, v238, v239
    v_mfma_f32_16x16x32_bf16 v[236:239], v[36:39], a[72:75], 0
    s_waitcnt lgkmcnt(2)
    v_mfma_f32_16x16x32_bf16 v[208:211], v[40:43], v[68:71], v[208:211]
    ds_read_b128 v[32:35], v3 offset:3072
    ds_read_b128 v[36:39], v3 offset:21504
    v_mfma_f32_16x16x32_bf16 v[212:215], v[40:43], v[140:143], v[212:215]
    v_mfma_f32_16x16x32_bf16 v[216:219], v[44:47], v[68:71], v[216:219]
    s_mov_b32 s28, s31
    buffer_store_dwordx4 v[8:11], v7, s[4:7], s28 offen sc1
    v_mfma_f32_16x16x32_bf16 v[220:223], v[44:47], v[140:143], v[220:223]
    v_mfma_f32_16x16x32_bf16 v[224:227], v[40:43], a[4:7], v[224:227]
    v_mfma_f32_16x16x32_bf16 v[228:231], v[40:43], a[76:79], v[228:231]
    v_mfma_f32_16x16x32_bf16 v[232:235], v[44:47], a[4:7], v[232:235]
    v_mfma_f32_16x16x32_bf16 v[236:239], v[44:47], a[76:79], v[236:239]
    s_waitcnt lgkmcnt(2)
    v_mfma_f32_16x16x32_bf16 v[208:211], v[48:51], v[72:75], v[208:211]
    ds_read_b128 v[40:43], v3 offset:4096
    ds_read_b128 v[44:47], v3 offset:22528
    v_mfma_f32_16x16x32_bf16 v[212:215], v[48:51], v[144:147], v[212:215]
    v_mfma_f32_16x16x32_bf16 v[216:219], v[52:55], v[72:75], v[216:219]
    s_add_u32 s28, s28, s40
    buffer_store_dwordx4 v[12:15], v7, s[4:7], s28 offen sc1
    v_mfma_f32_16x16x32_bf16 v[220:223], v[52:55], v[144:147], v[220:223]
    v_mfma_f32_16x16x32_bf16 v[224:227], v[48:51], a[8:11], v[224:227]
    v_mfma_f32_16x16x32_bf16 v[228:231], v[48:51], a[80:83], v[228:231]
    v_mfma_f32_16x16x32_bf16 v[232:235], v[52:55], a[8:11], v[232:235]
    v_mfma_f32_16x16x32_bf16 v[236:239], v[52:55], a[80:83], v[236:239]
    s_waitcnt lgkmcnt(2)
    v_mfma_f32_16x16x32_bf16 v[208:211], v[32:35], v[76:79], v[208:211]
    ds_read_b128 v[48:51], v3 offset:5120
    ds_read_b128 v[52:55], v3 offset:23552
    v_mfma_f32_16x16x32_bf16 v[212:215], v[32:35], v[148:151], v[212:215]
    v_mfma_f32_16x16x32_bf16 v[216:219], v[36:39], v[76:79], v[216:219]
    s_add_u32 s28, s31, s43
    buffer_store_dwordx4 v[16:19], v7, s[4:7], s28 offen sc1
    v_mfma_f32_16x16x32_bf16 v[220:223], v[36:39], v[148:151], v[220:223]
    v_mfma_f32_16x16x32_bf16 v[224:227], v[32:35], a[12:15], v[224:227]
    v_mfma_f32_16x16x32_bf16 v[228:231], v[32:35], a[84:87], v[228:231]
    v_mfma_f32_16x16x32_bf16 v[232:235], v[36:39], a[12:15], v[232:235]
    v_mfma_f32_16x16x32_bf16 v[236:239], v[36:39], a[84:87], v[236:239]
    s_waitcnt lgkmcnt(2)
    v_mfma_f32_16x16x32_bf16 v[208:211], v[40:43], v[80:83], v[208:211]
    ds_read_b128 v[32:35], v3 offset:6144
    ds_read_b128 v[36:39], v3 offset:24576
    v_mfma_f32_16x16x32_bf16 v[212:215], v[40:43], v[152:155], v[212:215]
    v_mfma_f32_16x16x32_bf16 v[216:219], v[44:47], v[80:83], v[216:219]
    s_add_u32 s28, s28, s40
    buffer_store_dwordx4 v[20:23], v7, s[4:7], s28 offen sc1
    v_mfma_f32_16x16x32_bf16 v[220:223], v[44:47], v[152:155], v[220:223]
    v_mfma_f32_16x16x32_bf16 v[224:227], v[40:43], a[16:19], v[224:227]
    v_mfma_f32_16x16x32_bf16 v[228:231], v[40:43], a[88:91], v[228:231]
    v_mfma_f32_16x16x32_bf16 v[232:235], v[44:47], a[16:19], v[232:235]
    v_mfma_f32_16x16x32_bf16 v[236:239], v[44:47], a[88:91], v[236:239]
    s_waitcnt lgkmcnt(2)
    v_mfma_f32_16x16x32_bf16 v[208:211], v[48:51], v[84:87], v[208:211]
    ds_read_b128 v[40:43], v3 offset:7168
    ds_read_b128 v[44:47], v3 offset:25600
    v_mfma_f32_16x16x32_bf16 v[212:215], v[48:51], v[156:159], v[212:215]
    v_mfma_f32_16x16x32_bf16 v[216:219], v[52:55], v[84:87], v[216:219]
    s_add_u32 s23, s22, s25
    s_add_u32 m0, s23, 0
    s_nop 0
    buffer_load_dwordx4 v2, s[8:11], s24 offen offset:0 lds
    v_mfma_f32_16x16x32_bf16 v[220:223], v[52:55], v[156:159], v[220:223]
    v_mfma_f32_16x16x32_bf16 v[224:227], v[48:51], a[20:23], v[224:227]
    v_mfma_f32_16x16x32_bf16 v[228:231], v[48:51], a[92:95], v[228:231]
    v_mfma_f32_16x16x32_bf16 v[232:235], v[52:55], a[20:23], v[232:235]
    v_mfma_f32_16x16x32_bf16 v[236:239], v[52:55], a[92:95], v[236:239]
    s_waitcnt lgkmcnt(2)
    v_mfma_f32_16x16x32_bf16 v[208:211], v[32:35], v[88:91], v[208:211]
    ds_read_b128 v[48:51], v3 offset:8192
    ds_read_b128 v[52:55], v3 offset:26624
    v_mfma_f32_16x16x32_bf16 v[212:215], v[32:35], v[160:163], v[212:215]
    v_mfma_f32_16x16x32_bf16 v[216:219], v[36:39], v[88:91], v[216:219]
    s_add_u32 m0, s23, 960
    s_nop 0
    buffer_load_dwordx4 v2, s[8:11], s24 offen offset:64 lds
    v_mfma_f32_16x16x32_bf16 v[220:223], v[36:39], v[160:163], v[220:223]
    v_mfma_f32_16x16x32_bf16 v[224:227], v[32:35], a[24:27], v[224:227]
    v_mfma_f32_16x16x32_bf16 v[228:231], v[32:35], a[96:99], v[228:231]
    v_mfma_f32_16x16x32_bf16 v[232:235], v[36:39], a[24:27], v[232:235]
    v_mfma_f32_16x16x32_bf16 v[236:239], v[36:39], a[96:99], v[236:239]
    s_waitcnt lgkmcnt(2)
    v_mfma_f32_16x16x32_bf16 v[208:211], v[40:43], v[92:95], v[208:211]
    ds_read_b128 v[32:35], v3 offset:9216
    ds_read_b128 v[36:39], v3 offset:27648
    v_mfma_f32_16x16x32_bf16 v[212:215], v[40:43], v[164:167], v[212:215]
    v_mfma_f32_16x16x32_bf16 v[216:219], v[44:47], v[92:95], v[216:219]
    s_add_u32 m0, s23, 1920
    s_nop 0
    buffer_load_dwordx4 v2, s[8:11], s24 offen offset:128 lds
    v_mfma_f32_16x16x32_bf16 v[220:223], v[44:47], v[164:167], v[220:223]
    v_mfma_f32_16x16x32_bf16 v[224:227], v[40:43], a[28:31], v[224:227]
    v_mfma_f32_16x16x32_bf16 v[228:231], v[40:43], a[100:103], v[228:231]
    v_mfma_f32_16x16x32_bf16 v[232:235], v[44:47], a[28:31], v[232:235]
    v_mfma_f32_16x16x32_bf16 v[236:239], v[44:47], a[100:103], v[236:239]
    s_waitcnt lgkmcnt(2)
    v_mfma_f32_16x16x32_bf16 v[208:211], v[48:51], v[96:99], v[208:211]
    ds_read_b128 v[40:43], v3 offset:10240
    ds_read_b128 v[44:47], v3 offset:28672
    v_mfma_f32_16x16x32_bf16 v[212:215], v[48:51], v[168:171], v[212:215]
    v_mfma_f32_16x16x32_bf16 v[216:219], v[52:55], v[96:99], v[216:219]
    s_add_u32 m0, s23, 2880
    s_nop 0
    buffer_load_dwordx4 v2, s[8:11], s24 offen offset:192 lds
    v_mfma_f32_16x16x32_bf16 v[220:223], v[52:55], v[168:171], v[220:223]
    v_mfma_f32_16x16x32_bf16 v[224:227], v[48:51], a[32:35], v[224:227]
    v_mfma_f32_16x16x32_bf16 v[228:231], v[48:51], a[104:107], v[228:231]
    v_mfma_f32_16x16x32_bf16 v[232:235], v[52:55], a[32:35], v[232:235]
    v_mfma_f32_16x16x32_bf16 v[236:239], v[52:55], a[104:107], v[236:239]
    s_waitcnt lgkmcnt(2)
    v_mfma_f32_16x16x32_bf16 v[208:211], v[32:35], v[100:103], v[208:211]
    ds_read_b128 v[48:51], v3 offset:11264
    ds_read_b128 v[52:55], v3 offset:29696
    v_mfma_f32_16x16x32_bf16 v[212:215], v[32:35], v[172:175], v[212:215]
    v_mfma_f32_16x16x32_bf16 v[216:219], v[36:39], v[100:103], v[216:219]
    s_add_u32 m0, s23, 3840
    s_nop 0
    buffer_load_dwordx4 v2, s[8:11], s24 offen offset:256 lds
    v_mfma_f32_16x16x32_bf16 v[220:223], v[36:39], v[172:175], v[220:223]
    v_mfma_f32_16x16x32_bf16 v[224:227], v[32:35], a[36:39], v[224:227]
    v_mfma_f32_16x16x32_bf16 v[228:231], v[32:35], a[108:111], v[228:231]
    v_mfma_f32_16x16x32_bf16 v[232:235], v[36:39], a[36:39], v[232:235]
    v_mfma_f32_16x16x32_bf16 v[236:239], v[36:39], a[108:111], v[236:239]
    s_waitcnt lgkmcnt(2)
    v_mfma_f32_16x16x32_bf16 v[208:211], v[40:43], v[104:107], v[208:211]
    ds_read_b128 v[32:35], v3 offset:12288
    ds_read_b128 v[36:39], v3 offset:30720
    v_mfma_f32_16x16x32_bf16 v[212:215], v[40:43], v[176:179], v[212:215]
    v_mfma_f32_16x16x32_bf16 v[216:219], v[44:47], v[104:107], v[216:219]
    s_add_u32 m0, s23, 4800
    s_nop 0
    buffer_load_dwordx4 v2, s[8:11], s24 offen offset:320 lds
    v_mfma_f32_16x16x32_bf16 v[220:223], v[44:47], v[176:179], v[220:223]
    v_mfma_f32_16x16x32_bf16 v[224:227], v[40:43], a[40:43], v[224:227]
    v_mfma_f32_16x16x32_bf16 v[228:231], v[40:43], a[112:115], v[228:231]
    v_mfma_f32_16x16x32_bf16 v[232:235], v[44:47], a[40:43], v[232:235]
    v_mfma_f32_16x16x32_bf16 v[236:239], v[44:47], a[112:115], v[236:239]
    s_waitcnt lgkmcnt(2)
    v_mfma_f32_16x16x32_bf16 v[208:211], v[48:51], v[108:111], v[208:211]
    ds_read_b128 v[40:43], v3 offset:13312
    ds_read_b128 v[44:47], v3 offset:31744
    v_mfma_f32_16x16x32_bf16 v[212:215], v[48:51], v[180:183], v[212:215]
    v_mfma_f32_16x16x32_bf16 v[216:219], v[52:55], v[108:111], v[216:219]
    s_add_u32 m0, s23, 5760
    s_nop 0
    buffer_load_dwordx4 v2, s[8:11], s24 offen offset:384 lds
    v_mfma_f32_16x16x32_bf16 v[220:223], v[52:55], v[180:183], v[220:223]
    v_mfma_f32_16x16x32_bf16 v[224:227], v[48:51], a[44:47], v[224:227]
    v_mfma_f32_16x16x32_bf16 v[228:231], v[48:51], a[116:119], v[228:231]
    v_mfma_f32_16x16x32_bf16 v[232:235], v[52:55], a[44:47], v[232:235]
    v_mfma_f32_16x16x32_bf16 v[236:239], v[52:55], a[116:119], v[236:239]
    s_waitcnt lgkmcnt(2)
    v_mfma_f32_16x16x32_bf16 v[208:211], v[32:35], v[112:115], v[208:211]
    ds_read_b128 v[48:51], v3 offset:14336
    ds_read_b128 v[52:55], v3 offset:32768
    v_mfma_f32_16x16x32_bf16 v[212:215], v[32:35], v[184:187], v[212:215]
    v_mfma_f32_16x16x32_bf16 v[216:219], v[36:39], v[112:115], v[216:219]
    s_add_u32 m0, s23, 6720
    s_nop 0
    buffer_load_dwordx4 v2, s[8:11], s24 offen offset:448 lds
    v_mfma_f32_16x16x32_bf16 v[220:223], v[36:39], v[184:187], v[220:223]
    v_mfma_f32_16x16x32_bf16 v[224:227], v[32:35], a[48:51], v[224:227]
    v_mfma_f32_16x16x32_bf16 v[228:231], v[32:35], a[120:123], v[228:231]
    v_mfma_f32_16x16x32_bf16 v[232:235], v[36:39], a[48:51], v[232:235]
    v_mfma_f32_16x16x32_bf16 v[236:239], v[36:39], a[120:123], v[236:239]
    s_waitcnt lgkmcnt(2)
    v_mfma_f32_16x16x32_bf16 v[208:211], v[40:43], v[116:119], v[208:211]
    ds_read_b128 v[32:35], v3 offset:15360
    ds_read_b128 v[36:39], v3 offset:33792
    v_mfma_f32_16x16x32_bf16 v[212:215], v[40:43], v[188:191], v[212:215]
    v_mfma_f32_16x16x32_bf16 v[216:219], v[44:47], v[116:119], v[216:219]
    s_add_u32 m0, s23, 7680
    s_nop 0
    buffer_load_dwordx4 v2, s[8:11], s24 offen offset:512 lds
    s_add_u32 s24, s24, s42
    v_mfma_f32_16x16x32_bf16 v[220:223], v[44:47], v[188:191], v[220:223]
    v_mfma_f32_16x16x32_bf16 v[224:227], v[40:43], a[52:55], v[224:227]
    v_mfma_f32_16x16x32_bf16 v[228:231], v[40:43], a[124:127], v[228:231]
    v_mfma_f32_16x16x32_bf16 v[232:235], v[44:47], a[52:55], v[232:235]
    v_mfma_f32_16x16x32_bf16 v[236:239], v[44:47], a[124:127], v[236:239]
    s_waitcnt lgkmcnt(2)
    v_mfma_f32_16x16x32_bf16 v[208:211], v[48:51], v[120:123], v[208:211]
    ds_read_b128 v[40:43], v3 offset:16384
    ds_read_b128 v[44:47], v3 offset:34816
    v_mfma_f32_16x16x32_bf16 v[212:215], v[48:51], v[192:195], v[212:215]
    v_mfma_f32_16x16x32_bf16 v[216:219], v[52:55], v[120:123], v[216:219]
    v_add_u32 v24, s27, v1
    v_mfma_f32_16x16x32_bf16 v[220:223], v[52:55], v[192:195], v[220:223]
    v_mfma_f32_16x16x32_bf16 v[224:227], v[48:51], a[56:59], v[224:227]
    v_mfma_f32_16x16x32_bf16 v[228:231], v[48:51], a[128:131], v[228:231]
    v_mfma_f32_16x16x32_bf16 v[232:235], v[52:55], a[56:59], v[232:235]
    v_mfma_f32_16x16x32_bf16 v[236:239], v[52:55], a[128:131], v[236:239]
    s_waitcnt lgkmcnt(2)
    v_mfma_f32_16x16x32_bf16 v[208:211], v[32:35], v[124:127], v[208:211]
    ds_read_b128 v[48:51], v3 offset:17408
    ds_read_b128 v[52:55], v3 offset:35840
    v_mfma_f32_16x16x32_bf16 v[212:215], v[32:35], v[196:199], v[212:215]
    v_mfma_f32_16x16x32_bf16 v[216:219], v[36:39], v[124:127], v[216:219]
    v_mfma_f32_16x16x32_bf16 v[220:223], v[36:39], v[196:199], v[220:223]
    v_mfma_f32_16x16x32_bf16 v[224:227], v[32:35], a[60:63], v[224:227]
    v_mfma_f32_16x16x32_bf16 v[228:231], v[32:35], a[132:135], v[228:231]
    s_waitcnt vmcnt(9)
    s_barrier
    v_mfma_f32_16x16x32_bf16 v[232:235], v[36:39], a[60:63], v[232:235]
    v_mfma_f32_16x16x32_bf16 v[236:239], v[36:39], a[132:135], v[236:239]
    s_waitcnt lgkmcnt(2)
    v_mfma_f32_16x16x32_bf16 v[208:211], v[40:43], v[128:131], v[208:211]
    ds_read_b128 v[32:35], v24 offset:0
    ds_read_b128 v[36:39], v24 offset:18432
    v_mfma_f32_16x16x32_bf16 v[212:215], v[40:43], v[200:203], v[212:215]
    v_mfma_f32_16x16x32_bf16 v[216:219], v[44:47], v[128:131], v[216:219]
    v_mov_b32 v4, s30
    s_mov_b64 exec, s[34:35]
    buffer_store_dword v4, off, s[4:7], s29 sc1
    s_mov_b64 exec, -1
    v_mfma_f32_16x16x32_bf16 v[220:223], v[44:47], v[200:203], v[220:223]
    v_mfma_f32_16x16x32_bf16 v[224:227], v[40:43], a[64:67], v[224:227]
    v_mfma_f32_16x16x32_bf16 v[228:231], v[40:43], a[136:139], v[228:231]
    v_mfma_f32_16x16x32_bf16 v[232:235], v[44:47], a[64:67], v[232:235]
    v_mfma_f32_16x16x32_bf16 v[236:239], v[44:47], a[136:139], v[236:239]
    s_waitcnt lgkmcnt(2)
    v_mfma_f32_16x16x32_bf16 v[208:211], v[48:51], v[132:135], v[208:211]
    ds_read_b128 v[40:43], v24 offset:1024
    ds_read_b128 v[44:47], v24 offset:19456
    v_mfma_f32_16x16x32_bf16 v[212:215], v[48:51], v[204:207], v[212:215]
    v_mfma_f32_16x16x32_bf16 v[216:219], v[52:55], v[132:135], v[216:219]
    v_mfma_f32_16x16x32_bf16 v[220:223], v[52:55], v[204:207], v[220:223]
    v_mfma_f32_16x16x32_bf16 v[224:227], v[48:51], a[68:71], v[224:227]
    v_mfma_f32_16x16x32_bf16 v[228:231], v[48:51], a[140:143], v[228:231]
    v_mfma_f32_16x16x32_bf16 v[232:235], v[52:55], a[68:71], v[232:235]
    v_mfma_f32_16x16x32_bf16 v[236:239], v[52:55], a[140:143], v[236:239]
    v_mov_b32 v3, v24
    s_mov_b32 s31, s26
    s_add_u32 s26, s26, s41
    s_add_u32 s30, s30, 1
    s_add_u32 s19, s19, s20
    s_cmp_lt_u32 s19, 64
    s_cbranch_scc1 qk_vloop
    v_cvt_pk_bf16_f32 v8, v208, v209
    v_cvt_pk_bf16_f32 v9, v210, v211
    v_cvt_pk_bf16_f32 v12, v212, v213
    v_cvt_pk_bf16_f32 v13, v214, v215
    v_cvt_pk_bf16_f32 v10, v216, v217
    v_cvt_pk_bf16_f32 v11, v218, v219
    v_cvt_pk_bf16_f32 v14, v220, v221
    v_cvt_pk_bf16_f32 v15, v222, v223
    v_cvt_pk_bf16_f32 v16, v224, v225
    v_cvt_pk_bf16_f32 v17, v226, v227
    v_cvt_pk_bf16_f32 v20, v228, v229
    v_cvt_pk_bf16_f32 v21, v230, v231
    v_cvt_pk_bf16_f32 v18, v232, v233
    v_cvt_pk_bf16_f32 v19, v234, v235
    v_cvt_pk_bf16_f32 v22, v236, v237
    v_cvt_pk_bf16_f32 v23, v238, v239
qk_done:
    s_mov_b32 s28, s31
    buffer_store_dwordx4 v[8:11], v7, s[4:7], s28 offen sc1
    s_add_u32 s28, s28, s40
    buffer_store_dwordx4 v[12:15], v7, s[4:7], s28 offen sc1
    s_add_u32 s28, s31, s43
    buffer_store_dwordx4 v[16:19], v7, s[4:7], s28 offen sc1
    s_add_u32 s28, s28, s40
    buffer_store_dwordx4 v[20:23], v7, s[4:7], s28 offen sc1
    s_waitcnt vmcnt(0) lgkmcnt(0)
    s_barrier
    s_add_u32 s22, s95, 63
    v_mov_b32 v4, s22
    s_mov_b64 exec, s[34:35]
    buffer_store_dword v4, off, s[4:7], s29 sc1
    s_mov_b64 exec, -1
    s_cmp_eq_u32 s16, 0
    s_cbranch_scc1 qk_nq
    s_add_u32 s29, s29, 4096
    v_mov_b32 v4, s22
    s_mov_b64 exec, s[34:35]
    buffer_store_dword v4, off, s[4:7], s29 sc1
    s_mov_b64 exec, -1
qk_nq:
    s_cmp_ge_u32 s36, 64
    s_cbranch_scc1 L_qkv_next
    s_lshr_b32 s33, s36, 5
    v_and_b32 v4, 63, v0
    v_lshrrev_b32 v5, 4, v4
    v_add_u32 v1, 0, v5
    v_mul_u32_u24 v6, 11, v1
    v_lshrrev_b32 v6, 5, v6
    v_add_u32 v1, v1, v6
    v_lshlrev_b32 v1, 7, v1
    v_and_b32 v6, 7, v4
    v_lshl_add_u32 v1, v6, 4, v1
    v_add_u32 v2, 4, v5
    v_mul_u32_u24 v6, 11, v2
    v_lshrrev_b32 v6, 5, v6
    v_add_u32 v2, v2, v6
    v_lshlrev_b32 v2, 7, v2
    v_and_b32 v6, 7, v4
    v_lshl_add_u32 v2, v6, 4, v2
    v_add_u32 v3, 8, v5
    v_mul_u32_u24 v6, 11, v3
    v_lshrrev_b32 v6, 5, v6
    v_add_u32 v3, v3, v6
    v_lshlrev_b32 v3, 7, v3
    v_and_b32 v6, 7, v4
    v_lshl_add_u32 v3, v6, 4, v3
    v_min_u32 v6, 23, v4
    v_lshlrev_b32 v6, 9, v6
    s_mov_b32 s19, s33
    s_mul_i32 s24, s19, 12288
    s_add_u32 s24, s24, 90177536
    s_lshl_b32 s26, s19, 5
    s_add_u32 s26, s26, s17
    s_lshl_b32 s26, s26, 12
    s_mov_b32 s21, 71303168
    s_cmp_eq_u32 s16, 2
    s_cselect_b32 s21, 80740352, s21
    s_add_u32 s26, s26, s21
    s_lshl_b32 s29, s17, 7
    s_lshl_b32 s21, s16, 1
    s_add_u32 s21, s21, s33
    s_lshl_b32 s21, s21, 2
    s_add_u32 s29, s29, s21
    s_add_u32 s29, s29, 125829240
mk_loop:
    s_cmp_lg_u32 s18, 0
    s_cbranch_scc1 mk_go
    s_mov_b32 s23, s24
    s_mov_b32 s21, 4194304
mk_wait:
    buffer_load_dword v4, v6, s[4:7], s23 offen offset:384 sc1
    s_sub_u32 s21, s21, 1
    s_cbranch_scc1 mk_go
    s_waitcnt vmcnt(0)
    v_cmp_ne_u32 vcc, s95, v4
    s_cbranch_vccz mk_go
    s_sleep 4
    s_branch mk_wait
mk_go:
    s_barrier
    s_mov_b32 s30, 4096
mk_again:
    v_mov_b32 v5, 0
    s_add_u32 s23, s24, 0
    buffer_load_dwordx4 v[24:27], v1, s[4:7], s23 offen offset:0 sc1
    buffer_load_dwordx4 v[28:31], v2, s[4:7], s23 offen offset:0 sc1
    buffer_load_dwordx4 v[32:35], v3, s[4:7], s23 offen offset:0 sc1
    buffer_load_dwordx4 v[36:39], v1, s[4:7], s23 offen offset:2048 sc1
    buffer_load_dwordx4 v[40:43], v2, s[4:7], s23 offen offset:2048 sc1
    buffer_load_dwordx4 v[44:47], v3, s[4:7], s23 offen offset:2048 sc1
    s_add_u32 s23, s24, 4096
    buffer_load_dwordx4 v[48:51], v1, s[4:7], s23 offen offset:0 sc1
    buffer_load_dwordx4 v[52:55], v2, s[4:7], s23 offen offset:0 sc1
    buffer_load_dwordx4 v[56:59], v3, s[4:7], s23 offen offset:0 sc1
    buffer_load_dwordx4 v[60:63], v1, s[4:7], s23 offen offset:2048 sc1
    buffer_load_dwordx4 v[208:211], v2, s[4:7], s23 offen offset:2048 sc1
    buffer_load_dwordx4 v[212:215], v3, s[4:7], s23 offen offset:2048 sc1
    s_add_u32 s23, s24, 8192
    buffer_load_dwordx4 v[216:219], v1, s[4:7], s23 offen offset:0 sc1
    buffer_load_dwordx4 v[220:223], v2, s[4:7], s23 offen offset:0 sc1
    buffer_load_dwordx4 v[224:227], v3, s[4:7], s23 offen offset:0 sc1
    buffer_load_dwordx4 v[228:231], v1, s[4:7], s23 offen offset:2048 sc1
    buffer_load_dwordx4 v[232:235], v2, s[4:7], s23 offen offset:2048 sc1
    buffer_load_dwordx4 v[236:239], v3, s[4:7], s23 offen offset:2048 sc1
    s_add_u32 s22, s19, s95
    s_add_u32 s22, s22, 1
    s_cmp_eq_u32 s16, 2
    s_cbranch_scc1 mk_v
    s_waitcnt vmcnt(17)
    v_mfma_f32_16x16x32_bf16 v[8:11], v[64:67], v[24:27], 0
    v_mfma_f32_16x16x32_bf16 v[12:15], v[136:139], v[24:27], 0
    v_max3_u32 v5, v5, v24, v25
    v_mfma_f32_16x16x32_bf16 v[16:19], a[0:3], v[24:27], 0
    v_mfma_f32_16x16x32_bf16 v[20:23], a[72:75], v[24:27], 0
    v_max3_u32 v5, v5, v26, v27
    s_waitcnt vmcnt(16)
    v_mfma_f32_16x16x32_bf16 v[8:11], v[68:71], v[28:31], v[8:11]
    v_mfma_f32_16x16x32_bf16 v[12:15], v[140:143], v[28:31], v[12:15]
    v_max3_u32 v5, v5, v28, v29
    v_mfma_f32_16x16x32_bf16 v[16:19], a[4:7], v[28:31], v[16:19]
    v_mfma_f32_16x16x32_bf16 v[20:23], a[76:79], v[28:31], v[20:23]
    v_max3_u32 v5, v5, v30, v31
    s_waitcnt vmcnt(15)
    v_mfma_f32_16x16x32_bf16 v[8:11], v[72:75], v[32:35], v[8:11]
    v_mfma_f32_16x16x32_bf16 v[12:15], v[144:147], v[32:35], v[12:15]
    v_max3_u32 v5, v5, v32, v33
    v_mfma_f32_16x16x32_bf16 v[16:19], a[8:11], v[32:35], v[16:19]
    v_mfma_f32_16x16x32_bf16 v[20:23], a[80:83], v[32:35], v[20:23]
    v_max3_u32 v5, v5, v34, v35
    s_waitcnt vmcnt(14)
    v_mfma_f32_16x16x32_bf16 v[8:11], v[76:79], v[36:39], v[8:11]
    v_mfma_f32_16x16x32_bf16 v[12:15], v[148:151], v[36:39], v[12:15]
    v_max3_u32 v5, v5, v36, v37
    v_mfma_f32_16x16x32_bf16 v[16:19], a[12:15], v[36:39], v[16:19]
    v_mfma_f32_16x16x32_bf16 v[20:23], a[84:87], v[36:39], v[20:23]
    v_max3_u32 v5, v5, v38, v39
    s_waitcnt vmcnt(13)
    v_mfma_f32_16x16x32_bf16 v[8:11], v[80:83], v[40:43], v[8:11]
    v_mfma_f32_16x16x32_bf16 v[12:15], v[152:155], v[40:43], v[12:15]
    v_max3_u32 v5, v5, v40, v41
    v_mfma_f32_16x16x32_bf16 v[16:19], a[16:19], v[40:43], v[16:19]
    v_mfma_f32_16x16x32_bf16 v[20:23], a[88:91], v[40:43], v[20:23]
    v_max3_u32 v5, v5, v42, v43
    s_waitcnt vmcnt(12)
    v_mfma_f32_16x16x32_bf16 v[8:11], v[84:87], v[44:47], v[8:11]
    v_mfma_f32_16x16x32_bf16 v[12:15], v[156:159], v[44:47], v[12:15]
    v_max3_u32 v5, v5, v44, v45
    v_mfma_f32_16x16x32_bf16 v[16:19], a[20:23], v[44:47], v[16:19]
    v_mfma_f32_16x16x32_bf16 v[20:23], a[92:95], v[44:47], v[20:23]
    v_max3_u32 v5, v5, v46, v47
    s_waitcnt vmcnt(11)
    v_mfma_f32_16x16x32_bf16 v[8:11], v[88:91], v[48:51], v[8:11]
    v_mfma_f32_16x16x32_bf16 v[12:15], v[160:163], v[48:51], v[12:15]
    v_max3_u32 v5, v5, v48, v49
    v_mfma_f32_16x16x32_bf16 v[16:19], a[24:27], v[48:51], v[16:19]
    v_mfma_f32_16x16x32_bf16 v[20:23], a[96:99], v[48:51], v[20:23]
    v_max3_u32 v5, v5, v50, v51
    s_waitcnt vmcnt(10)
    v_mfma_f32_16x16x32_bf16 v[8:11], v[92:95], v[52:55], v[8:11]
    v_mfma_f32_16x16x32_bf16 v[12:15], v[164:167], v[52:55], v[12:15]
    v_max3_u32 v5, v5, v52, v53
    v_mfma_f32_16x16x32_bf16 v[16:19], a[28:31], v[52:55], v[16:19]
    v_mfma_f32_16x16x32_bf16 v[20:23], a[100:103], v[52:55], v[20:23]
    v_max3_u32 v5, v5, v54, v55
    s_waitcnt vmcnt(9)
    v_mfma_f32_16x16x32_bf16 v[8:11], v[96:99], v[56:59], v[8:11]
    v_mfma_f32_16x16x32_bf16 v[12:15], v[168:171], v[56:59], v[12:15]
    v_max3_u32 v5, v5, v56, v57
    v_mfma_f32_16x16x32_bf16 v[16:19], a[32:35], v[56:59], v[16:19]
    v_mfma_f32_16x16x32_bf16 v[20:23], a[104:107], v[56:59], v[20:23]
    v_max3_u32 v5, v5, v58, v59
    s_waitcnt vmcnt(8)
    v_mfma_f32_16x16x32_bf16 v[8:11], v[100:103], v[60:63], v[8:11]
    v_mfma_f32_16x16x32_bf16 v[12:15], v[172:175], v[60:63], v[12:15]
    v_max3_u32 v5, v5, v60, v61
    v_mfma_f32_16x16x32_bf16 v[16:19], a[36:39], v[60:63], v[16:19]
    v_mfma_f32_16x16x32_bf16 v[20:23], a[108:111], v[60:63], v[20:23]
    v_max3_u32 v5, v5, v62, v63
    s_waitcnt vmcnt(7)
    v_mfma_f32_16x16x32_bf16 v[8:11], v[104:107], v[208:211], v[8:11]
    v_mfma_f32_16x16x32_bf16 v[12:15], v[176:179], v[208:211], v[12:15]
    v_max3_u32 v5, v5, v208, v209
    v_mfma_f32_16x16x32_bf16 v[16:19], a[40:43], v[208:211], v[16:19]
    v_mfma_f32_16x16x32_bf16 v[20:23], a[112:115], v[208:211], v[20:23]
    v_max3_u32 v5, v5, v210, v211
    s_waitcnt vmcnt(6)
    v_mfma_f32_16x16x32_bf16 v[8:11], v[108:111], v[212:215], v[8:11]
    v_mfma_f32_16x16x32_bf16 v[12:15], v[180:183], v[212:215], v[12:15]
    v_max3_u32 v5, v5, v212, v213
    v_mfma_f32_16x16x32_bf16 v[16:19], a[44:47], v[212:215], v[16:19]
    v_mfma_f32_16x16x32_bf16 v[20:23], a[116:119], v[212:215], v[20:23]
    v_max3_u32 v5, v5, v214, v215
    s_waitcnt vmcnt(5)
    v_mfma_f32_16x16x32_bf16 v[8:11], v[112:115], v[216:219], v[8:11]
    v_mfma_f32_16x16x32_bf16 v[12:15], v[184:187], v[216:219], v[12:15]
    v_max3_u32 v5, v5, v216, v217
    v_mfma_f32_16x16x32_bf16 v[16:19], a[48:51], v[216:219], v[16:19]
    v_mfma_f32_16x16x32_bf16 v[20:23], a[120:123], v[216:219], v[20:23]
    v_max3_u32 v5, v5, v218, v219
    s_waitcnt vmcnt(4)
    v_mfma_f32_16x16x32_bf16 v[8:11], v[116:119], v[220:223], v[8:11]
    v_mfma_f32_16x16x32_bf16 v[12:15], v[188:191], v[220:223], v[12:15]
    v_max3_u32 v5, v5, v220, v221
    v_mfma_f32_16x16x32_bf16 v[16:19], a[52:55], v[220:223], v[16:19]
    v_mfma_f32_16x16x32_bf16 v[20:23], a[124:127], v[220:223], v[20:23]
    v_max3_u32 v5, v5, v222, v223
    s_waitcnt vmcnt(3)
    v_mfma_f32_16x16x32_bf16 v[8:11], v[120:123], v[224:227], v[8:11]
    v_mfma_f32_16x16x32_bf16 v[12:15], v[192:195], v[224:227], v[12:15]
    v_max3_u32 v5, v5, v224, v225
    v_mfma_f32_16x16x32_bf16 v[16:19], a[56:59], v[224:227], v[16:19]
    v_mfma_f32_16x16x32_bf16 v[20:23], a[128:131], v[224:227], v[20:23]
    v_max3_u32 v5, v5, v226, v227
    s_waitcnt vmcnt(2)
    v_mfma_f32_16x16x32_bf16 v[8:11], v[124:127], v[228:231], v[8:11]
    v_mfma_f32_16x16x32_bf16 v[12:15], v[196:199], v[228:231], v[12:15]
    v_max3_u32 v5, v5, v228, v229
    v_mfma_f32_16x16x32_bf16 v[16:19], a[60:63], v[228:231], v[16:19]
    v_mfma_f32_16x16x32_bf16 v[20:23], a[132:135], v[228:231], v[20:23]
    v_max3_u32 v5, v5, v230, v231
    s_waitcnt vmcnt(1)
    v_mfma_f32_16x16x32_bf16 v[8:11], v[128:131], v[232:235], v[8:11]
    v_mfma_f32_16x16x32_bf16 v[12:15], v[200:203], v[232:235], v[12:15]
    v_max3_u32 v5, v5, v232, v233
    v_mfma_f32_16x16x32_bf16 v[16:19], a[64:67], v[232:235], v[16:19]
    v_mfma_f32_16x16x32_bf16 v[20:23], a[136:139], v[232:235], v[20:23]
    v_max3_u32 v5, v5, v234, v235
    s_waitcnt vmcnt(0)
    v_mfma_f32_16x16x32_bf16 v[8:11], v[132:135], v[236:239], v[8:11]
    v_mfma_f32_16x16x32_bf16 v[12:15], v[204:207], v[236:239], v[12:15]
    v_max3_u32 v5, v5, v236, v237
    v_mfma_f32_16x16x32_bf16 v[16:19], a[68:71], v[236:239], v[16:19]
    v_mfma_f32_16x16x32_bf16 v[20:23], a[140:143], v[236:239], v[20:23]
    v_max3_u32 v5, v5, v238, v239
    s_nop 5
    s_branch mk_st
mk_v:
    s_waitcnt vmcnt(17)
    v_mfma_f32_16x16x32_bf16 v[8:11], v[24:27], v[64:67], 0
    v_mfma_f32_16x16x32_bf16 v[12:15], v[24:27], v[136:139], 0
    v_max3_u32 v5, v5, v24, v25
    v_mfma_f32_16x16x32_bf16 v[16:19], v[24:27], a[0:3], 0
    v_mfma_f32_16x16x32_bf16 v[20:23], v[24:27], a[72:75], 0
    v_max3_u32 v5, v5, v26, v27
    s_waitcnt vmcnt(16)
    v_mfma_f32_16x16x32_bf16 v[8:11], v[28:31], v[68:71], v[8:11]
    v_mfma_f32_16x16x32_bf16 v[12:15], v[28:31], v[140:143], v[12:15]
    v_max3_u32 v5, v5, v28, v29
    v_mfma_f32_16x16x32_bf16 v[16:19], v[28:31], a[4:7], v[16:19]
    v_mfma_f32_16x16x32_bf16 v[20:23], v[28:31], a[76:79], v[20:23]
    v_max3_u32 v5, v5, v30, v31
    s_waitcnt vmcnt(15)
    v_mfma_f32_16x16x32_bf16 v[8:11], v[32:35], v[72:75], v[8:11]
    v_mfma_f32_16x16x32_bf16 v[12:15], v[32:35], v[144:147], v[12:15]
    v_max3_u32 v5, v5, v32, v33
    v_mfma_f32_16x16x32_bf16 v[16:19], v[32:35], a[8:11], v[16:19]
    v_mfma_f32_16x16x32_bf16 v[20:23], v[32:35], a[80:83], v[20:23]
    v_max3_u32 v5, v5, v34, v35
    s_waitcnt vmcnt(14)
    v_mfma_f32_16x16x32_bf16 v[8:11], v[36:39], v[76:79], v[8:11]
    v_mfma_f32_16x16x32_bf16 v[12:15], v[36:39], v[148:151], v[12:15]
    v_max3_u32 v5, v5, v36, v37
    v_mfma_f32_16x16x32_bf16 v[16:19], v[36:39], a[12:15], v[16:19]
    v_mfma_f32_16x16x32_bf16 v[20:23], v[36:39], a[84:87], v[20:23]
    v_max3_u32 v5, v5, v38, v39
    s_waitcnt vmcnt(13)
    v_mfma_f32_16x16x32_bf16 v[8:11], v[40:43], v[80:83], v[8:11]
    v_mfma_f32_16x16x32_bf16 v[12:15], v[40:43], v[152:155], v[12:15]
    v_max3_u32 v5, v5, v40, v41
    v_mfma_f32_16x16x32_bf16 v[16:19], v[40:43], a[16:19], v[16:19]
    v_mfma_f32_16x16x32_bf16 v[20:23], v[40:43], a[88:91], v[20:23]
    v_max3_u32 v5, v5, v42, v43
    s_waitcnt vmcnt(12)
    v_mfma_f32_16x16x32_bf16 v[8:11], v[44:47], v[84:87], v[8:11]
    v_mfma_f32_16x16x32_bf16 v[12:15], v[44:47], v[156:159], v[12:15]
    v_max3_u32 v5, v5, v44, v45
    v_mfma_f32_16x16x32_bf16 v[16:19], v[44:47], a[20:23], v[16:19]
    v_mfma_f32_16x16x32_bf16 v[20:23], v[44:47], a[92:95], v[20:23]
    v_max3_u32 v5, v5, v46, v47
    s_waitcnt vmcnt(11)
    v_mfma_f32_16x16x32_bf16 v[8:11], v[48:51], v[88:91], v[8:11]
    v_mfma_f32_16x16x32_bf16 v[12:15], v[48:51], v[160:163], v[12:15]
    v_max3_u32 v5, v5, v48, v49
    v_mfma_f32_16x16x32_bf16 v[16:19], v[48:51], a[24:27], v[16:19]
    v_mfma_f32_16x16x32_bf16 v[20:23], v[48:51], a[96:99], v[20:23]
    v_max3_u32 v5, v5, v50, v51
    s_waitcnt vmcnt(10)
    v_mfma_f32_16x16x32_bf16 v[8:11], v[52:55], v[92:95], v[8:11]
    v_mfma_f32_16x16x32_bf16 v[12:15], v[52:55], v[164:167], v[12:15]
    v_max3_u32 v5, v5, v52, v53
    v_mfma_f32_16x16x32_bf16 v[16:19], v[52:55], a[28:31], v[16:19]
    v_mfma_f32_16x16x32_bf16 v[20:23], v[52:55], a[100:103], v[20:23]
    v_max3_u32 v5, v5, v54, v55
    s_waitcnt vmcnt(9)
    v_mfma_f32_16x16x32_bf16 v[8:11], v[56:59], v[96:99], v[8:11]
    v_mfma_f32_16x16x32_bf16 v[12:15], v[56:59], v[168:171], v[12:15]
    v_max3_u32 v5, v5, v56, v57
    v_mfma_f32_16x16x32_bf16 v[16:19], v[56:59], a[32:35], v[16:19]
    v_mfma_f32_16x16x32_bf16 v[20:23], v[56:59], a[104:107], v[20:23]
    v_max3_u32 v5, v5, v58, v59
    s_waitcnt vmcnt(8)
    v_mfma_f32_16x16x32_bf16 v[8:11], v[60:63], v[100:103], v[8:11]
    v_mfma_f32_16x16x32_bf16 v[12:15], v[60:63], v[172:175], v[12:15]
    v_max3_u32 v5, v5, v60, v61
    v_mfma_f32_16x16x32_bf16 v[16:19], v[60:63], a[36:39], v[16:19]
    v_mfma_f32_16x16x32_bf16 v[20:23], v[60:63], a[108:111], v[20:23]
    v_max3_u32 v5, v5, v62, v63
    s_waitcnt vmcnt(7)
    v_mfma_f32_16x16x32_bf16 v[8:11], v[208:211], v[104:107], v[8:11]
    v_mfma_f32_16x16x32_bf16 v[12:15], v[208:211], v[176:179], v[12:15]
    v_max3_u32 v5, v5, v208, v209
    v_mfma_f32_16x16x32_bf16 v[16:19], v[208:211], a[40:43], v[16:19]
    v_mfma_f32_16x16x32_bf16 v[20:23], v[208:211], a[112:115], v[20:23]
    v_max3_u32 v5, v5, v210, v211
    s_waitcnt vmcnt(6)
    v_mfma_f32_16x16x32_bf16 v[8:11], v[212:215], v[108:111], v[8:11]
    v_mfma_f32_16x16x32_bf16 v[12:15], v[212:215], v[180:183], v[12:15]
    v_max3_u32 v5, v5, v212, v213
    v_mfma_f32_16x16x32_bf16 v[16:19], v[212:215], a[44:47], v[16:19]
    v_mfma_f32_16x16x32_bf16 v[20:23], v[212:215], a[116:119], v[20:23]
    v_max3_u32 v5, v5, v214, v215
    s_waitcnt vmcnt(5)
    v_mfma_f32_16x16x32_bf16 v[8:11], v[216:219], v[112:115], v[8:11]
    v_mfma_f32_16x16x32_bf16 v[12:15], v[216:219], v[184:187], v[12:15]
    v_max3_u32 v5, v5, v216, v217
    v_mfma_f32_16x16x32_bf16 v[16:19], v[216:219], a[48:51], v[16:19]
    v_mfma_f32_16x16x32_bf16 v[20:23], v[216:219], a[120:123], v[20:23]
    v_max3_u32 v5, v5, v218, v219
    s_waitcnt vmcnt(4)
    v_mfma_f32_16x16x32_bf16 v[8:11], v[220:223], v[116:119], v[8:11]
    v_mfma_f32_16x16x32_bf16 v[12:15], v[220:223], v[188:191], v[12:15]
    v_max3_u32 v5, v5, v220, v221
    v_mfma_f32_16x16x32_bf16 v[16:19], v[220:223], a[52:55], v[16:19]
    v_mfma_f32_16x16x32_bf16 v[20:23], v[220:223], a[124:127], v[20:23]
    v_max3_u32 v5, v5, v222, v223
    s_waitcnt vmcnt(3)
    v_mfma_f32_16x16x32_bf16 v[8:11], v[224:227], v[120:123], v[8:11]
    v_mfma_f32_16x16x32_bf16 v[12:15], v[224:227], v[192:195], v[12:15]
    v_max3_u32 v5, v5, v224, v225
    v_mfma_f32_16x16x32_bf16 v[16:19], v[224:227], a[56:59], v[16:19]
    v_mfma_f32_16x16x32_bf16 v[20:23], v[224:227], a[128:131], v[20:23]
    v_max3_u32 v5, v5, v226, v227
    s_waitcnt vmcnt(2)
    v_mfma_f32_16x16x32_bf16 v[8:11], v[228:231], v[124:127], v[8:11]
    v_mfma_f32_16x16x32_bf16 v[12:15], v[228:231], v[196:199], v[12:15]
    v_max3_u32 v5, v5, v228, v229
    v_mfma_f32_16x16x32_bf16 v[16:19], v[228:231], a[60:63], v[16:19]
    v_mfma_f32_16x16x32_bf16 v[20:23], v[228:231], a[132:135], v[20:23]
    v_max3_u32 v5, v5, v230, v231
    s_waitcnt vmcnt(1)
    v_mfma_f32_16x16x32_bf16 v[8:11], v[232:235], v[128:131], v[8:11]
    v_mfma_f32_16x16x32_bf16 v[12:15], v[232:235], v[200:203], v[12:15]
    v_max3_u32 v5, v5, v232, v233
    v_mfma_f32_16x16x32_bf16 v[16:19], v[232:235], a[64:67], v[16:19]
    v_mfma_f32_16x16x32_bf16 v[20:23], v[232:235], a[136:139], v[20:23]
    v_max3_u32 v5, v5, v234, v235
    s_waitcnt vmcnt(0)
    v_mfma_f32_16x16x32_bf16 v[8:11], v[236:239], v[132:135], v[8:11]
    v_mfma_f32_16x16x32_bf16 v[12:15], v[236:239], v[204:207], v[12:15]
    v_max3_u32 v5, v5, v236, v237
    v_mfma_f32_16x16x32_bf16 v[16:19], v[236:239], a[68:71], v[16:19]
    v_mfma_f32_16x16x32_bf16 v[20:23], v[236:239], a[140:143], v[20:23]
    v_max3_u32 v5, v5, v238, v239
    v_pk_mul_f32 v[8:9], v[8:9], 0.5 op_sel_hi:[1,0]
    v_pk_mul_f32 v[10:11], v[10:11], 0.5 op_sel_hi:[1,0]
    v_pk_mul_f32 v[12:13], v[12:13], 0.5 op_sel_hi:[1,0]
    v_pk_mul_f32 v[14:15], v[14:15], 0.5 op_sel_hi:[1,0]
    v_pk_mul_f32 v[16:17], v[16:17], 0.5 op_sel_hi:[1,0]
    v_pk_mul_f32 v[18:19], v[18:19], 0.5 op_sel_hi:[1,0]
    v_pk_mul_f32 v[20:21], v[20:21], 0.5 op_sel_hi:[1,0]
    v_pk_mul_f32 v[22:23], v[22:23], 0.5 op_sel_hi:[1,0]
    s_nop 1
mk_st:
    v_cmp_eq_u32 vcc, -1, v5
    s_sub_u32 s30, s30, 1
    s_cbranch_scc1 mk_ok
    s_cbranch_vccnz mk_again
mk_ok:
    s_add_u32 s24, s24, 24576
    v_cvt_pk_bf16_f32 v24, v8, v9
    v_cvt_pk_bf16_f32 v25, v10, v11
    v_cvt_pk_bf16_f32 v26, v12, v13
    v_cvt_pk_bf16_f32 v27, v14, v15
    v_cvt_pk_bf16_f32 v28, v16, v17
    v_cvt_pk_bf16_f32 v29, v18, v19
    v_cvt_pk_bf16_f32 v30, v20, v21
    v_cvt_pk_bf16_f32 v31, v22, v23
    s_add_u32 s21, s26, 4096
    buffer_store_dwordx4 v[24:27], v7, s[4:7], s26 offen sc1
    buffer_store_dwordx4 v[28:31], v7, s[4:7], s21 offen sc1
    s_waitcnt vmcnt(0)
    s_barrier
    v_mov_b32 v4, s22
    s_mov_b64 exec, s[34:35]
    buffer_store_dword v4, off, s[4:7], s29 sc1
    s_mov_b64 exec, -1
    s_add_u32 s19, s19, 2
    s_add_u32 s26, s26, 262144
    s_cmp_lt_u32 s19, 62
    s_cbranch_scc1 mk_loop
    s_endpgm
L_ssm_next:
    s_mov_b32 s37, 8
    v_mov_b32 v250, 1
    v_mov_b32 v251, 163832
    v_cmp_eq_u32 vcc, 0, v0
    s_nop 0
    s_and_saveexec_b64 s[38:39], vcc
    s_cbranch_execz tk8
    buffer_atomic_add v250, off, s[96:99], s37 sc0
    s_waitcnt vmcnt(0)
    ds_write_b32 v251, v250
    s_waitcnt lgkmcnt(0)
tk8:
    s_mov_b64 exec, -1
    s_barrier
    ds_read_b32 v252, v251
    s_waitcnt lgkmcnt(0)
    v_readfirstlane_b32 s20, v252
    s_barrier
    s_nop 3
    s_cmp_ge_u32 s20, 144
    s_cbranch_scc1 L_phase2
    s_lshl_b32 s20, s20, 2
    v_lshrrev_b32 v5, 6, v0
    s_nop 0
    v_readfirstlane_b32 s21, v5
    v_and_b32 v1, 63, v0
    v_and_b32 v2, 15, v1
    v_lshrrev_b32 v3, 4, v1
    v_lshlrev_b32 v4, 14, v5
    s_mov_b32 s8, s62
    s_mov_b32 s9, s63
    s_mov_b32 s10, 2359296
    s_mov_b32 s11, 0x20000
    s_mov_b32 s16, s76
    s_mov_b32 s17, s77
    s_mov_b32 s18, 4718592
    s_mov_b32 s19, 0x20000
    v_mul_u32_u24 v5, 9216, v0
    s_lshl_b32 s22, s20, 1
    s_add_u32 s23, s22, 0
    buffer_load_dwordx2 v[8:9], v5, s[8:11], s23 offen
    s_add_u32 s23, s22, 1152
    buffer_load_dwordx2 v[10:11], v5, s[8:11], s23 offen
    s_add_u32 s23, s22, 2304
    buffer_load_dwordx2 v[12:13], v5, s[8:11], s23 offen
    s_add_u32 s23, s22, 3456
    buffer_load_dwordx2 v[14:15], v5, s[8:11], s23 offen
    s_add_u32 s23, s22, 4608
    buffer_load_dwordx2 v[16:17], v5, s[8:11], s23 offen
    s_add_u32 s23, s22, 5760
    buffer_load_dwordx2 v[18:19], v5, s[8:11], s23 offen
    s_add_u32 s23, s22, 6912
    buffer_load_dwordx2 v[20:21], v5, s[8:11], s23 offen
    s_add_u32 s23, s22, 8064
    buffer_load_dwordx2 v[22:23], v5, s[8:11], s23 offen
    s_add_u32 s22, s20, s21
    s_lshl_b32 s23, s22, 8
    v_lshlrev_b32 v6, 3, v2
    v_lshl_add_u32 v6, v3, 1, v6
    s_mov_b32 s12, s64
    s_mov_b32 s13, s65
    s_mov_b32 s14, 147456
    s_mov_b32 s15, 0x20000
    buffer_load_ushort v24, v6, s[12:15], s23 offen offset:0
    buffer_load_ushort v28, v6, s[12:15], s23 offen offset:128
    s_mov_b32 s12, s66
    s_mov_b32 s13, s67
    s_mov_b32 s14, 147456
    s_mov_b32 s15, 0x20000
    buffer_load_ushort v25, v6, s[12:15], s23 offen offset:0
    buffer_load_ushort v29, v6, s[12:15], s23 offen offset:128
    s_mov_b32 s12, s68
    s_mov_b32 s13, s69
    s_mov_b32 s14, 147456
    s_mov_b32 s15, 0x20000
    buffer_load_ushort v26, v6, s[12:15], s23 offen offset:0
    buffer_load_ushort v30, v6, s[12:15], s23 offen offset:128
    s_mov_b32 s12, s70
    s_mov_b32 s13, s71
    s_mov_b32 s14, 147456
    s_mov_b32 s15, 0x20000
    buffer_load_ushort v27, v6, s[12:15], s23 offen offset:0
    buffer_load_ushort v31, v6, s[12:15], s23 offen offset:128
    s_mov_b32 s12, s72
    s_mov_b32 s13, s73
    s_mov_b32 s14, 1152
    s_mov_b32 s15, 0x20000
    s_lshl_b32 s23, s22, 1
    buffer_load_ushort v32, off, s[12:15], s23
    s_mov_b32 s26, 0x3fb8aa3b
    s_mov_b32 s27, 0x3e22f983
    v_mov_b32 v34, 0
    v_mov_b32 v35, 0
    v_lshl_add_u32 v6, v1, 3, v4
    ds_write_b64 v6, v[34:35] offset:0
    s_waitcnt vmcnt(0)
    v_mov_b32 v36, 0x05040100
    v_mov_b32 v37, 0x07060302
    v_lshlrev_b32 v6, 4, v0
    v_perm_b32 v40, v10, v8, v36
    v_perm_b32 v41, v14, v12, v36
    v_perm_b32 v42, v18, v16, v36
    v_perm_b32 v43, v22, v20, v36
    ds_write_b128 v6, v[40:43] offset:512
    s_nop 1
    v_perm_b32 v40, v10, v8, v37
    v_perm_b32 v41, v14, v12, v37
    v_perm_b32 v42, v18, v16, v37
    v_perm_b32 v43, v22, v20, v37
    ds_write_b128 v6, v[40:43] offset:16896
    s_nop 1
    v_perm_b32 v40, v11, v9, v36
    v_perm_b32 v41, v15, v13, v36
    v_perm_b32 v42, v19, v17, v36
    v_perm_b32 v43, v23, v21, v36
    ds_write_b128 v6, v[40:43] offset:33280
    s_nop 1
    v_perm_b32 v40, v11, v9, v37
    v_perm_b32 v41, v15, v13, v37
    v_perm_b32 v42, v19, v17, v37
    v_perm_b32 v43, v23, v21, v37
    ds_write_b128 v6, v[40:43] offset:49664
    s_nop 1
    v_lshlrev_b32 v32, 16, v32
    v_mul_f32 v32, s26, v32
    v_exp_f32 v32, v32
    s_nop 0
    v_cvt_pk_bf16_f32 v32, v32, v32
    v_and_b32 v32, 0xffff0000, v32
    v_add_f32 v33, v32, v32
    v_lshlrev_b32 v24, 16, v24
    v_mul_f32 v24, s26, v24
    v_exp_f32 v24, v24
    s_nop 0
    v_cvt_pk_bf16_f32 v24, v24, v24
    v_and_b32 v24, 0xffff0000, v24
    v_mul_f32 v24, v24, v32
    v_mul_f32 v24, s26, v24
    v_sub_f32 v24, 0, v24
    v_lshlrev_b32 v25, 16, v25
    v_mul_f32 v25, v25, v32
    v_mul_f32 v25, s27, v25
    v_lshlrev_b32 v26, 16, v26
    v_mul_f32 v26, v26, v33
    v_lshlrev_b32 v27, 16, v27
    v_mul_f32 v27, v27, v33
    v_lshlrev_b32 v28, 16, v28
    v_mul_f32 v28, s26, v28
    v_exp_f32 v28, v28
    s_nop 0
    v_cvt_pk_bf16_f32 v28, v28, v28
    v_and_b32 v28, 0xffff0000, v28
    v_mul_f32 v28, v28, v32
    v_mul_f32 v28, s26, v28
    v_sub_f32 v28, 0, v28
    v_lshlrev_b32 v29, 16, v29
    v_mul_f32 v29, v29, v32
    v_mul_f32 v29, s27, v29
    v_lshlrev_b32 v30, 16, v30
    v_mul_f32 v30, v30, v33
    v_lshlrev_b32 v31, 16, v31
    v_mul_f32 v31, v31, v33
    v_cvt_f32_u32 v47, v2
    v_mul_f32 v44, 0x41800000, v47
    v_and_b32 v5, 7, v2
    v_add_u32 v5, 8, v5
    v_cvt_f32_u32 v5, v5
    v_mul_f32 v45, 0x42000000, v5
    v_mul_f32 v6, 0x42800000, v5
    v_cmp_lt_u32 vcc, 7, v2
    s_nop 1
    v_cndmask_b32 v45, v45, v6, vcc
    v_add_f32 v5, 0x41000000, v47
    v_mul_f32 v46, 0x43000000, v5
    v_mov_b32 v48, 0
    v_mov_b32 v49, 0
    v_mov_b32 v50, 0
    v_mov_b32 v51, 0
    v_mov_b32 v52, 0
    v_mov_b32 v53, 0
    v_mov_b32 v54, 0
    v_mov_b32 v55, 0
    v_mov_b32 v56, 0
    v_mov_b32 v57, 0
    v_mov_b32 v58, 0
    v_mov_b32 v59, 0
    v_mov_b32 v60, 0
    v_mov_b32 v61, 0
    v_mov_b32 v62, 0
    v_mov_b32 v63, 0
    v_mov_b32_dpp v64, v24 row_newbcast:0 row_mask:0xf bank_mask:0xf
    v_mov_b32_dpp v65, v25 row_newbcast:0 row_mask:0xf bank_mask:0xf
    v_mov_b32_dpp v66, v26 row_newbcast:0 row_mask:0xf bank_mask:0xf
    v_mov_b32_dpp v67, v27 row_newbcast:0 row_mask:0xf bank_mask:0xf
    v_mul_f32 v82, v64, v47
    v_mul_f32 v83, v65, v47
    v_exp_f32 v82, v82
    v_fract_f32 v83, v83
    v_cos_f32 v74, v83
    v_sin_f32 v75, v83
    v_mul_f32 v74, v74, v82
    v_mul_f32 v75, v75, v82
    v_mul_f32 v84, v75, v75
    v_add_f32 v85, v74, v74
    v_fma_f32 v76, v74, v74, -v84
    v_mul_f32 v77, v85, v75
    v_mul_f32 v84, v77, v77
    v_add_f32 v85, v76, v76
    v_fma_f32 v78, v76, v76, -v84
    v_mul_f32 v79, v85, v77
    v_mul_f32 v84, v79, v79
    v_add_f32 v85, v78, v78
    v_fma_f32 v80, v78, v78, -v84
    v_mul_f32 v81, v85, v79
    v_mul_f32 v82, v64, v44
    v_mul_f32 v83, v65, v44
    v_exp_f32 v82, v82
    v_fract_f32 v83, v83
    v_cos_f32 v68, v83
    v_sin_f32 v69, v83
    v_mul_f32 v68, v68, v82
    v_mul_f32 v69, v69, v82
    v_mul_f32 v84, v67, v69
    v_mul_f32 v85, v67, v68
    v_fma_f32 v68, v66, v68, -v84
    v_fma_f32 v69, -v66, v69, -v85
    v_mul_f32 v82, v64, v45
    v_mul_f32 v83, v65, v45
    v_exp_f32 v82, v82
    v_fract_f32 v83, v83
    v_cos_f32 v70, v83
    v_sin_f32 v71, v83
    v_mul_f32 v70, v70, v82
    v_mul_f32 v71, v71, v82
    v_mul_f32 v84, v67, v71
    v_mul_f32 v85, v67, v70
    v_fma_f32 v70, v66, v70, -v84
    v_fma_f32 v71, -v66, v71, -v85
    v_mul_f32 v82, v64, v46
    v_mul_f32 v83, v65, v46
    v_exp_f32 v82, v82
    v_fract_f32 v83, v83
    v_cos_f32 v72, v83
    v_sin_f32 v73, v83
    v_mul_f32 v72, v72, v82
    v_mul_f32 v73, v73, v82
    v_mul_f32 v84, v67, v73
    v_mul_f32 v85, v67, v72
    v_fma_f32 v72, v66, v72, -v84
    v_fma_f32 v73, -v66, v73, -v85
    v_mfma_f32_16x16x4_f32 v[48:51], v68, v74, v[48:51]
    v_mfma_f32_16x16x4_f32 v[52:55], v70, v76, v[52:55]
    v_mfma_f32_16x16x4_f32 v[56:59], v70, v78, v[56:59]
    v_mfma_f32_16x16x4_f32 v[60:63], v72, v80, v[60:63]
    v_mfma_f32_16x16x4_f32 v[48:51], v69, v75, v[48:51]
    v_mfma_f32_16x16x4_f32 v[52:55], v71, v77, v[52:55]
    v_mfma_f32_16x16x4_f32 v[56:59], v71, v79, v[56:59]
    v_mfma_f32_16x16x4_f32 v[60:63], v73, v81, v[60:63]
    v_mov_b32_dpp v64, v24 row_newbcast:1 row_mask:0xf bank_mask:0xf
    v_mov_b32_dpp v65, v25 row_newbcast:1 row_mask:0xf bank_mask:0xf
    v_mov_b32_dpp v66, v26 row_newbcast:1 row_mask:0xf bank_mask:0xf
    v_mov_b32_dpp v67, v27 row_newbcast:1 row_mask:0xf bank_mask:0xf
    v_mul_f32 v82, v64, v47
    v_mul_f32 v83, v65, v47
    v_exp_f32 v82, v82
    v_fract_f32 v83, v83
    v_cos_f32 v74, v83
    v_sin_f32 v75, v83
    v_mul_f32 v74, v74, v82
    v_mul_f32 v75, v75, v82
    v_mul_f32 v84, v75, v75
    v_add_f32 v85, v74, v74
    v_fma_f32 v76, v74, v74, -v84
    v_mul_f32 v77, v85, v75
    v_mul_f32 v84, v77, v77
    v_add_f32 v85, v76, v76
    v_fma_f32 v78, v76, v76, -v84
    v_mul_f32 v79, v85, v77
    v_mul_f32 v84, v79, v79
    v_add_f32 v85, v78, v78
    v_fma_f32 v80, v78, v78, -v84
    v_mul_f32 v81, v85, v79
    v_mul_f32 v82, v64, v44
    v_mul_f32 v83, v65, v44
    v_exp_f32 v82, v82
    v_fract_f32 v83, v83
    v_cos_f32 v68, v83
    v_sin_f32 v69, v83
    v_mul_f32 v68, v68, v82
    v_mul_f32 v69, v69, v82
    v_mul_f32 v84, v67, v69
    v_mul_f32 v85, v67, v68
    v_fma_f32 v68, v66, v68, -v84
    v_fma_f32 v69, -v66, v69, -v85
    v_mul_f32 v82, v64, v45
    v_mul_f32 v83, v65, v45
    v_exp_f32 v82, v82
    v_fract_f32 v83, v83
    v_cos_f32 v70, v83
    v_sin_f32 v71, v83
    v_mul_f32 v70, v70, v82
    v_mul_f32 v71, v71, v82
    v_mul_f32 v84, v67, v71
    v_mul_f32 v85, v67, v70
    v_fma_f32 v70, v66, v70, -v84
    v_fma_f32 v71, -v66, v71, -v85
    v_mul_f32 v82, v64, v46
    v_mul_f32 v83, v65, v46
    v_exp_f32 v82, v82
    v_fract_f32 v83, v83
    v_cos_f32 v72, v83
    v_sin_f32 v73, v83
    v_mul_f32 v72, v72, v82
    v_mul_f32 v73, v73, v82
    v_mul_f32 v84, v67, v73
    v_mul_f32 v85, v67, v72
    v_fma_f32 v72, v66, v72, -v84
    v_fma_f32 v73, -v66, v73, -v85
    v_mfma_f32_16x16x4_f32 v[48:51], v68, v74, v[48:51]
    v_mfma_f32_16x16x4_f32 v[52:55], v70, v76, v[52:55]
    v_mfma_f32_16x16x4_f32 v[56:59], v70, v78, v[56:59]
    v_mfma_f32_16x16x4_f32 v[60:63], v72, v80, v[60:63]
    v_mfma_f32_16x16x4_f32 v[48:51], v69, v75, v[48:51]
    v_mfma_f32_16x16x4_f32 v[52:55], v71, v77, v[52:55]
    v_mfma_f32_16x16x4_f32 v[56:59], v71, v79, v[56:59]
    v_mfma_f32_16x16x4_f32 v[60:63], v73, v81, v[60:63]
    v_mov_b32_dpp v64, v24 row_newbcast:2 row_mask:0xf bank_mask:0xf
    v_mov_b32_dpp v65, v25 row_newbcast:2 row_mask:0xf bank_mask:0xf
    v_mov_b32_dpp v66, v26 row_newbcast:2 row_mask:0xf bank_mask:0xf
    v_mov_b32_dpp v67, v27 row_newbcast:2 row_mask:0xf bank_mask:0xf
    v_mul_f32 v82, v64, v47
    v_mul_f32 v83, v65, v47
    v_exp_f32 v82, v82
    v_fract_f32 v83, v83
    v_cos_f32 v74, v83
    v_sin_f32 v75, v83
    v_mul_f32 v74, v74, v82
    v_mul_f32 v75, v75, v82
    v_mul_f32 v84, v75, v75
    v_add_f32 v85, v74, v74
    v_fma_f32 v76, v74, v74, -v84
    v_mul_f32 v77, v85, v75
    v_mul_f32 v84, v77, v77
    v_add_f32 v85, v76, v76
    v_fma_f32 v78, v76, v76, -v84
    v_mul_f32 v79, v85, v77
    v_mul_f32 v84, v79, v79
    v_add_f32 v85, v78, v78
    v_fma_f32 v80, v78, v78, -v84
    v_mul_f32 v81, v85, v79
    v_mul_f32 v82, v64, v44
    v_mul_f32 v83, v65, v44
    v_exp_f32 v82, v82
    v_fract_f32 v83, v83
    v_cos_f32 v68, v83
    v_sin_f32 v69, v83
    v_mul_f32 v68, v68, v82
    v_mul_f32 v69, v69, v82
    v_mul_f32 v84, v67, v69
    v_mul_f32 v85, v67, v68
    v_fma_f32 v68, v66, v68, -v84
    v_fma_f32 v69, -v66, v69, -v85
    v_mul_f32 v82, v64, v45
    v_mul_f32 v83, v65, v45
    v_exp_f32 v82, v82
    v_fract_f32 v83, v83
    v_cos_f32 v70, v83
    v_sin_f32 v71, v83
    v_mul_f32 v70, v70, v82
    v_mul_f32 v71, v71, v82
    v_mul_f32 v84, v67, v71
    v_mul_f32 v85, v67, v70
    v_fma_f32 v70, v66, v70, -v84
    v_fma_f32 v71, -v66, v71, -v85
    v_mul_f32 v82, v64, v46
    v_mul_f32 v83, v65, v46
    v_exp_f32 v82, v82
    v_fract_f32 v83, v83
    v_cos_f32 v72, v83
    v_sin_f32 v73, v83
    v_mul_f32 v72, v72, v82
    v_mul_f32 v73, v73, v82
    v_mul_f32 v84, v67, v73
    v_mul_f32 v85, v67, v72
    v_fma_f32 v72, v66, v72, -v84
    v_fma_f32 v73, -v66, v73, -v85
    v_mfma_f32_16x16x4_f32 v[48:51], v68, v74, v[48:51]
    v_mfma_f32_16x16x4_f32 v[52:55], v70, v76, v[52:55]
    v_mfma_f32_16x16x4_f32 v[56:59], v70, v78, v[56:59]
    v_mfma_f32_16x16x4_f32 v[60:63], v72, v80, v[60:63]
    v_mfma_f32_16x16x4_f32 v[48:51], v69, v75, v[48:51]
    v_mfma_f32_16x16x4_f32 v[52:55], v71, v77, v[52:55]
    v_mfma_f32_16x16x4_f32 v[56:59], v71, v79, v[56:59]
    v_mfma_f32_16x16x4_f32 v[60:63], v73, v81, v[60:63]
    v_mov_b32_dpp v64, v24 row_newbcast:3 row_mask:0xf bank_mask:0xf
    v_mov_b32_dpp v65, v25 row_newbcast:3 row_mask:0xf bank_mask:0xf
    v_mov_b32_dpp v66, v26 row_newbcast:3 row_mask:0xf bank_mask:0xf
    v_mov_b32_dpp v67, v27 row_newbcast:3 row_mask:0xf bank_mask:0xf
    v_mul_f32 v82, v64, v47
    v_mul_f32 v83, v65, v47
    v_exp_f32 v82, v82
    v_fract_f32 v83, v83
    v_cos_f32 v74, v83
    v_sin_f32 v75, v83
    v_mul_f32 v74, v74, v82
    v_mul_f32 v75, v75, v82
    v_mul_f32 v84, v75, v75
    v_add_f32 v85, v74, v74
    v_fma_f32 v76, v74, v74, -v84
    v_mul_f32 v77, v85, v75
    v_mul_f32 v84, v77, v77
    v_add_f32 v85, v76, v76
    v_fma_f32 v78, v76, v76, -v84
    v_mul_f32 v79, v85, v77
    v_mul_f32 v84, v79, v79
    v_add_f32 v85, v78, v78
    v_fma_f32 v80, v78, v78, -v84
    v_mul_f32 v81, v85, v79
    v_mul_f32 v82, v64, v44
    v_mul_f32 v83, v65, v44
    v_exp_f32 v82, v82
    v_fract_f32 v83, v83
    v_cos_f32 v68, v83
    v_sin_f32 v69, v83
    v_mul_f32 v68, v68, v82
    v_mul_f32 v69, v69, v82
    v_mul_f32 v84, v67, v69
    v_mul_f32 v85, v67, v68
    v_fma_f32 v68, v66, v68, -v84
    v_fma_f32 v69, -v66, v69, -v85
    v_mul_f32 v82, v64, v45
    v_mul_f32 v83, v65, v45
    v_exp_f32 v82, v82
    v_fract_f32 v83, v83
    v_cos_f32 v70, v83
    v_sin_f32 v71, v83
    v_mul_f32 v70, v70, v82
    v_mul_f32 v71, v71, v82
    v_mul_f32 v84, v67, v71
    v_mul_f32 v85, v67, v70
    v_fma_f32 v70, v66, v70, -v84
    v_fma_f32 v71, -v66, v71, -v85
    v_mul_f32 v82, v64, v46
    v_mul_f32 v83, v65, v46
    v_exp_f32 v82, v82
    v_fract_f32 v83, v83
    v_cos_f32 v72, v83
    v_sin_f32 v73, v83
    v_mul_f32 v72, v72, v82
    v_mul_f32 v73, v73, v82
    v_mul_f32 v84, v67, v73
    v_mul_f32 v85, v67, v72
    v_fma_f32 v72, v66, v72, -v84
    v_fma_f32 v73, -v66, v73, -v85
    v_mfma_f32_16x16x4_f32 v[48:51], v68, v74, v[48:51]
    v_mfma_f32_16x16x4_f32 v[52:55], v70, v76, v[52:55]
    v_mfma_f32_16x16x4_f32 v[56:59], v70, v78, v[56:59]
    v_mfma_f32_16x16x4_f32 v[60:63], v72, v80, v[60:63]
    v_mfma_f32_16x16x4_f32 v[48:51], v69, v75, v[48:51]
    v_mfma_f32_16x16x4_f32 v[52:55], v71, v77, v[52:55]
    v_mfma_f32_16x16x4_f32 v[56:59], v71, v79, v[56:59]
    v_mfma_f32_16x16x4_f32 v[60:63], v73, v81, v[60:63]
    v_mov_b32_dpp v64, v24 row_newbcast:4 row_mask:0xf bank_mask:0xf
    v_mov_b32_dpp v65, v25 row_newbcast:4 row_mask:0xf bank_mask:0xf
    v_mov_b32_dpp v66, v26 row_newbcast:4 row_mask:0xf bank_mask:0xf
    v_mov_b32_dpp v67, v27 row_newbcast:4 row_mask:0xf bank_mask:0xf
    v_mul_f32 v82, v64, v47
    v_mul_f32 v83, v65, v47
    v_exp_f32 v82, v82
    v_fract_f32 v83, v83
    v_cos_f32 v74, v83
    v_sin_f32 v75, v83
    v_mul_f32 v74, v74, v82
    v_mul_f32 v75, v75, v82
    v_mul_f32 v84, v75, v75
    v_add_f32 v85, v74, v74
    v_fma_f32 v76, v74, v74, -v84
    v_mul_f32 v77, v85, v75
    v_mul_f32 v84, v77, v77
    v_add_f32 v85, v76, v76
    v_fma_f32 v78, v76, v76, -v84
    v_mul_f32 v79, v85, v77
    v_mul_f32 v84, v79, v79
    v_add_f32 v85, v78, v78
    v_fma_f32 v80, v78, v78, -v84
    v_mul_f32 v81, v85, v79
    v_mul_f32 v82, v64, v44
    v_mul_f32 v83, v65, v44
    v_exp_f32 v82, v82
    v_fract_f32 v83, v83
    v_cos_f32 v68, v83
    v_sin_f32 v69, v83
    v_mul_f32 v68, v68, v82
    v_mul_f32 v69, v69, v82
    v_mul_f32 v84, v67, v69
    v_mul_f32 v85, v67, v68
    v_fma_f32 v68, v66, v68, -v84
    v_fma_f32 v69, -v66, v69, -v85
    v_mul_f32 v82, v64, v45
    v_mul_f32 v83, v65, v45
    v_exp_f32 v82, v82
    v_fract_f32 v83, v83
    v_cos_f32 v70, v83
    v_sin_f32 v71, v83
    v_mul_f32 v70, v70, v82
    v_mul_f32 v71, v71, v82
    v_mul_f32 v84, v67, v71
    v_mul_f32 v85, v67, v70
    v_fma_f32 v70, v66, v70, -v84
    v_fma_f32 v71, -v66, v71, -v85
    v_mul_f32 v82, v64, v46
    v_mul_f32 v83, v65, v46
    v_exp_f32 v82, v82
    v_fract_f32 v83, v83
    v_cos_f32 v72, v83
    v_sin_f32 v73, v83
    v_mul_f32 v72, v72, v82
    v_mul_f32 v73, v73, v82
    v_mul_f32 v84, v67, v73
    v_mul_f32 v85, v67, v72
    v_fma_f32 v72, v66, v72, -v84
    v_fma_f32 v73, -v66, v73, -v85
    v_mfma_f32_16x16x4_f32 v[48:51], v68, v74, v[48:51]
    v_mfma_f32_16x16x4_f32 v[52:55], v70, v76, v[52:55]
    v_mfma_f32_16x16x4_f32 v[56:59], v70, v78, v[56:59]
    v_mfma_f32_16x16x4_f32 v[60:63], v72, v80, v[60:63]
    v_mfma_f32_16x16x4_f32 v[48:51], v69, v75, v[48:51]
    v_mfma_f32_16x16x4_f32 v[52:55], v71, v77, v[52:55]
    v_mfma_f32_16x16x4_f32 v[56:59], v71, v79, v[56:59]
    v_mfma_f32_16x16x4_f32 v[60:63], v73, v81, v[60:63]
    v_mov_b32_dpp v64, v24 row_newbcast:5 row_mask:0xf bank_mask:0xf
    v_mov_b32_dpp v65, v25 row_newbcast:5 row_mask:0xf bank_mask:0xf
    v_mov_b32_dpp v66, v26 row_newbcast:5 row_mask:0xf bank_mask:0xf
    v_mov_b32_dpp v67, v27 row_newbcast:5 row_mask:0xf bank_mask:0xf
    v_mul_f32 v82, v64, v47
    v_mul_f32 v83, v65, v47
    v_exp_f32 v82, v82
    v_fract_f32 v83, v83
    v_cos_f32 v74, v83
    v_sin_f32 v75, v83
    v_mul_f32 v74, v74, v82
    v_mul_f32 v75, v75, v82
    v_mul_f32 v84, v75, v75
    v_add_f32 v85, v74, v74
    v_fma_f32 v76, v74, v74, -v84
    v_mul_f32 v77, v85, v75
    v_mul_f32 v84, v77, v77
    v_add_f32 v85, v76, v76
    v_fma_f32 v78, v76, v76, -v84
    v_mul_f32 v79, v85, v77
    v_mul_f32 v84, v79, v79
    v_add_f32 v85, v78, v78
    v_fma_f32 v80, v78, v78, -v84
    v_mul_f32 v81, v85, v79
    v_mul_f32 v82, v64, v44
    v_mul_f32 v83, v65, v44
    v_exp_f32 v82, v82
    v_fract_f32 v83, v83
    v_cos_f32 v68, v83
    v_sin_f32 v69, v83
    v_mul_f32 v68, v68, v82
    v_mul_f32 v69, v69, v82
    v_mul_f32 v84, v67, v69
    v_mul_f32 v85, v67, v68
    v_fma_f32 v68, v66, v68, -v84
    v_fma_f32 v69, -v66, v69, -v85
    v_mul_f32 v82, v64, v45
    v_mul_f32 v83, v65, v45
    v_exp_f32 v82, v82
    v_fract_f32 v83, v83
    v_cos_f32 v70, v83
    v_sin_f32 v71, v83
    v_mul_f32 v70, v70, v82
    v_mul_f32 v71, v71, v82
    v_mul_f32 v84, v67, v71
    v_mul_f32 v85, v67, v70
    v_fma_f32 v70, v66, v70, -v84
    v_fma_f32 v71, -v66, v71, -v85
    v_mul_f32 v82, v64, v46
    v_mul_f32 v83, v65, v46
    v_exp_f32 v82, v82
    v_fract_f32 v83, v83
    v_cos_f32 v72, v83
    v_sin_f32 v73, v83
    v_mul_f32 v72, v72, v82
    v_mul_f32 v73, v73, v82
    v_mul_f32 v84, v67, v73
    v_mul_f32 v85, v67, v72
    v_fma_f32 v72, v66, v72, -v84
    v_fma_f32 v73, -v66, v73, -v85
    v_mfma_f32_16x16x4_f32 v[48:51], v68, v74, v[48:51]
    v_mfma_f32_16x16x4_f32 v[52:55], v70, v76, v[52:55]
    v_mfma_f32_16x16x4_f32 v[56:59], v70, v78, v[56:59]
    v_mfma_f32_16x16x4_f32 v[60:63], v72, v80, v[60:63]
    v_mfma_f32_16x16x4_f32 v[48:51], v69, v75, v[48:51]
    v_mfma_f32_16x16x4_f32 v[52:55], v71, v77, v[52:55]
    v_mfma_f32_16x16x4_f32 v[56:59], v71, v79, v[56:59]
    v_mfma_f32_16x16x4_f32 v[60:63], v73, v81, v[60:63]
    v_mov_b32_dpp v64, v24 row_newbcast:6 row_mask:0xf bank_mask:0xf
    v_mov_b32_dpp v65, v25 row_newbcast:6 row_mask:0xf bank_mask:0xf
    v_mov_b32_dpp v66, v26 row_newbcast:6 row_mask:0xf bank_mask:0xf
    v_mov_b32_dpp v67, v27 row_newbcast:6 row_mask:0xf bank_mask:0xf
    v_mul_f32 v82, v64, v47
    v_mul_f32 v83, v65, v47
    v_exp_f32 v82, v82
    v_fract_f32 v83, v83
    v_cos_f32 v74, v83
    v_sin_f32 v75, v83
    v_mul_f32 v74, v74, v82
    v_mul_f32 v75, v75, v82
    v_mul_f32 v84, v75, v75
    v_add_f32 v85, v74, v74
    v_fma_f32 v76, v74, v74, -v84
    v_mul_f32 v77, v85, v75
    v_mul_f32 v84, v77, v77
    v_add_f32 v85, v76, v76
    v_fma_f32 v78, v76, v76, -v84
    v_mul_f32 v79, v85, v77
    v_mul_f32 v84, v79, v79
    v_add_f32 v85, v78, v78
    v_fma_f32 v80, v78, v78, -v84
    v_mul_f32 v81, v85, v79
    v_mul_f32 v82, v64, v44
    v_mul_f32 v83, v65, v44
    v_exp_f32 v82, v82
    v_fract_f32 v83, v83
    v_cos_f32 v68, v83
    v_sin_f32 v69, v83
    v_mul_f32 v68, v68, v82
    v_mul_f32 v69, v69, v82
    v_mul_f32 v84, v67, v69
    v_mul_f32 v85, v67, v68
    v_fma_f32 v68, v66, v68, -v84
    v_fma_f32 v69, -v66, v69, -v85
    v_mul_f32 v82, v64, v45
    v_mul_f32 v83, v65, v45
    v_exp_f32 v82, v82
    v_fract_f32 v83, v83
    v_cos_f32 v70, v83
    v_sin_f32 v71, v83
    v_mul_f32 v70, v70, v82
    v_mul_f32 v71, v71, v82
    v_mul_f32 v84, v67, v71
    v_mul_f32 v85, v67, v70
    v_fma_f32 v70, v66, v70, -v84
    v_fma_f32 v71, -v66, v71, -v85
    v_mul_f32 v82, v64, v46
    v_mul_f32 v83, v65, v46
    v_exp_f32 v82, v82
    v_fract_f32 v83, v83
    v_cos_f32 v72, v83
    v_sin_f32 v73, v83
    v_mul_f32 v72, v72, v82
    v_mul_f32 v73, v73, v82
    v_mul_f32 v84, v67, v73
    v_mul_f32 v85, v67, v72
    v_fma_f32 v72, v66, v72, -v84
    v_fma_f32 v73, -v66, v73, -v85
    v_mfma_f32_16x16x4_f32 v[48:51], v68, v74, v[48:51]
    v_mfma_f32_16x16x4_f32 v[52:55], v70, v76, v[52:55]
    v_mfma_f32_16x16x4_f32 v[56:59], v70, v78, v[56:59]
    v_mfma_f32_16x16x4_f32 v[60:63], v72, v80, v[60:63]
    v_mfma_f32_16x16x4_f32 v[48:51], v69, v75, v[48:51]
    v_mfma_f32_16x16x4_f32 v[52:55], v71, v77, v[52:55]
    v_mfma_f32_16x16x4_f32 v[56:59], v71, v79, v[56:59]
    v_mfma_f32_16x16x4_f32 v[60:63], v73, v81, v[60:63]
    v_mov_b32_dpp v64, v24 row_newbcast:7 row_mask:0xf bank_mask:0xf
    v_mov_b32_dpp v65, v25 row_newbcast:7 row_mask:0xf bank_mask:0xf
    v_mov_b32_dpp v66, v26 row_newbcast:7 row_mask:0xf bank_mask:0xf
    v_mov_b32_dpp v67, v27 row_newbcast:7 row_mask:0xf bank_mask:0xf
    v_mul_f32 v82, v64, v47
    v_mul_f32 v83, v65, v47
    v_exp_f32 v82, v82
    v_fract_f32 v83, v83
    v_cos_f32 v74, v83
    v_sin_f32 v75, v83
    v_mul_f32 v74, v74, v82
    v_mul_f32 v75, v75, v82
    v_mul_f32 v84, v75, v75
    v_add_f32 v85, v74, v74
    v_fma_f32 v76, v74, v74, -v84
    v_mul_f32 v77, v85, v75
    v_mul_f32 v84, v77, v77
    v_add_f32 v85, v76, v76
    v_fma_f32 v78, v76, v76, -v84
    v_mul_f32 v79, v85, v77
    v_mul_f32 v84, v79, v79
    v_add_f32 v85, v78, v78
    v_fma_f32 v80, v78, v78, -v84
    v_mul_f32 v81, v85, v79
    v_mul_f32 v82, v64, v44
    v_mul_f32 v83, v65, v44
    v_exp_f32 v82, v82
    v_fract_f32 v83, v83
    v_cos_f32 v68, v83
    v_sin_f32 v69, v83
    v_mul_f32 v68, v68, v82
    v_mul_f32 v69, v69, v82
    v_mul_f32 v84, v67, v69
    v_mul_f32 v85, v67, v68
    v_fma_f32 v68, v66, v68, -v84
    v_fma_f32 v69, -v66, v69, -v85
    v_mul_f32 v82, v64, v45
    v_mul_f32 v83, v65, v45
    v_exp_f32 v82, v82
    v_fract_f32 v83, v83
    v_cos_f32 v70, v83
    v_sin_f32 v71, v83
    v_mul_f32 v70, v70, v82
    v_mul_f32 v71, v71, v82
    v_mul_f32 v84, v67, v71
    v_mul_f32 v85, v67, v70
    v_fma_f32 v70, v66, v70, -v84
    v_fma_f32 v71, -v66, v71, -v85
    v_mul_f32 v82, v64, v46
    v_mul_f32 v83, v65, v46
    v_exp_f32 v82, v82
    v_fract_f32 v83, v83
    v_cos_f32 v72, v83
    v_sin_f32 v73, v83
    v_mul_f32 v72, v72, v82
    v_mul_f32 v73, v73, v82
    v_mul_f32 v84, v67, v73
    v_mul_f32 v85, v67, v72
    v_fma_f32 v72, v66, v72, -v84
    v_fma_f32 v73, -v66, v73, -v85
    v_mfma_f32_16x16x4_f32 v[48:51], v68, v74, v[48:51]
    v_mfma_f32_16x16x4_f32 v[52:55], v70, v76, v[52:55]
    v_mfma_f32_16x16x4_f32 v[56:59], v70, v78, v[56:59]
    v_mfma_f32_16x16x4_f32 v[60:63], v72, v80, v[60:63]
    v_mfma_f32_16x16x4_f32 v[48:51], v69, v75, v[48:51]
    v_mfma_f32_16x16x4_f32 v[52:55], v71, v77, v[52:55]
    v_mfma_f32_16x16x4_f32 v[56:59], v71, v79, v[56:59]
    v_mfma_f32_16x16x4_f32 v[60:63], v73, v81, v[60:63]
    v_mov_b32_dpp v64, v24 row_newbcast:8 row_mask:0xf bank_mask:0xf
    v_mov_b32_dpp v65, v25 row_newbcast:8 row_mask:0xf bank_mask:0xf
    v_mov_b32_dpp v66, v26 row_newbcast:8 row_mask:0xf bank_mask:0xf
    v_mov_b32_dpp v67, v27 row_newbcast:8 row_mask:0xf bank_mask:0xf
    v_mul_f32 v82, v64, v47
    v_mul_f32 v83, v65, v47
    v_exp_f32 v82, v82
    v_fract_f32 v83, v83
    v_cos_f32 v74, v83
    v_sin_f32 v75, v83
    v_mul_f32 v74, v74, v82
    v_mul_f32 v75, v75, v82
    v_mul_f32 v84, v75, v75
    v_add_f32 v85, v74, v74
    v_fma_f32 v76, v74, v74, -v84
    v_mul_f32 v77, v85, v75
    v_mul_f32 v84, v77, v77
    v_add_f32 v85, v76, v76
    v_fma_f32 v78, v76, v76, -v84
    v_mul_f32 v79, v85, v77
    v_mul_f32 v84, v79, v79
    v_add_f32 v85, v78, v78
    v_fma_f32 v80, v78, v78, -v84
    v_mul_f32 v81, v85, v79
    v_mul_f32 v82, v64, v44
    v_mul_f32 v83, v65, v44
    v_exp_f32 v82, v82
    v_fract_f32 v83, v83
    v_cos_f32 v68, v83
    v_sin_f32 v69, v83
    v_mul_f32 v68, v68, v82
    v_mul_f32 v69, v69, v82
    v_mul_f32 v84, v67, v69
    v_mul_f32 v85, v67, v68
    v_fma_f32 v68, v66, v68, -v84
    v_fma_f32 v69, -v66, v69, -v85
    v_mul_f32 v82, v64, v45
    v_mul_f32 v83, v65, v45
    v_exp_f32 v82, v82
    v_fract_f32 v83, v83
    v_cos_f32 v70, v83
    v_sin_f32 v71, v83
    v_mul_f32 v70, v70, v82
    v_mul_f32 v71, v71, v82
    v_mul_f32 v84, v67, v71
    v_mul_f32 v85, v67, v70
    v_fma_f32 v70, v66, v70, -v84
    v_fma_f32 v71, -v66, v71, -v85
    v_mul_f32 v82, v64, v46
    v_mul_f32 v83, v65, v46
    v_exp_f32 v82, v82
    v_fract_f32 v83, v83
    v_cos_f32 v72, v83
    v_sin_f32 v73, v83
    v_mul_f32 v72, v72, v82
    v_mul_f32 v73, v73, v82
    v_mul_f32 v84, v67, v73
    v_mul_f32 v85, v67, v72
    v_fma_f32 v72, v66, v72, -v84
    v_fma_f32 v73, -v66, v73, -v85
    v_mfma_f32_16x16x4_f32 v[48:51], v68, v74, v[48:51]
    v_mfma_f32_16x16x4_f32 v[52:55], v70, v76, v[52:55]
    v_mfma_f32_16x16x4_f32 v[56:59], v70, v78, v[56:59]
    v_mfma_f32_16x16x4_f32 v[60:63], v72, v80, v[60:63]
    v_mfma_f32_16x16x4_f32 v[48:51], v69, v75, v[48:51]
    v_mfma_f32_16x16x4_f32 v[52:55], v71, v77, v[52:55]
    v_mfma_f32_16x16x4_f32 v[56:59], v71, v79, v[56:59]
    v_mfma_f32_16x16x4_f32 v[60:63], v73, v81, v[60:63]
    v_mov_b32_dpp v64, v24 row_newbcast:9 row_mask:0xf bank_mask:0xf
    v_mov_b32_dpp v65, v25 row_newbcast:9 row_mask:0xf bank_mask:0xf
    v_mov_b32_dpp v66, v26 row_newbcast:9 row_mask:0xf bank_mask:0xf
    v_mov_b32_dpp v67, v27 row_newbcast:9 row_mask:0xf bank_mask:0xf
    v_mul_f32 v82, v64, v47
    v_mul_f32 v83, v65, v47
    v_exp_f32 v82, v82
    v_fract_f32 v83, v83
    v_cos_f32 v74, v83
    v_sin_f32 v75, v83
    v_mul_f32 v74, v74, v82
    v_mul_f32 v75, v75, v82
    v_mul_f32 v84, v75, v75
    v_add_f32 v85, v74, v74
    v_fma_f32 v76, v74, v74, -v84
    v_mul_f32 v77, v85, v75
    v_mul_f32 v84, v77, v77
    v_add_f32 v85, v76, v76
    v_fma_f32 v78, v76, v76, -v84
    v_mul_f32 v79, v85, v77
    v_mul_f32 v84, v79, v79
    v_add_f32 v85, v78, v78
    v_fma_f32 v80, v78, v78, -v84
    v_mul_f32 v81, v85, v79
    v_mul_f32 v82, v64, v44
    v_mul_f32 v83, v65, v44
    v_exp_f32 v82, v82
    v_fract_f32 v83, v83
    v_cos_f32 v68, v83
    v_sin_f32 v69, v83
    v_mul_f32 v68, v68, v82
    v_mul_f32 v69, v69, v82
    v_mul_f32 v84, v67, v69
    v_mul_f32 v85, v67, v68
    v_fma_f32 v68, v66, v68, -v84
    v_fma_f32 v69, -v66, v69, -v85
    v_mul_f32 v82, v64, v45
    v_mul_f32 v83, v65, v45
    v_exp_f32 v82, v82
    v_fract_f32 v83, v83
    v_cos_f32 v70, v83
    v_sin_f32 v71, v83
    v_mul_f32 v70, v70, v82
    v_mul_f32 v71, v71, v82
    v_mul_f32 v84, v67, v71
    v_mul_f32 v85, v67, v70
    v_fma_f32 v70, v66, v70, -v84
    v_fma_f32 v71, -v66, v71, -v85
    v_mul_f32 v82, v64, v46
    v_mul_f32 v83, v65, v46
    v_exp_f32 v82, v82
    v_fract_f32 v83, v83
    v_cos_f32 v72, v83
    v_sin_f32 v73, v83
    v_mul_f32 v72, v72, v82
    v_mul_f32 v73, v73, v82
    v_mul_f32 v84, v67, v73
    v_mul_f32 v85, v67, v72
    v_fma_f32 v72, v66, v72, -v84
    v_fma_f32 v73, -v66, v73, -v85
    v_mfma_f32_16x16x4_f32 v[48:51], v68, v74, v[48:51]
    v_mfma_f32_16x16x4_f32 v[52:55], v70, v76, v[52:55]
    v_mfma_f32_16x16x4_f32 v[56:59], v70, v78, v[56:59]
    v_mfma_f32_16x16x4_f32 v[60:63], v72, v80, v[60:63]
    v_mfma_f32_16x16x4_f32 v[48:51], v69, v75, v[48:51]
    v_mfma_f32_16x16x4_f32 v[52:55], v71, v77, v[52:55]
    v_mfma_f32_16x16x4_f32 v[56:59], v71, v79, v[56:59]
    v_mfma_f32_16x16x4_f32 v[60:63], v73, v81, v[60:63]
    v_mov_b32_dpp v64, v24 row_newbcast:10 row_mask:0xf bank_mask:0xf
    v_mov_b32_dpp v65, v25 row_newbcast:10 row_mask:0xf bank_mask:0xf
    v_mov_b32_dpp v66, v26 row_newbcast:10 row_mask:0xf bank_mask:0xf
    v_mov_b32_dpp v67, v27 row_newbcast:10 row_mask:0xf bank_mask:0xf
    v_mul_f32 v82, v64, v47
    v_mul_f32 v83, v65, v47
    v_exp_f32 v82, v82
    v_fract_f32 v83, v83
    v_cos_f32 v74, v83
    v_sin_f32 v75, v83
    v_mul_f32 v74, v74, v82
    v_mul_f32 v75, v75, v82
    v_mul_f32 v84, v75, v75
    v_add_f32 v85, v74, v74
    v_fma_f32 v76, v74, v74, -v84
    v_mul_f32 v77, v85, v75
    v_mul_f32 v84, v77, v77
    v_add_f32 v85, v76, v76
    v_fma_f32 v78, v76, v76, -v84
    v_mul_f32 v79, v85, v77
    v_mul_f32 v84, v79, v79
    v_add_f32 v85, v78, v78
    v_fma_f32 v80, v78, v78, -v84
    v_mul_f32 v81, v85, v79
    v_mul_f32 v82, v64, v44
    v_mul_f32 v83, v65, v44
    v_exp_f32 v82, v82
    v_fract_f32 v83, v83
    v_cos_f32 v68, v83
    v_sin_f32 v69, v83
    v_mul_f32 v68, v68, v82
    v_mul_f32 v69, v69, v82
    v_mul_f32 v84, v67, v69
    v_mul_f32 v85, v67, v68
    v_fma_f32 v68, v66, v68, -v84
    v_fma_f32 v69, -v66, v69, -v85
    v_mul_f32 v82, v64, v45
    v_mul_f32 v83, v65, v45
    v_exp_f32 v82, v82
    v_fract_f32 v83, v83
    v_cos_f32 v70, v83
    v_sin_f32 v71, v83
    v_mul_f32 v70, v70, v82
    v_mul_f32 v71, v71, v82
    v_mul_f32 v84, v67, v71
    v_mul_f32 v85, v67, v70
    v_fma_f32 v70, v66, v70, -v84
    v_fma_f32 v71, -v66, v71, -v85
    v_mul_f32 v82, v64, v46
    v_mul_f32 v83, v65, v46
    v_exp_f32 v82, v82
    v_fract_f32 v83, v83
    v_cos_f32 v72, v83
    v_sin_f32 v73, v83
    v_mul_f32 v72, v72, v82
    v_mul_f32 v73, v73, v82
    v_mul_f32 v84, v67, v73
    v_mul_f32 v85, v67, v72
    v_fma_f32 v72, v66, v72, -v84
    v_fma_f32 v73, -v66, v73, -v85
    v_mfma_f32_16x16x4_f32 v[48:51], v68, v74, v[48:51]
    v_mfma_f32_16x16x4_f32 v[52:55], v70, v76, v[52:55]
    v_mfma_f32_16x16x4_f32 v[56:59], v70, v78, v[56:59]
    v_mfma_f32_16x16x4_f32 v[60:63], v72, v80, v[60:63]
    v_mfma_f32_16x16x4_f32 v[48:51], v69, v75, v[48:51]
    v_mfma_f32_16x16x4_f32 v[52:55], v71, v77, v[52:55]
    v_mfma_f32_16x16x4_f32 v[56:59], v71, v79, v[56:59]
    v_mfma_f32_16x16x4_f32 v[60:63], v73, v81, v[60:63]
    v_mov_b32_dpp v64, v24 row_newbcast:11 row_mask:0xf bank_mask:0xf
    v_mov_b32_dpp v65, v25 row_newbcast:11 row_mask:0xf bank_mask:0xf
    v_mov_b32_dpp v66, v26 row_newbcast:11 row_mask:0xf bank_mask:0xf
    v_mov_b32_dpp v67, v27 row_newbcast:11 row_mask:0xf bank_mask:0xf
    v_mul_f32 v82, v64, v47
    v_mul_f32 v83, v65, v47
    v_exp_f32 v82, v82
    v_fract_f32 v83, v83
    v_cos_f32 v74, v83
    v_sin_f32 v75, v83
    v_mul_f32 v74, v74, v82
    v_mul_f32 v75, v75, v82
    v_mul_f32 v84, v75, v75
    v_add_f32 v85, v74, v74
    v_fma_f32 v76, v74, v74, -v84
    v_mul_f32 v77, v85, v75
    v_mul_f32 v84, v77, v77
    v_add_f32 v85, v76, v76
    v_fma_f32 v78, v76, v76, -v84
    v_mul_f32 v79, v85, v77
    v_mul_f32 v84, v79, v79
    v_add_f32 v85, v78, v78
    v_fma_f32 v80, v78, v78, -v84
    v_mul_f32 v81, v85, v79
    v_mul_f32 v82, v64, v44
    v_mul_f32 v83, v65, v44
    v_exp_f32 v82, v82
    v_fract_f32 v83, v83
    v_cos_f32 v68, v83
    v_sin_f32 v69, v83
    v_mul_f32 v68, v68, v82
    v_mul_f32 v69, v69, v82
    v_mul_f32 v84, v67, v69
    v_mul_f32 v85, v67, v68
    v_fma_f32 v68, v66, v68, -v84
    v_fma_f32 v69, -v66, v69, -v85
    v_mul_f32 v82, v64, v45
    v_mul_f32 v83, v65, v45
    v_exp_f32 v82, v82
    v_fract_f32 v83, v83
    v_cos_f32 v70, v83
    v_sin_f32 v71, v83
    v_mul_f32 v70, v70, v82
    v_mul_f32 v71, v71, v82
    v_mul_f32 v84, v67, v71
    v_mul_f32 v85, v67, v70
    v_fma_f32 v70, v66, v70, -v84
    v_fma_f32 v71, -v66, v71, -v85
    v_mul_f32 v82, v64, v46
    v_mul_f32 v83, v65, v46
    v_exp_f32 v82, v82
    v_fract_f32 v83, v83
    v_cos_f32 v72, v83
    v_sin_f32 v73, v83
    v_mul_f32 v72, v72, v82
    v_mul_f32 v73, v73, v82
    v_mul_f32 v84, v67, v73
    v_mul_f32 v85, v67, v72
    v_fma_f32 v72, v66, v72, -v84
    v_fma_f32 v73, -v66, v73, -v85
    v_mfma_f32_16x16x4_f32 v[48:51], v68, v74, v[48:51]
    v_mfma_f32_16x16x4_f32 v[52:55], v70, v76, v[52:55]
    v_mfma_f32_16x16x4_f32 v[56:59], v70, v78, v[56:59]
    v_mfma_f32_16x16x4_f32 v[60:63], v72, v80, v[60:63]
    v_mfma_f32_16x16x4_f32 v[48:51], v69, v75, v[48:51]
    v_mfma_f32_16x16x4_f32 v[52:55], v71, v77, v[52:55]
    v_mfma_f32_16x16x4_f32 v[56:59], v71, v79, v[56:59]
    v_mfma_f32_16x16x4_f32 v[60:63], v73, v81, v[60:63]
    v_mov_b32_dpp v64, v24 row_newbcast:12 row_mask:0xf bank_mask:0xf
    v_mov_b32_dpp v65, v25 row_newbcast:12 row_mask:0xf bank_mask:0xf
    v_mov_b32_dpp v66, v26 row_newbcast:12 row_mask:0xf bank_mask:0xf
    v_mov_b32_dpp v67, v27 row_newbcast:12 row_mask:0xf bank_mask:0xf
    v_mul_f32 v82, v64, v47
    v_mul_f32 v83, v65, v47
    v_exp_f32 v82, v82
    v_fract_f32 v83, v83
    v_cos_f32 v74, v83
    v_sin_f32 v75, v83
    v_mul_f32 v74, v74, v82
    v_mul_f32 v75, v75, v82
    v_mul_f32 v84, v75, v75
    v_add_f32 v85, v74, v74
    v_fma_f32 v76, v74, v74, -v84
    v_mul_f32 v77, v85, v75
    v_mul_f32 v84, v77, v77
    v_add_f32 v85, v76, v76
    v_fma_f32 v78, v76, v76, -v84
    v_mul_f32 v79, v85, v77
    v_mul_f32 v84, v79, v79
    v_add_f32 v85, v78, v78
    v_fma_f32 v80, v78, v78, -v84
    v_mul_f32 v81, v85, v79
    v_mul_f32 v82, v64, v44
    v_mul_f32 v83, v65, v44
    v_exp_f32 v82, v82
    v_fract_f32 v83, v83
    v_cos_f32 v68, v83
    v_sin_f32 v69, v83
    v_mul_f32 v68, v68, v82
    v_mul_f32 v69, v69, v82
    v_mul_f32 v84, v67, v69
    v_mul_f32 v85, v67, v68
    v_fma_f32 v68, v66, v68, -v84
    v_fma_f32 v69, -v66, v69, -v85
    v_mul_f32 v82, v64, v45
    v_mul_f32 v83, v65, v45
    v_exp_f32 v82, v82
    v_fract_f32 v83, v83
    v_cos_f32 v70, v83
    v_sin_f32 v71, v83
    v_mul_f32 v70, v70, v82
    v_mul_f32 v71, v71, v82
    v_mul_f32 v84, v67, v71
    v_mul_f32 v85, v67, v70
    v_fma_f32 v70, v66, v70, -v84
    v_fma_f32 v71, -v66, v71, -v85
    v_mul_f32 v82, v64, v46
    v_mul_f32 v83, v65, v46
    v_exp_f32 v82, v82
    v_fract_f32 v83, v83
    v_cos_f32 v72, v83
    v_sin_f32 v73, v83
    v_mul_f32 v72, v72, v82
    v_mul_f32 v73, v73, v82
    v_mul_f32 v84, v67, v73
    v_mul_f32 v85, v67, v72
    v_fma_f32 v72, v66, v72, -v84
    v_fma_f32 v73, -v66, v73, -v85
    v_mfma_f32_16x16x4_f32 v[48:51], v68, v74, v[48:51]
    v_mfma_f32_16x16x4_f32 v[52:55], v70, v76, v[52:55]
    v_mfma_f32_16x16x4_f32 v[56:59], v70, v78, v[56:59]
    v_mfma_f32_16x16x4_f32 v[60:63], v72, v80, v[60:63]
    v_mfma_f32_16x16x4_f32 v[48:51], v69, v75, v[48:51]
    v_mfma_f32_16x16x4_f32 v[52:55], v71, v77, v[52:55]
    v_mfma_f32_16x16x4_f32 v[56:59], v71, v79, v[56:59]
    v_mfma_f32_16x16x4_f32 v[60:63], v73, v81, v[60:63]
    v_mov_b32_dpp v64, v24 row_newbcast:13 row_mask:0xf bank_mask:0xf
    v_mov_b32_dpp v65, v25 row_newbcast:13 row_mask:0xf bank_mask:0xf
    v_mov_b32_dpp v66, v26 row_newbcast:13 row_mask:0xf bank_mask:0xf
    v_mov_b32_dpp v67, v27 row_newbcast:13 row_mask:0xf bank_mask:0xf
    v_mul_f32 v82, v64, v47
    v_mul_f32 v83, v65, v47
    v_exp_f32 v82, v82
    v_fract_f32 v83, v83
    v_cos_f32 v74, v83
    v_sin_f32 v75, v83
    v_mul_f32 v74, v74, v82
    v_mul_f32 v75, v75, v82
    v_mul_f32 v84, v75, v75
    v_add_f32 v85, v74, v74
    v_fma_f32 v76, v74, v74, -v84
    v_mul_f32 v77, v85, v75
    v_mul_f32 v84, v77, v77
    v_add_f32 v85, v76, v76
    v_fma_f32 v78, v76, v76, -v84
    v_mul_f32 v79, v85, v77
    v_mul_f32 v84, v79, v79
    v_add_f32 v85, v78, v78
    v_fma_f32 v80, v78, v78, -v84
    v_mul_f32 v81, v85, v79
    v_mul_f32 v82, v64, v44
    v_mul_f32 v83, v65, v44
    v_exp_f32 v82, v82
    v_fract_f32 v83, v83
    v_cos_f32 v68, v83
    v_sin_f32 v69, v83
    v_mul_f32 v68, v68, v82
    v_mul_f32 v69, v69, v82
    v_mul_f32 v84, v67, v69
    v_mul_f32 v85, v67, v68
    v_fma_f32 v68, v66, v68, -v84
    v_fma_f32 v69, -v66, v69, -v85
    v_mul_f32 v82, v64, v45
    v_mul_f32 v83, v65, v45
    v_exp_f32 v82, v82
    v_fract_f32 v83, v83
    v_cos_f32 v70, v83
    v_sin_f32 v71, v83
    v_mul_f32 v70, v70, v82
    v_mul_f32 v71, v71, v82
    v_mul_f32 v84, v67, v71
    v_mul_f32 v85, v67, v70
    v_fma_f32 v70, v66, v70, -v84
    v_fma_f32 v71, -v66, v71, -v85
    v_mul_f32 v82, v64, v46
    v_mul_f32 v83, v65, v46
    v_exp_f32 v82, v82
    v_fract_f32 v83, v83
    v_cos_f32 v72, v83
    v_sin_f32 v73, v83
    v_mul_f32 v72, v72, v82
    v_mul_f32 v73, v73, v82
    v_mul_f32 v84, v67, v73
    v_mul_f32 v85, v67, v72
    v_fma_f32 v72, v66, v72, -v84
    v_fma_f32 v73, -v66, v73, -v85
    v_mfma_f32_16x16x4_f32 v[48:51], v68, v74, v[48:51]
    v_mfma_f32_16x16x4_f32 v[52:55], v70, v76, v[52:55]
    v_mfma_f32_16x16x4_f32 v[56:59], v70, v78, v[56:59]
    v_mfma_f32_16x16x4_f32 v[60:63], v72, v80, v[60:63]
    v_mfma_f32_16x16x4_f32 v[48:51], v69, v75, v[48:51]
    v_mfma_f32_16x16x4_f32 v[52:55], v71, v77, v[52:55]
    v_mfma_f32_16x16x4_f32 v[56:59], v71, v79, v[56:59]
    v_mfma_f32_16x16x4_f32 v[60:63], v73, v81, v[60:63]
    v_mov_b32_dpp v64, v24 row_newbcast:14 row_mask:0xf bank_mask:0xf
    v_mov_b32_dpp v65, v25 row_newbcast:14 row_mask:0xf bank_mask:0xf
    v_mov_b32_dpp v66, v26 row_newbcast:14 row_mask:0xf bank_mask:0xf
    v_mov_b32_dpp v67, v27 row_newbcast:14 row_mask:0xf bank_mask:0xf
    v_mul_f32 v82, v64, v47
    v_mul_f32 v83, v65, v47
    v_exp_f32 v82, v82
    v_fract_f32 v83, v83
    v_cos_f32 v74, v83
    v_sin_f32 v75, v83
    v_mul_f32 v74, v74, v82
    v_mul_f32 v75, v75, v82
    v_mul_f32 v84, v75, v75
    v_add_f32 v85, v74, v74
    v_fma_f32 v76, v74, v74, -v84
    v_mul_f32 v77, v85, v75
    v_mul_f32 v84, v77, v77
    v_add_f32 v85, v76, v76
    v_fma_f32 v78, v76, v76, -v84
    v_mul_f32 v79, v85, v77
    v_mul_f32 v84, v79, v79
    v_add_f32 v85, v78, v78
    v_fma_f32 v80, v78, v78, -v84
    v_mul_f32 v81, v85, v79
    v_mul_f32 v82, v64, v44
    v_mul_f32 v83, v65, v44
    v_exp_f32 v82, v82
    v_fract_f32 v83, v83
    v_cos_f32 v68, v83
    v_sin_f32 v69, v83
    v_mul_f32 v68, v68, v82
    v_mul_f32 v69, v69, v82
    v_mul_f32 v84, v67, v69
    v_mul_f32 v85, v67, v68
    v_fma_f32 v68, v66, v68, -v84
    v_fma_f32 v69, -v66, v69, -v85
    v_mul_f32 v82, v64, v45
    v_mul_f32 v83, v65, v45
    v_exp_f32 v82, v82
    v_fract_f32 v83, v83
    v_cos_f32 v70, v83
    v_sin_f32 v71, v83
    v_mul_f32 v70, v70, v82
    v_mul_f32 v71, v71, v82
    v_mul_f32 v84, v67, v71
    v_mul_f32 v85, v67, v70
    v_fma_f32 v70, v66, v70, -v84
    v_fma_f32 v71, -v66, v71, -v85
    v_mul_f32 v82, v64, v46
    v_mul_f32 v83, v65, v46
    v_exp_f32 v82, v82
    v_fract_f32 v83, v83
    v_cos_f32 v72, v83
    v_sin_f32 v73, v83
    v_mul_f32 v72, v72, v82
    v_mul_f32 v73, v73, v82
    v_mul_f32 v84, v67, v73
    v_mul_f32 v85, v67, v72
    v_fma_f32 v72, v66, v72, -v84
    v_fma_f32 v73, -v66, v73, -v85
    v_mfma_f32_16x16x4_f32 v[48:51], v68, v74, v[48:51]
    v_mfma_f32_16x16x4_f32 v[52:55], v70, v76, v[52:55]
    v_mfma_f32_16x16x4_f32 v[56:59], v70, v78, v[56:59]
    v_mfma_f32_16x16x4_f32 v[60:63], v72, v80, v[60:63]
    v_mfma_f32_16x16x4_f32 v[48:51], v69, v75, v[48:51]
    v_mfma_f32_16x16x4_f32 v[52:55], v71, v77, v[52:55]
    v_mfma_f32_16x16x4_f32 v[56:59], v71, v79, v[56:59]
    v_mfma_f32_16x16x4_f32 v[60:63], v73, v81, v[60:63]
    v_mov_b32_dpp v64, v24 row_newbcast:15 row_mask:0xf bank_mask:0xf
    v_mov_b32_dpp v65, v25 row_newbcast:15 row_mask:0xf bank_mask:0xf
    v_mov_b32_dpp v66, v26 row_newbcast:15 row_mask:0xf bank_mask:0xf
    v_mov_b32_dpp v67, v27 row_newbcast:15 row_mask:0xf bank_mask:0xf
    v_mul_f32 v82, v64, v47
    v_mul_f32 v83, v65, v47
    v_exp_f32 v82, v82
    v_fract_f32 v83, v83
    v_cos_f32 v74, v83
    v_sin_f32 v75, v83
    v_mul_f32 v74, v74, v82
    v_mul_f32 v75, v75, v82
    v_mul_f32 v84, v75, v75
    v_add_f32 v85, v74, v74
    v_fma_f32 v76, v74, v74, -v84
    v_mul_f32 v77, v85, v75
    v_mul_f32 v84, v77, v77
    v_add_f32 v85, v76, v76
    v_fma_f32 v78, v76, v76, -v84
    v_mul_f32 v79, v85, v77
    v_mul_f32 v84, v79, v79
    v_add_f32 v85, v78, v78
    v_fma_f32 v80, v78, v78, -v84
    v_mul_f32 v81, v85, v79
    v_mul_f32 v82, v64, v44
    v_mul_f32 v83, v65, v44
    v_exp_f32 v82, v82
    v_fract_f32 v83, v83
    v_cos_f32 v68, v83
    v_sin_f32 v69, v83
    v_mul_f32 v68, v68, v82
    v_mul_f32 v69, v69, v82
    v_mul_f32 v84, v67, v69
    v_mul_f32 v85, v67, v68
    v_fma_f32 v68, v66, v68, -v84
    v_fma_f32 v69, -v66, v69, -v85
    v_mul_f32 v82, v64, v45
    v_mul_f32 v83, v65, v45
    v_exp_f32 v82, v82
    v_fract_f32 v83, v83
    v_cos_f32 v70, v83
    v_sin_f32 v71, v83
    v_mul_f32 v70, v70, v82
    v_mul_f32 v71, v71, v82
    v_mul_f32 v84, v67, v71
    v_mul_f32 v85, v67, v70
    v_fma_f32 v70, v66, v70, -v84
    v_fma_f32 v71, -v66, v71, -v85
    v_mul_f32 v82, v64, v46
    v_mul_f32 v83, v65, v46
    v_exp_f32 v82, v82
    v_fract_f32 v83, v83
    v_cos_f32 v72, v83
    v_sin_f32 v73, v83
    v_mul_f32 v72, v72, v82
    v_mul_f32 v73, v73, v82
    v_mul_f32 v84, v67, v73
    v_mul_f32 v85, v67, v72
    v_fma_f32 v72, v66, v72, -v84
    v_fma_f32 v73, -v66, v73, -v85
    v_mfma_f32_16x16x4_f32 v[48:51], v68, v74, v[48:51]
    v_mfma_f32_16x16x4_f32 v[52:55], v70, v76, v[52:55]
    v_mfma_f32_16x16x4_f32 v[56:59], v70, v78, v[56:59]
    v_mfma_f32_16x16x4_f32 v[60:63], v72, v80, v[60:63]
    v_mfma_f32_16x16x4_f32 v[48:51], v69, v75, v[48:51]
    v_mfma_f32_16x16x4_f32 v[52:55], v71, v77, v[52:55]
    v_mfma_f32_16x16x4_f32 v[56:59], v71, v79, v[56:59]
    v_mfma_f32_16x16x4_f32 v[60:63], v73, v81, v[60:63]
    v_mov_b32_dpp v64, v28 row_newbcast:0 row_mask:0xf bank_mask:0xf
    v_mov_b32_dpp v65, v29 row_newbcast:0 row_mask:0xf bank_mask:0xf
    v_mov_b32_dpp v66, v30 row_newbcast:0 row_mask:0xf bank_mask:0xf
    v_mov_b32_dpp v67, v31 row_newbcast:0 row_mask:0xf bank_mask:0xf
    v_mul_f32 v82, v64, v47
    v_mul_f32 v83, v65, v47
    v_exp_f32 v82, v82
    v_fract_f32 v83, v83
    v_cos_f32 v74, v83
    v_sin_f32 v75, v83
    v_mul_f32 v74, v74, v82
    v_mul_f32 v75, v75, v82
    v_mul_f32 v84, v75, v75
    v_add_f32 v85, v74, v74
    v_fma_f32 v76, v74, v74, -v84
    v_mul_f32 v77, v85, v75
    v_mul_f32 v84, v77, v77
    v_add_f32 v85, v76, v76
    v_fma_f32 v78, v76, v76, -v84
    v_mul_f32 v79, v85, v77
    v_mul_f32 v84, v79, v79
    v_add_f32 v85, v78, v78
    v_fma_f32 v80, v78, v78, -v84
    v_mul_f32 v81, v85, v79
    v_mul_f32 v82, v64, v44
    v_mul_f32 v83, v65, v44
    v_exp_f32 v82, v82
    v_fract_f32 v83, v83
    v_cos_f32 v68, v83
    v_sin_f32 v69, v83
    v_mul_f32 v68, v68, v82
    v_mul_f32 v69, v69, v82
    v_mul_f32 v84, v67, v69
    v_mul_f32 v85, v67, v68
    v_fma_f32 v68, v66, v68, -v84
    v_fma_f32 v69, -v66, v69, -v85
    v_mul_f32 v82, v64, v45
    v_mul_f32 v83, v65, v45
    v_exp_f32 v82, v82
    v_fract_f32 v83, v83
    v_cos_f32 v70, v83
    v_sin_f32 v71, v83
    v_mul_f32 v70, v70, v82
    v_mul_f32 v71, v71, v82
    v_mul_f32 v84, v67, v71
    v_mul_f32 v85, v67, v70
    v_fma_f32 v70, v66, v70, -v84
    v_fma_f32 v71, -v66, v71, -v85
    v_mul_f32 v82, v64, v46
    v_mul_f32 v83, v65, v46
    v_exp_f32 v82, v82
    v_fract_f32 v83, v83
    v_cos_f32 v72, v83
    v_sin_f32 v73, v83
    v_mul_f32 v72, v72, v82
    v_mul_f32 v73, v73, v82
    v_mul_f32 v84, v67, v73
    v_mul_f32 v85, v67, v72
    v_fma_f32 v72, v66, v72, -v84
    v_fma_f32 v73, -v66, v73, -v85
    v_mfma_f32_16x16x4_f32 v[48:51], v68, v74, v[48:51]
    v_mfma_f32_16x16x4_f32 v[52:55], v70, v76, v[52:55]
    v_mfma_f32_16x16x4_f32 v[56:59], v70, v78, v[56:59]
    v_mfma_f32_16x16x4_f32 v[60:63], v72, v80, v[60:63]
    v_mfma_f32_16x16x4_f32 v[48:51], v69, v75, v[48:51]
    v_mfma_f32_16x16x4_f32 v[52:55], v71, v77, v[52:55]
    v_mfma_f32_16x16x4_f32 v[56:59], v71, v79, v[56:59]
    v_mfma_f32_16x16x4_f32 v[60:63], v73, v81, v[60:63]
    v_mov_b32_dpp v64, v28 row_newbcast:1 row_mask:0xf bank_mask:0xf
    v_mov_b32_dpp v65, v29 row_newbcast:1 row_mask:0xf bank_mask:0xf
    v_mov_b32_dpp v66, v30 row_newbcast:1 row_mask:0xf bank_mask:0xf
    v_mov_b32_dpp v67, v31 row_newbcast:1 row_mask:0xf bank_mask:0xf
    v_mul_f32 v82, v64, v47
    v_mul_f32 v83, v65, v47
    v_exp_f32 v82, v82
    v_fract_f32 v83, v83
    v_cos_f32 v74, v83
    v_sin_f32 v75, v83
    v_mul_f32 v74, v74, v82
    v_mul_f32 v75, v75, v82
    v_mul_f32 v84, v75, v75
    v_add_f32 v85, v74, v74
    v_fma_f32 v76, v74, v74, -v84
    v_mul_f32 v77, v85, v75
    v_mul_f32 v84, v77, v77
    v_add_f32 v85, v76, v76
    v_fma_f32 v78, v76, v76, -v84
    v_mul_f32 v79, v85, v77
    v_mul_f32 v84, v79, v79
    v_add_f32 v85, v78, v78
    v_fma_f32 v80, v78, v78, -v84
    v_mul_f32 v81, v85, v79
    v_mul_f32 v82, v64, v44
    v_mul_f32 v83, v65, v44
    v_exp_f32 v82, v82
    v_fract_f32 v83, v83
    v_cos_f32 v68, v83
    v_sin_f32 v69, v83
    v_mul_f32 v68, v68, v82
    v_mul_f32 v69, v69, v82
    v_mul_f32 v84, v67, v69
    v_mul_f32 v85, v67, v68
    v_fma_f32 v68, v66, v68, -v84
    v_fma_f32 v69, -v66, v69, -v85
    v_mul_f32 v82, v64, v45
    v_mul_f32 v83, v65, v45
    v_exp_f32 v82, v82
    v_fract_f32 v83, v83
    v_cos_f32 v70, v83
    v_sin_f32 v71, v83
    v_mul_f32 v70, v70, v82
    v_mul_f32 v71, v71, v82
    v_mul_f32 v84, v67, v71
    v_mul_f32 v85, v67, v70
    v_fma_f32 v70, v66, v70, -v84
    v_fma_f32 v71, -v66, v71, -v85
    v_mul_f32 v82, v64, v46
    v_mul_f32 v83, v65, v46
    v_exp_f32 v82, v82
    v_fract_f32 v83, v83
    v_cos_f32 v72, v83
    v_sin_f32 v73, v83
    v_mul_f32 v72, v72, v82
    v_mul_f32 v73, v73, v82
    v_mul_f32 v84, v67, v73
    v_mul_f32 v85, v67, v72
    v_fma_f32 v72, v66, v72, -v84
    v_fma_f32 v73, -v66, v73, -v85
    v_mfma_f32_16x16x4_f32 v[48:51], v68, v74, v[48:51]
    v_mfma_f32_16x16x4_f32 v[52:55], v70, v76, v[52:55]
    v_mfma_f32_16x16x4_f32 v[56:59], v70, v78, v[56:59]
    v_mfma_f32_16x16x4_f32 v[60:63], v72, v80, v[60:63]
    v_mfma_f32_16x16x4_f32 v[48:51], v69, v75, v[48:51]
    v_mfma_f32_16x16x4_f32 v[52:55], v71, v77, v[52:55]
    v_mfma_f32_16x16x4_f32 v[56:59], v71, v79, v[56:59]
    v_mfma_f32_16x16x4_f32 v[60:63], v73, v81, v[60:63]
    v_mov_b32_dpp v64, v28 row_newbcast:2 row_mask:0xf bank_mask:0xf
    v_mov_b32_dpp v65, v29 row_newbcast:2 row_mask:0xf bank_mask:0xf
    v_mov_b32_dpp v66, v30 row_newbcast:2 row_mask:0xf bank_mask:0xf
    v_mov_b32_dpp v67, v31 row_newbcast:2 row_mask:0xf bank_mask:0xf
    v_mul_f32 v82, v64, v47
    v_mul_f32 v83, v65, v47
    v_exp_f32 v82, v82
    v_fract_f32 v83, v83
    v_cos_f32 v74, v83
    v_sin_f32 v75, v83
    v_mul_f32 v74, v74, v82
    v_mul_f32 v75, v75, v82
    v_mul_f32 v84, v75, v75
    v_add_f32 v85, v74, v74
    v_fma_f32 v76, v74, v74, -v84
    v_mul_f32 v77, v85, v75
    v_mul_f32 v84, v77, v77
    v_add_f32 v85, v76, v76
    v_fma_f32 v78, v76, v76, -v84
    v_mul_f32 v79, v85, v77
    v_mul_f32 v84, v79, v79
    v_add_f32 v85, v78, v78
    v_fma_f32 v80, v78, v78, -v84
    v_mul_f32 v81, v85, v79
    v_mul_f32 v82, v64, v44
    v_mul_f32 v83, v65, v44
    v_exp_f32 v82, v82
    v_fract_f32 v83, v83
    v_cos_f32 v68, v83
    v_sin_f32 v69, v83
    v_mul_f32 v68, v68, v82
    v_mul_f32 v69, v69, v82
    v_mul_f32 v84, v67, v69
    v_mul_f32 v85, v67, v68
    v_fma_f32 v68, v66, v68, -v84
    v_fma_f32 v69, -v66, v69, -v85
    v_mul_f32 v82, v64, v45
    v_mul_f32 v83, v65, v45
    v_exp_f32 v82, v82
    v_fract_f32 v83, v83
    v_cos_f32 v70, v83
    v_sin_f32 v71, v83
    v_mul_f32 v70, v70, v82
    v_mul_f32 v71, v71, v82
    v_mul_f32 v84, v67, v71
    v_mul_f32 v85, v67, v70
    v_fma_f32 v70, v66, v70, -v84
    v_fma_f32 v71, -v66, v71, -v85
    v_mul_f32 v82, v64, v46
    v_mul_f32 v83, v65, v46
    v_exp_f32 v82, v82
    v_fract_f32 v83, v83
    v_cos_f32 v72, v83
    v_sin_f32 v73, v83
    v_mul_f32 v72, v72, v82
    v_mul_f32 v73, v73, v82
    v_mul_f32 v84, v67, v73
    v_mul_f32 v85, v67, v72
    v_fma_f32 v72, v66, v72, -v84
    v_fma_f32 v73, -v66, v73, -v85
    v_mfma_f32_16x16x4_f32 v[48:51], v68, v74, v[48:51]
    v_mfma_f32_16x16x4_f32 v[52:55], v70, v76, v[52:55]
    v_mfma_f32_16x16x4_f32 v[56:59], v70, v78, v[56:59]
    v_mfma_f32_16x16x4_f32 v[60:63], v72, v80, v[60:63]
    v_mfma_f32_16x16x4_f32 v[48:51], v69, v75, v[48:51]
    v_mfma_f32_16x16x4_f32 v[52:55], v71, v77, v[52:55]
    v_mfma_f32_16x16x4_f32 v[56:59], v71, v79, v[56:59]
    v_mfma_f32_16x16x4_f32 v[60:63], v73, v81, v[60:63]
    v_mov_b32_dpp v64, v28 row_newbcast:3 row_mask:0xf bank_mask:0xf
    v_mov_b32_dpp v65, v29 row_newbcast:3 row_mask:0xf bank_mask:0xf
    v_mov_b32_dpp v66, v30 row_newbcast:3 row_mask:0xf bank_mask:0xf
    v_mov_b32_dpp v67, v31 row_newbcast:3 row_mask:0xf bank_mask:0xf
    v_mul_f32 v82, v64, v47
    v_mul_f32 v83, v65, v47
    v_exp_f32 v82, v82
    v_fract_f32 v83, v83
    v_cos_f32 v74, v83
    v_sin_f32 v75, v83
    v_mul_f32 v74, v74, v82
    v_mul_f32 v75, v75, v82
    v_mul_f32 v84, v75, v75
    v_add_f32 v85, v74, v74
    v_fma_f32 v76, v74, v74, -v84
    v_mul_f32 v77, v85, v75
    v_mul_f32 v84, v77, v77
    v_add_f32 v85, v76, v76
    v_fma_f32 v78, v76, v76, -v84
    v_mul_f32 v79, v85, v77
    v_mul_f32 v84, v79, v79
    v_add_f32 v85, v78, v78
    v_fma_f32 v80, v78, v78, -v84
    v_mul_f32 v81, v85, v79
    v_mul_f32 v82, v64, v44
    v_mul_f32 v83, v65, v44
    v_exp_f32 v82, v82
    v_fract_f32 v83, v83
    v_cos_f32 v68, v83
    v_sin_f32 v69, v83
    v_mul_f32 v68, v68, v82
    v_mul_f32 v69, v69, v82
    v_mul_f32 v84, v67, v69
    v_mul_f32 v85, v67, v68
    v_fma_f32 v68, v66, v68, -v84
    v_fma_f32 v69, -v66, v69, -v85
    v_mul_f32 v82, v64, v45
    v_mul_f32 v83, v65, v45
    v_exp_f32 v82, v82
    v_fract_f32 v83, v83
    v_cos_f32 v70, v83
    v_sin_f32 v71, v83
    v_mul_f32 v70, v70, v82
    v_mul_f32 v71, v71, v82
    v_mul_f32 v84, v67, v71
    v_mul_f32 v85, v67, v70
    v_fma_f32 v70, v66, v70, -v84
    v_fma_f32 v71, -v66, v71, -v85
    v_mul_f32 v82, v64, v46
    v_mul_f32 v83, v65, v46
    v_exp_f32 v82, v82
    v_fract_f32 v83, v83
    v_cos_f32 v72, v83
    v_sin_f32 v73, v83
    v_mul_f32 v72, v72, v82
    v_mul_f32 v73, v73, v82
    v_mul_f32 v84, v67, v73
    v_mul_f32 v85, v67, v72
    v_fma_f32 v72, v66, v72, -v84
    v_fma_f32 v73, -v66, v73, -v85
    v_mfma_f32_16x16x4_f32 v[48:51], v68, v74, v[48:51]
    v_mfma_f32_16x16x4_f32 v[52:55], v70, v76, v[52:55]
    v_mfma_f32_16x16x4_f32 v[56:59], v70, v78, v[56:59]
    v_mfma_f32_16x16x4_f32 v[60:63], v72, v80, v[60:63]
    v_mfma_f32_16x16x4_f32 v[48:51], v69, v75, v[48:51]
    v_mfma_f32_16x16x4_f32 v[52:55], v71, v77, v[52:55]
    v_mfma_f32_16x16x4_f32 v[56:59], v71, v79, v[56:59]
    v_mfma_f32_16x16x4_f32 v[60:63], v73, v81, v[60:63]
    v_mov_b32_dpp v64, v28 row_newbcast:4 row_mask:0xf bank_mask:0xf
    v_mov_b32_dpp v65, v29 row_newbcast:4 row_mask:0xf bank_mask:0xf
    v_mov_b32_dpp v66, v30 row_newbcast:4 row_mask:0xf bank_mask:0xf
    v_mov_b32_dpp v67, v31 row_newbcast:4 row_mask:0xf bank_mask:0xf
    v_mul_f32 v82, v64, v47
    v_mul_f32 v83, v65, v47
    v_exp_f32 v82, v82
    v_fract_f32 v83, v83
    v_cos_f32 v74, v83
    v_sin_f32 v75, v83
    v_mul_f32 v74, v74, v82
    v_mul_f32 v75, v75, v82
    v_mul_f32 v84, v75, v75
    v_add_f32 v85, v74, v74
    v_fma_f32 v76, v74, v74, -v84
    v_mul_f32 v77, v85, v75
    v_mul_f32 v84, v77, v77
    v_add_f32 v85, v76, v76
    v_fma_f32 v78, v76, v76, -v84
    v_mul_f32 v79, v85, v77
    v_mul_f32 v84, v79, v79
    v_add_f32 v85, v78, v78
    v_fma_f32 v80, v78, v78, -v84
    v_mul_f32 v81, v85, v79
    v_mul_f32 v82, v64, v44
    v_mul_f32 v83, v65, v44
    v_exp_f32 v82, v82
    v_fract_f32 v83, v83
    v_cos_f32 v68, v83
    v_sin_f32 v69, v83
    v_mul_f32 v68, v68, v82
    v_mul_f32 v69, v69, v82
    v_mul_f32 v84, v67, v69
    v_mul_f32 v85, v67, v68
    v_fma_f32 v68, v66, v68, -v84
    v_fma_f32 v69, -v66, v69, -v85
    v_mul_f32 v82, v64, v45
    v_mul_f32 v83, v65, v45
    v_exp_f32 v82, v82
    v_fract_f32 v83, v83
    v_cos_f32 v70, v83
    v_sin_f32 v71, v83
    v_mul_f32 v70, v70, v82
    v_mul_f32 v71, v71, v82
    v_mul_f32 v84, v67, v71
    v_mul_f32 v85, v67, v70
    v_fma_f32 v70, v66, v70, -v84
    v_fma_f32 v71, -v66, v71, -v85
    v_mul_f32 v82, v64, v46
    v_mul_f32 v83, v65, v46
    v_exp_f32 v82, v82
    v_fract_f32 v83, v83
    v_cos_f32 v72, v83
    v_sin_f32 v73, v83
    v_mul_f32 v72, v72, v82
    v_mul_f32 v73, v73, v82
    v_mul_f32 v84, v67, v73
    v_mul_f32 v85, v67, v72
    v_fma_f32 v72, v66, v72, -v84
    v_fma_f32 v73, -v66, v73, -v85
    v_mfma_f32_16x16x4_f32 v[48:51], v68, v74, v[48:51]
    v_mfma_f32_16x16x4_f32 v[52:55], v70, v76, v[52:55]
    v_mfma_f32_16x16x4_f32 v[56:59], v70, v78, v[56:59]
    v_mfma_f32_16x16x4_f32 v[60:63], v72, v80, v[60:63]
    v_mfma_f32_16x16x4_f32 v[48:51], v69, v75, v[48:51]
    v_mfma_f32_16x16x4_f32 v[52:55], v71, v77, v[52:55]
    v_mfma_f32_16x16x4_f32 v[56:59], v71, v79, v[56:59]
    v_mfma_f32_16x16x4_f32 v[60:63], v73, v81, v[60:63]
    v_mov_b32_dpp v64, v28 row_newbcast:5 row_mask:0xf bank_mask:0xf
    v_mov_b32_dpp v65, v29 row_newbcast:5 row_mask:0xf bank_mask:0xf
    v_mov_b32_dpp v66, v30 row_newbcast:5 row_mask:0xf bank_mask:0xf
    v_mov_b32_dpp v67, v31 row_newbcast:5 row_mask:0xf bank_mask:0xf
    v_mul_f32 v82, v64, v47
    v_mul_f32 v83, v65, v47
    v_exp_f32 v82, v82
    v_fract_f32 v83, v83
    v_cos_f32 v74, v83
    v_sin_f32 v75, v83
    v_mul_f32 v74, v74, v82
    v_mul_f32 v75, v75, v82
    v_mul_f32 v84, v75, v75
    v_add_f32 v85, v74, v74
    v_fma_f32 v76, v74, v74, -v84
    v_mul_f32 v77, v85, v75
    v_mul_f32 v84, v77, v77
    v_add_f32 v85, v76, v76
    v_fma_f32 v78, v76, v76, -v84
    v_mul_f32 v79, v85, v77
    v_mul_f32 v84, v79, v79
    v_add_f32 v85, v78, v78
    v_fma_f32 v80, v78, v78, -v84
    v_mul_f32 v81, v85, v79
    v_mul_f32 v82, v64, v44
    v_mul_f32 v83, v65, v44
    v_exp_f32 v82, v82
    v_fract_f32 v83, v83
    v_cos_f32 v68, v83
    v_sin_f32 v69, v83
    v_mul_f32 v68, v68, v82
    v_mul_f32 v69, v69, v82
    v_mul_f32 v84, v67, v69
    v_mul_f32 v85, v67, v68
    v_fma_f32 v68, v66, v68, -v84
    v_fma_f32 v69, -v66, v69, -v85
    v_mul_f32 v82, v64, v45
    v_mul_f32 v83, v65, v45
    v_exp_f32 v82, v82
    v_fract_f32 v83, v83
    v_cos_f32 v70, v83
    v_sin_f32 v71, v83
    v_mul_f32 v70, v70, v82
    v_mul_f32 v71, v71, v82
    v_mul_f32 v84, v67, v71
    v_mul_f32 v85, v67, v70
    v_fma_f32 v70, v66, v70, -v84
    v_fma_f32 v71, -v66, v71, -v85
    v_mul_f32 v82, v64, v46
    v_mul_f32 v83, v65, v46
    v_exp_f32 v82, v82
    v_fract_f32 v83, v83
    v_cos_f32 v72, v83
    v_sin_f32 v73, v83
    v_mul_f32 v72, v72, v82
    v_mul_f32 v73, v73, v82
    v_mul_f32 v84, v67, v73
    v_mul_f32 v85, v67, v72
    v_fma_f32 v72, v66, v72, -v84
    v_fma_f32 v73, -v66, v73, -v85
    v_mfma_f32_16x16x4_f32 v[48:51], v68, v74, v[48:51]
    v_mfma_f32_16x16x4_f32 v[52:55], v70, v76, v[52:55]
    v_mfma_f32_16x16x4_f32 v[56:59], v70, v78, v[56:59]
    v_mfma_f32_16x16x4_f32 v[60:63], v72, v80, v[60:63]
    v_mfma_f32_16x16x4_f32 v[48:51], v69, v75, v[48:51]
    v_mfma_f32_16x16x4_f32 v[52:55], v71, v77, v[52:55]
    v_mfma_f32_16x16x4_f32 v[56:59], v71, v79, v[56:59]
    v_mfma_f32_16x16x4_f32 v[60:63], v73, v81, v[60:63]
    v_mov_b32_dpp v64, v28 row_newbcast:6 row_mask:0xf bank_mask:0xf
    v_mov_b32_dpp v65, v29 row_newbcast:6 row_mask:0xf bank_mask:0xf
    v_mov_b32_dpp v66, v30 row_newbcast:6 row_mask:0xf bank_mask:0xf
    v_mov_b32_dpp v67, v31 row_newbcast:6 row_mask:0xf bank_mask:0xf
    v_mul_f32 v82, v64, v47
    v_mul_f32 v83, v65, v47
    v_exp_f32 v82, v82
    v_fract_f32 v83, v83
    v_cos_f32 v74, v83
    v_sin_f32 v75, v83
    v_mul_f32 v74, v74, v82
    v_mul_f32 v75, v75, v82
    v_mul_f32 v84, v75, v75
    v_add_f32 v85, v74, v74
    v_fma_f32 v76, v74, v74, -v84
    v_mul_f32 v77, v85, v75
    v_mul_f32 v84, v77, v77
    v_add_f32 v85, v76, v76
    v_fma_f32 v78, v76, v76, -v84
    v_mul_f32 v79, v85, v77
    v_mul_f32 v84, v79, v79
    v_add_f32 v85, v78, v78
    v_fma_f32 v80, v78, v78, -v84
    v_mul_f32 v81, v85, v79
    v_mul_f32 v82, v64, v44
    v_mul_f32 v83, v65, v44
    v_exp_f32 v82, v82
    v_fract_f32 v83, v83
    v_cos_f32 v68, v83
    v_sin_f32 v69, v83
    v_mul_f32 v68, v68, v82
    v_mul_f32 v69, v69, v82
    v_mul_f32 v84, v67, v69
    v_mul_f32 v85, v67, v68
    v_fma_f32 v68, v66, v68, -v84
    v_fma_f32 v69, -v66, v69, -v85
    v_mul_f32 v82, v64, v45
    v_mul_f32 v83, v65, v45
    v_exp_f32 v82, v82
    v_fract_f32 v83, v83
    v_cos_f32 v70, v83
    v_sin_f32 v71, v83
    v_mul_f32 v70, v70, v82
    v_mul_f32 v71, v71, v82
    v_mul_f32 v84, v67, v71
    v_mul_f32 v85, v67, v70
    v_fma_f32 v70, v66, v70, -v84
    v_fma_f32 v71, -v66, v71, -v85
    v_mul_f32 v82, v64, v46
    v_mul_f32 v83, v65, v46
    v_exp_f32 v82, v82
    v_fract_f32 v83, v83
    v_cos_f32 v72, v83
    v_sin_f32 v73, v83
    v_mul_f32 v72, v72, v82
    v_mul_f32 v73, v73, v82
    v_mul_f32 v84, v67, v73
    v_mul_f32 v85, v67, v72
    v_fma_f32 v72, v66, v72, -v84
    v_fma_f32 v73, -v66, v73, -v85
    v_mfma_f32_16x16x4_f32 v[48:51], v68, v74, v[48:51]
    v_mfma_f32_16x16x4_f32 v[52:55], v70, v76, v[52:55]
    v_mfma_f32_16x16x4_f32 v[56:59], v70, v78, v[56:59]
    v_mfma_f32_16x16x4_f32 v[60:63], v72, v80, v[60:63]
    v_mfma_f32_16x16x4_f32 v[48:51], v69, v75, v[48:51]
    v_mfma_f32_16x16x4_f32 v[52:55], v71, v77, v[52:55]
    v_mfma_f32_16x16x4_f32 v[56:59], v71, v79, v[56:59]
    v_mfma_f32_16x16x4_f32 v[60:63], v73, v81, v[60:63]
    v_mov_b32_dpp v64, v28 row_newbcast:7 row_mask:0xf bank_mask:0xf
    v_mov_b32_dpp v65, v29 row_newbcast:7 row_mask:0xf bank_mask:0xf
    v_mov_b32_dpp v66, v30 row_newbcast:7 row_mask:0xf bank_mask:0xf
    v_mov_b32_dpp v67, v31 row_newbcast:7 row_mask:0xf bank_mask:0xf
    v_mul_f32 v82, v64, v47
    v_mul_f32 v83, v65, v47
    v_exp_f32 v82, v82
    v_fract_f32 v83, v83
    v_cos_f32 v74, v83
    v_sin_f32 v75, v83
    v_mul_f32 v74, v74, v82
    v_mul_f32 v75, v75, v82
    v_mul_f32 v84, v75, v75
    v_add_f32 v85, v74, v74
    v_fma_f32 v76, v74, v74, -v84
    v_mul_f32 v77, v85, v75
    v_mul_f32 v84, v77, v77
    v_add_f32 v85, v76, v76
    v_fma_f32 v78, v76, v76, -v84
    v_mul_f32 v79, v85, v77
    v_mul_f32 v84, v79, v79
    v_add_f32 v85, v78, v78
    v_fma_f32 v80, v78, v78, -v84
    v_mul_f32 v81, v85, v79
    v_mul_f32 v82, v64, v44
    v_mul_f32 v83, v65, v44
    v_exp_f32 v82, v82
    v_fract_f32 v83, v83
    v_cos_f32 v68, v83
    v_sin_f32 v69, v83
    v_mul_f32 v68, v68, v82
    v_mul_f32 v69, v69, v82
    v_mul_f32 v84, v67, v69
    v_mul_f32 v85, v67, v68
    v_fma_f32 v68, v66, v68, -v84
    v_fma_f32 v69, -v66, v69, -v85
    v_mul_f32 v82, v64, v45
    v_mul_f32 v83, v65, v45
    v_exp_f32 v82, v82
    v_fract_f32 v83, v83
    v_cos_f32 v70, v83
    v_sin_f32 v71, v83
    v_mul_f32 v70, v70, v82
    v_mul_f32 v71, v71, v82
    v_mul_f32 v84, v67, v71
    v_mul_f32 v85, v67, v70
    v_fma_f32 v70, v66, v70, -v84
    v_fma_f32 v71, -v66, v71, -v85
    v_mul_f32 v82, v64, v46
    v_mul_f32 v83, v65, v46
    v_exp_f32 v82, v82
    v_fract_f32 v83, v83
    v_cos_f32 v72, v83
    v_sin_f32 v73, v83
    v_mul_f32 v72, v72, v82
    v_mul_f32 v73, v73, v82
    v_mul_f32 v84, v67, v73
    v_mul_f32 v85, v67, v72
    v_fma_f32 v72, v66, v72, -v84
    v_fma_f32 v73, -v66, v73, -v85
    v_mfma_f32_16x16x4_f32 v[48:51], v68, v74, v[48:51]
    v_mfma_f32_16x16x4_f32 v[52:55], v70, v76, v[52:55]
    v_mfma_f32_16x16x4_f32 v[56:59], v70, v78, v[56:59]
    v_mfma_f32_16x16x4_f32 v[60:63], v72, v80, v[60:63]
    v_mfma_f32_16x16x4_f32 v[48:51], v69, v75, v[48:51]
    v_mfma_f32_16x16x4_f32 v[52:55], v71, v77, v[52:55]
    v_mfma_f32_16x16x4_f32 v[56:59], v71, v79, v[56:59]
    v_mfma_f32_16x16x4_f32 v[60:63], v73, v81, v[60:63]
    v_mov_b32_dpp v64, v28 row_newbcast:8 row_mask:0xf bank_mask:0xf
    v_mov_b32_dpp v65, v29 row_newbcast:8 row_mask:0xf bank_mask:0xf
    v_mov_b32_dpp v66, v30 row_newbcast:8 row_mask:0xf bank_mask:0xf
    v_mov_b32_dpp v67, v31 row_newbcast:8 row_mask:0xf bank_mask:0xf
    v_mul_f32 v82, v64, v47
    v_mul_f32 v83, v65, v47
    v_exp_f32 v82, v82
    v_fract_f32 v83, v83
    v_cos_f32 v74, v83
    v_sin_f32 v75, v83
    v_mul_f32 v74, v74, v82
    v_mul_f32 v75, v75, v82
    v_mul_f32 v84, v75, v75
    v_add_f32 v85, v74, v74
    v_fma_f32 v76, v74, v74, -v84
    v_mul_f32 v77, v85, v75
    v_mul_f32 v84, v77, v77
    v_add_f32 v85, v76, v76
    v_fma_f32 v78, v76, v76, -v84
    v_mul_f32 v79, v85, v77
    v_mul_f32 v84, v79, v79
    v_add_f32 v85, v78, v78
    v_fma_f32 v80, v78, v78, -v84
    v_mul_f32 v81, v85, v79
    v_mul_f32 v82, v64, v44
    v_mul_f32 v83, v65, v44
    v_exp_f32 v82, v82
    v_fract_f32 v83, v83
    v_cos_f32 v68, v83
    v_sin_f32 v69, v83
    v_mul_f32 v68, v68, v82
    v_mul_f32 v69, v69, v82
    v_mul_f32 v84, v67, v69
    v_mul_f32 v85, v67, v68
    v_fma_f32 v68, v66, v68, -v84
    v_fma_f32 v69, -v66, v69, -v85
    v_mul_f32 v82, v64, v45
    v_mul_f32 v83, v65, v45
    v_exp_f32 v82, v82
    v_fract_f32 v83, v83
    v_cos_f32 v70, v83
    v_sin_f32 v71, v83
    v_mul_f32 v70, v70, v82
    v_mul_f32 v71, v71, v82
    v_mul_f32 v84, v67, v71
    v_mul_f32 v85, v67, v70
    v_fma_f32 v70, v66, v70, -v84
    v_fma_f32 v71, -v66, v71, -v85
    v_mul_f32 v82, v64, v46
    v_mul_f32 v83, v65, v46
    v_exp_f32 v82, v82
    v_fract_f32 v83, v83
    v_cos_f32 v72, v83
    v_sin_f32 v73, v83
    v_mul_f32 v72, v72, v82
    v_mul_f32 v73, v73, v82
    v_mul_f32 v84, v67, v73
    v_mul_f32 v85, v67, v72
    v_fma_f32 v72, v66, v72, -v84
    v_fma_f32 v73, -v66, v73, -v85
    v_mfma_f32_16x16x4_f32 v[48:51], v68, v74, v[48:51]
    v_mfma_f32_16x16x4_f32 v[52:55], v70, v76, v[52:55]
    v_mfma_f32_16x16x4_f32 v[56:59], v70, v78, v[56:59]
    v_mfma_f32_16x16x4_f32 v[60:63], v72, v80, v[60:63]
    v_mfma_f32_16x16x4_f32 v[48:51], v69, v75, v[48:51]
    v_mfma_f32_16x16x4_f32 v[52:55], v71, v77, v[52:55]
    v_mfma_f32_16x16x4_f32 v[56:59], v71, v79, v[56:59]
    v_mfma_f32_16x16x4_f32 v[60:63], v73, v81, v[60:63]
    v_mov_b32_dpp v64, v28 row_newbcast:9 row_mask:0xf bank_mask:0xf
    v_mov_b32_dpp v65, v29 row_newbcast:9 row_mask:0xf bank_mask:0xf
    v_mov_b32_dpp v66, v30 row_newbcast:9 row_mask:0xf bank_mask:0xf
    v_mov_b32_dpp v67, v31 row_newbcast:9 row_mask:0xf bank_mask:0xf
    v_mul_f32 v82, v64, v47
    v_mul_f32 v83, v65, v47
    v_exp_f32 v82, v82
    v_fract_f32 v83, v83
    v_cos_f32 v74, v83
    v_sin_f32 v75, v83
    v_mul_f32 v74, v74, v82
    v_mul_f32 v75, v75, v82
    v_mul_f32 v84, v75, v75
    v_add_f32 v85, v74, v74
    v_fma_f32 v76, v74, v74, -v84
    v_mul_f32 v77, v85, v75
    v_mul_f32 v84, v77, v77
    v_add_f32 v85, v76, v76
    v_fma_f32 v78, v76, v76, -v84
    v_mul_f32 v79, v85, v77
    v_mul_f32 v84, v79, v79
    v_add_f32 v85, v78, v78
    v_fma_f32 v80, v78, v78, -v84
    v_mul_f32 v81, v85, v79
    v_mul_f32 v82, v64, v44
    v_mul_f32 v83, v65, v44
    v_exp_f32 v82, v82
    v_fract_f32 v83, v83
    v_cos_f32 v68, v83
    v_sin_f32 v69, v83
    v_mul_f32 v68, v68, v82
    v_mul_f32 v69, v69, v82
    v_mul_f32 v84, v67, v69
    v_mul_f32 v85, v67, v68
    v_fma_f32 v68, v66, v68, -v84
    v_fma_f32 v69, -v66, v69, -v85
    v_mul_f32 v82, v64, v45
    v_mul_f32 v83, v65, v45
    v_exp_f32 v82, v82
    v_fract_f32 v83, v83
    v_cos_f32 v70, v83
    v_sin_f32 v71, v83
    v_mul_f32 v70, v70, v82
    v_mul_f32 v71, v71, v82
    v_mul_f32 v84, v67, v71
    v_mul_f32 v85, v67, v70
    v_fma_f32 v70, v66, v70, -v84
    v_fma_f32 v71, -v66, v71, -v85
    v_mul_f32 v82, v64, v46
    v_mul_f32 v83, v65, v46
    v_exp_f32 v82, v82
    v_fract_f32 v83, v83
    v_cos_f32 v72, v83
    v_sin_f32 v73, v83
    v_mul_f32 v72, v72, v82
    v_mul_f32 v73, v73, v82
    v_mul_f32 v84, v67, v73
    v_mul_f32 v85, v67, v72
    v_fma_f32 v72, v66, v72, -v84
    v_fma_f32 v73, -v66, v73, -v85
    v_mfma_f32_16x16x4_f32 v[48:51], v68, v74, v[48:51]
    v_mfma_f32_16x16x4_f32 v[52:55], v70, v76, v[52:55]
    v_mfma_f32_16x16x4_f32 v[56:59], v70, v78, v[56:59]
    v_mfma_f32_16x16x4_f32 v[60:63], v72, v80, v[60:63]
    v_mfma_f32_16x16x4_f32 v[48:51], v69, v75, v[48:51]
    v_mfma_f32_16x16x4_f32 v[52:55], v71, v77, v[52:55]
    v_mfma_f32_16x16x4_f32 v[56:59], v71, v79, v[56:59]
    v_mfma_f32_16x16x4_f32 v[60:63], v73, v81, v[60:63]
    v_mov_b32_dpp v64, v28 row_newbcast:10 row_mask:0xf bank_mask:0xf
    v_mov_b32_dpp v65, v29 row_newbcast:10 row_mask:0xf bank_mask:0xf
    v_mov_b32_dpp v66, v30 row_newbcast:10 row_mask:0xf bank_mask:0xf
    v_mov_b32_dpp v67, v31 row_newbcast:10 row_mask:0xf bank_mask:0xf
    v_mul_f32 v82, v64, v47
    v_mul_f32 v83, v65, v47
    v_exp_f32 v82, v82
    v_fract_f32 v83, v83
    v_cos_f32 v74, v83
    v_sin_f32 v75, v83
    v_mul_f32 v74, v74, v82
    v_mul_f32 v75, v75, v82
    v_mul_f32 v84, v75, v75
    v_add_f32 v85, v74, v74
    v_fma_f32 v76, v74, v74, -v84
    v_mul_f32 v77, v85, v75
    v_mul_f32 v84, v77, v77
    v_add_f32 v85, v76, v76
    v_fma_f32 v78, v76, v76, -v84
    v_mul_f32 v79, v85, v77
    v_mul_f32 v84, v79, v79
    v_add_f32 v85, v78, v78
    v_fma_f32 v80, v78, v78, -v84
    v_mul_f32 v81, v85, v79
    v_mul_f32 v82, v64, v44
    v_mul_f32 v83, v65, v44
    v_exp_f32 v82, v82
    v_fract_f32 v83, v83
    v_cos_f32 v68, v83
    v_sin_f32 v69, v83
    v_mul_f32 v68, v68, v82
    v_mul_f32 v69, v69, v82
    v_mul_f32 v84, v67, v69
    v_mul_f32 v85, v67, v68
    v_fma_f32 v68, v66, v68, -v84
    v_fma_f32 v69, -v66, v69, -v85
    v_mul_f32 v82, v64, v45
    v_mul_f32 v83, v65, v45
    v_exp_f32 v82, v82
    v_fract_f32 v83, v83
    v_cos_f32 v70, v83
    v_sin_f32 v71, v83
    v_mul_f32 v70, v70, v82
    v_mul_f32 v71, v71, v82
    v_mul_f32 v84, v67, v71
    v_mul_f32 v85, v67, v70
    v_fma_f32 v70, v66, v70, -v84
    v_fma_f32 v71, -v66, v71, -v85
    v_mul_f32 v82, v64, v46
    v_mul_f32 v83, v65, v46
    v_exp_f32 v82, v82
    v_fract_f32 v83, v83
    v_cos_f32 v72, v83
    v_sin_f32 v73, v83
    v_mul_f32 v72, v72, v82
    v_mul_f32 v73, v73, v82
    v_mul_f32 v84, v67, v73
    v_mul_f32 v85, v67, v72
    v_fma_f32 v72, v66, v72, -v84
    v_fma_f32 v73, -v66, v73, -v85
    v_mfma_f32_16x16x4_f32 v[48:51], v68, v74, v[48:51]
    v_mfma_f32_16x16x4_f32 v[52:55], v70, v76, v[52:55]
    v_mfma_f32_16x16x4_f32 v[56:59], v70, v78, v[56:59]
    v_mfma_f32_16x16x4_f32 v[60:63], v72, v80, v[60:63]
    v_mfma_f32_16x16x4_f32 v[48:51], v69, v75, v[48:51]
    v_mfma_f32_16x16x4_f32 v[52:55], v71, v77, v[52:55]
    v_mfma_f32_16x16x4_f32 v[56:59], v71, v79, v[56:59]
    v_mfma_f32_16x16x4_f32 v[60:63], v73, v81, v[60:63]
    v_mov_b32_dpp v64, v28 row_newbcast:11 row_mask:0xf bank_mask:0xf
    v_mov_b32_dpp v65, v29 row_newbcast:11 row_mask:0xf bank_mask:0xf
    v_mov_b32_dpp v66, v30 row_newbcast:11 row_mask:0xf bank_mask:0xf
    v_mov_b32_dpp v67, v31 row_newbcast:11 row_mask:0xf bank_mask:0xf
    v_mul_f32 v82, v64, v47
    v_mul_f32 v83, v65, v47
    v_exp_f32 v82, v82
    v_fract_f32 v83, v83
    v_cos_f32 v74, v83
    v_sin_f32 v75, v83
    v_mul_f32 v74, v74, v82
    v_mul_f32 v75, v75, v82
    v_mul_f32 v84, v75, v75
    v_add_f32 v85, v74, v74
    v_fma_f32 v76, v74, v74, -v84
    v_mul_f32 v77, v85, v75
    v_mul_f32 v84, v77, v77
    v_add_f32 v85, v76, v76
    v_fma_f32 v78, v76, v76, -v84
    v_mul_f32 v79, v85, v77
    v_mul_f32 v84, v79, v79
    v_add_f32 v85, v78, v78
    v_fma_f32 v80, v78, v78, -v84
    v_mul_f32 v81, v85, v79
    v_mul_f32 v82, v64, v44
    v_mul_f32 v83, v65, v44
    v_exp_f32 v82, v82
    v_fract_f32 v83, v83
    v_cos_f32 v68, v83
    v_sin_f32 v69, v83
    v_mul_f32 v68, v68, v82
    v_mul_f32 v69, v69, v82
    v_mul_f32 v84, v67, v69
    v_mul_f32 v85, v67, v68
    v_fma_f32 v68, v66, v68, -v84
    v_fma_f32 v69, -v66, v69, -v85
    v_mul_f32 v82, v64, v45
    v_mul_f32 v83, v65, v45
    v_exp_f32 v82, v82
    v_fract_f32 v83, v83
    v_cos_f32 v70, v83
    v_sin_f32 v71, v83
    v_mul_f32 v70, v70, v82
    v_mul_f32 v71, v71, v82
    v_mul_f32 v84, v67, v71
    v_mul_f32 v85, v67, v70
    v_fma_f32 v70, v66, v70, -v84
    v_fma_f32 v71, -v66, v71, -v85
    v_mul_f32 v82, v64, v46
    v_mul_f32 v83, v65, v46
    v_exp_f32 v82, v82
    v_fract_f32 v83, v83
    v_cos_f32 v72, v83
    v_sin_f32 v73, v83
    v_mul_f32 v72, v72, v82
    v_mul_f32 v73, v73, v82
    v_mul_f32 v84, v67, v73
    v_mul_f32 v85, v67, v72
    v_fma_f32 v72, v66, v72, -v84
    v_fma_f32 v73, -v66, v73, -v85
    v_mfma_f32_16x16x4_f32 v[48:51], v68, v74, v[48:51]
    v_mfma_f32_16x16x4_f32 v[52:55], v70, v76, v[52:55]
    v_mfma_f32_16x16x4_f32 v[56:59], v70, v78, v[56:59]
    v_mfma_f32_16x16x4_f32 v[60:63], v72, v80, v[60:63]
    v_mfma_f32_16x16x4_f32 v[48:51], v69, v75, v[48:51]
    v_mfma_f32_16x16x4_f32 v[52:55], v71, v77, v[52:55]
    v_mfma_f32_16x16x4_f32 v[56:59], v71, v79, v[56:59]
    v_mfma_f32_16x16x4_f32 v[60:63], v73, v81, v[60:63]
    v_mov_b32_dpp v64, v28 row_newbcast:12 row_mask:0xf bank_mask:0xf
    v_mov_b32_dpp v65, v29 row_newbcast:12 row_mask:0xf bank_mask:0xf
    v_mov_b32_dpp v66, v30 row_newbcast:12 row_mask:0xf bank_mask:0xf
    v_mov_b32_dpp v67, v31 row_newbcast:12 row_mask:0xf bank_mask:0xf
    v_mul_f32 v82, v64, v47
    v_mul_f32 v83, v65, v47
    v_exp_f32 v82, v82
    v_fract_f32 v83, v83
    v_cos_f32 v74, v83
    v_sin_f32 v75, v83
    v_mul_f32 v74, v74, v82
    v_mul_f32 v75, v75, v82
    v_mul_f32 v84, v75, v75
    v_add_f32 v85, v74, v74
    v_fma_f32 v76, v74, v74, -v84
    v_mul_f32 v77, v85, v75
    v_mul_f32 v84, v77, v77
    v_add_f32 v85, v76, v76
    v_fma_f32 v78, v76, v76, -v84
    v_mul_f32 v79, v85, v77
    v_mul_f32 v84, v79, v79
    v_add_f32 v85, v78, v78
    v_fma_f32 v80, v78, v78, -v84
    v_mul_f32 v81, v85, v79
    v_mul_f32 v82, v64, v44
    v_mul_f32 v83, v65, v44
    v_exp_f32 v82, v82
    v_fract_f32 v83, v83
    v_cos_f32 v68, v83
    v_sin_f32 v69, v83
    v_mul_f32 v68, v68, v82
    v_mul_f32 v69, v69, v82
    v_mul_f32 v84, v67, v69
    v_mul_f32 v85, v67, v68
    v_fma_f32 v68, v66, v68, -v84
    v_fma_f32 v69, -v66, v69, -v85
    v_mul_f32 v82, v64, v45
    v_mul_f32 v83, v65, v45
    v_exp_f32 v82, v82
    v_fract_f32 v83, v83
    v_cos_f32 v70, v83
    v_sin_f32 v71, v83
    v_mul_f32 v70, v70, v82
    v_mul_f32 v71, v71, v82
    v_mul_f32 v84, v67, v71
    v_mul_f32 v85, v67, v70
    v_fma_f32 v70, v66, v70, -v84
    v_fma_f32 v71, -v66, v71, -v85
    v_mul_f32 v82, v64, v46
    v_mul_f32 v83, v65, v46
    v_exp_f32 v82, v82
    v_fract_f32 v83, v83
    v_cos_f32 v72, v83
    v_sin_f32 v73, v83
    v_mul_f32 v72, v72, v82
    v_mul_f32 v73, v73, v82
    v_mul_f32 v84, v67, v73
    v_mul_f32 v85, v67, v72
    v_fma_f32 v72, v66, v72, -v84
    v_fma_f32 v73, -v66, v73, -v85
    v_mfma_f32_16x16x4_f32 v[48:51], v68, v74, v[48:51]
    v_mfma_f32_16x16x4_f32 v[52:55], v70, v76, v[52:55]
    v_mfma_f32_16x16x4_f32 v[56:59], v70, v78, v[56:59]
    v_mfma_f32_16x16x4_f32 v[60:63], v72, v80, v[60:63]
    v_mfma_f32_16x16x4_f32 v[48:51], v69, v75, v[48:51]
    v_mfma_f32_16x16x4_f32 v[52:55], v71, v77, v[52:55]
    v_mfma_f32_16x16x4_f32 v[56:59], v71, v79, v[56:59]
    v_mfma_f32_16x16x4_f32 v[60:63], v73, v81, v[60:63]
    v_mov_b32_dpp v64, v28 row_newbcast:13 row_mask:0xf bank_mask:0xf
    v_mov_b32_dpp v65, v29 row_newbcast:13 row_mask:0xf bank_mask:0xf
    v_mov_b32_dpp v66, v30 row_newbcast:13 row_mask:0xf bank_mask:0xf
    v_mov_b32_dpp v67, v31 row_newbcast:13 row_mask:0xf bank_mask:0xf
    v_mul_f32 v82, v64, v47
    v_mul_f32 v83, v65, v47
    v_exp_f32 v82, v82
    v_fract_f32 v83, v83
    v_cos_f32 v74, v83
    v_sin_f32 v75, v83
    v_mul_f32 v74, v74, v82
    v_mul_f32 v75, v75, v82
    v_mul_f32 v84, v75, v75
    v_add_f32 v85, v74, v74
    v_fma_f32 v76, v74, v74, -v84
    v_mul_f32 v77, v85, v75
    v_mul_f32 v84, v77, v77
    v_add_f32 v85, v76, v76
    v_fma_f32 v78, v76, v76, -v84
    v_mul_f32 v79, v85, v77
    v_mul_f32 v84, v79, v79
    v_add_f32 v85, v78, v78
    v_fma_f32 v80, v78, v78, -v84
    v_mul_f32 v81, v85, v79
    v_mul_f32 v82, v64, v44
    v_mul_f32 v83, v65, v44
    v_exp_f32 v82, v82
    v_fract_f32 v83, v83
    v_cos_f32 v68, v83
    v_sin_f32 v69, v83
    v_mul_f32 v68, v68, v82
    v_mul_f32 v69, v69, v82
    v_mul_f32 v84, v67, v69
    v_mul_f32 v85, v67, v68
    v_fma_f32 v68, v66, v68, -v84
    v_fma_f32 v69, -v66, v69, -v85
    v_mul_f32 v82, v64, v45
    v_mul_f32 v83, v65, v45
    v_exp_f32 v82, v82
    v_fract_f32 v83, v83
    v_cos_f32 v70, v83
    v_sin_f32 v71, v83
    v_mul_f32 v70, v70, v82
    v_mul_f32 v71, v71, v82
    v_mul_f32 v84, v67, v71
    v_mul_f32 v85, v67, v70
    v_fma_f32 v70, v66, v70, -v84
    v_fma_f32 v71, -v66, v71, -v85
    v_mul_f32 v82, v64, v46
    v_mul_f32 v83, v65, v46
    v_exp_f32 v82, v82
    v_fract_f32 v83, v83
    v_cos_f32 v72, v83
    v_sin_f32 v73, v83
    v_mul_f32 v72, v72, v82
    v_mul_f32 v73, v73, v82
    v_mul_f32 v84, v67, v73
    v_mul_f32 v85, v67, v72
    v_fma_f32 v72, v66, v72, -v84
    v_fma_f32 v73, -v66, v73, -v85
    v_mfma_f32_16x16x4_f32 v[48:51], v68, v74, v[48:51]
    v_mfma_f32_16x16x4_f32 v[52:55], v70, v76, v[52:55]
    v_mfma_f32_16x16x4_f32 v[56:59], v70, v78, v[56:59]
    v_mfma_f32_16x16x4_f32 v[60:63], v72, v80, v[60:63]
    v_mfma_f32_16x16x4_f32 v[48:51], v69, v75, v[48:51]
    v_mfma_f32_16x16x4_f32 v[52:55], v71, v77, v[52:55]
    v_mfma_f32_16x16x4_f32 v[56:59], v71, v79, v[56:59]
    v_mfma_f32_16x16x4_f32 v[60:63], v73, v81, v[60:63]
    v_mov_b32_dpp v64, v28 row_newbcast:14 row_mask:0xf bank_mask:0xf
    v_mov_b32_dpp v65, v29 row_newbcast:14 row_mask:0xf bank_mask:0xf
    v_mov_b32_dpp v66, v30 row_newbcast:14 row_mask:0xf bank_mask:0xf
    v_mov_b32_dpp v67, v31 row_newbcast:14 row_mask:0xf bank_mask:0xf
    v_mul_f32 v82, v64, v47
    v_mul_f32 v83, v65, v47
    v_exp_f32 v82, v82
    v_fract_f32 v83, v83
    v_cos_f32 v74, v83
    v_sin_f32 v75, v83
    v_mul_f32 v74, v74, v82
    v_mul_f32 v75, v75, v82
    v_mul_f32 v84, v75, v75
    v_add_f32 v85, v74, v74
    v_fma_f32 v76, v74, v74, -v84
    v_mul_f32 v77, v85, v75
    v_mul_f32 v84, v77, v77
    v_add_f32 v85, v76, v76
    v_fma_f32 v78, v76, v76, -v84
    v_mul_f32 v79, v85, v77
    v_mul_f32 v84, v79, v79
    v_add_f32 v85, v78, v78
    v_fma_f32 v80, v78, v78, -v84
    v_mul_f32 v81, v85, v79
    v_mul_f32 v82, v64, v44
    v_mul_f32 v83, v65, v44
    v_exp_f32 v82, v82
    v_fract_f32 v83, v83
    v_cos_f32 v68, v83
    v_sin_f32 v69, v83
    v_mul_f32 v68, v68, v82
    v_mul_f32 v69, v69, v82
    v_mul_f32 v84, v67, v69
    v_mul_f32 v85, v67, v68
    v_fma_f32 v68, v66, v68, -v84
    v_fma_f32 v69, -v66, v69, -v85
    v_mul_f32 v82, v64, v45
    v_mul_f32 v83, v65, v45
    v_exp_f32 v82, v82
    v_fract_f32 v83, v83
    v_cos_f32 v70, v83
    v_sin_f32 v71, v83
    v_mul_f32 v70, v70, v82
    v_mul_f32 v71, v71, v82
    v_mul_f32 v84, v67, v71
    v_mul_f32 v85, v67, v70
    v_fma_f32 v70, v66, v70, -v84
    v_fma_f32 v71, -v66, v71, -v85
    v_mul_f32 v82, v64, v46
    v_mul_f32 v83, v65, v46
    v_exp_f32 v82, v82
    v_fract_f32 v83, v83
    v_cos_f32 v72, v83
    v_sin_f32 v73, v83
    v_mul_f32 v72, v72, v82
    v_mul_f32 v73, v73, v82
    v_mul_f32 v84, v67, v73
    v_mul_f32 v85, v67, v72
    v_fma_f32 v72, v66, v72, -v84
    v_fma_f32 v73, -v66, v73, -v85
    v_mfma_f32_16x16x4_f32 v[48:51], v68, v74, v[48:51]
    v_mfma_f32_16x16x4_f32 v[52:55], v70, v76, v[52:55]
    v_mfma_f32_16x16x4_f32 v[56:59], v70, v78, v[56:59]
    v_mfma_f32_16x16x4_f32 v[60:63], v72, v80, v[60:63]
    v_mfma_f32_16x16x4_f32 v[48:51], v69, v75, v[48:51]
    v_mfma_f32_16x16x4_f32 v[52:55], v71, v77, v[52:55]
    v_mfma_f32_16x16x4_f32 v[56:59], v71, v79, v[56:59]
    v_mfma_f32_16x16x4_f32 v[60:63], v73, v81, v[60:63]
    v_mov_b32_dpp v64, v28 row_newbcast:15 row_mask:0xf bank_mask:0xf
    v_mov_b32_dpp v65, v29 row_newbcast:15 row_mask:0xf bank_mask:0xf
    v_mov_b32_dpp v66, v30 row_newbcast:15 row_mask:0xf bank_mask:0xf
    v_mov_b32_dpp v67, v31 row_newbcast:15 row_mask:0xf bank_mask:0xf
    v_mul_f32 v82, v64, v47
    v_mul_f32 v83, v65, v47
    v_exp_f32 v82, v82
    v_fract_f32 v83, v83
    v_cos_f32 v74, v83
    v_sin_f32 v75, v83
    v_mul_f32 v74, v74, v82
    v_mul_f32 v75, v75, v82
    v_mul_f32 v84, v75, v75
    v_add_f32 v85, v74, v74
    v_fma_f32 v76, v74, v74, -v84
    v_mul_f32 v77, v85, v75
    v_mul_f32 v84, v77, v77
    v_add_f32 v85, v76, v76
    v_fma_f32 v78, v76, v76, -v84
    v_mul_f32 v79, v85, v77
    v_mul_f32 v84, v79, v79
    v_add_f32 v85, v78, v78
    v_fma_f32 v80, v78, v78, -v84
    v_mul_f32 v81, v85, v79
    v_mul_f32 v82, v64, v44
    v_mul_f32 v83, v65, v44
    v_exp_f32 v82, v82
    v_fract_f32 v83, v83
    v_cos_f32 v68, v83
    v_sin_f32 v69, v83
    v_mul_f32 v68, v68, v82
    v_mul_f32 v69, v69, v82
    v_mul_f32 v84, v67, v69
    v_mul_f32 v85, v67, v68
    v_fma_f32 v68, v66, v68, -v84
    v_fma_f32 v69, -v66, v69, -v85
    v_mul_f32 v82, v64, v45
    v_mul_f32 v83, v65, v45
    v_exp_f32 v82, v82
    v_fract_f32 v83, v83
    v_cos_f32 v70, v83
    v_sin_f32 v71, v83
    v_mul_f32 v70, v70, v82
    v_mul_f32 v71, v71, v82
    v_mul_f32 v84, v67, v71
    v_mul_f32 v85, v67, v70
    v_fma_f32 v70, v66, v70, -v84
    v_fma_f32 v71, -v66, v71, -v85
    v_mul_f32 v82, v64, v46
    v_mul_f32 v83, v65, v46
    v_exp_f32 v82, v82
    v_fract_f32 v83, v83
    v_cos_f32 v72, v83
    v_sin_f32 v73, v83
    v_mul_f32 v72, v72, v82
    v_mul_f32 v73, v73, v82
    v_mul_f32 v84, v67, v73
    v_mul_f32 v85, v67, v72
    v_fma_f32 v72, v66, v72, -v84
    v_fma_f32 v73, -v66, v73, -v85
    v_mfma_f32_16x16x4_f32 v[48:51], v68, v74, v[48:51]
    v_mfma_f32_16x16x4_f32 v[52:55], v70, v76, v[52:55]
    v_mfma_f32_16x16x4_f32 v[56:59], v70, v78, v[56:59]
    v_mfma_f32_16x16x4_f32 v[60:63], v72, v80, v[60:63]
    v_mfma_f32_16x16x4_f32 v[48:51], v69, v75, v[48:51]
    v_mfma_f32_16x16x4_f32 v[52:55], v71, v77, v[52:55]
    v_mfma_f32_16x16x4_f32 v[56:59], v71, v79, v[56:59]
    v_mfma_f32_16x16x4_f32 v[60:63], v73, v81, v[60:63]
    v_lshlrev_b32 v5, 8, v3
    v_lshl_add_u32 v5, v2, 2, v5
    v_add_u32 v5, v5, v4
    ds_write_b32 v5, v48 offset:4608
    ds_write_b32 v5, v49 offset:4672
    ds_write_b32 v5, v50 offset:4736
    ds_write_b32 v5, v51 offset:4800
    v_cmp_gt_u32 vcc, 2, v3
    s_nop 0
    s_mov_b64 exec, vcc
    ds_write_b32 v5, v52 offset:5632
    ds_write_b32 v5, v53 offset:5696
    ds_write_b32 v5, v54 offset:5760
    ds_write_b32 v5, v55 offset:5824
    ds_write_b32 v5, v60 offset:6656
    ds_write_b32 v5, v61 offset:6720
    ds_write_b32 v5, v62 offset:6784
    ds_write_b32 v5, v63 offset:6848
    s_not_b64 exec, exec
    ds_write_b32 v5, v56 offset:5632
    ds_write_b32 v5, v57 offset:5696
    ds_write_b32 v5, v58 offset:5760
    ds_write_b32 v5, v59 offset:5824
    s_mov_b32 exec_lo, 0
    s_mov_b32 exec_hi, 3
    v_cmp_eq_u32 vcc, 0, v2
    s_nop 1
    v_cndmask_b32 v6, 0, v60, vcc
    ds_write_b32 v5, v6 offset:6656
    s_mov_b64 exec, -1
    s_waitcnt lgkmcnt(0)
    v_lshlrev_b32 v7, 1, v1
    v_sub_u32 v7, 2065, v7
    v_lshl_add_u32 v64, v1, 2, v4
    v_mov_b32 v65, 641
    s_mov_b32 s25, 17
ss_exp:
    v_subrev_u32 v66, 0, v7
    v_cvt_f32_u32 v70, v66
    v_cvt_pk_bf16_f32 v70, v70, v70
    v_and_b32 v70, 0xffff, v70
    v_subrev_u32 v70, 0x4280, v70
    v_cmp_gt_u32 vcc, 256, v66
    s_nop 1
    v_cndmask_b32 v70, v70, v66, vcc
    v_cmp_gt_u32 vcc, 2048, v66
    s_nop 1
    v_cndmask_b32 v70, v65, v70, vcc
    v_lshl_add_u32 v70, v70, 2, v4
    ds_read_b32 v74, v70 offset:4608
    v_subrev_u32 v67, 1, v7
    v_cvt_f32_u32 v71, v67
    v_cvt_pk_bf16_f32 v71, v71, v71
    v_and_b32 v71, 0xffff, v71
    v_subrev_u32 v71, 0x4280, v71
    v_cmp_gt_u32 vcc, 256, v67
    s_nop 1
    v_cndmask_b32 v71, v71, v67, vcc
    v_cmp_gt_u32 vcc, 2048, v67
    s_nop 1
    v_cndmask_b32 v71, v65, v71, vcc
    v_lshl_add_u32 v71, v71, 2, v4
    ds_read_b32 v75, v71 offset:4608
    v_subrev_u32 v68, 2, v7
    v_cvt_f32_u32 v72, v68
    v_cvt_pk_bf16_f32 v72, v72, v72
    v_and_b32 v72, 0xffff, v72
    v_subrev_u32 v72, 0x4280, v72
    v_cmp_gt_u32 vcc, 256, v68
    s_nop 1
    v_cndmask_b32 v72, v72, v68, vcc
    v_cmp_gt_u32 vcc, 2048, v68
    s_nop 1
    v_cndmask_b32 v72, v65, v72, vcc
    v_lshl_add_u32 v72, v72, 2, v4
    ds_read_b32 v76, v72 offset:4608
    s_waitcnt lgkmcnt(0)
    v_cvt_pk_bf16_f32 v78, v75, v76
    v_cvt_pk_bf16_f32 v79, v74, v75
    ds_write_b32 v64, v78 offset:7424
    ds_write_b32 v64, v79 offset:11776
    v_subrev_u32 v7, 128, v7
    v_add_u32 v64, 256, v64
    s_sub_u32 s25, s25, 1
    s_cmp_lg_u32 s25, 0
    s_cbranch_scc1 ss_exp
    s_waitcnt lgkmcnt(0)
    s_barrier
    v_and_b32 v5, 1, v2
    v_mul_u32_u24 v64, 4352, v5
    v_sub_u32 v5, v5, v2
    v_lshl_add_u32 v5, v3, 3, v5
    v_lshl_add_u32 v64, v5, 1, v64
    v_add_u32 v64, 11520, v64
    v_add_u32 v64, v64, v4
    v_lshlrev_b32 v65, 5, v2
    v_lshl_add_u32 v65, v3, 4, v65
    v_add_u32 v65, 480, v65
    v_add_u32 v65, v65, v4
    v_mov_b32 v96, 0
    v_mov_b32 v97, 0
    v_mov_b32 v98, 0
    v_mov_b32 v99, 0
    v_mov_b32 v100, 0
    v_mov_b32 v101, 0
    v_mov_b32 v102, 0
    v_mov_b32 v103, 0
    v_mov_b32 v104, 0
    v_mov_b32 v105, 0
    v_mov_b32 v106, 0
    v_mov_b32 v107, 0
    v_mov_b32 v108, 0
    v_mov_b32 v109, 0
    v_mov_b32 v110, 0
    v_mov_b32 v111, 0
    v_mov_b32 v112, 0
    v_mov_b32 v113, 0
    v_mov_b32 v114, 0
    v_mov_b32 v115, 0
    v_mov_b32 v116, 0
    v_mov_b32 v117, 0
    v_mov_b32 v118, 0
    v_mov_b32 v119, 0
    v_mov_b32 v120, 0
    v_mov_b32 v121, 0
    v_mov_b32 v122, 0
    v_mov_b32 v123, 0
    v_mov_b32 v124, 0
    v_mov_b32 v125, 0
    v_mov_b32 v126, 0
    v_mov_b32 v127, 0
    s_mov_b32 s25, 8
ss_cv0:
    ds_read2_b32 v[68:69], v64 offset0:0 offset1:1
    ds_read2_b32 v[70:71], v64 offset0:2 offset1:3
    ds_read_b128 v[128:131], v65 offset:0
    ds_read_b128 v[132:135], v65 offset:512
    ds_read_b128 v[136:139], v65 offset:1024
    ds_read_b128 v[140:143], v65 offset:1536
    ds_read_b128 v[144:147], v65 offset:2048
    ds_read_b128 v[148:151], v65 offset:2560
    ds_read_b128 v[152:155], v65 offset:3072
    ds_read_b128 v[156:159], v65 offset:3584
    v_subrev_u32 v64, 64, v64
    v_subrev_u32 v65, 64, v65
    s_waitcnt lgkmcnt(7)
    v_mfma_f32_16x16x32_bf16 v[96:99], v[68:71], v[128:131], v[96:99]
    s_waitcnt lgkmcnt(6)
    v_mfma_f32_16x16x32_bf16 v[100:103], v[68:71], v[132:135], v[100:103]
    s_waitcnt lgkmcnt(5)
    v_mfma_f32_16x16x32_bf16 v[104:107], v[68:71], v[136:139], v[104:107]
    s_waitcnt lgkmcnt(4)
    v_mfma_f32_16x16x32_bf16 v[108:111], v[68:71], v[140:143], v[108:111]
    s_waitcnt lgkmcnt(3)
    v_mfma_f32_16x16x32_bf16 v[112:115], v[68:71], v[144:147], v[112:115]
    s_waitcnt lgkmcnt(2)
    v_mfma_f32_16x16x32_bf16 v[116:119], v[68:71], v[148:151], v[116:119]
    s_waitcnt lgkmcnt(1)
    v_mfma_f32_16x16x32_bf16 v[120:123], v[68:71], v[152:155], v[120:123]
    s_waitcnt lgkmcnt(0)
    v_mfma_f32_16x16x32_bf16 v[124:127], v[68:71], v[156:159], v[124:127]
    s_sub_u32 s25, s25, 1
    s_cmp_lg_u32 s25, 0
    s_cbranch_scc1 ss_cv0
    v_add_u32 v65, 512, v65
    s_mov_b32 s25, 8
ss_cv1:
    ds_read2_b32 v[68:69], v64 offset0:0 offset1:1
    ds_read2_b32 v[70:71], v64 offset0:2 offset1:3
    ds_read_b128 v[132:135], v65 offset:0
    ds_read_b128 v[136:139], v65 offset:512
    ds_read_b128 v[140:143], v65 offset:1024
    ds_read_b128 v[144:147], v65 offset:1536
    ds_read_b128 v[148:151], v65 offset:2048
    ds_read_b128 v[152:155], v65 offset:2560
    ds_read_b128 v[156:159], v65 offset:3072
    v_subrev_u32 v64, 64, v64
    v_subrev_u32 v65, 64, v65
    s_waitcnt lgkmcnt(6)
    v_mfma_f32_16x16x32_bf16 v[100:103], v[68:71], v[132:135], v[100:103]
    s_waitcnt lgkmcnt(5)
    v_mfma_f32_16x16x32_bf16 v[104:107], v[68:71], v[136:139], v[104:107]
    s_waitcnt lgkmcnt(4)
    v_mfma_f32_16x16x32_bf16 v[108:111], v[68:71], v[140:143], v[108:111]
    s_waitcnt lgkmcnt(3)
    v_mfma_f32_16x16x32_bf16 v[112:115], v[68:71], v[144:147], v[112:115]
    s_waitcnt lgkmcnt(2)
    v_mfma_f32_16x16x32_bf16 v[116:119], v[68:71], v[148:151], v[116:119]
    s_waitcnt lgkmcnt(1)
    v_mfma_f32_16x16x32_bf16 v[120:123], v[68:71], v[152:155], v[120:123]
    s_waitcnt lgkmcnt(0)
    v_mfma_f32_16x16x32_bf16 v[124:127], v[68:71], v[156:159], v[124:127]
    s_sub_u32 s25, s25, 1
    s_cmp_lg_u32 s25, 0
    s_cbranch_scc1 ss_cv1
    v_add_u32 v65, 512, v65
    s_mov_b32 s25, 8
ss_cv2:
    ds_read2_b32 v[68:69], v64 offset0:0 offset1:1
    ds_read2_b32 v[70:71], v64 offset0:2 offset1:3
    ds_read_b128 v[136:139], v65 offset:0
    ds_read_b128 v[140:143], v65 offset:512
    ds_read_b128 v[144:147], v65 offset:1024
    ds_read_b128 v[148:151], v65 offset:1536
    ds_read_b128 v[152:155], v65 offset:2048
    ds_read_b128 v[156:159], v65 offset:2560
    v_subrev_u32 v64, 64, v64
    v_subrev_u32 v65, 64, v65
    s_waitcnt lgkmcnt(5)
    v_mfma_f32_16x16x32_bf16 v[104:107], v[68:71], v[136:139], v[104:107]
    s_waitcnt lgkmcnt(4)
    v_mfma_f32_16x16x32_bf16 v[108:111], v[68:71], v[140:143], v[108:111]
    s_waitcnt lgkmcnt(3)
    v_mfma_f32_16x16x32_bf16 v[112:115], v[68:71], v[144:147], v[112:115]
    s_waitcnt lgkmcnt(2)
    v_mfma_f32_16x16x32_bf16 v[116:119], v[68:71], v[148:151], v[116:119]
    s_waitcnt lgkmcnt(1)
    v_mfma_f32_16x16x32_bf16 v[120:123], v[68:71], v[152:155], v[120:123]
    s_waitcnt lgkmcnt(0)
    v_mfma_f32_16x16x32_bf16 v[124:127], v[68:71], v[156:159], v[124:127]
    s_sub_u32 s25, s25, 1
    s_cmp_lg_u32 s25, 0
    s_cbranch_scc1 ss_cv2
    v_add_u32 v65, 512, v65
    s_mov_b32 s25, 8
ss_cv3:
    ds_read2_b32 v[68:69], v64 offset0:0 offset1:1
    ds_read2_b32 v[70:71], v64 offset0:2 offset1:3
    ds_read_b128 v[140:143], v65 offset:0
    ds_read_b128 v[144:147], v65 offset:512
    ds_read_b128 v[148:151], v65 offset:1024
    ds_read_b128 v[152:155], v65 offset:1536
    ds_read_b128 v[156:159], v65 offset:2048
    v_subrev_u32 v64, 64, v64
    v_subrev_u32 v65, 64, v65
    s_waitcnt lgkmcnt(4)
    v_mfma_f32_16x16x32_bf16 v[108:111], v[68:71], v[140:143], v[108:111]
    s_waitcnt lgkmcnt(3)
    v_mfma_f32_16x16x32_bf16 v[112:115], v[68:71], v[144:147], v[112:115]
    s_waitcnt lgkmcnt(2)
    v_mfma_f32_16x16x32_bf16 v[116:119], v[68:71], v[148:151], v[116:119]
    s_waitcnt lgkmcnt(1)
    v_mfma_f32_16x16x32_bf16 v[120:123], v[68:71], v[152:155], v[120:123]
    s_waitcnt lgkmcnt(0)
    v_mfma_f32_16x16x32_bf16 v[124:127], v[68:71], v[156:159], v[124:127]
    s_sub_u32 s25, s25, 1
    s_cmp_lg_u32 s25, 0
    s_cbranch_scc1 ss_cv3
    v_add_u32 v65, 512, v65
    s_mov_b32 s25, 8
ss_cv4:
    ds_read2_b32 v[68:69], v64 offset0:0 offset1:1
    ds_read2_b32 v[70:71], v64 offset0:2 offset1:3
    ds_read_b128 v[144:147], v65 offset:0
    ds_read_b128 v[148:151], v65 offset:512
    ds_read_b128 v[152:155], v65 offset:1024
    ds_read_b128 v[156:159], v65 offset:1536
    v_subrev_u32 v64, 64, v64
    v_subrev_u32 v65, 64, v65
    s_waitcnt lgkmcnt(3)
    v_mfma_f32_16x16x32_bf16 v[112:115], v[68:71], v[144:147], v[112:115]
    s_waitcnt lgkmcnt(2)
    v_mfma_f32_16x16x32_bf16 v[116:119], v[68:71], v[148:151], v[116:119]
    s_waitcnt lgkmcnt(1)
    v_mfma_f32_16x16x32_bf16 v[120:123], v[68:71], v[152:155], v[120:123]
    s_waitcnt lgkmcnt(0)
    v_mfma_f32_16x16x32_bf16 v[124:127], v[68:71], v[156:159], v[124:127]
    s_sub_u32 s25, s25, 1
    s_cmp_lg_u32 s25, 0
    s_cbranch_scc1 ss_cv4
    v_add_u32 v65, 512, v65
    s_mov_b32 s25, 8
ss_cv5:
    ds_read2_b32 v[68:69], v64 offset0:0 offset1:1
    ds_read2_b32 v[70:71], v64 offset0:2 offset1:3
    ds_read_b128 v[148:151], v65 offset:0
    ds_read_b128 v[152:155], v65 offset:512
    ds_read_b128 v[156:159], v65 offset:1024
    v_subrev_u32 v64, 64, v64
    v_subrev_u32 v65, 64, v65
    s_waitcnt lgkmcnt(2)
    v_mfma_f32_16x16x32_bf16 v[116:119], v[68:71], v[148:151], v[116:119]
    s_waitcnt lgkmcnt(1)
    v_mfma_f32_16x16x32_bf16 v[120:123], v[68:71], v[152:155], v[120:123]
    s_waitcnt lgkmcnt(0)
    v_mfma_f32_16x16x32_bf16 v[124:127], v[68:71], v[156:159], v[124:127]
    s_sub_u32 s25, s25, 1
    s_cmp_lg_u32 s25, 0
    s_cbranch_scc1 ss_cv5
    v_add_u32 v65, 512, v65
    s_mov_b32 s25, 8
ss_cv6:
    ds_read2_b32 v[68:69], v64 offset0:0 offset1:1
    ds_read2_b32 v[70:71], v64 offset0:2 offset1:3
    ds_read_b128 v[152:155], v65 offset:0
    ds_read_b128 v[156:159], v65 offset:512
    v_subrev_u32 v64, 64, v64
    v_subrev_u32 v65, 64, v65
    s_waitcnt lgkmcnt(1)
    v_mfma_f32_16x16x32_bf16 v[120:123], v[68:71], v[152:155], v[120:123]
    s_waitcnt lgkmcnt(0)
    v_mfma_f32_16x16x32_bf16 v[124:127], v[68:71], v[156:159], v[124:127]
    s_sub_u32 s25, s25, 1
    s_cmp_lg_u32 s25, 0
    s_cbranch_scc1 ss_cv6
    v_add_u32 v65, 512, v65
    s_mov_b32 s25, 8
ss_cv7:
    ds_read2_b32 v[68:69], v64 offset0:0 offset1:1
    ds_read2_b32 v[70:71], v64 offset0:2 offset1:3
    ds_read_b128 v[156:159], v65 offset:0
    v_subrev_u32 v64, 64, v64
    v_subrev_u32 v65, 64, v65
    s_waitcnt lgkmcnt(0)
    v_mfma_f32_16x16x32_bf16 v[124:127], v[68:71], v[156:159], v[124:127]
    s_sub_u32 s25, s25, 1
    s_cmp_lg_u32 s25, 0
    s_cbranch_scc1 ss_cv7
    v_add_u32 v65, 512, v65
    s_nop 3
    v_lshlrev_b32 v5, 6, v2
    v_lshl_add_u32 v5, v3, 4, v5
    v_add_u32 v5, v5, v4
    ds_write_b128 v5, v[96:99] offset:7424
    ds_write_b128 v5, v[100:103] offset:8448
    ds_write_b128 v5, v[104:107] offset:9472
    ds_write_b128 v5, v[108:111] offset:10496
    ds_write_b128 v5, v[112:115] offset:11520
    ds_write_b128 v5, v[116:119] offset:12544
    ds_write_b128 v5, v[120:123] offset:13568
    ds_write_b128 v5, v[124:127] offset:14592
    s_mov_b32 s12, s74
    s_mov_b32 s13, s75
    s_mov_b32 s14, 1152
    s_mov_b32 s15, 0x20000
    s_lshl_b32 s23, s20, 1
    buffer_load_dwordx2 v[24:25], off, s[12:15], s23
    s_waitcnt vmcnt(0) lgkmcnt(0)
    s_barrier
    v_lshlrev_b32 v26, 16, v24
    v_and_b32 v27, 0xffff0000, v24
    v_lshlrev_b32 v28, 16, v25
    v_and_b32 v29, 0xffff0000, v25
    v_lshlrev_b32 v5, 5, v0
    ds_read_b128 v[64:67], v5 offset:7424
    ds_read_b128 v[68:71], v5 offset:7440
    ds_read_b128 v[72:75], v5 offset:23808
    ds_read_b128 v[76:79], v5 offset:23824
    ds_read_b128 v[80:83], v5 offset:40192
    ds_read_b128 v[84:87], v5 offset:40208
    ds_read_b128 v[88:91], v5 offset:56576
    ds_read_b128 v[92:95], v5 offset:56592
    s_waitcnt lgkmcnt(0)
    v_mul_u32_u24 v5, 18432, v0
    s_lshl_b32 s22, s20, 1
    s_add_u32 s22, s22, 1152
    v_lshlrev_b32 v6, 16, v8
    v_fmac_f32 v64, v6, v26
    v_and_b32 v6, 0xffff0000, v8
    v_fmac_f32 v72, v6, v27
    v_lshlrev_b32 v6, 16, v9
    v_fmac_f32 v80, v6, v28
    v_and_b32 v6, 0xffff0000, v9
    v_fmac_f32 v88, v6, v29
    v_cvt_pk_bf16_f32 v8, v64, v72
    v_cvt_pk_bf16_f32 v9, v80, v88
    s_add_u32 s23, s22, 0
    buffer_store_dwordx2 v[8:9], v5, s[16:19], s23 offen
    v_lshlrev_b32 v6, 16, v10
    v_fmac_f32 v65, v6, v26
    v_and_b32 v6, 0xffff0000, v10
    v_fmac_f32 v73, v6, v27
    v_lshlrev_b32 v6, 16, v11
    v_fmac_f32 v81, v6, v28
    v_and_b32 v6, 0xffff0000, v11
    v_fmac_f32 v89, v6, v29
    v_cvt_pk_bf16_f32 v10, v65, v73
    v_cvt_pk_bf16_f32 v11, v81, v89
    s_add_u32 s23, s22, 2304
    buffer_store_dwordx2 v[10:11], v5, s[16:19], s23 offen
    v_lshlrev_b32 v6, 16, v12
    v_fmac_f32 v66, v6, v26
    v_and_b32 v6, 0xffff0000, v12
    v_fmac_f32 v74, v6, v27
    v_lshlrev_b32 v6, 16, v13
    v_fmac_f32 v82, v6, v28
    v_and_b32 v6, 0xffff0000, v13
    v_fmac_f32 v90, v6, v29
    v_cvt_pk_bf16_f32 v12, v66, v74
    v_cvt_pk_bf16_f32 v13, v82, v90
    s_add_u32 s23, s22, 4608
    buffer_store_dwordx2 v[12:13], v5, s[16:19], s23 offen
    v_lshlrev_b32 v6, 16, v14
    v_fmac_f32 v67, v6, v26
    v_and_b32 v6, 0xffff0000, v14
    v_fmac_f32 v75, v6, v27
    v_lshlrev_b32 v6, 16, v15
    v_fmac_f32 v83, v6, v28
    v_and_b32 v6, 0xffff0000, v15
    v_fmac_f32 v91, v6, v29
    v_cvt_pk_bf16_f32 v14, v67, v75
    v_cvt_pk_bf16_f32 v15, v83, v91
    s_add_u32 s23, s22, 6912
    buffer_store_dwordx2 v[14:15], v5, s[16:19], s23 offen
    v_lshlrev_b32 v6, 16, v16
    v_fmac_f32 v68, v6, v26
    v_and_b32 v6, 0xffff0000, v16
    v_fmac_f32 v76, v6, v27
    v_lshlrev_b32 v6, 16, v17
    v_fmac_f32 v84, v6, v28
    v_and_b32 v6, 0xffff0000, v17
    v_fmac_f32 v92, v6, v29
    v_cvt_pk_bf16_f32 v16, v68, v76
    v_cvt_pk_bf16_f32 v17, v84, v92
    s_add_u32 s23, s22, 9216
    buffer_store_dwordx2 v[16:17], v5, s[16:19], s23 offen
    v_lshlrev_b32 v6, 16, v18
    v_fmac_f32 v69, v6, v26
    v_and_b32 v6, 0xffff0000, v18
    v_fmac_f32 v77, v6, v27
    v_lshlrev_b32 v6, 16, v19
    v_fmac_f32 v85, v6, v28
    v_and_b32 v6, 0xffff0000, v19
    v_fmac_f32 v93, v6, v29
    v_cvt_pk_bf16_f32 v18, v69, v77
    v_cvt_pk_bf16_f32 v19, v85, v93
    s_add_u32 s23, s22, 11520
    buffer_store_dwordx2 v[18:19], v5, s[16:19], s23 offen
    v_lshlrev_b32 v6, 16, v20
    v_fmac_f32 v70, v6, v26
    v_and_b32 v6, 0xffff0000, v20
    v_fmac_f32 v78, v6, v27
    v_lshlrev_b32 v6, 16, v21
    v_fmac_f32 v86, v6, v28
    v_and_b32 v6, 0xffff0000, v21
    v_fmac_f32 v94, v6, v29
    v_cvt_pk_bf16_f32 v20, v70, v78
    v_cvt_pk_bf16_f32 v21, v86, v94
    s_add_u32 s23, s22, 13824
    buffer_store_dwordx2 v[20:21], v5, s[16:19], s23 offen
    v_lshlrev_b32 v6, 16, v22
    v_fmac_f32 v71, v6, v26
    v_and_b32 v6, 0xffff0000, v22
    v_fmac_f32 v79, v6, v27
    v_lshlrev_b32 v6, 16, v23
    v_fmac_f32 v87, v6, v28
    v_and_b32 v6, 0xffff0000, v23
    v_fmac_f32 v95, v6, v29
    v_cvt_pk_bf16_f32 v22, v71, v79
    v_cvt_pk_bf16_f32 v23, v87, v95
    s_add_u32 s23, s22, 16128
    buffer_store_dwordx2 v[22:23], v5, s[16:19], s23 offen
    s_branch L_ssm_next
L_phase2:
    v_and_b32 v1, 63, v0
    v_min_u32 v1, 6, v1
    v_lshlrev_b32 v2, 2, v1
    s_cmp_lg_u32 s32, 0
    v_mov_b32 v251, 163832
    s_cbranch_scc1 sw9
    buffer_load_dword v3, v2, s[96:99], 0 offen offset:32 sc1
    v_mov_b32 v4, 32
    s_waitcnt vmcnt(0)
    v_cmp_lt_u32 vcc, v3, v4
    s_nop 0
    s_ff1_i32_b64 s40, vcc
    v_mov_b32 v250, s40
    ds_write_b32 v251, v250
    s_waitcnt lgkmcnt(0)
sw9:
    s_barrier
    ds_read_b32 v252, v251
    s_waitcnt lgkmcnt(0)
    v_readfirstlane_b32 s33, v252
    s_barrier
    s_nop 1
    s_cmp_lt_u32 s33, 7
    s_cbranch_scc1 L_pool
    s_mov_b32 s88, 4194304
gn10:
    s_cmp_lg_u32 s95, 0
    s_cbranch_scc1 gn10x
    buffer_load_dword v250, off, s[96:99], 0 offset:64 sc1
    s_sub_u32 s88, s88, 1
    s_cbranch_scc1 gn10x
    s_waitcnt vmcnt(0)
    v_readfirstlane_b32 s95, v250
    s_nop 1
    s_branch gn10
gn10x:
    s_mov_b32 s40, 524288
mc2_w:
    buffer_load_dword v250, off, s[96:99], 0 offset:140 sc1
    s_waitcnt vmcnt(0)
    v_readfirstlane_b32 s41, v250
    s_nop 0
    s_cmp_lg_u32 s41, 0
    s_cbranch_scc1 mc2_known
    s_sub_u32 s40, s40, 1
    s_cbranch_scc1 mc2_force
    s_sleep 2
    s_branch mc2_w
mc2_force:
    v_mov_b32 v250, 2
    v_mov_b32 v251, 0
    s_mov_b64 exec, 1
    buffer_atomic_cmpswap v[250:251], off, s[96:99], 0 offset:140
    s_mov_b64 exec, -1
    s_waitcnt vmcnt(0)
    s_mov_b32 s40, 524288
    s_branch mc2_w
mc2_known:
    s_cmp_eq_u32 s41, 1
    s_cbranch_scc1 L_phase2b
    s_mov_b32 s37, 208
    v_mov_b32 v250, 1
    v_mov_b32 v251, 163832
    v_cmp_eq_u32 vcc, 0, v0
    s_nop 0
    s_and_saveexec_b64 s[38:39], vcc
    s_cbranch_execz tk11
    buffer_atomic_add v250, off, s[96:99], s37 sc0
    s_waitcnt vmcnt(0)
    ds_write_b32 v251, v250
    s_waitcnt lgkmcnt(0)
tk11:
    s_mov_b64 exec, -1
    s_barrier
    ds_read_b32 v252, v251
    s_waitcnt lgkmcnt(0)
    v_readfirstlane_b32 s12, v252
    s_barrier
    s_nop 3
    s_cmp_lt_u32 s12, 32
    s_cbranch_scc1 L_chain_safe
L_phase2b:
    s_mov_b32 s8, s76
    s_mov_b32 s9, s77
    s_mov_b32 s10, 4718592
    s_mov_b32 s11, 0x20000
    s_sub_u32 s33, s3, 1
    s_and_b32 s33, s33, 7
    s_cmp_eq_u32 s33, 7
    s_cbranch_scc1 L_p2scan
L_p2take:
    s_lshl_b32 s35, s33, 2
    s_add_u32 s35, s35, 160
    s_mov_b32 s37, s35
    v_mov_b32 v250, 1
    v_mov_b32 v251, 163832
    v_cmp_eq_u32 vcc, 0, v0
    s_nop 0
    s_and_saveexec_b64 s[38:39], vcc
    s_cbranch_execz tk12
    buffer_atomic_add v250, off, s[96:99], s37 sc0
    s_waitcnt vmcnt(0)
    ds_write_b32 v251, v250
    s_waitcnt lgkmcnt(0)
tk12:
    s_mov_b64 exec, -1
    s_barrier
    ds_read_b32 v252, v251
    s_waitcnt lgkmcnt(0)
    v_readfirstlane_b32 s34, v252
    s_barrier
    s_nop 3
    s_cmp_lt_u32 s33, 4
    s_cselect_b32 s36, 4, 6
    s_cmp_lt_u32 s34, s36
    s_cbranch_scc1 L_att0
    s_sub_u32 s34, s34, s36
    s_cmp_lt_u32 s34, 18
    s_cbranch_scc1 L_op_start
L_p2scan:
    v_and_b32 v1, 63, v0
    v_min_u32 v1, 6, v1
    v_lshlrev_b32 v2, 2, v1
    s_cmp_lg_u32 s32, 0
    v_mov_b32 v251, 163832
    s_cbranch_scc1 sw13
    buffer_load_dword v3, v2, s[96:99], 0 offen offset:160 sc1
    v_mov_b32 v4, 24
    v_cmp_gt_u32 vcc, 4, v1
    s_nop 1
    v_cndmask_b32 v4, v4, 22, vcc
    s_waitcnt vmcnt(0)
    v_cmp_lt_u32 vcc, v3, v4
    s_nop 0
    s_ff1_i32_b64 s40, vcc
    v_mov_b32 v250, s40
    ds_write_b32 v251, v250
    s_waitcnt lgkmcnt(0)
sw13:
    s_barrier
    ds_read_b32 v252, v251
    s_waitcnt lgkmcnt(0)
    v_readfirstlane_b32 s33, v252
    s_barrier
    s_nop 1
    s_cmp_lt_u32 s33, 7
    s_cbranch_scc1 L_p2take
    s_branch L_done
L_att0:
    s_mul_i32 s36, s34, 7
    s_mul_i32 s37, s34, 3
    s_add_u32 s37, s37, 12
    s_cmp_lt_u32 s34, 4
    s_cselect_b32 s34, s36, s37
    s_add_u32 s34, s34, s33
    s_cmp_ge_u32 s34, 32
    s_cbranch_scc1 L_done
L_att_next:
    s_lshr_b32 s16, s34, 3
    s_and_b32 s17, s34, 7
    s_lshl_b32 s17, s17, 2
    s_add_u32 s17, s17, s32
    s_lshr_b32 s36, s17, 1
    s_lshl_b32 s36, s36, 8
    s_add_u32 s36, s36, 125829120
    s_mul_i32 s37, s16, 43
    s_lshr_b32 s37, s37, 8
    s_mul_i32 s41, s37, 6
    s_sub_u32 s41, s16, s41
    v_and_b32 v1, 63, v0
    v_mul_u32_u24 v2, 6, v1
    v_add_u32 v2, s41, v2
    v_mov_b32 v4, s37
    s_and_b32 s41, s16, 7
    s_add_u32 s41, s41, 12
    s_lshr_b32 s37, s16, 3
    v_mov_b32 v5, s41
    v_mov_b32 v6, s37
    v_cmp_lt_u32 vcc, 1, v1
    s_nop 1
    v_cndmask_b32 v2, v2, v5, vcc
    v_cndmask_b32 v4, v4, v6, vcc
    v_lshlrev_b32 v2, 2, v2
    v_add3_u32 v4, v4, s95, 1
    s_mov_b32 s40, 4194304
L_aw1:
    buffer_load_dword v3, v2, s[4:7], s36 offen sc1
    s_sub_u32 s40, s40, 1
    s_cbranch_scc1 L_aw1_go
    s_waitcnt vmcnt(0)
    v_subrev_u32 v3, v4, v3
    v_cmp_lt_u32 vcc, 64, v3
    s_cbranch_vccz L_aw1_go
    s_sleep 4
    s_branch L_aw1
L_aw1_go:
    v_and_b32 v5, 63, v0
    v_lshlrev_b32 v1, 4, v5
    v_or_b32 v3, 128, v1
    v_lshrrev_b32 v4, 4, v5
    v_bfe_u32 v6, v5, 2, 2
    v_sub_u32 v4, v6, v4
    v_lshlrev_b32 v4, 3, v4
    v_and_b32 v6, 3, v5
    v_add_u32 v4, v4, v6
    v_mov_b32 v6, 0xf149f2ca
    s_mov_b32 s22, 0x3e0293ee
    s_lshl_b32 s18, s16, 5
    s_add_u32 s18, s18, s17
    s_lshl_b32 s19, s18, 13
    s_add_u32 s20, s19, 33554432
    buffer_load_dwordx4 v[8:11], v1, s[4:7], s20 offen offset:0 sc1
    s_add_u32 s20, s19, 33554432
    buffer_load_dwordx4 v[12:15], v1, s[4:7], s20 offen offset:1024 sc1
    s_add_u32 s20, s19, 33554432
    buffer_load_dwordx4 v[16:19], v1, s[4:7], s20 offen offset:2048 sc1
    s_add_u32 s20, s19, 33554432
    buffer_load_dwordx4 v[20:23], v1, s[4:7], s20 offen offset:3072 sc1
    s_add_u32 s20, s19, 33558528
    buffer_load_dwordx4 v[24:27], v1, s[4:7], s20 offen offset:0 sc1
    s_add_u32 s20, s19, 33558528
    buffer_load_dwordx4 v[28:31], v1, s[4:7], s20 offen offset:1024 sc1
    s_add_u32 s20, s19, 33558528
    buffer_load_dwordx4 v[32:35], v1, s[4:7], s20 offen offset:2048 sc1
    s_add_u32 s20, s19, 33558528
    buffer_load_dwordx4 v[36:39], v1, s[4:7], s20 offen offset:3072 sc1
    s_lshl_b32 s21, s18, 14
    s_add_u32 s20, s21, 0
    buffer_load_dwordx4 v[40:43], v1, s[4:7], s20 offen offset:0 sc1
    s_add_u32 s20, s21, 4096
    buffer_load_dwordx4 v[44:47], v1, s[4:7], s20 offen offset:0 sc1
    s_add_u32 s20, s21, 8192
    buffer_load_dwordx4 v[48:51], v1, s[4:7], s20 offen offset:0 sc1
    s_add_u32 s20, s21, 12288
    buffer_load_dwordx4 v[52:55], v1, s[4:7], s20 offen offset:0 sc1
    s_add_u32 s20, s21, 0
    buffer_load_dwordx4 v[56:59], v1, s[4:7], s20 offen offset:1024 sc1
    s_add_u32 s20, s21, 4096
    buffer_load_dwordx4 v[60:63], v1, s[4:7], s20 offen offset:1024 sc1
    s_add_u32 s20, s21, 8192
    buffer_load_dwordx4 v[64:67], v1, s[4:7], s20 offen offset:1024 sc1
    s_add_u32 s20, s21, 12288
    buffer_load_dwordx4 v[68:71], v1, s[4:7], s20 offen offset:1024 sc1
    s_add_u32 s20, s21, 0
    buffer_load_dwordx4 v[88:91], v1, s[4:7], s20 offen offset:2048 sc1
    s_add_u32 s20, s21, 4096
    buffer_load_dwordx4 v[92:95], v1, s[4:7], s20 offen offset:2048 sc1
    s_add_u32 s20, s21, 8192
    buffer_load_dwordx4 v[96:99], v1, s[4:7], s20 offen offset:2048 sc1
    s_add_u32 s20, s21, 12288
    buffer_load_dwordx4 v[100:103], v1, s[4:7], s20 offen offset:2048 sc1
    s_add_u32 s20, s21, 0
    buffer_load_dwordx4 v[104:107], v1, s[4:7], s20 offen offset:3072 sc1
    s_add_u32 s20, s21, 4096
    buffer_load_dwordx4 v[108:111], v1, s[4:7], s20 offen offset:3072 sc1
    s_add_u32 s20, s21, 8192
    buffer_load_dwordx4 v[112:115], v1, s[4:7], s20 offen offset:3072 sc1
    s_add_u32 s20, s21, 12288
    buffer_load_dwordx4 v[116:119], v1, s[4:7], s20 offen offset:3072 sc1
    v_mov_b32 v172, 0x3f803f80
    v_mov_b32 v173, 0x3f803f80
    v_mov_b32 v174, 0x3f803f80
    v_mov_b32 v175, 0x3f803f80
    v_mov_b32 v176, 0x3f003f00
    v_mov_b32 v177, 0x3f003f00
    s_waitcnt vmcnt(8)
    v_mfma_f32_16x16x32_bf16 v[136:139], v[40:43], v[8:11], 0
    v_mfma_f32_16x16x32_bf16 v[140:143], v[56:59], v[8:11], 0
    v_mfma_f32_16x16x32_bf16 v[148:151], v[40:43], v[24:27], 0
    v_mfma_f32_16x16x32_bf16 v[152:155], v[56:59], v[24:27], 0
    v_mfma_f32_16x16x32_bf16 v[136:139], v[44:47], v[12:15], v[136:139]
    v_mfma_f32_16x16x32_bf16 v[140:143], v[60:63], v[12:15], v[140:143]
    v_mfma_f32_16x16x32_bf16 v[148:151], v[44:47], v[28:31], v[148:151]
    v_mfma_f32_16x16x32_bf16 v[152:155], v[60:63], v[28:31], v[152:155]
    v_mfma_f32_16x16x32_bf16 v[136:139], v[48:51], v[16:19], v[136:139]
    v_mfma_f32_16x16x32_bf16 v[140:143], v[64:67], v[16:19], v[140:143]
    v_mfma_f32_16x16x32_bf16 v[148:151], v[48:51], v[32:35], v[148:151]
    v_mfma_f32_16x16x32_bf16 v[152:155], v[64:67], v[32:35], v[152:155]
    v_mfma_f32_16x16x32_bf16 v[136:139], v[52:55], v[20:23], v[136:139]
    v_mfma_f32_16x16x32_bf16 v[140:143], v[68:71], v[20:23], v[140:143]
    v_mfma_f32_16x16x32_bf16 v[148:151], v[52:55], v[36:39], v[148:151]
    v_mfma_f32_16x16x32_bf16 v[152:155], v[68:71], v[36:39], v[152:155]
    v_cmp_le_i32 vcc, 0, v4
    s_nop 1
    v_cndmask_b32 v136, v6, v136, vcc
    v_cmp_le_i32 vcc, 1, v4
    s_nop 1
    v_cndmask_b32 v137, v6, v137, vcc
    v_cmp_le_i32 vcc, 2, v4
    s_nop 1
    v_cndmask_b32 v138, v6, v138, vcc
    v_cmp_le_i32 vcc, 3, v4
    s_nop 1
    v_cndmask_b32 v139, v6, v139, vcc
    v_cmp_le_i32 vcc, 4, v4
    s_nop 1
    v_cndmask_b32 v140, v6, v140, vcc
    v_cmp_le_i32 vcc, 5, v4
    s_nop 1
    v_cndmask_b32 v141, v6, v141, vcc
    v_cmp_le_i32 vcc, 6, v4
    s_nop 1
    v_cndmask_b32 v142, v6, v142, vcc
    v_cmp_le_i32 vcc, 7, v4
    s_nop 1
    v_cndmask_b32 v143, v6, v143, vcc
    v_cmp_le_i32 vcc, -4, v4
    s_nop 1
    v_cndmask_b32 v148, v6, v148, vcc
    v_cmp_le_i32 vcc, -3, v4
    s_nop 1
    v_cndmask_b32 v149, v6, v149, vcc
    v_cmp_le_i32 vcc, -2, v4
    s_nop 1
    v_cndmask_b32 v150, v6, v150, vcc
    v_cmp_le_i32 vcc, -1, v4
    s_nop 1
    v_cndmask_b32 v151, v6, v151, vcc
    v_cmp_le_i32 vcc, 0, v4
    s_nop 1
    v_cndmask_b32 v152, v6, v152, vcc
    v_cmp_le_i32 vcc, 1, v4
    s_nop 1
    v_cndmask_b32 v153, v6, v153, vcc
    v_cmp_le_i32 vcc, 2, v4
    s_nop 1
    v_cndmask_b32 v154, v6, v154, vcc
    v_cmp_le_i32 vcc, 3, v4
    s_nop 1
    v_cndmask_b32 v155, v6, v155, vcc
    s_nop 1
    s_mov_b32 s88, 65536
cw14:
    buffer_load_dword v199, off, s[4:7], s36 offset:128 sc1
    s_waitcnt vmcnt(0)
    v_readfirstlane_b32 s42, v199
    s_nop 0
    s_sub_u32 s42, s42, s95
    s_cmp_gt_u32 s42, 64
    s_cselect_b32 s42, 0, s42
    s_add_u32 s42, s42, 2
    s_cmp_ge_u32 s42, s16
    s_cbranch_scc1 cw14x
    s_sub_u32 s88, s88, 1
    s_cbranch_scc1 cw14x
    s_sub_u32 s42, s16, s42
    s_min_u32 s42, s42, 6
cw14s:
    s_sleep 24
    s_sub_u32 s42, s42, 1
    s_cmp_lg_u32 s42, 0
    s_cbranch_scc1 cw14s
    s_branch cw14
cw14x:
    s_and_b32 s37, s16, 1
    s_lshl_b32 s37, s37, 2
    s_add_u32 s37, s37, s36
    s_add_u32 s37, s37, 128
    s_add_u32 s41, s16, s95
    s_add_u32 s41, s41, 1
    s_lshl_b32 s42, s17, 7
    s_add_u32 s42, s42, 125845504
    s_cmp_ge_u32 s16, 62
    s_cselect_b32 s37, s42, s37
    s_cselect_b32 s42, 12, 8
    v_lshlrev_b32 v198, 2, v0
    v_and_b32 v198, s42, v198
    s_mov_b32 s40, 4194304
L_aw2:
    buffer_load_dword v199, v198, s[4:7], s37 offen sc1
    s_sub_u32 s40, s40, 1
    s_cbranch_scc1 L_aw2_go
    s_waitcnt vmcnt(0)
    v_subrev_u32 v199, s41, v199
    v_cmp_lt_u32 vcc, 64, v199
    s_cbranch_vccz L_aw2_go
    s_sleep 1
    s_branch L_aw2
L_aw2_go:
    s_mov_b32 s21, 4096
at_again:
    s_lshl_b32 s20, s18, 12
    s_add_u32 s20, s20, 71303168
    buffer_load_dwordx4 v[72:75], v3, s[4:7], s20 offen offset:0 sc1
    buffer_load_dwordx4 v[76:79], v3, s[4:7], s20 offen offset:1024 sc1
    buffer_load_dwordx4 v[80:83], v3, s[4:7], s20 offen offset:2048 sc1
    buffer_load_dwordx4 v[84:87], v3, s[4:7], s20 offen offset:3072 sc1
    s_lshl_b32 s20, s18, 12
    s_add_u32 s20, s20, 80740352
    buffer_load_dwordx4 v[120:123], v1, s[4:7], s20 offen offset:0 sc1
    buffer_load_dwordx4 v[124:127], v1, s[4:7], s20 offen offset:1024 sc1
    buffer_load_dwordx4 v[128:131], v1, s[4:7], s20 offen offset:2048 sc1
    buffer_load_dwordx4 v[132:135], v1, s[4:7], s20 offen offset:3072 sc1
    s_waitcnt vmcnt(4)
    v_mfma_f32_16x16x32_bf16 v[144:147], v[72:75], v[8:11], 0
    v_mfma_f32_16x16x32_bf16 v[156:159], v[72:75], v[24:27], 0
    v_mfma_f32_16x16x32_bf16 v[144:147], v[76:79], v[12:15], v[144:147]
    v_mfma_f32_16x16x32_bf16 v[156:159], v[76:79], v[28:31], v[156:159]
    v_mfma_f32_16x16x32_bf16 v[144:147], v[80:83], v[16:19], v[144:147]
    v_mfma_f32_16x16x32_bf16 v[156:159], v[80:83], v[32:35], v[156:159]
    v_mfma_f32_16x16x32_bf16 v[144:147], v[84:87], v[20:23], v[144:147]
    v_mfma_f32_16x16x32_bf16 v[156:159], v[84:87], v[36:39], v[156:159]
    v_max3_u32 v196, v72, v76, v80
    s_waitcnt vmcnt(0)
    v_max3_u32 v196, v196, v84, v120
    v_max3_u32 v196, v196, v124, v128
    v_max_u32 v196, v196, v132
    v_cmp_eq_u32 vcc, -1, v196
    s_sub_u32 s21, s21, 1
    s_nop 3
    s_cbranch_scc1 at_ok
    s_cbranch_vccnz at_again
at_ok:
    v_max3_f32 v196, v136, v137, v138
    v_max3_f32 v197, v139, v140, v141
    v_max3_f32 v196, v196, v142, v143
    v_max3_f32 v197, v197, v144, v145
    v_max3_f32 v196, v196, v146, v147
    v_max_f32 v196, v196, v197
    v_mov_b32 v197, v196
    s_nop 1
    v_permlane32_swap_b32 v196, v197
    v_max_f32 v196, v196, v197
    v_mov_b32 v197, v196
    s_nop 1
    v_permlane16_swap_b32 v196, v197
    v_max_f32 v196, v196, v197
    v_mul_f32 v196, s22, v196
    v_sub_f32 v196, 0, v196
    v_fma_f32 v136, v136, s22, v196
    v_fma_f32 v137, v137, s22, v196
    v_fma_f32 v138, v138, s22, v196
    v_fma_f32 v139, v139, s22, v196
    v_fma_f32 v140, v140, s22, v196
    v_fma_f32 v141, v141, s22, v196
    v_fma_f32 v142, v142, s22, v196
    v_fma_f32 v143, v143, s22, v196
    v_fma_f32 v144, v144, s22, v196
    v_fma_f32 v145, v145, s22, v196
    v_fma_f32 v146, v146, s22, v196
    v_fma_f32 v147, v147, s22, v196
    v_exp_f32 v136, v136
    v_exp_f32 v137, v137
    v_exp_f32 v138, v138
    v_exp_f32 v139, v139
    v_exp_f32 v140, v140
    v_exp_f32 v141, v141
    v_exp_f32 v142, v142
    v_exp_f32 v143, v143
    v_exp_f32 v144, v144
    v_exp_f32 v145, v145
    v_exp_f32 v146, v146
    v_exp_f32 v147, v147
    v_cvt_pk_bf16_f32 v160, v136, v137
    v_cvt_pk_bf16_f32 v161, v138, v139
    v_cvt_pk_bf16_f32 v162, v140, v141
    v_cvt_pk_bf16_f32 v163, v142, v143
    v_cvt_pk_bf16_f32 v164, v144, v145
    v_cvt_pk_bf16_f32 v165, v146, v147
    v_max3_f32 v196, v148, v149, v150
    v_max3_f32 v197, v151, v152, v153
    v_max3_f32 v196, v196, v154, v155
    v_max3_f32 v197, v197, v156, v157
    v_max3_f32 v196, v196, v158, v159
    v_max_f32 v196, v196, v197
    v_mov_b32 v197, v196
    s_nop 1
    v_permlane32_swap_b32 v196, v197
    v_max_f32 v196, v196, v197
    v_mov_b32 v197, v196
    s_nop 1
    v_permlane16_swap_b32 v196, v197
    v_max_f32 v196, v196, v197
    v_mul_f32 v196, s22, v196
    v_sub_f32 v196, 0, v196
    v_fma_f32 v148, v148, s22, v196
    v_fma_f32 v149, v149, s22, v196
    v_fma_f32 v150, v150, s22, v196
    v_fma_f32 v151, v151, s22, v196
    v_fma_f32 v152, v152, s22, v196
    v_fma_f32 v153, v153, s22, v196
    v_fma_f32 v154, v154, s22, v196
    v_fma_f32 v155, v155, s22, v196
    v_fma_f32 v156, v156, s22, v196
    v_fma_f32 v157, v157, s22, v196
    v_fma_f32 v158, v158, s22, v196
    v_fma_f32 v159, v159, s22, v196
    v_exp_f32 v148, v148
    v_exp_f32 v149, v149
    v_exp_f32 v150, v150
    v_exp_f32 v151, v151
    v_exp_f32 v152, v152
    v_exp_f32 v153, v153
    v_exp_f32 v154, v154
    v_exp_f32 v155, v155
    v_exp_f32 v156, v156
    v_exp_f32 v157, v157
    v_exp_f32 v158, v158
    v_exp_f32 v159, v159
    v_cvt_pk_bf16_f32 v166, v148, v149
    v_cvt_pk_bf16_f32 v167, v150, v151
    v_cvt_pk_bf16_f32 v168, v152, v153
    v_cvt_pk_bf16_f32 v169, v154, v155
    v_cvt_pk_bf16_f32 v170, v156, v157
    v_cvt_pk_bf16_f32 v171, v158, v159
    v_mfma_f32_16x16x32_bf16 v[180:183], v[172:175], v[160:163], 0
    v_mfma_f32_16x16x32_bf16 v[184:187], v[172:175], v[166:169], 0
    v_mfma_f32_16x16x16_bf16 v[180:183], v[176:177], v[164:165], v[180:183]
    v_mfma_f32_16x16x16_bf16 v[184:187], v[176:177], v[170:171], v[184:187]
    s_nop 3
    v_rcp_f32 v180, v180
    s_nop 2
    v_rcp_f32 v184, v184
    s_waitcnt vmcnt(0)
    s_lshl_b32 s18, s16, 18
    s_lshl_b32 s19, s17, 12
    s_add_u32 s18, s18, s19
    s_add_u32 s18, s18, 50331648
    s_add_u32 s19, s18, 131072
    v_mfma_f32_16x16x32_bf16 v[8:11], v[88:91], v[160:163], 0
    v_mfma_f32_16x16x32_bf16 v[12:15], v[104:107], v[160:163], 0
    v_mfma_f32_16x16x32_bf16 v[16:19], v[88:91], v[166:169], 0
    v_mfma_f32_16x16x32_bf16 v[20:23], v[104:107], v[166:169], 0
    v_mfma_f32_16x16x32_bf16 v[24:27], v[92:95], v[160:163], 0
    v_mfma_f32_16x16x32_bf16 v[28:31], v[108:111], v[160:163], 0
    v_mfma_f32_16x16x32_bf16 v[32:35], v[92:95], v[166:169], 0
    v_mfma_f32_16x16x32_bf16 v[36:39], v[108:111], v[166:169], 0
    v_mfma_f32_16x16x32_bf16 v[40:43], v[96:99], v[160:163], 0
    v_mfma_f32_16x16x32_bf16 v[44:47], v[112:115], v[160:163], 0
    v_mfma_f32_16x16x32_bf16 v[48:51], v[96:99], v[166:169], 0
    v_mfma_f32_16x16x32_bf16 v[52:55], v[112:115], v[166:169], 0
    v_mfma_f32_16x16x32_bf16 v[56:59], v[100:103], v[160:163], 0
    v_mfma_f32_16x16x32_bf16 v[60:63], v[116:119], v[160:163], 0
    v_mfma_f32_16x16x32_bf16 v[64:67], v[100:103], v[166:169], 0
    v_mfma_f32_16x16x32_bf16 v[68:71], v[116:119], v[166:169], 0
    v_mfma_f32_16x16x16_bf16 v[8:11], v[120:121], v[164:165], v[8:11]
    v_mfma_f32_16x16x16_bf16 v[12:15], v[122:123], v[164:165], v[12:15]
    v_mfma_f32_16x16x16_bf16 v[16:19], v[120:121], v[170:171], v[16:19]
    v_mfma_f32_16x16x16_bf16 v[20:23], v[122:123], v[170:171], v[20:23]
    v_mfma_f32_16x16x16_bf16 v[24:27], v[124:125], v[164:165], v[24:27]
    v_mfma_f32_16x16x16_bf16 v[28:31], v[126:127], v[164:165], v[28:31]
    v_mfma_f32_16x16x16_bf16 v[32:35], v[124:125], v[170:171], v[32:35]
    v_mfma_f32_16x16x16_bf16 v[36:39], v[126:127], v[170:171], v[36:39]
    v_mfma_f32_16x16x16_bf16 v[40:43], v[128:129], v[164:165], v[40:43]
    v_mfma_f32_16x16x16_bf16 v[44:47], v[130:131], v[164:165], v[44:47]
    v_mfma_f32_16x16x16_bf16 v[48:51], v[128:129], v[170:171], v[48:51]
    v_mfma_f32_16x16x16_bf16 v[52:55], v[130:131], v[170:171], v[52:55]
    v_mfma_f32_16x16x16_bf16 v[56:59], v[132:133], v[164:165], v[56:59]
    v_mfma_f32_16x16x16_bf16 v[60:63], v[134:135], v[164:165], v[60:63]
    v_mfma_f32_16x16x16_bf16 v[64:67], v[132:133], v[170:171], v[64:67]
    v_mfma_f32_16x16x16_bf16 v[68:71], v[134:135], v[170:171], v[68:71]
    v_mul_f32 v8, v8, v180
    v_mul_f32 v12, v12, v180
    v_mul_f32 v9, v9, v180
    v_mul_f32 v13, v13, v180
    v_mul_f32 v10, v10, v180
    v_mul_f32 v14, v14, v180
    v_mul_f32 v11, v11, v180
    v_mul_f32 v15, v15, v180
    v_cvt_pk_bf16_f32 v8, v8, v9
    v_cvt_pk_bf16_f32 v9, v10, v11
    v_cvt_pk_bf16_f32 v10, v12, v13
    v_cvt_pk_bf16_f32 v11, v14, v15
    buffer_store_dwordx4 v[8:11], v1, s[4:7], s18 offen offset:0 sc1
    v_mul_f32 v16, v16, v184
    v_mul_f32 v20, v20, v184
    v_mul_f32 v17, v17, v184
    v_mul_f32 v21, v21, v184
    v_mul_f32 v18, v18, v184
    v_mul_f32 v22, v22, v184
    v_mul_f32 v19, v19, v184
    v_mul_f32 v23, v23, v184
    v_cvt_pk_bf16_f32 v16, v16, v17
    v_cvt_pk_bf16_f32 v17, v18, v19
    v_cvt_pk_bf16_f32 v18, v20, v21
    v_cvt_pk_bf16_f32 v19, v22, v23
    buffer_store_dwordx4 v[16:19], v1, s[4:7], s19 offen offset:0 sc1
    v_mul_f32 v24, v24, v180
    v_mul_f32 v28, v28, v180
    v_mul_f32 v25, v25, v180
    v_mul_f32 v29, v29, v180
    v_mul_f32 v26, v26, v180
    v_mul_f32 v30, v30, v180
    v_mul_f32 v27, v27, v180
    v_mul_f32 v31, v31, v180
    v_cvt_pk_bf16_f32 v24, v24, v25
    v_cvt_pk_bf16_f32 v25, v26, v27
    v_cvt_pk_bf16_f32 v26, v28, v29
    v_cvt_pk_bf16_f32 v27, v30, v31
    buffer_store_dwordx4 v[24:27], v1, s[4:7], s18 offen offset:1024 sc1
    v_mul_f32 v32, v32, v184
    v_mul_f32 v36, v36, v184
    v_mul_f32 v33, v33, v184
    v_mul_f32 v37, v37, v184
    v_mul_f32 v34, v34, v184
    v_mul_f32 v38, v38, v184
    v_mul_f32 v35, v35, v184
    v_mul_f32 v39, v39, v184
    v_cvt_pk_bf16_f32 v32, v32, v33
    v_cvt_pk_bf16_f32 v33, v34, v35
    v_cvt_pk_bf16_f32 v34, v36, v37
    v_cvt_pk_bf16_f32 v35, v38, v39
    buffer_store_dwordx4 v[32:35], v1, s[4:7], s19 offen offset:1024 sc1
    v_mul_f32 v40, v40, v180
    v_mul_f32 v44, v44, v180
    v_mul_f32 v41, v41, v180
    v_mul_f32 v45, v45, v180
    v_mul_f32 v42, v42, v180
    v_mul_f32 v46, v46, v180
    v_mul_f32 v43, v43, v180
    v_mul_f32 v47, v47, v180
    v_cvt_pk_bf16_f32 v40, v40, v41
    v_cvt_pk_bf16_f32 v41, v42, v43
    v_cvt_pk_bf16_f32 v42, v44, v45
    v_cvt_pk_bf16_f32 v43, v46, v47
    buffer_store_dwordx4 v[40:43], v1, s[4:7], s18 offen offset:2048 sc1
    v_mul_f32 v48, v48, v184
    v_mul_f32 v52, v52, v184
    v_mul_f32 v49, v49, v184
    v_mul_f32 v53, v53, v184
    v_mul_f32 v50, v50, v184
    v_mul_f32 v54, v54, v184
    v_mul_f32 v51, v51, v184
    v_mul_f32 v55, v55, v184
    v_cvt_pk_bf16_f32 v48, v48, v49
    v_cvt_pk_bf16_f32 v49, v50, v51
    v_cvt_pk_bf16_f32 v50, v52, v53
    v_cvt_pk_bf16_f32 v51, v54, v55
    buffer_store_dwordx4 v[48:51], v1, s[4:7], s19 offen offset:2048 sc1
    v_mul_f32 v56, v56, v180
    v_mul_f32 v60, v60, v180
    v_mul_f32 v57, v57, v180
    v_mul_f32 v61, v61, v180
    v_mul_f32 v58, v58, v180
    v_mul_f32 v62, v62, v180
    v_mul_f32 v59, v59, v180
    v_mul_f32 v63, v63, v180
    v_cvt_pk_bf16_f32 v56, v56, v57
    v_cvt_pk_bf16_f32 v57, v58, v59
    v_cvt_pk_bf16_f32 v58, v60, v61
    v_cvt_pk_bf16_f32 v59, v62, v63
    buffer_store_dwordx4 v[56:59], v1, s[4:7], s18 offen offset:3072 sc1
    v_mul_f32 v64, v64, v184
    v_mul_f32 v68, v68, v184
    v_mul_f32 v65, v65, v184
    v_mul_f32 v69, v69, v184
    v_mul_f32 v66, v66, v184
    v_mul_f32 v70, v70, v184
    v_mul_f32 v67, v67, v184
    v_mul_f32 v71, v71, v184
    v_cvt_pk_bf16_f32 v64, v64, v65
    v_cvt_pk_bf16_f32 v65, v66, v67
    v_cvt_pk_bf16_f32 v66, v68, v69
    v_cvt_pk_bf16_f32 v67, v70, v71
    buffer_store_dwordx4 v[64:67], v1, s[4:7], s19 offen offset:3072 sc1
    s_lshr_b32 s40, s34, 1
    s_lshl_b32 s40, s40, 7
    s_and_b32 s41, s17, 7
    s_lshl_b32 s41, s41, 2
    s_add_u32 s40, s40, s41
    s_add_u32 s40, s40, 125894656
    v_mov_b32 v250, s95
    s_cmp_ge_u32 s16, 62
    s_cbranch_scc1 L_afl
    s_waitcnt vmcnt(0)
L_afl:
    s_mov_b64 exec, 1
    buffer_store_dword v250, off, s[4:7], s40 sc1
    s_mov_b64 exec, -1
    s_add_u32 s34, s34, 32
    s_cmp_lt_u32 s34, 512
    s_cbranch_scc1 L_att_next
    s_branch L_done
L_op_start:
    s_mov_b32 s16, s33
    s_mov_b32 s33, s34
    v_and_b32 v2, 63, v0
    v_lshlrev_b32 v1, 4, v2
    v_lshrrev_b32 v5, 2, v2
    v_mul_u32_u24 v3, 1152, v5
    v_and_b32 v5, 3, v2
    v_lshl_add_u32 v3, v5, 4, v3
    s_lshl_b32 s21, s32, 12
    v_add_u32 v4, s21, v1
    s_mov_b64 s[12:13], s[58:59]
    s_mov_b32 s14, 4718592
    s_mov_b32 s15, 0x20000
    s_mul_i32 s19, s32, 1179648
    s_lshl_b32 s18, s33, 6
    s_add_u32 s19, s19, s18
    s_add_u32 s18, s19, 0
    s_add_u32 m0, s21, 0
    s_nop 0
    buffer_load_dwordx4 v3, s[12:15], s18 offen lds
    s_add_u32 m0, s21, 1024
    s_add_u32 s18, s18, 18432
    buffer_load_dwordx4 v3, s[12:15], s18 offen lds
    s_add_u32 m0, s21, 2048
    s_add_u32 s18, s18, 18432
    buffer_load_dwordx4 v3, s[12:15], s18 offen lds
    s_add_u32 m0, s21, 3072
    s_add_u32 s18, s18, 18432
    buffer_load_dwordx4 v3, s[12:15], s18 offen lds
    s_add_u32 s18, s19, 73728
    s_add_u32 m0, s21, 16384
    s_nop 0
    buffer_load_dwordx4 v3, s[12:15], s18 offen lds
    s_add_u32 m0, s21, 17408
    s_add_u32 s18, s18, 18432
    buffer_load_dwordx4 v3, s[12:15], s18 offen lds
    s_add_u32 m0, s21, 18432
    s_add_u32 s18, s18, 18432
    buffer_load_dwordx4 v3, s[12:15], s18 offen lds
    s_add_u32 m0, s21, 19456
    s_add_u32 s18, s18, 18432
    buffer_load_dwordx4 v3, s[12:15], s18 offen lds
    s_add_u32 s18, s19, 147456
    s_add_u32 m0, s21, 32768
    s_nop 0
    buffer_load_dwordx4 v3, s[12:15], s18 offen lds
    s_add_u32 m0, s21, 33792
    s_add_u32 s18, s18, 18432
    buffer_load_dwordx4 v3, s[12:15], s18 offen lds
    s_add_u32 m0, s21, 34816
    s_add_u32 s18, s18, 18432
    buffer_load_dwordx4 v3, s[12:15], s18 offen lds
    s_add_u32 m0, s21, 35840
    s_add_u32 s18, s18, 18432
    buffer_load_dwordx4 v3, s[12:15], s18 offen lds
    s_add_u32 s18, s19, 221184
    s_add_u32 m0, s21, 49152
    s_nop 0
    buffer_load_dwordx4 v3, s[12:15], s18 offen lds
    s_add_u32 m0, s21, 50176
    s_add_u32 s18, s18, 18432
    buffer_load_dwordx4 v3, s[12:15], s18 offen lds
    s_add_u32 m0, s21, 51200
    s_add_u32 s18, s18, 18432
    buffer_load_dwordx4 v3, s[12:15], s18 offen lds
    s_add_u32 m0, s21, 52224
    s_add_u32 s18, s18, 18432
    buffer_load_dwordx4 v3, s[12:15], s18 offen lds
    s_add_u32 s18, s19, 294912
    s_add_u32 m0, s21, 65536
    s_nop 0
    buffer_load_dwordx4 v3, s[12:15], s18 offen lds
    s_add_u32 m0, s21, 66560
    s_add_u32 s18, s18, 18432
    buffer_load_dwordx4 v3, s[12:15], s18 offen lds
    s_add_u32 m0, s21, 67584
    s_add_u32 s18, s18, 18432
    buffer_load_dwordx4 v3, s[12:15], s18 offen lds
    s_add_u32 m0, s21, 68608
    s_add_u32 s18, s18, 18432
    buffer_load_dwordx4 v3, s[12:15], s18 offen lds
    s_add_u32 s18, s19, 368640
    s_add_u32 m0, s21, 81920
    s_nop 0
    buffer_load_dwordx4 v3, s[12:15], s18 offen lds
    s_add_u32 m0, s21, 82944
    s_add_u32 s18, s18, 18432
    buffer_load_dwordx4 v3, s[12:15], s18 offen lds
    s_add_u32 m0, s21, 83968
    s_add_u32 s18, s18, 18432
    buffer_load_dwordx4 v3, s[12:15], s18 offen lds
    s_add_u32 m0, s21, 84992
    s_add_u32 s18, s18, 18432
    buffer_load_dwordx4 v3, s[12:15], s18 offen lds
    s_add_u32 s18, s19, 442368
    s_add_u32 m0, s21, 98304
    s_nop 0
    buffer_load_dwordx4 v3, s[12:15], s18 offen lds
    s_add_u32 m0, s21, 99328
    s_add_u32 s18, s18, 18432
    buffer_load_dwordx4 v3, s[12:15], s18 offen lds
    s_add_u32 m0, s21, 100352
    s_add_u32 s18, s18, 18432
    buffer_load_dwordx4 v3, s[12:15], s18 offen lds
    s_add_u32 m0, s21, 101376
    s_add_u32 s18, s18, 18432
    buffer_load_dwordx4 v3, s[12:15], s18 offen lds
    s_add_u32 s18, s19, 516096
    s_add_u32 m0, s21, 114688
    s_nop 0
    buffer_load_dwordx4 v3, s[12:15], s18 offen lds
    s_add_u32 m0, s21, 115712
    s_add_u32 s18, s18, 18432
    buffer_load_dwordx4 v3, s[12:15], s18 offen lds
    s_add_u32 m0, s21, 116736
    s_add_u32 s18, s18, 18432
    buffer_load_dwordx4 v3, s[12:15], s18 offen lds
    s_add_u32 m0, s21, 117760
    s_add_u32 s18, s18, 18432
    buffer_load_dwordx4 v3, s[12:15], s18 offen lds
    s_add_u32 s18, s19, 589824
    s_add_u32 m0, s21, 131072
    s_nop 0
    buffer_load_dwordx4 v3, s[12:15], s18 offen lds
    s_add_u32 m0, s21, 132096
    s_add_u32 s18, s18, 18432
    buffer_load_dwordx4 v3, s[12:15], s18 offen lds
    s_add_u32 m0, s21, 133120
    s_add_u32 s18, s18, 18432
    buffer_load_dwordx4 v3, s[12:15], s18 offen lds
    s_add_u32 m0, s21, 134144
    s_add_u32 s18, s18, 18432
    buffer_load_dwordx4 v3, s[12:15], s18 offen lds
    v_add_u32 v6, 0, v4
    v_xor_b32 v7, 32, v6
    s_waitcnt vmcnt(32)
    ds_read_b64_tr_b16 a[0:1], v6 offset:0
    ds_read_b64_tr_b16 a[2:3], v6 offset:1024
    ds_read_b64_tr_b16 a[4:5], v6 offset:8
    ds_read_b64_tr_b16 a[6:7], v6 offset:1032
    ds_read_b64_tr_b16 a[8:9], v6 offset:2048
    ds_read_b64_tr_b16 a[10:11], v6 offset:3072
    ds_read_b64_tr_b16 a[12:13], v6 offset:2056
    ds_read_b64_tr_b16 a[14:15], v6 offset:3080
    s_waitcnt lgkmcnt(0)
    s_add_u32 s18, s19, 663552
    s_add_u32 m0, s21, 0
    s_nop 0
    buffer_load_dwordx4 v3, s[12:15], s18 offen lds
    s_add_u32 m0, s21, 1024
    s_add_u32 s18, s18, 18432
    buffer_load_dwordx4 v3, s[12:15], s18 offen lds
    s_add_u32 m0, s21, 2048
    s_add_u32 s18, s18, 18432
    buffer_load_dwordx4 v3, s[12:15], s18 offen lds
    s_add_u32 m0, s21, 3072
    s_add_u32 s18, s18, 18432
    buffer_load_dwordx4 v3, s[12:15], s18 offen lds
    v_add_u32 v6, 16384, v4
    v_xor_b32 v7, 32, v6
    s_waitcnt vmcnt(32)
    ds_read_b64_tr_b16 a[16:17], v6 offset:0
    ds_read_b64_tr_b16 a[18:19], v6 offset:1024
    ds_read_b64_tr_b16 a[20:21], v6 offset:8
    ds_read_b64_tr_b16 a[22:23], v6 offset:1032
    ds_read_b64_tr_b16 a[24:25], v6 offset:2048
    ds_read_b64_tr_b16 a[26:27], v6 offset:3072
    ds_read_b64_tr_b16 a[28:29], v6 offset:2056
    ds_read_b64_tr_b16 a[30:31], v6 offset:3080
    s_waitcnt lgkmcnt(0)
    s_add_u32 s18, s19, 737280
    s_add_u32 m0, s21, 16384
    s_nop 0
    buffer_load_dwordx4 v3, s[12:15], s18 offen lds
    s_add_u32 m0, s21, 17408
    s_add_u32 s18, s18, 18432
    buffer_load_dwordx4 v3, s[12:15], s18 offen lds
    s_add_u32 m0, s21, 18432
    s_add_u32 s18, s18, 18432
    buffer_load_dwordx4 v3, s[12:15], s18 offen lds
    s_add_u32 m0, s21, 19456
    s_add_u32 s18, s18, 18432
    buffer_load_dwordx4 v3, s[12:15], s18 offen lds
    v_add_u32 v6, 32768, v4
    v_xor_b32 v7, 32, v6
    s_waitcnt vmcnt(32)
    ds_read_b64_tr_b16 a[32:33], v6 offset:0
    ds_read_b64_tr_b16 a[34:35], v6 offset:1024
    ds_read_b64_tr_b16 a[36:37], v6 offset:8
    ds_read_b64_tr_b16 a[38:39], v6 offset:1032
    ds_read_b64_tr_b16 a[40:41], v6 offset:2048
    ds_read_b64_tr_b16 a[42:43], v6 offset:3072
    ds_read_b64_tr_b16 a[44:45], v6 offset:2056
    ds_read_b64_tr_b16 a[46:47], v6 offset:3080
    s_waitcnt lgkmcnt(0)
    s_add_u32 s18, s19, 811008
    s_add_u32 m0, s21, 32768
    s_nop 0
    buffer_load_dwordx4 v3, s[12:15], s18 offen lds
    s_add_u32 m0, s21, 33792
    s_add_u32 s18, s18, 18432
    buffer_load_dwordx4 v3, s[12:15], s18 offen lds
    s_add_u32 m0, s21, 34816
    s_add_u32 s18, s18, 18432
    buffer_load_dwordx4 v3, s[12:15], s18 offen lds
    s_add_u32 m0, s21, 35840
    s_add_u32 s18, s18, 18432
    buffer_load_dwordx4 v3, s[12:15], s18 offen lds
    v_add_u32 v6, 49152, v4
    v_xor_b32 v7, 32, v6
    s_waitcnt vmcnt(32)
    ds_read_b64_tr_b16 a[48:49], v6 offset:0
    ds_read_b64_tr_b16 a[50:51], v6 offset:1024
    ds_read_b64_tr_b16 a[52:53], v6 offset:8
    ds_read_b64_tr_b16 a[54:55], v6 offset:1032
    ds_read_b64_tr_b16 a[56:57], v6 offset:2048
    ds_read_b64_tr_b16 a[58:59], v6 offset:3072
    ds_read_b64_tr_b16 a[60:61], v6 offset:2056
    ds_read_b64_tr_b16 a[62:63], v6 offset:3080
    s_waitcnt lgkmcnt(0)
    s_add_u32 s18, s19, 884736
    s_add_u32 m0, s21, 49152
    s_nop 0
    buffer_load_dwordx4 v3, s[12:15], s18 offen lds
    s_add_u32 m0, s21, 50176
    s_add_u32 s18, s18, 18432
    buffer_load_dwordx4 v3, s[12:15], s18 offen lds
    s_add_u32 m0, s21, 51200
    s_add_u32 s18, s18, 18432
    buffer_load_dwordx4 v3, s[12:15], s18 offen lds
    s_add_u32 m0, s21, 52224
    s_add_u32 s18, s18, 18432
    buffer_load_dwordx4 v3, s[12:15], s18 offen lds
    v_add_u32 v6, 65536, v4
    v_xor_b32 v7, 32, v6
    s_waitcnt vmcnt(32)
    ds_read_b64_tr_b16 a[64:65], v6 offset:0
    ds_read_b64_tr_b16 a[66:67], v6 offset:1024
    ds_read_b64_tr_b16 a[68:69], v6 offset:8
    ds_read_b64_tr_b16 a[70:71], v6 offset:1032
    ds_read_b64_tr_b16 a[72:73], v6 offset:2048
    ds_read_b64_tr_b16 a[74:75], v6 offset:3072
    ds_read_b64_tr_b16 a[76:77], v6 offset:2056
    ds_read_b64_tr_b16 a[78:79], v6 offset:3080
    s_waitcnt lgkmcnt(0)
    s_add_u32 s18, s19, 958464
    s_add_u32 m0, s21, 65536
    s_nop 0
    buffer_load_dwordx4 v3, s[12:15], s18 offen lds
    s_add_u32 m0, s21, 66560
    s_add_u32 s18, s18, 18432
    buffer_load_dwordx4 v3, s[12:15], s18 offen lds
    s_add_u32 m0, s21, 67584
    s_add_u32 s18, s18, 18432
    buffer_load_dwordx4 v3, s[12:15], s18 offen lds
    s_add_u32 m0, s21, 68608
    s_add_u32 s18, s18, 18432
    buffer_load_dwordx4 v3, s[12:15], s18 offen lds
    v_add_u32 v6, 81920, v4
    v_xor_b32 v7, 32, v6
    s_waitcnt vmcnt(32)
    ds_read_b64_tr_b16 a[80:81], v6 offset:0
    ds_read_b64_tr_b16 a[82:83], v6 offset:1024
    ds_read_b64_tr_b16 a[84:85], v6 offset:8
    ds_read_b64_tr_b16 a[86:87], v6 offset:1032
    ds_read_b64_tr_b16 a[88:89], v6 offset:2048
    ds_read_b64_tr_b16 a[90:91], v6 offset:3072
    ds_read_b64_tr_b16 a[92:93], v6 offset:2056
    ds_read_b64_tr_b16 a[94:95], v6 offset:3080
    s_waitcnt lgkmcnt(0)
    s_add_u32 s18, s19, 1032192
    s_add_u32 m0, s21, 81920
    s_nop 0
    buffer_load_dwordx4 v3, s[12:15], s18 offen lds
    s_add_u32 m0, s21, 82944
    s_add_u32 s18, s18, 18432
    buffer_load_dwordx4 v3, s[12:15], s18 offen lds
    s_add_u32 m0, s21, 83968
    s_add_u32 s18, s18, 18432
    buffer_load_dwordx4 v3, s[12:15], s18 offen lds
    s_add_u32 m0, s21, 84992
    s_add_u32 s18, s18, 18432
    buffer_load_dwordx4 v3, s[12:15], s18 offen lds
    v_add_u32 v6, 98304, v4
    v_xor_b32 v7, 32, v6
    s_waitcnt vmcnt(32)
    ds_read_b64_tr_b16 a[96:97], v6 offset:0
    ds_read_b64_tr_b16 a[98:99], v6 offset:1024
    ds_read_b64_tr_b16 a[100:101], v6 offset:8
    ds_read_b64_tr_b16 a[102:103], v6 offset:1032
    ds_read_b64_tr_b16 a[104:105], v6 offset:2048
    ds_read_b64_tr_b16 a[106:107], v6 offset:3072
    ds_read_b64_tr_b16 a[108:109], v6 offset:2056
    ds_read_b64_tr_b16 a[110:111], v6 offset:3080
    s_waitcnt lgkmcnt(0)
    s_add_u32 s18, s19, 1105920
    s_add_u32 m0, s21, 98304
    s_nop 0
    buffer_load_dwordx4 v3, s[12:15], s18 offen lds
    s_add_u32 m0, s21, 99328
    s_add_u32 s18, s18, 18432
    buffer_load_dwordx4 v3, s[12:15], s18 offen lds
    s_add_u32 m0, s21, 100352
    s_add_u32 s18, s18, 18432
    buffer_load_dwordx4 v3, s[12:15], s18 offen lds
    s_add_u32 m0, s21, 101376
    s_add_u32 s18, s18, 18432
    buffer_load_dwordx4 v3, s[12:15], s18 offen lds
    v_add_u32 v6, 114688, v4
    v_xor_b32 v7, 32, v6
    s_waitcnt vmcnt(32)
    ds_read_b64_tr_b16 a[112:113], v6 offset:0
    ds_read_b64_tr_b16 a[114:115], v6 offset:1024
    ds_read_b64_tr_b16 a[116:117], v6 offset:8
    ds_read_b64_tr_b16 a[118:119], v6 offset:1032
    ds_read_b64_tr_b16 a[120:121], v6 offset:2048
    ds_read_b64_tr_b16 a[122:123], v6 offset:3072
    ds_read_b64_tr_b16 a[124:125], v6 offset:2056
    ds_read_b64_tr_b16 a[126:127], v6 offset:3080
    s_waitcnt lgkmcnt(0)
    v_add_u32 v6, 131072, v4
    v_xor_b32 v7, 32, v6
    s_waitcnt vmcnt(28)
    ds_read_b64_tr_b16 a[128:129], v6 offset:0
    ds_read_b64_tr_b16 a[130:131], v6 offset:1024
    ds_read_b64_tr_b16 a[132:133], v6 offset:8
    ds_read_b64_tr_b16 a[134:135], v6 offset:1032
    ds_read_b64_tr_b16 a[136:137], v6 offset:2048
    ds_read_b64_tr_b16 a[138:139], v6 offset:3072
    ds_read_b64_tr_b16 a[140:141], v6 offset:2056
    ds_read_b64_tr_b16 a[142:143], v6 offset:3080
    s_waitcnt lgkmcnt(0)
    v_add_u32 v6, 0, v4
    v_xor_b32 v7, 32, v6
    s_waitcnt vmcnt(24)
    ds_read_b64_tr_b16 a[144:145], v6 offset:0
    ds_read_b64_tr_b16 a[146:147], v6 offset:1024
    ds_read_b64_tr_b16 a[148:149], v6 offset:8
    ds_read_b64_tr_b16 a[150:151], v6 offset:1032
    ds_read_b64_tr_b16 a[152:153], v6 offset:2048
    ds_read_b64_tr_b16 a[154:155], v6 offset:3072
    ds_read_b64_tr_b16 a[156:157], v6 offset:2056
    ds_read_b64_tr_b16 a[158:159], v6 offset:3080
    s_waitcnt lgkmcnt(0)
    v_add_u32 v6, 16384, v4
    v_xor_b32 v7, 32, v6
    s_waitcnt vmcnt(20)
    ds_read_b64_tr_b16 a[160:161], v6 offset:0
    ds_read_b64_tr_b16 a[162:163], v6 offset:1024
    ds_read_b64_tr_b16 a[164:165], v6 offset:8
    ds_read_b64_tr_b16 a[166:167], v6 offset:1032
    ds_read_b64_tr_b16 a[168:169], v6 offset:2048
    ds_read_b64_tr_b16 a[170:171], v6 offset:3072
    ds_read_b64_tr_b16 a[172:173], v6 offset:2056
    ds_read_b64_tr_b16 a[174:175], v6 offset:3080
    s_waitcnt lgkmcnt(0)
    v_add_u32 v6, 32768, v4
    v_xor_b32 v7, 32, v6
    s_waitcnt vmcnt(16)
    ds_read_b64_tr_b16 a[176:177], v6 offset:0
    ds_read_b64_tr_b16 a[178:179], v6 offset:1024
    ds_read_b64_tr_b16 a[180:181], v6 offset:8
    ds_read_b64_tr_b16 a[182:183], v6 offset:1032
    ds_read_b64_tr_b16 a[184:185], v6 offset:2048
    ds_read_b64_tr_b16 a[186:187], v6 offset:3072
    ds_read_b64_tr_b16 a[188:189], v6 offset:2056
    ds_read_b64_tr_b16 a[190:191], v6 offset:3080
    s_waitcnt lgkmcnt(0)
    v_add_u32 v6, 49152, v4
    v_xor_b32 v7, 32, v6
    s_waitcnt vmcnt(12)
    ds_read_b64_tr_b16 a[192:193], v6 offset:0
    ds_read_b64_tr_b16 a[194:195], v6 offset:1024
    ds_read_b64_tr_b16 a[196:197], v6 offset:8
    ds_read_b64_tr_b16 a[198:199], v6 offset:1032
    ds_read_b64_tr_b16 a[200:201], v6 offset:2048
    ds_read_b64_tr_b16 a[202:203], v6 offset:3072
    ds_read_b64_tr_b16 a[204:205], v6 offset:2056
    ds_read_b64_tr_b16 a[206:207], v6 offset:3080
    s_waitcnt lgkmcnt(0)
    v_add_u32 v6, 65536, v4
    v_xor_b32 v7, 32, v6
    s_waitcnt vmcnt(8)
    ds_read_b64_tr_b16 a[208:209], v6 offset:0
    ds_read_b64_tr_b16 a[210:211], v6 offset:1024
    ds_read_b64_tr_b16 a[212:213], v6 offset:8
    ds_read_b64_tr_b16 a[214:215], v6 offset:1032
    ds_read_b64_tr_b16 a[216:217], v6 offset:2048
    ds_read_b64_tr_b16 a[218:219], v6 offset:3072
    ds_read_b64_tr_b16 a[220:221], v6 offset:2056
    ds_read_b64_tr_b16 a[222:223], v6 offset:3080
    s_waitcnt lgkmcnt(0)
    v_add_u32 v6, 81920, v4
    v_xor_b32 v7, 32, v6
    s_waitcnt vmcnt(4)
    ds_read_b64_tr_b16 a[224:225], v6 offset:0
    ds_read_b64_tr_b16 a[226:227], v6 offset:1024
    ds_read_b64_tr_b16 a[228:229], v6 offset:8
    ds_read_b64_tr_b16 a[230:231], v6 offset:1032
    ds_read_b64_tr_b16 a[232:233], v6 offset:2048
    ds_read_b64_tr_b16 a[234:235], v6 offset:3072
    ds_read_b64_tr_b16 a[236:237], v6 offset:2056
    ds_read_b64_tr_b16 a[238:239], v6 offset:3080
    s_waitcnt lgkmcnt(0)
    v_add_u32 v6, 98304, v4
    v_xor_b32 v7, 32, v6
    s_waitcnt vmcnt(0)
    ds_read_b64_tr_b16 a[240:241], v6 offset:0
    ds_read_b64_tr_b16 a[242:243], v6 offset:1024
    ds_read_b64_tr_b16 a[244:245], v6 offset:8
    ds_read_b64_tr_b16 a[246:247], v6 offset:1032
    ds_read_b64_tr_b16 a[248:249], v6 offset:2048
    ds_read_b64_tr_b16 a[250:251], v6 offset:3072
    ds_read_b64_tr_b16 a[252:253], v6 offset:2056
    ds_read_b64_tr_b16 a[254:255], v6 offset:3080
    s_waitcnt lgkmcnt(0)
    s_barrier
L_op_seg:
    s_lshr_b32 s43, s16, 1
    s_add_u32 s43, s43, 1
    s_min_u32 s43, s43, 63
    s_and_b32 s36, s33, 15
    s_lshl_b32 s36, s36, 8
    s_add_u32 s36, s36, 125829120
    s_lshl_b32 s94, s33, 7
    s_add_u32 s94, s94, s16
    s_cmp_ge_u32 s16, 120
    s_cbranch_scc1 L_nocw
    s_mov_b32 s88, 65536
cw15:
    buffer_load_dword v3, off, s[4:7], s36 offset:128 sc1
    s_waitcnt vmcnt(0)
    v_readfirstlane_b32 s42, v3
    s_nop 0
    s_sub_u32 s42, s42, s95
    s_cmp_gt_u32 s42, 64
    s_cselect_b32 s42, 0, s42
    s_add_u32 s42, s42, 2
    s_cmp_ge_u32 s42, s43
    s_cbranch_scc1 cw15x
    s_sub_u32 s88, s88, 1
    s_cbranch_scc1 cw15x
    s_sub_u32 s42, s43, s42
    s_min_u32 s42, s42, 6
cw15s:
    s_sleep 24
    s_sub_u32 s42, s42, 1
    s_cmp_lg_u32 s42, 0
    s_cbranch_scc1 cw15s
    s_branch cw15
cw15x:
L_nocw:
    s_lshr_b32 s89, s16, 1
    s_lshl_b32 s89, s89, 2
    s_add_u32 s89, s89, s32
    s_lshl_b32 s89, s89, 7
    s_add_u32 s89, s89, 125894656
    v_mbcnt_lo_u32_b32 v2, -1, 0
    v_mbcnt_hi_u32_b32 v2, -1, v2
    v_min_u32 v2, 7, v2
    v_lshlrev_b32 v2, 2, v2
    s_mov_b32 s88, 4194304
fw16:
    buffer_load_dword v3, v2, s[4:7], s89 offen offset:0 sc1
    s_sub_u32 s88, s88, 1
    s_cbranch_scc1 fw16x
    s_waitcnt vmcnt(0)
    v_cmp_ne_u32 vcc, s95, v3
    s_cbranch_vccz fw16x
    s_sleep 2
    s_cmp_gt_u32 s88, 4194256
    s_cbranch_scc1 fw16
    s_sleep 40
    s_branch fw16
fw16x:
    s_mov_b32 s21, 4096
os_again:
    s_lshl_b32 s18, s16, 17
    s_lshl_b32 s19, s32, 15
    s_add_u32 s18, s18, s19
    s_add_u32 s18, s18, 50331648
    buffer_load_dwordx4 v[32:35], v1, s[4:7], s18 offen offset:0 sc1
    buffer_load_dwordx4 v[36:39], v1, s[4:7], s18 offen offset:1024 sc1
    buffer_load_dwordx4 v[40:43], v1, s[4:7], s18 offen offset:2048 sc1
    buffer_load_dwordx4 v[44:47], v1, s[4:7], s18 offen offset:3072 sc1
    s_add_u32 s18, s18, 4096
    buffer_load_dwordx4 v[48:51], v1, s[4:7], s18 offen offset:0 sc1
    buffer_load_dwordx4 v[52:55], v1, s[4:7], s18 offen offset:1024 sc1
    buffer_load_dwordx4 v[56:59], v1, s[4:7], s18 offen offset:2048 sc1
    buffer_load_dwordx4 v[60:63], v1, s[4:7], s18 offen offset:3072 sc1
    s_add_u32 s18, s18, 4096
    buffer_load_dwordx4 v[64:67], v1, s[4:7], s18 offen offset:0 sc1
    buffer_load_dwordx4 v[68:71], v1, s[4:7], s18 offen offset:1024 sc1
    buffer_load_dwordx4 v[72:75], v1, s[4:7], s18 offen offset:2048 sc1
    buffer_load_dwordx4 v[76:79], v1, s[4:7], s18 offen offset:3072 sc1
    s_add_u32 s18, s18, 4096
    buffer_load_dwordx4 v[80:83], v1, s[4:7], s18 offen offset:0 sc1
    buffer_load_dwordx4 v[84:87], v1, s[4:7], s18 offen offset:1024 sc1
    buffer_load_dwordx4 v[88:91], v1, s[4:7], s18 offen offset:2048 sc1
    buffer_load_dwordx4 v[92:95], v1, s[4:7], s18 offen offset:3072 sc1
    s_add_u32 s18, s18, 4096
    buffer_load_dwordx4 v[96:99], v1, s[4:7], s18 offen offset:0 sc1
    buffer_load_dwordx4 v[100:103], v1, s[4:7], s18 offen offset:1024 sc1
    buffer_load_dwordx4 v[104:107], v1, s[4:7], s18 offen offset:2048 sc1
    buffer_load_dwordx4 v[108:111], v1, s[4:7], s18 offen offset:3072 sc1
    s_add_u32 s18, s18, 4096
    buffer_load_dwordx4 v[112:115], v1, s[4:7], s18 offen offset:0 sc1
    buffer_load_dwordx4 v[116:119], v1, s[4:7], s18 offen offset:1024 sc1
    buffer_load_dwordx4 v[120:123], v1, s[4:7], s18 offen offset:2048 sc1
    buffer_load_dwordx4 v[124:127], v1, s[4:7], s18 offen offset:3072 sc1
    s_add_u32 s18, s18, 4096
    buffer_load_dwordx4 v[128:131], v1, s[4:7], s18 offen offset:0 sc1
    buffer_load_dwordx4 v[132:135], v1, s[4:7], s18 offen offset:1024 sc1
    buffer_load_dwordx4 v[136:139], v1, s[4:7], s18 offen offset:2048 sc1
    buffer_load_dwordx4 v[140:143], v1, s[4:7], s18 offen offset:3072 sc1
    s_add_u32 s18, s18, 4096
    buffer_load_dwordx4 v[144:147], v1, s[4:7], s18 offen offset:0 sc1
    buffer_load_dwordx4 v[148:151], v1, s[4:7], s18 offen offset:1024 sc1
    buffer_load_dwordx4 v[152:155], v1, s[4:7], s18 offen offset:2048 sc1
    buffer_load_dwordx4 v[156:159], v1, s[4:7], s18 offen offset:3072 sc1
    v_lshlrev_b32 v2, 4, v0
    v_and_b32 v3, 3072, v2
    v_lshl_add_u32 v2, v3, 1, v1
    s_waitcnt vmcnt(31)
    v_mfma_f32_16x16x32_bf16 v[8:11], a[0:3], v[32:35], 0
    v_mfma_f32_16x16x32_bf16 v[12:15], a[4:7], v[32:35], 0
    v_mov_b32 v4, v32
    s_waitcnt vmcnt(30)
    v_mfma_f32_16x16x32_bf16 v[8:11], a[8:11], v[36:39], v[8:11]
    v_mfma_f32_16x16x32_bf16 v[12:15], a[12:15], v[36:39], v[12:15]
    v_max_u32 v4, v4, v36
    s_waitcnt vmcnt(29)
    v_mfma_f32_16x16x32_bf16 v[8:11], a[16:19], v[40:43], v[8:11]
    v_mfma_f32_16x16x32_bf16 v[12:15], a[20:23], v[40:43], v[12:15]
    v_max_u32 v4, v4, v40
    s_waitcnt vmcnt(28)
    v_mfma_f32_16x16x32_bf16 v[8:11], a[24:27], v[44:47], v[8:11]
    v_mfma_f32_16x16x32_bf16 v[12:15], a[28:31], v[44:47], v[12:15]
    v_max_u32 v4, v4, v44
    s_waitcnt vmcnt(27)
    v_mfma_f32_16x16x32_bf16 v[8:11], a[32:35], v[48:51], v[8:11]
    v_mfma_f32_16x16x32_bf16 v[12:15], a[36:39], v[48:51], v[12:15]
    v_max_u32 v4, v4, v48
    s_waitcnt vmcnt(26)
    v_mfma_f32_16x16x32_bf16 v[8:11], a[40:43], v[52:55], v[8:11]
    v_mfma_f32_16x16x32_bf16 v[12:15], a[44:47], v[52:55], v[12:15]
    v_max_u32 v4, v4, v52
    s_waitcnt vmcnt(25)
    v_mfma_f32_16x16x32_bf16 v[8:11], a[48:51], v[56:59], v[8:11]
    v_mfma_f32_16x16x32_bf16 v[12:15], a[52:55], v[56:59], v[12:15]
    v_max_u32 v4, v4, v56
    s_waitcnt vmcnt(24)
    v_mfma_f32_16x16x32_bf16 v[8:11], a[56:59], v[60:63], v[8:11]
    v_mfma_f32_16x16x32_bf16 v[12:15], a[60:63], v[60:63], v[12:15]
    v_max_u32 v4, v4, v60
    s_waitcnt vmcnt(23)
    v_mfma_f32_16x16x32_bf16 v[8:11], a[64:67], v[64:67], v[8:11]
    v_mfma_f32_16x16x32_bf16 v[12:15], a[68:71], v[64:67], v[12:15]
    v_max_u32 v4, v4, v64
    s_waitcnt vmcnt(22)
    v_mfma_f32_16x16x32_bf16 v[8:11], a[72:75], v[68:71], v[8:11]
    v_mfma_f32_16x16x32_bf16 v[12:15], a[76:79], v[68:71], v[12:15]
    v_max_u32 v4, v4, v68
    s_waitcnt vmcnt(21)
    v_mfma_f32_16x16x32_bf16 v[8:11], a[80:83], v[72:75], v[8:11]
    v_mfma_f32_16x16x32_bf16 v[12:15], a[84:87], v[72:75], v[12:15]
    v_max_u32 v4, v4, v72
    s_waitcnt vmcnt(20)
    v_mfma_f32_16x16x32_bf16 v[8:11], a[88:91], v[76:79], v[8:11]
    v_mfma_f32_16x16x32_bf16 v[12:15], a[92:95], v[76:79], v[12:15]
    v_max_u32 v4, v4, v76
    s_waitcnt vmcnt(19)
    v_mfma_f32_16x16x32_bf16 v[8:11], a[96:99], v[80:83], v[8:11]
    v_mfma_f32_16x16x32_bf16 v[12:15], a[100:103], v[80:83], v[12:15]
    v_max_u32 v4, v4, v80
    s_waitcnt vmcnt(18)
    v_mfma_f32_16x16x32_bf16 v[8:11], a[104:107], v[84:87], v[8:11]
    v_mfma_f32_16x16x32_bf16 v[12:15], a[108:111], v[84:87], v[12:15]
    v_max_u32 v4, v4, v84
    s_waitcnt vmcnt(17)
    v_mfma_f32_16x16x32_bf16 v[8:11], a[112:115], v[88:91], v[8:11]
    v_mfma_f32_16x16x32_bf16 v[12:15], a[116:119], v[88:91], v[12:15]
    v_max_u32 v4, v4, v88
    s_waitcnt vmcnt(16)
    v_mfma_f32_16x16x32_bf16 v[8:11], a[120:123], v[92:95], v[8:11]
    v_mfma_f32_16x16x32_bf16 v[12:15], a[124:127], v[92:95], v[12:15]
    v_max_u32 v4, v4, v92
    s_waitcnt vmcnt(15)
    v_mfma_f32_16x16x32_bf16 v[8:11], a[128:131], v[96:99], v[8:11]
    v_mfma_f32_16x16x32_bf16 v[12:15], a[132:135], v[96:99], v[12:15]
    v_max_u32 v4, v4, v96
    s_waitcnt vmcnt(14)
    v_mfma_f32_16x16x32_bf16 v[8:11], a[136:139], v[100:103], v[8:11]
    v_mfma_f32_16x16x32_bf16 v[12:15], a[140:143], v[100:103], v[12:15]
    v_max_u32 v4, v4, v100
    s_waitcnt vmcnt(13)
    v_mfma_f32_16x16x32_bf16 v[8:11], a[144:147], v[104:107], v[8:11]
    v_mfma_f32_16x16x32_bf16 v[12:15], a[148:151], v[104:107], v[12:15]
    v_max_u32 v4, v4, v104
    s_waitcnt vmcnt(12)
    v_mfma_f32_16x16x32_bf16 v[8:11], a[152:155], v[108:111], v[8:11]
    v_mfma_f32_16x16x32_bf16 v[12:15], a[156:159], v[108:111], v[12:15]
    v_max_u32 v4, v4, v108
    s_waitcnt vmcnt(11)
    v_mfma_f32_16x16x32_bf16 v[8:11], a[160:163], v[112:115], v[8:11]
    v_mfma_f32_16x16x32_bf16 v[12:15], a[164:167], v[112:115], v[12:15]
    v_max_u32 v4, v4, v112
    s_waitcnt vmcnt(10)
    v_mfma_f32_16x16x32_bf16 v[8:11], a[168:171], v[116:119], v[8:11]
    v_mfma_f32_16x16x32_bf16 v[12:15], a[172:175], v[116:119], v[12:15]
    v_max_u32 v4, v4, v116
    s_waitcnt vmcnt(9)
    v_mfma_f32_16x16x32_bf16 v[8:11], a[176:179], v[120:123], v[8:11]
    v_mfma_f32_16x16x32_bf16 v[12:15], a[180:183], v[120:123], v[12:15]
    v_max_u32 v4, v4, v120
    s_waitcnt vmcnt(8)
    v_mfma_f32_16x16x32_bf16 v[8:11], a[184:187], v[124:127], v[8:11]
    v_mfma_f32_16x16x32_bf16 v[12:15], a[188:191], v[124:127], v[12:15]
    v_max_u32 v4, v4, v124
    s_waitcnt vmcnt(7)
    v_mfma_f32_16x16x32_bf16 v[8:11], a[192:195], v[128:131], v[8:11]
    v_mfma_f32_16x16x32_bf16 v[12:15], a[196:199], v[128:131], v[12:15]
    v_max_u32 v4, v4, v128
    s_waitcnt vmcnt(6)
    v_mfma_f32_16x16x32_bf16 v[8:11], a[200:203], v[132:135], v[8:11]
    v_mfma_f32_16x16x32_bf16 v[12:15], a[204:207], v[132:135], v[12:15]
    v_max_u32 v4, v4, v132
    s_waitcnt vmcnt(5)
    v_mfma_f32_16x16x32_bf16 v[8:11], a[208:211], v[136:139], v[8:11]
    v_mfma_f32_16x16x32_bf16 v[12:15], a[212:215], v[136:139], v[12:15]
    v_max_u32 v4, v4, v136
    s_waitcnt vmcnt(4)
    v_mfma_f32_16x16x32_bf16 v[8:11], a[216:219], v[140:143], v[8:11]
    v_mfma_f32_16x16x32_bf16 v[12:15], a[220:223], v[140:143], v[12:15]
    v_max_u32 v4, v4, v140
    s_waitcnt vmcnt(3)
    v_mfma_f32_16x16x32_bf16 v[8:11], a[224:227], v[144:147], v[8:11]
    v_mfma_f32_16x16x32_bf16 v[12:15], a[228:231], v[144:147], v[12:15]
    v_max_u32 v4, v4, v144
    s_waitcnt vmcnt(2)
    v_mfma_f32_16x16x32_bf16 v[8:11], a[232:235], v[148:151], v[8:11]
    v_mfma_f32_16x16x32_bf16 v[12:15], a[236:239], v[148:151], v[12:15]
    v_max_u32 v4, v4, v148
    s_waitcnt vmcnt(1)
    v_mfma_f32_16x16x32_bf16 v[8:11], a[240:243], v[152:155], v[8:11]
    v_mfma_f32_16x16x32_bf16 v[12:15], a[244:247], v[152:155], v[12:15]
    v_max_u32 v4, v4, v152
    s_waitcnt vmcnt(0)
    v_mfma_f32_16x16x32_bf16 v[8:11], a[248:251], v[156:159], v[8:11]
    v_mfma_f32_16x16x32_bf16 v[12:15], a[252:255], v[156:159], v[12:15]
    v_max_u32 v4, v4, v156
    v_cmp_eq_u32 vcc, -1, v4
    s_sub_u32 s21, s21, 1
    s_nop 3
    s_cbranch_scc1 os_ok
    s_cbranch_vccnz os_again
os_ok:
    ds_write_b128 v2, v[8:11] offset:0
    ds_write_b128 v2, v[12:15] offset:1024
    s_waitcnt lgkmcnt(0)
    s_barrier
    s_cmp_lg_u32 s32, 0
    s_cbranch_scc1 os_skip
    ds_read_b128 v[40:43], v1 offset:2048
    ds_read_b128 v[44:47], v1 offset:3072
    ds_read_b128 v[48:51], v1 offset:4096
    ds_read_b128 v[52:55], v1 offset:5120
    ds_read_b128 v[56:59], v1 offset:6144
    ds_read_b128 v[60:63], v1 offset:7168
    v_lshrrev_b32 v3, 4, v1
    v_bfe_u32 v4, v3, 2, 2
    v_lshlrev_b32 v4, 3, v4
    v_and_b32 v2, 3, v3
    v_add_u32 v4, v4, v2
    v_mul_u32_u24 v4, 2304, v4
    v_lshrrev_b32 v3, 4, v3
    v_lshl_add_u32 v4, v3, 4, v4
    s_lshr_b32 s18, s16, 1
    s_lshl_b32 s18, s18, 3
    s_and_b32 s19, s16, 1
    s_add_u32 s18, s18, s19
    s_mul_i32 s18, s18, 9216
    s_lshl_b32 s19, s33, 6
    s_add_u32 s18, s18, s19
    s_waitcnt lgkmcnt(0)
    v_pk_add_f32 v[8:9], v[8:9], v[40:41]
    v_pk_add_f32 v[48:49], v[48:49], v[56:57]
    v_pk_add_f32 v[8:9], v[8:9], v[48:49]
    v_pk_add_f32 v[10:11], v[10:11], v[42:43]
    v_pk_add_f32 v[50:51], v[50:51], v[58:59]
    v_pk_add_f32 v[10:11], v[10:11], v[50:51]
    v_pk_add_f32 v[12:13], v[12:13], v[44:45]
    v_pk_add_f32 v[52:53], v[52:53], v[60:61]
    v_pk_add_f32 v[12:13], v[12:13], v[52:53]
    v_pk_add_f32 v[14:15], v[14:15], v[46:47]
    v_pk_add_f32 v[54:55], v[54:55], v[62:63]
    v_pk_add_f32 v[14:15], v[14:15], v[54:55]
    v_cvt_pk_bf16_f32 v32, v8, v9
    v_cvt_pk_bf16_f32 v33, v10, v11
    v_cvt_pk_bf16_f32 v34, v12, v13
    v_cvt_pk_bf16_f32 v35, v14, v15
    buffer_store_dwordx4 v[32:35], v4, s[8:11], s18 offen sc1
os_skip:
    s_nop 1
    s_add_u32 s16, s16, 7
    s_cmp_ge_u32 s16, 128
    s_cbranch_scc1 L_done
    s_barrier
    s_branch L_op_seg
L_done:
L_exit:
    s_endpgm
.section .rodata,"a"
.p2align 6
.amdhsa_kernel concat_heads__memory_aug_recurrent_mem_tr__ssm_conv_s4d__prompt_kernel
  .amdhsa_next_free_vgpr 512
  .amdhsa_next_free_sgpr 102
  .amdhsa_accum_offset 256
  .amdhsa_group_segment_fixed_size 0
  .amdhsa_kernarg_size 136
  .amdhsa_user_sgpr_count 2
  .amdhsa_user_sgpr_kernarg_segment_ptr 1
  .amdhsa_system_sgpr_workgroup_id_x 1
.end_amdhsa_kernel
.text
```

```asm
; @launch grid=(256,1,1) block=(256,1,1) lds=163840
.amdgcn_target "amdgcn-amd-amdhsa--gfx950"
.text
.globl concat_heads__memory_aug_recurrent_mem_tr__ssm_conv_s4d__prompt_kernel
.p2align 8
.type concat_heads__memory_aug_recurrent_mem_tr__ssm_conv_s4d__prompt_kernel,@function
concat_heads__memory_aug_recurrent_mem_tr__ssm_conv_s4d__prompt_kernel:
    s_cmp_ge_u32 s2, 256
    s_cbranch_scc1 L_exit
    s_load_dwordx4 s[84:87], s[0:1], 120
    s_load_dwordx16 s[48:63], s[0:1], 0
    v_lshrrev_b32 v1, 6, v0
    s_nop 0
    v_readfirstlane_b32 s32, v1
    s_getreg_b32 s3, hwreg(HW_REG_XCC_ID)
    s_and_b32 s3, s3, 15
    s_cmp_lg_u32 s32, 3
    s_cbranch_scc1 L_nowarm
    s_getpc_b64 s[44:45]
L_pcw:
    v_and_b32 v1, 63, v0
    v_lshlrev_b32 v1, 7, v1
    s_cmp_lg_u32 s3, 0
    s_cselect_b32 s33, L_helper-L_pcw, 0
    v_add_u32 v1, s33, v1
    v_min_u32 v2, L_exit-L_pcw, v1
    global_load_dword v240, v2, s[44:45]
    v_add_u32 v1, 8192, v1
    v_min_u32 v2, L_exit-L_pcw, v1
    global_load_dword v241, v2, s[44:45]
    v_add_u32 v1, 8192, v1
    s_cbranch_scc0 L_nowarm
    v_min_u32 v2, L_exit-L_pcw, v1
    global_load_dword v242, v2, s[44:45]
    v_add_u32 v1, 8192, v1
    v_min_u32 v2, L_exit-L_pcw, v1
    global_load_dword v243, v2, s[44:45]
    v_add_u32 v1, 8192, v1
    v_min_u32 v2, L_exit-L_pcw, v1
    global_load_dword v244, v2, s[44:45]
    v_add_u32 v1, 8192, v1
L_nowarm:
    s_waitcnt lgkmcnt(0)
    s_mov_b32 s4, s86
    s_mov_b32 s5, s87
    s_mov_b32 s6, 268435456
    s_mov_b32 s7, 0x20000
    s_mov_b32 s96, s84
    s_mov_b32 s97, s85
    s_mov_b32 s98, 256
    s_mov_b32 s99, 0x20000
    s_mov_b32 s95, 0
    s_cmp_lg_u32 s3, 0
    s_cbranch_scc1 L_helper
    s_mov_b32 s37, 128
    v_mov_b32 v250, 1
    v_mov_b32 v251, 163832
    v_cmp_eq_u32 vcc, 0, v0
    s_nop 0
    s_and_saveexec_b64 s[38:39], vcc
    s_cbranch_execz tk1m
    buffer_atomic_add v250, off, s[96:99], s37 sc0
tk1m:
    s_mov_b64 s[38:39], exec
    s_mov_b64 exec, -1
    v_lshrrev_b32 v54, 6, v0
    s_nop 0
    v_readfirstlane_b32 s13, v54
    v_and_b32 v57, 63, v0
    v_bfe_u32 v54, v57, 2, 1
    v_lshlrev_b32 v48, 13, v54
    v_bfe_u32 v54, v57, 3, 1
    v_lshl_add_u32 v48, v54, 15, v48
    v_bfe_u32 v54, v57, 4, 1
    v_lshl_add_u32 v48, v54, 14, v48
    v_bfe_u32 v54, v57, 5, 1
    v_lshl_add_u32 v48, v54, 16, v48
    v_lshrrev_b32 v55, 4, v57
    v_and_b32 v55, 2, v55
    v_xor_b32 v55, v55, v57
    v_and_b32 v55, 3, v55
    v_lshl_add_u32 v48, v55, 4, v48
    v_bfe_u32 v54, v57, 2, 1
    v_lshlrev_b32 v51, 6, v54
    v_bfe_u32 v54, v57, 3, 1
    v_lshl_add_u32 v51, v54, 9, v51
    v_bfe_u32 v54, v57, 4, 1
    v_lshl_add_u32 v51, v54, 7, v51
    v_bfe_u32 v54, v57, 5, 1
    v_lshl_add_u32 v51, v54, 12, v51
    v_bfe_u32 v54, v57, 0, 1
    v_lshl_add_u32 v51, v54, 3, v51
    v_bfe_u32 v54, v57, 1, 1
    v_lshl_add_u32 v51, v54, 4, v51
    v_bfe_u32 v54, v57, 3, 1
    v_lshl_add_u32 v51, v54, 5, v51
    v_lshrrev_b32 v55, 3, v57
    v_mul_u32_u24 v49, 1152, v55
    v_and_b32 v55, 7, v57
    v_lshl_add_u32 v49, v55, 4, v49
    v_bfe_u32 v54, v57, 4, 1
    v_lshlrev_b32 v52, 13, v54
    v_bfe_u32 v54, v57, 5, 1
    v_lshl_add_u32 v52, v54, 9, v52
    v_bfe_u32 v54, v57, 2, 1
    v_lshl_add_u32 v52, v54, 7, v52
    v_bfe_u32 v54, v57, 3, 1
    v_lshl_add_u32 v52, v54, 5, v52
    v_and_b32 v55, 3, v57
    v_lshl_add_u32 v52, v55, 3, v52
    v_lshrrev_b32 v55, 2, v57
    v_mul_u32_u24 v50, 1152, v55
    v_and_b32 v55, 3, v57
    v_lshl_add_u32 v50, v55, 4, v50
    v_bfe_u32 v54, v57, 4, 1
    v_lshlrev_b32 v53, 12, v54
    v_bfe_u32 v54, v57, 5, 1
    v_lshl_add_u32 v53, v54, 8, v53
    v_bfe_u32 v54, v57, 2, 1
    v_lshl_add_u32 v53, v54, 6, v53
    v_bfe_u32 v54, v57, 3, 1
    v_lshl_add_u32 v53, v54, 5, v53
    v_and_b32 v55, 3, v57
    v_lshl_add_u32 v53, v55, 3, v53
    s_lshl_b32 s66, s13, 10
    s_and_b32 s93, s13, 1
    s_lshl_b32 s93, s93, 14
    s_and_b32 s75, s13, 2
    s_lshl_b32 s75, s75, 19
    v_add_u32 v51, s66, v51
    v_add_u32 v52, s66, v52
    v_add_u32 v53, s66, v53
    v_mov_b32 v58, v48
    s_mov_b32 s10, 4718592
    s_mov_b32 s11, 0x20000
    s_mov_b64 exec, s[38:39]
    s_cbranch_execz tk1
    s_waitcnt vmcnt(0)
    ds_write_b32 v251, v250
    s_waitcnt lgkmcnt(0)
tk1:
    s_mov_b64 exec, -1
    s_barrier
    ds_read_b32 v252, v251
    s_waitcnt lgkmcnt(0)
    v_readfirstlane_b32 s12, v252
    s_barrier
    s_nop 3
    s_cmp_ge_u32 s12, 32
    s_cbranch_scc1 L_helper
L_chain:
    s_mov_b64 s[48:49], s[50:51]
    s_mov_b64 s[50:51], s[52:53]
    s_mov_b64 s[52:53], s[54:55]
    s_mov_b64 s[54:55], s[56:57]
    s_mov_b64 s[56:57], s[58:59]
    s_lshl_b32 s67, s12, 8
    s_lshl_b32 s40, s13, 6
    s_add_u32 s67, s67, s40
    s_mul_i32 s92, s12, 147456
    s_lshr_b32 s73, s50, 8
    s_add_u32 s73, s73, s12
    s_and_b32 s73, s73, 31
    s_bitcmp1_b32 0xa2222222, s73
    s_cselect_b32 s88, 1, 0
    s_mov_b32 s72, 0
    s_add_u32 s73, s73, 1
    s_lshr_b32 s73, s73, 2
    s_xor_b32 s94, s13, 0
    s_mul_i32 s94, s94, 36864
    s_add_u32 s94, s94, s92
    s_lshl_b32 s74, s13, 7
    s_add_u32 s94, s94, s74
    s_add_u32 s78, s94, 0
    s_mov_b64 s[8:9], s[56:57]
    v_mov_b32 v58, v49
    s_mov_b32 s79, 9216
    s_mov_b32 s81, 0
    s_add_u32 s80, s66, 114688
    s_mov_b32 s76, 0
    s_mov_b32 s77, 8192
    s_call_b64 s[82:83], cf_dma
    s_mov_b32 s77, 16384
    s_call_b64 s[82:83], cf_dma
    s_xor_b32 s94, s13, 1
    s_mul_i32 s94, s94, 36864
    s_add_u32 s94, s94, s92
    s_lshl_b32 s74, s13, 7
    s_add_u32 s94, s94, s74
    s_add_u32 s78, s94, 0
    s_add_u32 s80, s66, 81920
    s_mov_b32 s76, 0
    s_mov_b32 s77, 8192
    s_call_b64 s[82:83], cf_dma
    s_mov_b32 s77, 16384
    s_call_b64 s[82:83], cf_dma
    s_xor_b32 s94, s13, 2
    s_mul_i32 s94, s94, 36864
    s_add_u32 s94, s94, s92
    s_lshl_b32 s74, s13, 7
    s_add_u32 s94, s94, s74
    s_add_u32 s78, s94, 0
    s_add_u32 s80, s66, 16384
    s_mov_b32 s76, 0
    s_mov_b32 s77, 8192
    s_call_b64 s[82:83], cf_dma
    s_mov_b32 s77, 16384
    s_call_b64 s[82:83], cf_dma
    s_xor_b32 s94, s13, 3
    s_mul_i32 s94, s94, 36864
    s_add_u32 s94, s94, s92
    s_lshl_b32 s74, s13, 7
    s_add_u32 s94, s94, s74
    s_add_u32 s78, s94, 0
    s_add_u32 s80, s66, 0
    s_mov_b32 s76, 0
    s_mov_b32 s77, 8192
    s_call_b64 s[82:83], cf_dma
    s_mov_b32 s77, 16384
    s_call_b64 s[82:83], cf_dma
    v_lshrrev_b32 v24, 6, v0
    v_lshlrev_b32 v61, 4, v0
    v_add_u32 v62, 57344, v61
    v_xor_b32 v63, 1024, v61
    v_add_u32 v63, 98304, v63
    v_xor_b32 v64, 2048, v61
    v_add_u32 v64, 98304, v64
    v_and_b32 v65, 1023, v61
    v_add_u32 v65, 98304, v65
    v_and_b32 v26, 15, v0
    v_bfe_u32 v27, v0, 4, 2
    v_mov_b32 v60, 0x4444
    v_mov_b32 v25, 0xeeee
    v_cmp_lt_u32 vcc, 7, v26
    s_nop 1
    v_cndmask_b32 v60, v60, v25, vcc
    s_nop 1
    v_and_b32 v67, 12, v26
    v_lshlrev_b32 v67, 3, v67
    v_and_b32 v25, 1, v26
    v_lshl_add_u32 v67, v25, 4, v67
    v_bfe_u32 v25, v26, 1, 1
    v_lshl_add_u32 v67, v25, 3, v67
    v_lshl_add_u32 v66, v27, 14, v67
    v_lshl_add_u32 v66, v24, 17, v66
    s_nop 1
    v_and_b32 v67, 63, v67
    v_lshrrev_b32 v25, 1, v24
    v_lshl_add_u32 v67, v25, 18, v67
    v_lshl_add_u32 v67, v27, 16, v67
    v_lshrrev_b32 v25, 3, v26
    v_lshl_add_u32 v67, v25, 15, v67
    v_and_b32 v25, 1, v24
    v_lshl_add_u32 v67, v25, 6, v67
    s_nop 1
    s_waitcnt vmcnt(12)
    v_add_u32 v55, 114688, v52
    ds_read_b64_tr_b16 v[160:161], v55 offset:0
    ds_read_b64_tr_b16 v[162:163], v55 offset:256
    ds_read_b64_tr_b16 v[164:165], v55 offset:4096
    ds_read_b64_tr_b16 v[166:167], v55 offset:4352
    s_xor_b32 s94, s13, 0
    s_mul_i32 s94, s94, 36864
    s_add_u32 s94, s94, s92
    s_lshl_b32 s74, s13, 7
    s_add_u32 s94, s94, s74
    s_add_u32 s78, s94, 512
    s_add_u32 s80, s66, 147456
    s_mov_b32 s76, 0
    s_mov_b32 s77, 8192
    s_call_b64 s[82:83], cf_dma
    ds_read_b64_tr_b16 v[192:193], v55 offset:64
    ds_read_b64_tr_b16 v[194:195], v55 offset:320
    ds_read_b64_tr_b16 v[196:197], v55 offset:4160
    ds_read_b64_tr_b16 v[198:199], v55 offset:4416
    s_mov_b32 s77, 16384
    s_call_b64 s[82:83], cf_dma
    v_and_b32 v25, 31, v0
    v_lshlrev_b32 v70, 4, v25
    v_lshlrev_b32 v28, 3, v25
    v_add_u32 v28, 108032, v28
    v_lshrrev_b32 v25, 1, v24
    v_lshl_add_u32 v70, v25, 9, v70
    v_and_b32 v25, 1, v24
    v_lshl_add_u32 v70, v25, 3, v70
    v_add_u32 v70, 109568, v70
    v_cmp_gt_u32 vcc, 2, v27
    s_nop 1
    v_cndmask_b32 v70, v70, v28, vcc
    s_nop 1
    s_waitcnt lgkmcnt(0)
    s_waitcnt vmcnt(12)
    v_add_u32 v55, 81920, v52
    ds_read_b64_tr_b16 v[168:169], v55 offset:0
    ds_read_b64_tr_b16 v[170:171], v55 offset:256
    ds_read_b64_tr_b16 v[172:173], v55 offset:4096
    ds_read_b64_tr_b16 v[174:175], v55 offset:4352
    s_xor_b32 s94, s13, 1
    s_mul_i32 s94, s94, 36864
    s_add_u32 s94, s94, s92
    s_lshl_b32 s74, s13, 7
    s_add_u32 s94, s94, s74
    s_add_u32 s78, s94, 512
    s_add_u32 s80, s66, 98304
    s_mov_b32 s76, 0
    s_mov_b32 s77, 8192
    s_call_b64 s[82:83], cf_dma
    ds_read_b64_tr_b16 v[200:201], v55 offset:64
    ds_read_b64_tr_b16 v[202:203], v55 offset:320
    ds_read_b64_tr_b16 v[204:205], v55 offset:4160
    ds_read_b64_tr_b16 v[206:207], v55 offset:4416
    s_mov_b32 s77, 16384
    s_call_b64 s[82:83], cf_dma
    v_xor_b32 v71, 2048, v63
    v_lshrrev_b32 v68, 4, v0
    v_lshlrev_b32 v68, 7, v68
    v_and_b32 v25, 7, v26
    v_lshl_add_u32 v68, v25, 4, v68
    v_add_u32 v68, 102400, v68
    v_xor_b32 v74, 512, v68
    v_xor_b32 v75, 1024, v68
    v_xor_b32 v76, 1536, v68
    v_lshrrev_b32 v25, 3, v26
    v_lshl_add_u32 v77, v25, 3, v68
    v_or_b32 v78, 512, v65
    v_lshlrev_b32 v79, 2, v61
    v_mov_b64 v[72:73], 0
    v_and_b32 v25, 1, v27
    v_lshlrev_b32 v69, 7, v25
    v_lshrrev_b32 v25, 1, v27
    v_lshl_add_u32 v69, v25, 3, v69
    v_and_b32 v25, 3, v26
    v_lshl_add_u32 v69, v25, 4, v69
    v_bfe_u32 v25, v26, 2, 1
    v_lshl_add_u32 v69, v25, 2, v69
    s_nop 1
    s_waitcnt lgkmcnt(0)
    s_waitcnt vmcnt(12)
    v_add_u32 v55, 16384, v52
    ds_read_b64_tr_b16 v[176:177], v55 offset:0
    ds_read_b64_tr_b16 v[178:179], v55 offset:256
    ds_read_b64_tr_b16 v[180:181], v55 offset:4096
    ds_read_b64_tr_b16 v[182:183], v55 offset:4352
    s_add_u32 s78, s67, 4194304
    s_mov_b64 s[8:9], s[54:55]
    v_mov_b32 v58, v48
    s_mov_b32 s79, 131072
    s_add_u32 s80, s66, 32768
    s_mov_b32 s76, 0
    s_mov_b32 s77, 8192
    s_call_b64 s[82:83], cf_dma
    ds_read_b64_tr_b16 v[208:209], v55 offset:64
    ds_read_b64_tr_b16 v[210:211], v55 offset:320
    ds_read_b64_tr_b16 v[212:213], v55 offset:4160
    ds_read_b64_tr_b16 v[214:215], v55 offset:4416
    s_mov_b32 s77, 16384
    s_call_b64 s[82:83], cf_dma
    s_mov_b32 s32, 0x00ff00ff
    s_mov_b32 s33, 0x00ff00ff
    s_not_b64 s[34:35], s[32:33]
    s_lshr_b32 s31, s12, 1
    s_lshl_b32 s31, s31, 8
    s_and_b32 s40, s12, 1
    s_lshl_b32 s40, s40, 6
    s_add_u32 s31, s31, s40
    s_and_b32 s40, s13, 1
    s_lshl_b32 s40, s40, 12
    s_add_u32 s31, s31, s40
    s_lshl_b32 s19, s12, 14
    s_add_u32 s19, s19, 67076096
    s_add_u32 s41, s19, 8192
    s_add_u32 s19, s19, s40
    s_and_b32 s40, s12, 1
    s_lshl_b32 s40, s40, 2
    s_or_b32 s40, s40, s13
    s_cmp_eq_u32 s40, 5
    s_cselect_b32 s64, 0, s13
    s_cmp_lg_u32 s13, 1
    s_cbranch_scc1 cf_notx
    s_mov_b32 s32, 0xff
    s_mov_b32 s33, 0xff
    s_mov_b32 s19, s41
    s_lshr_b32 s31, s12, 3
    s_lshl_b32 s31, s31, 8
    s_and_b32 s40, s12, 2
    s_lshl_b32 s40, s40, 6
    s_add_u32 s31, s31, s40
    s_and_b32 s40, s12, 4
    s_lshl_b32 s40, s40, 4
    s_add_u32 s31, s31, s40
    s_add_u32 s31, s31, 8192
cf_notx:
    s_cmp_lg_u32 s13, 0
    s_cbranch_scc1 cf_notp
    s_min_u32 s40, s12, 23
    s_mul_i32 s40, s40, 384
    s_add_u32 s40, s40, 98304
    v_add_u32 v69, s40, v61
    v_mov_b32 v25, 108288
    v_cmp_lt_u32 vcc, 23, v0
    s_nop 1
    v_cndmask_b32 v69, v69, v25, vcc
cf_notp:
    s_nop 1
    s_waitcnt lgkmcnt(0)
    s_waitcnt vmcnt(12)
    v_add_u32 v55, 0, v52
    ds_read_b64_tr_b16 v[184:185], v55 offset:0
    ds_read_b64_tr_b16 v[186:187], v55 offset:256
    ds_read_b64_tr_b16 v[188:189], v55 offset:4096
    ds_read_b64_tr_b16 v[190:191], v55 offset:4352
    s_xor_b32 s78, s75, 0
    s_add_u32 s78, s78, s67
    s_mov_b32 s81, s93
    s_add_u32 s80, s66, 114688
    s_mov_b32 s76, 0
    s_mov_b32 s77, 8192
    s_call_b64 s[82:83], cf_dma
    ds_read_b64_tr_b16 v[216:217], v55 offset:64
    ds_read_b64_tr_b16 v[218:219], v55 offset:320
    ds_read_b64_tr_b16 v[220:221], v55 offset:4160
    ds_read_b64_tr_b16 v[222:223], v55 offset:4416
    s_mov_b32 s77, 16384
    s_call_b64 s[82:83], cf_dma
    v_mov_b32 v28, 1
    v_mov_b32 v29, 1
    v_mov_b32 v30, 1
    v_mov_b32 v31, 1
    s_lshl_b32 s40, s12, 14
    s_add_u32 s40, s40, 67174400
    s_add_u32 s41, s40, 0
    buffer_store_dwordx4 v[28:31], v61, s[4:7], s41 offen
    s_add_u32 s41, s40, 4096
    buffer_store_dwordx4 v[28:31], v61, s[4:7], s41 offen
    s_add_u32 s41, s40, 8192
    buffer_store_dwordx4 v[28:31], v61, s[4:7], s41 offen
    s_cmp_eq_u32 s64, 0
    s_cselect_b64 exec, 0, s[32:33]
    v_mov_b32 v27, -1
    s_add_u32 s41, s31, 67108864
    buffer_store_dword v27, v69, s[4:7], s41 offen
    s_add_u32 s41, s31, 67125248
    buffer_store_dword v27, v69, s[4:7], s41 offen
    s_add_u32 s41, s31, 67141632
    buffer_store_dword v27, v69, s[4:7], s41 offen
    s_add_u32 s41, s31, 67158016
    buffer_store_dword v27, v69, s[4:7], s41 offen
    s_mov_b64 exec, -1
    s_waitcnt lgkmcnt(0)
    s_waitcnt vmcnt(12)
    v_add_u32 v55, 147456, v52
    ds_read_b64_tr_b16 v[224:225], v55 offset:0
    ds_read_b64_tr_b16 v[226:227], v55 offset:256
    ds_read_b64_tr_b16 v[228:229], v55 offset:4096
    ds_read_b64_tr_b16 v[230:231], v55 offset:4352
    s_mov_b32 s77, 24576
    s_call_b64 s[82:83], cf_dma
    ds_read_b64_tr_b16 v[240:241], v55 offset:64
    ds_read_b64_tr_b16 v[242:243], v55 offset:320
    ds_read_b64_tr_b16 v[244:245], v55 offset:4160
    ds_read_b64_tr_b16 v[246:247], v55 offset:4416
    s_mov_b32 s77, 32768
    s_call_b64 s[82:83], cf_dma
    s_mov_b64 s[68:69], s[48:49]
    s_mov_b32 s70, 9216
    s_mov_b32 s71, 0x20000
    v_and_b32 v25, 7, v0
    v_mul_u32_u24 v25, 1152, v25
    v_lshrrev_b32 v26, 3, v0
    v_lshl_add_u32 v25, v26, 4, v25
    buffer_load_dwordx4 v[36:39], v25, s[68:71], 0 offen
    buffer_load_dwordx4 v[40:43], v25, s[68:71], 0 offen offset:512
    v_bfe_u32 v25, v0, 2, 3
    v_mul_u32_u24 v25, 1152, v25
    v_lshrrev_b32 v26, 5, v0
    v_lshl_add_u32 v25, v26, 4, v25
    v_and_b32 v26, 3, v0
    v_lshl_add_u32 v25, v26, 2, v25
    buffer_load_dword v44, v25, s[68:71], 0 offen offset:1024
    s_nop 0
    s_waitcnt lgkmcnt(0)
    s_waitcnt vmcnt(15)
    v_add_u32 v55, 98304, v52
    ds_read_b64_tr_b16 v[232:233], v55 offset:0
    ds_read_b64_tr_b16 v[234:235], v55 offset:256
    ds_read_b64_tr_b16 v[236:237], v55 offset:4096
    ds_read_b64_tr_b16 v[238:239], v55 offset:4352
    s_xor_b32 s78, s75, 1048576
    s_add_u32 s78, s78, s67
    s_add_u32 s80, s66, 65536
    s_mov_b32 s76, 0
    s_mov_b32 s77, 8192
    s_call_b64 s[82:83], cf_dma
    ds_read_b64_tr_b16 v[248:249], v55 offset:64
    ds_read_b64_tr_b16 v[250:251], v55 offset:320
    ds_read_b64_tr_b16 v[252:253], v55 offset:4160
    ds_read_b64_tr_b16 v[254:255], v55 offset:4416
    s_mov_b32 s77, 16384
    s_call_b64 s[82:83], cf_dma
    s_mov_b32 s44, 0x3e0293ee
    s_mov_b32 s45, s44
    s_mov_b32 s46, 0x42000000
    s_mov_b32 s60, 0x3f803f80
    s_mov_b32 s61, s60
    s_mov_b32 s62, 0x3e803e80
    s_mov_b32 s63, s62
    s_mov_b32 s28, 0
    s_lshl_b32 s58, s13, 10
    s_add_u32 s58, s58, 102400
    s_lshl_b32 s59, s13, 8
    s_add_u32 s59, s59, 106496
    s_lshl_b32 s24, s12, 14
    s_add_u32 s24, s24, 0
    s_add_u32 s47, s24, 33030144
    s_mul_i32 s40, s13, 3072
    s_add_u32 s23, s24, s40
    s_lshl_b32 s20, s12, 7
    s_add_u32 s20, s20, 67174400
    s_add_u32 s21, s20, 65536
    s_add_u32 s38, s20, 4096
    s_add_u32 s39, s21, 4096
    s_lshl_b32 s22, s12, 7
    s_add_u32 s22, s22, 67182592
    s_waitcnt lgkmcnt(0)
    s_waitcnt vmcnt(15)
    v_add_u32 v55, 32768, v51
    v_xor_b32 v56, 32, v55
    ds_read_b64_tr_b16 v[144:145], v55 offset:0
    ds_read_b64_tr_b16 v[146:147], v55 offset:256
    ds_read_b64_tr_b16 v[148:149], v55 offset:8192
    ds_read_b64_tr_b16 v[150:151], v55 offset:8448
    s_mov_b32 s77, 24576
    s_call_b64 s[82:83], cf_dma
    ds_read_b64_tr_b16 v[152:153], v56 offset:0
    ds_read_b64_tr_b16 v[154:155], v56 offset:256
    ds_read_b64_tr_b16 v[156:157], v56 offset:8192
    ds_read_b64_tr_b16 v[158:159], v56 offset:8448
    s_mov_b32 s77, 32768
    s_call_b64 s[82:83], cf_dma
    s_lshl_b32 s40, s12, 12
    s_add_u32 s25, s40, 79429632
    s_add_u32 s26, s40, 88866816
    s_lshl_b32 s65, s12, 9
    s_add_u32 s65, s65, 90177536
    s_lshl_b32 s40, s13, 5
    s_or_b32 s40, s40, s12
    s_cmp_lt_u32 s40, 24
    s_cselect_b32 s36, 0x1ffffff, 0
    s_mov_b32 s37, 0
    s_lshl_b32 s27, s12, 7
    s_add_u32 s27, s27, 125845504
    s_lshl_b32 s40, s13, 2
    s_add_u32 s27, s27, s40
    v_bfe_u32 v28, v61, 4, 4
    v_bfe_u32 v29, v61, 8, 1
    v_lshlrev_b32 v29, 2, v29
    v_sub_u32 v29, v28, v29
    v_mov_b32 v31, 0x3f80
    v_mov_b32 v32, 0x3f800000
    s_nop 1
    s_waitcnt lgkmcnt(0)
    s_waitcnt vmcnt(11)
    v_add_u32 v55, 114688, v51
    v_xor_b32 v56, 32, v55
    ds_read_b64_tr_b16 a[192:193], v55 offset:0
    ds_read_b64_tr_b16 a[194:195], v55 offset:256
    ds_read_b64_tr_b16 a[196:197], v55 offset:8192
    ds_read_b64_tr_b16 a[198:199], v55 offset:8448
    s_xor_b32 s78, s75, 2097152
    s_add_u32 s78, s78, s67
    s_add_u32 s80, s66, 0
    s_mov_b32 s76, 0
    s_mov_b32 s77, 8192
    s_call_b64 s[82:83], cf_dma
    ds_read_b64_tr_b16 a[200:201], v56 offset:0
    ds_read_b64_tr_b16 a[202:203], v56 offset:256
    ds_read_b64_tr_b16 a[204:205], v56 offset:8192
    ds_read_b64_tr_b16 a[206:207], v56 offset:8448
    s_mov_b32 s77, 16384
    s_call_b64 s[82:83], cf_dma
    v_cmp_eq_u32 vcc, 0, v29
    s_nop 1
    v_cndmask_b32 v16, 0, v31, vcc
    v_cmp_eq_u32 vcc, 1, v29
    s_nop 1
    v_cndmask_b32 v16, v16, v32, vcc
    v_cmp_eq_u32 vcc, 0, v28
    s_nop 1
    v_cndmask_b32 v20, 0, v31, vcc
    v_cmp_eq_u32 vcc, 1, v28
    s_nop 1
    v_cndmask_b32 v20, v20, v32, vcc
    s_nop 1
    s_waitcnt lgkmcnt(0)
    v_add_u32 v55, 131072, v51
    v_xor_b32 v56, 32, v55
    ds_read_b64_tr_b16 a[208:209], v55 offset:0
    ds_read_b64_tr_b16 a[210:211], v55 offset:256
    ds_read_b64_tr_b16 a[212:213], v55 offset:8192
    ds_read_b64_tr_b16 a[214:215], v55 offset:8448
    s_mov_b32 s77, 24576
    s_call_b64 s[82:83], cf_dma
    ds_read_b64_tr_b16 a[216:217], v56 offset:0
    ds_read_b64_tr_b16 a[218:219], v56 offset:256
    ds_read_b64_tr_b16 a[220:221], v56 offset:8192
    ds_read_b64_tr_b16 a[222:223], v56 offset:8448
    s_mov_b32 s77, 32768
    s_call_b64 s[82:83], cf_dma
    v_cmp_eq_u32 vcc, 2, v29
    s_nop 1
    v_cndmask_b32 v17, 0, v31, vcc
    v_cmp_eq_u32 vcc, 3, v29
    s_nop 1
    v_cndmask_b32 v17, v17, v32, vcc
    v_cmp_eq_u32 vcc, 2, v28
    s_nop 1
    v_cndmask_b32 v21, 0, v31, vcc
    v_cmp_eq_u32 vcc, 3, v28
    s_nop 1
    v_cndmask_b32 v21, v21, v32, vcc
    s_nop 1
    s_waitcnt lgkmcnt(0)
    s_waitcnt vmcnt(8)
    v_add_u32 v55, 65536, v51
    v_xor_b32 v56, 32, v55
    ds_read_b64_tr_b16 a[224:225], v55 offset:0
    ds_read_b64_tr_b16 a[226:227], v55 offset:256
    ds_read_b64_tr_b16 a[228:229], v55 offset:8192
    ds_read_b64_tr_b16 a[230:231], v55 offset:8448
    s_cmp_eq_u32 s88, 0
    s_cbranch_scc1 cf_cpe626
    s_lshl_b32 s89, s73, 7
    s_add_u32 s89, s89, 125853696
    v_min_u32 v33, 11, v57
    v_lshlrev_b32 v33, 2, v33
    buffer_load_dword v34, off, s[96:99], 0 offset:64 sc1
    buffer_load_dword v35, v33, s[4:7], s89 offen sc1
cf_cpe626:
    s_xor_b32 s78, s75, 3145728
    s_add_u32 s78, s78, s67
    s_add_u32 s80, s66, 32768
    s_mov_b32 s76, 0
    s_mov_b32 s77, 8192
    s_call_b64 s[82:83], cf_dma
    ds_read_b64_tr_b16 a[232:233], v56 offset:0
    ds_read_b64_tr_b16 a[234:235], v56 offset:256
    ds_read_b64_tr_b16 a[236:237], v56 offset:8192
    ds_read_b64_tr_b16 a[238:239], v56 offset:8448
    s_mov_b32 s77, 16384
    s_call_b64 s[82:83], cf_dma
    v_cmp_eq_u32 vcc, 8, v29
    s_nop 1
    v_cndmask_b32 v18, 0, v31, vcc
    v_cmp_eq_u32 vcc, 9, v29
    s_nop 1
    v_cndmask_b32 v18, v18, v32, vcc
    v_cmp_eq_u32 vcc, 4, v28
    s_nop 1
    v_cndmask_b32 v22, 0, v31, vcc
    v_cmp_eq_u32 vcc, 5, v28
    s_nop 1
    v_cndmask_b32 v22, v22, v32, vcc
    s_nop 1
    s_waitcnt lgkmcnt(0)
    v_add_u32 v55, 81920, v51
    v_xor_b32 v56, 32, v55
    ds_read_b64_tr_b16 a[240:241], v55 offset:0
    ds_read_b64_tr_b16 a[242:243], v55 offset:256
    ds_read_b64_tr_b16 a[244:245], v55 offset:8192
    ds_read_b64_tr_b16 a[246:247], v55 offset:8448
    s_mov_b32 s77, 24576
    s_call_b64 s[82:83], cf_dma
    ds_read_b64_tr_b16 a[248:249], v56 offset:0
    ds_read_b64_tr_b16 a[250:251], v56 offset:256
    ds_read_b64_tr_b16 a[252:253], v56 offset:8192
    ds_read_b64_tr_b16 a[254:255], v56 offset:8448
    s_mov_b32 s77, 32768
    s_call_b64 s[82:83], cf_dma
    v_cmp_eq_u32 vcc, 10, v29
    s_nop 1
    v_cndmask_b32 v19, 0, v31, vcc
    v_cmp_eq_u32 vcc, 11, v29
    s_nop 1
    v_cndmask_b32 v19, v19, v32, vcc
    v_cmp_eq_u32 vcc, 6, v28
    s_nop 1
    v_cndmask_b32 v23, 0, v31, vcc
    v_cmp_eq_u32 vcc, 7, v28
    s_nop 1
    v_cndmask_b32 v23, v23, v32, vcc
    s_nop 1
    s_waitcnt lgkmcnt(0)
    s_waitcnt vmcnt(8)
    v_add_u32 v55, 0, v51
    v_xor_b32 v56, 32, v55
    ds_read_b64_tr_b16 v[80:81], v55 offset:0
    ds_read_b64_tr_b16 v[82:83], v55 offset:256
    ds_read_b64_tr_b16 v[84:85], v55 offset:8192
    ds_read_b64_tr_b16 v[86:87], v55 offset:8448
    s_cmp_eq_u32 s88, 0
    s_cbranch_scc1 cf_ncp696
    s_waitcnt vmcnt(8)
    v_max_u32 v34, 1, v34
    v_cmp_eq_u32 vcc, 1, v34
    s_cbranch_vccnz cf_ncp696
    v_cmp_ne_u32 vcc, v34, v35
    s_cbranch_vccnz cf_ncp696
    s_mov_b32 s88, 0
    s_mov_b32 s72, 5
    s_lshl_b32 s74, s73, 19
    s_add_u32 s74, s74, 96468992
    s_add_u32 s50, s4, s74
    s_addc_u32 s51, s5, 0
    s_add_u32 s52, s50, 147456
    s_addc_u32 s53, s51, 0
    s_lshl_b32 s67, s13, 6
    v_and_b32 v54, 63, v48
    v_lshrrev_b32 v48, 13, v48
    v_lshl_add_u32 v48, v48, 8, v54
cf_ncp696:
    s_cmp_eq_u32 s88, 0
    s_cbranch_scc1 cf_cpe717
    s_lshl_b32 s89, s73, 7
    s_add_u32 s89, s89, 125853696
    v_min_u32 v33, 11, v57
    v_lshlrev_b32 v33, 2, v33
    buffer_load_dword v34, off, s[96:99], 0 offset:64 sc1
    buffer_load_dword v35, v33, s[4:7], s89 offen sc1
cf_cpe717:
    s_xor_b32 s78, s75, 2097152
    s_lshr_b32 s78, s78, s72
    s_add_u32 s78, s78, s67
    s_mov_b64 s[8:9], s[52:53]
    v_mov_b32 v58, v48
    s_lshr_b32 s79, 131072, s72
    s_add_u32 s80, s66, 131072
    s_mov_b32 s76, 0
    s_mov_b32 s77, 8192
    s_call_b64 s[82:83], cf_dma
    ds_read_b64_tr_b16 v[88:89], v56 offset:0
    ds_read_b64_tr_b16 v[90:91], v56 offset:256
    ds_read_b64_tr_b16 v[92:93], v56 offset:8192
    ds_read_b64_tr_b16 v[94:95], v56 offset:8448
    s_mov_b32 s77, 16384
    s_call_b64 s[82:83], cf_dma
    v_mov_b32 v46, 1
    s_mov_b64 exec, 1
    buffer_atomic_add v46, off, s[96:99], 0 offset:132 sc0
    s_mov_b64 exec, -1
    s_waitcnt lgkmcnt(0)
    v_add_u32 v55, 16384, v51
    v_xor_b32 v56, 32, v55
    ds_read_b64_tr_b16 v[96:97], v55 offset:0
    ds_read_b64_tr_b16 v[98:99], v55 offset:256
    ds_read_b64_tr_b16 v[100:101], v55 offset:8192
    ds_read_b64_tr_b16 v[102:103], v55 offset:8448
    s_mov_b32 s77, 24576
    s_call_b64 s[82:83], cf_dma
    ds_read_b64_tr_b16 v[104:105], v56 offset:0
    ds_read_b64_tr_b16 v[106:107], v56 offset:256
    ds_read_b64_tr_b16 v[108:109], v56 offset:8192
    ds_read_b64_tr_b16 v[110:111], v56 offset:8448
    s_mov_b32 s77, 32768
    s_call_b64 s[82:83], cf_dma
    s_waitcnt lgkmcnt(0)
    s_waitcnt vmcnt(9)
    v_add_u32 v55, 32768, v51
    v_xor_b32 v56, 32, v55
    ds_read_b64_tr_b16 v[112:113], v55 offset:0
    ds_read_b64_tr_b16 v[114:115], v55 offset:256
    ds_read_b64_tr_b16 v[116:117], v55 offset:8192
    ds_read_b64_tr_b16 v[118:119], v55 offset:8448
    s_cmp_eq_u32 s88, 0
    s_cbranch_scc1 cf_ncp769
    s_waitcnt vmcnt(9)
    v_max_u32 v34, 1, v34
    v_cmp_eq_u32 vcc, 1, v34
    s_cbranch_vccnz cf_ncp769
    v_cmp_ne_u32 vcc, v34, v35
    s_cbranch_vccnz cf_ncp769
    s_mov_b32 s88, 0
    s_mov_b32 s72, 5
    s_lshl_b32 s74, s73, 19
    s_add_u32 s74, s74, 96468992
    s_add_u32 s50, s4, s74
    s_addc_u32 s51, s5, 0
    s_add_u32 s52, s50, 147456
    s_addc_u32 s53, s51, 0
    s_lshl_b32 s67, s13, 6
    v_and_b32 v54, 63, v48
    v_lshrrev_b32 v48, 13, v48
    v_lshl_add_u32 v48, v48, 8, v54
cf_ncp769:
    s_cmp_eq_u32 s88, 0
    s_cbranch_scc1 cf_cpe790
    s_lshl_b32 s89, s73, 7
    s_add_u32 s89, s89, 125853696
    v_min_u32 v33, 11, v57
    v_lshlrev_b32 v33, 2, v33
    buffer_load_dword v34, off, s[96:99], 0 offset:64 sc1
    buffer_load_dword v35, v33, s[4:7], s89 offen sc1
cf_cpe790:
    s_xor_b32 s78, s75, 3145728
    s_lshr_b32 s78, s78, s72
    s_add_u32 s78, s78, s67
    s_mov_b64 s[8:9], s[52:53]
    v_mov_b32 v58, v48
    s_lshr_b32 s79, 131072, s72
    s_add_u32 s80, s66, 65536
    s_mov_b32 s76, 0
    s_mov_b32 s77, 8192
    s_call_b64 s[82:83], cf_dma
    ds_read_b64_tr_b16 v[120:121], v56 offset:0
    ds_read_b64_tr_b16 v[122:123], v56 offset:256
    ds_read_b64_tr_b16 v[124:125], v56 offset:8192
    ds_read_b64_tr_b16 v[126:127], v56 offset:8448
    s_mov_b32 s77, 16384
    s_call_b64 s[82:83], cf_dma
    s_waitcnt lgkmcnt(0)
    v_add_u32 v55, 49152, v51
    v_xor_b32 v56, 32, v55
    ds_read_b64_tr_b16 v[128:129], v55 offset:0
    ds_read_b64_tr_b16 v[130:131], v55 offset:256
    ds_read_b64_tr_b16 v[132:133], v55 offset:8192
    ds_read_b64_tr_b16 v[134:135], v55 offset:8448
    s_mov_b32 s77, 24576
    s_call_b64 s[82:83], cf_dma
    ds_read_b64_tr_b16 v[136:137], v56 offset:0
    ds_read_b64_tr_b16 v[138:139], v56 offset:256
    ds_read_b64_tr_b16 v[140:141], v56 offset:8192
    ds_read_b64_tr_b16 v[142:143], v56 offset:8448
    s_mov_b32 s77, 32768
    s_call_b64 s[82:83], cf_dma
    s_waitcnt lgkmcnt(0)
    s_waitcnt vmcnt(8)
    v_add_u32 v55, 131072, v51
    v_xor_b32 v56, 32, v55
    ds_read_b64_tr_b16 a[128:129], v55 offset:0
    ds_read_b64_tr_b16 a[130:131], v55 offset:256
    ds_read_b64_tr_b16 a[132:133], v55 offset:8192
    ds_read_b64_tr_b16 a[134:135], v55 offset:8448
    s_cmp_eq_u32 s88, 0
    s_cbranch_scc1 cf_ncp838
    s_waitcnt vmcnt(8)
    v_max_u32 v34, 1, v34
    v_cmp_eq_u32 vcc, 1, v34
    s_cbranch_vccnz cf_ncp838
    v_cmp_ne_u32 vcc, v34, v35
    s_cbranch_vccnz cf_ncp838
    s_mov_b32 s88, 0
    s_mov_b32 s72, 5
    s_lshl_b32 s74, s73, 19
    s_add_u32 s74, s74, 96468992
    s_add_u32 s50, s4, s74
    s_addc_u32 s51, s5, 0
    s_add_u32 s52, s50, 147456
    s_addc_u32 s53, s51, 0
    s_lshl_b32 s67, s13, 6
    v_and_b32 v54, 63, v48
    v_lshrrev_b32 v48, 13, v48
    v_lshl_add_u32 v48, v48, 8, v54
cf_ncp838:
    s_cmp_eq_u32 s88, 0
    s_cbranch_scc1 cf_cpe859
    s_lshl_b32 s89, s73, 7
    s_add_u32 s89, s89, 125853696
    v_min_u32 v33, 11, v57
    v_lshlrev_b32 v33, 2, v33
    buffer_load_dword v34, off, s[96:99], 0 offset:64 sc1
    buffer_load_dword v35, v33, s[4:7], s89 offen sc1
cf_cpe859:
    s_xor_b32 s78, s75, 2097152
    s_lshr_b32 s78, s78, s72
    s_add_u32 s78, s78, s67
    s_mov_b64 s[8:9], s[50:51]
    v_mov_b32 v58, v48
    s_lshr_b32 s79, 131072, s72
    s_add_u32 s80, s66, 0
    s_mov_b32 s76, 0
    s_mov_b32 s77, 8192
    s_call_b64 s[82:83], cf_dma
    ds_read_b64_tr_b16 a[136:137], v56 offset:0
    ds_read_b64_tr_b16 a[138:139], v56 offset:256
    ds_read_b64_tr_b16 a[140:141], v56 offset:8192
    ds_read_b64_tr_b16 a[142:143], v56 offset:8448
    s_mov_b32 s77, 16384
    s_call_b64 s[82:83], cf_dma
    s_waitcnt lgkmcnt(0)
    v_add_u32 v55, 147456, v51
    v_xor_b32 v56, 32, v55
    ds_read_b64_tr_b16 a[144:145], v55 offset:0
    ds_read_b64_tr_b16 a[146:147], v55 offset:256
    ds_read_b64_tr_b16 a[148:149], v55 offset:8192
    ds_read_b64_tr_b16 a[150:151], v55 offset:8448
    s_mov_b32 s77, 24576
    s_call_b64 s[82:83], cf_dma
    ds_read_b64_tr_b16 a[152:153], v56 offset:0
    ds_read_b64_tr_b16 a[154:155], v56 offset:256
    ds_read_b64_tr_b16 a[156:157], v56 offset:8192
    ds_read_b64_tr_b16 a[158:159], v56 offset:8448
    s_mov_b32 s77, 32768
    s_call_b64 s[82:83], cf_dma
    s_waitcnt lgkmcnt(0)
    s_waitcnt vmcnt(8)
    v_add_u32 v55, 65536, v51
    v_xor_b32 v56, 32, v55
    ds_read_b64_tr_b16 a[160:161], v55 offset:0
    ds_read_b64_tr_b16 a[162:163], v55 offset:256
    ds_read_b64_tr_b16 a[164:165], v55 offset:8192
    ds_read_b64_tr_b16 a[166:167], v55 offset:8448
    s_cmp_eq_u32 s88, 0
    s_cbranch_scc1 cf_ncp907
    s_waitcnt vmcnt(8)
    v_max_u32 v34, 1, v34
    v_cmp_eq_u32 vcc, 1, v34
    s_cbranch_vccnz cf_ncp907
    v_cmp_ne_u32 vcc, v34, v35
    s_cbranch_vccnz cf_ncp907
    s_mov_b32 s88, 0
    s_mov_b32 s72, 5
    s_lshl_b32 s74, s73, 19
    s_add_u32 s74, s74, 96468992
    s_add_u32 s50, s4, s74
    s_addc_u32 s51, s5, 0
    s_add_u32 s52, s50, 147456
    s_addc_u32 s53, s51, 0
    s_lshl_b32 s67, s13, 6
    v_and_b32 v54, 63, v48
    v_lshrrev_b32 v48, 13, v48
    v_lshl_add_u32 v48, v48, 8, v54
cf_ncp907:
    s_cmp_eq_u32 s88, 0
    s_cbranch_scc1 cf_cpe928
    s_lshl_b32 s89, s73, 7
    s_add_u32 s89, s89, 125853696
    v_min_u32 v33, 11, v57
    v_lshlrev_b32 v33, 2, v33
    buffer_load_dword v34, off, s[96:99], 0 offset:64 sc1
    buffer_load_dword v35, v33, s[4:7], s89 offen sc1
cf_cpe928:
    s_xor_b32 s78, s75, 3145728
    s_lshr_b32 s78, s78, s72
    s_add_u32 s78, s78, s67
    s_mov_b64 s[8:9], s[50:51]
    v_mov_b32 v58, v48
    s_lshr_b32 s79, 131072, s72
    s_add_u32 s80, s66, 32768
    s_mov_b32 s76, 0
    s_mov_b32 s77, 8192
    s_call_b64 s[82:83], cf_dma
    ds_read_b64_tr_b16 a[168:169], v56 offset:0
    ds_read_b64_tr_b16 a[170:171], v56 offset:256
    ds_read_b64_tr_b16 a[172:173], v56 offset:8192
    ds_read_b64_tr_b16 a[174:175], v56 offset:8448
    s_mov_b32 s77, 16384
    s_call_b64 s[82:83], cf_dma
    v_readfirstlane_b32 s41, v46
    v_mov_b32 v46, 1
    v_mov_b32 v47, 0
    s_cmp_eq_u32 s41, 127
    s_cselect_b64 exec, 1, 0
    buffer_atomic_cmpswap v[46:47], off, s[96:99], 0 offset:140
    s_mov_b64 exec, -1
    s_waitcnt lgkmcnt(0)
    v_add_u32 v55, 81920, v51
    v_xor_b32 v56, 32, v55
    ds_read_b64_tr_b16 a[176:177], v55 offset:0
    ds_read_b64_tr_b16 a[178:179], v55 offset:256
    ds_read_b64_tr_b16 a[180:181], v55 offset:8192
    ds_read_b64_tr_b16 a[182:183], v55 offset:8448
    s_mov_b32 s77, 24576
    s_call_b64 s[82:83], cf_dma
    ds_read_b64_tr_b16 a[184:185], v56 offset:0
    ds_read_b64_tr_b16 a[186:187], v56 offset:256
    ds_read_b64_tr_b16 a[188:189], v56 offset:8192
    ds_read_b64_tr_b16 a[190:191], v56 offset:8448
    s_mov_b32 s77, 32768
    s_call_b64 s[82:83], cf_dma
    s_waitcnt lgkmcnt(0)
    s_waitcnt vmcnt(8)
    v_add_u32 v55, 0, v51
    v_xor_b32 v56, 32, v55
    ds_read_b64_tr_b16 a[48:49], v55 offset:0
    ds_read_b64_tr_b16 a[50:51], v55 offset:256
    ds_read_b64_tr_b16 a[52:53], v55 offset:8192
    ds_read_b64_tr_b16 a[54:55], v55 offset:8448
    s_lshr_b32 s78, 4194304, s72
    s_add_u32 s78, s78, s67
    s_mov_b32 s81, 0
    s_add_u32 s80, s66, 98304
    s_mov_b32 s76, 0
    s_mov_b32 s77, 8192
    s_call_b64 s[82:83], cf_dma
    ds_read_b64_tr_b16 a[56:57], v56 offset:0
    ds_read_b64_tr_b16 a[58:59], v56 offset:256
    ds_read_b64_tr_b16 a[60:61], v56 offset:8192
    ds_read_b64_tr_b16 a[62:63], v56 offset:8448
    s_mov_b32 s77, 16384
    s_call_b64 s[82:83], cf_dma
    s_waitcnt lgkmcnt(0)
    v_add_u32 v55, 16384, v51
    v_xor_b32 v56, 32, v55
    ds_read_b64_tr_b16 a[64:65], v55 offset:0
    ds_read_b64_tr_b16 a[66:67], v55 offset:256
    ds_read_b64_tr_b16 a[68:69], v55 offset:8192
    ds_read_b64_tr_b16 a[70:71], v55 offset:8448
    s_cmp_eq_u32 s88, 0
    s_cbranch_scc1 cf_ncp1003
    s_waitcnt vmcnt(12)
    v_max_u32 v34, 1, v34
    v_cmp_eq_u32 vcc, 1, v34
    s_cbranch_vccnz cf_ncp1003
    v_cmp_ne_u32 vcc, v34, v35
    s_cbranch_vccnz cf_ncp1003
    s_mov_b32 s88, 0
    s_mov_b32 s72, 5
    s_lshl_b32 s74, s73, 19
    s_add_u32 s74, s74, 96468992
    s_add_u32 s50, s4, s74
    s_addc_u32 s51, s5, 0
    s_add_u32 s52, s50, 147456
    s_addc_u32 s53, s51, 0
    s_lshl_b32 s67, s13, 6
    v_and_b32 v54, 63, v48
    v_lshrrev_b32 v48, 13, v48
    v_lshl_add_u32 v48, v48, 8, v54
cf_ncp1003:
    s_xor_b32 s78, s75, 1048576
    s_lshr_b32 s78, s78, s72
    s_add_u32 s78, s78, s67
    s_mov_b64 s[8:9], s[50:51]
    v_mov_b32 v58, v48
    s_lshr_b32 s79, 131072, s72
    s_mov_b32 s81, s93
    s_add_u32 s80, s66, 114688
    s_mov_b32 s76, 0
    s_mov_b32 s77, 8192
    s_call_b64 s[82:83], cf_dma
    ds_read_b64_tr_b16 a[72:73], v56 offset:0
    ds_read_b64_tr_b16 a[74:75], v56 offset:256
    ds_read_b64_tr_b16 a[76:77], v56 offset:8192
    ds_read_b64_tr_b16 a[78:79], v56 offset:8448
    s_mov_b32 s77, 16384
    s_call_b64 s[82:83], cf_dma
    s_waitcnt lgkmcnt(0)
    s_waitcnt vmcnt(8)
    v_add_u32 v55, 32768, v51
    v_xor_b32 v56, 32, v55
    ds_read_b64_tr_b16 a[80:81], v55 offset:0
    ds_read_b64_tr_b16 a[82:83], v55 offset:256
    ds_read_b64_tr_b16 a[84:85], v55 offset:8192
    ds_read_b64_tr_b16 a[86:87], v55 offset:8448
    s_mov_b32 s77, 24576
    s_call_b64 s[82:83], cf_dma
    ds_read_b64_tr_b16 a[88:89], v56 offset:0
    ds_read_b64_tr_b16 a[90:91], v56 offset:256
    ds_read_b64_tr_b16 a[92:93], v56 offset:8192
    ds_read_b64_tr_b16 a[94:95], v56 offset:8448
    s_mov_b32 s77, 32768
    s_call_b64 s[82:83], cf_dma
    s_waitcnt lgkmcnt(0)
    v_add_u32 v55, 49152, v51
    v_xor_b32 v56, 32, v55
    ds_read_b64_tr_b16 a[96:97], v55 offset:0
    ds_read_b64_tr_b16 a[98:99], v55 offset:256
    ds_read_b64_tr_b16 a[100:101], v55 offset:8192
    ds_read_b64_tr_b16 a[102:103], v55 offset:8448
    s_xor_b32 s78, s75, 0
    s_lshr_b32 s78, s78, s72
    s_add_u32 s78, s78, s67
    s_add_u32 s80, s66, 65536
    s_mov_b32 s76, 0
    s_mov_b32 s77, 8192
    s_call_b64 s[82:83], cf_dma
    ds_read_b64_tr_b16 a[104:105], v56 offset:0
    ds_read_b64_tr_b16 a[106:107], v56 offset:256
    ds_read_b64_tr_b16 a[108:109], v56 offset:8192
    ds_read_b64_tr_b16 a[110:111], v56 offset:8448
    s_mov_b32 s77, 16384
    s_call_b64 s[82:83], cf_dma
    s_waitcnt lgkmcnt(0)
    s_waitcnt vmcnt(12)
    v_add_u32 v55, 98304, v51
    v_xor_b32 v56, 32, v55
    ds_read_b64_tr_b16 a[112:113], v55 offset:0
    ds_read_b64_tr_b16 a[114:115], v55 offset:256
    ds_read_b64_tr_b16 a[116:117], v55 offset:8192
    ds_read_b64_tr_b16 a[118:119], v55 offset:8448
    s_mov_b32 s77, 24576
    s_call_b64 s[82:83], cf_dma
    ds_read_b64_tr_b16 a[120:121], v56 offset:0
    ds_read_b64_tr_b16 a[122:123], v56 offset:256
    ds_read_b64_tr_b16 a[124:125], v56 offset:8192
    ds_read_b64_tr_b16 a[126:127], v56 offset:8448
    s_mov_b32 s77, 32768
    s_call_b64 s[82:83], cf_dma
    s_waitcnt lgkmcnt(0)
    s_waitcnt vmcnt(8)
    v_add_u32 v55, 114688, v51
    v_xor_b32 v56, 32, v55
    ds_read_b64_tr_b16 a[16:17], v55 offset:0
    ds_read_b64_tr_b16 a[18:19], v55 offset:256
    ds_read_b64_tr_b16 a[20:21], v55 offset:8192
    ds_read_b64_tr_b16 a[22:23], v55 offset:8448
    s_xor_b32 s78, s75, 0
    s_lshr_b32 s78, s78, s72
    s_add_u32 s78, s78, s67
    s_mov_b64 s[8:9], s[52:53]
    s_add_u32 s80, s66, 0
    s_mov_b32 s76, 0
    s_mov_b32 s77, 8192
    s_call_b64 s[82:83], cf_dma
    ds_read_b64_tr_b16 a[24:25], v56 offset:0
    ds_read_b64_tr_b16 a[26:27], v56 offset:256
    ds_read_b64_tr_b16 a[28:29], v56 offset:8192
    ds_read_b64_tr_b16 a[30:31], v56 offset:8448
    s_mov_b32 s77, 16384
    s_call_b64 s[82:83], cf_dma
    s_waitcnt lgkmcnt(0)
    v_add_u32 v55, 131072, v51
    v_xor_b32 v56, 32, v55
    ds_read_b64_tr_b16 a[32:33], v55 offset:0
    ds_read_b64_tr_b16 a[34:35], v55 offset:256
    ds_read_b64_tr_b16 a[36:37], v55 offset:8192
    ds_read_b64_tr_b16 a[38:39], v55 offset:8448
    s_mov_b32 s77, 24576
    s_call_b64 s[82:83], cf_dma
    ds_read_b64_tr_b16 a[40:41], v56 offset:0
    ds_read_b64_tr_b16 a[42:43], v56 offset:256
    ds_read_b64_tr_b16 a[44:45], v56 offset:8192
    ds_read_b64_tr_b16 a[46:47], v56 offset:8448
    s_mov_b32 s77, 32768
    s_call_b64 s[82:83], cf_dma
    s_waitcnt lgkmcnt(0)
    s_waitcnt vmcnt(8)
    v_add_u32 v55, 65536, v51
    v_xor_b32 v56, 32, v55
    ds_read_b64_tr_b16 v[0:1], v55 offset:0
    ds_read_b64_tr_b16 v[2:3], v55 offset:256
    ds_read_b64_tr_b16 v[4:5], v55 offset:8192
    ds_read_b64_tr_b16 v[6:7], v55 offset:8448
    s_xor_b32 s78, s75, 1048576
    s_lshr_b32 s78, s78, s72
    s_add_u32 s78, s78, s67
    s_add_u32 s80, s66, 32768
    s_mov_b32 s76, 0
    s_mov_b32 s77, 8192
    s_call_b64 s[82:83], cf_dma
    ds_read_b64_tr_b16 v[8:9], v56 offset:0
    ds_read_b64_tr_b16 v[10:11], v56 offset:256
    ds_read_b64_tr_b16 v[12:13], v56 offset:8192
    ds_read_b64_tr_b16 v[14:15], v56 offset:8448
    s_mov_b32 s77, 16384
    s_call_b64 s[82:83], cf_dma
    s_waitcnt lgkmcnt(0)
    ds_write_b128 v62, v[0:3] offset:8192
    ds_write_b128 v62, v[4:7] offset:12288
    ds_write_b128 v62, v[8:11] offset:16384
    ds_write_b128 v62, v[12:15] offset:20480
    s_waitcnt lgkmcnt(0)
    v_add_u32 v55, 81920, v51
    v_xor_b32 v56, 32, v55
    ds_read_b64_tr_b16 a[0:1], v55 offset:0
    ds_read_b64_tr_b16 a[2:3], v55 offset:256
    ds_read_b64_tr_b16 a[4:5], v55 offset:8192
    ds_read_b64_tr_b16 a[6:7], v55 offset:8448
    s_mov_b32 s77, 24576
    s_call_b64 s[82:83], cf_dma
    ds_read_b64_tr_b16 a[8:9], v56 offset:0
    ds_read_b64_tr_b16 a[10:11], v56 offset:256
    ds_read_b64_tr_b16 a[12:13], v56 offset:8192
    ds_read_b64_tr_b16 a[14:15], v56 offset:8448
    s_mov_b32 s77, 32768
    s_call_b64 s[82:83], cf_dma
    s_waitcnt lgkmcnt(0)
    s_waitcnt vmcnt(8)
    v_add_u32 v55, 0, v51
    v_xor_b32 v56, 32, v55
    ds_read_b64_tr_b16 v[0:1], v55 offset:0
    ds_read_b64_tr_b16 v[2:3], v55 offset:256
    ds_read_b64_tr_b16 v[4:5], v55 offset:8192
    ds_read_b64_tr_b16 v[6:7], v55 offset:8448
    s_xor_b32 s94, s13, 0
    s_mul_i32 s94, s94, 36864
    s_add_u32 s94, s94, s92
    s_lshr_b32 s74, s13, 1
    s_lshl_b32 s74, s74, 6
    s_add_u32 s94, s94, s74
    s_add_u32 s78, s94, 1024
    s_mov_b64 s[8:9], s[56:57]
    v_mov_b32 v58, v50
    s_mov_b32 s79, 18432
    s_mov_b32 s81, 0
    s_add_u32 s80, s66, 147456
    s_mov_b32 s76, 0
    s_mov_b32 s77, 8192
    s_call_b64 s[82:83], cf_dma
    ds_read_b64_tr_b16 v[8:9], v56 offset:0
    ds_read_b64_tr_b16 v[10:11], v56 offset:256
    ds_read_b64_tr_b16 v[12:13], v56 offset:8192
    ds_read_b64_tr_b16 v[14:15], v56 offset:8448
    s_xor_b32 s94, s13, 2
    s_mul_i32 s94, s94, 36864
    s_add_u32 s94, s94, s92
    s_lshr_b32 s74, s13, 1
    s_lshl_b32 s74, s74, 6
    s_add_u32 s94, s94, s74
    s_add_u32 s78, s94, 1024
    s_mov_b32 s77, 16384
    s_call_b64 s[82:83], cf_dma
    s_waitcnt lgkmcnt(0)
    ds_write_b128 v61, v[0:3] offset:0
    ds_write_b128 v61, v[4:7] offset:4096
    ds_write_b128 v61, v[8:11] offset:8192
    ds_write_b128 v61, v[12:15] offset:12288
    s_waitcnt lgkmcnt(0)
    v_add_u32 v55, 16384, v51
    v_xor_b32 v56, 32, v55
    ds_read_b64_tr_b16 v[0:1], v55 offset:0
    ds_read_b64_tr_b16 v[2:3], v55 offset:256
    ds_read_b64_tr_b16 v[4:5], v55 offset:8192
    ds_read_b64_tr_b16 v[6:7], v55 offset:8448
    s_xor_b32 s94, s13, 3
    s_mul_i32 s94, s94, 36864
    s_add_u32 s94, s94, s92
    s_lshl_b32 s74, s13, 7
    s_add_u32 s94, s94, s74
    s_add_u32 s78, s94, 512
    v_mov_b32 v58, v49
    s_mov_b32 s79, 9216
    s_add_u32 s80, s66, 131072
    s_mov_b32 s76, 0
    s_mov_b32 s77, 8192
    s_call_b64 s[82:83], cf_dma
    ds_read_b64_tr_b16 v[8:9], v56 offset:0
    ds_read_b64_tr_b16 v[10:11], v56 offset:256
    ds_read_b64_tr_b16 v[12:13], v56 offset:8192
    ds_read_b64_tr_b16 v[14:15], v56 offset:8448
    s_mov_b32 s77, 16384
    s_call_b64 s[82:83], cf_dma
    s_waitcnt lgkmcnt(0)
    ds_write_b128 v61, v[0:3] offset:16384
    ds_write_b128 v61, v[4:7] offset:20480
    ds_write_b128 v61, v[8:11] offset:24576
    ds_write_b128 v61, v[12:15] offset:28672
    s_waitcnt lgkmcnt(0)
    s_waitcnt vmcnt(8)
    v_add_u32 v55, 32768, v51
    v_xor_b32 v56, 32, v55
    ds_read_b64_tr_b16 v[0:1], v55 offset:0
    ds_read_b64_tr_b16 v[2:3], v55 offset:256
    ds_read_b64_tr_b16 v[4:5], v55 offset:8192
    ds_read_b64_tr_b16 v[6:7], v55 offset:8448
    s_xor_b32 s94, s13, 2
    s_mul_i32 s94, s94, 36864
    s_add_u32 s94, s94, s92
    s_lshl_b32 s74, s13, 7
    s_add_u32 s94, s94, s74
    s_add_u32 s78, s94, 512
    s_add_u32 s80, s66, 114688
    s_mov_b32 s76, 0
    s_mov_b32 s77, 8192
    s_call_b64 s[82:83], cf_dma
    ds_read_b64_tr_b16 v[8:9], v56 offset:0
    ds_read_b64_tr_b16 v[10:11], v56 offset:256
    ds_read_b64_tr_b16 v[12:13], v56 offset:8192
    ds_read_b64_tr_b16 v[14:15], v56 offset:8448
    s_mov_b32 s77, 16384
    s_call_b64 s[82:83], cf_dma
    s_waitcnt lgkmcnt(0)
    ds_write_b128 v61, v[0:3] offset:32768
    ds_write_b128 v61, v[4:7] offset:36864
    ds_write_b128 v61, v[8:11] offset:40960
    ds_write_b128 v61, v[12:15] offset:45056
    s_waitcnt lgkmcnt(0)
    v_add_u32 v55, 49152, v51
    v_xor_b32 v56, 32, v55
    ds_read_b64_tr_b16 v[0:1], v55 offset:0
    ds_read_b64_tr_b16 v[2:3], v55 offset:256
    ds_read_b64_tr_b16 v[4:5], v55 offset:8192
    ds_read_b64_tr_b16 v[6:7], v55 offset:8448
    s_lshr_b32 s78, 4194304, s72
    s_add_u32 s78, s78, s67
    s_mov_b64 s[8:9], s[52:53]
    v_mov_b32 v58, v48
    s_lshr_b32 s79, 131072, s72
    s_add_u32 s80, s66, 81920
    s_mov_b32 s76, 0
    s_mov_b32 s77, 8192
    s_call_b64 s[82:83], cf_dma
    ds_read_b64_tr_b16 v[8:9], v56 offset:0
    ds_read_b64_tr_b16 v[10:11], v56 offset:256
    ds_read_b64_tr_b16 v[12:13], v56 offset:8192
    ds_read_b64_tr_b16 v[14:15], v56 offset:8448
    s_mov_b32 s77, 16384
    s_call_b64 s[82:83], cf_dma
    s_waitcnt lgkmcnt(0)
    ds_write_b128 v61, v[0:3] offset:49152
    ds_write_b128 v61, v[4:7] offset:53248
    ds_write_b128 v61, v[8:11] offset:57344
    ds_write_b128 v61, v[12:15] offset:61440
    s_waitcnt lgkmcnt(0)
    buffer_load_dword v24, off, s[96:99], 0 offset:140 sc1
    buffer_load_dword v25, off, s[96:99], 0 offset:64 sc1
    s_lshr_b32 s84, s12, 1
    s_lshl_b32 s84, s84, 8
    s_add_u32 s84, s84, 125829120
    v_bfe_u32 v26, v61, 4, 6
    v_min_u32 v26, 11, v26
    v_lshlrev_b32 v26, 2, v26
    buffer_load_dword v27, v26, s[4:7], s84 offen sc1
    s_waitcnt vmcnt(15)
    v_add_u32 v55, 147456, v53
    ds_read_b64_tr_b16 v[0:1], v55 offset:0
    ds_read_b64_tr_b16 v[2:3], v55 offset:128
    ds_read_b64_tr_b16 v[4:5], v55 offset:512
    ds_read_b64_tr_b16 v[6:7], v55 offset:640
    ds_read_b64_tr_b16 v[8:9], v55 offset:8192
    ds_read_b64_tr_b16 v[10:11], v55 offset:8320
    ds_read_b64_tr_b16 v[12:13], v55 offset:8704
    ds_read_b64_tr_b16 v[14:15], v55 offset:8832
    s_waitcnt lgkmcnt(0)
    s_barrier
    ds_write_b128 v63, v[0:3] offset:49152
    ds_write_b128 v63, v[4:7] offset:53248
    s_barrier
    ds_write_b128 v63, v[8:11] offset:57344
    ds_write_b128 v63, v[12:15] offset:61440
    s_waitcnt lgkmcnt(0)
    v_lshlrev_b32 v45, 3, v61
    s_lshl_b32 s40, s12, 14
    s_add_u32 s40, s40, 65536
    s_lshl_b32 s41, s12, 11
    s_sub_u32 s41, s41, 12288
    v_add_u32 v30, s40, v45
    v_add_u32 v45, s41, v45
    v_cmp_gt_u32 vcc, 1536, v61
    s_nop 1
    v_cndmask_b32 v45, v45, v30, vcc
    s_lshl_b32 s40, s12, 16
    s_add_u32 s40, s40, 25151488
    v_lshlrev_b32 v30, 3, v61
    v_add_u32 v30, s40, v30
    v_cmp_gt_u32 vcc, 1792, v61
    s_nop 1
    v_cndmask_b32 v45, v30, v45, vcc
    v_cmp_gt_u32 vcc, 2944, v61
    s_mov_b32 s40, 67108864
    s_mov_b64 exec, vcc
    buffer_load_dword v30, v45, s[4:7], s40 offen sc1
    s_mov_b64 exec, -1
    s_waitcnt vmcnt(11)
    v_add_u32 v55, 131072, v52
    ds_read_b64_tr_b16 v[0:1], v55 offset:0
    ds_read_b64_tr_b16 v[2:3], v55 offset:256
    ds_read_b64_tr_b16 v[4:5], v55 offset:4096
    ds_read_b64_tr_b16 v[6:7], v55 offset:4352
    ds_read_b64_tr_b16 v[8:9], v55 offset:64
    ds_read_b64_tr_b16 v[10:11], v55 offset:320
    ds_read_b64_tr_b16 v[12:13], v55 offset:4160
    ds_read_b64_tr_b16 v[14:15], v55 offset:4416
    s_waitcnt lgkmcnt(0)
    s_barrier
    ds_write_b128 v63, v[0:3] offset:32768
    ds_write_b128 v63, v[4:7] offset:36864
    s_barrier
    ds_write_b128 v63, v[8:11] offset:40960
    ds_write_b128 v63, v[12:15] offset:45056
    s_waitcnt lgkmcnt(0)
    s_waitcnt vmcnt(7)
    v_add_u32 v55, 114688, v52
    ds_read_b64_tr_b16 v[0:1], v55 offset:0
    ds_read_b64_tr_b16 v[2:3], v55 offset:256
    ds_read_b64_tr_b16 v[4:5], v55 offset:4096
    ds_read_b64_tr_b16 v[6:7], v55 offset:4352
    ds_read_b64_tr_b16 v[8:9], v55 offset:64
    ds_read_b64_tr_b16 v[10:11], v55 offset:320
    ds_read_b64_tr_b16 v[12:13], v55 offset:4160
    ds_read_b64_tr_b16 v[14:15], v55 offset:4416
    s_waitcnt lgkmcnt(0)
    s_barrier
    ds_write_b128 v63, v[0:3] offset:16384
    ds_write_b128 v63, v[4:7] offset:20480
    s_barrier
    ds_write_b128 v63, v[8:11] offset:24576
    ds_write_b128 v63, v[12:15] offset:28672
    s_waitcnt lgkmcnt(0)
    v_min_u32 v36, -2, v36
    v_min_u32 v37, -2, v37
    v_min_u32 v38, -2, v38
    v_min_u32 v39, -2, v39
    v_min_u32 v40, -2, v40
    v_min_u32 v41, -2, v41
    v_min_u32 v42, -2, v42
    v_min_u32 v43, -2, v43
    v_min_u32 v44, -2, v44
    s_lshl_b32 s14, s12, 16
    s_add_u32 s14, s14, 92274688
    s_add_u32 s41, s14, 4096
    s_add_u32 s42, s14, 8192
    v_lshrrev_b32 v45, 2, v61
    buffer_store_dwordx4 v[36:39], v61, s[4:7], s14 offen
    buffer_store_dwordx4 v[40:43], v61, s[4:7], s41 offen
    buffer_store_dword v44, v45, s[4:7], s42 offen
    s_waitcnt vmcnt(1)
    v_readfirstlane_b32 s95, v25
    v_readfirstlane_b32 s85, v24
    s_add_u32 s86, s95, 2
    s_waitcnt vmcnt(0)
    v_subrev_u32 v27, s86, v27
    v_cmp_lt_u32 s[86:87], 64, v27
    s_cmp_eq_u32 s95, 0
    s_cselect_b64 s[86:87], -1, s[86:87]
    s_cmp_lg_u64 s[86:87], 0
    s_cbranch_scc1 cf_nt
    s_add_u32 s40, s24, 524288
    buffer_load_dword v30, v79, s[4:7], s24 offen sc1
    buffer_load_dword v30, v79, s[4:7], s40 offen sc1
cf_nt:
    s_waitcnt vmcnt(3)
    v_add_u32 v55, 81920, v51
    v_xor_b32 v56, 32, v55
    ds_read_b64_tr_b16 v[0:1], v55 offset:0
    ds_read_b64_tr_b16 v[2:3], v55 offset:256
    ds_read_b64_tr_b16 v[4:5], v55 offset:8192
    ds_read_b64_tr_b16 v[6:7], v55 offset:8448
    ds_read_b64_tr_b16 v[8:9], v56 offset:0
    ds_read_b64_tr_b16 v[10:11], v56 offset:256
    ds_read_b64_tr_b16 v[12:13], v56 offset:8192
    ds_read_b64_tr_b16 v[14:15], v56 offset:8448
    s_waitcnt lgkmcnt(0)
    ds_write_b128 v62, v[0:3] offset:24576
    ds_write_b128 v62, v[4:7] offset:28672
    ds_write_b128 v62, v[8:11] offset:32768
    ds_write_b128 v62, v[12:15] offset:36864
    s_waitcnt lgkmcnt(0)
    s_barrier
    s_mov_b32 s88, 4194304
gn2:
    s_cmp_lg_u32 s95, 0
    s_cbranch_scc1 gn2x
    buffer_load_dword v27, off, s[96:99], 0 offset:64 sc1
    s_sub_u32 s88, s88, 1
    s_cbranch_scc1 gn2x
    s_waitcnt vmcnt(0)
    v_readfirstlane_b32 s95, v27
    s_nop 1
    s_branch gn2
gn2x:
    ds_write_b128 v78, v[16:19] offset:8704
    ds_write_b128 v65, v[20:23] offset:10240
    v_mov_b32 v44, s95
    v_mov_b32 v45, s95
    v_mov_b32 v46, s95
    v_mov_b32 v47, s95
    v_mov_b32 v48, 108288
    ds_write_b128 v48, v[44:47]
    s_waitcnt vmcnt(0) lgkmcnt(0)
    s_cmp_eq_u32 s85, 1
    s_cbranch_scc1 cf_run
    s_mov_b32 s40, 131072
cf_startpoll:
    buffer_load_dword v3, off, s[96:99], 0 offset:140 sc1
    s_waitcnt vmcnt(0)
    v_readfirstlane_b32 s85, v3
    s_nop 0
    s_cmp_eq_u32 s85, 1
    s_cbranch_scc1 cf_run
    s_cmp_eq_u32 s85, 2
    s_cbranch_scc1 cf_leave
    s_sleep 1
    s_sub_u32 s40, s40, 1
    s_cbranch_scc0 cf_startpoll
    v_mov_b32 v4, 2
    v_mov_b32 v5, 0
    s_mov_b64 exec, 1
    buffer_atomic_cmpswap v[4:5], off, s[96:99], 0 offset:140
    s_mov_b64 exec, -1
    s_mov_b32 s40, 1048576
    s_branch cf_startpoll
cf_leave:
    v_lshrrev_b32 v0, 4, v61
    s_mov_b32 s32, s13
    s_load_dwordx16 s[48:63], s[0:1], 0
    s_waitcnt lgkmcnt(0)
    s_branch L_helper
cf_run:
    s_cmp_eq_u64 s[86:87], 0
    s_cbranch_scc1 cf_kvok
    s_lshr_b32 s92, s12, 1
    s_lshl_b32 s92, s92, 8
    s_add_u32 s92, s92, 125829120
    v_bfe_u32 v2, v61, 4, 6
    v_min_u32 v2, 11, v2
    v_lshlrev_b32 v2, 2, v2
    s_add_u32 s93, s95, 2
    s_mov_b32 s94, 4194304
cf_kv0:
    buffer_load_dword v3, v2, s[4:7], s92 offen sc1
    s_sub_u32 s94, s94, 1
    s_cbranch_scc1 cf_kv0_go
    s_waitcnt vmcnt(0)
    v_subrev_u32 v3, s93, v3
    v_cmp_lt_u32 vcc, 64, v3
    s_cbranch_vccz cf_kv0_go
    s_sleep 2
    s_branch cf_kv0
cf_kv0_go:
    s_add_u32 s40, s24, 524288
    buffer_load_dword v30, v79, s[4:7], s24 offen sc1
    buffer_load_dword v30, v79, s[4:7], s40 offen sc1
    s_waitcnt vmcnt(0)
cf_kvok:
    s_mov_b32 m0, 108032
    s_add_u32 s24, s24, 1048576
    s_add_u32 s15, s14, 4096
    s_add_u32 s16, s14, 8192
    ds_read_b128 v[32:35], v62 offset:16384
    ds_read_b128 v[36:39], v62 offset:20480
    ds_read_b128 v[40:43], v61 offset:0
    ds_read_b128 v[44:47], v61 offset:4096
    ds_read_b128 v[48:51], v61 offset:8192
    ds_read_b128 v[52:55], v61 offset:12288
    s_add_u32 s18, s14, s31
    s_mov_b32 s29, 1048576
    buffer_load_dwordx4 v[24:27], v61, s[4:7], s14 offen nt
.p2align 6
cf_loop:
    v_mov_b64 v[0:1], 0
    v_mov_b64 v[2:3], 0
    v_mov_b64 v[4:5], 0
    v_mov_b64 v[6:7], 0
    v_mov_b64 v[8:9], 0
    v_mov_b64 v[10:11], 0
    v_mov_b64 v[12:13], 0
    v_mov_b64 v[14:15], 0
cf_loop2:
    ds_read_b128 v[16:19], v62 offset:8192
    ds_read_b128 v[20:23], v62 offset:12288
    v_lshrrev_b32 v56, 2, v61
    v_add_u32 v58, 106496, v56
    s_mov_b32 s29, 1048576
    s_nop 13
    buffer_load_dwordx4 v[24:27], v61, s[4:7], s14 offen nt
    s_waitcnt lgkmcnt(0)
cf_chk0:
    s_waitcnt vmcnt(1)
cf_chk0b:
    v_max3_u32 v57, v24, v25, v26
    v_max_u32 v57, v57, v27
    v_cmp_eq_u32 vcc, -1, v57
    ds_write_b128 v62, v[24:27] offset:40960
    s_cbranch_vccnz cf_spin0
    v_smfmac_f32_16x16x64_bf16 v[0:3], v[24:27], v[16:23], v60
    s_mov_b32 m0, s58
    s_nop 0
    buffer_load_dwordx4 v61, s[4:7], s15 offen nt lds
    v_smfmac_f32_16x16x64_bf16 v[8:11], v[24:27], v[32:39], v60
    s_mov_b32 m0, s59
    s_nop 0
    buffer_load_dword v56, s[4:7], s16 offen nt lds
    v_smfmac_f32_16x16x64_bf16 v[12:15], v[24:27], v[48:55], v60
    ds_read_b128 v[32:35], v61 offset:16384
    v_mfma_f32_16x16x16_bf16 v[16:19], v[72:73], v[72:73], 0
    ds_read_b128 v[36:39], v61 offset:20480
    s_waitcnt lgkmcnt(2)
    s_barrier
    ds_read_b128 v[48:51], v63 offset:0
    v_mfma_f32_16x16x16_bf16 v[20:23], v[72:73], v[72:73], 0
    ds_read_b128 v[52:55], v64 offset:0
    v_smfmac_f32_16x16x64_bf16 v[4:7], v[24:27], v[40:47], v60
    ds_read_b128 v[40:43], v61 offset:24576
    v_smfmac_f32_16x16x64_bf16 v[16:19], v[24:27], a[192:199], v60
    ds_read_b128 v[44:47], v61 offset:28672
    v_smfmac_f32_16x16x64_bf16 v[20:23], v[24:27], a[200:207], v60
    s_mov_b32 m0, 108032
    s_waitcnt lgkmcnt(3)
    v_smfmac_f32_16x16x64_bf16 v[0:3], v[48:51], a[0:7], v60
    s_add_u32 s43, s14, s31
    s_add_u32 s41, s14, 16384
    v_smfmac_f32_16x16x64_bf16 v[4:7], v[48:51], v[32:39], v60
    ds_read_b128 v[32:35], v61 offset:32768
    v_smfmac_f32_16x16x64_bf16 v[8:11], v[48:51], a[8:15], v60
    ds_read_b128 v[36:39], v61 offset:36864
    s_waitcnt lgkmcnt(2)
    v_smfmac_f32_16x16x64_bf16 v[12:15], v[48:51], v[40:47], v60
    ds_read_b128 v[40:43], v61 offset:40960
    v_smfmac_f32_16x16x64_bf16 v[16:19], v[48:51], a[208:215], v60
    ds_read_b128 v[44:47], v61 offset:45056
    v_smfmac_f32_16x16x64_bf16 v[20:23], v[48:51], a[216:223], v60
    ds_read_b128 v[48:51], v71 offset:0
    v_smfmac_f32_16x16x64_bf16 v[0:3], v[52:55], a[16:23], v60
    s_waitcnt vmcnt(0)
    ds_read_b128 v[28:31], v62 offset:45056
    s_waitcnt lgkmcnt(4)
    v_smfmac_f32_16x16x64_bf16 v[4:7], v[52:55], v[32:39], v60
    ds_read_b32 v59, v58
    buffer_load_dwordx4 v[24:27], v61, s[4:7], s23 offen offset:0 sc1
    v_smfmac_f32_16x16x64_bf16 v[8:11], v[52:55], a[24:31], v60
    ds_read_b128 v[32:35], v61 offset:49152
    s_waitcnt lgkmcnt(4)
    v_smfmac_f32_16x16x64_bf16 v[12:15], v[52:55], v[40:47], v60
    ds_read_b128 v[36:39], v61 offset:53248
    v_smfmac_f32_16x16x64_bf16 v[16:19], v[52:55], a[224:231], v60
    ds_read_b128 v[40:43], v61 offset:57344
    v_smfmac_f32_16x16x64_bf16 v[20:23], v[52:55], a[232:239], v60
    ds_read_b128 v[44:47], v61 offset:61440
    s_waitcnt lgkmcnt(4)
    v_smfmac_f32_16x16x64_bf16 v[0:3], v[48:51], a[32:39], v60
    v_max3_u32 v57, v28, v29, v30
    v_smfmac_f32_16x16x64_bf16 v[8:11], v[48:51], a[40:47], v60
    v_max3_u32 v57, v57, v31, v59
    s_waitcnt lgkmcnt(2)
    v_smfmac_f32_16x16x64_bf16 v[4:7], v[48:51], v[32:39], v60
    buffer_load_dwordx4 v[32:35], v61, s[4:7], s23 offen offset:1024 sc1
    v_cmp_eq_u32 vcc, -1, v57
    v_smfmac_f32_16x16x64_bf16 v[16:19], v[48:51], a[240:247], v60
    v_smfmac_f32_16x16x64_bf16 v[20:23], v[48:51], a[248:255], v60
    s_cbranch_vccnz cf_spin1
cf_go1:
    s_barrier
    ds_read_b128 v[52:55], v63 offset:4096
    s_waitcnt lgkmcnt(1)
    v_smfmac_f32_16x16x64_bf16 v[12:15], v[48:51], v[40:47], v60
    ds_read_b128 v[48:51], v64 offset:4096
    v_smfmac_f32_16x16x64_bf16 v[0:3], v[28:31], a[48:55], v60
    buffer_load_dwordx4 v[40:43], v61, s[4:7], s23 offen offset:2048 sc1
    v_smfmac_f32_16x16x64_bf16 v[8:11], v[28:31], a[56:63], v60
    ds_read_b128 v[56:59], v71 offset:4096
    s_and_b32 s41, s41, 65535
    v_smfmac_f32_16x16x64_bf16 v[4:7], v[28:31], a[128:135], v60
    ds_read_b128 v[36:39], v65 offset:8192
    s_add_u32 s41, s41, 67108864
    v_smfmac_f32_16x16x64_bf16 v[12:15], v[28:31], a[136:143], v60
    s_add_u32 s17, s41, s31
    s_and_b32 s30, s28, 1
    s_waitcnt lgkmcnt(3)
    v_smfmac_f32_16x16x64_bf16 v[0:3], v[52:55], a[64:71], v60
    buffer_load_dwordx4 v[44:47], v61, s[4:7], s23 offen offset:3072 sc1
    v_smfmac_f32_16x16x64_bf16 v[4:7], v[52:55], a[144:151], v60
    ds_read_b128 v[28:31], v78 offset:8704
    v_smfmac_f32_16x16x64_bf16 v[8:11], v[52:55], a[72:79], v60
    v_smfmac_f32_16x16x64_bf16 v[12:15], v[52:55], a[152:159], v60
    ds_read_b128 v[52:55], v62 offset:28672
    s_waitcnt lgkmcnt(4)
    v_smfmac_f32_16x16x64_bf16 v[0:3], v[48:51], a[80:87], v60
    v_smfmac_f32_16x16x64_bf16 v[4:7], v[48:51], a[160:167], v60
    v_smfmac_f32_16x16x64_bf16 v[8:11], v[48:51], a[88:95], v60
    buffer_load_dword v79, s[4:7], s24 offen sc1 lds
    v_smfmac_f32_16x16x64_bf16 v[12:15], v[48:51], a[168:175], v60
    v_smfmac_f32_16x16x64_bf16 v[16:19], v[48:51], v[112:119], v60
    v_smfmac_f32_16x16x64_bf16 v[20:23], v[48:51], v[120:127], v60
    ds_read_b128 v[48:51], v62 offset:24576
    s_waitcnt lgkmcnt(4)
    v_smfmac_f32_16x16x64_bf16 v[0:3], v[56:59], a[96:103], v60
    s_cmp_ge_u32 s28, 62
    v_smfmac_f32_16x16x64_bf16 v[8:11], v[56:59], a[104:111], v60
    s_waitcnt lgkmcnt(3)
    v_smfmac_f32_16x16x64_bf16 v[0:3], v[36:39], a[112:119], v60
    v_smfmac_f32_16x16x64_bf16 v[8:11], v[36:39], a[120:127], v60
    v_smfmac_f32_16x16x64_bf16 v[4:7], v[56:59], a[176:183], v60
    s_waitcnt lgkmcnt(0)
    v_cvt_pk_bf16_f32 v0, v0, v1
    v_smfmac_f32_16x16x64_bf16 v[4:7], v[36:39], v[48:55], v60
    ds_read_b128 v[48:51], v62 offset:32768
    v_cvt_pk_bf16_f32 v8, v8, v9
    v_smfmac_f32_16x16x64_bf16 v[12:15], v[56:59], a[184:191], v60
    ds_read_b128 v[52:55], v62 offset:36864
    v_cvt_pk_bf16_f32 v9, v10, v11
    v_smfmac_f32_16x16x64_bf16 v[16:19], v[56:59], v[128:135], v60
    v_cvt_pk_bf16_f32 v1, v2, v3
    v_mfma_f32_16x16x16_bf16 v[8:11], v[8:9], v[28:29], 0
    v_cvt_pk_bf16_f32 v2, v4, v5
    v_cvt_pk_bf16_f32 v3, v6, v7
    v_smfmac_f32_16x16x64_bf16 v[20:23], v[56:59], v[136:143], v60
    s_mov_b64 exec, s[36:37]
    ds_read_b128 v[56:59], v69
    s_mov_b64 exec, -1
    v_mfma_f32_16x16x32_bf16 v[4:7], v[0:3], v[28:31], 0
    v_cvt_pk_bf16_f32 v2, v8, v9
    s_waitcnt lgkmcnt(1)
    v_smfmac_f32_16x16x64_bf16 v[12:15], v[36:39], v[48:55], v60
    ds_read_b128 v[48:51], v63 offset:4096
    v_cvt_pk_bf16_f32 v3, v10, v11
    s_waitcnt vmcnt(3)
    v_cvt_pk_bf16_f32 v0, v4, v5
    v_cvt_pk_bf16_f32 v1, v6, v7
    s_nop 1
    v_mfma_f32_16x16x32_bf16 v[4:7], v[32:35], v[0:3], 0
    v_cvt_pk_bf16_f32 v12, v12, v13
    v_cvt_pk_bf16_f32 v13, v14, v15
    s_nop 1
    v_mfma_f32_16x16x16_bf16 v[12:15], v[12:13], v[30:31], 0
    ds_read_b128 v[52:55], v62 offset:45056
    ds_read_b128 v[32:35], v63 offset:49152
    v_mfma_f32_16x16x32_bf16 v[28:31], v[24:27], v[0:3], 0
    s_waitcnt vmcnt(1)
    s_mov_b64 exec, s[34:35]
    s_nop 1
    v_cvt_pk_bf16_f32 v2, v12, v13
    v_cvt_pk_bf16_f32 v3, v14, v15
    s_mov_b64 exec, -1
    s_nop 0
    v_mfma_f32_16x16x32_bf16 v[8:11], v[0:3], v[0:3], 0
    v_mov_b32_dpp v28, v4 row_ror:8 row_mask:0xf bank_mask:0xc
    v_mov_b32_dpp v29, v5 row_ror:8 row_mask:0xf bank_mask:0xc
    v_mov_b32_dpp v30, v6 row_ror:8 row_mask:0xf bank_mask:0xc
    v_mov_b32_dpp v31, v7 row_ror:8 row_mask:0xf bank_mask:0xc
    v_smfmac_f32_16x16x64_bf16 v[16:19], v[36:39], v[144:151], v60
    ds_write_b128 v62, v[28:31] offset:53248
    v_mov_b32_dpp v8, v10 row_ror:8 row_mask:0xf bank_mask:0xc
    v_mov_b32_dpp v9, v11 row_ror:8 row_mask:0xf bank_mask:0xc
    v_smfmac_f32_16x16x64_bf16 v[20:23], v[36:39], v[152:159], v60
    ds_write_b64 v70, v[8:9]
    s_waitcnt lgkmcnt(4)
    v_smfmac_f32_16x16x64_bf16 v[16:19], v[48:51], v[96:103], v60
    s_mov_b64 exec, s[36:37]
    buffer_store_dwordx4 v[56:59], v61, s[4:7], s65 offen sc1
    s_mov_b64 exec, -1
    v_smfmac_f32_16x16x64_bf16 v[20:23], v[48:51], v[104:111], v60
    s_cbranch_scc1 cf_last
cf_back:
    s_waitcnt lgkmcnt(0)
    s_barrier
    ds_read_b128 v[56:59], v78 offset:10752
    v_smfmac_f32_16x16x64_bf16 v[16:19], v[52:55], v[80:87], v60
    ds_read_b128 v[12:15], v78 offset:11264
    ds_read_b128 v[4:7], v63 offset:12288
    v_smfmac_f32_16x16x64_bf16 v[20:23], v[52:55], v[88:95], v60
    ds_read_b128 v[8:11], v64 offset:12288
    ds_read_b128 v[0:3], v71 offset:12288
    v_mov_b64 v[24:25], s[62:63]
    v_mov_b64 v[26:27], s[60:61]
    v_cvt_pk_bf16_f32 v16, v16, v17
    v_cvt_pk_bf16_f32 v17, v18, v19
    v_pk_mul_f32 v[28:29], v[28:29], s[44:45]
    v_pk_mul_f32 v[30:31], v[30:31], s[44:45]
    s_waitcnt lgkmcnt(3)
    v_pk_add_f32 v[56:57], v[56:57], v[58:59]
    v_pk_add_f32 v[12:13], v[12:13], v[14:15]
    v_pk_add_f32 v[56:57], v[56:57], v[12:13]
    v_pk_mul_f32 v[56:57], v[56:57], s[44:45]
    v_exp_f32 v58, v56
    v_exp_f32 v59, v57
    s_waitcnt lgkmcnt(1)
    v_pk_fma_f32 v[28:29], v[4:5], s[44:45], v[28:29]
    v_pk_fma_f32 v[30:31], v[6:7], s[44:45], v[30:31]
    v_cvt_pk_bf16_f32 v6, v58, v59
    v_pk_fma_f32 v[28:29], v[8:9], s[44:45], v[28:29]
    v_pk_fma_f32 v[30:31], v[10:11], s[44:45], v[30:31]
    s_waitcnt lgkmcnt(0)
    v_pk_fma_f32 v[28:29], v[0:1], s[44:45], v[28:29]
    v_mov_b32_dpp v7, v6 row_ror:8 row_mask:0xf bank_mask:0xf
    v_pk_fma_f32 v[30:31], v[2:3], s[44:45], v[30:31]
    v_exp_f32 v0, v28
    v_mfma_f32_16x16x16_bf16 v[12:15], v[16:17], v[6:7], 0
    ds_read_b128 v[48:51], v63 offset:57344
    v_exp_f32 v1, v29
    v_cvt_pk_bf16_f32 v18, v20, v21
    v_exp_f32 v2, v30
    v_cvt_pk_bf16_f32 v19, v22, v23
    v_cvt_pk_bf16_f32 v8, v0, v1
    v_exp_f32 v3, v31
    v_mfma_f32_16x16x16_bf16 v[20:23], v[18:19], v[6:7], 0
    ds_read_b128 v[52:55], v63 offset:61440
    v_cvt_pk_bf16_f32 v9, v2, v3
    v_mov_b32_dpp v10, v8 row_ror:8 row_mask:0xf bank_mask:0xf
    v_max3_f32 v4, |v28|, |v29|, |v30|
    v_mov_b32_dpp v11, v9 row_ror:8 row_mask:0xf bank_mask:0xf
    v_mfma_f32_16x16x32_bf16 v[0:3], v[24:27], v[6:9], 0
    ds_read_b128 v[36:39], v63 offset:53248
    v_max3_f32 v4, v4, |v31|, |v56|
    v_max_f32_e64 v4, v4, |v57|
    v_mfma_f32_16x16x32_bf16 v[12:15], v[40:43], v[8:11], v[12:15]
    v_cmp_nge_f32 vcc, s46, v4
    v_mfma_f32_16x16x32_bf16 v[20:23], v[44:47], v[8:11], v[20:23]
    v_add_f32_dpp v0, v0, v0 row_ror:8 row_mask:0xf bank_mask:0xf
    v_rcp_f32 v0, v0
    s_cbranch_vccnz cf_guard
cf_norm:
    v_mfma_f32_16x16x16_bf16 v[28:31], v[72:73], v[72:73], 0
    v_mul_f32 v12, v12, v0
    v_mul_f32 v13, v13, v0
    v_mul_f32 v14, v14, v0
    v_mul_f32 v15, v15, v0
    v_mul_f32_dpp v12, v20, v0 row_ror:8 row_mask:0xf bank_mask:0xc
    v_mul_f32_dpp v13, v21, v0 row_ror:8 row_mask:0xf bank_mask:0xc
    v_mul_f32_dpp v14, v22, v0 row_ror:8 row_mask:0xf bank_mask:0xc
    v_mul_f32_dpp v15, v23, v0 row_ror:8 row_mask:0xf bank_mask:0xc
    v_cvt_pk_bf16_f32 v12, v12, v13
    v_cvt_pk_bf16_f32 v13, v14, v15
    v_mfma_f32_16x16x16_bf16 v[8:11], v[72:73], v[72:73], 0
    ds_write_b64 v77, v[12:13]
    v_mfma_f32_16x16x16_bf16 v[4:7], v[72:73], v[72:73], 0
    ds_read_b128 v[0:3], v68
    v_mfma_f32_16x16x16_bf16 v[16:19], v[72:73], v[72:73], 0
    ds_read_b128 v[40:43], v63 offset:16384
    v_mfma_f32_16x16x16_bf16 v[20:23], v[72:73], v[72:73], 0
    ds_read_b128 v[44:47], v63 offset:20480
    s_waitcnt lgkmcnt(3)
    s_barrier
    ds_read_b128 v[24:27], v74
    ds_read_b128 v[12:15], v75
    ds_read_b128 v[56:59], v76
    s_waitcnt lgkmcnt(5)
    v_smfmac_f32_16x16x64_bf16 v[28:31], v[0:3], v[160:167], v60
    v_smfmac_f32_16x16x64_bf16 v[8:11], v[0:3], v[192:199], v60
    v_smfmac_f32_16x16x64_bf16 v[4:7], v[0:3], v[32:39], v60
    ds_read_b128 v[32:35], v63 offset:32768
    v_smfmac_f32_16x16x64_bf16 v[16:19], v[0:3], v[224:231], v60
    ds_read_b128 v[36:39], v63 offset:36864
    s_waitcnt lgkmcnt(3)
    v_smfmac_f32_16x16x64_bf16 v[28:31], v[24:27], v[168:175], v60
    v_smfmac_f32_16x16x64_bf16 v[4:7], v[12:15], v[48:55], v60
    ds_read_b128 v[48:51], v63 offset:24576
    v_smfmac_f32_16x16x64_bf16 v[28:31], v[12:15], v[176:183], v60
    ds_read_b128 v[52:55], v63 offset:28672
    s_waitcnt lgkmcnt(4)
    v_smfmac_f32_16x16x64_bf16 v[28:31], v[56:59], v[184:191], v60
    v_cvt_pk_bf16_f32 v4, v4, v5
    v_smfmac_f32_16x16x64_bf16 v[16:19], v[12:15], v[40:47], v60
    ds_read_b128 v[40:43], v63 offset:40960
    v_and_or_b32 v4, v4, -2, s30
    v_smfmac_f32_16x16x64_bf16 v[8:11], v[24:27], v[200:207], v60
    ds_read_b128 v[44:47], v63 offset:45056
    v_cvt_pk_bf16_f32 v5, v6, v7
    v_smfmac_f32_16x16x64_bf16 v[8:11], v[12:15], v[208:215], v60
    buffer_store_dwordx2 v[4:5], v67, s[4:7], s22 offen
    v_cvt_pk_bf16_f32 v28, v28, v29
    v_smfmac_f32_16x16x64_bf16 v[8:11], v[56:59], v[216:223], v60
    v_and_or_b32 v28, v28, -2, s30
    v_smfmac_f32_16x16x64_bf16 v[16:19], v[24:27], v[232:239], v60
    v_cvt_pk_bf16_f32 v29, v30, v31
    s_waitcnt lgkmcnt(4)
    v_smfmac_f32_16x16x64_bf16 v[16:19], v[56:59], v[32:39], v60
    buffer_store_dwordx2 v[28:29], v66, s[4:7], s20 offen
    v_cvt_pk_bf16_f32 v8, v8, v9
    s_waitcnt lgkmcnt(0)
    v_smfmac_f32_16x16x64_bf16 v[20:23], v[0:3], v[240:247], v60
    v_and_or_b32 v8, v8, -2, s30
    v_smfmac_f32_16x16x64_bf16 v[20:23], v[24:27], v[248:255], v60
    v_cvt_pk_bf16_f32 v9, v10, v11
    v_smfmac_f32_16x16x64_bf16 v[20:23], v[12:15], v[48:55], v60
    buffer_store_dwordx2 v[8:9], v66, s[4:7], s21 offen
    v_cvt_pk_bf16_f32 v16, v16, v17
    v_smfmac_f32_16x16x64_bf16 v[20:23], v[56:59], v[40:47], v60
    v_and_or_b32 v16, v16, -2, s30
    v_cvt_pk_bf16_f32 v17, v18, v19
    buffer_store_dwordx2 v[16:17], v66, s[4:7], s38 offen
    s_cmp_lg_u32 s13, 2
    s_nop 1
    v_cvt_pk_bf16_f32 v20, v20, v21
    v_and_or_b32 v20, v20, -2, s30
    v_cvt_pk_bf16_f32 v21, v22, v23
    buffer_store_dwordx2 v[20:21], v66, s[4:7], s39 offen
    s_cbranch_scc1 cf_w013
    v_mov_b32 v21, -1
    s_mov_b64 exec, s[32:33]
    buffer_store_dword v21, v69, s[4:7], s18 offen
    s_mov_b64 exec, -1
    s_mov_b32 s18, s43
    s_nop 15
    s_nop 15
    s_nop 15
    s_nop 14
    buffer_load_dwordx4 v[40:43], v65, s[4:7], s19 offen offset:0 nt
    buffer_load_dwordx4 v[44:47], v65, s[4:7], s19 offen offset:1024 nt
    buffer_load_dwordx4 v[48:51], v65, s[4:7], s19 offen offset:2048 nt
    buffer_load_dwordx4 v[52:55], v65, s[4:7], s19 offen offset:3072 nt
    ds_read_b128 v[56:59], v65 offset:10240
    s_add_u32 s28, s28, 1
    s_mov_b32 s14, s41
    s_add_u32 s23, s23, 524288
    s_add_u32 s24, s24, 524288
    s_min_u32 s24, s24, s47
    s_add_u32 s15, s14, 4096
    s_add_u32 s16, s14, 8192
    s_add_u32 s65, s65, 12288
    s_mov_b32 s40, 1
    v_mov_b64 v[0:1], 0
    v_mov_b64 v[2:3], 0
    v_mov_b64 v[4:5], 0
    v_mov_b64 v[6:7], 0
    v_mov_b64 v[8:9], 0
    v_mov_b64 v[10:11], 0
    v_mov_b64 v[12:13], 0
    v_mov_b64 v[14:15], 0
cf_chkF:
    v_mov_b32 v20, 0
    s_waitcnt vmcnt(3)
    s_waitcnt lgkmcnt(0)
    v_mfma_f32_16x16x32_bf16 v[28:31], v[40:43], v[56:59], 0
    v_bitop3_b32 v20, v20, v40, s30 bitop3:0xf6
    v_bitop3_b32 v20, v20, v42, s30 bitop3:0xf6
    s_waitcnt vmcnt(2)
    v_mfma_f32_16x16x32_bf16 v[28:31], v[44:47], v[56:59], v[28:31]
    v_bitop3_b32 v20, v20, v44, s30 bitop3:0xf6
    v_bitop3_b32 v20, v20, v46, s30 bitop3:0xf6
    s_waitcnt vmcnt(1)
    v_mfma_f32_16x16x32_bf16 v[28:31], v[48:51], v[56:59], v[28:31]
    v_bitop3_b32 v20, v20, v48, s30 bitop3:0xf6
    v_bitop3_b32 v20, v20, v50, s30 bitop3:0xf6
    s_waitcnt vmcnt(0)
    v_mfma_f32_16x16x32_bf16 v[28:31], v[52:55], v[56:59], v[28:31]
    v_bitop3_b32 v20, v20, v52, s30 bitop3:0xf6
    v_bitop3_b32 v20, v20, v54, s30 bitop3:0xf6
    v_and_b32 v20, s40, v20
    v_cmp_ne_u32 vcc, 0, v20
    s_cbranch_vccnz cf_spinF
    v_permlane32_swap_b32 v28, v30
    v_permlane32_swap_b32 v29, v31
    v_add_f32 v28, v28, v30
    v_add_f32 v30, v29, v31
    v_cvt_pk_bf16_f32 v28, v28, v30
    s_mov_b64 exec, s[32:33]
    buffer_store_dword v28, v69, s[4:7], s17 offen
    s_mov_b64 exec, -1
    ds_read_b128 v[32:35], v62 offset:16384
    ds_read_b128 v[36:39], v62 offset:20480
    ds_read_b128 v[40:43], v61 offset:0
    ds_read_b128 v[44:47], v61 offset:4096
    ds_read_b128 v[48:51], v61 offset:8192
    ds_read_b128 v[52:55], v61 offset:12288
    s_nop 15
    s_nop 1
    buffer_load_dwordx4 v[24:27], v61, s[4:7], s14 offen nt
    s_branch cf_loop2
cf_w013:
    ds_read_b128 v[56:59], v65 offset:10240
    ds_read_b128 v[32:35], v62 offset:16384
    ds_read_b128 v[36:39], v62 offset:20480
    ds_read_b128 v[40:43], v61 offset:0
    ds_read_b128 v[44:47], v61 offset:4096
    ds_read_b128 v[48:51], v61 offset:8192
    ds_read_b128 v[52:55], v61 offset:12288
    s_add_u32 s28, s28, 1
    s_mov_b32 s14, s41
    s_add_u32 s23, s23, 524288
    s_add_u32 s24, s24, 524288
    s_min_u32 s24, s24, s47
    s_add_u32 s15, s14, 4096
    s_add_u32 s16, s14, 8192
    s_add_u32 s65, s65, 12288
    s_mov_b32 s40, 1
    s_cmp_eq_u32 s64, 0
    s_cbranch_scc1 cf_w0
    v_mov_b32 v21, -1
    s_mov_b64 exec, s[32:33]
    buffer_store_dword v21, v69, s[4:7], s18 offen
    s_mov_b64 exec, -1
    s_mov_b32 s18, s43
    s_cmp_eq_u32 s13, 1
    s_nop 15
    s_nop 15
    s_nop 1
    s_cbranch_scc1 cf_sx
    s_nop 15
    s_nop 11
cf_sx:
    buffer_load_dwordx4 v[0:3], v65, s[4:7], s19 offen offset:0 nt
    buffer_load_dwordx4 v[4:7], v65, s[4:7], s19 offen offset:1024 nt
    buffer_load_dwordx4 v[8:11], v65, s[4:7], s19 offen offset:2048 nt
    buffer_load_dwordx4 v[12:15], v65, s[4:7], s19 offen offset:3072 nt
cf_chkG:
    v_mov_b32 v20, 0
    s_waitcnt vmcnt(3)
    s_waitcnt lgkmcnt(6)
    v_mfma_f32_16x16x32_bf16 v[28:31], v[0:3], v[56:59], 0
    v_bitop3_b32 v20, v20, v0, s30 bitop3:0xf6
    v_bitop3_b32 v20, v20, v2, s30 bitop3:0xf6
    s_waitcnt vmcnt(2)
    v_mfma_f32_16x16x32_bf16 v[28:31], v[4:7], v[56:59], v[28:31]
    v_bitop3_b32 v20, v20, v4, s30 bitop3:0xf6
    v_bitop3_b32 v20, v20, v6, s30 bitop3:0xf6
    s_waitcnt vmcnt(1)
    v_mfma_f32_16x16x32_bf16 v[28:31], v[8:11], v[56:59], v[28:31]
    v_bitop3_b32 v20, v20, v8, s30 bitop3:0xf6
    v_bitop3_b32 v20, v20, v10, s30 bitop3:0xf6
    s_waitcnt vmcnt(0)
    v_mfma_f32_16x16x32_bf16 v[28:31], v[12:15], v[56:59], v[28:31]
    v_bitop3_b32 v20, v20, v12, s30 bitop3:0xf6
    v_bitop3_b32 v20, v20, v14, s30 bitop3:0xf6
    v_and_b32 v20, s40, v20
    v_cmp_ne_u32 vcc, 0, v20
    s_cbranch_vccnz cf_spinG
    v_permlane32_swap_b32 v28, v30
    v_permlane32_swap_b32 v29, v31
    v_add_f32 v28, v28, v30
    v_add_f32 v30, v29, v31
    s_cmp_eq_u32 s13, 3
    s_cbranch_scc1 cf_w3
    v_mov_b32 v29, v28
    v_mov_b32 v31, v30
    s_nop 0
    v_permlane16_swap_b32 v28, v29
    v_permlane16_swap_b32 v30, v31
    v_add_f32 v28, v28, v29
    v_add_f32 v30, v30, v31
cf_w3:
    v_cvt_pk_bf16_f32 v28, v28, v30
    s_mov_b64 exec, s[32:33]
    buffer_store_dword v28, v69, s[4:7], s17 offen
    s_mov_b64 exec, -1
    buffer_load_dwordx4 v[24:27], v61, s[4:7], s14 offen nt
    s_branch cf_loop
cf_w0:
    v_mov_b64 v[0:1], 0
    v_mov_b64 v[2:3], 0
    v_mov_b64 v[4:5], 0
    v_mov_b64 v[6:7], 0
    v_mov_b64 v[8:9], 0
    v_mov_b64 v[10:11], 0
    v_mov_b64 v[12:13], 0
    v_mov_b64 v[14:15], 0
    s_cmp_lg_u32 s28, 10
    s_cbranch_scc1 cf_nokv
    s_lshr_b32 s92, s12, 1
    s_lshl_b32 s92, s92, 8
    s_add_u32 s92, s92, 125833216
    v_bfe_u32 v28, v61, 4, 6
    v_min_u32 v28, 11, v28
    v_lshlrev_b32 v28, 2, v28
    s_add_u32 s93, s95, 63
    s_mov_b32 s94, 4194304
cf_kv1:
    buffer_load_dword v29, v28, s[4:7], s92 offen sc1
    s_sub_u32 s94, s94, 1
    s_cbranch_scc1 cf_kv1_go
    s_waitcnt vmcnt(0)
    v_subrev_u32 v29, s93, v29
    v_cmp_lt_u32 vcc, 64, v29
    s_cbranch_vccz cf_kv1_go
    s_sleep 2
    s_branch cf_kv1
cf_kv1_go:
cf_nokv:
    s_nop 15
    s_nop 15
    s_nop 15
    s_nop 15
    s_nop 15
    s_nop 15
    s_nop 15
    s_nop 15
    s_nop 15
    s_nop 15
    s_nop 3
    buffer_load_dwordx4 v[24:27], v61, s[4:7], s14 offen nt
    s_branch cf_loop2
cf_spinF:
    buffer_load_dwordx4 v[40:43], v65, s[4:7], s19 offen offset:0 nt
    buffer_load_dwordx4 v[44:47], v65, s[4:7], s19 offen offset:1024 nt
    buffer_load_dwordx4 v[48:51], v65, s[4:7], s19 offen offset:2048 nt
    buffer_load_dwordx4 v[52:55], v65, s[4:7], s19 offen offset:3072 nt
    s_sub_u32 s29, s29, 1
    s_cmp_lt_i32 s29, 0
    s_cselect_b32 s40, 0, 1
    s_branch cf_chkF
cf_spinG:
    buffer_load_dwordx4 v[0:3], v65, s[4:7], s19 offen offset:0 nt
    buffer_load_dwordx4 v[4:7], v65, s[4:7], s19 offen offset:1024 nt
    buffer_load_dwordx4 v[8:11], v65, s[4:7], s19 offen offset:2048 nt
    buffer_load_dwordx4 v[12:15], v65, s[4:7], s19 offen offset:3072 nt
    s_sub_u32 s29, s29, 1
    s_cmp_lt_i32 s29, 0
    s_cselect_b32 s40, 0, 1
    s_branch cf_chkG
cf_guard:
    s_cbranch_scc0 cf_guard2
    buffer_store_dwordx4 v[16:19], v61, s[4:7], s26 offen sc1
    s_add_u32 s26, s26, 131072
    s_add_u32 s40, s95, 63
    v_mov_b32 v5, s40
    s_mov_b64 exec, 1
    buffer_store_dword v5, off, s[4:7], s27 sc1
    s_mov_b64 exec, -1
cf_guard2:
    s_nop 7
    v_max3_f32 v6, v28, v29, v30
    v_max3_f32 v7, v31, v56, v57
    v_max_f32 v6, v6, v7
    s_nop 1
    v_max_f32_dpp v6, v6, v6 row_ror:8 row_mask:0xf bank_mask:0xf
    v_mov_b32 v7, v6
    s_nop 1
    v_permlane32_swap_b32 v6, v7
    v_max_f32 v6, v6, v7
    v_mov_b32 v7, v6
    s_nop 1
    v_permlane16_swap_b32 v6, v7
    v_max_f32 v6, v6, v7
    v_sub_f32 v28, v28, v6
    v_sub_f32 v29, v29, v6
    v_sub_f32 v30, v30, v6
    v_sub_f32 v31, v31, v6
    v_sub_f32 v56, v56, v6
    v_sub_f32 v57, v57, v6
    v_exp_f32 v58, v56
    v_exp_f32 v59, v57
    s_nop 0
    v_cvt_pk_bf16_f32 v6, v58, v59
    s_nop 1
    v_mov_b32_dpp v7, v6 row_ror:8 row_mask:0xf bank_mask:0xf
    v_exp_f32 v0, v28
    s_nop 0
    v_mfma_f32_16x16x16_bf16 v[12:15], v[16:17], v[6:7], 0
    v_exp_f32 v1, v29
    v_exp_f32 v2, v30
    v_cvt_pk_bf16_f32 v8, v0, v1
    v_exp_f32 v3, v31
    v_mfma_f32_16x16x16_bf16 v[20:23], v[18:19], v[6:7], 0
    v_cvt_pk_bf16_f32 v9, v2, v3
    v_mov_b32_dpp v10, v8 row_ror:8 row_mask:0xf bank_mask:0xf
    v_max3_f32 v4, |v28|, |v29|, |v30|
    v_mov_b32_dpp v11, v9 row_ror:8 row_mask:0xf bank_mask:0xf
    v_mfma_f32_16x16x32_bf16 v[0:3], v[24:27], v[6:9], 0
    v_max3_f32 v4, v4, |v31|, |v56|
    v_max_f32_e64 v4, v4, |v57|
    v_mfma_f32_16x16x32_bf16 v[12:15], v[40:43], v[8:11], v[12:15]
    v_cmp_nge_f32 vcc, s46, v4
    v_mfma_f32_16x16x32_bf16 v[20:23], v[44:47], v[8:11], v[20:23]
    v_add_f32_dpp v0, v0, v0 row_ror:8 row_mask:0xf bank_mask:0xf
    v_rcp_f32 v0, v0
    s_nop 4
    s_branch cf_norm
cf_spin0:
    buffer_load_dwordx4 v[24:27], v61, s[4:7], s14 offen nt
    s_sub_u32 s29, s29, 1
    s_cmp_lt_i32 s29, 0
    s_cbranch_scc0 cf_chk0
    s_waitcnt vmcnt(0)
    v_min_u32 v24, -2, v24
    v_min_u32 v25, -2, v25
    v_min_u32 v26, -2, v26
    v_min_u32 v27, -2, v27
    s_branch cf_chk0
cf_spin1:
    s_mov_b32 m0, s58
    s_nop 0
    buffer_load_dwordx4 v61, s[4:7], s15 offen nt lds
    s_mov_b32 m0, s59
    s_nop 0
    buffer_load_dword v56, s[4:7], s16 offen nt lds
    s_mov_b32 m0, 108032
    s_sub_u32 s29, s29, 1
    s_cmp_lt_i32 s29, 0
    s_waitcnt vmcnt(0)
    ds_read_b128 v[28:31], v62 offset:45056
    ds_read_b32 v59, v58
    s_waitcnt lgkmcnt(0)
    v_max3_u32 v57, v28, v29, v30
    v_max3_u32 v57, v57, v31, v59
    v_cmp_eq_u32 vcc, -1, v57
    s_cbranch_scc1 cf_go1
    s_cbranch_vccnz cf_spin1
    s_branch cf_go1
cf_last:
    s_nop 1
    s_cmp_eq_u32 s28, 63
    s_cbranch_scc1 cf_last2
    s_mov_b64 exec, s[34:35]
    buffer_store_dwordx4 v[0:3], v61, s[4:7], s25 offen sc1
    s_mov_b64 exec, -1
    s_add_u32 s25, s25, 131072
    s_mov_b32 s46, 0xbf800000
    s_cmp_eq_u32 0, 0
    s_branch cf_back
cf_last2:
    s_waitcnt lgkmcnt(0)
    s_mov_b64 exec, s[34:35]
    buffer_store_dwordx4 v[0:3], v61, s[4:7], s25 offen sc1
    s_mov_b64 exec, -1
    s_add_u32 s40, s95, 64
    v_mov_b32 v40, s40
    v_smfmac_f32_16x16x64_bf16 v[16:19], v[52:55], v[80:87], v60
    v_smfmac_f32_16x16x64_bf16 v[20:23], v[52:55], v[88:95], v60
    s_nop 3
    v_cvt_pk_bf16_f32 v16, v16, v17
    v_cvt_pk_bf16_f32 v17, v18, v19
    s_nop 1
    v_cvt_pk_bf16_f32 v18, v20, v21
    v_cvt_pk_bf16_f32 v19, v22, v23
    buffer_store_dwordx4 v[16:19], v61, s[4:7], s26 offen sc1
    s_mov_b64 exec, 1
    buffer_store_dword v40, off, s[4:7], s27 sc1
    s_mov_b64 exec, -1
    s_endpgm
cf_dma:
    s_xor_b32 s74, s76, s81
    s_add_u32 m0, s74, s80
    s_add_u32 s76, s76, 4096
    buffer_load_dwordx4 v58, s[8:11], s78 offen lds
    s_add_u32 s78, s78, s79
    s_cmp_lt_u32 s76, s77
    s_cbranch_scc1 cf_dma
    s_setpc_b64 s[82:83]
L_chain_safe:
    s_mov_b64 s[48:49], s[50:51]
    s_mov_b64 s[50:51], s[52:53]
    s_mov_b64 s[52:53], s[54:55]
    s_mov_b64 s[54:55], s[56:57]
    s_mov_b64 s[56:57], s[58:59]
    v_lshrrev_b32 v54, 6, v0
    s_nop 0
    v_readfirstlane_b32 s13, v54
    v_and_b32 v57, 63, v0
    v_bfe_u32 v54, v57, 2, 1
    v_lshlrev_b32 v48, 13, v54
    v_bfe_u32 v54, v57, 3, 1
    v_lshl_add_u32 v48, v54, 15, v48
    v_bfe_u32 v54, v57, 4, 1
    v_lshl_add_u32 v48, v54, 14, v48
    v_bfe_u32 v54, v57, 5, 1
    v_lshl_add_u32 v48, v54, 16, v48
    v_lshrrev_b32 v55, 4, v57
    v_and_b32 v55, 2, v55
    v_xor_b32 v55, v55, v57
    v_and_b32 v55, 3, v55
    v_lshl_add_u32 v48, v55, 4, v48
    v_bfe_u32 v54, v57, 2, 1
    v_lshlrev_b32 v51, 6, v54
    v_bfe_u32 v54, v57, 3, 1
    v_lshl_add_u32 v51, v54, 9, v51
    v_bfe_u32 v54, v57, 4, 1
    v_lshl_add_u32 v51, v54, 7, v51
    v_bfe_u32 v54, v57, 5, 1
    v_lshl_add_u32 v51, v54, 12, v51
    v_bfe_u32 v54, v57, 0, 1
    v_lshl_add_u32 v51, v54, 3, v51
    v_bfe_u32 v54, v57, 1, 1
    v_lshl_add_u32 v51, v54, 4, v51
    v_bfe_u32 v54, v57, 3, 1
    v_lshl_add_u32 v51, v54, 5, v51
    v_lshrrev_b32 v55, 3, v57
    v_mul_u32_u24 v49, 1152, v55
    v_and_b32 v55, 7, v57
    v_lshl_add_u32 v49, v55, 4, v49
    v_bfe_u32 v54, v57, 4, 1
    v_lshlrev_b32 v52, 13, v54
    v_bfe_u32 v54, v57, 5, 1
    v_lshl_add_u32 v52, v54, 9, v52
    v_bfe_u32 v54, v57, 2, 1
    v_lshl_add_u32 v52, v54, 7, v52
    v_bfe_u32 v54, v57, 3, 1
    v_lshl_add_u32 v52, v54, 5, v52
    v_and_b32 v55, 3, v57
    v_lshl_add_u32 v52, v55, 3, v52
    v_lshrrev_b32 v55, 2, v57
    v_mul_u32_u24 v50, 1152, v55
    v_and_b32 v55, 3, v57
    v_lshl_add_u32 v50, v55, 4, v50
    v_bfe_u32 v54, v57, 4, 1
    v_lshlrev_b32 v53, 12, v54
    v_bfe_u32 v54, v57, 5, 1
    v_lshl_add_u32 v53, v54, 8, v53
    v_bfe_u32 v54, v57, 2, 1
    v_lshl_add_u32 v53, v54, 6, v53
    v_bfe_u32 v54, v57, 3, 1
    v_lshl_add_u32 v53, v54, 5, v53
    v_and_b32 v55, 3, v57
    v_lshl_add_u32 v53, v55, 3, v53
    s_lshl_b32 s66, s13, 10
    s_and_b32 s93, s13, 1
    s_lshl_b32 s93, s93, 14
    s_and_b32 s75, s13, 2
    s_lshl_b32 s75, s75, 19
    v_add_u32 v51, s66, v51
    v_add_u32 v52, s66, v52
    v_add_u32 v53, s66, v53
    v_mov_b32 v58, v48
    s_mov_b32 s10, 4718592
    s_mov_b32 s11, 0x20000
    s_lshl_b32 s67, s12, 8
    s_lshl_b32 s40, s13, 6
    s_add_u32 s67, s67, s40
    s_mul_i32 s92, s12, 147456
    s_lshr_b32 s73, s50, 8
    s_add_u32 s73, s73, s12
    s_and_b32 s73, s73, 31
    s_bitcmp1_b32 0xa2222222, s73
    s_cselect_b32 s88, 0, 0
    s_mov_b32 s72, 0
    s_add_u32 s73, s73, 1
    s_lshr_b32 s73, s73, 2
    s_xor_b32 s94, s13, 0
    s_mul_i32 s94, s94, 36864
    s_add_u32 s94, s94, s92
    s_lshl_b32 s74, s13, 7
    s_add_u32 s94, s94, s74
    s_add_u32 s78, s94, 0
    s_mov_b64 s[8:9], s[56:57]
    v_mov_b32 v58, v49
    s_mov_b32 s79, 9216
    s_mov_b32 s81, 0
    s_add_u32 s80, s66, 114688
    s_mov_b32 s76, 0
    s_mov_b32 s77, 8192
    s_call_b64 s[82:83], cs_dma
    s_mov_b32 s77, 16384
    s_call_b64 s[82:83], cs_dma
    s_xor_b32 s94, s13, 1
    s_mul_i32 s94, s94, 36864
    s_add_u32 s94, s94, s92
    s_lshl_b32 s74, s13, 7
    s_add_u32 s94, s94, s74
    s_add_u32 s78, s94, 0
    s_add_u32 s80, s66, 81920
    s_mov_b32 s76, 0
    s_mov_b32 s77, 8192
    s_call_b64 s[82:83], cs_dma
    s_mov_b32 s77, 16384
    s_call_b64 s[82:83], cs_dma
    s_xor_b32 s94, s13, 2
    s_mul_i32 s94, s94, 36864
    s_add_u32 s94, s94, s92
    s_lshl_b32 s74, s13, 7
    s_add_u32 s94, s94, s74
    s_add_u32 s78, s94, 0
    s_add_u32 s80, s66, 16384
    s_mov_b32 s76, 0
    s_mov_b32 s77, 8192
    s_call_b64 s[82:83], cs_dma
    s_mov_b32 s77, 16384
    s_call_b64 s[82:83], cs_dma
    s_xor_b32 s94, s13, 3
    s_mul_i32 s94, s94, 36864
    s_add_u32 s94, s94, s92
    s_lshl_b32 s74, s13, 7
    s_add_u32 s94, s94, s74
    s_add_u32 s78, s94, 0
    s_add_u32 s80, s66, 0
    s_mov_b32 s76, 0
    s_mov_b32 s77, 8192
    s_call_b64 s[82:83], cs_dma
    s_mov_b32 s77, 16384
    s_call_b64 s[82:83], cs_dma
    v_lshrrev_b32 v24, 6, v0
    v_lshlrev_b32 v61, 4, v0
    v_add_u32 v62, 57344, v61
    v_xor_b32 v63, 1024, v61
    v_add_u32 v63, 98304, v63
    v_xor_b32 v64, 2048, v61
    v_add_u32 v64, 98304, v64
    v_and_b32 v65, 1023, v61
    v_add_u32 v65, 98304, v65
    v_and_b32 v26, 15, v0
    v_bfe_u32 v27, v0, 4, 2
    v_mov_b32 v60, 0x4444
    v_mov_b32 v25, 0xeeee
    v_cmp_lt_u32 vcc, 7, v26
    s_nop 1
    v_cndmask_b32 v60, v60, v25, vcc
    s_nop 1
    v_and_b32 v67, 12, v26
    v_lshlrev_b32 v67, 3, v67
    v_and_b32 v25, 1, v26
    v_lshl_add_u32 v67, v25, 4, v67
    v_bfe_u32 v25, v26, 1, 1
    v_lshl_add_u32 v67, v25, 3, v67
    v_lshl_add_u32 v66, v27, 14, v67
    v_lshl_add_u32 v66, v24, 17, v66
    s_nop 1
    v_and_b32 v67, 63, v67
    v_lshrrev_b32 v25, 1, v24
    v_lshl_add_u32 v67, v25, 18, v67
    v_lshl_add_u32 v67, v27, 16, v67
    v_lshrrev_b32 v25, 3, v26
    v_lshl_add_u32 v67, v25, 15, v67
    v_and_b32 v25, 1, v24
    v_lshl_add_u32 v67, v25, 6, v67
    s_nop 1
    s_waitcnt vmcnt(12)
    v_add_u32 v55, 114688, v52
    ds_read_b64_tr_b16 v[160:161], v55 offset:0
    ds_read_b64_tr_b16 v[162:163], v55 offset:256
    ds_read_b64_tr_b16 v[164:165], v55 offset:4096
    ds_read_b64_tr_b16 v[166:167], v55 offset:4352
    s_xor_b32 s94, s13, 0
    s_mul_i32 s94, s94, 36864
    s_add_u32 s94, s94, s92
    s_lshl_b32 s74, s13, 7
    s_add_u32 s94, s94, s74
    s_add_u32 s78, s94, 512
    s_add_u32 s80, s66, 147456
    s_mov_b32 s76, 0
    s_mov_b32 s77, 8192
    s_call_b64 s[82:83], cs_dma
    ds_read_b64_tr_b16 v[192:193], v55 offset:64
    ds_read_b64_tr_b16 v[194:195], v55 offset:320
    ds_read_b64_tr_b16 v[196:197], v55 offset:4160
    ds_read_b64_tr_b16 v[198:199], v55 offset:4416
    s_mov_b32 s77, 16384
    s_call_b64 s[82:83], cs_dma
    v_and_b32 v25, 31, v0
    v_lshlrev_b32 v70, 4, v25
    v_lshlrev_b32 v28, 3, v25
    v_add_u32 v28, 108032, v28
    v_lshrrev_b32 v25, 1, v24
    v_lshl_add_u32 v70, v25, 9, v70
    v_and_b32 v25, 1, v24
    v_lshl_add_u32 v70, v25, 3, v70
    v_add_u32 v70, 109568, v70
    v_cmp_gt_u32 vcc, 2, v27
    s_nop 1
    v_cndmask_b32 v70, v70, v28, vcc
    s_nop 1
    s_waitcnt lgkmcnt(0)
    s_waitcnt vmcnt(12)
    v_add_u32 v55, 81920, v52
    ds_read_b64_tr_b16 v[168:169], v55 offset:0
    ds_read_b64_tr_b16 v[170:171], v55 offset:256
    ds_read_b64_tr_b16 v[172:173], v55 offset:4096
    ds_read_b64_tr_b16 v[174:175], v55 offset:4352
    s_xor_b32 s94, s13, 1
    s_mul_i32 s94, s94, 36864
    s_add_u32 s94, s94, s92
    s_lshl_b32 s74, s13, 7
    s_add_u32 s94, s94, s74
    s_add_u32 s78, s94, 512
    s_add_u32 s80, s66, 98304
    s_mov_b32 s76, 0
    s_mov_b32 s77, 8192
    s_call_b64 s[82:83], cs_dma
    ds_read_b64_tr_b16 v[200:201], v55 offset:64
    ds_read_b64_tr_b16 v[202:203], v55 offset:320
    ds_read_b64_tr_b16 v[204:205], v55 offset:4160
    ds_read_b64_tr_b16 v[206:207], v55 offset:4416
    s_mov_b32 s77, 16384
    s_call_b64 s[82:83], cs_dma
    v_xor_b32 v71, 2048, v63
    v_lshrrev_b32 v68, 4, v0
    v_lshlrev_b32 v68, 7, v68
    v_and_b32 v25, 7, v26
    v_lshl_add_u32 v68, v25, 4, v68
    v_add_u32 v68, 102400, v68
    v_xor_b32 v74, 512, v68
    v_xor_b32 v75, 1024, v68
    v_xor_b32 v76, 1536, v68
    v_lshrrev_b32 v25, 3, v26
    v_lshl_add_u32 v77, v25, 3, v68
    v_or_b32 v78, 512, v65
    v_lshlrev_b32 v79, 2, v61
    v_mov_b64 v[72:73], 0
    v_and_b32 v25, 1, v27
    v_lshlrev_b32 v69, 7, v25
    v_lshrrev_b32 v25, 1, v27
    v_lshl_add_u32 v69, v25, 3, v69
    v_and_b32 v25, 3, v26
    v_lshl_add_u32 v69, v25, 4, v69
    v_bfe_u32 v25, v26, 2, 1
    v_lshl_add_u32 v69, v25, 2, v69
    s_nop 1
    s_waitcnt lgkmcnt(0)
    s_waitcnt vmcnt(12)
    v_add_u32 v55, 16384, v52
    ds_read_b64_tr_b16 v[176:177], v55 offset:0
    ds_read_b64_tr_b16 v[178:179], v55 offset:256
    ds_read_b64_tr_b16 v[180:181], v55 offset:4096
    ds_read_b64_tr_b16 v[182:183], v55 offset:4352
    s_add_u32 s78, s67, 4194304
    s_mov_b64 s[8:9], s[54:55]
    v_mov_b32 v58, v48
    s_mov_b32 s79, 131072
    s_add_u32 s80, s66, 32768
    s_mov_b32 s76, 0
    s_mov_b32 s77, 8192
    s_call_b64 s[82:83], cs_dma
    ds_read_b64_tr_b16 v[208:209], v55 offset:64
    ds_read_b64_tr_b16 v[210:211], v55 offset:320
    ds_read_b64_tr_b16 v[212:213], v55 offset:4160
    ds_read_b64_tr_b16 v[214:215], v55 offset:4416
    s_mov_b32 s77, 16384
    s_call_b64 s[82:83], cs_dma
    s_mov_b32 s32, 0x00ff00ff
    s_mov_b32 s33, 0x00ff00ff
    s_not_b64 s[34:35], s[32:33]
    s_lshr_b32 s31, s12, 1
    s_lshl_b32 s31, s31, 8
    s_and_b32 s40, s12, 1
    s_lshl_b32 s40, s40, 6
    s_add_u32 s31, s31, s40
    s_and_b32 s40, s13, 1
    s_lshl_b32 s40, s40, 12
    s_add_u32 s31, s31, s40
    s_lshl_b32 s19, s12, 14
    s_add_u32 s19, s19, 68124672
    s_add_u32 s41, s19, 8192
    s_add_u32 s19, s19, s40
    s_and_b32 s40, s12, 1
    s_lshl_b32 s40, s40, 2
    s_or_b32 s40, s40, s13
    s_cmp_eq_u32 s40, 5
    s_cselect_b32 s64, 0, s13
    s_cmp_lg_u32 s13, 1
    s_cbranch_scc1 cs_notx
    s_mov_b32 s32, 0xff
    s_mov_b32 s33, 0xff
    s_mov_b32 s19, s41
    s_lshr_b32 s31, s12, 3
    s_lshl_b32 s31, s31, 8
    s_and_b32 s40, s12, 2
    s_lshl_b32 s40, s40, 6
    s_add_u32 s31, s31, s40
    s_and_b32 s40, s12, 4
    s_lshl_b32 s40, s40, 4
    s_add_u32 s31, s31, s40
    s_add_u32 s31, s31, 8192
cs_notx:
    s_cmp_lg_u32 s13, 0
    s_cbranch_scc1 cs_notp
    s_min_u32 s40, s12, 23
    s_mul_i32 s40, s40, 384
    s_add_u32 s40, s40, 98304
    v_add_u32 v69, s40, v61
    v_mov_b32 v25, 108288
    v_cmp_lt_u32 vcc, 23, v0
    s_nop 1
    v_cndmask_b32 v69, v69, v25, vcc
cs_notp:
    s_nop 1
    s_waitcnt lgkmcnt(0)
    s_waitcnt vmcnt(12)
    v_add_u32 v55, 0, v52
    ds_read_b64_tr_b16 v[184:185], v55 offset:0
    ds_read_b64_tr_b16 v[186:187], v55 offset:256
    ds_read_b64_tr_b16 v[188:189], v55 offset:4096
    ds_read_b64_tr_b16 v[190:191], v55 offset:4352
    s_xor_b32 s78, s75, 0
    s_add_u32 s78, s78, s67
    s_mov_b32 s81, s93
    s_add_u32 s80, s66, 114688
    s_mov_b32 s76, 0
    s_mov_b32 s77, 8192
    s_call_b64 s[82:83], cs_dma
    ds_read_b64_tr_b16 v[216:217], v55 offset:64
    ds_read_b64_tr_b16 v[218:219], v55 offset:320
    ds_read_b64_tr_b16 v[220:221], v55 offset:4160
    ds_read_b64_tr_b16 v[222:223], v55 offset:4416
    s_mov_b32 s77, 16384
    s_call_b64 s[82:83], cs_dma
    v_mov_b32 v28, 1
    v_mov_b32 v29, 1
    v_mov_b32 v30, 1
    v_mov_b32 v31, 1
    s_lshl_b32 s40, s12, 14
    s_add_u32 s40, s40, 68222976
    s_add_u32 s41, s40, 0
    buffer_store_dwordx4 v[28:31], v61, s[4:7], s41 offen sc1
    s_add_u32 s41, s40, 4096
    buffer_store_dwordx4 v[28:31], v61, s[4:7], s41 offen sc1
    s_add_u32 s41, s40, 8192
    buffer_store_dwordx4 v[28:31], v61, s[4:7], s41 offen sc1
    s_cmp_eq_u32 s64, 0
    s_cselect_b64 exec, 0, s[32:33]
    v_mov_b32 v27, -1
    s_add_u32 s41, s31, 68157440
    buffer_store_dword v27, v69, s[4:7], s41 offen sc1
    s_add_u32 s41, s31, 68173824
    buffer_store_dword v27, v69, s[4:7], s41 offen sc1
    s_add_u32 s41, s31, 68190208
    buffer_store_dword v27, v69, s[4:7], s41 offen sc1
    s_add_u32 s41, s31, 68206592
    buffer_store_dword v27, v69, s[4:7], s41 offen sc1
    s_mov_b64 exec, -1
    s_waitcnt lgkmcnt(0)
    s_waitcnt vmcnt(12)
    v_add_u32 v55, 147456, v52
    ds_read_b64_tr_b16 v[224:225], v55 offset:0
    ds_read_b64_tr_b16 v[226:227], v55 offset:256
    ds_read_b64_tr_b16 v[228:229], v55 offset:4096
    ds_read_b64_tr_b16 v[230:231], v55 offset:4352
    s_mov_b32 s77, 24576
    s_call_b64 s[82:83], cs_dma
    ds_read_b64_tr_b16 v[240:241], v55 offset:64
    ds_read_b64_tr_b16 v[242:243], v55 offset:320
    ds_read_b64_tr_b16 v[244:245], v55 offset:4160
    ds_read_b64_tr_b16 v[246:247], v55 offset:4416
    s_mov_b32 s77, 32768
    s_call_b64 s[82:83], cs_dma
    s_mov_b64 s[68:69], s[48:49]
    s_mov_b32 s70, 9216
    s_mov_b32 s71, 0x20000
    v_and_b32 v25, 7, v0
    v_mul_u32_u24 v25, 1152, v25
    v_lshrrev_b32 v26, 3, v0
    v_lshl_add_u32 v25, v26, 4, v25
    buffer_load_dwordx4 v[36:39], v25, s[68:71], 0 offen
    buffer_load_dwordx4 v[40:43], v25, s[68:71], 0 offen offset:512
    v_bfe_u32 v25, v0, 2, 3
    v_mul_u32_u24 v25, 1152, v25
    v_lshrrev_b32 v26, 5, v0
    v_lshl_add_u32 v25, v26, 4, v25
    v_and_b32 v26, 3, v0
    v_lshl_add_u32 v25, v26, 2, v25
    buffer_load_dword v44, v25, s[68:71], 0 offen offset:1024
    s_nop 0
    s_waitcnt lgkmcnt(0)
    s_waitcnt vmcnt(15)
    v_add_u32 v55, 98304, v52
    ds_read_b64_tr_b16 v[232:233], v55 offset:0
    ds_read_b64_tr_b16 v[234:235], v55 offset:256
    ds_read_b64_tr_b16 v[236:237], v55 offset:4096
    ds_read_b64_tr_b16 v[238:239], v55 offset:4352
    s_xor_b32 s78, s75, 1048576
    s_add_u32 s78, s78, s67
    s_add_u32 s80, s66, 65536
    s_mov_b32 s76, 0
    s_mov_b32 s77, 8192
    s_call_b64 s[82:83], cs_dma
    ds_read_b64_tr_b16 v[248:249], v55 offset:64
    ds_read_b64_tr_b16 v[250:251], v55 offset:320
    ds_read_b64_tr_b16 v[252:253], v55 offset:4160
    ds_read_b64_tr_b16 v[254:255], v55 offset:4416
    s_mov_b32 s77, 16384
    s_call_b64 s[82:83], cs_dma
    s_mov_b32 s44, 0x3e0293ee
    s_mov_b32 s45, s44
    s_mov_b32 s46, 0x42000000
    s_mov_b32 s60, 0x3f803f80
    s_mov_b32 s61, s60
    s_mov_b32 s62, 0x3e803e80
    s_mov_b32 s63, s62
    s_mov_b32 s28, 0
    s_lshl_b32 s58, s13, 10
    s_add_u32 s58, s58, 102400
    s_lshl_b32 s59, s13, 8
    s_add_u32 s59, s59, 106496
    s_lshl_b32 s24, s12, 14
    s_add_u32 s24, s24, 0
    s_add_u32 s47, s24, 33030144
    s_mul_i32 s40, s13, 3072
    s_add_u32 s23, s24, s40
    s_lshl_b32 s20, s12, 7
    s_add_u32 s20, s20, 68222976
    s_add_u32 s21, s20, 65536
    s_add_u32 s38, s20, 4096
    s_add_u32 s39, s21, 4096
    s_lshl_b32 s22, s12, 7
    s_add_u32 s22, s22, 68231168
    s_waitcnt lgkmcnt(0)
    s_waitcnt vmcnt(15)
    v_add_u32 v55, 32768, v51
    v_xor_b32 v56, 32, v55
    ds_read_b64_tr_b16 v[144:145], v55 offset:0
    ds_read_b64_tr_b16 v[146:147], v55 offset:256
    ds_read_b64_tr_b16 v[148:149], v55 offset:8192
    ds_read_b64_tr_b16 v[150:151], v55 offset:8448
    s_mov_b32 s77, 24576
    s_call_b64 s[82:83], cs_dma
    ds_read_b64_tr_b16 v[152:153], v56 offset:0
    ds_read_b64_tr_b16 v[154:155], v56 offset:256
    ds_read_b64_tr_b16 v[156:157], v56 offset:8192
    ds_read_b64_tr_b16 v[158:159], v56 offset:8448
    s_mov_b32 s77, 32768
    s_call_b64 s[82:83], cs_dma
    s_lshl_b32 s40, s12, 12
    s_add_u32 s25, s40, 79429632
    s_add_u32 s26, s40, 88866816
    s_lshl_b32 s65, s12, 9
    s_add_u32 s65, s65, 90177536
    s_lshl_b32 s40, s13, 5
    s_or_b32 s40, s40, s12
    s_cmp_lt_u32 s40, 24
    s_cselect_b32 s36, 0x1ffffff, 0
    s_mov_b32 s37, 0
    s_lshl_b32 s27, s12, 7
    s_add_u32 s27, s27, 125845504
    s_lshl_b32 s40, s13, 2
    s_add_u32 s27, s27, s40
    v_bfe_u32 v28, v61, 4, 4
    v_bfe_u32 v29, v61, 8, 1
    v_lshlrev_b32 v29, 2, v29
    v_sub_u32 v29, v28, v29
    v_mov_b32 v31, 0x3f80
    v_mov_b32 v32, 0x3f800000
    s_nop 1
    s_waitcnt lgkmcnt(0)
    s_waitcnt vmcnt(11)
    v_add_u32 v55, 114688, v51
    v_xor_b32 v56, 32, v55
    ds_read_b64_tr_b16 a[192:193], v55 offset:0
    ds_read_b64_tr_b16 a[194:195], v55 offset:256
    ds_read_b64_tr_b16 a[196:197], v55 offset:8192
    ds_read_b64_tr_b16 a[198:199], v55 offset:8448
    s_xor_b32 s78, s75, 2097152
    s_add_u32 s78, s78, s67
    s_add_u32 s80, s66, 0
    s_mov_b32 s76, 0
    s_mov_b32 s77, 8192
    s_call_b64 s[82:83], cs_dma
    ds_read_b64_tr_b16 a[200:201], v56 offset:0
    ds_read_b64_tr_b16 a[202:203], v56 offset:256
    ds_read_b64_tr_b16 a[204:205], v56 offset:8192
    ds_read_b64_tr_b16 a[206:207], v56 offset:8448
    s_mov_b32 s77, 16384
    s_call_b64 s[82:83], cs_dma
    v_cmp_eq_u32 vcc, 0, v29
    s_nop 1
    v_cndmask_b32 v16, 0, v31, vcc
    v_cmp_eq_u32 vcc, 1, v29
    s_nop 1
    v_cndmask_b32 v16, v16, v32, vcc
    v_cmp_eq_u32 vcc, 0, v28
    s_nop 1
    v_cndmask_b32 v20, 0, v31, vcc
    v_cmp_eq_u32 vcc, 1, v28
    s_nop 1
    v_cndmask_b32 v20, v20, v32, vcc
    s_nop 1
    s_waitcnt lgkmcnt(0)
    v_add_u32 v55, 131072, v51
    v_xor_b32 v56, 32, v55
    ds_read_b64_tr_b16 a[208:209], v55 offset:0
    ds_read_b64_tr_b16 a[210:211], v55 offset:256
    ds_read_b64_tr_b16 a[212:213], v55 offset:8192
    ds_read_b64_tr_b16 a[214:215], v55 offset:8448
    s_mov_b32 s77, 24576
    s_call_b64 s[82:83], cs_dma
    ds_read_b64_tr_b16 a[216:217], v56 offset:0
    ds_read_b64_tr_b16 a[218:219], v56 offset:256
    ds_read_b64_tr_b16 a[220:221], v56 offset:8192
    ds_read_b64_tr_b16 a[222:223], v56 offset:8448
    s_mov_b32 s77, 32768
    s_call_b64 s[82:83], cs_dma
    v_cmp_eq_u32 vcc, 2, v29
    s_nop 1
    v_cndmask_b32 v17, 0, v31, vcc
    v_cmp_eq_u32 vcc, 3, v29
    s_nop 1
    v_cndmask_b32 v17, v17, v32, vcc
    v_cmp_eq_u32 vcc, 2, v28
    s_nop 1
    v_cndmask_b32 v21, 0, v31, vcc
    v_cmp_eq_u32 vcc, 3, v28
    s_nop 1
    v_cndmask_b32 v21, v21, v32, vcc
    s_nop 1
    s_waitcnt lgkmcnt(0)
    s_waitcnt vmcnt(8)
    v_add_u32 v55, 65536, v51
    v_xor_b32 v56, 32, v55
    ds_read_b64_tr_b16 a[224:225], v55 offset:0
    ds_read_b64_tr_b16 a[226:227], v55 offset:256
    ds_read_b64_tr_b16 a[228:229], v55 offset:8192
    ds_read_b64_tr_b16 a[230:231], v55 offset:8448
    s_xor_b32 s78, s75, 3145728
    s_add_u32 s78, s78, s67
    s_add_u32 s80, s66, 32768
    s_mov_b32 s76, 0
    s_mov_b32 s77, 8192
    s_call_b64 s[82:83], cs_dma
    ds_read_b64_tr_b16 a[232:233], v56 offset:0
    ds_read_b64_tr_b16 a[234:235], v56 offset:256
    ds_read_b64_tr_b16 a[236:237], v56 offset:8192
    ds_read_b64_tr_b16 a[238:239], v56 offset:8448
    s_mov_b32 s77, 16384
    s_call_b64 s[82:83], cs_dma
    v_cmp_eq_u32 vcc, 8, v29
    s_nop 1
    v_cndmask_b32 v18, 0, v31, vcc
    v_cmp_eq_u32 vcc, 9, v29
    s_nop 1
    v_cndmask_b32 v18, v18, v32, vcc
    v_cmp_eq_u32 vcc, 4, v28
    s_nop 1
    v_cndmask_b32 v22, 0, v31, vcc
    v_cmp_eq_u32 vcc, 5, v28
    s_nop 1
    v_cndmask_b32 v22, v22, v32, vcc
    s_nop 1
    s_waitcnt lgkmcnt(0)
    v_add_u32 v55, 81920, v51
    v_xor_b32 v56, 32, v55
    ds_read_b64_tr_b16 a[240:241], v55 offset:0
    ds_read_b64_tr_b16 a[242:243], v55 offset:256
    ds_read_b64_tr_b16 a[244:245], v55 offset:8192
    ds_read_b64_tr_b16 a[246:247], v55 offset:8448
    s_mov_b32 s77, 24576
    s_call_b64 s[82:83], cs_dma
    ds_read_b64_tr_b16 a[248:249], v56 offset:0
    ds_read_b64_tr_b16 a[250:251], v56 offset:256
    ds_read_b64_tr_b16 a[252:253], v56 offset:8192
    ds_read_b64_tr_b16 a[254:255], v56 offset:8448
    s_mov_b32 s77, 32768
    s_call_b64 s[82:83], cs_dma
    v_cmp_eq_u32 vcc, 10, v29
    s_nop 1
    v_cndmask_b32 v19, 0, v31, vcc
    v_cmp_eq_u32 vcc, 11, v29
    s_nop 1
    v_cndmask_b32 v19, v19, v32, vcc
    v_cmp_eq_u32 vcc, 6, v28
    s_nop 1
    v_cndmask_b32 v23, 0, v31, vcc
    v_cmp_eq_u32 vcc, 7, v28
    s_nop 1
    v_cndmask_b32 v23, v23, v32, vcc
    s_nop 1
    s_waitcnt lgkmcnt(0)
    s_waitcnt vmcnt(8)
    v_add_u32 v55, 0, v51
    v_xor_b32 v56, 32, v55
    ds_read_b64_tr_b16 v[80:81], v55 offset:0
    ds_read_b64_tr_b16 v[82:83], v55 offset:256
    ds_read_b64_tr_b16 v[84:85], v55 offset:8192
    ds_read_b64_tr_b16 v[86:87], v55 offset:8448
    s_xor_b32 s78, s75, 2097152
    s_add_u32 s78, s78, s67
    s_mov_b64 s[8:9], s[52:53]
    s_add_u32 s80, s66, 131072
    s_mov_b32 s76, 0
    s_mov_b32 s77, 8192
    s_call_b64 s[82:83], cs_dma
    ds_read_b64_tr_b16 v[88:89], v56 offset:0
    ds_read_b64_tr_b16 v[90:91], v56 offset:256
    ds_read_b64_tr_b16 v[92:93], v56 offset:8192
    ds_read_b64_tr_b16 v[94:95], v56 offset:8448
    s_mov_b32 s77, 16384
    s_call_b64 s[82:83], cs_dma
    v_mov_b32 v46, 1
    s_mov_b64 exec, 1
    buffer_atomic_add v46, off, s[96:99], 0 offset:212 sc0
    s_mov_b64 exec, -1
    s_waitcnt lgkmcnt(0)
    v_add_u32 v55, 16384, v51
    v_xor_b32 v56, 32, v55
    ds_read_b64_tr_b16 v[96:97], v55 offset:0
    ds_read_b64_tr_b16 v[98:99], v55 offset:256
    ds_read_b64_tr_b16 v[100:101], v55 offset:8192
    ds_read_b64_tr_b16 v[102:103], v55 offset:8448
    s_mov_b32 s77, 24576
    s_call_b64 s[82:83], cs_dma
    ds_read_b64_tr_b16 v[104:105], v56 offset:0
    ds_read_b64_tr_b16 v[106:107], v56 offset:256
    ds_read_b64_tr_b16 v[108:109], v56 offset:8192
    ds_read_b64_tr_b16 v[110:111], v56 offset:8448
    s_mov_b32 s77, 32768
    s_call_b64 s[82:83], cs_dma
    s_waitcnt lgkmcnt(0)
    s_waitcnt vmcnt(9)
    v_add_u32 v55, 32768, v51
    v_xor_b32 v56, 32, v55
    ds_read_b64_tr_b16 v[112:113], v55 offset:0
    ds_read_b64_tr_b16 v[114:115], v55 offset:256
    ds_read_b64_tr_b16 v[116:117], v55 offset:8192
    ds_read_b64_tr_b16 v[118:119], v55 offset:8448
    s_xor_b32 s78, s75, 3145728
    s_add_u32 s78, s78, s67
    s_add_u32 s80, s66, 65536
    s_mov_b32 s76, 0
    s_mov_b32 s77, 8192
    s_call_b64 s[82:83], cs_dma
    ds_read_b64_tr_b16 v[120:121], v56 offset:0
    ds_read_b64_tr_b16 v[122:123], v56 offset:256
    ds_read_b64_tr_b16 v[124:125], v56 offset:8192
    ds_read_b64_tr_b16 v[126:127], v56 offset:8448
    s_mov_b32 s77, 16384
    s_call_b64 s[82:83], cs_dma
    s_waitcnt lgkmcnt(0)
    v_add_u32 v55, 49152, v51
    v_xor_b32 v56, 32, v55
    ds_read_b64_tr_b16 v[128:129], v55 offset:0
    ds_read_b64_tr_b16 v[130:131], v55 offset:256
    ds_read_b64_tr_b16 v[132:133], v55 offset:8192
    ds_read_b64_tr_b16 v[134:135], v55 offset:8448
    s_mov_b32 s77, 24576
    s_call_b64 s[82:83], cs_dma
    ds_read_b64_tr_b16 v[136:137], v56 offset:0
    ds_read_b64_tr_b16 v[138:139], v56 offset:256
    ds_read_b64_tr_b16 v[140:141], v56 offset:8192
    ds_read_b64_tr_b16 v[142:143], v56 offset:8448
    s_mov_b32 s77, 32768
    s_call_b64 s[82:83], cs_dma
    s_waitcnt lgkmcnt(0)
    s_waitcnt vmcnt(8)
    v_add_u32 v55, 131072, v51
    v_xor_b32 v56, 32, v55
    ds_read_b64_tr_b16 a[128:129], v55 offset:0
    ds_read_b64_tr_b16 a[130:131], v55 offset:256
    ds_read_b64_tr_b16 a[132:133], v55 offset:8192
    ds_read_b64_tr_b16 a[134:135], v55 offset:8448
    s_xor_b32 s78, s75, 2097152
    s_add_u32 s78, s78, s67
    s_mov_b64 s[8:9], s[50:51]
    s_add_u32 s80, s66, 0
    s_mov_b32 s76, 0
    s_mov_b32 s77, 8192
    s_call_b64 s[82:83], cs_dma
    ds_read_b64_tr_b16 a[136:137], v56 offset:0
    ds_read_b64_tr_b16 a[138:139], v56 offset:256
    ds_read_b64_tr_b16 a[140:141], v56 offset:8192
    ds_read_b64_tr_b16 a[142:143], v56 offset:8448
    s_mov_b32 s77, 16384
    s_call_b64 s[82:83], cs_dma
    s_waitcnt lgkmcnt(0)
    v_add_u32 v55, 147456, v51
    v_xor_b32 v56, 32, v55
    ds_read_b64_tr_b16 a[144:145], v55 offset:0
    ds_read_b64_tr_b16 a[146:147], v55 offset:256
    ds_read_b64_tr_b16 a[148:149], v55 offset:8192
    ds_read_b64_tr_b16 a[150:151], v55 offset:8448
    s_mov_b32 s77, 24576
    s_call_b64 s[82:83], cs_dma
    ds_read_b64_tr_b16 a[152:153], v56 offset:0
    ds_read_b64_tr_b16 a[154:155], v56 offset:256
    ds_read_b64_tr_b16 a[156:157], v56 offset:8192
    ds_read_b64_tr_b16 a[158:159], v56 offset:8448
    s_mov_b32 s77, 32768
    s_call_b64 s[82:83], cs_dma
    s_waitcnt lgkmcnt(0)
    s_waitcnt vmcnt(8)
    v_add_u32 v55, 65536, v51
    v_xor_b32 v56, 32, v55
    ds_read_b64_tr_b16 a[160:161], v55 offset:0
    ds_read_b64_tr_b16 a[162:163], v55 offset:256
    ds_read_b64_tr_b16 a[164:165], v55 offset:8192
    ds_read_b64_tr_b16 a[166:167], v55 offset:8448
    s_xor_b32 s78, s75, 3145728
    s_add_u32 s78, s78, s67
    s_add_u32 s80, s66, 32768
    s_mov_b32 s76, 0
    s_mov_b32 s77, 8192
    s_call_b64 s[82:83], cs_dma
    ds_read_b64_tr_b16 a[168:169], v56 offset:0
    ds_read_b64_tr_b16 a[170:171], v56 offset:256
    ds_read_b64_tr_b16 a[172:173], v56 offset:8192
    ds_read_b64_tr_b16 a[174:175], v56 offset:8448
    s_mov_b32 s77, 16384
    s_call_b64 s[82:83], cs_dma
    v_readfirstlane_b32 s41, v46
    v_mov_b32 v46, 1
    v_mov_b32 v47, 0
    s_cmp_eq_u32 s41, 127
    s_cselect_b64 exec, 1, 0
    buffer_atomic_cmpswap v[46:47], off, s[96:99], 0 offset:216
    s_mov_b64 exec, -1
    s_waitcnt lgkmcnt(0)
    v_add_u32 v55, 81920, v51
    v_xor_b32 v56, 32, v55
    ds_read_b64_tr_b16 a[176:177], v55 offset:0
    ds_read_b64_tr_b16 a[178:179], v55 offset:256
    ds_read_b64_tr_b16 a[180:181], v55 offset:8192
    ds_read_b64_tr_b16 a[182:183], v55 offset:8448
    s_mov_b32 s77, 24576
    s_call_b64 s[82:83], cs_dma
    ds_read_b64_tr_b16 a[184:185], v56 offset:0
    ds_read_b64_tr_b16 a[186:187], v56 offset:256
    ds_read_b64_tr_b16 a[188:189], v56 offset:8192
    ds_read_b64_tr_b16 a[190:191], v56 offset:8448
    s_mov_b32 s77, 32768
    s_call_b64 s[82:83], cs_dma
    s_waitcnt lgkmcnt(0)
    s_waitcnt vmcnt(8)
    v_add_u32 v55, 0, v51
    v_xor_b32 v56, 32, v55
    ds_read_b64_tr_b16 a[48:49], v55 offset:0
    ds_read_b64_tr_b16 a[50:51], v55 offset:256
    ds_read_b64_tr_b16 a[52:53], v55 offset:8192
    ds_read_b64_tr_b16 a[54:55], v55 offset:8448
    s_add_u32 s78, s67, 4194304
    s_mov_b32 s81, 0
    s_add_u32 s80, s66, 98304
    s_mov_b32 s76, 0
    s_mov_b32 s77, 8192
    s_call_b64 s[82:83], cs_dma
    ds_read_b64_tr_b16 a[56:57], v56 offset:0
    ds_read_b64_tr_b16 a[58:59], v56 offset:256
    ds_read_b64_tr_b16 a[60:61], v56 offset:8192
    ds_read_b64_tr_b16 a[62:63], v56 offset:8448
    s_mov_b32 s77, 16384
    s_call_b64 s[82:83], cs_dma
    s_waitcnt lgkmcnt(0)
    v_add_u32 v55, 16384, v51
    v_xor_b32 v56, 32, v55
    ds_read_b64_tr_b16 a[64:65], v55 offset:0
    ds_read_b64_tr_b16 a[66:67], v55 offset:256
    ds_read_b64_tr_b16 a[68:69], v55 offset:8192
    ds_read_b64_tr_b16 a[70:71], v55 offset:8448
    s_xor_b32 s78, s75, 1048576
    s_add_u32 s78, s78, s67
    s_mov_b32 s81, s93
    s_add_u32 s80, s66, 114688
    s_mov_b32 s76, 0
    s_mov_b32 s77, 8192
    s_call_b64 s[82:83], cs_dma
    ds_read_b64_tr_b16 a[72:73], v56 offset:0
    ds_read_b64_tr_b16 a[74:75], v56 offset:256
    ds_read_b64_tr_b16 a[76:77], v56 offset:8192
    ds_read_b64_tr_b16 a[78:79], v56 offset:8448
    s_mov_b32 s77, 16384
    s_call_b64 s[82:83], cs_dma
    s_waitcnt lgkmcnt(0)
    s_waitcnt vmcnt(8)
    v_add_u32 v55, 32768, v51
    v_xor_b32 v56, 32, v55
    ds_read_b64_tr_b16 a[80:81], v55 offset:0
    ds_read_b64_tr_b16 a[82:83], v55 offset:256
    ds_read_b64_tr_b16 a[84:85], v55 offset:8192
    ds_read_b64_tr_b16 a[86:87], v55 offset:8448
    s_mov_b32 s77, 24576
    s_call_b64 s[82:83], cs_dma
    ds_read_b64_tr_b16 a[88:89], v56 offset:0
    ds_read_b64_tr_b16 a[90:91], v56 offset:256
    ds_read_b64_tr_b16 a[92:93], v56 offset:8192
    ds_read_b64_tr_b16 a[94:95], v56 offset:8448
    s_mov_b32 s77, 32768
    s_call_b64 s[82:83], cs_dma
    s_waitcnt lgkmcnt(0)
    v_add_u32 v55, 49152, v51
    v_xor_b32 v56, 32, v55
    ds_read_b64_tr_b16 a[96:97], v55 offset:0
    ds_read_b64_tr_b16 a[98:99], v55 offset:256
    ds_read_b64_tr_b16 a[100:101], v55 offset:8192
    ds_read_b64_tr_b16 a[102:103], v55 offset:8448
    s_xor_b32 s78, s75, 0
    s_add_u32 s78, s78, s67
    s_add_u32 s80, s66, 65536
    s_mov_b32 s76, 0
    s_mov_b32 s77, 8192
    s_call_b64 s[82:83], cs_dma
    ds_read_b64_tr_b16 a[104:105], v56 offset:0
    ds_read_b64_tr_b16 a[106:107], v56 offset:256
    ds_read_b64_tr_b16 a[108:109], v56 offset:8192
    ds_read_b64_tr_b16 a[110:111], v56 offset:8448
    s_mov_b32 s77, 16384
    s_call_b64 s[82:83], cs_dma
    s_waitcnt lgkmcnt(0)
    s_waitcnt vmcnt(12)
    v_add_u32 v55, 98304, v51
    v_xor_b32 v56, 32, v55
    ds_read_b64_tr_b16 a[112:113], v55 offset:0
    ds_read_b64_tr_b16 a[114:115], v55 offset:256
    ds_read_b64_tr_b16 a[116:117], v55 offset:8192
    ds_read_b64_tr_b16 a[118:119], v55 offset:8448
    s_mov_b32 s77, 24576
    s_call_b64 s[82:83], cs_dma
    ds_read_b64_tr_b16 a[120:121], v56 offset:0
    ds_read_b64_tr_b16 a[122:123], v56 offset:256
    ds_read_b64_tr_b16 a[124:125], v56 offset:8192
    ds_read_b64_tr_b16 a[126:127], v56 offset:8448
    s_mov_b32 s77, 32768
    s_call_b64 s[82:83], cs_dma
    s_waitcnt lgkmcnt(0)
    s_waitcnt vmcnt(8)
    v_add_u32 v55, 114688, v51
    v_xor_b32 v56, 32, v55
    ds_read_b64_tr_b16 a[16:17], v55 offset:0
    ds_read_b64_tr_b16 a[18:19], v55 offset:256
    ds_read_b64_tr_b16 a[20:21], v55 offset:8192
    ds_read_b64_tr_b16 a[22:23], v55 offset:8448
    s_xor_b32 s78, s75, 0
    s_add_u32 s78, s78, s67
    s_mov_b64 s[8:9], s[52:53]
    s_add_u32 s80, s66, 0
    s_mov_b32 s76, 0
    s_mov_b32 s77, 8192
    s_call_b64 s[82:83], cs_dma
    ds_read_b64_tr_b16 a[24:25], v56 offset:0
    ds_read_b64_tr_b16 a[26:27], v56 offset:256
    ds_read_b64_tr_b16 a[28:29], v56 offset:8192
    ds_read_b64_tr_b16 a[30:31], v56 offset:8448
    s_mov_b32 s77, 16384
    s_call_b64 s[82:83], cs_dma
    s_waitcnt lgkmcnt(0)
    v_add_u32 v55, 131072, v51
    v_xor_b32 v56, 32, v55
    ds_read_b64_tr_b16 a[32:33], v55 offset:0
    ds_read_b64_tr_b16 a[34:35], v55 offset:256
    ds_read_b64_tr_b16 a[36:37], v55 offset:8192
    ds_read_b64_tr_b16 a[38:39], v55 offset:8448
    s_mov_b32 s77, 24576
    s_call_b64 s[82:83], cs_dma
    ds_read_b64_tr_b16 a[40:41], v56 offset:0
    ds_read_b64_tr_b16 a[42:43], v56 offset:256
    ds_read_b64_tr_b16 a[44:45], v56 offset:8192
    ds_read_b64_tr_b16 a[46:47], v56 offset:8448
    s_mov_b32 s77, 32768
    s_call_b64 s[82:83], cs_dma
    s_waitcnt lgkmcnt(0)
    s_waitcnt vmcnt(8)
    v_add_u32 v55, 65536, v51
    v_xor_b32 v56, 32, v55
    ds_read_b64_tr_b16 v[0:1], v55 offset:0
    ds_read_b64_tr_b16 v[2:3], v55 offset:256
    ds_read_b64_tr_b16 v[4:5], v55 offset:8192
    ds_read_b64_tr_b16 v[6:7], v55 offset:8448
    s_xor_b32 s78, s75, 1048576
    s_add_u32 s78, s78, s67
    s_add_u32 s80, s66, 32768
    s_mov_b32 s76, 0
    s_mov_b32 s77, 8192
    s_call_b64 s[82:83], cs_dma
    ds_read_b64_tr_b16 v[8:9], v56 offset:0
    ds_read_b64_tr_b16 v[10:11], v56 offset:256
    ds_read_b64_tr_b16 v[12:13], v56 offset:8192
    ds_read_b64_tr_b16 v[14:15], v56 offset:8448
    s_mov_b32 s77, 16384
    s_call_b64 s[82:83], cs_dma
    s_waitcnt lgkmcnt(0)
    ds_write_b128 v62, v[0:3] offset:8192
    ds_write_b128 v62, v[4:7] offset:12288
    ds_write_b128 v62, v[8:11] offset:16384
    ds_write_b128 v62, v[12:15] offset:20480
    s_waitcnt lgkmcnt(0)
    v_add_u32 v55, 81920, v51
    v_xor_b32 v56, 32, v55
    ds_read_b64_tr_b16 a[0:1], v55 offset:0
    ds_read_b64_tr_b16 a[2:3], v55 offset:256
    ds_read_b64_tr_b16 a[4:5], v55 offset:8192
    ds_read_b64_tr_b16 a[6:7], v55 offset:8448
    s_mov_b32 s77, 24576
    s_call_b64 s[82:83], cs_dma
    ds_read_b64_tr_b16 a[8:9], v56 offset:0
    ds_read_b64_tr_b16 a[10:11], v56 offset:256
    ds_read_b64_tr_b16 a[12:13], v56 offset:8192
    ds_read_b64_tr_b16 a[14:15], v56 offset:8448
    s_mov_b32 s77, 32768
    s_call_b64 s[82:83], cs_dma
    s_waitcnt lgkmcnt(0)
    s_waitcnt vmcnt(8)
    v_add_u32 v55, 0, v51
    v_xor_b32 v56, 32, v55
    ds_read_b64_tr_b16 v[0:1], v55 offset:0
    ds_read_b64_tr_b16 v[2:3], v55 offset:256
    ds_read_b64_tr_b16 v[4:5], v55 offset:8192
    ds_read_b64_tr_b16 v[6:7], v55 offset:8448
    s_xor_b32 s94, s13, 0
    s_mul_i32 s94, s94, 36864
    s_add_u32 s94, s94, s92
    s_lshr_b32 s74, s13, 1
    s_lshl_b32 s74, s74, 6
    s_add_u32 s94, s94, s74
    s_add_u32 s78, s94, 1024
    s_mov_b64 s[8:9], s[56:57]
    v_mov_b32 v58, v50
    s_mov_b32 s79, 18432
    s_mov_b32 s81, 0
    s_add_u32 s80, s66, 147456
    s_mov_b32 s76, 0
    s_mov_b32 s77, 8192
    s_call_b64 s[82:83], cs_dma
    ds_read_b64_tr_b16 v[8:9], v56 offset:0
    ds_read_b64_tr_b16 v[10:11], v56 offset:256
    ds_read_b64_tr_b16 v[12:13], v56 offset:8192
    ds_read_b64_tr_b16 v[14:15], v56 offset:8448
    s_xor_b32 s94, s13, 2
    s_mul_i32 s94, s94, 36864
    s_add_u32 s94, s94, s92
    s_lshr_b32 s74, s13, 1
    s_lshl_b32 s74, s74, 6
    s_add_u32 s94, s94, s74
    s_add_u32 s78, s94, 1024
    s_mov_b32 s77, 16384
    s_call_b64 s[82:83], cs_dma
    s_waitcnt lgkmcnt(0)
    ds_write_b128 v61, v[0:3] offset:0
    ds_write_b128 v61, v[4:7] offset:4096
    ds_write_b128 v61, v[8:11] offset:8192
    ds_write_b128 v61, v[12:15] offset:12288
    s_waitcnt lgkmcnt(0)
    v_add_u32 v55, 16384, v51
    v_xor_b32 v56, 32, v55
    ds_read_b64_tr_b16 v[0:1], v55 offset:0
    ds_read_b64_tr_b16 v[2:3], v55 offset:256
    ds_read_b64_tr_b16 v[4:5], v55 offset:8192
    ds_read_b64_tr_b16 v[6:7], v55 offset:8448
    s_xor_b32 s94, s13, 3
    s_mul_i32 s94, s94, 36864
    s_add_u32 s94, s94, s92
    s_lshl_b32 s74, s13, 7
    s_add_u32 s94, s94, s74
    s_add_u32 s78, s94, 512
    v_mov_b32 v58, v49
    s_mov_b32 s79, 9216
    s_add_u32 s80, s66, 131072
    s_mov_b32 s76, 0
    s_mov_b32 s77, 8192
    s_call_b64 s[82:83], cs_dma
    ds_read_b64_tr_b16 v[8:9], v56 offset:0
    ds_read_b64_tr_b16 v[10:11], v56 offset:256
    ds_read_b64_tr_b16 v[12:13], v56 offset:8192
    ds_read_b64_tr_b16 v[14:15], v56 offset:8448
    s_mov_b32 s77, 16384
    s_call_b64 s[82:83], cs_dma
    s_waitcnt lgkmcnt(0)
    ds_write_b128 v61, v[0:3] offset:16384
    ds_write_b128 v61, v[4:7] offset:20480
    ds_write_b128 v61, v[8:11] offset:24576
    ds_write_b128 v61, v[12:15] offset:28672
    s_waitcnt lgkmcnt(0)
    s_waitcnt vmcnt(8)
    v_add_u32 v55, 32768, v51
    v_xor_b32 v56, 32, v55
    ds_read_b64_tr_b16 v[0:1], v55 offset:0
    ds_read_b64_tr_b16 v[2:3], v55 offset:256
    ds_read_b64_tr_b16 v[4:5], v55 offset:8192
    ds_read_b64_tr_b16 v[6:7], v55 offset:8448
    s_xor_b32 s94, s13, 2
    s_mul_i32 s94, s94, 36864
    s_add_u32 s94, s94, s92
    s_lshl_b32 s74, s13, 7
    s_add_u32 s94, s94, s74
    s_add_u32 s78, s94, 512
    s_add_u32 s80, s66, 114688
    s_mov_b32 s76, 0
    s_mov_b32 s77, 8192
    s_call_b64 s[82:83], cs_dma
    ds_read_b64_tr_b16 v[8:9], v56 offset:0
    ds_read_b64_tr_b16 v[10:11], v56 offset:256
    ds_read_b64_tr_b16 v[12:13], v56 offset:8192
    ds_read_b64_tr_b16 v[14:15], v56 offset:8448
    s_mov_b32 s77, 16384
    s_call_b64 s[82:83], cs_dma
    s_waitcnt lgkmcnt(0)
    ds_write_b128 v61, v[0:3] offset:32768
    ds_write_b128 v61, v[4:7] offset:36864
    ds_write_b128 v61, v[8:11] offset:40960
    ds_write_b128 v61, v[12:15] offset:45056
    s_waitcnt lgkmcnt(0)
    v_add_u32 v55, 49152, v51
    v_xor_b32 v56, 32, v55
    ds_read_b64_tr_b16 v[0:1], v55 offset:0
    ds_read_b64_tr_b16 v[2:3], v55 offset:256
    ds_read_b64_tr_b16 v[4:5], v55 offset:8192
    ds_read_b64_tr_b16 v[6:7], v55 offset:8448
    s_add_u32 s78, s67, 4194304
    s_mov_b64 s[8:9], s[52:53]
    v_mov_b32 v58, v48
    s_mov_b32 s79, 131072
    s_add_u32 s80, s66, 81920
    s_mov_b32 s76, 0
    s_mov_b32 s77, 8192
    s_call_b64 s[82:83], cs_dma
    ds_read_b64_tr_b16 v[8:9], v56 offset:0
    ds_read_b64_tr_b16 v[10:11], v56 offset:256
    ds_read_b64_tr_b16 v[12:13], v56 offset:8192
    ds_read_b64_tr_b16 v[14:15], v56 offset:8448
    s_mov_b32 s77, 16384
    s_call_b64 s[82:83], cs_dma
    s_waitcnt lgkmcnt(0)
    ds_write_b128 v61, v[0:3] offset:49152
    ds_write_b128 v61, v[4:7] offset:53248
    ds_write_b128 v61, v[8:11] offset:57344
    ds_write_b128 v61, v[12:15] offset:61440
    s_waitcnt lgkmcnt(0)
    buffer_load_dword v24, off, s[96:99], 0 offset:216 sc1
    buffer_load_dword v25, off, s[96:99], 0 offset:64 sc1
    s_lshr_b32 s84, s12, 1
    s_lshl_b32 s84, s84, 8
    s_add_u32 s84, s84, 125829120
    v_bfe_u32 v26, v61, 4, 6
    v_min_u32 v26, 11, v26
    v_lshlrev_b32 v26, 2, v26
    buffer_load_dword v27, v26, s[4:7], s84 offen sc1
    s_waitcnt vmcnt(15)
    v_add_u32 v55, 147456, v53
    ds_read_b64_tr_b16 v[0:1], v55 offset:0
    ds_read_b64_tr_b16 v[2:3], v55 offset:128
    ds_read_b64_tr_b16 v[4:5], v55 offset:512
    ds_read_b64_tr_b16 v[6:7], v55 offset:640
    ds_read_b64_tr_b16 v[8:9], v55 offset:8192
    ds_read_b64_tr_b16 v[10:11], v55 offset:8320
    ds_read_b64_tr_b16 v[12:13], v55 offset:8704
    ds_read_b64_tr_b16 v[14:15], v55 offset:8832
    s_waitcnt lgkmcnt(0)
    s_barrier
    ds_write_b128 v63, v[0:3] offset:49152
    ds_write_b128 v63, v[4:7] offset:53248
    s_barrier
    ds_write_b128 v63, v[8:11] offset:57344
    ds_write_b128 v63, v[12:15] offset:61440
    s_waitcnt lgkmcnt(0)
    v_lshlrev_b32 v45, 3, v61
    s_lshl_b32 s40, s12, 14
    s_add_u32 s40, s40, 65536
    s_lshl_b32 s41, s12, 11
    s_sub_u32 s41, s41, 12288
    v_add_u32 v30, s40, v45
    v_add_u32 v45, s41, v45
    v_cmp_gt_u32 vcc, 1536, v61
    s_nop 1
    v_cndmask_b32 v45, v45, v30, vcc
    s_lshl_b32 s40, s12, 16
    s_add_u32 s40, s40, 24102912
    v_lshlrev_b32 v30, 3, v61
    v_add_u32 v30, s40, v30
    v_cmp_gt_u32 vcc, 1792, v61
    s_nop 1
    v_cndmask_b32 v45, v30, v45, vcc
    v_cmp_gt_u32 vcc, 2944, v61
    s_mov_b32 s40, 68157440
    s_mov_b64 exec, vcc
    buffer_load_dword v30, v45, s[4:7], s40 offen sc1
    s_mov_b64 exec, -1
    s_waitcnt vmcnt(11)
    v_add_u32 v55, 131072, v52
    ds_read_b64_tr_b16 v[0:1], v55 offset:0
    ds_read_b64_tr_b16 v[2:3], v55 offset:256
    ds_read_b64_tr_b16 v[4:5], v55 offset:4096
    ds_read_b64_tr_b16 v[6:7], v55 offset:4352
    ds_read_b64_tr_b16 v[8:9], v55 offset:64
    ds_read_b64_tr_b16 v[10:11], v55 offset:320
    ds_read_b64_tr_b16 v[12:13], v55 offset:4160
    ds_read_b64_tr_b16 v[14:15], v55 offset:4416
    s_waitcnt lgkmcnt(0)
    s_barrier
    ds_write_b128 v63, v[0:3] offset:32768
    ds_write_b128 v63, v[4:7] offset:36864
    s_barrier
    ds_write_b128 v63, v[8:11] offset:40960
    ds_write_b128 v63, v[12:15] offset:45056
    s_waitcnt lgkmcnt(0)
    s_waitcnt vmcnt(7)
    v_add_u32 v55, 114688, v52
    ds_read_b64_tr_b16 v[0:1], v55 offset:0
    ds_read_b64_tr_b16 v[2:3], v55 offset:256
    ds_read_b64_tr_b16 v[4:5], v55 offset:4096
    ds_read_b64_tr_b16 v[6:7], v55 offset:4352
    ds_read_b64_tr_b16 v[8:9], v55 offset:64
    ds_read_b64_tr_b16 v[10:11], v55 offset:320
    ds_read_b64_tr_b16 v[12:13], v55 offset:4160
    ds_read_b64_tr_b16 v[14:15], v55 offset:4416
    s_waitcnt lgkmcnt(0)
    s_barrier
    ds_write_b128 v63, v[0:3] offset:16384
    ds_write_b128 v63, v[4:7] offset:20480
    s_barrier
    ds_write_b128 v63, v[8:11] offset:24576
    ds_write_b128 v63, v[12:15] offset:28672
    s_waitcnt lgkmcnt(0)
    v_min_u32 v36, -2, v36
    v_min_u32 v37, -2, v37
    v_min_u32 v38, -2, v38
    v_min_u32 v39, -2, v39
    v_min_u32 v40, -2, v40
    v_min_u32 v41, -2, v41
    v_min_u32 v42, -2, v42
    v_min_u32 v43, -2, v43
    v_min_u32 v44, -2, v44
    s_lshl_b32 s14, s12, 16
    s_add_u32 s14, s14, 92274688
    s_add_u32 s41, s14, 4096
    s_add_u32 s42, s14, 8192
    v_lshrrev_b32 v45, 2, v61
    buffer_store_dwordx4 v[36:39], v61, s[4:7], s14 offen sc1
    buffer_store_dwordx4 v[40:43], v61, s[4:7], s41 offen sc1
    buffer_store_dword v44, v45, s[4:7], s42 offen sc1
    s_waitcnt vmcnt(1)
    v_readfirstlane_b32 s95, v25
    v_readfirstlane_b32 s85, v24
    s_add_u32 s86, s95, 2
    s_waitcnt vmcnt(0)
    v_subrev_u32 v27, s86, v27
    v_cmp_lt_u32 s[86:87], 64, v27
    s_cmp_eq_u32 s95, 0
    s_cselect_b64 s[86:87], -1, s[86:87]
    s_cmp_lg_u64 s[86:87], 0
    s_cbranch_scc1 cs_nt
    s_add_u32 s40, s24, 524288
    buffer_load_dword v30, v79, s[4:7], s24 offen sc1
    buffer_load_dword v30, v79, s[4:7], s40 offen sc1
cs_nt:
    s_waitcnt vmcnt(3)
    v_add_u32 v55, 81920, v51
    v_xor_b32 v56, 32, v55
    ds_read_b64_tr_b16 v[0:1], v55 offset:0
    ds_read_b64_tr_b16 v[2:3], v55 offset:256
    ds_read_b64_tr_b16 v[4:5], v55 offset:8192
    ds_read_b64_tr_b16 v[6:7], v55 offset:8448
    ds_read_b64_tr_b16 v[8:9], v56 offset:0
    ds_read_b64_tr_b16 v[10:11], v56 offset:256
    ds_read_b64_tr_b16 v[12:13], v56 offset:8192
    ds_read_b64_tr_b16 v[14:15], v56 offset:8448
    s_waitcnt lgkmcnt(0)
    ds_write_b128 v62, v[0:3] offset:24576
    ds_write_b128 v62, v[4:7] offset:28672
    ds_write_b128 v62, v[8:11] offset:32768
    ds_write_b128 v62, v[12:15] offset:36864
    s_waitcnt lgkmcnt(0)
    s_barrier
    s_mov_b32 s88, 4194304
gn3:
    s_cmp_lg_u32 s95, 0
    s_cbranch_scc1 gn3x
    buffer_load_dword v27, off, s[96:99], 0 offset:64 sc1
    s_sub_u32 s88, s88, 1
    s_cbranch_scc1 gn3x
    s_waitcnt vmcnt(0)
    v_readfirstlane_b32 s95, v27
    s_nop 1
    s_branch gn3
gn3x:
    ds_write_b128 v78, v[16:19] offset:8704
    ds_write_b128 v65, v[20:23] offset:10240
    v_mov_b32 v44, s95
    v_mov_b32 v45, s95
    v_mov_b32 v46, s95
    v_mov_b32 v47, s95
    v_mov_b32 v48, 108288
    ds_write_b128 v48, v[44:47]
    s_waitcnt vmcnt(0) lgkmcnt(0)
    s_cmp_eq_u32 s85, 1
    s_cbranch_scc1 cs_run
    s_mov_b32 s40, 16777216
cs_startpoll:
    buffer_load_dword v3, off, s[96:99], 0 offset:216 sc1
    s_waitcnt vmcnt(0)
    v_readfirstlane_b32 s85, v3
    s_nop 0
    s_cmp_eq_u32 s85, 1
    s_cbranch_scc1 cs_run
    s_sleep 1
    s_sub_u32 s40, s40, 1
    s_cbranch_scc0 cs_startpoll
    s_endpgm
cs_run:
    s_cmp_eq_u64 s[86:87], 0
    s_cbranch_scc1 cs_kvok
    s_lshr_b32 s92, s12, 1
    s_lshl_b32 s92, s92, 8
    s_add_u32 s92, s92, 125829120
    v_bfe_u32 v2, v61, 4, 6
    v_min_u32 v2, 11, v2
    v_lshlrev_b32 v2, 2, v2
    s_add_u32 s93, s95, 2
    s_mov_b32 s94, 4194304
cs_kv0:
    buffer_load_dword v3, v2, s[4:7], s92 offen sc1
    s_sub_u32 s94, s94, 1
    s_cbranch_scc1 cs_kv0_go
    s_waitcnt vmcnt(0)
    v_subrev_u32 v3, s93, v3
    v_cmp_lt_u32 vcc, 64, v3
    s_cbranch_vccz cs_kv0_go
    s_sleep 2
    s_branch cs_kv0
cs_kv0_go:
    s_add_u32 s40, s24, 524288
    buffer_load_dword v30, v79, s[4:7], s24 offen sc1
    buffer_load_dword v30, v79, s[4:7], s40 offen sc1
    s_waitcnt vmcnt(0)
cs_kvok:
    s_mov_b32 m0, 108032
    s_add_u32 s24, s24, 1048576
    s_add_u32 s15, s14, 4096
    s_add_u32 s16, s14, 8192
    ds_read_b128 v[32:35], v62 offset:16384
    ds_read_b128 v[36:39], v62 offset:20480
    ds_read_b128 v[40:43], v61 offset:0
    ds_read_b128 v[44:47], v61 offset:4096
    ds_read_b128 v[48:51], v61 offset:8192
    ds_read_b128 v[52:55], v61 offset:12288
    s_add_u32 s18, s14, s31
    s_mov_b32 s29, 1048576
    buffer_load_dwordx4 v[24:27], v61, s[4:7], s14 offen sc1
.p2align 6
cs_loop:
    v_mov_b64 v[0:1], 0
    v_mov_b64 v[2:3], 0
    v_mov_b64 v[4:5], 0
    v_mov_b64 v[6:7], 0
    v_mov_b64 v[8:9], 0
    v_mov_b64 v[10:11], 0
    v_mov_b64 v[12:13], 0
    v_mov_b64 v[14:15], 0
cs_loop2:
    ds_read_b128 v[16:19], v62 offset:8192
    ds_read_b128 v[20:23], v62 offset:12288
    v_lshrrev_b32 v56, 2, v61
    v_add_u32 v58, 106496, v56
    s_mov_b32 s29, 1048576
    s_waitcnt lgkmcnt(0)
cs_chk0:
    s_waitcnt vmcnt(0)
cs_chk0b:
    v_max3_u32 v57, v24, v25, v26
    v_max_u32 v57, v57, v27
    v_cmp_eq_u32 vcc, -1, v57
    ds_write_b128 v62, v[24:27] offset:40960
    s_cbranch_vccnz cs_spin0
    v_smfmac_f32_16x16x64_bf16 v[0:3], v[24:27], v[16:23], v60
    buffer_load_dwordx4 v[28:31], v61, s[4:7], s15 offen sc1
    buffer_load_dword v59, v56, s[4:7], s16 offen sc1
    v_smfmac_f32_16x16x64_bf16 v[8:11], v[24:27], v[32:39], v60
    ds_read_b128 v[32:35], v61 offset:16384
    v_smfmac_f32_16x16x64_bf16 v[12:15], v[24:27], v[48:55], v60
    ds_read_b128 v[36:39], v61 offset:20480
    v_mfma_f32_16x16x16_bf16 v[16:19], v[72:73], v[72:73], 0
    s_waitcnt lgkmcnt(2)
    s_barrier
    ds_read_b128 v[48:51], v63 offset:0
    v_mfma_f32_16x16x16_bf16 v[20:23], v[72:73], v[72:73], 0
    ds_read_b128 v[52:55], v64 offset:0
    v_smfmac_f32_16x16x64_bf16 v[4:7], v[24:27], v[40:47], v60
    ds_read_b128 v[40:43], v61 offset:24576
    v_smfmac_f32_16x16x64_bf16 v[16:19], v[24:27], a[192:199], v60
    ds_read_b128 v[44:47], v61 offset:28672
    v_smfmac_f32_16x16x64_bf16 v[20:23], v[24:27], a[200:207], v60
    s_waitcnt lgkmcnt(3)
    v_smfmac_f32_16x16x64_bf16 v[0:3], v[48:51], a[0:7], v60
    s_add_u32 s43, s14, s31
    s_add_u32 s41, s14, 16384
    v_smfmac_f32_16x16x64_bf16 v[4:7], v[48:51], v[32:39], v60
    ds_read_b128 v[32:35], v61 offset:32768
    v_smfmac_f32_16x16x64_bf16 v[8:11], v[48:51], a[8:15], v60
    ds_read_b128 v[36:39], v61 offset:36864
    s_waitcnt lgkmcnt(2)
    v_smfmac_f32_16x16x64_bf16 v[12:15], v[48:51], v[40:47], v60
    ds_read_b128 v[40:43], v61 offset:40960
    v_smfmac_f32_16x16x64_bf16 v[0:3], v[52:55], a[16:23], v60
    ds_read_b128 v[44:47], v61 offset:45056
    v_smfmac_f32_16x16x64_bf16 v[8:11], v[52:55], a[24:31], v60
    ds_read_b128 v[48:51], v71 offset:0
    s_waitcnt lgkmcnt(3)
    v_smfmac_f32_16x16x64_bf16 v[4:7], v[52:55], v[32:39], v60
    s_waitcnt vmcnt(0)
    ds_write_b128 v62, v[28:31] offset:45056
    s_waitcnt lgkmcnt(2)
    v_smfmac_f32_16x16x64_bf16 v[12:15], v[52:55], v[40:47], v60
    ds_write_b32 v58, v59
    v_max3_u32 v57, v28, v29, v30
    s_waitcnt lgkmcnt(2)
    v_smfmac_f32_16x16x64_bf16 v[0:3], v[48:51], a[32:39], v60
    ds_read_b128 v[32:35], v61 offset:49152
    v_max3_u32 v57, v57, v31, v59
    v_smfmac_f32_16x16x64_bf16 v[8:11], v[48:51], a[40:47], v60
    ds_read_b128 v[36:39], v61 offset:53248
    v_cmp_eq_u32 vcc, -1, v57
    v_smfmac_f32_16x16x64_bf16 v[16:19], v[52:55], a[224:231], v60
    ds_read_b128 v[40:43], v61 offset:57344
    v_smfmac_f32_16x16x64_bf16 v[20:23], v[52:55], a[232:239], v60
    ds_read_b128 v[44:47], v61 offset:61440
    s_cbranch_vccnz cs_spin1
cs_go1:
    v_smfmac_f32_16x16x64_bf16 v[0:3], v[28:31], a[48:55], v60
    s_waitcnt lgkmcnt(4)
    s_barrier
    ds_read_b128 v[52:55], v63 offset:4096
    v_smfmac_f32_16x16x64_bf16 v[8:11], v[28:31], a[56:63], v60
    ds_read_b128 v[56:59], v71 offset:4096
    v_smfmac_f32_16x16x64_bf16 v[4:7], v[28:31], a[128:135], v60
    s_waitcnt lgkmcnt(2)
    v_smfmac_f32_16x16x64_bf16 v[4:7], v[48:51], v[32:39], v60
    buffer_load_dwordx4 v[32:35], v61, s[4:7], s23 offen offset:0 sc1
    v_smfmac_f32_16x16x64_bf16 v[12:15], v[48:51], v[40:47], v60
    ds_read_b128 v[48:51], v64 offset:4096
    v_smfmac_f32_16x16x64_bf16 v[12:15], v[28:31], a[136:143], v60
    ds_read_b128 v[24:27], v65 offset:8192
    s_and_b32 s41, s41, 65535
    s_add_u32 s41, s41, 68157440
    v_smfmac_f32_16x16x64_bf16 v[16:19], v[28:31], v[80:87], v60
    buffer_load_dwordx4 v[36:39], v61, s[4:7], s23 offen offset:1024 sc1
    v_smfmac_f32_16x16x64_bf16 v[20:23], v[28:31], v[88:95], v60
    s_add_u32 s17, s41, s31
    s_and_b32 s30, s28, 1
    s_waitcnt lgkmcnt(3)
    v_smfmac_f32_16x16x64_bf16 v[0:3], v[52:55], a[64:71], v60
    ds_read_b128 v[28:31], v78 offset:8704
    v_smfmac_f32_16x16x64_bf16 v[4:7], v[52:55], a[144:151], v60
    buffer_load_dwordx4 v[40:43], v61, s[4:7], s23 offen offset:2048 sc1
    v_smfmac_f32_16x16x64_bf16 v[8:11], v[52:55], a[72:79], v60
    v_smfmac_f32_16x16x64_bf16 v[12:15], v[52:55], a[152:159], v60
    v_smfmac_f32_16x16x64_bf16 v[16:19], v[52:55], v[96:103], v60
    buffer_load_dwordx4 v[44:47], v61, s[4:7], s23 offen offset:3072 sc1
    v_smfmac_f32_16x16x64_bf16 v[20:23], v[52:55], v[104:111], v60
    ds_read_b128 v[52:55], v62 offset:28672
    s_waitcnt lgkmcnt(3)
    v_smfmac_f32_16x16x64_bf16 v[0:3], v[48:51], a[80:87], v60
    v_smfmac_f32_16x16x64_bf16 v[4:7], v[48:51], a[160:167], v60
    v_smfmac_f32_16x16x64_bf16 v[8:11], v[48:51], a[88:95], v60
    v_smfmac_f32_16x16x64_bf16 v[12:15], v[48:51], a[168:175], v60
    v_smfmac_f32_16x16x64_bf16 v[16:19], v[48:51], v[112:119], v60
    buffer_load_dword v79, s[4:7], s24 offen sc1 lds
    v_smfmac_f32_16x16x64_bf16 v[20:23], v[48:51], v[120:127], v60
    ds_read_b128 v[48:51], v62 offset:24576
    v_smfmac_f32_16x16x64_bf16 v[0:3], v[56:59], a[96:103], v60
    s_cmp_ge_u32 s28, 62
    v_smfmac_f32_16x16x64_bf16 v[8:11], v[56:59], a[104:111], v60
    s_waitcnt lgkmcnt(3)
    v_smfmac_f32_16x16x64_bf16 v[0:3], v[24:27], a[112:119], v60
    v_smfmac_f32_16x16x64_bf16 v[8:11], v[24:27], a[120:127], v60
    v_smfmac_f32_16x16x64_bf16 v[4:7], v[56:59], a[176:183], v60
    s_waitcnt lgkmcnt(0)
    v_cvt_pk_bf16_f32 v0, v0, v1
    v_smfmac_f32_16x16x64_bf16 v[4:7], v[24:27], v[48:55], v60
    ds_read_b128 v[48:51], v62 offset:32768
    v_cvt_pk_bf16_f32 v8, v8, v9
    v_smfmac_f32_16x16x64_bf16 v[12:15], v[56:59], a[184:191], v60
    ds_read_b128 v[52:55], v62 offset:36864
    v_cvt_pk_bf16_f32 v9, v10, v11
    v_smfmac_f32_16x16x64_bf16 v[16:19], v[56:59], v[128:135], v60
    v_cvt_pk_bf16_f32 v1, v2, v3
    v_mfma_f32_16x16x16_bf16 v[8:11], v[8:9], v[28:29], 0
    v_cvt_pk_bf16_f32 v2, v4, v5
    v_cvt_pk_bf16_f32 v3, v6, v7
    v_smfmac_f32_16x16x64_bf16 v[20:23], v[56:59], v[136:143], v60
    s_mov_b64 exec, s[36:37]
    ds_read_b128 v[56:59], v69
    s_mov_b64 exec, -1
    v_mfma_f32_16x16x32_bf16 v[4:7], v[0:3], v[28:31], 0
    v_cvt_pk_bf16_f32 v2, v8, v9
    s_waitcnt lgkmcnt(1)
    v_smfmac_f32_16x16x64_bf16 v[12:15], v[24:27], v[48:55], v60
    ds_read_b128 v[48:51], v63 offset:0
    v_cvt_pk_bf16_f32 v3, v10, v11
    s_waitcnt vmcnt(3)
    v_cvt_pk_bf16_f32 v0, v4, v5
    v_cvt_pk_bf16_f32 v1, v6, v7
    s_nop 1
    v_mfma_f32_16x16x32_bf16 v[4:7], v[36:39], v[0:3], 0
    v_cvt_pk_bf16_f32 v12, v12, v13
    v_cvt_pk_bf16_f32 v13, v14, v15
    s_nop 1
    v_mfma_f32_16x16x16_bf16 v[12:15], v[12:13], v[30:31], 0
    ds_read_b128 v[52:55], v71 offset:0
    ds_read_b128 v[36:39], v63 offset:53248
    v_mfma_f32_16x16x32_bf16 v[28:31], v[32:35], v[0:3], 0
    s_waitcnt vmcnt(1)
    ds_read_b128 v[32:35], v63 offset:49152
    s_mov_b64 exec, s[34:35]
    s_nop 0
    v_cvt_pk_bf16_f32 v2, v12, v13
    v_cvt_pk_bf16_f32 v3, v14, v15
    s_mov_b64 exec, -1
    s_nop 0
    v_mfma_f32_16x16x32_bf16 v[8:11], v[0:3], v[0:3], 0
    v_mov_b32_dpp v28, v4 row_ror:8 row_mask:0xf bank_mask:0xc
    v_mov_b32_dpp v29, v5 row_ror:8 row_mask:0xf bank_mask:0xc
    v_mov_b32_dpp v30, v6 row_ror:8 row_mask:0xf bank_mask:0xc
    v_mov_b32_dpp v31, v7 row_ror:8 row_mask:0xf bank_mask:0xc
    v_smfmac_f32_16x16x64_bf16 v[16:19], v[24:27], v[144:151], v60
    ds_write_b128 v62, v[28:31] offset:53248
    v_mov_b32_dpp v8, v10 row_ror:8 row_mask:0xf bank_mask:0xc
    v_mov_b32_dpp v9, v11 row_ror:8 row_mask:0xf bank_mask:0xc
    v_smfmac_f32_16x16x64_bf16 v[20:23], v[24:27], v[152:159], v60
    ds_write_b64 v70, v[8:9]
    s_waitcnt lgkmcnt(5)
    v_smfmac_f32_16x16x64_bf16 v[16:19], v[48:51], a[208:215], v60
    s_mov_b64 exec, s[36:37]
    s_cbranch_execz cs_np3635
    buffer_store_dwordx4 v[56:59], v61, s[4:7], s65 offen sc1
cs_np3635:
    s_mov_b64 exec, -1
    v_smfmac_f32_16x16x64_bf16 v[20:23], v[48:51], a[216:223], v60
    s_cbranch_scc1 cs_last
cs_back:
    s_waitcnt lgkmcnt(0)
    s_barrier
    ds_read_b128 v[56:59], v78 offset:10752
    v_smfmac_f32_16x16x64_bf16 v[16:19], v[52:55], a[240:247], v60
    ds_read_b128 v[12:15], v78 offset:11264
    ds_read_b128 v[4:7], v63 offset:12288
    v_smfmac_f32_16x16x64_bf16 v[20:23], v[52:55], a[248:255], v60
    ds_read_b128 v[8:11], v64 offset:12288
    ds_read_b128 v[0:3], v71 offset:12288
    v_mov_b64 v[24:25], s[62:63]
    v_mov_b64 v[26:27], s[60:61]
    v_cvt_pk_bf16_f32 v16, v16, v17
    v_cvt_pk_bf16_f32 v17, v18, v19
    v_pk_mul_f32 v[28:29], v[28:29], s[44:45]
    v_pk_mul_f32 v[30:31], v[30:31], s[44:45]
    s_waitcnt lgkmcnt(3)
    v_pk_add_f32 v[56:57], v[56:57], v[58:59]
    v_pk_add_f32 v[12:13], v[12:13], v[14:15]
    v_pk_add_f32 v[56:57], v[56:57], v[12:13]
    v_pk_mul_f32 v[56:57], v[56:57], s[44:45]
    v_exp_f32 v58, v56
    v_exp_f32 v59, v57
    s_waitcnt lgkmcnt(1)
    v_pk_fma_f32 v[28:29], v[4:5], s[44:45], v[28:29]
    v_pk_fma_f32 v[30:31], v[6:7], s[44:45], v[30:31]
    v_cvt_pk_bf16_f32 v6, v58, v59
    v_pk_fma_f32 v[28:29], v[8:9], s[44:45], v[28:29]
    v_pk_fma_f32 v[30:31], v[10:11], s[44:45], v[30:31]
    s_waitcnt lgkmcnt(0)
    v_pk_fma_f32 v[28:29], v[0:1], s[44:45], v[28:29]
    v_mov_b32_dpp v7, v6 row_ror:8 row_mask:0xf bank_mask:0xf
    v_pk_fma_f32 v[30:31], v[2:3], s[44:45], v[30:31]
    v_exp_f32 v0, v28
    v_mfma_f32_16x16x16_bf16 v[12:15], v[16:17], v[6:7], 0
    ds_read_b128 v[48:51], v63 offset:57344
    v_exp_f32 v1, v29
    v_cvt_pk_bf16_f32 v18, v20, v21
    v_exp_f32 v2, v30
    v_cvt_pk_bf16_f32 v19, v22, v23
    v_cvt_pk_bf16_f32 v8, v0, v1
    v_exp_f32 v3, v31
    v_mfma_f32_16x16x16_bf16 v[20:23], v[18:19], v[6:7], 0
    ds_read_b128 v[52:55], v63 offset:61440
    v_cvt_pk_bf16_f32 v9, v2, v3
    v_mov_b32_dpp v10, v8 row_ror:8 row_mask:0xf bank_mask:0xf
    v_max3_f32 v4, |v28|, |v29|, |v30|
    v_mov_b32_dpp v11, v9 row_ror:8 row_mask:0xf bank_mask:0xf
    v_mfma_f32_16x16x32_bf16 v[0:3], v[24:27], v[6:9], 0
    v_max3_f32 v4, v4, |v31|, |v56|
    v_max_f32_e64 v4, v4, |v57|
    v_mfma_f32_16x16x32_bf16 v[12:15], v[40:43], v[8:11], v[12:15]
    v_cmp_nge_f32 vcc, s46, v4
    v_mfma_f32_16x16x32_bf16 v[20:23], v[44:47], v[8:11], v[20:23]
    v_add_f32_dpp v0, v0, v0 row_ror:8 row_mask:0xf bank_mask:0xf
    v_rcp_f32 v0, v0
    s_cbranch_vccnz cs_guard
cs_norm:
    v_mfma_f32_16x16x16_bf16 v[28:31], v[72:73], v[72:73], 0
    v_mul_f32 v12, v12, v0
    v_mul_f32 v13, v13, v0
    v_mul_f32 v14, v14, v0
    v_mul_f32 v15, v15, v0
    v_mul_f32_dpp v12, v20, v0 row_ror:8 row_mask:0xf bank_mask:0xc
    v_mul_f32_dpp v13, v21, v0 row_ror:8 row_mask:0xf bank_mask:0xc
    v_mul_f32_dpp v14, v22, v0 row_ror:8 row_mask:0xf bank_mask:0xc
    v_mul_f32_dpp v15, v23, v0 row_ror:8 row_mask:0xf bank_mask:0xc
    v_cvt_pk_bf16_f32 v12, v12, v13
    v_cvt_pk_bf16_f32 v13, v14, v15
    v_mfma_f32_16x16x16_bf16 v[8:11], v[72:73], v[72:73], 0
    ds_write_b64 v77, v[12:13]
    v_mfma_f32_16x16x16_bf16 v[4:7], v[72:73], v[72:73], 0
    ds_read_b128 v[0:3], v68
    v_mfma_f32_16x16x16_bf16 v[16:19], v[72:73], v[72:73], 0
    ds_read_b128 v[40:43], v63 offset:16384
    v_mfma_f32_16x16x16_bf16 v[20:23], v[72:73], v[72:73], 0
    ds_read_b128 v[44:47], v63 offset:20480
    s_waitcnt lgkmcnt(3)
    s_barrier
    ds_read_b128 v[24:27], v74
    ds_read_b128 v[12:15], v75
    ds_read_b128 v[56:59], v76
    s_waitcnt lgkmcnt(5)
    v_smfmac_f32_16x16x64_bf16 v[28:31], v[0:3], v[160:167], v60
    v_smfmac_f32_16x16x64_bf16 v[8:11], v[0:3], v[192:199], v60
    v_smfmac_f32_16x16x64_bf16 v[4:7], v[0:3], v[32:39], v60
    ds_read_b128 v[32:35], v63 offset:32768
    v_smfmac_f32_16x16x64_bf16 v[16:19], v[0:3], v[224:231], v60
    ds_read_b128 v[36:39], v63 offset:36864
    s_waitcnt lgkmcnt(3)
    v_smfmac_f32_16x16x64_bf16 v[28:31], v[24:27], v[168:175], v60
    v_smfmac_f32_16x16x64_bf16 v[4:7], v[12:15], v[48:55], v60
    ds_read_b128 v[48:51], v63 offset:24576
    v_smfmac_f32_16x16x64_bf16 v[28:31], v[12:15], v[176:183], v60
    ds_read_b128 v[52:55], v63 offset:28672
    s_waitcnt lgkmcnt(4)
    v_smfmac_f32_16x16x64_bf16 v[28:31], v[56:59], v[184:191], v60
    v_cvt_pk_bf16_f32 v4, v4, v5
    v_smfmac_f32_16x16x64_bf16 v[16:19], v[12:15], v[40:47], v60
    ds_read_b128 v[40:43], v63 offset:40960
    v_and_or_b32 v4, v4, -2, s30
    v_smfmac_f32_16x16x64_bf16 v[8:11], v[24:27], v[200:207], v60
    ds_read_b128 v[44:47], v63 offset:45056
    v_cvt_pk_bf16_f32 v5, v6, v7
    v_smfmac_f32_16x16x64_bf16 v[8:11], v[12:15], v[208:215], v60
    buffer_store_dwordx2 v[4:5], v67, s[4:7], s22 offen sc1
    v_cvt_pk_bf16_f32 v28, v28, v29
    v_smfmac_f32_16x16x64_bf16 v[8:11], v[56:59], v[216:223], v60
    v_and_or_b32 v28, v28, -2, s30
    v_smfmac_f32_16x16x64_bf16 v[16:19], v[24:27], v[232:239], v60
    v_cvt_pk_bf16_f32 v29, v30, v31
    s_waitcnt lgkmcnt(4)
    v_smfmac_f32_16x16x64_bf16 v[16:19], v[56:59], v[32:39], v60
    buffer_store_dwordx2 v[28:29], v66, s[4:7], s20 offen sc1
    v_cvt_pk_bf16_f32 v8, v8, v9
    s_waitcnt lgkmcnt(0)
    v_smfmac_f32_16x16x64_bf16 v[20:23], v[0:3], v[240:247], v60
    v_and_or_b32 v8, v8, -2, s30
    v_smfmac_f32_16x16x64_bf16 v[20:23], v[24:27], v[248:255], v60
    v_cvt_pk_bf16_f32 v9, v10, v11
    v_smfmac_f32_16x16x64_bf16 v[20:23], v[12:15], v[48:55], v60
    buffer_store_dwordx2 v[8:9], v66, s[4:7], s21 offen sc1
    v_cvt_pk_bf16_f32 v16, v16, v17
    v_smfmac_f32_16x16x64_bf16 v[20:23], v[56:59], v[40:47], v60
    v_and_or_b32 v16, v16, -2, s30
    v_cvt_pk_bf16_f32 v17, v18, v19
    buffer_store_dwordx2 v[16:17], v66, s[4:7], s38 offen sc1
    s_cmp_lg_u32 s13, 2
    s_nop 1
    v_cvt_pk_bf16_f32 v20, v20, v21
    v_and_or_b32 v20, v20, -2, s30
    v_cvt_pk_bf16_f32 v21, v22, v23
    buffer_store_dwordx2 v[20:21], v66, s[4:7], s39 offen sc1
    s_cbranch_scc1 cs_w013
    v_mov_b32 v21, -1
    s_mov_b64 exec, s[32:33]
    buffer_store_dword v21, v69, s[4:7], s18 offen sc1
    s_mov_b64 exec, -1
    s_mov_b32 s18, s43
    s_nop 15
    s_nop 15
    s_nop 15
    s_nop 15
    s_nop 15
    s_nop 15
    s_nop 15
    s_nop 15
    s_nop 15
    s_nop 15
    s_nop 15
    s_nop 15
    s_nop 0
    buffer_load_dwordx4 v[40:43], v65, s[4:7], s19 offen offset:0 sc1
    buffer_load_dwordx4 v[44:47], v65, s[4:7], s19 offen offset:1024 sc1
    buffer_load_dwordx4 v[48:51], v65, s[4:7], s19 offen offset:2048 sc1
    buffer_load_dwordx4 v[52:55], v65, s[4:7], s19 offen offset:3072 sc1
    ds_read_b128 v[56:59], v65 offset:10240
    s_add_u32 s28, s28, 1
    s_mov_b32 s14, s41
    s_add_u32 s23, s23, 524288
    s_add_u32 s24, s24, 524288
    s_min_u32 s24, s24, s47
    s_add_u32 s15, s14, 4096
    s_add_u32 s16, s14, 8192
    s_add_u32 s65, s65, 12288
    s_mov_b32 s40, 1
    v_mov_b64 v[0:1], 0
    v_mov_b64 v[2:3], 0
    v_mov_b64 v[4:5], 0
    v_mov_b64 v[6:7], 0
    v_mov_b64 v[8:9], 0
    v_mov_b64 v[10:11], 0
    v_mov_b64 v[12:13], 0
    v_mov_b64 v[14:15], 0
cs_chkF:
    v_mov_b32 v20, 0
    s_waitcnt vmcnt(3)
    s_waitcnt lgkmcnt(0)
    v_mfma_f32_16x16x32_bf16 v[28:31], v[40:43], v[56:59], 0
    v_bitop3_b32 v20, v20, v40, s30 bitop3:0xf6
    v_bitop3_b32 v20, v20, v42, s30 bitop3:0xf6
    s_waitcnt vmcnt(2)
    v_mfma_f32_16x16x32_bf16 v[28:31], v[44:47], v[56:59], v[28:31]
    v_bitop3_b32 v20, v20, v44, s30 bitop3:0xf6
    v_bitop3_b32 v20, v20, v46, s30 bitop3:0xf6
    s_waitcnt vmcnt(1)
    v_mfma_f32_16x16x32_bf16 v[28:31], v[48:51], v[56:59], v[28:31]
    v_bitop3_b32 v20, v20, v48, s30 bitop3:0xf6
    v_bitop3_b32 v20, v20, v50, s30 bitop3:0xf6
    s_waitcnt vmcnt(0)
    v_mfma_f32_16x16x32_bf16 v[28:31], v[52:55], v[56:59], v[28:31]
    v_bitop3_b32 v20, v20, v52, s30 bitop3:0xf6
    v_bitop3_b32 v20, v20, v54, s30 bitop3:0xf6
    v_and_b32 v20, s40, v20
    v_cmp_ne_u32 vcc, 0, v20
    s_cbranch_vccnz cs_spinF
    v_permlane32_swap_b32 v28, v30
    v_permlane32_swap_b32 v29, v31
    v_add_f32 v28, v28, v30
    v_add_f32 v30, v29, v31
    v_cvt_pk_bf16_f32 v28, v28, v30
    s_mov_b64 exec, s[32:33]
    buffer_store_dword v28, v69, s[4:7], s17 offen sc1
    s_mov_b64 exec, -1
    ds_read_b128 v[32:35], v62 offset:16384
    ds_read_b128 v[36:39], v62 offset:20480
    ds_read_b128 v[40:43], v61 offset:0
    ds_read_b128 v[44:47], v61 offset:4096
    ds_read_b128 v[48:51], v61 offset:8192
    ds_read_b128 v[52:55], v61 offset:12288
    s_nop 15
    s_nop 15
    s_nop 15
    s_nop 15
    s_nop 15
    s_nop 15
    s_nop 3
    buffer_load_dwordx4 v[24:27], v61, s[4:7], s14 offen sc1
    s_branch cs_loop2
cs_w013:
    ds_read_b128 v[56:59], v65 offset:10240
    ds_read_b128 v[32:35], v62 offset:16384
    ds_read_b128 v[36:39], v62 offset:20480
    ds_read_b128 v[40:43], v61 offset:0
    ds_read_b128 v[44:47], v61 offset:4096
    ds_read_b128 v[48:51], v61 offset:8192
    ds_read_b128 v[52:55], v61 offset:12288
    s_add_u32 s28, s28, 1
    s_mov_b32 s14, s41
    s_add_u32 s23, s23, 524288
    s_add_u32 s24, s24, 524288
    s_min_u32 s24, s24, s47
    s_add_u32 s15, s14, 4096
    s_add_u32 s16, s14, 8192
    s_add_u32 s65, s65, 12288
    s_mov_b32 s40, 1
    s_cmp_eq_u32 s64, 0
    s_cbranch_scc1 cs_w0
    v_mov_b32 v21, -1
    s_mov_b64 exec, s[32:33]
    buffer_store_dword v21, v69, s[4:7], s18 offen sc1
    s_mov_b64 exec, -1
    s_mov_b32 s18, s43
    s_cmp_eq_u32 s13, 1
    s_cbranch_scc1 cs_sx
    s_nop 15
    s_nop 15
    s_nop 15
    s_nop 15
    s_nop 15
    s_nop 15
    s_nop 15
    s_nop 15
    s_nop 15
    s_nop 15
    s_nop 15
    s_nop 15
    s_nop 7
cs_sx:
    buffer_load_dwordx4 v[0:3], v65, s[4:7], s19 offen offset:0 sc1
    buffer_load_dwordx4 v[4:7], v65, s[4:7], s19 offen offset:1024 sc1
    buffer_load_dwordx4 v[8:11], v65, s[4:7], s19 offen offset:2048 sc1
    buffer_load_dwordx4 v[12:15], v65, s[4:7], s19 offen offset:3072 sc1
cs_chkG:
    v_mov_b32 v20, 0
    s_waitcnt vmcnt(3)
    s_waitcnt lgkmcnt(6)
    v_mfma_f32_16x16x32_bf16 v[28:31], v[0:3], v[56:59], 0
    v_bitop3_b32 v20, v20, v0, s30 bitop3:0xf6
    v_bitop3_b32 v20, v20, v2, s30 bitop3:0xf6
    s_waitcnt vmcnt(2)
    v_mfma_f32_16x16x32_bf16 v[28:31], v[4:7], v[56:59], v[28:31]
    v_bitop3_b32 v20, v20, v4, s30 bitop3:0xf6
    v_bitop3_b32 v20, v20, v6, s30 bitop3:0xf6
    s_waitcnt vmcnt(1)
    v_mfma_f32_16x16x32_bf16 v[28:31], v[8:11], v[56:59], v[28:31]
    v_bitop3_b32 v20, v20, v8, s30 bitop3:0xf6
    v_bitop3_b32 v20, v20, v10, s30 bitop3:0xf6
    s_waitcnt vmcnt(0)
    v_mfma_f32_16x16x32_bf16 v[28:31], v[12:15], v[56:59], v[28:31]
    v_bitop3_b32 v20, v20, v12, s30 bitop3:0xf6
    v_bitop3_b32 v20, v20, v14, s30 bitop3:0xf6
    v_and_b32 v20, s40, v20
    v_cmp_ne_u32 vcc, 0, v20
    s_cbranch_vccnz cs_spinG
    v_permlane32_swap_b32 v28, v30
    v_permlane32_swap_b32 v29, v31
    v_add_f32 v28, v28, v30
    v_add_f32 v30, v29, v31
    s_cmp_eq_u32 s13, 3
    s_cbranch_scc1 cs_w3
    v_mov_b32 v29, v28
    v_mov_b32 v31, v30
    s_nop 0
    v_permlane16_swap_b32 v28, v29
    v_permlane16_swap_b32 v30, v31
    v_add_f32 v28, v28, v29
    v_add_f32 v30, v30, v31
cs_w3:
    v_cvt_pk_bf16_f32 v28, v28, v30
    s_mov_b64 exec, s[32:33]
    buffer_store_dword v28, v69, s[4:7], s17 offen sc1
    s_mov_b64 exec, -1
    buffer_load_dwordx4 v[24:27], v61, s[4:7], s14 offen sc1
    s_branch cs_loop
cs_w0:
    v_mov_b64 v[0:1], 0
    v_mov_b64 v[2:3], 0
    v_mov_b64 v[4:5], 0
    v_mov_b64 v[6:7], 0
    v_mov_b64 v[8:9], 0
    v_mov_b64 v[10:11], 0
    v_mov_b64 v[12:13], 0
    v_mov_b64 v[14:15], 0
    s_cmp_lg_u32 s28, 10
    s_cbranch_scc1 cs_nokv
    s_lshr_b32 s92, s12, 1
    s_lshl_b32 s92, s92, 8
    s_add_u32 s92, s92, 125833216
    v_bfe_u32 v28, v61, 4, 6
    v_min_u32 v28, 11, v28
    v_lshlrev_b32 v28, 2, v28
    s_add_u32 s93, s95, 63
    s_mov_b32 s94, 4194304
cs_kv1:
    buffer_load_dword v29, v28, s[4:7], s92 offen sc1
    s_sub_u32 s94, s94, 1
    s_cbranch_scc1 cs_kv1_go
    s_waitcnt vmcnt(0)
    v_subrev_u32 v29, s93, v29
    v_cmp_lt_u32 vcc, 64, v29
    s_cbranch_vccz cs_kv1_go
    s_sleep 2
    s_branch cs_kv1
cs_kv1_go:
cs_nokv:
    s_nop 15
    s_nop 15
    s_nop 15
    s_nop 15
    s_nop 15
    s_nop 15
    s_nop 15
    s_nop 15
    s_nop 15
    s_nop 15
    s_nop 15
    s_nop 15
    s_nop 15
    s_nop 15
    s_nop 15
    s_nop 15
    s_nop 15
    s_nop 15
    s_nop 15
    s_nop 15
    s_nop 15
    s_nop 15
    s_nop 15
    s_nop 15
    s_nop 15
    buffer_load_dwordx4 v[24:27], v61, s[4:7], s14 offen sc1
    s_branch cs_loop2
cs_spinF:
    buffer_load_dwordx4 v[40:43], v65, s[4:7], s19 offen offset:0 sc1
    buffer_load_dwordx4 v[44:47], v65, s[4:7], s19 offen offset:1024 sc1
    buffer_load_dwordx4 v[48:51], v65, s[4:7], s19 offen offset:2048 sc1
    buffer_load_dwordx4 v[52:55], v65, s[4:7], s19 offen offset:3072 sc1
    s_sub_u32 s29, s29, 1
    s_cmp_lt_i32 s29, 0
    s_cselect_b32 s40, 0, 1
    s_branch cs_chkF
cs_spinG:
    buffer_load_dwordx4 v[0:3], v65, s[4:7], s19 offen offset:0 sc1
    buffer_load_dwordx4 v[4:7], v65, s[4:7], s19 offen offset:1024 sc1
    buffer_load_dwordx4 v[8:11], v65, s[4:7], s19 offen offset:2048 sc1
    buffer_load_dwordx4 v[12:15], v65, s[4:7], s19 offen offset:3072 sc1
    s_sub_u32 s29, s29, 1
    s_cmp_lt_i32 s29, 0
    s_cselect_b32 s40, 0, 1
    s_branch cs_chkG
cs_guard:
    s_cbranch_scc0 cs_guard2
    buffer_store_dwordx4 v[16:19], v61, s[4:7], s26 offen sc1
    s_add_u32 s26, s26, 131072
    s_add_u32 s40, s95, 63
    v_mov_b32 v5, s40
    s_mov_b64 exec, 1
    buffer_store_dword v5, off, s[4:7], s27 sc1
    s_mov_b64 exec, -1
cs_guard2:
    s_nop 7
    v_max3_f32 v6, v28, v29, v30
    v_max3_f32 v7, v31, v56, v57
    v_max_f32 v6, v6, v7
    s_nop 1
    v_max_f32_dpp v6, v6, v6 row_ror:8 row_mask:0xf bank_mask:0xf
    v_mov_b32 v7, v6
    s_nop 1
    v_permlane32_swap_b32 v6, v7
    v_max_f32 v6, v6, v7
    v_mov_b32 v7, v6
    s_nop 1
    v_permlane16_swap_b32 v6, v7
    v_max_f32 v6, v6, v7
    v_sub_f32 v28, v28, v6
    v_sub_f32 v29, v29, v6
    v_sub_f32 v30, v30, v6
    v_sub_f32 v31, v31, v6
    v_sub_f32 v56, v56, v6
    v_sub_f32 v57, v57, v6
    v_exp_f32 v58, v56
    v_exp_f32 v59, v57
    s_nop 0
    v_cvt_pk_bf16_f32 v6, v58, v59
    s_nop 1
    v_mov_b32_dpp v7, v6 row_ror:8 row_mask:0xf bank_mask:0xf
    v_exp_f32 v0, v28
    s_nop 0
    v_mfma_f32_16x16x16_bf16 v[12:15], v[16:17], v[6:7], 0
    v_exp_f32 v1, v29
    v_exp_f32 v2, v30
    v_cvt_pk_bf16_f32 v8, v0, v1
    v_exp_f32 v3, v31
    v_mfma_f32_16x16x16_bf16 v[20:23], v[18:19], v[6:7], 0
    v_cvt_pk_bf16_f32 v9, v2, v3
    v_mov_b32_dpp v10, v8 row_ror:8 row_mask:0xf bank_mask:0xf
    v_max3_f32 v4, |v28|, |v29|, |v30|
    v_mov_b32_dpp v11, v9 row_ror:8 row_mask:0xf bank_mask:0xf
    v_mfma_f32_16x16x32_bf16 v[0:3], v[24:27], v[6:9], 0
    v_max3_f32 v4, v4, |v31|, |v56|
    v_max_f32_e64 v4, v4, |v57|
    v_mfma_f32_16x16x32_bf16 v[12:15], v[40:43], v[8:11], v[12:15]
    v_cmp_nge_f32 vcc, s46, v4
    v_mfma_f32_16x16x32_bf16 v[20:23], v[44:47], v[8:11], v[20:23]
    v_add_f32_dpp v0, v0, v0 row_ror:8 row_mask:0xf bank_mask:0xf
    v_rcp_f32 v0, v0
    s_nop 4
    s_branch cs_norm
cs_spin0:
    buffer_load_dwordx4 v[24:27], v61, s[4:7], s14 offen sc1
    s_sub_u32 s29, s29, 1
    s_cmp_lt_i32 s29, 0
    s_cbranch_scc0 cs_chk0
    s_waitcnt vmcnt(0)
    v_min_u32 v24, -2, v24
    v_min_u32 v25, -2, v25
    v_min_u32 v26, -2, v26
    v_min_u32 v27, -2, v27
    s_branch cs_chk0
cs_spin1:
    buffer_load_dwordx4 v[28:31], v61, s[4:7], s15 offen sc1
    buffer_load_dword v59, v56, s[4:7], s16 offen sc1
    s_sub_u32 s29, s29, 1
    s_cmp_lt_i32 s29, 0
    s_waitcnt vmcnt(0)
    v_max3_u32 v57, v28, v29, v30
    v_max3_u32 v57, v57, v31, v59
    v_cmp_eq_u32 vcc, -1, v57
    ds_write_b128 v62, v[28:31] offset:45056
    ds_write_b32 v58, v59
    s_waitcnt lgkmcnt(0)
    s_cbranch_scc1 cs_go1
    s_cbranch_vccnz cs_spin1
    s_branch cs_go1
cs_last:
    s_nop 1
    s_cmp_eq_u32 s28, 63
    s_cbranch_scc1 cs_last2
    s_mov_b64 exec, s[34:35]
    buffer_store_dwordx4 v[0:3], v61, s[4:7], s25 offen sc1
    s_mov_b64 exec, -1
    s_add_u32 s25, s25, 131072
    s_mov_b32 s46, 0xbf800000
    s_cmp_eq_u32 0, 0
    s_branch cs_back
cs_last2:
    s_waitcnt lgkmcnt(0)
    s_mov_b64 exec, s[34:35]
    buffer_store_dwordx4 v[0:3], v61, s[4:7], s25 offen sc1
    s_mov_b64 exec, -1
    s_add_u32 s40, s95, 64
    v_mov_b32 v40, s40
    v_smfmac_f32_16x16x64_bf16 v[16:19], v[52:55], a[240:247], v60
    v_smfmac_f32_16x16x64_bf16 v[20:23], v[52:55], a[248:255], v60
    s_nop 3
    v_cvt_pk_bf16_f32 v16, v16, v17
    v_cvt_pk_bf16_f32 v17, v18, v19
    s_nop 1
    v_cvt_pk_bf16_f32 v18, v20, v21
    v_cvt_pk_bf16_f32 v19, v22, v23
    buffer_store_dwordx4 v[16:19], v61, s[4:7], s26 offen sc1
    s_mov_b64 exec, 1
    buffer_store_dword v40, off, s[4:7], s27 sc1
    s_mov_b64 exec, -1
    s_endpgm
cs_dma:
    s_xor_b32 s74, s76, s81
    s_add_u32 m0, s74, s80
    s_add_u32 s76, s76, 4096
    buffer_load_dwordx4 v58, s[8:11], s78 offen lds
    s_add_u32 s78, s78, s79
    s_cmp_lt_u32 s76, s77
    s_cbranch_scc1 cs_dma
    s_setpc_b64 s[82:83]
L_helper:
    s_load_dwordx16 s[64:79], s[0:1], 64
    s_sub_u32 s33, s3, 1
    s_and_b32 s33, s33, 7
L_pool:
    s_lshl_b32 s35, s33, 2
    s_add_u32 s35, s35, 32
    s_mov_b32 s37, s35
    v_mov_b32 v250, 1
    v_mov_b32 v251, 163832
    v_cmp_eq_u32 vcc, 0, v0
    s_nop 0
    s_and_saveexec_b64 s[38:39], vcc
    s_cbranch_execz tk4
    buffer_atomic_add v250, off, s[96:99], s37 sc0
    s_waitcnt vmcnt(0)
    ds_write_b32 v251, v250
    s_waitcnt lgkmcnt(0)
tk4:
    s_mov_b64 exec, -1
    s_barrier
    ds_read_b32 v252, v251
    s_waitcnt lgkmcnt(0)
    v_readfirstlane_b32 s34, v252
    s_barrier
    s_nop 3
    s_mov_b32 s36, s33
    s_or_b32 s33, s34, s32
    s_cmp_lg_u32 s33, 0
    s_cbranch_scc1 L_helper1
    s_memrealtime s[90:91]
    s_waitcnt lgkmcnt(0)
    s_lshl_b32 s90, s90, 8
    s_or_b32 s90, s90, 1
    v_mov_b32 v250, s90
    v_mov_b32 v251, 0
    s_mov_b64 exec, 1
    buffer_atomic_cmpswap v[250:251], off, s[96:99], 0 offset:64
    s_mov_b64 exec, -1
L_helper1:
    s_cmp_ge_u32 s34, 32
    s_cbranch_scc1 L_qkv_next
    s_cmp_ge_u32 s36, 7
    s_cbranch_scc1 L_qkv_next
    s_max_u32 s37, s36, 4
    s_sub_u32 s37, s37, 4
    s_mul_i32 s37, s37, 6
    s_lshl_b32 s38, s36, 1
    s_add_u32 s38, s38, s37
    s_cmp_lt_u32 s36, 4
    s_cselect_b32 s39, 2, 8
    s_mul_i32 s36, s36, 30
    s_sub_u32 s36, s36, s37
    s_cmp_lt_u32 s34, s39
    s_cbranch_scc1 L_copy
    s_add_u32 s36, s36, s34
    s_sub_u32 s36, s36, s39
    s_mul_i32 s37, s36, 171
    s_lshr_b32 s37, s37, 10
    s_mul_i32 s38, s37, 6
    s_sub_u32 s36, s36, s38
    s_lshl_b32 s36, s36, 5
    s_add_u32 s36, s36, s37
    s_branch L_job
L_copy:
    s_add_u32 s36, s38, s34
    s_mul_i32 s36, s36, 11
    s_and_b32 s36, s36, 31
    s_cmp_ge_u32 s36, 27
    s_cbranch_scc1 L_qkv_next
    s_mul_i32 s33, s36, 57
    s_lshr_b32 s33, s33, 9
    s_mul_i32 s37, s33, 9
    s_sub_u32 s37, s36, s37
    s_lshl_b32 s36, s37, 2
    s_add_u32 s36, s36, 1
    s_min_u32 s36, s36, 31
    s_lshr_b32 s39, s52, 8
    s_sub_u32 s36, s36, s39
    s_and_b32 s36, s36, 31
    s_lshl_b32 s36, s36, 8
    s_mov_b32 s14, 4718592
    s_mov_b32 s15, 0x20000
    v_lshrrev_b32 v1, 4, v0
    v_lshlrev_b32 v1, 13, v1
    v_and_b32 v2, 15, v0
    v_lshl_add_u32 v1, v2, 4, v1
    v_lshlrev_b32 v2, 4, v0
    s_mul_i32 s40, s33, 2
    s_mul_i32 s39, s40, 49152
    s_lshl_b32 s41, s37, 19
    s_add_u32 s39, s39, s41
    s_add_u32 s39, s39, 96468992
    s_add_u32 s41, s40, 0
    s_cmp_lt_u32 s41, 3
    s_cselect_b64 s[12:13], s[52:53], s[54:55]
    s_cselect_b32 s42, 0, 3
    s_cmp_ge_u32 s41, 6
    s_cselect_b64 s[12:13], s[56:57], s[12:13]
    s_cselect_b32 s42, 6, s42
    s_sub_u32 s41, s41, s42
    s_mul_i32 s38, s41, 1572864
    s_add_u32 s38, s38, s36
    buffer_load_dwordx4 v[8:11], v1, s[12:15], s38 offen
    s_add_u32 s38, s38, 131072
    buffer_load_dwordx4 v[12:15], v1, s[12:15], s38 offen
    s_add_u32 s38, s38, 131072
    buffer_load_dwordx4 v[16:19], v1, s[12:15], s38 offen
    s_add_u32 s38, s38, 131072
    buffer_load_dwordx4 v[20:23], v1, s[12:15], s38 offen
    s_add_u32 s38, s38, 131072
    buffer_load_dwordx4 v[24:27], v1, s[12:15], s38 offen
    s_add_u32 s38, s38, 131072
    buffer_load_dwordx4 v[28:31], v1, s[12:15], s38 offen
    s_add_u32 s38, s38, 131072
    buffer_load_dwordx4 v[32:35], v1, s[12:15], s38 offen
    s_add_u32 s38, s38, 131072
    buffer_load_dwordx4 v[36:39], v1, s[12:15], s38 offen
    s_add_u32 s38, s38, 131072
    buffer_load_dwordx4 v[40:43], v1, s[12:15], s38 offen
    s_add_u32 s38, s38, 131072
    buffer_load_dwordx4 v[44:47], v1, s[12:15], s38 offen
    s_add_u32 s38, s38, 131072
    buffer_load_dwordx4 v[48:51], v1, s[12:15], s38 offen
    s_add_u32 s38, s38, 131072
    buffer_load_dwordx4 v[52:55], v1, s[12:15], s38 offen
    s_add_u32 s38, s38, 131072
    s_add_u32 s41, s40, 1
    s_cmp_lt_u32 s41, 3
    s_cselect_b64 s[12:13], s[52:53], s[54:55]
    s_cselect_b32 s42, 0, 3
    s_cmp_ge_u32 s41, 6
    s_cselect_b64 s[12:13], s[56:57], s[12:13]
    s_cselect_b32 s42, 6, s42
    s_sub_u32 s41, s41, s42
    s_mul_i32 s38, s41, 1572864
    s_add_u32 s38, s38, s36
    buffer_load_dwordx4 v[56:59], v1, s[12:15], s38 offen
    s_add_u32 s38, s38, 131072
    buffer_load_dwordx4 v[60:63], v1, s[12:15], s38 offen
    s_add_u32 s38, s38, 131072
    buffer_load_dwordx4 v[64:67], v1, s[12:15], s38 offen
    s_add_u32 s38, s38, 131072
    buffer_load_dwordx4 v[68:71], v1, s[12:15], s38 offen
    s_add_u32 s38, s38, 131072
    buffer_load_dwordx4 v[72:75], v1, s[12:15], s38 offen
    s_add_u32 s38, s38, 131072
    buffer_load_dwordx4 v[76:79], v1, s[12:15], s38 offen
    s_add_u32 s38, s38, 131072
    buffer_load_dwordx4 v[80:83], v1, s[12:15], s38 offen
    s_add_u32 s38, s38, 131072
    buffer_load_dwordx4 v[84:87], v1, s[12:15], s38 offen
    s_add_u32 s38, s38, 131072
    buffer_load_dwordx4 v[88:91], v1, s[12:15], s38 offen
    s_add_u32 s38, s38, 131072
    buffer_load_dwordx4 v[92:95], v1, s[12:15], s38 offen
    s_add_u32 s38, s38, 131072
    buffer_load_dwordx4 v[96:99], v1, s[12:15], s38 offen
    s_add_u32 s38, s38, 131072
    buffer_load_dwordx4 v[100:103], v1, s[12:15], s38 offen
    s_add_u32 s38, s38, 131072
    buffer_load_dword v3, off, s[96:99], 0 offset:64 sc1
    s_waitcnt vmcnt(0)
    buffer_store_dwordx4 v[8:11], v2, s[4:7], s39 offen sc1
    s_add_u32 s39, s39, 4096
    buffer_store_dwordx4 v[12:15], v2, s[4:7], s39 offen sc1
    s_add_u32 s39, s39, 4096
    buffer_store_dwordx4 v[16:19], v2, s[4:7], s39 offen sc1
    s_add_u32 s39, s39, 4096
    buffer_store_dwordx4 v[20:23], v2, s[4:7], s39 offen sc1
    s_add_u32 s39, s39, 4096
    buffer_store_dwordx4 v[24:27], v2, s[4:7], s39 offen sc1
    s_add_u32 s39, s39, 4096
    buffer_store_dwordx4 v[28:31], v2, s[4:7], s39 offen sc1
    s_add_u32 s39, s39, 4096
    buffer_store_dwordx4 v[32:35], v2, s[4:7], s39 offen sc1
    s_add_u32 s39, s39, 4096
    buffer_store_dwordx4 v[36:39], v2, s[4:7], s39 offen sc1
    s_add_u32 s39, s39, 4096
    buffer_store_dwordx4 v[40:43], v2, s[4:7], s39 offen sc1
    s_add_u32 s39, s39, 4096
    buffer_store_dwordx4 v[44:47], v2, s[4:7], s39 offen sc1
    s_add_u32 s39, s39, 4096
    buffer_store_dwordx4 v[48:51], v2, s[4:7], s39 offen sc1
    s_add_u32 s39, s39, 4096
    buffer_store_dwordx4 v[52:55], v2, s[4:7], s39 offen sc1
    s_add_u32 s39, s39, 4096
    buffer_store_dwordx4 v[56:59], v2, s[4:7], s39 offen sc1
    s_add_u32 s39, s39, 4096
    buffer_store_dwordx4 v[60:63], v2, s[4:7], s39 offen sc1
    s_add_u32 s39, s39, 4096
    buffer_store_dwordx4 v[64:67], v2, s[4:7], s39 offen sc1
    s_add_u32 s39, s39, 4096
    buffer_store_dwordx4 v[68:71], v2, s[4:7], s39 offen sc1
    s_add_u32 s39, s39, 4096
    buffer_store_dwordx4 v[72:75], v2, s[4:7], s39 offen sc1
    s_add_u32 s39, s39, 4096
    buffer_store_dwordx4 v[76:79], v2, s[4:7], s39 offen sc1
    s_add_u32 s39, s39, 4096
    buffer_store_dwordx4 v[80:83], v2, s[4:7], s39 offen sc1
    s_add_u32 s39, s39, 4096
    buffer_store_dwordx4 v[84:87], v2, s[4:7], s39 offen sc1
    s_add_u32 s39, s39, 4096
    buffer_store_dwordx4 v[88:91], v2, s[4:7], s39 offen sc1
    s_add_u32 s39, s39, 4096
    buffer_store_dwordx4 v[92:95], v2, s[4:7], s39 offen sc1
    s_add_u32 s39, s39, 4096
    buffer_store_dwordx4 v[96:99], v2, s[4:7], s39 offen sc1
    s_add_u32 s39, s39, 4096
    buffer_store_dwordx4 v[100:103], v2, s[4:7], s39 offen sc1
    s_add_u32 s39, s39, 4096
    v_readfirstlane_b32 s95, v3
    s_nop 4
    s_mov_b32 s88, 4194304
gn5:
    s_cmp_lg_u32 s95, 0
    s_cbranch_scc1 gn5x
    buffer_load_dword v3, off, s[96:99], 0 offset:64 sc1
    s_sub_u32 s88, s88, 1
    s_cbranch_scc1 gn5x
    s_waitcnt vmcnt(0)
    v_readfirstlane_b32 s95, v3
    s_nop 1
    s_branch gn5
gn5x:
    s_lshl_b32 s37, s37, 7
    s_lshl_b32 s36, s33, 2
    s_add_u32 s36, s36, s32
    s_lshl_b32 s36, s36, 2
    s_add_u32 s37, s37, s36
    s_add_u32 s37, s37, 125853696
    v_mov_b32 v3, s95
    s_waitcnt vmcnt(0)
    s_mov_b64 exec, 1
    buffer_store_dword v3, off, s[4:7], s37 sc1
    s_mov_b64 exec, -1
L_qkv_next:
    s_mov_b32 s37, 4
    v_mov_b32 v250, 1
    v_mov_b32 v251, 163832
    v_cmp_eq_u32 vcc, 0, v0
    s_nop 0
    s_and_saveexec_b64 s[38:39], vcc
    s_cbranch_execz tk6
    buffer_atomic_add v250, off, s[96:99], s37 sc0
    s_waitcnt vmcnt(0)
    ds_write_b32 v251, v250
    s_waitcnt lgkmcnt(0)
tk6:
    s_mov_b64 exec, -1
    s_barrier
    ds_read_b32 v252, v251
    s_waitcnt lgkmcnt(0)
    v_readfirstlane_b32 s36, v252
    s_barrier
    s_nop 3
    s_add_u32 s36, s36, 192
    s_cmp_ge_u32 s36, 320
    s_cbranch_scc1 L_ssm_next
L_job:
    s_and_b32 s17, s36, 15
    s_lshl_b32 s17, s17, 1
    s_bfe_u32 s16, s36, 0x10004
    s_lshr_b32 s19, s36, 5
    s_mul_i32 s33, s16, 6
    s_add_u32 s33, s33, s19
    s_add_u32 s16, s16, 1
    s_lshr_b32 s37, s36, 4
    s_sub_u32 s38, s37, 12
    s_cmp_ge_u32 s36, 192
    s_cselect_b32 s16, 0, s16
    s_cselect_b32 s19, s38, s19
    s_cselect_b32 s33, s37, s33
    s_cselect_b32 s20, 8, 6
    v_lshrrev_b32 v4, 6, v0
    s_nop 0
    v_readfirstlane_b32 s18, v4
    v_lshlrev_b32 v7, 4, v0
    v_and_b32 v4, 63, v0
    v_lshrrev_b32 v6, 2, v4
    v_lshlrev_b32 v6, 13, v6
    v_lshrrev_b32 v5, 4, v4
    v_and_b32 v5, 2, v5
    v_xor_b32 v5, v5, v4
    v_and_b32 v5, 3, v5
    v_lshl_add_u32 v6, v5, 4, v6
    v_lshrrev_b32 v24, 4, v4
    v_lshlrev_b32 v24, 9, v24
    v_bfe_u32 v5, v4, 2, 2
    v_lshl_add_u32 v24, v5, 6, v24
    v_bfe_u32 v5, v4, 4, 1
    v_lshl_add_u32 v24, v5, 5, v24
    v_and_b32 v5, 3, v4
    v_lshl_add_u32 v24, v5, 3, v24
    s_lshl_b32 s31, s18, 12
    v_add_u32 v24, s31, v24
    s_cmp_eq_u32 s16, 1
    s_cselect_b64 s[12:13], s[54:55], s[52:53]
    s_cmp_eq_u32 s16, 2
    s_cselect_b64 s[12:13], s[56:57], s[12:13]
    s_mov_b32 s14, 4718592
    s_mov_b32 s15, 0x20000
    s_lshl_b32 s28, s17, 8
    s_lshl_b32 s21, s18, 6
    s_add_u32 s28, s28, s21
    s_add_u32 s21, s28, 0
    s_add_u32 m0, s31, 40960
    s_nop 0
    buffer_load_dwordx4 v6, s[12:15], s21 offen lds
    s_add_u32 m0, s31, 41984
    s_add_u32 s21, s21, 131072
    buffer_load_dwordx4 v6, s[12:15], s21 offen lds
    s_add_u32 m0, s31, 43008
    s_add_u32 s21, s21, 131072
    buffer_load_dwordx4 v6, s[12:15], s21 offen lds
    s_add_u32 m0, s31, 44032
    s_add_u32 s21, s21, 131072
    buffer_load_dwordx4 v6, s[12:15], s21 offen lds
    s_add_u32 s21, s28, 256
    s_add_u32 m0, s31, 57344
    s_nop 0
    buffer_load_dwordx4 v6, s[12:15], s21 offen lds
    s_add_u32 m0, s31, 58368
    s_add_u32 s21, s21, 131072
    buffer_load_dwordx4 v6, s[12:15], s21 offen lds
    s_add_u32 m0, s31, 59392
    s_add_u32 s21, s21, 131072
    buffer_load_dwordx4 v6, s[12:15], s21 offen lds
    s_add_u32 m0, s31, 60416
    s_add_u32 s21, s21, 131072
    buffer_load_dwordx4 v6, s[12:15], s21 offen lds
    s_add_u32 s21, s28, 524288
    s_add_u32 m0, s31, 73728
    s_nop 0
    buffer_load_dwordx4 v6, s[12:15], s21 offen lds
    s_add_u32 m0, s31, 74752
    s_add_u32 s21, s21, 131072
    buffer_load_dwordx4 v6, s[12:15], s21 offen lds
    s_add_u32 m0, s31, 75776
    s_add_u32 s21, s21, 131072
    buffer_load_dwordx4 v6, s[12:15], s21 offen lds
    s_add_u32 m0, s31, 76800
    s_add_u32 s21, s21, 131072
    buffer_load_dwordx4 v6, s[12:15], s21 offen lds
    s_add_u32 s21, s28, 524544
    s_add_u32 m0, s31, 90112
    s_nop 0
    buffer_load_dwordx4 v6, s[12:15], s21 offen lds
    s_add_u32 m0, s31, 91136
    s_add_u32 s21, s21, 131072
    buffer_load_dwordx4 v6, s[12:15], s21 offen lds
    s_add_u32 m0, s31, 92160
    s_add_u32 s21, s21, 131072
    buffer_load_dwordx4 v6, s[12:15], s21 offen lds
    s_add_u32 m0, s31, 93184
    s_add_u32 s21, s21, 131072
    buffer_load_dwordx4 v6, s[12:15], s21 offen lds
    s_add_u32 s21, s28, 1048576
    s_add_u32 m0, s31, 106496
    s_nop 0
    buffer_load_dwordx4 v6, s[12:15], s21 offen lds
    s_add_u32 m0, s31, 107520
    s_add_u32 s21, s21, 131072
    buffer_load_dwordx4 v6, s[12:15], s21 offen lds
    s_add_u32 m0, s31, 108544
    s_add_u32 s21, s21, 131072
    buffer_load_dwordx4 v6, s[12:15], s21 offen lds
    s_add_u32 m0, s31, 109568
    s_add_u32 s21, s21, 131072
    buffer_load_dwordx4 v6, s[12:15], s21 offen lds
    s_add_u32 s21, s28, 1048832
    s_add_u32 m0, s31, 122880
    s_nop 0
    buffer_load_dwordx4 v6, s[12:15], s21 offen lds
    s_add_u32 m0, s31, 123904
    s_add_u32 s21, s21, 131072
    buffer_load_dwordx4 v6, s[12:15], s21 offen lds
    s_add_u32 m0, s31, 124928
    s_add_u32 s21, s21, 131072
    buffer_load_dwordx4 v6, s[12:15], s21 offen lds
    s_add_u32 m0, s31, 125952
    s_add_u32 s21, s21, 131072
    buffer_load_dwordx4 v6, s[12:15], s21 offen lds
    s_add_u32 s21, s28, 1572864
    s_add_u32 m0, s31, 139264
    s_nop 0
    buffer_load_dwordx4 v6, s[12:15], s21 offen lds
    s_add_u32 m0, s31, 140288
    s_add_u32 s21, s21, 131072
    buffer_load_dwordx4 v6, s[12:15], s21 offen lds
    s_add_u32 m0, s31, 141312
    s_add_u32 s21, s21, 131072
    buffer_load_dwordx4 v6, s[12:15], s21 offen lds
    s_add_u32 m0, s31, 142336
    s_add_u32 s21, s21, 131072
    buffer_load_dwordx4 v6, s[12:15], s21 offen lds
    v_and_b32 v5, 15, v4
    v_lshrrev_b32 v3, 4, v4
    v_lshrrev_b32 v2, 2, v5
    v_xor_b32 v3, v3, v2
    v_lshl_add_u32 v3, v5, 2, v3
    v_lshlrev_b32 v1, 4, v3
    v_lshrrev_b32 v5, 2, v4
    v_lshrrev_b32 v3, 4, v4
    v_and_b32 v4, 3, v4
    v_xor_b32 v4, v4, v3
    v_lshlrev_b32 v3, 3, v3
    v_and_b32 v5, 3, v5
    v_add_u32 v3, v3, v5
    v_mul_u32_u24 v2, 1152, v3
    v_lshl_add_u32 v2, v4, 4, v2
    s_mov_b32 s8, s48
    s_mov_b32 s9, s49
    s_mov_b32 s10, 2359296
    s_mov_b32 s11, 0x20000
    s_lshr_b32 s22, s18, 1
    s_mul_i32 s24, s22, 4608
    s_and_b32 s22, s18, 1
    s_mul_i32 s23, s22, 576
    s_add_u32 s24, s24, s23
    s_mul_i32 s25, s18, 9216
    s_mul_i32 s22, s19, 36864
    s_add_u32 s24, s24, s22
    s_mul_i32 s42, s20, 36864
    s_mov_b32 s27, 0
    s_add_u32 s23, s27, s25
    s_add_u32 m0, s23, 0
    s_nop 0
    buffer_load_dwordx4 v2, s[8:11], s24 offen offset:0 lds
    s_add_u32 m0, s23, 960
    s_nop 0
    buffer_load_dwordx4 v2, s[8:11], s24 offen offset:64 lds
    s_add_u32 m0, s23, 1920
    s_nop 0
    buffer_load_dwordx4 v2, s[8:11], s24 offen offset:128 lds
    s_add_u32 m0, s23, 2880
    s_nop 0
    buffer_load_dwordx4 v2, s[8:11], s24 offen offset:192 lds
    s_add_u32 m0, s23, 3840
    s_nop 0
    buffer_load_dwordx4 v2, s[8:11], s24 offen offset:256 lds
    s_add_u32 m0, s23, 4800
    s_nop 0
    buffer_load_dwordx4 v2, s[8:11], s24 offen offset:320 lds
    s_add_u32 m0, s23, 5760
    s_nop 0
    buffer_load_dwordx4 v2, s[8:11], s24 offen offset:384 lds
    s_add_u32 m0, s23, 6720
    s_nop 0
    buffer_load_dwordx4 v2, s[8:11], s24 offen offset:448 lds
    s_add_u32 m0, s23, 7680
    s_nop 0
    buffer_load_dwordx4 v2, s[8:11], s24 offen offset:512 lds
    s_add_u32 s24, s24, s42
    s_lshl_b32 s22, s19, 5
    s_add_u32 s22, s22, s17
    s_lshl_b32 s26, s22, 14
    s_mul_i32 s23, s18, 3072
    s_add_u32 s26, s26, s23
    s_lshl_b32 s23, s16, 11
    s_add_u32 s26, s26, s23
    s_add_u32 s26, s26, -2048
    s_lshl_b32 s22, s22, 13
    s_add_u32 s22, s22, 33554432
    s_cmp_eq_u32 s16, 0
    s_cselect_b32 s26, s22, s26
    s_cselect_b32 s40, 4, 1
    s_cselect_b32 s43, 1, 2
    s_lshl_b32 s40, s40, 10
    s_lshl_b32 s43, s43, 13
    s_lshl_b32 s41, s43, 5
    s_mul_i32 s41, s41, s20
    s_lshl_b32 s29, s17, 7
    s_lshl_b32 s22, s33, 2
    s_add_u32 s29, s29, s22
    s_add_u32 s29, s29, 125829120
    v_add_u32 v25, 40960, v24
    v_xor_b32 v26, 32, v25
    s_waitcnt vmcnt(33)
    ds_read_b64_tr_b16 v[64:65], v25 offset:0
    ds_read_b64_tr_b16 v[66:67], v25 offset:256
    ds_read_b64_tr_b16 v[136:137], v26 offset:0
    ds_read_b64_tr_b16 v[138:139], v26 offset:256
    ds_read_b64_tr_b16 v[68:69], v25 offset:2048
    ds_read_b64_tr_b16 v[70:71], v25 offset:2304
    ds_read_b64_tr_b16 v[140:141], v26 offset:2048
    ds_read_b64_tr_b16 v[142:143], v26 offset:2304
    s_waitcnt lgkmcnt(0)
    s_add_u32 s21, s28, 1573120
    s_add_u32 m0, s31, 40960
    s_nop 0
    buffer_load_dwordx4 v6, s[12:15], s21 offen lds
    s_add_u32 m0, s31, 41984
    s_add_u32 s21, s21, 131072
    buffer_load_dwordx4 v6, s[12:15], s21 offen lds
    s_add_u32 m0, s31, 43008
    s_add_u32 s21, s21, 131072
    buffer_load_dwordx4 v6, s[12:15], s21 offen lds
    s_add_u32 m0, s31, 44032
    s_add_u32 s21, s21, 131072
    buffer_load_dwordx4 v6, s[12:15], s21 offen lds
    v_add_u32 v25, 57344, v24
    v_xor_b32 v26, 32, v25
    s_waitcnt vmcnt(33)
    ds_read_b64_tr_b16 a[0:1], v25 offset:0
    ds_read_b64_tr_b16 a[2:3], v25 offset:256
    ds_read_b64_tr_b16 a[72:73], v26 offset:0
    ds_read_b64_tr_b16 a[74:75], v26 offset:256
    ds_read_b64_tr_b16 a[4:5], v25 offset:2048
    ds_read_b64_tr_b16 a[6:7], v25 offset:2304
    ds_read_b64_tr_b16 a[76:77], v26 offset:2048
    ds_read_b64_tr_b16 a[78:79], v26 offset:2304
    s_waitcnt lgkmcnt(0)
    s_add_u32 s21, s28, 2097152
    s_add_u32 m0, s31, 57344
    s_nop 0
    buffer_load_dwordx4 v6, s[12:15], s21 offen lds
    s_add_u32 m0, s31, 58368
    s_add_u32 s21, s21, 131072
    buffer_load_dwordx4 v6, s[12:15], s21 offen lds
    s_add_u32 m0, s31, 59392
    s_add_u32 s21, s21, 131072
    buffer_load_dwordx4 v6, s[12:15], s21 offen lds
    s_add_u32 m0, s31, 60416
    s_add_u32 s21, s21, 131072
    buffer_load_dwordx4 v6, s[12:15], s21 offen lds
    v_add_u32 v25, 73728, v24
    v_xor_b32 v26, 32, v25
    s_waitcnt vmcnt(33)
    ds_read_b64_tr_b16 v[72:73], v25 offset:0
    ds_read_b64_tr_b16 v[74:75], v25 offset:256
    ds_read_b64_tr_b16 v[144:145], v26 offset:0
    ds_read_b64_tr_b16 v[146:147], v26 offset:256
    ds_read_b64_tr_b16 v[76:77], v25 offset:2048
    ds_read_b64_tr_b16 v[78:79], v25 offset:2304
    ds_read_b64_tr_b16 v[148:149], v26 offset:2048
    ds_read_b64_tr_b16 v[150:151], v26 offset:2304
    s_waitcnt lgkmcnt(0)
    s_add_u32 s21, s28, 2097408
    s_add_u32 m0, s31, 73728
    s_nop 0
    buffer_load_dwordx4 v6, s[12:15], s21 offen lds
    s_add_u32 m0, s31, 74752
    s_add_u32 s21, s21, 131072
    buffer_load_dwordx4 v6, s[12:15], s21 offen lds
    s_add_u32 m0, s31, 75776
    s_add_u32 s21, s21, 131072
    buffer_load_dwordx4 v6, s[12:15], s21 offen lds
    s_add_u32 m0, s31, 76800
    s_add_u32 s21, s21, 131072
    buffer_load_dwordx4 v6, s[12:15], s21 offen lds
    v_add_u32 v25, 90112, v24
    v_xor_b32 v26, 32, v25
    s_waitcnt vmcnt(33)
    ds_read_b64_tr_b16 a[8:9], v25 offset:0
    ds_read_b64_tr_b16 a[10:11], v25 offset:256
    ds_read_b64_tr_b16 a[80:81], v26 offset:0
    ds_read_b64_tr_b16 a[82:83], v26 offset:256
    ds_read_b64_tr_b16 a[12:13], v25 offset:2048
    ds_read_b64_tr_b16 a[14:15], v25 offset:2304
    ds_read_b64_tr_b16 a[84:85], v26 offset:2048
    ds_read_b64_tr_b16 a[86:87], v26 offset:2304
    s_waitcnt lgkmcnt(0)
    s_add_u32 s21, s28, 2621440
    s_add_u32 m0, s31, 90112
    s_nop 0
    buffer_load_dwordx4 v6, s[12:15], s21 offen lds
    s_add_u32 m0, s31, 91136
    s_add_u32 s21, s21, 131072
    buffer_load_dwordx4 v6, s[12:15], s21 offen lds
    s_add_u32 m0, s31, 92160
    s_add_u32 s21, s21, 131072
    buffer_load_dwordx4 v6, s[12:15], s21 offen lds
    s_add_u32 m0, s31, 93184
    s_add_u32 s21, s21, 131072
    buffer_load_dwordx4 v6, s[12:15], s21 offen lds
    v_add_u32 v25, 106496, v24
    v_xor_b32 v26, 32, v25
    s_waitcnt vmcnt(33)
    ds_read_b64_tr_b16 v[80:81], v25 offset:0
    ds_read_b64_tr_b16 v[82:83], v25 offset:256
    ds_read_b64_tr_b16 v[152:153], v26 offset:0
    ds_read_b64_tr_b16 v[154:155], v26 offset:256
    ds_read_b64_tr_b16 v[84:85], v25 offset:2048
    ds_read_b64_tr_b16 v[86:87], v25 offset:2304
    ds_read_b64_tr_b16 v[156:157], v26 offset:2048
    ds_read_b64_tr_b16 v[158:159], v26 offset:2304
    s_waitcnt lgkmcnt(0)
    s_add_u32 s21, s28, 2621696
    s_add_u32 m0, s31, 106496
    s_nop 0
    buffer_load_dwordx4 v6, s[12:15], s21 offen lds
    s_add_u32 m0, s31, 107520
    s_add_u32 s21, s21, 131072
    buffer_load_dwordx4 v6, s[12:15], s21 offen lds
    s_add_u32 m0, s31, 108544
    s_add_u32 s21, s21, 131072
    buffer_load_dwordx4 v6, s[12:15], s21 offen lds
    s_add_u32 m0, s31, 109568
    s_add_u32 s21, s21, 131072
    buffer_load_dwordx4 v6, s[12:15], s21 offen lds
    v_add_u32 v25, 122880, v24
    v_xor_b32 v26, 32, v25
    s_waitcnt vmcnt(33)
    ds_read_b64_tr_b16 a[16:17], v25 offset:0
    ds_read_b64_tr_b16 a[18:19], v25 offset:256
    ds_read_b64_tr_b16 a[88:89], v26 offset:0
    ds_read_b64_tr_b16 a[90:91], v26 offset:256
    ds_read_b64_tr_b16 a[20:21], v25 offset:2048
    ds_read_b64_tr_b16 a[22:23], v25 offset:2304
    ds_read_b64_tr_b16 a[92:93], v26 offset:2048
    ds_read_b64_tr_b16 a[94:95], v26 offset:2304
    s_waitcnt lgkmcnt(0)
    s_add_u32 s21, s28, 3145728
    s_add_u32 m0, s31, 122880
    s_nop 0
    buffer_load_dwordx4 v6, s[12:15], s21 offen lds
    s_add_u32 m0, s31, 123904
    s_add_u32 s21, s21, 131072
    buffer_load_dwordx4 v6, s[12:15], s21 offen lds
    s_add_u32 m0, s31, 124928
    s_add_u32 s21, s21, 131072
    buffer_load_dwordx4 v6, s[12:15], s21 offen lds
    s_add_u32 m0, s31, 125952
    s_add_u32 s21, s21, 131072
    buffer_load_dwordx4 v6, s[12:15], s21 offen lds
    v_add_u32 v25, 139264, v24
    v_xor_b32 v26, 32, v25
    s_waitcnt vmcnt(33)
    ds_read_b64_tr_b16 v[88:89], v25 offset:0
    ds_read_b64_tr_b16 v[90:91], v25 offset:256
    ds_read_b64_tr_b16 v[160:161], v26 offset:0
    ds_read_b64_tr_b16 v[162:163], v26 offset:256
    ds_read_b64_tr_b16 v[92:93], v25 offset:2048
    ds_read_b64_tr_b16 v[94:95], v25 offset:2304
    ds_read_b64_tr_b16 v[164:165], v26 offset:2048
    ds_read_b64_tr_b16 v[166:167], v26 offset:2304
    s_waitcnt lgkmcnt(0)
    s_add_u32 s21, s28, 3145984
    s_add_u32 m0, s31, 139264
    s_nop 0
    buffer_load_dwordx4 v6, s[12:15], s21 offen lds
    s_add_u32 m0, s31, 140288
    s_add_u32 s21, s21, 131072
    buffer_load_dwordx4 v6, s[12:15], s21 offen lds
    s_add_u32 m0, s31, 141312
    s_add_u32 s21, s21, 131072
    buffer_load_dwordx4 v6, s[12:15], s21 offen lds
    s_add_u32 m0, s31, 142336
    s_add_u32 s21, s21, 131072
    buffer_load_dwordx4 v6, s[12:15], s21 offen lds
    v_add_u32 v25, 40960, v24
    v_xor_b32 v26, 32, v25
    s_waitcnt vmcnt(24)
    ds_read_b64_tr_b16 a[24:25], v25 offset:0
    ds_read_b64_tr_b16 a[26:27], v25 offset:256
    ds_read_b64_tr_b16 a[96:97], v26 offset:0
    ds_read_b64_tr_b16 a[98:99], v26 offset:256
    ds_read_b64_tr_b16 a[28:29], v25 offset:2048
    ds_read_b64_tr_b16 a[30:31], v25 offset:2304
    ds_read_b64_tr_b16 a[100:101], v26 offset:2048
    ds_read_b64_tr_b16 a[102:103], v26 offset:2304
    s_waitcnt lgkmcnt(0)
    s_add_u32 s21, s28, 3670016
    s_add_u32 m0, s31, 40960
    s_nop 0
    buffer_load_dwordx4 v6, s[12:15], s21 offen lds
    s_add_u32 m0, s31, 41984
    s_add_u32 s21, s21, 131072
    buffer_load_dwordx4 v6, s[12:15], s21 offen lds
    s_add_u32 m0, s31, 43008
    s_add_u32 s21, s21, 131072
    buffer_load_dwordx4 v6, s[12:15], s21 offen lds
    s_add_u32 m0, s31, 44032
    s_add_u32 s21, s21, 131072
    buffer_load_dwordx4 v6, s[12:15], s21 offen lds
    v_add_u32 v25, 57344, v24
    v_xor_b32 v26, 32, v25
    s_waitcnt vmcnt(24)
    ds_read_b64_tr_b16 v[96:97], v25 offset:0
    ds_read_b64_tr_b16 v[98:99], v25 offset:256
    ds_read_b64_tr_b16 v[168:169], v26 offset:0
    ds_read_b64_tr_b16 v[170:171], v26 offset:256
    ds_read_b64_tr_b16 v[100:101], v25 offset:2048
    ds_read_b64_tr_b16 v[102:103], v25 offset:2304
    ds_read_b64_tr_b16 v[172:173], v26 offset:2048
    ds_read_b64_tr_b16 v[174:175], v26 offset:2304
    s_waitcnt lgkmcnt(0)
    s_add_u32 s21, s28, 3670272
    s_add_u32 m0, s31, 57344
    s_nop 0
    buffer_load_dwordx4 v6, s[12:15], s21 offen lds
    s_add_u32 m0, s31, 58368
    s_add_u32 s21, s21, 131072
    buffer_load_dwordx4 v6, s[12:15], s21 offen lds
    s_add_u32 m0, s31, 59392
    s_add_u32 s21, s21, 131072
    buffer_load_dwordx4 v6, s[12:15], s21 offen lds
    s_add_u32 m0, s31, 60416
    s_add_u32 s21, s21, 131072
    buffer_load_dwordx4 v6, s[12:15], s21 offen lds
    v_add_u32 v25, 73728, v24
    v_xor_b32 v26, 32, v25
    s_waitcnt vmcnt(24)
    ds_read_b64_tr_b16 a[32:33], v25 offset:0
    ds_read_b64_tr_b16 a[34:35], v25 offset:256
    ds_read_b64_tr_b16 a[104:105], v26 offset:0
    ds_read_b64_tr_b16 a[106:107], v26 offset:256
    ds_read_b64_tr_b16 a[36:37], v25 offset:2048
    ds_read_b64_tr_b16 a[38:39], v25 offset:2304
    ds_read_b64_tr_b16 a[108:109], v26 offset:2048
    ds_read_b64_tr_b16 a[110:111], v26 offset:2304
    s_waitcnt lgkmcnt(0)
    s_add_u32 s21, s28, 4194304
    s_add_u32 m0, s31, 73728
    s_nop 0
    buffer_load_dwordx4 v6, s[12:15], s21 offen lds
    s_add_u32 m0, s31, 74752
    s_add_u32 s21, s21, 131072
    buffer_load_dwordx4 v6, s[12:15], s21 offen lds
    s_add_u32 m0, s31, 75776
    s_add_u32 s21, s21, 131072
    buffer_load_dwordx4 v6, s[12:15], s21 offen lds
    s_add_u32 m0, s31, 76800
    s_add_u32 s21, s21, 131072
    buffer_load_dwordx4 v6, s[12:15], s21 offen lds
    v_add_u32 v25, 90112, v24
    v_xor_b32 v26, 32, v25
    s_waitcnt vmcnt(24)
    ds_read_b64_tr_b16 v[104:105], v25 offset:0
    ds_read_b64_tr_b16 v[106:107], v25 offset:256
    ds_read_b64_tr_b16 v[176:177], v26 offset:0
    ds_read_b64_tr_b16 v[178:179], v26 offset:256
    ds_read_b64_tr_b16 v[108:109], v25 offset:2048
    ds_read_b64_tr_b16 v[110:111], v25 offset:2304
    ds_read_b64_tr_b16 v[180:181], v26 offset:2048
    ds_read_b64_tr_b16 v[182:183], v26 offset:2304
    s_waitcnt lgkmcnt(0)
    v_mov_b32 v28, s95
    s_cmp_lg_u32 s95, 0
    s_cbranch_scc1 L_ne
    buffer_load_dword v28, off, s[96:99], 0 offset:64 sc1
    s_cmp_ge_u32 s36, 192
    s_cbranch_scc1 L_ne
    s_mul_i32 s37, s36, 24576
    s_mov_b32 s46, 4718592
    s_mov_b32 s47, 0x20000
    v_lshlrev_b32 v29, 7, v0
    v_min_u32 v29, 24448, v29
    s_mov_b64 s[44:45], s[58:59]
    buffer_load_dword v30, v29, s[44:47], s37 offen
    s_mov_b64 s[44:45], s[52:53]
    buffer_load_dword v30, v29, s[44:47], s37 offen
L_ne:
    s_add_u32 s21, s28, 4194560
    s_add_u32 m0, s31, 90112
    s_nop 0
    buffer_load_dwordx4 v6, s[12:15], s21 offen lds
    s_add_u32 m0, s31, 91136
    s_add_u32 s21, s21, 131072
    buffer_load_dwordx4 v6, s[12:15], s21 offen lds
    s_add_u32 m0, s31, 92160
    s_add_u32 s21, s21, 131072
    buffer_load_dwordx4 v6, s[12:15], s21 offen lds
    s_add_u32 m0, s31, 93184
    s_add_u32 s21, s21, 131072
    buffer_load_dwordx4 v6, s[12:15], s21 offen lds
    v_add_u32 v25, 106496, v24
    v_xor_b32 v26, 32, v25
    s_waitcnt vmcnt(24)
    ds_read_b64_tr_b16 a[40:41], v25 offset:0
    ds_read_b64_tr_b16 a[42:43], v25 offset:256
    ds_read_b64_tr_b16 a[112:113], v26 offset:0
    ds_read_b64_tr_b16 a[114:115], v26 offset:256
    ds_read_b64_tr_b16 a[44:45], v25 offset:2048
    ds_read_b64_tr_b16 a[46:47], v25 offset:2304
    ds_read_b64_tr_b16 a[116:117], v26 offset:2048
    ds_read_b64_tr_b16 a[118:119], v26 offset:2304
    s_waitcnt lgkmcnt(0)
    v_add_u32 v25, 122880, v24
    v_xor_b32 v26, 32, v25
    s_waitcnt vmcnt(20)
    ds_read_b64_tr_b16 v[112:113], v25 offset:0
    ds_read_b64_tr_b16 v[114:115], v25 offset:256
    ds_read_b64_tr_b16 v[184:185], v26 offset:0
    ds_read_b64_tr_b16 v[186:187], v26 offset:256
    ds_read_b64_tr_b16 v[116:117], v25 offset:2048
    ds_read_b64_tr_b16 v[118:119], v25 offset:2304
    ds_read_b64_tr_b16 v[188:189], v26 offset:2048
    ds_read_b64_tr_b16 v[190:191], v26 offset:2304
    s_waitcnt lgkmcnt(0)
    v_add_u32 v25, 139264, v24
    v_xor_b32 v26, 32, v25
    s_waitcnt vmcnt(16)
    ds_read_b64_tr_b16 a[48:49], v25 offset:0
    ds_read_b64_tr_b16 a[50:51], v25 offset:256
    ds_read_b64_tr_b16 a[120:121], v26 offset:0
    ds_read_b64_tr_b16 a[122:123], v26 offset:256
    ds_read_b64_tr_b16 a[52:53], v25 offset:2048
    ds_read_b64_tr_b16 a[54:55], v25 offset:2304
    ds_read_b64_tr_b16 a[124:125], v26 offset:2048
    ds_read_b64_tr_b16 a[126:127], v26 offset:2304
    s_waitcnt lgkmcnt(0)
    v_add_u32 v25, 40960, v24
    v_xor_b32 v26, 32, v25
    s_waitcnt vmcnt(12)
    ds_read_b64_tr_b16 v[120:121], v25 offset:0
    ds_read_b64_tr_b16 v[122:123], v25 offset:256
    ds_read_b64_tr_b16 v[192:193], v26 offset:0
    ds_read_b64_tr_b16 v[194:195], v26 offset:256
    ds_read_b64_tr_b16 v[124:125], v25 offset:2048
    ds_read_b64_tr_b16 v[126:127], v25 offset:2304
    ds_read_b64_tr_b16 v[196:197], v26 offset:2048
    ds_read_b64_tr_b16 v[198:199], v26 offset:2304
    s_waitcnt lgkmcnt(0)
    v_add_u32 v25, 57344, v24
    v_xor_b32 v26, 32, v25
    s_waitcnt vmcnt(8)
    ds_read_b64_tr_b16 a[56:57], v25 offset:0
    ds_read_b64_tr_b16 a[58:59], v25 offset:256
    ds_read_b64_tr_b16 a[128:129], v26 offset:0
    ds_read_b64_tr_b16 a[130:131], v26 offset:256
    ds_read_b64_tr_b16 a[60:61], v25 offset:2048
    ds_read_b64_tr_b16 a[62:63], v25 offset:2304
    ds_read_b64_tr_b16 a[132:133], v26 offset:2048
    ds_read_b64_tr_b16 a[134:135], v26 offset:2304
    s_waitcnt lgkmcnt(0)
    v_add_u32 v25, 73728, v24
    v_xor_b32 v26, 32, v25
    s_waitcnt vmcnt(4)
    ds_read_b64_tr_b16 v[128:129], v25 offset:0
    ds_read_b64_tr_b16 v[130:131], v25 offset:256
    ds_read_b64_tr_b16 v[200:201], v26 offset:0
    ds_read_b64_tr_b16 v[202:203], v26 offset:256
    ds_read_b64_tr_b16 v[132:133], v25 offset:2048
    ds_read_b64_tr_b16 v[134:135], v25 offset:2304
    ds_read_b64_tr_b16 v[204:205], v26 offset:2048
    ds_read_b64_tr_b16 v[206:207], v26 offset:2304
    s_waitcnt lgkmcnt(0)
    v_add_u32 v25, 90112, v24
    v_xor_b32 v26, 32, v25
    s_waitcnt vmcnt(0)
    ds_read_b64_tr_b16 a[64:65], v25 offset:0
    ds_read_b64_tr_b16 a[66:67], v25 offset:256
    ds_read_b64_tr_b16 a[136:137], v26 offset:0
    ds_read_b64_tr_b16 a[138:139], v26 offset:256
    ds_read_b64_tr_b16 a[68:69], v25 offset:2048
    ds_read_b64_tr_b16 a[70:71], v25 offset:2304
    ds_read_b64_tr_b16 a[140:141], v26 offset:2048
    ds_read_b64_tr_b16 a[142:143], v26 offset:2304
    s_waitcnt lgkmcnt(0)
    s_lshr_b32 s21, s17, 3
    s_cmp_eq_u32 s21, 3
    s_cselect_b32 s21, 1, s33
    s_cmp_lg_u32 s21, 0
    s_cbranch_scc1 qk_noclr
    v_mov_b32 v8, -1
    v_mov_b32 v9, -1
    v_mov_b32 v10, -1
    v_mov_b32 v11, -1
    v_lshrrev_b32 v25, 6, v0
    v_mul_u32_u24 v25, 11264, v25
    v_add_u32 v25, v25, v7
    s_lshl_b32 s21, s17, 9
    s_add_u32 s21, s21, 90177536
    s_add_u32 s22, s21, 786432
qk_clr:
    buffer_store_dwordx4 v[8:11], v25, s[4:7], s21 offen sc1
    s_add_u32 s21, s21, 49152
    s_cmp_lt_u32 s21, s22
    s_cbranch_scc1 qk_clr
qk_noclr:
    s_and_b32 s21, s33, -2
    s_cmp_lg_u32 s21, 2
    s_cbranch_scc1 qk_noclr2
    v_mov_b32 v8, -1
    v_mov_b32 v9, -1
    v_mov_b32 v10, -1
    v_mov_b32 v11, -1
    s_add_u32 s21, s33, 60
    s_lshl_b32 s23, s17, 12
    s_lshl_b32 s22, s21, 17
    s_add_u32 s22, s22, s23
    s_add_u32 s22, s22, 71303168
    buffer_store_dwordx4 v[8:11], v7, s[4:7], s22 offen sc1
    s_add_u32 s22, s22, 4096
    buffer_store_dwordx4 v[8:11], v7, s[4:7], s22 offen sc1
    s_lshl_b32 s22, s21, 17
    s_add_u32 s22, s22, s23
    s_add_u32 s22, s22, 80740352
    buffer_store_dwordx4 v[8:11], v7, s[4:7], s22 offen sc1
    s_add_u32 s22, s22, 4096
    buffer_store_dwordx4 v[8:11], v7, s[4:7], s22 offen sc1
    s_lshl_b32 s22, s21, 18
    s_add_u32 s22, s22, s23
    s_add_u32 s22, s22, 50331648
    buffer_store_dwordx4 v[8:11], v7, s[4:7], s22 offen sc1
    s_add_u32 s22, s22, 4096
    buffer_store_dwordx4 v[8:11], v7, s[4:7], s22 offen sc1
    s_lshl_b32 s22, s21, 18
    s_add_u32 s22, s22, s23
    s_add_u32 s22, s22, 50462720
    buffer_store_dwordx4 v[8:11], v7, s[4:7], s22 offen sc1
    s_add_u32 s22, s22, 4096
    buffer_store_dwordx4 v[8:11], v7, s[4:7], s22 offen sc1
qk_noclr2:
    v_readfirstlane_b32 s95, v28
    s_nop 4
    s_mov_b32 s88, 4194304
gn7:
    s_cmp_lg_u32 s95, 0
    s_cbranch_scc1 gn7x
    buffer_load_dword v25, off, s[96:99], 0 offset:64 sc1
    s_sub_u32 s88, s88, 1
    s_cbranch_scc1 gn7x
    s_waitcnt vmcnt(0)
    v_readfirstlane_b32 s95, v25
    s_nop 1
    s_branch gn7
gn7x:
    s_barrier
    s_mov_b32 s27, 36864
    s_add_u32 s23, s27, s25
    s_add_u32 m0, s23, 0
    s_nop 0
    buffer_load_dwordx4 v2, s[8:11], s24 offen offset:0 lds
    s_add_u32 m0, s23, 960
    s_nop 0
    buffer_load_dwordx4 v2, s[8:11], s24 offen offset:64 lds
    s_add_u32 m0, s23, 1920
    s_nop 0
    buffer_load_dwordx4 v2, s[8:11], s24 offen offset:128 lds
    s_add_u32 m0, s23, 2880
    s_nop 0
    buffer_load_dwordx4 v2, s[8:11], s24 offen offset:192 lds
    s_add_u32 m0, s23, 3840
    s_nop 0
    buffer_load_dwordx4 v2, s[8:11], s24 offen offset:256 lds
    s_add_u32 m0, s23, 4800
    s_nop 0
    buffer_load_dwordx4 v2, s[8:11], s24 offen offset:320 lds
    s_add_u32 m0, s23, 5760
    s_nop 0
    buffer_load_dwordx4 v2, s[8:11], s24 offen offset:384 lds
    s_add_u32 m0, s23, 6720
    s_nop 0
    buffer_load_dwordx4 v2, s[8:11], s24 offen offset:448 lds
    s_add_u32 m0, s23, 7680
    s_nop 0
    buffer_load_dwordx4 v2, s[8:11], s24 offen offset:512 lds
    s_add_u32 s24, s24, s42
    s_mov_b32 s27, 0
    s_mov_b32 s30, s95
    s_cmp_eq_u32 s18, 0
    s_cselect_b32 s34, 1, 0
    s_mov_b32 s35, 0
    s_mov_b32 s31, 0x80000000
    v_mov_b32 v3, v1
    ds_read_b128 v[32:35], v3 offset:0
    ds_read_b128 v[36:39], v3 offset:18432
    ds_read_b128 v[40:43], v3 offset:1024
    ds_read_b128 v[44:47], v3 offset:19456
    s_cmp_eq_u32 s16, 2
    s_cbranch_scc1 qk_vloop
qk_loop:
    s_add_u32 s22, s27, 73728
    s_sub_u32 s21, s22, 147456
    s_cselect_b32 s22, s22, s21
    s_add_u32 s27, s27, 36864
    s_cmp_eq_u32 s27, 147456
    s_cselect_b32 s27, 0, s27
    s_waitcnt lgkmcnt(2)
    v_cvt_pk_bf16_f32 v8, v208, v209
    v_cvt_pk_bf16_f32 v9, v210, v211
    v_mfma_f32_16x16x32_bf16 v[208:211], v[64:67], v[32:35], 0
    ds_read_b128 v[48:51], v3 offset:2048
    ds_read_b128 v[52:55], v3 offset:20480
    v_cvt_pk_bf16_f32 v10, v212, v213
    v_cvt_pk_bf16_f32 v11, v214, v215
    v_mfma_f32_16x16x32_bf16 v[212:215], v[136:139], v[32:35], 0
    v_cvt_pk_bf16_f32 v12, v216, v217
    v_cvt_pk_bf16_f32 v13, v218, v219
    v_mfma_f32_16x16x32_bf16 v[216:219], v[64:67], v[36:39], 0
    v_cvt_pk_bf16_f32 v14, v220, v221
    v_cvt_pk_bf16_f32 v15, v222, v223
    v_mfma_f32_16x16x32_bf16 v[220:223], v[136:139], v[36:39], 0
    v_cvt_pk_bf16_f32 v16, v224, v225
    v_cvt_pk_bf16_f32 v17, v226, v227
    v_mfma_f32_16x16x32_bf16 v[224:227], a[0:3], v[32:35], 0
    v_cvt_pk_bf16_f32 v18, v228, v229
    v_cvt_pk_bf16_f32 v19, v230, v231
    v_mfma_f32_16x16x32_bf16 v[228:231], a[72:75], v[32:35], 0
    v_cvt_pk_bf16_f32 v20, v232, v233
    v_cvt_pk_bf16_f32 v21, v234, v235
    v_mfma_f32_16x16x32_bf16 v[232:235], a[0:3], v[36:39], 0
    v_cvt_pk_bf16_f32 v22, v236, v237
    v_cvt_pk_bf16_f32 v23, v238, v239
    v_mfma_f32_16x16x32_bf16 v[236:239], a[72:75], v[36:39], 0
    s_waitcnt lgkmcnt(2)
    v_mfma_f32_16x16x32_bf16 v[208:211], v[68:71], v[40:43], v[208:211]
    ds_read_b128 v[32:35], v3 offset:3072
    ds_read_b128 v[36:39], v3 offset:21504
    v_mfma_f32_16x16x32_bf16 v[212:215], v[140:143], v[40:43], v[212:215]
    v_mfma_f32_16x16x32_bf16 v[216:219], v[68:71], v[44:47], v[216:219]
    s_mov_b32 s28, s31
    buffer_store_dwordx4 v[8:11], v7, s[4:7], s28 offen sc1
    v_mfma_f32_16x16x32_bf16 v[220:223], v[140:143], v[44:47], v[220:223]
    v_mfma_f32_16x16x32_bf16 v[224:227], a[4:7], v[40:43], v[224:227]
    v_mfma_f32_16x16x32_bf16 v[228:231], a[76:79], v[40:43], v[228:231]
    v_mfma_f32_16x16x32_bf16 v[232:235], a[4:7], v[44:47], v[232:235]
    v_mfma_f32_16x16x32_bf16 v[236:239], a[76:79], v[44:47], v[236:239]
    s_waitcnt lgkmcnt(2)
    v_mfma_f32_16x16x32_bf16 v[208:211], v[72:75], v[48:51], v[208:211]
    ds_read_b128 v[40:43], v3 offset:4096
    ds_read_b128 v[44:47], v3 offset:22528
    v_mfma_f32_16x16x32_bf16 v[212:215], v[144:147], v[48:51], v[212:215]
    v_mfma_f32_16x16x32_bf16 v[216:219], v[72:75], v[52:55], v[216:219]
    s_add_u32 s28, s28, s40
    buffer_store_dwordx4 v[12:15], v7, s[4:7], s28 offen sc1
    v_mfma_f32_16x16x32_bf16 v[220:223], v[144:147], v[52:55], v[220:223]
    v_mfma_f32_16x16x32_bf16 v[224:227], a[8:11], v[48:51], v[224:227]
    v_mfma_f32_16x16x32_bf16 v[228:231], a[80:83], v[48:51], v[228:231]
    v_mfma_f32_16x16x32_bf16 v[232:235], a[8:11], v[52:55], v[232:235]
    v_mfma_f32_16x16x32_bf16 v[236:239], a[80:83], v[52:55], v[236:239]
    s_waitcnt lgkmcnt(2)
    v_mfma_f32_16x16x32_bf16 v[208:211], v[76:79], v[32:35], v[208:211]
    ds_read_b128 v[48:51], v3 offset:5120
    ds_read_b128 v[52:55], v3 offset:23552
    v_mfma_f32_16x16x32_bf16 v[212:215], v[148:151], v[32:35], v[212:215]
    v_mfma_f32_16x16x32_bf16 v[216:219], v[76:79], v[36:39], v[216:219]
    s_add_u32 s28, s31, s43
    buffer_store_dwordx4 v[16:19], v7, s[4:7], s28 offen sc1
    v_mfma_f32_16x16x32_bf16 v[220:223], v[148:151], v[36:39], v[220:223]
    v_mfma_f32_16x16x32_bf16 v[224:227], a[12:15], v[32:35], v[224:227]
    v_mfma_f32_16x16x32_bf16 v[228:231], a[84:87], v[32:35], v[228:231]
    v_mfma_f32_16x16x32_bf16 v[232:235], a[12:15], v[36:39], v[232:235]
    v_mfma_f32_16x16x32_bf16 v[236:239], a[84:87], v[36:39], v[236:239]
    s_waitcnt lgkmcnt(2)
    v_mfma_f32_16x16x32_bf16 v[208:211], v[80:83], v[40:43], v[208:211]
    ds_read_b128 v[32:35], v3 offset:6144
    ds_read_b128 v[36:39], v3 offset:24576
    v_mfma_f32_16x16x32_bf16 v[212:215], v[152:155], v[40:43], v[212:215]
    v_mfma_f32_16x16x32_bf16 v[216:219], v[80:83], v[44:47], v[216:219]
    s_add_u32 s28, s28, s40
    buffer_store_dwordx4 v[20:23], v7, s[4:7], s28 offen sc1
    v_mfma_f32_16x16x32_bf16 v[220:223], v[152:155], v[44:47], v[220:223]
    v_mfma_f32_16x16x32_bf16 v[224:227], a[16:19], v[40:43], v[224:227]
    v_mfma_f32_16x16x32_bf16 v[228:231], a[88:91], v[40:43], v[228:231]
    v_mfma_f32_16x16x32_bf16 v[232:235], a[16:19], v[44:47], v[232:235]
    v_mfma_f32_16x16x32_bf16 v[236:239], a[88:91], v[44:47], v[236:239]
    s_waitcnt lgkmcnt(2)
    v_mfma_f32_16x16x32_bf16 v[208:211], v[84:87], v[48:51], v[208:211]
    ds_read_b128 v[40:43], v3 offset:7168
    ds_read_b128 v[44:47], v3 offset:25600
    v_mfma_f32_16x16x32_bf16 v[212:215], v[156:159], v[48:51], v[212:215]
    v_mfma_f32_16x16x32_bf16 v[216:219], v[84:87], v[52:55], v[216:219]
    s_add_u32 s23, s22, s25
    s_add_u32 m0, s23, 0
    s_nop 0
    buffer_load_dwordx4 v2, s[8:11], s24 offen offset:0 lds
    v_mfma_f32_16x16x32_bf16 v[220:223], v[156:159], v[52:55], v[220:223]
    v_mfma_f32_16x16x32_bf16 v[224:227], a[20:23], v[48:51], v[224:227]
    v_mfma_f32_16x16x32_bf16 v[228:231], a[92:95], v[48:51], v[228:231]
    v_mfma_f32_16x16x32_bf16 v[232:235], a[20:23], v[52:55], v[232:235]
    v_mfma_f32_16x16x32_bf16 v[236:239], a[92:95], v[52:55], v[236:239]
    s_waitcnt lgkmcnt(2)
    v_mfma_f32_16x16x32_bf16 v[208:211], v[88:91], v[32:35], v[208:211]
    ds_read_b128 v[48:51], v3 offset:8192
    ds_read_b128 v[52:55], v3 offset:26624
    v_mfma_f32_16x16x32_bf16 v[212:215], v[160:163], v[32:35], v[212:215]
    v_mfma_f32_16x16x32_bf16 v[216:219], v[88:91], v[36:39], v[216:219]
    s_add_u32 m0, s23, 960
    s_nop 0
    buffer_load_dwordx4 v2, s[8:11], s24 offen offset:64 lds
    v_mfma_f32_16x16x32_bf16 v[220:223], v[160:163], v[36:39], v[220:223]
    v_mfma_f32_16x16x32_bf16 v[224:227], a[24:27], v[32:35], v[224:227]
    v_mfma_f32_16x16x32_bf16 v[228:231], a[96:99], v[32:35], v[228:231]
    v_mfma_f32_16x16x32_bf16 v[232:235], a[24:27], v[36:39], v[232:235]
    v_mfma_f32_16x16x32_bf16 v[236:239], a[96:99], v[36:39], v[236:239]
    s_waitcnt lgkmcnt(2)
    v_mfma_f32_16x16x32_bf16 v[208:211], v[92:95], v[40:43], v[208:211]
    ds_read_b128 v[32:35], v3 offset:9216
    ds_read_b128 v[36:39], v3 offset:27648
    v_mfma_f32_16x16x32_bf16 v[212:215], v[164:167], v[40:43], v[212:215]
    v_mfma_f32_16x16x32_bf16 v[216:219], v[92:95], v[44:47], v[216:219]
    s_add_u32 m0, s23, 1920
    s_nop 0
    buffer_load_dwordx4 v2, s[8:11], s24 offen offset:128 lds
    v_mfma_f32_16x16x32_bf16 v[220:223], v[164:167], v[44:47], v[220:223]
    v_mfma_f32_16x16x32_bf16 v[224:227], a[28:31], v[40:43], v[224:227]
    v_mfma_f32_16x16x32_bf16 v[228:231], a[100:103], v[40:43], v[228:231]
    v_mfma_f32_16x16x32_bf16 v[232:235], a[28:31], v[44:47], v[232:235]
    v_mfma_f32_16x16x32_bf16 v[236:239], a[100:103], v[44:47], v[236:239]
    s_waitcnt lgkmcnt(2)
    v_mfma_f32_16x16x32_bf16 v[208:211], v[96:99], v[48:51], v[208:211]
    ds_read_b128 v[40:43], v3 offset:10240
    ds_read_b128 v[44:47], v3 offset:28672
    v_mfma_f32_16x16x32_bf16 v[212:215], v[168:171], v[48:51], v[212:215]
    v_mfma_f32_16x16x32_bf16 v[216:219], v[96:99], v[52:55], v[216:219]
    s_add_u32 m0, s23, 2880
    s_nop 0
    buffer_load_dwordx4 v2, s[8:11], s24 offen offset:192 lds
    v_mfma_f32_16x16x32_bf16 v[220:223], v[168:171], v[52:55], v[220:223]
    v_mfma_f32_16x16x32_bf16 v[224:227], a[32:35], v[48:51], v[224:227]
    v_mfma_f32_16x16x32_bf16 v[228:231], a[104:107], v[48:51], v[228:231]
    v_mfma_f32_16x16x32_bf16 v[232:235], a[32:35], v[52:55], v[232:235]
    v_mfma_f32_16x16x32_bf16 v[236:239], a[104:107], v[52:55], v[236:239]
    s_waitcnt lgkmcnt(2)
    v_mfma_f32_16x16x32_bf16 v[208:211], v[100:103], v[32:35], v[208:211]
    ds_read_b128 v[48:51], v3 offset:11264
    ds_read_b128 v[52:55], v3 offset:29696
    v_mfma_f32_16x16x32_bf16 v[212:215], v[172:175], v[32:35], v[212:215]
    v_mfma_f32_16x16x32_bf16 v[216:219], v[100:103], v[36:39], v[216:219]
    s_add_u32 m0, s23, 3840
    s_nop 0
    buffer_load_dwordx4 v2, s[8:11], s24 offen offset:256 lds
    v_mfma_f32_16x16x32_bf16 v[220:223], v[172:175], v[36:39], v[220:223]
    v_mfma_f32_16x16x32_bf16 v[224:227], a[36:39], v[32:35], v[224:227]
    v_mfma_f32_16x16x32_bf16 v[228:231], a[108:111], v[32:35], v[228:231]
    v_mfma_f32_16x16x32_bf16 v[232:235], a[36:39], v[36:39], v[232:235]
    v_mfma_f32_16x16x32_bf16 v[236:239], a[108:111], v[36:39], v[236:239]
    s_waitcnt lgkmcnt(2)
    v_mfma_f32_16x16x32_bf16 v[208:211], v[104:107], v[40:43], v[208:211]
    ds_read_b128 v[32:35], v3 offset:12288
    ds_read_b128 v[36:39], v3 offset:30720
    v_mfma_f32_16x16x32_bf16 v[212:215], v[176:179], v[40:43], v[212:215]
    v_mfma_f32_16x16x32_bf16 v[216:219], v[104:107], v[44:47], v[216:219]
    s_add_u32 m0, s23, 4800
    s_nop 0
    buffer_load_dwordx4 v2, s[8:11], s24 offen offset:320 lds
    v_mfma_f32_16x16x32_bf16 v[220:223], v[176:179], v[44:47], v[220:223]
    v_mfma_f32_16x16x32_bf16 v[224:227], a[40:43], v[40:43], v[224:227]
    v_mfma_f32_16x16x32_bf16 v[228:231], a[112:115], v[40:43], v[228:231]
    v_mfma_f32_16x16x32_bf16 v[232:235], a[40:43], v[44:47], v[232:235]
    v_mfma_f32_16x16x32_bf16 v[236:239], a[112:115], v[44:47], v[236:239]
    s_waitcnt lgkmcnt(2)
    v_mfma_f32_16x16x32_bf16 v[208:211], v[108:111], v[48:51], v[208:211]
    ds_read_b128 v[40:43], v3 offset:13312
    ds_read_b128 v[44:47], v3 offset:31744
    v_mfma_f32_16x16x32_bf16 v[212:215], v[180:183], v[48:51], v[212:215]
    v_mfma_f32_16x16x32_bf16 v[216:219], v[108:111], v[52:55], v[216:219]
    s_add_u32 m0, s23, 5760
    s_nop 0
    buffer_load_dwordx4 v2, s[8:11], s24 offen offset:384 lds
    v_mfma_f32_16x16x32_bf16 v[220:223], v[180:183], v[52:55], v[220:223]
    v_mfma_f32_16x16x32_bf16 v[224:227], a[44:47], v[48:51], v[224:227]
    v_mfma_f32_16x16x32_bf16 v[228:231], a[116:119], v[48:51], v[228:231]
    v_mfma_f32_16x16x32_bf16 v[232:235], a[44:47], v[52:55], v[232:235]
    v_mfma_f32_16x16x32_bf16 v[236:239], a[116:119], v[52:55], v[236:239]
    s_waitcnt lgkmcnt(2)
    v_mfma_f32_16x16x32_bf16 v[208:211], v[112:115], v[32:35], v[208:211]
    ds_read_b128 v[48:51], v3 offset:14336
    ds_read_b128 v[52:55], v3 offset:32768
    v_mfma_f32_16x16x32_bf16 v[212:215], v[184:187], v[32:35], v[212:215]
    v_mfma_f32_16x16x32_bf16 v[216:219], v[112:115], v[36:39], v[216:219]
    s_add_u32 m0, s23, 6720
    s_nop 0
    buffer_load_dwordx4 v2, s[8:11], s24 offen offset:448 lds
    v_mfma_f32_16x16x32_bf16 v[220:223], v[184:187], v[36:39], v[220:223]
    v_mfma_f32_16x16x32_bf16 v[224:227], a[48:51], v[32:35], v[224:227]
    v_mfma_f32_16x16x32_bf16 v[228:231], a[120:123], v[32:35], v[228:231]
    v_mfma_f32_16x16x32_bf16 v[232:235], a[48:51], v[36:39], v[232:235]
    v_mfma_f32_16x16x32_bf16 v[236:239], a[120:123], v[36:39], v[236:239]
    s_waitcnt lgkmcnt(2)
    v_mfma_f32_16x16x32_bf16 v[208:211], v[116:119], v[40:43], v[208:211]
    ds_read_b128 v[32:35], v3 offset:15360
    ds_read_b128 v[36:39], v3 offset:33792
    v_mfma_f32_16x16x32_bf16 v[212:215], v[188:191], v[40:43], v[212:215]
    v_mfma_f32_16x16x32_bf16 v[216:219], v[116:119], v[44:47], v[216:219]
    s_add_u32 m0, s23, 7680
    s_nop 0
    buffer_load_dwordx4 v2, s[8:11], s24 offen offset:512 lds
    s_add_u32 s24, s24, s42
    v_mfma_f32_16x16x32_bf16 v[220:223], v[188:191], v[44:47], v[220:223]
    v_mfma_f32_16x16x32_bf16 v[224:227], a[52:55], v[40:43], v[224:227]
    v_mfma_f32_16x16x32_bf16 v[228:231], a[124:127], v[40:43], v[228:231]
    v_mfma_f32_16x16x32_bf16 v[232:235], a[52:55], v[44:47], v[232:235]
    v_mfma_f32_16x16x32_bf16 v[236:239], a[124:127], v[44:47], v[236:239]
    s_waitcnt lgkmcnt(2)
    v_mfma_f32_16x16x32_bf16 v[208:211], v[120:123], v[48:51], v[208:211]
    ds_read_b128 v[40:43], v3 offset:16384
    ds_read_b128 v[44:47], v3 offset:34816
    v_mfma_f32_16x16x32_bf16 v[212:215], v[192:195], v[48:51], v[212:215]
    v_mfma_f32_16x16x32_bf16 v[216:219], v[120:123], v[52:55], v[216:219]
    v_add_u32 v24, s27, v1
    v_mfma_f32_16x16x32_bf16 v[220:223], v[192:195], v[52:55], v[220:223]
    v_mfma_f32_16x16x32_bf16 v[224:227], a[56:59], v[48:51], v[224:227]
    v_mfma_f32_16x16x32_bf16 v[228:231], a[128:131], v[48:51], v[228:231]
    v_mfma_f32_16x16x32_bf16 v[232:235], a[56:59], v[52:55], v[232:235]
    v_mfma_f32_16x16x32_bf16 v[236:239], a[128:131], v[52:55], v[236:239]
    s_waitcnt lgkmcnt(2)
    v_mfma_f32_16x16x32_bf16 v[208:211], v[124:127], v[32:35], v[208:211]
    ds_read_b128 v[48:51], v3 offset:17408
    ds_read_b128 v[52:55], v3 offset:35840
    v_mfma_f32_16x16x32_bf16 v[212:215], v[196:199], v[32:35], v[212:215]
    v_mfma_f32_16x16x32_bf16 v[216:219], v[124:127], v[36:39], v[216:219]
    v_mfma_f32_16x16x32_bf16 v[220:223], v[196:199], v[36:39], v[220:223]
    v_mfma_f32_16x16x32_bf16 v[224:227], a[60:63], v[32:35], v[224:227]
    v_mfma_f32_16x16x32_bf16 v[228:231], a[132:135], v[32:35], v[228:231]
    s_waitcnt vmcnt(9)
    s_barrier
    v_mfma_f32_16x16x32_bf16 v[232:235], a[60:63], v[36:39], v[232:235]
    v_mfma_f32_16x16x32_bf16 v[236:239], a[132:135], v[36:39], v[236:239]
    s_waitcnt lgkmcnt(2)
    v_mfma_f32_16x16x32_bf16 v[208:211], v[128:131], v[40:43], v[208:211]
    ds_read_b128 v[32:35], v24 offset:0
    ds_read_b128 v[36:39], v24 offset:18432
    v_mfma_f32_16x16x32_bf16 v[212:215], v[200:203], v[40:43], v[212:215]
    v_mfma_f32_16x16x32_bf16 v[216:219], v[128:131], v[44:47], v[216:219]
    v_mov_b32 v4, s30
    s_mov_b64 exec, s[34:35]
    buffer_store_dword v4, off, s[4:7], s29 sc1
    s_mov_b64 exec, -1
    v_mfma_f32_16x16x32_bf16 v[220:223], v[200:203], v[44:47], v[220:223]
    v_mfma_f32_16x16x32_bf16 v[224:227], a[64:67], v[40:43], v[224:227]
    v_mfma_f32_16x16x32_bf16 v[228:231], a[136:139], v[40:43], v[228:231]
    v_mfma_f32_16x16x32_bf16 v[232:235], a[64:67], v[44:47], v[232:235]
    v_mfma_f32_16x16x32_bf16 v[236:239], a[136:139], v[44:47], v[236:239]
    s_waitcnt lgkmcnt(2)
    v_mfma_f32_16x16x32_bf16 v[208:211], v[132:135], v[48:51], v[208:211]
    ds_read_b128 v[40:43], v24 offset:1024
    ds_read_b128 v[44:47], v24 offset:19456
    v_mfma_f32_16x16x32_bf16 v[212:215], v[204:207], v[48:51], v[212:215]
    v_mfma_f32_16x16x32_bf16 v[216:219], v[132:135], v[52:55], v[216:219]
    v_mfma_f32_16x16x32_bf16 v[220:223], v[204:207], v[52:55], v[220:223]
    v_mfma_f32_16x16x32_bf16 v[224:227], a[68:71], v[48:51], v[224:227]
    v_mfma_f32_16x16x32_bf16 v[228:231], a[140:143], v[48:51], v[228:231]
    v_mfma_f32_16x16x32_bf16 v[232:235], a[68:71], v[52:55], v[232:235]
    v_mfma_f32_16x16x32_bf16 v[236:239], a[140:143], v[52:55], v[236:239]
    v_mov_b32 v3, v24
    s_mov_b32 s31, s26
    s_add_u32 s26, s26, s41
    s_add_u32 s30, s30, 1
    s_add_u32 s19, s19, s20
    s_cmp_lt_u32 s19, 64
    s_cbranch_scc1 qk_loop
    v_cvt_pk_bf16_f32 v8, v208, v209
    v_cvt_pk_bf16_f32 v9, v210, v211
    v_cvt_pk_bf16_f32 v10, v212, v213
    v_cvt_pk_bf16_f32 v11, v214, v215
    v_cvt_pk_bf16_f32 v12, v216, v217
    v_cvt_pk_bf16_f32 v13, v218, v219
    v_cvt_pk_bf16_f32 v14, v220, v221
    v_cvt_pk_bf16_f32 v15, v222, v223
    v_cvt_pk_bf16_f32 v16, v224, v225
    v_cvt_pk_bf16_f32 v17, v226, v227
    v_cvt_pk_bf16_f32 v18, v228, v229
    v_cvt_pk_bf16_f32 v19, v230, v231
    v_cvt_pk_bf16_f32 v20, v232, v233
    v_cvt_pk_bf16_f32 v21, v234, v235
    v_cvt_pk_bf16_f32 v22, v236, v237
    v_cvt_pk_bf16_f32 v23, v238, v239
    s_branch qk_done
    s_nop 0
qk_vloop:
    s_add_u32 s22, s27, 73728
    s_sub_u32 s21, s22, 147456
    s_cselect_b32 s22, s22, s21
    s_add_u32 s27, s27, 36864
    s_cmp_eq_u32 s27, 147456
    s_cselect_b32 s27, 0, s27
    s_waitcnt lgkmcnt(2)
    v_cvt_pk_bf16_f32 v8, v208, v209
    v_cvt_pk_bf16_f32 v9, v210, v211
    v_mfma_f32_16x16x32_bf16 v[208:211], v[32:35], v[64:67], 0
    ds_read_b128 v[48:51], v3 offset:2048
    ds_read_b128 v[52:55], v3 offset:20480
    v_cvt_pk_bf16_f32 v12, v212, v213
    v_cvt_pk_bf16_f32 v13, v214, v215
    v_mfma_f32_16x16x32_bf16 v[212:215], v[32:35], v[136:139], 0
    v_cvt_pk_bf16_f32 v10, v216, v217
    v_cvt_pk_bf16_f32 v11, v218, v219
    v_mfma_f32_16x16x32_bf16 v[216:219], v[36:39], v[64:67], 0
    v_cvt_pk_bf16_f32 v14, v220, v221
    v_cvt_pk_bf16_f32 v15, v222, v223
    v_mfma_f32_16x16x32_bf16 v[220:223], v[36:39], v[136:139], 0
    v_cvt_pk_bf16_f32 v16, v224, v225
    v_cvt_pk_bf16_f32 v17, v226, v227
    v_mfma_f32_16x16x32_bf16 v[224:227], v[32:35], a[0:3], 0
    v_cvt_pk_bf16_f32 v20, v228, v229
    v_cvt_pk_bf16_f32 v21, v230, v231
    v_mfma_f32_16x16x32_bf16 v[228:231], v[32:35], a[72:75], 0
    v_cvt_pk_bf16_f32 v18, v232, v233
    v_cvt_pk_bf16_f32 v19, v234, v235
    v_mfma_f32_16x16x32_bf16 v[232:235], v[36:39], a[0:3], 0
    v_cvt_pk_bf16_f32 v22, v236, v237
    v_cvt_pk_bf16_f32 v23, v238, v239
    v_mfma_f32_16x16x32_bf16 v[236:239], v[36:39], a[72:75], 0
    s_waitcnt lgkmcnt(2)
    v_mfma_f32_16x16x32_bf16 v[208:211], v[40:43], v[68:71], v[208:211]
    ds_read_b128 v[32:35], v3 offset:3072
    ds_read_b128 v[36:39], v3 offset:21504
    v_mfma_f32_16x16x32_bf16 v[212:215], v[40:43], v[140:143], v[212:215]
    v_mfma_f32_16x16x32_bf16 v[216:219], v[44:47], v[68:71], v[216:219]
    s_mov_b32 s28, s31
    buffer_store_dwordx4 v[8:11], v7, s[4:7], s28 offen sc1
    v_mfma_f32_16x16x32_bf16 v[220:223], v[44:47], v[140:143], v[220:223]
    v_mfma_f32_16x16x32_bf16 v[224:227], v[40:43], a[4:7], v[224:227]
    v_mfma_f32_16x16x32_bf16 v[228:231], v[40:43], a[76:79], v[228:231]
    v_mfma_f32_16x16x32_bf16 v[232:235], v[44:47], a[4:7], v[232:235]
    v_mfma_f32_16x16x32_bf16 v[236:239], v[44:47], a[76:79], v[236:239]
    s_waitcnt lgkmcnt(2)
    v_mfma_f32_16x16x32_bf16 v[208:211], v[48:51], v[72:75], v[208:211]
    ds_read_b128 v[40:43], v3 offset:4096
    ds_read_b128 v[44:47], v3 offset:22528
    v_mfma_f32_16x16x32_bf16 v[212:215], v[48:51], v[144:147], v[212:215]
    v_mfma_f32_16x16x32_bf16 v[216:219], v[52:55], v[72:75], v[216:219]
    s_add_u32 s28, s28, s40
    buffer_store_dwordx4 v[12:15], v7, s[4:7], s28 offen sc1
    v_mfma_f32_16x16x32_bf16 v[220:223], v[52:55], v[144:147], v[220:223]
    v_mfma_f32_16x16x32_bf16 v[224:227], v[48:51], a[8:11], v[224:227]
    v_mfma_f32_16x16x32_bf16 v[228:231], v[48:51], a[80:83], v[228:231]
    v_mfma_f32_16x16x32_bf16 v[232:235], v[52:55], a[8:11], v[232:235]
    v_mfma_f32_16x16x32_bf16 v[236:239], v[52:55], a[80:83], v[236:239]
    s_waitcnt lgkmcnt(2)
    v_mfma_f32_16x16x32_bf16 v[208:211], v[32:35], v[76:79], v[208:211]
    ds_read_b128 v[48:51], v3 offset:5120
    ds_read_b128 v[52:55], v3 offset:23552
    v_mfma_f32_16x16x32_bf16 v[212:215], v[32:35], v[148:151], v[212:215]
    v_mfma_f32_16x16x32_bf16 v[216:219], v[36:39], v[76:79], v[216:219]
    s_add_u32 s28, s31, s43
    buffer_store_dwordx4 v[16:19], v7, s[4:7], s28 offen sc1
    v_mfma_f32_16x16x32_bf16 v[220:223], v[36:39], v[148:151], v[220:223]
    v_mfma_f32_16x16x32_bf16 v[224:227], v[32:35], a[12:15], v[224:227]
    v_mfma_f32_16x16x32_bf16 v[228:231], v[32:35], a[84:87], v[228:231]
    v_mfma_f32_16x16x32_bf16 v[232:235], v[36:39], a[12:15], v[232:235]
    v_mfma_f32_16x16x32_bf16 v[236:239], v[36:39], a[84:87], v[236:239]
    s_waitcnt lgkmcnt(2)
    v_mfma_f32_16x16x32_bf16 v[208:211], v[40:43], v[80:83], v[208:211]
    ds_read_b128 v[32:35], v3 offset:6144
    ds_read_b128 v[36:39], v3 offset:24576
    v_mfma_f32_16x16x32_bf16 v[212:215], v[40:43], v[152:155], v[212:215]
    v_mfma_f32_16x16x32_bf16 v[216:219], v[44:47], v[80:83], v[216:219]
    s_add_u32 s28, s28, s40
    buffer_store_dwordx4 v[20:23], v7, s[4:7], s28 offen sc1
    v_mfma_f32_16x16x32_bf16 v[220:223], v[44:47], v[152:155], v[220:223]
    v_mfma_f32_16x16x32_bf16 v[224:227], v[40:43], a[16:19], v[224:227]
    v_mfma_f32_16x16x32_bf16 v[228:231], v[40:43], a[88:91], v[228:231]
    v_mfma_f32_16x16x32_bf16 v[232:235], v[44:47], a[16:19], v[232:235]
    v_mfma_f32_16x16x32_bf16 v[236:239], v[44:47], a[88:91], v[236:239]
    s_waitcnt lgkmcnt(2)
    v_mfma_f32_16x16x32_bf16 v[208:211], v[48:51], v[84:87], v[208:211]
    ds_read_b128 v[40:43], v3 offset:7168
    ds_read_b128 v[44:47], v3 offset:25600
    v_mfma_f32_16x16x32_bf16 v[212:215], v[48:51], v[156:159], v[212:215]
    v_mfma_f32_16x16x32_bf16 v[216:219], v[52:55], v[84:87], v[216:219]
    s_add_u32 s23, s22, s25
    s_add_u32 m0, s23, 0
    s_nop 0
    buffer_load_dwordx4 v2, s[8:11], s24 offen offset:0 lds
    v_mfma_f32_16x16x32_bf16 v[220:223], v[52:55], v[156:159], v[220:223]
    v_mfma_f32_16x16x32_bf16 v[224:227], v[48:51], a[20:23], v[224:227]
    v_mfma_f32_16x16x32_bf16 v[228:231], v[48:51], a[92:95], v[228:231]
    v_mfma_f32_16x16x32_bf16 v[232:235], v[52:55], a[20:23], v[232:235]
    v_mfma_f32_16x16x32_bf16 v[236:239], v[52:55], a[92:95], v[236:239]
    s_waitcnt lgkmcnt(2)
    v_mfma_f32_16x16x32_bf16 v[208:211], v[32:35], v[88:91], v[208:211]
    ds_read_b128 v[48:51], v3 offset:8192
    ds_read_b128 v[52:55], v3 offset:26624
    v_mfma_f32_16x16x32_bf16 v[212:215], v[32:35], v[160:163], v[212:215]
    v_mfma_f32_16x16x32_bf16 v[216:219], v[36:39], v[88:91], v[216:219]
    s_add_u32 m0, s23, 960
    s_nop 0
    buffer_load_dwordx4 v2, s[8:11], s24 offen offset:64 lds
    v_mfma_f32_16x16x32_bf16 v[220:223], v[36:39], v[160:163], v[220:223]
    v_mfma_f32_16x16x32_bf16 v[224:227], v[32:35], a[24:27], v[224:227]
    v_mfma_f32_16x16x32_bf16 v[228:231], v[32:35], a[96:99], v[228:231]
    v_mfma_f32_16x16x32_bf16 v[232:235], v[36:39], a[24:27], v[232:235]
    v_mfma_f32_16x16x32_bf16 v[236:239], v[36:39], a[96:99], v[236:239]
    s_waitcnt lgkmcnt(2)
    v_mfma_f32_16x16x32_bf16 v[208:211], v[40:43], v[92:95], v[208:211]
    ds_read_b128 v[32:35], v3 offset:9216
    ds_read_b128 v[36:39], v3 offset:27648
    v_mfma_f32_16x16x32_bf16 v[212:215], v[40:43], v[164:167], v[212:215]
    v_mfma_f32_16x16x32_bf16 v[216:219], v[44:47], v[92:95], v[216:219]
    s_add_u32 m0, s23, 1920
    s_nop 0
    buffer_load_dwordx4 v2, s[8:11], s24 offen offset:128 lds
    v_mfma_f32_16x16x32_bf16 v[220:223], v[44:47], v[164:167], v[220:223]
    v_mfma_f32_16x16x32_bf16 v[224:227], v[40:43], a[28:31], v[224:227]
    v_mfma_f32_16x16x32_bf16 v[228:231], v[40:43], a[100:103], v[228:231]
    v_mfma_f32_16x16x32_bf16 v[232:235], v[44:47], a[28:31], v[232:235]
    v_mfma_f32_16x16x32_bf16 v[236:239], v[44:47], a[100:103], v[236:239]
    s_waitcnt lgkmcnt(2)
    v_mfma_f32_16x16x32_bf16 v[208:211], v[48:51], v[96:99], v[208:211]
    ds_read_b128 v[40:43], v3 offset:10240
    ds_read_b128 v[44:47], v3 offset:28672
    v_mfma_f32_16x16x32_bf16 v[212:215], v[48:51], v[168:171], v[212:215]
    v_mfma_f32_16x16x32_bf16 v[216:219], v[52:55], v[96:99], v[216:219]
    s_add_u32 m0, s23, 2880
    s_nop 0
    buffer_load_dwordx4 v2, s[8:11], s24 offen offset:192 lds
    v_mfma_f32_16x16x32_bf16 v[220:223], v[52:55], v[168:171], v[220:223]
    v_mfma_f32_16x16x32_bf16 v[224:227], v[48:51], a[32:35], v[224:227]
    v_mfma_f32_16x16x32_bf16 v[228:231], v[48:51], a[104:107], v[228:231]
    v_mfma_f32_16x16x32_bf16 v[232:235], v[52:55], a[32:35], v[232:235]
    v_mfma_f32_16x16x32_bf16 v[236:239], v[52:55], a[104:107], v[236:239]
    s_waitcnt lgkmcnt(2)
    v_mfma_f32_16x16x32_bf16 v[208:211], v[32:35], v[100:103], v[208:211]
    ds_read_b128 v[48:51], v3 offset:11264
    ds_read_b128 v[52:55], v3 offset:29696
    v_mfma_f32_16x16x32_bf16 v[212:215], v[32:35], v[172:175], v[212:215]
    v_mfma_f32_16x16x32_bf16 v[216:219], v[36:39], v[100:103], v[216:219]
    s_add_u32 m0, s23, 3840
    s_nop 0
    buffer_load_dwordx4 v2, s[8:11], s24 offen offset:256 lds
    v_mfma_f32_16x16x32_bf16 v[220:223], v[36:39], v[172:175], v[220:223]
    v_mfma_f32_16x16x32_bf16 v[224:227], v[32:35], a[36:39], v[224:227]
    v_mfma_f32_16x16x32_bf16 v[228:231], v[32:35], a[108:111], v[228:231]
    v_mfma_f32_16x16x32_bf16 v[232:235], v[36:39], a[36:39], v[232:235]
    v_mfma_f32_16x16x32_bf16 v[236:239], v[36:39], a[108:111], v[236:239]
    s_waitcnt lgkmcnt(2)
    v_mfma_f32_16x16x32_bf16 v[208:211], v[40:43], v[104:107], v[208:211]
    ds_read_b128 v[32:35], v3 offset:12288
    ds_read_b128 v[36:39], v3 offset:30720
    v_mfma_f32_16x16x32_bf16 v[212:215], v[40:43], v[176:179], v[212:215]
    v_mfma_f32_16x16x32_bf16 v[216:219], v[44:47], v[104:107], v[216:219]
    s_add_u32 m0, s23, 4800
    s_nop 0
    buffer_load_dwordx4 v2, s[8:11], s24 offen offset:320 lds
    v_mfma_f32_16x16x32_bf16 v[220:223], v[44:47], v[176:179], v[220:223]
    v_mfma_f32_16x16x32_bf16 v[224:227], v[40:43], a[40:43], v[224:227]
    v_mfma_f32_16x16x32_bf16 v[228:231], v[40:43], a[112:115], v[228:231]
    v_mfma_f32_16x16x32_bf16 v[232:235], v[44:47], a[40:43], v[232:235]
    v_mfma_f32_16x16x32_bf16 v[236:239], v[44:47], a[112:115], v[236:239]
    s_waitcnt lgkmcnt(2)
    v_mfma_f32_16x16x32_bf16 v[208:211], v[48:51], v[108:111], v[208:211]
    ds_read_b128 v[40:43], v3 offset:13312
    ds_read_b128 v[44:47], v3 offset:31744
    v_mfma_f32_16x16x32_bf16 v[212:215], v[48:51], v[180:183], v[212:215]
    v_mfma_f32_16x16x32_bf16 v[216:219], v[52:55], v[108:111], v[216:219]
    s_add_u32 m0, s23, 5760
    s_nop 0
    buffer_load_dwordx4 v2, s[8:11], s24 offen offset:384 lds
    v_mfma_f32_16x16x32_bf16 v[220:223], v[52:55], v[180:183], v[220:223]
    v_mfma_f32_16x16x32_bf16 v[224:227], v[48:51], a[44:47], v[224:227]
    v_mfma_f32_16x16x32_bf16 v[228:231], v[48:51], a[116:119], v[228:231]
    v_mfma_f32_16x16x32_bf16 v[232:235], v[52:55], a[44:47], v[232:235]
    v_mfma_f32_16x16x32_bf16 v[236:239], v[52:55], a[116:119], v[236:239]
    s_waitcnt lgkmcnt(2)
    v_mfma_f32_16x16x32_bf16 v[208:211], v[32:35], v[112:115], v[208:211]
    ds_read_b128 v[48:51], v3 offset:14336
    ds_read_b128 v[52:55], v3 offset:32768
    v_mfma_f32_16x16x32_bf16 v[212:215], v[32:35], v[184:187], v[212:215]
    v_mfma_f32_16x16x32_bf16 v[216:219], v[36:39], v[112:115], v[216:219]
    s_add_u32 m0, s23, 6720
    s_nop 0
    buffer_load_dwordx4 v2, s[8:11], s24 offen offset:448 lds
    v_mfma_f32_16x16x32_bf16 v[220:223], v[36:39], v[184:187], v[220:223]
    v_mfma_f32_16x16x32_bf16 v[224:227], v[32:35], a[48:51], v[224:227]
    v_mfma_f32_16x16x32_bf16 v[228:231], v[32:35], a[120:123], v[228:231]
    v_mfma_f32_16x16x32_bf16 v[232:235], v[36:39], a[48:51], v[232:235]
    v_mfma_f32_16x16x32_bf16 v[236:239], v[36:39], a[120:123], v[236:239]
    s_waitcnt lgkmcnt(2)
    v_mfma_f32_16x16x32_bf16 v[208:211], v[40:43], v[116:119], v[208:211]
    ds_read_b128 v[32:35], v3 offset:15360
    ds_read_b128 v[36:39], v3 offset:33792
    v_mfma_f32_16x16x32_bf16 v[212:215], v[40:43], v[188:191], v[212:215]
    v_mfma_f32_16x16x32_bf16 v[216:219], v[44:47], v[116:119], v[216:219]
    s_add_u32 m0, s23, 7680
    s_nop 0
    buffer_load_dwordx4 v2, s[8:11], s24 offen offset:512 lds
    s_add_u32 s24, s24, s42
    v_mfma_f32_16x16x32_bf16 v[220:223], v[44:47], v[188:191], v[220:223]
    v_mfma_f32_16x16x32_bf16 v[224:227], v[40:43], a[52:55], v[224:227]
    v_mfma_f32_16x16x32_bf16 v[228:231], v[40:43], a[124:127], v[228:231]
    v_mfma_f32_16x16x32_bf16 v[232:235], v[44:47], a[52:55], v[232:235]
    v_mfma_f32_16x16x32_bf16 v[236:239], v[44:47], a[124:127], v[236:239]
    s_waitcnt lgkmcnt(2)
    v_mfma_f32_16x16x32_bf16 v[208:211], v[48:51], v[120:123], v[208:211]
    ds_read_b128 v[40:43], v3 offset:16384
    ds_read_b128 v[44:47], v3 offset:34816
    v_mfma_f32_16x16x32_bf16 v[212:215], v[48:51], v[192:195], v[212:215]
    v_mfma_f32_16x16x32_bf16 v[216:219], v[52:55], v[120:123], v[216:219]
    v_add_u32 v24, s27, v1
    v_mfma_f32_16x16x32_bf16 v[220:223], v[52:55], v[192:195], v[220:223]
    v_mfma_f32_16x16x32_bf16 v[224:227], v[48:51], a[56:59], v[224:227]
    v_mfma_f32_16x16x32_bf16 v[228:231], v[48:51], a[128:131], v[228:231]
    v_mfma_f32_16x16x32_bf16 v[232:235], v[52:55], a[56:59], v[232:235]
    v_mfma_f32_16x16x32_bf16 v[236:239], v[52:55], a[128:131], v[236:239]
    s_waitcnt lgkmcnt(2)
    v_mfma_f32_16x16x32_bf16 v[208:211], v[32:35], v[124:127], v[208:211]
    ds_read_b128 v[48:51], v3 offset:17408
    ds_read_b128 v[52:55], v3 offset:35840
    v_mfma_f32_16x16x32_bf16 v[212:215], v[32:35], v[196:199], v[212:215]
    v_mfma_f32_16x16x32_bf16 v[216:219], v[36:39], v[124:127], v[216:219]
    v_mfma_f32_16x16x32_bf16 v[220:223], v[36:39], v[196:199], v[220:223]
    v_mfma_f32_16x16x32_bf16 v[224:227], v[32:35], a[60:63], v[224:227]
    v_mfma_f32_16x16x32_bf16 v[228:231], v[32:35], a[132:135], v[228:231]
    s_waitcnt vmcnt(9)
    s_barrier
    v_mfma_f32_16x16x32_bf16 v[232:235], v[36:39], a[60:63], v[232:235]
    v_mfma_f32_16x16x32_bf16 v[236:239], v[36:39], a[132:135], v[236:239]
    s_waitcnt lgkmcnt(2)
    v_mfma_f32_16x16x32_bf16 v[208:211], v[40:43], v[128:131], v[208:211]
    ds_read_b128 v[32:35], v24 offset:0
    ds_read_b128 v[36:39], v24 offset:18432
    v_mfma_f32_16x16x32_bf16 v[212:215], v[40:43], v[200:203], v[212:215]
    v_mfma_f32_16x16x32_bf16 v[216:219], v[44:47], v[128:131], v[216:219]
    v_mov_b32 v4, s30
    s_mov_b64 exec, s[34:35]
    buffer_store_dword v4, off, s[4:7], s29 sc1
    s_mov_b64 exec, -1
    v_mfma_f32_16x16x32_bf16 v[220:223], v[44:47], v[200:203], v[220:223]
    v_mfma_f32_16x16x32_bf16 v[224:227], v[40:43], a[64:67], v[224:227]
    v_mfma_f32_16x16x32_bf16 v[228:231], v[40:43], a[136:139], v[228:231]
    v_mfma_f32_16x16x32_bf16 v[232:235], v[44:47], a[64:67], v[232:235]
    v_mfma_f32_16x16x32_bf16 v[236:239], v[44:47], a[136:139], v[236:239]
    s_waitcnt lgkmcnt(2)
    v_mfma_f32_16x16x32_bf16 v[208:211], v[48:51], v[132:135], v[208:211]
    ds_read_b128 v[40:43], v24 offset:1024
    ds_read_b128 v[44:47], v24 offset:19456
    v_mfma_f32_16x16x32_bf16 v[212:215], v[48:51], v[204:207], v[212:215]
    v_mfma_f32_16x16x32_bf16 v[216:219], v[52:55], v[132:135], v[216:219]
    v_mfma_f32_16x16x32_bf16 v[220:223], v[52:55], v[204:207], v[220:223]
    v_mfma_f32_16x16x32_bf16 v[224:227], v[48:51], a[68:71], v[224:227]
    v_mfma_f32_16x16x32_bf16 v[228:231], v[48:51], a[140:143], v[228:231]
    v_mfma_f32_16x16x32_bf16 v[232:235], v[52:55], a[68:71], v[232:235]
    v_mfma_f32_16x16x32_bf16 v[236:239], v[52:55], a[140:143], v[236:239]
    v_mov_b32 v3, v24
    s_mov_b32 s31, s26
    s_add_u32 s26, s26, s41
    s_add_u32 s30, s30, 1
    s_add_u32 s19, s19, s20
    s_cmp_lt_u32 s19, 64
    s_cbranch_scc1 qk_vloop
    v_cvt_pk_bf16_f32 v8, v208, v209
    v_cvt_pk_bf16_f32 v9, v210, v211
    v_cvt_pk_bf16_f32 v12, v212, v213
    v_cvt_pk_bf16_f32 v13, v214, v215
    v_cvt_pk_bf16_f32 v10, v216, v217
    v_cvt_pk_bf16_f32 v11, v218, v219
    v_cvt_pk_bf16_f32 v14, v220, v221
    v_cvt_pk_bf16_f32 v15, v222, v223
    v_cvt_pk_bf16_f32 v16, v224, v225
    v_cvt_pk_bf16_f32 v17, v226, v227
    v_cvt_pk_bf16_f32 v20, v228, v229
    v_cvt_pk_bf16_f32 v21, v230, v231
    v_cvt_pk_bf16_f32 v18, v232, v233
    v_cvt_pk_bf16_f32 v19, v234, v235
    v_cvt_pk_bf16_f32 v22, v236, v237
    v_cvt_pk_bf16_f32 v23, v238, v239
qk_done:
    s_mov_b32 s28, s31
    buffer_store_dwordx4 v[8:11], v7, s[4:7], s28 offen sc1
    s_add_u32 s28, s28, s40
    buffer_store_dwordx4 v[12:15], v7, s[4:7], s28 offen sc1
    s_add_u32 s28, s31, s43
    buffer_store_dwordx4 v[16:19], v7, s[4:7], s28 offen sc1
    s_add_u32 s28, s28, s40
    buffer_store_dwordx4 v[20:23], v7, s[4:7], s28 offen sc1
    s_waitcnt vmcnt(0) lgkmcnt(0)
    s_barrier
    s_add_u32 s22, s95, 63
    v_mov_b32 v4, s22
    s_mov_b64 exec, s[34:35]
    buffer_store_dword v4, off, s[4:7], s29 sc1
    s_mov_b64 exec, -1
    s_cmp_eq_u32 s16, 0
    s_cbranch_scc1 qk_nq
    s_add_u32 s29, s29, 4096
    v_mov_b32 v4, s22
    s_mov_b64 exec, s[34:35]
    buffer_store_dword v4, off, s[4:7], s29 sc1
    s_mov_b64 exec, -1
qk_nq:
    s_cmp_ge_u32 s36, 64
    s_cbranch_scc1 L_qkv_next
    s_lshr_b32 s33, s36, 5
    v_and_b32 v4, 63, v0
    v_lshrrev_b32 v5, 4, v4
    v_add_u32 v1, 0, v5
    v_mul_u32_u24 v6, 11, v1
    v_lshrrev_b32 v6, 5, v6
    v_add_u32 v1, v1, v6
    v_lshlrev_b32 v1, 7, v1
    v_and_b32 v6, 7, v4
    v_lshl_add_u32 v1, v6, 4, v1
    v_add_u32 v2, 4, v5
    v_mul_u32_u24 v6, 11, v2
    v_lshrrev_b32 v6, 5, v6
    v_add_u32 v2, v2, v6
    v_lshlrev_b32 v2, 7, v2
    v_and_b32 v6, 7, v4
    v_lshl_add_u32 v2, v6, 4, v2
    v_add_u32 v3, 8, v5
    v_mul_u32_u24 v6, 11, v3
    v_lshrrev_b32 v6, 5, v6
    v_add_u32 v3, v3, v6
    v_lshlrev_b32 v3, 7, v3
    v_and_b32 v6, 7, v4
    v_lshl_add_u32 v3, v6, 4, v3
    v_min_u32 v6, 23, v4
    v_lshlrev_b32 v6, 9, v6
    s_mov_b32 s19, s33
    s_mul_i32 s24, s19, 12288
    s_add_u32 s24, s24, 90177536
    s_lshl_b32 s26, s19, 5
    s_add_u32 s26, s26, s17
    s_lshl_b32 s26, s26, 12
    s_mov_b32 s21, 71303168
    s_cmp_eq_u32 s16, 2
    s_cselect_b32 s21, 80740352, s21
    s_add_u32 s26, s26, s21
    s_lshl_b32 s29, s17, 7
    s_lshl_b32 s21, s16, 1
    s_add_u32 s21, s21, s33
    s_lshl_b32 s21, s21, 2
    s_add_u32 s29, s29, s21
    s_add_u32 s29, s29, 125829240
mk_loop:
    s_cmp_lg_u32 s18, 0
    s_cbranch_scc1 mk_go
    s_mov_b32 s23, s24
    s_mov_b32 s21, 4194304
mk_wait:
    buffer_load_dword v4, v6, s[4:7], s23 offen offset:384 sc1
    s_sub_u32 s21, s21, 1
    s_cbranch_scc1 mk_go
    s_waitcnt vmcnt(0)
    v_cmp_ne_u32 vcc, s95, v4
    s_cbranch_vccz mk_go
    s_sleep 4
    s_branch mk_wait
mk_go:
    s_barrier
    s_mov_b32 s30, 4096
mk_again:
    v_mov_b32 v5, 0
    s_add_u32 s23, s24, 0
    buffer_load_dwordx4 v[24:27], v1, s[4:7], s23 offen offset:0 sc1
    buffer_load_dwordx4 v[28:31], v2, s[4:7], s23 offen offset:0 sc1
    buffer_load_dwordx4 v[32:35], v3, s[4:7], s23 offen offset:0 sc1
    buffer_load_dwordx4 v[36:39], v1, s[4:7], s23 offen offset:2048 sc1
    buffer_load_dwordx4 v[40:43], v2, s[4:7], s23 offen offset:2048 sc1
    buffer_load_dwordx4 v[44:47], v3, s[4:7], s23 offen offset:2048 sc1
    s_add_u32 s23, s24, 4096
    buffer_load_dwordx4 v[48:51], v1, s[4:7], s23 offen offset:0 sc1
    buffer_load_dwordx4 v[52:55], v2, s[4:7], s23 offen offset:0 sc1
    buffer_load_dwordx4 v[56:59], v3, s[4:7], s23 offen offset:0 sc1
    buffer_load_dwordx4 v[60:63], v1, s[4:7], s23 offen offset:2048 sc1
    buffer_load_dwordx4 v[208:211], v2, s[4:7], s23 offen offset:2048 sc1
    buffer_load_dwordx4 v[212:215], v3, s[4:7], s23 offen offset:2048 sc1
    s_add_u32 s23, s24, 8192
    buffer_load_dwordx4 v[216:219], v1, s[4:7], s23 offen offset:0 sc1
    buffer_load_dwordx4 v[220:223], v2, s[4:7], s23 offen offset:0 sc1
    buffer_load_dwordx4 v[224:227], v3, s[4:7], s23 offen offset:0 sc1
    buffer_load_dwordx4 v[228:231], v1, s[4:7], s23 offen offset:2048 sc1
    buffer_load_dwordx4 v[232:235], v2, s[4:7], s23 offen offset:2048 sc1
    buffer_load_dwordx4 v[236:239], v3, s[4:7], s23 offen offset:2048 sc1
    s_add_u32 s22, s19, s95
    s_add_u32 s22, s22, 1
    s_cmp_eq_u32 s16, 2
    s_cbranch_scc1 mk_v
    s_waitcnt vmcnt(17)
    v_mfma_f32_16x16x32_bf16 v[8:11], v[64:67], v[24:27], 0
    v_mfma_f32_16x16x32_bf16 v[12:15], v[136:139], v[24:27], 0
    v_max3_u32 v5, v5, v24, v25
    v_mfma_f32_16x16x32_bf16 v[16:19], a[0:3], v[24:27], 0
    v_mfma_f32_16x16x32_bf16 v[20:23], a[72:75], v[24:27], 0
    v_max3_u32 v5, v5, v26, v27
    s_waitcnt vmcnt(16)
    v_mfma_f32_16x16x32_bf16 v[8:11], v[68:71], v[28:31], v[8:11]
    v_mfma_f32_16x16x32_bf16 v[12:15], v[140:143], v[28:31], v[12:15]
    v_max3_u32 v5, v5, v28, v29
    v_mfma_f32_16x16x32_bf16 v[16:19], a[4:7], v[28:31], v[16:19]
    v_mfma_f32_16x16x32_bf16 v[20:23], a[76:79], v[28:31], v[20:23]
    v_max3_u32 v5, v5, v30, v31
    s_waitcnt vmcnt(15)
    v_mfma_f32_16x16x32_bf16 v[8:11], v[72:75], v[32:35], v[8:11]
    v_mfma_f32_16x16x32_bf16 v[12:15], v[144:147], v[32:35], v[12:15]
    v_max3_u32 v5, v5, v32, v33
    v_mfma_f32_16x16x32_bf16 v[16:19], a[8:11], v[32:35], v[16:19]
    v_mfma_f32_16x16x32_bf16 v[20:23], a[80:83], v[32:35], v[20:23]
    v_max3_u32 v5, v5, v34, v35
    s_waitcnt vmcnt(14)
    v_mfma_f32_16x16x32_bf16 v[8:11], v[76:79], v[36:39], v[8:11]
    v_mfma_f32_16x16x32_bf16 v[12:15], v[148:151], v[36:39], v[12:15]
    v_max3_u32 v5, v5, v36, v37
    v_mfma_f32_16x16x32_bf16 v[16:19], a[12:15], v[36:39], v[16:19]
    v_mfma_f32_16x16x32_bf16 v[20:23], a[84:87], v[36:39], v[20:23]
    v_max3_u32 v5, v5, v38, v39
    s_waitcnt vmcnt(13)
    v_mfma_f32_16x16x32_bf16 v[8:11], v[80:83], v[40:43], v[8:11]
    v_mfma_f32_16x16x32_bf16 v[12:15], v[152:155], v[40:43], v[12:15]
    v_max3_u32 v5, v5, v40, v41
    v_mfma_f32_16x16x32_bf16 v[16:19], a[16:19], v[40:43], v[16:19]
    v_mfma_f32_16x16x32_bf16 v[20:23], a[88:91], v[40:43], v[20:23]
    v_max3_u32 v5, v5, v42, v43
    s_waitcnt vmcnt(12)
    v_mfma_f32_16x16x32_bf16 v[8:11], v[84:87], v[44:47], v[8:11]
    v_mfma_f32_16x16x32_bf16 v[12:15], v[156:159], v[44:47], v[12:15]
    v_max3_u32 v5, v5, v44, v45
    v_mfma_f32_16x16x32_bf16 v[16:19], a[20:23], v[44:47], v[16:19]
    v_mfma_f32_16x16x32_bf16 v[20:23], a[92:95], v[44:47], v[20:23]
    v_max3_u32 v5, v5, v46, v47
    s_waitcnt vmcnt(11)
    v_mfma_f32_16x16x32_bf16 v[8:11], v[88:91], v[48:51], v[8:11]
    v_mfma_f32_16x16x32_bf16 v[12:15], v[160:163], v[48:51], v[12:15]
    v_max3_u32 v5, v5, v48, v49
    v_mfma_f32_16x16x32_bf16 v[16:19], a[24:27], v[48:51], v[16:19]
    v_mfma_f32_16x16x32_bf16 v[20:23], a[96:99], v[48:51], v[20:23]
    v_max3_u32 v5, v5, v50, v51
    s_waitcnt vmcnt(10)
    v_mfma_f32_16x16x32_bf16 v[8:11], v[92:95], v[52:55], v[8:11]
    v_mfma_f32_16x16x32_bf16 v[12:15], v[164:167], v[52:55], v[12:15]
    v_max3_u32 v5, v5, v52, v53
    v_mfma_f32_16x16x32_bf16 v[16:19], a[28:31], v[52:55], v[16:19]
    v_mfma_f32_16x16x32_bf16 v[20:23], a[100:103], v[52:55], v[20:23]
    v_max3_u32 v5, v5, v54, v55
    s_waitcnt vmcnt(9)
    v_mfma_f32_16x16x32_bf16 v[8:11], v[96:99], v[56:59], v[8:11]
    v_mfma_f32_16x16x32_bf16 v[12:15], v[168:171], v[56:59], v[12:15]
    v_max3_u32 v5, v5, v56, v57
    v_mfma_f32_16x16x32_bf16 v[16:19], a[32:35], v[56:59], v[16:19]
    v_mfma_f32_16x16x32_bf16 v[20:23], a[104:107], v[56:59], v[20:23]
    v_max3_u32 v5, v5, v58, v59
    s_waitcnt vmcnt(8)
    v_mfma_f32_16x16x32_bf16 v[8:11], v[100:103], v[60:63], v[8:11]
    v_mfma_f32_16x16x32_bf16 v[12:15], v[172:175], v[60:63], v[12:15]
    v_max3_u32 v5, v5, v60, v61
    v_mfma_f32_16x16x32_bf16 v[16:19], a[36:39], v[60:63], v[16:19]
    v_mfma_f32_16x16x32_bf16 v[20:23], a[108:111], v[60:63], v[20:23]
    v_max3_u32 v5, v5, v62, v63
    s_waitcnt vmcnt(7)
    v_mfma_f32_16x16x32_bf16 v[8:11], v[104:107], v[208:211], v[8:11]
    v_mfma_f32_16x16x32_bf16 v[12:15], v[176:179], v[208:211], v[12:15]
    v_max3_u32 v5, v5, v208, v209
    v_mfma_f32_16x16x32_bf16 v[16:19], a[40:43], v[208:211], v[16:19]
    v_mfma_f32_16x16x32_bf16 v[20:23], a[112:115], v[208:211], v[20:23]
    v_max3_u32 v5, v5, v210, v211
    s_waitcnt vmcnt(6)
    v_mfma_f32_16x16x32_bf16 v[8:11], v[108:111], v[212:215], v[8:11]
    v_mfma_f32_16x16x32_bf16 v[12:15], v[180:183], v[212:215], v[12:15]
    v_max3_u32 v5, v5, v212, v213
    v_mfma_f32_16x16x32_bf16 v[16:19], a[44:47], v[212:215], v[16:19]
    v_mfma_f32_16x16x32_bf16 v[20:23], a[116:119], v[212:215], v[20:23]
    v_max3_u32 v5, v5, v214, v215
    s_waitcnt vmcnt(5)
    v_mfma_f32_16x16x32_bf16 v[8:11], v[112:115], v[216:219], v[8:11]
    v_mfma_f32_16x16x32_bf16 v[12:15], v[184:187], v[216:219], v[12:15]
    v_max3_u32 v5, v5, v216, v217
    v_mfma_f32_16x16x32_bf16 v[16:19], a[48:51], v[216:219], v[16:19]
    v_mfma_f32_16x16x32_bf16 v[20:23], a[120:123], v[216:219], v[20:23]
    v_max3_u32 v5, v5, v218, v219
    s_waitcnt vmcnt(4)
    v_mfma_f32_16x16x32_bf16 v[8:11], v[116:119], v[220:223], v[8:11]
    v_mfma_f32_16x16x32_bf16 v[12:15], v[188:191], v[220:223], v[12:15]
    v_max3_u32 v5, v5, v220, v221
    v_mfma_f32_16x16x32_bf16 v[16:19], a[52:55], v[220:223], v[16:19]
    v_mfma_f32_16x16x32_bf16 v[20:23], a[124:127], v[220:223], v[20:23]
    v_max3_u32 v5, v5, v222, v223
    s_waitcnt vmcnt(3)
    v_mfma_f32_16x16x32_bf16 v[8:11], v[120:123], v[224:227], v[8:11]
    v_mfma_f32_16x16x32_bf16 v[12:15], v[192:195], v[224:227], v[12:15]
    v_max3_u32 v5, v5, v224, v225
    v_mfma_f32_16x16x32_bf16 v[16:19], a[56:59], v[224:227], v[16:19]
    v_mfma_f32_16x16x32_bf16 v[20:23], a[128:131], v[224:227], v[20:23]
    v_max3_u32 v5, v5, v226, v227
    s_waitcnt vmcnt(2)
    v_mfma_f32_16x16x32_bf16 v[8:11], v[124:127], v[228:231], v[8:11]
    v_mfma_f32_16x16x32_bf16 v[12:15], v[196:199], v[228:231], v[12:15]
    v_max3_u32 v5, v5, v228, v229
    v_mfma_f32_16x16x32_bf16 v[16:19], a[60:63], v[228:231], v[16:19]
    v_mfma_f32_16x16x32_bf16 v[20:23], a[132:135], v[228:231], v[20:23]
    v_max3_u32 v5, v5, v230, v231
    s_waitcnt vmcnt(1)
    v_mfma_f32_16x16x32_bf16 v[8:11], v[128:131], v[232:235], v[8:11]
    v_mfma_f32_16x16x32_bf16 v[12:15], v[200:203], v[232:235], v[12:15]
    v_max3_u32 v5, v5, v232, v233
    v_mfma_f32_16x16x32_bf16 v[16:19], a[64:67], v[232:235], v[16:19]
    v_mfma_f32_16x16x32_bf16 v[20:23], a[136:139], v[232:235], v[20:23]
    v_max3_u32 v5, v5, v234, v235
    s_waitcnt vmcnt(0)
    v_mfma_f32_16x16x32_bf16 v[8:11], v[132:135], v[236:239], v[8:11]
    v_mfma_f32_16x16x32_bf16 v[12:15], v[204:207], v[236:239], v[12:15]
    v_max3_u32 v5, v5, v236, v237
    v_mfma_f32_16x16x32_bf16 v[16:19], a[68:71], v[236:239], v[16:19]
    v_mfma_f32_16x16x32_bf16 v[20:23], a[140:143], v[236:239], v[20:23]
    v_max3_u32 v5, v5, v238, v239
    s_nop 5
    s_branch mk_st
mk_v:
    s_waitcnt vmcnt(17)
    v_mfma_f32_16x16x32_bf16 v[8:11], v[24:27], v[64:67], 0
    v_mfma_f32_16x16x32_bf16 v[12:15], v[24:27], v[136:139], 0
    v_max3_u32 v5, v5, v24, v25
    v_mfma_f32_16x16x32_bf16 v[16:19], v[24:27], a[0:3], 0
    v_mfma_f32_16x16x32_bf16 v[20:23], v[24:27], a[72:75], 0
    v_max3_u32 v5, v5, v26, v27
    s_waitcnt vmcnt(16)
    v_mfma_f32_16x16x32_bf16 v[8:11], v[28:31], v[68:71], v[8:11]
    v_mfma_f32_16x16x32_bf16 v[12:15], v[28:31], v[140:143], v[12:15]
    v_max3_u32 v5, v5, v28, v29
    v_mfma_f32_16x16x32_bf16 v[16:19], v[28:31], a[4:7], v[16:19]
    v_mfma_f32_16x16x32_bf16 v[20:23], v[28:31], a[76:79], v[20:23]
    v_max3_u32 v5, v5, v30, v31
    s_waitcnt vmcnt(15)
    v_mfma_f32_16x16x32_bf16 v[8:11], v[32:35], v[72:75], v[8:11]
    v_mfma_f32_16x16x32_bf16 v[12:15], v[32:35], v[144:147], v[12:15]
    v_max3_u32 v5, v5, v32, v33
    v_mfma_f32_16x16x32_bf16 v[16:19], v[32:35], a[8:11], v[16:19]
    v_mfma_f32_16x16x32_bf16 v[20:23], v[32:35], a[80:83], v[20:23]
    v_max3_u32 v5, v5, v34, v35
    s_waitcnt vmcnt(14)
    v_mfma_f32_16x16x32_bf16 v[8:11], v[36:39], v[76:79], v[8:11]
    v_mfma_f32_16x16x32_bf16 v[12:15], v[36:39], v[148:151], v[12:15]
    v_max3_u32 v5, v5, v36, v37
    v_mfma_f32_16x16x32_bf16 v[16:19], v[36:39], a[12:15], v[16:19]
    v_mfma_f32_16x16x32_bf16 v[20:23], v[36:39], a[84:87], v[20:23]
    v_max3_u32 v5, v5, v38, v39
    s_waitcnt vmcnt(13)
    v_mfma_f32_16x16x32_bf16 v[8:11], v[40:43], v[80:83], v[8:11]
    v_mfma_f32_16x16x32_bf16 v[12:15], v[40:43], v[152:155], v[12:15]
    v_max3_u32 v5, v5, v40, v41
    v_mfma_f32_16x16x32_bf16 v[16:19], v[40:43], a[16:19], v[16:19]
    v_mfma_f32_16x16x32_bf16 v[20:23], v[40:43], a[88:91], v[20:23]
    v_max3_u32 v5, v5, v42, v43
    s_waitcnt vmcnt(12)
    v_mfma_f32_16x16x32_bf16 v[8:11], v[44:47], v[84:87], v[8:11]
    v_mfma_f32_16x16x32_bf16 v[12:15], v[44:47], v[156:159], v[12:15]
    v_max3_u32 v5, v5, v44, v45
    v_mfma_f32_16x16x32_bf16 v[16:19], v[44:47], a[20:23], v[16:19]
    v_mfma_f32_16x16x32_bf16 v[20:23], v[44:47], a[92:95], v[20:23]
    v_max3_u32 v5, v5, v46, v47
    s_waitcnt vmcnt(11)
    v_mfma_f32_16x16x32_bf16 v[8:11], v[48:51], v[88:91], v[8:11]
    v_mfma_f32_16x16x32_bf16 v[12:15], v[48:51], v[160:163], v[12:15]
    v_max3_u32 v5, v5, v48, v49
    v_mfma_f32_16x16x32_bf16 v[16:19], v[48:51], a[24:27], v[16:19]
    v_mfma_f32_16x16x32_bf16 v[20:23], v[48:51], a[96:99], v[20:23]
    v_max3_u32 v5, v5, v50, v51
    s_waitcnt vmcnt(10)
    v_mfma_f32_16x16x32_bf16 v[8:11], v[52:55], v[92:95], v[8:11]
    v_mfma_f32_16x16x32_bf16 v[12:15], v[52:55], v[164:167], v[12:15]
    v_max3_u32 v5, v5, v52, v53
    v_mfma_f32_16x16x32_bf16 v[16:19], v[52:55], a[28:31], v[16:19]
    v_mfma_f32_16x16x32_bf16 v[20:23], v[52:55], a[100:103], v[20:23]
    v_max3_u32 v5, v5, v54, v55
    s_waitcnt vmcnt(9)
    v_mfma_f32_16x16x32_bf16 v[8:11], v[56:59], v[96:99], v[8:11]
    v_mfma_f32_16x16x32_bf16 v[12:15], v[56:59], v[168:171], v[12:15]
    v_max3_u32 v5, v5, v56, v57
    v_mfma_f32_16x16x32_bf16 v[16:19], v[56:59], a[32:35], v[16:19]
    v_mfma_f32_16x16x32_bf16 v[20:23], v[56:59], a[104:107], v[20:23]
    v_max3_u32 v5, v5, v58, v59
    s_waitcnt vmcnt(8)
    v_mfma_f32_16x16x32_bf16 v[8:11], v[60:63], v[100:103], v[8:11]
    v_mfma_f32_16x16x32_bf16 v[12:15], v[60:63], v[172:175], v[12:15]
    v_max3_u32 v5, v5, v60, v61
    v_mfma_f32_16x16x32_bf16 v[16:19], v[60:63], a[36:39], v[16:19]
    v_mfma_f32_16x16x32_bf16 v[20:23], v[60:63], a[108:111], v[20:23]
    v_max3_u32 v5, v5, v62, v63
    s_waitcnt vmcnt(7)
    v_mfma_f32_16x16x32_bf16 v[8:11], v[208:211], v[104:107], v[8:11]
    v_mfma_f32_16x16x32_bf16 v[12:15], v[208:211], v[176:179], v[12:15]
    v_max3_u32 v5, v5, v208, v209
    v_mfma_f32_16x16x32_bf16 v[16:19], v[208:211], a[40:43], v[16:19]
    v_mfma_f32_16x16x32_bf16 v[20:23], v[208:211], a[112:115], v[20:23]
    v_max3_u32 v5, v5, v210, v211
    s_waitcnt vmcnt(6)
    v_mfma_f32_16x16x32_bf16 v[8:11], v[212:215], v[108:111], v[8:11]
    v_mfma_f32_16x16x32_bf16 v[12:15], v[212:215], v[180:183], v[12:15]
    v_max3_u32 v5, v5, v212, v213
    v_mfma_f32_16x16x32_bf16 v[16:19], v[212:215], a[44:47], v[16:19]
    v_mfma_f32_16x16x32_bf16 v[20:23], v[212:215], a[116:119], v[20:23]
    v_max3_u32 v5, v5, v214, v215
    s_waitcnt vmcnt(5)
    v_mfma_f32_16x16x32_bf16 v[8:11], v[216:219], v[112:115], v[8:11]
    v_mfma_f32_16x16x32_bf16 v[12:15], v[216:219], v[184:187], v[12:15]
    v_max3_u32 v5, v5, v216, v217
    v_mfma_f32_16x16x32_bf16 v[16:19], v[216:219], a[48:51], v[16:19]
    v_mfma_f32_16x16x32_bf16 v[20:23], v[216:219], a[120:123], v[20:23]
    v_max3_u32 v5, v5, v218, v219
    s_waitcnt vmcnt(4)
    v_mfma_f32_16x16x32_bf16 v[8:11], v[220:223], v[116:119], v[8:11]
    v_mfma_f32_16x16x32_bf16 v[12:15], v[220:223], v[188:191], v[12:15]
    v_max3_u32 v5, v5, v220, v221
    v_mfma_f32_16x16x32_bf16 v[16:19], v[220:223], a[52:55], v[16:19]
    v_mfma_f32_16x16x32_bf16 v[20:23], v[220:223], a[124:127], v[20:23]
    v_max3_u32 v5, v5, v222, v223
    s_waitcnt vmcnt(3)
    v_mfma_f32_16x16x32_bf16 v[8:11], v[224:227], v[120:123], v[8:11]
    v_mfma_f32_16x16x32_bf16 v[12:15], v[224:227], v[192:195], v[12:15]
    v_max3_u32 v5, v5, v224, v225
    v_mfma_f32_16x16x32_bf16 v[16:19], v[224:227], a[56:59], v[16:19]
    v_mfma_f32_16x16x32_bf16 v[20:23], v[224:227], a[128:131], v[20:23]
    v_max3_u32 v5, v5, v226, v227
    s_waitcnt vmcnt(2)
    v_mfma_f32_16x16x32_bf16 v[8:11], v[228:231], v[124:127], v[8:11]
    v_mfma_f32_16x16x32_bf16 v[12:15], v[228:231], v[196:199], v[12:15]
    v_max3_u32 v5, v5, v228, v229
    v_mfma_f32_16x16x32_bf16 v[16:19], v[228:231], a[60:63], v[16:19]
    v_mfma_f32_16x16x32_bf16 v[20:23], v[228:231], a[132:135], v[20:23]
    v_max3_u32 v5, v5, v230, v231
    s_waitcnt vmcnt(1)
    v_mfma_f32_16x16x32_bf16 v[8:11], v[232:235], v[128:131], v[8:11]
    v_mfma_f32_16x16x32_bf16 v[12:15], v[232:235], v[200:203], v[12:15]
    v_max3_u32 v5, v5, v232, v233
    v_mfma_f32_16x16x32_bf16 v[16:19], v[232:235], a[64:67], v[16:19]
    v_mfma_f32_16x16x32_bf16 v[20:23], v[232:235], a[136:139], v[20:23]
    v_max3_u32 v5, v5, v234, v235
    s_waitcnt vmcnt(0)
    v_mfma_f32_16x16x32_bf16 v[8:11], v[236:239], v[132:135], v[8:11]
    v_mfma_f32_16x16x32_bf16 v[12:15], v[236:239], v[204:207], v[12:15]
    v_max3_u32 v5, v5, v236, v237
    v_mfma_f32_16x16x32_bf16 v[16:19], v[236:239], a[68:71], v[16:19]
    v_mfma_f32_16x16x32_bf16 v[20:23], v[236:239], a[140:143], v[20:23]
    v_max3_u32 v5, v5, v238, v239
    v_pk_mul_f32 v[8:9], v[8:9], 0.5 op_sel_hi:[1,0]
    v_pk_mul_f32 v[10:11], v[10:11], 0.5 op_sel_hi:[1,0]
    v_pk_mul_f32 v[12:13], v[12:13], 0.5 op_sel_hi:[1,0]
    v_pk_mul_f32 v[14:15], v[14:15], 0.5 op_sel_hi:[1,0]
    v_pk_mul_f32 v[16:17], v[16:17], 0.5 op_sel_hi:[1,0]
    v_pk_mul_f32 v[18:19], v[18:19], 0.5 op_sel_hi:[1,0]
    v_pk_mul_f32 v[20:21], v[20:21], 0.5 op_sel_hi:[1,0]
    v_pk_mul_f32 v[22:23], v[22:23], 0.5 op_sel_hi:[1,0]
    s_nop 1
mk_st:
    v_cmp_eq_u32 vcc, -1, v5
    s_sub_u32 s30, s30, 1
    s_cbranch_scc1 mk_ok
    s_cbranch_vccnz mk_again
mk_ok:
    s_add_u32 s24, s24, 24576
    v_cvt_pk_bf16_f32 v24, v8, v9
    v_cvt_pk_bf16_f32 v25, v10, v11
    v_cvt_pk_bf16_f32 v26, v12, v13
    v_cvt_pk_bf16_f32 v27, v14, v15
    v_cvt_pk_bf16_f32 v28, v16, v17
    v_cvt_pk_bf16_f32 v29, v18, v19
    v_cvt_pk_bf16_f32 v30, v20, v21
    v_cvt_pk_bf16_f32 v31, v22, v23
    s_add_u32 s21, s26, 4096
    buffer_store_dwordx4 v[24:27], v7, s[4:7], s26 offen sc1
    buffer_store_dwordx4 v[28:31], v7, s[4:7], s21 offen sc1
    s_waitcnt vmcnt(0)
    s_barrier
    v_mov_b32 v4, s22
    s_mov_b64 exec, s[34:35]
    buffer_store_dword v4, off, s[4:7], s29 sc1
    s_mov_b64 exec, -1
    s_add_u32 s19, s19, 2
    s_add_u32 s26, s26, 262144
    s_cmp_lt_u32 s19, 62
    s_cbranch_scc1 mk_loop
    s_endpgm
L_ssm_next:
    s_mov_b32 s37, 8
    v_mov_b32 v250, 1
    v_mov_b32 v251, 163832
    v_cmp_eq_u32 vcc, 0, v0
    s_nop 0
    s_and_saveexec_b64 s[38:39], vcc
    s_cbranch_execz tk8
    buffer_atomic_add v250, off, s[96:99], s37 sc0
    s_waitcnt vmcnt(0)
    ds_write_b32 v251, v250
    s_waitcnt lgkmcnt(0)
tk8:
    s_mov_b64 exec, -1
    s_barrier
    ds_read_b32 v252, v251
    s_waitcnt lgkmcnt(0)
    v_readfirstlane_b32 s20, v252
    s_barrier
    s_nop 3
    s_cmp_ge_u32 s20, 144
    s_cbranch_scc1 L_phase2
    s_lshl_b32 s20, s20, 2
    v_lshrrev_b32 v5, 6, v0
    s_nop 0
    v_readfirstlane_b32 s21, v5
    v_and_b32 v1, 63, v0
    v_and_b32 v2, 15, v1
    v_lshrrev_b32 v3, 4, v1
    v_lshlrev_b32 v4, 14, v5
    s_mov_b32 s8, s62
    s_mov_b32 s9, s63
    s_mov_b32 s10, 2359296
    s_mov_b32 s11, 0x20000
    s_mov_b32 s16, s76
    s_mov_b32 s17, s77
    s_mov_b32 s18, 4718592
    s_mov_b32 s19, 0x20000
    v_mul_u32_u24 v5, 9216, v0
    s_lshl_b32 s22, s20, 1
    s_add_u32 s23, s22, 0
    buffer_load_dwordx2 v[8:9], v5, s[8:11], s23 offen
    s_add_u32 s23, s22, 1152
    buffer_load_dwordx2 v[10:11], v5, s[8:11], s23 offen
    s_add_u32 s23, s22, 2304
    buffer_load_dwordx2 v[12:13], v5, s[8:11], s23 offen
    s_add_u32 s23, s22, 3456
    buffer_load_dwordx2 v[14:15], v5, s[8:11], s23 offen
    s_add_u32 s23, s22, 4608
    buffer_load_dwordx2 v[16:17], v5, s[8:11], s23 offen
    s_add_u32 s23, s22, 5760
    buffer_load_dwordx2 v[18:19], v5, s[8:11], s23 offen
    s_add_u32 s23, s22, 6912
    buffer_load_dwordx2 v[20:21], v5, s[8:11], s23 offen
    s_add_u32 s23, s22, 8064
    buffer_load_dwordx2 v[22:23], v5, s[8:11], s23 offen
    s_add_u32 s22, s20, s21
    s_lshl_b32 s23, s22, 8
    v_lshlrev_b32 v6, 3, v2
    v_lshl_add_u32 v6, v3, 1, v6
    s_mov_b32 s12, s64
    s_mov_b32 s13, s65
    s_mov_b32 s14, 147456
    s_mov_b32 s15, 0x20000
    buffer_load_ushort v24, v6, s[12:15], s23 offen offset:0
    buffer_load_ushort v28, v6, s[12:15], s23 offen offset:128
    s_mov_b32 s12, s66
    s_mov_b32 s13, s67
    s_mov_b32 s14, 147456
    s_mov_b32 s15, 0x20000
    buffer_load_ushort v25, v6, s[12:15], s23 offen offset:0
    buffer_load_ushort v29, v6, s[12:15], s23 offen offset:128
    s_mov_b32 s12, s68
    s_mov_b32 s13, s69
    s_mov_b32 s14, 147456
    s_mov_b32 s15, 0x20000
    buffer_load_ushort v26, v6, s[12:15], s23 offen offset:0
    buffer_load_ushort v30, v6, s[12:15], s23 offen offset:128
    s_mov_b32 s12, s70
    s_mov_b32 s13, s71
    s_mov_b32 s14, 147456
    s_mov_b32 s15, 0x20000
    buffer_load_ushort v27, v6, s[12:15], s23 offen offset:0
    buffer_load_ushort v31, v6, s[12:15], s23 offen offset:128
    s_mov_b32 s12, s72
    s_mov_b32 s13, s73
    s_mov_b32 s14, 1152
    s_mov_b32 s15, 0x20000
    s_lshl_b32 s23, s22, 1
    buffer_load_ushort v32, off, s[12:15], s23
    s_mov_b32 s26, 0x3fb8aa3b
    s_mov_b32 s27, 0x3e22f983
    v_mov_b32 v34, 0
    v_mov_b32 v35, 0
    v_lshl_add_u32 v6, v1, 3, v4
    ds_write_b64 v6, v[34:35] offset:0
    s_waitcnt vmcnt(0)
    v_mov_b32 v36, 0x05040100
    v_mov_b32 v37, 0x07060302
    v_lshlrev_b32 v6, 4, v0
    v_perm_b32 v40, v10, v8, v36
    v_perm_b32 v41, v14, v12, v36
    v_perm_b32 v42, v18, v16, v36
    v_perm_b32 v43, v22, v20, v36
    ds_write_b128 v6, v[40:43] offset:512
    s_nop 1
    v_perm_b32 v40, v10, v8, v37
    v_perm_b32 v41, v14, v12, v37
    v_perm_b32 v42, v18, v16, v37
    v_perm_b32 v43, v22, v20, v37
    ds_write_b128 v6, v[40:43] offset:16896
    s_nop 1
    v_perm_b32 v40, v11, v9, v36
    v_perm_b32 v41, v15, v13, v36
    v_perm_b32 v42, v19, v17, v36
    v_perm_b32 v43, v23, v21, v36
    ds_write_b128 v6, v[40:43] offset:33280
    s_nop 1
    v_perm_b32 v40, v11, v9, v37
    v_perm_b32 v41, v15, v13, v37
    v_perm_b32 v42, v19, v17, v37
    v_perm_b32 v43, v23, v21, v37
    ds_write_b128 v6, v[40:43] offset:49664
    s_nop 1
    v_lshlrev_b32 v32, 16, v32
    v_mul_f32 v32, s26, v32
    v_exp_f32 v32, v32
    s_nop 0
    v_cvt_pk_bf16_f32 v32, v32, v32
    v_and_b32 v32, 0xffff0000, v32
    v_add_f32 v33, v32, v32
    v_lshlrev_b32 v24, 16, v24
    v_mul_f32 v24, s26, v24
    v_exp_f32 v24, v24
    s_nop 0
    v_cvt_pk_bf16_f32 v24, v24, v24
    v_and_b32 v24, 0xffff0000, v24
    v_mul_f32 v24, v24, v32
    v_mul_f32 v24, s26, v24
    v_sub_f32 v24, 0, v24
    v_lshlrev_b32 v25, 16, v25
    v_mul_f32 v25, v25, v32
    v_mul_f32 v25, s27, v25
    v_lshlrev_b32 v26, 16, v26
    v_mul_f32 v26, v26, v33
    v_lshlrev_b32 v27, 16, v27
    v_mul_f32 v27, v27, v33
    v_lshlrev_b32 v28, 16, v28
    v_mul_f32 v28, s26, v28
    v_exp_f32 v28, v28
    s_nop 0
    v_cvt_pk_bf16_f32 v28, v28, v28
    v_and_b32 v28, 0xffff0000, v28
    v_mul_f32 v28, v28, v32
    v_mul_f32 v28, s26, v28
    v_sub_f32 v28, 0, v28
    v_lshlrev_b32 v29, 16, v29
    v_mul_f32 v29, v29, v32
    v_mul_f32 v29, s27, v29
    v_lshlrev_b32 v30, 16, v30
    v_mul_f32 v30, v30, v33
    v_lshlrev_b32 v31, 16, v31
    v_mul_f32 v31, v31, v33
    v_cvt_f32_u32 v47, v2
    v_mul_f32 v44, 0x41800000, v47
    v_and_b32 v5, 7, v2
    v_add_u32 v5, 8, v5
    v_cvt_f32_u32 v5, v5
    v_mul_f32 v45, 0x42000000, v5
    v_mul_f32 v6, 0x42800000, v5
    v_cmp_lt_u32 vcc, 7, v2
    s_nop 1
    v_cndmask_b32 v45, v45, v6, vcc
    v_add_f32 v5, 0x41000000, v47
    v_mul_f32 v46, 0x43000000, v5
    v_mov_b32 v48, 0
    v_mov_b32 v49, 0
    v_mov_b32 v50, 0
    v_mov_b32 v51, 0
    v_mov_b32 v52, 0
    v_mov_b32 v53, 0
    v_mov_b32 v54, 0
    v_mov_b32 v55, 0
    v_mov_b32 v56, 0
    v_mov_b32 v57, 0
    v_mov_b32 v58, 0
    v_mov_b32 v59, 0
    v_mov_b32 v60, 0
    v_mov_b32 v61, 0
    v_mov_b32 v62, 0
    v_mov_b32 v63, 0
    v_mov_b32_dpp v64, v24 row_newbcast:0 row_mask:0xf bank_mask:0xf
    v_mov_b32_dpp v65, v25 row_newbcast:0 row_mask:0xf bank_mask:0xf
    v_mov_b32_dpp v66, v26 row_newbcast:0 row_mask:0xf bank_mask:0xf
    v_mov_b32_dpp v67, v27 row_newbcast:0 row_mask:0xf bank_mask:0xf
    v_mul_f32 v82, v64, v47
    v_mul_f32 v83, v65, v47
    v_exp_f32 v82, v82
    v_fract_f32 v83, v83
    v_cos_f32 v74, v83
    v_sin_f32 v75, v83
    v_mul_f32 v74, v74, v82
    v_mul_f32 v75, v75, v82
    v_mul_f32 v84, v75, v75
    v_add_f32 v85, v74, v74
    v_fma_f32 v76, v74, v74, -v84
    v_mul_f32 v77, v85, v75
    v_mul_f32 v84, v77, v77
    v_add_f32 v85, v76, v76
    v_fma_f32 v78, v76, v76, -v84
    v_mul_f32 v79, v85, v77
    v_mul_f32 v84, v79, v79
    v_add_f32 v85, v78, v78
    v_fma_f32 v80, v78, v78, -v84
    v_mul_f32 v81, v85, v79
    v_mul_f32 v82, v64, v44
    v_mul_f32 v83, v65, v44
    v_exp_f32 v82, v82
    v_fract_f32 v83, v83
    v_cos_f32 v68, v83
    v_sin_f32 v69, v83
    v_mul_f32 v68, v68, v82
    v_mul_f32 v69, v69, v82
    v_mul_f32 v84, v67, v69
    v_mul_f32 v85, v67, v68
    v_fma_f32 v68, v66, v68, -v84
    v_fma_f32 v69, -v66, v69, -v85
    v_mul_f32 v82, v64, v45
    v_mul_f32 v83, v65, v45
    v_exp_f32 v82, v82
    v_fract_f32 v83, v83
    v_cos_f32 v70, v83
    v_sin_f32 v71, v83
    v_mul_f32 v70, v70, v82
    v_mul_f32 v71, v71, v82
    v_mul_f32 v84, v67, v71
    v_mul_f32 v85, v67, v70
    v_fma_f32 v70, v66, v70, -v84
    v_fma_f32 v71, -v66, v71, -v85
    v_mul_f32 v82, v64, v46
    v_mul_f32 v83, v65, v46
    v_exp_f32 v82, v82
    v_fract_f32 v83, v83
    v_cos_f32 v72, v83
    v_sin_f32 v73, v83
    v_mul_f32 v72, v72, v82
    v_mul_f32 v73, v73, v82
    v_mul_f32 v84, v67, v73
    v_mul_f32 v85, v67, v72
    v_fma_f32 v72, v66, v72, -v84
    v_fma_f32 v73, -v66, v73, -v85
    v_mfma_f32_16x16x4_f32 v[48:51], v68, v74, v[48:51]
    v_mfma_f32_16x16x4_f32 v[52:55], v70, v76, v[52:55]
    v_mfma_f32_16x16x4_f32 v[56:59], v70, v78, v[56:59]
    v_mfma_f32_16x16x4_f32 v[60:63], v72, v80, v[60:63]
    v_mfma_f32_16x16x4_f32 v[48:51], v69, v75, v[48:51]
    v_mfma_f32_16x16x4_f32 v[52:55], v71, v77, v[52:55]
    v_mfma_f32_16x16x4_f32 v[56:59], v71, v79, v[56:59]
    v_mfma_f32_16x16x4_f32 v[60:63], v73, v81, v[60:63]
    v_mov_b32_dpp v64, v24 row_newbcast:1 row_mask:0xf bank_mask:0xf
    v_mov_b32_dpp v65, v25 row_newbcast:1 row_mask:0xf bank_mask:0xf
    v_mov_b32_dpp v66, v26 row_newbcast:1 row_mask:0xf bank_mask:0xf
    v_mov_b32_dpp v67, v27 row_newbcast:1 row_mask:0xf bank_mask:0xf
    v_mul_f32 v82, v64, v47
    v_mul_f32 v83, v65, v47
    v_exp_f32 v82, v82
    v_fract_f32 v83, v83
    v_cos_f32 v74, v83
    v_sin_f32 v75, v83
    v_mul_f32 v74, v74, v82
    v_mul_f32 v75, v75, v82
    v_mul_f32 v84, v75, v75
    v_add_f32 v85, v74, v74
    v_fma_f32 v76, v74, v74, -v84
    v_mul_f32 v77, v85, v75
    v_mul_f32 v84, v77, v77
    v_add_f32 v85, v76, v76
    v_fma_f32 v78, v76, v76, -v84
    v_mul_f32 v79, v85, v77
    v_mul_f32 v84, v79, v79
    v_add_f32 v85, v78, v78
    v_fma_f32 v80, v78, v78, -v84
    v_mul_f32 v81, v85, v79
    v_mul_f32 v82, v64, v44
    v_mul_f32 v83, v65, v44
    v_exp_f32 v82, v82
    v_fract_f32 v83, v83
    v_cos_f32 v68, v83
    v_sin_f32 v69, v83
    v_mul_f32 v68, v68, v82
    v_mul_f32 v69, v69, v82
    v_mul_f32 v84, v67, v69
    v_mul_f32 v85, v67, v68
    v_fma_f32 v68, v66, v68, -v84
    v_fma_f32 v69, -v66, v69, -v85
    v_mul_f32 v82, v64, v45
    v_mul_f32 v83, v65, v45
    v_exp_f32 v82, v82
    v_fract_f32 v83, v83
    v_cos_f32 v70, v83
    v_sin_f32 v71, v83
    v_mul_f32 v70, v70, v82
    v_mul_f32 v71, v71, v82
    v_mul_f32 v84, v67, v71
    v_mul_f32 v85, v67, v70
    v_fma_f32 v70, v66, v70, -v84
    v_fma_f32 v71, -v66, v71, -v85
    v_mul_f32 v82, v64, v46
    v_mul_f32 v83, v65, v46
    v_exp_f32 v82, v82
    v_fract_f32 v83, v83
    v_cos_f32 v72, v83
    v_sin_f32 v73, v83
    v_mul_f32 v72, v72, v82
    v_mul_f32 v73, v73, v82
    v_mul_f32 v84, v67, v73
    v_mul_f32 v85, v67, v72
    v_fma_f32 v72, v66, v72, -v84
    v_fma_f32 v73, -v66, v73, -v85
    v_mfma_f32_16x16x4_f32 v[48:51], v68, v74, v[48:51]
    v_mfma_f32_16x16x4_f32 v[52:55], v70, v76, v[52:55]
    v_mfma_f32_16x16x4_f32 v[56:59], v70, v78, v[56:59]
    v_mfma_f32_16x16x4_f32 v[60:63], v72, v80, v[60:63]
    v_mfma_f32_16x16x4_f32 v[48:51], v69, v75, v[48:51]
    v_mfma_f32_16x16x4_f32 v[52:55], v71, v77, v[52:55]
    v_mfma_f32_16x16x4_f32 v[56:59], v71, v79, v[56:59]
    v_mfma_f32_16x16x4_f32 v[60:63], v73, v81, v[60:63]
    v_mov_b32_dpp v64, v24 row_newbcast:2 row_mask:0xf bank_mask:0xf
    v_mov_b32_dpp v65, v25 row_newbcast:2 row_mask:0xf bank_mask:0xf
    v_mov_b32_dpp v66, v26 row_newbcast:2 row_mask:0xf bank_mask:0xf
    v_mov_b32_dpp v67, v27 row_newbcast:2 row_mask:0xf bank_mask:0xf
    v_mul_f32 v82, v64, v47
    v_mul_f32 v83, v65, v47
    v_exp_f32 v82, v82
    v_fract_f32 v83, v83
    v_cos_f32 v74, v83
    v_sin_f32 v75, v83
    v_mul_f32 v74, v74, v82
    v_mul_f32 v75, v75, v82
    v_mul_f32 v84, v75, v75
    v_add_f32 v85, v74, v74
    v_fma_f32 v76, v74, v74, -v84
    v_mul_f32 v77, v85, v75
    v_mul_f32 v84, v77, v77
    v_add_f32 v85, v76, v76
    v_fma_f32 v78, v76, v76, -v84
    v_mul_f32 v79, v85, v77
    v_mul_f32 v84, v79, v79
    v_add_f32 v85, v78, v78
    v_fma_f32 v80, v78, v78, -v84
    v_mul_f32 v81, v85, v79
    v_mul_f32 v82, v64, v44
    v_mul_f32 v83, v65, v44
    v_exp_f32 v82, v82
    v_fract_f32 v83, v83
    v_cos_f32 v68, v83
    v_sin_f32 v69, v83
    v_mul_f32 v68, v68, v82
    v_mul_f32 v69, v69, v82
    v_mul_f32 v84, v67, v69
    v_mul_f32 v85, v67, v68
    v_fma_f32 v68, v66, v68, -v84
    v_fma_f32 v69, -v66, v69, -v85
    v_mul_f32 v82, v64, v45
    v_mul_f32 v83, v65, v45
    v_exp_f32 v82, v82
    v_fract_f32 v83, v83
    v_cos_f32 v70, v83
    v_sin_f32 v71, v83
    v_mul_f32 v70, v70, v82
    v_mul_f32 v71, v71, v82
    v_mul_f32 v84, v67, v71
    v_mul_f32 v85, v67, v70
    v_fma_f32 v70, v66, v70, -v84
    v_fma_f32 v71, -v66, v71, -v85
    v_mul_f32 v82, v64, v46
    v_mul_f32 v83, v65, v46
    v_exp_f32 v82, v82
    v_fract_f32 v83, v83
    v_cos_f32 v72, v83
    v_sin_f32 v73, v83
    v_mul_f32 v72, v72, v82
    v_mul_f32 v73, v73, v82
    v_mul_f32 v84, v67, v73
    v_mul_f32 v85, v67, v72
    v_fma_f32 v72, v66, v72, -v84
    v_fma_f32 v73, -v66, v73, -v85
    v_mfma_f32_16x16x4_f32 v[48:51], v68, v74, v[48:51]
    v_mfma_f32_16x16x4_f32 v[52:55], v70, v76, v[52:55]
    v_mfma_f32_16x16x4_f32 v[56:59], v70, v78, v[56:59]
    v_mfma_f32_16x16x4_f32 v[60:63], v72, v80, v[60:63]
    v_mfma_f32_16x16x4_f32 v[48:51], v69, v75, v[48:51]
    v_mfma_f32_16x16x4_f32 v[52:55], v71, v77, v[52:55]
    v_mfma_f32_16x16x4_f32 v[56:59], v71, v79, v[56:59]
    v_mfma_f32_16x16x4_f32 v[60:63], v73, v81, v[60:63]
    v_mov_b32_dpp v64, v24 row_newbcast:3 row_mask:0xf bank_mask:0xf
    v_mov_b32_dpp v65, v25 row_newbcast:3 row_mask:0xf bank_mask:0xf
    v_mov_b32_dpp v66, v26 row_newbcast:3 row_mask:0xf bank_mask:0xf
    v_mov_b32_dpp v67, v27 row_newbcast:3 row_mask:0xf bank_mask:0xf
    v_mul_f32 v82, v64, v47
    v_mul_f32 v83, v65, v47
    v_exp_f32 v82, v82
    v_fract_f32 v83, v83
    v_cos_f32 v74, v83
    v_sin_f32 v75, v83
    v_mul_f32 v74, v74, v82
    v_mul_f32 v75, v75, v82
    v_mul_f32 v84, v75, v75
    v_add_f32 v85, v74, v74
    v_fma_f32 v76, v74, v74, -v84
    v_mul_f32 v77, v85, v75
    v_mul_f32 v84, v77, v77
    v_add_f32 v85, v76, v76
    v_fma_f32 v78, v76, v76, -v84
    v_mul_f32 v79, v85, v77
    v_mul_f32 v84, v79, v79
    v_add_f32 v85, v78, v78
    v_fma_f32 v80, v78, v78, -v84
    v_mul_f32 v81, v85, v79
    v_mul_f32 v82, v64, v44
    v_mul_f32 v83, v65, v44
    v_exp_f32 v82, v82
    v_fract_f32 v83, v83
    v_cos_f32 v68, v83
    v_sin_f32 v69, v83
    v_mul_f32 v68, v68, v82
    v_mul_f32 v69, v69, v82
    v_mul_f32 v84, v67, v69
    v_mul_f32 v85, v67, v68
    v_fma_f32 v68, v66, v68, -v84
    v_fma_f32 v69, -v66, v69, -v85
    v_mul_f32 v82, v64, v45
    v_mul_f32 v83, v65, v45
    v_exp_f32 v82, v82
    v_fract_f32 v83, v83
    v_cos_f32 v70, v83
    v_sin_f32 v71, v83
    v_mul_f32 v70, v70, v82
    v_mul_f32 v71, v71, v82
    v_mul_f32 v84, v67, v71
    v_mul_f32 v85, v67, v70
    v_fma_f32 v70, v66, v70, -v84
    v_fma_f32 v71, -v66, v71, -v85
    v_mul_f32 v82, v64, v46
    v_mul_f32 v83, v65, v46
    v_exp_f32 v82, v82
    v_fract_f32 v83, v83
    v_cos_f32 v72, v83
    v_sin_f32 v73, v83
    v_mul_f32 v72, v72, v82
    v_mul_f32 v73, v73, v82
    v_mul_f32 v84, v67, v73
    v_mul_f32 v85, v67, v72
    v_fma_f32 v72, v66, v72, -v84
    v_fma_f32 v73, -v66, v73, -v85
    v_mfma_f32_16x16x4_f32 v[48:51], v68, v74, v[48:51]
    v_mfma_f32_16x16x4_f32 v[52:55], v70, v76, v[52:55]
    v_mfma_f32_16x16x4_f32 v[56:59], v70, v78, v[56:59]
    v_mfma_f32_16x16x4_f32 v[60:63], v72, v80, v[60:63]
    v_mfma_f32_16x16x4_f32 v[48:51], v69, v75, v[48:51]
    v_mfma_f32_16x16x4_f32 v[52:55], v71, v77, v[52:55]
    v_mfma_f32_16x16x4_f32 v[56:59], v71, v79, v[56:59]
    v_mfma_f32_16x16x4_f32 v[60:63], v73, v81, v[60:63]
    v_mov_b32_dpp v64, v24 row_newbcast:4 row_mask:0xf bank_mask:0xf
    v_mov_b32_dpp v65, v25 row_newbcast:4 row_mask:0xf bank_mask:0xf
    v_mov_b32_dpp v66, v26 row_newbcast:4 row_mask:0xf bank_mask:0xf
    v_mov_b32_dpp v67, v27 row_newbcast:4 row_mask:0xf bank_mask:0xf
    v_mul_f32 v82, v64, v47
    v_mul_f32 v83, v65, v47
    v_exp_f32 v82, v82
    v_fract_f32 v83, v83
    v_cos_f32 v74, v83
    v_sin_f32 v75, v83
    v_mul_f32 v74, v74, v82
    v_mul_f32 v75, v75, v82
    v_mul_f32 v84, v75, v75
    v_add_f32 v85, v74, v74
    v_fma_f32 v76, v74, v74, -v84
    v_mul_f32 v77, v85, v75
    v_mul_f32 v84, v77, v77
    v_add_f32 v85, v76, v76
    v_fma_f32 v78, v76, v76, -v84
    v_mul_f32 v79, v85, v77
    v_mul_f32 v84, v79, v79
    v_add_f32 v85, v78, v78
    v_fma_f32 v80, v78, v78, -v84
    v_mul_f32 v81, v85, v79
    v_mul_f32 v82, v64, v44
    v_mul_f32 v83, v65, v44
    v_exp_f32 v82, v82
    v_fract_f32 v83, v83
    v_cos_f32 v68, v83
    v_sin_f32 v69, v83
    v_mul_f32 v68, v68, v82
    v_mul_f32 v69, v69, v82
    v_mul_f32 v84, v67, v69
    v_mul_f32 v85, v67, v68
    v_fma_f32 v68, v66, v68, -v84
    v_fma_f32 v69, -v66, v69, -v85
    v_mul_f32 v82, v64, v45
    v_mul_f32 v83, v65, v45
    v_exp_f32 v82, v82
    v_fract_f32 v83, v83
    v_cos_f32 v70, v83
    v_sin_f32 v71, v83
    v_mul_f32 v70, v70, v82
    v_mul_f32 v71, v71, v82
    v_mul_f32 v84, v67, v71
    v_mul_f32 v85, v67, v70
    v_fma_f32 v70, v66, v70, -v84
    v_fma_f32 v71, -v66, v71, -v85
    v_mul_f32 v82, v64, v46
    v_mul_f32 v83, v65, v46
    v_exp_f32 v82, v82
    v_fract_f32 v83, v83
    v_cos_f32 v72, v83
    v_sin_f32 v73, v83
    v_mul_f32 v72, v72, v82
    v_mul_f32 v73, v73, v82
    v_mul_f32 v84, v67, v73
    v_mul_f32 v85, v67, v72
    v_fma_f32 v72, v66, v72, -v84
    v_fma_f32 v73, -v66, v73, -v85
    v_mfma_f32_16x16x4_f32 v[48:51], v68, v74, v[48:51]
    v_mfma_f32_16x16x4_f32 v[52:55], v70, v76, v[52:55]
    v_mfma_f32_16x16x4_f32 v[56:59], v70, v78, v[56:59]
    v_mfma_f32_16x16x4_f32 v[60:63], v72, v80, v[60:63]
    v_mfma_f32_16x16x4_f32 v[48:51], v69, v75, v[48:51]
    v_mfma_f32_16x16x4_f32 v[52:55], v71, v77, v[52:55]
    v_mfma_f32_16x16x4_f32 v[56:59], v71, v79, v[56:59]
    v_mfma_f32_16x16x4_f32 v[60:63], v73, v81, v[60:63]
    v_mov_b32_dpp v64, v24 row_newbcast:5 row_mask:0xf bank_mask:0xf
    v_mov_b32_dpp v65, v25 row_newbcast:5 row_mask:0xf bank_mask:0xf
    v_mov_b32_dpp v66, v26 row_newbcast:5 row_mask:0xf bank_mask:0xf
    v_mov_b32_dpp v67, v27 row_newbcast:5 row_mask:0xf bank_mask:0xf
    v_mul_f32 v82, v64, v47
    v_mul_f32 v83, v65, v47
    v_exp_f32 v82, v82
    v_fract_f32 v83, v83
    v_cos_f32 v74, v83
    v_sin_f32 v75, v83
    v_mul_f32 v74, v74, v82
    v_mul_f32 v75, v75, v82
    v_mul_f32 v84, v75, v75
    v_add_f32 v85, v74, v74
    v_fma_f32 v76, v74, v74, -v84
    v_mul_f32 v77, v85, v75
    v_mul_f32 v84, v77, v77
    v_add_f32 v85, v76, v76
    v_fma_f32 v78, v76, v76, -v84
    v_mul_f32 v79, v85, v77
    v_mul_f32 v84, v79, v79
    v_add_f32 v85, v78, v78
    v_fma_f32 v80, v78, v78, -v84
    v_mul_f32 v81, v85, v79
    v_mul_f32 v82, v64, v44
    v_mul_f32 v83, v65, v44
    v_exp_f32 v82, v82
    v_fract_f32 v83, v83
    v_cos_f32 v68, v83
    v_sin_f32 v69, v83
    v_mul_f32 v68, v68, v82
    v_mul_f32 v69, v69, v82
    v_mul_f32 v84, v67, v69
    v_mul_f32 v85, v67, v68
    v_fma_f32 v68, v66, v68, -v84
    v_fma_f32 v69, -v66, v69, -v85
    v_mul_f32 v82, v64, v45
    v_mul_f32 v83, v65, v45
    v_exp_f32 v82, v82
    v_fract_f32 v83, v83
    v_cos_f32 v70, v83
    v_sin_f32 v71, v83
    v_mul_f32 v70, v70, v82
    v_mul_f32 v71, v71, v82
    v_mul_f32 v84, v67, v71
    v_mul_f32 v85, v67, v70
    v_fma_f32 v70, v66, v70, -v84
    v_fma_f32 v71, -v66, v71, -v85
    v_mul_f32 v82, v64, v46
    v_mul_f32 v83, v65, v46
    v_exp_f32 v82, v82
    v_fract_f32 v83, v83
    v_cos_f32 v72, v83
    v_sin_f32 v73, v83
    v_mul_f32 v72, v72, v82
    v_mul_f32 v73, v73, v82
    v_mul_f32 v84, v67, v73
    v_mul_f32 v85, v67, v72
    v_fma_f32 v72, v66, v72, -v84
    v_fma_f32 v73, -v66, v73, -v85
    v_mfma_f32_16x16x4_f32 v[48:51], v68, v74, v[48:51]
    v_mfma_f32_16x16x4_f32 v[52:55], v70, v76, v[52:55]
    v_mfma_f32_16x16x4_f32 v[56:59], v70, v78, v[56:59]
    v_mfma_f32_16x16x4_f32 v[60:63], v72, v80, v[60:63]
    v_mfma_f32_16x16x4_f32 v[48:51], v69, v75, v[48:51]
    v_mfma_f32_16x16x4_f32 v[52:55], v71, v77, v[52:55]
    v_mfma_f32_16x16x4_f32 v[56:59], v71, v79, v[56:59]
    v_mfma_f32_16x16x4_f32 v[60:63], v73, v81, v[60:63]
    v_mov_b32_dpp v64, v24 row_newbcast:6 row_mask:0xf bank_mask:0xf
    v_mov_b32_dpp v65, v25 row_newbcast:6 row_mask:0xf bank_mask:0xf
    v_mov_b32_dpp v66, v26 row_newbcast:6 row_mask:0xf bank_mask:0xf
    v_mov_b32_dpp v67, v27 row_newbcast:6 row_mask:0xf bank_mask:0xf
    v_mul_f32 v82, v64, v47
    v_mul_f32 v83, v65, v47
    v_exp_f32 v82, v82
    v_fract_f32 v83, v83
    v_cos_f32 v74, v83
    v_sin_f32 v75, v83
    v_mul_f32 v74, v74, v82
    v_mul_f32 v75, v75, v82
    v_mul_f32 v84, v75, v75
    v_add_f32 v85, v74, v74
    v_fma_f32 v76, v74, v74, -v84
    v_mul_f32 v77, v85, v75
    v_mul_f32 v84, v77, v77
    v_add_f32 v85, v76, v76
    v_fma_f32 v78, v76, v76, -v84
    v_mul_f32 v79, v85, v77
    v_mul_f32 v84, v79, v79
    v_add_f32 v85, v78, v78
    v_fma_f32 v80, v78, v78, -v84
    v_mul_f32 v81, v85, v79
    v_mul_f32 v82, v64, v44
    v_mul_f32 v83, v65, v44
    v_exp_f32 v82, v82
    v_fract_f32 v83, v83
    v_cos_f32 v68, v83
    v_sin_f32 v69, v83
    v_mul_f32 v68, v68, v82
    v_mul_f32 v69, v69, v82
    v_mul_f32 v84, v67, v69
    v_mul_f32 v85, v67, v68
    v_fma_f32 v68, v66, v68, -v84
    v_fma_f32 v69, -v66, v69, -v85
    v_mul_f32 v82, v64, v45
    v_mul_f32 v83, v65, v45
    v_exp_f32 v82, v82
    v_fract_f32 v83, v83
    v_cos_f32 v70, v83
    v_sin_f32 v71, v83
    v_mul_f32 v70, v70, v82
    v_mul_f32 v71, v71, v82
    v_mul_f32 v84, v67, v71
    v_mul_f32 v85, v67, v70
    v_fma_f32 v70, v66, v70, -v84
    v_fma_f32 v71, -v66, v71, -v85
    v_mul_f32 v82, v64, v46
    v_mul_f32 v83, v65, v46
    v_exp_f32 v82, v82
    v_fract_f32 v83, v83
    v_cos_f32 v72, v83
    v_sin_f32 v73, v83
    v_mul_f32 v72, v72, v82
    v_mul_f32 v73, v73, v82
    v_mul_f32 v84, v67, v73
    v_mul_f32 v85, v67, v72
    v_fma_f32 v72, v66, v72, -v84
    v_fma_f32 v73, -v66, v73, -v85
    v_mfma_f32_16x16x4_f32 v[48:51], v68, v74, v[48:51]
    v_mfma_f32_16x16x4_f32 v[52:55], v70, v76, v[52:55]
    v_mfma_f32_16x16x4_f32 v[56:59], v70, v78, v[56:59]
    v_mfma_f32_16x16x4_f32 v[60:63], v72, v80, v[60:63]
    v_mfma_f32_16x16x4_f32 v[48:51], v69, v75, v[48:51]
    v_mfma_f32_16x16x4_f32 v[52:55], v71, v77, v[52:55]
    v_mfma_f32_16x16x4_f32 v[56:59], v71, v79, v[56:59]
    v_mfma_f32_16x16x4_f32 v[60:63], v73, v81, v[60:63]
    v_mov_b32_dpp v64, v24 row_newbcast:7 row_mask:0xf bank_mask:0xf
    v_mov_b32_dpp v65, v25 row_newbcast:7 row_mask:0xf bank_mask:0xf
    v_mov_b32_dpp v66, v26 row_newbcast:7 row_mask:0xf bank_mask:0xf
    v_mov_b32_dpp v67, v27 row_newbcast:7 row_mask:0xf bank_mask:0xf
    v_mul_f32 v82, v64, v47
    v_mul_f32 v83, v65, v47
    v_exp_f32 v82, v82
    v_fract_f32 v83, v83
    v_cos_f32 v74, v83
    v_sin_f32 v75, v83
    v_mul_f32 v74, v74, v82
    v_mul_f32 v75, v75, v82
    v_mul_f32 v84, v75, v75
    v_add_f32 v85, v74, v74
    v_fma_f32 v76, v74, v74, -v84
    v_mul_f32 v77, v85, v75
    v_mul_f32 v84, v77, v77
    v_add_f32 v85, v76, v76
    v_fma_f32 v78, v76, v76, -v84
    v_mul_f32 v79, v85, v77
    v_mul_f32 v84, v79, v79
    v_add_f32 v85, v78, v78
    v_fma_f32 v80, v78, v78, -v84
    v_mul_f32 v81, v85, v79
    v_mul_f32 v82, v64, v44
    v_mul_f32 v83, v65, v44
    v_exp_f32 v82, v82
    v_fract_f32 v83, v83
    v_cos_f32 v68, v83
    v_sin_f32 v69, v83
    v_mul_f32 v68, v68, v82
    v_mul_f32 v69, v69, v82
    v_mul_f32 v84, v67, v69
    v_mul_f32 v85, v67, v68
    v_fma_f32 v68, v66, v68, -v84
    v_fma_f32 v69, -v66, v69, -v85
    v_mul_f32 v82, v64, v45
    v_mul_f32 v83, v65, v45
    v_exp_f32 v82, v82
    v_fract_f32 v83, v83
    v_cos_f32 v70, v83
    v_sin_f32 v71, v83
    v_mul_f32 v70, v70, v82
    v_mul_f32 v71, v71, v82
    v_mul_f32 v84, v67, v71
    v_mul_f32 v85, v67, v70
    v_fma_f32 v70, v66, v70, -v84
    v_fma_f32 v71, -v66, v71, -v85
    v_mul_f32 v82, v64, v46
    v_mul_f32 v83, v65, v46
    v_exp_f32 v82, v82
    v_fract_f32 v83, v83
    v_cos_f32 v72, v83
    v_sin_f32 v73, v83
    v_mul_f32 v72, v72, v82
    v_mul_f32 v73, v73, v82
    v_mul_f32 v84, v67, v73
    v_mul_f32 v85, v67, v72
    v_fma_f32 v72, v66, v72, -v84
    v_fma_f32 v73, -v66, v73, -v85
    v_mfma_f32_16x16x4_f32 v[48:51], v68, v74, v[48:51]
    v_mfma_f32_16x16x4_f32 v[52:55], v70, v76, v[52:55]
    v_mfma_f32_16x16x4_f32 v[56:59], v70, v78, v[56:59]
    v_mfma_f32_16x16x4_f32 v[60:63], v72, v80, v[60:63]
    v_mfma_f32_16x16x4_f32 v[48:51], v69, v75, v[48:51]
    v_mfma_f32_16x16x4_f32 v[52:55], v71, v77, v[52:55]
    v_mfma_f32_16x16x4_f32 v[56:59], v71, v79, v[56:59]
    v_mfma_f32_16x16x4_f32 v[60:63], v73, v81, v[60:63]
    v_mov_b32_dpp v64, v24 row_newbcast:8 row_mask:0xf bank_mask:0xf
    v_mov_b32_dpp v65, v25 row_newbcast:8 row_mask:0xf bank_mask:0xf
    v_mov_b32_dpp v66, v26 row_newbcast:8 row_mask:0xf bank_mask:0xf
    v_mov_b32_dpp v67, v27 row_newbcast:8 row_mask:0xf bank_mask:0xf
    v_mul_f32 v82, v64, v47
    v_mul_f32 v83, v65, v47
    v_exp_f32 v82, v82
    v_fract_f32 v83, v83
    v_cos_f32 v74, v83
    v_sin_f32 v75, v83
    v_mul_f32 v74, v74, v82
    v_mul_f32 v75, v75, v82
    v_mul_f32 v84, v75, v75
    v_add_f32 v85, v74, v74
    v_fma_f32 v76, v74, v74, -v84
    v_mul_f32 v77, v85, v75
    v_mul_f32 v84, v77, v77
    v_add_f32 v85, v76, v76
    v_fma_f32 v78, v76, v76, -v84
    v_mul_f32 v79, v85, v77
    v_mul_f32 v84, v79, v79
    v_add_f32 v85, v78, v78
    v_fma_f32 v80, v78, v78, -v84
    v_mul_f32 v81, v85, v79
    v_mul_f32 v82, v64, v44
    v_mul_f32 v83, v65, v44
    v_exp_f32 v82, v82
    v_fract_f32 v83, v83
    v_cos_f32 v68, v83
    v_sin_f32 v69, v83
    v_mul_f32 v68, v68, v82
    v_mul_f32 v69, v69, v82
    v_mul_f32 v84, v67, v69
    v_mul_f32 v85, v67, v68
    v_fma_f32 v68, v66, v68, -v84
    v_fma_f32 v69, -v66, v69, -v85
    v_mul_f32 v82, v64, v45
    v_mul_f32 v83, v65, v45
    v_exp_f32 v82, v82
    v_fract_f32 v83, v83
    v_cos_f32 v70, v83
    v_sin_f32 v71, v83
    v_mul_f32 v70, v70, v82
    v_mul_f32 v71, v71, v82
    v_mul_f32 v84, v67, v71
    v_mul_f32 v85, v67, v70
    v_fma_f32 v70, v66, v70, -v84
    v_fma_f32 v71, -v66, v71, -v85
    v_mul_f32 v82, v64, v46
    v_mul_f32 v83, v65, v46
    v_exp_f32 v82, v82
    v_fract_f32 v83, v83
    v_cos_f32 v72, v83
    v_sin_f32 v73, v83
    v_mul_f32 v72, v72, v82
    v_mul_f32 v73, v73, v82
    v_mul_f32 v84, v67, v73
    v_mul_f32 v85, v67, v72
    v_fma_f32 v72, v66, v72, -v84
    v_fma_f32 v73, -v66, v73, -v85
    v_mfma_f32_16x16x4_f32 v[48:51], v68, v74, v[48:51]
    v_mfma_f32_16x16x4_f32 v[52:55], v70, v76, v[52:55]
    v_mfma_f32_16x16x4_f32 v[56:59], v70, v78, v[56:59]
    v_mfma_f32_16x16x4_f32 v[60:63], v72, v80, v[60:63]
    v_mfma_f32_16x16x4_f32 v[48:51], v69, v75, v[48:51]
    v_mfma_f32_16x16x4_f32 v[52:55], v71, v77, v[52:55]
    v_mfma_f32_16x16x4_f32 v[56:59], v71, v79, v[56:59]
    v_mfma_f32_16x16x4_f32 v[60:63], v73, v81, v[60:63]
    v_mov_b32_dpp v64, v24 row_newbcast:9 row_mask:0xf bank_mask:0xf
    v_mov_b32_dpp v65, v25 row_newbcast:9 row_mask:0xf bank_mask:0xf
    v_mov_b32_dpp v66, v26 row_newbcast:9 row_mask:0xf bank_mask:0xf
    v_mov_b32_dpp v67, v27 row_newbcast:9 row_mask:0xf bank_mask:0xf
    v_mul_f32 v82, v64, v47
    v_mul_f32 v83, v65, v47
    v_exp_f32 v82, v82
    v_fract_f32 v83, v83
    v_cos_f32 v74, v83
    v_sin_f32 v75, v83
    v_mul_f32 v74, v74, v82
    v_mul_f32 v75, v75, v82
    v_mul_f32 v84, v75, v75
    v_add_f32 v85, v74, v74
    v_fma_f32 v76, v74, v74, -v84
    v_mul_f32 v77, v85, v75
    v_mul_f32 v84, v77, v77
    v_add_f32 v85, v76, v76
    v_fma_f32 v78, v76, v76, -v84
    v_mul_f32 v79, v85, v77
    v_mul_f32 v84, v79, v79
    v_add_f32 v85, v78, v78
    v_fma_f32 v80, v78, v78, -v84
    v_mul_f32 v81, v85, v79
    v_mul_f32 v82, v64, v44
    v_mul_f32 v83, v65, v44
    v_exp_f32 v82, v82
    v_fract_f32 v83, v83
    v_cos_f32 v68, v83
    v_sin_f32 v69, v83
    v_mul_f32 v68, v68, v82
    v_mul_f32 v69, v69, v82
    v_mul_f32 v84, v67, v69
    v_mul_f32 v85, v67, v68
    v_fma_f32 v68, v66, v68, -v84
    v_fma_f32 v69, -v66, v69, -v85
    v_mul_f32 v82, v64, v45
    v_mul_f32 v83, v65, v45
    v_exp_f32 v82, v82
    v_fract_f32 v83, v83
    v_cos_f32 v70, v83
    v_sin_f32 v71, v83
    v_mul_f32 v70, v70, v82
    v_mul_f32 v71, v71, v82
    v_mul_f32 v84, v67, v71
    v_mul_f32 v85, v67, v70
    v_fma_f32 v70, v66, v70, -v84
    v_fma_f32 v71, -v66, v71, -v85
    v_mul_f32 v82, v64, v46
    v_mul_f32 v83, v65, v46
    v_exp_f32 v82, v82
    v_fract_f32 v83, v83
    v_cos_f32 v72, v83
    v_sin_f32 v73, v83
    v_mul_f32 v72, v72, v82
    v_mul_f32 v73, v73, v82
    v_mul_f32 v84, v67, v73
    v_mul_f32 v85, v67, v72
    v_fma_f32 v72, v66, v72, -v84
    v_fma_f32 v73, -v66, v73, -v85
    v_mfma_f32_16x16x4_f32 v[48:51], v68, v74, v[48:51]
    v_mfma_f32_16x16x4_f32 v[52:55], v70, v76, v[52:55]
    v_mfma_f32_16x16x4_f32 v[56:59], v70, v78, v[56:59]
    v_mfma_f32_16x16x4_f32 v[60:63], v72, v80, v[60:63]
    v_mfma_f32_16x16x4_f32 v[48:51], v69, v75, v[48:51]
    v_mfma_f32_16x16x4_f32 v[52:55], v71, v77, v[52:55]
    v_mfma_f32_16x16x4_f32 v[56:59], v71, v79, v[56:59]
    v_mfma_f32_16x16x4_f32 v[60:63], v73, v81, v[60:63]
    v_mov_b32_dpp v64, v24 row_newbcast:10 row_mask:0xf bank_mask:0xf
    v_mov_b32_dpp v65, v25 row_newbcast:10 row_mask:0xf bank_mask:0xf
    v_mov_b32_dpp v66, v26 row_newbcast:10 row_mask:0xf bank_mask:0xf
    v_mov_b32_dpp v67, v27 row_newbcast:10 row_mask:0xf bank_mask:0xf
    v_mul_f32 v82, v64, v47
    v_mul_f32 v83, v65, v47
    v_exp_f32 v82, v82
    v_fract_f32 v83, v83
    v_cos_f32 v74, v83
    v_sin_f32 v75, v83
    v_mul_f32 v74, v74, v82
    v_mul_f32 v75, v75, v82
    v_mul_f32 v84, v75, v75
    v_add_f32 v85, v74, v74
    v_fma_f32 v76, v74, v74, -v84
    v_mul_f32 v77, v85, v75
    v_mul_f32 v84, v77, v77
    v_add_f32 v85, v76, v76
    v_fma_f32 v78, v76, v76, -v84
    v_mul_f32 v79, v85, v77
    v_mul_f32 v84, v79, v79
    v_add_f32 v85, v78, v78
    v_fma_f32 v80, v78, v78, -v84
    v_mul_f32 v81, v85, v79
    v_mul_f32 v82, v64, v44
    v_mul_f32 v83, v65, v44
    v_exp_f32 v82, v82
    v_fract_f32 v83, v83
    v_cos_f32 v68, v83
    v_sin_f32 v69, v83
    v_mul_f32 v68, v68, v82
    v_mul_f32 v69, v69, v82
    v_mul_f32 v84, v67, v69
    v_mul_f32 v85, v67, v68
    v_fma_f32 v68, v66, v68, -v84
    v_fma_f32 v69, -v66, v69, -v85
    v_mul_f32 v82, v64, v45
    v_mul_f32 v83, v65, v45
    v_exp_f32 v82, v82
    v_fract_f32 v83, v83
    v_cos_f32 v70, v83
    v_sin_f32 v71, v83
    v_mul_f32 v70, v70, v82
    v_mul_f32 v71, v71, v82
    v_mul_f32 v84, v67, v71
    v_mul_f32 v85, v67, v70
    v_fma_f32 v70, v66, v70, -v84
    v_fma_f32 v71, -v66, v71, -v85
    v_mul_f32 v82, v64, v46
    v_mul_f32 v83, v65, v46
    v_exp_f32 v82, v82
    v_fract_f32 v83, v83
    v_cos_f32 v72, v83
    v_sin_f32 v73, v83
    v_mul_f32 v72, v72, v82
    v_mul_f32 v73, v73, v82
    v_mul_f32 v84, v67, v73
    v_mul_f32 v85, v67, v72
    v_fma_f32 v72, v66, v72, -v84
    v_fma_f32 v73, -v66, v73, -v85
    v_mfma_f32_16x16x4_f32 v[48:51], v68, v74, v[48:51]
    v_mfma_f32_16x16x4_f32 v[52:55], v70, v76, v[52:55]
    v_mfma_f32_16x16x4_f32 v[56:59], v70, v78, v[56:59]
    v_mfma_f32_16x16x4_f32 v[60:63], v72, v80, v[60:63]
    v_mfma_f32_16x16x4_f32 v[48:51], v69, v75, v[48:51]
    v_mfma_f32_16x16x4_f32 v[52:55], v71, v77, v[52:55]
    v_mfma_f32_16x16x4_f32 v[56:59], v71, v79, v[56:59]
    v_mfma_f32_16x16x4_f32 v[60:63], v73, v81, v[60:63]
    v_mov_b32_dpp v64, v24 row_newbcast:11 row_mask:0xf bank_mask:0xf
    v_mov_b32_dpp v65, v25 row_newbcast:11 row_mask:0xf bank_mask:0xf
    v_mov_b32_dpp v66, v26 row_newbcast:11 row_mask:0xf bank_mask:0xf
    v_mov_b32_dpp v67, v27 row_newbcast:11 row_mask:0xf bank_mask:0xf
    v_mul_f32 v82, v64, v47
    v_mul_f32 v83, v65, v47
    v_exp_f32 v82, v82
    v_fract_f32 v83, v83
    v_cos_f32 v74, v83
    v_sin_f32 v75, v83
    v_mul_f32 v74, v74, v82
    v_mul_f32 v75, v75, v82
    v_mul_f32 v84, v75, v75
    v_add_f32 v85, v74, v74
    v_fma_f32 v76, v74, v74, -v84
    v_mul_f32 v77, v85, v75
    v_mul_f32 v84, v77, v77
    v_add_f32 v85, v76, v76
    v_fma_f32 v78, v76, v76, -v84
    v_mul_f32 v79, v85, v77
    v_mul_f32 v84, v79, v79
    v_add_f32 v85, v78, v78
    v_fma_f32 v80, v78, v78, -v84
    v_mul_f32 v81, v85, v79
    v_mul_f32 v82, v64, v44
    v_mul_f32 v83, v65, v44
    v_exp_f32 v82, v82
    v_fract_f32 v83, v83
    v_cos_f32 v68, v83
    v_sin_f32 v69, v83
    v_mul_f32 v68, v68, v82
    v_mul_f32 v69, v69, v82
    v_mul_f32 v84, v67, v69
    v_mul_f32 v85, v67, v68
    v_fma_f32 v68, v66, v68, -v84
    v_fma_f32 v69, -v66, v69, -v85
    v_mul_f32 v82, v64, v45
    v_mul_f32 v83, v65, v45
    v_exp_f32 v82, v82
    v_fract_f32 v83, v83
    v_cos_f32 v70, v83
    v_sin_f32 v71, v83
    v_mul_f32 v70, v70, v82
    v_mul_f32 v71, v71, v82
    v_mul_f32 v84, v67, v71
    v_mul_f32 v85, v67, v70
    v_fma_f32 v70, v66, v70, -v84
    v_fma_f32 v71, -v66, v71, -v85
    v_mul_f32 v82, v64, v46
    v_mul_f32 v83, v65, v46
    v_exp_f32 v82, v82
    v_fract_f32 v83, v83
    v_cos_f32 v72, v83
    v_sin_f32 v73, v83
    v_mul_f32 v72, v72, v82
    v_mul_f32 v73, v73, v82
    v_mul_f32 v84, v67, v73
    v_mul_f32 v85, v67, v72
    v_fma_f32 v72, v66, v72, -v84
    v_fma_f32 v73, -v66, v73, -v85
    v_mfma_f32_16x16x4_f32 v[48:51], v68, v74, v[48:51]
    v_mfma_f32_16x16x4_f32 v[52:55], v70, v76, v[52:55]
    v_mfma_f32_16x16x4_f32 v[56:59], v70, v78, v[56:59]
    v_mfma_f32_16x16x4_f32 v[60:63], v72, v80, v[60:63]
    v_mfma_f32_16x16x4_f32 v[48:51], v69, v75, v[48:51]
    v_mfma_f32_16x16x4_f32 v[52:55], v71, v77, v[52:55]
    v_mfma_f32_16x16x4_f32 v[56:59], v71, v79, v[56:59]
    v_mfma_f32_16x16x4_f32 v[60:63], v73, v81, v[60:63]
    v_mov_b32_dpp v64, v24 row_newbcast:12 row_mask:0xf bank_mask:0xf
    v_mov_b32_dpp v65, v25 row_newbcast:12 row_mask:0xf bank_mask:0xf
    v_mov_b32_dpp v66, v26 row_newbcast:12 row_mask:0xf bank_mask:0xf
    v_mov_b32_dpp v67, v27 row_newbcast:12 row_mask:0xf bank_mask:0xf
    v_mul_f32 v82, v64, v47
    v_mul_f32 v83, v65, v47
    v_exp_f32 v82, v82
    v_fract_f32 v83, v83
    v_cos_f32 v74, v83
    v_sin_f32 v75, v83
    v_mul_f32 v74, v74, v82
    v_mul_f32 v75, v75, v82
    v_mul_f32 v84, v75, v75
    v_add_f32 v85, v74, v74
    v_fma_f32 v76, v74, v74, -v84
    v_mul_f32 v77, v85, v75
    v_mul_f32 v84, v77, v77
    v_add_f32 v85, v76, v76
    v_fma_f32 v78, v76, v76, -v84
    v_mul_f32 v79, v85, v77
    v_mul_f32 v84, v79, v79
    v_add_f32 v85, v78, v78
    v_fma_f32 v80, v78, v78, -v84
    v_mul_f32 v81, v85, v79
    v_mul_f32 v82, v64, v44
    v_mul_f32 v83, v65, v44
    v_exp_f32 v82, v82
    v_fract_f32 v83, v83
    v_cos_f32 v68, v83
    v_sin_f32 v69, v83
    v_mul_f32 v68, v68, v82
    v_mul_f32 v69, v69, v82
    v_mul_f32 v84, v67, v69
    v_mul_f32 v85, v67, v68
    v_fma_f32 v68, v66, v68, -v84
    v_fma_f32 v69, -v66, v69, -v85
    v_mul_f32 v82, v64, v45
    v_mul_f32 v83, v65, v45
    v_exp_f32 v82, v82
    v_fract_f32 v83, v83
    v_cos_f32 v70, v83
    v_sin_f32 v71, v83
    v_mul_f32 v70, v70, v82
    v_mul_f32 v71, v71, v82
    v_mul_f32 v84, v67, v71
    v_mul_f32 v85, v67, v70
    v_fma_f32 v70, v66, v70, -v84
    v_fma_f32 v71, -v66, v71, -v85
    v_mul_f32 v82, v64, v46
    v_mul_f32 v83, v65, v46
    v_exp_f32 v82, v82
    v_fract_f32 v83, v83
    v_cos_f32 v72, v83
    v_sin_f32 v73, v83
    v_mul_f32 v72, v72, v82
    v_mul_f32 v73, v73, v82
    v_mul_f32 v84, v67, v73
    v_mul_f32 v85, v67, v72
    v_fma_f32 v72, v66, v72, -v84
    v_fma_f32 v73, -v66, v73, -v85
    v_mfma_f32_16x16x4_f32 v[48:51], v68, v74, v[48:51]
    v_mfma_f32_16x16x4_f32 v[52:55], v70, v76, v[52:55]
    v_mfma_f32_16x16x4_f32 v[56:59], v70, v78, v[56:59]
    v_mfma_f32_16x16x4_f32 v[60:63], v72, v80, v[60:63]
    v_mfma_f32_16x16x4_f32 v[48:51], v69, v75, v[48:51]
    v_mfma_f32_16x16x4_f32 v[52:55], v71, v77, v[52:55]
    v_mfma_f32_16x16x4_f32 v[56:59], v71, v79, v[56:59]
    v_mfma_f32_16x16x4_f32 v[60:63], v73, v81, v[60:63]
    v_mov_b32_dpp v64, v24 row_newbcast:13 row_mask:0xf bank_mask:0xf
    v_mov_b32_dpp v65, v25 row_newbcast:13 row_mask:0xf bank_mask:0xf
    v_mov_b32_dpp v66, v26 row_newbcast:13 row_mask:0xf bank_mask:0xf
    v_mov_b32_dpp v67, v27 row_newbcast:13 row_mask:0xf bank_mask:0xf
    v_mul_f32 v82, v64, v47
    v_mul_f32 v83, v65, v47
    v_exp_f32 v82, v82
    v_fract_f32 v83, v83
    v_cos_f32 v74, v83
    v_sin_f32 v75, v83
    v_mul_f32 v74, v74, v82
    v_mul_f32 v75, v75, v82
    v_mul_f32 v84, v75, v75
    v_add_f32 v85, v74, v74
    v_fma_f32 v76, v74, v74, -v84
    v_mul_f32 v77, v85, v75
    v_mul_f32 v84, v77, v77
    v_add_f32 v85, v76, v76
    v_fma_f32 v78, v76, v76, -v84
    v_mul_f32 v79, v85, v77
    v_mul_f32 v84, v79, v79
    v_add_f32 v85, v78, v78
    v_fma_f32 v80, v78, v78, -v84
    v_mul_f32 v81, v85, v79
    v_mul_f32 v82, v64, v44
    v_mul_f32 v83, v65, v44
    v_exp_f32 v82, v82
    v_fract_f32 v83, v83
    v_cos_f32 v68, v83
    v_sin_f32 v69, v83
    v_mul_f32 v68, v68, v82
    v_mul_f32 v69, v69, v82
    v_mul_f32 v84, v67, v69
    v_mul_f32 v85, v67, v68
    v_fma_f32 v68, v66, v68, -v84
    v_fma_f32 v69, -v66, v69, -v85
    v_mul_f32 v82, v64, v45
    v_mul_f32 v83, v65, v45
    v_exp_f32 v82, v82
    v_fract_f32 v83, v83
    v_cos_f32 v70, v83
    v_sin_f32 v71, v83
    v_mul_f32 v70, v70, v82
    v_mul_f32 v71, v71, v82
    v_mul_f32 v84, v67, v71
    v_mul_f32 v85, v67, v70
    v_fma_f32 v70, v66, v70, -v84
    v_fma_f32 v71, -v66, v71, -v85
    v_mul_f32 v82, v64, v46
    v_mul_f32 v83, v65, v46
    v_exp_f32 v82, v82
    v_fract_f32 v83, v83
    v_cos_f32 v72, v83
    v_sin_f32 v73, v83
    v_mul_f32 v72, v72, v82
    v_mul_f32 v73, v73, v82
    v_mul_f32 v84, v67, v73
    v_mul_f32 v85, v67, v72
    v_fma_f32 v72, v66, v72, -v84
    v_fma_f32 v73, -v66, v73, -v85
    v_mfma_f32_16x16x4_f32 v[48:51], v68, v74, v[48:51]
    v_mfma_f32_16x16x4_f32 v[52:55], v70, v76, v[52:55]
    v_mfma_f32_16x16x4_f32 v[56:59], v70, v78, v[56:59]
    v_mfma_f32_16x16x4_f32 v[60:63], v72, v80, v[60:63]
    v_mfma_f32_16x16x4_f32 v[48:51], v69, v75, v[48:51]
    v_mfma_f32_16x16x4_f32 v[52:55], v71, v77, v[52:55]
    v_mfma_f32_16x16x4_f32 v[56:59], v71, v79, v[56:59]
    v_mfma_f32_16x16x4_f32 v[60:63], v73, v81, v[60:63]
    v_mov_b32_dpp v64, v24 row_newbcast:14 row_mask:0xf bank_mask:0xf
    v_mov_b32_dpp v65, v25 row_newbcast:14 row_mask:0xf bank_mask:0xf
    v_mov_b32_dpp v66, v26 row_newbcast:14 row_mask:0xf bank_mask:0xf
    v_mov_b32_dpp v67, v27 row_newbcast:14 row_mask:0xf bank_mask:0xf
    v_mul_f32 v82, v64, v47
    v_mul_f32 v83, v65, v47
    v_exp_f32 v82, v82
    v_fract_f32 v83, v83
    v_cos_f32 v74, v83
    v_sin_f32 v75, v83
    v_mul_f32 v74, v74, v82
    v_mul_f32 v75, v75, v82
    v_mul_f32 v84, v75, v75
    v_add_f32 v85, v74, v74
    v_fma_f32 v76, v74, v74, -v84
    v_mul_f32 v77, v85, v75
    v_mul_f32 v84, v77, v77
    v_add_f32 v85, v76, v76
    v_fma_f32 v78, v76, v76, -v84
    v_mul_f32 v79, v85, v77
    v_mul_f32 v84, v79, v79
    v_add_f32 v85, v78, v78
    v_fma_f32 v80, v78, v78, -v84
    v_mul_f32 v81, v85, v79
    v_mul_f32 v82, v64, v44
    v_mul_f32 v83, v65, v44
    v_exp_f32 v82, v82
    v_fract_f32 v83, v83
    v_cos_f32 v68, v83
    v_sin_f32 v69, v83
    v_mul_f32 v68, v68, v82
    v_mul_f32 v69, v69, v82
    v_mul_f32 v84, v67, v69
    v_mul_f32 v85, v67, v68
    v_fma_f32 v68, v66, v68, -v84
    v_fma_f32 v69, -v66, v69, -v85
    v_mul_f32 v82, v64, v45
    v_mul_f32 v83, v65, v45
    v_exp_f32 v82, v82
    v_fract_f32 v83, v83
    v_cos_f32 v70, v83
    v_sin_f32 v71, v83
    v_mul_f32 v70, v70, v82
    v_mul_f32 v71, v71, v82
    v_mul_f32 v84, v67, v71
    v_mul_f32 v85, v67, v70
    v_fma_f32 v70, v66, v70, -v84
    v_fma_f32 v71, -v66, v71, -v85
    v_mul_f32 v82, v64, v46
    v_mul_f32 v83, v65, v46
    v_exp_f32 v82, v82
    v_fract_f32 v83, v83
    v_cos_f32 v72, v83
    v_sin_f32 v73, v83
    v_mul_f32 v72, v72, v82
    v_mul_f32 v73, v73, v82
    v_mul_f32 v84, v67, v73
    v_mul_f32 v85, v67, v72
    v_fma_f32 v72, v66, v72, -v84
    v_fma_f32 v73, -v66, v73, -v85
    v_mfma_f32_16x16x4_f32 v[48:51], v68, v74, v[48:51]
    v_mfma_f32_16x16x4_f32 v[52:55], v70, v76, v[52:55]
    v_mfma_f32_16x16x4_f32 v[56:59], v70, v78, v[56:59]
    v_mfma_f32_16x16x4_f32 v[60:63], v72, v80, v[60:63]
    v_mfma_f32_16x16x4_f32 v[48:51], v69, v75, v[48:51]
    v_mfma_f32_16x16x4_f32 v[52:55], v71, v77, v[52:55]
    v_mfma_f32_16x16x4_f32 v[56:59], v71, v79, v[56:59]
    v_mfma_f32_16x16x4_f32 v[60:63], v73, v81, v[60:63]
    v_mov_b32_dpp v64, v24 row_newbcast:15 row_mask:0xf bank_mask:0xf
    v_mov_b32_dpp v65, v25 row_newbcast:15 row_mask:0xf bank_mask:0xf
    v_mov_b32_dpp v66, v26 row_newbcast:15 row_mask:0xf bank_mask:0xf
    v_mov_b32_dpp v67, v27 row_newbcast:15 row_mask:0xf bank_mask:0xf
    v_mul_f32 v82, v64, v47
    v_mul_f32 v83, v65, v47
    v_exp_f32 v82, v82
    v_fract_f32 v83, v83
    v_cos_f32 v74, v83
    v_sin_f32 v75, v83
    v_mul_f32 v74, v74, v82
    v_mul_f32 v75, v75, v82
    v_mul_f32 v84, v75, v75
    v_add_f32 v85, v74, v74
    v_fma_f32 v76, v74, v74, -v84
    v_mul_f32 v77, v85, v75
    v_mul_f32 v84, v77, v77
    v_add_f32 v85, v76, v76
    v_fma_f32 v78, v76, v76, -v84
    v_mul_f32 v79, v85, v77
    v_mul_f32 v84, v79, v79
    v_add_f32 v85, v78, v78
    v_fma_f32 v80, v78, v78, -v84
    v_mul_f32 v81, v85, v79
    v_mul_f32 v82, v64, v44
    v_mul_f32 v83, v65, v44
    v_exp_f32 v82, v82
    v_fract_f32 v83, v83
    v_cos_f32 v68, v83
    v_sin_f32 v69, v83
    v_mul_f32 v68, v68, v82
    v_mul_f32 v69, v69, v82
    v_mul_f32 v84, v67, v69
    v_mul_f32 v85, v67, v68
    v_fma_f32 v68, v66, v68, -v84
    v_fma_f32 v69, -v66, v69, -v85
    v_mul_f32 v82, v64, v45
    v_mul_f32 v83, v65, v45
    v_exp_f32 v82, v82
    v_fract_f32 v83, v83
    v_cos_f32 v70, v83
    v_sin_f32 v71, v83
    v_mul_f32 v70, v70, v82
    v_mul_f32 v71, v71, v82
    v_mul_f32 v84, v67, v71
    v_mul_f32 v85, v67, v70
    v_fma_f32 v70, v66, v70, -v84
    v_fma_f32 v71, -v66, v71, -v85
    v_mul_f32 v82, v64, v46
    v_mul_f32 v83, v65, v46
    v_exp_f32 v82, v82
    v_fract_f32 v83, v83
    v_cos_f32 v72, v83
    v_sin_f32 v73, v83
    v_mul_f32 v72, v72, v82
    v_mul_f32 v73, v73, v82
    v_mul_f32 v84, v67, v73
    v_mul_f32 v85, v67, v72
    v_fma_f32 v72, v66, v72, -v84
    v_fma_f32 v73, -v66, v73, -v85
    v_mfma_f32_16x16x4_f32 v[48:51], v68, v74, v[48:51]
    v_mfma_f32_16x16x4_f32 v[52:55], v70, v76, v[52:55]
    v_mfma_f32_16x16x4_f32 v[56:59], v70, v78, v[56:59]
    v_mfma_f32_16x16x4_f32 v[60:63], v72, v80, v[60:63]
    v_mfma_f32_16x16x4_f32 v[48:51], v69, v75, v[48:51]
    v_mfma_f32_16x16x4_f32 v[52:55], v71, v77, v[52:55]
    v_mfma_f32_16x16x4_f32 v[56:59], v71, v79, v[56:59]
    v_mfma_f32_16x16x4_f32 v[60:63], v73, v81, v[60:63]
    v_mov_b32_dpp v64, v28 row_newbcast:0 row_mask:0xf bank_mask:0xf
    v_mov_b32_dpp v65, v29 row_newbcast:0 row_mask:0xf bank_mask:0xf
    v_mov_b32_dpp v66, v30 row_newbcast:0 row_mask:0xf bank_mask:0xf
    v_mov_b32_dpp v67, v31 row_newbcast:0 row_mask:0xf bank_mask:0xf
    v_mul_f32 v82, v64, v47
    v_mul_f32 v83, v65, v47
    v_exp_f32 v82, v82
    v_fract_f32 v83, v83
    v_cos_f32 v74, v83
    v_sin_f32 v75, v83
    v_mul_f32 v74, v74, v82
    v_mul_f32 v75, v75, v82
    v_mul_f32 v84, v75, v75
    v_add_f32 v85, v74, v74
    v_fma_f32 v76, v74, v74, -v84
    v_mul_f32 v77, v85, v75
    v_mul_f32 v84, v77, v77
    v_add_f32 v85, v76, v76
    v_fma_f32 v78, v76, v76, -v84
    v_mul_f32 v79, v85, v77
    v_mul_f32 v84, v79, v79
    v_add_f32 v85, v78, v78
    v_fma_f32 v80, v78, v78, -v84
    v_mul_f32 v81, v85, v79
    v_mul_f32 v82, v64, v44
    v_mul_f32 v83, v65, v44
    v_exp_f32 v82, v82
    v_fract_f32 v83, v83
    v_cos_f32 v68, v83
    v_sin_f32 v69, v83
    v_mul_f32 v68, v68, v82
    v_mul_f32 v69, v69, v82
    v_mul_f32 v84, v67, v69
    v_mul_f32 v85, v67, v68
    v_fma_f32 v68, v66, v68, -v84
    v_fma_f32 v69, -v66, v69, -v85
    v_mul_f32 v82, v64, v45
    v_mul_f32 v83, v65, v45
    v_exp_f32 v82, v82
    v_fract_f32 v83, v83
    v_cos_f32 v70, v83
    v_sin_f32 v71, v83
    v_mul_f32 v70, v70, v82
    v_mul_f32 v71, v71, v82
    v_mul_f32 v84, v67, v71
    v_mul_f32 v85, v67, v70
    v_fma_f32 v70, v66, v70, -v84
    v_fma_f32 v71, -v66, v71, -v85
    v_mul_f32 v82, v64, v46
    v_mul_f32 v83, v65, v46
    v_exp_f32 v82, v82
    v_fract_f32 v83, v83
    v_cos_f32 v72, v83
    v_sin_f32 v73, v83
    v_mul_f32 v72, v72, v82
    v_mul_f32 v73, v73, v82
    v_mul_f32 v84, v67, v73
    v_mul_f32 v85, v67, v72
    v_fma_f32 v72, v66, v72, -v84
    v_fma_f32 v73, -v66, v73, -v85
    v_mfma_f32_16x16x4_f32 v[48:51], v68, v74, v[48:51]
    v_mfma_f32_16x16x4_f32 v[52:55], v70, v76, v[52:55]
    v_mfma_f32_16x16x4_f32 v[56:59], v70, v78, v[56:59]
    v_mfma_f32_16x16x4_f32 v[60:63], v72, v80, v[60:63]
    v_mfma_f32_16x16x4_f32 v[48:51], v69, v75, v[48:51]
    v_mfma_f32_16x16x4_f32 v[52:55], v71, v77, v[52:55]
    v_mfma_f32_16x16x4_f32 v[56:59], v71, v79, v[56:59]
    v_mfma_f32_16x16x4_f32 v[60:63], v73, v81, v[60:63]
    v_mov_b32_dpp v64, v28 row_newbcast:1 row_mask:0xf bank_mask:0xf
    v_mov_b32_dpp v65, v29 row_newbcast:1 row_mask:0xf bank_mask:0xf
    v_mov_b32_dpp v66, v30 row_newbcast:1 row_mask:0xf bank_mask:0xf
    v_mov_b32_dpp v67, v31 row_newbcast:1 row_mask:0xf bank_mask:0xf
    v_mul_f32 v82, v64, v47
    v_mul_f32 v83, v65, v47
    v_exp_f32 v82, v82
    v_fract_f32 v83, v83
    v_cos_f32 v74, v83
    v_sin_f32 v75, v83
    v_mul_f32 v74, v74, v82
    v_mul_f32 v75, v75, v82
    v_mul_f32 v84, v75, v75
    v_add_f32 v85, v74, v74
    v_fma_f32 v76, v74, v74, -v84
    v_mul_f32 v77, v85, v75
    v_mul_f32 v84, v77, v77
    v_add_f32 v85, v76, v76
    v_fma_f32 v78, v76, v76, -v84
    v_mul_f32 v79, v85, v77
    v_mul_f32 v84, v79, v79
    v_add_f32 v85, v78, v78
    v_fma_f32 v80, v78, v78, -v84
    v_mul_f32 v81, v85, v79
    v_mul_f32 v82, v64, v44
    v_mul_f32 v83, v65, v44
    v_exp_f32 v82, v82
    v_fract_f32 v83, v83
    v_cos_f32 v68, v83
    v_sin_f32 v69, v83
    v_mul_f32 v68, v68, v82
    v_mul_f32 v69, v69, v82
    v_mul_f32 v84, v67, v69
    v_mul_f32 v85, v67, v68
    v_fma_f32 v68, v66, v68, -v84
    v_fma_f32 v69, -v66, v69, -v85
    v_mul_f32 v82, v64, v45
    v_mul_f32 v83, v65, v45
    v_exp_f32 v82, v82
    v_fract_f32 v83, v83
    v_cos_f32 v70, v83
    v_sin_f32 v71, v83
    v_mul_f32 v70, v70, v82
    v_mul_f32 v71, v71, v82
    v_mul_f32 v84, v67, v71
    v_mul_f32 v85, v67, v70
    v_fma_f32 v70, v66, v70, -v84
    v_fma_f32 v71, -v66, v71, -v85
    v_mul_f32 v82, v64, v46
    v_mul_f32 v83, v65, v46
    v_exp_f32 v82, v82
    v_fract_f32 v83, v83
    v_cos_f32 v72, v83
    v_sin_f32 v73, v83
    v_mul_f32 v72, v72, v82
    v_mul_f32 v73, v73, v82
    v_mul_f32 v84, v67, v73
    v_mul_f32 v85, v67, v72
    v_fma_f32 v72, v66, v72, -v84
    v_fma_f32 v73, -v66, v73, -v85
    v_mfma_f32_16x16x4_f32 v[48:51], v68, v74, v[48:51]
    v_mfma_f32_16x16x4_f32 v[52:55], v70, v76, v[52:55]
    v_mfma_f32_16x16x4_f32 v[56:59], v70, v78, v[56:59]
    v_mfma_f32_16x16x4_f32 v[60:63], v72, v80, v[60:63]
    v_mfma_f32_16x16x4_f32 v[48:51], v69, v75, v[48:51]
    v_mfma_f32_16x16x4_f32 v[52:55], v71, v77, v[52:55]
    v_mfma_f32_16x16x4_f32 v[56:59], v71, v79, v[56:59]
    v_mfma_f32_16x16x4_f32 v[60:63], v73, v81, v[60:63]
    v_mov_b32_dpp v64, v28 row_newbcast:2 row_mask:0xf bank_mask:0xf
    v_mov_b32_dpp v65, v29 row_newbcast:2 row_mask:0xf bank_mask:0xf
    v_mov_b32_dpp v66, v30 row_newbcast:2 row_mask:0xf bank_mask:0xf
    v_mov_b32_dpp v67, v31 row_newbcast:2 row_mask:0xf bank_mask:0xf
    v_mul_f32 v82, v64, v47
    v_mul_f32 v83, v65, v47
    v_exp_f32 v82, v82
    v_fract_f32 v83, v83
    v_cos_f32 v74, v83
    v_sin_f32 v75, v83
    v_mul_f32 v74, v74, v82
    v_mul_f32 v75, v75, v82
    v_mul_f32 v84, v75, v75
    v_add_f32 v85, v74, v74
    v_fma_f32 v76, v74, v74, -v84
    v_mul_f32 v77, v85, v75
    v_mul_f32 v84, v77, v77
    v_add_f32 v85, v76, v76
    v_fma_f32 v78, v76, v76, -v84
    v_mul_f32 v79, v85, v77
    v_mul_f32 v84, v79, v79
    v_add_f32 v85, v78, v78
    v_fma_f32 v80, v78, v78, -v84
    v_mul_f32 v81, v85, v79
    v_mul_f32 v82, v64, v44
    v_mul_f32 v83, v65, v44
    v_exp_f32 v82, v82
    v_fract_f32 v83, v83
    v_cos_f32 v68, v83
    v_sin_f32 v69, v83
    v_mul_f32 v68, v68, v82
    v_mul_f32 v69, v69, v82
    v_mul_f32 v84, v67, v69
    v_mul_f32 v85, v67, v68
    v_fma_f32 v68, v66, v68, -v84
    v_fma_f32 v69, -v66, v69, -v85
    v_mul_f32 v82, v64, v45
    v_mul_f32 v83, v65, v45
    v_exp_f32 v82, v82
    v_fract_f32 v83, v83
    v_cos_f32 v70, v83
    v_sin_f32 v71, v83
    v_mul_f32 v70, v70, v82
    v_mul_f32 v71, v71, v82
    v_mul_f32 v84, v67, v71
    v_mul_f32 v85, v67, v70
    v_fma_f32 v70, v66, v70, -v84
    v_fma_f32 v71, -v66, v71, -v85
    v_mul_f32 v82, v64, v46
    v_mul_f32 v83, v65, v46
    v_exp_f32 v82, v82
    v_fract_f32 v83, v83
    v_cos_f32 v72, v83
    v_sin_f32 v73, v83
    v_mul_f32 v72, v72, v82
    v_mul_f32 v73, v73, v82
    v_mul_f32 v84, v67, v73
    v_mul_f32 v85, v67, v72
    v_fma_f32 v72, v66, v72, -v84
    v_fma_f32 v73, -v66, v73, -v85
    v_mfma_f32_16x16x4_f32 v[48:51], v68, v74, v[48:51]
    v_mfma_f32_16x16x4_f32 v[52:55], v70, v76, v[52:55]
    v_mfma_f32_16x16x4_f32 v[56:59], v70, v78, v[56:59]
    v_mfma_f32_16x16x4_f32 v[60:63], v72, v80, v[60:63]
    v_mfma_f32_16x16x4_f32 v[48:51], v69, v75, v[48:51]
    v_mfma_f32_16x16x4_f32 v[52:55], v71, v77, v[52:55]
    v_mfma_f32_16x16x4_f32 v[56:59], v71, v79, v[56:59]
    v_mfma_f32_16x16x4_f32 v[60:63], v73, v81, v[60:63]
    v_mov_b32_dpp v64, v28 row_newbcast:3 row_mask:0xf bank_mask:0xf
    v_mov_b32_dpp v65, v29 row_newbcast:3 row_mask:0xf bank_mask:0xf
    v_mov_b32_dpp v66, v30 row_newbcast:3 row_mask:0xf bank_mask:0xf
    v_mov_b32_dpp v67, v31 row_newbcast:3 row_mask:0xf bank_mask:0xf
    v_mul_f32 v82, v64, v47
    v_mul_f32 v83, v65, v47
    v_exp_f32 v82, v82
    v_fract_f32 v83, v83
    v_cos_f32 v74, v83
    v_sin_f32 v75, v83
    v_mul_f32 v74, v74, v82
    v_mul_f32 v75, v75, v82
    v_mul_f32 v84, v75, v75
    v_add_f32 v85, v74, v74
    v_fma_f32 v76, v74, v74, -v84
    v_mul_f32 v77, v85, v75
    v_mul_f32 v84, v77, v77
    v_add_f32 v85, v76, v76
    v_fma_f32 v78, v76, v76, -v84
    v_mul_f32 v79, v85, v77
    v_mul_f32 v84, v79, v79
    v_add_f32 v85, v78, v78
    v_fma_f32 v80, v78, v78, -v84
    v_mul_f32 v81, v85, v79
    v_mul_f32 v82, v64, v44
    v_mul_f32 v83, v65, v44
    v_exp_f32 v82, v82
    v_fract_f32 v83, v83
    v_cos_f32 v68, v83
    v_sin_f32 v69, v83
    v_mul_f32 v68, v68, v82
    v_mul_f32 v69, v69, v82
    v_mul_f32 v84, v67, v69
    v_mul_f32 v85, v67, v68
    v_fma_f32 v68, v66, v68, -v84
    v_fma_f32 v69, -v66, v69, -v85
    v_mul_f32 v82, v64, v45
    v_mul_f32 v83, v65, v45
    v_exp_f32 v82, v82
    v_fract_f32 v83, v83
    v_cos_f32 v70, v83
    v_sin_f32 v71, v83
    v_mul_f32 v70, v70, v82
    v_mul_f32 v71, v71, v82
    v_mul_f32 v84, v67, v71
    v_mul_f32 v85, v67, v70
    v_fma_f32 v70, v66, v70, -v84
    v_fma_f32 v71, -v66, v71, -v85
    v_mul_f32 v82, v64, v46
    v_mul_f32 v83, v65, v46
    v_exp_f32 v82, v82
    v_fract_f32 v83, v83
    v_cos_f32 v72, v83
    v_sin_f32 v73, v83
    v_mul_f32 v72, v72, v82
    v_mul_f32 v73, v73, v82
    v_mul_f32 v84, v67, v73
    v_mul_f32 v85, v67, v72
    v_fma_f32 v72, v66, v72, -v84
    v_fma_f32 v73, -v66, v73, -v85
    v_mfma_f32_16x16x4_f32 v[48:51], v68, v74, v[48:51]
    v_mfma_f32_16x16x4_f32 v[52:55], v70, v76, v[52:55]
    v_mfma_f32_16x16x4_f32 v[56:59], v70, v78, v[56:59]
    v_mfma_f32_16x16x4_f32 v[60:63], v72, v80, v[60:63]
    v_mfma_f32_16x16x4_f32 v[48:51], v69, v75, v[48:51]
    v_mfma_f32_16x16x4_f32 v[52:55], v71, v77, v[52:55]
    v_mfma_f32_16x16x4_f32 v[56:59], v71, v79, v[56:59]
    v_mfma_f32_16x16x4_f32 v[60:63], v73, v81, v[60:63]
    v_mov_b32_dpp v64, v28 row_newbcast:4 row_mask:0xf bank_mask:0xf
    v_mov_b32_dpp v65, v29 row_newbcast:4 row_mask:0xf bank_mask:0xf
    v_mov_b32_dpp v66, v30 row_newbcast:4 row_mask:0xf bank_mask:0xf
    v_mov_b32_dpp v67, v31 row_newbcast:4 row_mask:0xf bank_mask:0xf
    v_mul_f32 v82, v64, v47
    v_mul_f32 v83, v65, v47
    v_exp_f32 v82, v82
    v_fract_f32 v83, v83
    v_cos_f32 v74, v83
    v_sin_f32 v75, v83
    v_mul_f32 v74, v74, v82
    v_mul_f32 v75, v75, v82
    v_mul_f32 v84, v75, v75
    v_add_f32 v85, v74, v74
    v_fma_f32 v76, v74, v74, -v84
    v_mul_f32 v77, v85, v75
    v_mul_f32 v84, v77, v77
    v_add_f32 v85, v76, v76
    v_fma_f32 v78, v76, v76, -v84
    v_mul_f32 v79, v85, v77
    v_mul_f32 v84, v79, v79
    v_add_f32 v85, v78, v78
    v_fma_f32 v80, v78, v78, -v84
    v_mul_f32 v81, v85, v79
    v_mul_f32 v82, v64, v44
    v_mul_f32 v83, v65, v44
    v_exp_f32 v82, v82
    v_fract_f32 v83, v83
    v_cos_f32 v68, v83
    v_sin_f32 v69, v83
    v_mul_f32 v68, v68, v82
    v_mul_f32 v69, v69, v82
    v_mul_f32 v84, v67, v69
    v_mul_f32 v85, v67, v68
    v_fma_f32 v68, v66, v68, -v84
    v_fma_f32 v69, -v66, v69, -v85
    v_mul_f32 v82, v64, v45
    v_mul_f32 v83, v65, v45
    v_exp_f32 v82, v82
    v_fract_f32 v83, v83
    v_cos_f32 v70, v83
    v_sin_f32 v71, v83
    v_mul_f32 v70, v70, v82
    v_mul_f32 v71, v71, v82
    v_mul_f32 v84, v67, v71
    v_mul_f32 v85, v67, v70
    v_fma_f32 v70, v66, v70, -v84
    v_fma_f32 v71, -v66, v71, -v85
    v_mul_f32 v82, v64, v46
    v_mul_f32 v83, v65, v46
    v_exp_f32 v82, v82
    v_fract_f32 v83, v83
    v_cos_f32 v72, v83
    v_sin_f32 v73, v83
    v_mul_f32 v72, v72, v82
    v_mul_f32 v73, v73, v82
    v_mul_f32 v84, v67, v73
    v_mul_f32 v85, v67, v72
    v_fma_f32 v72, v66, v72, -v84
    v_fma_f32 v73, -v66, v73, -v85
    v_mfma_f32_16x16x4_f32 v[48:51], v68, v74, v[48:51]
    v_mfma_f32_16x16x4_f32 v[52:55], v70, v76, v[52:55]
    v_mfma_f32_16x16x4_f32 v[56:59], v70, v78, v[56:59]
    v_mfma_f32_16x16x4_f32 v[60:63], v72, v80, v[60:63]
    v_mfma_f32_16x16x4_f32 v[48:51], v69, v75, v[48:51]
    v_mfma_f32_16x16x4_f32 v[52:55], v71, v77, v[52:55]
    v_mfma_f32_16x16x4_f32 v[56:59], v71, v79, v[56:59]
    v_mfma_f32_16x16x4_f32 v[60:63], v73, v81, v[60:63]
    v_mov_b32_dpp v64, v28 row_newbcast:5 row_mask:0xf bank_mask:0xf
    v_mov_b32_dpp v65, v29 row_newbcast:5 row_mask:0xf bank_mask:0xf
    v_mov_b32_dpp v66, v30 row_newbcast:5 row_mask:0xf bank_mask:0xf
    v_mov_b32_dpp v67, v31 row_newbcast:5 row_mask:0xf bank_mask:0xf
    v_mul_f32 v82, v64, v47
    v_mul_f32 v83, v65, v47
    v_exp_f32 v82, v82
    v_fract_f32 v83, v83
    v_cos_f32 v74, v83
    v_sin_f32 v75, v83
    v_mul_f32 v74, v74, v82
    v_mul_f32 v75, v75, v82
    v_mul_f32 v84, v75, v75
    v_add_f32 v85, v74, v74
    v_fma_f32 v76, v74, v74, -v84
    v_mul_f32 v77, v85, v75
    v_mul_f32 v84, v77, v77
    v_add_f32 v85, v76, v76
    v_fma_f32 v78, v76, v76, -v84
    v_mul_f32 v79, v85, v77
    v_mul_f32 v84, v79, v79
    v_add_f32 v85, v78, v78
    v_fma_f32 v80, v78, v78, -v84
    v_mul_f32 v81, v85, v79
    v_mul_f32 v82, v64, v44
    v_mul_f32 v83, v65, v44
    v_exp_f32 v82, v82
    v_fract_f32 v83, v83
    v_cos_f32 v68, v83
    v_sin_f32 v69, v83
    v_mul_f32 v68, v68, v82
    v_mul_f32 v69, v69, v82
    v_mul_f32 v84, v67, v69
    v_mul_f32 v85, v67, v68
    v_fma_f32 v68, v66, v68, -v84
    v_fma_f32 v69, -v66, v69, -v85
    v_mul_f32 v82, v64, v45
    v_mul_f32 v83, v65, v45
    v_exp_f32 v82, v82
    v_fract_f32 v83, v83
    v_cos_f32 v70, v83
    v_sin_f32 v71, v83
    v_mul_f32 v70, v70, v82
    v_mul_f32 v71, v71, v82
    v_mul_f32 v84, v67, v71
    v_mul_f32 v85, v67, v70
    v_fma_f32 v70, v66, v70, -v84
    v_fma_f32 v71, -v66, v71, -v85
    v_mul_f32 v82, v64, v46
    v_mul_f32 v83, v65, v46
    v_exp_f32 v82, v82
    v_fract_f32 v83, v83
    v_cos_f32 v72, v83
    v_sin_f32 v73, v83
    v_mul_f32 v72, v72, v82
    v_mul_f32 v73, v73, v82
    v_mul_f32 v84, v67, v73
    v_mul_f32 v85, v67, v72
    v_fma_f32 v72, v66, v72, -v84
    v_fma_f32 v73, -v66, v73, -v85
    v_mfma_f32_16x16x4_f32 v[48:51], v68, v74, v[48:51]
    v_mfma_f32_16x16x4_f32 v[52:55], v70, v76, v[52:55]
    v_mfma_f32_16x16x4_f32 v[56:59], v70, v78, v[56:59]
    v_mfma_f32_16x16x4_f32 v[60:63], v72, v80, v[60:63]
    v_mfma_f32_16x16x4_f32 v[48:51], v69, v75, v[48:51]
    v_mfma_f32_16x16x4_f32 v[52:55], v71, v77, v[52:55]
    v_mfma_f32_16x16x4_f32 v[56:59], v71, v79, v[56:59]
    v_mfma_f32_16x16x4_f32 v[60:63], v73, v81, v[60:63]
    v_mov_b32_dpp v64, v28 row_newbcast:6 row_mask:0xf bank_mask:0xf
    v_mov_b32_dpp v65, v29 row_newbcast:6 row_mask:0xf bank_mask:0xf
    v_mov_b32_dpp v66, v30 row_newbcast:6 row_mask:0xf bank_mask:0xf
    v_mov_b32_dpp v67, v31 row_newbcast:6 row_mask:0xf bank_mask:0xf
    v_mul_f32 v82, v64, v47
    v_mul_f32 v83, v65, v47
    v_exp_f32 v82, v82
    v_fract_f32 v83, v83
    v_cos_f32 v74, v83
    v_sin_f32 v75, v83
    v_mul_f32 v74, v74, v82
    v_mul_f32 v75, v75, v82
    v_mul_f32 v84, v75, v75
    v_add_f32 v85, v74, v74
    v_fma_f32 v76, v74, v74, -v84
    v_mul_f32 v77, v85, v75
    v_mul_f32 v84, v77, v77
    v_add_f32 v85, v76, v76
    v_fma_f32 v78, v76, v76, -v84
    v_mul_f32 v79, v85, v77
    v_mul_f32 v84, v79, v79
    v_add_f32 v85, v78, v78
    v_fma_f32 v80, v78, v78, -v84
    v_mul_f32 v81, v85, v79
    v_mul_f32 v82, v64, v44
    v_mul_f32 v83, v65, v44
    v_exp_f32 v82, v82
    v_fract_f32 v83, v83
    v_cos_f32 v68, v83
    v_sin_f32 v69, v83
    v_mul_f32 v68, v68, v82
    v_mul_f32 v69, v69, v82
    v_mul_f32 v84, v67, v69
    v_mul_f32 v85, v67, v68
    v_fma_f32 v68, v66, v68, -v84
    v_fma_f32 v69, -v66, v69, -v85
    v_mul_f32 v82, v64, v45
    v_mul_f32 v83, v65, v45
    v_exp_f32 v82, v82
    v_fract_f32 v83, v83
    v_cos_f32 v70, v83
    v_sin_f32 v71, v83
    v_mul_f32 v70, v70, v82
    v_mul_f32 v71, v71, v82
    v_mul_f32 v84, v67, v71
    v_mul_f32 v85, v67, v70
    v_fma_f32 v70, v66, v70, -v84
    v_fma_f32 v71, -v66, v71, -v85
    v_mul_f32 v82, v64, v46
    v_mul_f32 v83, v65, v46
    v_exp_f32 v82, v82
    v_fract_f32 v83, v83
    v_cos_f32 v72, v83
    v_sin_f32 v73, v83
    v_mul_f32 v72, v72, v82
    v_mul_f32 v73, v73, v82
    v_mul_f32 v84, v67, v73
    v_mul_f32 v85, v67, v72
    v_fma_f32 v72, v66, v72, -v84
    v_fma_f32 v73, -v66, v73, -v85
    v_mfma_f32_16x16x4_f32 v[48:51], v68, v74, v[48:51]
    v_mfma_f32_16x16x4_f32 v[52:55], v70, v76, v[52:55]
    v_mfma_f32_16x16x4_f32 v[56:59], v70, v78, v[56:59]
    v_mfma_f32_16x16x4_f32 v[60:63], v72, v80, v[60:63]
    v_mfma_f32_16x16x4_f32 v[48:51], v69, v75, v[48:51]
    v_mfma_f32_16x16x4_f32 v[52:55], v71, v77, v[52:55]
    v_mfma_f32_16x16x4_f32 v[56:59], v71, v79, v[56:59]
    v_mfma_f32_16x16x4_f32 v[60:63], v73, v81, v[60:63]
    v_mov_b32_dpp v64, v28 row_newbcast:7 row_mask:0xf bank_mask:0xf
    v_mov_b32_dpp v65, v29 row_newbcast:7 row_mask:0xf bank_mask:0xf
    v_mov_b32_dpp v66, v30 row_newbcast:7 row_mask:0xf bank_mask:0xf
    v_mov_b32_dpp v67, v31 row_newbcast:7 row_mask:0xf bank_mask:0xf
    v_mul_f32 v82, v64, v47
    v_mul_f32 v83, v65, v47
    v_exp_f32 v82, v82
    v_fract_f32 v83, v83
    v_cos_f32 v74, v83
    v_sin_f32 v75, v83
    v_mul_f32 v74, v74, v82
    v_mul_f32 v75, v75, v82
    v_mul_f32 v84, v75, v75
    v_add_f32 v85, v74, v74
    v_fma_f32 v76, v74, v74, -v84
    v_mul_f32 v77, v85, v75
    v_mul_f32 v84, v77, v77
    v_add_f32 v85, v76, v76
    v_fma_f32 v78, v76, v76, -v84
    v_mul_f32 v79, v85, v77
    v_mul_f32 v84, v79, v79
    v_add_f32 v85, v78, v78
    v_fma_f32 v80, v78, v78, -v84
    v_mul_f32 v81, v85, v79
    v_mul_f32 v82, v64, v44
    v_mul_f32 v83, v65, v44
    v_exp_f32 v82, v82
    v_fract_f32 v83, v83
    v_cos_f32 v68, v83
    v_sin_f32 v69, v83
    v_mul_f32 v68, v68, v82
    v_mul_f32 v69, v69, v82
    v_mul_f32 v84, v67, v69
    v_mul_f32 v85, v67, v68
    v_fma_f32 v68, v66, v68, -v84
    v_fma_f32 v69, -v66, v69, -v85
    v_mul_f32 v82, v64, v45
    v_mul_f32 v83, v65, v45
    v_exp_f32 v82, v82
    v_fract_f32 v83, v83
    v_cos_f32 v70, v83
    v_sin_f32 v71, v83
    v_mul_f32 v70, v70, v82
    v_mul_f32 v71, v71, v82
    v_mul_f32 v84, v67, v71
    v_mul_f32 v85, v67, v70
    v_fma_f32 v70, v66, v70, -v84
    v_fma_f32 v71, -v66, v71, -v85
    v_mul_f32 v82, v64, v46
    v_mul_f32 v83, v65, v46
    v_exp_f32 v82, v82
    v_fract_f32 v83, v83
    v_cos_f32 v72, v83
    v_sin_f32 v73, v83
    v_mul_f32 v72, v72, v82
    v_mul_f32 v73, v73, v82
    v_mul_f32 v84, v67, v73
    v_mul_f32 v85, v67, v72
    v_fma_f32 v72, v66, v72, -v84
    v_fma_f32 v73, -v66, v73, -v85
    v_mfma_f32_16x16x4_f32 v[48:51], v68, v74, v[48:51]
    v_mfma_f32_16x16x4_f32 v[52:55], v70, v76, v[52:55]
    v_mfma_f32_16x16x4_f32 v[56:59], v70, v78, v[56:59]
    v_mfma_f32_16x16x4_f32 v[60:63], v72, v80, v[60:63]
    v_mfma_f32_16x16x4_f32 v[48:51], v69, v75, v[48:51]
    v_mfma_f32_16x16x4_f32 v[52:55], v71, v77, v[52:55]
    v_mfma_f32_16x16x4_f32 v[56:59], v71, v79, v[56:59]
    v_mfma_f32_16x16x4_f32 v[60:63], v73, v81, v[60:63]
    v_mov_b32_dpp v64, v28 row_newbcast:8 row_mask:0xf bank_mask:0xf
    v_mov_b32_dpp v65, v29 row_newbcast:8 row_mask:0xf bank_mask:0xf
    v_mov_b32_dpp v66, v30 row_newbcast:8 row_mask:0xf bank_mask:0xf
    v_mov_b32_dpp v67, v31 row_newbcast:8 row_mask:0xf bank_mask:0xf
    v_mul_f32 v82, v64, v47
    v_mul_f32 v83, v65, v47
    v_exp_f32 v82, v82
    v_fract_f32 v83, v83
    v_cos_f32 v74, v83
    v_sin_f32 v75, v83
    v_mul_f32 v74, v74, v82
    v_mul_f32 v75, v75, v82
    v_mul_f32 v84, v75, v75
    v_add_f32 v85, v74, v74
    v_fma_f32 v76, v74, v74, -v84
    v_mul_f32 v77, v85, v75
    v_mul_f32 v84, v77, v77
    v_add_f32 v85, v76, v76
    v_fma_f32 v78, v76, v76, -v84
    v_mul_f32 v79, v85, v77
    v_mul_f32 v84, v79, v79
    v_add_f32 v85, v78, v78
    v_fma_f32 v80, v78, v78, -v84
    v_mul_f32 v81, v85, v79
    v_mul_f32 v82, v64, v44
    v_mul_f32 v83, v65, v44
    v_exp_f32 v82, v82
    v_fract_f32 v83, v83
    v_cos_f32 v68, v83
    v_sin_f32 v69, v83
    v_mul_f32 v68, v68, v82
    v_mul_f32 v69, v69, v82
    v_mul_f32 v84, v67, v69
    v_mul_f32 v85, v67, v68
    v_fma_f32 v68, v66, v68, -v84
    v_fma_f32 v69, -v66, v69, -v85
    v_mul_f32 v82, v64, v45
    v_mul_f32 v83, v65, v45
    v_exp_f32 v82, v82
    v_fract_f32 v83, v83
    v_cos_f32 v70, v83
    v_sin_f32 v71, v83
    v_mul_f32 v70, v70, v82
    v_mul_f32 v71, v71, v82
    v_mul_f32 v84, v67, v71
    v_mul_f32 v85, v67, v70
    v_fma_f32 v70, v66, v70, -v84
    v_fma_f32 v71, -v66, v71, -v85
    v_mul_f32 v82, v64, v46
    v_mul_f32 v83, v65, v46
    v_exp_f32 v82, v82
    v_fract_f32 v83, v83
    v_cos_f32 v72, v83
    v_sin_f32 v73, v83
    v_mul_f32 v72, v72, v82
    v_mul_f32 v73, v73, v82
    v_mul_f32 v84, v67, v73
    v_mul_f32 v85, v67, v72
    v_fma_f32 v72, v66, v72, -v84
    v_fma_f32 v73, -v66, v73, -v85
    v_mfma_f32_16x16x4_f32 v[48:51], v68, v74, v[48:51]
    v_mfma_f32_16x16x4_f32 v[52:55], v70, v76, v[52:55]
    v_mfma_f32_16x16x4_f32 v[56:59], v70, v78, v[56:59]
    v_mfma_f32_16x16x4_f32 v[60:63], v72, v80, v[60:63]
    v_mfma_f32_16x16x4_f32 v[48:51], v69, v75, v[48:51]
    v_mfma_f32_16x16x4_f32 v[52:55], v71, v77, v[52:55]
    v_mfma_f32_16x16x4_f32 v[56:59], v71, v79, v[56:59]
    v_mfma_f32_16x16x4_f32 v[60:63], v73, v81, v[60:63]
    v_mov_b32_dpp v64, v28 row_newbcast:9 row_mask:0xf bank_mask:0xf
    v_mov_b32_dpp v65, v29 row_newbcast:9 row_mask:0xf bank_mask:0xf
    v_mov_b32_dpp v66, v30 row_newbcast:9 row_mask:0xf bank_mask:0xf
    v_mov_b32_dpp v67, v31 row_newbcast:9 row_mask:0xf bank_mask:0xf
    v_mul_f32 v82, v64, v47
    v_mul_f32 v83, v65, v47
    v_exp_f32 v82, v82
    v_fract_f32 v83, v83
    v_cos_f32 v74, v83
    v_sin_f32 v75, v83
    v_mul_f32 v74, v74, v82
    v_mul_f32 v75, v75, v82
    v_mul_f32 v84, v75, v75
    v_add_f32 v85, v74, v74
    v_fma_f32 v76, v74, v74, -v84
    v_mul_f32 v77, v85, v75
    v_mul_f32 v84, v77, v77
    v_add_f32 v85, v76, v76
    v_fma_f32 v78, v76, v76, -v84
    v_mul_f32 v79, v85, v77
    v_mul_f32 v84, v79, v79
    v_add_f32 v85, v78, v78
    v_fma_f32 v80, v78, v78, -v84
    v_mul_f32 v81, v85, v79
    v_mul_f32 v82, v64, v44
    v_mul_f32 v83, v65, v44
    v_exp_f32 v82, v82
    v_fract_f32 v83, v83
    v_cos_f32 v68, v83
    v_sin_f32 v69, v83
    v_mul_f32 v68, v68, v82
    v_mul_f32 v69, v69, v82
    v_mul_f32 v84, v67, v69
    v_mul_f32 v85, v67, v68
    v_fma_f32 v68, v66, v68, -v84
    v_fma_f32 v69, -v66, v69, -v85
    v_mul_f32 v82, v64, v45
    v_mul_f32 v83, v65, v45
    v_exp_f32 v82, v82
    v_fract_f32 v83, v83
    v_cos_f32 v70, v83
    v_sin_f32 v71, v83
    v_mul_f32 v70, v70, v82
    v_mul_f32 v71, v71, v82
    v_mul_f32 v84, v67, v71
    v_mul_f32 v85, v67, v70
    v_fma_f32 v70, v66, v70, -v84
    v_fma_f32 v71, -v66, v71, -v85
    v_mul_f32 v82, v64, v46
    v_mul_f32 v83, v65, v46
    v_exp_f32 v82, v82
    v_fract_f32 v83, v83
    v_cos_f32 v72, v83
    v_sin_f32 v73, v83
    v_mul_f32 v72, v72, v82
    v_mul_f32 v73, v73, v82
    v_mul_f32 v84, v67, v73
    v_mul_f32 v85, v67, v72
    v_fma_f32 v72, v66, v72, -v84
    v_fma_f32 v73, -v66, v73, -v85
    v_mfma_f32_16x16x4_f32 v[48:51], v68, v74, v[48:51]
    v_mfma_f32_16x16x4_f32 v[52:55], v70, v76, v[52:55]
    v_mfma_f32_16x16x4_f32 v[56:59], v70, v78, v[56:59]
    v_mfma_f32_16x16x4_f32 v[60:63], v72, v80, v[60:63]
    v_mfma_f32_16x16x4_f32 v[48:51], v69, v75, v[48:51]
    v_mfma_f32_16x16x4_f32 v[52:55], v71, v77, v[52:55]
    v_mfma_f32_16x16x4_f32 v[56:59], v71, v79, v[56:59]
    v_mfma_f32_16x16x4_f32 v[60:63], v73, v81, v[60:63]
    v_mov_b32_dpp v64, v28 row_newbcast:10 row_mask:0xf bank_mask:0xf
    v_mov_b32_dpp v65, v29 row_newbcast:10 row_mask:0xf bank_mask:0xf
    v_mov_b32_dpp v66, v30 row_newbcast:10 row_mask:0xf bank_mask:0xf
    v_mov_b32_dpp v67, v31 row_newbcast:10 row_mask:0xf bank_mask:0xf
    v_mul_f32 v82, v64, v47
    v_mul_f32 v83, v65, v47
    v_exp_f32 v82, v82
    v_fract_f32 v83, v83
    v_cos_f32 v74, v83
    v_sin_f32 v75, v83
    v_mul_f32 v74, v74, v82
    v_mul_f32 v75, v75, v82
    v_mul_f32 v84, v75, v75
    v_add_f32 v85, v74, v74
    v_fma_f32 v76, v74, v74, -v84
    v_mul_f32 v77, v85, v75
    v_mul_f32 v84, v77, v77
    v_add_f32 v85, v76, v76
    v_fma_f32 v78, v76, v76, -v84
    v_mul_f32 v79, v85, v77
    v_mul_f32 v84, v79, v79
    v_add_f32 v85, v78, v78
    v_fma_f32 v80, v78, v78, -v84
    v_mul_f32 v81, v85, v79
    v_mul_f32 v82, v64, v44
    v_mul_f32 v83, v65, v44
    v_exp_f32 v82, v82
    v_fract_f32 v83, v83
    v_cos_f32 v68, v83
    v_sin_f32 v69, v83
    v_mul_f32 v68, v68, v82
    v_mul_f32 v69, v69, v82
    v_mul_f32 v84, v67, v69
    v_mul_f32 v85, v67, v68
    v_fma_f32 v68, v66, v68, -v84
    v_fma_f32 v69, -v66, v69, -v85
    v_mul_f32 v82, v64, v45
    v_mul_f32 v83, v65, v45
    v_exp_f32 v82, v82
    v_fract_f32 v83, v83
    v_cos_f32 v70, v83
    v_sin_f32 v71, v83
    v_mul_f32 v70, v70, v82
    v_mul_f32 v71, v71, v82
    v_mul_f32 v84, v67, v71
    v_mul_f32 v85, v67, v70
    v_fma_f32 v70, v66, v70, -v84
    v_fma_f32 v71, -v66, v71, -v85
    v_mul_f32 v82, v64, v46
    v_mul_f32 v83, v65, v46
    v_exp_f32 v82, v82
    v_fract_f32 v83, v83
    v_cos_f32 v72, v83
    v_sin_f32 v73, v83
    v_mul_f32 v72, v72, v82
    v_mul_f32 v73, v73, v82
    v_mul_f32 v84, v67, v73
    v_mul_f32 v85, v67, v72
    v_fma_f32 v72, v66, v72, -v84
    v_fma_f32 v73, -v66, v73, -v85
    v_mfma_f32_16x16x4_f32 v[48:51], v68, v74, v[48:51]
    v_mfma_f32_16x16x4_f32 v[52:55], v70, v76, v[52:55]
    v_mfma_f32_16x16x4_f32 v[56:59], v70, v78, v[56:59]
    v_mfma_f32_16x16x4_f32 v[60:63], v72, v80, v[60:63]
    v_mfma_f32_16x16x4_f32 v[48:51], v69, v75, v[48:51]
    v_mfma_f32_16x16x4_f32 v[52:55], v71, v77, v[52:55]
    v_mfma_f32_16x16x4_f32 v[56:59], v71, v79, v[56:59]
    v_mfma_f32_16x16x4_f32 v[60:63], v73, v81, v[60:63]
    v_mov_b32_dpp v64, v28 row_newbcast:11 row_mask:0xf bank_mask:0xf
    v_mov_b32_dpp v65, v29 row_newbcast:11 row_mask:0xf bank_mask:0xf
    v_mov_b32_dpp v66, v30 row_newbcast:11 row_mask:0xf bank_mask:0xf
    v_mov_b32_dpp v67, v31 row_newbcast:11 row_mask:0xf bank_mask:0xf
    v_mul_f32 v82, v64, v47
    v_mul_f32 v83, v65, v47
    v_exp_f32 v82, v82
    v_fract_f32 v83, v83
    v_cos_f32 v74, v83
    v_sin_f32 v75, v83
    v_mul_f32 v74, v74, v82
    v_mul_f32 v75, v75, v82
    v_mul_f32 v84, v75, v75
    v_add_f32 v85, v74, v74
    v_fma_f32 v76, v74, v74, -v84
    v_mul_f32 v77, v85, v75
    v_mul_f32 v84, v77, v77
    v_add_f32 v85, v76, v76
    v_fma_f32 v78, v76, v76, -v84
    v_mul_f32 v79, v85, v77
    v_mul_f32 v84, v79, v79
    v_add_f32 v85, v78, v78
    v_fma_f32 v80, v78, v78, -v84
    v_mul_f32 v81, v85, v79
    v_mul_f32 v82, v64, v44
    v_mul_f32 v83, v65, v44
    v_exp_f32 v82, v82
    v_fract_f32 v83, v83
    v_cos_f32 v68, v83
    v_sin_f32 v69, v83
    v_mul_f32 v68, v68, v82
    v_mul_f32 v69, v69, v82
    v_mul_f32 v84, v67, v69
    v_mul_f32 v85, v67, v68
    v_fma_f32 v68, v66, v68, -v84
    v_fma_f32 v69, -v66, v69, -v85
    v_mul_f32 v82, v64, v45
    v_mul_f32 v83, v65, v45
    v_exp_f32 v82, v82
    v_fract_f32 v83, v83
    v_cos_f32 v70, v83
    v_sin_f32 v71, v83
    v_mul_f32 v70, v70, v82
    v_mul_f32 v71, v71, v82
    v_mul_f32 v84, v67, v71
    v_mul_f32 v85, v67, v70
    v_fma_f32 v70, v66, v70, -v84
    v_fma_f32 v71, -v66, v71, -v85
    v_mul_f32 v82, v64, v46
    v_mul_f32 v83, v65, v46
    v_exp_f32 v82, v82
    v_fract_f32 v83, v83
    v_cos_f32 v72, v83
    v_sin_f32 v73, v83
    v_mul_f32 v72, v72, v82
    v_mul_f32 v73, v73, v82
    v_mul_f32 v84, v67, v73
    v_mul_f32 v85, v67, v72
    v_fma_f32 v72, v66, v72, -v84
    v_fma_f32 v73, -v66, v73, -v85
    v_mfma_f32_16x16x4_f32 v[48:51], v68, v74, v[48:51]
    v_mfma_f32_16x16x4_f32 v[52:55], v70, v76, v[52:55]
    v_mfma_f32_16x16x4_f32 v[56:59], v70, v78, v[56:59]
    v_mfma_f32_16x16x4_f32 v[60:63], v72, v80, v[60:63]
    v_mfma_f32_16x16x4_f32 v[48:51], v69, v75, v[48:51]
    v_mfma_f32_16x16x4_f32 v[52:55], v71, v77, v[52:55]
    v_mfma_f32_16x16x4_f32 v[56:59], v71, v79, v[56:59]
    v_mfma_f32_16x16x4_f32 v[60:63], v73, v81, v[60:63]
    v_mov_b32_dpp v64, v28 row_newbcast:12 row_mask:0xf bank_mask:0xf
    v_mov_b32_dpp v65, v29 row_newbcast:12 row_mask:0xf bank_mask:0xf
    v_mov_b32_dpp v66, v30 row_newbcast:12 row_mask:0xf bank_mask:0xf
    v_mov_b32_dpp v67, v31 row_newbcast:12 row_mask:0xf bank_mask:0xf
    v_mul_f32 v82, v64, v47
    v_mul_f32 v83, v65, v47
    v_exp_f32 v82, v82
    v_fract_f32 v83, v83
    v_cos_f32 v74, v83
    v_sin_f32 v75, v83
    v_mul_f32 v74, v74, v82
    v_mul_f32 v75, v75, v82
    v_mul_f32 v84, v75, v75
    v_add_f32 v85, v74, v74
    v_fma_f32 v76, v74, v74, -v84
    v_mul_f32 v77, v85, v75
    v_mul_f32 v84, v77, v77
    v_add_f32 v85, v76, v76
    v_fma_f32 v78, v76, v76, -v84
    v_mul_f32 v79, v85, v77
    v_mul_f32 v84, v79, v79
    v_add_f32 v85, v78, v78
    v_fma_f32 v80, v78, v78, -v84
    v_mul_f32 v81, v85, v79
    v_mul_f32 v82, v64, v44
    v_mul_f32 v83, v65, v44
    v_exp_f32 v82, v82
    v_fract_f32 v83, v83
    v_cos_f32 v68, v83
    v_sin_f32 v69, v83
    v_mul_f32 v68, v68, v82
    v_mul_f32 v69, v69, v82
    v_mul_f32 v84, v67, v69
    v_mul_f32 v85, v67, v68
    v_fma_f32 v68, v66, v68, -v84
    v_fma_f32 v69, -v66, v69, -v85
    v_mul_f32 v82, v64, v45
    v_mul_f32 v83, v65, v45
    v_exp_f32 v82, v82
    v_fract_f32 v83, v83
    v_cos_f32 v70, v83
    v_sin_f32 v71, v83
    v_mul_f32 v70, v70, v82
    v_mul_f32 v71, v71, v82
    v_mul_f32 v84, v67, v71
    v_mul_f32 v85, v67, v70
    v_fma_f32 v70, v66, v70, -v84
    v_fma_f32 v71, -v66, v71, -v85
    v_mul_f32 v82, v64, v46
    v_mul_f32 v83, v65, v46
    v_exp_f32 v82, v82
    v_fract_f32 v83, v83
    v_cos_f32 v72, v83
    v_sin_f32 v73, v83
    v_mul_f32 v72, v72, v82
    v_mul_f32 v73, v73, v82
    v_mul_f32 v84, v67, v73
    v_mul_f32 v85, v67, v72
    v_fma_f32 v72, v66, v72, -v84
    v_fma_f32 v73, -v66, v73, -v85
    v_mfma_f32_16x16x4_f32 v[48:51], v68, v74, v[48:51]
    v_mfma_f32_16x16x4_f32 v[52:55], v70, v76, v[52:55]
    v_mfma_f32_16x16x4_f32 v[56:59], v70, v78, v[56:59]
    v_mfma_f32_16x16x4_f32 v[60:63], v72, v80, v[60:63]
    v_mfma_f32_16x16x4_f32 v[48:51], v69, v75, v[48:51]
    v_mfma_f32_16x16x4_f32 v[52:55], v71, v77, v[52:55]
    v_mfma_f32_16x16x4_f32 v[56:59], v71, v79, v[56:59]
    v_mfma_f32_16x16x4_f32 v[60:63], v73, v81, v[60:63]
    v_mov_b32_dpp v64, v28 row_newbcast:13 row_mask:0xf bank_mask:0xf
    v_mov_b32_dpp v65, v29 row_newbcast:13 row_mask:0xf bank_mask:0xf
    v_mov_b32_dpp v66, v30 row_newbcast:13 row_mask:0xf bank_mask:0xf
    v_mov_b32_dpp v67, v31 row_newbcast:13 row_mask:0xf bank_mask:0xf
    v_mul_f32 v82, v64, v47
    v_mul_f32 v83, v65, v47
    v_exp_f32 v82, v82
    v_fract_f32 v83, v83
    v_cos_f32 v74, v83
    v_sin_f32 v75, v83
    v_mul_f32 v74, v74, v82
    v_mul_f32 v75, v75, v82
    v_mul_f32 v84, v75, v75
    v_add_f32 v85, v74, v74
    v_fma_f32 v76, v74, v74, -v84
    v_mul_f32 v77, v85, v75
    v_mul_f32 v84, v77, v77
    v_add_f32 v85, v76, v76
    v_fma_f32 v78, v76, v76, -v84
    v_mul_f32 v79, v85, v77
    v_mul_f32 v84, v79, v79
    v_add_f32 v85, v78, v78
    v_fma_f32 v80, v78, v78, -v84
    v_mul_f32 v81, v85, v79
    v_mul_f32 v82, v64, v44
    v_mul_f32 v83, v65, v44
    v_exp_f32 v82, v82
    v_fract_f32 v83, v83
    v_cos_f32 v68, v83
    v_sin_f32 v69, v83
    v_mul_f32 v68, v68, v82
    v_mul_f32 v69, v69, v82
    v_mul_f32 v84, v67, v69
    v_mul_f32 v85, v67, v68
    v_fma_f32 v68, v66, v68, -v84
    v_fma_f32 v69, -v66, v69, -v85
    v_mul_f32 v82, v64, v45
    v_mul_f32 v83, v65, v45
    v_exp_f32 v82, v82
    v_fract_f32 v83, v83
    v_cos_f32 v70, v83
    v_sin_f32 v71, v83
    v_mul_f32 v70, v70, v82
    v_mul_f32 v71, v71, v82
    v_mul_f32 v84, v67, v71
    v_mul_f32 v85, v67, v70
    v_fma_f32 v70, v66, v70, -v84
    v_fma_f32 v71, -v66, v71, -v85
    v_mul_f32 v82, v64, v46
    v_mul_f32 v83, v65, v46
    v_exp_f32 v82, v82
    v_fract_f32 v83, v83
    v_cos_f32 v72, v83
    v_sin_f32 v73, v83
    v_mul_f32 v72, v72, v82
    v_mul_f32 v73, v73, v82
    v_mul_f32 v84, v67, v73
    v_mul_f32 v85, v67, v72
    v_fma_f32 v72, v66, v72, -v84
    v_fma_f32 v73, -v66, v73, -v85
    v_mfma_f32_16x16x4_f32 v[48:51], v68, v74, v[48:51]
    v_mfma_f32_16x16x4_f32 v[52:55], v70, v76, v[52:55]
    v_mfma_f32_16x16x4_f32 v[56:59], v70, v78, v[56:59]
    v_mfma_f32_16x16x4_f32 v[60:63], v72, v80, v[60:63]
    v_mfma_f32_16x16x4_f32 v[48:51], v69, v75, v[48:51]
    v_mfma_f32_16x16x4_f32 v[52:55], v71, v77, v[52:55]
    v_mfma_f32_16x16x4_f32 v[56:59], v71, v79, v[56:59]
    v_mfma_f32_16x16x4_f32 v[60:63], v73, v81, v[60:63]
    v_mov_b32_dpp v64, v28 row_newbcast:14 row_mask:0xf bank_mask:0xf
    v_mov_b32_dpp v65, v29 row_newbcast:14 row_mask:0xf bank_mask:0xf
    v_mov_b32_dpp v66, v30 row_newbcast:14 row_mask:0xf bank_mask:0xf
    v_mov_b32_dpp v67, v31 row_newbcast:14 row_mask:0xf bank_mask:0xf
    v_mul_f32 v82, v64, v47
    v_mul_f32 v83, v65, v47
    v_exp_f32 v82, v82
    v_fract_f32 v83, v83
    v_cos_f32 v74, v83
    v_sin_f32 v75, v83
    v_mul_f32 v74, v74, v82
    v_mul_f32 v75, v75, v82
    v_mul_f32 v84, v75, v75
    v_add_f32 v85, v74, v74
    v_fma_f32 v76, v74, v74, -v84
    v_mul_f32 v77, v85, v75
    v_mul_f32 v84, v77, v77
    v_add_f32 v85, v76, v76
    v_fma_f32 v78, v76, v76, -v84
    v_mul_f32 v79, v85, v77
    v_mul_f32 v84, v79, v79
    v_add_f32 v85, v78, v78
    v_fma_f32 v80, v78, v78, -v84
    v_mul_f32 v81, v85, v79
    v_mul_f32 v82, v64, v44
    v_mul_f32 v83, v65, v44
    v_exp_f32 v82, v82
    v_fract_f32 v83, v83
    v_cos_f32 v68, v83
    v_sin_f32 v69, v83
    v_mul_f32 v68, v68, v82
    v_mul_f32 v69, v69, v82
    v_mul_f32 v84, v67, v69
    v_mul_f32 v85, v67, v68
    v_fma_f32 v68, v66, v68, -v84
    v_fma_f32 v69, -v66, v69, -v85
    v_mul_f32 v82, v64, v45
    v_mul_f32 v83, v65, v45
    v_exp_f32 v82, v82
    v_fract_f32 v83, v83
    v_cos_f32 v70, v83
    v_sin_f32 v71, v83
    v_mul_f32 v70, v70, v82
    v_mul_f32 v71, v71, v82
    v_mul_f32 v84, v67, v71
    v_mul_f32 v85, v67, v70
    v_fma_f32 v70, v66, v70, -v84
    v_fma_f32 v71, -v66, v71, -v85
    v_mul_f32 v82, v64, v46
    v_mul_f32 v83, v65, v46
    v_exp_f32 v82, v82
    v_fract_f32 v83, v83
    v_cos_f32 v72, v83
    v_sin_f32 v73, v83
    v_mul_f32 v72, v72, v82
    v_mul_f32 v73, v73, v82
    v_mul_f32 v84, v67, v73
    v_mul_f32 v85, v67, v72
    v_fma_f32 v72, v66, v72, -v84
    v_fma_f32 v73, -v66, v73, -v85
    v_mfma_f32_16x16x4_f32 v[48:51], v68, v74, v[48:51]
    v_mfma_f32_16x16x4_f32 v[52:55], v70, v76, v[52:55]
    v_mfma_f32_16x16x4_f32 v[56:59], v70, v78, v[56:59]
    v_mfma_f32_16x16x4_f32 v[60:63], v72, v80, v[60:63]
    v_mfma_f32_16x16x4_f32 v[48:51], v69, v75, v[48:51]
    v_mfma_f32_16x16x4_f32 v[52:55], v71, v77, v[52:55]
    v_mfma_f32_16x16x4_f32 v[56:59], v71, v79, v[56:59]
    v_mfma_f32_16x16x4_f32 v[60:63], v73, v81, v[60:63]
    v_mov_b32_dpp v64, v28 row_newbcast:15 row_mask:0xf bank_mask:0xf
    v_mov_b32_dpp v65, v29 row_newbcast:15 row_mask:0xf bank_mask:0xf
    v_mov_b32_dpp v66, v30 row_newbcast:15 row_mask:0xf bank_mask:0xf
    v_mov_b32_dpp v67, v31 row_newbcast:15 row_mask:0xf bank_mask:0xf
    v_mul_f32 v82, v64, v47
    v_mul_f32 v83, v65, v47
    v_exp_f32 v82, v82
    v_fract_f32 v83, v83
    v_cos_f32 v74, v83
    v_sin_f32 v75, v83
    v_mul_f32 v74, v74, v82
    v_mul_f32 v75, v75, v82
    v_mul_f32 v84, v75, v75
    v_add_f32 v85, v74, v74
    v_fma_f32 v76, v74, v74, -v84
    v_mul_f32 v77, v85, v75
    v_mul_f32 v84, v77, v77
    v_add_f32 v85, v76, v76
    v_fma_f32 v78, v76, v76, -v84
    v_mul_f32 v79, v85, v77
    v_mul_f32 v84, v79, v79
    v_add_f32 v85, v78, v78
    v_fma_f32 v80, v78, v78, -v84
    v_mul_f32 v81, v85, v79
    v_mul_f32 v82, v64, v44
    v_mul_f32 v83, v65, v44
    v_exp_f32 v82, v82
    v_fract_f32 v83, v83
    v_cos_f32 v68, v83
    v_sin_f32 v69, v83
    v_mul_f32 v68, v68, v82
    v_mul_f32 v69, v69, v82
    v_mul_f32 v84, v67, v69
    v_mul_f32 v85, v67, v68
    v_fma_f32 v68, v66, v68, -v84
    v_fma_f32 v69, -v66, v69, -v85
    v_mul_f32 v82, v64, v45
    v_mul_f32 v83, v65, v45
    v_exp_f32 v82, v82
    v_fract_f32 v83, v83
    v_cos_f32 v70, v83
    v_sin_f32 v71, v83
    v_mul_f32 v70, v70, v82
    v_mul_f32 v71, v71, v82
    v_mul_f32 v84, v67, v71
    v_mul_f32 v85, v67, v70
    v_fma_f32 v70, v66, v70, -v84
    v_fma_f32 v71, -v66, v71, -v85
    v_mul_f32 v82, v64, v46
    v_mul_f32 v83, v65, v46
    v_exp_f32 v82, v82
    v_fract_f32 v83, v83
    v_cos_f32 v72, v83
    v_sin_f32 v73, v83
    v_mul_f32 v72, v72, v82
    v_mul_f32 v73, v73, v82
    v_mul_f32 v84, v67, v73
    v_mul_f32 v85, v67, v72
    v_fma_f32 v72, v66, v72, -v84
    v_fma_f32 v73, -v66, v73, -v85
    v_mfma_f32_16x16x4_f32 v[48:51], v68, v74, v[48:51]
    v_mfma_f32_16x16x4_f32 v[52:55], v70, v76, v[52:55]
    v_mfma_f32_16x16x4_f32 v[56:59], v70, v78, v[56:59]
    v_mfma_f32_16x16x4_f32 v[60:63], v72, v80, v[60:63]
    v_mfma_f32_16x16x4_f32 v[48:51], v69, v75, v[48:51]
    v_mfma_f32_16x16x4_f32 v[52:55], v71, v77, v[52:55]
    v_mfma_f32_16x16x4_f32 v[56:59], v71, v79, v[56:59]
    v_mfma_f32_16x16x4_f32 v[60:63], v73, v81, v[60:63]
    v_lshlrev_b32 v5, 8, v3
    v_lshl_add_u32 v5, v2, 2, v5
    v_add_u32 v5, v5, v4
    ds_write_b32 v5, v48 offset:4608
    ds_write_b32 v5, v49 offset:4672
    ds_write_b32 v5, v50 offset:4736
    ds_write_b32 v5, v51 offset:4800
    v_cmp_gt_u32 vcc, 2, v3
    s_nop 0
    s_mov_b64 exec, vcc
    ds_write_b32 v5, v52 offset:5632
    ds_write_b32 v5, v53 offset:5696
    ds_write_b32 v5, v54 offset:5760
    ds_write_b32 v5, v55 offset:5824
    ds_write_b32 v5, v60 offset:6656
    ds_write_b32 v5, v61 offset:6720
    ds_write_b32 v5, v62 offset:6784
    ds_write_b32 v5, v63 offset:6848
    s_not_b64 exec, exec
    ds_write_b32 v5, v56 offset:5632
    ds_write_b32 v5, v57 offset:5696
    ds_write_b32 v5, v58 offset:5760
    ds_write_b32 v5, v59 offset:5824
    s_mov_b32 exec_lo, 0
    s_mov_b32 exec_hi, 3
    v_cmp_eq_u32 vcc, 0, v2
    s_nop 1
    v_cndmask_b32 v6, 0, v60, vcc
    ds_write_b32 v5, v6 offset:6656
    s_mov_b64 exec, -1
    s_waitcnt lgkmcnt(0)
    v_lshlrev_b32 v7, 1, v1
    v_sub_u32 v7, 2065, v7
    v_lshl_add_u32 v64, v1, 2, v4
    v_mov_b32 v65, 641
    s_mov_b32 s25, 17
ss_exp:
    v_subrev_u32 v66, 0, v7
    v_cvt_f32_u32 v70, v66
    v_cvt_pk_bf16_f32 v70, v70, v70
    v_and_b32 v70, 0xffff, v70
    v_subrev_u32 v70, 0x4280, v70
    v_cmp_gt_u32 vcc, 256, v66
    s_nop 1
    v_cndmask_b32 v70, v70, v66, vcc
    v_cmp_gt_u32 vcc, 2048, v66
    s_nop 1
    v_cndmask_b32 v70, v65, v70, vcc
    v_lshl_add_u32 v70, v70, 2, v4
    ds_read_b32 v74, v70 offset:4608
    v_subrev_u32 v67, 1, v7
    v_cvt_f32_u32 v71, v67
    v_cvt_pk_bf16_f32 v71, v71, v71
    v_and_b32 v71, 0xffff, v71
    v_subrev_u32 v71, 0x4280, v71
    v_cmp_gt_u32 vcc, 256, v67
    s_nop 1
    v_cndmask_b32 v71, v71, v67, vcc
    v_cmp_gt_u32 vcc, 2048, v67
    s_nop 1
    v_cndmask_b32 v71, v65, v71, vcc
    v_lshl_add_u32 v71, v71, 2, v4
    ds_read_b32 v75, v71 offset:4608
    v_subrev_u32 v68, 2, v7
    v_cvt_f32_u32 v72, v68
    v_cvt_pk_bf16_f32 v72, v72, v72
    v_and_b32 v72, 0xffff, v72
    v_subrev_u32 v72, 0x4280, v72
    v_cmp_gt_u32 vcc, 256, v68
    s_nop 1
    v_cndmask_b32 v72, v72, v68, vcc
    v_cmp_gt_u32 vcc, 2048, v68
    s_nop 1
    v_cndmask_b32 v72, v65, v72, vcc
    v_lshl_add_u32 v72, v72, 2, v4
    ds_read_b32 v76, v72 offset:4608
    s_waitcnt lgkmcnt(0)
    v_cvt_pk_bf16_f32 v78, v75, v76
    v_cvt_pk_bf16_f32 v79, v74, v75
    ds_write_b32 v64, v78 offset:7424
    ds_write_b32 v64, v79 offset:11776
    v_subrev_u32 v7, 128, v7
    v_add_u32 v64, 256, v64
    s_sub_u32 s25, s25, 1
    s_cmp_lg_u32 s25, 0
    s_cbranch_scc1 ss_exp
    s_waitcnt lgkmcnt(0)
    s_barrier
    v_and_b32 v5, 1, v2
    v_mul_u32_u24 v64, 4352, v5
    v_sub_u32 v5, v5, v2
    v_lshl_add_u32 v5, v3, 3, v5
    v_lshl_add_u32 v64, v5, 1, v64
    v_add_u32 v64, 11520, v64
    v_add_u32 v64, v64, v4
    v_lshlrev_b32 v65, 5, v2
    v_lshl_add_u32 v65, v3, 4, v65
    v_add_u32 v65, 480, v65
    v_add_u32 v65, v65, v4
    v_mov_b32 v96, 0
    v_mov_b32 v97, 0
    v_mov_b32 v98, 0
    v_mov_b32 v99, 0
    v_mov_b32 v100, 0
    v_mov_b32 v101, 0
    v_mov_b32 v102, 0
    v_mov_b32 v103, 0
    v_mov_b32 v104, 0
    v_mov_b32 v105, 0
    v_mov_b32 v106, 0
    v_mov_b32 v107, 0
    v_mov_b32 v108, 0
    v_mov_b32 v109, 0
    v_mov_b32 v110, 0
    v_mov_b32 v111, 0
    v_mov_b32 v112, 0
    v_mov_b32 v113, 0
    v_mov_b32 v114, 0
    v_mov_b32 v115, 0
    v_mov_b32 v116, 0
    v_mov_b32 v117, 0
    v_mov_b32 v118, 0
    v_mov_b32 v119, 0
    v_mov_b32 v120, 0
    v_mov_b32 v121, 0
    v_mov_b32 v122, 0
    v_mov_b32 v123, 0
    v_mov_b32 v124, 0
    v_mov_b32 v125, 0
    v_mov_b32 v126, 0
    v_mov_b32 v127, 0
    s_mov_b32 s25, 8
ss_cv0:
    ds_read2_b32 v[68:69], v64 offset0:0 offset1:1
    ds_read2_b32 v[70:71], v64 offset0:2 offset1:3
    ds_read_b128 v[128:131], v65 offset:0
    ds_read_b128 v[132:135], v65 offset:512
    ds_read_b128 v[136:139], v65 offset:1024
    ds_read_b128 v[140:143], v65 offset:1536
    ds_read_b128 v[144:147], v65 offset:2048
    ds_read_b128 v[148:151], v65 offset:2560
    ds_read_b128 v[152:155], v65 offset:3072
    ds_read_b128 v[156:159], v65 offset:3584
    v_subrev_u32 v64, 64, v64
    v_subrev_u32 v65, 64, v65
    s_waitcnt lgkmcnt(7)
    v_mfma_f32_16x16x32_bf16 v[96:99], v[68:71], v[128:131], v[96:99]
    s_waitcnt lgkmcnt(6)
    v_mfma_f32_16x16x32_bf16 v[100:103], v[68:71], v[132:135], v[100:103]
    s_waitcnt lgkmcnt(5)
    v_mfma_f32_16x16x32_bf16 v[104:107], v[68:71], v[136:139], v[104:107]
    s_waitcnt lgkmcnt(4)
    v_mfma_f32_16x16x32_bf16 v[108:111], v[68:71], v[140:143], v[108:111]
    s_waitcnt lgkmcnt(3)
    v_mfma_f32_16x16x32_bf16 v[112:115], v[68:71], v[144:147], v[112:115]
    s_waitcnt lgkmcnt(2)
    v_mfma_f32_16x16x32_bf16 v[116:119], v[68:71], v[148:151], v[116:119]
    s_waitcnt lgkmcnt(1)
    v_mfma_f32_16x16x32_bf16 v[120:123], v[68:71], v[152:155], v[120:123]
    s_waitcnt lgkmcnt(0)
    v_mfma_f32_16x16x32_bf16 v[124:127], v[68:71], v[156:159], v[124:127]
    s_sub_u32 s25, s25, 1
    s_cmp_lg_u32 s25, 0
    s_cbranch_scc1 ss_cv0
    v_add_u32 v65, 512, v65
    s_mov_b32 s25, 8
ss_cv1:
    ds_read2_b32 v[68:69], v64 offset0:0 offset1:1
    ds_read2_b32 v[70:71], v64 offset0:2 offset1:3
    ds_read_b128 v[132:135], v65 offset:0
    ds_read_b128 v[136:139], v65 offset:512
    ds_read_b128 v[140:143], v65 offset:1024
    ds_read_b128 v[144:147], v65 offset:1536
    ds_read_b128 v[148:151], v65 offset:2048
    ds_read_b128 v[152:155], v65 offset:2560
    ds_read_b128 v[156:159], v65 offset:3072
    v_subrev_u32 v64, 64, v64
    v_subrev_u32 v65, 64, v65
    s_waitcnt lgkmcnt(6)
    v_mfma_f32_16x16x32_bf16 v[100:103], v[68:71], v[132:135], v[100:103]
    s_waitcnt lgkmcnt(5)
    v_mfma_f32_16x16x32_bf16 v[104:107], v[68:71], v[136:139], v[104:107]
    s_waitcnt lgkmcnt(4)
    v_mfma_f32_16x16x32_bf16 v[108:111], v[68:71], v[140:143], v[108:111]
    s_waitcnt lgkmcnt(3)
    v_mfma_f32_16x16x32_bf16 v[112:115], v[68:71], v[144:147], v[112:115]
    s_waitcnt lgkmcnt(2)
    v_mfma_f32_16x16x32_bf16 v[116:119], v[68:71], v[148:151], v[116:119]
    s_waitcnt lgkmcnt(1)
    v_mfma_f32_16x16x32_bf16 v[120:123], v[68:71], v[152:155], v[120:123]
    s_waitcnt lgkmcnt(0)
    v_mfma_f32_16x16x32_bf16 v[124:127], v[68:71], v[156:159], v[124:127]
    s_sub_u32 s25, s25, 1
    s_cmp_lg_u32 s25, 0
    s_cbranch_scc1 ss_cv1
    v_add_u32 v65, 512, v65
    s_mov_b32 s25, 8
ss_cv2:
    ds_read2_b32 v[68:69], v64 offset0:0 offset1:1
    ds_read2_b32 v[70:71], v64 offset0:2 offset1:3
    ds_read_b128 v[136:139], v65 offset:0
    ds_read_b128 v[140:143], v65 offset:512
    ds_read_b128 v[144:147], v65 offset:1024
    ds_read_b128 v[148:151], v65 offset:1536
    ds_read_b128 v[152:155], v65 offset:2048
    ds_read_b128 v[156:159], v65 offset:2560
    v_subrev_u32 v64, 64, v64
    v_subrev_u32 v65, 64, v65
    s_waitcnt lgkmcnt(5)
    v_mfma_f32_16x16x32_bf16 v[104:107], v[68:71], v[136:139], v[104:107]
    s_waitcnt lgkmcnt(4)
    v_mfma_f32_16x16x32_bf16 v[108:111], v[68:71], v[140:143], v[108:111]
    s_waitcnt lgkmcnt(3)
    v_mfma_f32_16x16x32_bf16 v[112:115], v[68:71], v[144:147], v[112:115]
    s_waitcnt lgkmcnt(2)
    v_mfma_f32_16x16x32_bf16 v[116:119], v[68:71], v[148:151], v[116:119]
    s_waitcnt lgkmcnt(1)
    v_mfma_f32_16x16x32_bf16 v[120:123], v[68:71], v[152:155], v[120:123]
    s_waitcnt lgkmcnt(0)
    v_mfma_f32_16x16x32_bf16 v[124:127], v[68:71], v[156:159], v[124:127]
    s_sub_u32 s25, s25, 1
    s_cmp_lg_u32 s25, 0
    s_cbranch_scc1 ss_cv2
    v_add_u32 v65, 512, v65
    s_mov_b32 s25, 8
ss_cv3:
    ds_read2_b32 v[68:69], v64 offset0:0 offset1:1
    ds_read2_b32 v[70:71], v64 offset0:2 offset1:3
    ds_read_b128 v[140:143], v65 offset:0
    ds_read_b128 v[144:147], v65 offset:512
    ds_read_b128 v[148:151], v65 offset:1024
    ds_read_b128 v[152:155], v65 offset:1536
    ds_read_b128 v[156:159], v65 offset:2048
    v_subrev_u32 v64, 64, v64
    v_subrev_u32 v65, 64, v65
    s_waitcnt lgkmcnt(4)
    v_mfma_f32_16x16x32_bf16 v[108:111], v[68:71], v[140:143], v[108:111]
    s_waitcnt lgkmcnt(3)
    v_mfma_f32_16x16x32_bf16 v[112:115], v[68:71], v[144:147], v[112:115]
    s_waitcnt lgkmcnt(2)
    v_mfma_f32_16x16x32_bf16 v[116:119], v[68:71], v[148:151], v[116:119]
    s_waitcnt lgkmcnt(1)
    v_mfma_f32_16x16x32_bf16 v[120:123], v[68:71], v[152:155], v[120:123]
    s_waitcnt lgkmcnt(0)
    v_mfma_f32_16x16x32_bf16 v[124:127], v[68:71], v[156:159], v[124:127]
    s_sub_u32 s25, s25, 1
    s_cmp_lg_u32 s25, 0
    s_cbranch_scc1 ss_cv3
    v_add_u32 v65, 512, v65
    s_mov_b32 s25, 8
ss_cv4:
    ds_read2_b32 v[68:69], v64 offset0:0 offset1:1
    ds_read2_b32 v[70:71], v64 offset0:2 offset1:3
    ds_read_b128 v[144:147], v65 offset:0
    ds_read_b128 v[148:151], v65 offset:512
    ds_read_b128 v[152:155], v65 offset:1024
    ds_read_b128 v[156:159], v65 offset:1536
    v_subrev_u32 v64, 64, v64
    v_subrev_u32 v65, 64, v65
    s_waitcnt lgkmcnt(3)
    v_mfma_f32_16x16x32_bf16 v[112:115], v[68:71], v[144:147], v[112:115]
    s_waitcnt lgkmcnt(2)
    v_mfma_f32_16x16x32_bf16 v[116:119], v[68:71], v[148:151], v[116:119]
    s_waitcnt lgkmcnt(1)
    v_mfma_f32_16x16x32_bf16 v[120:123], v[68:71], v[152:155], v[120:123]
    s_waitcnt lgkmcnt(0)
    v_mfma_f32_16x16x32_bf16 v[124:127], v[68:71], v[156:159], v[124:127]
    s_sub_u32 s25, s25, 1
    s_cmp_lg_u32 s25, 0
    s_cbranch_scc1 ss_cv4
    v_add_u32 v65, 512, v65
    s_mov_b32 s25, 8
ss_cv5:
    ds_read2_b32 v[68:69], v64 offset0:0 offset1:1
    ds_read2_b32 v[70:71], v64 offset0:2 offset1:3
    ds_read_b128 v[148:151], v65 offset:0
    ds_read_b128 v[152:155], v65 offset:512
    ds_read_b128 v[156:159], v65 offset:1024
    v_subrev_u32 v64, 64, v64
    v_subrev_u32 v65, 64, v65
    s_waitcnt lgkmcnt(2)
    v_mfma_f32_16x16x32_bf16 v[116:119], v[68:71], v[148:151], v[116:119]
    s_waitcnt lgkmcnt(1)
    v_mfma_f32_16x16x32_bf16 v[120:123], v[68:71], v[152:155], v[120:123]
    s_waitcnt lgkmcnt(0)
    v_mfma_f32_16x16x32_bf16 v[124:127], v[68:71], v[156:159], v[124:127]
    s_sub_u32 s25, s25, 1
    s_cmp_lg_u32 s25, 0
    s_cbranch_scc1 ss_cv5
    v_add_u32 v65, 512, v65
    s_mov_b32 s25, 8
ss_cv6:
    ds_read2_b32 v[68:69], v64 offset0:0 offset1:1
    ds_read2_b32 v[70:71], v64 offset0:2 offset1:3
    ds_read_b128 v[152:155], v65 offset:0
    ds_read_b128 v[156:159], v65 offset:512
    v_subrev_u32 v64, 64, v64
    v_subrev_u32 v65, 64, v65
    s_waitcnt lgkmcnt(1)
    v_mfma_f32_16x16x32_bf16 v[120:123], v[68:71], v[152:155], v[120:123]
    s_waitcnt lgkmcnt(0)
    v_mfma_f32_16x16x32_bf16 v[124:127], v[68:71], v[156:159], v[124:127]
    s_sub_u32 s25, s25, 1
    s_cmp_lg_u32 s25, 0
    s_cbranch_scc1 ss_cv6
    v_add_u32 v65, 512, v65
    s_mov_b32 s25, 8
ss_cv7:
    ds_read2_b32 v[68:69], v64 offset0:0 offset1:1
    ds_read2_b32 v[70:71], v64 offset0:2 offset1:3
    ds_read_b128 v[156:159], v65 offset:0
    v_subrev_u32 v64, 64, v64
    v_subrev_u32 v65, 64, v65
    s_waitcnt lgkmcnt(0)
    v_mfma_f32_16x16x32_bf16 v[124:127], v[68:71], v[156:159], v[124:127]
    s_sub_u32 s25, s25, 1
    s_cmp_lg_u32 s25, 0
    s_cbranch_scc1 ss_cv7
    v_add_u32 v65, 512, v65
    s_nop 3
    v_lshlrev_b32 v5, 6, v2
    v_lshl_add_u32 v5, v3, 4, v5
    v_add_u32 v5, v5, v4
    ds_write_b128 v5, v[96:99] offset:7424
    ds_write_b128 v5, v[100:103] offset:8448
    ds_write_b128 v5, v[104:107] offset:9472
    ds_write_b128 v5, v[108:111] offset:10496
    ds_write_b128 v5, v[112:115] offset:11520
    ds_write_b128 v5, v[116:119] offset:12544
    ds_write_b128 v5, v[120:123] offset:13568
    ds_write_b128 v5, v[124:127] offset:14592
    s_mov_b32 s12, s74
    s_mov_b32 s13, s75
    s_mov_b32 s14, 1152
    s_mov_b32 s15, 0x20000
    s_lshl_b32 s23, s20, 1
    buffer_load_dwordx2 v[24:25], off, s[12:15], s23
    s_waitcnt vmcnt(0) lgkmcnt(0)
    s_barrier
    v_lshlrev_b32 v26, 16, v24
    v_and_b32 v27, 0xffff0000, v24
    v_lshlrev_b32 v28, 16, v25
    v_and_b32 v29, 0xffff0000, v25
    v_lshlrev_b32 v5, 5, v0
    ds_read_b128 v[64:67], v5 offset:7424
    ds_read_b128 v[68:71], v5 offset:7440
    ds_read_b128 v[72:75], v5 offset:23808
    ds_read_b128 v[76:79], v5 offset:23824
    ds_read_b128 v[80:83], v5 offset:40192
    ds_read_b128 v[84:87], v5 offset:40208
    ds_read_b128 v[88:91], v5 offset:56576
    ds_read_b128 v[92:95], v5 offset:56592
    s_waitcnt lgkmcnt(0)
    v_mul_u32_u24 v5, 18432, v0
    s_lshl_b32 s22, s20, 1
    s_add_u32 s22, s22, 1152
    v_lshlrev_b32 v6, 16, v8
    v_fmac_f32 v64, v6, v26
    v_and_b32 v6, 0xffff0000, v8
    v_fmac_f32 v72, v6, v27
    v_lshlrev_b32 v6, 16, v9
    v_fmac_f32 v80, v6, v28
    v_and_b32 v6, 0xffff0000, v9
    v_fmac_f32 v88, v6, v29
    v_cvt_pk_bf16_f32 v8, v64, v72
    v_cvt_pk_bf16_f32 v9, v80, v88
    s_add_u32 s23, s22, 0
    buffer_store_dwordx2 v[8:9], v5, s[16:19], s23 offen
    v_lshlrev_b32 v6, 16, v10
    v_fmac_f32 v65, v6, v26
    v_and_b32 v6, 0xffff0000, v10
    v_fmac_f32 v73, v6, v27
    v_lshlrev_b32 v6, 16, v11
    v_fmac_f32 v81, v6, v28
    v_and_b32 v6, 0xffff0000, v11
    v_fmac_f32 v89, v6, v29
    v_cvt_pk_bf16_f32 v10, v65, v73
    v_cvt_pk_bf16_f32 v11, v81, v89
    s_add_u32 s23, s22, 2304
    buffer_store_dwordx2 v[10:11], v5, s[16:19], s23 offen
    v_lshlrev_b32 v6, 16, v12
    v_fmac_f32 v66, v6, v26
    v_and_b32 v6, 0xffff0000, v12
    v_fmac_f32 v74, v6, v27
    v_lshlrev_b32 v6, 16, v13
    v_fmac_f32 v82, v6, v28
    v_and_b32 v6, 0xffff0000, v13
    v_fmac_f32 v90, v6, v29
    v_cvt_pk_bf16_f32 v12, v66, v74
    v_cvt_pk_bf16_f32 v13, v82, v90
    s_add_u32 s23, s22, 4608
    buffer_store_dwordx2 v[12:13], v5, s[16:19], s23 offen
    v_lshlrev_b32 v6, 16, v14
    v_fmac_f32 v67, v6, v26
    v_and_b32 v6, 0xffff0000, v14
    v_fmac_f32 v75, v6, v27
    v_lshlrev_b32 v6, 16, v15
    v_fmac_f32 v83, v6, v28
    v_and_b32 v6, 0xffff0000, v15
    v_fmac_f32 v91, v6, v29
    v_cvt_pk_bf16_f32 v14, v67, v75
    v_cvt_pk_bf16_f32 v15, v83, v91
    s_add_u32 s23, s22, 6912
    buffer_store_dwordx2 v[14:15], v5, s[16:19], s23 offen
    v_lshlrev_b32 v6, 16, v16
    v_fmac_f32 v68, v6, v26
    v_and_b32 v6, 0xffff0000, v16
    v_fmac_f32 v76, v6, v27
    v_lshlrev_b32 v6, 16, v17
    v_fmac_f32 v84, v6, v28
    v_and_b32 v6, 0xffff0000, v17
    v_fmac_f32 v92, v6, v29
    v_cvt_pk_bf16_f32 v16, v68, v76
    v_cvt_pk_bf16_f32 v17, v84, v92
    s_add_u32 s23, s22, 9216
    buffer_store_dwordx2 v[16:17], v5, s[16:19], s23 offen
    v_lshlrev_b32 v6, 16, v18
    v_fmac_f32 v69, v6, v26
    v_and_b32 v6, 0xffff0000, v18
    v_fmac_f32 v77, v6, v27
    v_lshlrev_b32 v6, 16, v19
    v_fmac_f32 v85, v6, v28
    v_and_b32 v6, 0xffff0000, v19
    v_fmac_f32 v93, v6, v29
    v_cvt_pk_bf16_f32 v18, v69, v77
    v_cvt_pk_bf16_f32 v19, v85, v93
    s_add_u32 s23, s22, 11520
    buffer_store_dwordx2 v[18:19], v5, s[16:19], s23 offen
    v_lshlrev_b32 v6, 16, v20
    v_fmac_f32 v70, v6, v26
    v_and_b32 v6, 0xffff0000, v20
    v_fmac_f32 v78, v6, v27
    v_lshlrev_b32 v6, 16, v21
    v_fmac_f32 v86, v6, v28
    v_and_b32 v6, 0xffff0000, v21
    v_fmac_f32 v94, v6, v29
    v_cvt_pk_bf16_f32 v20, v70, v78
    v_cvt_pk_bf16_f32 v21, v86, v94
    s_add_u32 s23, s22, 13824
    buffer_store_dwordx2 v[20:21], v5, s[16:19], s23 offen
    v_lshlrev_b32 v6, 16, v22
    v_fmac_f32 v71, v6, v26
    v_and_b32 v6, 0xffff0000, v22
    v_fmac_f32 v79, v6, v27
    v_lshlrev_b32 v6, 16, v23
    v_fmac_f32 v87, v6, v28
    v_and_b32 v6, 0xffff0000, v23
    v_fmac_f32 v95, v6, v29
    v_cvt_pk_bf16_f32 v22, v71, v79
    v_cvt_pk_bf16_f32 v23, v87, v95
    s_add_u32 s23, s22, 16128
    buffer_store_dwordx2 v[22:23], v5, s[16:19], s23 offen
    s_branch L_ssm_next
L_phase2:
    v_and_b32 v1, 63, v0
    v_min_u32 v1, 6, v1
    v_lshlrev_b32 v2, 2, v1
    s_cmp_lg_u32 s32, 0
    v_mov_b32 v251, 163832
    s_cbranch_scc1 sw9
    buffer_load_dword v3, v2, s[96:99], 0 offen offset:32 sc1
    v_mov_b32 v4, 32
    s_waitcnt vmcnt(0)
    v_cmp_lt_u32 vcc, v3, v4
    s_nop 0
    s_ff1_i32_b64 s40, vcc
    v_mov_b32 v250, s40
    ds_write_b32 v251, v250
    s_waitcnt lgkmcnt(0)
sw9:
    s_barrier
    ds_read_b32 v252, v251
    s_waitcnt lgkmcnt(0)
    v_readfirstlane_b32 s33, v252
    s_barrier
    s_nop 1
    s_cmp_lt_u32 s33, 7
    s_cbranch_scc1 L_pool
    s_mov_b32 s88, 4194304
gn10:
    s_cmp_lg_u32 s95, 0
    s_cbranch_scc1 gn10x
    buffer_load_dword v250, off, s[96:99], 0 offset:64 sc1
    s_sub_u32 s88, s88, 1
    s_cbranch_scc1 gn10x
    s_waitcnt vmcnt(0)
    v_readfirstlane_b32 s95, v250
    s_nop 1
    s_branch gn10
gn10x:
    s_mov_b32 s40, 524288
mc2_w:
    buffer_load_dword v250, off, s[96:99], 0 offset:140 sc1
    s_waitcnt vmcnt(0)
    v_readfirstlane_b32 s41, v250
    s_nop 0
    s_cmp_lg_u32 s41, 0
    s_cbranch_scc1 mc2_known
    s_sub_u32 s40, s40, 1
    s_cbranch_scc1 mc2_force
    s_sleep 2
    s_branch mc2_w
mc2_force:
    v_mov_b32 v250, 2
    v_mov_b32 v251, 0
    s_mov_b64 exec, 1
    buffer_atomic_cmpswap v[250:251], off, s[96:99], 0 offset:140
    s_mov_b64 exec, -1
    s_waitcnt vmcnt(0)
    s_mov_b32 s40, 524288
    s_branch mc2_w
mc2_known:
    s_cmp_eq_u32 s41, 1
    s_cbranch_scc1 L_phase2b
    s_mov_b32 s37, 208
    v_mov_b32 v250, 1
    v_mov_b32 v251, 163832
    v_cmp_eq_u32 vcc, 0, v0
    s_nop 0
    s_and_saveexec_b64 s[38:39], vcc
    s_cbranch_execz tk11
    buffer_atomic_add v250, off, s[96:99], s37 sc0
    s_waitcnt vmcnt(0)
    ds_write_b32 v251, v250
    s_waitcnt lgkmcnt(0)
tk11:
    s_mov_b64 exec, -1
    s_barrier
    ds_read_b32 v252, v251
    s_waitcnt lgkmcnt(0)
    v_readfirstlane_b32 s12, v252
    s_barrier
    s_nop 3
    s_cmp_lt_u32 s12, 32
    s_cbranch_scc1 L_chain_safe
L_phase2b:
    s_mov_b32 s8, s76
    s_mov_b32 s9, s77
    s_mov_b32 s10, 4718592
    s_mov_b32 s11, 0x20000
    s_sub_u32 s33, s3, 1
    s_and_b32 s33, s33, 7
    s_cmp_eq_u32 s33, 7
    s_cbranch_scc1 L_p2scan
L_p2take:
    s_lshl_b32 s35, s33, 2
    s_add_u32 s35, s35, 160
    s_mov_b32 s37, s35
    v_mov_b32 v250, 1
    v_mov_b32 v251, 163832
    v_cmp_eq_u32 vcc, 0, v0
    s_nop 0
    s_and_saveexec_b64 s[38:39], vcc
    s_cbranch_execz tk12
    buffer_atomic_add v250, off, s[96:99], s37 sc0
    s_waitcnt vmcnt(0)
    ds_write_b32 v251, v250
    s_waitcnt lgkmcnt(0)
tk12:
    s_mov_b64 exec, -1
    s_barrier
    ds_read_b32 v252, v251
    s_waitcnt lgkmcnt(0)
    v_readfirstlane_b32 s34, v252
    s_barrier
    s_nop 3
    s_cmp_lt_u32 s33, 4
    s_cselect_b32 s36, 4, 6
    s_cmp_lt_u32 s34, s36
    s_cbranch_scc1 L_att0
    s_sub_u32 s34, s34, s36
    s_cmp_lt_u32 s34, 18
    s_cbranch_scc1 L_op_start
L_p2scan:
    v_and_b32 v1, 63, v0
    v_min_u32 v1, 6, v1
    v_lshlrev_b32 v2, 2, v1
    s_cmp_lg_u32 s32, 0
    v_mov_b32 v251, 163832
    s_cbranch_scc1 sw13
    buffer_load_dword v3, v2, s[96:99], 0 offen offset:160 sc1
    v_mov_b32 v4, 24
    v_cmp_gt_u32 vcc, 4, v1
    s_nop 1
    v_cndmask_b32 v4, v4, 22, vcc
    s_waitcnt vmcnt(0)
    v_cmp_lt_u32 vcc, v3, v4
    s_nop 0
    s_ff1_i32_b64 s40, vcc
    v_mov_b32 v250, s40
    ds_write_b32 v251, v250
    s_waitcnt lgkmcnt(0)
sw13:
    s_barrier
    ds_read_b32 v252, v251
    s_waitcnt lgkmcnt(0)
    v_readfirstlane_b32 s33, v252
    s_barrier
    s_nop 1
    s_cmp_lt_u32 s33, 7
    s_cbranch_scc1 L_p2take
    s_branch L_done
L_att0:
    s_mul_i32 s36, s34, 7
    s_mul_i32 s37, s34, 3
    s_add_u32 s37, s37, 12
    s_cmp_lt_u32 s34, 4
    s_cselect_b32 s34, s36, s37
    s_add_u32 s34, s34, s33
    s_cmp_ge_u32 s34, 32
    s_cbranch_scc1 L_done
L_att_next:
    s_lshr_b32 s16, s34, 3
    s_and_b32 s17, s34, 7
    s_lshl_b32 s17, s17, 2
    s_add_u32 s17, s17, s32
    s_lshr_b32 s36, s17, 1
    s_lshl_b32 s36, s36, 8
    s_add_u32 s36, s36, 125829120
    s_mul_i32 s37, s16, 43
    s_lshr_b32 s37, s37, 8
    s_mul_i32 s41, s37, 6
    s_sub_u32 s41, s16, s41
    v_and_b32 v1, 63, v0
    v_mul_u32_u24 v2, 6, v1
    v_add_u32 v2, s41, v2
    v_mov_b32 v4, s37
    s_and_b32 s41, s16, 7
    s_add_u32 s41, s41, 12
    s_lshr_b32 s37, s16, 3
    v_mov_b32 v5, s41
    v_mov_b32 v6, s37
    v_cmp_lt_u32 vcc, 1, v1
    s_nop 1
    v_cndmask_b32 v2, v2, v5, vcc
    v_cndmask_b32 v4, v4, v6, vcc
    v_lshlrev_b32 v2, 2, v2
    v_add3_u32 v4, v4, s95, 1
    s_mov_b32 s40, 4194304
L_aw1:
    buffer_load_dword v3, v2, s[4:7], s36 offen sc1
    s_sub_u32 s40, s40, 1
    s_cbranch_scc1 L_aw1_go
    s_waitcnt vmcnt(0)
    v_subrev_u32 v3, v4, v3
    v_cmp_lt_u32 vcc, 64, v3
    s_cbranch_vccz L_aw1_go
    s_sleep 4
    s_branch L_aw1
L_aw1_go:
    v_and_b32 v5, 63, v0
    v_lshlrev_b32 v1, 4, v5
    v_or_b32 v3, 128, v1
    v_lshrrev_b32 v4, 4, v5
    v_bfe_u32 v6, v5, 2, 2
    v_sub_u32 v4, v6, v4
    v_lshlrev_b32 v4, 3, v4
    v_and_b32 v6, 3, v5
    v_add_u32 v4, v4, v6
    v_mov_b32 v6, 0xf149f2ca
    s_mov_b32 s22, 0x3e0293ee
    s_lshl_b32 s18, s16, 5
    s_add_u32 s18, s18, s17
    s_lshl_b32 s19, s18, 13
    s_add_u32 s20, s19, 33554432
    buffer_load_dwordx4 v[8:11], v1, s[4:7], s20 offen offset:0 sc1
    s_add_u32 s20, s19, 33554432
    buffer_load_dwordx4 v[12:15], v1, s[4:7], s20 offen offset:1024 sc1
    s_add_u32 s20, s19, 33554432
    buffer_load_dwordx4 v[16:19], v1, s[4:7], s20 offen offset:2048 sc1
    s_add_u32 s20, s19, 33554432
    buffer_load_dwordx4 v[20:23], v1, s[4:7], s20 offen offset:3072 sc1
    s_add_u32 s20, s19, 33558528
    buffer_load_dwordx4 v[24:27], v1, s[4:7], s20 offen offset:0 sc1
    s_add_u32 s20, s19, 33558528
    buffer_load_dwordx4 v[28:31], v1, s[4:7], s20 offen offset:1024 sc1
    s_add_u32 s20, s19, 33558528
    buffer_load_dwordx4 v[32:35], v1, s[4:7], s20 offen offset:2048 sc1
    s_add_u32 s20, s19, 33558528
    buffer_load_dwordx4 v[36:39], v1, s[4:7], s20 offen offset:3072 sc1
    s_lshl_b32 s21, s18, 14
    s_add_u32 s20, s21, 0
    buffer_load_dwordx4 v[40:43], v1, s[4:7], s20 offen offset:0 sc1
    s_add_u32 s20, s21, 4096
    buffer_load_dwordx4 v[44:47], v1, s[4:7], s20 offen offset:0 sc1
    s_add_u32 s20, s21, 8192
    buffer_load_dwordx4 v[48:51], v1, s[4:7], s20 offen offset:0 sc1
    s_add_u32 s20, s21, 12288
    buffer_load_dwordx4 v[52:55], v1, s[4:7], s20 offen offset:0 sc1
    s_add_u32 s20, s21, 0
    buffer_load_dwordx4 v[56:59], v1, s[4:7], s20 offen offset:1024 sc1
    s_add_u32 s20, s21, 4096
    buffer_load_dwordx4 v[60:63], v1, s[4:7], s20 offen offset:1024 sc1
    s_add_u32 s20, s21, 8192
    buffer_load_dwordx4 v[64:67], v1, s[4:7], s20 offen offset:1024 sc1
    s_add_u32 s20, s21, 12288
    buffer_load_dwordx4 v[68:71], v1, s[4:7], s20 offen offset:1024 sc1
    s_add_u32 s20, s21, 0
    buffer_load_dwordx4 v[88:91], v1, s[4:7], s20 offen offset:2048 sc1
    s_add_u32 s20, s21, 4096
    buffer_load_dwordx4 v[92:95], v1, s[4:7], s20 offen offset:2048 sc1
    s_add_u32 s20, s21, 8192
    buffer_load_dwordx4 v[96:99], v1, s[4:7], s20 offen offset:2048 sc1
    s_add_u32 s20, s21, 12288
    buffer_load_dwordx4 v[100:103], v1, s[4:7], s20 offen offset:2048 sc1
    s_add_u32 s20, s21, 0
    buffer_load_dwordx4 v[104:107], v1, s[4:7], s20 offen offset:3072 sc1
    s_add_u32 s20, s21, 4096
    buffer_load_dwordx4 v[108:111], v1, s[4:7], s20 offen offset:3072 sc1
    s_add_u32 s20, s21, 8192
    buffer_load_dwordx4 v[112:115], v1, s[4:7], s20 offen offset:3072 sc1
    s_add_u32 s20, s21, 12288
    buffer_load_dwordx4 v[116:119], v1, s[4:7], s20 offen offset:3072 sc1
    v_mov_b32 v172, 0x3f803f80
    v_mov_b32 v173, 0x3f803f80
    v_mov_b32 v174, 0x3f803f80
    v_mov_b32 v175, 0x3f803f80
    v_mov_b32 v176, 0x3f003f00
    v_mov_b32 v177, 0x3f003f00
    s_waitcnt vmcnt(8)
    v_mfma_f32_16x16x32_bf16 v[136:139], v[40:43], v[8:11], 0
    v_mfma_f32_16x16x32_bf16 v[140:143], v[56:59], v[8:11], 0
    v_mfma_f32_16x16x32_bf16 v[148:151], v[40:43], v[24:27], 0
    v_mfma_f32_16x16x32_bf16 v[152:155], v[56:59], v[24:27], 0
    v_mfma_f32_16x16x32_bf16 v[136:139], v[44:47], v[12:15], v[136:139]
    v_mfma_f32_16x16x32_bf16 v[140:143], v[60:63], v[12:15], v[140:143]
    v_mfma_f32_16x16x32_bf16 v[148:151], v[44:47], v[28:31], v[148:151]
    v_mfma_f32_16x16x32_bf16 v[152:155], v[60:63], v[28:31], v[152:155]
    v_mfma_f32_16x16x32_bf16 v[136:139], v[48:51], v[16:19], v[136:139]
    v_mfma_f32_16x16x32_bf16 v[140:143], v[64:67], v[16:19], v[140:143]
    v_mfma_f32_16x16x32_bf16 v[148:151], v[48:51], v[32:35], v[148:151]
    v_mfma_f32_16x16x32_bf16 v[152:155], v[64:67], v[32:35], v[152:155]
    v_mfma_f32_16x16x32_bf16 v[136:139], v[52:55], v[20:23], v[136:139]
    v_mfma_f32_16x16x32_bf16 v[140:143], v[68:71], v[20:23], v[140:143]
    v_mfma_f32_16x16x32_bf16 v[148:151], v[52:55], v[36:39], v[148:151]
    v_mfma_f32_16x16x32_bf16 v[152:155], v[68:71], v[36:39], v[152:155]
    v_cmp_le_i32 vcc, 0, v4
    s_nop 1
    v_cndmask_b32 v136, v6, v136, vcc
    v_cmp_le_i32 vcc, 1, v4
    s_nop 1
    v_cndmask_b32 v137, v6, v137, vcc
    v_cmp_le_i32 vcc, 2, v4
    s_nop 1
    v_cndmask_b32 v138, v6, v138, vcc
    v_cmp_le_i32 vcc, 3, v4
    s_nop 1
    v_cndmask_b32 v139, v6, v139, vcc
    v_cmp_le_i32 vcc, 4, v4
    s_nop 1
    v_cndmask_b32 v140, v6, v140, vcc
    v_cmp_le_i32 vcc, 5, v4
    s_nop 1
    v_cndmask_b32 v141, v6, v141, vcc
    v_cmp_le_i32 vcc, 6, v4
    s_nop 1
    v_cndmask_b32 v142, v6, v142, vcc
    v_cmp_le_i32 vcc, 7, v4
    s_nop 1
    v_cndmask_b32 v143, v6, v143, vcc
    v_cmp_le_i32 vcc, -4, v4
    s_nop 1
    v_cndmask_b32 v148, v6, v148, vcc
    v_cmp_le_i32 vcc, -3, v4
    s_nop 1
    v_cndmask_b32 v149, v6, v149, vcc
    v_cmp_le_i32 vcc, -2, v4
    s_nop 1
    v_cndmask_b32 v150, v6, v150, vcc
    v_cmp_le_i32 vcc, -1, v4
    s_nop 1
    v_cndmask_b32 v151, v6, v151, vcc
    v_cmp_le_i32 vcc, 0, v4
    s_nop 1
    v_cndmask_b32 v152, v6, v152, vcc
    v_cmp_le_i32 vcc, 1, v4
    s_nop 1
    v_cndmask_b32 v153, v6, v153, vcc
    v_cmp_le_i32 vcc, 2, v4
    s_nop 1
    v_cndmask_b32 v154, v6, v154, vcc
    v_cmp_le_i32 vcc, 3, v4
    s_nop 1
    v_cndmask_b32 v155, v6, v155, vcc
    s_nop 1
    s_mov_b32 s88, 65536
cw14:
    buffer_load_dword v199, off, s[4:7], s36 offset:128 sc1
    s_waitcnt vmcnt(0)
    v_readfirstlane_b32 s42, v199
    s_nop 0
    s_sub_u32 s42, s42, s95
    s_cmp_gt_u32 s42, 64
    s_cselect_b32 s42, 0, s42
    s_add_u32 s42, s42, 2
    s_cmp_ge_u32 s42, s16
    s_cbranch_scc1 cw14x
    s_sub_u32 s88, s88, 1
    s_cbranch_scc1 cw14x
    s_sub_u32 s42, s16, s42
    s_min_u32 s42, s42, 6
cw14s:
    s_sleep 24
    s_sub_u32 s42, s42, 1
    s_cmp_lg_u32 s42, 0
    s_cbranch_scc1 cw14s
    s_branch cw14
cw14x:
    s_and_b32 s37, s16, 1
    s_lshl_b32 s37, s37, 2
    s_add_u32 s37, s37, s36
    s_add_u32 s37, s37, 128
    s_add_u32 s41, s16, s95
    s_add_u32 s41, s41, 1
    s_lshl_b32 s42, s17, 7
    s_add_u32 s42, s42, 125845504
    s_cmp_ge_u32 s16, 62
    s_cselect_b32 s37, s42, s37
    s_cselect_b32 s42, 12, 8
    v_lshlrev_b32 v198, 2, v0
    v_and_b32 v198, s42, v198
    s_mov_b32 s40, 4194304
L_aw2:
    buffer_load_dword v199, v198, s[4:7], s37 offen sc1
    s_sub_u32 s40, s40, 1
    s_cbranch_scc1 L_aw2_go
    s_waitcnt vmcnt(0)
    v_subrev_u32 v199, s41, v199
    v_cmp_lt_u32 vcc, 64, v199
    s_cbranch_vccz L_aw2_go
    s_sleep 1
    s_branch L_aw2
L_aw2_go:
    s_mov_b32 s21, 4096
at_again:
    s_lshl_b32 s20, s18, 12
    s_add_u32 s20, s20, 71303168
    buffer_load_dwordx4 v[72:75], v3, s[4:7], s20 offen offset:0 sc1
    buffer_load_dwordx4 v[76:79], v3, s[4:7], s20 offen offset:1024 sc1
    buffer_load_dwordx4 v[80:83], v3, s[4:7], s20 offen offset:2048 sc1
    buffer_load_dwordx4 v[84:87], v3, s[4:7], s20 offen offset:3072 sc1
    s_lshl_b32 s20, s18, 12
    s_add_u32 s20, s20, 80740352
    buffer_load_dwordx4 v[120:123], v1, s[4:7], s20 offen offset:0 sc1
    buffer_load_dwordx4 v[124:127], v1, s[4:7], s20 offen offset:1024 sc1
    buffer_load_dwordx4 v[128:131], v1, s[4:7], s20 offen offset:2048 sc1
    buffer_load_dwordx4 v[132:135], v1, s[4:7], s20 offen offset:3072 sc1
    s_waitcnt vmcnt(4)
    v_mfma_f32_16x16x32_bf16 v[144:147], v[72:75], v[8:11], 0
    v_mfma_f32_16x16x32_bf16 v[156:159], v[72:75], v[24:27], 0
    v_mfma_f32_16x16x32_bf16 v[144:147], v[76:79], v[12:15], v[144:147]
    v_mfma_f32_16x16x32_bf16 v[156:159], v[76:79], v[28:31], v[156:159]
    v_mfma_f32_16x16x32_bf16 v[144:147], v[80:83], v[16:19], v[144:147]
    v_mfma_f32_16x16x32_bf16 v[156:159], v[80:83], v[32:35], v[156:159]
    v_mfma_f32_16x16x32_bf16 v[144:147], v[84:87], v[20:23], v[144:147]
    v_mfma_f32_16x16x32_bf16 v[156:159], v[84:87], v[36:39], v[156:159]
    v_max3_u32 v196, v72, v76, v80
    s_waitcnt vmcnt(0)
    v_max3_u32 v196, v196, v84, v120
    v_max3_u32 v196, v196, v124, v128
    v_max_u32 v196, v196, v132
    v_cmp_eq_u32 vcc, -1, v196
    s_sub_u32 s21, s21, 1
    s_nop 3
    s_cbranch_scc1 at_ok
    s_cbranch_vccnz at_again
at_ok:
    v_max3_f32 v196, v136, v137, v138
    v_max3_f32 v197, v139, v140, v141
    v_max3_f32 v196, v196, v142, v143
    v_max3_f32 v197, v197, v144, v145
    v_max3_f32 v196, v196, v146, v147
    v_max_f32 v196, v196, v197
    v_mov_b32 v197, v196
    s_nop 1
    v_permlane32_swap_b32 v196, v197
    v_max_f32 v196, v196, v197
    v_mov_b32 v197, v196
    s_nop 1
    v_permlane16_swap_b32 v196, v197
    v_max_f32 v196, v196, v197
    v_mul_f32 v196, s22, v196
    v_sub_f32 v196, 0, v196
    v_fma_f32 v136, v136, s22, v196
    v_fma_f32 v137, v137, s22, v196
    v_fma_f32 v138, v138, s22, v196
    v_fma_f32 v139, v139, s22, v196
    v_fma_f32 v140, v140, s22, v196
    v_fma_f32 v141, v141, s22, v196
    v_fma_f32 v142, v142, s22, v196
    v_fma_f32 v143, v143, s22, v196
    v_fma_f32 v144, v144, s22, v196
    v_fma_f32 v145, v145, s22, v196
    v_fma_f32 v146, v146, s22, v196
    v_fma_f32 v147, v147, s22, v196
    v_exp_f32 v136, v136
    v_exp_f32 v137, v137
    v_exp_f32 v138, v138
    v_exp_f32 v139, v139
    v_exp_f32 v140, v140
    v_exp_f32 v141, v141
    v_exp_f32 v142, v142
    v_exp_f32 v143, v143
    v_exp_f32 v144, v144
    v_exp_f32 v145, v145
    v_exp_f32 v146, v146
    v_exp_f32 v147, v147
    v_cvt_pk_bf16_f32 v160, v136, v137
    v_cvt_pk_bf16_f32 v161, v138, v139
    v_cvt_pk_bf16_f32 v162, v140, v141
    v_cvt_pk_bf16_f32 v163, v142, v143
    v_cvt_pk_bf16_f32 v164, v144, v145
    v_cvt_pk_bf16_f32 v165, v146, v147
    v_max3_f32 v196, v148, v149, v150
    v_max3_f32 v197, v151, v152, v153
    v_max3_f32 v196, v196, v154, v155
    v_max3_f32 v197, v197, v156, v157
    v_max3_f32 v196, v196, v158, v159
    v_max_f32 v196, v196, v197
    v_mov_b32 v197, v196
    s_nop 1
    v_permlane32_swap_b32 v196, v197
    v_max_f32 v196, v196, v197
    v_mov_b32 v197, v196
    s_nop 1
    v_permlane16_swap_b32 v196, v197
    v_max_f32 v196, v196, v197
    v_mul_f32 v196, s22, v196
    v_sub_f32 v196, 0, v196
    v_fma_f32 v148, v148, s22, v196
    v_fma_f32 v149, v149, s22, v196
    v_fma_f32 v150, v150, s22, v196
    v_fma_f32 v151, v151, s22, v196
    v_fma_f32 v152, v152, s22, v196
    v_fma_f32 v153, v153, s22, v196
    v_fma_f32 v154, v154, s22, v196
    v_fma_f32 v155, v155, s22, v196
    v_fma_f32 v156, v156, s22, v196
    v_fma_f32 v157, v157, s22, v196
    v_fma_f32 v158, v158, s22, v196
    v_fma_f32 v159, v159, s22, v196
    v_exp_f32 v148, v148
    v_exp_f32 v149, v149
    v_exp_f32 v150, v150
    v_exp_f32 v151, v151
    v_exp_f32 v152, v152
    v_exp_f32 v153, v153
    v_exp_f32 v154, v154
    v_exp_f32 v155, v155
    v_exp_f32 v156, v156
    v_exp_f32 v157, v157
    v_exp_f32 v158, v158
    v_exp_f32 v159, v159
    v_cvt_pk_bf16_f32 v166, v148, v149
    v_cvt_pk_bf16_f32 v167, v150, v151
    v_cvt_pk_bf16_f32 v168, v152, v153
    v_cvt_pk_bf16_f32 v169, v154, v155
    v_cvt_pk_bf16_f32 v170, v156, v157
    v_cvt_pk_bf16_f32 v171, v158, v159
    v_mfma_f32_16x16x32_bf16 v[180:183], v[172:175], v[160:163], 0
    v_mfma_f32_16x16x32_bf16 v[184:187], v[172:175], v[166:169], 0
    v_mfma_f32_16x16x16_bf16 v[180:183], v[176:177], v[164:165], v[180:183]
    v_mfma_f32_16x16x16_bf16 v[184:187], v[176:177], v[170:171], v[184:187]
    s_nop 3
    v_rcp_f32 v180, v180
    s_nop 2
    v_rcp_f32 v184, v184
    s_waitcnt vmcnt(0)
    s_lshl_b32 s18, s16, 18
    s_lshl_b32 s19, s17, 12
    s_add_u32 s18, s18, s19
    s_add_u32 s18, s18, 50331648
    s_add_u32 s19, s18, 131072
    v_mfma_f32_16x16x32_bf16 v[8:11], v[88:91], v[160:163], 0
    v_mfma_f32_16x16x32_bf16 v[12:15], v[104:107], v[160:163], 0
    v_mfma_f32_16x16x32_bf16 v[16:19], v[88:91], v[166:169], 0
    v_mfma_f32_16x16x32_bf16 v[20:23], v[104:107], v[166:169], 0
    v_mfma_f32_16x16x32_bf16 v[24:27], v[92:95], v[160:163], 0
    v_mfma_f32_16x16x32_bf16 v[28:31], v[108:111], v[160:163], 0
    v_mfma_f32_16x16x32_bf16 v[32:35], v[92:95], v[166:169], 0
    v_mfma_f32_16x16x32_bf16 v[36:39], v[108:111], v[166:169], 0
    v_mfma_f32_16x16x32_bf16 v[40:43], v[96:99], v[160:163], 0
    v_mfma_f32_16x16x32_bf16 v[44:47], v[112:115], v[160:163], 0
    v_mfma_f32_16x16x32_bf16 v[48:51], v[96:99], v[166:169], 0
    v_mfma_f32_16x16x32_bf16 v[52:55], v[112:115], v[166:169], 0
    v_mfma_f32_16x16x32_bf16 v[56:59], v[100:103], v[160:163], 0
    v_mfma_f32_16x16x32_bf16 v[60:63], v[116:119], v[160:163], 0
    v_mfma_f32_16x16x32_bf16 v[64:67], v[100:103], v[166:169], 0
    v_mfma_f32_16x16x32_bf16 v[68:71], v[116:119], v[166:169], 0
    v_mfma_f32_16x16x16_bf16 v[8:11], v[120:121], v[164:165], v[8:11]
    v_mfma_f32_16x16x16_bf16 v[12:15], v[122:123], v[164:165], v[12:15]
    v_mfma_f32_16x16x16_bf16 v[16:19], v[120:121], v[170:171], v[16:19]
    v_mfma_f32_16x16x16_bf16 v[20:23], v[122:123], v[170:171], v[20:23]
    v_mfma_f32_16x16x16_bf16 v[24:27], v[124:125], v[164:165], v[24:27]
    v_mfma_f32_16x16x16_bf16 v[28:31], v[126:127], v[164:165], v[28:31]
    v_mfma_f32_16x16x16_bf16 v[32:35], v[124:125], v[170:171], v[32:35]
    v_mfma_f32_16x16x16_bf16 v[36:39], v[126:127], v[170:171], v[36:39]
    v_mfma_f32_16x16x16_bf16 v[40:43], v[128:129], v[164:165], v[40:43]
    v_mfma_f32_16x16x16_bf16 v[44:47], v[130:131], v[164:165], v[44:47]
    v_mfma_f32_16x16x16_bf16 v[48:51], v[128:129], v[170:171], v[48:51]
    v_mfma_f32_16x16x16_bf16 v[52:55], v[130:131], v[170:171], v[52:55]
    v_mfma_f32_16x16x16_bf16 v[56:59], v[132:133], v[164:165], v[56:59]
    v_mfma_f32_16x16x16_bf16 v[60:63], v[134:135], v[164:165], v[60:63]
    v_mfma_f32_16x16x16_bf16 v[64:67], v[132:133], v[170:171], v[64:67]
    v_mfma_f32_16x16x16_bf16 v[68:71], v[134:135], v[170:171], v[68:71]
    v_mul_f32 v8, v8, v180
    v_mul_f32 v12, v12, v180
    v_mul_f32 v9, v9, v180
    v_mul_f32 v13, v13, v180
    v_mul_f32 v10, v10, v180
    v_mul_f32 v14, v14, v180
    v_mul_f32 v11, v11, v180
    v_mul_f32 v15, v15, v180
    v_cvt_pk_bf16_f32 v8, v8, v9
    v_cvt_pk_bf16_f32 v9, v10, v11
    v_cvt_pk_bf16_f32 v10, v12, v13
    v_cvt_pk_bf16_f32 v11, v14, v15
    buffer_store_dwordx4 v[8:11], v1, s[4:7], s18 offen offset:0 sc1
    v_mul_f32 v16, v16, v184
    v_mul_f32 v20, v20, v184
    v_mul_f32 v17, v17, v184
    v_mul_f32 v21, v21, v184
    v_mul_f32 v18, v18, v184
    v_mul_f32 v22, v22, v184
    v_mul_f32 v19, v19, v184
    v_mul_f32 v23, v23, v184
    v_cvt_pk_bf16_f32 v16, v16, v17
    v_cvt_pk_bf16_f32 v17, v18, v19
    v_cvt_pk_bf16_f32 v18, v20, v21
    v_cvt_pk_bf16_f32 v19, v22, v23
    buffer_store_dwordx4 v[16:19], v1, s[4:7], s19 offen offset:0 sc1
    v_mul_f32 v24, v24, v180
    v_mul_f32 v28, v28, v180
    v_mul_f32 v25, v25, v180
    v_mul_f32 v29, v29, v180
    v_mul_f32 v26, v26, v180
    v_mul_f32 v30, v30, v180
    v_mul_f32 v27, v27, v180
    v_mul_f32 v31, v31, v180
    v_cvt_pk_bf16_f32 v24, v24, v25
    v_cvt_pk_bf16_f32 v25, v26, v27
    v_cvt_pk_bf16_f32 v26, v28, v29
    v_cvt_pk_bf16_f32 v27, v30, v31
    buffer_store_dwordx4 v[24:27], v1, s[4:7], s18 offen offset:1024 sc1
    v_mul_f32 v32, v32, v184
    v_mul_f32 v36, v36, v184
    v_mul_f32 v33, v33, v184
    v_mul_f32 v37, v37, v184
    v_mul_f32 v34, v34, v184
    v_mul_f32 v38, v38, v184
    v_mul_f32 v35, v35, v184
    v_mul_f32 v39, v39, v184
    v_cvt_pk_bf16_f32 v32, v32, v33
    v_cvt_pk_bf16_f32 v33, v34, v35
    v_cvt_pk_bf16_f32 v34, v36, v37
    v_cvt_pk_bf16_f32 v35, v38, v39
    buffer_store_dwordx4 v[32:35], v1, s[4:7], s19 offen offset:1024 sc1
    v_mul_f32 v40, v40, v180
    v_mul_f32 v44, v44, v180
    v_mul_f32 v41, v41, v180
    v_mul_f32 v45, v45, v180
    v_mul_f32 v42, v42, v180
    v_mul_f32 v46, v46, v180
    v_mul_f32 v43, v43, v180
    v_mul_f32 v47, v47, v180
    v_cvt_pk_bf16_f32 v40, v40, v41
    v_cvt_pk_bf16_f32 v41, v42, v43
    v_cvt_pk_bf16_f32 v42, v44, v45
    v_cvt_pk_bf16_f32 v43, v46, v47
    buffer_store_dwordx4 v[40:43], v1, s[4:7], s18 offen offset:2048 sc1
    v_mul_f32 v48, v48, v184
    v_mul_f32 v52, v52, v184
    v_mul_f32 v49, v49, v184
    v_mul_f32 v53, v53, v184
    v_mul_f32 v50, v50, v184
    v_mul_f32 v54, v54, v184
    v_mul_f32 v51, v51, v184
    v_mul_f32 v55, v55, v184
    v_cvt_pk_bf16_f32 v48, v48, v49
    v_cvt_pk_bf16_f32 v49, v50, v51
    v_cvt_pk_bf16_f32 v50, v52, v53
    v_cvt_pk_bf16_f32 v51, v54, v55
    buffer_store_dwordx4 v[48:51], v1, s[4:7], s19 offen offset:2048 sc1
    v_mul_f32 v56, v56, v180
    v_mul_f32 v60, v60, v180
    v_mul_f32 v57, v57, v180
    v_mul_f32 v61, v61, v180
    v_mul_f32 v58, v58, v180
    v_mul_f32 v62, v62, v180
    v_mul_f32 v59, v59, v180
    v_mul_f32 v63, v63, v180
    v_cvt_pk_bf16_f32 v56, v56, v57
    v_cvt_pk_bf16_f32 v57, v58, v59
    v_cvt_pk_bf16_f32 v58, v60, v61
    v_cvt_pk_bf16_f32 v59, v62, v63
    buffer_store_dwordx4 v[56:59], v1, s[4:7], s18 offen offset:3072 sc1
    v_mul_f32 v64, v64, v184
    v_mul_f32 v68, v68, v184
    v_mul_f32 v65, v65, v184
    v_mul_f32 v69, v69, v184
    v_mul_f32 v66, v66, v184
    v_mul_f32 v70, v70, v184
    v_mul_f32 v67, v67, v184
    v_mul_f32 v71, v71, v184
    v_cvt_pk_bf16_f32 v64, v64, v65
    v_cvt_pk_bf16_f32 v65, v66, v67
    v_cvt_pk_bf16_f32 v66, v68, v69
    v_cvt_pk_bf16_f32 v67, v70, v71
    buffer_store_dwordx4 v[64:67], v1, s[4:7], s19 offen offset:3072 sc1
    s_lshr_b32 s40, s34, 1
    s_lshl_b32 s40, s40, 7
    s_and_b32 s41, s17, 7
    s_lshl_b32 s41, s41, 2
    s_add_u32 s40, s40, s41
    s_add_u32 s40, s40, 125894656
    v_mov_b32 v250, s95
    s_cmp_ge_u32 s16, 62
    s_cbranch_scc1 L_afl
    s_waitcnt vmcnt(0)
L_afl:
    s_mov_b64 exec, 1
    buffer_store_dword v250, off, s[4:7], s40 sc1
    s_mov_b64 exec, -1
    s_add_u32 s34, s34, 32
    s_cmp_lt_u32 s34, 512
    s_cbranch_scc1 L_att_next
    s_branch L_done
L_op_start:
    s_mov_b32 s16, s33
    s_mov_b32 s33, s34
    v_and_b32 v2, 63, v0
    v_lshlrev_b32 v1, 4, v2
    v_lshrrev_b32 v5, 2, v2
    v_mul_u32_u24 v3, 1152, v5
    v_and_b32 v5, 3, v2
    v_lshl_add_u32 v3, v5, 4, v3
    s_lshl_b32 s21, s32, 12
    v_add_u32 v4, s21, v1
    s_mov_b64 s[12:13], s[58:59]
    s_mov_b32 s14, 4718592
    s_mov_b32 s15, 0x20000
    s_mul_i32 s19, s32, 1179648
    s_lshl_b32 s18, s33, 6
    s_add_u32 s19, s19, s18
    s_add_u32 s18, s19, 0
    s_add_u32 m0, s21, 0
    s_nop 0
    buffer_load_dwordx4 v3, s[12:15], s18 offen lds
    s_add_u32 m0, s21, 1024
    s_add_u32 s18, s18, 18432
    buffer_load_dwordx4 v3, s[12:15], s18 offen lds
    s_add_u32 m0, s21, 2048
    s_add_u32 s18, s18, 18432
    buffer_load_dwordx4 v3, s[12:15], s18 offen lds
    s_add_u32 m0, s21, 3072
    s_add_u32 s18, s18, 18432
    buffer_load_dwordx4 v3, s[12:15], s18 offen lds
    s_add_u32 s18, s19, 73728
    s_add_u32 m0, s21, 16384
    s_nop 0
    buffer_load_dwordx4 v3, s[12:15], s18 offen lds
    s_add_u32 m0, s21, 17408
    s_add_u32 s18, s18, 18432
    buffer_load_dwordx4 v3, s[12:15], s18 offen lds
    s_add_u32 m0, s21, 18432
    s_add_u32 s18, s18, 18432
    buffer_load_dwordx4 v3, s[12:15], s18 offen lds
    s_add_u32 m0, s21, 19456
    s_add_u32 s18, s18, 18432
    buffer_load_dwordx4 v3, s[12:15], s18 offen lds
    s_add_u32 s18, s19, 147456
    s_add_u32 m0, s21, 32768
    s_nop 0
    buffer_load_dwordx4 v3, s[12:15], s18 offen lds
    s_add_u32 m0, s21, 33792
    s_add_u32 s18, s18, 18432
    buffer_load_dwordx4 v3, s[12:15], s18 offen lds
    s_add_u32 m0, s21, 34816
    s_add_u32 s18, s18, 18432
    buffer_load_dwordx4 v3, s[12:15], s18 offen lds
    s_add_u32 m0, s21, 35840
    s_add_u32 s18, s18, 18432
    buffer_load_dwordx4 v3, s[12:15], s18 offen lds
    s_add_u32 s18, s19, 221184
    s_add_u32 m0, s21, 49152
    s_nop 0
    buffer_load_dwordx4 v3, s[12:15], s18 offen lds
    s_add_u32 m0, s21, 50176
    s_add_u32 s18, s18, 18432
    buffer_load_dwordx4 v3, s[12:15], s18 offen lds
    s_add_u32 m0, s21, 51200
    s_add_u32 s18, s18, 18432
    buffer_load_dwordx4 v3, s[12:15], s18 offen lds
    s_add_u32 m0, s21, 52224
    s_add_u32 s18, s18, 18432
    buffer_load_dwordx4 v3, s[12:15], s18 offen lds
    s_add_u32 s18, s19, 294912
    s_add_u32 m0, s21, 65536
    s_nop 0
    buffer_load_dwordx4 v3, s[12:15], s18 offen lds
    s_add_u32 m0, s21, 66560
    s_add_u32 s18, s18, 18432
    buffer_load_dwordx4 v3, s[12:15], s18 offen lds
    s_add_u32 m0, s21, 67584
    s_add_u32 s18, s18, 18432
    buffer_load_dwordx4 v3, s[12:15], s18 offen lds
    s_add_u32 m0, s21, 68608
    s_add_u32 s18, s18, 18432
    buffer_load_dwordx4 v3, s[12:15], s18 offen lds
    s_add_u32 s18, s19, 368640
    s_add_u32 m0, s21, 81920
    s_nop 0
    buffer_load_dwordx4 v3, s[12:15], s18 offen lds
    s_add_u32 m0, s21, 82944
    s_add_u32 s18, s18, 18432
    buffer_load_dwordx4 v3, s[12:15], s18 offen lds
    s_add_u32 m0, s21, 83968
    s_add_u32 s18, s18, 18432
    buffer_load_dwordx4 v3, s[12:15], s18 offen lds
    s_add_u32 m0, s21, 84992
    s_add_u32 s18, s18, 18432
    buffer_load_dwordx4 v3, s[12:15], s18 offen lds
    s_add_u32 s18, s19, 442368
    s_add_u32 m0, s21, 98304
    s_nop 0
    buffer_load_dwordx4 v3, s[12:15], s18 offen lds
    s_add_u32 m0, s21, 99328
    s_add_u32 s18, s18, 18432
    buffer_load_dwordx4 v3, s[12:15], s18 offen lds
    s_add_u32 m0, s21, 100352
    s_add_u32 s18, s18, 18432
    buffer_load_dwordx4 v3, s[12:15], s18 offen lds
    s_add_u32 m0, s21, 101376
    s_add_u32 s18, s18, 18432
    buffer_load_dwordx4 v3, s[12:15], s18 offen lds
    s_add_u32 s18, s19, 516096
    s_add_u32 m0, s21, 114688
    s_nop 0
    buffer_load_dwordx4 v3, s[12:15], s18 offen lds
    s_add_u32 m0, s21, 115712
    s_add_u32 s18, s18, 18432
    buffer_load_dwordx4 v3, s[12:15], s18 offen lds
    s_add_u32 m0, s21, 116736
    s_add_u32 s18, s18, 18432
    buffer_load_dwordx4 v3, s[12:15], s18 offen lds
    s_add_u32 m0, s21, 117760
    s_add_u32 s18, s18, 18432
    buffer_load_dwordx4 v3, s[12:15], s18 offen lds
    s_add_u32 s18, s19, 589824
    s_add_u32 m0, s21, 131072
    s_nop 0
    buffer_load_dwordx4 v3, s[12:15], s18 offen lds
    s_add_u32 m0, s21, 132096
    s_add_u32 s18, s18, 18432
    buffer_load_dwordx4 v3, s[12:15], s18 offen lds
    s_add_u32 m0, s21, 133120
    s_add_u32 s18, s18, 18432
    buffer_load_dwordx4 v3, s[12:15], s18 offen lds
    s_add_u32 m0, s21, 134144
    s_add_u32 s18, s18, 18432
    buffer_load_dwordx4 v3, s[12:15], s18 offen lds
    v_add_u32 v6, 0, v4
    v_xor_b32 v7, 32, v6
    s_waitcnt vmcnt(32)
    ds_read_b64_tr_b16 a[0:1], v6 offset:0
    ds_read_b64_tr_b16 a[2:3], v6 offset:1024
    ds_read_b64_tr_b16 a[4:5], v6 offset:8
    ds_read_b64_tr_b16 a[6:7], v6 offset:1032
    ds_read_b64_tr_b16 a[8:9], v6 offset:2048
    ds_read_b64_tr_b16 a[10:11], v6 offset:3072
    ds_read_b64_tr_b16 a[12:13], v6 offset:2056
    ds_read_b64_tr_b16 a[14:15], v6 offset:3080
    s_waitcnt lgkmcnt(0)
    s_add_u32 s18, s19, 663552
    s_add_u32 m0, s21, 0
    s_nop 0
    buffer_load_dwordx4 v3, s[12:15], s18 offen lds
    s_add_u32 m0, s21, 1024
    s_add_u32 s18, s18, 18432
    buffer_load_dwordx4 v3, s[12:15], s18 offen lds
    s_add_u32 m0, s21, 2048
    s_add_u32 s18, s18, 18432
    buffer_load_dwordx4 v3, s[12:15], s18 offen lds
    s_add_u32 m0, s21, 3072
    s_add_u32 s18, s18, 18432
    buffer_load_dwordx4 v3, s[12:15], s18 offen lds
    v_add_u32 v6, 16384, v4
    v_xor_b32 v7, 32, v6
    s_waitcnt vmcnt(32)
    ds_read_b64_tr_b16 a[16:17], v6 offset:0
    ds_read_b64_tr_b16 a[18:19], v6 offset:1024
    ds_read_b64_tr_b16 a[20:21], v6 offset:8
    ds_read_b64_tr_b16 a[22:23], v6 offset:1032
    ds_read_b64_tr_b16 a[24:25], v6 offset:2048
    ds_read_b64_tr_b16 a[26:27], v6 offset:3072
    ds_read_b64_tr_b16 a[28:29], v6 offset:2056
    ds_read_b64_tr_b16 a[30:31], v6 offset:3080
    s_waitcnt lgkmcnt(0)
    s_add_u32 s18, s19, 737280
    s_add_u32 m0, s21, 16384
    s_nop 0
    buffer_load_dwordx4 v3, s[12:15], s18 offen lds
    s_add_u32 m0, s21, 17408
    s_add_u32 s18, s18, 18432
    buffer_load_dwordx4 v3, s[12:15], s18 offen lds
    s_add_u32 m0, s21, 18432
    s_add_u32 s18, s18, 18432
    buffer_load_dwordx4 v3, s[12:15], s18 offen lds
    s_add_u32 m0, s21, 19456
    s_add_u32 s18, s18, 18432
    buffer_load_dwordx4 v3, s[12:15], s18 offen lds
    v_add_u32 v6, 32768, v4
    v_xor_b32 v7, 32, v6
    s_waitcnt vmcnt(32)
    ds_read_b64_tr_b16 a[32:33], v6 offset:0
    ds_read_b64_tr_b16 a[34:35], v6 offset:1024
    ds_read_b64_tr_b16 a[36:37], v6 offset:8
    ds_read_b64_tr_b16 a[38:39], v6 offset:1032
    ds_read_b64_tr_b16 a[40:41], v6 offset:2048
    ds_read_b64_tr_b16 a[42:43], v6 offset:3072
    ds_read_b64_tr_b16 a[44:45], v6 offset:2056
    ds_read_b64_tr_b16 a[46:47], v6 offset:3080
    s_waitcnt lgkmcnt(0)
    s_add_u32 s18, s19, 811008
    s_add_u32 m0, s21, 32768
    s_nop 0
    buffer_load_dwordx4 v3, s[12:15], s18 offen lds
    s_add_u32 m0, s21, 33792
    s_add_u32 s18, s18, 18432
    buffer_load_dwordx4 v3, s[12:15], s18 offen lds
    s_add_u32 m0, s21, 34816
    s_add_u32 s18, s18, 18432
    buffer_load_dwordx4 v3, s[12:15], s18 offen lds
    s_add_u32 m0, s21, 35840
    s_add_u32 s18, s18, 18432
    buffer_load_dwordx4 v3, s[12:15], s18 offen lds
    v_add_u32 v6, 49152, v4
    v_xor_b32 v7, 32, v6
    s_waitcnt vmcnt(32)
    ds_read_b64_tr_b16 a[48:49], v6 offset:0
    ds_read_b64_tr_b16 a[50:51], v6 offset:1024
    ds_read_b64_tr_b16 a[52:53], v6 offset:8
    ds_read_b64_tr_b16 a[54:55], v6 offset:1032
    ds_read_b64_tr_b16 a[56:57], v6 offset:2048
    ds_read_b64_tr_b16 a[58:59], v6 offset:3072
    ds_read_b64_tr_b16 a[60:61], v6 offset:2056
    ds_read_b64_tr_b16 a[62:63], v6 offset:3080
    s_waitcnt lgkmcnt(0)
    s_add_u32 s18, s19, 884736
    s_add_u32 m0, s21, 49152
    s_nop 0
    buffer_load_dwordx4 v3, s[12:15], s18 offen lds
    s_add_u32 m0, s21, 50176
    s_add_u32 s18, s18, 18432
    buffer_load_dwordx4 v3, s[12:15], s18 offen lds
    s_add_u32 m0, s21, 51200
    s_add_u32 s18, s18, 18432
    buffer_load_dwordx4 v3, s[12:15], s18 offen lds
    s_add_u32 m0, s21, 52224
    s_add_u32 s18, s18, 18432
    buffer_load_dwordx4 v3, s[12:15], s18 offen lds
    v_add_u32 v6, 65536, v4
    v_xor_b32 v7, 32, v6
    s_waitcnt vmcnt(32)
    ds_read_b64_tr_b16 a[64:65], v6 offset:0
    ds_read_b64_tr_b16 a[66:67], v6 offset:1024
    ds_read_b64_tr_b16 a[68:69], v6 offset:8
    ds_read_b64_tr_b16 a[70:71], v6 offset:1032
    ds_read_b64_tr_b16 a[72:73], v6 offset:2048
    ds_read_b64_tr_b16 a[74:75], v6 offset:3072
    ds_read_b64_tr_b16 a[76:77], v6 offset:2056
    ds_read_b64_tr_b16 a[78:79], v6 offset:3080
    s_waitcnt lgkmcnt(0)
    s_add_u32 s18, s19, 958464
    s_add_u32 m0, s21, 65536
    s_nop 0
    buffer_load_dwordx4 v3, s[12:15], s18 offen lds
    s_add_u32 m0, s21, 66560
    s_add_u32 s18, s18, 18432
    buffer_load_dwordx4 v3, s[12:15], s18 offen lds
    s_add_u32 m0, s21, 67584
    s_add_u32 s18, s18, 18432
    buffer_load_dwordx4 v3, s[12:15], s18 offen lds
    s_add_u32 m0, s21, 68608
    s_add_u32 s18, s18, 18432
    buffer_load_dwordx4 v3, s[12:15], s18 offen lds
    v_add_u32 v6, 81920, v4
    v_xor_b32 v7, 32, v6
    s_waitcnt vmcnt(32)
    ds_read_b64_tr_b16 a[80:81], v6 offset:0
    ds_read_b64_tr_b16 a[82:83], v6 offset:1024
    ds_read_b64_tr_b16 a[84:85], v6 offset:8
    ds_read_b64_tr_b16 a[86:87], v6 offset:1032
    ds_read_b64_tr_b16 a[88:89], v6 offset:2048
    ds_read_b64_tr_b16 a[90:91], v6 offset:3072
    ds_read_b64_tr_b16 a[92:93], v6 offset:2056
    ds_read_b64_tr_b16 a[94:95], v6 offset:3080
    s_waitcnt lgkmcnt(0)
    s_add_u32 s18, s19, 1032192
    s_add_u32 m0, s21, 81920
    s_nop 0
    buffer_load_dwordx4 v3, s[12:15], s18 offen lds
    s_add_u32 m0, s21, 82944
    s_add_u32 s18, s18, 18432
    buffer_load_dwordx4 v3, s[12:15], s18 offen lds
    s_add_u32 m0, s21, 83968
    s_add_u32 s18, s18, 18432
    buffer_load_dwordx4 v3, s[12:15], s18 offen lds
    s_add_u32 m0, s21, 84992
    s_add_u32 s18, s18, 18432
    buffer_load_dwordx4 v3, s[12:15], s18 offen lds
    v_add_u32 v6, 98304, v4
    v_xor_b32 v7, 32, v6
    s_waitcnt vmcnt(32)
    ds_read_b64_tr_b16 a[96:97], v6 offset:0
    ds_read_b64_tr_b16 a[98:99], v6 offset:1024
    ds_read_b64_tr_b16 a[100:101], v6 offset:8
    ds_read_b64_tr_b16 a[102:103], v6 offset:1032
    ds_read_b64_tr_b16 a[104:105], v6 offset:2048
    ds_read_b64_tr_b16 a[106:107], v6 offset:3072
    ds_read_b64_tr_b16 a[108:109], v6 offset:2056
    ds_read_b64_tr_b16 a[110:111], v6 offset:3080
    s_waitcnt lgkmcnt(0)
    s_add_u32 s18, s19, 1105920
    s_add_u32 m0, s21, 98304
    s_nop 0
    buffer_load_dwordx4 v3, s[12:15], s18 offen lds
    s_add_u32 m0, s21, 99328
    s_add_u32 s18, s18, 18432
    buffer_load_dwordx4 v3, s[12:15], s18 offen lds
    s_add_u32 m0, s21, 100352
    s_add_u32 s18, s18, 18432
    buffer_load_dwordx4 v3, s[12:15], s18 offen lds
    s_add_u32 m0, s21, 101376
    s_add_u32 s18, s18, 18432
    buffer_load_dwordx4 v3, s[12:15], s18 offen lds
    v_add_u32 v6, 114688, v4
    v_xor_b32 v7, 32, v6
    s_waitcnt vmcnt(32)
    ds_read_b64_tr_b16 a[112:113], v6 offset:0
    ds_read_b64_tr_b16 a[114:115], v6 offset:1024
    ds_read_b64_tr_b16 a[116:117], v6 offset:8
    ds_read_b64_tr_b16 a[118:119], v6 offset:1032
    ds_read_b64_tr_b16 a[120:121], v6 offset:2048
    ds_read_b64_tr_b16 a[122:123], v6 offset:3072
    ds_read_b64_tr_b16 a[124:125], v6 offset:2056
    ds_read_b64_tr_b16 a[126:127], v6 offset:3080
    s_waitcnt lgkmcnt(0)
    v_add_u32 v6, 131072, v4
    v_xor_b32 v7, 32, v6
    s_waitcnt vmcnt(28)
    ds_read_b64_tr_b16 a[128:129], v6 offset:0
    ds_read_b64_tr_b16 a[130:131], v6 offset:1024
    ds_read_b64_tr_b16 a[132:133], v6 offset:8
    ds_read_b64_tr_b16 a[134:135], v6 offset:1032
    ds_read_b64_tr_b16 a[136:137], v6 offset:2048
    ds_read_b64_tr_b16 a[138:139], v6 offset:3072
    ds_read_b64_tr_b16 a[140:141], v6 offset:2056
    ds_read_b64_tr_b16 a[142:143], v6 offset:3080
    s_waitcnt lgkmcnt(0)
    v_add_u32 v6, 0, v4
    v_xor_b32 v7, 32, v6
    s_waitcnt vmcnt(24)
    ds_read_b64_tr_b16 a[144:145], v6 offset:0
    ds_read_b64_tr_b16 a[146:147], v6 offset:1024
    ds_read_b64_tr_b16 a[148:149], v6 offset:8
    ds_read_b64_tr_b16 a[150:151], v6 offset:1032
    ds_read_b64_tr_b16 a[152:153], v6 offset:2048
    ds_read_b64_tr_b16 a[154:155], v6 offset:3072
    ds_read_b64_tr_b16 a[156:157], v6 offset:2056
    ds_read_b64_tr_b16 a[158:159], v6 offset:3080
    s_waitcnt lgkmcnt(0)
    v_add_u32 v6, 16384, v4
    v_xor_b32 v7, 32, v6
    s_waitcnt vmcnt(20)
    ds_read_b64_tr_b16 a[160:161], v6 offset:0
    ds_read_b64_tr_b16 a[162:163], v6 offset:1024
    ds_read_b64_tr_b16 a[164:165], v6 offset:8
    ds_read_b64_tr_b16 a[166:167], v6 offset:1032
    ds_read_b64_tr_b16 a[168:169], v6 offset:2048
    ds_read_b64_tr_b16 a[170:171], v6 offset:3072
    ds_read_b64_tr_b16 a[172:173], v6 offset:2056
    ds_read_b64_tr_b16 a[174:175], v6 offset:3080
    s_waitcnt lgkmcnt(0)
    v_add_u32 v6, 32768, v4
    v_xor_b32 v7, 32, v6
    s_waitcnt vmcnt(16)
    ds_read_b64_tr_b16 a[176:177], v6 offset:0
    ds_read_b64_tr_b16 a[178:179], v6 offset:1024
    ds_read_b64_tr_b16 a[180:181], v6 offset:8
    ds_read_b64_tr_b16 a[182:183], v6 offset:1032
    ds_read_b64_tr_b16 a[184:185], v6 offset:2048
    ds_read_b64_tr_b16 a[186:187], v6 offset:3072
    ds_read_b64_tr_b16 a[188:189], v6 offset:2056
    ds_read_b64_tr_b16 a[190:191], v6 offset:3080
    s_waitcnt lgkmcnt(0)
    v_add_u32 v6, 49152, v4
    v_xor_b32 v7, 32, v6
    s_waitcnt vmcnt(12)
    ds_read_b64_tr_b16 a[192:193], v6 offset:0
    ds_read_b64_tr_b16 a[194:195], v6 offset:1024
    ds_read_b64_tr_b16 a[196:197], v6 offset:8
    ds_read_b64_tr_b16 a[198:199], v6 offset:1032
    ds_read_b64_tr_b16 a[200:201], v6 offset:2048
    ds_read_b64_tr_b16 a[202:203], v6 offset:3072
    ds_read_b64_tr_b16 a[204:205], v6 offset:2056
    ds_read_b64_tr_b16 a[206:207], v6 offset:3080
    s_waitcnt lgkmcnt(0)
    v_add_u32 v6, 65536, v4
    v_xor_b32 v7, 32, v6
    s_waitcnt vmcnt(8)
    ds_read_b64_tr_b16 a[208:209], v6 offset:0
    ds_read_b64_tr_b16 a[210:211], v6 offset:1024
    ds_read_b64_tr_b16 a[212:213], v6 offset:8
    ds_read_b64_tr_b16 a[214:215], v6 offset:1032
    ds_read_b64_tr_b16 a[216:217], v6 offset:2048
    ds_read_b64_tr_b16 a[218:219], v6 offset:3072
    ds_read_b64_tr_b16 a[220:221], v6 offset:2056
    ds_read_b64_tr_b16 a[222:223], v6 offset:3080
    s_waitcnt lgkmcnt(0)
    v_add_u32 v6, 81920, v4
    v_xor_b32 v7, 32, v6
    s_waitcnt vmcnt(4)
    ds_read_b64_tr_b16 a[224:225], v6 offset:0
    ds_read_b64_tr_b16 a[226:227], v6 offset:1024
    ds_read_b64_tr_b16 a[228:229], v6 offset:8
    ds_read_b64_tr_b16 a[230:231], v6 offset:1032
    ds_read_b64_tr_b16 a[232:233], v6 offset:2048
    ds_read_b64_tr_b16 a[234:235], v6 offset:3072
    ds_read_b64_tr_b16 a[236:237], v6 offset:2056
    ds_read_b64_tr_b16 a[238:239], v6 offset:3080
    s_waitcnt lgkmcnt(0)
    v_add_u32 v6, 98304, v4
    v_xor_b32 v7, 32, v6
    s_waitcnt vmcnt(0)
    ds_read_b64_tr_b16 a[240:241], v6 offset:0
    ds_read_b64_tr_b16 a[242:243], v6 offset:1024
    ds_read_b64_tr_b16 a[244:245], v6 offset:8
    ds_read_b64_tr_b16 a[246:247], v6 offset:1032
    ds_read_b64_tr_b16 a[248:249], v6 offset:2048
    ds_read_b64_tr_b16 a[250:251], v6 offset:3072
    ds_read_b64_tr_b16 a[252:253], v6 offset:2056
    ds_read_b64_tr_b16 a[254:255], v6 offset:3080
    s_waitcnt lgkmcnt(0)
    s_barrier
L_op_seg:
    s_lshr_b32 s43, s16, 1
    s_add_u32 s43, s43, 1
    s_min_u32 s43, s43, 63
    s_and_b32 s36, s33, 15
    s_lshl_b32 s36, s36, 8
    s_add_u32 s36, s36, 125829120
    s_lshl_b32 s94, s33, 7
    s_add_u32 s94, s94, s16
    s_cmp_ge_u32 s16, 120
    s_cbranch_scc1 L_nocw
    s_mov_b32 s88, 65536
cw15:
    buffer_load_dword v3, off, s[4:7], s36 offset:128 sc1
    s_waitcnt vmcnt(0)
    v_readfirstlane_b32 s42, v3
    s_nop 0
    s_sub_u32 s42, s42, s95
    s_cmp_gt_u32 s42, 64
    s_cselect_b32 s42, 0, s42
    s_add_u32 s42, s42, 2
    s_cmp_ge_u32 s42, s43
    s_cbranch_scc1 cw15x
    s_sub_u32 s88, s88, 1
    s_cbranch_scc1 cw15x
    s_sub_u32 s42, s43, s42
    s_min_u32 s42, s42, 6
cw15s:
    s_sleep 24
    s_sub_u32 s42, s42, 1
    s_cmp_lg_u32 s42, 0
    s_cbranch_scc1 cw15s
    s_branch cw15
cw15x:
L_nocw:
    s_lshr_b32 s89, s16, 1
    s_lshl_b32 s89, s89, 2
    s_add_u32 s89, s89, s32
    s_lshl_b32 s89, s89, 7
    s_add_u32 s89, s89, 125894656
    v_mbcnt_lo_u32_b32 v2, -1, 0
    v_mbcnt_hi_u32_b32 v2, -1, v2
    v_min_u32 v2, 7, v2
    v_lshlrev_b32 v2, 2, v2
    s_mov_b32 s88, 4194304
fw16:
    buffer_load_dword v3, v2, s[4:7], s89 offen offset:0 sc1
    s_sub_u32 s88, s88, 1
    s_cbranch_scc1 fw16x
    s_waitcnt vmcnt(0)
    v_cmp_ne_u32 vcc, s95, v3
    s_cbranch_vccz fw16x
    s_sleep 2
    s_cmp_gt_u32 s88, 4194256
    s_cbranch_scc1 fw16
    s_sleep 40
    s_branch fw16
fw16x:
    s_mov_b32 s21, 4096
os_again:
    s_lshl_b32 s18, s16, 17
    s_lshl_b32 s19, s32, 15
    s_add_u32 s18, s18, s19
    s_add_u32 s18, s18, 50331648
    buffer_load_dwordx4 v[32:35], v1, s[4:7], s18 offen offset:0 sc1
    buffer_load_dwordx4 v[36:39], v1, s[4:7], s18 offen offset:1024 sc1
    buffer_load_dwordx4 v[40:43], v1, s[4:7], s18 offen offset:2048 sc1
    buffer_load_dwordx4 v[44:47], v1, s[4:7], s18 offen offset:3072 sc1
    s_add_u32 s18, s18, 4096
    buffer_load_dwordx4 v[48:51], v1, s[4:7], s18 offen offset:0 sc1
    buffer_load_dwordx4 v[52:55], v1, s[4:7], s18 offen offset:1024 sc1
    buffer_load_dwordx4 v[56:59], v1, s[4:7], s18 offen offset:2048 sc1
    buffer_load_dwordx4 v[60:63], v1, s[4:7], s18 offen offset:3072 sc1
    s_add_u32 s18, s18, 4096
    buffer_load_dwordx4 v[64:67], v1, s[4:7], s18 offen offset:0 sc1
    buffer_load_dwordx4 v[68:71], v1, s[4:7], s18 offen offset:1024 sc1
    buffer_load_dwordx4 v[72:75], v1, s[4:7], s18 offen offset:2048 sc1
    buffer_load_dwordx4 v[76:79], v1, s[4:7], s18 offen offset:3072 sc1
    s_add_u32 s18, s18, 4096
    buffer_load_dwordx4 v[80:83], v1, s[4:7], s18 offen offset:0 sc1
    buffer_load_dwordx4 v[84:87], v1, s[4:7], s18 offen offset:1024 sc1
    buffer_load_dwordx4 v[88:91], v1, s[4:7], s18 offen offset:2048 sc1
    buffer_load_dwordx4 v[92:95], v1, s[4:7], s18 offen offset:3072 sc1
    s_add_u32 s18, s18, 4096
    buffer_load_dwordx4 v[96:99], v1, s[4:7], s18 offen offset:0 sc1
    buffer_load_dwordx4 v[100:103], v1, s[4:7], s18 offen offset:1024 sc1
    buffer_load_dwordx4 v[104:107], v1, s[4:7], s18 offen offset:2048 sc1
    buffer_load_dwordx4 v[108:111], v1, s[4:7], s18 offen offset:3072 sc1
    s_add_u32 s18, s18, 4096
    buffer_load_dwordx4 v[112:115], v1, s[4:7], s18 offen offset:0 sc1
    buffer_load_dwordx4 v[116:119], v1, s[4:7], s18 offen offset:1024 sc1
    buffer_load_dwordx4 v[120:123], v1, s[4:7], s18 offen offset:2048 sc1
    buffer_load_dwordx4 v[124:127], v1, s[4:7], s18 offen offset:3072 sc1
    s_add_u32 s18, s18, 4096
    buffer_load_dwordx4 v[128:131], v1, s[4:7], s18 offen offset:0 sc1
    buffer_load_dwordx4 v[132:135], v1, s[4:7], s18 offen offset:1024 sc1
    buffer_load_dwordx4 v[136:139], v1, s[4:7], s18 offen offset:2048 sc1
    buffer_load_dwordx4 v[140:143], v1, s[4:7], s18 offen offset:3072 sc1
    s_add_u32 s18, s18, 4096
    buffer_load_dwordx4 v[144:147], v1, s[4:7], s18 offen offset:0 sc1
    buffer_load_dwordx4 v[148:151], v1, s[4:7], s18 offen offset:1024 sc1
    buffer_load_dwordx4 v[152:155], v1, s[4:7], s18 offen offset:2048 sc1
    buffer_load_dwordx4 v[156:159], v1, s[4:7], s18 offen offset:3072 sc1
    v_lshlrev_b32 v2, 4, v0
    v_and_b32 v3, 3072, v2
    v_lshl_add_u32 v2, v3, 1, v1
    s_waitcnt vmcnt(31)
    v_mfma_f32_16x16x32_bf16 v[8:11], a[0:3], v[32:35], 0
    v_mfma_f32_16x16x32_bf16 v[12:15], a[4:7], v[32:35], 0
    v_mov_b32 v4, v32
    s_waitcnt vmcnt(30)
    v_mfma_f32_16x16x32_bf16 v[8:11], a[8:11], v[36:39], v[8:11]
    v_mfma_f32_16x16x32_bf16 v[12:15], a[12:15], v[36:39], v[12:15]
    v_max_u32 v4, v4, v36
    s_waitcnt vmcnt(29)
    v_mfma_f32_16x16x32_bf16 v[8:11], a[16:19], v[40:43], v[8:11]
    v_mfma_f32_16x16x32_bf16 v[12:15], a[20:23], v[40:43], v[12:15]
    v_max_u32 v4, v4, v40
    s_waitcnt vmcnt(28)
    v_mfma_f32_16x16x32_bf16 v[8:11], a[24:27], v[44:47], v[8:11]
    v_mfma_f32_16x16x32_bf16 v[12:15], a[28:31], v[44:47], v[12:15]
    v_max_u32 v4, v4, v44
    s_waitcnt vmcnt(27)
    v_mfma_f32_16x16x32_bf16 v[8:11], a[32:35], v[48:51], v[8:11]
    v_mfma_f32_16x16x32_bf16 v[12:15], a[36:39], v[48:51], v[12:15]
    v_max_u32 v4, v4, v48
    s_waitcnt vmcnt(26)
    v_mfma_f32_16x16x32_bf16 v[8:11], a[40:43], v[52:55], v[8:11]
    v_mfma_f32_16x16x32_bf16 v[12:15], a[44:47], v[52:55], v[12:15]
    v_max_u32 v4, v4, v52
    s_waitcnt vmcnt(25)
    v_mfma_f32_16x16x32_bf16 v[8:11], a[48:51], v[56:59], v[8:11]
    v_mfma_f32_16x16x32_bf16 v[12:15], a[52:55], v[56:59], v[12:15]
    v_max_u32 v4, v4, v56
    s_waitcnt vmcnt(24)
    v_mfma_f32_16x16x32_bf16 v[8:11], a[56:59], v[60:63], v[8:11]
    v_mfma_f32_16x16x32_bf16 v[12:15], a[60:63], v[60:63], v[12:15]
    v_max_u32 v4, v4, v60
    s_waitcnt vmcnt(23)
    v_mfma_f32_16x16x32_bf16 v[8:11], a[64:67], v[64:67], v[8:11]
    v_mfma_f32_16x16x32_bf16 v[12:15], a[68:71], v[64:67], v[12:15]
    v_max_u32 v4, v4, v64
    s_waitcnt vmcnt(22)
    v_mfma_f32_16x16x32_bf16 v[8:11], a[72:75], v[68:71], v[8:11]
    v_mfma_f32_16x16x32_bf16 v[12:15], a[76:79], v[68:71], v[12:15]
    v_max_u32 v4, v4, v68
    s_waitcnt vmcnt(21)
    v_mfma_f32_16x16x32_bf16 v[8:11], a[80:83], v[72:75], v[8:11]
    v_mfma_f32_16x16x32_bf16 v[12:15], a[84:87], v[72:75], v[12:15]
    v_max_u32 v4, v4, v72
    s_waitcnt vmcnt(20)
    v_mfma_f32_16x16x32_bf16 v[8:11], a[88:91], v[76:79], v[8:11]
    v_mfma_f32_16x16x32_bf16 v[12:15], a[92:95], v[76:79], v[12:15]
    v_max_u32 v4, v4, v76
    s_waitcnt vmcnt(19)
    v_mfma_f32_16x16x32_bf16 v[8:11], a[96:99], v[80:83], v[8:11]
    v_mfma_f32_16x16x32_bf16 v[12:15], a[100:103], v[80:83], v[12:15]
    v_max_u32 v4, v4, v80
    s_waitcnt vmcnt(18)
    v_mfma_f32_16x16x32_bf16 v[8:11], a[104:107], v[84:87], v[8:11]
    v_mfma_f32_16x16x32_bf16 v[12:15], a[108:111], v[84:87], v[12:15]
    v_max_u32 v4, v4, v84
    s_waitcnt vmcnt(17)
    v_mfma_f32_16x16x32_bf16 v[8:11], a[112:115], v[88:91], v[8:11]
    v_mfma_f32_16x16x32_bf16 v[12:15], a[116:119], v[88:91], v[12:15]
    v_max_u32 v4, v4, v88
    s_waitcnt vmcnt(16)
    v_mfma_f32_16x16x32_bf16 v[8:11], a[120:123], v[92:95], v[8:11]
    v_mfma_f32_16x16x32_bf16 v[12:15], a[124:127], v[92:95], v[12:15]
    v_max_u32 v4, v4, v92
    s_waitcnt vmcnt(15)
    v_mfma_f32_16x16x32_bf16 v[8:11], a[128:131], v[96:99], v[8:11]
    v_mfma_f32_16x16x32_bf16 v[12:15], a[132:135], v[96:99], v[12:15]
    v_max_u32 v4, v4, v96
    s_waitcnt vmcnt(14)
    v_mfma_f32_16x16x32_bf16 v[8:11], a[136:139], v[100:103], v[8:11]
    v_mfma_f32_16x16x32_bf16 v[12:15], a[140:143], v[100:103], v[12:15]
    v_max_u32 v4, v4, v100
    s_waitcnt vmcnt(13)
    v_mfma_f32_16x16x32_bf16 v[8:11], a[144:147], v[104:107], v[8:11]
    v_mfma_f32_16x16x32_bf16 v[12:15], a[148:151], v[104:107], v[12:15]
    v_max_u32 v4, v4, v104
    s_waitcnt vmcnt(12)
    v_mfma_f32_16x16x32_bf16 v[8:11], a[152:155], v[108:111], v[8:11]
    v_mfma_f32_16x16x32_bf16 v[12:15], a[156:159], v[108:111], v[12:15]
    v_max_u32 v4, v4, v108
    s_waitcnt vmcnt(11)
    v_mfma_f32_16x16x32_bf16 v[8:11], a[160:163], v[112:115], v[8:11]
    v_mfma_f32_16x16x32_bf16 v[12:15], a[164:167], v[112:115], v[12:15]
    v_max_u32 v4, v4, v112
    s_waitcnt vmcnt(10)
    v_mfma_f32_16x16x32_bf16 v[8:11], a[168:171], v[116:119], v[8:11]
    v_mfma_f32_16x16x32_bf16 v[12:15], a[172:175], v[116:119], v[12:15]
    v_max_u32 v4, v4, v116
    s_waitcnt vmcnt(9)
    v_mfma_f32_16x16x32_bf16 v[8:11], a[176:179], v[120:123], v[8:11]
    v_mfma_f32_16x16x32_bf16 v[12:15], a[180:183], v[120:123], v[12:15]
    v_max_u32 v4, v4, v120
    s_waitcnt vmcnt(8)
    v_mfma_f32_16x16x32_bf16 v[8:11], a[184:187], v[124:127], v[8:11]
    v_mfma_f32_16x16x32_bf16 v[12:15], a[188:191], v[124:127], v[12:15]
    v_max_u32 v4, v4, v124
    s_waitcnt vmcnt(7)
    v_mfma_f32_16x16x32_bf16 v[8:11], a[192:195], v[128:131], v[8:11]
    v_mfma_f32_16x16x32_bf16 v[12:15], a[196:199], v[128:131], v[12:15]
    v_max_u32 v4, v4, v128
    s_waitcnt vmcnt(6)
    v_mfma_f32_16x16x32_bf16 v[8:11], a[200:203], v[132:135], v[8:11]
    v_mfma_f32_16x16x32_bf16 v[12:15], a[204:207], v[132:135], v[12:15]
    v_max_u32 v4, v4, v132
    s_waitcnt vmcnt(5)
    v_mfma_f32_16x16x32_bf16 v[8:11], a[208:211], v[136:139], v[8:11]
    v_mfma_f32_16x16x32_bf16 v[12:15], a[212:215], v[136:139], v[12:15]
    v_max_u32 v4, v4, v136
    s_waitcnt vmcnt(4)
    v_mfma_f32_16x16x32_bf16 v[8:11], a[216:219], v[140:143], v[8:11]
    v_mfma_f32_16x16x32_bf16 v[12:15], a[220:223], v[140:143], v[12:15]
    v_max_u32 v4, v4, v140
    s_waitcnt vmcnt(3)
    v_mfma_f32_16x16x32_bf16 v[8:11], a[224:227], v[144:147], v[8:11]
    v_mfma_f32_16x16x32_bf16 v[12:15], a[228:231], v[144:147], v[12:15]
    v_max_u32 v4, v4, v144
    s_waitcnt vmcnt(2)
    v_mfma_f32_16x16x32_bf16 v[8:11], a[232:235], v[148:151], v[8:11]
    v_mfma_f32_16x16x32_bf16 v[12:15], a[236:239], v[148:151], v[12:15]
    v_max_u32 v4, v4, v148
    s_waitcnt vmcnt(1)
    v_mfma_f32_16x16x32_bf16 v[8:11], a[240:243], v[152:155], v[8:11]
    v_mfma_f32_16x16x32_bf16 v[12:15], a[244:247], v[152:155], v[12:15]
    v_max_u32 v4, v4, v152
    s_waitcnt vmcnt(0)
    v_mfma_f32_16x16x32_bf16 v[8:11], a[248:251], v[156:159], v[8:11]
    v_mfma_f32_16x16x32_bf16 v[12:15], a[252:255], v[156:159], v[12:15]
    v_max_u32 v4, v4, v156
    v_cmp_eq_u32 vcc, -1, v4
    s_sub_u32 s21, s21, 1
    s_nop 3
    s_cbranch_scc1 os_ok
    s_cbranch_vccnz os_again
os_ok:
    ds_write_b128 v2, v[8:11] offset:0
    ds_write_b128 v2, v[12:15] offset:1024
    s_waitcnt lgkmcnt(0)
    s_barrier
    s_cmp_lg_u32 s32, 0
    s_cbranch_scc1 os_skip
    ds_read_b128 v[40:43], v1 offset:2048
    ds_read_b128 v[44:47], v1 offset:3072
    ds_read_b128 v[48:51], v1 offset:4096
    ds_read_b128 v[52:55], v1 offset:5120
    ds_read_b128 v[56:59], v1 offset:6144
    ds_read_b128 v[60:63], v1 offset:7168
    v_lshrrev_b32 v3, 4, v1
    v_bfe_u32 v4, v3, 2, 2
    v_lshlrev_b32 v4, 3, v4
    v_and_b32 v2, 3, v3
    v_add_u32 v4, v4, v2
    v_mul_u32_u24 v4, 2304, v4
    v_lshrrev_b32 v3, 4, v3
    v_lshl_add_u32 v4, v3, 4, v4
    s_lshr_b32 s18, s16, 1
    s_lshl_b32 s18, s18, 3
    s_and_b32 s19, s16, 1
    s_add_u32 s18, s18, s19
    s_mul_i32 s18, s18, 9216
    s_lshl_b32 s19, s33, 6
    s_add_u32 s18, s18, s19
    s_waitcnt lgkmcnt(0)
    v_pk_add_f32 v[8:9], v[8:9], v[40:41]
    v_pk_add_f32 v[48:49], v[48:49], v[56:57]
    v_pk_add_f32 v[8:9], v[8:9], v[48:49]
    v_pk_add_f32 v[10:11], v[10:11], v[42:43]
    v_pk_add_f32 v[50:51], v[50:51], v[58:59]
    v_pk_add_f32 v[10:11], v[10:11], v[50:51]
    v_pk_add_f32 v[12:13], v[12:13], v[44:45]
    v_pk_add_f32 v[52:53], v[52:53], v[60:61]
    v_pk_add_f32 v[12:13], v[12:13], v[52:53]
    v_pk_add_f32 v[14:15], v[14:15], v[46:47]
    v_pk_add_f32 v[54:55], v[54:55], v[62:63]
    v_pk_add_f32 v[14:15], v[14:15], v[54:55]
    v_cvt_pk_bf16_f32 v32, v8, v9
    v_cvt_pk_bf16_f32 v33, v10, v11
    v_cvt_pk_bf16_f32 v34, v12, v13
    v_cvt_pk_bf16_f32 v35, v14, v15
    buffer_store_dwordx4 v[32:35], v4, s[8:11], s18 offen sc1
os_skip:
    s_nop 1
    s_add_u32 s16, s16, 7
    s_cmp_ge_u32 s16, 128
    s_cbranch_scc1 L_done
    s_barrier
    s_branch L_op_seg
L_done:
L_exit:
    s_endpgm
.section .rodata,"a"
.p2align 6
.amdhsa_kernel concat_heads__memory_aug_recurrent_mem_tr__ssm_conv_s4d__prompt_kernel
  .amdhsa_next_free_vgpr 512
  .amdhsa_next_free_sgpr 102
  .amdhsa_accum_offset 256
  .amdhsa_group_segment_fixed_size 0
  .amdhsa_kernarg_size 136
  .amdhsa_user_sgpr_count 2
  .amdhsa_user_sgpr_kernarg_segment_ptr 1
  .amdhsa_system_sgpr_workgroup_id_x 1
.end_amdhsa_kernel
.text
```

```asm
; @launch grid=(256,1,1) block=(256,1,1) lds=163840
.amdgcn_target "amdgcn-amd-amdhsa--gfx950"
.text
.globl concat_heads__memory_aug_recurrent_mem_tr__ssm_conv_s4d__prompt_kernel
.p2align 8
.type concat_heads__memory_aug_recurrent_mem_tr__ssm_conv_s4d__prompt_kernel,@function
concat_heads__memory_aug_recurrent_mem_tr__ssm_conv_s4d__prompt_kernel:
    s_cmp_ge_u32 s2, 256
    s_cbranch_scc1 L_exit
    s_load_dwordx4 s[84:87], s[0:1], 120
    s_load_dwordx16 s[48:63], s[0:1], 0
    v_lshrrev_b32 v1, 6, v0
    s_nop 0
    v_readfirstlane_b32 s32, v1
    s_getreg_b32 s3, hwreg(HW_REG_XCC_ID)
    s_and_b32 s3, s3, 15
    s_cmp_lg_u32 s32, 3
    s_cbranch_scc1 L_nowarm
    s_getpc_b64 s[44:45]
L_pcw:
    v_and_b32 v1, 63, v0
    v_lshlrev_b32 v1, 7, v1
    s_cmp_lg_u32 s3, 0
    s_cselect_b32 s33, L_helper-L_pcw, 0
    v_add_u32 v1, s33, v1
    v_min_u32 v2, L_exit-L_pcw, v1
    global_load_dword v240, v2, s[44:45]
    v_add_u32 v1, 8192, v1
    v_min_u32 v2, L_exit-L_pcw, v1
    global_load_dword v241, v2, s[44:45]
    v_add_u32 v1, 8192, v1
    s_cbranch_scc0 L_nowarm
    v_min_u32 v2, L_exit-L_pcw, v1
    global_load_dword v242, v2, s[44:45]
    v_add_u32 v1, 8192, v1
    v_min_u32 v2, L_exit-L_pcw, v1
    global_load_dword v243, v2, s[44:45]
    v_add_u32 v1, 8192, v1
    v_min_u32 v2, L_exit-L_pcw, v1
    global_load_dword v244, v2, s[44:45]
    v_add_u32 v1, 8192, v1
L_nowarm:
    s_waitcnt lgkmcnt(0)
    s_mov_b32 s4, s86
    s_mov_b32 s5, s87
    s_mov_b32 s6, 268435456
    s_mov_b32 s7, 0x20000
    s_mov_b32 s96, s84
    s_mov_b32 s97, s85
    s_mov_b32 s98, 256
    s_mov_b32 s99, 0x20000
    s_mov_b32 s95, 0
    s_cmp_lg_u32 s3, 0
    s_cbranch_scc1 L_helper
    s_mov_b32 s37, 128
    v_mov_b32 v250, 1
    v_mov_b32 v251, 163832
    v_cmp_eq_u32 vcc, 0, v0
    s_nop 0
    s_and_saveexec_b64 s[38:39], vcc
    s_cbranch_execz tk1m
    buffer_atomic_add v250, off, s[96:99], s37 sc0
tk1m:
    s_mov_b64 s[38:39], exec
    s_mov_b64 exec, -1
    v_lshrrev_b32 v54, 6, v0
    s_nop 0
    v_readfirstlane_b32 s13, v54
    v_and_b32 v57, 63, v0
    v_bfe_u32 v54, v57, 2, 1
    v_lshlrev_b32 v48, 13, v54
    v_bfe_u32 v54, v57, 3, 1
    v_lshl_add_u32 v48, v54, 15, v48
    v_bfe_u32 v54, v57, 4, 1
    v_lshl_add_u32 v48, v54, 14, v48
    v_bfe_u32 v54, v57, 5, 1
    v_lshl_add_u32 v48, v54, 16, v48
    v_lshrrev_b32 v55, 4, v57
    v_and_b32 v55, 2, v55
    v_xor_b32 v55, v55, v57
    v_and_b32 v55, 3, v55
    v_lshl_add_u32 v48, v55, 4, v48
    v_bfe_u32 v54, v57, 2, 1
    v_lshlrev_b32 v51, 6, v54
    v_bfe_u32 v54, v57, 3, 1
    v_lshl_add_u32 v51, v54, 9, v51
    v_bfe_u32 v54, v57, 4, 1
    v_lshl_add_u32 v51, v54, 7, v51
    v_bfe_u32 v54, v57, 5, 1
    v_lshl_add_u32 v51, v54, 12, v51
    v_bfe_u32 v54, v57, 0, 1
    v_lshl_add_u32 v51, v54, 3, v51
    v_bfe_u32 v54, v57, 1, 1
    v_lshl_add_u32 v51, v54, 4, v51
    v_bfe_u32 v54, v57, 3, 1
    v_lshl_add_u32 v51, v54, 5, v51
    v_lshrrev_b32 v55, 3, v57
    v_mul_u32_u24 v49, 1152, v55
    v_and_b32 v55, 7, v57
    v_lshl_add_u32 v49, v55, 4, v49
    v_bfe_u32 v54, v57, 4, 1
    v_lshlrev_b32 v52, 13, v54
    v_bfe_u32 v54, v57, 5, 1
    v_lshl_add_u32 v52, v54, 9, v52
    v_bfe_u32 v54, v57, 2, 1
    v_lshl_add_u32 v52, v54, 7, v52
    v_bfe_u32 v54, v57, 3, 1
    v_lshl_add_u32 v52, v54, 5, v52
    v_and_b32 v55, 3, v57
    v_lshl_add_u32 v52, v55, 3, v52
    v_lshrrev_b32 v55, 2, v57
    v_mul_u32_u24 v50, 1152, v55
    v_and_b32 v55, 3, v57
    v_lshl_add_u32 v50, v55, 4, v50
    v_bfe_u32 v54, v57, 4, 1
    v_lshlrev_b32 v53, 12, v54
    v_bfe_u32 v54, v57, 5, 1
    v_lshl_add_u32 v53, v54, 8, v53
    v_bfe_u32 v54, v57, 2, 1
    v_lshl_add_u32 v53, v54, 6, v53
    v_bfe_u32 v54, v57, 3, 1
    v_lshl_add_u32 v53, v54, 5, v53
    v_and_b32 v55, 3, v57
    v_lshl_add_u32 v53, v55, 3, v53
    s_lshl_b32 s66, s13, 10
    s_and_b32 s93, s13, 1
    s_lshl_b32 s93, s93, 14
    s_and_b32 s75, s13, 2
    s_lshl_b32 s75, s75, 19
    v_add_u32 v51, s66, v51
    v_add_u32 v52, s66, v52
    v_add_u32 v53, s66, v53
    v_mov_b32 v58, v48
    s_mov_b32 s10, 4718592
    s_mov_b32 s11, 0x20000
    s_mov_b64 exec, s[38:39]
    s_cbranch_execz tk1
    s_waitcnt vmcnt(0)
    ds_write_b32 v251, v250
    s_waitcnt lgkmcnt(0)
tk1:
    s_mov_b64 exec, -1
    s_barrier
    ds_read_b32 v252, v251
    s_waitcnt lgkmcnt(0)
    v_readfirstlane_b32 s12, v252
    s_barrier
    s_nop 3
    s_cmp_ge_u32 s12, 32
    s_cbranch_scc1 L_helper
L_chain:
    s_mov_b64 s[48:49], s[50:51]
    s_mov_b64 s[50:51], s[52:53]
    s_mov_b64 s[52:53], s[54:55]
    s_mov_b64 s[54:55], s[56:57]
    s_mov_b64 s[56:57], s[58:59]
    s_lshl_b32 s67, s12, 8
    s_lshl_b32 s40, s13, 6
    s_add_u32 s67, s67, s40
    s_mul_i32 s92, s12, 147456
    s_lshr_b32 s73, s50, 8
    s_add_u32 s73, s73, s12
    s_and_b32 s73, s73, 31
    s_bitcmp1_b32 0xa2222222, s73
    s_cselect_b32 s88, 1, 0
    s_mov_b32 s72, 0
    s_add_u32 s73, s73, 1
    s_lshr_b32 s73, s73, 2
    s_xor_b32 s94, s13, 0
    s_mul_i32 s94, s94, 36864
    s_add_u32 s94, s94, s92
    s_lshl_b32 s74, s13, 7
    s_add_u32 s94, s94, s74
    s_add_u32 s78, s94, 0
    s_mov_b64 s[8:9], s[56:57]
    v_mov_b32 v58, v49
    s_mov_b32 s79, 9216
    s_mov_b32 s81, 0
    s_add_u32 s80, s66, 114688
    s_mov_b32 s76, 0
    s_mov_b32 s77, 8192
    s_call_b64 s[82:83], cf_dma
    s_mov_b32 s77, 16384
    s_call_b64 s[82:83], cf_dma
    s_xor_b32 s94, s13, 1
    s_mul_i32 s94, s94, 36864
    s_add_u32 s94, s94, s92
    s_lshl_b32 s74, s13, 7
    s_add_u32 s94, s94, s74
    s_add_u32 s78, s94, 0
    s_add_u32 s80, s66, 81920
    s_mov_b32 s76, 0
    s_mov_b32 s77, 8192
    s_call_b64 s[82:83], cf_dma
    s_mov_b32 s77, 16384
    s_call_b64 s[82:83], cf_dma
    s_xor_b32 s94, s13, 2
    s_mul_i32 s94, s94, 36864
    s_add_u32 s94, s94, s92
    s_lshl_b32 s74, s13, 7
    s_add_u32 s94, s94, s74
    s_add_u32 s78, s94, 0
    s_add_u32 s80, s66, 16384
    s_mov_b32 s76, 0
    s_mov_b32 s77, 8192
    s_call_b64 s[82:83], cf_dma
    s_mov_b32 s77, 16384
    s_call_b64 s[82:83], cf_dma
    s_xor_b32 s94, s13, 3
    s_mul_i32 s94, s94, 36864
    s_add_u32 s94, s94, s92
    s_lshl_b32 s74, s13, 7
    s_add_u32 s94, s94, s74
    s_add_u32 s78, s94, 0
    s_add_u32 s80, s66, 0
    s_mov_b32 s76, 0
    s_mov_b32 s77, 8192
    s_call_b64 s[82:83], cf_dma
    s_mov_b32 s77, 16384
    s_call_b64 s[82:83], cf_dma
    v_lshrrev_b32 v24, 6, v0
    v_lshlrev_b32 v61, 4, v0
    v_add_u32 v62, 57344, v61
    v_xor_b32 v63, 1024, v61
    v_add_u32 v63, 98304, v63
    v_xor_b32 v64, 2048, v61
    v_add_u32 v64, 98304, v64
    v_and_b32 v65, 1023, v61
    v_add_u32 v65, 98304, v65
    v_and_b32 v26, 15, v0
    v_bfe_u32 v27, v0, 4, 2
    v_mov_b32 v60, 0x4444
    v_mov_b32 v25, 0xeeee
    v_cmp_lt_u32 vcc, 7, v26
    s_nop 1
    v_cndmask_b32 v60, v60, v25, vcc
    s_nop 1
    v_and_b32 v67, 12, v26
    v_lshlrev_b32 v67, 3, v67
    v_and_b32 v25, 1, v26
    v_lshl_add_u32 v67, v25, 4, v67
    v_bfe_u32 v25, v26, 1, 1
    v_lshl_add_u32 v67, v25, 3, v67
    v_lshl_add_u32 v66, v27, 14, v67
    v_lshl_add_u32 v66, v24, 17, v66
    s_nop 1
    v_and_b32 v67, 63, v67
    v_lshrrev_b32 v25, 1, v24
    v_lshl_add_u32 v67, v25, 18, v67
    v_lshl_add_u32 v67, v27, 16, v67
    v_lshrrev_b32 v25, 3, v26
    v_lshl_add_u32 v67, v25, 15, v67
    v_and_b32 v25, 1, v24
    v_lshl_add_u32 v67, v25, 6, v67
    s_nop 1
    s_waitcnt vmcnt(12)
    v_add_u32 v55, 114688, v52
    ds_read_b64_tr_b16 v[160:161], v55 offset:0
    ds_read_b64_tr_b16 v[162:163], v55 offset:256
    ds_read_b64_tr_b16 v[164:165], v55 offset:4096
    ds_read_b64_tr_b16 v[166:167], v55 offset:4352
    s_xor_b32 s94, s13, 0
    s_mul_i32 s94, s94, 36864
    s_add_u32 s94, s94, s92
    s_lshl_b32 s74, s13, 7
    s_add_u32 s94, s94, s74
    s_add_u32 s78, s94, 512
    s_add_u32 s80, s66, 147456
    s_mov_b32 s76, 0
    s_mov_b32 s77, 8192
    s_call_b64 s[82:83], cf_dma
    ds_read_b64_tr_b16 v[192:193], v55 offset:64
    ds_read_b64_tr_b16 v[194:195], v55 offset:320
    ds_read_b64_tr_b16 v[196:197], v55 offset:4160
    ds_read_b64_tr_b16 v[198:199], v55 offset:4416
    s_mov_b32 s77, 16384
    s_call_b64 s[82:83], cf_dma
    v_and_b32 v25, 31, v0
    v_lshlrev_b32 v70, 4, v25
    v_lshlrev_b32 v28, 3, v25
    v_add_u32 v28, 108032, v28
    v_lshrrev_b32 v25, 1, v24
    v_lshl_add_u32 v70, v25, 9, v70
    v_and_b32 v25, 1, v24
    v_lshl_add_u32 v70, v25, 3, v70
    v_add_u32 v70, 109568, v70
    v_cmp_gt_u32 vcc, 2, v27
    s_nop 1
    v_cndmask_b32 v70, v70, v28, vcc
    s_nop 1
    s_waitcnt lgkmcnt(0)
    s_waitcnt vmcnt(12)
    v_add_u32 v55, 81920, v52
    ds_read_b64_tr_b16 v[168:169], v55 offset:0
    ds_read_b64_tr_b16 v[170:171], v55 offset:256
    ds_read_b64_tr_b16 v[172:173], v55 offset:4096
    ds_read_b64_tr_b16 v[174:175], v55 offset:4352
    s_xor_b32 s94, s13, 1
    s_mul_i32 s94, s94, 36864
    s_add_u32 s94, s94, s92
    s_lshl_b32 s74, s13, 7
    s_add_u32 s94, s94, s74
    s_add_u32 s78, s94, 512
    s_add_u32 s80, s66, 98304
    s_mov_b32 s76, 0
    s_mov_b32 s77, 8192
    s_call_b64 s[82:83], cf_dma
    ds_read_b64_tr_b16 v[200:201], v55 offset:64
    ds_read_b64_tr_b16 v[202:203], v55 offset:320
    ds_read_b64_tr_b16 v[204:205], v55 offset:4160
    ds_read_b64_tr_b16 v[206:207], v55 offset:4416
    s_mov_b32 s77, 16384
    s_call_b64 s[82:83], cf_dma
    v_xor_b32 v71, 2048, v63
    v_lshrrev_b32 v68, 4, v0
    v_lshlrev_b32 v68, 7, v68
    v_and_b32 v25, 7, v26
    v_lshl_add_u32 v68, v25, 4, v68
    v_add_u32 v68, 102400, v68
    v_xor_b32 v74, 512, v68
    v_xor_b32 v75, 1024, v68
    v_xor_b32 v76, 1536, v68
    v_lshrrev_b32 v25, 3, v26
    v_lshl_add_u32 v77, v25, 3, v68
    v_or_b32 v78, 512, v65
    v_lshlrev_b32 v79, 2, v61
    v_mov_b64 v[72:73], 0
    v_and_b32 v25, 1, v27
    v_lshlrev_b32 v69, 7, v25
    v_lshrrev_b32 v25, 1, v27
    v_lshl_add_u32 v69, v25, 3, v69
    v_and_b32 v25, 3, v26
    v_lshl_add_u32 v69, v25, 4, v69
    v_bfe_u32 v25, v26, 2, 1
    v_lshl_add_u32 v69, v25, 2, v69
    s_nop 1
    s_waitcnt lgkmcnt(0)
    s_waitcnt vmcnt(12)
    v_add_u32 v55, 16384, v52
    ds_read_b64_tr_b16 v[176:177], v55 offset:0
    ds_read_b64_tr_b16 v[178:179], v55 offset:256
    ds_read_b64_tr_b16 v[180:181], v55 offset:4096
    ds_read_b64_tr_b16 v[182:183], v55 offset:4352
    s_add_u32 s78, s67, 4194304
    s_mov_b64 s[8:9], s[54:55]
    v_mov_b32 v58, v48
    s_mov_b32 s79, 131072
    s_add_u32 s80, s66, 32768
    s_mov_b32 s76, 0
    s_mov_b32 s77, 8192
    s_call_b64 s[82:83], cf_dma
    ds_read_b64_tr_b16 v[208:209], v55 offset:64
    ds_read_b64_tr_b16 v[210:211], v55 offset:320
    ds_read_b64_tr_b16 v[212:213], v55 offset:4160
    ds_read_b64_tr_b16 v[214:215], v55 offset:4416
    s_mov_b32 s77, 16384
    s_call_b64 s[82:83], cf_dma
    s_mov_b32 s32, 0x00ff00ff
    s_mov_b32 s33, 0x00ff00ff
    s_not_b64 s[34:35], s[32:33]
    s_lshr_b32 s31, s12, 1
    s_lshl_b32 s31, s31, 8
    s_and_b32 s40, s12, 1
    s_lshl_b32 s40, s40, 6
    s_add_u32 s31, s31, s40
    s_and_b32 s40, s13, 1
    s_lshl_b32 s40, s40, 12
    s_add_u32 s31, s31, s40
    s_lshl_b32 s19, s12, 14
    s_add_u32 s19, s19, 67076096
    s_add_u32 s41, s19, 8192
    s_add_u32 s19, s19, s40
    s_and_b32 s40, s12, 1
    s_lshl_b32 s40, s40, 2
    s_or_b32 s40, s40, s13
    s_cmp_eq_u32 s40, 5
    s_cselect_b32 s64, 0, s13
    s_cmp_lg_u32 s13, 1
    s_cbranch_scc1 cf_notx
    s_mov_b32 s32, 0xff
    s_mov_b32 s33, 0xff
    s_mov_b32 s19, s41
    s_lshr_b32 s31, s12, 3
    s_lshl_b32 s31, s31, 8
    s_and_b32 s40, s12, 2
    s_lshl_b32 s40, s40, 6
    s_add_u32 s31, s31, s40
    s_and_b32 s40, s12, 4
    s_lshl_b32 s40, s40, 4
    s_add_u32 s31, s31, s40
    s_add_u32 s31, s31, 8192
cf_notx:
    s_cmp_lg_u32 s13, 0
    s_cbranch_scc1 cf_notp
    s_min_u32 s40, s12, 23
    s_mul_i32 s40, s40, 384
    s_add_u32 s40, s40, 98304
    v_add_u32 v69, s40, v61
    v_mov_b32 v25, 108288
    v_cmp_lt_u32 vcc, 23, v0
    s_nop 1
    v_cndmask_b32 v69, v69, v25, vcc
cf_notp:
    s_nop 1
    s_waitcnt lgkmcnt(0)
    s_waitcnt vmcnt(12)
    v_add_u32 v55, 0, v52
    ds_read_b64_tr_b16 v[184:185], v55 offset:0
    ds_read_b64_tr_b16 v[186:187], v55 offset:256
    ds_read_b64_tr_b16 v[188:189], v55 offset:4096
    ds_read_b64_tr_b16 v[190:191], v55 offset:4352
    s_xor_b32 s78, s75, 0
    s_add_u32 s78, s78, s67
    s_mov_b32 s81, s93
    s_add_u32 s80, s66, 114688
    s_mov_b32 s76, 0
    s_mov_b32 s77, 8192
    s_call_b64 s[82:83], cf_dma
    ds_read_b64_tr_b16 v[216:217], v55 offset:64
    ds_read_b64_tr_b16 v[218:219], v55 offset:320
    ds_read_b64_tr_b16 v[220:221], v55 offset:4160
    ds_read_b64_tr_b16 v[222:223], v55 offset:4416
    s_mov_b32 s77, 16384
    s_call_b64 s[82:83], cf_dma
    v_mov_b32 v28, 1
    v_mov_b32 v29, 1
    v_mov_b32 v30, 1
    v_mov_b32 v31, 1
    s_lshl_b32 s40, s12, 14
    s_add_u32 s40, s40, 67174400
    s_add_u32 s41, s40, 0
    buffer_store_dwordx4 v[28:31], v61, s[4:7], s41 offen
    s_add_u32 s41, s40, 4096
    buffer_store_dwordx4 v[28:31], v61, s[4:7], s41 offen
    s_add_u32 s41, s40, 8192
    buffer_store_dwordx4 v[28:31], v61, s[4:7], s41 offen
    s_cmp_eq_u32 s64, 0
    s_cselect_b64 exec, 0, s[32:33]
    v_mov_b32 v27, -1
    s_add_u32 s41, s31, 67108864
    buffer_store_dword v27, v69, s[4:7], s41 offen
    s_add_u32 s41, s31, 67125248
    buffer_store_dword v27, v69, s[4:7], s41 offen
    s_add_u32 s41, s31, 67141632
    buffer_store_dword v27, v69, s[4:7], s41 offen
    s_add_u32 s41, s31, 67158016
    buffer_store_dword v27, v69, s[4:7], s41 offen
    s_mov_b64 exec, -1
    s_waitcnt lgkmcnt(0)
    s_waitcnt vmcnt(12)
    v_add_u32 v55, 147456, v52
    ds_read_b64_tr_b16 v[224:225], v55 offset:0
    ds_read_b64_tr_b16 v[226:227], v55 offset:256
    ds_read_b64_tr_b16 v[228:229], v55 offset:4096
    ds_read_b64_tr_b16 v[230:231], v55 offset:4352
    s_mov_b32 s77, 24576
    s_call_b64 s[82:83], cf_dma
    ds_read_b64_tr_b16 v[240:241], v55 offset:64
    ds_read_b64_tr_b16 v[242:243], v55 offset:320
    ds_read_b64_tr_b16 v[244:245], v55 offset:4160
    ds_read_b64_tr_b16 v[246:247], v55 offset:4416
    s_mov_b32 s77, 32768
    s_call_b64 s[82:83], cf_dma
    s_mov_b64 s[68:69], s[48:49]
    s_mov_b32 s70, 9216
    s_mov_b32 s71, 0x20000
    v_and_b32 v25, 7, v0
    v_mul_u32_u24 v25, 1152, v25
    v_lshrrev_b32 v26, 3, v0
    v_lshl_add_u32 v25, v26, 4, v25
    buffer_load_dwordx4 v[36:39], v25, s[68:71], 0 offen
    buffer_load_dwordx4 v[40:43], v25, s[68:71], 0 offen offset:512
    v_bfe_u32 v25, v0, 2, 3
    v_mul_u32_u24 v25, 1152, v25
    v_lshrrev_b32 v26, 5, v0
    v_lshl_add_u32 v25, v26, 4, v25
    v_and_b32 v26, 3, v0
    v_lshl_add_u32 v25, v26, 2, v25
    buffer_load_dword v44, v25, s[68:71], 0 offen offset:1024
    s_nop 0
    s_waitcnt lgkmcnt(0)
    s_waitcnt vmcnt(15)
    v_add_u32 v55, 98304, v52
    ds_read_b64_tr_b16 v[232:233], v55 offset:0
    ds_read_b64_tr_b16 v[234:235], v55 offset:256
    ds_read_b64_tr_b16 v[236:237], v55 offset:4096
    ds_read_b64_tr_b16 v[238:239], v55 offset:4352
    s_xor_b32 s78, s75, 1048576
    s_add_u32 s78, s78, s67
    s_add_u32 s80, s66, 65536
    s_mov_b32 s76, 0
    s_mov_b32 s77, 8192
    s_call_b64 s[82:83], cf_dma
    ds_read_b64_tr_b16 v[248:249], v55 offset:64
    ds_read_b64_tr_b16 v[250:251], v55 offset:320
    ds_read_b64_tr_b16 v[252:253], v55 offset:4160
    ds_read_b64_tr_b16 v[254:255], v55 offset:4416
    s_mov_b32 s77, 16384
    s_call_b64 s[82:83], cf_dma
    s_mov_b32 s44, 0x3e0293ee
    s_mov_b32 s45, s44
    s_mov_b32 s46, 0x42000000
    s_mov_b32 s60, 0x3f803f80
    s_mov_b32 s61, s60
    s_mov_b32 s62, 0x3e803e80
    s_mov_b32 s63, s62
    s_mov_b32 s28, 0
    s_lshl_b32 s58, s13, 10
    s_add_u32 s58, s58, 102400
    s_lshl_b32 s59, s13, 8
    s_add_u32 s59, s59, 106496
    s_lshl_b32 s24, s12, 14
    s_add_u32 s24, s24, 0
    s_add_u32 s47, s24, 33030144
    s_mul_i32 s40, s13, 3072
    s_add_u32 s23, s24, s40
    s_lshl_b32 s20, s12, 7
    s_add_u32 s20, s20, 67174400
    s_add_u32 s21, s20, 65536
    s_add_u32 s38, s20, 4096
    s_add_u32 s39, s21, 4096
    s_lshl_b32 s22, s12, 7
    s_add_u32 s22, s22, 67182592
    s_waitcnt lgkmcnt(0)
    s_waitcnt vmcnt(15)
    v_add_u32 v55, 32768, v51
    v_xor_b32 v56, 32, v55
    ds_read_b64_tr_b16 v[144:145], v55 offset:0
    ds_read_b64_tr_b16 v[146:147], v55 offset:256
    ds_read_b64_tr_b16 v[148:149], v55 offset:8192
    ds_read_b64_tr_b16 v[150:151], v55 offset:8448
    s_mov_b32 s77, 24576
    s_call_b64 s[82:83], cf_dma
    ds_read_b64_tr_b16 v[152:153], v56 offset:0
    ds_read_b64_tr_b16 v[154:155], v56 offset:256
    ds_read_b64_tr_b16 v[156:157], v56 offset:8192
    ds_read_b64_tr_b16 v[158:159], v56 offset:8448
    s_mov_b32 s77, 32768
    s_call_b64 s[82:83], cf_dma
    s_lshl_b32 s40, s12, 12
    s_add_u32 s25, s40, 79429632
    s_add_u32 s26, s40, 88866816
    s_lshl_b32 s65, s12, 9
    s_add_u32 s65, s65, 90177536
    s_lshl_b32 s40, s13, 5
    s_or_b32 s40, s40, s12
    s_cmp_lt_u32 s40, 24
    s_cselect_b32 s36, 0x1ffffff, 0
    s_mov_b32 s37, 0
    s_lshl_b32 s27, s12, 7
    s_add_u32 s27, s27, 125845504
    s_lshl_b32 s40, s13, 2
    s_add_u32 s27, s27, s40
    v_bfe_u32 v28, v61, 4, 4
    v_bfe_u32 v29, v61, 8, 1
    v_lshlrev_b32 v29, 2, v29
    v_sub_u32 v29, v28, v29
    v_mov_b32 v31, 0x3f80
    v_mov_b32 v32, 0x3f800000
    s_nop 1
    s_waitcnt lgkmcnt(0)
    s_waitcnt vmcnt(11)
    v_add_u32 v55, 114688, v51
    v_xor_b32 v56, 32, v55
    ds_read_b64_tr_b16 a[192:193], v55 offset:0
    ds_read_b64_tr_b16 a[194:195], v55 offset:256
    ds_read_b64_tr_b16 a[196:197], v55 offset:8192
    ds_read_b64_tr_b16 a[198:199], v55 offset:8448
    s_xor_b32 s78, s75, 2097152
    s_add_u32 s78, s78, s67
    s_add_u32 s80, s66, 0
    s_mov_b32 s76, 0
    s_mov_b32 s77, 8192
    s_call_b64 s[82:83], cf_dma
    ds_read_b64_tr_b16 a[200:201], v56 offset:0
    ds_read_b64_tr_b16 a[202:203], v56 offset:256
    ds_read_b64_tr_b16 a[204:205], v56 offset:8192
    ds_read_b64_tr_b16 a[206:207], v56 offset:8448
    s_mov_b32 s77, 16384
    s_call_b64 s[82:83], cf_dma
    v_cmp_eq_u32 vcc, 0, v29
    s_nop 1
    v_cndmask_b32 v16, 0, v31, vcc
    v_cmp_eq_u32 vcc, 1, v29
    s_nop 1
    v_cndmask_b32 v16, v16, v32, vcc
    v_cmp_eq_u32 vcc, 0, v28
    s_nop 1
    v_cndmask_b32 v20, 0, v31, vcc
    v_cmp_eq_u32 vcc, 1, v28
    s_nop 1
    v_cndmask_b32 v20, v20, v32, vcc
    s_nop 1
    s_waitcnt lgkmcnt(0)
    v_add_u32 v55, 131072, v51
    v_xor_b32 v56, 32, v55
    ds_read_b64_tr_b16 a[208:209], v55 offset:0
    ds_read_b64_tr_b16 a[210:211], v55 offset:256
    ds_read_b64_tr_b16 a[212:213], v55 offset:8192
    ds_read_b64_tr_b16 a[214:215], v55 offset:8448
    s_mov_b32 s77, 24576
    s_call_b64 s[82:83], cf_dma
    ds_read_b64_tr_b16 a[216:217], v56 offset:0
    ds_read_b64_tr_b16 a[218:219], v56 offset:256
    ds_read_b64_tr_b16 a[220:221], v56 offset:8192
    ds_read_b64_tr_b16 a[222:223], v56 offset:8448
    s_mov_b32 s77, 32768
    s_call_b64 s[82:83], cf_dma
    v_cmp_eq_u32 vcc, 2, v29
    s_nop 1
    v_cndmask_b32 v17, 0, v31, vcc
    v_cmp_eq_u32 vcc, 3, v29
    s_nop 1
    v_cndmask_b32 v17, v17, v32, vcc
    v_cmp_eq_u32 vcc, 2, v28
    s_nop 1
    v_cndmask_b32 v21, 0, v31, vcc
    v_cmp_eq_u32 vcc, 3, v28
    s_nop 1
    v_cndmask_b32 v21, v21, v32, vcc
    s_nop 1
    s_waitcnt lgkmcnt(0)
    s_waitcnt vmcnt(8)
    v_add_u32 v55, 65536, v51
    v_xor_b32 v56, 32, v55
    ds_read_b64_tr_b16 a[224:225], v55 offset:0
    ds_read_b64_tr_b16 a[226:227], v55 offset:256
    ds_read_b64_tr_b16 a[228:229], v55 offset:8192
    ds_read_b64_tr_b16 a[230:231], v55 offset:8448
    s_cmp_eq_u32 s88, 0
    s_cbranch_scc1 cf_cpe626
    s_lshl_b32 s89, s73, 7
    s_add_u32 s89, s89, 125853696
    v_min_u32 v33, 11, v57
    v_lshlrev_b32 v33, 2, v33
    buffer_load_dword v34, off, s[96:99], 0 offset:64 sc1
    buffer_load_dword v35, v33, s[4:7], s89 offen sc1
cf_cpe626:
    s_xor_b32 s78, s75, 3145728
    s_add_u32 s78, s78, s67
    s_add_u32 s80, s66, 32768
    s_mov_b32 s76, 0
    s_mov_b32 s77, 8192
    s_call_b64 s[82:83], cf_dma
    ds_read_b64_tr_b16 a[232:233], v56 offset:0
    ds_read_b64_tr_b16 a[234:235], v56 offset:256
    ds_read_b64_tr_b16 a[236:237], v56 offset:8192
    ds_read_b64_tr_b16 a[238:239], v56 offset:8448
    s_mov_b32 s77, 16384
    s_call_b64 s[82:83], cf_dma
    v_cmp_eq_u32 vcc, 8, v29
    s_nop 1
    v_cndmask_b32 v18, 0, v31, vcc
    v_cmp_eq_u32 vcc, 9, v29
    s_nop 1
    v_cndmask_b32 v18, v18, v32, vcc
    v_cmp_eq_u32 vcc, 4, v28
    s_nop 1
    v_cndmask_b32 v22, 0, v31, vcc
    v_cmp_eq_u32 vcc, 5, v28
    s_nop 1
    v_cndmask_b32 v22, v22, v32, vcc
    s_nop 1
    s_waitcnt lgkmcnt(0)
    v_add_u32 v55, 81920, v51
    v_xor_b32 v56, 32, v55
    ds_read_b64_tr_b16 a[240:241], v55 offset:0
    ds_read_b64_tr_b16 a[242:243], v55 offset:256
    ds_read_b64_tr_b16 a[244:245], v55 offset:8192
    ds_read_b64_tr_b16 a[246:247], v55 offset:8448
    s_mov_b32 s77, 24576
    s_call_b64 s[82:83], cf_dma
    ds_read_b64_tr_b16 a[248:249], v56 offset:0
    ds_read_b64_tr_b16 a[250:251], v56 offset:256
    ds_read_b64_tr_b16 a[252:253], v56 offset:8192
    ds_read_b64_tr_b16 a[254:255], v56 offset:8448
    s_mov_b32 s77, 32768
    s_call_b64 s[82:83], cf_dma
    v_cmp_eq_u32 vcc, 10, v29
    s_nop 1
    v_cndmask_b32 v19, 0, v31, vcc
    v_cmp_eq_u32 vcc, 11, v29
    s_nop 1
    v_cndmask_b32 v19, v19, v32, vcc
    v_cmp_eq_u32 vcc, 6, v28
    s_nop 1
    v_cndmask_b32 v23, 0, v31, vcc
    v_cmp_eq_u32 vcc, 7, v28
    s_nop 1
    v_cndmask_b32 v23, v23, v32, vcc
    s_nop 1
    s_waitcnt lgkmcnt(0)
    s_waitcnt vmcnt(8)
    v_add_u32 v55, 0, v51
    v_xor_b32 v56, 32, v55
    ds_read_b64_tr_b16 v[80:81], v55 offset:0
    ds_read_b64_tr_b16 v[82:83], v55 offset:256
    ds_read_b64_tr_b16 v[84:85], v55 offset:8192
    ds_read_b64_tr_b16 v[86:87], v55 offset:8448
    s_cmp_eq_u32 s88, 0
    s_cbranch_scc1 cf_ncp696
    s_waitcnt vmcnt(8)
    v_max_u32 v34, 1, v34
    v_cmp_eq_u32 vcc, 1, v34
    s_cbranch_vccnz cf_ncp696
    v_cmp_ne_u32 vcc, v34, v35
    s_cbranch_vccnz cf_ncp696
    s_mov_b32 s88, 0
    s_mov_b32 s72, 5
    s_lshl_b32 s74, s73, 19
    s_add_u32 s74, s74, 96468992
    s_add_u32 s50, s4, s74
    s_addc_u32 s51, s5, 0
    s_add_u32 s52, s50, 147456
    s_addc_u32 s53, s51, 0
    s_lshl_b32 s67, s13, 6
    v_and_b32 v54, 63, v48
    v_lshrrev_b32 v48, 13, v48
    v_lshl_add_u32 v48, v48, 8, v54
cf_ncp696:
    s_cmp_eq_u32 s88, 0
    s_cbranch_scc1 cf_cpe717
    s_lshl_b32 s89, s73, 7
    s_add_u32 s89, s89, 125853696
    v_min_u32 v33, 11, v57
    v_lshlrev_b32 v33, 2, v33
    buffer_load_dword v34, off, s[96:99], 0 offset:64 sc1
    buffer_load_dword v35, v33, s[4:7], s89 offen sc1
cf_cpe717:
    s_xor_b32 s78, s75, 2097152
    s_lshr_b32 s78, s78, s72
    s_add_u32 s78, s78, s67
    s_mov_b64 s[8:9], s[52:53]
    v_mov_b32 v58, v48
    s_lshr_b32 s79, 131072, s72
    s_add_u32 s80, s66, 131072
    s_mov_b32 s76, 0
    s_mov_b32 s77, 8192
    s_call_b64 s[82:83], cf_dma
    ds_read_b64_tr_b16 v[88:89], v56 offset:0
    ds_read_b64_tr_b16 v[90:91], v56 offset:256
    ds_read_b64_tr_b16 v[92:93], v56 offset:8192
    ds_read_b64_tr_b16 v[94:95], v56 offset:8448
    s_mov_b32 s77, 16384
    s_call_b64 s[82:83], cf_dma
    v_mov_b32 v46, 1
    s_mov_b64 exec, 1
    buffer_atomic_add v46, off, s[96:99], 0 offset:132 sc0
    s_mov_b64 exec, -1
    s_waitcnt lgkmcnt(0)
    v_add_u32 v55, 16384, v51
    v_xor_b32 v56, 32, v55
    ds_read_b64_tr_b16 v[96:97], v55 offset:0
    ds_read_b64_tr_b16 v[98:99], v55 offset:256
    ds_read_b64_tr_b16 v[100:101], v55 offset:8192
    ds_read_b64_tr_b16 v[102:103], v55 offset:8448
    s_mov_b32 s77, 24576
    s_call_b64 s[82:83], cf_dma
    ds_read_b64_tr_b16 v[104:105], v56 offset:0
    ds_read_b64_tr_b16 v[106:107], v56 offset:256
    ds_read_b64_tr_b16 v[108:109], v56 offset:8192
    ds_read_b64_tr_b16 v[110:111], v56 offset:8448
    s_mov_b32 s77, 32768
    s_call_b64 s[82:83], cf_dma
    s_waitcnt lgkmcnt(0)
    s_waitcnt vmcnt(9)
    v_add_u32 v55, 32768, v51
    v_xor_b32 v56, 32, v55
    ds_read_b64_tr_b16 v[112:113], v55 offset:0
    ds_read_b64_tr_b16 v[114:115], v55 offset:256
    ds_read_b64_tr_b16 v[116:117], v55 offset:8192
    ds_read_b64_tr_b16 v[118:119], v55 offset:8448
    s_cmp_eq_u32 s88, 0
    s_cbranch_scc1 cf_ncp769
    s_waitcnt vmcnt(9)
    v_max_u32 v34, 1, v34
    v_cmp_eq_u32 vcc, 1, v34
    s_cbranch_vccnz cf_ncp769
    v_cmp_ne_u32 vcc, v34, v35
    s_cbranch_vccnz cf_ncp769
    s_mov_b32 s88, 0
    s_mov_b32 s72, 5
    s_lshl_b32 s74, s73, 19
    s_add_u32 s74, s74, 96468992
    s_add_u32 s50, s4, s74
    s_addc_u32 s51, s5, 0
    s_add_u32 s52, s50, 147456
    s_addc_u32 s53, s51, 0
    s_lshl_b32 s67, s13, 6
    v_and_b32 v54, 63, v48
    v_lshrrev_b32 v48, 13, v48
    v_lshl_add_u32 v48, v48, 8, v54
cf_ncp769:
    s_cmp_eq_u32 s88, 0
    s_cbranch_scc1 cf_cpe790
    s_lshl_b32 s89, s73, 7
    s_add_u32 s89, s89, 125853696
    v_min_u32 v33, 11, v57
    v_lshlrev_b32 v33, 2, v33
    buffer_load_dword v34, off, s[96:99], 0 offset:64 sc1
    buffer_load_dword v35, v33, s[4:7], s89 offen sc1
cf_cpe790:
    s_xor_b32 s78, s75, 3145728
    s_lshr_b32 s78, s78, s72
    s_add_u32 s78, s78, s67
    s_mov_b64 s[8:9], s[52:53]
    v_mov_b32 v58, v48
    s_lshr_b32 s79, 131072, s72
    s_add_u32 s80, s66, 65536
    s_mov_b32 s76, 0
    s_mov_b32 s77, 8192
    s_call_b64 s[82:83], cf_dma
    ds_read_b64_tr_b16 v[120:121], v56 offset:0
    ds_read_b64_tr_b16 v[122:123], v56 offset:256
    ds_read_b64_tr_b16 v[124:125], v56 offset:8192
    ds_read_b64_tr_b16 v[126:127], v56 offset:8448
    s_mov_b32 s77, 16384
    s_call_b64 s[82:83], cf_dma
    s_waitcnt lgkmcnt(0)
    v_add_u32 v55, 49152, v51
    v_xor_b32 v56, 32, v55
    ds_read_b64_tr_b16 v[128:129], v55 offset:0
    ds_read_b64_tr_b16 v[130:131], v55 offset:256
    ds_read_b64_tr_b16 v[132:133], v55 offset:8192
    ds_read_b64_tr_b16 v[134:135], v55 offset:8448
    s_mov_b32 s77, 24576
    s_call_b64 s[82:83], cf_dma
    ds_read_b64_tr_b16 v[136:137], v56 offset:0
    ds_read_b64_tr_b16 v[138:139], v56 offset:256
    ds_read_b64_tr_b16 v[140:141], v56 offset:8192
    ds_read_b64_tr_b16 v[142:143], v56 offset:8448
    s_mov_b32 s77, 32768
    s_call_b64 s[82:83], cf_dma
    s_waitcnt lgkmcnt(0)
    s_waitcnt vmcnt(8)
    v_add_u32 v55, 131072, v51
    v_xor_b32 v56, 32, v55
    ds_read_b64_tr_b16 a[128:129], v55 offset:0
    ds_read_b64_tr_b16 a[130:131], v55 offset:256
    ds_read_b64_tr_b16 a[132:133], v55 offset:8192
    ds_read_b64_tr_b16 a[134:135], v55 offset:8448
    s_cmp_eq_u32 s88, 0
    s_cbranch_scc1 cf_ncp838
    s_waitcnt vmcnt(8)
    v_max_u32 v34, 1, v34
    v_cmp_eq_u32 vcc, 1, v34
    s_cbranch_vccnz cf_ncp838
    v_cmp_ne_u32 vcc, v34, v35
    s_cbranch_vccnz cf_ncp838
    s_mov_b32 s88, 0
    s_mov_b32 s72, 5
    s_lshl_b32 s74, s73, 19
    s_add_u32 s74, s74, 96468992
    s_add_u32 s50, s4, s74
    s_addc_u32 s51, s5, 0
    s_add_u32 s52, s50, 147456
    s_addc_u32 s53, s51, 0
    s_lshl_b32 s67, s13, 6
    v_and_b32 v54, 63, v48
    v_lshrrev_b32 v48, 13, v48
    v_lshl_add_u32 v48, v48, 8, v54
cf_ncp838:
    s_cmp_eq_u32 s88, 0
    s_cbranch_scc1 cf_cpe859
    s_lshl_b32 s89, s73, 7
    s_add_u32 s89, s89, 125853696
    v_min_u32 v33, 11, v57
    v_lshlrev_b32 v33, 2, v33
    buffer_load_dword v34, off, s[96:99], 0 offset:64 sc1
    buffer_load_dword v35, v33, s[4:7], s89 offen sc1
cf_cpe859:
    s_xor_b32 s78, s75, 2097152
    s_lshr_b32 s78, s78, s72
    s_add_u32 s78, s78, s67
    s_mov_b64 s[8:9], s[50:51]
    v_mov_b32 v58, v48
    s_lshr_b32 s79, 131072, s72
    s_add_u32 s80, s66, 0
    s_mov_b32 s76, 0
    s_mov_b32 s77, 8192
    s_call_b64 s[82:83], cf_dma
    ds_read_b64_tr_b16 a[136:137], v56 offset:0
    ds_read_b64_tr_b16 a[138:139], v56 offset:256
    ds_read_b64_tr_b16 a[140:141], v56 offset:8192
    ds_read_b64_tr_b16 a[142:143], v56 offset:8448
    s_mov_b32 s77, 16384
    s_call_b64 s[82:83], cf_dma
    s_waitcnt lgkmcnt(0)
    v_add_u32 v55, 147456, v51
    v_xor_b32 v56, 32, v55
    ds_read_b64_tr_b16 a[144:145], v55 offset:0
    ds_read_b64_tr_b16 a[146:147], v55 offset:256
    ds_read_b64_tr_b16 a[148:149], v55 offset:8192
    ds_read_b64_tr_b16 a[150:151], v55 offset:8448
    s_mov_b32 s77, 24576
    s_call_b64 s[82:83], cf_dma
    ds_read_b64_tr_b16 a[152:153], v56 offset:0
    ds_read_b64_tr_b16 a[154:155], v56 offset:256
    ds_read_b64_tr_b16 a[156:157], v56 offset:8192
    ds_read_b64_tr_b16 a[158:159], v56 offset:8448
    s_mov_b32 s77, 32768
    s_call_b64 s[82:83], cf_dma
    s_waitcnt lgkmcnt(0)
    s_waitcnt vmcnt(8)
    v_add_u32 v55, 65536, v51
    v_xor_b32 v56, 32, v55
    ds_read_b64_tr_b16 a[160:161], v55 offset:0
    ds_read_b64_tr_b16 a[162:163], v55 offset:256
    ds_read_b64_tr_b16 a[164:165], v55 offset:8192
    ds_read_b64_tr_b16 a[166:167], v55 offset:8448
    s_cmp_eq_u32 s88, 0
    s_cbranch_scc1 cf_ncp907
    s_waitcnt vmcnt(8)
    v_max_u32 v34, 1, v34
    v_cmp_eq_u32 vcc, 1, v34
    s_cbranch_vccnz cf_ncp907
    v_cmp_ne_u32 vcc, v34, v35
    s_cbranch_vccnz cf_ncp907
    s_mov_b32 s88, 0
    s_mov_b32 s72, 5
    s_lshl_b32 s74, s73, 19
    s_add_u32 s74, s74, 96468992
    s_add_u32 s50, s4, s74
    s_addc_u32 s51, s5, 0
    s_add_u32 s52, s50, 147456
    s_addc_u32 s53, s51, 0
    s_lshl_b32 s67, s13, 6
    v_and_b32 v54, 63, v48
    v_lshrrev_b32 v48, 13, v48
    v_lshl_add_u32 v48, v48, 8, v54
cf_ncp907:
    s_cmp_eq_u32 s88, 0
    s_cbranch_scc1 cf_cpe928
    s_lshl_b32 s89, s73, 7
    s_add_u32 s89, s89, 125853696
    v_min_u32 v33, 11, v57
    v_lshlrev_b32 v33, 2, v33
    buffer_load_dword v34, off, s[96:99], 0 offset:64 sc1
    buffer_load_dword v35, v33, s[4:7], s89 offen sc1
cf_cpe928:
    s_xor_b32 s78, s75, 3145728
    s_lshr_b32 s78, s78, s72
    s_add_u32 s78, s78, s67
    s_mov_b64 s[8:9], s[50:51]
    v_mov_b32 v58, v48
    s_lshr_b32 s79, 131072, s72
    s_add_u32 s80, s66, 32768
    s_mov_b32 s76, 0
    s_mov_b32 s77, 8192
    s_call_b64 s[82:83], cf_dma
    ds_read_b64_tr_b16 a[168:169], v56 offset:0
    ds_read_b64_tr_b16 a[170:171], v56 offset:256
    ds_read_b64_tr_b16 a[172:173], v56 offset:8192
    ds_read_b64_tr_b16 a[174:175], v56 offset:8448
    s_mov_b32 s77, 16384
    s_call_b64 s[82:83], cf_dma
    v_readfirstlane_b32 s41, v46
    v_mov_b32 v46, 1
    v_mov_b32 v47, 0
    s_cmp_eq_u32 s41, 127
    s_cselect_b64 exec, 1, 0
    buffer_atomic_cmpswap v[46:47], off, s[96:99], 0 offset:140
    s_mov_b64 exec, -1
    s_waitcnt lgkmcnt(0)
    v_add_u32 v55, 81920, v51
    v_xor_b32 v56, 32, v55
    ds_read_b64_tr_b16 a[176:177], v55 offset:0
    ds_read_b64_tr_b16 a[178:179], v55 offset:256
    ds_read_b64_tr_b16 a[180:181], v55 offset:8192
    ds_read_b64_tr_b16 a[182:183], v55 offset:8448
    s_mov_b32 s77, 24576
    s_call_b64 s[82:83], cf_dma
    ds_read_b64_tr_b16 a[184:185], v56 offset:0
    ds_read_b64_tr_b16 a[186:187], v56 offset:256
    ds_read_b64_tr_b16 a[188:189], v56 offset:8192
    ds_read_b64_tr_b16 a[190:191], v56 offset:8448
    s_mov_b32 s77, 32768
    s_call_b64 s[82:83], cf_dma
    s_waitcnt lgkmcnt(0)
    s_waitcnt vmcnt(8)
    v_add_u32 v55, 0, v51
    v_xor_b32 v56, 32, v55
    ds_read_b64_tr_b16 a[48:49], v55 offset:0
    ds_read_b64_tr_b16 a[50:51], v55 offset:256
    ds_read_b64_tr_b16 a[52:53], v55 offset:8192
    ds_read_b64_tr_b16 a[54:55], v55 offset:8448
    s_lshr_b32 s78, 4194304, s72
    s_add_u32 s78, s78, s67
    s_mov_b32 s81, 0
    s_add_u32 s80, s66, 98304
    s_mov_b32 s76, 0
    s_mov_b32 s77, 8192
    s_call_b64 s[82:83], cf_dma
    ds_read_b64_tr_b16 a[56:57], v56 offset:0
    ds_read_b64_tr_b16 a[58:59], v56 offset:256
    ds_read_b64_tr_b16 a[60:61], v56 offset:8192
    ds_read_b64_tr_b16 a[62:63], v56 offset:8448
    s_mov_b32 s77, 16384
    s_call_b64 s[82:83], cf_dma
    s_waitcnt lgkmcnt(0)
    v_add_u32 v55, 16384, v51
    v_xor_b32 v56, 32, v55
    ds_read_b64_tr_b16 a[64:65], v55 offset:0
    ds_read_b64_tr_b16 a[66:67], v55 offset:256
    ds_read_b64_tr_b16 a[68:69], v55 offset:8192
    ds_read_b64_tr_b16 a[70:71], v55 offset:8448
    s_cmp_eq_u32 s88, 0
    s_cbranch_scc1 cf_ncp1003
    s_waitcnt vmcnt(12)
    v_max_u32 v34, 1, v34
    v_cmp_eq_u32 vcc, 1, v34
    s_cbranch_vccnz cf_ncp1003
    v_cmp_ne_u32 vcc, v34, v35
    s_cbranch_vccnz cf_ncp1003
    s_mov_b32 s88, 0
    s_mov_b32 s72, 5
    s_lshl_b32 s74, s73, 19
    s_add_u32 s74, s74, 96468992
    s_add_u32 s50, s4, s74
    s_addc_u32 s51, s5, 0
    s_add_u32 s52, s50, 147456
    s_addc_u32 s53, s51, 0
    s_lshl_b32 s67, s13, 6
    v_and_b32 v54, 63, v48
    v_lshrrev_b32 v48, 13, v48
    v_lshl_add_u32 v48, v48, 8, v54
cf_ncp1003:
    s_xor_b32 s78, s75, 1048576
    s_lshr_b32 s78, s78, s72
    s_add_u32 s78, s78, s67
    s_mov_b64 s[8:9], s[50:51]
    v_mov_b32 v58, v48
    s_lshr_b32 s79, 131072, s72
    s_mov_b32 s81, s93
    s_add_u32 s80, s66, 114688
    s_mov_b32 s76, 0
    s_mov_b32 s77, 8192
    s_call_b64 s[82:83], cf_dma
    ds_read_b64_tr_b16 a[72:73], v56 offset:0
    ds_read_b64_tr_b16 a[74:75], v56 offset:256
    ds_read_b64_tr_b16 a[76:77], v56 offset:8192
    ds_read_b64_tr_b16 a[78:79], v56 offset:8448
    s_mov_b32 s77, 16384
    s_call_b64 s[82:83], cf_dma
    s_waitcnt lgkmcnt(0)
    s_waitcnt vmcnt(8)
    v_add_u32 v55, 32768, v51
    v_xor_b32 v56, 32, v55
    ds_read_b64_tr_b16 a[80:81], v55 offset:0
    ds_read_b64_tr_b16 a[82:83], v55 offset:256
    ds_read_b64_tr_b16 a[84:85], v55 offset:8192
    ds_read_b64_tr_b16 a[86:87], v55 offset:8448
    s_mov_b32 s77, 24576
    s_call_b64 s[82:83], cf_dma
    ds_read_b64_tr_b16 a[88:89], v56 offset:0
    ds_read_b64_tr_b16 a[90:91], v56 offset:256
    ds_read_b64_tr_b16 a[92:93], v56 offset:8192
    ds_read_b64_tr_b16 a[94:95], v56 offset:8448
    s_mov_b32 s77, 32768
    s_call_b64 s[82:83], cf_dma
    s_waitcnt lgkmcnt(0)
    v_add_u32 v55, 49152, v51
    v_xor_b32 v56, 32, v55
    ds_read_b64_tr_b16 a[96:97], v55 offset:0
    ds_read_b64_tr_b16 a[98:99], v55 offset:256
    ds_read_b64_tr_b16 a[100:101], v55 offset:8192
    ds_read_b64_tr_b16 a[102:103], v55 offset:8448
    s_xor_b32 s78, s75, 0
    s_lshr_b32 s78, s78, s72
    s_add_u32 s78, s78, s67
    s_add_u32 s80, s66, 65536
    s_mov_b32 s76, 0
    s_mov_b32 s77, 8192
    s_call_b64 s[82:83], cf_dma
    ds_read_b64_tr_b16 a[104:105], v56 offset:0
    ds_read_b64_tr_b16 a[106:107], v56 offset:256
    ds_read_b64_tr_b16 a[108:109], v56 offset:8192
    ds_read_b64_tr_b16 a[110:111], v56 offset:8448
    s_mov_b32 s77, 16384
    s_call_b64 s[82:83], cf_dma
    s_waitcnt lgkmcnt(0)
    s_waitcnt vmcnt(12)
    v_add_u32 v55, 98304, v51
    v_xor_b32 v56, 32, v55
    ds_read_b64_tr_b16 a[112:113], v55 offset:0
    ds_read_b64_tr_b16 a[114:115], v55 offset:256
    ds_read_b64_tr_b16 a[116:117], v55 offset:8192
    ds_read_b64_tr_b16 a[118:119], v55 offset:8448
    s_mov_b32 s77, 24576
    s_call_b64 s[82:83], cf_dma
    ds_read_b64_tr_b16 a[120:121], v56 offset:0
    ds_read_b64_tr_b16 a[122:123], v56 offset:256
    ds_read_b64_tr_b16 a[124:125], v56 offset:8192
    ds_read_b64_tr_b16 a[126:127], v56 offset:8448
    s_mov_b32 s77, 32768
    s_call_b64 s[82:83], cf_dma
    s_waitcnt lgkmcnt(0)
    s_waitcnt vmcnt(8)
    v_add_u32 v55, 114688, v51
    v_xor_b32 v56, 32, v55
    ds_read_b64_tr_b16 a[16:17], v55 offset:0
    ds_read_b64_tr_b16 a[18:19], v55 offset:256
    ds_read_b64_tr_b16 a[20:21], v55 offset:8192
    ds_read_b64_tr_b16 a[22:23], v55 offset:8448
    s_xor_b32 s78, s75, 0
    s_lshr_b32 s78, s78, s72
    s_add_u32 s78, s78, s67
    s_mov_b64 s[8:9], s[52:53]
    s_add_u32 s80, s66, 0
    s_mov_b32 s76, 0
    s_mov_b32 s77, 8192
    s_call_b64 s[82:83], cf_dma
    ds_read_b64_tr_b16 a[24:25], v56 offset:0
    ds_read_b64_tr_b16 a[26:27], v56 offset:256
    ds_read_b64_tr_b16 a[28:29], v56 offset:8192
    ds_read_b64_tr_b16 a[30:31], v56 offset:8448
    s_mov_b32 s77, 16384
    s_call_b64 s[82:83], cf_dma
    s_waitcnt lgkmcnt(0)
    v_add_u32 v55, 131072, v51
    v_xor_b32 v56, 32, v55
    ds_read_b64_tr_b16 a[32:33], v55 offset:0
    ds_read_b64_tr_b16 a[34:35], v55 offset:256
    ds_read_b64_tr_b16 a[36:37], v55 offset:8192
    ds_read_b64_tr_b16 a[38:39], v55 offset:8448
    s_mov_b32 s77, 24576
    s_call_b64 s[82:83], cf_dma
    ds_read_b64_tr_b16 a[40:41], v56 offset:0
    ds_read_b64_tr_b16 a[42:43], v56 offset:256
    ds_read_b64_tr_b16 a[44:45], v56 offset:8192
    ds_read_b64_tr_b16 a[46:47], v56 offset:8448
    s_mov_b32 s77, 32768
    s_call_b64 s[82:83], cf_dma
    s_waitcnt lgkmcnt(0)
    s_waitcnt vmcnt(8)
    v_add_u32 v55, 65536, v51
    v_xor_b32 v56, 32, v55
    ds_read_b64_tr_b16 v[0:1], v55 offset:0
    ds_read_b64_tr_b16 v[2:3], v55 offset:256
    ds_read_b64_tr_b16 v[4:5], v55 offset:8192
    ds_read_b64_tr_b16 v[6:7], v55 offset:8448
    s_xor_b32 s78, s75, 1048576
    s_lshr_b32 s78, s78, s72
    s_add_u32 s78, s78, s67
    s_add_u32 s80, s66, 32768
    s_mov_b32 s76, 0
    s_mov_b32 s77, 8192
    s_call_b64 s[82:83], cf_dma
    ds_read_b64_tr_b16 v[8:9], v56 offset:0
    ds_read_b64_tr_b16 v[10:11], v56 offset:256
    ds_read_b64_tr_b16 v[12:13], v56 offset:8192
    ds_read_b64_tr_b16 v[14:15], v56 offset:8448
    s_mov_b32 s77, 16384
    s_call_b64 s[82:83], cf_dma
    s_waitcnt lgkmcnt(0)
    ds_write_b128 v62, v[0:3] offset:8192
    ds_write_b128 v62, v[4:7] offset:12288
    ds_write_b128 v62, v[8:11] offset:16384
    ds_write_b128 v62, v[12:15] offset:20480
    s_waitcnt lgkmcnt(0)
    v_add_u32 v55, 81920, v51
    v_xor_b32 v56, 32, v55
    ds_read_b64_tr_b16 a[0:1], v55 offset:0
    ds_read_b64_tr_b16 a[2:3], v55 offset:256
    ds_read_b64_tr_b16 a[4:5], v55 offset:8192
    ds_read_b64_tr_b16 a[6:7], v55 offset:8448
    s_mov_b32 s77, 24576
    s_call_b64 s[82:83], cf_dma
    ds_read_b64_tr_b16 a[8:9], v56 offset:0
    ds_read_b64_tr_b16 a[10:11], v56 offset:256
    ds_read_b64_tr_b16 a[12:13], v56 offset:8192
    ds_read_b64_tr_b16 a[14:15], v56 offset:8448
    s_mov_b32 s77, 32768
    s_call_b64 s[82:83], cf_dma
    s_waitcnt lgkmcnt(0)
    s_waitcnt vmcnt(8)
    v_add_u32 v55, 0, v51
    v_xor_b32 v56, 32, v55
    ds_read_b64_tr_b16 v[0:1], v55 offset:0
    ds_read_b64_tr_b16 v[2:3], v55 offset:256
    ds_read_b64_tr_b16 v[4:5], v55 offset:8192
    ds_read_b64_tr_b16 v[6:7], v55 offset:8448
    s_xor_b32 s94, s13, 0
    s_mul_i32 s94, s94, 36864
    s_add_u32 s94, s94, s92
    s_lshr_b32 s74, s13, 1
    s_lshl_b32 s74, s74, 6
    s_add_u32 s94, s94, s74
    s_add_u32 s78, s94, 1024
    s_mov_b64 s[8:9], s[56:57]
    v_mov_b32 v58, v50
    s_mov_b32 s79, 18432
    s_mov_b32 s81, 0
    s_add_u32 s80, s66, 147456
    s_mov_b32 s76, 0
    s_mov_b32 s77, 8192
    s_call_b64 s[82:83], cf_dma
    ds_read_b64_tr_b16 v[8:9], v56 offset:0
    ds_read_b64_tr_b16 v[10:11], v56 offset:256
    ds_read_b64_tr_b16 v[12:13], v56 offset:8192
    ds_read_b64_tr_b16 v[14:15], v56 offset:8448
    s_xor_b32 s94, s13, 2
    s_mul_i32 s94, s94, 36864
    s_add_u32 s94, s94, s92
    s_lshr_b32 s74, s13, 1
    s_lshl_b32 s74, s74, 6
    s_add_u32 s94, s94, s74
    s_add_u32 s78, s94, 1024
    s_mov_b32 s77, 16384
    s_call_b64 s[82:83], cf_dma
    s_waitcnt lgkmcnt(0)
    ds_write_b128 v61, v[0:3] offset:0
    ds_write_b128 v61, v[4:7] offset:4096
    ds_write_b128 v61, v[8:11] offset:8192
    ds_write_b128 v61, v[12:15] offset:12288
    s_waitcnt lgkmcnt(0)
    v_add_u32 v55, 16384, v51
    v_xor_b32 v56, 32, v55
    ds_read_b64_tr_b16 v[0:1], v55 offset:0
    ds_read_b64_tr_b16 v[2:3], v55 offset:256
    ds_read_b64_tr_b16 v[4:5], v55 offset:8192
    ds_read_b64_tr_b16 v[6:7], v55 offset:8448
    s_xor_b32 s94, s13, 3
    s_mul_i32 s94, s94, 36864
    s_add_u32 s94, s94, s92
    s_lshl_b32 s74, s13, 7
    s_add_u32 s94, s94, s74
    s_add_u32 s78, s94, 512
    v_mov_b32 v58, v49
    s_mov_b32 s79, 9216
    s_add_u32 s80, s66, 131072
    s_mov_b32 s76, 0
    s_mov_b32 s77, 8192
    s_call_b64 s[82:83], cf_dma
    ds_read_b64_tr_b16 v[8:9], v56 offset:0
    ds_read_b64_tr_b16 v[10:11], v56 offset:256
    ds_read_b64_tr_b16 v[12:13], v56 offset:8192
    ds_read_b64_tr_b16 v[14:15], v56 offset:8448
    s_mov_b32 s77, 16384
    s_call_b64 s[82:83], cf_dma
    s_waitcnt lgkmcnt(0)
    ds_write_b128 v61, v[0:3] offset:16384
    ds_write_b128 v61, v[4:7] offset:20480
    ds_write_b128 v61, v[8:11] offset:24576
    ds_write_b128 v61, v[12:15] offset:28672
    s_waitcnt lgkmcnt(0)
    s_waitcnt vmcnt(8)
    v_add_u32 v55, 32768, v51
    v_xor_b32 v56, 32, v55
    ds_read_b64_tr_b16 v[0:1], v55 offset:0
    ds_read_b64_tr_b16 v[2:3], v55 offset:256
    ds_read_b64_tr_b16 v[4:5], v55 offset:8192
    ds_read_b64_tr_b16 v[6:7], v55 offset:8448
    s_xor_b32 s94, s13, 2
    s_mul_i32 s94, s94, 36864
    s_add_u32 s94, s94, s92
    s_lshl_b32 s74, s13, 7
    s_add_u32 s94, s94, s74
    s_add_u32 s78, s94, 512
    s_add_u32 s80, s66, 114688
    s_mov_b32 s76, 0
    s_mov_b32 s77, 8192
    s_call_b64 s[82:83], cf_dma
    ds_read_b64_tr_b16 v[8:9], v56 offset:0
    ds_read_b64_tr_b16 v[10:11], v56 offset:256
    ds_read_b64_tr_b16 v[12:13], v56 offset:8192
    ds_read_b64_tr_b16 v[14:15], v56 offset:8448
    s_mov_b32 s77, 16384
    s_call_b64 s[82:83], cf_dma
    s_waitcnt lgkmcnt(0)
    ds_write_b128 v61, v[0:3] offset:32768
    ds_write_b128 v61, v[4:7] offset:36864
    ds_write_b128 v61, v[8:11] offset:40960
    ds_write_b128 v61, v[12:15] offset:45056
    s_waitcnt lgkmcnt(0)
    v_add_u32 v55, 49152, v51
    v_xor_b32 v56, 32, v55
    ds_read_b64_tr_b16 v[0:1], v55 offset:0
    ds_read_b64_tr_b16 v[2:3], v55 offset:256
    ds_read_b64_tr_b16 v[4:5], v55 offset:8192
    ds_read_b64_tr_b16 v[6:7], v55 offset:8448
    s_lshr_b32 s78, 4194304, s72
    s_add_u32 s78, s78, s67
    s_mov_b64 s[8:9], s[52:53]
    v_mov_b32 v58, v48
    s_lshr_b32 s79, 131072, s72
    s_add_u32 s80, s66, 81920
    s_mov_b32 s76, 0
    s_mov_b32 s77, 8192
    s_call_b64 s[82:83], cf_dma
    ds_read_b64_tr_b16 v[8:9], v56 offset:0
    ds_read_b64_tr_b16 v[10:11], v56 offset:256
    ds_read_b64_tr_b16 v[12:13], v56 offset:8192
    ds_read_b64_tr_b16 v[14:15], v56 offset:8448
    s_mov_b32 s77, 16384
    s_call_b64 s[82:83], cf_dma
    s_waitcnt lgkmcnt(0)
    ds_write_b128 v61, v[0:3] offset:49152
    ds_write_b128 v61, v[4:7] offset:53248
    ds_write_b128 v61, v[8:11] offset:57344
    ds_write_b128 v61, v[12:15] offset:61440
    s_waitcnt lgkmcnt(0)
    buffer_load_dword v24, off, s[96:99], 0 offset:140 sc1
    buffer_load_dword v25, off, s[96:99], 0 offset:64 sc1
    s_lshr_b32 s84, s12, 1
    s_lshl_b32 s84, s84, 8
    s_add_u32 s84, s84, 125829120
    v_bfe_u32 v26, v61, 4, 6
    v_min_u32 v26, 11, v26
    v_lshlrev_b32 v26, 2, v26
    buffer_load_dword v27, v26, s[4:7], s84 offen sc1
    s_waitcnt vmcnt(15)
    v_add_u32 v55, 147456, v53
    ds_read_b64_tr_b16 v[0:1], v55 offset:0
    ds_read_b64_tr_b16 v[2:3], v55 offset:128
    ds_read_b64_tr_b16 v[4:5], v55 offset:512
    ds_read_b64_tr_b16 v[6:7], v55 offset:640
    ds_read_b64_tr_b16 v[8:9], v55 offset:8192
    ds_read_b64_tr_b16 v[10:11], v55 offset:8320
    ds_read_b64_tr_b16 v[12:13], v55 offset:8704
    ds_read_b64_tr_b16 v[14:15], v55 offset:8832
    s_waitcnt lgkmcnt(0)
    s_barrier
    ds_write_b128 v63, v[0:3] offset:49152
    ds_write_b128 v63, v[4:7] offset:53248
    s_barrier
    ds_write_b128 v63, v[8:11] offset:57344
    ds_write_b128 v63, v[12:15] offset:61440
    s_waitcnt lgkmcnt(0)
    v_lshlrev_b32 v45, 3, v61
    s_lshl_b32 s40, s12, 14
    s_add_u32 s40, s40, 65536
    s_lshl_b32 s41, s12, 11
    s_sub_u32 s41, s41, 12288
    v_add_u32 v30, s40, v45
    v_add_u32 v45, s41, v45
    v_cmp_gt_u32 vcc, 1536, v61
    s_nop 1
    v_cndmask_b32 v45, v45, v30, vcc
    s_lshl_b32 s40, s12, 16
    s_add_u32 s40, s40, 25151488
    v_lshlrev_b32 v30, 3, v61
    v_add_u32 v30, s40, v30
    v_cmp_gt_u32 vcc, 1792, v61
    s_nop 1
    v_cndmask_b32 v45, v30, v45, vcc
    v_cmp_gt_u32 vcc, 2944, v61
    s_mov_b32 s40, 67108864
    s_mov_b64 exec, vcc
    buffer_load_dword v30, v45, s[4:7], s40 offen sc1
    s_mov_b64 exec, -1
    s_waitcnt vmcnt(11)
    v_add_u32 v55, 131072, v52
    ds_read_b64_tr_b16 v[0:1], v55 offset:0
    ds_read_b64_tr_b16 v[2:3], v55 offset:256
    ds_read_b64_tr_b16 v[4:5], v55 offset:4096
    ds_read_b64_tr_b16 v[6:7], v55 offset:4352
    ds_read_b64_tr_b16 v[8:9], v55 offset:64
    ds_read_b64_tr_b16 v[10:11], v55 offset:320
    ds_read_b64_tr_b16 v[12:13], v55 offset:4160
    ds_read_b64_tr_b16 v[14:15], v55 offset:4416
    s_waitcnt lgkmcnt(0)
    s_barrier
    ds_write_b128 v63, v[0:3] offset:32768
    ds_write_b128 v63, v[4:7] offset:36864
    s_barrier
    ds_write_b128 v63, v[8:11] offset:40960
    ds_write_b128 v63, v[12:15] offset:45056
    s_waitcnt lgkmcnt(0)
    s_waitcnt vmcnt(7)
    v_add_u32 v55, 114688, v52
    ds_read_b64_tr_b16 v[0:1], v55 offset:0
    ds_read_b64_tr_b16 v[2:3], v55 offset:256
    ds_read_b64_tr_b16 v[4:5], v55 offset:4096
    ds_read_b64_tr_b16 v[6:7], v55 offset:4352
    ds_read_b64_tr_b16 v[8:9], v55 offset:64
    ds_read_b64_tr_b16 v[10:11], v55 offset:320
    ds_read_b64_tr_b16 v[12:13], v55 offset:4160
    ds_read_b64_tr_b16 v[14:15], v55 offset:4416
    s_waitcnt lgkmcnt(0)
    s_barrier
    ds_write_b128 v63, v[0:3] offset:16384
    ds_write_b128 v63, v[4:7] offset:20480
    s_barrier
    ds_write_b128 v63, v[8:11] offset:24576
    ds_write_b128 v63, v[12:15] offset:28672
    s_waitcnt lgkmcnt(0)
    v_min_u32 v36, -2, v36
    v_min_u32 v37, -2, v37
    v_min_u32 v38, -2, v38
    v_min_u32 v39, -2, v39
    v_min_u32 v40, -2, v40
    v_min_u32 v41, -2, v41
    v_min_u32 v42, -2, v42
    v_min_u32 v43, -2, v43
    v_min_u32 v44, -2, v44
    s_lshl_b32 s14, s12, 16
    s_add_u32 s14, s14, 92274688
    s_add_u32 s41, s14, 4096
    s_add_u32 s42, s14, 8192
    v_lshrrev_b32 v45, 2, v61
    buffer_store_dwordx4 v[36:39], v61, s[4:7], s14 offen
    buffer_store_dwordx4 v[40:43], v61, s[4:7], s41 offen
    buffer_store_dword v44, v45, s[4:7], s42 offen
    s_waitcnt vmcnt(1)
    v_readfirstlane_b32 s95, v25
    v_readfirstlane_b32 s85, v24
    s_add_u32 s86, s95, 2
    s_waitcnt vmcnt(0)
    v_subrev_u32 v27, s86, v27
    v_cmp_lt_u32 s[86:87], 64, v27
    s_cmp_eq_u32 s95, 0
    s_cselect_b64 s[86:87], -1, s[86:87]
    s_cmp_lg_u64 s[86:87], 0
    s_cbranch_scc1 cf_nt
    s_add_u32 s40, s24, 524288
    buffer_load_dword v30, v79, s[4:7], s24 offen sc1
    buffer_load_dword v30, v79, s[4:7], s40 offen sc1
cf_nt:
    s_waitcnt vmcnt(3)
    v_add_u32 v55, 81920, v51
    v_xor_b32 v56, 32, v55
    ds_read_b64_tr_b16 v[0:1], v55 offset:0
    ds_read_b64_tr_b16 v[2:3], v55 offset:256
    ds_read_b64_tr_b16 v[4:5], v55 offset:8192
    ds_read_b64_tr_b16 v[6:7], v55 offset:8448
    ds_read_b64_tr_b16 v[8:9], v56 offset:0
    ds_read_b64_tr_b16 v[10:11], v56 offset:256
    ds_read_b64_tr_b16 v[12:13], v56 offset:8192
    ds_read_b64_tr_b16 v[14:15], v56 offset:8448
    s_waitcnt lgkmcnt(0)
    ds_write_b128 v62, v[0:3] offset:24576
    ds_write_b128 v62, v[4:7] offset:28672
    ds_write_b128 v62, v[8:11] offset:32768
    ds_write_b128 v62, v[12:15] offset:36864
    s_waitcnt lgkmcnt(0)
    s_barrier
    s_mov_b32 s88, 4194304
gn2:
    s_cmp_lg_u32 s95, 0
    s_cbranch_scc1 gn2x
    buffer_load_dword v27, off, s[96:99], 0 offset:64 sc1
    s_sub_u32 s88, s88, 1
    s_cbranch_scc1 gn2x
    s_waitcnt vmcnt(0)
    v_readfirstlane_b32 s95, v27
    s_nop 1
    s_branch gn2
gn2x:
    ds_write_b128 v78, v[16:19] offset:8704
    ds_write_b128 v65, v[20:23] offset:10240
    v_mov_b32 v44, s95
    v_mov_b32 v45, s95
    v_mov_b32 v46, s95
    v_mov_b32 v47, s95
    v_mov_b32 v48, 108288
    ds_write_b128 v48, v[44:47]
    s_waitcnt vmcnt(0) lgkmcnt(0)
    s_cmp_eq_u32 s85, 1
    s_cbranch_scc1 cf_run
    s_mov_b32 s40, 131072
cf_startpoll:
    buffer_load_dword v3, off, s[96:99], 0 offset:140 sc1
    s_waitcnt vmcnt(0)
    v_readfirstlane_b32 s85, v3
    s_nop 0
    s_cmp_eq_u32 s85, 1
    s_cbranch_scc1 cf_run
    s_cmp_eq_u32 s85, 2
    s_cbranch_scc1 cf_leave
    s_sleep 1
    s_sub_u32 s40, s40, 1
    s_cbranch_scc0 cf_startpoll
    v_mov_b32 v4, 2
    v_mov_b32 v5, 0
    s_mov_b64 exec, 1
    buffer_atomic_cmpswap v[4:5], off, s[96:99], 0 offset:140
    s_mov_b64 exec, -1
    s_mov_b32 s40, 1048576
    s_branch cf_startpoll
cf_leave:
    v_lshrrev_b32 v0, 4, v61
    s_mov_b32 s32, s13
    s_load_dwordx16 s[48:63], s[0:1], 0
    s_waitcnt lgkmcnt(0)
    s_branch L_helper
cf_run:
    s_cmp_eq_u64 s[86:87], 0
    s_cbranch_scc1 cf_kvok
    s_lshr_b32 s92, s12, 1
    s_lshl_b32 s92, s92, 8
    s_add_u32 s92, s92, 125829120
    v_bfe_u32 v2, v61, 4, 6
    v_min_u32 v2, 11, v2
    v_lshlrev_b32 v2, 2, v2
    s_add_u32 s93, s95, 2
    s_mov_b32 s94, 4194304
cf_kv0:
    buffer_load_dword v3, v2, s[4:7], s92 offen sc1
    s_sub_u32 s94, s94, 1
    s_cbranch_scc1 cf_kv0_go
    s_waitcnt vmcnt(0)
    v_subrev_u32 v3, s93, v3
    v_cmp_lt_u32 vcc, 64, v3
    s_cbranch_vccz cf_kv0_go
    s_sleep 2
    s_branch cf_kv0
cf_kv0_go:
    s_add_u32 s40, s24, 524288
    buffer_load_dword v30, v79, s[4:7], s24 offen sc1
    buffer_load_dword v30, v79, s[4:7], s40 offen sc1
    s_waitcnt vmcnt(0)
cf_kvok:
    s_mov_b32 m0, 108032
    s_add_u32 s24, s24, 1048576
    s_mov_b32 s66, 0x201
    s_mov_b32 s67, 0xc0000000
    s_add_u32 s15, s14, 4096
    s_add_u32 s16, s14, 8192
    ds_read_b128 v[32:35], v62 offset:16384
    ds_read_b128 v[36:39], v62 offset:20480
    ds_read_b128 v[40:43], v61 offset:0
    ds_read_b128 v[44:47], v61 offset:4096
    ds_read_b128 v[48:51], v61 offset:8192
    ds_read_b128 v[52:55], v61 offset:12288
    s_add_u32 s18, s14, s31
    s_mov_b32 s29, 1048576
    buffer_load_dwordx4 v[24:27], v61, s[4:7], s14 offen nt
.p2align 6
cf_loop:
    v_mov_b64 v[0:1], 0
    v_mov_b64 v[2:3], 0
    v_mov_b64 v[4:5], 0
    v_mov_b64 v[6:7], 0
    v_mov_b64 v[8:9], 0
    v_mov_b64 v[10:11], 0
    v_mov_b64 v[12:13], 0
    v_mov_b64 v[14:15], 0
cf_loop2:
    ds_read_b128 v[16:19], v62 offset:8192
    ds_read_b128 v[20:23], v62 offset:12288
    v_lshrrev_b32 v56, 2, v61
    v_add_u32 v58, 106496, v56
    s_mov_b32 s29, 1048576
    s_nop 13
    buffer_load_dwordx4 v[24:27], v61, s[4:7], s14 offen nt
    s_waitcnt lgkmcnt(0)
cf_chk0:
    s_waitcnt vmcnt(1)
cf_chk0b:
    v_max3_u32 v57, v24, v25, v26
    v_max_u32 v57, v57, v27
    v_cmp_eq_u32 vcc, -1, v57
    ds_write_b128 v62, v[24:27] offset:40960
    s_cbranch_vccnz cf_spin0
    v_smfmac_f32_16x16x64_bf16 v[0:3], v[24:27], v[16:23], v60
    s_mov_b32 m0, s58
    s_nop 0
    buffer_load_dwordx4 v61, s[4:7], s15 offen nt lds
    v_smfmac_f32_16x16x64_bf16 v[8:11], v[24:27], v[32:39], v60
    s_mov_b32 m0, s59
    s_nop 0
    buffer_load_dword v56, s[4:7], s16 offen nt lds
    v_smfmac_f32_16x16x64_bf16 v[12:15], v[24:27], v[48:55], v60
    ds_read_b128 v[32:35], v61 offset:16384
    v_mfma_f32_16x16x16_bf16 v[16:19], v[72:73], v[72:73], 0
    ds_read_b128 v[36:39], v61 offset:20480
    s_waitcnt lgkmcnt(2)
    s_barrier
    ds_read_b128 v[48:51], v63 offset:0
    v_mfma_f32_16x16x16_bf16 v[20:23], v[72:73], v[72:73], 0
    ds_read_b128 v[52:55], v64 offset:0
    v_smfmac_f32_16x16x64_bf16 v[4:7], v[24:27], v[40:47], v60
    ds_read_b128 v[40:43], v61 offset:24576
    v_smfmac_f32_16x16x64_bf16 v[16:19], v[24:27], a[192:199], v60
    ds_read_b128 v[44:47], v61 offset:28672
    v_smfmac_f32_16x16x64_bf16 v[20:23], v[24:27], a[200:207], v60
    s_mov_b32 m0, 108032
    s_waitcnt lgkmcnt(3)
    v_smfmac_f32_16x16x64_bf16 v[0:3], v[48:51], a[0:7], v60
    s_add_u32 s43, s14, s31
    s_add_u32 s41, s14, 16384
    v_smfmac_f32_16x16x64_bf16 v[4:7], v[48:51], v[32:39], v60
    ds_read_b128 v[32:35], v61 offset:32768
    v_smfmac_f32_16x16x64_bf16 v[8:11], v[48:51], a[8:15], v60
    ds_read_b128 v[36:39], v61 offset:36864
    s_waitcnt lgkmcnt(2)
    v_smfmac_f32_16x16x64_bf16 v[12:15], v[48:51], v[40:47], v60
    ds_read_b128 v[40:43], v61 offset:40960
    v_smfmac_f32_16x16x64_bf16 v[16:19], v[48:51], a[208:215], v60
    ds_read_b128 v[44:47], v61 offset:45056
    v_smfmac_f32_16x16x64_bf16 v[20:23], v[48:51], a[216:223], v60
    ds_read_b128 v[48:51], v71 offset:0
    v_smfmac_f32_16x16x64_bf16 v[0:3], v[52:55], a[16:23], v60
    s_waitcnt vmcnt(0)
    ds_read_b128 v[28:31], v62 offset:45056
    s_waitcnt lgkmcnt(4)
    v_smfmac_f32_16x16x64_bf16 v[4:7], v[52:55], v[32:39], v60
    ds_read_b32 v59, v58
    buffer_load_dwordx4 v[24:27], v61, s[4:7], s23 offen offset:0 sc1
    v_smfmac_f32_16x16x64_bf16 v[8:11], v[52:55], a[24:31], v60
    ds_read_b128 v[32:35], v61 offset:49152
    s_waitcnt lgkmcnt(4)
    v_smfmac_f32_16x16x64_bf16 v[12:15], v[52:55], v[40:47], v60
    ds_read_b128 v[36:39], v61 offset:53248
    v_smfmac_f32_16x16x64_bf16 v[16:19], v[52:55], a[224:231], v60
    ds_read_b128 v[40:43], v61 offset:57344
    v_smfmac_f32_16x16x64_bf16 v[20:23], v[52:55], a[232:239], v60
    ds_read_b128 v[44:47], v61 offset:61440
    s_waitcnt lgkmcnt(4)
    v_smfmac_f32_16x16x64_bf16 v[0:3], v[48:51], a[32:39], v60
    v_max3_u32 v57, v28, v29, v30
    v_smfmac_f32_16x16x64_bf16 v[8:11], v[48:51], a[40:47], v60
    v_max3_u32 v57, v57, v31, v59
    s_waitcnt lgkmcnt(2)
    v_smfmac_f32_16x16x64_bf16 v[4:7], v[48:51], v[32:39], v60
    buffer_load_dwordx4 v[32:35], v61, s[4:7], s23 offen offset:1024 sc1
    v_cmp_eq_u32 vcc, -1, v57
    v_smfmac_f32_16x16x64_bf16 v[16:19], v[48:51], a[240:247], v60
    v_smfmac_f32_16x16x64_bf16 v[20:23], v[48:51], a[248:255], v60
    s_cbranch_vccnz cf_spin1
cf_go1:
    s_barrier
    ds_read_b128 v[52:55], v63 offset:4096
    s_waitcnt lgkmcnt(1)
    v_smfmac_f32_16x16x64_bf16 v[12:15], v[48:51], v[40:47], v60
    ds_read_b128 v[48:51], v64 offset:4096
    v_smfmac_f32_16x16x64_bf16 v[0:3], v[28:31], a[48:55], v60
    buffer_load_dwordx4 v[40:43], v61, s[4:7], s23 offen offset:2048 sc1
    v_smfmac_f32_16x16x64_bf16 v[8:11], v[28:31], a[56:63], v60
    ds_read_b128 v[56:59], v71 offset:4096
    s_and_b32 s41, s41, 65535
    v_smfmac_f32_16x16x64_bf16 v[4:7], v[28:31], a[128:135], v60
    ds_read_b128 v[36:39], v65 offset:8192
    s_add_u32 s41, s41, 67108864
    v_smfmac_f32_16x16x64_bf16 v[12:15], v[28:31], a[136:143], v60
    s_add_u32 s17, s41, s31
    s_and_b32 s30, s28, 1
    s_waitcnt lgkmcnt(3)
    v_smfmac_f32_16x16x64_bf16 v[0:3], v[52:55], a[64:71], v60
    buffer_load_dwordx4 v[44:47], v61, s[4:7], s23 offen offset:3072 sc1
    v_smfmac_f32_16x16x64_bf16 v[4:7], v[52:55], a[144:151], v60
    ds_read_b128 v[28:31], v78 offset:8704
    v_smfmac_f32_16x16x64_bf16 v[8:11], v[52:55], a[72:79], v60
    v_smfmac_f32_16x16x64_bf16 v[12:15], v[52:55], a[152:159], v60
    ds_read_b128 v[52:55], v62 offset:28672
    s_waitcnt lgkmcnt(4)
    v_smfmac_f32_16x16x64_bf16 v[0:3], v[48:51], a[80:87], v60
    v_smfmac_f32_16x16x64_bf16 v[4:7], v[48:51], a[160:167], v60
    v_smfmac_f32_16x16x64_bf16 v[8:11], v[48:51], a[88:95], v60
    buffer_load_dword v79, s[4:7], s24 offen sc1 lds
    v_smfmac_f32_16x16x64_bf16 v[12:15], v[48:51], a[168:175], v60
    v_smfmac_f32_16x16x64_bf16 v[16:19], v[48:51], v[112:119], v60
    v_smfmac_f32_16x16x64_bf16 v[20:23], v[48:51], v[120:127], v60
    ds_read_b128 v[48:51], v62 offset:24576
    s_waitcnt lgkmcnt(4)
    v_smfmac_f32_16x16x64_bf16 v[0:3], v[56:59], a[96:103], v60
    s_bitcmp1_b64 s[66:67], s28
    v_smfmac_f32_16x16x64_bf16 v[8:11], v[56:59], a[104:111], v60
    s_waitcnt lgkmcnt(3)
    v_smfmac_f32_16x16x64_bf16 v[0:3], v[36:39], a[112:119], v60
    v_smfmac_f32_16x16x64_bf16 v[8:11], v[36:39], a[120:127], v60
    v_smfmac_f32_16x16x64_bf16 v[4:7], v[56:59], a[176:183], v60
    s_waitcnt lgkmcnt(0)
    v_cvt_pk_bf16_f32 v0, v0, v1
    v_smfmac_f32_16x16x64_bf16 v[4:7], v[36:39], v[48:55], v60
    ds_read_b128 v[48:51], v62 offset:32768
    v_cvt_pk_bf16_f32 v8, v8, v9
    v_smfmac_f32_16x16x64_bf16 v[12:15], v[56:59], a[184:191], v60
    ds_read_b128 v[52:55], v62 offset:36864
    v_cvt_pk_bf16_f32 v9, v10, v11
    v_smfmac_f32_16x16x64_bf16 v[16:19], v[56:59], v[128:135], v60
    v_cvt_pk_bf16_f32 v1, v2, v3
    v_mfma_f32_16x16x16_bf16 v[8:11], v[8:9], v[28:29], 0
    v_cvt_pk_bf16_f32 v2, v4, v5
    v_cvt_pk_bf16_f32 v3, v6, v7
    v_smfmac_f32_16x16x64_bf16 v[20:23], v[56:59], v[136:143], v60
    s_mov_b64 exec, s[36:37]
    ds_read_b128 v[56:59], v69
    s_mov_b64 exec, -1
    v_mfma_f32_16x16x32_bf16 v[4:7], v[0:3], v[28:31], 0
    v_cvt_pk_bf16_f32 v2, v8, v9
    s_waitcnt lgkmcnt(1)
    v_smfmac_f32_16x16x64_bf16 v[12:15], v[36:39], v[48:55], v60
    ds_read_b128 v[48:51], v63 offset:4096
    v_cvt_pk_bf16_f32 v3, v10, v11
    s_waitcnt vmcnt(3)
    v_cvt_pk_bf16_f32 v0, v4, v5
    v_cvt_pk_bf16_f32 v1, v6, v7
    s_nop 1
    v_mfma_f32_16x16x32_bf16 v[4:7], v[32:35], v[0:3], 0
    v_cvt_pk_bf16_f32 v12, v12, v13
    v_cvt_pk_bf16_f32 v13, v14, v15
    s_nop 1
    v_mfma_f32_16x16x16_bf16 v[12:15], v[12:13], v[30:31], 0
    ds_read_b128 v[52:55], v62 offset:45056
    ds_read_b128 v[32:35], v63 offset:49152
    v_mfma_f32_16x16x32_bf16 v[28:31], v[24:27], v[0:3], 0
    s_waitcnt vmcnt(1)
    s_mov_b64 exec, s[34:35]
    s_nop 1
    v_cvt_pk_bf16_f32 v2, v12, v13
    v_cvt_pk_bf16_f32 v3, v14, v15
    s_mov_b64 exec, -1
    s_nop 0
    v_mfma_f32_16x16x32_bf16 v[8:11], v[0:3], v[0:3], 0
    v_mov_b32_dpp v28, v4 row_ror:8 row_mask:0xf bank_mask:0xc
    v_mov_b32_dpp v29, v5 row_ror:8 row_mask:0xf bank_mask:0xc
    v_mov_b32_dpp v30, v6 row_ror:8 row_mask:0xf bank_mask:0xc
    v_mov_b32_dpp v31, v7 row_ror:8 row_mask:0xf bank_mask:0xc
    v_smfmac_f32_16x16x64_bf16 v[16:19], v[36:39], v[144:151], v60
    ds_write_b128 v62, v[28:31] offset:53248
    v_mov_b32_dpp v8, v10 row_ror:8 row_mask:0xf bank_mask:0xc
    v_mov_b32_dpp v9, v11 row_ror:8 row_mask:0xf bank_mask:0xc
    v_smfmac_f32_16x16x64_bf16 v[20:23], v[36:39], v[152:159], v60
    ds_write_b64 v70, v[8:9]
    s_waitcnt lgkmcnt(4)
    v_smfmac_f32_16x16x64_bf16 v[16:19], v[48:51], v[96:103], v60
    s_mov_b64 exec, s[36:37]
    buffer_store_dwordx4 v[56:59], v61, s[4:7], s65 offen sc1
    s_mov_b64 exec, -1
    v_smfmac_f32_16x16x64_bf16 v[20:23], v[48:51], v[104:111], v60
    s_cbranch_scc1 cf_last
cf_back:
    s_waitcnt lgkmcnt(0)
    s_barrier
    ds_read_b128 v[56:59], v78 offset:10752
    v_smfmac_f32_16x16x64_bf16 v[16:19], v[52:55], v[80:87], v60
    ds_read_b128 v[12:15], v78 offset:11264
    ds_read_b128 v[4:7], v63 offset:12288
    v_smfmac_f32_16x16x64_bf16 v[20:23], v[52:55], v[88:95], v60
    ds_read_b128 v[8:11], v64 offset:12288
    ds_read_b128 v[0:3], v71 offset:12288
    v_mov_b64 v[24:25], s[62:63]
    v_mov_b64 v[26:27], s[60:61]
    v_cvt_pk_bf16_f32 v16, v16, v17
    v_cvt_pk_bf16_f32 v17, v18, v19
    v_pk_mul_f32 v[28:29], v[28:29], s[44:45]
    v_pk_mul_f32 v[30:31], v[30:31], s[44:45]
    s_waitcnt lgkmcnt(3)
    v_pk_add_f32 v[56:57], v[56:57], v[58:59]
    v_pk_add_f32 v[12:13], v[12:13], v[14:15]
    v_pk_add_f32 v[56:57], v[56:57], v[12:13]
    v_pk_mul_f32 v[56:57], v[56:57], s[44:45]
    v_exp_f32 v58, v56
    v_exp_f32 v59, v57
    s_waitcnt lgkmcnt(1)
    v_pk_fma_f32 v[28:29], v[4:5], s[44:45], v[28:29]
    v_pk_fma_f32 v[30:31], v[6:7], s[44:45], v[30:31]
    v_cvt_pk_bf16_f32 v6, v58, v59
    v_pk_fma_f32 v[28:29], v[8:9], s[44:45], v[28:29]
    v_pk_fma_f32 v[30:31], v[10:11], s[44:45], v[30:31]
    s_waitcnt lgkmcnt(0)
    v_pk_fma_f32 v[28:29], v[0:1], s[44:45], v[28:29]
    v_mov_b32_dpp v7, v6 row_ror:8 row_mask:0xf bank_mask:0xf
    v_pk_fma_f32 v[30:31], v[2:3], s[44:45], v[30:31]
    v_exp_f32 v0, v28
    v_mfma_f32_16x16x16_bf16 v[12:15], v[16:17], v[6:7], 0
    ds_read_b128 v[48:51], v63 offset:57344
    v_exp_f32 v1, v29
    v_cvt_pk_bf16_f32 v18, v20, v21
    v_exp_f32 v2, v30
    v_cvt_pk_bf16_f32 v19, v22, v23
    v_cvt_pk_bf16_f32 v8, v0, v1
    v_exp_f32 v3, v31
    v_mfma_f32_16x16x16_bf16 v[20:23], v[18:19], v[6:7], 0
    ds_read_b128 v[52:55], v63 offset:61440
    v_cvt_pk_bf16_f32 v9, v2, v3
    v_mov_b32_dpp v10, v8 row_ror:8 row_mask:0xf bank_mask:0xf
    v_max3_f32 v4, |v28|, |v29|, |v30|
    v_mov_b32_dpp v11, v9 row_ror:8 row_mask:0xf bank_mask:0xf
    v_mfma_f32_16x16x32_bf16 v[0:3], v[24:27], v[6:9], 0
    ds_read_b128 v[36:39], v63 offset:53248
    v_max3_f32 v4, v4, |v31|, |v56|
    v_max_f32_e64 v4, v4, |v57|
    v_mfma_f32_16x16x32_bf16 v[12:15], v[40:43], v[8:11], v[12:15]
    v_cmp_nge_f32 vcc, s46, v4
    v_mfma_f32_16x16x32_bf16 v[20:23], v[44:47], v[8:11], v[20:23]
    v_add_f32_dpp v0, v0, v0 row_ror:8 row_mask:0xf bank_mask:0xf
    v_rcp_f32 v0, v0
    s_cbranch_vccnz cf_guard
cf_norm:
    v_mfma_f32_16x16x16_bf16 v[28:31], v[72:73], v[72:73], 0
    v_mul_f32 v12, v12, v0
    v_mul_f32 v13, v13, v0
    v_mul_f32 v14, v14, v0
    v_mul_f32 v15, v15, v0
    v_mul_f32_dpp v12, v20, v0 row_ror:8 row_mask:0xf bank_mask:0xc
    v_mul_f32_dpp v13, v21, v0 row_ror:8 row_mask:0xf bank_mask:0xc
    v_mul_f32_dpp v14, v22, v0 row_ror:8 row_mask:0xf bank_mask:0xc
    v_mul_f32_dpp v15, v23, v0 row_ror:8 row_mask:0xf bank_mask:0xc
    v_cvt_pk_bf16_f32 v12, v12, v13
    v_cvt_pk_bf16_f32 v13, v14, v15
    v_mfma_f32_16x16x16_bf16 v[8:11], v[72:73], v[72:73], 0
    ds_write_b64 v77, v[12:13]
    v_mfma_f32_16x16x16_bf16 v[4:7], v[72:73], v[72:73], 0
    ds_read_b128 v[0:3], v68
    v_mfma_f32_16x16x16_bf16 v[16:19], v[72:73], v[72:73], 0
    ds_read_b128 v[40:43], v63 offset:16384
    v_mfma_f32_16x16x16_bf16 v[20:23], v[72:73], v[72:73], 0
    ds_read_b128 v[44:47], v63 offset:20480
    s_waitcnt lgkmcnt(3)
    s_barrier
    ds_read_b128 v[24:27], v74
    ds_read_b128 v[12:15], v75
    ds_read_b128 v[56:59], v76
    s_waitcnt lgkmcnt(5)
    v_smfmac_f32_16x16x64_bf16 v[28:31], v[0:3], v[160:167], v60
    v_smfmac_f32_16x16x64_bf16 v[8:11], v[0:3], v[192:199], v60
    v_smfmac_f32_16x16x64_bf16 v[4:7], v[0:3], v[32:39], v60
    ds_read_b128 v[32:35], v63 offset:32768
    v_smfmac_f32_16x16x64_bf16 v[16:19], v[0:3], v[224:231], v60
    ds_read_b128 v[36:39], v63 offset:36864
    s_waitcnt lgkmcnt(3)
    v_smfmac_f32_16x16x64_bf16 v[28:31], v[24:27], v[168:175], v60
    v_smfmac_f32_16x16x64_bf16 v[4:7], v[12:15], v[48:55], v60
    ds_read_b128 v[48:51], v63 offset:24576
    v_smfmac_f32_16x16x64_bf16 v[28:31], v[12:15], v[176:183], v60
    ds_read_b128 v[52:55], v63 offset:28672
    s_waitcnt lgkmcnt(4)
    v_smfmac_f32_16x16x64_bf16 v[28:31], v[56:59], v[184:191], v60
    v_cvt_pk_bf16_f32 v4, v4, v5
    v_smfmac_f32_16x16x64_bf16 v[16:19], v[12:15], v[40:47], v60
    ds_read_b128 v[40:43], v63 offset:40960
    v_and_or_b32 v4, v4, -2, s30
    v_smfmac_f32_16x16x64_bf16 v[8:11], v[24:27], v[200:207], v60
    ds_read_b128 v[44:47], v63 offset:45056
    v_cvt_pk_bf16_f32 v5, v6, v7
    v_smfmac_f32_16x16x64_bf16 v[8:11], v[12:15], v[208:215], v60
    buffer_store_dwordx2 v[4:5], v67, s[4:7], s22 offen
    v_cvt_pk_bf16_f32 v28, v28, v29
    v_smfmac_f32_16x16x64_bf16 v[8:11], v[56:59], v[216:223], v60
    v_and_or_b32 v28, v28, -2, s30
    v_smfmac_f32_16x16x64_bf16 v[16:19], v[24:27], v[232:239], v60
    v_cvt_pk_bf16_f32 v29, v30, v31
    s_waitcnt lgkmcnt(4)
    v_smfmac_f32_16x16x64_bf16 v[16:19], v[56:59], v[32:39], v60
    buffer_store_dwordx2 v[28:29], v66, s[4:7], s20 offen
    v_cvt_pk_bf16_f32 v8, v8, v9
    s_waitcnt lgkmcnt(0)
    v_smfmac_f32_16x16x64_bf16 v[20:23], v[0:3], v[240:247], v60
    v_and_or_b32 v8, v8, -2, s30
    v_smfmac_f32_16x16x64_bf16 v[20:23], v[24:27], v[248:255], v60
    v_cvt_pk_bf16_f32 v9, v10, v11
    v_smfmac_f32_16x16x64_bf16 v[20:23], v[12:15], v[48:55], v60
    buffer_store_dwordx2 v[8:9], v66, s[4:7], s21 offen
    v_cvt_pk_bf16_f32 v16, v16, v17
    v_smfmac_f32_16x16x64_bf16 v[20:23], v[56:59], v[40:47], v60
    v_and_or_b32 v16, v16, -2, s30
    v_cvt_pk_bf16_f32 v17, v18, v19
    buffer_store_dwordx2 v[16:17], v66, s[4:7], s38 offen
    s_cmp_lg_u32 s13, 2
    s_nop 1
    v_cvt_pk_bf16_f32 v20, v20, v21
    v_and_or_b32 v20, v20, -2, s30
    v_cvt_pk_bf16_f32 v21, v22, v23
    buffer_store_dwordx2 v[20:21], v66, s[4:7], s39 offen
    s_cbranch_scc1 cf_w013
    v_mov_b32 v21, -1
    s_mov_b64 exec, s[32:33]
    buffer_store_dword v21, v69, s[4:7], s18 offen
    s_mov_b64 exec, -1
    s_mov_b32 s18, s43
    s_nop 15
    s_nop 15
    s_nop 15
    s_nop 14
    buffer_load_dwordx4 v[40:43], v65, s[4:7], s19 offen offset:0 nt
    buffer_load_dwordx4 v[44:47], v65, s[4:7], s19 offen offset:1024 nt
    buffer_load_dwordx4 v[48:51], v65, s[4:7], s19 offen offset:2048 nt
    buffer_load_dwordx4 v[52:55], v65, s[4:7], s19 offen offset:3072 nt
    ds_read_b128 v[56:59], v65 offset:10240
    s_add_u32 s28, s28, 1
    s_mov_b32 s14, s41
    s_add_u32 s23, s23, 524288
    s_add_u32 s24, s24, 524288
    s_min_u32 s24, s24, s47
    s_add_u32 s15, s14, 4096
    s_add_u32 s16, s14, 8192
    s_add_u32 s65, s65, 12288
    s_mov_b32 s40, 1
    v_mov_b64 v[0:1], 0
    v_mov_b64 v[2:3], 0
    v_mov_b64 v[4:5], 0
    v_mov_b64 v[6:7], 0
    v_mov_b64 v[8:9], 0
    v_mov_b64 v[10:11], 0
    v_mov_b64 v[12:13], 0
    v_mov_b64 v[14:15], 0
cf_chkF:
    v_mov_b32 v20, 0
    s_waitcnt vmcnt(3)
    s_waitcnt lgkmcnt(0)
    v_mfma_f32_16x16x32_bf16 v[28:31], v[40:43], v[56:59], 0
    v_bitop3_b32 v20, v20, v40, s30 bitop3:0xf6
    v_bitop3_b32 v20, v20, v42, s30 bitop3:0xf6
    s_waitcnt vmcnt(2)
    v_mfma_f32_16x16x32_bf16 v[28:31], v[44:47], v[56:59], v[28:31]
    v_bitop3_b32 v20, v20, v44, s30 bitop3:0xf6
    v_bitop3_b32 v20, v20, v46, s30 bitop3:0xf6
    s_waitcnt vmcnt(1)
    v_mfma_f32_16x16x32_bf16 v[28:31], v[48:51], v[56:59], v[28:31]
    v_bitop3_b32 v20, v20, v48, s30 bitop3:0xf6
    v_bitop3_b32 v20, v20, v50, s30 bitop3:0xf6
    s_waitcnt vmcnt(0)
    v_mfma_f32_16x16x32_bf16 v[28:31], v[52:55], v[56:59], v[28:31]
    v_bitop3_b32 v20, v20, v52, s30 bitop3:0xf6
    v_bitop3_b32 v20, v20, v54, s30 bitop3:0xf6
    v_and_b32 v20, s40, v20
    v_cmp_ne_u32 vcc, 0, v20
    s_cbranch_vccnz cf_spinF
    v_permlane32_swap_b32 v28, v30
    v_permlane32_swap_b32 v29, v31
    v_add_f32 v28, v28, v30
    v_add_f32 v30, v29, v31
    v_cvt_pk_bf16_f32 v28, v28, v30
    s_mov_b64 exec, s[32:33]
    buffer_store_dword v28, v69, s[4:7], s17 offen
    s_mov_b64 exec, -1
    ds_read_b128 v[32:35], v62 offset:16384
    ds_read_b128 v[36:39], v62 offset:20480
    ds_read_b128 v[40:43], v61 offset:0
    ds_read_b128 v[44:47], v61 offset:4096
    ds_read_b128 v[48:51], v61 offset:8192
    ds_read_b128 v[52:55], v61 offset:12288
    s_nop 15
    s_nop 1
    buffer_load_dwordx4 v[24:27], v61, s[4:7], s14 offen nt
    s_branch cf_loop2
cf_w013:
    ds_read_b128 v[56:59], v65 offset:10240
    ds_read_b128 v[32:35], v62 offset:16384
    ds_read_b128 v[36:39], v62 offset:20480
    ds_read_b128 v[40:43], v61 offset:0
    ds_read_b128 v[44:47], v61 offset:4096
    ds_read_b128 v[48:51], v61 offset:8192
    ds_read_b128 v[52:55], v61 offset:12288
    s_add_u32 s28, s28, 1
    s_mov_b32 s14, s41
    s_add_u32 s23, s23, 524288
    s_add_u32 s24, s24, 524288
    s_min_u32 s24, s24, s47
    s_add_u32 s15, s14, 4096
    s_add_u32 s16, s14, 8192
    s_add_u32 s65, s65, 12288
    s_mov_b32 s40, 1
    s_cmp_eq_u32 s64, 0
    s_cbranch_scc1 cf_w0
    v_mov_b32 v21, -1
    s_mov_b64 exec, s[32:33]
    buffer_store_dword v21, v69, s[4:7], s18 offen
    s_mov_b64 exec, -1
    s_mov_b32 s18, s43
    s_cmp_eq_u32 s13, 1
    s_nop 15
    s_nop 15
    s_nop 1
    s_cbranch_scc1 cf_sx
    s_nop 15
    s_nop 11
cf_sx:
    buffer_load_dwordx4 v[0:3], v65, s[4:7], s19 offen offset:0 nt
    buffer_load_dwordx4 v[4:7], v65, s[4:7], s19 offen offset:1024 nt
    buffer_load_dwordx4 v[8:11], v65, s[4:7], s19 offen offset:2048 nt
    buffer_load_dwordx4 v[12:15], v65, s[4:7], s19 offen offset:3072 nt
cf_chkG:
    v_mov_b32 v20, 0
    s_waitcnt vmcnt(3)
    s_waitcnt lgkmcnt(6)
    v_mfma_f32_16x16x32_bf16 v[28:31], v[0:3], v[56:59], 0
    v_bitop3_b32 v20, v20, v0, s30 bitop3:0xf6
    v_bitop3_b32 v20, v20, v2, s30 bitop3:0xf6
    s_waitcnt vmcnt(2)
    v_mfma_f32_16x16x32_bf16 v[28:31], v[4:7], v[56:59], v[28:31]
    v_bitop3_b32 v20, v20, v4, s30 bitop3:0xf6
    v_bitop3_b32 v20, v20, v6, s30 bitop3:0xf6
    s_waitcnt vmcnt(1)
    v_mfma_f32_16x16x32_bf16 v[28:31], v[8:11], v[56:59], v[28:31]
    v_bitop3_b32 v20, v20, v8, s30 bitop3:0xf6
    v_bitop3_b32 v20, v20, v10, s30 bitop3:0xf6
    s_waitcnt vmcnt(0)
    v_mfma_f32_16x16x32_bf16 v[28:31], v[12:15], v[56:59], v[28:31]
    v_bitop3_b32 v20, v20, v12, s30 bitop3:0xf6
    v_bitop3_b32 v20, v20, v14, s30 bitop3:0xf6
    v_and_b32 v20, s40, v20
    v_cmp_ne_u32 vcc, 0, v20
    s_cbranch_vccnz cf_spinG
    v_permlane32_swap_b32 v28, v30
    v_permlane32_swap_b32 v29, v31
    v_add_f32 v28, v28, v30
    v_add_f32 v30, v29, v31
    s_cmp_eq_u32 s13, 3
    s_cbranch_scc1 cf_w3
    v_mov_b32 v29, v28
    v_mov_b32 v31, v30
    s_nop 0
    v_permlane16_swap_b32 v28, v29
    v_permlane16_swap_b32 v30, v31
    v_add_f32 v28, v28, v29
    v_add_f32 v30, v30, v31
cf_w3:
    v_cvt_pk_bf16_f32 v28, v28, v30
    s_mov_b64 exec, s[32:33]
    buffer_store_dword v28, v69, s[4:7], s17 offen
    s_mov_b64 exec, -1
    buffer_load_dwordx4 v[24:27], v61, s[4:7], s14 offen nt
    s_branch cf_loop
cf_w0:
    v_mov_b64 v[0:1], 0
    v_mov_b64 v[2:3], 0
    v_mov_b64 v[4:5], 0
    v_mov_b64 v[6:7], 0
    v_mov_b64 v[8:9], 0
    v_mov_b64 v[10:11], 0
    v_mov_b64 v[12:13], 0
    v_mov_b64 v[14:15], 0
    s_nop 15
    s_nop 15
    s_nop 15
    s_nop 5
    s_cmp_lg_u32 s28, 10
    s_cbranch_scc1 cf_nokv
    s_lshr_b32 s92, s12, 1
    s_lshl_b32 s92, s92, 8
    s_add_u32 s92, s92, 125829120
    v_bfe_u32 v28, v61, 4, 6
    v_min_u32 v28, 11, v28
    v_lshlrev_b32 v28, 2, v28
    v_add_u32 v28, 108304, v28
    s_waitcnt vmcnt(0)
    ds_read_b32 v29, v28
    s_add_u32 s93, s95, 63
    s_waitcnt lgkmcnt(0)
    v_cmp_ne_u32 vcc, s93, v29
    s_cbranch_vccz cf_kv1_go
    s_lshr_b32 s92, s12, 1
    s_lshl_b32 s92, s92, 8
    s_add_u32 s92, s92, 125833216
    v_bfe_u32 v28, v61, 4, 6
    v_min_u32 v28, 11, v28
    v_lshlrev_b32 v28, 2, v28
    s_add_u32 s93, s95, 63
    s_mov_b32 s94, 4194304
cf_kv1:
    buffer_load_dword v29, v28, s[4:7], s92 offen sc1
    s_sub_u32 s94, s94, 1
    s_cbranch_scc1 cf_kv1_go
    s_waitcnt vmcnt(0)
    v_subrev_u32 v29, s93, v29
    v_cmp_lt_u32 vcc, 64, v29
    s_cbranch_vccz cf_kv1_go
    s_sleep 2
    s_branch cf_kv1
cf_kv1_go:
    s_branch cf_w0p
cf_nokv:
    s_nop 15
    s_nop 15
    s_nop 15
    s_nop 15
    s_nop 15
    s_nop 15
    s_nop 13
cf_w0p:
    buffer_load_dwordx4 v[24:27], v61, s[4:7], s14 offen nt
    s_branch cf_loop2
cf_spinF:
    buffer_load_dwordx4 v[40:43], v65, s[4:7], s19 offen offset:0 nt
    buffer_load_dwordx4 v[44:47], v65, s[4:7], s19 offen offset:1024 nt
    buffer_load_dwordx4 v[48:51], v65, s[4:7], s19 offen offset:2048 nt
    buffer_load_dwordx4 v[52:55], v65, s[4:7], s19 offen offset:3072 nt
    s_sub_u32 s29, s29, 1
    s_cmp_lt_i32 s29, 0
    s_cselect_b32 s40, 0, 1
    s_branch cf_chkF
cf_spinG:
    buffer_load_dwordx4 v[0:3], v65, s[4:7], s19 offen offset:0 nt
    buffer_load_dwordx4 v[4:7], v65, s[4:7], s19 offen offset:1024 nt
    buffer_load_dwordx4 v[8:11], v65, s[4:7], s19 offen offset:2048 nt
    buffer_load_dwordx4 v[12:15], v65, s[4:7], s19 offen offset:3072 nt
    s_sub_u32 s29, s29, 1
    s_cmp_lt_i32 s29, 0
    s_cselect_b32 s40, 0, 1
    s_branch cf_chkG
cf_guard:
    s_cbranch_scc0 cf_guard2
    buffer_store_dwordx4 v[16:19], v61, s[4:7], s26 offen sc1
    s_add_u32 s26, s26, 131072
    s_add_u32 s40, s95, 63
    v_mov_b32 v5, s40
    s_mov_b64 exec, 1
    buffer_store_dword v5, off, s[4:7], s27 sc1
    s_mov_b64 exec, -1
cf_guard2:
    s_nop 7
    v_max3_f32 v6, v28, v29, v30
    v_max3_f32 v7, v31, v56, v57
    v_max_f32 v6, v6, v7
    s_nop 1
    v_max_f32_dpp v6, v6, v6 row_ror:8 row_mask:0xf bank_mask:0xf
    v_mov_b32 v7, v6
    s_nop 1
    v_permlane32_swap_b32 v6, v7
    v_max_f32 v6, v6, v7
    v_mov_b32 v7, v6
    s_nop 1
    v_permlane16_swap_b32 v6, v7
    v_max_f32 v6, v6, v7
    v_sub_f32 v28, v28, v6
    v_sub_f32 v29, v29, v6
    v_sub_f32 v30, v30, v6
    v_sub_f32 v31, v31, v6
    v_sub_f32 v56, v56, v6
    v_sub_f32 v57, v57, v6
    v_exp_f32 v58, v56
    v_exp_f32 v59, v57
    s_nop 0
    v_cvt_pk_bf16_f32 v6, v58, v59
    s_nop 1
    v_mov_b32_dpp v7, v6 row_ror:8 row_mask:0xf bank_mask:0xf
    v_exp_f32 v0, v28
    s_nop 0
    v_mfma_f32_16x16x16_bf16 v[12:15], v[16:17], v[6:7], 0
    v_exp_f32 v1, v29
    v_exp_f32 v2, v30
    v_cvt_pk_bf16_f32 v8, v0, v1
    v_exp_f32 v3, v31
    v_mfma_f32_16x16x16_bf16 v[20:23], v[18:19], v[6:7], 0
    v_cvt_pk_bf16_f32 v9, v2, v3
    v_mov_b32_dpp v10, v8 row_ror:8 row_mask:0xf bank_mask:0xf
    v_max3_f32 v4, |v28|, |v29|, |v30|
    v_mov_b32_dpp v11, v9 row_ror:8 row_mask:0xf bank_mask:0xf
    v_mfma_f32_16x16x32_bf16 v[0:3], v[24:27], v[6:9], 0
    v_max3_f32 v4, v4, |v31|, |v56|
    v_max_f32_e64 v4, v4, |v57|
    v_mfma_f32_16x16x32_bf16 v[12:15], v[40:43], v[8:11], v[12:15]
    v_cmp_nge_f32 vcc, s46, v4
    v_mfma_f32_16x16x32_bf16 v[20:23], v[44:47], v[8:11], v[20:23]
    v_add_f32_dpp v0, v0, v0 row_ror:8 row_mask:0xf bank_mask:0xf
    v_rcp_f32 v0, v0
    s_nop 4
    s_branch cf_norm
cf_spin0:
    buffer_load_dwordx4 v[24:27], v61, s[4:7], s14 offen nt
    s_sub_u32 s29, s29, 1
    s_cmp_lt_i32 s29, 0
    s_cbranch_scc0 cf_chk0
    s_waitcnt vmcnt(0)
    v_min_u32 v24, -2, v24
    v_min_u32 v25, -2, v25
    v_min_u32 v26, -2, v26
    v_min_u32 v27, -2, v27
    s_branch cf_chk0
cf_spin1:
    s_mov_b32 m0, s58
    s_nop 0
    buffer_load_dwordx4 v61, s[4:7], s15 offen nt lds
    s_mov_b32 m0, s59
    s_nop 0
    buffer_load_dword v56, s[4:7], s16 offen nt lds
    s_mov_b32 m0, 108032
    s_sub_u32 s29, s29, 1
    s_cmp_lt_i32 s29, 0
    s_waitcnt vmcnt(0)
    ds_read_b128 v[28:31], v62 offset:45056
    ds_read_b32 v59, v58
    s_waitcnt lgkmcnt(0)
    v_max3_u32 v57, v28, v29, v30
    v_max3_u32 v57, v57, v31, v59
    v_cmp_eq_u32 vcc, -1, v57
    s_cbranch_scc1 cf_go1
    s_cbranch_vccnz cf_spin1
    s_branch cf_go1
cf_last:
    s_nop 1
    s_cmp_ge_u32 s28, 2
    s_cbranch_scc1 cf_last0
    s_and_b32 s40, s12, 3
    s_lshl_b32 s40, s40, 14
    s_add_u32 s40, s40, 67108864
    s_lshr_b32 s42, s12, 2
    s_lshl_b32 s42, s42, 3
    s_lshl_b64 exec, 0x55, s42
    buffer_load_dword v79, s[4:7], s40 offen sc1 lds
    s_mov_b64 exec, -1
    s_cmp_eq_u32 0, 1
    s_branch cf_back
cf_last0:
    s_cmp_lg_u32 s28, 9
    s_cbranch_scc1 cf_last1
    s_lshr_b32 s92, s12, 1
    s_lshl_b32 s92, s92, 8
    s_add_u32 s92, s92, 125833216
    v_bfe_u32 v48, v61, 4, 6
    v_min_u32 v48, 11, v48
    v_lshlrev_b32 v48, 2, v48
    s_mov_b32 m0, 108304
    s_mov_b64 exec, 0xfff
    buffer_load_dword v48, s[4:7], s92 offen sc1 lds
    s_mov_b64 exec, -1
    s_mov_b32 m0, 108032
    s_cmp_eq_u32 0, 1
    s_branch cf_back
cf_last1:
    s_cmp_eq_u32 s28, 63
    s_cbranch_scc1 cf_last2
    s_mov_b64 exec, s[34:35]
    buffer_store_dwordx4 v[0:3], v61, s[4:7], s25 offen sc1
    s_mov_b64 exec, -1
    s_add_u32 s25, s25, 131072
    s_mov_b32 s46, 0xbf800000
    s_cmp_eq_u32 0, 0
    s_branch cf_back
cf_last2:
    s_waitcnt lgkmcnt(0)
    s_mov_b64 exec, s[34:35]
    buffer_store_dwordx4 v[0:3], v61, s[4:7], s25 offen sc1
    s_mov_b64 exec, -1
    s_add_u32 s40, s95, 64
    v_mov_b32 v40, s40
    v_smfmac_f32_16x16x64_bf16 v[16:19], v[52:55], v[80:87], v60
    v_smfmac_f32_16x16x64_bf16 v[20:23], v[52:55], v[88:95], v60
    s_nop 3
    v_cvt_pk_bf16_f32 v16, v16, v17
    v_cvt_pk_bf16_f32 v17, v18, v19
    s_nop 1
    v_cvt_pk_bf16_f32 v18, v20, v21
    v_cvt_pk_bf16_f32 v19, v22, v23
    buffer_store_dwordx4 v[16:19], v61, s[4:7], s26 offen sc1
    s_mov_b64 exec, 1
    buffer_store_dword v40, off, s[4:7], s27 sc1
    s_mov_b64 exec, -1
    s_endpgm
cf_dma:
    s_xor_b32 s74, s76, s81
    s_add_u32 m0, s74, s80
    s_add_u32 s76, s76, 4096
    buffer_load_dwordx4 v58, s[8:11], s78 offen lds
    s_add_u32 s78, s78, s79
    s_cmp_lt_u32 s76, s77
    s_cbranch_scc1 cf_dma
    s_setpc_b64 s[82:83]
L_chain_safe:
    s_mov_b64 s[48:49], s[50:51]
    s_mov_b64 s[50:51], s[52:53]
    s_mov_b64 s[52:53], s[54:55]
    s_mov_b64 s[54:55], s[56:57]
    s_mov_b64 s[56:57], s[58:59]
    v_lshrrev_b32 v54, 6, v0
    s_nop 0
    v_readfirstlane_b32 s13, v54
    v_and_b32 v57, 63, v0
    v_bfe_u32 v54, v57, 2, 1
    v_lshlrev_b32 v48, 13, v54
    v_bfe_u32 v54, v57, 3, 1
    v_lshl_add_u32 v48, v54, 15, v48
    v_bfe_u32 v54, v57, 4, 1
    v_lshl_add_u32 v48, v54, 14, v48
    v_bfe_u32 v54, v57, 5, 1
    v_lshl_add_u32 v48, v54, 16, v48
    v_lshrrev_b32 v55, 4, v57
    v_and_b32 v55, 2, v55
    v_xor_b32 v55, v55, v57
    v_and_b32 v55, 3, v55
    v_lshl_add_u32 v48, v55, 4, v48
    v_bfe_u32 v54, v57, 2, 1
    v_lshlrev_b32 v51, 6, v54
    v_bfe_u32 v54, v57, 3, 1
    v_lshl_add_u32 v51, v54, 9, v51
    v_bfe_u32 v54, v57, 4, 1
    v_lshl_add_u32 v51, v54, 7, v51
    v_bfe_u32 v54, v57, 5, 1
    v_lshl_add_u32 v51, v54, 12, v51
    v_bfe_u32 v54, v57, 0, 1
    v_lshl_add_u32 v51, v54, 3, v51
    v_bfe_u32 v54, v57, 1, 1
    v_lshl_add_u32 v51, v54, 4, v51
    v_bfe_u32 v54, v57, 3, 1
    v_lshl_add_u32 v51, v54, 5, v51
    v_lshrrev_b32 v55, 3, v57
    v_mul_u32_u24 v49, 1152, v55
    v_and_b32 v55, 7, v57
    v_lshl_add_u32 v49, v55, 4, v49
    v_bfe_u32 v54, v57, 4, 1
    v_lshlrev_b32 v52, 13, v54
    v_bfe_u32 v54, v57, 5, 1
    v_lshl_add_u32 v52, v54, 9, v52
    v_bfe_u32 v54, v57, 2, 1
    v_lshl_add_u32 v52, v54, 7, v52
    v_bfe_u32 v54, v57, 3, 1
    v_lshl_add_u32 v52, v54, 5, v52
    v_and_b32 v55, 3, v57
    v_lshl_add_u32 v52, v55, 3, v52
    v_lshrrev_b32 v55, 2, v57
    v_mul_u32_u24 v50, 1152, v55
    v_and_b32 v55, 3, v57
    v_lshl_add_u32 v50, v55, 4, v50
    v_bfe_u32 v54, v57, 4, 1
    v_lshlrev_b32 v53, 12, v54
    v_bfe_u32 v54, v57, 5, 1
    v_lshl_add_u32 v53, v54, 8, v53
    v_bfe_u32 v54, v57, 2, 1
    v_lshl_add_u32 v53, v54, 6, v53
    v_bfe_u32 v54, v57, 3, 1
    v_lshl_add_u32 v53, v54, 5, v53
    v_and_b32 v55, 3, v57
    v_lshl_add_u32 v53, v55, 3, v53
    s_lshl_b32 s66, s13, 10
    s_and_b32 s93, s13, 1
    s_lshl_b32 s93, s93, 14
    s_and_b32 s75, s13, 2
    s_lshl_b32 s75, s75, 19
    v_add_u32 v51, s66, v51
    v_add_u32 v52, s66, v52
    v_add_u32 v53, s66, v53
    v_mov_b32 v58, v48
    s_mov_b32 s10, 4718592
    s_mov_b32 s11, 0x20000
    s_lshl_b32 s67, s12, 8
    s_lshl_b32 s40, s13, 6
    s_add_u32 s67, s67, s40
    s_mul_i32 s92, s12, 147456
    s_lshr_b32 s73, s50, 8
    s_add_u32 s73, s73, s12
    s_and_b32 s73, s73, 31
    s_bitcmp1_b32 0xa2222222, s73
    s_cselect_b32 s88, 0, 0
    s_mov_b32 s72, 0
    s_add_u32 s73, s73, 1
    s_lshr_b32 s73, s73, 2
    s_xor_b32 s94, s13, 0
    s_mul_i32 s94, s94, 36864
    s_add_u32 s94, s94, s92
    s_lshl_b32 s74, s13, 7
    s_add_u32 s94, s94, s74
    s_add_u32 s78, s94, 0
    s_mov_b64 s[8:9], s[56:57]
    v_mov_b32 v58, v49
    s_mov_b32 s79, 9216
    s_mov_b32 s81, 0
    s_add_u32 s80, s66, 114688
    s_mov_b32 s76, 0
    s_mov_b32 s77, 8192
    s_call_b64 s[82:83], cs_dma
    s_mov_b32 s77, 16384
    s_call_b64 s[82:83], cs_dma
    s_xor_b32 s94, s13, 1
    s_mul_i32 s94, s94, 36864
    s_add_u32 s94, s94, s92
    s_lshl_b32 s74, s13, 7
    s_add_u32 s94, s94, s74
    s_add_u32 s78, s94, 0
    s_add_u32 s80, s66, 81920
    s_mov_b32 s76, 0
    s_mov_b32 s77, 8192
    s_call_b64 s[82:83], cs_dma
    s_mov_b32 s77, 16384
    s_call_b64 s[82:83], cs_dma
    s_xor_b32 s94, s13, 2
    s_mul_i32 s94, s94, 36864
    s_add_u32 s94, s94, s92
    s_lshl_b32 s74, s13, 7
    s_add_u32 s94, s94, s74
    s_add_u32 s78, s94, 0
    s_add_u32 s80, s66, 16384
    s_mov_b32 s76, 0
    s_mov_b32 s77, 8192
    s_call_b64 s[82:83], cs_dma
    s_mov_b32 s77, 16384
    s_call_b64 s[82:83], cs_dma
    s_xor_b32 s94, s13, 3
    s_mul_i32 s94, s94, 36864
    s_add_u32 s94, s94, s92
    s_lshl_b32 s74, s13, 7
    s_add_u32 s94, s94, s74
    s_add_u32 s78, s94, 0
    s_add_u32 s80, s66, 0
    s_mov_b32 s76, 0
    s_mov_b32 s77, 8192
    s_call_b64 s[82:83], cs_dma
    s_mov_b32 s77, 16384
    s_call_b64 s[82:83], cs_dma
    v_lshrrev_b32 v24, 6, v0
    v_lshlrev_b32 v61, 4, v0
    v_add_u32 v62, 57344, v61
    v_xor_b32 v63, 1024, v61
    v_add_u32 v63, 98304, v63
    v_xor_b32 v64, 2048, v61
    v_add_u32 v64, 98304, v64
    v_and_b32 v65, 1023, v61
    v_add_u32 v65, 98304, v65
    v_and_b32 v26, 15, v0
    v_bfe_u32 v27, v0, 4, 2
    v_mov_b32 v60, 0x4444
    v_mov_b32 v25, 0xeeee
    v_cmp_lt_u32 vcc, 7, v26
    s_nop 1
    v_cndmask_b32 v60, v60, v25, vcc
    s_nop 1
    v_and_b32 v67, 12, v26
    v_lshlrev_b32 v67, 3, v67
    v_and_b32 v25, 1, v26
    v_lshl_add_u32 v67, v25, 4, v67
    v_bfe_u32 v25, v26, 1, 1
    v_lshl_add_u32 v67, v25, 3, v67
    v_lshl_add_u32 v66, v27, 14, v67
    v_lshl_add_u32 v66, v24, 17, v66
    s_nop 1
    v_and_b32 v67, 63, v67
    v_lshrrev_b32 v25, 1, v24
    v_lshl_add_u32 v67, v25, 18, v67
    v_lshl_add_u32 v67, v27, 16, v67
    v_lshrrev_b32 v25, 3, v26
    v_lshl_add_u32 v67, v25, 15, v67
    v_and_b32 v25, 1, v24
    v_lshl_add_u32 v67, v25, 6, v67
    s_nop 1
    s_waitcnt vmcnt(12)
    v_add_u32 v55, 114688, v52
    ds_read_b64_tr_b16 v[160:161], v55 offset:0
    ds_read_b64_tr_b16 v[162:163], v55 offset:256
    ds_read_b64_tr_b16 v[164:165], v55 offset:4096
    ds_read_b64_tr_b16 v[166:167], v55 offset:4352
    s_xor_b32 s94, s13, 0
    s_mul_i32 s94, s94, 36864
    s_add_u32 s94, s94, s92
    s_lshl_b32 s74, s13, 7
    s_add_u32 s94, s94, s74
    s_add_u32 s78, s94, 512
    s_add_u32 s80, s66, 147456
    s_mov_b32 s76, 0
    s_mov_b32 s77, 8192
    s_call_b64 s[82:83], cs_dma
    ds_read_b64_tr_b16 v[192:193], v55 offset:64
    ds_read_b64_tr_b16 v[194:195], v55 offset:320
    ds_read_b64_tr_b16 v[196:197], v55 offset:4160
    ds_read_b64_tr_b16 v[198:199], v55 offset:4416
    s_mov_b32 s77, 16384
    s_call_b64 s[82:83], cs_dma
    v_and_b32 v25, 31, v0
    v_lshlrev_b32 v70, 4, v25
    v_lshlrev_b32 v28, 3, v25
    v_add_u32 v28, 108032, v28
    v_lshrrev_b32 v25, 1, v24
    v_lshl_add_u32 v70, v25, 9, v70
    v_and_b32 v25, 1, v24
    v_lshl_add_u32 v70, v25, 3, v70
    v_add_u32 v70, 109568, v70
    v_cmp_gt_u32 vcc, 2, v27
    s_nop 1
    v_cndmask_b32 v70, v70, v28, vcc
    s_nop 1
    s_waitcnt lgkmcnt(0)
    s_waitcnt vmcnt(12)
    v_add_u32 v55, 81920, v52
    ds_read_b64_tr_b16 v[168:169], v55 offset:0
    ds_read_b64_tr_b16 v[170:171], v55 offset:256
    ds_read_b64_tr_b16 v[172:173], v55 offset:4096
    ds_read_b64_tr_b16 v[174:175], v55 offset:4352
    s_xor_b32 s94, s13, 1
    s_mul_i32 s94, s94, 36864
    s_add_u32 s94, s94, s92
    s_lshl_b32 s74, s13, 7
    s_add_u32 s94, s94, s74
    s_add_u32 s78, s94, 512
    s_add_u32 s80, s66, 98304
    s_mov_b32 s76, 0
    s_mov_b32 s77, 8192
    s_call_b64 s[82:83], cs_dma
    ds_read_b64_tr_b16 v[200:201], v55 offset:64
    ds_read_b64_tr_b16 v[202:203], v55 offset:320
    ds_read_b64_tr_b16 v[204:205], v55 offset:4160
    ds_read_b64_tr_b16 v[206:207], v55 offset:4416
    s_mov_b32 s77, 16384
    s_call_b64 s[82:83], cs_dma
    v_xor_b32 v71, 2048, v63
    v_lshrrev_b32 v68, 4, v0
    v_lshlrev_b32 v68, 7, v68
    v_and_b32 v25, 7, v26
    v_lshl_add_u32 v68, v25, 4, v68
    v_add_u32 v68, 102400, v68
    v_xor_b32 v74, 512, v68
    v_xor_b32 v75, 1024, v68
    v_xor_b32 v76, 1536, v68
    v_lshrrev_b32 v25, 3, v26
    v_lshl_add_u32 v77, v25, 3, v68
    v_or_b32 v78, 512, v65
    v_lshlrev_b32 v79, 2, v61
    v_mov_b64 v[72:73], 0
    v_and_b32 v25, 1, v27
    v_lshlrev_b32 v69, 7, v25
    v_lshrrev_b32 v25, 1, v27
    v_lshl_add_u32 v69, v25, 3, v69
    v_and_b32 v25, 3, v26
    v_lshl_add_u32 v69, v25, 4, v69
    v_bfe_u32 v25, v26, 2, 1
    v_lshl_add_u32 v69, v25, 2, v69
    s_nop 1
    s_waitcnt lgkmcnt(0)
    s_waitcnt vmcnt(12)
    v_add_u32 v55, 16384, v52
    ds_read_b64_tr_b16 v[176:177], v55 offset:0
    ds_read_b64_tr_b16 v[178:179], v55 offset:256
    ds_read_b64_tr_b16 v[180:181], v55 offset:4096
    ds_read_b64_tr_b16 v[182:183], v55 offset:4352
    s_add_u32 s78, s67, 4194304
    s_mov_b64 s[8:9], s[54:55]
    v_mov_b32 v58, v48
    s_mov_b32 s79, 131072
    s_add_u32 s80, s66, 32768
    s_mov_b32 s76, 0
    s_mov_b32 s77, 8192
    s_call_b64 s[82:83], cs_dma
    ds_read_b64_tr_b16 v[208:209], v55 offset:64
    ds_read_b64_tr_b16 v[210:211], v55 offset:320
    ds_read_b64_tr_b16 v[212:213], v55 offset:4160
    ds_read_b64_tr_b16 v[214:215], v55 offset:4416
    s_mov_b32 s77, 16384
    s_call_b64 s[82:83], cs_dma
    s_mov_b32 s32, 0x00ff00ff
    s_mov_b32 s33, 0x00ff00ff
    s_not_b64 s[34:35], s[32:33]
    s_lshr_b32 s31, s12, 1
    s_lshl_b32 s31, s31, 8
    s_and_b32 s40, s12, 1
    s_lshl_b32 s40, s40, 6
    s_add_u32 s31, s31, s40
    s_and_b32 s40, s13, 1
    s_lshl_b32 s40, s40, 12
    s_add_u32 s31, s31, s40
    s_lshl_b32 s19, s12, 14
    s_add_u32 s19, s19, 68124672
    s_add_u32 s41, s19, 8192
    s_add_u32 s19, s19, s40
    s_and_b32 s40, s12, 1
    s_lshl_b32 s40, s40, 2
    s_or_b32 s40, s40, s13
    s_cmp_eq_u32 s40, 5
    s_cselect_b32 s64, 0, s13
    s_cmp_lg_u32 s13, 1
    s_cbranch_scc1 cs_notx
    s_mov_b32 s32, 0xff
    s_mov_b32 s33, 0xff
    s_mov_b32 s19, s41
    s_lshr_b32 s31, s12, 3
    s_lshl_b32 s31, s31, 8
    s_and_b32 s40, s12, 2
    s_lshl_b32 s40, s40, 6
    s_add_u32 s31, s31, s40
    s_and_b32 s40, s12, 4
    s_lshl_b32 s40, s40, 4
    s_add_u32 s31, s31, s40
    s_add_u32 s31, s31, 8192
cs_notx:
    s_cmp_lg_u32 s13, 0
    s_cbranch_scc1 cs_notp
    s_min_u32 s40, s12, 23
    s_mul_i32 s40, s40, 384
    s_add_u32 s40, s40, 98304
    v_add_u32 v69, s40, v61
    v_mov_b32 v25, 108288
    v_cmp_lt_u32 vcc, 23, v0
    s_nop 1
    v_cndmask_b32 v69, v69, v25, vcc
cs_notp:
    s_nop 1
    s_waitcnt lgkmcnt(0)
    s_waitcnt vmcnt(12)
    v_add_u32 v55, 0, v52
    ds_read_b64_tr_b16 v[184:185], v55 offset:0
    ds_read_b64_tr_b16 v[186:187], v55 offset:256
    ds_read_b64_tr_b16 v[188:189], v55 offset:4096
    ds_read_b64_tr_b16 v[190:191], v55 offset:4352
    s_xor_b32 s78, s75, 0
    s_add_u32 s78, s78, s67
    s_mov_b32 s81, s93
    s_add_u32 s80, s66, 114688
    s_mov_b32 s76, 0
    s_mov_b32 s77, 8192
    s_call_b64 s[82:83], cs_dma
    ds_read_b64_tr_b16 v[216:217], v55 offset:64
    ds_read_b64_tr_b16 v[218:219], v55 offset:320
    ds_read_b64_tr_b16 v[220:221], v55 offset:4160
    ds_read_b64_tr_b16 v[222:223], v55 offset:4416
    s_mov_b32 s77, 16384
    s_call_b64 s[82:83], cs_dma
    v_mov_b32 v28, 1
    v_mov_b32 v29, 1
    v_mov_b32 v30, 1
    v_mov_b32 v31, 1
    s_lshl_b32 s40, s12, 14
    s_add_u32 s40, s40, 68222976
    s_add_u32 s41, s40, 0
    buffer_store_dwordx4 v[28:31], v61, s[4:7], s41 offen sc1
    s_add_u32 s41, s40, 4096
    buffer_store_dwordx4 v[28:31], v61, s[4:7], s41 offen sc1
    s_add_u32 s41, s40, 8192
    buffer_store_dwordx4 v[28:31], v61, s[4:7], s41 offen sc1
    s_cmp_eq_u32 s64, 0
    s_cselect_b64 exec, 0, s[32:33]
    v_mov_b32 v27, -1
    s_add_u32 s41, s31, 68157440
    buffer_store_dword v27, v69, s[4:7], s41 offen sc1
    s_add_u32 s41, s31, 68173824
    buffer_store_dword v27, v69, s[4:7], s41 offen sc1
    s_add_u32 s41, s31, 68190208
    buffer_store_dword v27, v69, s[4:7], s41 offen sc1
    s_add_u32 s41, s31, 68206592
    buffer_store_dword v27, v69, s[4:7], s41 offen sc1
    s_mov_b64 exec, -1
    s_waitcnt lgkmcnt(0)
    s_waitcnt vmcnt(12)
    v_add_u32 v55, 147456, v52
    ds_read_b64_tr_b16 v[224:225], v55 offset:0
    ds_read_b64_tr_b16 v[226:227], v55 offset:256
    ds_read_b64_tr_b16 v[228:229], v55 offset:4096
    ds_read_b64_tr_b16 v[230:231], v55 offset:4352
    s_mov_b32 s77, 24576
    s_call_b64 s[82:83], cs_dma
    ds_read_b64_tr_b16 v[240:241], v55 offset:64
    ds_read_b64_tr_b16 v[242:243], v55 offset:320
    ds_read_b64_tr_b16 v[244:245], v55 offset:4160
    ds_read_b64_tr_b16 v[246:247], v55 offset:4416
    s_mov_b32 s77, 32768
    s_call_b64 s[82:83], cs_dma
    s_mov_b64 s[68:69], s[48:49]
    s_mov_b32 s70, 9216
    s_mov_b32 s71, 0x20000
    v_and_b32 v25, 7, v0
    v_mul_u32_u24 v25, 1152, v25
    v_lshrrev_b32 v26, 3, v0
    v_lshl_add_u32 v25, v26, 4, v25
    buffer_load_dwordx4 v[36:39], v25, s[68:71], 0 offen
    buffer_load_dwordx4 v[40:43], v25, s[68:71], 0 offen offset:512
    v_bfe_u32 v25, v0, 2, 3
    v_mul_u32_u24 v25, 1152, v25
    v_lshrrev_b32 v26, 5, v0
    v_lshl_add_u32 v25, v26, 4, v25
    v_and_b32 v26, 3, v0
    v_lshl_add_u32 v25, v26, 2, v25
    buffer_load_dword v44, v25, s[68:71], 0 offen offset:1024
    s_nop 0
    s_waitcnt lgkmcnt(0)
    s_waitcnt vmcnt(15)
    v_add_u32 v55, 98304, v52
    ds_read_b64_tr_b16 v[232:233], v55 offset:0
    ds_read_b64_tr_b16 v[234:235], v55 offset:256
    ds_read_b64_tr_b16 v[236:237], v55 offset:4096
    ds_read_b64_tr_b16 v[238:239], v55 offset:4352
    s_xor_b32 s78, s75, 1048576
    s_add_u32 s78, s78, s67
    s_add_u32 s80, s66, 65536
    s_mov_b32 s76, 0
    s_mov_b32 s77, 8192
    s_call_b64 s[82:83], cs_dma
    ds_read_b64_tr_b16 v[248:249], v55 offset:64
    ds_read_b64_tr_b16 v[250:251], v55 offset:320
    ds_read_b64_tr_b16 v[252:253], v55 offset:4160
    ds_read_b64_tr_b16 v[254:255], v55 offset:4416
    s_mov_b32 s77, 16384
    s_call_b64 s[82:83], cs_dma
    s_mov_b32 s44, 0x3e0293ee
    s_mov_b32 s45, s44
    s_mov_b32 s46, 0x42000000
    s_mov_b32 s60, 0x3f803f80
    s_mov_b32 s61, s60
    s_mov_b32 s62, 0x3e803e80
    s_mov_b32 s63, s62
    s_mov_b32 s28, 0
    s_lshl_b32 s58, s13, 10
    s_add_u32 s58, s58, 102400
    s_lshl_b32 s59, s13, 8
    s_add_u32 s59, s59, 106496
    s_lshl_b32 s24, s12, 14
    s_add_u32 s24, s24, 0
    s_add_u32 s47, s24, 33030144
    s_mul_i32 s40, s13, 3072
    s_add_u32 s23, s24, s40
    s_lshl_b32 s20, s12, 7
    s_add_u32 s20, s20, 68222976
    s_add_u32 s21, s20, 65536
    s_add_u32 s38, s20, 4096
    s_add_u32 s39, s21, 4096
    s_lshl_b32 s22, s12, 7
    s_add_u32 s22, s22, 68231168
    s_waitcnt lgkmcnt(0)
    s_waitcnt vmcnt(15)
    v_add_u32 v55, 32768, v51
    v_xor_b32 v56, 32, v55
    ds_read_b64_tr_b16 v[144:145], v55 offset:0
    ds_read_b64_tr_b16 v[146:147], v55 offset:256
    ds_read_b64_tr_b16 v[148:149], v55 offset:8192
    ds_read_b64_tr_b16 v[150:151], v55 offset:8448
    s_mov_b32 s77, 24576
    s_call_b64 s[82:83], cs_dma
    ds_read_b64_tr_b16 v[152:153], v56 offset:0
    ds_read_b64_tr_b16 v[154:155], v56 offset:256
    ds_read_b64_tr_b16 v[156:157], v56 offset:8192
    ds_read_b64_tr_b16 v[158:159], v56 offset:8448
    s_mov_b32 s77, 32768
    s_call_b64 s[82:83], cs_dma
    s_lshl_b32 s40, s12, 12
    s_add_u32 s25, s40, 79429632
    s_add_u32 s26, s40, 88866816
    s_lshl_b32 s65, s12, 9
    s_add_u32 s65, s65, 90177536
    s_lshl_b32 s40, s13, 5
    s_or_b32 s40, s40, s12
    s_cmp_lt_u32 s40, 24
    s_cselect_b32 s36, 0x1ffffff, 0
    s_mov_b32 s37, 0
    s_lshl_b32 s27, s12, 7
    s_add_u32 s27, s27, 125845504
    s_lshl_b32 s40, s13, 2
    s_add_u32 s27, s27, s40
    v_bfe_u32 v28, v61, 4, 4
    v_bfe_u32 v29, v61, 8, 1
    v_lshlrev_b32 v29, 2, v29
    v_sub_u32 v29, v28, v29
    v_mov_b32 v31, 0x3f80
    v_mov_b32 v32, 0x3f800000
    s_nop 1
    s_waitcnt lgkmcnt(0)
    s_waitcnt vmcnt(11)
    v_add_u32 v55, 114688, v51
    v_xor_b32 v56, 32, v55
    ds_read_b64_tr_b16 a[192:193], v55 offset:0
    ds_read_b64_tr_b16 a[194:195], v55 offset:256
    ds_read_b64_tr_b16 a[196:197], v55 offset:8192
    ds_read_b64_tr_b16 a[198:199], v55 offset:8448
    s_xor_b32 s78, s75, 2097152
    s_add_u32 s78, s78, s67
    s_add_u32 s80, s66, 0
    s_mov_b32 s76, 0
    s_mov_b32 s77, 8192
    s_call_b64 s[82:83], cs_dma
    ds_read_b64_tr_b16 a[200:201], v56 offset:0
    ds_read_b64_tr_b16 a[202:203], v56 offset:256
    ds_read_b64_tr_b16 a[204:205], v56 offset:8192
    ds_read_b64_tr_b16 a[206:207], v56 offset:8448
    s_mov_b32 s77, 16384
    s_call_b64 s[82:83], cs_dma
    v_cmp_eq_u32 vcc, 0, v29
    s_nop 1
    v_cndmask_b32 v16, 0, v31, vcc
    v_cmp_eq_u32 vcc, 1, v29
    s_nop 1
    v_cndmask_b32 v16, v16, v32, vcc
    v_cmp_eq_u32 vcc, 0, v28
    s_nop 1
    v_cndmask_b32 v20, 0, v31, vcc
    v_cmp_eq_u32 vcc, 1, v28
    s_nop 1
    v_cndmask_b32 v20, v20, v32, vcc
    s_nop 1
    s_waitcnt lgkmcnt(0)
    v_add_u32 v55, 131072, v51
    v_xor_b32 v56, 32, v55
    ds_read_b64_tr_b16 a[208:209], v55 offset:0
    ds_read_b64_tr_b16 a[210:211], v55 offset:256
    ds_read_b64_tr_b16 a[212:213], v55 offset:8192
    ds_read_b64_tr_b16 a[214:215], v55 offset:8448
    s_mov_b32 s77, 24576
    s_call_b64 s[82:83], cs_dma
    ds_read_b64_tr_b16 a[216:217], v56 offset:0
    ds_read_b64_tr_b16 a[218:219], v56 offset:256
    ds_read_b64_tr_b16 a[220:221], v56 offset:8192
    ds_read_b64_tr_b16 a[222:223], v56 offset:8448
    s_mov_b32 s77, 32768
    s_call_b64 s[82:83], cs_dma
    v_cmp_eq_u32 vcc, 2, v29
    s_nop 1
    v_cndmask_b32 v17, 0, v31, vcc
    v_cmp_eq_u32 vcc, 3, v29
    s_nop 1
    v_cndmask_b32 v17, v17, v32, vcc
    v_cmp_eq_u32 vcc, 2, v28
    s_nop 1
    v_cndmask_b32 v21, 0, v31, vcc
    v_cmp_eq_u32 vcc, 3, v28
    s_nop 1
    v_cndmask_b32 v21, v21, v32, vcc
    s_nop 1
    s_waitcnt lgkmcnt(0)
    s_waitcnt vmcnt(8)
    v_add_u32 v55, 65536, v51
    v_xor_b32 v56, 32, v55
    ds_read_b64_tr_b16 a[224:225], v55 offset:0
    ds_read_b64_tr_b16 a[226:227], v55 offset:256
    ds_read_b64_tr_b16 a[228:229], v55 offset:8192
    ds_read_b64_tr_b16 a[230:231], v55 offset:8448
    s_xor_b32 s78, s75, 3145728
    s_add_u32 s78, s78, s67
    s_add_u32 s80, s66, 32768
    s_mov_b32 s76, 0
    s_mov_b32 s77, 8192
    s_call_b64 s[82:83], cs_dma
    ds_read_b64_tr_b16 a[232:233], v56 offset:0
    ds_read_b64_tr_b16 a[234:235], v56 offset:256
    ds_read_b64_tr_b16 a[236:237], v56 offset:8192
    ds_read_b64_tr_b16 a[238:239], v56 offset:8448
    s_mov_b32 s77, 16384
    s_call_b64 s[82:83], cs_dma
    v_cmp_eq_u32 vcc, 8, v29
    s_nop 1
    v_cndmask_b32 v18, 0, v31, vcc
    v_cmp_eq_u32 vcc, 9, v29
    s_nop 1
    v_cndmask_b32 v18, v18, v32, vcc
    v_cmp_eq_u32 vcc, 4, v28
    s_nop 1
    v_cndmask_b32 v22, 0, v31, vcc
    v_cmp_eq_u32 vcc, 5, v28
    s_nop 1
    v_cndmask_b32 v22, v22, v32, vcc
    s_nop 1
    s_waitcnt lgkmcnt(0)
    v_add_u32 v55, 81920, v51
    v_xor_b32 v56, 32, v55
    ds_read_b64_tr_b16 a[240:241], v55 offset:0
    ds_read_b64_tr_b16 a[242:243], v55 offset:256
    ds_read_b64_tr_b16 a[244:245], v55 offset:8192
    ds_read_b64_tr_b16 a[246:247], v55 offset:8448
    s_mov_b32 s77, 24576
    s_call_b64 s[82:83], cs_dma
    ds_read_b64_tr_b16 a[248:249], v56 offset:0
    ds_read_b64_tr_b16 a[250:251], v56 offset:256
    ds_read_b64_tr_b16 a[252:253], v56 offset:8192
    ds_read_b64_tr_b16 a[254:255], v56 offset:8448
    s_mov_b32 s77, 32768
    s_call_b64 s[82:83], cs_dma
    v_cmp_eq_u32 vcc, 10, v29
    s_nop 1
    v_cndmask_b32 v19, 0, v31, vcc
    v_cmp_eq_u32 vcc, 11, v29
    s_nop 1
    v_cndmask_b32 v19, v19, v32, vcc
    v_cmp_eq_u32 vcc, 6, v28
    s_nop 1
    v_cndmask_b32 v23, 0, v31, vcc
    v_cmp_eq_u32 vcc, 7, v28
    s_nop 1
    v_cndmask_b32 v23, v23, v32, vcc
    s_nop 1
    s_waitcnt lgkmcnt(0)
    s_waitcnt vmcnt(8)
    v_add_u32 v55, 0, v51
    v_xor_b32 v56, 32, v55
    ds_read_b64_tr_b16 v[80:81], v55 offset:0
    ds_read_b64_tr_b16 v[82:83], v55 offset:256
    ds_read_b64_tr_b16 v[84:85], v55 offset:8192
    ds_read_b64_tr_b16 v[86:87], v55 offset:8448
    s_xor_b32 s78, s75, 2097152
    s_add_u32 s78, s78, s67
    s_mov_b64 s[8:9], s[52:53]
    s_add_u32 s80, s66, 131072
    s_mov_b32 s76, 0
    s_mov_b32 s77, 8192
    s_call_b64 s[82:83], cs_dma
    ds_read_b64_tr_b16 v[88:89], v56 offset:0
    ds_read_b64_tr_b16 v[90:91], v56 offset:256
    ds_read_b64_tr_b16 v[92:93], v56 offset:8192
    ds_read_b64_tr_b16 v[94:95], v56 offset:8448
    s_mov_b32 s77, 16384
    s_call_b64 s[82:83], cs_dma
    v_mov_b32 v46, 1
    s_mov_b64 exec, 1
    buffer_atomic_add v46, off, s[96:99], 0 offset:212 sc0
    s_mov_b64 exec, -1
    s_waitcnt lgkmcnt(0)
    v_add_u32 v55, 16384, v51
    v_xor_b32 v56, 32, v55
    ds_read_b64_tr_b16 v[96:97], v55 offset:0
    ds_read_b64_tr_b16 v[98:99], v55 offset:256
    ds_read_b64_tr_b16 v[100:101], v55 offset:8192
    ds_read_b64_tr_b16 v[102:103], v55 offset:8448
    s_mov_b32 s77, 24576
    s_call_b64 s[82:83], cs_dma
    ds_read_b64_tr_b16 v[104:105], v56 offset:0
    ds_read_b64_tr_b16 v[106:107], v56 offset:256
    ds_read_b64_tr_b16 v[108:109], v56 offset:8192
    ds_read_b64_tr_b16 v[110:111], v56 offset:8448
    s_mov_b32 s77, 32768
    s_call_b64 s[82:83], cs_dma
    s_waitcnt lgkmcnt(0)
    s_waitcnt vmcnt(9)
    v_add_u32 v55, 32768, v51
    v_xor_b32 v56, 32, v55
    ds_read_b64_tr_b16 v[112:113], v55 offset:0
    ds_read_b64_tr_b16 v[114:115], v55 offset:256
    ds_read_b64_tr_b16 v[116:117], v55 offset:8192
    ds_read_b64_tr_b16 v[118:119], v55 offset:8448
    s_xor_b32 s78, s75, 3145728
    s_add_u32 s78, s78, s67
    s_add_u32 s80, s66, 65536
    s_mov_b32 s76, 0
    s_mov_b32 s77, 8192
    s_call_b64 s[82:83], cs_dma
    ds_read_b64_tr_b16 v[120:121], v56 offset:0
    ds_read_b64_tr_b16 v[122:123], v56 offset:256
    ds_read_b64_tr_b16 v[124:125], v56 offset:8192
    ds_read_b64_tr_b16 v[126:127], v56 offset:8448
    s_mov_b32 s77, 16384
    s_call_b64 s[82:83], cs_dma
    s_waitcnt lgkmcnt(0)
    v_add_u32 v55, 49152, v51
    v_xor_b32 v56, 32, v55
    ds_read_b64_tr_b16 v[128:129], v55 offset:0
    ds_read_b64_tr_b16 v[130:131], v55 offset:256
    ds_read_b64_tr_b16 v[132:133], v55 offset:8192
    ds_read_b64_tr_b16 v[134:135], v55 offset:8448
    s_mov_b32 s77, 24576
    s_call_b64 s[82:83], cs_dma
    ds_read_b64_tr_b16 v[136:137], v56 offset:0
    ds_read_b64_tr_b16 v[138:139], v56 offset:256
    ds_read_b64_tr_b16 v[140:141], v56 offset:8192
    ds_read_b64_tr_b16 v[142:143], v56 offset:8448
    s_mov_b32 s77, 32768
    s_call_b64 s[82:83], cs_dma
    s_waitcnt lgkmcnt(0)
    s_waitcnt vmcnt(8)
    v_add_u32 v55, 131072, v51
    v_xor_b32 v56, 32, v55
    ds_read_b64_tr_b16 a[128:129], v55 offset:0
    ds_read_b64_tr_b16 a[130:131], v55 offset:256
    ds_read_b64_tr_b16 a[132:133], v55 offset:8192
    ds_read_b64_tr_b16 a[134:135], v55 offset:8448
    s_xor_b32 s78, s75, 2097152
    s_add_u32 s78, s78, s67
    s_mov_b64 s[8:9], s[50:51]
    s_add_u32 s80, s66, 0
    s_mov_b32 s76, 0
    s_mov_b32 s77, 8192
    s_call_b64 s[82:83], cs_dma
    ds_read_b64_tr_b16 a[136:137], v56 offset:0
    ds_read_b64_tr_b16 a[138:139], v56 offset:256
    ds_read_b64_tr_b16 a[140:141], v56 offset:8192
    ds_read_b64_tr_b16 a[142:143], v56 offset:8448
    s_mov_b32 s77, 16384
    s_call_b64 s[82:83], cs_dma
    s_waitcnt lgkmcnt(0)
    v_add_u32 v55, 147456, v51
    v_xor_b32 v56, 32, v55
    ds_read_b64_tr_b16 a[144:145], v55 offset:0
    ds_read_b64_tr_b16 a[146:147], v55 offset:256
    ds_read_b64_tr_b16 a[148:149], v55 offset:8192
    ds_read_b64_tr_b16 a[150:151], v55 offset:8448
    s_mov_b32 s77, 24576
    s_call_b64 s[82:83], cs_dma
    ds_read_b64_tr_b16 a[152:153], v56 offset:0
    ds_read_b64_tr_b16 a[154:155], v56 offset:256
    ds_read_b64_tr_b16 a[156:157], v56 offset:8192
    ds_read_b64_tr_b16 a[158:159], v56 offset:8448
    s_mov_b32 s77, 32768
    s_call_b64 s[82:83], cs_dma
    s_waitcnt lgkmcnt(0)
    s_waitcnt vmcnt(8)
    v_add_u32 v55, 65536, v51
    v_xor_b32 v56, 32, v55
    ds_read_b64_tr_b16 a[160:161], v55 offset:0
    ds_read_b64_tr_b16 a[162:163], v55 offset:256
    ds_read_b64_tr_b16 a[164:165], v55 offset:8192
    ds_read_b64_tr_b16 a[166:167], v55 offset:8448
    s_xor_b32 s78, s75, 3145728
    s_add_u32 s78, s78, s67
    s_add_u32 s80, s66, 32768
    s_mov_b32 s76, 0
    s_mov_b32 s77, 8192
    s_call_b64 s[82:83], cs_dma
    ds_read_b64_tr_b16 a[168:169], v56 offset:0
    ds_read_b64_tr_b16 a[170:171], v56 offset:256
    ds_read_b64_tr_b16 a[172:173], v56 offset:8192
    ds_read_b64_tr_b16 a[174:175], v56 offset:8448
    s_mov_b32 s77, 16384
    s_call_b64 s[82:83], cs_dma
    v_readfirstlane_b32 s41, v46
    v_mov_b32 v46, 1
    v_mov_b32 v47, 0
    s_cmp_eq_u32 s41, 127
    s_cselect_b64 exec, 1, 0
    buffer_atomic_cmpswap v[46:47], off, s[96:99], 0 offset:216
    s_mov_b64 exec, -1
    s_waitcnt lgkmcnt(0)
    v_add_u32 v55, 81920, v51
    v_xor_b32 v56, 32, v55
    ds_read_b64_tr_b16 a[176:177], v55 offset:0
    ds_read_b64_tr_b16 a[178:179], v55 offset:256
    ds_read_b64_tr_b16 a[180:181], v55 offset:8192
    ds_read_b64_tr_b16 a[182:183], v55 offset:8448
    s_mov_b32 s77, 24576
    s_call_b64 s[82:83], cs_dma
    ds_read_b64_tr_b16 a[184:185], v56 offset:0
    ds_read_b64_tr_b16 a[186:187], v56 offset:256
    ds_read_b64_tr_b16 a[188:189], v56 offset:8192
    ds_read_b64_tr_b16 a[190:191], v56 offset:8448
    s_mov_b32 s77, 32768
    s_call_b64 s[82:83], cs_dma
    s_waitcnt lgkmcnt(0)
    s_waitcnt vmcnt(8)
    v_add_u32 v55, 0, v51
    v_xor_b32 v56, 32, v55
    ds_read_b64_tr_b16 a[48:49], v55 offset:0
    ds_read_b64_tr_b16 a[50:51], v55 offset:256
    ds_read_b64_tr_b16 a[52:53], v55 offset:8192
    ds_read_b64_tr_b16 a[54:55], v55 offset:8448
    s_add_u32 s78, s67, 4194304
    s_mov_b32 s81, 0
    s_add_u32 s80, s66, 98304
    s_mov_b32 s76, 0
    s_mov_b32 s77, 8192
    s_call_b64 s[82:83], cs_dma
    ds_read_b64_tr_b16 a[56:57], v56 offset:0
    ds_read_b64_tr_b16 a[58:59], v56 offset:256
    ds_read_b64_tr_b16 a[60:61], v56 offset:8192
    ds_read_b64_tr_b16 a[62:63], v56 offset:8448
    s_mov_b32 s77, 16384
    s_call_b64 s[82:83], cs_dma
    s_waitcnt lgkmcnt(0)
    v_add_u32 v55, 16384, v51
    v_xor_b32 v56, 32, v55
    ds_read_b64_tr_b16 a[64:65], v55 offset:0
    ds_read_b64_tr_b16 a[66:67], v55 offset:256
    ds_read_b64_tr_b16 a[68:69], v55 offset:8192
    ds_read_b64_tr_b16 a[70:71], v55 offset:8448
    s_xor_b32 s78, s75, 1048576
    s_add_u32 s78, s78, s67
    s_mov_b32 s81, s93
    s_add_u32 s80, s66, 114688
    s_mov_b32 s76, 0
    s_mov_b32 s77, 8192
    s_call_b64 s[82:83], cs_dma
    ds_read_b64_tr_b16 a[72:73], v56 offset:0
    ds_read_b64_tr_b16 a[74:75], v56 offset:256
    ds_read_b64_tr_b16 a[76:77], v56 offset:8192
    ds_read_b64_tr_b16 a[78:79], v56 offset:8448
    s_mov_b32 s77, 16384
    s_call_b64 s[82:83], cs_dma
    s_waitcnt lgkmcnt(0)
    s_waitcnt vmcnt(8)
    v_add_u32 v55, 32768, v51
    v_xor_b32 v56, 32, v55
    ds_read_b64_tr_b16 a[80:81], v55 offset:0
    ds_read_b64_tr_b16 a[82:83], v55 offset:256
    ds_read_b64_tr_b16 a[84:85], v55 offset:8192
    ds_read_b64_tr_b16 a[86:87], v55 offset:8448
    s_mov_b32 s77, 24576
    s_call_b64 s[82:83], cs_dma
    ds_read_b64_tr_b16 a[88:89], v56 offset:0
    ds_read_b64_tr_b16 a[90:91], v56 offset:256
    ds_read_b64_tr_b16 a[92:93], v56 offset:8192
    ds_read_b64_tr_b16 a[94:95], v56 offset:8448
    s_mov_b32 s77, 32768
    s_call_b64 s[82:83], cs_dma
    s_waitcnt lgkmcnt(0)
    v_add_u32 v55, 49152, v51
    v_xor_b32 v56, 32, v55
    ds_read_b64_tr_b16 a[96:97], v55 offset:0
    ds_read_b64_tr_b16 a[98:99], v55 offset:256
    ds_read_b64_tr_b16 a[100:101], v55 offset:8192
    ds_read_b64_tr_b16 a[102:103], v55 offset:8448
    s_xor_b32 s78, s75, 0
    s_add_u32 s78, s78, s67
    s_add_u32 s80, s66, 65536
    s_mov_b32 s76, 0
    s_mov_b32 s77, 8192
    s_call_b64 s[82:83], cs_dma
    ds_read_b64_tr_b16 a[104:105], v56 offset:0
    ds_read_b64_tr_b16 a[106:107], v56 offset:256
    ds_read_b64_tr_b16 a[108:109], v56 offset:8192
    ds_read_b64_tr_b16 a[110:111], v56 offset:8448
    s_mov_b32 s77, 16384
    s_call_b64 s[82:83], cs_dma
    s_waitcnt lgkmcnt(0)
    s_waitcnt vmcnt(12)
    v_add_u32 v55, 98304, v51
    v_xor_b32 v56, 32, v55
    ds_read_b64_tr_b16 a[112:113], v55 offset:0
    ds_read_b64_tr_b16 a[114:115], v55 offset:256
    ds_read_b64_tr_b16 a[116:117], v55 offset:8192
    ds_read_b64_tr_b16 a[118:119], v55 offset:8448
    s_mov_b32 s77, 24576
    s_call_b64 s[82:83], cs_dma
    ds_read_b64_tr_b16 a[120:121], v56 offset:0
    ds_read_b64_tr_b16 a[122:123], v56 offset:256
    ds_read_b64_tr_b16 a[124:125], v56 offset:8192
    ds_read_b64_tr_b16 a[126:127], v56 offset:8448
    s_mov_b32 s77, 32768
    s_call_b64 s[82:83], cs_dma
    s_waitcnt lgkmcnt(0)
    s_waitcnt vmcnt(8)
    v_add_u32 v55, 114688, v51
    v_xor_b32 v56, 32, v55
    ds_read_b64_tr_b16 a[16:17], v55 offset:0
    ds_read_b64_tr_b16 a[18:19], v55 offset:256
    ds_read_b64_tr_b16 a[20:21], v55 offset:8192
    ds_read_b64_tr_b16 a[22:23], v55 offset:8448
    s_xor_b32 s78, s75, 0
    s_add_u32 s78, s78, s67
    s_mov_b64 s[8:9], s[52:53]
    s_add_u32 s80, s66, 0
    s_mov_b32 s76, 0
    s_mov_b32 s77, 8192
    s_call_b64 s[82:83], cs_dma
    ds_read_b64_tr_b16 a[24:25], v56 offset:0
    ds_read_b64_tr_b16 a[26:27], v56 offset:256
    ds_read_b64_tr_b16 a[28:29], v56 offset:8192
    ds_read_b64_tr_b16 a[30:31], v56 offset:8448
    s_mov_b32 s77, 16384
    s_call_b64 s[82:83], cs_dma
    s_waitcnt lgkmcnt(0)
    v_add_u32 v55, 131072, v51
    v_xor_b32 v56, 32, v55
    ds_read_b64_tr_b16 a[32:33], v55 offset:0
    ds_read_b64_tr_b16 a[34:35], v55 offset:256
    ds_read_b64_tr_b16 a[36:37], v55 offset:8192
    ds_read_b64_tr_b16 a[38:39], v55 offset:8448
    s_mov_b32 s77, 24576
    s_call_b64 s[82:83], cs_dma
    ds_read_b64_tr_b16 a[40:41], v56 offset:0
    ds_read_b64_tr_b16 a[42:43], v56 offset:256
    ds_read_b64_tr_b16 a[44:45], v56 offset:8192
    ds_read_b64_tr_b16 a[46:47], v56 offset:8448
    s_mov_b32 s77, 32768
    s_call_b64 s[82:83], cs_dma
    s_waitcnt lgkmcnt(0)
    s_waitcnt vmcnt(8)
    v_add_u32 v55, 65536, v51
    v_xor_b32 v56, 32, v55
    ds_read_b64_tr_b16 v[0:1], v55 offset:0
    ds_read_b64_tr_b16 v[2:3], v55 offset:256
    ds_read_b64_tr_b16 v[4:5], v55 offset:8192
    ds_read_b64_tr_b16 v[6:7], v55 offset:8448
    s_xor_b32 s78, s75, 1048576
    s_add_u32 s78, s78, s67
    s_add_u32 s80, s66, 32768
    s_mov_b32 s76, 0
    s_mov_b32 s77, 8192
    s_call_b64 s[82:83], cs_dma
    ds_read_b64_tr_b16 v[8:9], v56 offset:0
    ds_read_b64_tr_b16 v[10:11], v56 offset:256
    ds_read_b64_tr_b16 v[12:13], v56 offset:8192
    ds_read_b64_tr_b16 v[14:15], v56 offset:8448
    s_mov_b32 s77, 16384
    s_call_b64 s[82:83], cs_dma
    s_waitcnt lgkmcnt(0)
    ds_write_b128 v62, v[0:3] offset:8192
    ds_write_b128 v62, v[4:7] offset:12288
    ds_write_b128 v62, v[8:11] offset:16384
    ds_write_b128 v62, v[12:15] offset:20480
    s_waitcnt lgkmcnt(0)
    v_add_u32 v55, 81920, v51
    v_xor_b32 v56, 32, v55
    ds_read_b64_tr_b16 a[0:1], v55 offset:0
    ds_read_b64_tr_b16 a[2:3], v55 offset:256
    ds_read_b64_tr_b16 a[4:5], v55 offset:8192
    ds_read_b64_tr_b16 a[6:7], v55 offset:8448
    s_mov_b32 s77, 24576
    s_call_b64 s[82:83], cs_dma
    ds_read_b64_tr_b16 a[8:9], v56 offset:0
    ds_read_b64_tr_b16 a[10:11], v56 offset:256
    ds_read_b64_tr_b16 a[12:13], v56 offset:8192
    ds_read_b64_tr_b16 a[14:15], v56 offset:8448
    s_mov_b32 s77, 32768
    s_call_b64 s[82:83], cs_dma
    s_waitcnt lgkmcnt(0)
    s_waitcnt vmcnt(8)
    v_add_u32 v55, 0, v51
    v_xor_b32 v56, 32, v55
    ds_read_b64_tr_b16 v[0:1], v55 offset:0
    ds_read_b64_tr_b16 v[2:3], v55 offset:256
    ds_read_b64_tr_b16 v[4:5], v55 offset:8192
    ds_read_b64_tr_b16 v[6:7], v55 offset:8448
    s_xor_b32 s94, s13, 0
    s_mul_i32 s94, s94, 36864
    s_add_u32 s94, s94, s92
    s_lshr_b32 s74, s13, 1
    s_lshl_b32 s74, s74, 6
    s_add_u32 s94, s94, s74
    s_add_u32 s78, s94, 1024
    s_mov_b64 s[8:9], s[56:57]
    v_mov_b32 v58, v50
    s_mov_b32 s79, 18432
    s_mov_b32 s81, 0
    s_add_u32 s80, s66, 147456
    s_mov_b32 s76, 0
    s_mov_b32 s77, 8192
    s_call_b64 s[82:83], cs_dma
    ds_read_b64_tr_b16 v[8:9], v56 offset:0
    ds_read_b64_tr_b16 v[10:11], v56 offset:256
    ds_read_b64_tr_b16 v[12:13], v56 offset:8192
    ds_read_b64_tr_b16 v[14:15], v56 offset:8448
    s_xor_b32 s94, s13, 2
    s_mul_i32 s94, s94, 36864
    s_add_u32 s94, s94, s92
    s_lshr_b32 s74, s13, 1
    s_lshl_b32 s74, s74, 6
    s_add_u32 s94, s94, s74
    s_add_u32 s78, s94, 1024
    s_mov_b32 s77, 16384
    s_call_b64 s[82:83], cs_dma
    s_waitcnt lgkmcnt(0)
    ds_write_b128 v61, v[0:3] offset:0
    ds_write_b128 v61, v[4:7] offset:4096
    ds_write_b128 v61, v[8:11] offset:8192
    ds_write_b128 v61, v[12:15] offset:12288
    s_waitcnt lgkmcnt(0)
    v_add_u32 v55, 16384, v51
    v_xor_b32 v56, 32, v55
    ds_read_b64_tr_b16 v[0:1], v55 offset:0
    ds_read_b64_tr_b16 v[2:3], v55 offset:256
    ds_read_b64_tr_b16 v[4:5], v55 offset:8192
    ds_read_b64_tr_b16 v[6:7], v55 offset:8448
    s_xor_b32 s94, s13, 3
    s_mul_i32 s94, s94, 36864
    s_add_u32 s94, s94, s92
    s_lshl_b32 s74, s13, 7
    s_add_u32 s94, s94, s74
    s_add_u32 s78, s94, 512
    v_mov_b32 v58, v49
    s_mov_b32 s79, 9216
    s_add_u32 s80, s66, 131072
    s_mov_b32 s76, 0
    s_mov_b32 s77, 8192
    s_call_b64 s[82:83], cs_dma
    ds_read_b64_tr_b16 v[8:9], v56 offset:0
    ds_read_b64_tr_b16 v[10:11], v56 offset:256
    ds_read_b64_tr_b16 v[12:13], v56 offset:8192
    ds_read_b64_tr_b16 v[14:15], v56 offset:8448
    s_mov_b32 s77, 16384
    s_call_b64 s[82:83], cs_dma
    s_waitcnt lgkmcnt(0)
    ds_write_b128 v61, v[0:3] offset:16384
    ds_write_b128 v61, v[4:7] offset:20480
    ds_write_b128 v61, v[8:11] offset:24576
    ds_write_b128 v61, v[12:15] offset:28672
    s_waitcnt lgkmcnt(0)
    s_waitcnt vmcnt(8)
    v_add_u32 v55, 32768, v51
    v_xor_b32 v56, 32, v55
    ds_read_b64_tr_b16 v[0:1], v55 offset:0
    ds_read_b64_tr_b16 v[2:3], v55 offset:256
    ds_read_b64_tr_b16 v[4:5], v55 offset:8192
    ds_read_b64_tr_b16 v[6:7], v55 offset:8448
    s_xor_b32 s94, s13, 2
    s_mul_i32 s94, s94, 36864
    s_add_u32 s94, s94, s92
    s_lshl_b32 s74, s13, 7
    s_add_u32 s94, s94, s74
    s_add_u32 s78, s94, 512
    s_add_u32 s80, s66, 114688
    s_mov_b32 s76, 0
    s_mov_b32 s77, 8192
    s_call_b64 s[82:83], cs_dma
    ds_read_b64_tr_b16 v[8:9], v56 offset:0
    ds_read_b64_tr_b16 v[10:11], v56 offset:256
    ds_read_b64_tr_b16 v[12:13], v56 offset:8192
    ds_read_b64_tr_b16 v[14:15], v56 offset:8448
    s_mov_b32 s77, 16384
    s_call_b64 s[82:83], cs_dma
    s_waitcnt lgkmcnt(0)
    ds_write_b128 v61, v[0:3] offset:32768
    ds_write_b128 v61, v[4:7] offset:36864
    ds_write_b128 v61, v[8:11] offset:40960
    ds_write_b128 v61, v[12:15] offset:45056
    s_waitcnt lgkmcnt(0)
    v_add_u32 v55, 49152, v51
    v_xor_b32 v56, 32, v55
    ds_read_b64_tr_b16 v[0:1], v55 offset:0
    ds_read_b64_tr_b16 v[2:3], v55 offset:256
    ds_read_b64_tr_b16 v[4:5], v55 offset:8192
    ds_read_b64_tr_b16 v[6:7], v55 offset:8448
    s_add_u32 s78, s67, 4194304
    s_mov_b64 s[8:9], s[52:53]
    v_mov_b32 v58, v48
    s_mov_b32 s79, 131072
    s_add_u32 s80, s66, 81920
    s_mov_b32 s76, 0
    s_mov_b32 s77, 8192
    s_call_b64 s[82:83], cs_dma
    ds_read_b64_tr_b16 v[8:9], v56 offset:0
    ds_read_b64_tr_b16 v[10:11], v56 offset:256
    ds_read_b64_tr_b16 v[12:13], v56 offset:8192
    ds_read_b64_tr_b16 v[14:15], v56 offset:8448
    s_mov_b32 s77, 16384
    s_call_b64 s[82:83], cs_dma
    s_waitcnt lgkmcnt(0)
    ds_write_b128 v61, v[0:3] offset:49152
    ds_write_b128 v61, v[4:7] offset:53248
    ds_write_b128 v61, v[8:11] offset:57344
    ds_write_b128 v61, v[12:15] offset:61440
    s_waitcnt lgkmcnt(0)
    buffer_load_dword v24, off, s[96:99], 0 offset:216 sc1
    buffer_load_dword v25, off, s[96:99], 0 offset:64 sc1
    s_lshr_b32 s84, s12, 1
    s_lshl_b32 s84, s84, 8
    s_add_u32 s84, s84, 125829120
    v_bfe_u32 v26, v61, 4, 6
    v_min_u32 v26, 11, v26
    v_lshlrev_b32 v26, 2, v26
    buffer_load_dword v27, v26, s[4:7], s84 offen sc1
    s_waitcnt vmcnt(15)
    v_add_u32 v55, 147456, v53
    ds_read_b64_tr_b16 v[0:1], v55 offset:0
    ds_read_b64_tr_b16 v[2:3], v55 offset:128
    ds_read_b64_tr_b16 v[4:5], v55 offset:512
    ds_read_b64_tr_b16 v[6:7], v55 offset:640
    ds_read_b64_tr_b16 v[8:9], v55 offset:8192
    ds_read_b64_tr_b16 v[10:11], v55 offset:8320
    ds_read_b64_tr_b16 v[12:13], v55 offset:8704
    ds_read_b64_tr_b16 v[14:15], v55 offset:8832
    s_waitcnt lgkmcnt(0)
    s_barrier
    ds_write_b128 v63, v[0:3] offset:49152
    ds_write_b128 v63, v[4:7] offset:53248
    s_barrier
    ds_write_b128 v63, v[8:11] offset:57344
    ds_write_b128 v63, v[12:15] offset:61440
    s_waitcnt lgkmcnt(0)
    v_lshlrev_b32 v45, 3, v61
    s_lshl_b32 s40, s12, 14
    s_add_u32 s40, s40, 65536
    s_lshl_b32 s41, s12, 11
    s_sub_u32 s41, s41, 12288
    v_add_u32 v30, s40, v45
    v_add_u32 v45, s41, v45
    v_cmp_gt_u32 vcc, 1536, v61
    s_nop 1
    v_cndmask_b32 v45, v45, v30, vcc
    s_lshl_b32 s40, s12, 16
    s_add_u32 s40, s40, 24102912
    v_lshlrev_b32 v30, 3, v61
    v_add_u32 v30, s40, v30
    v_cmp_gt_u32 vcc, 1792, v61
    s_nop 1
    v_cndmask_b32 v45, v30, v45, vcc
    v_cmp_gt_u32 vcc, 2944, v61
    s_mov_b32 s40, 68157440
    s_mov_b64 exec, vcc
    buffer_load_dword v30, v45, s[4:7], s40 offen sc1
    s_mov_b64 exec, -1
    s_waitcnt vmcnt(11)
    v_add_u32 v55, 131072, v52
    ds_read_b64_tr_b16 v[0:1], v55 offset:0
    ds_read_b64_tr_b16 v[2:3], v55 offset:256
    ds_read_b64_tr_b16 v[4:5], v55 offset:4096
    ds_read_b64_tr_b16 v[6:7], v55 offset:4352
    ds_read_b64_tr_b16 v[8:9], v55 offset:64
    ds_read_b64_tr_b16 v[10:11], v55 offset:320
    ds_read_b64_tr_b16 v[12:13], v55 offset:4160
    ds_read_b64_tr_b16 v[14:15], v55 offset:4416
    s_waitcnt lgkmcnt(0)
    s_barrier
    ds_write_b128 v63, v[0:3] offset:32768
    ds_write_b128 v63, v[4:7] offset:36864
    s_barrier
    ds_write_b128 v63, v[8:11] offset:40960
    ds_write_b128 v63, v[12:15] offset:45056
    s_waitcnt lgkmcnt(0)
    s_waitcnt vmcnt(7)
    v_add_u32 v55, 114688, v52
    ds_read_b64_tr_b16 v[0:1], v55 offset:0
    ds_read_b64_tr_b16 v[2:3], v55 offset:256
    ds_read_b64_tr_b16 v[4:5], v55 offset:4096
    ds_read_b64_tr_b16 v[6:7], v55 offset:4352
    ds_read_b64_tr_b16 v[8:9], v55 offset:64
    ds_read_b64_tr_b16 v[10:11], v55 offset:320
    ds_read_b64_tr_b16 v[12:13], v55 offset:4160
    ds_read_b64_tr_b16 v[14:15], v55 offset:4416
    s_waitcnt lgkmcnt(0)
    s_barrier
    ds_write_b128 v63, v[0:3] offset:16384
    ds_write_b128 v63, v[4:7] offset:20480
    s_barrier
    ds_write_b128 v63, v[8:11] offset:24576
    ds_write_b128 v63, v[12:15] offset:28672
    s_waitcnt lgkmcnt(0)
    v_min_u32 v36, -2, v36
    v_min_u32 v37, -2, v37
    v_min_u32 v38, -2, v38
    v_min_u32 v39, -2, v39
    v_min_u32 v40, -2, v40
    v_min_u32 v41, -2, v41
    v_min_u32 v42, -2, v42
    v_min_u32 v43, -2, v43
    v_min_u32 v44, -2, v44
    s_lshl_b32 s14, s12, 16
    s_add_u32 s14, s14, 92274688
    s_add_u32 s41, s14, 4096
    s_add_u32 s42, s14, 8192
    v_lshrrev_b32 v45, 2, v61
    buffer_store_dwordx4 v[36:39], v61, s[4:7], s14 offen sc1
    buffer_store_dwordx4 v[40:43], v61, s[4:7], s41 offen sc1
    buffer_store_dword v44, v45, s[4:7], s42 offen sc1
    s_waitcnt vmcnt(1)
    v_readfirstlane_b32 s95, v25
    v_readfirstlane_b32 s85, v24
    s_add_u32 s86, s95, 2
    s_waitcnt vmcnt(0)
    v_subrev_u32 v27, s86, v27
    v_cmp_lt_u32 s[86:87], 64, v27
    s_cmp_eq_u32 s95, 0
    s_cselect_b64 s[86:87], -1, s[86:87]
    s_cmp_lg_u64 s[86:87], 0
    s_cbranch_scc1 cs_nt
    s_add_u32 s40, s24, 524288
    buffer_load_dword v30, v79, s[4:7], s24 offen sc1
    buffer_load_dword v30, v79, s[4:7], s40 offen sc1
cs_nt:
    s_waitcnt vmcnt(3)
    v_add_u32 v55, 81920, v51
    v_xor_b32 v56, 32, v55
    ds_read_b64_tr_b16 v[0:1], v55 offset:0
    ds_read_b64_tr_b16 v[2:3], v55 offset:256
    ds_read_b64_tr_b16 v[4:5], v55 offset:8192
    ds_read_b64_tr_b16 v[6:7], v55 offset:8448
    ds_read_b64_tr_b16 v[8:9], v56 offset:0
    ds_read_b64_tr_b16 v[10:11], v56 offset:256
    ds_read_b64_tr_b16 v[12:13], v56 offset:8192
    ds_read_b64_tr_b16 v[14:15], v56 offset:8448
    s_waitcnt lgkmcnt(0)
    ds_write_b128 v62, v[0:3] offset:24576
    ds_write_b128 v62, v[4:7] offset:28672
    ds_write_b128 v62, v[8:11] offset:32768
    ds_write_b128 v62, v[12:15] offset:36864
    s_waitcnt lgkmcnt(0)
    s_barrier
    s_mov_b32 s88, 4194304
gn3:
    s_cmp_lg_u32 s95, 0
    s_cbranch_scc1 gn3x
    buffer_load_dword v27, off, s[96:99], 0 offset:64 sc1
    s_sub_u32 s88, s88, 1
    s_cbranch_scc1 gn3x
    s_waitcnt vmcnt(0)
    v_readfirstlane_b32 s95, v27
    s_nop 1
    s_branch gn3
gn3x:
    ds_write_b128 v78, v[16:19] offset:8704
    ds_write_b128 v65, v[20:23] offset:10240
    v_mov_b32 v44, s95
    v_mov_b32 v45, s95
    v_mov_b32 v46, s95
    v_mov_b32 v47, s95
    v_mov_b32 v48, 108288
    ds_write_b128 v48, v[44:47]
    s_waitcnt vmcnt(0) lgkmcnt(0)
    s_cmp_eq_u32 s85, 1
    s_cbranch_scc1 cs_run
    s_mov_b32 s40, 16777216
cs_startpoll:
    buffer_load_dword v3, off, s[96:99], 0 offset:216 sc1
    s_waitcnt vmcnt(0)
    v_readfirstlane_b32 s85, v3
    s_nop 0
    s_cmp_eq_u32 s85, 1
    s_cbranch_scc1 cs_run
    s_sleep 1
    s_sub_u32 s40, s40, 1
    s_cbranch_scc0 cs_startpoll
    s_endpgm
cs_run:
    s_cmp_eq_u64 s[86:87], 0
    s_cbranch_scc1 cs_kvok
    s_lshr_b32 s92, s12, 1
    s_lshl_b32 s92, s92, 8
    s_add_u32 s92, s92, 125829120
    v_bfe_u32 v2, v61, 4, 6
    v_min_u32 v2, 11, v2
    v_lshlrev_b32 v2, 2, v2
    s_add_u32 s93, s95, 2
    s_mov_b32 s94, 4194304
cs_kv0:
    buffer_load_dword v3, v2, s[4:7], s92 offen sc1
    s_sub_u32 s94, s94, 1
    s_cbranch_scc1 cs_kv0_go
    s_waitcnt vmcnt(0)
    v_subrev_u32 v3, s93, v3
    v_cmp_lt_u32 vcc, 64, v3
    s_cbranch_vccz cs_kv0_go
    s_sleep 2
    s_branch cs_kv0
cs_kv0_go:
    s_add_u32 s40, s24, 524288
    buffer_load_dword v30, v79, s[4:7], s24 offen sc1
    buffer_load_dword v30, v79, s[4:7], s40 offen sc1
    s_waitcnt vmcnt(0)
cs_kvok:
    s_mov_b32 m0, 108032
    s_add_u32 s24, s24, 1048576
    s_mov_b32 s66, 0x201
    s_mov_b32 s67, 0xc0000000
    s_add_u32 s15, s14, 4096
    s_add_u32 s16, s14, 8192
    ds_read_b128 v[32:35], v62 offset:16384
    ds_read_b128 v[36:39], v62 offset:20480
    ds_read_b128 v[40:43], v61 offset:0
    ds_read_b128 v[44:47], v61 offset:4096
    ds_read_b128 v[48:51], v61 offset:8192
    ds_read_b128 v[52:55], v61 offset:12288
    s_add_u32 s18, s14, s31
    s_mov_b32 s29, 1048576
    buffer_load_dwordx4 v[24:27], v61, s[4:7], s14 offen sc1
.p2align 6
cs_loop:
    v_mov_b64 v[0:1], 0
    v_mov_b64 v[2:3], 0
    v_mov_b64 v[4:5], 0
    v_mov_b64 v[6:7], 0
    v_mov_b64 v[8:9], 0
    v_mov_b64 v[10:11], 0
    v_mov_b64 v[12:13], 0
    v_mov_b64 v[14:15], 0
cs_loop2:
    ds_read_b128 v[16:19], v62 offset:8192
    ds_read_b128 v[20:23], v62 offset:12288
    v_lshrrev_b32 v56, 2, v61
    v_add_u32 v58, 106496, v56
    s_mov_b32 s29, 1048576
    s_waitcnt lgkmcnt(0)
cs_chk0:
    s_waitcnt vmcnt(0)
cs_chk0b:
    v_max3_u32 v57, v24, v25, v26
    v_max_u32 v57, v57, v27
    v_cmp_eq_u32 vcc, -1, v57
    ds_write_b128 v62, v[24:27] offset:40960
    s_cbranch_vccnz cs_spin0
    v_smfmac_f32_16x16x64_bf16 v[0:3], v[24:27], v[16:23], v60
    buffer_load_dwordx4 v[28:31], v61, s[4:7], s15 offen sc1
    buffer_load_dword v59, v56, s[4:7], s16 offen sc1
    v_smfmac_f32_16x16x64_bf16 v[8:11], v[24:27], v[32:39], v60
    ds_read_b128 v[32:35], v61 offset:16384
    v_smfmac_f32_16x16x64_bf16 v[12:15], v[24:27], v[48:55], v60
    ds_read_b128 v[36:39], v61 offset:20480
    v_mfma_f32_16x16x16_bf16 v[16:19], v[72:73], v[72:73], 0
    s_waitcnt lgkmcnt(2)
    s_barrier
    ds_read_b128 v[48:51], v63 offset:0
    v_mfma_f32_16x16x16_bf16 v[20:23], v[72:73], v[72:73], 0
    ds_read_b128 v[52:55], v64 offset:0
    v_smfmac_f32_16x16x64_bf16 v[4:7], v[24:27], v[40:47], v60
    ds_read_b128 v[40:43], v61 offset:24576
    v_smfmac_f32_16x16x64_bf16 v[16:19], v[24:27], a[192:199], v60
    ds_read_b128 v[44:47], v61 offset:28672
    v_smfmac_f32_16x16x64_bf16 v[20:23], v[24:27], a[200:207], v60
    s_waitcnt lgkmcnt(3)
    v_smfmac_f32_16x16x64_bf16 v[0:3], v[48:51], a[0:7], v60
    s_add_u32 s43, s14, s31
    s_add_u32 s41, s14, 16384
    v_smfmac_f32_16x16x64_bf16 v[4:7], v[48:51], v[32:39], v60
    ds_read_b128 v[32:35], v61 offset:32768
    v_smfmac_f32_16x16x64_bf16 v[8:11], v[48:51], a[8:15], v60
    ds_read_b128 v[36:39], v61 offset:36864
    s_waitcnt lgkmcnt(2)
    v_smfmac_f32_16x16x64_bf16 v[12:15], v[48:51], v[40:47], v60
    ds_read_b128 v[40:43], v61 offset:40960
    v_smfmac_f32_16x16x64_bf16 v[0:3], v[52:55], a[16:23], v60
    ds_read_b128 v[44:47], v61 offset:45056
    v_smfmac_f32_16x16x64_bf16 v[8:11], v[52:55], a[24:31], v60
    ds_read_b128 v[48:51], v71 offset:0
    s_waitcnt lgkmcnt(3)
    v_smfmac_f32_16x16x64_bf16 v[4:7], v[52:55], v[32:39], v60
    s_waitcnt vmcnt(0)
    ds_write_b128 v62, v[28:31] offset:45056
    s_waitcnt lgkmcnt(2)
    v_smfmac_f32_16x16x64_bf16 v[12:15], v[52:55], v[40:47], v60
    ds_write_b32 v58, v59
    v_max3_u32 v57, v28, v29, v30
    s_waitcnt lgkmcnt(2)
    v_smfmac_f32_16x16x64_bf16 v[0:3], v[48:51], a[32:39], v60
    ds_read_b128 v[32:35], v61 offset:49152
    v_max3_u32 v57, v57, v31, v59
    v_smfmac_f32_16x16x64_bf16 v[8:11], v[48:51], a[40:47], v60
    ds_read_b128 v[36:39], v61 offset:53248
    v_cmp_eq_u32 vcc, -1, v57
    v_smfmac_f32_16x16x64_bf16 v[16:19], v[52:55], a[224:231], v60
    ds_read_b128 v[40:43], v61 offset:57344
    v_smfmac_f32_16x16x64_bf16 v[20:23], v[52:55], a[232:239], v60
    ds_read_b128 v[44:47], v61 offset:61440
    s_cbranch_vccnz cs_spin1
cs_go1:
    v_smfmac_f32_16x16x64_bf16 v[0:3], v[28:31], a[48:55], v60
    s_waitcnt lgkmcnt(4)
    s_barrier
    ds_read_b128 v[52:55], v63 offset:4096
    v_smfmac_f32_16x16x64_bf16 v[8:11], v[28:31], a[56:63], v60
    ds_read_b128 v[56:59], v71 offset:4096
    v_smfmac_f32_16x16x64_bf16 v[4:7], v[28:31], a[128:135], v60
    s_waitcnt lgkmcnt(2)
    v_smfmac_f32_16x16x64_bf16 v[4:7], v[48:51], v[32:39], v60
    buffer_load_dwordx4 v[32:35], v61, s[4:7], s23 offen offset:0 sc1
    v_smfmac_f32_16x16x64_bf16 v[12:15], v[48:51], v[40:47], v60
    ds_read_b128 v[48:51], v64 offset:4096
    v_smfmac_f32_16x16x64_bf16 v[12:15], v[28:31], a[136:143], v60
    ds_read_b128 v[24:27], v65 offset:8192
    s_and_b32 s41, s41, 65535
    s_add_u32 s41, s41, 68157440
    v_smfmac_f32_16x16x64_bf16 v[16:19], v[28:31], v[80:87], v60
    buffer_load_dwordx4 v[36:39], v61, s[4:7], s23 offen offset:1024 sc1
    v_smfmac_f32_16x16x64_bf16 v[20:23], v[28:31], v[88:95], v60
    s_add_u32 s17, s41, s31
    s_and_b32 s30, s28, 1
    s_waitcnt lgkmcnt(3)
    v_smfmac_f32_16x16x64_bf16 v[0:3], v[52:55], a[64:71], v60
    ds_read_b128 v[28:31], v78 offset:8704
    v_smfmac_f32_16x16x64_bf16 v[4:7], v[52:55], a[144:151], v60
    buffer_load_dwordx4 v[40:43], v61, s[4:7], s23 offen offset:2048 sc1
    v_smfmac_f32_16x16x64_bf16 v[8:11], v[52:55], a[72:79], v60
    v_smfmac_f32_16x16x64_bf16 v[12:15], v[52:55], a[152:159], v60
    v_smfmac_f32_16x16x64_bf16 v[16:19], v[52:55], v[96:103], v60
    buffer_load_dwordx4 v[44:47], v61, s[4:7], s23 offen offset:3072 sc1
    v_smfmac_f32_16x16x64_bf16 v[20:23], v[52:55], v[104:111], v60
    ds_read_b128 v[52:55], v62 offset:28672
    s_waitcnt lgkmcnt(3)
    v_smfmac_f32_16x16x64_bf16 v[0:3], v[48:51], a[80:87], v60
    v_smfmac_f32_16x16x64_bf16 v[4:7], v[48:51], a[160:167], v60
    v_smfmac_f32_16x16x64_bf16 v[8:11], v[48:51], a[88:95], v60
    v_smfmac_f32_16x16x64_bf16 v[12:15], v[48:51], a[168:175], v60
    v_smfmac_f32_16x16x64_bf16 v[16:19], v[48:51], v[112:119], v60
    buffer_load_dword v79, s[4:7], s24 offen sc1 lds
    v_smfmac_f32_16x16x64_bf16 v[20:23], v[48:51], v[120:127], v60
    ds_read_b128 v[48:51], v62 offset:24576
    v_smfmac_f32_16x16x64_bf16 v[0:3], v[56:59], a[96:103], v60
    s_bitcmp1_b64 s[66:67], s28
    v_smfmac_f32_16x16x64_bf16 v[8:11], v[56:59], a[104:111], v60
    s_waitcnt lgkmcnt(3)
    v_smfmac_f32_16x16x64_bf16 v[0:3], v[24:27], a[112:119], v60
    v_smfmac_f32_16x16x64_bf16 v[8:11], v[24:27], a[120:127], v60
    v_smfmac_f32_16x16x64_bf16 v[4:7], v[56:59], a[176:183], v60
    s_waitcnt lgkmcnt(0)
    v_cvt_pk_bf16_f32 v0, v0, v1
    v_smfmac_f32_16x16x64_bf16 v[4:7], v[24:27], v[48:55], v60
    ds_read_b128 v[48:51], v62 offset:32768
    v_cvt_pk_bf16_f32 v8, v8, v9
    v_smfmac_f32_16x16x64_bf16 v[12:15], v[56:59], a[184:191], v60
    ds_read_b128 v[52:55], v62 offset:36864
    v_cvt_pk_bf16_f32 v9, v10, v11
    v_smfmac_f32_16x16x64_bf16 v[16:19], v[56:59], v[128:135], v60
    v_cvt_pk_bf16_f32 v1, v2, v3
    v_mfma_f32_16x16x16_bf16 v[8:11], v[8:9], v[28:29], 0
    v_cvt_pk_bf16_f32 v2, v4, v5
    v_cvt_pk_bf16_f32 v3, v6, v7
    v_smfmac_f32_16x16x64_bf16 v[20:23], v[56:59], v[136:143], v60
    s_mov_b64 exec, s[36:37]
    ds_read_b128 v[56:59], v69
    s_mov_b64 exec, -1
    v_mfma_f32_16x16x32_bf16 v[4:7], v[0:3], v[28:31], 0
    v_cvt_pk_bf16_f32 v2, v8, v9
    s_waitcnt lgkmcnt(1)
    v_smfmac_f32_16x16x64_bf16 v[12:15], v[24:27], v[48:55], v60
    ds_read_b128 v[48:51], v63 offset:0
    v_cvt_pk_bf16_f32 v3, v10, v11
    s_waitcnt vmcnt(3)
    v_cvt_pk_bf16_f32 v0, v4, v5
    v_cvt_pk_bf16_f32 v1, v6, v7
    s_nop 1
    v_mfma_f32_16x16x32_bf16 v[4:7], v[36:39], v[0:3], 0
    v_cvt_pk_bf16_f32 v12, v12, v13
    v_cvt_pk_bf16_f32 v13, v14, v15
    s_nop 1
    v_mfma_f32_16x16x16_bf16 v[12:15], v[12:13], v[30:31], 0
    ds_read_b128 v[52:55], v71 offset:0
    ds_read_b128 v[36:39], v63 offset:53248
    v_mfma_f32_16x16x32_bf16 v[28:31], v[32:35], v[0:3], 0
    s_waitcnt vmcnt(1)
    ds_read_b128 v[32:35], v63 offset:49152
    s_mov_b64 exec, s[34:35]
    s_nop 0
    v_cvt_pk_bf16_f32 v2, v12, v13
    v_cvt_pk_bf16_f32 v3, v14, v15
    s_mov_b64 exec, -1
    s_nop 0
    v_mfma_f32_16x16x32_bf16 v[8:11], v[0:3], v[0:3], 0
    v_mov_b32_dpp v28, v4 row_ror:8 row_mask:0xf bank_mask:0xc
    v_mov_b32_dpp v29, v5 row_ror:8 row_mask:0xf bank_mask:0xc
    v_mov_b32_dpp v30, v6 row_ror:8 row_mask:0xf bank_mask:0xc
    v_mov_b32_dpp v31, v7 row_ror:8 row_mask:0xf bank_mask:0xc
    v_smfmac_f32_16x16x64_bf16 v[16:19], v[24:27], v[144:151], v60
    ds_write_b128 v62, v[28:31] offset:53248
    v_mov_b32_dpp v8, v10 row_ror:8 row_mask:0xf bank_mask:0xc
    v_mov_b32_dpp v9, v11 row_ror:8 row_mask:0xf bank_mask:0xc
    v_smfmac_f32_16x16x64_bf16 v[20:23], v[24:27], v[152:159], v60
    ds_write_b64 v70, v[8:9]
    s_waitcnt lgkmcnt(5)
    v_smfmac_f32_16x16x64_bf16 v[16:19], v[48:51], a[208:215], v60
    s_mov_b64 exec, s[36:37]
    s_cbranch_execz cs_np3683
    buffer_store_dwordx4 v[56:59], v61, s[4:7], s65 offen sc1
cs_np3683:
    s_mov_b64 exec, -1
    v_smfmac_f32_16x16x64_bf16 v[20:23], v[48:51], a[216:223], v60
    s_cbranch_scc1 cs_last
cs_back:
    s_waitcnt lgkmcnt(0)
    s_barrier
    ds_read_b128 v[56:59], v78 offset:10752
    v_smfmac_f32_16x16x64_bf16 v[16:19], v[52:55], a[240:247], v60
    ds_read_b128 v[12:15], v78 offset:11264
    ds_read_b128 v[4:7], v63 offset:12288
    v_smfmac_f32_16x16x64_bf16 v[20:23], v[52:55], a[248:255], v60
    ds_read_b128 v[8:11], v64 offset:12288
    ds_read_b128 v[0:3], v71 offset:12288
    v_mov_b64 v[24:25], s[62:63]
    v_mov_b64 v[26:27], s[60:61]
    v_cvt_pk_bf16_f32 v16, v16, v17
    v_cvt_pk_bf16_f32 v17, v18, v19
    v_pk_mul_f32 v[28:29], v[28:29], s[44:45]
    v_pk_mul_f32 v[30:31], v[30:31], s[44:45]
    s_waitcnt lgkmcnt(3)
    v_pk_add_f32 v[56:57], v[56:57], v[58:59]
    v_pk_add_f32 v[12:13], v[12:13], v[14:15]
    v_pk_add_f32 v[56:57], v[56:57], v[12:13]
    v_pk_mul_f32 v[56:57], v[56:57], s[44:45]
    v_exp_f32 v58, v56
    v_exp_f32 v59, v57
    s_waitcnt lgkmcnt(1)
    v_pk_fma_f32 v[28:29], v[4:5], s[44:45], v[28:29]
    v_pk_fma_f32 v[30:31], v[6:7], s[44:45], v[30:31]
    v_cvt_pk_bf16_f32 v6, v58, v59
    v_pk_fma_f32 v[28:29], v[8:9], s[44:45], v[28:29]
    v_pk_fma_f32 v[30:31], v[10:11], s[44:45], v[30:31]
    s_waitcnt lgkmcnt(0)
    v_pk_fma_f32 v[28:29], v[0:1], s[44:45], v[28:29]
    v_mov_b32_dpp v7, v6 row_ror:8 row_mask:0xf bank_mask:0xf
    v_pk_fma_f32 v[30:31], v[2:3], s[44:45], v[30:31]
    v_exp_f32 v0, v28
    v_mfma_f32_16x16x16_bf16 v[12:15], v[16:17], v[6:7], 0
    ds_read_b128 v[48:51], v63 offset:57344
    v_exp_f32 v1, v29
    v_cvt_pk_bf16_f32 v18, v20, v21
    v_exp_f32 v2, v30
    v_cvt_pk_bf16_f32 v19, v22, v23
    v_cvt_pk_bf16_f32 v8, v0, v1
    v_exp_f32 v3, v31
    v_mfma_f32_16x16x16_bf16 v[20:23], v[18:19], v[6:7], 0
    ds_read_b128 v[52:55], v63 offset:61440
    v_cvt_pk_bf16_f32 v9, v2, v3
    v_mov_b32_dpp v10, v8 row_ror:8 row_mask:0xf bank_mask:0xf
    v_max3_f32 v4, |v28|, |v29|, |v30|
    v_mov_b32_dpp v11, v9 row_ror:8 row_mask:0xf bank_mask:0xf
    v_mfma_f32_16x16x32_bf16 v[0:3], v[24:27], v[6:9], 0
    v_max3_f32 v4, v4, |v31|, |v56|
    v_max_f32_e64 v4, v4, |v57|
    v_mfma_f32_16x16x32_bf16 v[12:15], v[40:43], v[8:11], v[12:15]
    v_cmp_nge_f32 vcc, s46, v4
    v_mfma_f32_16x16x32_bf16 v[20:23], v[44:47], v[8:11], v[20:23]
    v_add_f32_dpp v0, v0, v0 row_ror:8 row_mask:0xf bank_mask:0xf
    v_rcp_f32 v0, v0
    s_cbranch_vccnz cs_guard
cs_norm:
    v_mfma_f32_16x16x16_bf16 v[28:31], v[72:73], v[72:73], 0
    v_mul_f32 v12, v12, v0
    v_mul_f32 v13, v13, v0
    v_mul_f32 v14, v14, v0
    v_mul_f32 v15, v15, v0
    v_mul_f32_dpp v12, v20, v0 row_ror:8 row_mask:0xf bank_mask:0xc
    v_mul_f32_dpp v13, v21, v0 row_ror:8 row_mask:0xf bank_mask:0xc
    v_mul_f32_dpp v14, v22, v0 row_ror:8 row_mask:0xf bank_mask:0xc
    v_mul_f32_dpp v15, v23, v0 row_ror:8 row_mask:0xf bank_mask:0xc
    v_cvt_pk_bf16_f32 v12, v12, v13
    v_cvt_pk_bf16_f32 v13, v14, v15
    v_mfma_f32_16x16x16_bf16 v[8:11], v[72:73], v[72:73], 0
    ds_write_b64 v77, v[12:13]
    v_mfma_f32_16x16x16_bf16 v[4:7], v[72:73], v[72:73], 0
    ds_read_b128 v[0:3], v68
    v_mfma_f32_16x16x16_bf16 v[16:19], v[72:73], v[72:73], 0
    ds_read_b128 v[40:43], v63 offset:16384
    v_mfma_f32_16x16x16_bf16 v[20:23], v[72:73], v[72:73], 0
    ds_read_b128 v[44:47], v63 offset:20480
    s_waitcnt lgkmcnt(3)
    s_barrier
    ds_read_b128 v[24:27], v74
    ds_read_b128 v[12:15], v75
    ds_read_b128 v[56:59], v76
    s_waitcnt lgkmcnt(5)
    v_smfmac_f32_16x16x64_bf16 v[28:31], v[0:3], v[160:167], v60
    v_smfmac_f32_16x16x64_bf16 v[8:11], v[0:3], v[192:199], v60
    v_smfmac_f32_16x16x64_bf16 v[4:7], v[0:3], v[32:39], v60
    ds_read_b128 v[32:35], v63 offset:32768
    v_smfmac_f32_16x16x64_bf16 v[16:19], v[0:3], v[224:231], v60
    ds_read_b128 v[36:39], v63 offset:36864
    s_waitcnt lgkmcnt(3)
    v_smfmac_f32_16x16x64_bf16 v[28:31], v[24:27], v[168:175], v60
    v_smfmac_f32_16x16x64_bf16 v[4:7], v[12:15], v[48:55], v60
    ds_read_b128 v[48:51], v63 offset:24576
    v_smfmac_f32_16x16x64_bf16 v[28:31], v[12:15], v[176:183], v60
    ds_read_b128 v[52:55], v63 offset:28672
    s_waitcnt lgkmcnt(4)
    v_smfmac_f32_16x16x64_bf16 v[28:31], v[56:59], v[184:191], v60
    v_cvt_pk_bf16_f32 v4, v4, v5
    v_smfmac_f32_16x16x64_bf16 v[16:19], v[12:15], v[40:47], v60
    ds_read_b128 v[40:43], v63 offset:40960
    v_and_or_b32 v4, v4, -2, s30
    v_smfmac_f32_16x16x64_bf16 v[8:11], v[24:27], v[200:207], v60
    ds_read_b128 v[44:47], v63 offset:45056
    v_cvt_pk_bf16_f32 v5, v6, v7
    v_smfmac_f32_16x16x64_bf16 v[8:11], v[12:15], v[208:215], v60
    buffer_store_dwordx2 v[4:5], v67, s[4:7], s22 offen sc1
    v_cvt_pk_bf16_f32 v28, v28, v29
    v_smfmac_f32_16x16x64_bf16 v[8:11], v[56:59], v[216:223], v60
    v_and_or_b32 v28, v28, -2, s30
    v_smfmac_f32_16x16x64_bf16 v[16:19], v[24:27], v[232:239], v60
    v_cvt_pk_bf16_f32 v29, v30, v31
    s_waitcnt lgkmcnt(4)
    v_smfmac_f32_16x16x64_bf16 v[16:19], v[56:59], v[32:39], v60
    buffer_store_dwordx2 v[28:29], v66, s[4:7], s20 offen sc1
    v_cvt_pk_bf16_f32 v8, v8, v9
    s_waitcnt lgkmcnt(0)
    v_smfmac_f32_16x16x64_bf16 v[20:23], v[0:3], v[240:247], v60
    v_and_or_b32 v8, v8, -2, s30
    v_smfmac_f32_16x16x64_bf16 v[20:23], v[24:27], v[248:255], v60
    v_cvt_pk_bf16_f32 v9, v10, v11
    v_smfmac_f32_16x16x64_bf16 v[20:23], v[12:15], v[48:55], v60
    buffer_store_dwordx2 v[8:9], v66, s[4:7], s21 offen sc1
    v_cvt_pk_bf16_f32 v16, v16, v17
    v_smfmac_f32_16x16x64_bf16 v[20:23], v[56:59], v[40:47], v60
    v_and_or_b32 v16, v16, -2, s30
    v_cvt_pk_bf16_f32 v17, v18, v19
    buffer_store_dwordx2 v[16:17], v66, s[4:7], s38 offen sc1
    s_cmp_lg_u32 s13, 2
    s_nop 1
    v_cvt_pk_bf16_f32 v20, v20, v21
    v_and_or_b32 v20, v20, -2, s30
    v_cvt_pk_bf16_f32 v21, v22, v23
    buffer_store_dwordx2 v[20:21], v66, s[4:7], s39 offen sc1
    s_cbranch_scc1 cs_w013
    v_mov_b32 v21, -1
    s_mov_b64 exec, s[32:33]
    buffer_store_dword v21, v69, s[4:7], s18 offen sc1
    s_mov_b64 exec, -1
    s_mov_b32 s18, s43
    s_nop 15
    s_nop 15
    s_nop 15
    s_nop 15
    s_nop 15
    s_nop 15
    s_nop 15
    s_nop 15
    s_nop 15
    s_nop 15
    s_nop 15
    s_nop 15
    s_nop 0
    buffer_load_dwordx4 v[40:43], v65, s[4:7], s19 offen offset:0 sc1
    buffer_load_dwordx4 v[44:47], v65, s[4:7], s19 offen offset:1024 sc1
    buffer_load_dwordx4 v[48:51], v65, s[4:7], s19 offen offset:2048 sc1
    buffer_load_dwordx4 v[52:55], v65, s[4:7], s19 offen offset:3072 sc1
    ds_read_b128 v[56:59], v65 offset:10240
    s_add_u32 s28, s28, 1
    s_mov_b32 s14, s41
    s_add_u32 s23, s23, 524288
    s_add_u32 s24, s24, 524288
    s_min_u32 s24, s24, s47
    s_add_u32 s15, s14, 4096
    s_add_u32 s16, s14, 8192
    s_add_u32 s65, s65, 12288
    s_mov_b32 s40, 1
    v_mov_b64 v[0:1], 0
    v_mov_b64 v[2:3], 0
    v_mov_b64 v[4:5], 0
    v_mov_b64 v[6:7], 0
    v_mov_b64 v[8:9], 0
    v_mov_b64 v[10:11], 0
    v_mov_b64 v[12:13], 0
    v_mov_b64 v[14:15], 0
cs_chkF:
    v_mov_b32 v20, 0
    s_waitcnt vmcnt(3)
    s_waitcnt lgkmcnt(0)
    v_mfma_f32_16x16x32_bf16 v[28:31], v[40:43], v[56:59], 0
    v_bitop3_b32 v20, v20, v40, s30 bitop3:0xf6
    v_bitop3_b32 v20, v20, v42, s30 bitop3:0xf6
    s_waitcnt vmcnt(2)
    v_mfma_f32_16x16x32_bf16 v[28:31], v[44:47], v[56:59], v[28:31]
    v_bitop3_b32 v20, v20, v44, s30 bitop3:0xf6
    v_bitop3_b32 v20, v20, v46, s30 bitop3:0xf6
    s_waitcnt vmcnt(1)
    v_mfma_f32_16x16x32_bf16 v[28:31], v[48:51], v[56:59], v[28:31]
    v_bitop3_b32 v20, v20, v48, s30 bitop3:0xf6
    v_bitop3_b32 v20, v20, v50, s30 bitop3:0xf6
    s_waitcnt vmcnt(0)
    v_mfma_f32_16x16x32_bf16 v[28:31], v[52:55], v[56:59], v[28:31]
    v_bitop3_b32 v20, v20, v52, s30 bitop3:0xf6
    v_bitop3_b32 v20, v20, v54, s30 bitop3:0xf6
    v_and_b32 v20, s40, v20
    v_cmp_ne_u32 vcc, 0, v20
    s_cbranch_vccnz cs_spinF
    v_permlane32_swap_b32 v28, v30
    v_permlane32_swap_b32 v29, v31
    v_add_f32 v28, v28, v30
    v_add_f32 v30, v29, v31
    v_cvt_pk_bf16_f32 v28, v28, v30
    s_mov_b64 exec, s[32:33]
    buffer_store_dword v28, v69, s[4:7], s17 offen sc1
    s_mov_b64 exec, -1
    ds_read_b128 v[32:35], v62 offset:16384
    ds_read_b128 v[36:39], v62 offset:20480
    ds_read_b128 v[40:43], v61 offset:0
    ds_read_b128 v[44:47], v61 offset:4096
    ds_read_b128 v[48:51], v61 offset:8192
    ds_read_b128 v[52:55], v61 offset:12288
    s_nop 15
    s_nop 15
    s_nop 15
    s_nop 15
    s_nop 15
    s_nop 15
    s_nop 3
    buffer_load_dwordx4 v[24:27], v61, s[4:7], s14 offen sc1
    s_branch cs_loop2
cs_w013:
    ds_read_b128 v[56:59], v65 offset:10240
    ds_read_b128 v[32:35], v62 offset:16384
    ds_read_b128 v[36:39], v62 offset:20480
    ds_read_b128 v[40:43], v61 offset:0
    ds_read_b128 v[44:47], v61 offset:4096
    ds_read_b128 v[48:51], v61 offset:8192
    ds_read_b128 v[52:55], v61 offset:12288
    s_add_u32 s28, s28, 1
    s_mov_b32 s14, s41
    s_add_u32 s23, s23, 524288
    s_add_u32 s24, s24, 524288
    s_min_u32 s24, s24, s47
    s_add_u32 s15, s14, 4096
    s_add_u32 s16, s14, 8192
    s_add_u32 s65, s65, 12288
    s_mov_b32 s40, 1
    s_cmp_eq_u32 s64, 0
    s_cbranch_scc1 cs_w0
    v_mov_b32 v21, -1
    s_mov_b64 exec, s[32:33]
    buffer_store_dword v21, v69, s[4:7], s18 offen sc1
    s_mov_b64 exec, -1
    s_mov_b32 s18, s43
    s_cmp_eq_u32 s13, 1
    s_cbranch_scc1 cs_sx
    s_nop 15
    s_nop 15
    s_nop 15
    s_nop 15
    s_nop 15
    s_nop 15
    s_nop 15
    s_nop 15
    s_nop 15
    s_nop 15
    s_nop 15
    s_nop 15
    s_nop 7
cs_sx:
    buffer_load_dwordx4 v[0:3], v65, s[4:7], s19 offen offset:0 sc1
    buffer_load_dwordx4 v[4:7], v65, s[4:7], s19 offen offset:1024 sc1
    buffer_load_dwordx4 v[8:11], v65, s[4:7], s19 offen offset:2048 sc1
    buffer_load_dwordx4 v[12:15], v65, s[4:7], s19 offen offset:3072 sc1
cs_chkG:
    v_mov_b32 v20, 0
    s_waitcnt vmcnt(3)
    s_waitcnt lgkmcnt(6)
    v_mfma_f32_16x16x32_bf16 v[28:31], v[0:3], v[56:59], 0
    v_bitop3_b32 v20, v20, v0, s30 bitop3:0xf6
    v_bitop3_b32 v20, v20, v2, s30 bitop3:0xf6
    s_waitcnt vmcnt(2)
    v_mfma_f32_16x16x32_bf16 v[28:31], v[4:7], v[56:59], v[28:31]
    v_bitop3_b32 v20, v20, v4, s30 bitop3:0xf6
    v_bitop3_b32 v20, v20, v6, s30 bitop3:0xf6
    s_waitcnt vmcnt(1)
    v_mfma_f32_16x16x32_bf16 v[28:31], v[8:11], v[56:59], v[28:31]
    v_bitop3_b32 v20, v20, v8, s30 bitop3:0xf6
    v_bitop3_b32 v20, v20, v10, s30 bitop3:0xf6
    s_waitcnt vmcnt(0)
    v_mfma_f32_16x16x32_bf16 v[28:31], v[12:15], v[56:59], v[28:31]
    v_bitop3_b32 v20, v20, v12, s30 bitop3:0xf6
    v_bitop3_b32 v20, v20, v14, s30 bitop3:0xf6
    v_and_b32 v20, s40, v20
    v_cmp_ne_u32 vcc, 0, v20
    s_cbranch_vccnz cs_spinG
    v_permlane32_swap_b32 v28, v30
    v_permlane32_swap_b32 v29, v31
    v_add_f32 v28, v28, v30
    v_add_f32 v30, v29, v31
    s_cmp_eq_u32 s13, 3
    s_cbranch_scc1 cs_w3
    v_mov_b32 v29, v28
    v_mov_b32 v31, v30
    s_nop 0
    v_permlane16_swap_b32 v28, v29
    v_permlane16_swap_b32 v30, v31
    v_add_f32 v28, v28, v29
    v_add_f32 v30, v30, v31
cs_w3:
    v_cvt_pk_bf16_f32 v28, v28, v30
    s_mov_b64 exec, s[32:33]
    buffer_store_dword v28, v69, s[4:7], s17 offen sc1
    s_mov_b64 exec, -1
    buffer_load_dwordx4 v[24:27], v61, s[4:7], s14 offen sc1
    s_branch cs_loop
cs_w0:
    v_mov_b64 v[0:1], 0
    v_mov_b64 v[2:3], 0
    v_mov_b64 v[4:5], 0
    v_mov_b64 v[6:7], 0
    v_mov_b64 v[8:9], 0
    v_mov_b64 v[10:11], 0
    v_mov_b64 v[12:13], 0
    v_mov_b64 v[14:15], 0
    s_nop 15
    s_nop 15
    s_nop 15
    s_nop 15
    s_nop 15
    s_nop 15
    s_nop 15
    s_nop 15
    s_nop 4
    s_cmp_lg_u32 s28, 10
    s_cbranch_scc1 cs_nokv
    s_lshr_b32 s92, s12, 1
    s_lshl_b32 s92, s92, 8
    s_add_u32 s92, s92, 125829120
    v_bfe_u32 v28, v61, 4, 6
    v_min_u32 v28, 11, v28
    v_lshlrev_b32 v28, 2, v28
    v_add_u32 v28, 108304, v28
    s_waitcnt vmcnt(0)
    ds_read_b32 v29, v28
    s_add_u32 s93, s95, 63
    s_waitcnt lgkmcnt(0)
    v_cmp_ne_u32 vcc, s93, v29
    s_cbranch_vccz cs_kv1_go
    s_lshr_b32 s92, s12, 1
    s_lshl_b32 s92, s92, 8
    s_add_u32 s92, s92, 125833216
    v_bfe_u32 v28, v61, 4, 6
    v_min_u32 v28, 11, v28
    v_lshlrev_b32 v28, 2, v28
    s_add_u32 s93, s95, 63
    s_mov_b32 s94, 4194304
cs_kv1:
    buffer_load_dword v29, v28, s[4:7], s92 offen sc1
    s_sub_u32 s94, s94, 1
    s_cbranch_scc1 cs_kv1_go
    s_waitcnt vmcnt(0)
    v_subrev_u32 v29, s93, v29
    v_cmp_lt_u32 vcc, 64, v29
    s_cbranch_vccz cs_kv1_go
    s_sleep 2
    s_branch cs_kv1
cs_kv1_go:
    s_branch cs_w0p
cs_nokv:
    s_nop 15
    s_nop 15
    s_nop 15
    s_nop 15
    s_nop 15
    s_nop 15
    s_nop 15
    s_nop 15
    s_nop 15
    s_nop 15
    s_nop 15
    s_nop 15
    s_nop 15
    s_nop 15
    s_nop 15
    s_nop 15
    s_nop 10
cs_w0p:
    buffer_load_dwordx4 v[24:27], v61, s[4:7], s14 offen sc1
    s_branch cs_loop2
cs_spinF:
    buffer_load_dwordx4 v[40:43], v65, s[4:7], s19 offen offset:0 sc1
    buffer_load_dwordx4 v[44:47], v65, s[4:7], s19 offen offset:1024 sc1
    buffer_load_dwordx4 v[48:51], v65, s[4:7], s19 offen offset:2048 sc1
    buffer_load_dwordx4 v[52:55], v65, s[4:7], s19 offen offset:3072 sc1
    s_sub_u32 s29, s29, 1
    s_cmp_lt_i32 s29, 0
    s_cselect_b32 s40, 0, 1
    s_branch cs_chkF
cs_spinG:
    buffer_load_dwordx4 v[0:3], v65, s[4:7], s19 offen offset:0 sc1
    buffer_load_dwordx4 v[4:7], v65, s[4:7], s19 offen offset:1024 sc1
    buffer_load_dwordx4 v[8:11], v65, s[4:7], s19 offen offset:2048 sc1
    buffer_load_dwordx4 v[12:15], v65, s[4:7], s19 offen offset:3072 sc1
    s_sub_u32 s29, s29, 1
    s_cmp_lt_i32 s29, 0
    s_cselect_b32 s40, 0, 1
    s_branch cs_chkG
cs_guard:
    s_cbranch_scc0 cs_guard2
    buffer_store_dwordx4 v[16:19], v61, s[4:7], s26 offen sc1
    s_add_u32 s26, s26, 131072
    s_add_u32 s40, s95, 63
    v_mov_b32 v5, s40
    s_mov_b64 exec, 1
    buffer_store_dword v5, off, s[4:7], s27 sc1
    s_mov_b64 exec, -1
cs_guard2:
    s_nop 7
    v_max3_f32 v6, v28, v29, v30
    v_max3_f32 v7, v31, v56, v57
    v_max_f32 v6, v6, v7
    s_nop 1
    v_max_f32_dpp v6, v6, v6 row_ror:8 row_mask:0xf bank_mask:0xf
    v_mov_b32 v7, v6
    s_nop 1
    v_permlane32_swap_b32 v6, v7
    v_max_f32 v6, v6, v7
    v_mov_b32 v7, v6
    s_nop 1
    v_permlane16_swap_b32 v6, v7
    v_max_f32 v6, v6, v7
    v_sub_f32 v28, v28, v6
    v_sub_f32 v29, v29, v6
    v_sub_f32 v30, v30, v6
    v_sub_f32 v31, v31, v6
    v_sub_f32 v56, v56, v6
    v_sub_f32 v57, v57, v6
    v_exp_f32 v58, v56
    v_exp_f32 v59, v57
    s_nop 0
    v_cvt_pk_bf16_f32 v6, v58, v59
    s_nop 1
    v_mov_b32_dpp v7, v6 row_ror:8 row_mask:0xf bank_mask:0xf
    v_exp_f32 v0, v28
    s_nop 0
    v_mfma_f32_16x16x16_bf16 v[12:15], v[16:17], v[6:7], 0
    v_exp_f32 v1, v29
    v_exp_f32 v2, v30
    v_cvt_pk_bf16_f32 v8, v0, v1
    v_exp_f32 v3, v31
    v_mfma_f32_16x16x16_bf16 v[20:23], v[18:19], v[6:7], 0
    v_cvt_pk_bf16_f32 v9, v2, v3
    v_mov_b32_dpp v10, v8 row_ror:8 row_mask:0xf bank_mask:0xf
    v_max3_f32 v4, |v28|, |v29|, |v30|
    v_mov_b32_dpp v11, v9 row_ror:8 row_mask:0xf bank_mask:0xf
    v_mfma_f32_16x16x32_bf16 v[0:3], v[24:27], v[6:9], 0
    v_max3_f32 v4, v4, |v31|, |v56|
    v_max_f32_e64 v4, v4, |v57|
    v_mfma_f32_16x16x32_bf16 v[12:15], v[40:43], v[8:11], v[12:15]
    v_cmp_nge_f32 vcc, s46, v4
    v_mfma_f32_16x16x32_bf16 v[20:23], v[44:47], v[8:11], v[20:23]
    v_add_f32_dpp v0, v0, v0 row_ror:8 row_mask:0xf bank_mask:0xf
    v_rcp_f32 v0, v0
    s_nop 4
    s_branch cs_norm
cs_spin0:
    buffer_load_dwordx4 v[24:27], v61, s[4:7], s14 offen sc1
    s_sub_u32 s29, s29, 1
    s_cmp_lt_i32 s29, 0
    s_cbranch_scc0 cs_chk0
    s_waitcnt vmcnt(0)
    v_min_u32 v24, -2, v24
    v_min_u32 v25, -2, v25
    v_min_u32 v26, -2, v26
    v_min_u32 v27, -2, v27
    s_branch cs_chk0
cs_spin1:
    buffer_load_dwordx4 v[28:31], v61, s[4:7], s15 offen sc1
    buffer_load_dword v59, v56, s[4:7], s16 offen sc1
    s_sub_u32 s29, s29, 1
    s_cmp_lt_i32 s29, 0
    s_waitcnt vmcnt(0)
    v_max3_u32 v57, v28, v29, v30
    v_max3_u32 v57, v57, v31, v59
    v_cmp_eq_u32 vcc, -1, v57
    ds_write_b128 v62, v[28:31] offset:45056
    ds_write_b32 v58, v59
    s_waitcnt lgkmcnt(0)
    s_cbranch_scc1 cs_go1
    s_cbranch_vccnz cs_spin1
    s_branch cs_go1
cs_last:
    s_nop 1
    s_cmp_ge_u32 s28, 2
    s_cbranch_scc1 cs_last0
    s_and_b32 s40, s12, 3
    s_lshl_b32 s40, s40, 14
    s_add_u32 s40, s40, 68157440
    s_lshr_b32 s42, s12, 2
    s_lshl_b32 s42, s42, 3
    s_lshl_b64 exec, 0x55, s42
    buffer_load_dword v79, s[4:7], s40 offen sc1 lds
    s_mov_b64 exec, -1
    s_cmp_eq_u32 0, 1
    s_branch cs_back
cs_last0:
    s_cmp_lg_u32 s28, 9
    s_cbranch_scc1 cs_last1
    s_lshr_b32 s92, s12, 1
    s_lshl_b32 s92, s92, 8
    s_add_u32 s92, s92, 125833216
    v_bfe_u32 v48, v61, 4, 6
    v_min_u32 v48, 11, v48
    v_lshlrev_b32 v48, 2, v48
    s_mov_b32 m0, 108304
    s_mov_b64 exec, 0xfff
    buffer_load_dword v48, s[4:7], s92 offen sc1 lds
    s_mov_b64 exec, -1
    s_mov_b32 m0, 108032
    s_cmp_eq_u32 0, 1
    s_branch cs_back
cs_last1:
    s_cmp_eq_u32 s28, 63
    s_cbranch_scc1 cs_last2
    s_mov_b64 exec, s[34:35]
    buffer_store_dwordx4 v[0:3], v61, s[4:7], s25 offen sc1
    s_mov_b64 exec, -1
    s_add_u32 s25, s25, 131072
    s_mov_b32 s46, 0xbf800000
    s_cmp_eq_u32 0, 0
    s_branch cs_back
cs_last2:
    s_waitcnt lgkmcnt(0)
    s_mov_b64 exec, s[34:35]
    buffer_store_dwordx4 v[0:3], v61, s[4:7], s25 offen sc1
    s_mov_b64 exec, -1
    s_add_u32 s40, s95, 64
    v_mov_b32 v40, s40
    v_smfmac_f32_16x16x64_bf16 v[16:19], v[52:55], a[240:247], v60
    v_smfmac_f32_16x16x64_bf16 v[20:23], v[52:55], a[248:255], v60
    s_nop 3
    v_cvt_pk_bf16_f32 v16, v16, v17
    v_cvt_pk_bf16_f32 v17, v18, v19
    s_nop 1
    v_cvt_pk_bf16_f32 v18, v20, v21
    v_cvt_pk_bf16_f32 v19, v22, v23
    buffer_store_dwordx4 v[16:19], v61, s[4:7], s26 offen sc1
    s_mov_b64 exec, 1
    buffer_store_dword v40, off, s[4:7], s27 sc1
    s_mov_b64 exec, -1
    s_endpgm
cs_dma:
    s_xor_b32 s74, s76, s81
    s_add_u32 m0, s74, s80
    s_add_u32 s76, s76, 4096
    buffer_load_dwordx4 v58, s[8:11], s78 offen lds
    s_add_u32 s78, s78, s79
    s_cmp_lt_u32 s76, s77
    s_cbranch_scc1 cs_dma
    s_setpc_b64 s[82:83]
L_helper:
    s_load_dwordx16 s[64:79], s[0:1], 64
    s_sub_u32 s33, s3, 1
    s_and_b32 s33, s33, 7
L_pool:
    s_lshl_b32 s35, s33, 2
    s_add_u32 s35, s35, 32
    s_mov_b32 s37, s35
    v_mov_b32 v250, 1
    v_mov_b32 v251, 163832
    v_cmp_eq_u32 vcc, 0, v0
    s_nop 0
    s_and_saveexec_b64 s[38:39], vcc
    s_cbranch_execz tk4
    buffer_atomic_add v250, off, s[96:99], s37 sc0
    s_waitcnt vmcnt(0)
    ds_write_b32 v251, v250
    s_waitcnt lgkmcnt(0)
tk4:
    s_mov_b64 exec, -1
    s_barrier
    ds_read_b32 v252, v251
    s_waitcnt lgkmcnt(0)
    v_readfirstlane_b32 s34, v252
    s_barrier
    s_nop 3
    s_mov_b32 s36, s33
    s_or_b32 s33, s34, s32
    s_cmp_lg_u32 s33, 0
    s_cbranch_scc1 L_helper1
    s_memrealtime s[90:91]
    s_waitcnt lgkmcnt(0)
    s_lshl_b32 s90, s90, 8
    s_or_b32 s90, s90, 1
    v_mov_b32 v250, s90
    v_mov_b32 v251, 0
    s_mov_b64 exec, 1
    buffer_atomic_cmpswap v[250:251], off, s[96:99], 0 offset:64
    s_mov_b64 exec, -1
L_helper1:
    s_cmp_ge_u32 s34, 32
    s_cbranch_scc1 L_qkv_next
    s_cmp_ge_u32 s36, 7
    s_cbranch_scc1 L_qkv_next
    s_max_u32 s37, s36, 4
    s_sub_u32 s37, s37, 4
    s_mul_i32 s37, s37, 6
    s_lshl_b32 s38, s36, 1
    s_add_u32 s38, s38, s37
    s_cmp_lt_u32 s36, 4
    s_cselect_b32 s39, 2, 8
    s_mul_i32 s36, s36, 30
    s_sub_u32 s36, s36, s37
    s_cmp_lt_u32 s34, s39
    s_cbranch_scc1 L_copy
    s_add_u32 s36, s36, s34
    s_sub_u32 s36, s36, s39
    s_mul_i32 s37, s36, 171
    s_lshr_b32 s37, s37, 10
    s_mul_i32 s38, s37, 6
    s_sub_u32 s36, s36, s38
    s_lshl_b32 s36, s36, 5
    s_add_u32 s36, s36, s37
    s_branch L_job
L_copy:
    s_add_u32 s36, s38, s34
    s_mul_i32 s36, s36, 11
    s_and_b32 s36, s36, 31
    s_cmp_ge_u32 s36, 27
    s_cbranch_scc1 L_qkv_next
    s_mul_i32 s33, s36, 57
    s_lshr_b32 s33, s33, 9
    s_mul_i32 s37, s33, 9
    s_sub_u32 s37, s36, s37
    s_lshl_b32 s36, s37, 2
    s_add_u32 s36, s36, 1
    s_min_u32 s36, s36, 31
    s_lshr_b32 s39, s52, 8
    s_sub_u32 s36, s36, s39
    s_and_b32 s36, s36, 31
    s_lshl_b32 s36, s36, 8
    s_mov_b32 s14, 4718592
    s_mov_b32 s15, 0x20000
    v_lshrrev_b32 v1, 4, v0
    v_lshlrev_b32 v1, 13, v1
    v_and_b32 v2, 15, v0
    v_lshl_add_u32 v1, v2, 4, v1
    v_lshlrev_b32 v2, 4, v0
    s_mul_i32 s40, s33, 2
    s_mul_i32 s39, s40, 49152
    s_lshl_b32 s41, s37, 19
    s_add_u32 s39, s39, s41
    s_add_u32 s39, s39, 96468992
    s_add_u32 s41, s40, 0
    s_cmp_lt_u32 s41, 3
    s_cselect_b64 s[12:13], s[52:53], s[54:55]
    s_cselect_b32 s42, 0, 3
    s_cmp_ge_u32 s41, 6
    s_cselect_b64 s[12:13], s[56:57], s[12:13]
    s_cselect_b32 s42, 6, s42
    s_sub_u32 s41, s41, s42
    s_mul_i32 s38, s41, 1572864
    s_add_u32 s38, s38, s36
    buffer_load_dwordx4 v[8:11], v1, s[12:15], s38 offen
    s_add_u32 s38, s38, 131072
    buffer_load_dwordx4 v[12:15], v1, s[12:15], s38 offen
    s_add_u32 s38, s38, 131072
    buffer_load_dwordx4 v[16:19], v1, s[12:15], s38 offen
    s_add_u32 s38, s38, 131072
    buffer_load_dwordx4 v[20:23], v1, s[12:15], s38 offen
    s_add_u32 s38, s38, 131072
    buffer_load_dwordx4 v[24:27], v1, s[12:15], s38 offen
    s_add_u32 s38, s38, 131072
    buffer_load_dwordx4 v[28:31], v1, s[12:15], s38 offen
    s_add_u32 s38, s38, 131072
    buffer_load_dwordx4 v[32:35], v1, s[12:15], s38 offen
    s_add_u32 s38, s38, 131072
    buffer_load_dwordx4 v[36:39], v1, s[12:15], s38 offen
    s_add_u32 s38, s38, 131072
    buffer_load_dwordx4 v[40:43], v1, s[12:15], s38 offen
    s_add_u32 s38, s38, 131072
    buffer_load_dwordx4 v[44:47], v1, s[12:15], s38 offen
    s_add_u32 s38, s38, 131072
    buffer_load_dwordx4 v[48:51], v1, s[12:15], s38 offen
    s_add_u32 s38, s38, 131072
    buffer_load_dwordx4 v[52:55], v1, s[12:15], s38 offen
    s_add_u32 s38, s38, 131072
    s_add_u32 s41, s40, 1
    s_cmp_lt_u32 s41, 3
    s_cselect_b64 s[12:13], s[52:53], s[54:55]
    s_cselect_b32 s42, 0, 3
    s_cmp_ge_u32 s41, 6
    s_cselect_b64 s[12:13], s[56:57], s[12:13]
    s_cselect_b32 s42, 6, s42
    s_sub_u32 s41, s41, s42
    s_mul_i32 s38, s41, 1572864
    s_add_u32 s38, s38, s36
    buffer_load_dwordx4 v[56:59], v1, s[12:15], s38 offen
    s_add_u32 s38, s38, 131072
    buffer_load_dwordx4 v[60:63], v1, s[12:15], s38 offen
    s_add_u32 s38, s38, 131072
    buffer_load_dwordx4 v[64:67], v1, s[12:15], s38 offen
    s_add_u32 s38, s38, 131072
    buffer_load_dwordx4 v[68:71], v1, s[12:15], s38 offen
    s_add_u32 s38, s38, 131072
    buffer_load_dwordx4 v[72:75], v1, s[12:15], s38 offen
    s_add_u32 s38, s38, 131072
    buffer_load_dwordx4 v[76:79], v1, s[12:15], s38 offen
    s_add_u32 s38, s38, 131072
    buffer_load_dwordx4 v[80:83], v1, s[12:15], s38 offen
    s_add_u32 s38, s38, 131072
    buffer_load_dwordx4 v[84:87], v1, s[12:15], s38 offen
    s_add_u32 s38, s38, 131072
    buffer_load_dwordx4 v[88:91], v1, s[12:15], s38 offen
    s_add_u32 s38, s38, 131072
    buffer_load_dwordx4 v[92:95], v1, s[12:15], s38 offen
    s_add_u32 s38, s38, 131072
    buffer_load_dwordx4 v[96:99], v1, s[12:15], s38 offen
    s_add_u32 s38, s38, 131072
    buffer_load_dwordx4 v[100:103], v1, s[12:15], s38 offen
    s_add_u32 s38, s38, 131072
    buffer_load_dword v3, off, s[96:99], 0 offset:64 sc1
    s_waitcnt vmcnt(0)
    buffer_store_dwordx4 v[8:11], v2, s[4:7], s39 offen sc1
    s_add_u32 s39, s39, 4096
    buffer_store_dwordx4 v[12:15], v2, s[4:7], s39 offen sc1
    s_add_u32 s39, s39, 4096
    buffer_store_dwordx4 v[16:19], v2, s[4:7], s39 offen sc1
    s_add_u32 s39, s39, 4096
    buffer_store_dwordx4 v[20:23], v2, s[4:7], s39 offen sc1
    s_add_u32 s39, s39, 4096
    buffer_store_dwordx4 v[24:27], v2, s[4:7], s39 offen sc1
    s_add_u32 s39, s39, 4096
    buffer_store_dwordx4 v[28:31], v2, s[4:7], s39 offen sc1
    s_add_u32 s39, s39, 4096
    buffer_store_dwordx4 v[32:35], v2, s[4:7], s39 offen sc1
    s_add_u32 s39, s39, 4096
    buffer_store_dwordx4 v[36:39], v2, s[4:7], s39 offen sc1
    s_add_u32 s39, s39, 4096
    buffer_store_dwordx4 v[40:43], v2, s[4:7], s39 offen sc1
    s_add_u32 s39, s39, 4096
    buffer_store_dwordx4 v[44:47], v2, s[4:7], s39 offen sc1
    s_add_u32 s39, s39, 4096
    buffer_store_dwordx4 v[48:51], v2, s[4:7], s39 offen sc1
    s_add_u32 s39, s39, 4096
    buffer_store_dwordx4 v[52:55], v2, s[4:7], s39 offen sc1
    s_add_u32 s39, s39, 4096
    buffer_store_dwordx4 v[56:59], v2, s[4:7], s39 offen sc1
    s_add_u32 s39, s39, 4096
    buffer_store_dwordx4 v[60:63], v2, s[4:7], s39 offen sc1
    s_add_u32 s39, s39, 4096
    buffer_store_dwordx4 v[64:67], v2, s[4:7], s39 offen sc1
    s_add_u32 s39, s39, 4096
    buffer_store_dwordx4 v[68:71], v2, s[4:7], s39 offen sc1
    s_add_u32 s39, s39, 4096
    buffer_store_dwordx4 v[72:75], v2, s[4:7], s39 offen sc1
    s_add_u32 s39, s39, 4096
    buffer_store_dwordx4 v[76:79], v2, s[4:7], s39 offen sc1
    s_add_u32 s39, s39, 4096
    buffer_store_dwordx4 v[80:83], v2, s[4:7], s39 offen sc1
    s_add_u32 s39, s39, 4096
    buffer_store_dwordx4 v[84:87], v2, s[4:7], s39 offen sc1
    s_add_u32 s39, s39, 4096
    buffer_store_dwordx4 v[88:91], v2, s[4:7], s39 offen sc1
    s_add_u32 s39, s39, 4096
    buffer_store_dwordx4 v[92:95], v2, s[4:7], s39 offen sc1
    s_add_u32 s39, s39, 4096
    buffer_store_dwordx4 v[96:99], v2, s[4:7], s39 offen sc1
    s_add_u32 s39, s39, 4096
    buffer_store_dwordx4 v[100:103], v2, s[4:7], s39 offen sc1
    s_add_u32 s39, s39, 4096
    v_readfirstlane_b32 s95, v3
    s_nop 4
    s_mov_b32 s88, 4194304
gn5:
    s_cmp_lg_u32 s95, 0
    s_cbranch_scc1 gn5x
    buffer_load_dword v3, off, s[96:99], 0 offset:64 sc1
    s_sub_u32 s88, s88, 1
    s_cbranch_scc1 gn5x
    s_waitcnt vmcnt(0)
    v_readfirstlane_b32 s95, v3
    s_nop 1
    s_branch gn5
gn5x:
    s_lshl_b32 s37, s37, 7
    s_lshl_b32 s36, s33, 2
    s_add_u32 s36, s36, s32
    s_lshl_b32 s36, s36, 2
    s_add_u32 s37, s37, s36
    s_add_u32 s37, s37, 125853696
    v_mov_b32 v3, s95
    s_waitcnt vmcnt(0)
    s_mov_b64 exec, 1
    buffer_store_dword v3, off, s[4:7], s37 sc1
    s_mov_b64 exec, -1
L_qkv_next:
    s_mov_b32 s37, 4
    v_mov_b32 v250, 1
    v_mov_b32 v251, 163832
    v_cmp_eq_u32 vcc, 0, v0
    s_nop 0
    s_and_saveexec_b64 s[38:39], vcc
    s_cbranch_execz tk6
    buffer_atomic_add v250, off, s[96:99], s37 sc0
    s_waitcnt vmcnt(0)
    ds_write_b32 v251, v250
    s_waitcnt lgkmcnt(0)
tk6:
    s_mov_b64 exec, -1
    s_barrier
    ds_read_b32 v252, v251
    s_waitcnt lgkmcnt(0)
    v_readfirstlane_b32 s36, v252
    s_barrier
    s_nop 3
    s_add_u32 s36, s36, 192
    s_cmp_ge_u32 s36, 320
    s_cbranch_scc1 L_ssm_next
L_job:
    s_and_b32 s17, s36, 15
    s_lshl_b32 s17, s17, 1
    s_bfe_u32 s16, s36, 0x10004
    s_lshr_b32 s19, s36, 5
    s_mul_i32 s33, s16, 6
    s_add_u32 s33, s33, s19
    s_add_u32 s16, s16, 1
    s_lshr_b32 s37, s36, 4
    s_sub_u32 s38, s37, 12
    s_cmp_ge_u32 s36, 192
    s_cselect_b32 s16, 0, s16
    s_cselect_b32 s19, s38, s19
    s_cselect_b32 s33, s37, s33
    s_cselect_b32 s20, 8, 6
    v_lshrrev_b32 v4, 6, v0
    s_nop 0
    v_readfirstlane_b32 s18, v4
    v_lshlrev_b32 v7, 4, v0
    v_and_b32 v4, 63, v0
    v_lshrrev_b32 v6, 2, v4
    v_lshlrev_b32 v6, 13, v6
    v_lshrrev_b32 v5, 4, v4
    v_and_b32 v5, 2, v5
    v_xor_b32 v5, v5, v4
    v_and_b32 v5, 3, v5
    v_lshl_add_u32 v6, v5, 4, v6
    v_lshrrev_b32 v24, 4, v4
    v_lshlrev_b32 v24, 9, v24
    v_bfe_u32 v5, v4, 2, 2
    v_lshl_add_u32 v24, v5, 6, v24
    v_bfe_u32 v5, v4, 4, 1
    v_lshl_add_u32 v24, v5, 5, v24
    v_and_b32 v5, 3, v4
    v_lshl_add_u32 v24, v5, 3, v24
    s_lshl_b32 s31, s18, 12
    v_add_u32 v24, s31, v24
    s_cmp_eq_u32 s16, 1
    s_cselect_b64 s[12:13], s[54:55], s[52:53]
    s_cmp_eq_u32 s16, 2
    s_cselect_b64 s[12:13], s[56:57], s[12:13]
    s_mov_b32 s14, 4718592
    s_mov_b32 s15, 0x20000
    s_lshl_b32 s28, s17, 8
    s_lshl_b32 s21, s18, 6
    s_add_u32 s28, s28, s21
    s_add_u32 s21, s28, 0
    s_add_u32 m0, s31, 40960
    s_nop 0
    buffer_load_dwordx4 v6, s[12:15], s21 offen lds
    s_add_u32 m0, s31, 41984
    s_add_u32 s21, s21, 131072
    buffer_load_dwordx4 v6, s[12:15], s21 offen lds
    s_add_u32 m0, s31, 43008
    s_add_u32 s21, s21, 131072
    buffer_load_dwordx4 v6, s[12:15], s21 offen lds
    s_add_u32 m0, s31, 44032
    s_add_u32 s21, s21, 131072
    buffer_load_dwordx4 v6, s[12:15], s21 offen lds
    s_add_u32 s21, s28, 256
    s_add_u32 m0, s31, 57344
    s_nop 0
    buffer_load_dwordx4 v6, s[12:15], s21 offen lds
    s_add_u32 m0, s31, 58368
    s_add_u32 s21, s21, 131072
    buffer_load_dwordx4 v6, s[12:15], s21 offen lds
    s_add_u32 m0, s31, 59392
    s_add_u32 s21, s21, 131072
    buffer_load_dwordx4 v6, s[12:15], s21 offen lds
    s_add_u32 m0, s31, 60416
    s_add_u32 s21, s21, 131072
    buffer_load_dwordx4 v6, s[12:15], s21 offen lds
    s_add_u32 s21, s28, 524288
    s_add_u32 m0, s31, 73728
    s_nop 0
    buffer_load_dwordx4 v6, s[12:15], s21 offen lds
    s_add_u32 m0, s31, 74752
    s_add_u32 s21, s21, 131072
    buffer_load_dwordx4 v6, s[12:15], s21 offen lds
    s_add_u32 m0, s31, 75776
    s_add_u32 s21, s21, 131072
    buffer_load_dwordx4 v6, s[12:15], s21 offen lds
    s_add_u32 m0, s31, 76800
    s_add_u32 s21, s21, 131072
    buffer_load_dwordx4 v6, s[12:15], s21 offen lds
    s_add_u32 s21, s28, 524544
    s_add_u32 m0, s31, 90112
    s_nop 0
    buffer_load_dwordx4 v6, s[12:15], s21 offen lds
    s_add_u32 m0, s31, 91136
    s_add_u32 s21, s21, 131072
    buffer_load_dwordx4 v6, s[12:15], s21 offen lds
    s_add_u32 m0, s31, 92160
    s_add_u32 s21, s21, 131072
    buffer_load_dwordx4 v6, s[12:15], s21 offen lds
    s_add_u32 m0, s31, 93184
    s_add_u32 s21, s21, 131072
    buffer_load_dwordx4 v6, s[12:15], s21 offen lds
    s_add_u32 s21, s28, 1048576
    s_add_u32 m0, s31, 106496
    s_nop 0
    buffer_load_dwordx4 v6, s[12:15], s21 offen lds
    s_add_u32 m0, s31, 107520
    s_add_u32 s21, s21, 131072
    buffer_load_dwordx4 v6, s[12:15], s21 offen lds
    s_add_u32 m0, s31, 108544
    s_add_u32 s21, s21, 131072
    buffer_load_dwordx4 v6, s[12:15], s21 offen lds
    s_add_u32 m0, s31, 109568
    s_add_u32 s21, s21, 131072
    buffer_load_dwordx4 v6, s[12:15], s21 offen lds
    s_add_u32 s21, s28, 1048832
    s_add_u32 m0, s31, 122880
    s_nop 0
    buffer_load_dwordx4 v6, s[12:15], s21 offen lds
    s_add_u32 m0, s31, 123904
    s_add_u32 s21, s21, 131072
    buffer_load_dwordx4 v6, s[12:15], s21 offen lds
    s_add_u32 m0, s31, 124928
    s_add_u32 s21, s21, 131072
    buffer_load_dwordx4 v6, s[12:15], s21 offen lds
    s_add_u32 m0, s31, 125952
    s_add_u32 s21, s21, 131072
    buffer_load_dwordx4 v6, s[12:15], s21 offen lds
    s_add_u32 s21, s28, 1572864
    s_add_u32 m0, s31, 139264
    s_nop 0
    buffer_load_dwordx4 v6, s[12:15], s21 offen lds
    s_add_u32 m0, s31, 140288
    s_add_u32 s21, s21, 131072
    buffer_load_dwordx4 v6, s[12:15], s21 offen lds
    s_add_u32 m0, s31, 141312
    s_add_u32 s21, s21, 131072
    buffer_load_dwordx4 v6, s[12:15], s21 offen lds
    s_add_u32 m0, s31, 142336
    s_add_u32 s21, s21, 131072
    buffer_load_dwordx4 v6, s[12:15], s21 offen lds
    v_and_b32 v5, 15, v4
    v_lshrrev_b32 v3, 4, v4
    v_lshrrev_b32 v2, 2, v5
    v_xor_b32 v3, v3, v2
    v_lshl_add_u32 v3, v5, 2, v3
    v_lshlrev_b32 v1, 4, v3
    v_lshrrev_b32 v5, 2, v4
    v_lshrrev_b32 v3, 4, v4
    v_and_b32 v4, 3, v4
    v_xor_b32 v4, v4, v3
    v_lshlrev_b32 v3, 3, v3
    v_and_b32 v5, 3, v5
    v_add_u32 v3, v3, v5
    v_mul_u32_u24 v2, 1152, v3
    v_lshl_add_u32 v2, v4, 4, v2
    s_mov_b32 s8, s48
    s_mov_b32 s9, s49
    s_mov_b32 s10, 2359296
    s_mov_b32 s11, 0x20000
    s_lshr_b32 s22, s18, 1
    s_mul_i32 s24, s22, 4608
    s_and_b32 s22, s18, 1
    s_mul_i32 s23, s22, 576
    s_add_u32 s24, s24, s23
    s_mul_i32 s25, s18, 9216
    s_mul_i32 s22, s19, 36864
    s_add_u32 s24, s24, s22
    s_mul_i32 s42, s20, 36864
    s_mov_b32 s27, 0
    s_add_u32 s23, s27, s25
    s_add_u32 m0, s23, 0
    s_nop 0
    buffer_load_dwordx4 v2, s[8:11], s24 offen offset:0 lds
    s_add_u32 m0, s23, 960
    s_nop 0
    buffer_load_dwordx4 v2, s[8:11], s24 offen offset:64 lds
    s_add_u32 m0, s23, 1920
    s_nop 0
    buffer_load_dwordx4 v2, s[8:11], s24 offen offset:128 lds
    s_add_u32 m0, s23, 2880
    s_nop 0
    buffer_load_dwordx4 v2, s[8:11], s24 offen offset:192 lds
    s_add_u32 m0, s23, 3840
    s_nop 0
    buffer_load_dwordx4 v2, s[8:11], s24 offen offset:256 lds
    s_add_u32 m0, s23, 4800
    s_nop 0
    buffer_load_dwordx4 v2, s[8:11], s24 offen offset:320 lds
    s_add_u32 m0, s23, 5760
    s_nop 0
    buffer_load_dwordx4 v2, s[8:11], s24 offen offset:384 lds
    s_add_u32 m0, s23, 6720
    s_nop 0
    buffer_load_dwordx4 v2, s[8:11], s24 offen offset:448 lds
    s_add_u32 m0, s23, 7680
    s_nop 0
    buffer_load_dwordx4 v2, s[8:11], s24 offen offset:512 lds
    s_add_u32 s24, s24, s42
    s_lshl_b32 s22, s19, 5
    s_add_u32 s22, s22, s17
    s_lshl_b32 s26, s22, 14
    s_mul_i32 s23, s18, 3072
    s_add_u32 s26, s26, s23
    s_lshl_b32 s23, s16, 11
    s_add_u32 s26, s26, s23
    s_add_u32 s26, s26, -2048
    s_lshl_b32 s22, s22, 13
    s_add_u32 s22, s22, 33554432
    s_cmp_eq_u32 s16, 0
    s_cselect_b32 s26, s22, s26
    s_cselect_b32 s40, 4, 1
    s_cselect_b32 s43, 1, 2
    s_lshl_b32 s40, s40, 10
    s_lshl_b32 s43, s43, 13
    s_lshl_b32 s41, s43, 5
    s_mul_i32 s41, s41, s20
    s_lshl_b32 s29, s17, 7
    s_lshl_b32 s22, s33, 2
    s_add_u32 s29, s29, s22
    s_add_u32 s29, s29, 125829120
    v_add_u32 v25, 40960, v24
    v_xor_b32 v26, 32, v25
    s_waitcnt vmcnt(33)
    ds_read_b64_tr_b16 v[64:65], v25 offset:0
    ds_read_b64_tr_b16 v[66:67], v25 offset:256
    ds_read_b64_tr_b16 v[136:137], v26 offset:0
    ds_read_b64_tr_b16 v[138:139], v26 offset:256
    ds_read_b64_tr_b16 v[68:69], v25 offset:2048
    ds_read_b64_tr_b16 v[70:71], v25 offset:2304
    ds_read_b64_tr_b16 v[140:141], v26 offset:2048
    ds_read_b64_tr_b16 v[142:143], v26 offset:2304
    s_waitcnt lgkmcnt(0)
    s_add_u32 s21, s28, 1573120
    s_add_u32 m0, s31, 40960
    s_nop 0
    buffer_load_dwordx4 v6, s[12:15], s21 offen lds
    s_add_u32 m0, s31, 41984
    s_add_u32 s21, s21, 131072
    buffer_load_dwordx4 v6, s[12:15], s21 offen lds
    s_add_u32 m0, s31, 43008
    s_add_u32 s21, s21, 131072
    buffer_load_dwordx4 v6, s[12:15], s21 offen lds
    s_add_u32 m0, s31, 44032
    s_add_u32 s21, s21, 131072
    buffer_load_dwordx4 v6, s[12:15], s21 offen lds
    v_add_u32 v25, 57344, v24
    v_xor_b32 v26, 32, v25
    s_waitcnt vmcnt(33)
    ds_read_b64_tr_b16 a[0:1], v25 offset:0
    ds_read_b64_tr_b16 a[2:3], v25 offset:256
    ds_read_b64_tr_b16 a[72:73], v26 offset:0
    ds_read_b64_tr_b16 a[74:75], v26 offset:256
    ds_read_b64_tr_b16 a[4:5], v25 offset:2048
    ds_read_b64_tr_b16 a[6:7], v25 offset:2304
    ds_read_b64_tr_b16 a[76:77], v26 offset:2048
    ds_read_b64_tr_b16 a[78:79], v26 offset:2304
    s_waitcnt lgkmcnt(0)
    s_add_u32 s21, s28, 2097152
    s_add_u32 m0, s31, 57344
    s_nop 0
    buffer_load_dwordx4 v6, s[12:15], s21 offen lds
    s_add_u32 m0, s31, 58368
    s_add_u32 s21, s21, 131072
    buffer_load_dwordx4 v6, s[12:15], s21 offen lds
    s_add_u32 m0, s31, 59392
    s_add_u32 s21, s21, 131072
    buffer_load_dwordx4 v6, s[12:15], s21 offen lds
    s_add_u32 m0, s31, 60416
    s_add_u32 s21, s21, 131072
    buffer_load_dwordx4 v6, s[12:15], s21 offen lds
    v_add_u32 v25, 73728, v24
    v_xor_b32 v26, 32, v25
    s_waitcnt vmcnt(33)
    ds_read_b64_tr_b16 v[72:73], v25 offset:0
    ds_read_b64_tr_b16 v[74:75], v25 offset:256
    ds_read_b64_tr_b16 v[144:145], v26 offset:0
    ds_read_b64_tr_b16 v[146:147], v26 offset:256
    ds_read_b64_tr_b16 v[76:77], v25 offset:2048
    ds_read_b64_tr_b16 v[78:79], v25 offset:2304
    ds_read_b64_tr_b16 v[148:149], v26 offset:2048
    ds_read_b64_tr_b16 v[150:151], v26 offset:2304
    s_waitcnt lgkmcnt(0)
    s_add_u32 s21, s28, 2097408
    s_add_u32 m0, s31, 73728
    s_nop 0
    buffer_load_dwordx4 v6, s[12:15], s21 offen lds
    s_add_u32 m0, s31, 74752
    s_add_u32 s21, s21, 131072
    buffer_load_dwordx4 v6, s[12:15], s21 offen lds
    s_add_u32 m0, s31, 75776
    s_add_u32 s21, s21, 131072
    buffer_load_dwordx4 v6, s[12:15], s21 offen lds
    s_add_u32 m0, s31, 76800
    s_add_u32 s21, s21, 131072
    buffer_load_dwordx4 v6, s[12:15], s21 offen lds
    v_add_u32 v25, 90112, v24
    v_xor_b32 v26, 32, v25
    s_waitcnt vmcnt(33)
    ds_read_b64_tr_b16 a[8:9], v25 offset:0
    ds_read_b64_tr_b16 a[10:11], v25 offset:256
    ds_read_b64_tr_b16 a[80:81], v26 offset:0
    ds_read_b64_tr_b16 a[82:83], v26 offset:256
    ds_read_b64_tr_b16 a[12:13], v25 offset:2048
    ds_read_b64_tr_b16 a[14:15], v25 offset:2304
    ds_read_b64_tr_b16 a[84:85], v26 offset:2048
    ds_read_b64_tr_b16 a[86:87], v26 offset:2304
    s_waitcnt lgkmcnt(0)
    s_add_u32 s21, s28, 2621440
    s_add_u32 m0, s31, 90112
    s_nop 0
    buffer_load_dwordx4 v6, s[12:15], s21 offen lds
    s_add_u32 m0, s31, 91136
    s_add_u32 s21, s21, 131072
    buffer_load_dwordx4 v6, s[12:15], s21 offen lds
    s_add_u32 m0, s31, 92160
    s_add_u32 s21, s21, 131072
    buffer_load_dwordx4 v6, s[12:15], s21 offen lds
    s_add_u32 m0, s31, 93184
    s_add_u32 s21, s21, 131072
    buffer_load_dwordx4 v6, s[12:15], s21 offen lds
    v_add_u32 v25, 106496, v24
    v_xor_b32 v26, 32, v25
    s_waitcnt vmcnt(33)
    ds_read_b64_tr_b16 v[80:81], v25 offset:0
    ds_read_b64_tr_b16 v[82:83], v25 offset:256
    ds_read_b64_tr_b16 v[152:153], v26 offset:0
    ds_read_b64_tr_b16 v[154:155], v26 offset:256
    ds_read_b64_tr_b16 v[84:85], v25 offset:2048
    ds_read_b64_tr_b16 v[86:87], v25 offset:2304
    ds_read_b64_tr_b16 v[156:157], v26 offset:2048
    ds_read_b64_tr_b16 v[158:159], v26 offset:2304
    s_waitcnt lgkmcnt(0)
    s_add_u32 s21, s28, 2621696
    s_add_u32 m0, s31, 106496
    s_nop 0
    buffer_load_dwordx4 v6, s[12:15], s21 offen lds
    s_add_u32 m0, s31, 107520
    s_add_u32 s21, s21, 131072
    buffer_load_dwordx4 v6, s[12:15], s21 offen lds
    s_add_u32 m0, s31, 108544
    s_add_u32 s21, s21, 131072
    buffer_load_dwordx4 v6, s[12:15], s21 offen lds
    s_add_u32 m0, s31, 109568
    s_add_u32 s21, s21, 131072
    buffer_load_dwordx4 v6, s[12:15], s21 offen lds
    v_add_u32 v25, 122880, v24
    v_xor_b32 v26, 32, v25
    s_waitcnt vmcnt(33)
    ds_read_b64_tr_b16 a[16:17], v25 offset:0
    ds_read_b64_tr_b16 a[18:19], v25 offset:256
    ds_read_b64_tr_b16 a[88:89], v26 offset:0
    ds_read_b64_tr_b16 a[90:91], v26 offset:256
    ds_read_b64_tr_b16 a[20:21], v25 offset:2048
    ds_read_b64_tr_b16 a[22:23], v25 offset:2304
    ds_read_b64_tr_b16 a[92:93], v26 offset:2048
    ds_read_b64_tr_b16 a[94:95], v26 offset:2304
    s_waitcnt lgkmcnt(0)
    s_add_u32 s21, s28, 3145728
    s_add_u32 m0, s31, 122880
    s_nop 0
    buffer_load_dwordx4 v6, s[12:15], s21 offen lds
    s_add_u32 m0, s31, 123904
    s_add_u32 s21, s21, 131072
    buffer_load_dwordx4 v6, s[12:15], s21 offen lds
    s_add_u32 m0, s31, 124928
    s_add_u32 s21, s21, 131072
    buffer_load_dwordx4 v6, s[12:15], s21 offen lds
    s_add_u32 m0, s31, 125952
    s_add_u32 s21, s21, 131072
    buffer_load_dwordx4 v6, s[12:15], s21 offen lds
    v_add_u32 v25, 139264, v24
    v_xor_b32 v26, 32, v25
    s_waitcnt vmcnt(33)
    ds_read_b64_tr_b16 v[88:89], v25 offset:0
    ds_read_b64_tr_b16 v[90:91], v25 offset:256
    ds_read_b64_tr_b16 v[160:161], v26 offset:0
    ds_read_b64_tr_b16 v[162:163], v26 offset:256
    ds_read_b64_tr_b16 v[92:93], v25 offset:2048
    ds_read_b64_tr_b16 v[94:95], v25 offset:2304
    ds_read_b64_tr_b16 v[164:165], v26 offset:2048
    ds_read_b64_tr_b16 v[166:167], v26 offset:2304
    s_waitcnt lgkmcnt(0)
    s_add_u32 s21, s28, 3145984
    s_add_u32 m0, s31, 139264
    s_nop 0
    buffer_load_dwordx4 v6, s[12:15], s21 offen lds
    s_add_u32 m0, s31, 140288
    s_add_u32 s21, s21, 131072
    buffer_load_dwordx4 v6, s[12:15], s21 offen lds
    s_add_u32 m0, s31, 141312
    s_add_u32 s21, s21, 131072
    buffer_load_dwordx4 v6, s[12:15], s21 offen lds
    s_add_u32 m0, s31, 142336
    s_add_u32 s21, s21, 131072
    buffer_load_dwordx4 v6, s[12:15], s21 offen lds
    v_add_u32 v25, 40960, v24
    v_xor_b32 v26, 32, v25
    s_waitcnt vmcnt(24)
    ds_read_b64_tr_b16 a[24:25], v25 offset:0
    ds_read_b64_tr_b16 a[26:27], v25 offset:256
    ds_read_b64_tr_b16 a[96:97], v26 offset:0
    ds_read_b64_tr_b16 a[98:99], v26 offset:256
    ds_read_b64_tr_b16 a[28:29], v25 offset:2048
    ds_read_b64_tr_b16 a[30:31], v25 offset:2304
    ds_read_b64_tr_b16 a[100:101], v26 offset:2048
    ds_read_b64_tr_b16 a[102:103], v26 offset:2304
    s_waitcnt lgkmcnt(0)
    s_add_u32 s21, s28, 3670016
    s_add_u32 m0, s31, 40960
    s_nop 0
    buffer_load_dwordx4 v6, s[12:15], s21 offen lds
    s_add_u32 m0, s31, 41984
    s_add_u32 s21, s21, 131072
    buffer_load_dwordx4 v6, s[12:15], s21 offen lds
    s_add_u32 m0, s31, 43008
    s_add_u32 s21, s21, 131072
    buffer_load_dwordx4 v6, s[12:15], s21 offen lds
    s_add_u32 m0, s31, 44032
    s_add_u32 s21, s21, 131072
    buffer_load_dwordx4 v6, s[12:15], s21 offen lds
    v_add_u32 v25, 57344, v24
    v_xor_b32 v26, 32, v25
    s_waitcnt vmcnt(24)
    ds_read_b64_tr_b16 v[96:97], v25 offset:0
    ds_read_b64_tr_b16 v[98:99], v25 offset:256
    ds_read_b64_tr_b16 v[168:169], v26 offset:0
    ds_read_b64_tr_b16 v[170:171], v26 offset:256
    ds_read_b64_tr_b16 v[100:101], v25 offset:2048
    ds_read_b64_tr_b16 v[102:103], v25 offset:2304
    ds_read_b64_tr_b16 v[172:173], v26 offset:2048
    ds_read_b64_tr_b16 v[174:175], v26 offset:2304
    s_waitcnt lgkmcnt(0)
    s_add_u32 s21, s28, 3670272
    s_add_u32 m0, s31, 57344
    s_nop 0
    buffer_load_dwordx4 v6, s[12:15], s21 offen lds
    s_add_u32 m0, s31, 58368
    s_add_u32 s21, s21, 131072
    buffer_load_dwordx4 v6, s[12:15], s21 offen lds
    s_add_u32 m0, s31, 59392
    s_add_u32 s21, s21, 131072
    buffer_load_dwordx4 v6, s[12:15], s21 offen lds
    s_add_u32 m0, s31, 60416
    s_add_u32 s21, s21, 131072
    buffer_load_dwordx4 v6, s[12:15], s21 offen lds
    v_add_u32 v25, 73728, v24
    v_xor_b32 v26, 32, v25
    s_waitcnt vmcnt(24)
    ds_read_b64_tr_b16 a[32:33], v25 offset:0
    ds_read_b64_tr_b16 a[34:35], v25 offset:256
    ds_read_b64_tr_b16 a[104:105], v26 offset:0
    ds_read_b64_tr_b16 a[106:107], v26 offset:256
    ds_read_b64_tr_b16 a[36:37], v25 offset:2048
    ds_read_b64_tr_b16 a[38:39], v25 offset:2304
    ds_read_b64_tr_b16 a[108:109], v26 offset:2048
    ds_read_b64_tr_b16 a[110:111], v26 offset:2304
    s_waitcnt lgkmcnt(0)
    s_add_u32 s21, s28, 4194304
    s_add_u32 m0, s31, 73728
    s_nop 0
    buffer_load_dwordx4 v6, s[12:15], s21 offen lds
    s_add_u32 m0, s31, 74752
    s_add_u32 s21, s21, 131072
    buffer_load_dwordx4 v6, s[12:15], s21 offen lds
    s_add_u32 m0, s31, 75776
    s_add_u32 s21, s21, 131072
    buffer_load_dwordx4 v6, s[12:15], s21 offen lds
    s_add_u32 m0, s31, 76800
    s_add_u32 s21, s21, 131072
    buffer_load_dwordx4 v6, s[12:15], s21 offen lds
    v_add_u32 v25, 90112, v24
    v_xor_b32 v26, 32, v25
    s_waitcnt vmcnt(24)
    ds_read_b64_tr_b16 v[104:105], v25 offset:0
    ds_read_b64_tr_b16 v[106:107], v25 offset:256
    ds_read_b64_tr_b16 v[176:177], v26 offset:0
    ds_read_b64_tr_b16 v[178:179], v26 offset:256
    ds_read_b64_tr_b16 v[108:109], v25 offset:2048
    ds_read_b64_tr_b16 v[110:111], v25 offset:2304
    ds_read_b64_tr_b16 v[180:181], v26 offset:2048
    ds_read_b64_tr_b16 v[182:183], v26 offset:2304
    s_waitcnt lgkmcnt(0)
    v_mov_b32 v28, s95
    s_cmp_lg_u32 s95, 0
    s_cbranch_scc1 L_ne
    buffer_load_dword v28, off, s[96:99], 0 offset:64 sc1
    s_cmp_ge_u32 s36, 192
    s_cbranch_scc1 L_ne
    s_mul_i32 s37, s36, 24576
    s_mov_b32 s46, 4718592
    s_mov_b32 s47, 0x20000
    v_lshlrev_b32 v29, 7, v0
    v_min_u32 v29, 24448, v29
    s_mov_b64 s[44:45], s[58:59]
    buffer_load_dword v30, v29, s[44:47], s37 offen
    s_mov_b64 s[44:45], s[52:53]
    buffer_load_dword v30, v29, s[44:47], s37 offen
L_ne:
    s_add_u32 s21, s28, 4194560
    s_add_u32 m0, s31, 90112
    s_nop 0
    buffer_load_dwordx4 v6, s[12:15], s21 offen lds
    s_add_u32 m0, s31, 91136
    s_add_u32 s21, s21, 131072
    buffer_load_dwordx4 v6, s[12:15], s21 offen lds
    s_add_u32 m0, s31, 92160
    s_add_u32 s21, s21, 131072
    buffer_load_dwordx4 v6, s[12:15], s21 offen lds
    s_add_u32 m0, s31, 93184
    s_add_u32 s21, s21, 131072
    buffer_load_dwordx4 v6, s[12:15], s21 offen lds
    v_add_u32 v25, 106496, v24
    v_xor_b32 v26, 32, v25
    s_waitcnt vmcnt(24)
    ds_read_b64_tr_b16 a[40:41], v25 offset:0
    ds_read_b64_tr_b16 a[42:43], v25 offset:256
    ds_read_b64_tr_b16 a[112:113], v26 offset:0
    ds_read_b64_tr_b16 a[114:115], v26 offset:256
    ds_read_b64_tr_b16 a[44:45], v25 offset:2048
    ds_read_b64_tr_b16 a[46:47], v25 offset:2304
    ds_read_b64_tr_b16 a[116:117], v26 offset:2048
    ds_read_b64_tr_b16 a[118:119], v26 offset:2304
    s_waitcnt lgkmcnt(0)
    v_add_u32 v25, 122880, v24
    v_xor_b32 v26, 32, v25
    s_waitcnt vmcnt(20)
    ds_read_b64_tr_b16 v[112:113], v25 offset:0
    ds_read_b64_tr_b16 v[114:115], v25 offset:256
    ds_read_b64_tr_b16 v[184:185], v26 offset:0
    ds_read_b64_tr_b16 v[186:187], v26 offset:256
    ds_read_b64_tr_b16 v[116:117], v25 offset:2048
    ds_read_b64_tr_b16 v[118:119], v25 offset:2304
    ds_read_b64_tr_b16 v[188:189], v26 offset:2048
    ds_read_b64_tr_b16 v[190:191], v26 offset:2304
    s_waitcnt lgkmcnt(0)
    v_add_u32 v25, 139264, v24
    v_xor_b32 v26, 32, v25
    s_waitcnt vmcnt(16)
    ds_read_b64_tr_b16 a[48:49], v25 offset:0
    ds_read_b64_tr_b16 a[50:51], v25 offset:256
    ds_read_b64_tr_b16 a[120:121], v26 offset:0
    ds_read_b64_tr_b16 a[122:123], v26 offset:256
    ds_read_b64_tr_b16 a[52:53], v25 offset:2048
    ds_read_b64_tr_b16 a[54:55], v25 offset:2304
    ds_read_b64_tr_b16 a[124:125], v26 offset:2048
    ds_read_b64_tr_b16 a[126:127], v26 offset:2304
    s_waitcnt lgkmcnt(0)
    v_add_u32 v25, 40960, v24
    v_xor_b32 v26, 32, v25
    s_waitcnt vmcnt(12)
    ds_read_b64_tr_b16 v[120:121], v25 offset:0
    ds_read_b64_tr_b16 v[122:123], v25 offset:256
    ds_read_b64_tr_b16 v[192:193], v26 offset:0
    ds_read_b64_tr_b16 v[194:195], v26 offset:256
    ds_read_b64_tr_b16 v[124:125], v25 offset:2048
    ds_read_b64_tr_b16 v[126:127], v25 offset:2304
    ds_read_b64_tr_b16 v[196:197], v26 offset:2048
    ds_read_b64_tr_b16 v[198:199], v26 offset:2304
    s_waitcnt lgkmcnt(0)
    v_add_u32 v25, 57344, v24
    v_xor_b32 v26, 32, v25
    s_waitcnt vmcnt(8)
    ds_read_b64_tr_b16 a[56:57], v25 offset:0
    ds_read_b64_tr_b16 a[58:59], v25 offset:256
    ds_read_b64_tr_b16 a[128:129], v26 offset:0
    ds_read_b64_tr_b16 a[130:131], v26 offset:256
    ds_read_b64_tr_b16 a[60:61], v25 offset:2048
    ds_read_b64_tr_b16 a[62:63], v25 offset:2304
    ds_read_b64_tr_b16 a[132:133], v26 offset:2048
    ds_read_b64_tr_b16 a[134:135], v26 offset:2304
    s_waitcnt lgkmcnt(0)
    v_add_u32 v25, 73728, v24
    v_xor_b32 v26, 32, v25
    s_waitcnt vmcnt(4)
    ds_read_b64_tr_b16 v[128:129], v25 offset:0
    ds_read_b64_tr_b16 v[130:131], v25 offset:256
    ds_read_b64_tr_b16 v[200:201], v26 offset:0
    ds_read_b64_tr_b16 v[202:203], v26 offset:256
    ds_read_b64_tr_b16 v[132:133], v25 offset:2048
    ds_read_b64_tr_b16 v[134:135], v25 offset:2304
    ds_read_b64_tr_b16 v[204:205], v26 offset:2048
    ds_read_b64_tr_b16 v[206:207], v26 offset:2304
    s_waitcnt lgkmcnt(0)
    v_add_u32 v25, 90112, v24
    v_xor_b32 v26, 32, v25
    s_waitcnt vmcnt(0)
    ds_read_b64_tr_b16 a[64:65], v25 offset:0
    ds_read_b64_tr_b16 a[66:67], v25 offset:256
    ds_read_b64_tr_b16 a[136:137], v26 offset:0
    ds_read_b64_tr_b16 a[138:139], v26 offset:256
    ds_read_b64_tr_b16 a[68:69], v25 offset:2048
    ds_read_b64_tr_b16 a[70:71], v25 offset:2304
    ds_read_b64_tr_b16 a[140:141], v26 offset:2048
    ds_read_b64_tr_b16 a[142:143], v26 offset:2304
    s_waitcnt lgkmcnt(0)
    s_lshr_b32 s21, s17, 3
    s_cmp_eq_u32 s21, 3
    s_cselect_b32 s21, 1, s33
    s_cmp_lg_u32 s21, 0
    s_cbranch_scc1 qk_noclr
    v_mov_b32 v8, -1
    v_mov_b32 v9, -1
    v_mov_b32 v10, -1
    v_mov_b32 v11, -1
    v_lshrrev_b32 v25, 6, v0
    v_mul_u32_u24 v25, 11264, v25
    v_add_u32 v25, v25, v7
    s_lshl_b32 s21, s17, 9
    s_add_u32 s21, s21, 90177536
    s_add_u32 s22, s21, 786432
qk_clr:
    buffer_store_dwordx4 v[8:11], v25, s[4:7], s21 offen sc1
    s_add_u32 s21, s21, 49152
    s_cmp_lt_u32 s21, s22
    s_cbranch_scc1 qk_clr
qk_noclr:
    s_and_b32 s21, s33, -2
    s_cmp_lg_u32 s21, 2
    s_cbranch_scc1 qk_noclr2
    v_mov_b32 v8, -1
    v_mov_b32 v9, -1
    v_mov_b32 v10, -1
    v_mov_b32 v11, -1
    s_add_u32 s21, s33, 60
    s_lshl_b32 s23, s17, 12
    s_lshl_b32 s22, s21, 17
    s_add_u32 s22, s22, s23
    s_add_u32 s22, s22, 71303168
    buffer_store_dwordx4 v[8:11], v7, s[4:7], s22 offen sc1
    s_add_u32 s22, s22, 4096
    buffer_store_dwordx4 v[8:11], v7, s[4:7], s22 offen sc1
    s_lshl_b32 s22, s21, 17
    s_add_u32 s22, s22, s23
    s_add_u32 s22, s22, 80740352
    buffer_store_dwordx4 v[8:11], v7, s[4:7], s22 offen sc1
    s_add_u32 s22, s22, 4096
    buffer_store_dwordx4 v[8:11], v7, s[4:7], s22 offen sc1
    s_lshl_b32 s22, s21, 18
    s_add_u32 s22, s22, s23
    s_add_u32 s22, s22, 50331648
    buffer_store_dwordx4 v[8:11], v7, s[4:7], s22 offen sc1
    s_add_u32 s22, s22, 4096
    buffer_store_dwordx4 v[8:11], v7, s[4:7], s22 offen sc1
    s_lshl_b32 s22, s21, 18
    s_add_u32 s22, s22, s23
    s_add_u32 s22, s22, 50462720
    buffer_store_dwordx4 v[8:11], v7, s[4:7], s22 offen sc1
    s_add_u32 s22, s22, 4096
    buffer_store_dwordx4 v[8:11], v7, s[4:7], s22 offen sc1
qk_noclr2:
    v_readfirstlane_b32 s95, v28
    s_nop 4
    s_mov_b32 s88, 4194304
gn7:
    s_cmp_lg_u32 s95, 0
    s_cbranch_scc1 gn7x
    buffer_load_dword v25, off, s[96:99], 0 offset:64 sc1
    s_sub_u32 s88, s88, 1
    s_cbranch_scc1 gn7x
    s_waitcnt vmcnt(0)
    v_readfirstlane_b32 s95, v25
    s_nop 1
    s_branch gn7
gn7x:
    s_barrier
    s_mov_b32 s27, 36864
    s_add_u32 s23, s27, s25
    s_add_u32 m0, s23, 0
    s_nop 0
    buffer_load_dwordx4 v2, s[8:11], s24 offen offset:0 lds
    s_add_u32 m0, s23, 960
    s_nop 0
    buffer_load_dwordx4 v2, s[8:11], s24 offen offset:64 lds
    s_add_u32 m0, s23, 1920
    s_nop 0
    buffer_load_dwordx4 v2, s[8:11], s24 offen offset:128 lds
    s_add_u32 m0, s23, 2880
    s_nop 0
    buffer_load_dwordx4 v2, s[8:11], s24 offen offset:192 lds
    s_add_u32 m0, s23, 3840
    s_nop 0
    buffer_load_dwordx4 v2, s[8:11], s24 offen offset:256 lds
    s_add_u32 m0, s23, 4800
    s_nop 0
    buffer_load_dwordx4 v2, s[8:11], s24 offen offset:320 lds
    s_add_u32 m0, s23, 5760
    s_nop 0
    buffer_load_dwordx4 v2, s[8:11], s24 offen offset:384 lds
    s_add_u32 m0, s23, 6720
    s_nop 0
    buffer_load_dwordx4 v2, s[8:11], s24 offen offset:448 lds
    s_add_u32 m0, s23, 7680
    s_nop 0
    buffer_load_dwordx4 v2, s[8:11], s24 offen offset:512 lds
    s_add_u32 s24, s24, s42
    s_mov_b32 s27, 0
    s_mov_b32 s30, s95
    s_cmp_eq_u32 s18, 0
    s_cselect_b32 s34, 1, 0
    s_mov_b32 s35, 0
    s_mov_b32 s31, 0x80000000
    v_mov_b32 v3, v1
    ds_read_b128 v[32:35], v3 offset:0
    ds_read_b128 v[36:39], v3 offset:18432
    ds_read_b128 v[40:43], v3 offset:1024
    ds_read_b128 v[44:47], v3 offset:19456
    s_cmp_eq_u32 s16, 2
    s_cbranch_scc1 qk_vloop
qk_loop:
    s_add_u32 s22, s27, 73728
    s_sub_u32 s21, s22, 147456
    s_cselect_b32 s22, s22, s21
    s_add_u32 s27, s27, 36864
    s_cmp_eq_u32 s27, 147456
    s_cselect_b32 s27, 0, s27
    s_waitcnt lgkmcnt(2)
    v_cvt_pk_bf16_f32 v8, v208, v209
    v_cvt_pk_bf16_f32 v9, v210, v211
    v_mfma_f32_16x16x32_bf16 v[208:211], v[64:67], v[32:35], 0
    ds_read_b128 v[48:51], v3 offset:2048
    ds_read_b128 v[52:55], v3 offset:20480
    v_cvt_pk_bf16_f32 v10, v212, v213
    v_cvt_pk_bf16_f32 v11, v214, v215
    v_mfma_f32_16x16x32_bf16 v[212:215], v[136:139], v[32:35], 0
    v_cvt_pk_bf16_f32 v12, v216, v217
    v_cvt_pk_bf16_f32 v13, v218, v219
    v_mfma_f32_16x16x32_bf16 v[216:219], v[64:67], v[36:39], 0
    v_cvt_pk_bf16_f32 v14, v220, v221
    v_cvt_pk_bf16_f32 v15, v222, v223
    v_mfma_f32_16x16x32_bf16 v[220:223], v[136:139], v[36:39], 0
    v_cvt_pk_bf16_f32 v16, v224, v225
    v_cvt_pk_bf16_f32 v17, v226, v227
    v_mfma_f32_16x16x32_bf16 v[224:227], a[0:3], v[32:35], 0
    v_cvt_pk_bf16_f32 v18, v228, v229
    v_cvt_pk_bf16_f32 v19, v230, v231
    v_mfma_f32_16x16x32_bf16 v[228:231], a[72:75], v[32:35], 0
    v_cvt_pk_bf16_f32 v20, v232, v233
    v_cvt_pk_bf16_f32 v21, v234, v235
    v_mfma_f32_16x16x32_bf16 v[232:235], a[0:3], v[36:39], 0
    v_cvt_pk_bf16_f32 v22, v236, v237
    v_cvt_pk_bf16_f32 v23, v238, v239
    v_mfma_f32_16x16x32_bf16 v[236:239], a[72:75], v[36:39], 0
    s_waitcnt lgkmcnt(2)
    v_mfma_f32_16x16x32_bf16 v[208:211], v[68:71], v[40:43], v[208:211]
    ds_read_b128 v[32:35], v3 offset:3072
    ds_read_b128 v[36:39], v3 offset:21504
    v_mfma_f32_16x16x32_bf16 v[212:215], v[140:143], v[40:43], v[212:215]
    v_mfma_f32_16x16x32_bf16 v[216:219], v[68:71], v[44:47], v[216:219]
    s_mov_b32 s28, s31
    buffer_store_dwordx4 v[8:11], v7, s[4:7], s28 offen sc1
    v_mfma_f32_16x16x32_bf16 v[220:223], v[140:143], v[44:47], v[220:223]
    v_mfma_f32_16x16x32_bf16 v[224:227], a[4:7], v[40:43], v[224:227]
    v_mfma_f32_16x16x32_bf16 v[228:231], a[76:79], v[40:43], v[228:231]
    v_mfma_f32_16x16x32_bf16 v[232:235], a[4:7], v[44:47], v[232:235]
    v_mfma_f32_16x16x32_bf16 v[236:239], a[76:79], v[44:47], v[236:239]
    s_waitcnt lgkmcnt(2)
    v_mfma_f32_16x16x32_bf16 v[208:211], v[72:75], v[48:51], v[208:211]
    ds_read_b128 v[40:43], v3 offset:4096
    ds_read_b128 v[44:47], v3 offset:22528
    v_mfma_f32_16x16x32_bf16 v[212:215], v[144:147], v[48:51], v[212:215]
    v_mfma_f32_16x16x32_bf16 v[216:219], v[72:75], v[52:55], v[216:219]
    s_add_u32 s28, s28, s40
    buffer_store_dwordx4 v[12:15], v7, s[4:7], s28 offen sc1
    v_mfma_f32_16x16x32_bf16 v[220:223], v[144:147], v[52:55], v[220:223]
    v_mfma_f32_16x16x32_bf16 v[224:227], a[8:11], v[48:51], v[224:227]
    v_mfma_f32_16x16x32_bf16 v[228:231], a[80:83], v[48:51], v[228:231]
    v_mfma_f32_16x16x32_bf16 v[232:235], a[8:11], v[52:55], v[232:235]
    v_mfma_f32_16x16x32_bf16 v[236:239], a[80:83], v[52:55], v[236:239]
    s_waitcnt lgkmcnt(2)
    v_mfma_f32_16x16x32_bf16 v[208:211], v[76:79], v[32:35], v[208:211]
    ds_read_b128 v[48:51], v3 offset:5120
    ds_read_b128 v[52:55], v3 offset:23552
    v_mfma_f32_16x16x32_bf16 v[212:215], v[148:151], v[32:35], v[212:215]
    v_mfma_f32_16x16x32_bf16 v[216:219], v[76:79], v[36:39], v[216:219]
    s_add_u32 s28, s31, s43
    buffer_store_dwordx4 v[16:19], v7, s[4:7], s28 offen sc1
    v_mfma_f32_16x16x32_bf16 v[220:223], v[148:151], v[36:39], v[220:223]
    v_mfma_f32_16x16x32_bf16 v[224:227], a[12:15], v[32:35], v[224:227]
    v_mfma_f32_16x16x32_bf16 v[228:231], a[84:87], v[32:35], v[228:231]
    v_mfma_f32_16x16x32_bf16 v[232:235], a[12:15], v[36:39], v[232:235]
    v_mfma_f32_16x16x32_bf16 v[236:239], a[84:87], v[36:39], v[236:239]
    s_waitcnt lgkmcnt(2)
    v_mfma_f32_16x16x32_bf16 v[208:211], v[80:83], v[40:43], v[208:211]
    ds_read_b128 v[32:35], v3 offset:6144
    ds_read_b128 v[36:39], v3 offset:24576
    v_mfma_f32_16x16x32_bf16 v[212:215], v[152:155], v[40:43], v[212:215]
    v_mfma_f32_16x16x32_bf16 v[216:219], v[80:83], v[44:47], v[216:219]
    s_add_u32 s28, s28, s40
    buffer_store_dwordx4 v[20:23], v7, s[4:7], s28 offen sc1
    v_mfma_f32_16x16x32_bf16 v[220:223], v[152:155], v[44:47], v[220:223]
    v_mfma_f32_16x16x32_bf16 v[224:227], a[16:19], v[40:43], v[224:227]
    v_mfma_f32_16x16x32_bf16 v[228:231], a[88:91], v[40:43], v[228:231]
    v_mfma_f32_16x16x32_bf16 v[232:235], a[16:19], v[44:47], v[232:235]
    v_mfma_f32_16x16x32_bf16 v[236:239], a[88:91], v[44:47], v[236:239]
    s_waitcnt lgkmcnt(2)
    v_mfma_f32_16x16x32_bf16 v[208:211], v[84:87], v[48:51], v[208:211]
    ds_read_b128 v[40:43], v3 offset:7168
    ds_read_b128 v[44:47], v3 offset:25600
    v_mfma_f32_16x16x32_bf16 v[212:215], v[156:159], v[48:51], v[212:215]
    v_mfma_f32_16x16x32_bf16 v[216:219], v[84:87], v[52:55], v[216:219]
    s_add_u32 s23, s22, s25
    s_add_u32 m0, s23, 0
    s_nop 0
    buffer_load_dwordx4 v2, s[8:11], s24 offen offset:0 lds
    v_mfma_f32_16x16x32_bf16 v[220:223], v[156:159], v[52:55], v[220:223]
    v_mfma_f32_16x16x32_bf16 v[224:227], a[20:23], v[48:51], v[224:227]
    v_mfma_f32_16x16x32_bf16 v[228:231], a[92:95], v[48:51], v[228:231]
    v_mfma_f32_16x16x32_bf16 v[232:235], a[20:23], v[52:55], v[232:235]
    v_mfma_f32_16x16x32_bf16 v[236:239], a[92:95], v[52:55], v[236:239]
    s_waitcnt lgkmcnt(2)
    v_mfma_f32_16x16x32_bf16 v[208:211], v[88:91], v[32:35], v[208:211]
    ds_read_b128 v[48:51], v3 offset:8192
    ds_read_b128 v[52:55], v3 offset:26624
    v_mfma_f32_16x16x32_bf16 v[212:215], v[160:163], v[32:35], v[212:215]
    v_mfma_f32_16x16x32_bf16 v[216:219], v[88:91], v[36:39], v[216:219]
    s_add_u32 m0, s23, 960
    s_nop 0
    buffer_load_dwordx4 v2, s[8:11], s24 offen offset:64 lds
    v_mfma_f32_16x16x32_bf16 v[220:223], v[160:163], v[36:39], v[220:223]
    v_mfma_f32_16x16x32_bf16 v[224:227], a[24:27], v[32:35], v[224:227]
    v_mfma_f32_16x16x32_bf16 v[228:231], a[96:99], v[32:35], v[228:231]
    v_mfma_f32_16x16x32_bf16 v[232:235], a[24:27], v[36:39], v[232:235]
    v_mfma_f32_16x16x32_bf16 v[236:239], a[96:99], v[36:39], v[236:239]
    s_waitcnt lgkmcnt(2)
    v_mfma_f32_16x16x32_bf16 v[208:211], v[92:95], v[40:43], v[208:211]
    ds_read_b128 v[32:35], v3 offset:9216
    ds_read_b128 v[36:39], v3 offset:27648
    v_mfma_f32_16x16x32_bf16 v[212:215], v[164:167], v[40:43], v[212:215]
    v_mfma_f32_16x16x32_bf16 v[216:219], v[92:95], v[44:47], v[216:219]
    s_add_u32 m0, s23, 1920
    s_nop 0
    buffer_load_dwordx4 v2, s[8:11], s24 offen offset:128 lds
    v_mfma_f32_16x16x32_bf16 v[220:223], v[164:167], v[44:47], v[220:223]
    v_mfma_f32_16x16x32_bf16 v[224:227], a[28:31], v[40:43], v[224:227]
    v_mfma_f32_16x16x32_bf16 v[228:231], a[100:103], v[40:43], v[228:231]
    v_mfma_f32_16x16x32_bf16 v[232:235], a[28:31], v[44:47], v[232:235]
    v_mfma_f32_16x16x32_bf16 v[236:239], a[100:103], v[44:47], v[236:239]
    s_waitcnt lgkmcnt(2)
    v_mfma_f32_16x16x32_bf16 v[208:211], v[96:99], v[48:51], v[208:211]
    ds_read_b128 v[40:43], v3 offset:10240
    ds_read_b128 v[44:47], v3 offset:28672
    v_mfma_f32_16x16x32_bf16 v[212:215], v[168:171], v[48:51], v[212:215]
    v_mfma_f32_16x16x32_bf16 v[216:219], v[96:99], v[52:55], v[216:219]
    s_add_u32 m0, s23, 2880
    s_nop 0
    buffer_load_dwordx4 v2, s[8:11], s24 offen offset:192 lds
    v_mfma_f32_16x16x32_bf16 v[220:223], v[168:171], v[52:55], v[220:223]
    v_mfma_f32_16x16x32_bf16 v[224:227], a[32:35], v[48:51], v[224:227]
    v_mfma_f32_16x16x32_bf16 v[228:231], a[104:107], v[48:51], v[228:231]
    v_mfma_f32_16x16x32_bf16 v[232:235], a[32:35], v[52:55], v[232:235]
    v_mfma_f32_16x16x32_bf16 v[236:239], a[104:107], v[52:55], v[236:239]
    s_waitcnt lgkmcnt(2)
    v_mfma_f32_16x16x32_bf16 v[208:211], v[100:103], v[32:35], v[208:211]
    ds_read_b128 v[48:51], v3 offset:11264
    ds_read_b128 v[52:55], v3 offset:29696
    v_mfma_f32_16x16x32_bf16 v[212:215], v[172:175], v[32:35], v[212:215]
    v_mfma_f32_16x16x32_bf16 v[216:219], v[100:103], v[36:39], v[216:219]
    s_add_u32 m0, s23, 3840
    s_nop 0
    buffer_load_dwordx4 v2, s[8:11], s24 offen offset:256 lds
    v_mfma_f32_16x16x32_bf16 v[220:223], v[172:175], v[36:39], v[220:223]
    v_mfma_f32_16x16x32_bf16 v[224:227], a[36:39], v[32:35], v[224:227]
    v_mfma_f32_16x16x32_bf16 v[228:231], a[108:111], v[32:35], v[228:231]
    v_mfma_f32_16x16x32_bf16 v[232:235], a[36:39], v[36:39], v[232:235]
    v_mfma_f32_16x16x32_bf16 v[236:239], a[108:111], v[36:39], v[236:239]
    s_waitcnt lgkmcnt(2)
    v_mfma_f32_16x16x32_bf16 v[208:211], v[104:107], v[40:43], v[208:211]
    ds_read_b128 v[32:35], v3 offset:12288
    ds_read_b128 v[36:39], v3 offset:30720
    v_mfma_f32_16x16x32_bf16 v[212:215], v[176:179], v[40:43], v[212:215]
    v_mfma_f32_16x16x32_bf16 v[216:219], v[104:107], v[44:47], v[216:219]
    s_add_u32 m0, s23, 4800
    s_nop 0
    buffer_load_dwordx4 v2, s[8:11], s24 offen offset:320 lds
    v_mfma_f32_16x16x32_bf16 v[220:223], v[176:179], v[44:47], v[220:223]
    v_mfma_f32_16x16x32_bf16 v[224:227], a[40:43], v[40:43], v[224:227]
    v_mfma_f32_16x16x32_bf16 v[228:231], a[112:115], v[40:43], v[228:231]
    v_mfma_f32_16x16x32_bf16 v[232:235], a[40:43], v[44:47], v[232:235]
    v_mfma_f32_16x16x32_bf16 v[236:239], a[112:115], v[44:47], v[236:239]
    s_waitcnt lgkmcnt(2)
    v_mfma_f32_16x16x32_bf16 v[208:211], v[108:111], v[48:51], v[208:211]
    ds_read_b128 v[40:43], v3 offset:13312
    ds_read_b128 v[44:47], v3 offset:31744
    v_mfma_f32_16x16x32_bf16 v[212:215], v[180:183], v[48:51], v[212:215]
    v_mfma_f32_16x16x32_bf16 v[216:219], v[108:111], v[52:55], v[216:219]
    s_add_u32 m0, s23, 5760
    s_nop 0
    buffer_load_dwordx4 v2, s[8:11], s24 offen offset:384 lds
    v_mfma_f32_16x16x32_bf16 v[220:223], v[180:183], v[52:55], v[220:223]
    v_mfma_f32_16x16x32_bf16 v[224:227], a[44:47], v[48:51], v[224:227]
    v_mfma_f32_16x16x32_bf16 v[228:231], a[116:119], v[48:51], v[228:231]
    v_mfma_f32_16x16x32_bf16 v[232:235], a[44:47], v[52:55], v[232:235]
    v_mfma_f32_16x16x32_bf16 v[236:239], a[116:119], v[52:55], v[236:239]
    s_waitcnt lgkmcnt(2)
    v_mfma_f32_16x16x32_bf16 v[208:211], v[112:115], v[32:35], v[208:211]
    ds_read_b128 v[48:51], v3 offset:14336
    ds_read_b128 v[52:55], v3 offset:32768
    v_mfma_f32_16x16x32_bf16 v[212:215], v[184:187], v[32:35], v[212:215]
    v_mfma_f32_16x16x32_bf16 v[216:219], v[112:115], v[36:39], v[216:219]
    s_add_u32 m0, s23, 6720
    s_nop 0
    buffer_load_dwordx4 v2, s[8:11], s24 offen offset:448 lds
    v_mfma_f32_16x16x32_bf16 v[220:223], v[184:187], v[36:39], v[220:223]
    v_mfma_f32_16x16x32_bf16 v[224:227], a[48:51], v[32:35], v[224:227]
    v_mfma_f32_16x16x32_bf16 v[228:231], a[120:123], v[32:35], v[228:231]
    v_mfma_f32_16x16x32_bf16 v[232:235], a[48:51], v[36:39], v[232:235]
    v_mfma_f32_16x16x32_bf16 v[236:239], a[120:123], v[36:39], v[236:239]
    s_waitcnt lgkmcnt(2)
    v_mfma_f32_16x16x32_bf16 v[208:211], v[116:119], v[40:43], v[208:211]
    ds_read_b128 v[32:35], v3 offset:15360
    ds_read_b128 v[36:39], v3 offset:33792
    v_mfma_f32_16x16x32_bf16 v[212:215], v[188:191], v[40:43], v[212:215]
    v_mfma_f32_16x16x32_bf16 v[216:219], v[116:119], v[44:47], v[216:219]
    s_add_u32 m0, s23, 7680
    s_nop 0
    buffer_load_dwordx4 v2, s[8:11], s24 offen offset:512 lds
    s_add_u32 s24, s24, s42
    v_mfma_f32_16x16x32_bf16 v[220:223], v[188:191], v[44:47], v[220:223]
    v_mfma_f32_16x16x32_bf16 v[224:227], a[52:55], v[40:43], v[224:227]
    v_mfma_f32_16x16x32_bf16 v[228:231], a[124:127], v[40:43], v[228:231]
    v_mfma_f32_16x16x32_bf16 v[232:235], a[52:55], v[44:47], v[232:235]
    v_mfma_f32_16x16x32_bf16 v[236:239], a[124:127], v[44:47], v[236:239]
    s_waitcnt lgkmcnt(2)
    v_mfma_f32_16x16x32_bf16 v[208:211], v[120:123], v[48:51], v[208:211]
    ds_read_b128 v[40:43], v3 offset:16384
    ds_read_b128 v[44:47], v3 offset:34816
    v_mfma_f32_16x16x32_bf16 v[212:215], v[192:195], v[48:51], v[212:215]
    v_mfma_f32_16x16x32_bf16 v[216:219], v[120:123], v[52:55], v[216:219]
    v_add_u32 v24, s27, v1
    v_mfma_f32_16x16x32_bf16 v[220:223], v[192:195], v[52:55], v[220:223]
    v_mfma_f32_16x16x32_bf16 v[224:227], a[56:59], v[48:51], v[224:227]
    v_mfma_f32_16x16x32_bf16 v[228:231], a[128:131], v[48:51], v[228:231]
    v_mfma_f32_16x16x32_bf16 v[232:235], a[56:59], v[52:55], v[232:235]
    v_mfma_f32_16x16x32_bf16 v[236:239], a[128:131], v[52:55], v[236:239]
    s_waitcnt lgkmcnt(2)
    v_mfma_f32_16x16x32_bf16 v[208:211], v[124:127], v[32:35], v[208:211]
    ds_read_b128 v[48:51], v3 offset:17408
    ds_read_b128 v[52:55], v3 offset:35840
    v_mfma_f32_16x16x32_bf16 v[212:215], v[196:199], v[32:35], v[212:215]
    v_mfma_f32_16x16x32_bf16 v[216:219], v[124:127], v[36:39], v[216:219]
    v_mfma_f32_16x16x32_bf16 v[220:223], v[196:199], v[36:39], v[220:223]
    v_mfma_f32_16x16x32_bf16 v[224:227], a[60:63], v[32:35], v[224:227]
    v_mfma_f32_16x16x32_bf16 v[228:231], a[132:135], v[32:35], v[228:231]
    s_waitcnt vmcnt(9)
    s_barrier
    v_mfma_f32_16x16x32_bf16 v[232:235], a[60:63], v[36:39], v[232:235]
    v_mfma_f32_16x16x32_bf16 v[236:239], a[132:135], v[36:39], v[236:239]
    s_waitcnt lgkmcnt(2)
    v_mfma_f32_16x16x32_bf16 v[208:211], v[128:131], v[40:43], v[208:211]
    ds_read_b128 v[32:35], v24 offset:0
    ds_read_b128 v[36:39], v24 offset:18432
    v_mfma_f32_16x16x32_bf16 v[212:215], v[200:203], v[40:43], v[212:215]
    v_mfma_f32_16x16x32_bf16 v[216:219], v[128:131], v[44:47], v[216:219]
    v_mov_b32 v4, s30
    s_mov_b64 exec, s[34:35]
    buffer_store_dword v4, off, s[4:7], s29 sc1
    s_mov_b64 exec, -1
    v_mfma_f32_16x16x32_bf16 v[220:223], v[200:203], v[44:47], v[220:223]
    v_mfma_f32_16x16x32_bf16 v[224:227], a[64:67], v[40:43], v[224:227]
    v_mfma_f32_16x16x32_bf16 v[228:231], a[136:139], v[40:43], v[228:231]
    v_mfma_f32_16x16x32_bf16 v[232:235], a[64:67], v[44:47], v[232:235]
    v_mfma_f32_16x16x32_bf16 v[236:239], a[136:139], v[44:47], v[236:239]
    s_waitcnt lgkmcnt(2)
    v_mfma_f32_16x16x32_bf16 v[208:211], v[132:135], v[48:51], v[208:211]
    ds_read_b128 v[40:43], v24 offset:1024
    ds_read_b128 v[44:47], v24 offset:19456
    v_mfma_f32_16x16x32_bf16 v[212:215], v[204:207], v[48:51], v[212:215]
    v_mfma_f32_16x16x32_bf16 v[216:219], v[132:135], v[52:55], v[216:219]
    v_mfma_f32_16x16x32_bf16 v[220:223], v[204:207], v[52:55], v[220:223]
    v_mfma_f32_16x16x32_bf16 v[224:227], a[68:71], v[48:51], v[224:227]
    v_mfma_f32_16x16x32_bf16 v[228:231], a[140:143], v[48:51], v[228:231]
    v_mfma_f32_16x16x32_bf16 v[232:235], a[68:71], v[52:55], v[232:235]
    v_mfma_f32_16x16x32_bf16 v[236:239], a[140:143], v[52:55], v[236:239]
    v_mov_b32 v3, v24
    s_mov_b32 s31, s26
    s_add_u32 s26, s26, s41
    s_add_u32 s30, s30, 1
    s_add_u32 s19, s19, s20
    s_cmp_lt_u32 s19, 64
    s_cbranch_scc1 qk_loop
    v_cvt_pk_bf16_f32 v8, v208, v209
    v_cvt_pk_bf16_f32 v9, v210, v211
    v_cvt_pk_bf16_f32 v10, v212, v213
    v_cvt_pk_bf16_f32 v11, v214, v215
    v_cvt_pk_bf16_f32 v12, v216, v217
    v_cvt_pk_bf16_f32 v13, v218, v219
    v_cvt_pk_bf16_f32 v14, v220, v221
    v_cvt_pk_bf16_f32 v15, v222, v223
    v_cvt_pk_bf16_f32 v16, v224, v225
    v_cvt_pk_bf16_f32 v17, v226, v227
    v_cvt_pk_bf16_f32 v18, v228, v229
    v_cvt_pk_bf16_f32 v19, v230, v231
    v_cvt_pk_bf16_f32 v20, v232, v233
    v_cvt_pk_bf16_f32 v21, v234, v235
    v_cvt_pk_bf16_f32 v22, v236, v237
    v_cvt_pk_bf16_f32 v23, v238, v239
    s_branch qk_done
    s_nop 0
qk_vloop:
    s_add_u32 s22, s27, 73728
    s_sub_u32 s21, s22, 147456
    s_cselect_b32 s22, s22, s21
    s_add_u32 s27, s27, 36864
    s_cmp_eq_u32 s27, 147456
    s_cselect_b32 s27, 0, s27
    s_waitcnt lgkmcnt(2)
    v_cvt_pk_bf16_f32 v8, v208, v209
    v_cvt_pk_bf16_f32 v9, v210, v211
    v_mfma_f32_16x16x32_bf16 v[208:211], v[32:35], v[64:67], 0
    ds_read_b128 v[48:51], v3 offset:2048
    ds_read_b128 v[52:55], v3 offset:20480
    v_cvt_pk_bf16_f32 v12, v212, v213
    v_cvt_pk_bf16_f32 v13, v214, v215
    v_mfma_f32_16x16x32_bf16 v[212:215], v[32:35], v[136:139], 0
    v_cvt_pk_bf16_f32 v10, v216, v217
    v_cvt_pk_bf16_f32 v11, v218, v219
    v_mfma_f32_16x16x32_bf16 v[216:219], v[36:39], v[64:67], 0
    v_cvt_pk_bf16_f32 v14, v220, v221
    v_cvt_pk_bf16_f32 v15, v222, v223
    v_mfma_f32_16x16x32_bf16 v[220:223], v[36:39], v[136:139], 0
    v_cvt_pk_bf16_f32 v16, v224, v225
    v_cvt_pk_bf16_f32 v17, v226, v227
    v_mfma_f32_16x16x32_bf16 v[224:227], v[32:35], a[0:3], 0
    v_cvt_pk_bf16_f32 v20, v228, v229
    v_cvt_pk_bf16_f32 v21, v230, v231
    v_mfma_f32_16x16x32_bf16 v[228:231], v[32:35], a[72:75], 0
    v_cvt_pk_bf16_f32 v18, v232, v233
    v_cvt_pk_bf16_f32 v19, v234, v235
    v_mfma_f32_16x16x32_bf16 v[232:235], v[36:39], a[0:3], 0
    v_cvt_pk_bf16_f32 v22, v236, v237
    v_cvt_pk_bf16_f32 v23, v238, v239
    v_mfma_f32_16x16x32_bf16 v[236:239], v[36:39], a[72:75], 0
    s_waitcnt lgkmcnt(2)
    v_mfma_f32_16x16x32_bf16 v[208:211], v[40:43], v[68:71], v[208:211]
    ds_read_b128 v[32:35], v3 offset:3072
    ds_read_b128 v[36:39], v3 offset:21504
    v_mfma_f32_16x16x32_bf16 v[212:215], v[40:43], v[140:143], v[212:215]
    v_mfma_f32_16x16x32_bf16 v[216:219], v[44:47], v[68:71], v[216:219]
    s_mov_b32 s28, s31
    buffer_store_dwordx4 v[8:11], v7, s[4:7], s28 offen sc1
    v_mfma_f32_16x16x32_bf16 v[220:223], v[44:47], v[140:143], v[220:223]
    v_mfma_f32_16x16x32_bf16 v[224:227], v[40:43], a[4:7], v[224:227]
    v_mfma_f32_16x16x32_bf16 v[228:231], v[40:43], a[76:79], v[228:231]
    v_mfma_f32_16x16x32_bf16 v[232:235], v[44:47], a[4:7], v[232:235]
    v_mfma_f32_16x16x32_bf16 v[236:239], v[44:47], a[76:79], v[236:239]
    s_waitcnt lgkmcnt(2)
    v_mfma_f32_16x16x32_bf16 v[208:211], v[48:51], v[72:75], v[208:211]
    ds_read_b128 v[40:43], v3 offset:4096
    ds_read_b128 v[44:47], v3 offset:22528
    v_mfma_f32_16x16x32_bf16 v[212:215], v[48:51], v[144:147], v[212:215]
    v_mfma_f32_16x16x32_bf16 v[216:219], v[52:55], v[72:75], v[216:219]
    s_add_u32 s28, s28, s40
    buffer_store_dwordx4 v[12:15], v7, s[4:7], s28 offen sc1
    v_mfma_f32_16x16x32_bf16 v[220:223], v[52:55], v[144:147], v[220:223]
    v_mfma_f32_16x16x32_bf16 v[224:227], v[48:51], a[8:11], v[224:227]
    v_mfma_f32_16x16x32_bf16 v[228:231], v[48:51], a[80:83], v[228:231]
    v_mfma_f32_16x16x32_bf16 v[232:235], v[52:55], a[8:11], v[232:235]
    v_mfma_f32_16x16x32_bf16 v[236:239], v[52:55], a[80:83], v[236:239]
    s_waitcnt lgkmcnt(2)
    v_mfma_f32_16x16x32_bf16 v[208:211], v[32:35], v[76:79], v[208:211]
    ds_read_b128 v[48:51], v3 offset:5120
    ds_read_b128 v[52:55], v3 offset:23552
    v_mfma_f32_16x16x32_bf16 v[212:215], v[32:35], v[148:151], v[212:215]
    v_mfma_f32_16x16x32_bf16 v[216:219], v[36:39], v[76:79], v[216:219]
    s_add_u32 s28, s31, s43
    buffer_store_dwordx4 v[16:19], v7, s[4:7], s28 offen sc1
    v_mfma_f32_16x16x32_bf16 v[220:223], v[36:39], v[148:151], v[220:223]
    v_mfma_f32_16x16x32_bf16 v[224:227], v[32:35], a[12:15], v[224:227]
    v_mfma_f32_16x16x32_bf16 v[228:231], v[32:35], a[84:87], v[228:231]
    v_mfma_f32_16x16x32_bf16 v[232:235], v[36:39], a[12:15], v[232:235]
    v_mfma_f32_16x16x32_bf16 v[236:239], v[36:39], a[84:87], v[236:239]
    s_waitcnt lgkmcnt(2)
    v_mfma_f32_16x16x32_bf16 v[208:211], v[40:43], v[80:83], v[208:211]
    ds_read_b128 v[32:35], v3 offset:6144
    ds_read_b128 v[36:39], v3 offset:24576
    v_mfma_f32_16x16x32_bf16 v[212:215], v[40:43], v[152:155], v[212:215]
    v_mfma_f32_16x16x32_bf16 v[216:219], v[44:47], v[80:83], v[216:219]
    s_add_u32 s28, s28, s40
    buffer_store_dwordx4 v[20:23], v7, s[4:7], s28 offen sc1
    v_mfma_f32_16x16x32_bf16 v[220:223], v[44:47], v[152:155], v[220:223]
    v_mfma_f32_16x16x32_bf16 v[224:227], v[40:43], a[16:19], v[224:227]
    v_mfma_f32_16x16x32_bf16 v[228:231], v[40:43], a[88:91], v[228:231]
    v_mfma_f32_16x16x32_bf16 v[232:235], v[44:47], a[16:19], v[232:235]
    v_mfma_f32_16x16x32_bf16 v[236:239], v[44:47], a[88:91], v[236:239]
    s_waitcnt lgkmcnt(2)
    v_mfma_f32_16x16x32_bf16 v[208:211], v[48:51], v[84:87], v[208:211]
    ds_read_b128 v[40:43], v3 offset:7168
    ds_read_b128 v[44:47], v3 offset:25600
    v_mfma_f32_16x16x32_bf16 v[212:215], v[48:51], v[156:159], v[212:215]
    v_mfma_f32_16x16x32_bf16 v[216:219], v[52:55], v[84:87], v[216:219]
    s_add_u32 s23, s22, s25
    s_add_u32 m0, s23, 0
    s_nop 0
    buffer_load_dwordx4 v2, s[8:11], s24 offen offset:0 lds
    v_mfma_f32_16x16x32_bf16 v[220:223], v[52:55], v[156:159], v[220:223]
    v_mfma_f32_16x16x32_bf16 v[224:227], v[48:51], a[20:23], v[224:227]
    v_mfma_f32_16x16x32_bf16 v[228:231], v[48:51], a[92:95], v[228:231]
    v_mfma_f32_16x16x32_bf16 v[232:235], v[52:55], a[20:23], v[232:235]
    v_mfma_f32_16x16x32_bf16 v[236:239], v[52:55], a[92:95], v[236:239]
    s_waitcnt lgkmcnt(2)
    v_mfma_f32_16x16x32_bf16 v[208:211], v[32:35], v[88:91], v[208:211]
    ds_read_b128 v[48:51], v3 offset:8192
    ds_read_b128 v[52:55], v3 offset:26624
    v_mfma_f32_16x16x32_bf16 v[212:215], v[32:35], v[160:163], v[212:215]
    v_mfma_f32_16x16x32_bf16 v[216:219], v[36:39], v[88:91], v[216:219]
    s_add_u32 m0, s23, 960
    s_nop 0
    buffer_load_dwordx4 v2, s[8:11], s24 offen offset:64 lds
    v_mfma_f32_16x16x32_bf16 v[220:223], v[36:39], v[160:163], v[220:223]
    v_mfma_f32_16x16x32_bf16 v[224:227], v[32:35], a[24:27], v[224:227]
    v_mfma_f32_16x16x32_bf16 v[228:231], v[32:35], a[96:99], v[228:231]
    v_mfma_f32_16x16x32_bf16 v[232:235], v[36:39], a[24:27], v[232:235]
    v_mfma_f32_16x16x32_bf16 v[236:239], v[36:39], a[96:99], v[236:239]
    s_waitcnt lgkmcnt(2)
    v_mfma_f32_16x16x32_bf16 v[208:211], v[40:43], v[92:95], v[208:211]
    ds_read_b128 v[32:35], v3 offset:9216
    ds_read_b128 v[36:39], v3 offset:27648
    v_mfma_f32_16x16x32_bf16 v[212:215], v[40:43], v[164:167], v[212:215]
    v_mfma_f32_16x16x32_bf16 v[216:219], v[44:47], v[92:95], v[216:219]
    s_add_u32 m0, s23, 1920
    s_nop 0
    buffer_load_dwordx4 v2, s[8:11], s24 offen offset:128 lds
    v_mfma_f32_16x16x32_bf16 v[220:223], v[44:47], v[164:167], v[220:223]
    v_mfma_f32_16x16x32_bf16 v[224:227], v[40:43], a[28:31], v[224:227]
    v_mfma_f32_16x16x32_bf16 v[228:231], v[40:43], a[100:103], v[228:231]
    v_mfma_f32_16x16x32_bf16 v[232:235], v[44:47], a[28:31], v[232:235]
    v_mfma_f32_16x16x32_bf16 v[236:239], v[44:47], a[100:103], v[236:239]
    s_waitcnt lgkmcnt(2)
    v_mfma_f32_16x16x32_bf16 v[208:211], v[48:51], v[96:99], v[208:211]
    ds_read_b128 v[40:43], v3 offset:10240
    ds_read_b128 v[44:47], v3 offset:28672
    v_mfma_f32_16x16x32_bf16 v[212:215], v[48:51], v[168:171], v[212:215]
    v_mfma_f32_16x16x32_bf16 v[216:219], v[52:55], v[96:99], v[216:219]
    s_add_u32 m0, s23, 2880
    s_nop 0
    buffer_load_dwordx4 v2, s[8:11], s24 offen offset:192 lds
    v_mfma_f32_16x16x32_bf16 v[220:223], v[52:55], v[168:171], v[220:223]
    v_mfma_f32_16x16x32_bf16 v[224:227], v[48:51], a[32:35], v[224:227]
    v_mfma_f32_16x16x32_bf16 v[228:231], v[48:51], a[104:107], v[228:231]
    v_mfma_f32_16x16x32_bf16 v[232:235], v[52:55], a[32:35], v[232:235]
    v_mfma_f32_16x16x32_bf16 v[236:239], v[52:55], a[104:107], v[236:239]
    s_waitcnt lgkmcnt(2)
    v_mfma_f32_16x16x32_bf16 v[208:211], v[32:35], v[100:103], v[208:211]
    ds_read_b128 v[48:51], v3 offset:11264
    ds_read_b128 v[52:55], v3 offset:29696
    v_mfma_f32_16x16x32_bf16 v[212:215], v[32:35], v[172:175], v[212:215]
    v_mfma_f32_16x16x32_bf16 v[216:219], v[36:39], v[100:103], v[216:219]
    s_add_u32 m0, s23, 3840
    s_nop 0
    buffer_load_dwordx4 v2, s[8:11], s24 offen offset:256 lds
    v_mfma_f32_16x16x32_bf16 v[220:223], v[36:39], v[172:175], v[220:223]
    v_mfma_f32_16x16x32_bf16 v[224:227], v[32:35], a[36:39], v[224:227]
    v_mfma_f32_16x16x32_bf16 v[228:231], v[32:35], a[108:111], v[228:231]
    v_mfma_f32_16x16x32_bf16 v[232:235], v[36:39], a[36:39], v[232:235]
    v_mfma_f32_16x16x32_bf16 v[236:239], v[36:39], a[108:111], v[236:239]
    s_waitcnt lgkmcnt(2)
    v_mfma_f32_16x16x32_bf16 v[208:211], v[40:43], v[104:107], v[208:211]
    ds_read_b128 v[32:35], v3 offset:12288
    ds_read_b128 v[36:39], v3 offset:30720
    v_mfma_f32_16x16x32_bf16 v[212:215], v[40:43], v[176:179], v[212:215]
    v_mfma_f32_16x16x32_bf16 v[216:219], v[44:47], v[104:107], v[216:219]
    s_add_u32 m0, s23, 4800
    s_nop 0
    buffer_load_dwordx4 v2, s[8:11], s24 offen offset:320 lds
    v_mfma_f32_16x16x32_bf16 v[220:223], v[44:47], v[176:179], v[220:223]
    v_mfma_f32_16x16x32_bf16 v[224:227], v[40:43], a[40:43], v[224:227]
    v_mfma_f32_16x16x32_bf16 v[228:231], v[40:43], a[112:115], v[228:231]
    v_mfma_f32_16x16x32_bf16 v[232:235], v[44:47], a[40:43], v[232:235]
    v_mfma_f32_16x16x32_bf16 v[236:239], v[44:47], a[112:115], v[236:239]
    s_waitcnt lgkmcnt(2)
    v_mfma_f32_16x16x32_bf16 v[208:211], v[48:51], v[108:111], v[208:211]
    ds_read_b128 v[40:43], v3 offset:13312
    ds_read_b128 v[44:47], v3 offset:31744
    v_mfma_f32_16x16x32_bf16 v[212:215], v[48:51], v[180:183], v[212:215]
    v_mfma_f32_16x16x32_bf16 v[216:219], v[52:55], v[108:111], v[216:219]
    s_add_u32 m0, s23, 5760
    s_nop 0
    buffer_load_dwordx4 v2, s[8:11], s24 offen offset:384 lds
    v_mfma_f32_16x16x32_bf16 v[220:223], v[52:55], v[180:183], v[220:223]
    v_mfma_f32_16x16x32_bf16 v[224:227], v[48:51], a[44:47], v[224:227]
    v_mfma_f32_16x16x32_bf16 v[228:231], v[48:51], a[116:119], v[228:231]
    v_mfma_f32_16x16x32_bf16 v[232:235], v[52:55], a[44:47], v[232:235]
    v_mfma_f32_16x16x32_bf16 v[236:239], v[52:55], a[116:119], v[236:239]
    s_waitcnt lgkmcnt(2)
    v_mfma_f32_16x16x32_bf16 v[208:211], v[32:35], v[112:115], v[208:211]
    ds_read_b128 v[48:51], v3 offset:14336
    ds_read_b128 v[52:55], v3 offset:32768
    v_mfma_f32_16x16x32_bf16 v[212:215], v[32:35], v[184:187], v[212:215]
    v_mfma_f32_16x16x32_bf16 v[216:219], v[36:39], v[112:115], v[216:219]
    s_add_u32 m0, s23, 6720
    s_nop 0
    buffer_load_dwordx4 v2, s[8:11], s24 offen offset:448 lds
    v_mfma_f32_16x16x32_bf16 v[220:223], v[36:39], v[184:187], v[220:223]
    v_mfma_f32_16x16x32_bf16 v[224:227], v[32:35], a[48:51], v[224:227]
    v_mfma_f32_16x16x32_bf16 v[228:231], v[32:35], a[120:123], v[228:231]
    v_mfma_f32_16x16x32_bf16 v[232:235], v[36:39], a[48:51], v[232:235]
    v_mfma_f32_16x16x32_bf16 v[236:239], v[36:39], a[120:123], v[236:239]
    s_waitcnt lgkmcnt(2)
    v_mfma_f32_16x16x32_bf16 v[208:211], v[40:43], v[116:119], v[208:211]
    ds_read_b128 v[32:35], v3 offset:15360
    ds_read_b128 v[36:39], v3 offset:33792
    v_mfma_f32_16x16x32_bf16 v[212:215], v[40:43], v[188:191], v[212:215]
    v_mfma_f32_16x16x32_bf16 v[216:219], v[44:47], v[116:119], v[216:219]
    s_add_u32 m0, s23, 7680
    s_nop 0
    buffer_load_dwordx4 v2, s[8:11], s24 offen offset:512 lds
    s_add_u32 s24, s24, s42
    v_mfma_f32_16x16x32_bf16 v[220:223], v[44:47], v[188:191], v[220:223]
    v_mfma_f32_16x16x32_bf16 v[224:227], v[40:43], a[52:55], v[224:227]
    v_mfma_f32_16x16x32_bf16 v[228:231], v[40:43], a[124:127], v[228:231]
    v_mfma_f32_16x16x32_bf16 v[232:235], v[44:47], a[52:55], v[232:235]
    v_mfma_f32_16x16x32_bf16 v[236:239], v[44:47], a[124:127], v[236:239]
    s_waitcnt lgkmcnt(2)
    v_mfma_f32_16x16x32_bf16 v[208:211], v[48:51], v[120:123], v[208:211]
    ds_read_b128 v[40:43], v3 offset:16384
    ds_read_b128 v[44:47], v3 offset:34816
    v_mfma_f32_16x16x32_bf16 v[212:215], v[48:51], v[192:195], v[212:215]
    v_mfma_f32_16x16x32_bf16 v[216:219], v[52:55], v[120:123], v[216:219]
    v_add_u32 v24, s27, v1
    v_mfma_f32_16x16x32_bf16 v[220:223], v[52:55], v[192:195], v[220:223]
    v_mfma_f32_16x16x32_bf16 v[224:227], v[48:51], a[56:59], v[224:227]
    v_mfma_f32_16x16x32_bf16 v[228:231], v[48:51], a[128:131], v[228:231]
    v_mfma_f32_16x16x32_bf16 v[232:235], v[52:55], a[56:59], v[232:235]
    v_mfma_f32_16x16x32_bf16 v[236:239], v[52:55], a[128:131], v[236:239]
    s_waitcnt lgkmcnt(2)
    v_mfma_f32_16x16x32_bf16 v[208:211], v[32:35], v[124:127], v[208:211]
    ds_read_b128 v[48:51], v3 offset:17408
    ds_read_b128 v[52:55], v3 offset:35840
    v_mfma_f32_16x16x32_bf16 v[212:215], v[32:35], v[196:199], v[212:215]
    v_mfma_f32_16x16x32_bf16 v[216:219], v[36:39], v[124:127], v[216:219]
    v_mfma_f32_16x16x32_bf16 v[220:223], v[36:39], v[196:199], v[220:223]
    v_mfma_f32_16x16x32_bf16 v[224:227], v[32:35], a[60:63], v[224:227]
    v_mfma_f32_16x16x32_bf16 v[228:231], v[32:35], a[132:135], v[228:231]
    s_waitcnt vmcnt(9)
    s_barrier
    v_mfma_f32_16x16x32_bf16 v[232:235], v[36:39], a[60:63], v[232:235]
    v_mfma_f32_16x16x32_bf16 v[236:239], v[36:39], a[132:135], v[236:239]
    s_waitcnt lgkmcnt(2)
    v_mfma_f32_16x16x32_bf16 v[208:211], v[40:43], v[128:131], v[208:211]
    ds_read_b128 v[32:35], v24 offset:0
    ds_read_b128 v[36:39], v24 offset:18432
    v_mfma_f32_16x16x32_bf16 v[212:215], v[40:43], v[200:203], v[212:215]
    v_mfma_f32_16x16x32_bf16 v[216:219], v[44:47], v[128:131], v[216:219]
    v_mov_b32 v4, s30
    s_mov_b64 exec, s[34:35]
    buffer_store_dword v4, off, s[4:7], s29 sc1
    s_mov_b64 exec, -1
    v_mfma_f32_16x16x32_bf16 v[220:223], v[44:47], v[200:203], v[220:223]
    v_mfma_f32_16x16x32_bf16 v[224:227], v[40:43], a[64:67], v[224:227]
    v_mfma_f32_16x16x32_bf16 v[228:231], v[40:43], a[136:139], v[228:231]
    v_mfma_f32_16x16x32_bf16 v[232:235], v[44:47], a[64:67], v[232:235]
    v_mfma_f32_16x16x32_bf16 v[236:239], v[44:47], a[136:139], v[236:239]
    s_waitcnt lgkmcnt(2)
    v_mfma_f32_16x16x32_bf16 v[208:211], v[48:51], v[132:135], v[208:211]
    ds_read_b128 v[40:43], v24 offset:1024
    ds_read_b128 v[44:47], v24 offset:19456
    v_mfma_f32_16x16x32_bf16 v[212:215], v[48:51], v[204:207], v[212:215]
    v_mfma_f32_16x16x32_bf16 v[216:219], v[52:55], v[132:135], v[216:219]
    v_mfma_f32_16x16x32_bf16 v[220:223], v[52:55], v[204:207], v[220:223]
    v_mfma_f32_16x16x32_bf16 v[224:227], v[48:51], a[68:71], v[224:227]
    v_mfma_f32_16x16x32_bf16 v[228:231], v[48:51], a[140:143], v[228:231]
    v_mfma_f32_16x16x32_bf16 v[232:235], v[52:55], a[68:71], v[232:235]
    v_mfma_f32_16x16x32_bf16 v[236:239], v[52:55], a[140:143], v[236:239]
    v_mov_b32 v3, v24
    s_mov_b32 s31, s26
    s_add_u32 s26, s26, s41
    s_add_u32 s30, s30, 1
    s_add_u32 s19, s19, s20
    s_cmp_lt_u32 s19, 64
    s_cbranch_scc1 qk_vloop
    v_cvt_pk_bf16_f32 v8, v208, v209
    v_cvt_pk_bf16_f32 v9, v210, v211
    v_cvt_pk_bf16_f32 v12, v212, v213
    v_cvt_pk_bf16_f32 v13, v214, v215
    v_cvt_pk_bf16_f32 v10, v216, v217
    v_cvt_pk_bf16_f32 v11, v218, v219
    v_cvt_pk_bf16_f32 v14, v220, v221
    v_cvt_pk_bf16_f32 v15, v222, v223
    v_cvt_pk_bf16_f32 v16, v224, v225
    v_cvt_pk_bf16_f32 v17, v226, v227
    v_cvt_pk_bf16_f32 v20, v228, v229
    v_cvt_pk_bf16_f32 v21, v230, v231
    v_cvt_pk_bf16_f32 v18, v232, v233
    v_cvt_pk_bf16_f32 v19, v234, v235
    v_cvt_pk_bf16_f32 v22, v236, v237
    v_cvt_pk_bf16_f32 v23, v238, v239
qk_done:
    s_mov_b32 s28, s31
    buffer_store_dwordx4 v[8:11], v7, s[4:7], s28 offen sc1
    s_add_u32 s28, s28, s40
    buffer_store_dwordx4 v[12:15], v7, s[4:7], s28 offen sc1
    s_add_u32 s28, s31, s43
    buffer_store_dwordx4 v[16:19], v7, s[4:7], s28 offen sc1
    s_add_u32 s28, s28, s40
    buffer_store_dwordx4 v[20:23], v7, s[4:7], s28 offen sc1
    s_waitcnt vmcnt(0) lgkmcnt(0)
    s_barrier
    s_add_u32 s22, s95, 63
    v_mov_b32 v4, s22
    s_mov_b64 exec, s[34:35]
    buffer_store_dword v4, off, s[4:7], s29 sc1
    s_mov_b64 exec, -1
    s_cmp_eq_u32 s16, 0
    s_cbranch_scc1 qk_nq
    s_add_u32 s29, s29, 4096
    v_mov_b32 v4, s22
    s_mov_b64 exec, s[34:35]
    buffer_store_dword v4, off, s[4:7], s29 sc1
    s_mov_b64 exec, -1
qk_nq:
    s_cmp_ge_u32 s36, 64
    s_cbranch_scc1 L_qkv_next
    s_lshr_b32 s33, s36, 5
    v_and_b32 v4, 63, v0
    v_lshrrev_b32 v5, 4, v4
    v_add_u32 v1, 0, v5
    v_mul_u32_u24 v6, 11, v1
    v_lshrrev_b32 v6, 5, v6
    v_add_u32 v1, v1, v6
    v_lshlrev_b32 v1, 7, v1
    v_and_b32 v6, 7, v4
    v_lshl_add_u32 v1, v6, 4, v1
    v_add_u32 v2, 4, v5
    v_mul_u32_u24 v6, 11, v2
    v_lshrrev_b32 v6, 5, v6
    v_add_u32 v2, v2, v6
    v_lshlrev_b32 v2, 7, v2
    v_and_b32 v6, 7, v4
    v_lshl_add_u32 v2, v6, 4, v2
    v_add_u32 v3, 8, v5
    v_mul_u32_u24 v6, 11, v3
    v_lshrrev_b32 v6, 5, v6
    v_add_u32 v3, v3, v6
    v_lshlrev_b32 v3, 7, v3
    v_and_b32 v6, 7, v4
    v_lshl_add_u32 v3, v6, 4, v3
    v_min_u32 v6, 23, v4
    v_lshlrev_b32 v6, 9, v6
    s_mov_b32 s19, s33
    s_mul_i32 s24, s19, 12288
    s_add_u32 s24, s24, 90177536
    s_lshl_b32 s26, s19, 5
    s_add_u32 s26, s26, s17
    s_lshl_b32 s26, s26, 12
    s_mov_b32 s21, 71303168
    s_cmp_eq_u32 s16, 2
    s_cselect_b32 s21, 80740352, s21
    s_add_u32 s26, s26, s21
    s_lshl_b32 s29, s17, 7
    s_lshl_b32 s21, s16, 1
    s_add_u32 s21, s21, s33
    s_lshl_b32 s21, s21, 2
    s_add_u32 s29, s29, s21
    s_add_u32 s29, s29, 125829240
mk_loop:
    s_cmp_lg_u32 s18, 0
    s_cbranch_scc1 mk_go
    s_mov_b32 s23, s24
    s_mov_b32 s21, 4194304
mk_wait:
    buffer_load_dword v4, v6, s[4:7], s23 offen offset:384 sc1
    s_sub_u32 s21, s21, 1
    s_cbranch_scc1 mk_go
    s_waitcnt vmcnt(0)
    v_cmp_ne_u32 vcc, s95, v4
    s_cbranch_vccz mk_go
    s_sleep 4
    s_branch mk_wait
mk_go:
    s_barrier
    s_mov_b32 s30, 4096
mk_again:
    v_mov_b32 v5, 0
    s_add_u32 s23, s24, 0
    buffer_load_dwordx4 v[24:27], v1, s[4:7], s23 offen offset:0 sc1
    buffer_load_dwordx4 v[28:31], v2, s[4:7], s23 offen offset:0 sc1
    buffer_load_dwordx4 v[32:35], v3, s[4:7], s23 offen offset:0 sc1
    buffer_load_dwordx4 v[36:39], v1, s[4:7], s23 offen offset:2048 sc1
    buffer_load_dwordx4 v[40:43], v2, s[4:7], s23 offen offset:2048 sc1
    buffer_load_dwordx4 v[44:47], v3, s[4:7], s23 offen offset:2048 sc1
    s_add_u32 s23, s24, 4096
    buffer_load_dwordx4 v[48:51], v1, s[4:7], s23 offen offset:0 sc1
    buffer_load_dwordx4 v[52:55], v2, s[4:7], s23 offen offset:0 sc1
    buffer_load_dwordx4 v[56:59], v3, s[4:7], s23 offen offset:0 sc1
    buffer_load_dwordx4 v[60:63], v1, s[4:7], s23 offen offset:2048 sc1
    buffer_load_dwordx4 v[208:211], v2, s[4:7], s23 offen offset:2048 sc1
    buffer_load_dwordx4 v[212:215], v3, s[4:7], s23 offen offset:2048 sc1
    s_add_u32 s23, s24, 8192
    buffer_load_dwordx4 v[216:219], v1, s[4:7], s23 offen offset:0 sc1
    buffer_load_dwordx4 v[220:223], v2, s[4:7], s23 offen offset:0 sc1
    buffer_load_dwordx4 v[224:227], v3, s[4:7], s23 offen offset:0 sc1
    buffer_load_dwordx4 v[228:231], v1, s[4:7], s23 offen offset:2048 sc1
    buffer_load_dwordx4 v[232:235], v2, s[4:7], s23 offen offset:2048 sc1
    buffer_load_dwordx4 v[236:239], v3, s[4:7], s23 offen offset:2048 sc1
    s_add_u32 s22, s19, s95
    s_add_u32 s22, s22, 1
    s_cmp_eq_u32 s16, 2
    s_cbranch_scc1 mk_v
    s_waitcnt vmcnt(17)
    v_mfma_f32_16x16x32_bf16 v[8:11], v[64:67], v[24:27], 0
    v_mfma_f32_16x16x32_bf16 v[12:15], v[136:139], v[24:27], 0
    v_max3_u32 v5, v5, v24, v25
    v_mfma_f32_16x16x32_bf16 v[16:19], a[0:3], v[24:27], 0
    v_mfma_f32_16x16x32_bf16 v[20:23], a[72:75], v[24:27], 0
    v_max3_u32 v5, v5, v26, v27
    s_waitcnt vmcnt(16)
    v_mfma_f32_16x16x32_bf16 v[8:11], v[68:71], v[28:31], v[8:11]
    v_mfma_f32_16x16x32_bf16 v[12:15], v[140:143], v[28:31], v[12:15]
    v_max3_u32 v5, v5, v28, v29
    v_mfma_f32_16x16x32_bf16 v[16:19], a[4:7], v[28:31], v[16:19]
    v_mfma_f32_16x16x32_bf16 v[20:23], a[76:79], v[28:31], v[20:23]
    v_max3_u32 v5, v5, v30, v31
    s_waitcnt vmcnt(15)
    v_mfma_f32_16x16x32_bf16 v[8:11], v[72:75], v[32:35], v[8:11]
    v_mfma_f32_16x16x32_bf16 v[12:15], v[144:147], v[32:35], v[12:15]
    v_max3_u32 v5, v5, v32, v33
    v_mfma_f32_16x16x32_bf16 v[16:19], a[8:11], v[32:35], v[16:19]
    v_mfma_f32_16x16x32_bf16 v[20:23], a[80:83], v[32:35], v[20:23]
    v_max3_u32 v5, v5, v34, v35
    s_waitcnt vmcnt(14)
    v_mfma_f32_16x16x32_bf16 v[8:11], v[76:79], v[36:39], v[8:11]
    v_mfma_f32_16x16x32_bf16 v[12:15], v[148:151], v[36:39], v[12:15]
    v_max3_u32 v5, v5, v36, v37
    v_mfma_f32_16x16x32_bf16 v[16:19], a[12:15], v[36:39], v[16:19]
    v_mfma_f32_16x16x32_bf16 v[20:23], a[84:87], v[36:39], v[20:23]
    v_max3_u32 v5, v5, v38, v39
    s_waitcnt vmcnt(13)
    v_mfma_f32_16x16x32_bf16 v[8:11], v[80:83], v[40:43], v[8:11]
    v_mfma_f32_16x16x32_bf16 v[12:15], v[152:155], v[40:43], v[12:15]
    v_max3_u32 v5, v5, v40, v41
    v_mfma_f32_16x16x32_bf16 v[16:19], a[16:19], v[40:43], v[16:19]
    v_mfma_f32_16x16x32_bf16 v[20:23], a[88:91], v[40:43], v[20:23]
    v_max3_u32 v5, v5, v42, v43
    s_waitcnt vmcnt(12)
    v_mfma_f32_16x16x32_bf16 v[8:11], v[84:87], v[44:47], v[8:11]
    v_mfma_f32_16x16x32_bf16 v[12:15], v[156:159], v[44:47], v[12:15]
    v_max3_u32 v5, v5, v44, v45
    v_mfma_f32_16x16x32_bf16 v[16:19], a[20:23], v[44:47], v[16:19]
    v_mfma_f32_16x16x32_bf16 v[20:23], a[92:95], v[44:47], v[20:23]
    v_max3_u32 v5, v5, v46, v47
    s_waitcnt vmcnt(11)
    v_mfma_f32_16x16x32_bf16 v[8:11], v[88:91], v[48:51], v[8:11]
    v_mfma_f32_16x16x32_bf16 v[12:15], v[160:163], v[48:51], v[12:15]
    v_max3_u32 v5, v5, v48, v49
    v_mfma_f32_16x16x32_bf16 v[16:19], a[24:27], v[48:51], v[16:19]
    v_mfma_f32_16x16x32_bf16 v[20:23], a[96:99], v[48:51], v[20:23]
    v_max3_u32 v5, v5, v50, v51
    s_waitcnt vmcnt(10)
    v_mfma_f32_16x16x32_bf16 v[8:11], v[92:95], v[52:55], v[8:11]
    v_mfma_f32_16x16x32_bf16 v[12:15], v[164:167], v[52:55], v[12:15]
    v_max3_u32 v5, v5, v52, v53
    v_mfma_f32_16x16x32_bf16 v[16:19], a[28:31], v[52:55], v[16:19]
    v_mfma_f32_16x16x32_bf16 v[20:23], a[100:103], v[52:55], v[20:23]
    v_max3_u32 v5, v5, v54, v55
    s_waitcnt vmcnt(9)
    v_mfma_f32_16x16x32_bf16 v[8:11], v[96:99], v[56:59], v[8:11]
    v_mfma_f32_16x16x32_bf16 v[12:15], v[168:171], v[56:59], v[12:15]
    v_max3_u32 v5, v5, v56, v57
    v_mfma_f32_16x16x32_bf16 v[16:19], a[32:35], v[56:59], v[16:19]
    v_mfma_f32_16x16x32_bf16 v[20:23], a[104:107], v[56:59], v[20:23]
    v_max3_u32 v5, v5, v58, v59
    s_waitcnt vmcnt(8)
    v_mfma_f32_16x16x32_bf16 v[8:11], v[100:103], v[60:63], v[8:11]
    v_mfma_f32_16x16x32_bf16 v[12:15], v[172:175], v[60:63], v[12:15]
    v_max3_u32 v5, v5, v60, v61
    v_mfma_f32_16x16x32_bf16 v[16:19], a[36:39], v[60:63], v[16:19]
    v_mfma_f32_16x16x32_bf16 v[20:23], a[108:111], v[60:63], v[20:23]
    v_max3_u32 v5, v5, v62, v63
    s_waitcnt vmcnt(7)
    v_mfma_f32_16x16x32_bf16 v[8:11], v[104:107], v[208:211], v[8:11]
    v_mfma_f32_16x16x32_bf16 v[12:15], v[176:179], v[208:211], v[12:15]
    v_max3_u32 v5, v5, v208, v209
    v_mfma_f32_16x16x32_bf16 v[16:19], a[40:43], v[208:211], v[16:19]
    v_mfma_f32_16x16x32_bf16 v[20:23], a[112:115], v[208:211], v[20:23]
    v_max3_u32 v5, v5, v210, v211
    s_waitcnt vmcnt(6)
    v_mfma_f32_16x16x32_bf16 v[8:11], v[108:111], v[212:215], v[8:11]
    v_mfma_f32_16x16x32_bf16 v[12:15], v[180:183], v[212:215], v[12:15]
    v_max3_u32 v5, v5, v212, v213
    v_mfma_f32_16x16x32_bf16 v[16:19], a[44:47], v[212:215], v[16:19]
    v_mfma_f32_16x16x32_bf16 v[20:23], a[116:119], v[212:215], v[20:23]
    v_max3_u32 v5, v5, v214, v215
    s_waitcnt vmcnt(5)
    v_mfma_f32_16x16x32_bf16 v[8:11], v[112:115], v[216:219], v[8:11]
    v_mfma_f32_16x16x32_bf16 v[12:15], v[184:187], v[216:219], v[12:15]
    v_max3_u32 v5, v5, v216, v217
    v_mfma_f32_16x16x32_bf16 v[16:19], a[48:51], v[216:219], v[16:19]
    v_mfma_f32_16x16x32_bf16 v[20:23], a[120:123], v[216:219], v[20:23]
    v_max3_u32 v5, v5, v218, v219
    s_waitcnt vmcnt(4)
    v_mfma_f32_16x16x32_bf16 v[8:11], v[116:119], v[220:223], v[8:11]
    v_mfma_f32_16x16x32_bf16 v[12:15], v[188:191], v[220:223], v[12:15]
    v_max3_u32 v5, v5, v220, v221
    v_mfma_f32_16x16x32_bf16 v[16:19], a[52:55], v[220:223], v[16:19]
    v_mfma_f32_16x16x32_bf16 v[20:23], a[124:127], v[220:223], v[20:23]
    v_max3_u32 v5, v5, v222, v223
    s_waitcnt vmcnt(3)
    v_mfma_f32_16x16x32_bf16 v[8:11], v[120:123], v[224:227], v[8:11]
    v_mfma_f32_16x16x32_bf16 v[12:15], v[192:195], v[224:227], v[12:15]
    v_max3_u32 v5, v5, v224, v225
    v_mfma_f32_16x16x32_bf16 v[16:19], a[56:59], v[224:227], v[16:19]
    v_mfma_f32_16x16x32_bf16 v[20:23], a[128:131], v[224:227], v[20:23]
    v_max3_u32 v5, v5, v226, v227
    s_waitcnt vmcnt(2)
    v_mfma_f32_16x16x32_bf16 v[8:11], v[124:127], v[228:231], v[8:11]
    v_mfma_f32_16x16x32_bf16 v[12:15], v[196:199], v[228:231], v[12:15]
    v_max3_u32 v5, v5, v228, v229
    v_mfma_f32_16x16x32_bf16 v[16:19], a[60:63], v[228:231], v[16:19]
    v_mfma_f32_16x16x32_bf16 v[20:23], a[132:135], v[228:231], v[20:23]
    v_max3_u32 v5, v5, v230, v231
    s_waitcnt vmcnt(1)
    v_mfma_f32_16x16x32_bf16 v[8:11], v[128:131], v[232:235], v[8:11]
    v_mfma_f32_16x16x32_bf16 v[12:15], v[200:203], v[232:235], v[12:15]
    v_max3_u32 v5, v5, v232, v233
    v_mfma_f32_16x16x32_bf16 v[16:19], a[64:67], v[232:235], v[16:19]
    v_mfma_f32_16x16x32_bf16 v[20:23], a[136:139], v[232:235], v[20:23]
    v_max3_u32 v5, v5, v234, v235
    s_waitcnt vmcnt(0)
    v_mfma_f32_16x16x32_bf16 v[8:11], v[132:135], v[236:239], v[8:11]
    v_mfma_f32_16x16x32_bf16 v[12:15], v[204:207], v[236:239], v[12:15]
    v_max3_u32 v5, v5, v236, v237
    v_mfma_f32_16x16x32_bf16 v[16:19], a[68:71], v[236:239], v[16:19]
    v_mfma_f32_16x16x32_bf16 v[20:23], a[140:143], v[236:239], v[20:23]
    v_max3_u32 v5, v5, v238, v239
    s_nop 5
    s_branch mk_st
mk_v:
    s_waitcnt vmcnt(17)
    v_mfma_f32_16x16x32_bf16 v[8:11], v[24:27], v[64:67], 0
    v_mfma_f32_16x16x32_bf16 v[12:15], v[24:27], v[136:139], 0
    v_max3_u32 v5, v5, v24, v25
    v_mfma_f32_16x16x32_bf16 v[16:19], v[24:27], a[0:3], 0
    v_mfma_f32_16x16x32_bf16 v[20:23], v[24:27], a[72:75], 0
    v_max3_u32 v5, v5, v26, v27
    s_waitcnt vmcnt(16)
    v_mfma_f32_16x16x32_bf16 v[8:11], v[28:31], v[68:71], v[8:11]
    v_mfma_f32_16x16x32_bf16 v[12:15], v[28:31], v[140:143], v[12:15]
    v_max3_u32 v5, v5, v28, v29
    v_mfma_f32_16x16x32_bf16 v[16:19], v[28:31], a[4:7], v[16:19]
    v_mfma_f32_16x16x32_bf16 v[20:23], v[28:31], a[76:79], v[20:23]
    v_max3_u32 v5, v5, v30, v31
    s_waitcnt vmcnt(15)
    v_mfma_f32_16x16x32_bf16 v[8:11], v[32:35], v[72:75], v[8:11]
    v_mfma_f32_16x16x32_bf16 v[12:15], v[32:35], v[144:147], v[12:15]
    v_max3_u32 v5, v5, v32, v33
    v_mfma_f32_16x16x32_bf16 v[16:19], v[32:35], a[8:11], v[16:19]
    v_mfma_f32_16x16x32_bf16 v[20:23], v[32:35], a[80:83], v[20:23]
    v_max3_u32 v5, v5, v34, v35
    s_waitcnt vmcnt(14)
    v_mfma_f32_16x16x32_bf16 v[8:11], v[36:39], v[76:79], v[8:11]
    v_mfma_f32_16x16x32_bf16 v[12:15], v[36:39], v[148:151], v[12:15]
    v_max3_u32 v5, v5, v36, v37
    v_mfma_f32_16x16x32_bf16 v[16:19], v[36:39], a[12:15], v[16:19]
    v_mfma_f32_16x16x32_bf16 v[20:23], v[36:39], a[84:87], v[20:23]
    v_max3_u32 v5, v5, v38, v39
    s_waitcnt vmcnt(13)
    v_mfma_f32_16x16x32_bf16 v[8:11], v[40:43], v[80:83], v[8:11]
    v_mfma_f32_16x16x32_bf16 v[12:15], v[40:43], v[152:155], v[12:15]
    v_max3_u32 v5, v5, v40, v41
    v_mfma_f32_16x16x32_bf16 v[16:19], v[40:43], a[16:19], v[16:19]
    v_mfma_f32_16x16x32_bf16 v[20:23], v[40:43], a[88:91], v[20:23]
    v_max3_u32 v5, v5, v42, v43
    s_waitcnt vmcnt(12)
    v_mfma_f32_16x16x32_bf16 v[8:11], v[44:47], v[84:87], v[8:11]
    v_mfma_f32_16x16x32_bf16 v[12:15], v[44:47], v[156:159], v[12:15]
    v_max3_u32 v5, v5, v44, v45
    v_mfma_f32_16x16x32_bf16 v[16:19], v[44:47], a[20:23], v[16:19]
    v_mfma_f32_16x16x32_bf16 v[20:23], v[44:47], a[92:95], v[20:23]
    v_max3_u32 v5, v5, v46, v47
    s_waitcnt vmcnt(11)
    v_mfma_f32_16x16x32_bf16 v[8:11], v[48:51], v[88:91], v[8:11]
    v_mfma_f32_16x16x32_bf16 v[12:15], v[48:51], v[160:163], v[12:15]
    v_max3_u32 v5, v5, v48, v49
    v_mfma_f32_16x16x32_bf16 v[16:19], v[48:51], a[24:27], v[16:19]
    v_mfma_f32_16x16x32_bf16 v[20:23], v[48:51], a[96:99], v[20:23]
    v_max3_u32 v5, v5, v50, v51
    s_waitcnt vmcnt(10)
    v_mfma_f32_16x16x32_bf16 v[8:11], v[52:55], v[92:95], v[8:11]
    v_mfma_f32_16x16x32_bf16 v[12:15], v[52:55], v[164:167], v[12:15]
    v_max3_u32 v5, v5, v52, v53
    v_mfma_f32_16x16x32_bf16 v[16:19], v[52:55], a[28:31], v[16:19]
    v_mfma_f32_16x16x32_bf16 v[20:23], v[52:55], a[100:103], v[20:23]
    v_max3_u32 v5, v5, v54, v55
    s_waitcnt vmcnt(9)
    v_mfma_f32_16x16x32_bf16 v[8:11], v[56:59], v[96:99], v[8:11]
    v_mfma_f32_16x16x32_bf16 v[12:15], v[56:59], v[168:171], v[12:15]
    v_max3_u32 v5, v5, v56, v57
    v_mfma_f32_16x16x32_bf16 v[16:19], v[56:59], a[32:35], v[16:19]
    v_mfma_f32_16x16x32_bf16 v[20:23], v[56:59], a[104:107], v[20:23]
    v_max3_u32 v5, v5, v58, v59
    s_waitcnt vmcnt(8)
    v_mfma_f32_16x16x32_bf16 v[8:11], v[60:63], v[100:103], v[8:11]
    v_mfma_f32_16x16x32_bf16 v[12:15], v[60:63], v[172:175], v[12:15]
    v_max3_u32 v5, v5, v60, v61
    v_mfma_f32_16x16x32_bf16 v[16:19], v[60:63], a[36:39], v[16:19]
    v_mfma_f32_16x16x32_bf16 v[20:23], v[60:63], a[108:111], v[20:23]
    v_max3_u32 v5, v5, v62, v63
    s_waitcnt vmcnt(7)
    v_mfma_f32_16x16x32_bf16 v[8:11], v[208:211], v[104:107], v[8:11]
    v_mfma_f32_16x16x32_bf16 v[12:15], v[208:211], v[176:179], v[12:15]
    v_max3_u32 v5, v5, v208, v209
    v_mfma_f32_16x16x32_bf16 v[16:19], v[208:211], a[40:43], v[16:19]
    v_mfma_f32_16x16x32_bf16 v[20:23], v[208:211], a[112:115], v[20:23]
    v_max3_u32 v5, v5, v210, v211
    s_waitcnt vmcnt(6)
    v_mfma_f32_16x16x32_bf16 v[8:11], v[212:215], v[108:111], v[8:11]
    v_mfma_f32_16x16x32_bf16 v[12:15], v[212:215], v[180:183], v[12:15]
    v_max3_u32 v5, v5, v212, v213
    v_mfma_f32_16x16x32_bf16 v[16:19], v[212:215], a[44:47], v[16:19]
    v_mfma_f32_16x16x32_bf16 v[20:23], v[212:215], a[116:119], v[20:23]
    v_max3_u32 v5, v5, v214, v215
    s_waitcnt vmcnt(5)
    v_mfma_f32_16x16x32_bf16 v[8:11], v[216:219], v[112:115], v[8:11]
    v_mfma_f32_16x16x32_bf16 v[12:15], v[216:219], v[184:187], v[12:15]
    v_max3_u32 v5, v5, v216, v217
    v_mfma_f32_16x16x32_bf16 v[16:19], v[216:219], a[48:51], v[16:19]
    v_mfma_f32_16x16x32_bf16 v[20:23], v[216:219], a[120:123], v[20:23]
    v_max3_u32 v5, v5, v218, v219
    s_waitcnt vmcnt(4)
    v_mfma_f32_16x16x32_bf16 v[8:11], v[220:223], v[116:119], v[8:11]
    v_mfma_f32_16x16x32_bf16 v[12:15], v[220:223], v[188:191], v[12:15]
    v_max3_u32 v5, v5, v220, v221
    v_mfma_f32_16x16x32_bf16 v[16:19], v[220:223], a[52:55], v[16:19]
    v_mfma_f32_16x16x32_bf16 v[20:23], v[220:223], a[124:127], v[20:23]
    v_max3_u32 v5, v5, v222, v223
    s_waitcnt vmcnt(3)
    v_mfma_f32_16x16x32_bf16 v[8:11], v[224:227], v[120:123], v[8:11]
    v_mfma_f32_16x16x32_bf16 v[12:15], v[224:227], v[192:195], v[12:15]
    v_max3_u32 v5, v5, v224, v225
    v_mfma_f32_16x16x32_bf16 v[16:19], v[224:227], a[56:59], v[16:19]
    v_mfma_f32_16x16x32_bf16 v[20:23], v[224:227], a[128:131], v[20:23]
    v_max3_u32 v5, v5, v226, v227
    s_waitcnt vmcnt(2)
    v_mfma_f32_16x16x32_bf16 v[8:11], v[228:231], v[124:127], v[8:11]
    v_mfma_f32_16x16x32_bf16 v[12:15], v[228:231], v[196:199], v[12:15]
    v_max3_u32 v5, v5, v228, v229
    v_mfma_f32_16x16x32_bf16 v[16:19], v[228:231], a[60:63], v[16:19]
    v_mfma_f32_16x16x32_bf16 v[20:23], v[228:231], a[132:135], v[20:23]
    v_max3_u32 v5, v5, v230, v231
    s_waitcnt vmcnt(1)
    v_mfma_f32_16x16x32_bf16 v[8:11], v[232:235], v[128:131], v[8:11]
    v_mfma_f32_16x16x32_bf16 v[12:15], v[232:235], v[200:203], v[12:15]
    v_max3_u32 v5, v5, v232, v233
    v_mfma_f32_16x16x32_bf16 v[16:19], v[232:235], a[64:67], v[16:19]
    v_mfma_f32_16x16x32_bf16 v[20:23], v[232:235], a[136:139], v[20:23]
    v_max3_u32 v5, v5, v234, v235
    s_waitcnt vmcnt(0)
    v_mfma_f32_16x16x32_bf16 v[8:11], v[236:239], v[132:135], v[8:11]
    v_mfma_f32_16x16x32_bf16 v[12:15], v[236:239], v[204:207], v[12:15]
    v_max3_u32 v5, v5, v236, v237
    v_mfma_f32_16x16x32_bf16 v[16:19], v[236:239], a[68:71], v[16:19]
    v_mfma_f32_16x16x32_bf16 v[20:23], v[236:239], a[140:143], v[20:23]
    v_max3_u32 v5, v5, v238, v239
    v_pk_mul_f32 v[8:9], v[8:9], 0.5 op_sel_hi:[1,0]
    v_pk_mul_f32 v[10:11], v[10:11], 0.5 op_sel_hi:[1,0]
    v_pk_mul_f32 v[12:13], v[12:13], 0.5 op_sel_hi:[1,0]
    v_pk_mul_f32 v[14:15], v[14:15], 0.5 op_sel_hi:[1,0]
    v_pk_mul_f32 v[16:17], v[16:17], 0.5 op_sel_hi:[1,0]
    v_pk_mul_f32 v[18:19], v[18:19], 0.5 op_sel_hi:[1,0]
    v_pk_mul_f32 v[20:21], v[20:21], 0.5 op_sel_hi:[1,0]
    v_pk_mul_f32 v[22:23], v[22:23], 0.5 op_sel_hi:[1,0]
    s_nop 1
mk_st:
    v_cmp_eq_u32 vcc, -1, v5
    s_sub_u32 s30, s30, 1
    s_cbranch_scc1 mk_ok
    s_cbranch_vccnz mk_again
mk_ok:
    s_add_u32 s24, s24, 24576
    v_cvt_pk_bf16_f32 v24, v8, v9
    v_cvt_pk_bf16_f32 v25, v10, v11
    v_cvt_pk_bf16_f32 v26, v12, v13
    v_cvt_pk_bf16_f32 v27, v14, v15
    v_cvt_pk_bf16_f32 v28, v16, v17
    v_cvt_pk_bf16_f32 v29, v18, v19
    v_cvt_pk_bf16_f32 v30, v20, v21
    v_cvt_pk_bf16_f32 v31, v22, v23
    s_add_u32 s21, s26, 4096
    buffer_store_dwordx4 v[24:27], v7, s[4:7], s26 offen sc1
    buffer_store_dwordx4 v[28:31], v7, s[4:7], s21 offen sc1
    s_waitcnt vmcnt(0)
    s_barrier
    v_mov_b32 v4, s22
    s_mov_b64 exec, s[34:35]
    buffer_store_dword v4, off, s[4:7], s29 sc1
    s_mov_b64 exec, -1
    s_add_u32 s19, s19, 2
    s_add_u32 s26, s26, 262144
    s_cmp_lt_u32 s19, 62
    s_cbranch_scc1 mk_loop
    s_endpgm
L_ssm_next:
    s_mov_b32 s37, 8
    v_mov_b32 v250, 1
    v_mov_b32 v251, 163832
    v_cmp_eq_u32 vcc, 0, v0
    s_nop 0
    s_and_saveexec_b64 s[38:39], vcc
    s_cbranch_execz tk8
    buffer_atomic_add v250, off, s[96:99], s37 sc0
    s_waitcnt vmcnt(0)
    ds_write_b32 v251, v250
    s_waitcnt lgkmcnt(0)
tk8:
    s_mov_b64 exec, -1
    s_barrier
    ds_read_b32 v252, v251
    s_waitcnt lgkmcnt(0)
    v_readfirstlane_b32 s20, v252
    s_barrier
    s_nop 3
    s_cmp_ge_u32 s20, 144
    s_cbranch_scc1 L_phase2
    s_lshl_b32 s20, s20, 2
    v_lshrrev_b32 v5, 6, v0
    s_nop 0
    v_readfirstlane_b32 s21, v5
    v_and_b32 v1, 63, v0
    v_and_b32 v2, 15, v1
    v_lshrrev_b32 v3, 4, v1
    v_lshlrev_b32 v4, 14, v5
    s_mov_b32 s8, s62
    s_mov_b32 s9, s63
    s_mov_b32 s10, 2359296
    s_mov_b32 s11, 0x20000
    s_mov_b32 s16, s76
    s_mov_b32 s17, s77
    s_mov_b32 s18, 4718592
    s_mov_b32 s19, 0x20000
    v_mul_u32_u24 v5, 9216, v0
    s_lshl_b32 s22, s20, 1
    s_add_u32 s23, s22, 0
    buffer_load_dwordx2 v[8:9], v5, s[8:11], s23 offen
    s_add_u32 s23, s22, 1152
    buffer_load_dwordx2 v[10:11], v5, s[8:11], s23 offen
    s_add_u32 s23, s22, 2304
    buffer_load_dwordx2 v[12:13], v5, s[8:11], s23 offen
    s_add_u32 s23, s22, 3456
    buffer_load_dwordx2 v[14:15], v5, s[8:11], s23 offen
    s_add_u32 s23, s22, 4608
    buffer_load_dwordx2 v[16:17], v5, s[8:11], s23 offen
    s_add_u32 s23, s22, 5760
    buffer_load_dwordx2 v[18:19], v5, s[8:11], s23 offen
    s_add_u32 s23, s22, 6912
    buffer_load_dwordx2 v[20:21], v5, s[8:11], s23 offen
    s_add_u32 s23, s22, 8064
    buffer_load_dwordx2 v[22:23], v5, s[8:11], s23 offen
    s_add_u32 s22, s20, s21
    s_lshl_b32 s23, s22, 8
    v_lshlrev_b32 v6, 3, v2
    v_lshl_add_u32 v6, v3, 1, v6
    s_mov_b32 s12, s64
    s_mov_b32 s13, s65
    s_mov_b32 s14, 147456
    s_mov_b32 s15, 0x20000
    buffer_load_ushort v24, v6, s[12:15], s23 offen offset:0
    buffer_load_ushort v28, v6, s[12:15], s23 offen offset:128
    s_mov_b32 s12, s66
    s_mov_b32 s13, s67
    s_mov_b32 s14, 147456
    s_mov_b32 s15, 0x20000
    buffer_load_ushort v25, v6, s[12:15], s23 offen offset:0
    buffer_load_ushort v29, v6, s[12:15], s23 offen offset:128
    s_mov_b32 s12, s68
    s_mov_b32 s13, s69
    s_mov_b32 s14, 147456
    s_mov_b32 s15, 0x20000
    buffer_load_ushort v26, v6, s[12:15], s23 offen offset:0
    buffer_load_ushort v30, v6, s[12:15], s23 offen offset:128
    s_mov_b32 s12, s70
    s_mov_b32 s13, s71
    s_mov_b32 s14, 147456
    s_mov_b32 s15, 0x20000
    buffer_load_ushort v27, v6, s[12:15], s23 offen offset:0
    buffer_load_ushort v31, v6, s[12:15], s23 offen offset:128
    s_mov_b32 s12, s72
    s_mov_b32 s13, s73
    s_mov_b32 s14, 1152
    s_mov_b32 s15, 0x20000
    s_lshl_b32 s23, s22, 1
    buffer_load_ushort v32, off, s[12:15], s23
    s_mov_b32 s26, 0x3fb8aa3b
    s_mov_b32 s27, 0x3e22f983
    v_mov_b32 v34, 0
    v_mov_b32 v35, 0
    v_lshl_add_u32 v6, v1, 3, v4
    ds_write_b64 v6, v[34:35] offset:0
    s_waitcnt vmcnt(0)
    v_mov_b32 v36, 0x05040100
    v_mov_b32 v37, 0x07060302
    v_lshlrev_b32 v6, 4, v0
    v_perm_b32 v40, v10, v8, v36
    v_perm_b32 v41, v14, v12, v36
    v_perm_b32 v42, v18, v16, v36
    v_perm_b32 v43, v22, v20, v36
    ds_write_b128 v6, v[40:43] offset:512
    s_nop 1
    v_perm_b32 v40, v10, v8, v37
    v_perm_b32 v41, v14, v12, v37
    v_perm_b32 v42, v18, v16, v37
    v_perm_b32 v43, v22, v20, v37
    ds_write_b128 v6, v[40:43] offset:16896
    s_nop 1
    v_perm_b32 v40, v11, v9, v36
    v_perm_b32 v41, v15, v13, v36
    v_perm_b32 v42, v19, v17, v36
    v_perm_b32 v43, v23, v21, v36
    ds_write_b128 v6, v[40:43] offset:33280
    s_nop 1
    v_perm_b32 v40, v11, v9, v37
    v_perm_b32 v41, v15, v13, v37
    v_perm_b32 v42, v19, v17, v37
    v_perm_b32 v43, v23, v21, v37
    ds_write_b128 v6, v[40:43] offset:49664
    s_nop 1
    v_lshlrev_b32 v32, 16, v32
    v_mul_f32 v32, s26, v32
    v_exp_f32 v32, v32
    s_nop 0
    v_cvt_pk_bf16_f32 v32, v32, v32
    v_and_b32 v32, 0xffff0000, v32
    v_add_f32 v33, v32, v32
    v_lshlrev_b32 v24, 16, v24
    v_mul_f32 v24, s26, v24
    v_exp_f32 v24, v24
    s_nop 0
    v_cvt_pk_bf16_f32 v24, v24, v24
    v_and_b32 v24, 0xffff0000, v24
    v_mul_f32 v24, v24, v32
    v_mul_f32 v24, s26, v24
    v_sub_f32 v24, 0, v24
    v_lshlrev_b32 v25, 16, v25
    v_mul_f32 v25, v25, v32
    v_mul_f32 v25, s27, v25
    v_lshlrev_b32 v26, 16, v26
    v_mul_f32 v26, v26, v33
    v_lshlrev_b32 v27, 16, v27
    v_mul_f32 v27, v27, v33
    v_lshlrev_b32 v28, 16, v28
    v_mul_f32 v28, s26, v28
    v_exp_f32 v28, v28
    s_nop 0
    v_cvt_pk_bf16_f32 v28, v28, v28
    v_and_b32 v28, 0xffff0000, v28
    v_mul_f32 v28, v28, v32
    v_mul_f32 v28, s26, v28
    v_sub_f32 v28, 0, v28
    v_lshlrev_b32 v29, 16, v29
    v_mul_f32 v29, v29, v32
    v_mul_f32 v29, s27, v29
    v_lshlrev_b32 v30, 16, v30
    v_mul_f32 v30, v30, v33
    v_lshlrev_b32 v31, 16, v31
    v_mul_f32 v31, v31, v33
    v_cvt_f32_u32 v47, v2
    v_mul_f32 v44, 0x41800000, v47
    v_and_b32 v5, 7, v2
    v_add_u32 v5, 8, v5
    v_cvt_f32_u32 v5, v5
    v_mul_f32 v45, 0x42000000, v5
    v_mul_f32 v6, 0x42800000, v5
    v_cmp_lt_u32 vcc, 7, v2
    s_nop 1
    v_cndmask_b32 v45, v45, v6, vcc
    v_add_f32 v5, 0x41000000, v47
    v_mul_f32 v46, 0x43000000, v5
    v_mov_b32 v48, 0
    v_mov_b32 v49, 0
    v_mov_b32 v50, 0
    v_mov_b32 v51, 0
    v_mov_b32 v52, 0
    v_mov_b32 v53, 0
    v_mov_b32 v54, 0
    v_mov_b32 v55, 0
    v_mov_b32 v56, 0
    v_mov_b32 v57, 0
    v_mov_b32 v58, 0
    v_mov_b32 v59, 0
    v_mov_b32 v60, 0
    v_mov_b32 v61, 0
    v_mov_b32 v62, 0
    v_mov_b32 v63, 0
    v_mov_b32_dpp v64, v24 row_newbcast:0 row_mask:0xf bank_mask:0xf
    v_mov_b32_dpp v65, v25 row_newbcast:0 row_mask:0xf bank_mask:0xf
    v_mov_b32_dpp v66, v26 row_newbcast:0 row_mask:0xf bank_mask:0xf
    v_mov_b32_dpp v67, v27 row_newbcast:0 row_mask:0xf bank_mask:0xf
    v_mul_f32 v82, v64, v47
    v_mul_f32 v83, v65, v47
    v_exp_f32 v82, v82
    v_fract_f32 v83, v83
    v_cos_f32 v74, v83
    v_sin_f32 v75, v83
    v_mul_f32 v74, v74, v82
    v_mul_f32 v75, v75, v82
    v_mul_f32 v84, v75, v75
    v_add_f32 v85, v74, v74
    v_fma_f32 v76, v74, v74, -v84
    v_mul_f32 v77, v85, v75
    v_mul_f32 v84, v77, v77
    v_add_f32 v85, v76, v76
    v_fma_f32 v78, v76, v76, -v84
    v_mul_f32 v79, v85, v77
    v_mul_f32 v84, v79, v79
    v_add_f32 v85, v78, v78
    v_fma_f32 v80, v78, v78, -v84
    v_mul_f32 v81, v85, v79
    v_mul_f32 v82, v64, v44
    v_mul_f32 v83, v65, v44
    v_exp_f32 v82, v82
    v_fract_f32 v83, v83
    v_cos_f32 v68, v83
    v_sin_f32 v69, v83
    v_mul_f32 v68, v68, v82
    v_mul_f32 v69, v69, v82
    v_mul_f32 v84, v67, v69
    v_mul_f32 v85, v67, v68
    v_fma_f32 v68, v66, v68, -v84
    v_fma_f32 v69, -v66, v69, -v85
    v_mul_f32 v82, v64, v45
    v_mul_f32 v83, v65, v45
    v_exp_f32 v82, v82
    v_fract_f32 v83, v83
    v_cos_f32 v70, v83
    v_sin_f32 v71, v83
    v_mul_f32 v70, v70, v82
    v_mul_f32 v71, v71, v82
    v_mul_f32 v84, v67, v71
    v_mul_f32 v85, v67, v70
    v_fma_f32 v70, v66, v70, -v84
    v_fma_f32 v71, -v66, v71, -v85
    v_mul_f32 v82, v64, v46
    v_mul_f32 v83, v65, v46
    v_exp_f32 v82, v82
    v_fract_f32 v83, v83
    v_cos_f32 v72, v83
    v_sin_f32 v73, v83
    v_mul_f32 v72, v72, v82
    v_mul_f32 v73, v73, v82
    v_mul_f32 v84, v67, v73
    v_mul_f32 v85, v67, v72
    v_fma_f32 v72, v66, v72, -v84
    v_fma_f32 v73, -v66, v73, -v85
    v_mfma_f32_16x16x4_f32 v[48:51], v68, v74, v[48:51]
    v_mfma_f32_16x16x4_f32 v[52:55], v70, v76, v[52:55]
    v_mfma_f32_16x16x4_f32 v[56:59], v70, v78, v[56:59]
    v_mfma_f32_16x16x4_f32 v[60:63], v72, v80, v[60:63]
    v_mfma_f32_16x16x4_f32 v[48:51], v69, v75, v[48:51]
    v_mfma_f32_16x16x4_f32 v[52:55], v71, v77, v[52:55]
    v_mfma_f32_16x16x4_f32 v[56:59], v71, v79, v[56:59]
    v_mfma_f32_16x16x4_f32 v[60:63], v73, v81, v[60:63]
    v_mov_b32_dpp v64, v24 row_newbcast:1 row_mask:0xf bank_mask:0xf
    v_mov_b32_dpp v65, v25 row_newbcast:1 row_mask:0xf bank_mask:0xf
    v_mov_b32_dpp v66, v26 row_newbcast:1 row_mask:0xf bank_mask:0xf
    v_mov_b32_dpp v67, v27 row_newbcast:1 row_mask:0xf bank_mask:0xf
    v_mul_f32 v82, v64, v47
    v_mul_f32 v83, v65, v47
    v_exp_f32 v82, v82
    v_fract_f32 v83, v83
    v_cos_f32 v74, v83
    v_sin_f32 v75, v83
    v_mul_f32 v74, v74, v82
    v_mul_f32 v75, v75, v82
    v_mul_f32 v84, v75, v75
    v_add_f32 v85, v74, v74
    v_fma_f32 v76, v74, v74, -v84
    v_mul_f32 v77, v85, v75
    v_mul_f32 v84, v77, v77
    v_add_f32 v85, v76, v76
    v_fma_f32 v78, v76, v76, -v84
    v_mul_f32 v79, v85, v77
    v_mul_f32 v84, v79, v79
    v_add_f32 v85, v78, v78
    v_fma_f32 v80, v78, v78, -v84
    v_mul_f32 v81, v85, v79
    v_mul_f32 v82, v64, v44
    v_mul_f32 v83, v65, v44
    v_exp_f32 v82, v82
    v_fract_f32 v83, v83
    v_cos_f32 v68, v83
    v_sin_f32 v69, v83
    v_mul_f32 v68, v68, v82
    v_mul_f32 v69, v69, v82
    v_mul_f32 v84, v67, v69
    v_mul_f32 v85, v67, v68
    v_fma_f32 v68, v66, v68, -v84
    v_fma_f32 v69, -v66, v69, -v85
    v_mul_f32 v82, v64, v45
    v_mul_f32 v83, v65, v45
    v_exp_f32 v82, v82
    v_fract_f32 v83, v83
    v_cos_f32 v70, v83
    v_sin_f32 v71, v83
    v_mul_f32 v70, v70, v82
    v_mul_f32 v71, v71, v82
    v_mul_f32 v84, v67, v71
    v_mul_f32 v85, v67, v70
    v_fma_f32 v70, v66, v70, -v84
    v_fma_f32 v71, -v66, v71, -v85
    v_mul_f32 v82, v64, v46
    v_mul_f32 v83, v65, v46
    v_exp_f32 v82, v82
    v_fract_f32 v83, v83
    v_cos_f32 v72, v83
    v_sin_f32 v73, v83
    v_mul_f32 v72, v72, v82
    v_mul_f32 v73, v73, v82
    v_mul_f32 v84, v67, v73
    v_mul_f32 v85, v67, v72
    v_fma_f32 v72, v66, v72, -v84
    v_fma_f32 v73, -v66, v73, -v85
    v_mfma_f32_16x16x4_f32 v[48:51], v68, v74, v[48:51]
    v_mfma_f32_16x16x4_f32 v[52:55], v70, v76, v[52:55]
    v_mfma_f32_16x16x4_f32 v[56:59], v70, v78, v[56:59]
    v_mfma_f32_16x16x4_f32 v[60:63], v72, v80, v[60:63]
    v_mfma_f32_16x16x4_f32 v[48:51], v69, v75, v[48:51]
    v_mfma_f32_16x16x4_f32 v[52:55], v71, v77, v[52:55]
    v_mfma_f32_16x16x4_f32 v[56:59], v71, v79, v[56:59]
    v_mfma_f32_16x16x4_f32 v[60:63], v73, v81, v[60:63]
    v_mov_b32_dpp v64, v24 row_newbcast:2 row_mask:0xf bank_mask:0xf
    v_mov_b32_dpp v65, v25 row_newbcast:2 row_mask:0xf bank_mask:0xf
    v_mov_b32_dpp v66, v26 row_newbcast:2 row_mask:0xf bank_mask:0xf
    v_mov_b32_dpp v67, v27 row_newbcast:2 row_mask:0xf bank_mask:0xf
    v_mul_f32 v82, v64, v47
    v_mul_f32 v83, v65, v47
    v_exp_f32 v82, v82
    v_fract_f32 v83, v83
    v_cos_f32 v74, v83
    v_sin_f32 v75, v83
    v_mul_f32 v74, v74, v82
    v_mul_f32 v75, v75, v82
    v_mul_f32 v84, v75, v75
    v_add_f32 v85, v74, v74
    v_fma_f32 v76, v74, v74, -v84
    v_mul_f32 v77, v85, v75
    v_mul_f32 v84, v77, v77
    v_add_f32 v85, v76, v76
    v_fma_f32 v78, v76, v76, -v84
    v_mul_f32 v79, v85, v77
    v_mul_f32 v84, v79, v79
    v_add_f32 v85, v78, v78
    v_fma_f32 v80, v78, v78, -v84
    v_mul_f32 v81, v85, v79
    v_mul_f32 v82, v64, v44
    v_mul_f32 v83, v65, v44
    v_exp_f32 v82, v82
    v_fract_f32 v83, v83
    v_cos_f32 v68, v83
    v_sin_f32 v69, v83
    v_mul_f32 v68, v68, v82
    v_mul_f32 v69, v69, v82
    v_mul_f32 v84, v67, v69
    v_mul_f32 v85, v67, v68
    v_fma_f32 v68, v66, v68, -v84
    v_fma_f32 v69, -v66, v69, -v85
    v_mul_f32 v82, v64, v45
    v_mul_f32 v83, v65, v45
    v_exp_f32 v82, v82
    v_fract_f32 v83, v83
    v_cos_f32 v70, v83
    v_sin_f32 v71, v83
    v_mul_f32 v70, v70, v82
    v_mul_f32 v71, v71, v82
    v_mul_f32 v84, v67, v71
    v_mul_f32 v85, v67, v70
    v_fma_f32 v70, v66, v70, -v84
    v_fma_f32 v71, -v66, v71, -v85
    v_mul_f32 v82, v64, v46
    v_mul_f32 v83, v65, v46
    v_exp_f32 v82, v82
    v_fract_f32 v83, v83
    v_cos_f32 v72, v83
    v_sin_f32 v73, v83
    v_mul_f32 v72, v72, v82
    v_mul_f32 v73, v73, v82
    v_mul_f32 v84, v67, v73
    v_mul_f32 v85, v67, v72
    v_fma_f32 v72, v66, v72, -v84
    v_fma_f32 v73, -v66, v73, -v85
    v_mfma_f32_16x16x4_f32 v[48:51], v68, v74, v[48:51]
    v_mfma_f32_16x16x4_f32 v[52:55], v70, v76, v[52:55]
    v_mfma_f32_16x16x4_f32 v[56:59], v70, v78, v[56:59]
    v_mfma_f32_16x16x4_f32 v[60:63], v72, v80, v[60:63]
    v_mfma_f32_16x16x4_f32 v[48:51], v69, v75, v[48:51]
    v_mfma_f32_16x16x4_f32 v[52:55], v71, v77, v[52:55]
    v_mfma_f32_16x16x4_f32 v[56:59], v71, v79, v[56:59]
    v_mfma_f32_16x16x4_f32 v[60:63], v73, v81, v[60:63]
    v_mov_b32_dpp v64, v24 row_newbcast:3 row_mask:0xf bank_mask:0xf
    v_mov_b32_dpp v65, v25 row_newbcast:3 row_mask:0xf bank_mask:0xf
    v_mov_b32_dpp v66, v26 row_newbcast:3 row_mask:0xf bank_mask:0xf
    v_mov_b32_dpp v67, v27 row_newbcast:3 row_mask:0xf bank_mask:0xf
    v_mul_f32 v82, v64, v47
    v_mul_f32 v83, v65, v47
    v_exp_f32 v82, v82
    v_fract_f32 v83, v83
    v_cos_f32 v74, v83
    v_sin_f32 v75, v83
    v_mul_f32 v74, v74, v82
    v_mul_f32 v75, v75, v82
    v_mul_f32 v84, v75, v75
    v_add_f32 v85, v74, v74
    v_fma_f32 v76, v74, v74, -v84
    v_mul_f32 v77, v85, v75
    v_mul_f32 v84, v77, v77
    v_add_f32 v85, v76, v76
    v_fma_f32 v78, v76, v76, -v84
    v_mul_f32 v79, v85, v77
    v_mul_f32 v84, v79, v79
    v_add_f32 v85, v78, v78
    v_fma_f32 v80, v78, v78, -v84
    v_mul_f32 v81, v85, v79
    v_mul_f32 v82, v64, v44
    v_mul_f32 v83, v65, v44
    v_exp_f32 v82, v82
    v_fract_f32 v83, v83
    v_cos_f32 v68, v83
    v_sin_f32 v69, v83
    v_mul_f32 v68, v68, v82
    v_mul_f32 v69, v69, v82
    v_mul_f32 v84, v67, v69
    v_mul_f32 v85, v67, v68
    v_fma_f32 v68, v66, v68, -v84
    v_fma_f32 v69, -v66, v69, -v85
    v_mul_f32 v82, v64, v45
    v_mul_f32 v83, v65, v45
    v_exp_f32 v82, v82
    v_fract_f32 v83, v83
    v_cos_f32 v70, v83
    v_sin_f32 v71, v83
    v_mul_f32 v70, v70, v82
    v_mul_f32 v71, v71, v82
    v_mul_f32 v84, v67, v71
    v_mul_f32 v85, v67, v70
    v_fma_f32 v70, v66, v70, -v84
    v_fma_f32 v71, -v66, v71, -v85
    v_mul_f32 v82, v64, v46
    v_mul_f32 v83, v65, v46
    v_exp_f32 v82, v82
    v_fract_f32 v83, v83
    v_cos_f32 v72, v83
    v_sin_f32 v73, v83
    v_mul_f32 v72, v72, v82
    v_mul_f32 v73, v73, v82
    v_mul_f32 v84, v67, v73
    v_mul_f32 v85, v67, v72
    v_fma_f32 v72, v66, v72, -v84
    v_fma_f32 v73, -v66, v73, -v85
    v_mfma_f32_16x16x4_f32 v[48:51], v68, v74, v[48:51]
    v_mfma_f32_16x16x4_f32 v[52:55], v70, v76, v[52:55]
    v_mfma_f32_16x16x4_f32 v[56:59], v70, v78, v[56:59]
    v_mfma_f32_16x16x4_f32 v[60:63], v72, v80, v[60:63]
    v_mfma_f32_16x16x4_f32 v[48:51], v69, v75, v[48:51]
    v_mfma_f32_16x16x4_f32 v[52:55], v71, v77, v[52:55]
    v_mfma_f32_16x16x4_f32 v[56:59], v71, v79, v[56:59]
    v_mfma_f32_16x16x4_f32 v[60:63], v73, v81, v[60:63]
    v_mov_b32_dpp v64, v24 row_newbcast:4 row_mask:0xf bank_mask:0xf
    v_mov_b32_dpp v65, v25 row_newbcast:4 row_mask:0xf bank_mask:0xf
    v_mov_b32_dpp v66, v26 row_newbcast:4 row_mask:0xf bank_mask:0xf
    v_mov_b32_dpp v67, v27 row_newbcast:4 row_mask:0xf bank_mask:0xf
    v_mul_f32 v82, v64, v47
    v_mul_f32 v83, v65, v47
    v_exp_f32 v82, v82
    v_fract_f32 v83, v83
    v_cos_f32 v74, v83
    v_sin_f32 v75, v83
    v_mul_f32 v74, v74, v82
    v_mul_f32 v75, v75, v82
    v_mul_f32 v84, v75, v75
    v_add_f32 v85, v74, v74
    v_fma_f32 v76, v74, v74, -v84
    v_mul_f32 v77, v85, v75
    v_mul_f32 v84, v77, v77
    v_add_f32 v85, v76, v76
    v_fma_f32 v78, v76, v76, -v84
    v_mul_f32 v79, v85, v77
    v_mul_f32 v84, v79, v79
    v_add_f32 v85, v78, v78
    v_fma_f32 v80, v78, v78, -v84
    v_mul_f32 v81, v85, v79
    v_mul_f32 v82, v64, v44
    v_mul_f32 v83, v65, v44
    v_exp_f32 v82, v82
    v_fract_f32 v83, v83
    v_cos_f32 v68, v83
    v_sin_f32 v69, v83
    v_mul_f32 v68, v68, v82
    v_mul_f32 v69, v69, v82
    v_mul_f32 v84, v67, v69
    v_mul_f32 v85, v67, v68
    v_fma_f32 v68, v66, v68, -v84
    v_fma_f32 v69, -v66, v69, -v85
    v_mul_f32 v82, v64, v45
    v_mul_f32 v83, v65, v45
    v_exp_f32 v82, v82
    v_fract_f32 v83, v83
    v_cos_f32 v70, v83
    v_sin_f32 v71, v83
    v_mul_f32 v70, v70, v82
    v_mul_f32 v71, v71, v82
    v_mul_f32 v84, v67, v71
    v_mul_f32 v85, v67, v70
    v_fma_f32 v70, v66, v70, -v84
    v_fma_f32 v71, -v66, v71, -v85
    v_mul_f32 v82, v64, v46
    v_mul_f32 v83, v65, v46
    v_exp_f32 v82, v82
    v_fract_f32 v83, v83
    v_cos_f32 v72, v83
    v_sin_f32 v73, v83
    v_mul_f32 v72, v72, v82
    v_mul_f32 v73, v73, v82
    v_mul_f32 v84, v67, v73
    v_mul_f32 v85, v67, v72
    v_fma_f32 v72, v66, v72, -v84
    v_fma_f32 v73, -v66, v73, -v85
    v_mfma_f32_16x16x4_f32 v[48:51], v68, v74, v[48:51]
    v_mfma_f32_16x16x4_f32 v[52:55], v70, v76, v[52:55]
    v_mfma_f32_16x16x4_f32 v[56:59], v70, v78, v[56:59]
    v_mfma_f32_16x16x4_f32 v[60:63], v72, v80, v[60:63]
    v_mfma_f32_16x16x4_f32 v[48:51], v69, v75, v[48:51]
    v_mfma_f32_16x16x4_f32 v[52:55], v71, v77, v[52:55]
    v_mfma_f32_16x16x4_f32 v[56:59], v71, v79, v[56:59]
    v_mfma_f32_16x16x4_f32 v[60:63], v73, v81, v[60:63]
    v_mov_b32_dpp v64, v24 row_newbcast:5 row_mask:0xf bank_mask:0xf
    v_mov_b32_dpp v65, v25 row_newbcast:5 row_mask:0xf bank_mask:0xf
    v_mov_b32_dpp v66, v26 row_newbcast:5 row_mask:0xf bank_mask:0xf
    v_mov_b32_dpp v67, v27 row_newbcast:5 row_mask:0xf bank_mask:0xf
    v_mul_f32 v82, v64, v47
    v_mul_f32 v83, v65, v47
    v_exp_f32 v82, v82
    v_fract_f32 v83, v83
    v_cos_f32 v74, v83
    v_sin_f32 v75, v83
    v_mul_f32 v74, v74, v82
    v_mul_f32 v75, v75, v82
    v_mul_f32 v84, v75, v75
    v_add_f32 v85, v74, v74
    v_fma_f32 v76, v74, v74, -v84
    v_mul_f32 v77, v85, v75
    v_mul_f32 v84, v77, v77
    v_add_f32 v85, v76, v76
    v_fma_f32 v78, v76, v76, -v84
    v_mul_f32 v79, v85, v77
    v_mul_f32 v84, v79, v79
    v_add_f32 v85, v78, v78
    v_fma_f32 v80, v78, v78, -v84
    v_mul_f32 v81, v85, v79
    v_mul_f32 v82, v64, v44
    v_mul_f32 v83, v65, v44
    v_exp_f32 v82, v82
    v_fract_f32 v83, v83
    v_cos_f32 v68, v83
    v_sin_f32 v69, v83
    v_mul_f32 v68, v68, v82
    v_mul_f32 v69, v69, v82
    v_mul_f32 v84, v67, v69
    v_mul_f32 v85, v67, v68
    v_fma_f32 v68, v66, v68, -v84
    v_fma_f32 v69, -v66, v69, -v85
    v_mul_f32 v82, v64, v45
    v_mul_f32 v83, v65, v45
    v_exp_f32 v82, v82
    v_fract_f32 v83, v83
    v_cos_f32 v70, v83
    v_sin_f32 v71, v83
    v_mul_f32 v70, v70, v82
    v_mul_f32 v71, v71, v82
    v_mul_f32 v84, v67, v71
    v_mul_f32 v85, v67, v70
    v_fma_f32 v70, v66, v70, -v84
    v_fma_f32 v71, -v66, v71, -v85
    v_mul_f32 v82, v64, v46
    v_mul_f32 v83, v65, v46
    v_exp_f32 v82, v82
    v_fract_f32 v83, v83
    v_cos_f32 v72, v83
    v_sin_f32 v73, v83
    v_mul_f32 v72, v72, v82
    v_mul_f32 v73, v73, v82
    v_mul_f32 v84, v67, v73
    v_mul_f32 v85, v67, v72
    v_fma_f32 v72, v66, v72, -v84
    v_fma_f32 v73, -v66, v73, -v85
    v_mfma_f32_16x16x4_f32 v[48:51], v68, v74, v[48:51]
    v_mfma_f32_16x16x4_f32 v[52:55], v70, v76, v[52:55]
    v_mfma_f32_16x16x4_f32 v[56:59], v70, v78, v[56:59]
    v_mfma_f32_16x16x4_f32 v[60:63], v72, v80, v[60:63]
    v_mfma_f32_16x16x4_f32 v[48:51], v69, v75, v[48:51]
    v_mfma_f32_16x16x4_f32 v[52:55], v71, v77, v[52:55]
    v_mfma_f32_16x16x4_f32 v[56:59], v71, v79, v[56:59]
    v_mfma_f32_16x16x4_f32 v[60:63], v73, v81, v[60:63]
    v_mov_b32_dpp v64, v24 row_newbcast:6 row_mask:0xf bank_mask:0xf
    v_mov_b32_dpp v65, v25 row_newbcast:6 row_mask:0xf bank_mask:0xf
    v_mov_b32_dpp v66, v26 row_newbcast:6 row_mask:0xf bank_mask:0xf
    v_mov_b32_dpp v67, v27 row_newbcast:6 row_mask:0xf bank_mask:0xf
    v_mul_f32 v82, v64, v47
    v_mul_f32 v83, v65, v47
    v_exp_f32 v82, v82
    v_fract_f32 v83, v83
    v_cos_f32 v74, v83
    v_sin_f32 v75, v83
    v_mul_f32 v74, v74, v82
    v_mul_f32 v75, v75, v82
    v_mul_f32 v84, v75, v75
    v_add_f32 v85, v74, v74
    v_fma_f32 v76, v74, v74, -v84
    v_mul_f32 v77, v85, v75
    v_mul_f32 v84, v77, v77
    v_add_f32 v85, v76, v76
    v_fma_f32 v78, v76, v76, -v84
    v_mul_f32 v79, v85, v77
    v_mul_f32 v84, v79, v79
    v_add_f32 v85, v78, v78
    v_fma_f32 v80, v78, v78, -v84
    v_mul_f32 v81, v85, v79
    v_mul_f32 v82, v64, v44
    v_mul_f32 v83, v65, v44
    v_exp_f32 v82, v82
    v_fract_f32 v83, v83
    v_cos_f32 v68, v83
    v_sin_f32 v69, v83
    v_mul_f32 v68, v68, v82
    v_mul_f32 v69, v69, v82
    v_mul_f32 v84, v67, v69
    v_mul_f32 v85, v67, v68
    v_fma_f32 v68, v66, v68, -v84
    v_fma_f32 v69, -v66, v69, -v85
    v_mul_f32 v82, v64, v45
    v_mul_f32 v83, v65, v45
    v_exp_f32 v82, v82
    v_fract_f32 v83, v83
    v_cos_f32 v70, v83
    v_sin_f32 v71, v83
    v_mul_f32 v70, v70, v82
    v_mul_f32 v71, v71, v82
    v_mul_f32 v84, v67, v71
    v_mul_f32 v85, v67, v70
    v_fma_f32 v70, v66, v70, -v84
    v_fma_f32 v71, -v66, v71, -v85
    v_mul_f32 v82, v64, v46
    v_mul_f32 v83, v65, v46
    v_exp_f32 v82, v82
    v_fract_f32 v83, v83
    v_cos_f32 v72, v83
    v_sin_f32 v73, v83
    v_mul_f32 v72, v72, v82
    v_mul_f32 v73, v73, v82
    v_mul_f32 v84, v67, v73
    v_mul_f32 v85, v67, v72
    v_fma_f32 v72, v66, v72, -v84
    v_fma_f32 v73, -v66, v73, -v85
    v_mfma_f32_16x16x4_f32 v[48:51], v68, v74, v[48:51]
    v_mfma_f32_16x16x4_f32 v[52:55], v70, v76, v[52:55]
    v_mfma_f32_16x16x4_f32 v[56:59], v70, v78, v[56:59]
    v_mfma_f32_16x16x4_f32 v[60:63], v72, v80, v[60:63]
    v_mfma_f32_16x16x4_f32 v[48:51], v69, v75, v[48:51]
    v_mfma_f32_16x16x4_f32 v[52:55], v71, v77, v[52:55]
    v_mfma_f32_16x16x4_f32 v[56:59], v71, v79, v[56:59]
    v_mfma_f32_16x16x4_f32 v[60:63], v73, v81, v[60:63]
    v_mov_b32_dpp v64, v24 row_newbcast:7 row_mask:0xf bank_mask:0xf
    v_mov_b32_dpp v65, v25 row_newbcast:7 row_mask:0xf bank_mask:0xf
    v_mov_b32_dpp v66, v26 row_newbcast:7 row_mask:0xf bank_mask:0xf
    v_mov_b32_dpp v67, v27 row_newbcast:7 row_mask:0xf bank_mask:0xf
    v_mul_f32 v82, v64, v47
    v_mul_f32 v83, v65, v47
    v_exp_f32 v82, v82
    v_fract_f32 v83, v83
    v_cos_f32 v74, v83
    v_sin_f32 v75, v83
    v_mul_f32 v74, v74, v82
    v_mul_f32 v75, v75, v82
    v_mul_f32 v84, v75, v75
    v_add_f32 v85, v74, v74
    v_fma_f32 v76, v74, v74, -v84
    v_mul_f32 v77, v85, v75
    v_mul_f32 v84, v77, v77
    v_add_f32 v85, v76, v76
    v_fma_f32 v78, v76, v76, -v84
    v_mul_f32 v79, v85, v77
    v_mul_f32 v84, v79, v79
    v_add_f32 v85, v78, v78
    v_fma_f32 v80, v78, v78, -v84
    v_mul_f32 v81, v85, v79
    v_mul_f32 v82, v64, v44
    v_mul_f32 v83, v65, v44
    v_exp_f32 v82, v82
    v_fract_f32 v83, v83
    v_cos_f32 v68, v83
    v_sin_f32 v69, v83
    v_mul_f32 v68, v68, v82
    v_mul_f32 v69, v69, v82
    v_mul_f32 v84, v67, v69
    v_mul_f32 v85, v67, v68
    v_fma_f32 v68, v66, v68, -v84
    v_fma_f32 v69, -v66, v69, -v85
    v_mul_f32 v82, v64, v45
    v_mul_f32 v83, v65, v45
    v_exp_f32 v82, v82
    v_fract_f32 v83, v83
    v_cos_f32 v70, v83
    v_sin_f32 v71, v83
    v_mul_f32 v70, v70, v82
    v_mul_f32 v71, v71, v82
    v_mul_f32 v84, v67, v71
    v_mul_f32 v85, v67, v70
    v_fma_f32 v70, v66, v70, -v84
    v_fma_f32 v71, -v66, v71, -v85
    v_mul_f32 v82, v64, v46
    v_mul_f32 v83, v65, v46
    v_exp_f32 v82, v82
    v_fract_f32 v83, v83
    v_cos_f32 v72, v83
    v_sin_f32 v73, v83
    v_mul_f32 v72, v72, v82
    v_mul_f32 v73, v73, v82
    v_mul_f32 v84, v67, v73
    v_mul_f32 v85, v67, v72
    v_fma_f32 v72, v66, v72, -v84
    v_fma_f32 v73, -v66, v73, -v85
    v_mfma_f32_16x16x4_f32 v[48:51], v68, v74, v[48:51]
    v_mfma_f32_16x16x4_f32 v[52:55], v70, v76, v[52:55]
    v_mfma_f32_16x16x4_f32 v[56:59], v70, v78, v[56:59]
    v_mfma_f32_16x16x4_f32 v[60:63], v72, v80, v[60:63]
    v_mfma_f32_16x16x4_f32 v[48:51], v69, v75, v[48:51]
    v_mfma_f32_16x16x4_f32 v[52:55], v71, v77, v[52:55]
    v_mfma_f32_16x16x4_f32 v[56:59], v71, v79, v[56:59]
    v_mfma_f32_16x16x4_f32 v[60:63], v73, v81, v[60:63]
    v_mov_b32_dpp v64, v24 row_newbcast:8 row_mask:0xf bank_mask:0xf
    v_mov_b32_dpp v65, v25 row_newbcast:8 row_mask:0xf bank_mask:0xf
    v_mov_b32_dpp v66, v26 row_newbcast:8 row_mask:0xf bank_mask:0xf
    v_mov_b32_dpp v67, v27 row_newbcast:8 row_mask:0xf bank_mask:0xf
    v_mul_f32 v82, v64, v47
    v_mul_f32 v83, v65, v47
    v_exp_f32 v82, v82
    v_fract_f32 v83, v83
    v_cos_f32 v74, v83
    v_sin_f32 v75, v83
    v_mul_f32 v74, v74, v82
    v_mul_f32 v75, v75, v82
    v_mul_f32 v84, v75, v75
    v_add_f32 v85, v74, v74
    v_fma_f32 v76, v74, v74, -v84
    v_mul_f32 v77, v85, v75
    v_mul_f32 v84, v77, v77
    v_add_f32 v85, v76, v76
    v_fma_f32 v78, v76, v76, -v84
    v_mul_f32 v79, v85, v77
    v_mul_f32 v84, v79, v79
    v_add_f32 v85, v78, v78
    v_fma_f32 v80, v78, v78, -v84
    v_mul_f32 v81, v85, v79
    v_mul_f32 v82, v64, v44
    v_mul_f32 v83, v65, v44
    v_exp_f32 v82, v82
    v_fract_f32 v83, v83
    v_cos_f32 v68, v83
    v_sin_f32 v69, v83
    v_mul_f32 v68, v68, v82
    v_mul_f32 v69, v69, v82
    v_mul_f32 v84, v67, v69
    v_mul_f32 v85, v67, v68
    v_fma_f32 v68, v66, v68, -v84
    v_fma_f32 v69, -v66, v69, -v85
    v_mul_f32 v82, v64, v45
    v_mul_f32 v83, v65, v45
    v_exp_f32 v82, v82
    v_fract_f32 v83, v83
    v_cos_f32 v70, v83
    v_sin_f32 v71, v83
    v_mul_f32 v70, v70, v82
    v_mul_f32 v71, v71, v82
    v_mul_f32 v84, v67, v71
    v_mul_f32 v85, v67, v70
    v_fma_f32 v70, v66, v70, -v84
    v_fma_f32 v71, -v66, v71, -v85
    v_mul_f32 v82, v64, v46
    v_mul_f32 v83, v65, v46
    v_exp_f32 v82, v82
    v_fract_f32 v83, v83
    v_cos_f32 v72, v83
    v_sin_f32 v73, v83
    v_mul_f32 v72, v72, v82
    v_mul_f32 v73, v73, v82
    v_mul_f32 v84, v67, v73
    v_mul_f32 v85, v67, v72
    v_fma_f32 v72, v66, v72, -v84
    v_fma_f32 v73, -v66, v73, -v85
    v_mfma_f32_16x16x4_f32 v[48:51], v68, v74, v[48:51]
    v_mfma_f32_16x16x4_f32 v[52:55], v70, v76, v[52:55]
    v_mfma_f32_16x16x4_f32 v[56:59], v70, v78, v[56:59]
    v_mfma_f32_16x16x4_f32 v[60:63], v72, v80, v[60:63]
    v_mfma_f32_16x16x4_f32 v[48:51], v69, v75, v[48:51]
    v_mfma_f32_16x16x4_f32 v[52:55], v71, v77, v[52:55]
    v_mfma_f32_16x16x4_f32 v[56:59], v71, v79, v[56:59]
    v_mfma_f32_16x16x4_f32 v[60:63], v73, v81, v[60:63]
    v_mov_b32_dpp v64, v24 row_newbcast:9 row_mask:0xf bank_mask:0xf
    v_mov_b32_dpp v65, v25 row_newbcast:9 row_mask:0xf bank_mask:0xf
    v_mov_b32_dpp v66, v26 row_newbcast:9 row_mask:0xf bank_mask:0xf
    v_mov_b32_dpp v67, v27 row_newbcast:9 row_mask:0xf bank_mask:0xf
    v_mul_f32 v82, v64, v47
    v_mul_f32 v83, v65, v47
    v_exp_f32 v82, v82
    v_fract_f32 v83, v83
    v_cos_f32 v74, v83
    v_sin_f32 v75, v83
    v_mul_f32 v74, v74, v82
    v_mul_f32 v75, v75, v82
    v_mul_f32 v84, v75, v75
    v_add_f32 v85, v74, v74
    v_fma_f32 v76, v74, v74, -v84
    v_mul_f32 v77, v85, v75
    v_mul_f32 v84, v77, v77
    v_add_f32 v85, v76, v76
    v_fma_f32 v78, v76, v76, -v84
    v_mul_f32 v79, v85, v77
    v_mul_f32 v84, v79, v79
    v_add_f32 v85, v78, v78
    v_fma_f32 v80, v78, v78, -v84
    v_mul_f32 v81, v85, v79
    v_mul_f32 v82, v64, v44
    v_mul_f32 v83, v65, v44
    v_exp_f32 v82, v82
    v_fract_f32 v83, v83
    v_cos_f32 v68, v83
    v_sin_f32 v69, v83
    v_mul_f32 v68, v68, v82
    v_mul_f32 v69, v69, v82
    v_mul_f32 v84, v67, v69
    v_mul_f32 v85, v67, v68
    v_fma_f32 v68, v66, v68, -v84
    v_fma_f32 v69, -v66, v69, -v85
    v_mul_f32 v82, v64, v45
    v_mul_f32 v83, v65, v45
    v_exp_f32 v82, v82
    v_fract_f32 v83, v83
    v_cos_f32 v70, v83
    v_sin_f32 v71, v83
    v_mul_f32 v70, v70, v82
    v_mul_f32 v71, v71, v82
    v_mul_f32 v84, v67, v71
    v_mul_f32 v85, v67, v70
    v_fma_f32 v70, v66, v70, -v84
    v_fma_f32 v71, -v66, v71, -v85
    v_mul_f32 v82, v64, v46
    v_mul_f32 v83, v65, v46
    v_exp_f32 v82, v82
    v_fract_f32 v83, v83
    v_cos_f32 v72, v83
    v_sin_f32 v73, v83
    v_mul_f32 v72, v72, v82
    v_mul_f32 v73, v73, v82
    v_mul_f32 v84, v67, v73
    v_mul_f32 v85, v67, v72
    v_fma_f32 v72, v66, v72, -v84
    v_fma_f32 v73, -v66, v73, -v85
    v_mfma_f32_16x16x4_f32 v[48:51], v68, v74, v[48:51]
    v_mfma_f32_16x16x4_f32 v[52:55], v70, v76, v[52:55]
    v_mfma_f32_16x16x4_f32 v[56:59], v70, v78, v[56:59]
    v_mfma_f32_16x16x4_f32 v[60:63], v72, v80, v[60:63]
    v_mfma_f32_16x16x4_f32 v[48:51], v69, v75, v[48:51]
    v_mfma_f32_16x16x4_f32 v[52:55], v71, v77, v[52:55]
    v_mfma_f32_16x16x4_f32 v[56:59], v71, v79, v[56:59]
    v_mfma_f32_16x16x4_f32 v[60:63], v73, v81, v[60:63]
    v_mov_b32_dpp v64, v24 row_newbcast:10 row_mask:0xf bank_mask:0xf
    v_mov_b32_dpp v65, v25 row_newbcast:10 row_mask:0xf bank_mask:0xf
    v_mov_b32_dpp v66, v26 row_newbcast:10 row_mask:0xf bank_mask:0xf
    v_mov_b32_dpp v67, v27 row_newbcast:10 row_mask:0xf bank_mask:0xf
    v_mul_f32 v82, v64, v47
    v_mul_f32 v83, v65, v47
    v_exp_f32 v82, v82
    v_fract_f32 v83, v83
    v_cos_f32 v74, v83
    v_sin_f32 v75, v83
    v_mul_f32 v74, v74, v82
    v_mul_f32 v75, v75, v82
    v_mul_f32 v84, v75, v75
    v_add_f32 v85, v74, v74
    v_fma_f32 v76, v74, v74, -v84
    v_mul_f32 v77, v85, v75
    v_mul_f32 v84, v77, v77
    v_add_f32 v85, v76, v76
    v_fma_f32 v78, v76, v76, -v84
    v_mul_f32 v79, v85, v77
    v_mul_f32 v84, v79, v79
    v_add_f32 v85, v78, v78
    v_fma_f32 v80, v78, v78, -v84
    v_mul_f32 v81, v85, v79
    v_mul_f32 v82, v64, v44
    v_mul_f32 v83, v65, v44
    v_exp_f32 v82, v82
    v_fract_f32 v83, v83
    v_cos_f32 v68, v83
    v_sin_f32 v69, v83
    v_mul_f32 v68, v68, v82
    v_mul_f32 v69, v69, v82
    v_mul_f32 v84, v67, v69
    v_mul_f32 v85, v67, v68
    v_fma_f32 v68, v66, v68, -v84
    v_fma_f32 v69, -v66, v69, -v85
    v_mul_f32 v82, v64, v45
    v_mul_f32 v83, v65, v45
    v_exp_f32 v82, v82
    v_fract_f32 v83, v83
    v_cos_f32 v70, v83
    v_sin_f32 v71, v83
    v_mul_f32 v70, v70, v82
    v_mul_f32 v71, v71, v82
    v_mul_f32 v84, v67, v71
    v_mul_f32 v85, v67, v70
    v_fma_f32 v70, v66, v70, -v84
    v_fma_f32 v71, -v66, v71, -v85
    v_mul_f32 v82, v64, v46
    v_mul_f32 v83, v65, v46
    v_exp_f32 v82, v82
    v_fract_f32 v83, v83
    v_cos_f32 v72, v83
    v_sin_f32 v73, v83
    v_mul_f32 v72, v72, v82
    v_mul_f32 v73, v73, v82
    v_mul_f32 v84, v67, v73
    v_mul_f32 v85, v67, v72
    v_fma_f32 v72, v66, v72, -v84
    v_fma_f32 v73, -v66, v73, -v85
    v_mfma_f32_16x16x4_f32 v[48:51], v68, v74, v[48:51]
    v_mfma_f32_16x16x4_f32 v[52:55], v70, v76, v[52:55]
    v_mfma_f32_16x16x4_f32 v[56:59], v70, v78, v[56:59]
    v_mfma_f32_16x16x4_f32 v[60:63], v72, v80, v[60:63]
    v_mfma_f32_16x16x4_f32 v[48:51], v69, v75, v[48:51]
    v_mfma_f32_16x16x4_f32 v[52:55], v71, v77, v[52:55]
    v_mfma_f32_16x16x4_f32 v[56:59], v71, v79, v[56:59]
    v_mfma_f32_16x16x4_f32 v[60:63], v73, v81, v[60:63]
    v_mov_b32_dpp v64, v24 row_newbcast:11 row_mask:0xf bank_mask:0xf
    v_mov_b32_dpp v65, v25 row_newbcast:11 row_mask:0xf bank_mask:0xf
    v_mov_b32_dpp v66, v26 row_newbcast:11 row_mask:0xf bank_mask:0xf
    v_mov_b32_dpp v67, v27 row_newbcast:11 row_mask:0xf bank_mask:0xf
    v_mul_f32 v82, v64, v47
    v_mul_f32 v83, v65, v47
    v_exp_f32 v82, v82
    v_fract_f32 v83, v83
    v_cos_f32 v74, v83
    v_sin_f32 v75, v83
    v_mul_f32 v74, v74, v82
    v_mul_f32 v75, v75, v82
    v_mul_f32 v84, v75, v75
    v_add_f32 v85, v74, v74
    v_fma_f32 v76, v74, v74, -v84
    v_mul_f32 v77, v85, v75
    v_mul_f32 v84, v77, v77
    v_add_f32 v85, v76, v76
    v_fma_f32 v78, v76, v76, -v84
    v_mul_f32 v79, v85, v77
    v_mul_f32 v84, v79, v79
    v_add_f32 v85, v78, v78
    v_fma_f32 v80, v78, v78, -v84
    v_mul_f32 v81, v85, v79
    v_mul_f32 v82, v64, v44
    v_mul_f32 v83, v65, v44
    v_exp_f32 v82, v82
    v_fract_f32 v83, v83
    v_cos_f32 v68, v83
    v_sin_f32 v69, v83
    v_mul_f32 v68, v68, v82
    v_mul_f32 v69, v69, v82
    v_mul_f32 v84, v67, v69
    v_mul_f32 v85, v67, v68
    v_fma_f32 v68, v66, v68, -v84
    v_fma_f32 v69, -v66, v69, -v85
    v_mul_f32 v82, v64, v45
    v_mul_f32 v83, v65, v45
    v_exp_f32 v82, v82
    v_fract_f32 v83, v83
    v_cos_f32 v70, v83
    v_sin_f32 v71, v83
    v_mul_f32 v70, v70, v82
    v_mul_f32 v71, v71, v82
    v_mul_f32 v84, v67, v71
    v_mul_f32 v85, v67, v70
    v_fma_f32 v70, v66, v70, -v84
    v_fma_f32 v71, -v66, v71, -v85
    v_mul_f32 v82, v64, v46
    v_mul_f32 v83, v65, v46
    v_exp_f32 v82, v82
    v_fract_f32 v83, v83
    v_cos_f32 v72, v83
    v_sin_f32 v73, v83
    v_mul_f32 v72, v72, v82
    v_mul_f32 v73, v73, v82
    v_mul_f32 v84, v67, v73
    v_mul_f32 v85, v67, v72
    v_fma_f32 v72, v66, v72, -v84
    v_fma_f32 v73, -v66, v73, -v85
    v_mfma_f32_16x16x4_f32 v[48:51], v68, v74, v[48:51]
    v_mfma_f32_16x16x4_f32 v[52:55], v70, v76, v[52:55]
    v_mfma_f32_16x16x4_f32 v[56:59], v70, v78, v[56:59]
    v_mfma_f32_16x16x4_f32 v[60:63], v72, v80, v[60:63]
    v_mfma_f32_16x16x4_f32 v[48:51], v69, v75, v[48:51]
    v_mfma_f32_16x16x4_f32 v[52:55], v71, v77, v[52:55]
    v_mfma_f32_16x16x4_f32 v[56:59], v71, v79, v[56:59]
    v_mfma_f32_16x16x4_f32 v[60:63], v73, v81, v[60:63]
    v_mov_b32_dpp v64, v24 row_newbcast:12 row_mask:0xf bank_mask:0xf
    v_mov_b32_dpp v65, v25 row_newbcast:12 row_mask:0xf bank_mask:0xf
    v_mov_b32_dpp v66, v26 row_newbcast:12 row_mask:0xf bank_mask:0xf
    v_mov_b32_dpp v67, v27 row_newbcast:12 row_mask:0xf bank_mask:0xf
    v_mul_f32 v82, v64, v47
    v_mul_f32 v83, v65, v47
    v_exp_f32 v82, v82
    v_fract_f32 v83, v83
    v_cos_f32 v74, v83
    v_sin_f32 v75, v83
    v_mul_f32 v74, v74, v82
    v_mul_f32 v75, v75, v82
    v_mul_f32 v84, v75, v75
    v_add_f32 v85, v74, v74
    v_fma_f32 v76, v74, v74, -v84
    v_mul_f32 v77, v85, v75
    v_mul_f32 v84, v77, v77
    v_add_f32 v85, v76, v76
    v_fma_f32 v78, v76, v76, -v84
    v_mul_f32 v79, v85, v77
    v_mul_f32 v84, v79, v79
    v_add_f32 v85, v78, v78
    v_fma_f32 v80, v78, v78, -v84
    v_mul_f32 v81, v85, v79
    v_mul_f32 v82, v64, v44
    v_mul_f32 v83, v65, v44
    v_exp_f32 v82, v82
    v_fract_f32 v83, v83
    v_cos_f32 v68, v83
    v_sin_f32 v69, v83
    v_mul_f32 v68, v68, v82
    v_mul_f32 v69, v69, v82
    v_mul_f32 v84, v67, v69
    v_mul_f32 v85, v67, v68
    v_fma_f32 v68, v66, v68, -v84
    v_fma_f32 v69, -v66, v69, -v85
    v_mul_f32 v82, v64, v45
    v_mul_f32 v83, v65, v45
    v_exp_f32 v82, v82
    v_fract_f32 v83, v83
    v_cos_f32 v70, v83
    v_sin_f32 v71, v83
    v_mul_f32 v70, v70, v82
    v_mul_f32 v71, v71, v82
    v_mul_f32 v84, v67, v71
    v_mul_f32 v85, v67, v70
    v_fma_f32 v70, v66, v70, -v84
    v_fma_f32 v71, -v66, v71, -v85
    v_mul_f32 v82, v64, v46
    v_mul_f32 v83, v65, v46
    v_exp_f32 v82, v82
    v_fract_f32 v83, v83
    v_cos_f32 v72, v83
    v_sin_f32 v73, v83
    v_mul_f32 v72, v72, v82
    v_mul_f32 v73, v73, v82
    v_mul_f32 v84, v67, v73
    v_mul_f32 v85, v67, v72
    v_fma_f32 v72, v66, v72, -v84
    v_fma_f32 v73, -v66, v73, -v85
    v_mfma_f32_16x16x4_f32 v[48:51], v68, v74, v[48:51]
    v_mfma_f32_16x16x4_f32 v[52:55], v70, v76, v[52:55]
    v_mfma_f32_16x16x4_f32 v[56:59], v70, v78, v[56:59]
    v_mfma_f32_16x16x4_f32 v[60:63], v72, v80, v[60:63]
    v_mfma_f32_16x16x4_f32 v[48:51], v69, v75, v[48:51]
    v_mfma_f32_16x16x4_f32 v[52:55], v71, v77, v[52:55]
    v_mfma_f32_16x16x4_f32 v[56:59], v71, v79, v[56:59]
    v_mfma_f32_16x16x4_f32 v[60:63], v73, v81, v[60:63]
    v_mov_b32_dpp v64, v24 row_newbcast:13 row_mask:0xf bank_mask:0xf
    v_mov_b32_dpp v65, v25 row_newbcast:13 row_mask:0xf bank_mask:0xf
    v_mov_b32_dpp v66, v26 row_newbcast:13 row_mask:0xf bank_mask:0xf
    v_mov_b32_dpp v67, v27 row_newbcast:13 row_mask:0xf bank_mask:0xf
    v_mul_f32 v82, v64, v47
    v_mul_f32 v83, v65, v47
    v_exp_f32 v82, v82
    v_fract_f32 v83, v83
    v_cos_f32 v74, v83
    v_sin_f32 v75, v83
    v_mul_f32 v74, v74, v82
    v_mul_f32 v75, v75, v82
    v_mul_f32 v84, v75, v75
    v_add_f32 v85, v74, v74
    v_fma_f32 v76, v74, v74, -v84
    v_mul_f32 v77, v85, v75
    v_mul_f32 v84, v77, v77
    v_add_f32 v85, v76, v76
    v_fma_f32 v78, v76, v76, -v84
    v_mul_f32 v79, v85, v77
    v_mul_f32 v84, v79, v79
    v_add_f32 v85, v78, v78
    v_fma_f32 v80, v78, v78, -v84
    v_mul_f32 v81, v85, v79
    v_mul_f32 v82, v64, v44
    v_mul_f32 v83, v65, v44
    v_exp_f32 v82, v82
    v_fract_f32 v83, v83
    v_cos_f32 v68, v83
    v_sin_f32 v69, v83
    v_mul_f32 v68, v68, v82
    v_mul_f32 v69, v69, v82
    v_mul_f32 v84, v67, v69
    v_mul_f32 v85, v67, v68
    v_fma_f32 v68, v66, v68, -v84
    v_fma_f32 v69, -v66, v69, -v85
    v_mul_f32 v82, v64, v45
    v_mul_f32 v83, v65, v45
    v_exp_f32 v82, v82
    v_fract_f32 v83, v83
    v_cos_f32 v70, v83
    v_sin_f32 v71, v83
    v_mul_f32 v70, v70, v82
    v_mul_f32 v71, v71, v82
    v_mul_f32 v84, v67, v71
    v_mul_f32 v85, v67, v70
    v_fma_f32 v70, v66, v70, -v84
    v_fma_f32 v71, -v66, v71, -v85
    v_mul_f32 v82, v64, v46
    v_mul_f32 v83, v65, v46
    v_exp_f32 v82, v82
    v_fract_f32 v83, v83
    v_cos_f32 v72, v83
    v_sin_f32 v73, v83
    v_mul_f32 v72, v72, v82
    v_mul_f32 v73, v73, v82
    v_mul_f32 v84, v67, v73
    v_mul_f32 v85, v67, v72
    v_fma_f32 v72, v66, v72, -v84
    v_fma_f32 v73, -v66, v73, -v85
    v_mfma_f32_16x16x4_f32 v[48:51], v68, v74, v[48:51]
    v_mfma_f32_16x16x4_f32 v[52:55], v70, v76, v[52:55]
    v_mfma_f32_16x16x4_f32 v[56:59], v70, v78, v[56:59]
    v_mfma_f32_16x16x4_f32 v[60:63], v72, v80, v[60:63]
    v_mfma_f32_16x16x4_f32 v[48:51], v69, v75, v[48:51]
    v_mfma_f32_16x16x4_f32 v[52:55], v71, v77, v[52:55]
    v_mfma_f32_16x16x4_f32 v[56:59], v71, v79, v[56:59]
    v_mfma_f32_16x16x4_f32 v[60:63], v73, v81, v[60:63]
    v_mov_b32_dpp v64, v24 row_newbcast:14 row_mask:0xf bank_mask:0xf
    v_mov_b32_dpp v65, v25 row_newbcast:14 row_mask:0xf bank_mask:0xf
    v_mov_b32_dpp v66, v26 row_newbcast:14 row_mask:0xf bank_mask:0xf
    v_mov_b32_dpp v67, v27 row_newbcast:14 row_mask:0xf bank_mask:0xf
    v_mul_f32 v82, v64, v47
    v_mul_f32 v83, v65, v47
    v_exp_f32 v82, v82
    v_fract_f32 v83, v83
    v_cos_f32 v74, v83
    v_sin_f32 v75, v83
    v_mul_f32 v74, v74, v82
    v_mul_f32 v75, v75, v82
    v_mul_f32 v84, v75, v75
    v_add_f32 v85, v74, v74
    v_fma_f32 v76, v74, v74, -v84
    v_mul_f32 v77, v85, v75
    v_mul_f32 v84, v77, v77
    v_add_f32 v85, v76, v76
    v_fma_f32 v78, v76, v76, -v84
    v_mul_f32 v79, v85, v77
    v_mul_f32 v84, v79, v79
    v_add_f32 v85, v78, v78
    v_fma_f32 v80, v78, v78, -v84
    v_mul_f32 v81, v85, v79
    v_mul_f32 v82, v64, v44
    v_mul_f32 v83, v65, v44
    v_exp_f32 v82, v82
    v_fract_f32 v83, v83
    v_cos_f32 v68, v83
    v_sin_f32 v69, v83
    v_mul_f32 v68, v68, v82
    v_mul_f32 v69, v69, v82
    v_mul_f32 v84, v67, v69
    v_mul_f32 v85, v67, v68
    v_fma_f32 v68, v66, v68, -v84
    v_fma_f32 v69, -v66, v69, -v85
    v_mul_f32 v82, v64, v45
    v_mul_f32 v83, v65, v45
    v_exp_f32 v82, v82
    v_fract_f32 v83, v83
    v_cos_f32 v70, v83
    v_sin_f32 v71, v83
    v_mul_f32 v70, v70, v82
    v_mul_f32 v71, v71, v82
    v_mul_f32 v84, v67, v71
    v_mul_f32 v85, v67, v70
    v_fma_f32 v70, v66, v70, -v84
    v_fma_f32 v71, -v66, v71, -v85
    v_mul_f32 v82, v64, v46
    v_mul_f32 v83, v65, v46
    v_exp_f32 v82, v82
    v_fract_f32 v83, v83
    v_cos_f32 v72, v83
    v_sin_f32 v73, v83
    v_mul_f32 v72, v72, v82
    v_mul_f32 v73, v73, v82
    v_mul_f32 v84, v67, v73
    v_mul_f32 v85, v67, v72
    v_fma_f32 v72, v66, v72, -v84
    v_fma_f32 v73, -v66, v73, -v85
    v_mfma_f32_16x16x4_f32 v[48:51], v68, v74, v[48:51]
    v_mfma_f32_16x16x4_f32 v[52:55], v70, v76, v[52:55]
    v_mfma_f32_16x16x4_f32 v[56:59], v70, v78, v[56:59]
    v_mfma_f32_16x16x4_f32 v[60:63], v72, v80, v[60:63]
    v_mfma_f32_16x16x4_f32 v[48:51], v69, v75, v[48:51]
    v_mfma_f32_16x16x4_f32 v[52:55], v71, v77, v[52:55]
    v_mfma_f32_16x16x4_f32 v[56:59], v71, v79, v[56:59]
    v_mfma_f32_16x16x4_f32 v[60:63], v73, v81, v[60:63]
    v_mov_b32_dpp v64, v24 row_newbcast:15 row_mask:0xf bank_mask:0xf
    v_mov_b32_dpp v65, v25 row_newbcast:15 row_mask:0xf bank_mask:0xf
    v_mov_b32_dpp v66, v26 row_newbcast:15 row_mask:0xf bank_mask:0xf
    v_mov_b32_dpp v67, v27 row_newbcast:15 row_mask:0xf bank_mask:0xf
    v_mul_f32 v82, v64, v47
    v_mul_f32 v83, v65, v47
    v_exp_f32 v82, v82
    v_fract_f32 v83, v83
    v_cos_f32 v74, v83
    v_sin_f32 v75, v83
    v_mul_f32 v74, v74, v82
    v_mul_f32 v75, v75, v82
    v_mul_f32 v84, v75, v75
    v_add_f32 v85, v74, v74
    v_fma_f32 v76, v74, v74, -v84
    v_mul_f32 v77, v85, v75
    v_mul_f32 v84, v77, v77
    v_add_f32 v85, v76, v76
    v_fma_f32 v78, v76, v76, -v84
    v_mul_f32 v79, v85, v77
    v_mul_f32 v84, v79, v79
    v_add_f32 v85, v78, v78
    v_fma_f32 v80, v78, v78, -v84
    v_mul_f32 v81, v85, v79
    v_mul_f32 v82, v64, v44
    v_mul_f32 v83, v65, v44
    v_exp_f32 v82, v82
    v_fract_f32 v83, v83
    v_cos_f32 v68, v83
    v_sin_f32 v69, v83
    v_mul_f32 v68, v68, v82
    v_mul_f32 v69, v69, v82
    v_mul_f32 v84, v67, v69
    v_mul_f32 v85, v67, v68
    v_fma_f32 v68, v66, v68, -v84
    v_fma_f32 v69, -v66, v69, -v85
    v_mul_f32 v82, v64, v45
    v_mul_f32 v83, v65, v45
    v_exp_f32 v82, v82
    v_fract_f32 v83, v83
    v_cos_f32 v70, v83
    v_sin_f32 v71, v83
    v_mul_f32 v70, v70, v82
    v_mul_f32 v71, v71, v82
    v_mul_f32 v84, v67, v71
    v_mul_f32 v85, v67, v70
    v_fma_f32 v70, v66, v70, -v84
    v_fma_f32 v71, -v66, v71, -v85
    v_mul_f32 v82, v64, v46
    v_mul_f32 v83, v65, v46
    v_exp_f32 v82, v82
    v_fract_f32 v83, v83
    v_cos_f32 v72, v83
    v_sin_f32 v73, v83
    v_mul_f32 v72, v72, v82
    v_mul_f32 v73, v73, v82
    v_mul_f32 v84, v67, v73
    v_mul_f32 v85, v67, v72
    v_fma_f32 v72, v66, v72, -v84
    v_fma_f32 v73, -v66, v73, -v85
    v_mfma_f32_16x16x4_f32 v[48:51], v68, v74, v[48:51]
    v_mfma_f32_16x16x4_f32 v[52:55], v70, v76, v[52:55]
    v_mfma_f32_16x16x4_f32 v[56:59], v70, v78, v[56:59]
    v_mfma_f32_16x16x4_f32 v[60:63], v72, v80, v[60:63]
    v_mfma_f32_16x16x4_f32 v[48:51], v69, v75, v[48:51]
    v_mfma_f32_16x16x4_f32 v[52:55], v71, v77, v[52:55]
    v_mfma_f32_16x16x4_f32 v[56:59], v71, v79, v[56:59]
    v_mfma_f32_16x16x4_f32 v[60:63], v73, v81, v[60:63]
    v_mov_b32_dpp v64, v28 row_newbcast:0 row_mask:0xf bank_mask:0xf
    v_mov_b32_dpp v65, v29 row_newbcast:0 row_mask:0xf bank_mask:0xf
    v_mov_b32_dpp v66, v30 row_newbcast:0 row_mask:0xf bank_mask:0xf
    v_mov_b32_dpp v67, v31 row_newbcast:0 row_mask:0xf bank_mask:0xf
    v_mul_f32 v82, v64, v47
    v_mul_f32 v83, v65, v47
    v_exp_f32 v82, v82
    v_fract_f32 v83, v83
    v_cos_f32 v74, v83
    v_sin_f32 v75, v83
    v_mul_f32 v74, v74, v82
    v_mul_f32 v75, v75, v82
    v_mul_f32 v84, v75, v75
    v_add_f32 v85, v74, v74
    v_fma_f32 v76, v74, v74, -v84
    v_mul_f32 v77, v85, v75
    v_mul_f32 v84, v77, v77
    v_add_f32 v85, v76, v76
    v_fma_f32 v78, v76, v76, -v84
    v_mul_f32 v79, v85, v77
    v_mul_f32 v84, v79, v79
    v_add_f32 v85, v78, v78
    v_fma_f32 v80, v78, v78, -v84
    v_mul_f32 v81, v85, v79
    v_mul_f32 v82, v64, v44
    v_mul_f32 v83, v65, v44
    v_exp_f32 v82, v82
    v_fract_f32 v83, v83
    v_cos_f32 v68, v83
    v_sin_f32 v69, v83
    v_mul_f32 v68, v68, v82
    v_mul_f32 v69, v69, v82
    v_mul_f32 v84, v67, v69
    v_mul_f32 v85, v67, v68
    v_fma_f32 v68, v66, v68, -v84
    v_fma_f32 v69, -v66, v69, -v85
    v_mul_f32 v82, v64, v45
    v_mul_f32 v83, v65, v45
    v_exp_f32 v82, v82
    v_fract_f32 v83, v83
    v_cos_f32 v70, v83
    v_sin_f32 v71, v83
    v_mul_f32 v70, v70, v82
    v_mul_f32 v71, v71, v82
    v_mul_f32 v84, v67, v71
    v_mul_f32 v85, v67, v70
    v_fma_f32 v70, v66, v70, -v84
    v_fma_f32 v71, -v66, v71, -v85
    v_mul_f32 v82, v64, v46
    v_mul_f32 v83, v65, v46
    v_exp_f32 v82, v82
    v_fract_f32 v83, v83
    v_cos_f32 v72, v83
    v_sin_f32 v73, v83
    v_mul_f32 v72, v72, v82
    v_mul_f32 v73, v73, v82
    v_mul_f32 v84, v67, v73
    v_mul_f32 v85, v67, v72
    v_fma_f32 v72, v66, v72, -v84
    v_fma_f32 v73, -v66, v73, -v85
    v_mfma_f32_16x16x4_f32 v[48:51], v68, v74, v[48:51]
    v_mfma_f32_16x16x4_f32 v[52:55], v70, v76, v[52:55]
    v_mfma_f32_16x16x4_f32 v[56:59], v70, v78, v[56:59]
    v_mfma_f32_16x16x4_f32 v[60:63], v72, v80, v[60:63]
    v_mfma_f32_16x16x4_f32 v[48:51], v69, v75, v[48:51]
    v_mfma_f32_16x16x4_f32 v[52:55], v71, v77, v[52:55]
    v_mfma_f32_16x16x4_f32 v[56:59], v71, v79, v[56:59]
    v_mfma_f32_16x16x4_f32 v[60:63], v73, v81, v[60:63]
    v_mov_b32_dpp v64, v28 row_newbcast:1 row_mask:0xf bank_mask:0xf
    v_mov_b32_dpp v65, v29 row_newbcast:1 row_mask:0xf bank_mask:0xf
    v_mov_b32_dpp v66, v30 row_newbcast:1 row_mask:0xf bank_mask:0xf
    v_mov_b32_dpp v67, v31 row_newbcast:1 row_mask:0xf bank_mask:0xf
    v_mul_f32 v82, v64, v47
    v_mul_f32 v83, v65, v47
    v_exp_f32 v82, v82
    v_fract_f32 v83, v83
    v_cos_f32 v74, v83
    v_sin_f32 v75, v83
    v_mul_f32 v74, v74, v82
    v_mul_f32 v75, v75, v82
    v_mul_f32 v84, v75, v75
    v_add_f32 v85, v74, v74
    v_fma_f32 v76, v74, v74, -v84
    v_mul_f32 v77, v85, v75
    v_mul_f32 v84, v77, v77
    v_add_f32 v85, v76, v76
    v_fma_f32 v78, v76, v76, -v84
    v_mul_f32 v79, v85, v77
    v_mul_f32 v84, v79, v79
    v_add_f32 v85, v78, v78
    v_fma_f32 v80, v78, v78, -v84
    v_mul_f32 v81, v85, v79
    v_mul_f32 v82, v64, v44
    v_mul_f32 v83, v65, v44
    v_exp_f32 v82, v82
    v_fract_f32 v83, v83
    v_cos_f32 v68, v83
    v_sin_f32 v69, v83
    v_mul_f32 v68, v68, v82
    v_mul_f32 v69, v69, v82
    v_mul_f32 v84, v67, v69
    v_mul_f32 v85, v67, v68
    v_fma_f32 v68, v66, v68, -v84
    v_fma_f32 v69, -v66, v69, -v85
    v_mul_f32 v82, v64, v45
    v_mul_f32 v83, v65, v45
    v_exp_f32 v82, v82
    v_fract_f32 v83, v83
    v_cos_f32 v70, v83
    v_sin_f32 v71, v83
    v_mul_f32 v70, v70, v82
    v_mul_f32 v71, v71, v82
    v_mul_f32 v84, v67, v71
    v_mul_f32 v85, v67, v70
    v_fma_f32 v70, v66, v70, -v84
    v_fma_f32 v71, -v66, v71, -v85
    v_mul_f32 v82, v64, v46
    v_mul_f32 v83, v65, v46
    v_exp_f32 v82, v82
    v_fract_f32 v83, v83
    v_cos_f32 v72, v83
    v_sin_f32 v73, v83
    v_mul_f32 v72, v72, v82
    v_mul_f32 v73, v73, v82
    v_mul_f32 v84, v67, v73
    v_mul_f32 v85, v67, v72
    v_fma_f32 v72, v66, v72, -v84
    v_fma_f32 v73, -v66, v73, -v85
    v_mfma_f32_16x16x4_f32 v[48:51], v68, v74, v[48:51]
    v_mfma_f32_16x16x4_f32 v[52:55], v70, v76, v[52:55]
    v_mfma_f32_16x16x4_f32 v[56:59], v70, v78, v[56:59]
    v_mfma_f32_16x16x4_f32 v[60:63], v72, v80, v[60:63]
    v_mfma_f32_16x16x4_f32 v[48:51], v69, v75, v[48:51]
    v_mfma_f32_16x16x4_f32 v[52:55], v71, v77, v[52:55]
    v_mfma_f32_16x16x4_f32 v[56:59], v71, v79, v[56:59]
    v_mfma_f32_16x16x4_f32 v[60:63], v73, v81, v[60:63]
    v_mov_b32_dpp v64, v28 row_newbcast:2 row_mask:0xf bank_mask:0xf
    v_mov_b32_dpp v65, v29 row_newbcast:2 row_mask:0xf bank_mask:0xf
    v_mov_b32_dpp v66, v30 row_newbcast:2 row_mask:0xf bank_mask:0xf
    v_mov_b32_dpp v67, v31 row_newbcast:2 row_mask:0xf bank_mask:0xf
    v_mul_f32 v82, v64, v47
    v_mul_f32 v83, v65, v47
    v_exp_f32 v82, v82
    v_fract_f32 v83, v83
    v_cos_f32 v74, v83
    v_sin_f32 v75, v83
    v_mul_f32 v74, v74, v82
    v_mul_f32 v75, v75, v82
    v_mul_f32 v84, v75, v75
    v_add_f32 v85, v74, v74
    v_fma_f32 v76, v74, v74, -v84
    v_mul_f32 v77, v85, v75
    v_mul_f32 v84, v77, v77
    v_add_f32 v85, v76, v76
    v_fma_f32 v78, v76, v76, -v84
    v_mul_f32 v79, v85, v77
    v_mul_f32 v84, v79, v79
    v_add_f32 v85, v78, v78
    v_fma_f32 v80, v78, v78, -v84
    v_mul_f32 v81, v85, v79
    v_mul_f32 v82, v64, v44
    v_mul_f32 v83, v65, v44
    v_exp_f32 v82, v82
    v_fract_f32 v83, v83
    v_cos_f32 v68, v83
    v_sin_f32 v69, v83
    v_mul_f32 v68, v68, v82
    v_mul_f32 v69, v69, v82
    v_mul_f32 v84, v67, v69
    v_mul_f32 v85, v67, v68
    v_fma_f32 v68, v66, v68, -v84
    v_fma_f32 v69, -v66, v69, -v85
    v_mul_f32 v82, v64, v45
    v_mul_f32 v83, v65, v45
    v_exp_f32 v82, v82
    v_fract_f32 v83, v83
    v_cos_f32 v70, v83
    v_sin_f32 v71, v83
    v_mul_f32 v70, v70, v82
    v_mul_f32 v71, v71, v82
    v_mul_f32 v84, v67, v71
    v_mul_f32 v85, v67, v70
    v_fma_f32 v70, v66, v70, -v84
    v_fma_f32 v71, -v66, v71, -v85
    v_mul_f32 v82, v64, v46
    v_mul_f32 v83, v65, v46
    v_exp_f32 v82, v82
    v_fract_f32 v83, v83
    v_cos_f32 v72, v83
    v_sin_f32 v73, v83
    v_mul_f32 v72, v72, v82
    v_mul_f32 v73, v73, v82
    v_mul_f32 v84, v67, v73
    v_mul_f32 v85, v67, v72
    v_fma_f32 v72, v66, v72, -v84
    v_fma_f32 v73, -v66, v73, -v85
    v_mfma_f32_16x16x4_f32 v[48:51], v68, v74, v[48:51]
    v_mfma_f32_16x16x4_f32 v[52:55], v70, v76, v[52:55]
    v_mfma_f32_16x16x4_f32 v[56:59], v70, v78, v[56:59]
    v_mfma_f32_16x16x4_f32 v[60:63], v72, v80, v[60:63]
    v_mfma_f32_16x16x4_f32 v[48:51], v69, v75, v[48:51]
    v_mfma_f32_16x16x4_f32 v[52:55], v71, v77, v[52:55]
    v_mfma_f32_16x16x4_f32 v[56:59], v71, v79, v[56:59]
    v_mfma_f32_16x16x4_f32 v[60:63], v73, v81, v[60:63]
    v_mov_b32_dpp v64, v28 row_newbcast:3 row_mask:0xf bank_mask:0xf
    v_mov_b32_dpp v65, v29 row_newbcast:3 row_mask:0xf bank_mask:0xf
    v_mov_b32_dpp v66, v30 row_newbcast:3 row_mask:0xf bank_mask:0xf
    v_mov_b32_dpp v67, v31 row_newbcast:3 row_mask:0xf bank_mask:0xf
    v_mul_f32 v82, v64, v47
    v_mul_f32 v83, v65, v47
    v_exp_f32 v82, v82
    v_fract_f32 v83, v83
    v_cos_f32 v74, v83
    v_sin_f32 v75, v83
    v_mul_f32 v74, v74, v82
    v_mul_f32 v75, v75, v82
    v_mul_f32 v84, v75, v75
    v_add_f32 v85, v74, v74
    v_fma_f32 v76, v74, v74, -v84
    v_mul_f32 v77, v85, v75
    v_mul_f32 v84, v77, v77
    v_add_f32 v85, v76, v76
    v_fma_f32 v78, v76, v76, -v84
    v_mul_f32 v79, v85, v77
    v_mul_f32 v84, v79, v79
    v_add_f32 v85, v78, v78
    v_fma_f32 v80, v78, v78, -v84
    v_mul_f32 v81, v85, v79
    v_mul_f32 v82, v64, v44
    v_mul_f32 v83, v65, v44
    v_exp_f32 v82, v82
    v_fract_f32 v83, v83
    v_cos_f32 v68, v83
    v_sin_f32 v69, v83
    v_mul_f32 v68, v68, v82
    v_mul_f32 v69, v69, v82
    v_mul_f32 v84, v67, v69
    v_mul_f32 v85, v67, v68
    v_fma_f32 v68, v66, v68, -v84
    v_fma_f32 v69, -v66, v69, -v85
    v_mul_f32 v82, v64, v45
    v_mul_f32 v83, v65, v45
    v_exp_f32 v82, v82
    v_fract_f32 v83, v83
    v_cos_f32 v70, v83
    v_sin_f32 v71, v83
    v_mul_f32 v70, v70, v82
    v_mul_f32 v71, v71, v82
    v_mul_f32 v84, v67, v71
    v_mul_f32 v85, v67, v70
    v_fma_f32 v70, v66, v70, -v84
    v_fma_f32 v71, -v66, v71, -v85
    v_mul_f32 v82, v64, v46
    v_mul_f32 v83, v65, v46
    v_exp_f32 v82, v82
    v_fract_f32 v83, v83
    v_cos_f32 v72, v83
    v_sin_f32 v73, v83
    v_mul_f32 v72, v72, v82
    v_mul_f32 v73, v73, v82
    v_mul_f32 v84, v67, v73
    v_mul_f32 v85, v67, v72
    v_fma_f32 v72, v66, v72, -v84
    v_fma_f32 v73, -v66, v73, -v85
    v_mfma_f32_16x16x4_f32 v[48:51], v68, v74, v[48:51]
    v_mfma_f32_16x16x4_f32 v[52:55], v70, v76, v[52:55]
    v_mfma_f32_16x16x4_f32 v[56:59], v70, v78, v[56:59]
    v_mfma_f32_16x16x4_f32 v[60:63], v72, v80, v[60:63]
    v_mfma_f32_16x16x4_f32 v[48:51], v69, v75, v[48:51]
    v_mfma_f32_16x16x4_f32 v[52:55], v71, v77, v[52:55]
    v_mfma_f32_16x16x4_f32 v[56:59], v71, v79, v[56:59]
    v_mfma_f32_16x16x4_f32 v[60:63], v73, v81, v[60:63]
    v_mov_b32_dpp v64, v28 row_newbcast:4 row_mask:0xf bank_mask:0xf
    v_mov_b32_dpp v65, v29 row_newbcast:4 row_mask:0xf bank_mask:0xf
    v_mov_b32_dpp v66, v30 row_newbcast:4 row_mask:0xf bank_mask:0xf
    v_mov_b32_dpp v67, v31 row_newbcast:4 row_mask:0xf bank_mask:0xf
    v_mul_f32 v82, v64, v47
    v_mul_f32 v83, v65, v47
    v_exp_f32 v82, v82
    v_fract_f32 v83, v83
    v_cos_f32 v74, v83
    v_sin_f32 v75, v83
    v_mul_f32 v74, v74, v82
    v_mul_f32 v75, v75, v82
    v_mul_f32 v84, v75, v75
    v_add_f32 v85, v74, v74
    v_fma_f32 v76, v74, v74, -v84
    v_mul_f32 v77, v85, v75
    v_mul_f32 v84, v77, v77
    v_add_f32 v85, v76, v76
    v_fma_f32 v78, v76, v76, -v84
    v_mul_f32 v79, v85, v77
    v_mul_f32 v84, v79, v79
    v_add_f32 v85, v78, v78
    v_fma_f32 v80, v78, v78, -v84
    v_mul_f32 v81, v85, v79
    v_mul_f32 v82, v64, v44
    v_mul_f32 v83, v65, v44
    v_exp_f32 v82, v82
    v_fract_f32 v83, v83
    v_cos_f32 v68, v83
    v_sin_f32 v69, v83
    v_mul_f32 v68, v68, v82
    v_mul_f32 v69, v69, v82
    v_mul_f32 v84, v67, v69
    v_mul_f32 v85, v67, v68
    v_fma_f32 v68, v66, v68, -v84
    v_fma_f32 v69, -v66, v69, -v85
    v_mul_f32 v82, v64, v45
    v_mul_f32 v83, v65, v45
    v_exp_f32 v82, v82
    v_fract_f32 v83, v83
    v_cos_f32 v70, v83
    v_sin_f32 v71, v83
    v_mul_f32 v70, v70, v82
    v_mul_f32 v71, v71, v82
    v_mul_f32 v84, v67, v71
    v_mul_f32 v85, v67, v70
    v_fma_f32 v70, v66, v70, -v84
    v_fma_f32 v71, -v66, v71, -v85
    v_mul_f32 v82, v64, v46
    v_mul_f32 v83, v65, v46
    v_exp_f32 v82, v82
    v_fract_f32 v83, v83
    v_cos_f32 v72, v83
    v_sin_f32 v73, v83
    v_mul_f32 v72, v72, v82
    v_mul_f32 v73, v73, v82
    v_mul_f32 v84, v67, v73
    v_mul_f32 v85, v67, v72
    v_fma_f32 v72, v66, v72, -v84
    v_fma_f32 v73, -v66, v73, -v85
    v_mfma_f32_16x16x4_f32 v[48:51], v68, v74, v[48:51]
    v_mfma_f32_16x16x4_f32 v[52:55], v70, v76, v[52:55]
    v_mfma_f32_16x16x4_f32 v[56:59], v70, v78, v[56:59]
    v_mfma_f32_16x16x4_f32 v[60:63], v72, v80, v[60:63]
    v_mfma_f32_16x16x4_f32 v[48:51], v69, v75, v[48:51]
    v_mfma_f32_16x16x4_f32 v[52:55], v71, v77, v[52:55]
    v_mfma_f32_16x16x4_f32 v[56:59], v71, v79, v[56:59]
    v_mfma_f32_16x16x4_f32 v[60:63], v73, v81, v[60:63]
    v_mov_b32_dpp v64, v28 row_newbcast:5 row_mask:0xf bank_mask:0xf
    v_mov_b32_dpp v65, v29 row_newbcast:5 row_mask:0xf bank_mask:0xf
    v_mov_b32_dpp v66, v30 row_newbcast:5 row_mask:0xf bank_mask:0xf
    v_mov_b32_dpp v67, v31 row_newbcast:5 row_mask:0xf bank_mask:0xf
    v_mul_f32 v82, v64, v47
    v_mul_f32 v83, v65, v47
    v_exp_f32 v82, v82
    v_fract_f32 v83, v83
    v_cos_f32 v74, v83
    v_sin_f32 v75, v83
    v_mul_f32 v74, v74, v82
    v_mul_f32 v75, v75, v82
    v_mul_f32 v84, v75, v75
    v_add_f32 v85, v74, v74
    v_fma_f32 v76, v74, v74, -v84
    v_mul_f32 v77, v85, v75
    v_mul_f32 v84, v77, v77
    v_add_f32 v85, v76, v76
    v_fma_f32 v78, v76, v76, -v84
    v_mul_f32 v79, v85, v77
    v_mul_f32 v84, v79, v79
    v_add_f32 v85, v78, v78
    v_fma_f32 v80, v78, v78, -v84
    v_mul_f32 v81, v85, v79
    v_mul_f32 v82, v64, v44
    v_mul_f32 v83, v65, v44
    v_exp_f32 v82, v82
    v_fract_f32 v83, v83
    v_cos_f32 v68, v83
    v_sin_f32 v69, v83
    v_mul_f32 v68, v68, v82
    v_mul_f32 v69, v69, v82
    v_mul_f32 v84, v67, v69
    v_mul_f32 v85, v67, v68
    v_fma_f32 v68, v66, v68, -v84
    v_fma_f32 v69, -v66, v69, -v85
    v_mul_f32 v82, v64, v45
    v_mul_f32 v83, v65, v45
    v_exp_f32 v82, v82
    v_fract_f32 v83, v83
    v_cos_f32 v70, v83
    v_sin_f32 v71, v83
    v_mul_f32 v70, v70, v82
    v_mul_f32 v71, v71, v82
    v_mul_f32 v84, v67, v71
    v_mul_f32 v85, v67, v70
    v_fma_f32 v70, v66, v70, -v84
    v_fma_f32 v71, -v66, v71, -v85
    v_mul_f32 v82, v64, v46
    v_mul_f32 v83, v65, v46
    v_exp_f32 v82, v82
    v_fract_f32 v83, v83
    v_cos_f32 v72, v83
    v_sin_f32 v73, v83
    v_mul_f32 v72, v72, v82
    v_mul_f32 v73, v73, v82
    v_mul_f32 v84, v67, v73
    v_mul_f32 v85, v67, v72
    v_fma_f32 v72, v66, v72, -v84
    v_fma_f32 v73, -v66, v73, -v85
    v_mfma_f32_16x16x4_f32 v[48:51], v68, v74, v[48:51]
    v_mfma_f32_16x16x4_f32 v[52:55], v70, v76, v[52:55]
    v_mfma_f32_16x16x4_f32 v[56:59], v70, v78, v[56:59]
    v_mfma_f32_16x16x4_f32 v[60:63], v72, v80, v[60:63]
    v_mfma_f32_16x16x4_f32 v[48:51], v69, v75, v[48:51]
    v_mfma_f32_16x16x4_f32 v[52:55], v71, v77, v[52:55]
    v_mfma_f32_16x16x4_f32 v[56:59], v71, v79, v[56:59]
    v_mfma_f32_16x16x4_f32 v[60:63], v73, v81, v[60:63]
    v_mov_b32_dpp v64, v28 row_newbcast:6 row_mask:0xf bank_mask:0xf
    v_mov_b32_dpp v65, v29 row_newbcast:6 row_mask:0xf bank_mask:0xf
    v_mov_b32_dpp v66, v30 row_newbcast:6 row_mask:0xf bank_mask:0xf
    v_mov_b32_dpp v67, v31 row_newbcast:6 row_mask:0xf bank_mask:0xf
    v_mul_f32 v82, v64, v47
    v_mul_f32 v83, v65, v47
    v_exp_f32 v82, v82
    v_fract_f32 v83, v83
    v_cos_f32 v74, v83
    v_sin_f32 v75, v83
    v_mul_f32 v74, v74, v82
    v_mul_f32 v75, v75, v82
    v_mul_f32 v84, v75, v75
    v_add_f32 v85, v74, v74
    v_fma_f32 v76, v74, v74, -v84
    v_mul_f32 v77, v85, v75
    v_mul_f32 v84, v77, v77
    v_add_f32 v85, v76, v76
    v_fma_f32 v78, v76, v76, -v84
    v_mul_f32 v79, v85, v77
    v_mul_f32 v84, v79, v79
    v_add_f32 v85, v78, v78
    v_fma_f32 v80, v78, v78, -v84
    v_mul_f32 v81, v85, v79
    v_mul_f32 v82, v64, v44
    v_mul_f32 v83, v65, v44
    v_exp_f32 v82, v82
    v_fract_f32 v83, v83
    v_cos_f32 v68, v83
    v_sin_f32 v69, v83
    v_mul_f32 v68, v68, v82
    v_mul_f32 v69, v69, v82
    v_mul_f32 v84, v67, v69
    v_mul_f32 v85, v67, v68
    v_fma_f32 v68, v66, v68, -v84
    v_fma_f32 v69, -v66, v69, -v85
    v_mul_f32 v82, v64, v45
    v_mul_f32 v83, v65, v45
    v_exp_f32 v82, v82
    v_fract_f32 v83, v83
    v_cos_f32 v70, v83
    v_sin_f32 v71, v83
    v_mul_f32 v70, v70, v82
    v_mul_f32 v71, v71, v82
    v_mul_f32 v84, v67, v71
    v_mul_f32 v85, v67, v70
    v_fma_f32 v70, v66, v70, -v84
    v_fma_f32 v71, -v66, v71, -v85
    v_mul_f32 v82, v64, v46
    v_mul_f32 v83, v65, v46
    v_exp_f32 v82, v82
    v_fract_f32 v83, v83
    v_cos_f32 v72, v83
    v_sin_f32 v73, v83
    v_mul_f32 v72, v72, v82
    v_mul_f32 v73, v73, v82
    v_mul_f32 v84, v67, v73
    v_mul_f32 v85, v67, v72
    v_fma_f32 v72, v66, v72, -v84
    v_fma_f32 v73, -v66, v73, -v85
    v_mfma_f32_16x16x4_f32 v[48:51], v68, v74, v[48:51]
    v_mfma_f32_16x16x4_f32 v[52:55], v70, v76, v[52:55]
    v_mfma_f32_16x16x4_f32 v[56:59], v70, v78, v[56:59]
    v_mfma_f32_16x16x4_f32 v[60:63], v72, v80, v[60:63]
    v_mfma_f32_16x16x4_f32 v[48:51], v69, v75, v[48:51]
    v_mfma_f32_16x16x4_f32 v[52:55], v71, v77, v[52:55]
    v_mfma_f32_16x16x4_f32 v[56:59], v71, v79, v[56:59]
    v_mfma_f32_16x16x4_f32 v[60:63], v73, v81, v[60:63]
    v_mov_b32_dpp v64, v28 row_newbcast:7 row_mask:0xf bank_mask:0xf
    v_mov_b32_dpp v65, v29 row_newbcast:7 row_mask:0xf bank_mask:0xf
    v_mov_b32_dpp v66, v30 row_newbcast:7 row_mask:0xf bank_mask:0xf
    v_mov_b32_dpp v67, v31 row_newbcast:7 row_mask:0xf bank_mask:0xf
    v_mul_f32 v82, v64, v47
    v_mul_f32 v83, v65, v47
    v_exp_f32 v82, v82
    v_fract_f32 v83, v83
    v_cos_f32 v74, v83
    v_sin_f32 v75, v83
    v_mul_f32 v74, v74, v82
    v_mul_f32 v75, v75, v82
    v_mul_f32 v84, v75, v75
    v_add_f32 v85, v74, v74
    v_fma_f32 v76, v74, v74, -v84
    v_mul_f32 v77, v85, v75
    v_mul_f32 v84, v77, v77
    v_add_f32 v85, v76, v76
    v_fma_f32 v78, v76, v76, -v84
    v_mul_f32 v79, v85, v77
    v_mul_f32 v84, v79, v79
    v_add_f32 v85, v78, v78
    v_fma_f32 v80, v78, v78, -v84
    v_mul_f32 v81, v85, v79
    v_mul_f32 v82, v64, v44
    v_mul_f32 v83, v65, v44
    v_exp_f32 v82, v82
    v_fract_f32 v83, v83
    v_cos_f32 v68, v83
    v_sin_f32 v69, v83
    v_mul_f32 v68, v68, v82
    v_mul_f32 v69, v69, v82
    v_mul_f32 v84, v67, v69
    v_mul_f32 v85, v67, v68
    v_fma_f32 v68, v66, v68, -v84
    v_fma_f32 v69, -v66, v69, -v85
    v_mul_f32 v82, v64, v45
    v_mul_f32 v83, v65, v45
    v_exp_f32 v82, v82
    v_fract_f32 v83, v83
    v_cos_f32 v70, v83
    v_sin_f32 v71, v83
    v_mul_f32 v70, v70, v82
    v_mul_f32 v71, v71, v82
    v_mul_f32 v84, v67, v71
    v_mul_f32 v85, v67, v70
    v_fma_f32 v70, v66, v70, -v84
    v_fma_f32 v71, -v66, v71, -v85
    v_mul_f32 v82, v64, v46
    v_mul_f32 v83, v65, v46
    v_exp_f32 v82, v82
    v_fract_f32 v83, v83
    v_cos_f32 v72, v83
    v_sin_f32 v73, v83
    v_mul_f32 v72, v72, v82
    v_mul_f32 v73, v73, v82
    v_mul_f32 v84, v67, v73
    v_mul_f32 v85, v67, v72
    v_fma_f32 v72, v66, v72, -v84
    v_fma_f32 v73, -v66, v73, -v85
    v_mfma_f32_16x16x4_f32 v[48:51], v68, v74, v[48:51]
    v_mfma_f32_16x16x4_f32 v[52:55], v70, v76, v[52:55]
    v_mfma_f32_16x16x4_f32 v[56:59], v70, v78, v[56:59]
    v_mfma_f32_16x16x4_f32 v[60:63], v72, v80, v[60:63]
    v_mfma_f32_16x16x4_f32 v[48:51], v69, v75, v[48:51]
    v_mfma_f32_16x16x4_f32 v[52:55], v71, v77, v[52:55]
    v_mfma_f32_16x16x4_f32 v[56:59], v71, v79, v[56:59]
    v_mfma_f32_16x16x4_f32 v[60:63], v73, v81, v[60:63]
    v_mov_b32_dpp v64, v28 row_newbcast:8 row_mask:0xf bank_mask:0xf
    v_mov_b32_dpp v65, v29 row_newbcast:8 row_mask:0xf bank_mask:0xf
    v_mov_b32_dpp v66, v30 row_newbcast:8 row_mask:0xf bank_mask:0xf
    v_mov_b32_dpp v67, v31 row_newbcast:8 row_mask:0xf bank_mask:0xf
    v_mul_f32 v82, v64, v47
    v_mul_f32 v83, v65, v47
    v_exp_f32 v82, v82
    v_fract_f32 v83, v83
    v_cos_f32 v74, v83
    v_sin_f32 v75, v83
    v_mul_f32 v74, v74, v82
    v_mul_f32 v75, v75, v82
    v_mul_f32 v84, v75, v75
    v_add_f32 v85, v74, v74
    v_fma_f32 v76, v74, v74, -v84
    v_mul_f32 v77, v85, v75
    v_mul_f32 v84, v77, v77
    v_add_f32 v85, v76, v76
    v_fma_f32 v78, v76, v76, -v84
    v_mul_f32 v79, v85, v77
    v_mul_f32 v84, v79, v79
    v_add_f32 v85, v78, v78
    v_fma_f32 v80, v78, v78, -v84
    v_mul_f32 v81, v85, v79
    v_mul_f32 v82, v64, v44
    v_mul_f32 v83, v65, v44
    v_exp_f32 v82, v82
    v_fract_f32 v83, v83
    v_cos_f32 v68, v83
    v_sin_f32 v69, v83
    v_mul_f32 v68, v68, v82
    v_mul_f32 v69, v69, v82
    v_mul_f32 v84, v67, v69
    v_mul_f32 v85, v67, v68
    v_fma_f32 v68, v66, v68, -v84
    v_fma_f32 v69, -v66, v69, -v85
    v_mul_f32 v82, v64, v45
    v_mul_f32 v83, v65, v45
    v_exp_f32 v82, v82
    v_fract_f32 v83, v83
    v_cos_f32 v70, v83
    v_sin_f32 v71, v83
    v_mul_f32 v70, v70, v82
    v_mul_f32 v71, v71, v82
    v_mul_f32 v84, v67, v71
    v_mul_f32 v85, v67, v70
    v_fma_f32 v70, v66, v70, -v84
    v_fma_f32 v71, -v66, v71, -v85
    v_mul_f32 v82, v64, v46
    v_mul_f32 v83, v65, v46
    v_exp_f32 v82, v82
    v_fract_f32 v83, v83
    v_cos_f32 v72, v83
    v_sin_f32 v73, v83
    v_mul_f32 v72, v72, v82
    v_mul_f32 v73, v73, v82
    v_mul_f32 v84, v67, v73
    v_mul_f32 v85, v67, v72
    v_fma_f32 v72, v66, v72, -v84
    v_fma_f32 v73, -v66, v73, -v85
    v_mfma_f32_16x16x4_f32 v[48:51], v68, v74, v[48:51]
    v_mfma_f32_16x16x4_f32 v[52:55], v70, v76, v[52:55]
    v_mfma_f32_16x16x4_f32 v[56:59], v70, v78, v[56:59]
    v_mfma_f32_16x16x4_f32 v[60:63], v72, v80, v[60:63]
    v_mfma_f32_16x16x4_f32 v[48:51], v69, v75, v[48:51]
    v_mfma_f32_16x16x4_f32 v[52:55], v71, v77, v[52:55]
    v_mfma_f32_16x16x4_f32 v[56:59], v71, v79, v[56:59]
    v_mfma_f32_16x16x4_f32 v[60:63], v73, v81, v[60:63]
    v_mov_b32_dpp v64, v28 row_newbcast:9 row_mask:0xf bank_mask:0xf
    v_mov_b32_dpp v65, v29 row_newbcast:9 row_mask:0xf bank_mask:0xf
    v_mov_b32_dpp v66, v30 row_newbcast:9 row_mask:0xf bank_mask:0xf
    v_mov_b32_dpp v67, v31 row_newbcast:9 row_mask:0xf bank_mask:0xf
    v_mul_f32 v82, v64, v47
    v_mul_f32 v83, v65, v47
    v_exp_f32 v82, v82
    v_fract_f32 v83, v83
    v_cos_f32 v74, v83
    v_sin_f32 v75, v83
    v_mul_f32 v74, v74, v82
    v_mul_f32 v75, v75, v82
    v_mul_f32 v84, v75, v75
    v_add_f32 v85, v74, v74
    v_fma_f32 v76, v74, v74, -v84
    v_mul_f32 v77, v85, v75
    v_mul_f32 v84, v77, v77
    v_add_f32 v85, v76, v76
    v_fma_f32 v78, v76, v76, -v84
    v_mul_f32 v79, v85, v77
    v_mul_f32 v84, v79, v79
    v_add_f32 v85, v78, v78
    v_fma_f32 v80, v78, v78, -v84
    v_mul_f32 v81, v85, v79
    v_mul_f32 v82, v64, v44
    v_mul_f32 v83, v65, v44
    v_exp_f32 v82, v82
    v_fract_f32 v83, v83
    v_cos_f32 v68, v83
    v_sin_f32 v69, v83
    v_mul_f32 v68, v68, v82
    v_mul_f32 v69, v69, v82
    v_mul_f32 v84, v67, v69
    v_mul_f32 v85, v67, v68
    v_fma_f32 v68, v66, v68, -v84
    v_fma_f32 v69, -v66, v69, -v85
    v_mul_f32 v82, v64, v45
    v_mul_f32 v83, v65, v45
    v_exp_f32 v82, v82
    v_fract_f32 v83, v83
    v_cos_f32 v70, v83
    v_sin_f32 v71, v83
    v_mul_f32 v70, v70, v82
    v_mul_f32 v71, v71, v82
    v_mul_f32 v84, v67, v71
    v_mul_f32 v85, v67, v70
    v_fma_f32 v70, v66, v70, -v84
    v_fma_f32 v71, -v66, v71, -v85
    v_mul_f32 v82, v64, v46
    v_mul_f32 v83, v65, v46
    v_exp_f32 v82, v82
    v_fract_f32 v83, v83
    v_cos_f32 v72, v83
    v_sin_f32 v73, v83
    v_mul_f32 v72, v72, v82
    v_mul_f32 v73, v73, v82
    v_mul_f32 v84, v67, v73
    v_mul_f32 v85, v67, v72
    v_fma_f32 v72, v66, v72, -v84
    v_fma_f32 v73, -v66, v73, -v85
    v_mfma_f32_16x16x4_f32 v[48:51], v68, v74, v[48:51]
    v_mfma_f32_16x16x4_f32 v[52:55], v70, v76, v[52:55]
    v_mfma_f32_16x16x4_f32 v[56:59], v70, v78, v[56:59]
    v_mfma_f32_16x16x4_f32 v[60:63], v72, v80, v[60:63]
    v_mfma_f32_16x16x4_f32 v[48:51], v69, v75, v[48:51]
    v_mfma_f32_16x16x4_f32 v[52:55], v71, v77, v[52:55]
    v_mfma_f32_16x16x4_f32 v[56:59], v71, v79, v[56:59]
    v_mfma_f32_16x16x4_f32 v[60:63], v73, v81, v[60:63]
    v_mov_b32_dpp v64, v28 row_newbcast:10 row_mask:0xf bank_mask:0xf
    v_mov_b32_dpp v65, v29 row_newbcast:10 row_mask:0xf bank_mask:0xf
    v_mov_b32_dpp v66, v30 row_newbcast:10 row_mask:0xf bank_mask:0xf
    v_mov_b32_dpp v67, v31 row_newbcast:10 row_mask:0xf bank_mask:0xf
    v_mul_f32 v82, v64, v47
    v_mul_f32 v83, v65, v47
    v_exp_f32 v82, v82
    v_fract_f32 v83, v83
    v_cos_f32 v74, v83
    v_sin_f32 v75, v83
    v_mul_f32 v74, v74, v82
    v_mul_f32 v75, v75, v82
    v_mul_f32 v84, v75, v75
    v_add_f32 v85, v74, v74
    v_fma_f32 v76, v74, v74, -v84
    v_mul_f32 v77, v85, v75
    v_mul_f32 v84, v77, v77
    v_add_f32 v85, v76, v76
    v_fma_f32 v78, v76, v76, -v84
    v_mul_f32 v79, v85, v77
    v_mul_f32 v84, v79, v79
    v_add_f32 v85, v78, v78
    v_fma_f32 v80, v78, v78, -v84
    v_mul_f32 v81, v85, v79
    v_mul_f32 v82, v64, v44
    v_mul_f32 v83, v65, v44
    v_exp_f32 v82, v82
    v_fract_f32 v83, v83
    v_cos_f32 v68, v83
    v_sin_f32 v69, v83
    v_mul_f32 v68, v68, v82
    v_mul_f32 v69, v69, v82
    v_mul_f32 v84, v67, v69
    v_mul_f32 v85, v67, v68
    v_fma_f32 v68, v66, v68, -v84
    v_fma_f32 v69, -v66, v69, -v85
    v_mul_f32 v82, v64, v45
    v_mul_f32 v83, v65, v45
    v_exp_f32 v82, v82
    v_fract_f32 v83, v83
    v_cos_f32 v70, v83
    v_sin_f32 v71, v83
    v_mul_f32 v70, v70, v82
    v_mul_f32 v71, v71, v82
    v_mul_f32 v84, v67, v71
    v_mul_f32 v85, v67, v70
    v_fma_f32 v70, v66, v70, -v84
    v_fma_f32 v71, -v66, v71, -v85
    v_mul_f32 v82, v64, v46
    v_mul_f32 v83, v65, v46
    v_exp_f32 v82, v82
    v_fract_f32 v83, v83
    v_cos_f32 v72, v83
    v_sin_f32 v73, v83
    v_mul_f32 v72, v72, v82
    v_mul_f32 v73, v73, v82
    v_mul_f32 v84, v67, v73
    v_mul_f32 v85, v67, v72
    v_fma_f32 v72, v66, v72, -v84
    v_fma_f32 v73, -v66, v73, -v85
    v_mfma_f32_16x16x4_f32 v[48:51], v68, v74, v[48:51]
    v_mfma_f32_16x16x4_f32 v[52:55], v70, v76, v[52:55]
    v_mfma_f32_16x16x4_f32 v[56:59], v70, v78, v[56:59]
    v_mfma_f32_16x16x4_f32 v[60:63], v72, v80, v[60:63]
    v_mfma_f32_16x16x4_f32 v[48:51], v69, v75, v[48:51]
    v_mfma_f32_16x16x4_f32 v[52:55], v71, v77, v[52:55]
    v_mfma_f32_16x16x4_f32 v[56:59], v71, v79, v[56:59]
    v_mfma_f32_16x16x4_f32 v[60:63], v73, v81, v[60:63]
    v_mov_b32_dpp v64, v28 row_newbcast:11 row_mask:0xf bank_mask:0xf
    v_mov_b32_dpp v65, v29 row_newbcast:11 row_mask:0xf bank_mask:0xf
    v_mov_b32_dpp v66, v30 row_newbcast:11 row_mask:0xf bank_mask:0xf
    v_mov_b32_dpp v67, v31 row_newbcast:11 row_mask:0xf bank_mask:0xf
    v_mul_f32 v82, v64, v47
    v_mul_f32 v83, v65, v47
    v_exp_f32 v82, v82
    v_fract_f32 v83, v83
    v_cos_f32 v74, v83
    v_sin_f32 v75, v83
    v_mul_f32 v74, v74, v82
    v_mul_f32 v75, v75, v82
    v_mul_f32 v84, v75, v75
    v_add_f32 v85, v74, v74
    v_fma_f32 v76, v74, v74, -v84
    v_mul_f32 v77, v85, v75
    v_mul_f32 v84, v77, v77
    v_add_f32 v85, v76, v76
    v_fma_f32 v78, v76, v76, -v84
    v_mul_f32 v79, v85, v77
    v_mul_f32 v84, v79, v79
    v_add_f32 v85, v78, v78
    v_fma_f32 v80, v78, v78, -v84
    v_mul_f32 v81, v85, v79
    v_mul_f32 v82, v64, v44
    v_mul_f32 v83, v65, v44
    v_exp_f32 v82, v82
    v_fract_f32 v83, v83
    v_cos_f32 v68, v83
    v_sin_f32 v69, v83
    v_mul_f32 v68, v68, v82
    v_mul_f32 v69, v69, v82
    v_mul_f32 v84, v67, v69
    v_mul_f32 v85, v67, v68
    v_fma_f32 v68, v66, v68, -v84
    v_fma_f32 v69, -v66, v69, -v85
    v_mul_f32 v82, v64, v45
    v_mul_f32 v83, v65, v45
    v_exp_f32 v82, v82
    v_fract_f32 v83, v83
    v_cos_f32 v70, v83
    v_sin_f32 v71, v83
    v_mul_f32 v70, v70, v82
    v_mul_f32 v71, v71, v82
    v_mul_f32 v84, v67, v71
    v_mul_f32 v85, v67, v70
    v_fma_f32 v70, v66, v70, -v84
    v_fma_f32 v71, -v66, v71, -v85
    v_mul_f32 v82, v64, v46
    v_mul_f32 v83, v65, v46
    v_exp_f32 v82, v82
    v_fract_f32 v83, v83
    v_cos_f32 v72, v83
    v_sin_f32 v73, v83
    v_mul_f32 v72, v72, v82
    v_mul_f32 v73, v73, v82
    v_mul_f32 v84, v67, v73
    v_mul_f32 v85, v67, v72
    v_fma_f32 v72, v66, v72, -v84
    v_fma_f32 v73, -v66, v73, -v85
    v_mfma_f32_16x16x4_f32 v[48:51], v68, v74, v[48:51]
    v_mfma_f32_16x16x4_f32 v[52:55], v70, v76, v[52:55]
    v_mfma_f32_16x16x4_f32 v[56:59], v70, v78, v[56:59]
    v_mfma_f32_16x16x4_f32 v[60:63], v72, v80, v[60:63]
    v_mfma_f32_16x16x4_f32 v[48:51], v69, v75, v[48:51]
    v_mfma_f32_16x16x4_f32 v[52:55], v71, v77, v[52:55]
    v_mfma_f32_16x16x4_f32 v[56:59], v71, v79, v[56:59]
    v_mfma_f32_16x16x4_f32 v[60:63], v73, v81, v[60:63]
    v_mov_b32_dpp v64, v28 row_newbcast:12 row_mask:0xf bank_mask:0xf
    v_mov_b32_dpp v65, v29 row_newbcast:12 row_mask:0xf bank_mask:0xf
    v_mov_b32_dpp v66, v30 row_newbcast:12 row_mask:0xf bank_mask:0xf
    v_mov_b32_dpp v67, v31 row_newbcast:12 row_mask:0xf bank_mask:0xf
    v_mul_f32 v82, v64, v47
    v_mul_f32 v83, v65, v47
    v_exp_f32 v82, v82
    v_fract_f32 v83, v83
    v_cos_f32 v74, v83
    v_sin_f32 v75, v83
    v_mul_f32 v74, v74, v82
    v_mul_f32 v75, v75, v82
    v_mul_f32 v84, v75, v75
    v_add_f32 v85, v74, v74
    v_fma_f32 v76, v74, v74, -v84
    v_mul_f32 v77, v85, v75
    v_mul_f32 v84, v77, v77
    v_add_f32 v85, v76, v76
    v_fma_f32 v78, v76, v76, -v84
    v_mul_f32 v79, v85, v77
    v_mul_f32 v84, v79, v79
    v_add_f32 v85, v78, v78
    v_fma_f32 v80, v78, v78, -v84
    v_mul_f32 v81, v85, v79
    v_mul_f32 v82, v64, v44
    v_mul_f32 v83, v65, v44
    v_exp_f32 v82, v82
    v_fract_f32 v83, v83
    v_cos_f32 v68, v83
    v_sin_f32 v69, v83
    v_mul_f32 v68, v68, v82
    v_mul_f32 v69, v69, v82
    v_mul_f32 v84, v67, v69
    v_mul_f32 v85, v67, v68
    v_fma_f32 v68, v66, v68, -v84
    v_fma_f32 v69, -v66, v69, -v85
    v_mul_f32 v82, v64, v45
    v_mul_f32 v83, v65, v45
    v_exp_f32 v82, v82
    v_fract_f32 v83, v83
    v_cos_f32 v70, v83
    v_sin_f32 v71, v83
    v_mul_f32 v70, v70, v82
    v_mul_f32 v71, v71, v82
    v_mul_f32 v84, v67, v71
    v_mul_f32 v85, v67, v70
    v_fma_f32 v70, v66, v70, -v84
    v_fma_f32 v71, -v66, v71, -v85
    v_mul_f32 v82, v64, v46
    v_mul_f32 v83, v65, v46
    v_exp_f32 v82, v82
    v_fract_f32 v83, v83
    v_cos_f32 v72, v83
    v_sin_f32 v73, v83
    v_mul_f32 v72, v72, v82
    v_mul_f32 v73, v73, v82
    v_mul_f32 v84, v67, v73
    v_mul_f32 v85, v67, v72
    v_fma_f32 v72, v66, v72, -v84
    v_fma_f32 v73, -v66, v73, -v85
    v_mfma_f32_16x16x4_f32 v[48:51], v68, v74, v[48:51]
    v_mfma_f32_16x16x4_f32 v[52:55], v70, v76, v[52:55]
    v_mfma_f32_16x16x4_f32 v[56:59], v70, v78, v[56:59]
    v_mfma_f32_16x16x4_f32 v[60:63], v72, v80, v[60:63]
    v_mfma_f32_16x16x4_f32 v[48:51], v69, v75, v[48:51]
    v_mfma_f32_16x16x4_f32 v[52:55], v71, v77, v[52:55]
    v_mfma_f32_16x16x4_f32 v[56:59], v71, v79, v[56:59]
    v_mfma_f32_16x16x4_f32 v[60:63], v73, v81, v[60:63]
    v_mov_b32_dpp v64, v28 row_newbcast:13 row_mask:0xf bank_mask:0xf
    v_mov_b32_dpp v65, v29 row_newbcast:13 row_mask:0xf bank_mask:0xf
    v_mov_b32_dpp v66, v30 row_newbcast:13 row_mask:0xf bank_mask:0xf
    v_mov_b32_dpp v67, v31 row_newbcast:13 row_mask:0xf bank_mask:0xf
    v_mul_f32 v82, v64, v47
    v_mul_f32 v83, v65, v47
    v_exp_f32 v82, v82
    v_fract_f32 v83, v83
    v_cos_f32 v74, v83
    v_sin_f32 v75, v83
    v_mul_f32 v74, v74, v82
    v_mul_f32 v75, v75, v82
    v_mul_f32 v84, v75, v75
    v_add_f32 v85, v74, v74
    v_fma_f32 v76, v74, v74, -v84
    v_mul_f32 v77, v85, v75
    v_mul_f32 v84, v77, v77
    v_add_f32 v85, v76, v76
    v_fma_f32 v78, v76, v76, -v84
    v_mul_f32 v79, v85, v77
    v_mul_f32 v84, v79, v79
    v_add_f32 v85, v78, v78
    v_fma_f32 v80, v78, v78, -v84
    v_mul_f32 v81, v85, v79
    v_mul_f32 v82, v64, v44
    v_mul_f32 v83, v65, v44
    v_exp_f32 v82, v82
    v_fract_f32 v83, v83
    v_cos_f32 v68, v83
    v_sin_f32 v69, v83
    v_mul_f32 v68, v68, v82
    v_mul_f32 v69, v69, v82
    v_mul_f32 v84, v67, v69
    v_mul_f32 v85, v67, v68
    v_fma_f32 v68, v66, v68, -v84
    v_fma_f32 v69, -v66, v69, -v85
    v_mul_f32 v82, v64, v45
    v_mul_f32 v83, v65, v45
    v_exp_f32 v82, v82
    v_fract_f32 v83, v83
    v_cos_f32 v70, v83
    v_sin_f32 v71, v83
    v_mul_f32 v70, v70, v82
    v_mul_f32 v71, v71, v82
    v_mul_f32 v84, v67, v71
    v_mul_f32 v85, v67, v70
    v_fma_f32 v70, v66, v70, -v84
    v_fma_f32 v71, -v66, v71, -v85
    v_mul_f32 v82, v64, v46
    v_mul_f32 v83, v65, v46
    v_exp_f32 v82, v82
    v_fract_f32 v83, v83
    v_cos_f32 v72, v83
    v_sin_f32 v73, v83
    v_mul_f32 v72, v72, v82
    v_mul_f32 v73, v73, v82
    v_mul_f32 v84, v67, v73
    v_mul_f32 v85, v67, v72
    v_fma_f32 v72, v66, v72, -v84
    v_fma_f32 v73, -v66, v73, -v85
    v_mfma_f32_16x16x4_f32 v[48:51], v68, v74, v[48:51]
    v_mfma_f32_16x16x4_f32 v[52:55], v70, v76, v[52:55]
    v_mfma_f32_16x16x4_f32 v[56:59], v70, v78, v[56:59]
    v_mfma_f32_16x16x4_f32 v[60:63], v72, v80, v[60:63]
    v_mfma_f32_16x16x4_f32 v[48:51], v69, v75, v[48:51]
    v_mfma_f32_16x16x4_f32 v[52:55], v71, v77, v[52:55]
    v_mfma_f32_16x16x4_f32 v[56:59], v71, v79, v[56:59]
    v_mfma_f32_16x16x4_f32 v[60:63], v73, v81, v[60:63]
    v_mov_b32_dpp v64, v28 row_newbcast:14 row_mask:0xf bank_mask:0xf
    v_mov_b32_dpp v65, v29 row_newbcast:14 row_mask:0xf bank_mask:0xf
    v_mov_b32_dpp v66, v30 row_newbcast:14 row_mask:0xf bank_mask:0xf
    v_mov_b32_dpp v67, v31 row_newbcast:14 row_mask:0xf bank_mask:0xf
    v_mul_f32 v82, v64, v47
    v_mul_f32 v83, v65, v47
    v_exp_f32 v82, v82
    v_fract_f32 v83, v83
    v_cos_f32 v74, v83
    v_sin_f32 v75, v83
    v_mul_f32 v74, v74, v82
    v_mul_f32 v75, v75, v82
    v_mul_f32 v84, v75, v75
    v_add_f32 v85, v74, v74
    v_fma_f32 v76, v74, v74, -v84
    v_mul_f32 v77, v85, v75
    v_mul_f32 v84, v77, v77
    v_add_f32 v85, v76, v76
    v_fma_f32 v78, v76, v76, -v84
    v_mul_f32 v79, v85, v77
    v_mul_f32 v84, v79, v79
    v_add_f32 v85, v78, v78
    v_fma_f32 v80, v78, v78, -v84
    v_mul_f32 v81, v85, v79
    v_mul_f32 v82, v64, v44
    v_mul_f32 v83, v65, v44
    v_exp_f32 v82, v82
    v_fract_f32 v83, v83
    v_cos_f32 v68, v83
    v_sin_f32 v69, v83
    v_mul_f32 v68, v68, v82
    v_mul_f32 v69, v69, v82
    v_mul_f32 v84, v67, v69
    v_mul_f32 v85, v67, v68
    v_fma_f32 v68, v66, v68, -v84
    v_fma_f32 v69, -v66, v69, -v85
    v_mul_f32 v82, v64, v45
    v_mul_f32 v83, v65, v45
    v_exp_f32 v82, v82
    v_fract_f32 v83, v83
    v_cos_f32 v70, v83
    v_sin_f32 v71, v83
    v_mul_f32 v70, v70, v82
    v_mul_f32 v71, v71, v82
    v_mul_f32 v84, v67, v71
    v_mul_f32 v85, v67, v70
    v_fma_f32 v70, v66, v70, -v84
    v_fma_f32 v71, -v66, v71, -v85
    v_mul_f32 v82, v64, v46
    v_mul_f32 v83, v65, v46
    v_exp_f32 v82, v82
    v_fract_f32 v83, v83
    v_cos_f32 v72, v83
    v_sin_f32 v73, v83
    v_mul_f32 v72, v72, v82
    v_mul_f32 v73, v73, v82
    v_mul_f32 v84, v67, v73
    v_mul_f32 v85, v67, v72
    v_fma_f32 v72, v66, v72, -v84
    v_fma_f32 v73, -v66, v73, -v85
    v_mfma_f32_16x16x4_f32 v[48:51], v68, v74, v[48:51]
    v_mfma_f32_16x16x4_f32 v[52:55], v70, v76, v[52:55]
    v_mfma_f32_16x16x4_f32 v[56:59], v70, v78, v[56:59]
    v_mfma_f32_16x16x4_f32 v[60:63], v72, v80, v[60:63]
    v_mfma_f32_16x16x4_f32 v[48:51], v69, v75, v[48:51]
    v_mfma_f32_16x16x4_f32 v[52:55], v71, v77, v[52:55]
    v_mfma_f32_16x16x4_f32 v[56:59], v71, v79, v[56:59]
    v_mfma_f32_16x16x4_f32 v[60:63], v73, v81, v[60:63]
    v_mov_b32_dpp v64, v28 row_newbcast:15 row_mask:0xf bank_mask:0xf
    v_mov_b32_dpp v65, v29 row_newbcast:15 row_mask:0xf bank_mask:0xf
    v_mov_b32_dpp v66, v30 row_newbcast:15 row_mask:0xf bank_mask:0xf
    v_mov_b32_dpp v67, v31 row_newbcast:15 row_mask:0xf bank_mask:0xf
    v_mul_f32 v82, v64, v47
    v_mul_f32 v83, v65, v47
    v_exp_f32 v82, v82
    v_fract_f32 v83, v83
    v_cos_f32 v74, v83
    v_sin_f32 v75, v83
    v_mul_f32 v74, v74, v82
    v_mul_f32 v75, v75, v82
    v_mul_f32 v84, v75, v75
    v_add_f32 v85, v74, v74
    v_fma_f32 v76, v74, v74, -v84
    v_mul_f32 v77, v85, v75
    v_mul_f32 v84, v77, v77
    v_add_f32 v85, v76, v76
    v_fma_f32 v78, v76, v76, -v84
    v_mul_f32 v79, v85, v77
    v_mul_f32 v84, v79, v79
    v_add_f32 v85, v78, v78
    v_fma_f32 v80, v78, v78, -v84
    v_mul_f32 v81, v85, v79
    v_mul_f32 v82, v64, v44
    v_mul_f32 v83, v65, v44
    v_exp_f32 v82, v82
    v_fract_f32 v83, v83
    v_cos_f32 v68, v83
    v_sin_f32 v69, v83
    v_mul_f32 v68, v68, v82
    v_mul_f32 v69, v69, v82
    v_mul_f32 v84, v67, v69
    v_mul_f32 v85, v67, v68
    v_fma_f32 v68, v66, v68, -v84
    v_fma_f32 v69, -v66, v69, -v85
    v_mul_f32 v82, v64, v45
    v_mul_f32 v83, v65, v45
    v_exp_f32 v82, v82
    v_fract_f32 v83, v83
    v_cos_f32 v70, v83
    v_sin_f32 v71, v83
    v_mul_f32 v70, v70, v82
    v_mul_f32 v71, v71, v82
    v_mul_f32 v84, v67, v71
    v_mul_f32 v85, v67, v70
    v_fma_f32 v70, v66, v70, -v84
    v_fma_f32 v71, -v66, v71, -v85
    v_mul_f32 v82, v64, v46
    v_mul_f32 v83, v65, v46
    v_exp_f32 v82, v82
    v_fract_f32 v83, v83
    v_cos_f32 v72, v83
    v_sin_f32 v73, v83
    v_mul_f32 v72, v72, v82
    v_mul_f32 v73, v73, v82
    v_mul_f32 v84, v67, v73
    v_mul_f32 v85, v67, v72
    v_fma_f32 v72, v66, v72, -v84
    v_fma_f32 v73, -v66, v73, -v85
    v_mfma_f32_16x16x4_f32 v[48:51], v68, v74, v[48:51]
    v_mfma_f32_16x16x4_f32 v[52:55], v70, v76, v[52:55]
    v_mfma_f32_16x16x4_f32 v[56:59], v70, v78, v[56:59]
    v_mfma_f32_16x16x4_f32 v[60:63], v72, v80, v[60:63]
    v_mfma_f32_16x16x4_f32 v[48:51], v69, v75, v[48:51]
    v_mfma_f32_16x16x4_f32 v[52:55], v71, v77, v[52:55]
    v_mfma_f32_16x16x4_f32 v[56:59], v71, v79, v[56:59]
    v_mfma_f32_16x16x4_f32 v[60:63], v73, v81, v[60:63]
    v_lshlrev_b32 v5, 8, v3
    v_lshl_add_u32 v5, v2, 2, v5
    v_add_u32 v5, v5, v4
    ds_write_b32 v5, v48 offset:4608
    ds_write_b32 v5, v49 offset:4672
    ds_write_b32 v5, v50 offset:4736
    ds_write_b32 v5, v51 offset:4800
    v_cmp_gt_u32 vcc, 2, v3
    s_nop 0
    s_mov_b64 exec, vcc
    ds_write_b32 v5, v52 offset:5632
    ds_write_b32 v5, v53 offset:5696
    ds_write_b32 v5, v54 offset:5760
    ds_write_b32 v5, v55 offset:5824
    ds_write_b32 v5, v60 offset:6656
    ds_write_b32 v5, v61 offset:6720
    ds_write_b32 v5, v62 offset:6784
    ds_write_b32 v5, v63 offset:6848
    s_not_b64 exec, exec
    ds_write_b32 v5, v56 offset:5632
    ds_write_b32 v5, v57 offset:5696
    ds_write_b32 v5, v58 offset:5760
    ds_write_b32 v5, v59 offset:5824
    s_mov_b32 exec_lo, 0
    s_mov_b32 exec_hi, 3
    v_cmp_eq_u32 vcc, 0, v2
    s_nop 1
    v_cndmask_b32 v6, 0, v60, vcc
    ds_write_b32 v5, v6 offset:6656
    s_mov_b64 exec, -1
    s_waitcnt lgkmcnt(0)
    v_lshlrev_b32 v7, 1, v1
    v_sub_u32 v7, 2065, v7
    v_lshl_add_u32 v64, v1, 2, v4
    v_mov_b32 v65, 641
    s_mov_b32 s25, 17
ss_exp:
    v_subrev_u32 v66, 0, v7
    v_cvt_f32_u32 v70, v66
    v_cvt_pk_bf16_f32 v70, v70, v70
    v_and_b32 v70, 0xffff, v70
    v_subrev_u32 v70, 0x4280, v70
    v_cmp_gt_u32 vcc, 256, v66
    s_nop 1
    v_cndmask_b32 v70, v70, v66, vcc
    v_cmp_gt_u32 vcc, 2048, v66
    s_nop 1
    v_cndmask_b32 v70, v65, v70, vcc
    v_lshl_add_u32 v70, v70, 2, v4
    ds_read_b32 v74, v70 offset:4608
    v_subrev_u32 v67, 1, v7
    v_cvt_f32_u32 v71, v67
    v_cvt_pk_bf16_f32 v71, v71, v71
    v_and_b32 v71, 0xffff, v71
    v_subrev_u32 v71, 0x4280, v71
    v_cmp_gt_u32 vcc, 256, v67
    s_nop 1
    v_cndmask_b32 v71, v71, v67, vcc
    v_cmp_gt_u32 vcc, 2048, v67
    s_nop 1
    v_cndmask_b32 v71, v65, v71, vcc
    v_lshl_add_u32 v71, v71, 2, v4
    ds_read_b32 v75, v71 offset:4608
    v_subrev_u32 v68, 2, v7
    v_cvt_f32_u32 v72, v68
    v_cvt_pk_bf16_f32 v72, v72, v72
    v_and_b32 v72, 0xffff, v72
    v_subrev_u32 v72, 0x4280, v72
    v_cmp_gt_u32 vcc, 256, v68
    s_nop 1
    v_cndmask_b32 v72, v72, v68, vcc
    v_cmp_gt_u32 vcc, 2048, v68
    s_nop 1
    v_cndmask_b32 v72, v65, v72, vcc
    v_lshl_add_u32 v72, v72, 2, v4
    ds_read_b32 v76, v72 offset:4608
    s_waitcnt lgkmcnt(0)
    v_cvt_pk_bf16_f32 v78, v75, v76
    v_cvt_pk_bf16_f32 v79, v74, v75
    ds_write_b32 v64, v78 offset:7424
    ds_write_b32 v64, v79 offset:11776
    v_subrev_u32 v7, 128, v7
    v_add_u32 v64, 256, v64
    s_sub_u32 s25, s25, 1
    s_cmp_lg_u32 s25, 0
    s_cbranch_scc1 ss_exp
    s_waitcnt lgkmcnt(0)
    s_barrier
    v_and_b32 v5, 1, v2
    v_mul_u32_u24 v64, 4352, v5
    v_sub_u32 v5, v5, v2
    v_lshl_add_u32 v5, v3, 3, v5
    v_lshl_add_u32 v64, v5, 1, v64
    v_add_u32 v64, 11520, v64
    v_add_u32 v64, v64, v4
    v_lshlrev_b32 v65, 5, v2
    v_lshl_add_u32 v65, v3, 4, v65
    v_add_u32 v65, 480, v65
    v_add_u32 v65, v65, v4
    v_mov_b32 v96, 0
    v_mov_b32 v97, 0
    v_mov_b32 v98, 0
    v_mov_b32 v99, 0
    v_mov_b32 v100, 0
    v_mov_b32 v101, 0
    v_mov_b32 v102, 0
    v_mov_b32 v103, 0
    v_mov_b32 v104, 0
    v_mov_b32 v105, 0
    v_mov_b32 v106, 0
    v_mov_b32 v107, 0
    v_mov_b32 v108, 0
    v_mov_b32 v109, 0
    v_mov_b32 v110, 0
    v_mov_b32 v111, 0
    v_mov_b32 v112, 0
    v_mov_b32 v113, 0
    v_mov_b32 v114, 0
    v_mov_b32 v115, 0
    v_mov_b32 v116, 0
    v_mov_b32 v117, 0
    v_mov_b32 v118, 0
    v_mov_b32 v119, 0
    v_mov_b32 v120, 0
    v_mov_b32 v121, 0
    v_mov_b32 v122, 0
    v_mov_b32 v123, 0
    v_mov_b32 v124, 0
    v_mov_b32 v125, 0
    v_mov_b32 v126, 0
    v_mov_b32 v127, 0
    s_mov_b32 s25, 8
ss_cv0:
    ds_read2_b32 v[68:69], v64 offset0:0 offset1:1
    ds_read2_b32 v[70:71], v64 offset0:2 offset1:3
    ds_read_b128 v[128:131], v65 offset:0
    ds_read_b128 v[132:135], v65 offset:512
    ds_read_b128 v[136:139], v65 offset:1024
    ds_read_b128 v[140:143], v65 offset:1536
    ds_read_b128 v[144:147], v65 offset:2048
    ds_read_b128 v[148:151], v65 offset:2560
    ds_read_b128 v[152:155], v65 offset:3072
    ds_read_b128 v[156:159], v65 offset:3584
    v_subrev_u32 v64, 64, v64
    v_subrev_u32 v65, 64, v65
    s_waitcnt lgkmcnt(7)
    v_mfma_f32_16x16x32_bf16 v[96:99], v[68:71], v[128:131], v[96:99]
    s_waitcnt lgkmcnt(6)
    v_mfma_f32_16x16x32_bf16 v[100:103], v[68:71], v[132:135], v[100:103]
    s_waitcnt lgkmcnt(5)
    v_mfma_f32_16x16x32_bf16 v[104:107], v[68:71], v[136:139], v[104:107]
    s_waitcnt lgkmcnt(4)
    v_mfma_f32_16x16x32_bf16 v[108:111], v[68:71], v[140:143], v[108:111]
    s_waitcnt lgkmcnt(3)
    v_mfma_f32_16x16x32_bf16 v[112:115], v[68:71], v[144:147], v[112:115]
    s_waitcnt lgkmcnt(2)
    v_mfma_f32_16x16x32_bf16 v[116:119], v[68:71], v[148:151], v[116:119]
    s_waitcnt lgkmcnt(1)
    v_mfma_f32_16x16x32_bf16 v[120:123], v[68:71], v[152:155], v[120:123]
    s_waitcnt lgkmcnt(0)
    v_mfma_f32_16x16x32_bf16 v[124:127], v[68:71], v[156:159], v[124:127]
    s_sub_u32 s25, s25, 1
    s_cmp_lg_u32 s25, 0
    s_cbranch_scc1 ss_cv0
    v_add_u32 v65, 512, v65
    s_mov_b32 s25, 8
ss_cv1:
    ds_read2_b32 v[68:69], v64 offset0:0 offset1:1
    ds_read2_b32 v[70:71], v64 offset0:2 offset1:3
    ds_read_b128 v[132:135], v65 offset:0
    ds_read_b128 v[136:139], v65 offset:512
    ds_read_b128 v[140:143], v65 offset:1024
    ds_read_b128 v[144:147], v65 offset:1536
    ds_read_b128 v[148:151], v65 offset:2048
    ds_read_b128 v[152:155], v65 offset:2560
    ds_read_b128 v[156:159], v65 offset:3072
    v_subrev_u32 v64, 64, v64
    v_subrev_u32 v65, 64, v65
    s_waitcnt lgkmcnt(6)
    v_mfma_f32_16x16x32_bf16 v[100:103], v[68:71], v[132:135], v[100:103]
    s_waitcnt lgkmcnt(5)
    v_mfma_f32_16x16x32_bf16 v[104:107], v[68:71], v[136:139], v[104:107]
    s_waitcnt lgkmcnt(4)
    v_mfma_f32_16x16x32_bf16 v[108:111], v[68:71], v[140:143], v[108:111]
    s_waitcnt lgkmcnt(3)
    v_mfma_f32_16x16x32_bf16 v[112:115], v[68:71], v[144:147], v[112:115]
    s_waitcnt lgkmcnt(2)
    v_mfma_f32_16x16x32_bf16 v[116:119], v[68:71], v[148:151], v[116:119]
    s_waitcnt lgkmcnt(1)
    v_mfma_f32_16x16x32_bf16 v[120:123], v[68:71], v[152:155], v[120:123]
    s_waitcnt lgkmcnt(0)
    v_mfma_f32_16x16x32_bf16 v[124:127], v[68:71], v[156:159], v[124:127]
    s_sub_u32 s25, s25, 1
    s_cmp_lg_u32 s25, 0
    s_cbranch_scc1 ss_cv1
    v_add_u32 v65, 512, v65
    s_mov_b32 s25, 8
ss_cv2:
    ds_read2_b32 v[68:69], v64 offset0:0 offset1:1
    ds_read2_b32 v[70:71], v64 offset0:2 offset1:3
    ds_read_b128 v[136:139], v65 offset:0
    ds_read_b128 v[140:143], v65 offset:512
    ds_read_b128 v[144:147], v65 offset:1024
    ds_read_b128 v[148:151], v65 offset:1536
    ds_read_b128 v[152:155], v65 offset:2048
    ds_read_b128 v[156:159], v65 offset:2560
    v_subrev_u32 v64, 64, v64
    v_subrev_u32 v65, 64, v65
    s_waitcnt lgkmcnt(5)
    v_mfma_f32_16x16x32_bf16 v[104:107], v[68:71], v[136:139], v[104:107]
    s_waitcnt lgkmcnt(4)
    v_mfma_f32_16x16x32_bf16 v[108:111], v[68:71], v[140:143], v[108:111]
    s_waitcnt lgkmcnt(3)
    v_mfma_f32_16x16x32_bf16 v[112:115], v[68:71], v[144:147], v[112:115]
    s_waitcnt lgkmcnt(2)
    v_mfma_f32_16x16x32_bf16 v[116:119], v[68:71], v[148:151], v[116:119]
    s_waitcnt lgkmcnt(1)
    v_mfma_f32_16x16x32_bf16 v[120:123], v[68:71], v[152:155], v[120:123]
    s_waitcnt lgkmcnt(0)
    v_mfma_f32_16x16x32_bf16 v[124:127], v[68:71], v[156:159], v[124:127]
    s_sub_u32 s25, s25, 1
    s_cmp_lg_u32 s25, 0
    s_cbranch_scc1 ss_cv2
    v_add_u32 v65, 512, v65
    s_mov_b32 s25, 8
ss_cv3:
    ds_read2_b32 v[68:69], v64 offset0:0 offset1:1
    ds_read2_b32 v[70:71], v64 offset0:2 offset1:3
    ds_read_b128 v[140:143], v65 offset:0
    ds_read_b128 v[144:147], v65 offset:512
    ds_read_b128 v[148:151], v65 offset:1024
    ds_read_b128 v[152:155], v65 offset:1536
    ds_read_b128 v[156:159], v65 offset:2048
    v_subrev_u32 v64, 64, v64
    v_subrev_u32 v65, 64, v65
    s_waitcnt lgkmcnt(4)
    v_mfma_f32_16x16x32_bf16 v[108:111], v[68:71], v[140:143], v[108:111]
    s_waitcnt lgkmcnt(3)
    v_mfma_f32_16x16x32_bf16 v[112:115], v[68:71], v[144:147], v[112:115]
    s_waitcnt lgkmcnt(2)
    v_mfma_f32_16x16x32_bf16 v[116:119], v[68:71], v[148:151], v[116:119]
    s_waitcnt lgkmcnt(1)
    v_mfma_f32_16x16x32_bf16 v[120:123], v[68:71], v[152:155], v[120:123]
    s_waitcnt lgkmcnt(0)
    v_mfma_f32_16x16x32_bf16 v[124:127], v[68:71], v[156:159], v[124:127]
    s_sub_u32 s25, s25, 1
    s_cmp_lg_u32 s25, 0
    s_cbranch_scc1 ss_cv3
    v_add_u32 v65, 512, v65
    s_mov_b32 s25, 8
ss_cv4:
    ds_read2_b32 v[68:69], v64 offset0:0 offset1:1
    ds_read2_b32 v[70:71], v64 offset0:2 offset1:3
    ds_read_b128 v[144:147], v65 offset:0
    ds_read_b128 v[148:151], v65 offset:512
    ds_read_b128 v[152:155], v65 offset:1024
    ds_read_b128 v[156:159], v65 offset:1536
    v_subrev_u32 v64, 64, v64
    v_subrev_u32 v65, 64, v65
    s_waitcnt lgkmcnt(3)
    v_mfma_f32_16x16x32_bf16 v[112:115], v[68:71], v[144:147], v[112:115]
    s_waitcnt lgkmcnt(2)
    v_mfma_f32_16x16x32_bf16 v[116:119], v[68:71], v[148:151], v[116:119]
    s_waitcnt lgkmcnt(1)
    v_mfma_f32_16x16x32_bf16 v[120:123], v[68:71], v[152:155], v[120:123]
    s_waitcnt lgkmcnt(0)
    v_mfma_f32_16x16x32_bf16 v[124:127], v[68:71], v[156:159], v[124:127]
    s_sub_u32 s25, s25, 1
    s_cmp_lg_u32 s25, 0
    s_cbranch_scc1 ss_cv4
    v_add_u32 v65, 512, v65
    s_mov_b32 s25, 8
ss_cv5:
    ds_read2_b32 v[68:69], v64 offset0:0 offset1:1
    ds_read2_b32 v[70:71], v64 offset0:2 offset1:3
    ds_read_b128 v[148:151], v65 offset:0
    ds_read_b128 v[152:155], v65 offset:512
    ds_read_b128 v[156:159], v65 offset:1024
    v_subrev_u32 v64, 64, v64
    v_subrev_u32 v65, 64, v65
    s_waitcnt lgkmcnt(2)
    v_mfma_f32_16x16x32_bf16 v[116:119], v[68:71], v[148:151], v[116:119]
    s_waitcnt lgkmcnt(1)
    v_mfma_f32_16x16x32_bf16 v[120:123], v[68:71], v[152:155], v[120:123]
    s_waitcnt lgkmcnt(0)
    v_mfma_f32_16x16x32_bf16 v[124:127], v[68:71], v[156:159], v[124:127]
    s_sub_u32 s25, s25, 1
    s_cmp_lg_u32 s25, 0
    s_cbranch_scc1 ss_cv5
    v_add_u32 v65, 512, v65
    s_mov_b32 s25, 8
ss_cv6:
    ds_read2_b32 v[68:69], v64 offset0:0 offset1:1
    ds_read2_b32 v[70:71], v64 offset0:2 offset1:3
    ds_read_b128 v[152:155], v65 offset:0
    ds_read_b128 v[156:159], v65 offset:512
    v_subrev_u32 v64, 64, v64
    v_subrev_u32 v65, 64, v65
    s_waitcnt lgkmcnt(1)
    v_mfma_f32_16x16x32_bf16 v[120:123], v[68:71], v[152:155], v[120:123]
    s_waitcnt lgkmcnt(0)
    v_mfma_f32_16x16x32_bf16 v[124:127], v[68:71], v[156:159], v[124:127]
    s_sub_u32 s25, s25, 1
    s_cmp_lg_u32 s25, 0
    s_cbranch_scc1 ss_cv6
    v_add_u32 v65, 512, v65
    s_mov_b32 s25, 8
ss_cv7:
    ds_read2_b32 v[68:69], v64 offset0:0 offset1:1
    ds_read2_b32 v[70:71], v64 offset0:2 offset1:3
    ds_read_b128 v[156:159], v65 offset:0
    v_subrev_u32 v64, 64, v64
    v_subrev_u32 v65, 64, v65
    s_waitcnt lgkmcnt(0)
    v_mfma_f32_16x16x32_bf16 v[124:127], v[68:71], v[156:159], v[124:127]
    s_sub_u32 s25, s25, 1
    s_cmp_lg_u32 s25, 0
    s_cbranch_scc1 ss_cv7
    v_add_u32 v65, 512, v65
    s_nop 3
    v_lshlrev_b32 v5, 6, v2
    v_lshl_add_u32 v5, v3, 4, v5
    v_add_u32 v5, v5, v4
    ds_write_b128 v5, v[96:99] offset:7424
    ds_write_b128 v5, v[100:103] offset:8448
    ds_write_b128 v5, v[104:107] offset:9472
    ds_write_b128 v5, v[108:111] offset:10496
    ds_write_b128 v5, v[112:115] offset:11520
    ds_write_b128 v5, v[116:119] offset:12544
    ds_write_b128 v5, v[120:123] offset:13568
    ds_write_b128 v5, v[124:127] offset:14592
    s_mov_b32 s12, s74
    s_mov_b32 s13, s75
    s_mov_b32 s14, 1152
    s_mov_b32 s15, 0x20000
    s_lshl_b32 s23, s20, 1
    buffer_load_dwordx2 v[24:25], off, s[12:15], s23
    s_waitcnt vmcnt(0) lgkmcnt(0)
    s_barrier
    v_lshlrev_b32 v26, 16, v24
    v_and_b32 v27, 0xffff0000, v24
    v_lshlrev_b32 v28, 16, v25
    v_and_b32 v29, 0xffff0000, v25
    v_lshlrev_b32 v5, 5, v0
    ds_read_b128 v[64:67], v5 offset:7424
    ds_read_b128 v[68:71], v5 offset:7440
    ds_read_b128 v[72:75], v5 offset:23808
    ds_read_b128 v[76:79], v5 offset:23824
    ds_read_b128 v[80:83], v5 offset:40192
    ds_read_b128 v[84:87], v5 offset:40208
    ds_read_b128 v[88:91], v5 offset:56576
    ds_read_b128 v[92:95], v5 offset:56592
    s_waitcnt lgkmcnt(0)
    v_mul_u32_u24 v5, 18432, v0
    s_lshl_b32 s22, s20, 1
    s_add_u32 s22, s22, 1152
    v_lshlrev_b32 v6, 16, v8
    v_fmac_f32 v64, v6, v26
    v_and_b32 v6, 0xffff0000, v8
    v_fmac_f32 v72, v6, v27
    v_lshlrev_b32 v6, 16, v9
    v_fmac_f32 v80, v6, v28
    v_and_b32 v6, 0xffff0000, v9
    v_fmac_f32 v88, v6, v29
    v_cvt_pk_bf16_f32 v8, v64, v72
    v_cvt_pk_bf16_f32 v9, v80, v88
    s_add_u32 s23, s22, 0
    buffer_store_dwordx2 v[8:9], v5, s[16:19], s23 offen
    v_lshlrev_b32 v6, 16, v10
    v_fmac_f32 v65, v6, v26
    v_and_b32 v6, 0xffff0000, v10
    v_fmac_f32 v73, v6, v27
    v_lshlrev_b32 v6, 16, v11
    v_fmac_f32 v81, v6, v28
    v_and_b32 v6, 0xffff0000, v11
    v_fmac_f32 v89, v6, v29
    v_cvt_pk_bf16_f32 v10, v65, v73
    v_cvt_pk_bf16_f32 v11, v81, v89
    s_add_u32 s23, s22, 2304
    buffer_store_dwordx2 v[10:11], v5, s[16:19], s23 offen
    v_lshlrev_b32 v6, 16, v12
    v_fmac_f32 v66, v6, v26
    v_and_b32 v6, 0xffff0000, v12
    v_fmac_f32 v74, v6, v27
    v_lshlrev_b32 v6, 16, v13
    v_fmac_f32 v82, v6, v28
    v_and_b32 v6, 0xffff0000, v13
    v_fmac_f32 v90, v6, v29
    v_cvt_pk_bf16_f32 v12, v66, v74
    v_cvt_pk_bf16_f32 v13, v82, v90
    s_add_u32 s23, s22, 4608
    buffer_store_dwordx2 v[12:13], v5, s[16:19], s23 offen
    v_lshlrev_b32 v6, 16, v14
    v_fmac_f32 v67, v6, v26
    v_and_b32 v6, 0xffff0000, v14
    v_fmac_f32 v75, v6, v27
    v_lshlrev_b32 v6, 16, v15
    v_fmac_f32 v83, v6, v28
    v_and_b32 v6, 0xffff0000, v15
    v_fmac_f32 v91, v6, v29
    v_cvt_pk_bf16_f32 v14, v67, v75
    v_cvt_pk_bf16_f32 v15, v83, v91
    s_add_u32 s23, s22, 6912
    buffer_store_dwordx2 v[14:15], v5, s[16:19], s23 offen
    v_lshlrev_b32 v6, 16, v16
    v_fmac_f32 v68, v6, v26
    v_and_b32 v6, 0xffff0000, v16
    v_fmac_f32 v76, v6, v27
    v_lshlrev_b32 v6, 16, v17
    v_fmac_f32 v84, v6, v28
    v_and_b32 v6, 0xffff0000, v17
    v_fmac_f32 v92, v6, v29
    v_cvt_pk_bf16_f32 v16, v68, v76
    v_cvt_pk_bf16_f32 v17, v84, v92
    s_add_u32 s23, s22, 9216
    buffer_store_dwordx2 v[16:17], v5, s[16:19], s23 offen
    v_lshlrev_b32 v6, 16, v18
    v_fmac_f32 v69, v6, v26
    v_and_b32 v6, 0xffff0000, v18
    v_fmac_f32 v77, v6, v27
    v_lshlrev_b32 v6, 16, v19
    v_fmac_f32 v85, v6, v28
    v_and_b32 v6, 0xffff0000, v19
    v_fmac_f32 v93, v6, v29
    v_cvt_pk_bf16_f32 v18, v69, v77
    v_cvt_pk_bf16_f32 v19, v85, v93
    s_add_u32 s23, s22, 11520
    buffer_store_dwordx2 v[18:19], v5, s[16:19], s23 offen
    v_lshlrev_b32 v6, 16, v20
    v_fmac_f32 v70, v6, v26
    v_and_b32 v6, 0xffff0000, v20
    v_fmac_f32 v78, v6, v27
    v_lshlrev_b32 v6, 16, v21
    v_fmac_f32 v86, v6, v28
    v_and_b32 v6, 0xffff0000, v21
    v_fmac_f32 v94, v6, v29
    v_cvt_pk_bf16_f32 v20, v70, v78
    v_cvt_pk_bf16_f32 v21, v86, v94
    s_add_u32 s23, s22, 13824
    buffer_store_dwordx2 v[20:21], v5, s[16:19], s23 offen
    v_lshlrev_b32 v6, 16, v22
    v_fmac_f32 v71, v6, v26
    v_and_b32 v6, 0xffff0000, v22
    v_fmac_f32 v79, v6, v27
    v_lshlrev_b32 v6, 16, v23
    v_fmac_f32 v87, v6, v28
    v_and_b32 v6, 0xffff0000, v23
    v_fmac_f32 v95, v6, v29
    v_cvt_pk_bf16_f32 v22, v71, v79
    v_cvt_pk_bf16_f32 v23, v87, v95
    s_add_u32 s23, s22, 16128
    buffer_store_dwordx2 v[22:23], v5, s[16:19], s23 offen
    s_branch L_ssm_next
L_phase2:
    v_and_b32 v1, 63, v0
    v_min_u32 v1, 6, v1
    v_lshlrev_b32 v2, 2, v1
    s_cmp_lg_u32 s32, 0
    v_mov_b32 v251, 163832
    s_cbranch_scc1 sw9
    buffer_load_dword v3, v2, s[96:99], 0 offen offset:32 sc1
    v_mov_b32 v4, 32
    s_waitcnt vmcnt(0)
    v_cmp_lt_u32 vcc, v3, v4
    s_nop 0
    s_ff1_i32_b64 s40, vcc
    v_mov_b32 v250, s40
    ds_write_b32 v251, v250
    s_waitcnt lgkmcnt(0)
sw9:
    s_barrier
    ds_read_b32 v252, v251
    s_waitcnt lgkmcnt(0)
    v_readfirstlane_b32 s33, v252
    s_barrier
    s_nop 1
    s_cmp_lt_u32 s33, 7
    s_cbranch_scc1 L_pool
    s_mov_b32 s88, 4194304
gn10:
    s_cmp_lg_u32 s95, 0
    s_cbranch_scc1 gn10x
    buffer_load_dword v250, off, s[96:99], 0 offset:64 sc1
    s_sub_u32 s88, s88, 1
    s_cbranch_scc1 gn10x
    s_waitcnt vmcnt(0)
    v_readfirstlane_b32 s95, v250
    s_nop 1
    s_branch gn10
gn10x:
    s_mov_b32 s40, 524288
mc2_w:
    buffer_load_dword v250, off, s[96:99], 0 offset:140 sc1
    s_waitcnt vmcnt(0)
    v_readfirstlane_b32 s41, v250
    s_nop 0
    s_cmp_lg_u32 s41, 0
    s_cbranch_scc1 mc2_known
    s_sub_u32 s40, s40, 1
    s_cbranch_scc1 mc2_force
    s_sleep 2
    s_branch mc2_w
mc2_force:
    v_mov_b32 v250, 2
    v_mov_b32 v251, 0
    s_mov_b64 exec, 1
    buffer_atomic_cmpswap v[250:251], off, s[96:99], 0 offset:140
    s_mov_b64 exec, -1
    s_waitcnt vmcnt(0)
    s_mov_b32 s40, 524288
    s_branch mc2_w
mc2_known:
    s_cmp_eq_u32 s41, 1
    s_cbranch_scc1 L_phase2b
    s_mov_b32 s37, 208
    v_mov_b32 v250, 1
    v_mov_b32 v251, 163832
    v_cmp_eq_u32 vcc, 0, v0
    s_nop 0
    s_and_saveexec_b64 s[38:39], vcc
    s_cbranch_execz tk11
    buffer_atomic_add v250, off, s[96:99], s37 sc0
    s_waitcnt vmcnt(0)
    ds_write_b32 v251, v250
    s_waitcnt lgkmcnt(0)
tk11:
    s_mov_b64 exec, -1
    s_barrier
    ds_read_b32 v252, v251
    s_waitcnt lgkmcnt(0)
    v_readfirstlane_b32 s12, v252
    s_barrier
    s_nop 3
    s_cmp_lt_u32 s12, 32
    s_cbranch_scc1 L_chain_safe
L_phase2b:
    s_mov_b32 s8, s76
    s_mov_b32 s9, s77
    s_mov_b32 s10, 4718592
    s_mov_b32 s11, 0x20000
    s_sub_u32 s33, s3, 1
    s_and_b32 s33, s33, 7
    s_cmp_eq_u32 s33, 7
    s_cbranch_scc1 L_p2scan
L_p2take:
    s_lshl_b32 s35, s33, 2
    s_add_u32 s35, s35, 160
    s_mov_b32 s37, s35
    v_mov_b32 v250, 1
    v_mov_b32 v251, 163832
    v_cmp_eq_u32 vcc, 0, v0
    s_nop 0
    s_and_saveexec_b64 s[38:39], vcc
    s_cbranch_execz tk12
    buffer_atomic_add v250, off, s[96:99], s37 sc0
    s_waitcnt vmcnt(0)
    ds_write_b32 v251, v250
    s_waitcnt lgkmcnt(0)
tk12:
    s_mov_b64 exec, -1
    s_barrier
    ds_read_b32 v252, v251
    s_waitcnt lgkmcnt(0)
    v_readfirstlane_b32 s34, v252
    s_barrier
    s_nop 3
    s_cmp_lt_u32 s33, 4
    s_cselect_b32 s36, 4, 6
    s_cmp_lt_u32 s34, s36
    s_cbranch_scc1 L_att0
    s_sub_u32 s34, s34, s36
    s_cmp_lt_u32 s34, 18
    s_cbranch_scc1 L_op_start
L_p2scan:
    v_and_b32 v1, 63, v0
    v_min_u32 v1, 6, v1
    v_lshlrev_b32 v2, 2, v1
    s_cmp_lg_u32 s32, 0
    v_mov_b32 v251, 163832
    s_cbranch_scc1 sw13
    buffer_load_dword v3, v2, s[96:99], 0 offen offset:160 sc1
    v_mov_b32 v4, 24
    v_cmp_gt_u32 vcc, 4, v1
    s_nop 1
    v_cndmask_b32 v4, v4, 22, vcc
    s_waitcnt vmcnt(0)
    v_cmp_lt_u32 vcc, v3, v4
    s_nop 0
    s_ff1_i32_b64 s40, vcc
    v_mov_b32 v250, s40
    ds_write_b32 v251, v250
    s_waitcnt lgkmcnt(0)
sw13:
    s_barrier
    ds_read_b32 v252, v251
    s_waitcnt lgkmcnt(0)
    v_readfirstlane_b32 s33, v252
    s_barrier
    s_nop 1
    s_cmp_lt_u32 s33, 7
    s_cbranch_scc1 L_p2take
    s_branch L_done
L_att0:
    s_mul_i32 s36, s34, 7
    s_mul_i32 s37, s34, 3
    s_add_u32 s37, s37, 12
    s_cmp_lt_u32 s34, 4
    s_cselect_b32 s34, s36, s37
    s_add_u32 s34, s34, s33
    s_cmp_ge_u32 s34, 32
    s_cbranch_scc1 L_done
L_att_next:
    s_lshr_b32 s16, s34, 3
    s_and_b32 s17, s34, 7
    s_lshl_b32 s17, s17, 2
    s_add_u32 s17, s17, s32
    s_lshr_b32 s36, s17, 1
    s_lshl_b32 s36, s36, 8
    s_add_u32 s36, s36, 125829120
    s_mul_i32 s37, s16, 43
    s_lshr_b32 s37, s37, 8
    s_mul_i32 s41, s37, 6
    s_sub_u32 s41, s16, s41
    v_and_b32 v1, 63, v0
    v_mul_u32_u24 v2, 6, v1
    v_add_u32 v2, s41, v2
    v_mov_b32 v4, s37
    s_and_b32 s41, s16, 7
    s_add_u32 s41, s41, 12
    s_lshr_b32 s37, s16, 3
    v_mov_b32 v5, s41
    v_mov_b32 v6, s37
    v_cmp_lt_u32 vcc, 1, v1
    s_nop 1
    v_cndmask_b32 v2, v2, v5, vcc
    v_cndmask_b32 v4, v4, v6, vcc
    v_lshlrev_b32 v2, 2, v2
    v_add3_u32 v4, v4, s95, 1
    s_mov_b32 s40, 4194304
L_aw1:
    buffer_load_dword v3, v2, s[4:7], s36 offen sc1
    s_sub_u32 s40, s40, 1
    s_cbranch_scc1 L_aw1_go
    s_waitcnt vmcnt(0)
    v_subrev_u32 v3, v4, v3
    v_cmp_lt_u32 vcc, 64, v3
    s_cbranch_vccz L_aw1_go
    s_sleep 4
    s_branch L_aw1
L_aw1_go:
    v_and_b32 v5, 63, v0
    v_lshlrev_b32 v1, 4, v5
    v_or_b32 v3, 128, v1
    v_lshrrev_b32 v4, 4, v5
    v_bfe_u32 v6, v5, 2, 2
    v_sub_u32 v4, v6, v4
    v_lshlrev_b32 v4, 3, v4
    v_and_b32 v6, 3, v5
    v_add_u32 v4, v4, v6
    v_mov_b32 v6, 0xf149f2ca
    s_mov_b32 s22, 0x3e0293ee
    s_lshl_b32 s18, s16, 5
    s_add_u32 s18, s18, s17
    s_lshl_b32 s19, s18, 13
    s_add_u32 s20, s19, 33554432
    buffer_load_dwordx4 v[8:11], v1, s[4:7], s20 offen offset:0 sc1
    s_add_u32 s20, s19, 33554432
    buffer_load_dwordx4 v[12:15], v1, s[4:7], s20 offen offset:1024 sc1
    s_add_u32 s20, s19, 33554432
    buffer_load_dwordx4 v[16:19], v1, s[4:7], s20 offen offset:2048 sc1
    s_add_u32 s20, s19, 33554432
    buffer_load_dwordx4 v[20:23], v1, s[4:7], s20 offen offset:3072 sc1
    s_add_u32 s20, s19, 33558528
    buffer_load_dwordx4 v[24:27], v1, s[4:7], s20 offen offset:0 sc1
    s_add_u32 s20, s19, 33558528
    buffer_load_dwordx4 v[28:31], v1, s[4:7], s20 offen offset:1024 sc1
    s_add_u32 s20, s19, 33558528
    buffer_load_dwordx4 v[32:35], v1, s[4:7], s20 offen offset:2048 sc1
    s_add_u32 s20, s19, 33558528
    buffer_load_dwordx4 v[36:39], v1, s[4:7], s20 offen offset:3072 sc1
    s_lshl_b32 s21, s18, 14
    s_add_u32 s20, s21, 0
    buffer_load_dwordx4 v[40:43], v1, s[4:7], s20 offen offset:0 sc1
    s_add_u32 s20, s21, 4096
    buffer_load_dwordx4 v[44:47], v1, s[4:7], s20 offen offset:0 sc1
    s_add_u32 s20, s21, 8192
    buffer_load_dwordx4 v[48:51], v1, s[4:7], s20 offen offset:0 sc1
    s_add_u32 s20, s21, 12288
    buffer_load_dwordx4 v[52:55], v1, s[4:7], s20 offen offset:0 sc1
    s_add_u32 s20, s21, 0
    buffer_load_dwordx4 v[56:59], v1, s[4:7], s20 offen offset:1024 sc1
    s_add_u32 s20, s21, 4096
    buffer_load_dwordx4 v[60:63], v1, s[4:7], s20 offen offset:1024 sc1
    s_add_u32 s20, s21, 8192
    buffer_load_dwordx4 v[64:67], v1, s[4:7], s20 offen offset:1024 sc1
    s_add_u32 s20, s21, 12288
    buffer_load_dwordx4 v[68:71], v1, s[4:7], s20 offen offset:1024 sc1
    s_add_u32 s20, s21, 0
    buffer_load_dwordx4 v[88:91], v1, s[4:7], s20 offen offset:2048 sc1
    s_add_u32 s20, s21, 4096
    buffer_load_dwordx4 v[92:95], v1, s[4:7], s20 offen offset:2048 sc1
    s_add_u32 s20, s21, 8192
    buffer_load_dwordx4 v[96:99], v1, s[4:7], s20 offen offset:2048 sc1
    s_add_u32 s20, s21, 12288
    buffer_load_dwordx4 v[100:103], v1, s[4:7], s20 offen offset:2048 sc1
    s_add_u32 s20, s21, 0
    buffer_load_dwordx4 v[104:107], v1, s[4:7], s20 offen offset:3072 sc1
    s_add_u32 s20, s21, 4096
    buffer_load_dwordx4 v[108:111], v1, s[4:7], s20 offen offset:3072 sc1
    s_add_u32 s20, s21, 8192
    buffer_load_dwordx4 v[112:115], v1, s[4:7], s20 offen offset:3072 sc1
    s_add_u32 s20, s21, 12288
    buffer_load_dwordx4 v[116:119], v1, s[4:7], s20 offen offset:3072 sc1
    v_mov_b32 v172, 0x3f803f80
    v_mov_b32 v173, 0x3f803f80
    v_mov_b32 v174, 0x3f803f80
    v_mov_b32 v175, 0x3f803f80
    v_mov_b32 v176, 0x3f003f00
    v_mov_b32 v177, 0x3f003f00
    s_waitcnt vmcnt(8)
    v_mfma_f32_16x16x32_bf16 v[136:139], v[40:43], v[8:11], 0
    v_mfma_f32_16x16x32_bf16 v[140:143], v[56:59], v[8:11], 0
    v_mfma_f32_16x16x32_bf16 v[148:151], v[40:43], v[24:27], 0
    v_mfma_f32_16x16x32_bf16 v[152:155], v[56:59], v[24:27], 0
    v_mfma_f32_16x16x32_bf16 v[136:139], v[44:47], v[12:15], v[136:139]
    v_mfma_f32_16x16x32_bf16 v[140:143], v[60:63], v[12:15], v[140:143]
    v_mfma_f32_16x16x32_bf16 v[148:151], v[44:47], v[28:31], v[148:151]
    v_mfma_f32_16x16x32_bf16 v[152:155], v[60:63], v[28:31], v[152:155]
    v_mfma_f32_16x16x32_bf16 v[136:139], v[48:51], v[16:19], v[136:139]
    v_mfma_f32_16x16x32_bf16 v[140:143], v[64:67], v[16:19], v[140:143]
    v_mfma_f32_16x16x32_bf16 v[148:151], v[48:51], v[32:35], v[148:151]
    v_mfma_f32_16x16x32_bf16 v[152:155], v[64:67], v[32:35], v[152:155]
    v_mfma_f32_16x16x32_bf16 v[136:139], v[52:55], v[20:23], v[136:139]
    v_mfma_f32_16x16x32_bf16 v[140:143], v[68:71], v[20:23], v[140:143]
    v_mfma_f32_16x16x32_bf16 v[148:151], v[52:55], v[36:39], v[148:151]
    v_mfma_f32_16x16x32_bf16 v[152:155], v[68:71], v[36:39], v[152:155]
    v_cmp_le_i32 vcc, 0, v4
    s_nop 1
    v_cndmask_b32 v136, v6, v136, vcc
    v_cmp_le_i32 vcc, 1, v4
    s_nop 1
    v_cndmask_b32 v137, v6, v137, vcc
    v_cmp_le_i32 vcc, 2, v4
    s_nop 1
    v_cndmask_b32 v138, v6, v138, vcc
    v_cmp_le_i32 vcc, 3, v4
    s_nop 1
    v_cndmask_b32 v139, v6, v139, vcc
    v_cmp_le_i32 vcc, 4, v4
    s_nop 1
    v_cndmask_b32 v140, v6, v140, vcc
    v_cmp_le_i32 vcc, 5, v4
    s_nop 1
    v_cndmask_b32 v141, v6, v141, vcc
    v_cmp_le_i32 vcc, 6, v4
    s_nop 1
    v_cndmask_b32 v142, v6, v142, vcc
    v_cmp_le_i32 vcc, 7, v4
    s_nop 1
    v_cndmask_b32 v143, v6, v143, vcc
    v_cmp_le_i32 vcc, -4, v4
    s_nop 1
    v_cndmask_b32 v148, v6, v148, vcc
    v_cmp_le_i32 vcc, -3, v4
    s_nop 1
    v_cndmask_b32 v149, v6, v149, vcc
    v_cmp_le_i32 vcc, -2, v4
    s_nop 1
    v_cndmask_b32 v150, v6, v150, vcc
    v_cmp_le_i32 vcc, -1, v4
    s_nop 1
    v_cndmask_b32 v151, v6, v151, vcc
    v_cmp_le_i32 vcc, 0, v4
    s_nop 1
    v_cndmask_b32 v152, v6, v152, vcc
    v_cmp_le_i32 vcc, 1, v4
    s_nop 1
    v_cndmask_b32 v153, v6, v153, vcc
    v_cmp_le_i32 vcc, 2, v4
    s_nop 1
    v_cndmask_b32 v154, v6, v154, vcc
    v_cmp_le_i32 vcc, 3, v4
    s_nop 1
    v_cndmask_b32 v155, v6, v155, vcc
    v_max3_f32 v196, v136, v137, v138
    v_max3_f32 v196, v196, v139, v140
    v_max3_f32 v196, v196, v141, v142
    v_max_f32 v196, v196, v143
    v_mov_b32 v197, v196
    s_nop 1
    v_permlane32_swap_b32 v196, v197
    v_max_f32 v196, v196, v197
    v_mov_b32 v197, v196
    s_nop 1
    v_permlane16_swap_b32 v196, v197
    v_max_f32 v196, v196, v197
    v_mul_f32 v192, s22, v196
    v_fma_f32 v136, v136, s22, -v192
    v_fma_f32 v137, v137, s22, -v192
    v_fma_f32 v138, v138, s22, -v192
    v_fma_f32 v139, v139, s22, -v192
    v_fma_f32 v140, v140, s22, -v192
    v_fma_f32 v141, v141, s22, -v192
    v_fma_f32 v142, v142, s22, -v192
    v_fma_f32 v143, v143, s22, -v192
    v_exp_f32 v136, v136
    v_exp_f32 v137, v137
    v_exp_f32 v138, v138
    v_exp_f32 v139, v139
    v_exp_f32 v140, v140
    v_exp_f32 v141, v141
    v_exp_f32 v142, v142
    v_exp_f32 v143, v143
    v_cvt_pk_bf16_f32 v160, v136, v137
    v_cvt_pk_bf16_f32 v161, v138, v139
    v_cvt_pk_bf16_f32 v162, v140, v141
    v_cvt_pk_bf16_f32 v163, v142, v143
    v_max3_f32 v196, v148, v149, v150
    v_max3_f32 v196, v196, v151, v152
    v_max3_f32 v196, v196, v153, v154
    v_max_f32 v196, v196, v155
    v_mov_b32 v197, v196
    s_nop 1
    v_permlane32_swap_b32 v196, v197
    v_max_f32 v196, v196, v197
    v_mov_b32 v197, v196
    s_nop 1
    v_permlane16_swap_b32 v196, v197
    v_max_f32 v196, v196, v197
    v_mul_f32 v193, s22, v196
    v_fma_f32 v148, v148, s22, -v193
    v_fma_f32 v149, v149, s22, -v193
    v_fma_f32 v150, v150, s22, -v193
    v_fma_f32 v151, v151, s22, -v193
    v_fma_f32 v152, v152, s22, -v193
    v_fma_f32 v153, v153, s22, -v193
    v_fma_f32 v154, v154, s22, -v193
    v_fma_f32 v155, v155, s22, -v193
    v_exp_f32 v148, v148
    v_exp_f32 v149, v149
    v_exp_f32 v150, v150
    v_exp_f32 v151, v151
    v_exp_f32 v152, v152
    v_exp_f32 v153, v153
    v_exp_f32 v154, v154
    v_exp_f32 v155, v155
    v_cvt_pk_bf16_f32 v166, v148, v149
    v_cvt_pk_bf16_f32 v167, v150, v151
    v_cvt_pk_bf16_f32 v168, v152, v153
    v_cvt_pk_bf16_f32 v169, v154, v155
    v_mfma_f32_16x16x32_bf16 v[180:183], v[172:175], v[160:163], 0
    v_mfma_f32_16x16x32_bf16 v[184:187], v[172:175], v[166:169], 0
    s_waitcnt vmcnt(7)
    v_mfma_f32_16x16x32_bf16 v[40:43], v[88:91], v[160:163], 0
    s_waitcnt vmcnt(3)
    v_mfma_f32_16x16x32_bf16 v[44:47], v[104:107], v[160:163], 0
    v_mfma_f32_16x16x32_bf16 v[48:51], v[88:91], v[166:169], 0
    v_mfma_f32_16x16x32_bf16 v[52:55], v[104:107], v[166:169], 0
    v_mfma_f32_16x16x32_bf16 v[56:59], v[92:95], v[160:163], 0
    s_waitcnt vmcnt(2)
    v_mfma_f32_16x16x32_bf16 v[60:63], v[108:111], v[160:163], 0
    v_mfma_f32_16x16x32_bf16 v[64:67], v[92:95], v[166:169], 0
    v_mfma_f32_16x16x32_bf16 v[68:71], v[108:111], v[166:169], 0
    v_mfma_f32_16x16x32_bf16 v[200:203], v[96:99], v[160:163], 0
    s_waitcnt vmcnt(1)
    v_mfma_f32_16x16x32_bf16 v[204:207], v[112:115], v[160:163], 0
    v_mfma_f32_16x16x32_bf16 v[208:211], v[96:99], v[166:169], 0
    v_mfma_f32_16x16x32_bf16 v[212:215], v[112:115], v[166:169], 0
    v_mfma_f32_16x16x32_bf16 v[216:219], v[100:103], v[160:163], 0
    s_waitcnt vmcnt(0)
    v_mfma_f32_16x16x32_bf16 v[220:223], v[116:119], v[160:163], 0
    v_mfma_f32_16x16x32_bf16 v[224:227], v[100:103], v[166:169], 0
    v_mfma_f32_16x16x32_bf16 v[228:231], v[116:119], v[166:169], 0
    s_nop 7
    s_mov_b32 s88, 65536
cw14:
    buffer_load_dword v199, off, s[4:7], s36 offset:128 sc1
    s_waitcnt vmcnt(0)
    v_readfirstlane_b32 s42, v199
    s_nop 0
    s_sub_u32 s42, s42, s95
    s_cmp_gt_u32 s42, 64
    s_cselect_b32 s42, 0, s42
    s_add_u32 s42, s42, 2
    s_cmp_ge_u32 s42, s16
    s_cbranch_scc1 cw14x
    s_sub_u32 s88, s88, 1
    s_cbranch_scc1 cw14x
    s_sub_u32 s42, s16, s42
    s_min_u32 s42, s42, 6
cw14s:
    s_sleep 24
    s_sub_u32 s42, s42, 1
    s_cmp_lg_u32 s42, 0
    s_cbranch_scc1 cw14s
    s_branch cw14
cw14x:
    s_and_b32 s37, s16, 1
    s_lshl_b32 s37, s37, 2
    s_add_u32 s37, s37, s36
    s_add_u32 s37, s37, 128
    s_add_u32 s41, s16, s95
    s_add_u32 s41, s41, 1
    s_lshl_b32 s42, s17, 7
    s_add_u32 s42, s42, 125845504
    s_cmp_ge_u32 s16, 62
    s_cselect_b32 s37, s42, s37
    s_cselect_b32 s42, 12, 8
    v_lshlrev_b32 v198, 2, v0
    v_and_b32 v198, s42, v198
    s_mov_b32 s40, 4194304
L_aw2:
    buffer_load_dword v199, v198, s[4:7], s37 offen sc1
    s_sub_u32 s40, s40, 1
    s_cbranch_scc1 L_aw2_go
    s_waitcnt vmcnt(0)
    v_subrev_u32 v199, s41, v199
    v_cmp_lt_u32 vcc, 64, v199
    s_cbranch_vccz L_aw2_go
    s_sleep 1
    s_branch L_aw2
L_aw2_go:
    s_mov_b32 s21, 4096
at_again:
    s_lshl_b32 s20, s18, 12
    s_add_u32 s20, s20, 71303168
    buffer_load_dwordx4 v[72:75], v3, s[4:7], s20 offen offset:0 sc1
    buffer_load_dwordx4 v[76:79], v3, s[4:7], s20 offen offset:1024 sc1
    buffer_load_dwordx4 v[80:83], v3, s[4:7], s20 offen offset:2048 sc1
    buffer_load_dwordx4 v[84:87], v3, s[4:7], s20 offen offset:3072 sc1
    s_lshl_b32 s20, s18, 12
    s_add_u32 s20, s20, 80740352
    buffer_load_dwordx4 v[120:123], v1, s[4:7], s20 offen offset:0 sc1
    buffer_load_dwordx4 v[124:127], v1, s[4:7], s20 offen offset:1024 sc1
    buffer_load_dwordx4 v[128:131], v1, s[4:7], s20 offen offset:2048 sc1
    buffer_load_dwordx4 v[132:135], v1, s[4:7], s20 offen offset:3072 sc1
    s_waitcnt vmcnt(7)
    v_mfma_f32_16x16x32_bf16 v[144:147], v[72:75], v[8:11], 0
    v_mfma_f32_16x16x32_bf16 v[156:159], v[72:75], v[24:27], 0
    s_waitcnt vmcnt(6)
    v_mfma_f32_16x16x32_bf16 v[144:147], v[76:79], v[12:15], v[144:147]
    v_mfma_f32_16x16x32_bf16 v[156:159], v[76:79], v[28:31], v[156:159]
    s_waitcnt vmcnt(5)
    v_mfma_f32_16x16x32_bf16 v[144:147], v[80:83], v[16:19], v[144:147]
    v_mfma_f32_16x16x32_bf16 v[156:159], v[80:83], v[32:35], v[156:159]
    s_waitcnt vmcnt(4)
    v_mfma_f32_16x16x32_bf16 v[144:147], v[84:87], v[20:23], v[144:147]
    v_mfma_f32_16x16x32_bf16 v[156:159], v[84:87], v[36:39], v[156:159]
    v_max3_u32 v196, v72, v76, v80
    s_waitcnt vmcnt(0)
    v_max3_u32 v196, v196, v84, v120
    v_max3_u32 v196, v196, v124, v128
    v_max_u32 v196, v196, v132
    v_cmp_eq_u32 vcc, -1, v196
    s_sub_u32 s21, s21, 1
    s_nop 3
    s_cbranch_scc1 at_ok
    s_cbranch_vccnz at_again
at_ok:
    v_max3_f32 v196, v144, v145, v146
    v_max_f32 v196, v196, v147
    v_mov_b32 v197, v196
    s_nop 1
    v_permlane16_swap_b32 v196, v197
    v_max_f32 v196, v196, v197
    v_mul_f32 v196, s22, v196
    v_max_f32 v196, v196, v192
    v_sub_f32 v192, v192, v196
    v_fma_f32 v144, v144, s22, -v196
    v_fma_f32 v145, v145, s22, -v196
    v_fma_f32 v146, v146, s22, -v196
    v_fma_f32 v147, v147, s22, -v196
    v_exp_f32 v192, v192
    v_exp_f32 v144, v144
    v_exp_f32 v145, v145
    v_exp_f32 v146, v146
    v_exp_f32 v147, v147
    v_add_f32 v196, v144, v145
    v_add_f32 v197, v146, v147
    v_add_f32 v196, v196, v197
    v_mov_b32 v197, v196
    s_nop 1
    v_permlane16_swap_b32 v196, v197
    v_add_f32 v196, v196, v197
    v_fmac_f32 v196, v192, v180
    v_rcp_f32 v196, v196
    s_nop 0
    v_mul_f32 v144, v144, v196
    v_mul_f32 v145, v145, v196
    v_mul_f32 v146, v146, v196
    v_mul_f32 v147, v147, v196
    v_mul_f32 v192, v192, v196
    v_cvt_pk_bf16_f32 v164, v144, v145
    v_cvt_pk_bf16_f32 v165, v146, v147
    v_max3_f32 v196, v156, v157, v158
    v_max_f32 v196, v196, v159
    v_mov_b32 v197, v196
    s_nop 1
    v_permlane16_swap_b32 v196, v197
    v_max_f32 v196, v196, v197
    v_mul_f32 v196, s22, v196
    v_max_f32 v196, v196, v193
    v_sub_f32 v193, v193, v196
    v_fma_f32 v156, v156, s22, -v196
    v_fma_f32 v157, v157, s22, -v196
    v_fma_f32 v158, v158, s22, -v196
    v_fma_f32 v159, v159, s22, -v196
    v_exp_f32 v193, v193
    v_exp_f32 v156, v156
    v_exp_f32 v157, v157
    v_exp_f32 v158, v158
    v_exp_f32 v159, v159
    v_add_f32 v196, v156, v157
    v_add_f32 v197, v158, v159
    v_add_f32 v196, v196, v197
    v_mov_b32 v197, v196
    s_nop 1
    v_permlane16_swap_b32 v196, v197
    v_add_f32 v196, v196, v197
    v_fmac_f32 v196, v193, v184
    v_rcp_f32 v196, v196
    s_nop 0
    v_mul_f32 v156, v156, v196
    v_mul_f32 v157, v157, v196
    v_mul_f32 v158, v158, v196
    v_mul_f32 v159, v159, v196
    v_mul_f32 v193, v193, v196
    v_cvt_pk_bf16_f32 v170, v156, v157
    v_cvt_pk_bf16_f32 v171, v158, v159
    s_lshl_b32 s18, s16, 18
    s_lshl_b32 s19, s17, 12
    s_add_u32 s18, s18, s19
    s_add_u32 s18, s18, 50331648
    s_add_u32 s19, s18, 131072
    v_mul_f32 v40, v40, v192
    v_mul_f32 v41, v41, v192
    v_mul_f32 v42, v42, v192
    v_mul_f32 v43, v43, v192
    v_mul_f32 v44, v44, v192
    v_mul_f32 v45, v45, v192
    v_mul_f32 v46, v46, v192
    v_mul_f32 v47, v47, v192
    v_mfma_f32_16x16x16_bf16 v[40:43], v[120:121], v[164:165], v[40:43]
    v_mfma_f32_16x16x16_bf16 v[44:47], v[122:123], v[164:165], v[44:47]
    v_mul_f32 v48, v48, v193
    v_mul_f32 v49, v49, v193
    v_mul_f32 v50, v50, v193
    v_mul_f32 v51, v51, v193
    v_mul_f32 v52, v52, v193
    v_mul_f32 v53, v53, v193
    v_mul_f32 v54, v54, v193
    v_mul_f32 v55, v55, v193
    v_mfma_f32_16x16x16_bf16 v[48:51], v[120:121], v[170:171], v[48:51]
    v_mfma_f32_16x16x16_bf16 v[52:55], v[122:123], v[170:171], v[52:55]
    v_cvt_pk_bf16_f32 v40, v40, v41
    v_cvt_pk_bf16_f32 v41, v42, v43
    v_cvt_pk_bf16_f32 v42, v44, v45
    v_cvt_pk_bf16_f32 v43, v46, v47
    buffer_store_dwordx4 v[40:43], v1, s[4:7], s18 offen offset:0 sc1
    v_mul_f32 v56, v56, v192
    v_mul_f32 v57, v57, v192
    v_mul_f32 v58, v58, v192
    v_mul_f32 v59, v59, v192
    v_mul_f32 v60, v60, v192
    v_mul_f32 v61, v61, v192
    v_mul_f32 v62, v62, v192
    v_mul_f32 v63, v63, v192
    v_mfma_f32_16x16x16_bf16 v[56:59], v[124:125], v[164:165], v[56:59]
    v_mfma_f32_16x16x16_bf16 v[60:63], v[126:127], v[164:165], v[60:63]
    v_cvt_pk_bf16_f32 v48, v48, v49
    v_cvt_pk_bf16_f32 v49, v50, v51
    v_cvt_pk_bf16_f32 v50, v52, v53
    v_cvt_pk_bf16_f32 v51, v54, v55
    buffer_store_dwordx4 v[48:51], v1, s[4:7], s19 offen offset:0 sc1
    v_mul_f32 v64, v64, v193
    v_mul_f32 v65, v65, v193
    v_mul_f32 v66, v66, v193
    v_mul_f32 v67, v67, v193
    v_mul_f32 v68, v68, v193
    v_mul_f32 v69, v69, v193
    v_mul_f32 v70, v70, v193
    v_mul_f32 v71, v71, v193
    v_mfma_f32_16x16x16_bf16 v[64:67], v[124:125], v[170:171], v[64:67]
    v_mfma_f32_16x16x16_bf16 v[68:71], v[126:127], v[170:171], v[68:71]
    v_cvt_pk_bf16_f32 v56, v56, v57
    v_cvt_pk_bf16_f32 v57, v58, v59
    v_cvt_pk_bf16_f32 v58, v60, v61
    v_cvt_pk_bf16_f32 v59, v62, v63
    buffer_store_dwordx4 v[56:59], v1, s[4:7], s18 offen offset:1024 sc1
    v_mul_f32 v200, v200, v192
    v_mul_f32 v201, v201, v192
    v_mul_f32 v202, v202, v192
    v_mul_f32 v203, v203, v192
    v_mul_f32 v204, v204, v192
    v_mul_f32 v205, v205, v192
    v_mul_f32 v206, v206, v192
    v_mul_f32 v207, v207, v192
    v_mfma_f32_16x16x16_bf16 v[200:203], v[128:129], v[164:165], v[200:203]
    v_mfma_f32_16x16x16_bf16 v[204:207], v[130:131], v[164:165], v[204:207]
    v_cvt_pk_bf16_f32 v64, v64, v65
    v_cvt_pk_bf16_f32 v65, v66, v67
    v_cvt_pk_bf16_f32 v66, v68, v69
    v_cvt_pk_bf16_f32 v67, v70, v71
    buffer_store_dwordx4 v[64:67], v1, s[4:7], s19 offen offset:1024 sc1
    v_mul_f32 v208, v208, v193
    v_mul_f32 v209, v209, v193
    v_mul_f32 v210, v210, v193
    v_mul_f32 v211, v211, v193
    v_mul_f32 v212, v212, v193
    v_mul_f32 v213, v213, v193
    v_mul_f32 v214, v214, v193
    v_mul_f32 v215, v215, v193
    v_mfma_f32_16x16x16_bf16 v[208:211], v[128:129], v[170:171], v[208:211]
    v_mfma_f32_16x16x16_bf16 v[212:215], v[130:131], v[170:171], v[212:215]
    v_cvt_pk_bf16_f32 v200, v200, v201
    v_cvt_pk_bf16_f32 v201, v202, v203
    v_cvt_pk_bf16_f32 v202, v204, v205
    v_cvt_pk_bf16_f32 v203, v206, v207
    buffer_store_dwordx4 v[200:203], v1, s[4:7], s18 offen offset:2048 sc1
    v_mul_f32 v216, v216, v192
    v_mul_f32 v217, v217, v192
    v_mul_f32 v218, v218, v192
    v_mul_f32 v219, v219, v192
    v_mul_f32 v220, v220, v192
    v_mul_f32 v221, v221, v192
    v_mul_f32 v222, v222, v192
    v_mul_f32 v223, v223, v192
    v_mfma_f32_16x16x16_bf16 v[216:219], v[132:133], v[164:165], v[216:219]
    v_mfma_f32_16x16x16_bf16 v[220:223], v[134:135], v[164:165], v[220:223]
    v_cvt_pk_bf16_f32 v208, v208, v209
    v_cvt_pk_bf16_f32 v209, v210, v211
    v_cvt_pk_bf16_f32 v210, v212, v213
    v_cvt_pk_bf16_f32 v211, v214, v215
    buffer_store_dwordx4 v[208:211], v1, s[4:7], s19 offen offset:2048 sc1
    v_mul_f32 v224, v224, v193
    v_mul_f32 v225, v225, v193
    v_mul_f32 v226, v226, v193
    v_mul_f32 v227, v227, v193
    v_mul_f32 v228, v228, v193
    v_mul_f32 v229, v229, v193
    v_mul_f32 v230, v230, v193
    v_mul_f32 v231, v231, v193
    v_mfma_f32_16x16x16_bf16 v[224:227], v[132:133], v[170:171], v[224:227]
    v_mfma_f32_16x16x16_bf16 v[228:231], v[134:135], v[170:171], v[228:231]
    v_cvt_pk_bf16_f32 v216, v216, v217
    v_cvt_pk_bf16_f32 v217, v218, v219
    v_cvt_pk_bf16_f32 v218, v220, v221
    v_cvt_pk_bf16_f32 v219, v222, v223
    buffer_store_dwordx4 v[216:219], v1, s[4:7], s18 offen offset:3072 sc1
    v_cvt_pk_bf16_f32 v224, v224, v225
    v_cvt_pk_bf16_f32 v225, v226, v227
    v_cvt_pk_bf16_f32 v226, v228, v229
    v_cvt_pk_bf16_f32 v227, v230, v231
    buffer_store_dwordx4 v[224:227], v1, s[4:7], s19 offen offset:3072 sc1
    s_lshr_b32 s40, s34, 1
    s_lshl_b32 s40, s40, 7
    s_and_b32 s41, s17, 7
    s_lshl_b32 s41, s41, 2
    s_add_u32 s40, s40, s41
    s_add_u32 s40, s40, 125894656
    v_mov_b32 v250, s95
    s_cmp_ge_u32 s16, 62
    s_cbranch_scc1 L_afl
    s_waitcnt vmcnt(0)
L_afl:
    s_mov_b64 exec, 1
    buffer_store_dword v250, off, s[4:7], s40 sc1
    s_mov_b64 exec, -1
    s_add_u32 s34, s34, 32
    s_cmp_lt_u32 s34, 512
    s_cbranch_scc1 L_att_next
    s_branch L_done
L_op_start:
    s_mov_b32 s16, s33
    s_mov_b32 s33, s34
    v_and_b32 v2, 63, v0
    v_lshlrev_b32 v1, 4, v2
    v_lshrrev_b32 v5, 2, v2
    v_mul_u32_u24 v3, 1152, v5
    v_and_b32 v5, 3, v2
    v_lshl_add_u32 v3, v5, 4, v3
    s_lshl_b32 s21, s32, 12
    v_add_u32 v4, s21, v1
    s_mov_b64 s[12:13], s[58:59]
    s_mov_b32 s14, 4718592
    s_mov_b32 s15, 0x20000
    s_mul_i32 s19, s32, 1179648
    s_lshl_b32 s18, s33, 6
    s_add_u32 s19, s19, s18
    s_add_u32 s18, s19, 0
    s_add_u32 m0, s21, 0
    s_nop 0
    buffer_load_dwordx4 v3, s[12:15], s18 offen lds
    s_add_u32 m0, s21, 1024
    s_add_u32 s18, s18, 18432
    buffer_load_dwordx4 v3, s[12:15], s18 offen lds
    s_add_u32 m0, s21, 2048
    s_add_u32 s18, s18, 18432
    buffer_load_dwordx4 v3, s[12:15], s18 offen lds
    s_add_u32 m0, s21, 3072
    s_add_u32 s18, s18, 18432
    buffer_load_dwordx4 v3, s[12:15], s18 offen lds
    s_add_u32 s18, s19, 73728
    s_add_u32 m0, s21, 16384
    s_nop 0
    buffer_load_dwordx4 v3, s[12:15], s18 offen lds
    s_add_u32 m0, s21, 17408
    s_add_u32 s18, s18, 18432
    buffer_load_dwordx4 v3, s[12:15], s18 offen lds
    s_add_u32 m0, s21, 18432
    s_add_u32 s18, s18, 18432
    buffer_load_dwordx4 v3, s[12:15], s18 offen lds
    s_add_u32 m0, s21, 19456
    s_add_u32 s18, s18, 18432
    buffer_load_dwordx4 v3, s[12:15], s18 offen lds
    s_add_u32 s18, s19, 147456
    s_add_u32 m0, s21, 32768
    s_nop 0
    buffer_load_dwordx4 v3, s[12:15], s18 offen lds
    s_add_u32 m0, s21, 33792
    s_add_u32 s18, s18, 18432
    buffer_load_dwordx4 v3, s[12:15], s18 offen lds
    s_add_u32 m0, s21, 34816
    s_add_u32 s18, s18, 18432
    buffer_load_dwordx4 v3, s[12:15], s18 offen lds
    s_add_u32 m0, s21, 35840
    s_add_u32 s18, s18, 18432
    buffer_load_dwordx4 v3, s[12:15], s18 offen lds
    s_add_u32 s18, s19, 221184
    s_add_u32 m0, s21, 49152
    s_nop 0
    buffer_load_dwordx4 v3, s[12:15], s18 offen lds
    s_add_u32 m0, s21, 50176
    s_add_u32 s18, s18, 18432
    buffer_load_dwordx4 v3, s[12:15], s18 offen lds
    s_add_u32 m0, s21, 51200
    s_add_u32 s18, s18, 18432
    buffer_load_dwordx4 v3, s[12:15], s18 offen lds
    s_add_u32 m0, s21, 52224
    s_add_u32 s18, s18, 18432
    buffer_load_dwordx4 v3, s[12:15], s18 offen lds
    s_add_u32 s18, s19, 294912
    s_add_u32 m0, s21, 65536
    s_nop 0
    buffer_load_dwordx4 v3, s[12:15], s18 offen lds
    s_add_u32 m0, s21, 66560
    s_add_u32 s18, s18, 18432
    buffer_load_dwordx4 v3, s[12:15], s18 offen lds
    s_add_u32 m0, s21, 67584
    s_add_u32 s18, s18, 18432
    buffer_load_dwordx4 v3, s[12:15], s18 offen lds
    s_add_u32 m0, s21, 68608
    s_add_u32 s18, s18, 18432
    buffer_load_dwordx4 v3, s[12:15], s18 offen lds
    s_add_u32 s18, s19, 368640
    s_add_u32 m0, s21, 81920
    s_nop 0
    buffer_load_dwordx4 v3, s[12:15], s18 offen lds
    s_add_u32 m0, s21, 82944
    s_add_u32 s18, s18, 18432
    buffer_load_dwordx4 v3, s[12:15], s18 offen lds
    s_add_u32 m0, s21, 83968
    s_add_u32 s18, s18, 18432
    buffer_load_dwordx4 v3, s[12:15], s18 offen lds
    s_add_u32 m0, s21, 84992
    s_add_u32 s18, s18, 18432
    buffer_load_dwordx4 v3, s[12:15], s18 offen lds
    s_add_u32 s18, s19, 442368
    s_add_u32 m0, s21, 98304
    s_nop 0
    buffer_load_dwordx4 v3, s[12:15], s18 offen lds
    s_add_u32 m0, s21, 99328
    s_add_u32 s18, s18, 18432
    buffer_load_dwordx4 v3, s[12:15], s18 offen lds
    s_add_u32 m0, s21, 100352
    s_add_u32 s18, s18, 18432
    buffer_load_dwordx4 v3, s[12:15], s18 offen lds
    s_add_u32 m0, s21, 101376
    s_add_u32 s18, s18, 18432
    buffer_load_dwordx4 v3, s[12:15], s18 offen lds
    s_add_u32 s18, s19, 516096
    s_add_u32 m0, s21, 114688
    s_nop 0
    buffer_load_dwordx4 v3, s[12:15], s18 offen lds
    s_add_u32 m0, s21, 115712
    s_add_u32 s18, s18, 18432
    buffer_load_dwordx4 v3, s[12:15], s18 offen lds
    s_add_u32 m0, s21, 116736
    s_add_u32 s18, s18, 18432
    buffer_load_dwordx4 v3, s[12:15], s18 offen lds
    s_add_u32 m0, s21, 117760
    s_add_u32 s18, s18, 18432
    buffer_load_dwordx4 v3, s[12:15], s18 offen lds
    s_add_u32 s18, s19, 589824
    s_add_u32 m0, s21, 131072
    s_nop 0
    buffer_load_dwordx4 v3, s[12:15], s18 offen lds
    s_add_u32 m0, s21, 132096
    s_add_u32 s18, s18, 18432
    buffer_load_dwordx4 v3, s[12:15], s18 offen lds
    s_add_u32 m0, s21, 133120
    s_add_u32 s18, s18, 18432
    buffer_load_dwordx4 v3, s[12:15], s18 offen lds
    s_add_u32 m0, s21, 134144
    s_add_u32 s18, s18, 18432
    buffer_load_dwordx4 v3, s[12:15], s18 offen lds
    v_add_u32 v6, 0, v4
    v_xor_b32 v7, 32, v6
    s_waitcnt vmcnt(32)
    ds_read_b64_tr_b16 a[0:1], v6 offset:0
    ds_read_b64_tr_b16 a[2:3], v6 offset:1024
    ds_read_b64_tr_b16 a[4:5], v6 offset:8
    ds_read_b64_tr_b16 a[6:7], v6 offset:1032
    ds_read_b64_tr_b16 a[8:9], v6 offset:2048
    ds_read_b64_tr_b16 a[10:11], v6 offset:3072
    ds_read_b64_tr_b16 a[12:13], v6 offset:2056
    ds_read_b64_tr_b16 a[14:15], v6 offset:3080
    s_waitcnt lgkmcnt(0)
    s_add_u32 s18, s19, 663552
    s_add_u32 m0, s21, 0
    s_nop 0
    buffer_load_dwordx4 v3, s[12:15], s18 offen lds
    s_add_u32 m0, s21, 1024
    s_add_u32 s18, s18, 18432
    buffer_load_dwordx4 v3, s[12:15], s18 offen lds
    s_add_u32 m0, s21, 2048
    s_add_u32 s18, s18, 18432
    buffer_load_dwordx4 v3, s[12:15], s18 offen lds
    s_add_u32 m0, s21, 3072
    s_add_u32 s18, s18, 18432
    buffer_load_dwordx4 v3, s[12:15], s18 offen lds
    v_add_u32 v6, 16384, v4
    v_xor_b32 v7, 32, v6
    s_waitcnt vmcnt(32)
    ds_read_b64_tr_b16 a[16:17], v6 offset:0
    ds_read_b64_tr_b16 a[18:19], v6 offset:1024
    ds_read_b64_tr_b16 a[20:21], v6 offset:8
    ds_read_b64_tr_b16 a[22:23], v6 offset:1032
    ds_read_b64_tr_b16 a[24:25], v6 offset:2048
    ds_read_b64_tr_b16 a[26:27], v6 offset:3072
    ds_read_b64_tr_b16 a[28:29], v6 offset:2056
    ds_read_b64_tr_b16 a[30:31], v6 offset:3080
    s_waitcnt lgkmcnt(0)
    s_add_u32 s18, s19, 737280
    s_add_u32 m0, s21, 16384
    s_nop 0
    buffer_load_dwordx4 v3, s[12:15], s18 offen lds
    s_add_u32 m0, s21, 17408
    s_add_u32 s18, s18, 18432
    buffer_load_dwordx4 v3, s[12:15], s18 offen lds
    s_add_u32 m0, s21, 18432
    s_add_u32 s18, s18, 18432
    buffer_load_dwordx4 v3, s[12:15], s18 offen lds
    s_add_u32 m0, s21, 19456
    s_add_u32 s18, s18, 18432
    buffer_load_dwordx4 v3, s[12:15], s18 offen lds
    v_add_u32 v6, 32768, v4
    v_xor_b32 v7, 32, v6
    s_waitcnt vmcnt(32)
    ds_read_b64_tr_b16 a[32:33], v6 offset:0
    ds_read_b64_tr_b16 a[34:35], v6 offset:1024
    ds_read_b64_tr_b16 a[36:37], v6 offset:8
    ds_read_b64_tr_b16 a[38:39], v6 offset:1032
    ds_read_b64_tr_b16 a[40:41], v6 offset:2048
    ds_read_b64_tr_b16 a[42:43], v6 offset:3072
    ds_read_b64_tr_b16 a[44:45], v6 offset:2056
    ds_read_b64_tr_b16 a[46:47], v6 offset:3080
    s_waitcnt lgkmcnt(0)
    s_add_u32 s18, s19, 811008
    s_add_u32 m0, s21, 32768
    s_nop 0
    buffer_load_dwordx4 v3, s[12:15], s18 offen lds
    s_add_u32 m0, s21, 33792
    s_add_u32 s18, s18, 18432
    buffer_load_dwordx4 v3, s[12:15], s18 offen lds
    s_add_u32 m0, s21, 34816
    s_add_u32 s18, s18, 18432
    buffer_load_dwordx4 v3, s[12:15], s18 offen lds
    s_add_u32 m0, s21, 35840
    s_add_u32 s18, s18, 18432
    buffer_load_dwordx4 v3, s[12:15], s18 offen lds
    v_add_u32 v6, 49152, v4
    v_xor_b32 v7, 32, v6
    s_waitcnt vmcnt(32)
    ds_read_b64_tr_b16 a[48:49], v6 offset:0
    ds_read_b64_tr_b16 a[50:51], v6 offset:1024
    ds_read_b64_tr_b16 a[52:53], v6 offset:8
    ds_read_b64_tr_b16 a[54:55], v6 offset:1032
    ds_read_b64_tr_b16 a[56:57], v6 offset:2048
    ds_read_b64_tr_b16 a[58:59], v6 offset:3072
    ds_read_b64_tr_b16 a[60:61], v6 offset:2056
    ds_read_b64_tr_b16 a[62:63], v6 offset:3080
    s_waitcnt lgkmcnt(0)
    s_add_u32 s18, s19, 884736
    s_add_u32 m0, s21, 49152
    s_nop 0
    buffer_load_dwordx4 v3, s[12:15], s18 offen lds
    s_add_u32 m0, s21, 50176
    s_add_u32 s18, s18, 18432
    buffer_load_dwordx4 v3, s[12:15], s18 offen lds
    s_add_u32 m0, s21, 51200
    s_add_u32 s18, s18, 18432
    buffer_load_dwordx4 v3, s[12:15], s18 offen lds
    s_add_u32 m0, s21, 52224
    s_add_u32 s18, s18, 18432
    buffer_load_dwordx4 v3, s[12:15], s18 offen lds
    v_add_u32 v6, 65536, v4
    v_xor_b32 v7, 32, v6
    s_waitcnt vmcnt(32)
    ds_read_b64_tr_b16 a[64:65], v6 offset:0
    ds_read_b64_tr_b16 a[66:67], v6 offset:1024
    ds_read_b64_tr_b16 a[68:69], v6 offset:8
    ds_read_b64_tr_b16 a[70:71], v6 offset:1032
    ds_read_b64_tr_b16 a[72:73], v6 offset:2048
    ds_read_b64_tr_b16 a[74:75], v6 offset:3072
    ds_read_b64_tr_b16 a[76:77], v6 offset:2056
    ds_read_b64_tr_b16 a[78:79], v6 offset:3080
    s_waitcnt lgkmcnt(0)
    s_add_u32 s18, s19, 958464
    s_add_u32 m0, s21, 65536
    s_nop 0
    buffer_load_dwordx4 v3, s[12:15], s18 offen lds
    s_add_u32 m0, s21, 66560
    s_add_u32 s18, s18, 18432
    buffer_load_dwordx4 v3, s[12:15], s18 offen lds
    s_add_u32 m0, s21, 67584
    s_add_u32 s18, s18, 18432
    buffer_load_dwordx4 v3, s[12:15], s18 offen lds
    s_add_u32 m0, s21, 68608
    s_add_u32 s18, s18, 18432
    buffer_load_dwordx4 v3, s[12:15], s18 offen lds
    v_add_u32 v6, 81920, v4
    v_xor_b32 v7, 32, v6
    s_waitcnt vmcnt(32)
    ds_read_b64_tr_b16 a[80:81], v6 offset:0
    ds_read_b64_tr_b16 a[82:83], v6 offset:1024
    ds_read_b64_tr_b16 a[84:85], v6 offset:8
    ds_read_b64_tr_b16 a[86:87], v6 offset:1032
    ds_read_b64_tr_b16 a[88:89], v6 offset:2048
    ds_read_b64_tr_b16 a[90:91], v6 offset:3072
    ds_read_b64_tr_b16 a[92:93], v6 offset:2056
    ds_read_b64_tr_b16 a[94:95], v6 offset:3080
    s_waitcnt lgkmcnt(0)
    s_add_u32 s18, s19, 1032192
    s_add_u32 m0, s21, 81920
    s_nop 0
    buffer_load_dwordx4 v3, s[12:15], s18 offen lds
    s_add_u32 m0, s21, 82944
    s_add_u32 s18, s18, 18432
    buffer_load_dwordx4 v3, s[12:15], s18 offen lds
    s_add_u32 m0, s21, 83968
    s_add_u32 s18, s18, 18432
    buffer_load_dwordx4 v3, s[12:15], s18 offen lds
    s_add_u32 m0, s21, 84992
    s_add_u32 s18, s18, 18432
    buffer_load_dwordx4 v3, s[12:15], s18 offen lds
    v_add_u32 v6, 98304, v4
    v_xor_b32 v7, 32, v6
    s_waitcnt vmcnt(32)
    ds_read_b64_tr_b16 a[96:97], v6 offset:0
    ds_read_b64_tr_b16 a[98:99], v6 offset:1024
    ds_read_b64_tr_b16 a[100:101], v6 offset:8
    ds_read_b64_tr_b16 a[102:103], v6 offset:1032
    ds_read_b64_tr_b16 a[104:105], v6 offset:2048
    ds_read_b64_tr_b16 a[106:107], v6 offset:3072
    ds_read_b64_tr_b16 a[108:109], v6 offset:2056
    ds_read_b64_tr_b16 a[110:111], v6 offset:3080
    s_waitcnt lgkmcnt(0)
    s_add_u32 s18, s19, 1105920
    s_add_u32 m0, s21, 98304
    s_nop 0
    buffer_load_dwordx4 v3, s[12:15], s18 offen lds
    s_add_u32 m0, s21, 99328
    s_add_u32 s18, s18, 18432
    buffer_load_dwordx4 v3, s[12:15], s18 offen lds
    s_add_u32 m0, s21, 100352
    s_add_u32 s18, s18, 18432
    buffer_load_dwordx4 v3, s[12:15], s18 offen lds
    s_add_u32 m0, s21, 101376
    s_add_u32 s18, s18, 18432
    buffer_load_dwordx4 v3, s[12:15], s18 offen lds
    v_add_u32 v6, 114688, v4
    v_xor_b32 v7, 32, v6
    s_waitcnt vmcnt(32)
    ds_read_b64_tr_b16 a[112:113], v6 offset:0
    ds_read_b64_tr_b16 a[114:115], v6 offset:1024
    ds_read_b64_tr_b16 a[116:117], v6 offset:8
    ds_read_b64_tr_b16 a[118:119], v6 offset:1032
    ds_read_b64_tr_b16 a[120:121], v6 offset:2048
    ds_read_b64_tr_b16 a[122:123], v6 offset:3072
    ds_read_b64_tr_b16 a[124:125], v6 offset:2056
    ds_read_b64_tr_b16 a[126:127], v6 offset:3080
    s_waitcnt lgkmcnt(0)
    v_add_u32 v6, 131072, v4
    v_xor_b32 v7, 32, v6
    s_waitcnt vmcnt(28)
    ds_read_b64_tr_b16 a[128:129], v6 offset:0
    ds_read_b64_tr_b16 a[130:131], v6 offset:1024
    ds_read_b64_tr_b16 a[132:133], v6 offset:8
    ds_read_b64_tr_b16 a[134:135], v6 offset:1032
    ds_read_b64_tr_b16 a[136:137], v6 offset:2048
    ds_read_b64_tr_b16 a[138:139], v6 offset:3072
    ds_read_b64_tr_b16 a[140:141], v6 offset:2056
    ds_read_b64_tr_b16 a[142:143], v6 offset:3080
    s_waitcnt lgkmcnt(0)
    v_add_u32 v6, 0, v4
    v_xor_b32 v7, 32, v6
    s_waitcnt vmcnt(24)
    ds_read_b64_tr_b16 a[144:145], v6 offset:0
    ds_read_b64_tr_b16 a[146:147], v6 offset:1024
    ds_read_b64_tr_b16 a[148:149], v6 offset:8
    ds_read_b64_tr_b16 a[150:151], v6 offset:1032
    ds_read_b64_tr_b16 a[152:153], v6 offset:2048
    ds_read_b64_tr_b16 a[154:155], v6 offset:3072
    ds_read_b64_tr_b16 a[156:157], v6 offset:2056
    ds_read_b64_tr_b16 a[158:159], v6 offset:3080
    s_waitcnt lgkmcnt(0)
    v_add_u32 v6, 16384, v4
    v_xor_b32 v7, 32, v6
    s_waitcnt vmcnt(20)
    ds_read_b64_tr_b16 a[160:161], v6 offset:0
    ds_read_b64_tr_b16 a[162:163], v6 offset:1024
    ds_read_b64_tr_b16 a[164:165], v6 offset:8
    ds_read_b64_tr_b16 a[166:167], v6 offset:1032
    ds_read_b64_tr_b16 a[168:169], v6 offset:2048
    ds_read_b64_tr_b16 a[170:171], v6 offset:3072
    ds_read_b64_tr_b16 a[172:173], v6 offset:2056
    ds_read_b64_tr_b16 a[174:175], v6 offset:3080
    s_waitcnt lgkmcnt(0)
    v_add_u32 v6, 32768, v4
    v_xor_b32 v7, 32, v6
    s_waitcnt vmcnt(16)
    ds_read_b64_tr_b16 a[176:177], v6 offset:0
    ds_read_b64_tr_b16 a[178:179], v6 offset:1024
    ds_read_b64_tr_b16 a[180:181], v6 offset:8
    ds_read_b64_tr_b16 a[182:183], v6 offset:1032
    ds_read_b64_tr_b16 a[184:185], v6 offset:2048
    ds_read_b64_tr_b16 a[186:187], v6 offset:3072
    ds_read_b64_tr_b16 a[188:189], v6 offset:2056
    ds_read_b64_tr_b16 a[190:191], v6 offset:3080
    s_waitcnt lgkmcnt(0)
    v_add_u32 v6, 49152, v4
    v_xor_b32 v7, 32, v6
    s_waitcnt vmcnt(12)
    ds_read_b64_tr_b16 a[192:193], v6 offset:0
    ds_read_b64_tr_b16 a[194:195], v6 offset:1024
    ds_read_b64_tr_b16 a[196:197], v6 offset:8
    ds_read_b64_tr_b16 a[198:199], v6 offset:1032
    ds_read_b64_tr_b16 a[200:201], v6 offset:2048
    ds_read_b64_tr_b16 a[202:203], v6 offset:3072
    ds_read_b64_tr_b16 a[204:205], v6 offset:2056
    ds_read_b64_tr_b16 a[206:207], v6 offset:3080
    s_waitcnt lgkmcnt(0)
    v_add_u32 v6, 65536, v4
    v_xor_b32 v7, 32, v6
    s_waitcnt vmcnt(8)
    ds_read_b64_tr_b16 a[208:209], v6 offset:0
    ds_read_b64_tr_b16 a[210:211], v6 offset:1024
    ds_read_b64_tr_b16 a[212:213], v6 offset:8
    ds_read_b64_tr_b16 a[214:215], v6 offset:1032
    ds_read_b64_tr_b16 a[216:217], v6 offset:2048
    ds_read_b64_tr_b16 a[218:219], v6 offset:3072
    ds_read_b64_tr_b16 a[220:221], v6 offset:2056
    ds_read_b64_tr_b16 a[222:223], v6 offset:3080
    s_waitcnt lgkmcnt(0)
    v_add_u32 v6, 81920, v4
    v_xor_b32 v7, 32, v6
    s_waitcnt vmcnt(4)
    ds_read_b64_tr_b16 a[224:225], v6 offset:0
    ds_read_b64_tr_b16 a[226:227], v6 offset:1024
    ds_read_b64_tr_b16 a[228:229], v6 offset:8
    ds_read_b64_tr_b16 a[230:231], v6 offset:1032
    ds_read_b64_tr_b16 a[232:233], v6 offset:2048
    ds_read_b64_tr_b16 a[234:235], v6 offset:3072
    ds_read_b64_tr_b16 a[236:237], v6 offset:2056
    ds_read_b64_tr_b16 a[238:239], v6 offset:3080
    s_waitcnt lgkmcnt(0)
    v_add_u32 v6, 98304, v4
    v_xor_b32 v7, 32, v6
    s_waitcnt vmcnt(0)
    ds_read_b64_tr_b16 a[240:241], v6 offset:0
    ds_read_b64_tr_b16 a[242:243], v6 offset:1024
    ds_read_b64_tr_b16 a[244:245], v6 offset:8
    ds_read_b64_tr_b16 a[246:247], v6 offset:1032
    ds_read_b64_tr_b16 a[248:249], v6 offset:2048
    ds_read_b64_tr_b16 a[250:251], v6 offset:3072
    ds_read_b64_tr_b16 a[252:253], v6 offset:2056
    ds_read_b64_tr_b16 a[254:255], v6 offset:3080
    s_waitcnt lgkmcnt(0)
    s_barrier
    s_mov_b32 s35, s16
L_op_seg:
    s_sub_u32 s40, s35, 126
    s_lshr_b32 s41, s40, 1
    s_add_u32 s41, s41, 126
    s_and_b32 s40, s40, 1
    s_lshl_b32 s40, s40, 3
    s_lshl_b32 s44, 0x00ff00ff, s40
    s_cmp_ge_u32 s35, 999
    s_cselect_b32 s16, s41, s35
    s_cselect_b32 s44, s44, -1
    s_mov_b32 s45, s44
    s_lshr_b32 s43, s16, 1
    s_add_u32 s43, s43, 1
    s_min_u32 s43, s43, 63
    s_and_b32 s36, s33, 15
    s_lshl_b32 s36, s36, 8
    s_add_u32 s36, s36, 125829120
    s_lshl_b32 s94, s33, 7
    s_add_u32 s94, s94, s16
    s_cmp_ge_u32 s16, 120
    s_cbranch_scc1 L_nocw
    s_mov_b32 s88, 65536
cw15:
    buffer_load_dword v3, off, s[4:7], s36 offset:128 sc1
    s_waitcnt vmcnt(0)
    v_readfirstlane_b32 s42, v3
    s_nop 0
    s_sub_u32 s42, s42, s95
    s_cmp_gt_u32 s42, 64
    s_cselect_b32 s42, 0, s42
    s_add_u32 s42, s42, 2
    s_cmp_ge_u32 s42, s43
    s_cbranch_scc1 cw15x
    s_sub_u32 s88, s88, 1
    s_cbranch_scc1 cw15x
    s_sub_u32 s42, s43, s42
    s_min_u32 s42, s42, 6
cw15s:
    s_sleep 24
    s_sub_u32 s42, s42, 1
    s_cmp_lg_u32 s42, 0
    s_cbranch_scc1 cw15s
    s_branch cw15
cw15x:
L_nocw:
    s_lshr_b32 s89, s16, 1
    s_lshl_b32 s89, s89, 2
    s_add_u32 s89, s89, s32
    s_lshl_b32 s89, s89, 7
    s_add_u32 s89, s89, 125894656
    v_mbcnt_lo_u32_b32 v2, -1, 0
    v_mbcnt_hi_u32_b32 v2, -1, v2
    v_min_u32 v2, 7, v2
    v_lshlrev_b32 v2, 2, v2
    s_mov_b32 s88, 4194304
fw16:
    buffer_load_dword v3, v2, s[4:7], s89 offen offset:0 sc1
    s_sub_u32 s88, s88, 1
    s_cbranch_scc1 fw16x
    s_waitcnt vmcnt(0)
    v_cmp_ne_u32 vcc, s95, v3
    s_cbranch_vccz fw16x
    s_sleep 2
    s_cmp_gt_u32 s88, 4194256
    s_cbranch_scc1 fw16
    s_sleep 40
    s_branch fw16
fw16x:
    s_mov_b32 s21, 4096
os_again:
    s_lshl_b32 s18, s16, 17
    s_lshl_b32 s19, s32, 15
    s_add_u32 s18, s18, s19
    s_add_u32 s18, s18, 50331648
    s_mov_b64 exec, s[44:45]
    buffer_load_dwordx4 v[32:35], v1, s[4:7], s18 offen offset:0 sc1
    buffer_load_dwordx4 v[36:39], v1, s[4:7], s18 offen offset:1024 sc1
    buffer_load_dwordx4 v[40:43], v1, s[4:7], s18 offen offset:2048 sc1
    buffer_load_dwordx4 v[44:47], v1, s[4:7], s18 offen offset:3072 sc1
    s_add_u32 s18, s18, 4096
    buffer_load_dwordx4 v[48:51], v1, s[4:7], s18 offen offset:0 sc1
    buffer_load_dwordx4 v[52:55], v1, s[4:7], s18 offen offset:1024 sc1
    buffer_load_dwordx4 v[56:59], v1, s[4:7], s18 offen offset:2048 sc1
    buffer_load_dwordx4 v[60:63], v1, s[4:7], s18 offen offset:3072 sc1
    s_add_u32 s18, s18, 4096
    buffer_load_dwordx4 v[64:67], v1, s[4:7], s18 offen offset:0 sc1
    buffer_load_dwordx4 v[68:71], v1, s[4:7], s18 offen offset:1024 sc1
    buffer_load_dwordx4 v[72:75], v1, s[4:7], s18 offen offset:2048 sc1
    buffer_load_dwordx4 v[76:79], v1, s[4:7], s18 offen offset:3072 sc1
    s_add_u32 s18, s18, 4096
    buffer_load_dwordx4 v[80:83], v1, s[4:7], s18 offen offset:0 sc1
    buffer_load_dwordx4 v[84:87], v1, s[4:7], s18 offen offset:1024 sc1
    buffer_load_dwordx4 v[88:91], v1, s[4:7], s18 offen offset:2048 sc1
    buffer_load_dwordx4 v[92:95], v1, s[4:7], s18 offen offset:3072 sc1
    s_add_u32 s18, s18, 4096
    buffer_load_dwordx4 v[96:99], v1, s[4:7], s18 offen offset:0 sc1
    buffer_load_dwordx4 v[100:103], v1, s[4:7], s18 offen offset:1024 sc1
    buffer_load_dwordx4 v[104:107], v1, s[4:7], s18 offen offset:2048 sc1
    buffer_load_dwordx4 v[108:111], v1, s[4:7], s18 offen offset:3072 sc1
    s_add_u32 s18, s18, 4096
    buffer_load_dwordx4 v[112:115], v1, s[4:7], s18 offen offset:0 sc1
    buffer_load_dwordx4 v[116:119], v1, s[4:7], s18 offen offset:1024 sc1
    buffer_load_dwordx4 v[120:123], v1, s[4:7], s18 offen offset:2048 sc1
    buffer_load_dwordx4 v[124:127], v1, s[4:7], s18 offen offset:3072 sc1
    s_add_u32 s18, s18, 4096
    buffer_load_dwordx4 v[128:131], v1, s[4:7], s18 offen offset:0 sc1
    buffer_load_dwordx4 v[132:135], v1, s[4:7], s18 offen offset:1024 sc1
    buffer_load_dwordx4 v[136:139], v1, s[4:7], s18 offen offset:2048 sc1
    buffer_load_dwordx4 v[140:143], v1, s[4:7], s18 offen offset:3072 sc1
    s_add_u32 s18, s18, 4096
    buffer_load_dwordx4 v[144:147], v1, s[4:7], s18 offen offset:0 sc1
    buffer_load_dwordx4 v[148:151], v1, s[4:7], s18 offen offset:1024 sc1
    buffer_load_dwordx4 v[152:155], v1, s[4:7], s18 offen offset:2048 sc1
    buffer_load_dwordx4 v[156:159], v1, s[4:7], s18 offen offset:3072 sc1
    s_mov_b64 exec, -1
    v_lshlrev_b32 v2, 4, v0
    v_and_b32 v3, 3072, v2
    v_lshl_add_u32 v2, v3, 1, v1
    s_waitcnt vmcnt(31)
    v_mfma_f32_16x16x32_bf16 v[8:11], a[0:3], v[32:35], 0
    v_mfma_f32_16x16x32_bf16 v[12:15], a[4:7], v[32:35], 0
    v_mov_b32 v4, v32
    s_waitcnt vmcnt(30)
    v_mfma_f32_16x16x32_bf16 v[8:11], a[8:11], v[36:39], v[8:11]
    v_mfma_f32_16x16x32_bf16 v[12:15], a[12:15], v[36:39], v[12:15]
    v_max_u32 v4, v4, v36
    s_waitcnt vmcnt(29)
    v_mfma_f32_16x16x32_bf16 v[8:11], a[16:19], v[40:43], v[8:11]
    v_mfma_f32_16x16x32_bf16 v[12:15], a[20:23], v[40:43], v[12:15]
    v_max_u32 v4, v4, v40
    s_waitcnt vmcnt(28)
    v_mfma_f32_16x16x32_bf16 v[8:11], a[24:27], v[44:47], v[8:11]
    v_mfma_f32_16x16x32_bf16 v[12:15], a[28:31], v[44:47], v[12:15]
    v_max_u32 v4, v4, v44
    s_waitcnt vmcnt(27)
    v_mfma_f32_16x16x32_bf16 v[8:11], a[32:35], v[48:51], v[8:11]
    v_mfma_f32_16x16x32_bf16 v[12:15], a[36:39], v[48:51], v[12:15]
    v_max_u32 v4, v4, v48
    s_waitcnt vmcnt(26)
    v_mfma_f32_16x16x32_bf16 v[8:11], a[40:43], v[52:55], v[8:11]
    v_mfma_f32_16x16x32_bf16 v[12:15], a[44:47], v[52:55], v[12:15]
    v_max_u32 v4, v4, v52
    s_waitcnt vmcnt(25)
    v_mfma_f32_16x16x32_bf16 v[8:11], a[48:51], v[56:59], v[8:11]
    v_mfma_f32_16x16x32_bf16 v[12:15], a[52:55], v[56:59], v[12:15]
    v_max_u32 v4, v4, v56
    s_waitcnt vmcnt(24)
    v_mfma_f32_16x16x32_bf16 v[8:11], a[56:59], v[60:63], v[8:11]
    v_mfma_f32_16x16x32_bf16 v[12:15], a[60:63], v[60:63], v[12:15]
    v_max_u32 v4, v4, v60
    s_waitcnt vmcnt(23)
    v_mfma_f32_16x16x32_bf16 v[8:11], a[64:67], v[64:67], v[8:11]
    v_mfma_f32_16x16x32_bf16 v[12:15], a[68:71], v[64:67], v[12:15]
    v_max_u32 v4, v4, v64
    s_waitcnt vmcnt(22)
    v_mfma_f32_16x16x32_bf16 v[8:11], a[72:75], v[68:71], v[8:11]
    v_mfma_f32_16x16x32_bf16 v[12:15], a[76:79], v[68:71], v[12:15]
    v_max_u32 v4, v4, v68
    s_waitcnt vmcnt(21)
    v_mfma_f32_16x16x32_bf16 v[8:11], a[80:83], v[72:75], v[8:11]
    v_mfma_f32_16x16x32_bf16 v[12:15], a[84:87], v[72:75], v[12:15]
    v_max_u32 v4, v4, v72
    s_waitcnt vmcnt(20)
    v_mfma_f32_16x16x32_bf16 v[8:11], a[88:91], v[76:79], v[8:11]
    v_mfma_f32_16x16x32_bf16 v[12:15], a[92:95], v[76:79], v[12:15]
    v_max_u32 v4, v4, v76
    s_waitcnt vmcnt(19)
    v_mfma_f32_16x16x32_bf16 v[8:11], a[96:99], v[80:83], v[8:11]
    v_mfma_f32_16x16x32_bf16 v[12:15], a[100:103], v[80:83], v[12:15]
    v_max_u32 v4, v4, v80
    s_waitcnt vmcnt(18)
    v_mfma_f32_16x16x32_bf16 v[8:11], a[104:107], v[84:87], v[8:11]
    v_mfma_f32_16x16x32_bf16 v[12:15], a[108:111], v[84:87], v[12:15]
    v_max_u32 v4, v4, v84
    s_waitcnt vmcnt(17)
    v_mfma_f32_16x16x32_bf16 v[8:11], a[112:115], v[88:91], v[8:11]
    v_mfma_f32_16x16x32_bf16 v[12:15], a[116:119], v[88:91], v[12:15]
    v_max_u32 v4, v4, v88
    s_waitcnt vmcnt(16)
    v_mfma_f32_16x16x32_bf16 v[8:11], a[120:123], v[92:95], v[8:11]
    v_mfma_f32_16x16x32_bf16 v[12:15], a[124:127], v[92:95], v[12:15]
    v_max_u32 v4, v4, v92
    s_waitcnt vmcnt(15)
    v_mfma_f32_16x16x32_bf16 v[8:11], a[128:131], v[96:99], v[8:11]
    v_mfma_f32_16x16x32_bf16 v[12:15], a[132:135], v[96:99], v[12:15]
    v_max_u32 v4, v4, v96
    s_waitcnt vmcnt(14)
    v_mfma_f32_16x16x32_bf16 v[8:11], a[136:139], v[100:103], v[8:11]
    v_mfma_f32_16x16x32_bf16 v[12:15], a[140:143], v[100:103], v[12:15]
    v_max_u32 v4, v4, v100
    s_waitcnt vmcnt(13)
    v_mfma_f32_16x16x32_bf16 v[8:11], a[144:147], v[104:107], v[8:11]
    v_mfma_f32_16x16x32_bf16 v[12:15], a[148:151], v[104:107], v[12:15]
    v_max_u32 v4, v4, v104
    s_waitcnt vmcnt(12)
    v_mfma_f32_16x16x32_bf16 v[8:11], a[152:155], v[108:111], v[8:11]
    v_mfma_f32_16x16x32_bf16 v[12:15], a[156:159], v[108:111], v[12:15]
    v_max_u32 v4, v4, v108
    s_waitcnt vmcnt(11)
    v_mfma_f32_16x16x32_bf16 v[8:11], a[160:163], v[112:115], v[8:11]
    v_mfma_f32_16x16x32_bf16 v[12:15], a[164:167], v[112:115], v[12:15]
    v_max_u32 v4, v4, v112
    s_waitcnt vmcnt(10)
    v_mfma_f32_16x16x32_bf16 v[8:11], a[168:171], v[116:119], v[8:11]
    v_mfma_f32_16x16x32_bf16 v[12:15], a[172:175], v[116:119], v[12:15]
    v_max_u32 v4, v4, v116
    s_waitcnt vmcnt(9)
    v_mfma_f32_16x16x32_bf16 v[8:11], a[176:179], v[120:123], v[8:11]
    v_mfma_f32_16x16x32_bf16 v[12:15], a[180:183], v[120:123], v[12:15]
    v_max_u32 v4, v4, v120
    s_waitcnt vmcnt(8)
    v_mfma_f32_16x16x32_bf16 v[8:11], a[184:187], v[124:127], v[8:11]
    v_mfma_f32_16x16x32_bf16 v[12:15], a[188:191], v[124:127], v[12:15]
    v_max_u32 v4, v4, v124
    s_waitcnt vmcnt(7)
    v_mfma_f32_16x16x32_bf16 v[8:11], a[192:195], v[128:131], v[8:11]
    v_mfma_f32_16x16x32_bf16 v[12:15], a[196:199], v[128:131], v[12:15]
    v_max_u32 v4, v4, v128
    s_waitcnt vmcnt(6)
    v_mfma_f32_16x16x32_bf16 v[8:11], a[200:203], v[132:135], v[8:11]
    v_mfma_f32_16x16x32_bf16 v[12:15], a[204:207], v[132:135], v[12:15]
    v_max_u32 v4, v4, v132
    s_waitcnt vmcnt(5)
    v_mfma_f32_16x16x32_bf16 v[8:11], a[208:211], v[136:139], v[8:11]
    v_mfma_f32_16x16x32_bf16 v[12:15], a[212:215], v[136:139], v[12:15]
    v_max_u32 v4, v4, v136
    s_waitcnt vmcnt(4)
    v_mfma_f32_16x16x32_bf16 v[8:11], a[216:219], v[140:143], v[8:11]
    v_mfma_f32_16x16x32_bf16 v[12:15], a[220:223], v[140:143], v[12:15]
    v_max_u32 v4, v4, v140
    s_waitcnt vmcnt(3)
    v_mfma_f32_16x16x32_bf16 v[8:11], a[224:227], v[144:147], v[8:11]
    v_mfma_f32_16x16x32_bf16 v[12:15], a[228:231], v[144:147], v[12:15]
    v_max_u32 v4, v4, v144
    s_waitcnt vmcnt(2)
    v_mfma_f32_16x16x32_bf16 v[8:11], a[232:235], v[148:151], v[8:11]
    v_mfma_f32_16x16x32_bf16 v[12:15], a[236:239], v[148:151], v[12:15]
    v_max_u32 v4, v4, v148
    s_waitcnt vmcnt(1)
    v_mfma_f32_16x16x32_bf16 v[8:11], a[240:243], v[152:155], v[8:11]
    v_mfma_f32_16x16x32_bf16 v[12:15], a[244:247], v[152:155], v[12:15]
    v_max_u32 v4, v4, v152
    s_waitcnt vmcnt(0)
    v_mfma_f32_16x16x32_bf16 v[8:11], a[248:251], v[156:159], v[8:11]
    v_mfma_f32_16x16x32_bf16 v[12:15], a[252:255], v[156:159], v[12:15]
    v_max_u32 v4, v4, v156
    v_cmp_eq_u32 vcc, -1, v4
    s_nop 0
    s_and_b64 vcc, vcc, s[44:45]
    s_sub_u32 s21, s21, 1
    s_nop 1
    s_cbranch_scc1 os_ok
    s_cbranch_vccnz os_again
os_ok:
    ds_write_b128 v2, v[8:11] offset:0
    ds_write_b128 v2, v[12:15] offset:1024
    s_waitcnt lgkmcnt(0)
    s_barrier
    s_cmp_lg_u32 s32, 0
    s_cbranch_scc1 os_skip
    ds_read_b128 v[40:43], v1 offset:2048
    ds_read_b128 v[44:47], v1 offset:3072
    ds_read_b128 v[48:51], v1 offset:4096
    ds_read_b128 v[52:55], v1 offset:5120
    ds_read_b128 v[56:59], v1 offset:6144
    ds_read_b128 v[60:63], v1 offset:7168
    v_lshrrev_b32 v3, 4, v1
    v_bfe_u32 v4, v3, 2, 2
    v_lshlrev_b32 v4, 3, v4
    v_and_b32 v2, 3, v3
    v_add_u32 v4, v4, v2
    v_mul_u32_u24 v4, 2304, v4
    v_lshrrev_b32 v3, 4, v3
    v_lshl_add_u32 v4, v3, 4, v4
    s_lshr_b32 s18, s16, 1
    s_lshl_b32 s18, s18, 3
    s_and_b32 s19, s16, 1
    s_add_u32 s18, s18, s19
    s_mul_i32 s18, s18, 9216
    s_lshl_b32 s19, s33, 6
    s_add_u32 s18, s18, s19
    s_waitcnt lgkmcnt(0)
    v_pk_add_f32 v[8:9], v[8:9], v[40:41]
    v_pk_add_f32 v[48:49], v[48:49], v[56:57]
    v_pk_add_f32 v[8:9], v[8:9], v[48:49]
    v_pk_add_f32 v[10:11], v[10:11], v[42:43]
    v_pk_add_f32 v[50:51], v[50:51], v[58:59]
    v_pk_add_f32 v[10:11], v[10:11], v[50:51]
    v_pk_add_f32 v[12:13], v[12:13], v[44:45]
    v_pk_add_f32 v[52:53], v[52:53], v[60:61]
    v_pk_add_f32 v[12:13], v[12:13], v[52:53]
    v_pk_add_f32 v[14:15], v[14:15], v[46:47]
    v_pk_add_f32 v[54:55], v[54:55], v[62:63]
    v_pk_add_f32 v[14:15], v[14:15], v[54:55]
    v_cvt_pk_bf16_f32 v32, v8, v9
    v_cvt_pk_bf16_f32 v33, v10, v11
    v_cvt_pk_bf16_f32 v34, v12, v13
    v_cvt_pk_bf16_f32 v35, v14, v15
    s_mov_b64 exec, s[44:45]
    buffer_store_dwordx4 v[32:35], v4, s[8:11], s18 offen sc1
    s_mov_b64 exec, -1
os_skip:
    s_nop 0
    s_add_u32 s35, s35, 7
    s_cmp_ge_u32 s35, 128
    s_cbranch_scc1 L_done
    s_barrier
    s_branch L_op_seg
L_done:
L_exit:
    s_endpgm
.section .rodata,"a"
.p2align 6
.amdhsa_kernel concat_heads__memory_aug_recurrent_mem_tr__ssm_conv_s4d__prompt_kernel
  .amdhsa_next_free_vgpr 512
  .amdhsa_next_free_sgpr 102
  .amdhsa_accum_offset 256
  .amdhsa_group_segment_fixed_size 0
  .amdhsa_kernarg_size 136
  .amdhsa_user_sgpr_count 2
  .amdhsa_user_sgpr_kernarg_segment_ptr 1
  .amdhsa_system_sgpr_workgroup_id_x 1
.end_amdhsa_kernel
.text
```

```asm
; @launch grid=(256,1,1) block=(256,1,1) lds=163840
.amdgcn_target "amdgcn-amd-amdhsa--gfx950"
.text
.globl concat_heads__memory_aug_recurrent_mem_tr__ssm_conv_s4d__prompt_kernel
.p2align 8
.type concat_heads__memory_aug_recurrent_mem_tr__ssm_conv_s4d__prompt_kernel,@function
concat_heads__memory_aug_recurrent_mem_tr__ssm_conv_s4d__prompt_kernel:
    s_cmp_ge_u32 s2, 256
    s_cbranch_scc1 L_exit
    s_load_dwordx4 s[84:87], s[0:1], 120
    s_load_dwordx16 s[48:63], s[0:1], 0
    v_lshrrev_b32 v1, 6, v0
    s_nop 0
    v_readfirstlane_b32 s32, v1
    s_getreg_b32 s3, hwreg(HW_REG_XCC_ID)
    s_and_b32 s3, s3, 15
    s_cmp_lg_u32 s32, 3
    s_cbranch_scc1 L_nowarm
    s_getpc_b64 s[44:45]
L_pcw:
    v_and_b32 v1, 63, v0
    v_lshlrev_b32 v1, 7, v1
    s_cmp_lg_u32 s3, 3
    s_cselect_b32 s33, L_helper-L_pcw, 0
    v_add_u32 v1, s33, v1
    v_min_u32 v2, L_exit-L_pcw, v1
    global_load_dword v240, v2, s[44:45]
    v_add_u32 v1, 8192, v1
    v_min_u32 v2, L_exit-L_pcw, v1
    global_load_dword v241, v2, s[44:45]
    v_add_u32 v1, 8192, v1
    s_cbranch_scc0 L_nowarm
    v_min_u32 v2, L_exit-L_pcw, v1
    global_load_dword v242, v2, s[44:45]
    v_add_u32 v1, 8192, v1
    v_min_u32 v2, L_exit-L_pcw, v1
    global_load_dword v243, v2, s[44:45]
    v_add_u32 v1, 8192, v1
    v_min_u32 v2, L_exit-L_pcw, v1
    global_load_dword v244, v2, s[44:45]
    v_add_u32 v1, 8192, v1
L_nowarm:
    s_waitcnt lgkmcnt(0)
    s_mov_b32 s4, s86
    s_mov_b32 s5, s87
    s_mov_b32 s6, 268435456
    s_mov_b32 s7, 0x20000
    s_mov_b32 s96, s84
    s_mov_b32 s97, s85
    s_mov_b32 s98, 256
    s_mov_b32 s99, 0x20000
    s_mov_b32 s95, 0
    s_cmp_lg_u32 s3, 3
    s_cbranch_scc1 L_helper
    s_mov_b32 s37, 128
    v_mov_b32 v250, 1
    v_mov_b32 v251, 163832
    v_cmp_eq_u32 vcc, 0, v0
    s_nop 0
    s_and_saveexec_b64 s[38:39], vcc
    s_cbranch_execz tk1m
    buffer_atomic_add v250, off, s[96:99], s37 sc0
tk1m:
    s_mov_b64 s[38:39], exec
    s_mov_b64 exec, -1
    v_lshrrev_b32 v54, 6, v0
    s_nop 0
    v_readfirstlane_b32 s13, v54
    v_and_b32 v57, 63, v0
    v_bfe_u32 v54, v57, 2, 1
    v_lshlrev_b32 v48, 13, v54
    v_bfe_u32 v54, v57, 3, 1
    v_lshl_add_u32 v48, v54, 15, v48
    v_bfe_u32 v54, v57, 4, 1
    v_lshl_add_u32 v48, v54, 14, v48
    v_bfe_u32 v54, v57, 5, 1
    v_lshl_add_u32 v48, v54, 16, v48
    v_lshrrev_b32 v55, 4, v57
    v_and_b32 v55, 2, v55
    v_xor_b32 v55, v55, v57
    v_and_b32 v55, 3, v55
    v_lshl_add_u32 v48, v55, 4, v48
    v_bfe_u32 v54, v57, 2, 1
    v_lshlrev_b32 v51, 6, v54
    v_bfe_u32 v54, v57, 3, 1
    v_lshl_add_u32 v51, v54, 9, v51
    v_bfe_u32 v54, v57, 4, 1
    v_lshl_add_u32 v51, v54, 7, v51
    v_bfe_u32 v54, v57, 5, 1
    v_lshl_add_u32 v51, v54, 12, v51
    v_bfe_u32 v54, v57, 0, 1
    v_lshl_add_u32 v51, v54, 3, v51
    v_bfe_u32 v54, v57, 1, 1
    v_lshl_add_u32 v51, v54, 4, v51
    v_bfe_u32 v54, v57, 3, 1
    v_lshl_add_u32 v51, v54, 5, v51
    v_lshrrev_b32 v55, 3, v57
    v_mul_u32_u24 v49, 1152, v55
    v_and_b32 v55, 7, v57
    v_lshl_add_u32 v49, v55, 4, v49
    v_bfe_u32 v54, v57, 4, 1
    v_lshlrev_b32 v52, 13, v54
    v_bfe_u32 v54, v57, 5, 1
    v_lshl_add_u32 v52, v54, 9, v52
    v_bfe_u32 v54, v57, 2, 1
    v_lshl_add_u32 v52, v54, 7, v52
    v_bfe_u32 v54, v57, 3, 1
    v_lshl_add_u32 v52, v54, 5, v52
    v_and_b32 v55, 3, v57
    v_lshl_add_u32 v52, v55, 3, v52
    v_lshrrev_b32 v55, 2, v57
    v_mul_u32_u24 v50, 1152, v55
    v_and_b32 v55, 3, v57
    v_lshl_add_u32 v50, v55, 4, v50
    v_bfe_u32 v54, v57, 4, 1
    v_lshlrev_b32 v53, 12, v54
    v_bfe_u32 v54, v57, 5, 1
    v_lshl_add_u32 v53, v54, 8, v53
    v_bfe_u32 v54, v57, 2, 1
    v_lshl_add_u32 v53, v54, 6, v53
    v_bfe_u32 v54, v57, 3, 1
    v_lshl_add_u32 v53, v54, 5, v53
    v_and_b32 v55, 3, v57
    v_lshl_add_u32 v53, v55, 3, v53
    s_lshl_b32 s66, s13, 10
    s_and_b32 s93, s13, 1
    s_lshl_b32 s93, s93, 14
    s_and_b32 s75, s13, 2
    s_lshl_b32 s75, s75, 19
    v_add_u32 v51, s66, v51
    v_add_u32 v52, s66, v52
    v_add_u32 v53, s66, v53
    v_mov_b32 v58, v48
    s_mov_b32 s10, 4718592
    s_mov_b32 s11, 0x20000
    s_mov_b64 exec, s[38:39]
    s_cbranch_execz tk1
    s_waitcnt vmcnt(0)
    ds_write_b32 v251, v250
    s_waitcnt lgkmcnt(0)
tk1:
    s_mov_b64 exec, -1
    s_barrier
    ds_read_b32 v252, v251
    s_waitcnt lgkmcnt(0)
    v_readfirstlane_b32 s12, v252
    s_barrier
    s_nop 3
    s_cmp_ge_u32 s12, 32
    s_cbranch_scc1 L_helper
L_chain:
    s_mov_b64 s[48:49], s[50:51]
    s_mov_b64 s[50:51], s[52:53]
    s_mov_b64 s[52:53], s[54:55]
    s_mov_b64 s[54:55], s[56:57]
    s_mov_b64 s[56:57], s[58:59]
    s_lshl_b32 s67, s12, 8
    s_lshl_b32 s40, s13, 6
    s_add_u32 s67, s67, s40
    s_mul_i32 s92, s12, 147456
    s_lshr_b32 s73, s50, 8
    s_add_u32 s73, s73, s12
    s_and_b32 s73, s73, 31
    s_bitcmp1_b32 0xa2222222, s73
    s_cselect_b32 s88, 1, 0
    s_mov_b32 s72, 0
    s_add_u32 s73, s73, 1
    s_lshr_b32 s73, s73, 2
    s_xor_b32 s94, s13, 0
    s_mul_i32 s94, s94, 36864
    s_add_u32 s94, s94, s92
    s_lshl_b32 s74, s13, 7
    s_add_u32 s94, s94, s74
    s_add_u32 s78, s94, 0
    s_mov_b64 s[8:9], s[56:57]
    v_mov_b32 v58, v49
    s_mov_b32 s79, 9216
    s_mov_b32 s81, 0
    s_add_u32 s80, s66, 114688
    s_mov_b32 s76, 0
    s_mov_b32 s77, 8192
    s_call_b64 s[82:83], cf_dma
    s_mov_b32 s77, 16384
    s_call_b64 s[82:83], cf_dma
    s_xor_b32 s94, s13, 1
    s_mul_i32 s94, s94, 36864
    s_add_u32 s94, s94, s92
    s_lshl_b32 s74, s13, 7
    s_add_u32 s94, s94, s74
    s_add_u32 s78, s94, 0
    s_add_u32 s80, s66, 81920
    s_mov_b32 s76, 0
    s_mov_b32 s77, 8192
    s_call_b64 s[82:83], cf_dma
    s_mov_b32 s77, 16384
    s_call_b64 s[82:83], cf_dma
    s_xor_b32 s94, s13, 2
    s_mul_i32 s94, s94, 36864
    s_add_u32 s94, s94, s92
    s_lshl_b32 s74, s13, 7
    s_add_u32 s94, s94, s74
    s_add_u32 s78, s94, 0
    s_add_u32 s80, s66, 16384
    s_mov_b32 s76, 0
    s_mov_b32 s77, 8192
    s_call_b64 s[82:83], cf_dma
    s_mov_b32 s77, 16384
    s_call_b64 s[82:83], cf_dma
    s_xor_b32 s94, s13, 3
    s_mul_i32 s94, s94, 36864
    s_add_u32 s94, s94, s92
    s_lshl_b32 s74, s13, 7
    s_add_u32 s94, s94, s74
    s_add_u32 s78, s94, 0
    s_add_u32 s80, s66, 0
    s_mov_b32 s76, 0
    s_mov_b32 s77, 8192
    s_call_b64 s[82:83], cf_dma
    s_mov_b32 s77, 16384
    s_call_b64 s[82:83], cf_dma
    v_lshrrev_b32 v24, 6, v0
    v_lshlrev_b32 v61, 4, v0
    v_add_u32 v62, 57344, v61
    v_xor_b32 v63, 1024, v61
    v_add_u32 v63, 98304, v63
    v_xor_b32 v64, 2048, v61
    v_add_u32 v64, 98304, v64
    v_and_b32 v65, 1023, v61
    v_add_u32 v65, 98304, v65
    v_and_b32 v26, 15, v0
    v_bfe_u32 v27, v0, 4, 2
    v_mov_b32 v60, 0x4444
    v_mov_b32 v25, 0xeeee
    v_cmp_lt_u32 vcc, 7, v26
    s_nop 1
    v_cndmask_b32 v60, v60, v25, vcc
    s_nop 1
    v_and_b32 v67, 12, v26
    v_lshlrev_b32 v67, 3, v67
    v_and_b32 v25, 1, v26
    v_lshl_add_u32 v67, v25, 4, v67
    v_bfe_u32 v25, v26, 1, 1
    v_lshl_add_u32 v67, v25, 3, v67
    v_lshl_add_u32 v66, v27, 14, v67
    v_lshl_add_u32 v66, v24, 17, v66
    s_nop 1
    v_and_b32 v67, 63, v67
    v_lshrrev_b32 v25, 1, v24
    v_lshl_add_u32 v67, v25, 18, v67
    v_lshl_add_u32 v67, v27, 16, v67
    v_lshrrev_b32 v25, 3, v26
    v_lshl_add_u32 v67, v25, 15, v67
    v_and_b32 v25, 1, v24
    v_lshl_add_u32 v67, v25, 6, v67
    s_nop 1
    s_waitcnt vmcnt(12)
    v_add_u32 v55, 114688, v52
    ds_read_b64_tr_b16 v[160:161], v55 offset:0
    ds_read_b64_tr_b16 v[162:163], v55 offset:256
    ds_read_b64_tr_b16 v[164:165], v55 offset:4096
    ds_read_b64_tr_b16 v[166:167], v55 offset:4352
    s_xor_b32 s94, s13, 0
    s_mul_i32 s94, s94, 36864
    s_add_u32 s94, s94, s92
    s_lshl_b32 s74, s13, 7
    s_add_u32 s94, s94, s74
    s_add_u32 s78, s94, 512
    s_add_u32 s80, s66, 147456
    s_mov_b32 s76, 0
    s_mov_b32 s77, 8192
    s_call_b64 s[82:83], cf_dma
    ds_read_b64_tr_b16 v[192:193], v55 offset:64
    ds_read_b64_tr_b16 v[194:195], v55 offset:320
    ds_read_b64_tr_b16 v[196:197], v55 offset:4160
    ds_read_b64_tr_b16 v[198:199], v55 offset:4416
    s_mov_b32 s77, 16384
    s_call_b64 s[82:83], cf_dma
    v_and_b32 v25, 31, v0
    v_lshlrev_b32 v70, 4, v25
    v_lshlrev_b32 v28, 3, v25
    v_add_u32 v28, 108032, v28
    v_lshrrev_b32 v25, 1, v24
    v_lshl_add_u32 v70, v25, 9, v70
    v_and_b32 v25, 1, v24
    v_lshl_add_u32 v70, v25, 3, v70
    v_add_u32 v70, 109568, v70
    v_cmp_gt_u32 vcc, 2, v27
    s_nop 1
    v_cndmask_b32 v70, v70, v28, vcc
    s_nop 1
    s_waitcnt lgkmcnt(0)
    s_waitcnt vmcnt(12)
    v_add_u32 v55, 81920, v52
    ds_read_b64_tr_b16 v[168:169], v55 offset:0
    ds_read_b64_tr_b16 v[170:171], v55 offset:256
    ds_read_b64_tr_b16 v[172:173], v55 offset:4096
    ds_read_b64_tr_b16 v[174:175], v55 offset:4352
    s_xor_b32 s94, s13, 1
    s_mul_i32 s94, s94, 36864
    s_add_u32 s94, s94, s92
    s_lshl_b32 s74, s13, 7
    s_add_u32 s94, s94, s74
    s_add_u32 s78, s94, 512
    s_add_u32 s80, s66, 98304
    s_mov_b32 s76, 0
    s_mov_b32 s77, 8192
    s_call_b64 s[82:83], cf_dma
    ds_read_b64_tr_b16 v[200:201], v55 offset:64
    ds_read_b64_tr_b16 v[202:203], v55 offset:320
    ds_read_b64_tr_b16 v[204:205], v55 offset:4160
    ds_read_b64_tr_b16 v[206:207], v55 offset:4416
    s_mov_b32 s77, 16384
    s_call_b64 s[82:83], cf_dma
    v_xor_b32 v71, 2048, v63
    v_lshrrev_b32 v68, 4, v0
    v_lshlrev_b32 v68, 7, v68
    v_and_b32 v25, 7, v26
    v_lshl_add_u32 v68, v25, 4, v68
    v_add_u32 v68, 102400, v68
    v_xor_b32 v74, 512, v68
    v_xor_b32 v75, 1024, v68
    v_xor_b32 v76, 1536, v68
    v_lshrrev_b32 v25, 3, v26
    v_lshl_add_u32 v77, v25, 3, v68
    v_or_b32 v78, 512, v65
    v_lshlrev_b32 v79, 2, v61
    v_mov_b64 v[72:73], 0
    v_and_b32 v25, 1, v27
    v_lshlrev_b32 v69, 7, v25
    v_lshrrev_b32 v25, 1, v27
    v_lshl_add_u32 v69, v25, 3, v69
    v_and_b32 v25, 3, v26
    v_lshl_add_u32 v69, v25, 4, v69
    v_bfe_u32 v25, v26, 2, 1
    v_lshl_add_u32 v69, v25, 2, v69
    s_nop 1
    s_waitcnt lgkmcnt(0)
    s_waitcnt vmcnt(12)
    v_add_u32 v55, 16384, v52
    ds_read_b64_tr_b16 v[176:177], v55 offset:0
    ds_read_b64_tr_b16 v[178:179], v55 offset:256
    ds_read_b64_tr_b16 v[180:181], v55 offset:4096
    ds_read_b64_tr_b16 v[182:183], v55 offset:4352
    s_add_u32 s78, s67, 4194304
    s_mov_b64 s[8:9], s[54:55]
    v_mov_b32 v58, v48
    s_mov_b32 s79, 131072
    s_add_u32 s80, s66, 32768
    s_mov_b32 s76, 0
    s_mov_b32 s77, 8192
    s_call_b64 s[82:83], cf_dma
    ds_read_b64_tr_b16 v[208:209], v55 offset:64
    ds_read_b64_tr_b16 v[210:211], v55 offset:320
    ds_read_b64_tr_b16 v[212:213], v55 offset:4160
    ds_read_b64_tr_b16 v[214:215], v55 offset:4416
    s_mov_b32 s77, 16384
    s_call_b64 s[82:83], cf_dma
    s_mov_b32 s32, 0x00ff00ff
    s_mov_b32 s33, 0x00ff00ff
    s_not_b64 s[34:35], s[32:33]
    s_lshr_b32 s31, s12, 1
    s_lshl_b32 s31, s31, 8
    s_and_b32 s40, s12, 1
    s_lshl_b32 s40, s40, 6
    s_add_u32 s31, s31, s40
    s_and_b32 s40, s13, 1
    s_lshl_b32 s40, s40, 12
    s_add_u32 s31, s31, s40
    s_lshl_b32 s19, s12, 14
    s_add_u32 s19, s19, 67076096
    s_add_u32 s41, s19, 8192
    s_add_u32 s19, s19, s40
    s_and_b32 s40, s12, 1
    s_lshl_b32 s40, s40, 2
    s_or_b32 s40, s40, s13
    s_cmp_eq_u32 s40, 5
    s_cselect_b32 s64, 0, s13
    s_cmp_lg_u32 s13, 1
    s_cbranch_scc1 cf_notx
    s_mov_b32 s32, 0xff
    s_mov_b32 s33, 0xff
    s_mov_b32 s19, s41
    s_lshr_b32 s31, s12, 3
    s_lshl_b32 s31, s31, 8
    s_and_b32 s40, s12, 2
    s_lshl_b32 s40, s40, 6
    s_add_u32 s31, s31, s40
    s_and_b32 s40, s12, 4
    s_lshl_b32 s40, s40, 4
    s_add_u32 s31, s31, s40
    s_add_u32 s31, s31, 8192
cf_notx:
    s_cmp_lg_u32 s13, 0
    s_cbranch_scc1 cf_notp
    s_min_u32 s40, s12, 23
    s_mul_i32 s40, s40, 384
    s_add_u32 s40, s40, 98304
    v_add_u32 v69, s40, v61
    v_mov_b32 v25, 108288
    v_cmp_lt_u32 vcc, 23, v0
    s_nop 1
    v_cndmask_b32 v69, v69, v25, vcc
cf_notp:
    s_nop 1
    s_waitcnt lgkmcnt(0)
    s_waitcnt vmcnt(12)
    v_add_u32 v55, 0, v52
    ds_read_b64_tr_b16 v[184:185], v55 offset:0
    ds_read_b64_tr_b16 v[186:187], v55 offset:256
    ds_read_b64_tr_b16 v[188:189], v55 offset:4096
    ds_read_b64_tr_b16 v[190:191], v55 offset:4352
    s_xor_b32 s78, s75, 0
    s_add_u32 s78, s78, s67
    s_mov_b32 s81, s93
    s_add_u32 s80, s66, 114688
    s_mov_b32 s76, 0
    s_mov_b32 s77, 8192
    s_call_b64 s[82:83], cf_dma
    ds_read_b64_tr_b16 v[216:217], v55 offset:64
    ds_read_b64_tr_b16 v[218:219], v55 offset:320
    ds_read_b64_tr_b16 v[220:221], v55 offset:4160
    ds_read_b64_tr_b16 v[222:223], v55 offset:4416
    s_mov_b32 s77, 16384
    s_call_b64 s[82:83], cf_dma
    v_mov_b32 v28, 1
    v_mov_b32 v29, 1
    v_mov_b32 v30, 1
    v_mov_b32 v31, 1
    s_lshl_b32 s40, s12, 14
    s_add_u32 s40, s40, 67174400
    s_add_u32 s41, s40, 0
    buffer_store_dwordx4 v[28:31], v61, s[4:7], s41 offen
    s_add_u32 s41, s40, 4096
    buffer_store_dwordx4 v[28:31], v61, s[4:7], s41 offen
    s_add_u32 s41, s40, 8192
    buffer_store_dwordx4 v[28:31], v61, s[4:7], s41 offen
    s_cmp_eq_u32 s64, 0
    s_cselect_b64 exec, 0, s[32:33]
    v_mov_b32 v27, -1
    s_add_u32 s41, s31, 67108864
    buffer_store_dword v27, v69, s[4:7], s41 offen
    s_add_u32 s41, s31, 67125248
    buffer_store_dword v27, v69, s[4:7], s41 offen
    s_add_u32 s41, s31, 67141632
    buffer_store_dword v27, v69, s[4:7], s41 offen
    s_add_u32 s41, s31, 67158016
    buffer_store_dword v27, v69, s[4:7], s41 offen
    s_mov_b64 exec, -1
    s_waitcnt lgkmcnt(0)
    s_waitcnt vmcnt(12)
    v_add_u32 v55, 147456, v52
    ds_read_b64_tr_b16 v[224:225], v55 offset:0
    ds_read_b64_tr_b16 v[226:227], v55 offset:256
    ds_read_b64_tr_b16 v[228:229], v55 offset:4096
    ds_read_b64_tr_b16 v[230:231], v55 offset:4352
    s_mov_b32 s77, 24576
    s_call_b64 s[82:83], cf_dma
    ds_read_b64_tr_b16 v[240:241], v55 offset:64
    ds_read_b64_tr_b16 v[242:243], v55 offset:320
    ds_read_b64_tr_b16 v[244:245], v55 offset:4160
    ds_read_b64_tr_b16 v[246:247], v55 offset:4416
    s_mov_b32 s77, 32768
    s_call_b64 s[82:83], cf_dma
    s_mov_b64 s[68:69], s[48:49]
    s_mov_b32 s70, 9216
    s_mov_b32 s71, 0x20000
    v_and_b32 v25, 7, v0
    v_mul_u32_u24 v25, 1152, v25
    v_lshrrev_b32 v26, 3, v0
    v_lshl_add_u32 v25, v26, 4, v25
    buffer_load_dwordx4 v[36:39], v25, s[68:71], 0 offen
    buffer_load_dwordx4 v[40:43], v25, s[68:71], 0 offen offset:512
    v_bfe_u32 v25, v0, 2, 3
    v_mul_u32_u24 v25, 1152, v25
    v_lshrrev_b32 v26, 5, v0
    v_lshl_add_u32 v25, v26, 4, v25
    v_and_b32 v26, 3, v0
    v_lshl_add_u32 v25, v26, 2, v25
    buffer_load_dword v44, v25, s[68:71], 0 offen offset:1024
    s_nop 0
    s_waitcnt lgkmcnt(0)
    s_waitcnt vmcnt(15)
    v_add_u32 v55, 98304, v52
    ds_read_b64_tr_b16 v[232:233], v55 offset:0
    ds_read_b64_tr_b16 v[234:235], v55 offset:256
    ds_read_b64_tr_b16 v[236:237], v55 offset:4096
    ds_read_b64_tr_b16 v[238:239], v55 offset:4352
    s_xor_b32 s78, s75, 1048576
    s_add_u32 s78, s78, s67
    s_add_u32 s80, s66, 65536
    s_mov_b32 s76, 0
    s_mov_b32 s77, 8192
    s_call_b64 s[82:83], cf_dma
    ds_read_b64_tr_b16 v[248:249], v55 offset:64
    ds_read_b64_tr_b16 v[250:251], v55 offset:320
    ds_read_b64_tr_b16 v[252:253], v55 offset:4160
    ds_read_b64_tr_b16 v[254:255], v55 offset:4416
    s_mov_b32 s77, 16384
    s_call_b64 s[82:83], cf_dma
    s_mov_b32 s44, 0x3e0293ee
    s_mov_b32 s45, s44
    s_mov_b32 s46, 0x42000000
    s_mov_b32 s60, 0x3f803f80
    s_mov_b32 s61, s60
    s_mov_b32 s62, 0x3e803e80
    s_mov_b32 s63, s62
    s_mov_b32 s28, 0
    s_lshl_b32 s58, s13, 10
    s_add_u32 s58, s58, 102400
    s_lshl_b32 s59, s13, 8
    s_add_u32 s59, s59, 106496
    s_lshl_b32 s24, s12, 14
    s_add_u32 s24, s24, 0
    s_add_u32 s47, s24, 33030144
    s_mul_i32 s40, s13, 3072
    s_add_u32 s23, s24, s40
    s_lshl_b32 s20, s12, 7
    s_add_u32 s20, s20, 67174400
    s_add_u32 s21, s20, 65536
    s_add_u32 s38, s20, 4096
    s_add_u32 s39, s21, 4096
    s_lshl_b32 s22, s12, 7
    s_add_u32 s22, s22, 67182592
    s_waitcnt lgkmcnt(0)
    s_waitcnt vmcnt(15)
    v_add_u32 v55, 32768, v51
    v_xor_b32 v56, 32, v55
    ds_read_b64_tr_b16 v[144:145], v55 offset:0
    ds_read_b64_tr_b16 v[146:147], v55 offset:256
    ds_read_b64_tr_b16 v[148:149], v55 offset:8192
    ds_read_b64_tr_b16 v[150:151], v55 offset:8448
    s_mov_b32 s77, 24576
    s_call_b64 s[82:83], cf_dma
    ds_read_b64_tr_b16 v[152:153], v56 offset:0
    ds_read_b64_tr_b16 v[154:155], v56 offset:256
    ds_read_b64_tr_b16 v[156:157], v56 offset:8192
    ds_read_b64_tr_b16 v[158:159], v56 offset:8448
    s_mov_b32 s77, 32768
    s_call_b64 s[82:83], cf_dma
    s_lshl_b32 s40, s12, 12
    s_add_u32 s25, s40, 79429632
    s_add_u32 s26, s40, 88866816
    s_lshl_b32 s65, s12, 9
    s_add_u32 s65, s65, 90177536
    s_lshl_b32 s40, s13, 5
    s_or_b32 s40, s40, s12
    s_cmp_lt_u32 s40, 24
    s_cselect_b32 s36, 0x1ffffff, 0
    s_mov_b32 s37, 0
    s_lshl_b32 s27, s12, 7
    s_add_u32 s27, s27, 125845504
    s_lshl_b32 s40, s13, 2
    s_add_u32 s27, s27, s40
    v_bfe_u32 v28, v61, 4, 4
    v_bfe_u32 v29, v61, 8, 1
    v_lshlrev_b32 v29, 2, v29
    v_sub_u32 v29, v28, v29
    v_mov_b32 v31, 0x3f80
    v_mov_b32 v32, 0x3f800000
    s_nop 1
    s_waitcnt lgkmcnt(0)
    s_waitcnt vmcnt(11)
    v_add_u32 v55, 114688, v51
    v_xor_b32 v56, 32, v55
    ds_read_b64_tr_b16 a[192:193], v55 offset:0
    ds_read_b64_tr_b16 a[194:195], v55 offset:256
    ds_read_b64_tr_b16 a[196:197], v55 offset:8192
    ds_read_b64_tr_b16 a[198:199], v55 offset:8448
    s_xor_b32 s78, s75, 2097152
    s_add_u32 s78, s78, s67
    s_add_u32 s80, s66, 0
    s_mov_b32 s76, 0
    s_mov_b32 s77, 8192
    s_call_b64 s[82:83], cf_dma
    ds_read_b64_tr_b16 a[200:201], v56 offset:0
    ds_read_b64_tr_b16 a[202:203], v56 offset:256
    ds_read_b64_tr_b16 a[204:205], v56 offset:8192
    ds_read_b64_tr_b16 a[206:207], v56 offset:8448
    s_mov_b32 s77, 16384
    s_call_b64 s[82:83], cf_dma
    v_cmp_eq_u32 vcc, 0, v29
    s_nop 1
    v_cndmask_b32 v16, 0, v31, vcc
    v_cmp_eq_u32 vcc, 1, v29
    s_nop 1
    v_cndmask_b32 v16, v16, v32, vcc
    v_cmp_eq_u32 vcc, 0, v28
    s_nop 1
    v_cndmask_b32 v20, 0, v31, vcc
    v_cmp_eq_u32 vcc, 1, v28
    s_nop 1
    v_cndmask_b32 v20, v20, v32, vcc
    s_nop 1
    s_waitcnt lgkmcnt(0)
    v_add_u32 v55, 131072, v51
    v_xor_b32 v56, 32, v55
    ds_read_b64_tr_b16 a[208:209], v55 offset:0
    ds_read_b64_tr_b16 a[210:211], v55 offset:256
    ds_read_b64_tr_b16 a[212:213], v55 offset:8192
    ds_read_b64_tr_b16 a[214:215], v55 offset:8448
    s_mov_b32 s77, 24576
    s_call_b64 s[82:83], cf_dma
    ds_read_b64_tr_b16 a[216:217], v56 offset:0
    ds_read_b64_tr_b16 a[218:219], v56 offset:256
    ds_read_b64_tr_b16 a[220:221], v56 offset:8192
    ds_read_b64_tr_b16 a[222:223], v56 offset:8448
    s_mov_b32 s77, 32768
    s_call_b64 s[82:83], cf_dma
    v_cmp_eq_u32 vcc, 2, v29
    s_nop 1
    v_cndmask_b32 v17, 0, v31, vcc
    v_cmp_eq_u32 vcc, 3, v29
    s_nop 1
    v_cndmask_b32 v17, v17, v32, vcc
    v_cmp_eq_u32 vcc, 2, v28
    s_nop 1
    v_cndmask_b32 v21, 0, v31, vcc
    v_cmp_eq_u32 vcc, 3, v28
    s_nop 1
    v_cndmask_b32 v21, v21, v32, vcc
    s_nop 1
    s_waitcnt lgkmcnt(0)
    s_waitcnt vmcnt(8)
    v_add_u32 v55, 65536, v51
    v_xor_b32 v56, 32, v55
    ds_read_b64_tr_b16 a[224:225], v55 offset:0
    ds_read_b64_tr_b16 a[226:227], v55 offset:256
    ds_read_b64_tr_b16 a[228:229], v55 offset:8192
    ds_read_b64_tr_b16 a[230:231], v55 offset:8448
    s_cmp_eq_u32 s88, 0
    s_cbranch_scc1 cf_cpe626
    s_lshl_b32 s89, s73, 7
    s_add_u32 s89, s89, 125853696
    v_min_u32 v33, 11, v57
    v_lshlrev_b32 v33, 2, v33
    buffer_load_dword v34, off, s[96:99], 0 offset:64 sc1
    buffer_load_dword v35, v33, s[4:7], s89 offen sc1
cf_cpe626:
    s_xor_b32 s78, s75, 3145728
    s_add_u32 s78, s78, s67
    s_add_u32 s80, s66, 32768
    s_mov_b32 s76, 0
    s_mov_b32 s77, 8192
    s_call_b64 s[82:83], cf_dma
    ds_read_b64_tr_b16 a[232:233], v56 offset:0
    ds_read_b64_tr_b16 a[234:235], v56 offset:256
    ds_read_b64_tr_b16 a[236:237], v56 offset:8192
    ds_read_b64_tr_b16 a[238:239], v56 offset:8448
    s_mov_b32 s77, 16384
    s_call_b64 s[82:83], cf_dma
    v_cmp_eq_u32 vcc, 8, v29
    s_nop 1
    v_cndmask_b32 v18, 0, v31, vcc
    v_cmp_eq_u32 vcc, 9, v29
    s_nop 1
    v_cndmask_b32 v18, v18, v32, vcc
    v_cmp_eq_u32 vcc, 4, v28
    s_nop 1
    v_cndmask_b32 v22, 0, v31, vcc
    v_cmp_eq_u32 vcc, 5, v28
    s_nop 1
    v_cndmask_b32 v22, v22, v32, vcc
    s_nop 1
    s_waitcnt lgkmcnt(0)
    v_add_u32 v55, 81920, v51
    v_xor_b32 v56, 32, v55
    ds_read_b64_tr_b16 a[240:241], v55 offset:0
    ds_read_b64_tr_b16 a[242:243], v55 offset:256
    ds_read_b64_tr_b16 a[244:245], v55 offset:8192
    ds_read_b64_tr_b16 a[246:247], v55 offset:8448
    s_mov_b32 s77, 24576
    s_call_b64 s[82:83], cf_dma
    ds_read_b64_tr_b16 a[248:249], v56 offset:0
    ds_read_b64_tr_b16 a[250:251], v56 offset:256
    ds_read_b64_tr_b16 a[252:253], v56 offset:8192
    ds_read_b64_tr_b16 a[254:255], v56 offset:8448
    s_mov_b32 s77, 32768
    s_call_b64 s[82:83], cf_dma
    v_cmp_eq_u32 vcc, 10, v29
    s_nop 1
    v_cndmask_b32 v19, 0, v31, vcc
    v_cmp_eq_u32 vcc, 11, v29
    s_nop 1
    v_cndmask_b32 v19, v19, v32, vcc
    v_cmp_eq_u32 vcc, 6, v28
    s_nop 1
    v_cndmask_b32 v23, 0, v31, vcc
    v_cmp_eq_u32 vcc, 7, v28
    s_nop 1
    v_cndmask_b32 v23, v23, v32, vcc
    s_nop 1
    s_waitcnt lgkmcnt(0)
    s_waitcnt vmcnt(8)
    v_add_u32 v55, 0, v51
    v_xor_b32 v56, 32, v55
    ds_read_b64_tr_b16 v[80:81], v55 offset:0
    ds_read_b64_tr_b16 v[82:83], v55 offset:256
    ds_read_b64_tr_b16 v[84:85], v55 offset:8192
    ds_read_b64_tr_b16 v[86:87], v55 offset:8448
    s_cmp_eq_u32 s88, 0
    s_cbranch_scc1 cf_ncp696
    s_waitcnt vmcnt(8)
    v_max_u32 v34, 1, v34
    v_cmp_eq_u32 vcc, 1, v34
    s_cbranch_vccnz cf_ncp696
    v_cmp_ne_u32 vcc, v34, v35
    s_cbranch_vccnz cf_ncp696
    s_mov_b32 s88, 0
    s_mov_b32 s72, 5
    s_lshl_b32 s74, s73, 19
    s_add_u32 s74, s74, 96468992
    s_add_u32 s50, s4, s74
    s_addc_u32 s51, s5, 0
    s_add_u32 s52, s50, 147456
    s_addc_u32 s53, s51, 0
    s_lshl_b32 s67, s13, 6
    v_and_b32 v54, 63, v48
    v_lshrrev_b32 v48, 13, v48
    v_lshl_add_u32 v48, v48, 8, v54
cf_ncp696:
    s_cmp_eq_u32 s88, 0
    s_cbranch_scc1 cf_cpe717
    s_lshl_b32 s89, s73, 7
    s_add_u32 s89, s89, 125853696
    v_min_u32 v33, 11, v57
    v_lshlrev_b32 v33, 2, v33
    buffer_load_dword v34, off, s[96:99], 0 offset:64 sc1
    buffer_load_dword v35, v33, s[4:7], s89 offen sc1
cf_cpe717:
    s_xor_b32 s78, s75, 2097152
    s_lshr_b32 s78, s78, s72
    s_add_u32 s78, s78, s67
    s_mov_b64 s[8:9], s[52:53]
    v_mov_b32 v58, v48
    s_lshr_b32 s79, 131072, s72
    s_add_u32 s80, s66, 131072
    s_mov_b32 s76, 0
    s_mov_b32 s77, 8192
    s_call_b64 s[82:83], cf_dma
    ds_read_b64_tr_b16 v[88:89], v56 offset:0
    ds_read_b64_tr_b16 v[90:91], v56 offset:256
    ds_read_b64_tr_b16 v[92:93], v56 offset:8192
    ds_read_b64_tr_b16 v[94:95], v56 offset:8448
    s_mov_b32 s77, 16384
    s_call_b64 s[82:83], cf_dma
    v_mov_b32 v46, 1
    s_mov_b64 exec, 1
    buffer_atomic_add v46, off, s[96:99], 0 offset:132 sc0
    s_mov_b64 exec, -1
    s_waitcnt lgkmcnt(0)
    v_add_u32 v55, 16384, v51
    v_xor_b32 v56, 32, v55
    ds_read_b64_tr_b16 v[96:97], v55 offset:0
    ds_read_b64_tr_b16 v[98:99], v55 offset:256
    ds_read_b64_tr_b16 v[100:101], v55 offset:8192
    ds_read_b64_tr_b16 v[102:103], v55 offset:8448
    s_mov_b32 s77, 24576
    s_call_b64 s[82:83], cf_dma
    ds_read_b64_tr_b16 v[104:105], v56 offset:0
    ds_read_b64_tr_b16 v[106:107], v56 offset:256
    ds_read_b64_tr_b16 v[108:109], v56 offset:8192
    ds_read_b64_tr_b16 v[110:111], v56 offset:8448
    s_mov_b32 s77, 32768
    s_call_b64 s[82:83], cf_dma
    s_waitcnt lgkmcnt(0)
    s_waitcnt vmcnt(9)
    v_add_u32 v55, 32768, v51
    v_xor_b32 v56, 32, v55
    ds_read_b64_tr_b16 v[112:113], v55 offset:0
    ds_read_b64_tr_b16 v[114:115], v55 offset:256
    ds_read_b64_tr_b16 v[116:117], v55 offset:8192
    ds_read_b64_tr_b16 v[118:119], v55 offset:8448
    s_cmp_eq_u32 s88, 0
    s_cbranch_scc1 cf_ncp769
    s_waitcnt vmcnt(9)
    v_max_u32 v34, 1, v34
    v_cmp_eq_u32 vcc, 1, v34
    s_cbranch_vccnz cf_ncp769
    v_cmp_ne_u32 vcc, v34, v35
    s_cbranch_vccnz cf_ncp769
    s_mov_b32 s88, 0
    s_mov_b32 s72, 5
    s_lshl_b32 s74, s73, 19
    s_add_u32 s74, s74, 96468992
    s_add_u32 s50, s4, s74
    s_addc_u32 s51, s5, 0
    s_add_u32 s52, s50, 147456
    s_addc_u32 s53, s51, 0
    s_lshl_b32 s67, s13, 6
    v_and_b32 v54, 63, v48
    v_lshrrev_b32 v48, 13, v48
    v_lshl_add_u32 v48, v48, 8, v54
cf_ncp769:
    s_cmp_eq_u32 s88, 0
    s_cbranch_scc1 cf_cpe790
    s_lshl_b32 s89, s73, 7
    s_add_u32 s89, s89, 125853696
    v_min_u32 v33, 11, v57
    v_lshlrev_b32 v33, 2, v33
    buffer_load_dword v34, off, s[96:99], 0 offset:64 sc1
    buffer_load_dword v35, v33, s[4:7], s89 offen sc1
cf_cpe790:
    s_xor_b32 s78, s75, 3145728
    s_lshr_b32 s78, s78, s72
    s_add_u32 s78, s78, s67
    s_mov_b64 s[8:9], s[52:53]
    v_mov_b32 v58, v48
    s_lshr_b32 s79, 131072, s72
    s_add_u32 s80, s66, 65536
    s_mov_b32 s76, 0
    s_mov_b32 s77, 8192
    s_call_b64 s[82:83], cf_dma
    ds_read_b64_tr_b16 v[120:121], v56 offset:0
    ds_read_b64_tr_b16 v[122:123], v56 offset:256
    ds_read_b64_tr_b16 v[124:125], v56 offset:8192
    ds_read_b64_tr_b16 v[126:127], v56 offset:8448
    s_mov_b32 s77, 16384
    s_call_b64 s[82:83], cf_dma
    s_waitcnt lgkmcnt(0)
    v_add_u32 v55, 49152, v51
    v_xor_b32 v56, 32, v55
    ds_read_b64_tr_b16 v[128:129], v55 offset:0
    ds_read_b64_tr_b16 v[130:131], v55 offset:256
    ds_read_b64_tr_b16 v[132:133], v55 offset:8192
    ds_read_b64_tr_b16 v[134:135], v55 offset:8448
    s_mov_b32 s77, 24576
    s_call_b64 s[82:83], cf_dma
    ds_read_b64_tr_b16 v[136:137], v56 offset:0
    ds_read_b64_tr_b16 v[138:139], v56 offset:256
    ds_read_b64_tr_b16 v[140:141], v56 offset:8192
    ds_read_b64_tr_b16 v[142:143], v56 offset:8448
    s_mov_b32 s77, 32768
    s_call_b64 s[82:83], cf_dma
    s_waitcnt lgkmcnt(0)
    s_waitcnt vmcnt(8)
    v_add_u32 v55, 131072, v51
    v_xor_b32 v56, 32, v55
    ds_read_b64_tr_b16 a[128:129], v55 offset:0
    ds_read_b64_tr_b16 a[130:131], v55 offset:256
    ds_read_b64_tr_b16 a[132:133], v55 offset:8192
    ds_read_b64_tr_b16 a[134:135], v55 offset:8448
    s_cmp_eq_u32 s88, 0
    s_cbranch_scc1 cf_ncp838
    s_waitcnt vmcnt(8)
    v_max_u32 v34, 1, v34
    v_cmp_eq_u32 vcc, 1, v34
    s_cbranch_vccnz cf_ncp838
    v_cmp_ne_u32 vcc, v34, v35
    s_cbranch_vccnz cf_ncp838
    s_mov_b32 s88, 0
    s_mov_b32 s72, 5
    s_lshl_b32 s74, s73, 19
    s_add_u32 s74, s74, 96468992
    s_add_u32 s50, s4, s74
    s_addc_u32 s51, s5, 0
    s_add_u32 s52, s50, 147456
    s_addc_u32 s53, s51, 0
    s_lshl_b32 s67, s13, 6
    v_and_b32 v54, 63, v48
    v_lshrrev_b32 v48, 13, v48
    v_lshl_add_u32 v48, v48, 8, v54
cf_ncp838:
    s_cmp_eq_u32 s88, 0
    s_cbranch_scc1 cf_cpe859
    s_lshl_b32 s89, s73, 7
    s_add_u32 s89, s89, 125853696
    v_min_u32 v33, 11, v57
    v_lshlrev_b32 v33, 2, v33
    buffer_load_dword v34, off, s[96:99], 0 offset:64 sc1
    buffer_load_dword v35, v33, s[4:7], s89 offen sc1
cf_cpe859:
    s_xor_b32 s78, s75, 2097152
    s_lshr_b32 s78, s78, s72
    s_add_u32 s78, s78, s67
    s_mov_b64 s[8:9], s[50:51]
    v_mov_b32 v58, v48
    s_lshr_b32 s79, 131072, s72
    s_add_u32 s80, s66, 0
    s_mov_b32 s76, 0
    s_mov_b32 s77, 8192
    s_call_b64 s[82:83], cf_dma
    ds_read_b64_tr_b16 a[136:137], v56 offset:0
    ds_read_b64_tr_b16 a[138:139], v56 offset:256
    ds_read_b64_tr_b16 a[140:141], v56 offset:8192
    ds_read_b64_tr_b16 a[142:143], v56 offset:8448
    s_mov_b32 s77, 16384
    s_call_b64 s[82:83], cf_dma
    s_waitcnt lgkmcnt(0)
    v_add_u32 v55, 147456, v51
    v_xor_b32 v56, 32, v55
    ds_read_b64_tr_b16 a[144:145], v55 offset:0
    ds_read_b64_tr_b16 a[146:147], v55 offset:256
    ds_read_b64_tr_b16 a[148:149], v55 offset:8192
    ds_read_b64_tr_b16 a[150:151], v55 offset:8448
    s_mov_b32 s77, 24576
    s_call_b64 s[82:83], cf_dma
    ds_read_b64_tr_b16 a[152:153], v56 offset:0
    ds_read_b64_tr_b16 a[154:155], v56 offset:256
    ds_read_b64_tr_b16 a[156:157], v56 offset:8192
    ds_read_b64_tr_b16 a[158:159], v56 offset:8448
    s_mov_b32 s77, 32768
    s_call_b64 s[82:83], cf_dma
    s_waitcnt lgkmcnt(0)
    s_waitcnt vmcnt(8)
    v_add_u32 v55, 65536, v51
    v_xor_b32 v56, 32, v55
    ds_read_b64_tr_b16 a[160:161], v55 offset:0
    ds_read_b64_tr_b16 a[162:163], v55 offset:256
    ds_read_b64_tr_b16 a[164:165], v55 offset:8192
    ds_read_b64_tr_b16 a[166:167], v55 offset:8448
    s_cmp_eq_u32 s88, 0
    s_cbranch_scc1 cf_ncp907
    s_waitcnt vmcnt(8)
    v_max_u32 v34, 1, v34
    v_cmp_eq_u32 vcc, 1, v34
    s_cbranch_vccnz cf_ncp907
    v_cmp_ne_u32 vcc, v34, v35
    s_cbranch_vccnz cf_ncp907
    s_mov_b32 s88, 0
    s_mov_b32 s72, 5
    s_lshl_b32 s74, s73, 19
    s_add_u32 s74, s74, 96468992
    s_add_u32 s50, s4, s74
    s_addc_u32 s51, s5, 0
    s_add_u32 s52, s50, 147456
    s_addc_u32 s53, s51, 0
    s_lshl_b32 s67, s13, 6
    v_and_b32 v54, 63, v48
    v_lshrrev_b32 v48, 13, v48
    v_lshl_add_u32 v48, v48, 8, v54
cf_ncp907:
    s_cmp_eq_u32 s88, 0
    s_cbranch_scc1 cf_cpe928
    s_lshl_b32 s89, s73, 7
    s_add_u32 s89, s89, 125853696
    v_min_u32 v33, 11, v57
    v_lshlrev_b32 v33, 2, v33
    buffer_load_dword v34, off, s[96:99], 0 offset:64 sc1
    buffer_load_dword v35, v33, s[4:7], s89 offen sc1
cf_cpe928:
    s_xor_b32 s78, s75, 3145728
    s_lshr_b32 s78, s78, s72
    s_add_u32 s78, s78, s67
    s_mov_b64 s[8:9], s[50:51]
    v_mov_b32 v58, v48
    s_lshr_b32 s79, 131072, s72
    s_add_u32 s80, s66, 32768
    s_mov_b32 s76, 0
    s_mov_b32 s77, 8192
    s_call_b64 s[82:83], cf_dma
    ds_read_b64_tr_b16 a[168:169], v56 offset:0
    ds_read_b64_tr_b16 a[170:171], v56 offset:256
    ds_read_b64_tr_b16 a[172:173], v56 offset:8192
    ds_read_b64_tr_b16 a[174:175], v56 offset:8448
    s_mov_b32 s77, 16384
    s_call_b64 s[82:83], cf_dma
    v_readfirstlane_b32 s41, v46
    v_mov_b32 v46, 1
    v_mov_b32 v47, 0
    s_cmp_eq_u32 s41, 127
    s_cselect_b64 exec, 1, 0
    buffer_atomic_cmpswap v[46:47], off, s[96:99], 0 offset:140
    s_mov_b64 exec, -1
    s_waitcnt lgkmcnt(0)
    v_add_u32 v55, 81920, v51
    v_xor_b32 v56, 32, v55
    ds_read_b64_tr_b16 a[176:177], v55 offset:0
    ds_read_b64_tr_b16 a[178:179], v55 offset:256
    ds_read_b64_tr_b16 a[180:181], v55 offset:8192
    ds_read_b64_tr_b16 a[182:183], v55 offset:8448
    s_mov_b32 s77, 24576
    s_call_b64 s[82:83], cf_dma
    ds_read_b64_tr_b16 a[184:185], v56 offset:0
    ds_read_b64_tr_b16 a[186:187], v56 offset:256
    ds_read_b64_tr_b16 a[188:189], v56 offset:8192
    ds_read_b64_tr_b16 a[190:191], v56 offset:8448
    s_mov_b32 s77, 32768
    s_call_b64 s[82:83], cf_dma
    s_waitcnt lgkmcnt(0)
    s_waitcnt vmcnt(8)
    v_add_u32 v55, 0, v51
    v_xor_b32 v56, 32, v55
    ds_read_b64_tr_b16 a[48:49], v55 offset:0
    ds_read_b64_tr_b16 a[50:51], v55 offset:256
    ds_read_b64_tr_b16 a[52:53], v55 offset:8192
    ds_read_b64_tr_b16 a[54:55], v55 offset:8448
    s_lshr_b32 s78, 4194304, s72
    s_add_u32 s78, s78, s67
    s_mov_b32 s81, 0
    s_add_u32 s80, s66, 98304
    s_mov_b32 s76, 0
    s_mov_b32 s77, 8192
    s_call_b64 s[82:83], cf_dma
    ds_read_b64_tr_b16 a[56:57], v56 offset:0
    ds_read_b64_tr_b16 a[58:59], v56 offset:256
    ds_read_b64_tr_b16 a[60:61], v56 offset:8192
    ds_read_b64_tr_b16 a[62:63], v56 offset:8448
    s_mov_b32 s77, 16384
    s_call_b64 s[82:83], cf_dma
    s_waitcnt lgkmcnt(0)
    v_add_u32 v55, 16384, v51
    v_xor_b32 v56, 32, v55
    ds_read_b64_tr_b16 a[64:65], v55 offset:0
    ds_read_b64_tr_b16 a[66:67], v55 offset:256
    ds_read_b64_tr_b16 a[68:69], v55 offset:8192
    ds_read_b64_tr_b16 a[70:71], v55 offset:8448
    s_cmp_eq_u32 s88, 0
    s_cbranch_scc1 cf_ncp1003
    s_waitcnt vmcnt(12)
    v_max_u32 v34, 1, v34
    v_cmp_eq_u32 vcc, 1, v34
    s_cbranch_vccnz cf_ncp1003
    v_cmp_ne_u32 vcc, v34, v35
    s_cbranch_vccnz cf_ncp1003
    s_mov_b32 s88, 0
    s_mov_b32 s72, 5
    s_lshl_b32 s74, s73, 19
    s_add_u32 s74, s74, 96468992
    s_add_u32 s50, s4, s74
    s_addc_u32 s51, s5, 0
    s_add_u32 s52, s50, 147456
    s_addc_u32 s53, s51, 0
    s_lshl_b32 s67, s13, 6
    v_and_b32 v54, 63, v48
    v_lshrrev_b32 v48, 13, v48
    v_lshl_add_u32 v48, v48, 8, v54
cf_ncp1003:
    s_xor_b32 s78, s75, 1048576
    s_lshr_b32 s78, s78, s72
    s_add_u32 s78, s78, s67
    s_mov_b64 s[8:9], s[50:51]
    v_mov_b32 v58, v48
    s_lshr_b32 s79, 131072, s72
    s_mov_b32 s81, s93
    s_add_u32 s80, s66, 114688
    s_mov_b32 s76, 0
    s_mov_b32 s77, 8192
    s_call_b64 s[82:83], cf_dma
    ds_read_b64_tr_b16 a[72:73], v56 offset:0
    ds_read_b64_tr_b16 a[74:75], v56 offset:256
    ds_read_b64_tr_b16 a[76:77], v56 offset:8192
    ds_read_b64_tr_b16 a[78:79], v56 offset:8448
    s_mov_b32 s77, 16384
    s_call_b64 s[82:83], cf_dma
    s_waitcnt lgkmcnt(0)
    s_waitcnt vmcnt(8)
    v_add_u32 v55, 32768, v51
    v_xor_b32 v56, 32, v55
    ds_read_b64_tr_b16 a[80:81], v55 offset:0
    ds_read_b64_tr_b16 a[82:83], v55 offset:256
    ds_read_b64_tr_b16 a[84:85], v55 offset:8192
    ds_read_b64_tr_b16 a[86:87], v55 offset:8448
    s_mov_b32 s77, 24576
    s_call_b64 s[82:83], cf_dma
    ds_read_b64_tr_b16 a[88:89], v56 offset:0
    ds_read_b64_tr_b16 a[90:91], v56 offset:256
    ds_read_b64_tr_b16 a[92:93], v56 offset:8192
    ds_read_b64_tr_b16 a[94:95], v56 offset:8448
    s_mov_b32 s77, 32768
    s_call_b64 s[82:83], cf_dma
    s_waitcnt lgkmcnt(0)
    v_add_u32 v55, 49152, v51
    v_xor_b32 v56, 32, v55
    ds_read_b64_tr_b16 a[96:97], v55 offset:0
    ds_read_b64_tr_b16 a[98:99], v55 offset:256
    ds_read_b64_tr_b16 a[100:101], v55 offset:8192
    ds_read_b64_tr_b16 a[102:103], v55 offset:8448
    s_xor_b32 s78, s75, 0
    s_lshr_b32 s78, s78, s72
    s_add_u32 s78, s78, s67
    s_add_u32 s80, s66, 65536
    s_mov_b32 s76, 0
    s_mov_b32 s77, 8192
    s_call_b64 s[82:83], cf_dma
    ds_read_b64_tr_b16 a[104:105], v56 offset:0
    ds_read_b64_tr_b16 a[106:107], v56 offset:256
    ds_read_b64_tr_b16 a[108:109], v56 offset:8192
    ds_read_b64_tr_b16 a[110:111], v56 offset:8448
    s_mov_b32 s77, 16384
    s_call_b64 s[82:83], cf_dma
    s_waitcnt lgkmcnt(0)
    s_waitcnt vmcnt(12)
    v_add_u32 v55, 98304, v51
    v_xor_b32 v56, 32, v55
    ds_read_b64_tr_b16 a[112:113], v55 offset:0
    ds_read_b64_tr_b16 a[114:115], v55 offset:256
    ds_read_b64_tr_b16 a[116:117], v55 offset:8192
    ds_read_b64_tr_b16 a[118:119], v55 offset:8448
    s_mov_b32 s77, 24576
    s_call_b64 s[82:83], cf_dma
    ds_read_b64_tr_b16 a[120:121], v56 offset:0
    ds_read_b64_tr_b16 a[122:123], v56 offset:256
    ds_read_b64_tr_b16 a[124:125], v56 offset:8192
    ds_read_b64_tr_b16 a[126:127], v56 offset:8448
    s_mov_b32 s77, 32768
    s_call_b64 s[82:83], cf_dma
    s_waitcnt lgkmcnt(0)
    s_waitcnt vmcnt(8)
    v_add_u32 v55, 114688, v51
    v_xor_b32 v56, 32, v55
    ds_read_b64_tr_b16 a[16:17], v55 offset:0
    ds_read_b64_tr_b16 a[18:19], v55 offset:256
    ds_read_b64_tr_b16 a[20:21], v55 offset:8192
    ds_read_b64_tr_b16 a[22:23], v55 offset:8448
    s_xor_b32 s78, s75, 0
    s_lshr_b32 s78, s78, s72
    s_add_u32 s78, s78, s67
    s_mov_b64 s[8:9], s[52:53]
    s_add_u32 s80, s66, 0
    s_mov_b32 s76, 0
    s_mov_b32 s77, 8192
    s_call_b64 s[82:83], cf_dma
    ds_read_b64_tr_b16 a[24:25], v56 offset:0
    ds_read_b64_tr_b16 a[26:27], v56 offset:256
    ds_read_b64_tr_b16 a[28:29], v56 offset:8192
    ds_read_b64_tr_b16 a[30:31], v56 offset:8448
    s_mov_b32 s77, 16384
    s_call_b64 s[82:83], cf_dma
    s_waitcnt lgkmcnt(0)
    v_add_u32 v55, 131072, v51
    v_xor_b32 v56, 32, v55
    ds_read_b64_tr_b16 a[32:33], v55 offset:0
    ds_read_b64_tr_b16 a[34:35], v55 offset:256
    ds_read_b64_tr_b16 a[36:37], v55 offset:8192
    ds_read_b64_tr_b16 a[38:39], v55 offset:8448
    s_mov_b32 s77, 24576
    s_call_b64 s[82:83], cf_dma
    ds_read_b64_tr_b16 a[40:41], v56 offset:0
    ds_read_b64_tr_b16 a[42:43], v56 offset:256
    ds_read_b64_tr_b16 a[44:45], v56 offset:8192
    ds_read_b64_tr_b16 a[46:47], v56 offset:8448
    s_mov_b32 s77, 32768
    s_call_b64 s[82:83], cf_dma
    s_waitcnt lgkmcnt(0)
    s_waitcnt vmcnt(8)
    v_add_u32 v55, 65536, v51
    v_xor_b32 v56, 32, v55
    ds_read_b64_tr_b16 v[0:1], v55 offset:0
    ds_read_b64_tr_b16 v[2:3], v55 offset:256
    ds_read_b64_tr_b16 v[4:5], v55 offset:8192
    ds_read_b64_tr_b16 v[6:7], v55 offset:8448
    s_xor_b32 s78, s75, 1048576
    s_lshr_b32 s78, s78, s72
    s_add_u32 s78, s78, s67
    s_add_u32 s80, s66, 32768
    s_mov_b32 s76, 0
    s_mov_b32 s77, 8192
    s_call_b64 s[82:83], cf_dma
    ds_read_b64_tr_b16 v[8:9], v56 offset:0
    ds_read_b64_tr_b16 v[10:11], v56 offset:256
    ds_read_b64_tr_b16 v[12:13], v56 offset:8192
    ds_read_b64_tr_b16 v[14:15], v56 offset:8448
    s_mov_b32 s77, 16384
    s_call_b64 s[82:83], cf_dma
    s_waitcnt lgkmcnt(0)
    ds_write_b128 v62, v[0:3] offset:8192
    ds_write_b128 v62, v[4:7] offset:12288
    ds_write_b128 v62, v[8:11] offset:16384
    ds_write_b128 v62, v[12:15] offset:20480
    s_waitcnt lgkmcnt(0)
    v_add_u32 v55, 81920, v51
    v_xor_b32 v56, 32, v55
    ds_read_b64_tr_b16 a[0:1], v55 offset:0
    ds_read_b64_tr_b16 a[2:3], v55 offset:256
    ds_read_b64_tr_b16 a[4:5], v55 offset:8192
    ds_read_b64_tr_b16 a[6:7], v55 offset:8448
    s_mov_b32 s77, 24576
    s_call_b64 s[82:83], cf_dma
    ds_read_b64_tr_b16 a[8:9], v56 offset:0
    ds_read_b64_tr_b16 a[10:11], v56 offset:256
    ds_read_b64_tr_b16 a[12:13], v56 offset:8192
    ds_read_b64_tr_b16 a[14:15], v56 offset:8448
    s_mov_b32 s77, 32768
    s_call_b64 s[82:83], cf_dma
    s_waitcnt lgkmcnt(0)
    s_waitcnt vmcnt(8)
    v_add_u32 v55, 0, v51
    v_xor_b32 v56, 32, v55
    ds_read_b64_tr_b16 v[0:1], v55 offset:0
    ds_read_b64_tr_b16 v[2:3], v55 offset:256
    ds_read_b64_tr_b16 v[4:5], v55 offset:8192
    ds_read_b64_tr_b16 v[6:7], v55 offset:8448
    s_xor_b32 s94, s13, 0
    s_mul_i32 s94, s94, 36864
    s_add_u32 s94, s94, s92
    s_lshr_b32 s74, s13, 1
    s_lshl_b32 s74, s74, 6
    s_add_u32 s94, s94, s74
    s_add_u32 s78, s94, 1024
    s_mov_b64 s[8:9], s[56:57]
    v_mov_b32 v58, v50
    s_mov_b32 s79, 18432
    s_mov_b32 s81, 0
    s_add_u32 s80, s66, 147456
    s_mov_b32 s76, 0
    s_mov_b32 s77, 8192
    s_call_b64 s[82:83], cf_dma
    ds_read_b64_tr_b16 v[8:9], v56 offset:0
    ds_read_b64_tr_b16 v[10:11], v56 offset:256
    ds_read_b64_tr_b16 v[12:13], v56 offset:8192
    ds_read_b64_tr_b16 v[14:15], v56 offset:8448
    s_xor_b32 s94, s13, 2
    s_mul_i32 s94, s94, 36864
    s_add_u32 s94, s94, s92
    s_lshr_b32 s74, s13, 1
    s_lshl_b32 s74, s74, 6
    s_add_u32 s94, s94, s74
    s_add_u32 s78, s94, 1024
    s_mov_b32 s77, 16384
    s_call_b64 s[82:83], cf_dma
    s_waitcnt lgkmcnt(0)
    ds_write_b128 v61, v[0:3] offset:0
    ds_write_b128 v61, v[4:7] offset:4096
    ds_write_b128 v61, v[8:11] offset:8192
    ds_write_b128 v61, v[12:15] offset:12288
    s_waitcnt lgkmcnt(0)
    v_add_u32 v55, 16384, v51
    v_xor_b32 v56, 32, v55
    ds_read_b64_tr_b16 v[0:1], v55 offset:0
    ds_read_b64_tr_b16 v[2:3], v55 offset:256
    ds_read_b64_tr_b16 v[4:5], v55 offset:8192
    ds_read_b64_tr_b16 v[6:7], v55 offset:8448
    s_xor_b32 s94, s13, 3
    s_mul_i32 s94, s94, 36864
    s_add_u32 s94, s94, s92
    s_lshl_b32 s74, s13, 7
    s_add_u32 s94, s94, s74
    s_add_u32 s78, s94, 512
    v_mov_b32 v58, v49
    s_mov_b32 s79, 9216
    s_add_u32 s80, s66, 131072
    s_mov_b32 s76, 0
    s_mov_b32 s77, 8192
    s_call_b64 s[82:83], cf_dma
    ds_read_b64_tr_b16 v[8:9], v56 offset:0
    ds_read_b64_tr_b16 v[10:11], v56 offset:256
    ds_read_b64_tr_b16 v[12:13], v56 offset:8192
    ds_read_b64_tr_b16 v[14:15], v56 offset:8448
    s_mov_b32 s77, 16384
    s_call_b64 s[82:83], cf_dma
    s_waitcnt lgkmcnt(0)
    ds_write_b128 v61, v[0:3] offset:16384
    ds_write_b128 v61, v[4:7] offset:20480
    ds_write_b128 v61, v[8:11] offset:24576
    ds_write_b128 v61, v[12:15] offset:28672
    s_waitcnt lgkmcnt(0)
    s_waitcnt vmcnt(8)
    v_add_u32 v55, 32768, v51
    v_xor_b32 v56, 32, v55
    ds_read_b64_tr_b16 v[0:1], v55 offset:0
    ds_read_b64_tr_b16 v[2:3], v55 offset:256
    ds_read_b64_tr_b16 v[4:5], v55 offset:8192
    ds_read_b64_tr_b16 v[6:7], v55 offset:8448
    s_xor_b32 s94, s13, 2
    s_mul_i32 s94, s94, 36864
    s_add_u32 s94, s94, s92
    s_lshl_b32 s74, s13, 7
    s_add_u32 s94, s94, s74
    s_add_u32 s78, s94, 512
    s_add_u32 s80, s66, 114688
    s_mov_b32 s76, 0
    s_mov_b32 s77, 8192
    s_call_b64 s[82:83], cf_dma
    ds_read_b64_tr_b16 v[8:9], v56 offset:0
    ds_read_b64_tr_b16 v[10:11], v56 offset:256
    ds_read_b64_tr_b16 v[12:13], v56 offset:8192
    ds_read_b64_tr_b16 v[14:15], v56 offset:8448
    s_mov_b32 s77, 16384
    s_call_b64 s[82:83], cf_dma
    s_waitcnt lgkmcnt(0)
    ds_write_b128 v61, v[0:3] offset:32768
    ds_write_b128 v61, v[4:7] offset:36864
    ds_write_b128 v61, v[8:11] offset:40960
    ds_write_b128 v61, v[12:15] offset:45056
    s_waitcnt lgkmcnt(0)
    v_add_u32 v55, 49152, v51
    v_xor_b32 v56, 32, v55
    ds_read_b64_tr_b16 v[0:1], v55 offset:0
    ds_read_b64_tr_b16 v[2:3], v55 offset:256
    ds_read_b64_tr_b16 v[4:5], v55 offset:8192
    ds_read_b64_tr_b16 v[6:7], v55 offset:8448
    s_lshr_b32 s78, 4194304, s72
    s_add_u32 s78, s78, s67
    s_mov_b64 s[8:9], s[52:53]
    v_mov_b32 v58, v48
    s_lshr_b32 s79, 131072, s72
    s_add_u32 s80, s66, 81920
    s_mov_b32 s76, 0
    s_mov_b32 s77, 8192
    s_call_b64 s[82:83], cf_dma
    ds_read_b64_tr_b16 v[8:9], v56 offset:0
    ds_read_b64_tr_b16 v[10:11], v56 offset:256
    ds_read_b64_tr_b16 v[12:13], v56 offset:8192
    ds_read_b64_tr_b16 v[14:15], v56 offset:8448
    s_mov_b32 s77, 16384
    s_call_b64 s[82:83], cf_dma
    s_waitcnt lgkmcnt(0)
    ds_write_b128 v61, v[0:3] offset:49152
    ds_write_b128 v61, v[4:7] offset:53248
    ds_write_b128 v61, v[8:11] offset:57344
    ds_write_b128 v61, v[12:15] offset:61440
    s_waitcnt lgkmcnt(0)
    buffer_load_dword v24, off, s[96:99], 0 offset:140 sc1
    buffer_load_dword v25, off, s[96:99], 0 offset:64 sc1
    s_lshr_b32 s84, s12, 1
    s_lshl_b32 s84, s84, 8
    s_add_u32 s84, s84, 125829120
    v_bfe_u32 v26, v61, 4, 6
    v_min_u32 v26, 11, v26
    v_lshlrev_b32 v26, 2, v26
    buffer_load_dword v27, v26, s[4:7], s84 offen sc1
    s_waitcnt vmcnt(15)
    v_add_u32 v55, 147456, v53
    ds_read_b64_tr_b16 v[0:1], v55 offset:0
    ds_read_b64_tr_b16 v[2:3], v55 offset:128
    ds_read_b64_tr_b16 v[4:5], v55 offset:512
    ds_read_b64_tr_b16 v[6:7], v55 offset:640
    ds_read_b64_tr_b16 v[8:9], v55 offset:8192
    ds_read_b64_tr_b16 v[10:11], v55 offset:8320
    ds_read_b64_tr_b16 v[12:13], v55 offset:8704
    ds_read_b64_tr_b16 v[14:15], v55 offset:8832
    s_waitcnt lgkmcnt(0)
    s_barrier
    ds_write_b128 v63, v[0:3] offset:49152
    ds_write_b128 v63, v[4:7] offset:53248
    s_barrier
    ds_write_b128 v63, v[8:11] offset:57344
    ds_write_b128 v63, v[12:15] offset:61440
    s_waitcnt lgkmcnt(0)
    v_lshlrev_b32 v45, 3, v61
    s_lshl_b32 s40, s12, 14
    s_add_u32 s40, s40, 65536
    s_lshl_b32 s41, s12, 11
    s_sub_u32 s41, s41, 12288
    v_add_u32 v30, s40, v45
    v_add_u32 v45, s41, v45
    v_cmp_gt_u32 vcc, 1536, v61
    s_nop 1
    v_cndmask_b32 v45, v45, v30, vcc
    s_lshl_b32 s40, s12, 16
    s_add_u32 s40, s40, 25151488
    v_lshlrev_b32 v30, 3, v61
    v_add_u32 v30, s40, v30
    v_cmp_gt_u32 vcc, 1792, v61
    s_nop 1
    v_cndmask_b32 v45, v30, v45, vcc
    v_cmp_gt_u32 vcc, 2944, v61
    s_mov_b32 s40, 67108864
    s_mov_b64 exec, vcc
    buffer_load_dword v30, v45, s[4:7], s40 offen sc1
    s_mov_b64 exec, -1
    s_waitcnt vmcnt(11)
    v_add_u32 v55, 131072, v52
    ds_read_b64_tr_b16 v[0:1], v55 offset:0
    ds_read_b64_tr_b16 v[2:3], v55 offset:256
    ds_read_b64_tr_b16 v[4:5], v55 offset:4096
    ds_read_b64_tr_b16 v[6:7], v55 offset:4352
    ds_read_b64_tr_b16 v[8:9], v55 offset:64
    ds_read_b64_tr_b16 v[10:11], v55 offset:320
    ds_read_b64_tr_b16 v[12:13], v55 offset:4160
    ds_read_b64_tr_b16 v[14:15], v55 offset:4416
    s_waitcnt lgkmcnt(0)
    s_barrier
    ds_write_b128 v63, v[0:3] offset:32768
    ds_write_b128 v63, v[4:7] offset:36864
    s_barrier
    ds_write_b128 v63, v[8:11] offset:40960
    ds_write_b128 v63, v[12:15] offset:45056
    s_waitcnt lgkmcnt(0)
    s_waitcnt vmcnt(7)
    v_add_u32 v55, 114688, v52
    ds_read_b64_tr_b16 v[0:1], v55 offset:0
    ds_read_b64_tr_b16 v[2:3], v55 offset:256
    ds_read_b64_tr_b16 v[4:5], v55 offset:4096
    ds_read_b64_tr_b16 v[6:7], v55 offset:4352
    ds_read_b64_tr_b16 v[8:9], v55 offset:64
    ds_read_b64_tr_b16 v[10:11], v55 offset:320
    ds_read_b64_tr_b16 v[12:13], v55 offset:4160
    ds_read_b64_tr_b16 v[14:15], v55 offset:4416
    s_waitcnt lgkmcnt(0)
    s_barrier
    ds_write_b128 v63, v[0:3] offset:16384
    ds_write_b128 v63, v[4:7] offset:20480
    s_barrier
    ds_write_b128 v63, v[8:11] offset:24576
    ds_write_b128 v63, v[12:15] offset:28672
    s_waitcnt lgkmcnt(0)
    v_min_u32 v36, -2, v36
    v_min_u32 v37, -2, v37
    v_min_u32 v38, -2, v38
    v_min_u32 v39, -2, v39
    v_min_u32 v40, -2, v40
    v_min_u32 v41, -2, v41
    v_min_u32 v42, -2, v42
    v_min_u32 v43, -2, v43
    v_min_u32 v44, -2, v44
    s_lshl_b32 s14, s12, 16
    s_add_u32 s14, s14, 92274688
    s_add_u32 s41, s14, 4096
    s_add_u32 s42, s14, 8192
    v_lshrrev_b32 v45, 2, v61
    buffer_store_dwordx4 v[36:39], v61, s[4:7], s14 offen
    buffer_store_dwordx4 v[40:43], v61, s[4:7], s41 offen
    buffer_store_dword v44, v45, s[4:7], s42 offen
    s_waitcnt vmcnt(1)
    v_readfirstlane_b32 s95, v25
    v_readfirstlane_b32 s85, v24
    s_add_u32 s86, s95, 2
    s_waitcnt vmcnt(0)
    v_subrev_u32 v27, s86, v27
    v_cmp_lt_u32 s[86:87], 64, v27
    s_cmp_eq_u32 s95, 0
    s_cselect_b64 s[86:87], -1, s[86:87]
    s_cmp_lg_u64 s[86:87], 0
    s_cbranch_scc1 cf_nt
    s_add_u32 s40, s24, 524288
    buffer_load_dword v30, v79, s[4:7], s24 offen sc1
    buffer_load_dword v30, v79, s[4:7], s40 offen sc1
cf_nt:
    s_waitcnt vmcnt(3)
    v_add_u32 v55, 81920, v51
    v_xor_b32 v56, 32, v55
    ds_read_b64_tr_b16 v[0:1], v55 offset:0
    ds_read_b64_tr_b16 v[2:3], v55 offset:256
    ds_read_b64_tr_b16 v[4:5], v55 offset:8192
    ds_read_b64_tr_b16 v[6:7], v55 offset:8448
    ds_read_b64_tr_b16 v[8:9], v56 offset:0
    ds_read_b64_tr_b16 v[10:11], v56 offset:256
    ds_read_b64_tr_b16 v[12:13], v56 offset:8192
    ds_read_b64_tr_b16 v[14:15], v56 offset:8448
    s_waitcnt lgkmcnt(0)
    ds_write_b128 v62, v[0:3] offset:24576
    ds_write_b128 v62, v[4:7] offset:28672
    ds_write_b128 v62, v[8:11] offset:32768
    ds_write_b128 v62, v[12:15] offset:36864
    s_waitcnt lgkmcnt(0)
    s_barrier
    s_mov_b32 s88, 4194304
gn2:
    s_cmp_lg_u32 s95, 0
    s_cbranch_scc1 gn2x
    buffer_load_dword v27, off, s[96:99], 0 offset:64 sc1
    s_sub_u32 s88, s88, 1
    s_cbranch_scc1 gn2x
    s_waitcnt vmcnt(0)
    v_readfirstlane_b32 s95, v27
    s_nop 1
    s_branch gn2
gn2x:
    ds_write_b128 v78, v[16:19] offset:8704
    ds_write_b128 v65, v[20:23] offset:10240
    v_mov_b32 v44, s95
    v_mov_b32 v45, s95
    v_mov_b32 v46, s95
    v_mov_b32 v47, s95
    v_mov_b32 v48, 108288
    ds_write_b128 v48, v[44:47]
    s_waitcnt vmcnt(0) lgkmcnt(0)
    s_cmp_eq_u32 s85, 1
    s_cbranch_scc1 cf_run
    s_mov_b32 s40, 131072
cf_startpoll:
    buffer_load_dword v3, off, s[96:99], 0 offset:140 sc1
    s_waitcnt vmcnt(0)
    v_readfirstlane_b32 s85, v3
    s_nop 0
    s_cmp_eq_u32 s85, 1
    s_cbranch_scc1 cf_run
    s_cmp_eq_u32 s85, 2
    s_cbranch_scc1 cf_leave
    s_sleep 1
    s_sub_u32 s40, s40, 1
    s_cbranch_scc0 cf_startpoll
    v_mov_b32 v4, 2
    v_mov_b32 v5, 0
    s_mov_b64 exec, 1
    buffer_atomic_cmpswap v[4:5], off, s[96:99], 0 offset:140
    s_mov_b64 exec, -1
    s_mov_b32 s40, 1048576
    s_branch cf_startpoll
cf_leave:
    v_lshrrev_b32 v0, 4, v61
    s_mov_b32 s32, s13
    s_load_dwordx16 s[48:63], s[0:1], 0
    s_waitcnt lgkmcnt(0)
    s_branch L_helper
cf_run:
    s_cmp_eq_u64 s[86:87], 0
    s_cbranch_scc1 cf_kvok
    s_lshr_b32 s92, s12, 1
    s_lshl_b32 s92, s92, 8
    s_add_u32 s92, s92, 125829120
    v_bfe_u32 v2, v61, 4, 6
    v_min_u32 v2, 11, v2
    v_lshlrev_b32 v2, 2, v2
    s_add_u32 s93, s95, 2
    s_mov_b32 s94, 4194304
cf_kv0:
    buffer_load_dword v3, v2, s[4:7], s92 offen sc1
    s_sub_u32 s94, s94, 1
    s_cbranch_scc1 cf_kv0_go
    s_waitcnt vmcnt(0)
    v_subrev_u32 v3, s93, v3
    v_cmp_lt_u32 vcc, 64, v3
    s_cbranch_vccz cf_kv0_go
    s_sleep 2
    s_branch cf_kv0
cf_kv0_go:
    s_add_u32 s40, s24, 524288
    buffer_load_dword v30, v79, s[4:7], s24 offen sc1
    buffer_load_dword v30, v79, s[4:7], s40 offen sc1
    s_waitcnt vmcnt(0)
cf_kvok:
    s_mov_b32 m0, 108032
    s_add_u32 s24, s24, 1048576
    s_mov_b32 s66, 0x201
    s_mov_b32 s67, 0xc0000000
    s_add_u32 s15, s14, 4096
    s_add_u32 s16, s14, 8192
    ds_read_b128 v[32:35], v62 offset:16384
    ds_read_b128 v[36:39], v62 offset:20480
    ds_read_b128 v[40:43], v61 offset:0
    ds_read_b128 v[44:47], v61 offset:4096
    ds_read_b128 v[48:51], v61 offset:8192
    ds_read_b128 v[52:55], v61 offset:12288
    s_add_u32 s18, s14, s31
    s_mov_b32 s29, 1048576
    buffer_load_dwordx4 v[24:27], v61, s[4:7], s14 offen nt
.p2align 6
cf_loop:
    v_mov_b64 v[0:1], 0
    v_mov_b64 v[2:3], 0
    v_mov_b64 v[4:5], 0
    v_mov_b64 v[6:7], 0
    v_mov_b64 v[8:9], 0
    v_mov_b64 v[10:11], 0
    v_mov_b64 v[12:13], 0
    v_mov_b64 v[14:15], 0
cf_loop2:
    ds_read_b128 v[16:19], v62 offset:8192
    ds_read_b128 v[20:23], v62 offset:12288
    v_lshrrev_b32 v56, 2, v61
    v_add_u32 v58, 106496, v56
    s_mov_b32 s29, 1048576
    s_nop 13
    buffer_load_dwordx4 v[24:27], v61, s[4:7], s14 offen nt
    s_waitcnt lgkmcnt(0)
cf_chk0:
    s_waitcnt vmcnt(1)
cf_chk0b:
    v_max3_u32 v57, v24, v25, v26
    v_max_u32 v57, v57, v27
    v_cmp_eq_u32 vcc, -1, v57
    ds_write_b128 v62, v[24:27] offset:40960
    s_cbranch_vccnz cf_spin0
    v_smfmac_f32_16x16x64_bf16 v[0:3], v[24:27], v[16:23], v60
    s_mov_b32 m0, s58
    s_nop 0
    buffer_load_dwordx4 v61, s[4:7], s15 offen nt lds
    v_smfmac_f32_16x16x64_bf16 v[8:11], v[24:27], v[32:39], v60
    s_mov_b32 m0, s59
    s_nop 0
    buffer_load_dword v56, s[4:7], s16 offen nt lds
    v_smfmac_f32_16x16x64_bf16 v[12:15], v[24:27], v[48:55], v60
    ds_read_b128 v[32:35], v61 offset:16384
    v_mfma_f32_16x16x16_bf16 v[16:19], v[72:73], v[72:73], 0
    ds_read_b128 v[36:39], v61 offset:20480
    s_waitcnt lgkmcnt(2)
    s_barrier
    ds_read_b128 v[48:51], v63 offset:0
    v_mfma_f32_16x16x16_bf16 v[20:23], v[72:73], v[72:73], 0
    ds_read_b128 v[52:55], v64 offset:0
    v_smfmac_f32_16x16x64_bf16 v[4:7], v[24:27], v[40:47], v60
    ds_read_b128 v[40:43], v61 offset:24576
    v_smfmac_f32_16x16x64_bf16 v[16:19], v[24:27], a[192:199], v60
    ds_read_b128 v[44:47], v61 offset:28672
    v_smfmac_f32_16x16x64_bf16 v[20:23], v[24:27], a[200:207], v60
    s_mov_b32 m0, 108032
    s_waitcnt lgkmcnt(3)
    v_smfmac_f32_16x16x64_bf16 v[0:3], v[48:51], a[0:7], v60
    s_add_u32 s43, s14, s31
    s_add_u32 s41, s14, 16384
    v_smfmac_f32_16x16x64_bf16 v[4:7], v[48:51], v[32:39], v60
    ds_read_b128 v[32:35], v61 offset:32768
    v_smfmac_f32_16x16x64_bf16 v[8:11], v[48:51], a[8:15], v60
    ds_read_b128 v[36:39], v61 offset:36864
    s_waitcnt lgkmcnt(2)
    v_smfmac_f32_16x16x64_bf16 v[12:15], v[48:51], v[40:47], v60
    ds_read_b128 v[40:43], v61 offset:40960
    v_smfmac_f32_16x16x64_bf16 v[16:19], v[48:51], a[208:215], v60
    ds_read_b128 v[44:47], v61 offset:45056
    v_smfmac_f32_16x16x64_bf16 v[20:23], v[48:51], a[216:223], v60
    ds_read_b128 v[48:51], v71 offset:0
    v_smfmac_f32_16x16x64_bf16 v[0:3], v[52:55], a[16:23], v60
    s_waitcnt vmcnt(0)
    ds_read_b128 v[28:31], v62 offset:45056
    s_waitcnt lgkmcnt(4)
    v_smfmac_f32_16x16x64_bf16 v[4:7], v[52:55], v[32:39], v60
    ds_read_b32 v59, v58
    buffer_load_dwordx4 v[24:27], v61, s[4:7], s23 offen offset:0 sc1
    v_smfmac_f32_16x16x64_bf16 v[8:11], v[52:55], a[24:31], v60
    ds_read_b128 v[32:35], v61 offset:49152
    s_waitcnt lgkmcnt(4)
    v_smfmac_f32_16x16x64_bf16 v[12:15], v[52:55], v[40:47], v60
    ds_read_b128 v[36:39], v61 offset:53248
    v_smfmac_f32_16x16x64_bf16 v[16:19], v[52:55], a[224:231], v60
    ds_read_b128 v[40:43], v61 offset:57344
    v_smfmac_f32_16x16x64_bf16 v[20:23], v[52:55], a[232:239], v60
    ds_read_b128 v[44:47], v61 offset:61440
    s_waitcnt lgkmcnt(4)
    v_smfmac_f32_16x16x64_bf16 v[0:3], v[48:51], a[32:39], v60
    v_max3_u32 v57, v28, v29, v30
    v_smfmac_f32_16x16x64_bf16 v[8:11], v[48:51], a[40:47], v60
    v_max3_u32 v57, v57, v31, v59
    s_waitcnt lgkmcnt(2)
    v_smfmac_f32_16x16x64_bf16 v[4:7], v[48:51], v[32:39], v60
    buffer_load_dwordx4 v[32:35], v61, s[4:7], s23 offen offset:1024 sc1
    v_cmp_eq_u32 vcc, -1, v57
    v_smfmac_f32_16x16x64_bf16 v[16:19], v[48:51], a[240:247], v60
    v_smfmac_f32_16x16x64_bf16 v[20:23], v[48:51], a[248:255], v60
    s_cbranch_vccnz cf_spin1
cf_go1:
    s_barrier
    ds_read_b128 v[52:55], v63 offset:4096
    s_waitcnt lgkmcnt(1)
    v_smfmac_f32_16x16x64_bf16 v[12:15], v[48:51], v[40:47], v60
    ds_read_b128 v[48:51], v64 offset:4096
    v_smfmac_f32_16x16x64_bf16 v[0:3], v[28:31], a[48:55], v60
    buffer_load_dwordx4 v[40:43], v61, s[4:7], s23 offen offset:2048 sc1
    v_smfmac_f32_16x16x64_bf16 v[8:11], v[28:31], a[56:63], v60
    ds_read_b128 v[56:59], v71 offset:4096
    s_and_b32 s41, s41, 65535
    v_smfmac_f32_16x16x64_bf16 v[4:7], v[28:31], a[128:135], v60
    ds_read_b128 v[36:39], v65 offset:8192
    s_add_u32 s41, s41, 67108864
    v_smfmac_f32_16x16x64_bf16 v[12:15], v[28:31], a[136:143], v60
    s_add_u32 s17, s41, s31
    s_and_b32 s30, s28, 1
    s_waitcnt lgkmcnt(3)
    v_smfmac_f32_16x16x64_bf16 v[0:3], v[52:55], a[64:71], v60
    buffer_load_dwordx4 v[44:47], v61, s[4:7], s23 offen offset:3072 sc1
    v_smfmac_f32_16x16x64_bf16 v[4:7], v[52:55], a[144:151], v60
    ds_read_b128 v[28:31], v78 offset:8704
    v_smfmac_f32_16x16x64_bf16 v[8:11], v[52:55], a[72:79], v60
    v_smfmac_f32_16x16x64_bf16 v[12:15], v[52:55], a[152:159], v60
    ds_read_b128 v[52:55], v62 offset:28672
    s_waitcnt lgkmcnt(4)
    v_smfmac_f32_16x16x64_bf16 v[0:3], v[48:51], a[80:87], v60
    v_smfmac_f32_16x16x64_bf16 v[4:7], v[48:51], a[160:167], v60
    v_smfmac_f32_16x16x64_bf16 v[8:11], v[48:51], a[88:95], v60
    buffer_load_dword v79, s[4:7], s24 offen sc1 lds
    v_smfmac_f32_16x16x64_bf16 v[12:15], v[48:51], a[168:175], v60
    v_smfmac_f32_16x16x64_bf16 v[16:19], v[48:51], v[112:119], v60
    v_smfmac_f32_16x16x64_bf16 v[20:23], v[48:51], v[120:127], v60
    ds_read_b128 v[48:51], v62 offset:24576
    s_waitcnt lgkmcnt(4)
    v_smfmac_f32_16x16x64_bf16 v[0:3], v[56:59], a[96:103], v60
    s_bitcmp1_b64 s[66:67], s28
    v_smfmac_f32_16x16x64_bf16 v[8:11], v[56:59], a[104:111], v60
    s_waitcnt lgkmcnt(3)
    v_smfmac_f32_16x16x64_bf16 v[0:3], v[36:39], a[112:119], v60
    v_smfmac_f32_16x16x64_bf16 v[8:11], v[36:39], a[120:127], v60
    v_smfmac_f32_16x16x64_bf16 v[4:7], v[56:59], a[176:183], v60
    s_waitcnt lgkmcnt(0)
    v_cvt_pk_bf16_f32 v0, v0, v1
    v_smfmac_f32_16x16x64_bf16 v[4:7], v[36:39], v[48:55], v60
    ds_read_b128 v[48:51], v62 offset:32768
    v_cvt_pk_bf16_f32 v8, v8, v9
    v_smfmac_f32_16x16x64_bf16 v[12:15], v[56:59], a[184:191], v60
    ds_read_b128 v[52:55], v62 offset:36864
    v_cvt_pk_bf16_f32 v9, v10, v11
    v_smfmac_f32_16x16x64_bf16 v[16:19], v[56:59], v[128:135], v60
    v_cvt_pk_bf16_f32 v1, v2, v3
    v_mfma_f32_16x16x16_bf16 v[8:11], v[8:9], v[28:29], 0
    v_cvt_pk_bf16_f32 v2, v4, v5
    v_cvt_pk_bf16_f32 v3, v6, v7
    v_smfmac_f32_16x16x64_bf16 v[20:23], v[56:59], v[136:143], v60
    s_mov_b64 exec, s[36:37]
    ds_read_b128 v[56:59], v69
    s_mov_b64 exec, -1
    v_mfma_f32_16x16x32_bf16 v[4:7], v[0:3], v[28:31], 0
    v_cvt_pk_bf16_f32 v2, v8, v9
    s_waitcnt lgkmcnt(1)
    v_smfmac_f32_16x16x64_bf16 v[12:15], v[36:39], v[48:55], v60
    ds_read_b128 v[48:51], v63 offset:4096
    v_cvt_pk_bf16_f32 v3, v10, v11
    s_waitcnt vmcnt(3)
    v_cvt_pk_bf16_f32 v0, v4, v5
    v_cvt_pk_bf16_f32 v1, v6, v7
    s_nop 1
    v_mfma_f32_16x16x32_bf16 v[4:7], v[32:35], v[0:3], 0
    v_cvt_pk_bf16_f32 v12, v12, v13
    v_cvt_pk_bf16_f32 v13, v14, v15
    s_nop 1
    v_mfma_f32_16x16x16_bf16 v[12:15], v[12:13], v[30:31], 0
    ds_read_b128 v[52:55], v62 offset:45056
    ds_read_b128 v[32:35], v63 offset:49152
    v_mfma_f32_16x16x32_bf16 v[28:31], v[24:27], v[0:3], 0
    s_waitcnt vmcnt(1)
    s_mov_b64 exec, s[34:35]
    s_nop 1
    v_cvt_pk_bf16_f32 v2, v12, v13
    v_cvt_pk_bf16_f32 v3, v14, v15
    s_mov_b64 exec, -1
    s_nop 0
    v_mfma_f32_16x16x32_bf16 v[8:11], v[0:3], v[0:3], 0
    v_mov_b32_dpp v28, v4 row_ror:8 row_mask:0xf bank_mask:0xc
    v_mov_b32_dpp v29, v5 row_ror:8 row_mask:0xf bank_mask:0xc
    v_mov_b32_dpp v30, v6 row_ror:8 row_mask:0xf bank_mask:0xc
    v_mov_b32_dpp v31, v7 row_ror:8 row_mask:0xf bank_mask:0xc
    v_smfmac_f32_16x16x64_bf16 v[16:19], v[36:39], v[144:151], v60
    ds_write_b128 v62, v[28:31] offset:53248
    v_mov_b32_dpp v8, v10 row_ror:8 row_mask:0xf bank_mask:0xc
    v_mov_b32_dpp v9, v11 row_ror:8 row_mask:0xf bank_mask:0xc
    v_smfmac_f32_16x16x64_bf16 v[20:23], v[36:39], v[152:159], v60
    ds_write_b64 v70, v[8:9]
    s_waitcnt lgkmcnt(4)
    v_smfmac_f32_16x16x64_bf16 v[16:19], v[48:51], v[96:103], v60
    s_mov_b64 exec, s[36:37]
    buffer_store_dwordx4 v[56:59], v61, s[4:7], s65 offen sc1
    s_mov_b64 exec, -1
    v_smfmac_f32_16x16x64_bf16 v[20:23], v[48:51], v[104:111], v60
    s_cbranch_scc1 cf_last
cf_back:
    s_waitcnt lgkmcnt(0)
    s_barrier
    ds_read_b128 v[56:59], v78 offset:10752
    v_smfmac_f32_16x16x64_bf16 v[16:19], v[52:55], v[80:87], v60
    ds_read_b128 v[12:15], v78 offset:11264
    ds_read_b128 v[4:7], v63 offset:12288
    v_smfmac_f32_16x16x64_bf16 v[20:23], v[52:55], v[88:95], v60
    ds_read_b128 v[8:11], v64 offset:12288
    ds_read_b128 v[0:3], v71 offset:12288
    v_mov_b64 v[24:25], s[62:63]
    v_mov_b64 v[26:27], s[60:61]
    v_cvt_pk_bf16_f32 v16, v16, v17
    v_cvt_pk_bf16_f32 v17, v18, v19
    v_pk_mul_f32 v[28:29], v[28:29], s[44:45]
    v_pk_mul_f32 v[30:31], v[30:31], s[44:45]
    s_waitcnt lgkmcnt(3)
    v_pk_add_f32 v[56:57], v[56:57], v[58:59]
    v_pk_add_f32 v[12:13], v[12:13], v[14:15]
    v_pk_add_f32 v[56:57], v[56:57], v[12:13]
    v_pk_mul_f32 v[56:57], v[56:57], s[44:45]
    v_exp_f32 v58, v56
    v_exp_f32 v59, v57
    s_waitcnt lgkmcnt(1)
    v_pk_fma_f32 v[28:29], v[4:5], s[44:45], v[28:29]
    v_pk_fma_f32 v[30:31], v[6:7], s[44:45], v[30:31]
    v_cvt_pk_bf16_f32 v6, v58, v59
    v_pk_fma_f32 v[28:29], v[8:9], s[44:45], v[28:29]
    v_pk_fma_f32 v[30:31], v[10:11], s[44:45], v[30:31]
    s_waitcnt lgkmcnt(0)
    v_pk_fma_f32 v[28:29], v[0:1], s[44:45], v[28:29]
    v_mov_b32_dpp v7, v6 row_ror:8 row_mask:0xf bank_mask:0xf
    v_pk_fma_f32 v[30:31], v[2:3], s[44:45], v[30:31]
    v_exp_f32 v0, v28
    v_mfma_f32_16x16x16_bf16 v[12:15], v[16:17], v[6:7], 0
    ds_read_b128 v[48:51], v63 offset:57344
    v_exp_f32 v1, v29
    v_cvt_pk_bf16_f32 v18, v20, v21
    v_exp_f32 v2, v30
    v_cvt_pk_bf16_f32 v19, v22, v23
    v_cvt_pk_bf16_f32 v8, v0, v1
    v_exp_f32 v3, v31
    v_mfma_f32_16x16x16_bf16 v[20:23], v[18:19], v[6:7], 0
    ds_read_b128 v[52:55], v63 offset:61440
    v_cvt_pk_bf16_f32 v9, v2, v3
    v_mov_b32_dpp v10, v8 row_ror:8 row_mask:0xf bank_mask:0xf
    v_max3_f32 v4, |v28|, |v29|, |v30|
    v_mov_b32_dpp v11, v9 row_ror:8 row_mask:0xf bank_mask:0xf
    v_mfma_f32_16x16x32_bf16 v[0:3], v[24:27], v[6:9], 0
    ds_read_b128 v[36:39], v63 offset:53248
    v_max3_f32 v4, v4, |v31|, |v56|
    v_max_f32_e64 v4, v4, |v57|
    v_mfma_f32_16x16x32_bf16 v[12:15], v[40:43], v[8:11], v[12:15]
    v_cmp_nge_f32 vcc, s46, v4
    v_mfma_f32_16x16x32_bf16 v[20:23], v[44:47], v[8:11], v[20:23]
    v_add_f32_dpp v0, v0, v0 row_ror:8 row_mask:0xf bank_mask:0xf
    v_rcp_f32 v0, v0
    s_cbranch_vccnz cf_guard
cf_norm:
    v_mfma_f32_16x16x16_bf16 v[28:31], v[72:73], v[72:73], 0
    v_mul_f32 v12, v12, v0
    v_mul_f32 v13, v13, v0
    v_mul_f32 v14, v14, v0
    v_mul_f32 v15, v15, v0
    v_mul_f32_dpp v12, v20, v0 row_ror:8 row_mask:0xf bank_mask:0xc
    v_mul_f32_dpp v13, v21, v0 row_ror:8 row_mask:0xf bank_mask:0xc
    v_mul_f32_dpp v14, v22, v0 row_ror:8 row_mask:0xf bank_mask:0xc
    v_mul_f32_dpp v15, v23, v0 row_ror:8 row_mask:0xf bank_mask:0xc
    v_cvt_pk_bf16_f32 v12, v12, v13
    v_cvt_pk_bf16_f32 v13, v14, v15
    v_mfma_f32_16x16x16_bf16 v[8:11], v[72:73], v[72:73], 0
    ds_write_b64 v77, v[12:13]
    v_mfma_f32_16x16x16_bf16 v[4:7], v[72:73], v[72:73], 0
    ds_read_b128 v[0:3], v68
    v_mfma_f32_16x16x16_bf16 v[16:19], v[72:73], v[72:73], 0
    ds_read_b128 v[40:43], v63 offset:16384
    v_mfma_f32_16x16x16_bf16 v[20:23], v[72:73], v[72:73], 0
    ds_read_b128 v[44:47], v63 offset:20480
    s_waitcnt lgkmcnt(3)
    s_barrier
    ds_read_b128 v[24:27], v74
    ds_read_b128 v[12:15], v75
    ds_read_b128 v[56:59], v76
    s_waitcnt lgkmcnt(5)
    v_smfmac_f32_16x16x64_bf16 v[28:31], v[0:3], v[160:167], v60
    v_smfmac_f32_16x16x64_bf16 v[8:11], v[0:3], v[192:199], v60
    v_smfmac_f32_16x16x64_bf16 v[4:7], v[0:3], v[32:39], v60
    ds_read_b128 v[32:35], v63 offset:32768
    v_smfmac_f32_16x16x64_bf16 v[16:19], v[0:3], v[224:231], v60
    ds_read_b128 v[36:39], v63 offset:36864
    s_waitcnt lgkmcnt(3)
    v_smfmac_f32_16x16x64_bf16 v[28:31], v[24:27], v[168:175], v60
    v_smfmac_f32_16x16x64_bf16 v[4:7], v[12:15], v[48:55], v60
    ds_read_b128 v[48:51], v63 offset:24576
    v_smfmac_f32_16x16x64_bf16 v[28:31], v[12:15], v[176:183], v60
    ds_read_b128 v[52:55], v63 offset:28672
    s_waitcnt lgkmcnt(4)
    v_smfmac_f32_16x16x64_bf16 v[28:31], v[56:59], v[184:191], v60
    v_cvt_pk_bf16_f32 v4, v4, v5
    v_smfmac_f32_16x16x64_bf16 v[16:19], v[12:15], v[40:47], v60
    ds_read_b128 v[40:43], v63 offset:40960
    v_and_or_b32 v4, v4, -2, s30
    v_smfmac_f32_16x16x64_bf16 v[8:11], v[24:27], v[200:207], v60
    ds_read_b128 v[44:47], v63 offset:45056
    v_cvt_pk_bf16_f32 v5, v6, v7
    v_smfmac_f32_16x16x64_bf16 v[8:11], v[12:15], v[208:215], v60
    buffer_store_dwordx2 v[4:5], v67, s[4:7], s22 offen
    v_cvt_pk_bf16_f32 v28, v28, v29
    v_smfmac_f32_16x16x64_bf16 v[8:11], v[56:59], v[216:223], v60
    v_and_or_b32 v28, v28, -2, s30
    v_smfmac_f32_16x16x64_bf16 v[16:19], v[24:27], v[232:239], v60
    v_cvt_pk_bf16_f32 v29, v30, v31
    s_waitcnt lgkmcnt(4)
    v_smfmac_f32_16x16x64_bf16 v[16:19], v[56:59], v[32:39], v60
    buffer_store_dwordx2 v[28:29], v66, s[4:7], s20 offen
    v_cvt_pk_bf16_f32 v8, v8, v9
    s_waitcnt lgkmcnt(0)
    v_smfmac_f32_16x16x64_bf16 v[20:23], v[0:3], v[240:247], v60
    v_and_or_b32 v8, v8, -2, s30
    v_smfmac_f32_16x16x64_bf16 v[20:23], v[24:27], v[248:255], v60
    v_cvt_pk_bf16_f32 v9, v10, v11
    v_smfmac_f32_16x16x64_bf16 v[20:23], v[12:15], v[48:55], v60
    buffer_store_dwordx2 v[8:9], v66, s[4:7], s21 offen
    v_cvt_pk_bf16_f32 v16, v16, v17
    v_smfmac_f32_16x16x64_bf16 v[20:23], v[56:59], v[40:47], v60
    v_and_or_b32 v16, v16, -2, s30
    v_cvt_pk_bf16_f32 v17, v18, v19
    buffer_store_dwordx2 v[16:17], v66, s[4:7], s38 offen
    s_cmp_lg_u32 s13, 2
    s_nop 1
    v_cvt_pk_bf16_f32 v20, v20, v21
    v_and_or_b32 v20, v20, -2, s30
    v_cvt_pk_bf16_f32 v21, v22, v23
    buffer_store_dwordx2 v[20:21], v66, s[4:7], s39 offen
    s_cbranch_scc1 cf_w013
    v_mov_b32 v21, -1
    s_mov_b64 exec, s[32:33]
    buffer_store_dword v21, v69, s[4:7], s18 offen
    s_mov_b64 exec, -1
    s_mov_b32 s18, s43
    s_nop 15
    s_nop 15
    s_nop 15
    s_nop 14
    buffer_load_dwordx4 v[40:43], v65, s[4:7], s19 offen offset:0 nt
    buffer_load_dwordx4 v[44:47], v65, s[4:7], s19 offen offset:1024 nt
    buffer_load_dwordx4 v[48:51], v65, s[4:7], s19 offen offset:2048 nt
    buffer_load_dwordx4 v[52:55], v65, s[4:7], s19 offen offset:3072 nt
    ds_read_b128 v[56:59], v65 offset:10240
    s_add_u32 s28, s28, 1
    s_mov_b32 s14, s41
    s_add_u32 s23, s23, 524288
    s_add_u32 s24, s24, 524288
    s_min_u32 s24, s24, s47
    s_add_u32 s15, s14, 4096
    s_add_u32 s16, s14, 8192
    s_add_u32 s65, s65, 12288
    s_mov_b32 s40, 1
    v_mov_b64 v[0:1], 0
    v_mov_b64 v[2:3], 0
    v_mov_b64 v[4:5], 0
    v_mov_b64 v[6:7], 0
    v_mov_b64 v[8:9], 0
    v_mov_b64 v[10:11], 0
    v_mov_b64 v[12:13], 0
    v_mov_b64 v[14:15], 0
cf_chkF:
    v_mov_b32 v20, 0
    s_waitcnt vmcnt(3)
    s_waitcnt lgkmcnt(0)
    v_mfma_f32_16x16x32_bf16 v[28:31], v[40:43], v[56:59], 0
    v_bitop3_b32 v20, v20, v40, s30 bitop3:0xf6
    v_bitop3_b32 v20, v20, v42, s30 bitop3:0xf6
    s_waitcnt vmcnt(2)
    v_mfma_f32_16x16x32_bf16 v[28:31], v[44:47], v[56:59], v[28:31]
    v_bitop3_b32 v20, v20, v44, s30 bitop3:0xf6
    v_bitop3_b32 v20, v20, v46, s30 bitop3:0xf6
    s_waitcnt vmcnt(1)
    v_mfma_f32_16x16x32_bf16 v[28:31], v[48:51], v[56:59], v[28:31]
    v_bitop3_b32 v20, v20, v48, s30 bitop3:0xf6
    v_bitop3_b32 v20, v20, v50, s30 bitop3:0xf6
    s_waitcnt vmcnt(0)
    v_mfma_f32_16x16x32_bf16 v[28:31], v[52:55], v[56:59], v[28:31]
    v_bitop3_b32 v20, v20, v52, s30 bitop3:0xf6
    v_bitop3_b32 v20, v20, v54, s30 bitop3:0xf6
    v_and_b32 v20, s40, v20
    v_cmp_ne_u32 vcc, 0, v20
    s_cbranch_vccnz cf_spinF
    v_permlane32_swap_b32 v28, v30
    v_permlane32_swap_b32 v29, v31
    v_add_f32 v28, v28, v30
    v_add_f32 v30, v29, v31
    v_cvt_pk_bf16_f32 v28, v28, v30
    s_mov_b64 exec, s[32:33]
    buffer_store_dword v28, v69, s[4:7], s17 offen
    s_mov_b64 exec, -1
    ds_read_b128 v[32:35], v62 offset:16384
    ds_read_b128 v[36:39], v62 offset:20480
    ds_read_b128 v[40:43], v61 offset:0
    ds_read_b128 v[44:47], v61 offset:4096
    ds_read_b128 v[48:51], v61 offset:8192
    ds_read_b128 v[52:55], v61 offset:12288
    s_nop 15
    s_nop 1
    buffer_load_dwordx4 v[24:27], v61, s[4:7], s14 offen nt
    s_branch cf_loop2
cf_w013:
    ds_read_b128 v[56:59], v65 offset:10240
    ds_read_b128 v[32:35], v62 offset:16384
    ds_read_b128 v[36:39], v62 offset:20480
    ds_read_b128 v[40:43], v61 offset:0
    ds_read_b128 v[44:47], v61 offset:4096
    ds_read_b128 v[48:51], v61 offset:8192
    ds_read_b128 v[52:55], v61 offset:12288
    s_add_u32 s28, s28, 1
    s_mov_b32 s14, s41
    s_add_u32 s23, s23, 524288
    s_add_u32 s24, s24, 524288
    s_min_u32 s24, s24, s47
    s_add_u32 s15, s14, 4096
    s_add_u32 s16, s14, 8192
    s_add_u32 s65, s65, 12288
    s_mov_b32 s40, 1
    s_cmp_eq_u32 s64, 0
    s_cbranch_scc1 cf_w0
    v_mov_b32 v21, -1
    s_mov_b64 exec, s[32:33]
    buffer_store_dword v21, v69, s[4:7], s18 offen
    s_mov_b64 exec, -1
    s_mov_b32 s18, s43
    s_cmp_eq_u32 s13, 1
    s_nop 15
    s_nop 15
    s_nop 1
    s_cbranch_scc1 cf_sx
    s_nop 15
    s_nop 11
cf_sx:
    buffer_load_dwordx4 v[0:3], v65, s[4:7], s19 offen offset:0 nt
    buffer_load_dwordx4 v[4:7], v65, s[4:7], s19 offen offset:1024 nt
    buffer_load_dwordx4 v[8:11], v65, s[4:7], s19 offen offset:2048 nt
    buffer_load_dwordx4 v[12:15], v65, s[4:7], s19 offen offset:3072 nt
cf_chkG:
    v_mov_b32 v20, 0
    s_waitcnt vmcnt(3)
    s_waitcnt lgkmcnt(6)
    v_mfma_f32_16x16x32_bf16 v[28:31], v[0:3], v[56:59], 0
    v_bitop3_b32 v20, v20, v0, s30 bitop3:0xf6
    v_bitop3_b32 v20, v20, v2, s30 bitop3:0xf6
    s_waitcnt vmcnt(2)
    v_mfma_f32_16x16x32_bf16 v[28:31], v[4:7], v[56:59], v[28:31]
    v_bitop3_b32 v20, v20, v4, s30 bitop3:0xf6
    v_bitop3_b32 v20, v20, v6, s30 bitop3:0xf6
    s_waitcnt vmcnt(1)
    v_mfma_f32_16x16x32_bf16 v[28:31], v[8:11], v[56:59], v[28:31]
    v_bitop3_b32 v20, v20, v8, s30 bitop3:0xf6
    v_bitop3_b32 v20, v20, v10, s30 bitop3:0xf6
    s_waitcnt vmcnt(0)
    v_mfma_f32_16x16x32_bf16 v[28:31], v[12:15], v[56:59], v[28:31]
    v_bitop3_b32 v20, v20, v12, s30 bitop3:0xf6
    v_bitop3_b32 v20, v20, v14, s30 bitop3:0xf6
    v_and_b32 v20, s40, v20
    v_cmp_ne_u32 vcc, 0, v20
    s_cbranch_vccnz cf_spinG
    v_permlane32_swap_b32 v28, v30
    v_permlane32_swap_b32 v29, v31
    v_add_f32 v28, v28, v30
    v_add_f32 v30, v29, v31
    s_cmp_eq_u32 s13, 3
    s_cbranch_scc1 cf_w3
    v_mov_b32 v29, v28
    v_mov_b32 v31, v30
    s_nop 0
    v_permlane16_swap_b32 v28, v29
    v_permlane16_swap_b32 v30, v31
    v_add_f32 v28, v28, v29
    v_add_f32 v30, v30, v31
cf_w3:
    v_cvt_pk_bf16_f32 v28, v28, v30
    s_mov_b64 exec, s[32:33]
    buffer_store_dword v28, v69, s[4:7], s17 offen
    s_mov_b64 exec, -1
    buffer_load_dwordx4 v[24:27], v61, s[4:7], s14 offen nt
    s_branch cf_loop
cf_w0:
    v_mov_b64 v[0:1], 0
    v_mov_b64 v[2:3], 0
    v_mov_b64 v[4:5], 0
    v_mov_b64 v[6:7], 0
    v_mov_b64 v[8:9], 0
    v_mov_b64 v[10:11], 0
    v_mov_b64 v[12:13], 0
    v_mov_b64 v[14:15], 0
    s_nop 15
    s_nop 15
    s_nop 15
    s_nop 5
    s_cmp_lg_u32 s28, 10
    s_cbranch_scc1 cf_nokv
    s_lshr_b32 s92, s12, 1
    s_lshl_b32 s92, s92, 8
    s_add_u32 s92, s92, 125829120
    v_bfe_u32 v28, v61, 4, 6
    v_min_u32 v28, 11, v28
    v_lshlrev_b32 v28, 2, v28
    v_add_u32 v28, 108304, v28
    s_waitcnt vmcnt(0)
    ds_read_b32 v29, v28
    s_add_u32 s93, s95, 63
    s_waitcnt lgkmcnt(0)
    v_cmp_ne_u32 vcc, s93, v29
    s_cbranch_vccz cf_kv1_go
    s_lshr_b32 s92, s12, 1
    s_lshl_b32 s92, s92, 8
    s_add_u32 s92, s92, 125833216
    v_bfe_u32 v28, v61, 4, 6
    v_min_u32 v28, 11, v28
    v_lshlrev_b32 v28, 2, v28
    s_add_u32 s93, s95, 63
    s_mov_b32 s94, 4194304
cf_kv1:
    buffer_load_dword v29, v28, s[4:7], s92 offen sc1
    s_sub_u32 s94, s94, 1
    s_cbranch_scc1 cf_kv1_go
    s_waitcnt vmcnt(0)
    v_subrev_u32 v29, s93, v29
    v_cmp_lt_u32 vcc, 64, v29
    s_cbranch_vccz cf_kv1_go
    s_sleep 2
    s_branch cf_kv1
cf_kv1_go:
    s_branch cf_w0p
cf_nokv:
    s_nop 15
    s_nop 15
    s_nop 15
    s_nop 15
    s_nop 15
    s_nop 15
    s_nop 13
cf_w0p:
    buffer_load_dwordx4 v[24:27], v61, s[4:7], s14 offen nt
    s_branch cf_loop2
cf_spinF:
    buffer_load_dwordx4 v[40:43], v65, s[4:7], s19 offen offset:0 nt
    buffer_load_dwordx4 v[44:47], v65, s[4:7], s19 offen offset:1024 nt
    buffer_load_dwordx4 v[48:51], v65, s[4:7], s19 offen offset:2048 nt
    buffer_load_dwordx4 v[52:55], v65, s[4:7], s19 offen offset:3072 nt
    s_sub_u32 s29, s29, 1
    s_cmp_lt_i32 s29, 0
    s_cselect_b32 s40, 0, 1
    s_branch cf_chkF
cf_spinG:
    buffer_load_dwordx4 v[0:3], v65, s[4:7], s19 offen offset:0 nt
    buffer_load_dwordx4 v[4:7], v65, s[4:7], s19 offen offset:1024 nt
    buffer_load_dwordx4 v[8:11], v65, s[4:7], s19 offen offset:2048 nt
    buffer_load_dwordx4 v[12:15], v65, s[4:7], s19 offen offset:3072 nt
    s_sub_u32 s29, s29, 1
    s_cmp_lt_i32 s29, 0
    s_cselect_b32 s40, 0, 1
    s_branch cf_chkG
cf_guard:
    s_cbranch_scc0 cf_guard2
    buffer_store_dwordx4 v[16:19], v61, s[4:7], s26 offen sc1
    s_add_u32 s26, s26, 131072
    s_add_u32 s40, s95, 63
    v_mov_b32 v5, s40
    s_mov_b64 exec, 1
    buffer_store_dword v5, off, s[4:7], s27 sc1
    s_mov_b64 exec, -1
cf_guard2:
    s_nop 7
    v_max3_f32 v6, v28, v29, v30
    v_max3_f32 v7, v31, v56, v57
    v_max_f32 v6, v6, v7
    s_nop 1
    v_max_f32_dpp v6, v6, v6 row_ror:8 row_mask:0xf bank_mask:0xf
    v_mov_b32 v7, v6
    s_nop 1
    v_permlane32_swap_b32 v6, v7
    v_max_f32 v6, v6, v7
    v_mov_b32 v7, v6
    s_nop 1
    v_permlane16_swap_b32 v6, v7
    v_max_f32 v6, v6, v7
    v_sub_f32 v28, v28, v6
    v_sub_f32 v29, v29, v6
    v_sub_f32 v30, v30, v6
    v_sub_f32 v31, v31, v6
    v_sub_f32 v56, v56, v6
    v_sub_f32 v57, v57, v6
    v_exp_f32 v58, v56
    v_exp_f32 v59, v57
    s_nop 0
    v_cvt_pk_bf16_f32 v6, v58, v59
    s_nop 1
    v_mov_b32_dpp v7, v6 row_ror:8 row_mask:0xf bank_mask:0xf
    v_exp_f32 v0, v28
    s_nop 0
    v_mfma_f32_16x16x16_bf16 v[12:15], v[16:17], v[6:7], 0
    v_exp_f32 v1, v29
    v_exp_f32 v2, v30
    v_cvt_pk_bf16_f32 v8, v0, v1
    v_exp_f32 v3, v31
    v_mfma_f32_16x16x16_bf16 v[20:23], v[18:19], v[6:7], 0
    v_cvt_pk_bf16_f32 v9, v2, v3
    v_mov_b32_dpp v10, v8 row_ror:8 row_mask:0xf bank_mask:0xf
    v_max3_f32 v4, |v28|, |v29|, |v30|
    v_mov_b32_dpp v11, v9 row_ror:8 row_mask:0xf bank_mask:0xf
    v_mfma_f32_16x16x32_bf16 v[0:3], v[24:27], v[6:9], 0
    v_max3_f32 v4, v4, |v31|, |v56|
    v_max_f32_e64 v4, v4, |v57|
    v_mfma_f32_16x16x32_bf16 v[12:15], v[40:43], v[8:11], v[12:15]
    v_cmp_nge_f32 vcc, s46, v4
    v_mfma_f32_16x16x32_bf16 v[20:23], v[44:47], v[8:11], v[20:23]
    v_add_f32_dpp v0, v0, v0 row_ror:8 row_mask:0xf bank_mask:0xf
    v_rcp_f32 v0, v0
    s_nop 4
    s_branch cf_norm
cf_spin0:
    buffer_load_dwordx4 v[24:27], v61, s[4:7], s14 offen nt
    s_sub_u32 s29, s29, 1
    s_cmp_lt_i32 s29, 0
    s_cbranch_scc0 cf_chk0
    s_waitcnt vmcnt(0)
    v_min_u32 v24, -2, v24
    v_min_u32 v25, -2, v25
    v_min_u32 v26, -2, v26
    v_min_u32 v27, -2, v27
    s_branch cf_chk0
cf_spin1:
    s_mov_b32 m0, s58
    s_nop 0
    buffer_load_dwordx4 v61, s[4:7], s15 offen nt lds
    s_mov_b32 m0, s59
    s_nop 0
    buffer_load_dword v56, s[4:7], s16 offen nt lds
    s_mov_b32 m0, 108032
    s_sub_u32 s29, s29, 1
    s_cmp_lt_i32 s29, 0
    s_waitcnt vmcnt(0)
    ds_read_b128 v[28:31], v62 offset:45056
    ds_read_b32 v59, v58
    s_waitcnt lgkmcnt(0)
    v_max3_u32 v57, v28, v29, v30
    v_max3_u32 v57, v57, v31, v59
    v_cmp_eq_u32 vcc, -1, v57
    s_cbranch_scc1 cf_go1
    s_cbranch_vccnz cf_spin1
    s_branch cf_go1
cf_last:
    s_nop 1
    s_cmp_ge_u32 s28, 2
    s_cbranch_scc1 cf_last0
    s_and_b32 s40, s12, 3
    s_lshl_b32 s40, s40, 14
    s_add_u32 s40, s40, 67108864
    s_lshr_b32 s42, s12, 2
    s_lshl_b32 s42, s42, 3
    s_lshl_b64 exec, 0x55, s42
    buffer_load_dword v79, s[4:7], s40 offen sc1 lds
    s_mov_b64 exec, -1
    s_cmp_eq_u32 0, 1
    s_branch cf_back
cf_last0:
    s_cmp_lg_u32 s28, 9
    s_cbranch_scc1 cf_last1
    s_lshr_b32 s92, s12, 1
    s_lshl_b32 s92, s92, 8
    s_add_u32 s92, s92, 125833216
    v_bfe_u32 v48, v61, 4, 6
    v_min_u32 v48, 11, v48
    v_lshlrev_b32 v48, 2, v48
    s_mov_b32 m0, 108304
    s_mov_b64 exec, 0xfff
    buffer_load_dword v48, s[4:7], s92 offen sc1 lds
    s_mov_b64 exec, -1
    s_mov_b32 m0, 108032
    s_cmp_eq_u32 0, 1
    s_branch cf_back
cf_last1:
    s_cmp_eq_u32 s28, 63
    s_cbranch_scc1 cf_last2
    s_mov_b64 exec, s[34:35]
    buffer_store_dwordx4 v[0:3], v61, s[4:7], s25 offen sc1
    s_mov_b64 exec, -1
    s_add_u32 s25, s25, 131072
    s_mov_b32 s46, 0xbf800000
    s_cmp_eq_u32 0, 0
    s_branch cf_back
cf_last2:
    s_waitcnt lgkmcnt(0)
    s_mov_b64 exec, s[34:35]
    buffer_store_dwordx4 v[0:3], v61, s[4:7], s25 offen sc1
    s_mov_b64 exec, -1
    s_add_u32 s40, s95, 64
    v_mov_b32 v40, s40
    v_smfmac_f32_16x16x64_bf16 v[16:19], v[52:55], v[80:87], v60
    v_smfmac_f32_16x16x64_bf16 v[20:23], v[52:55], v[88:95], v60
    s_nop 3
    v_cvt_pk_bf16_f32 v16, v16, v17
    v_cvt_pk_bf16_f32 v17, v18, v19
    s_nop 1
    v_cvt_pk_bf16_f32 v18, v20, v21
    v_cvt_pk_bf16_f32 v19, v22, v23
    buffer_store_dwordx4 v[16:19], v61, s[4:7], s26 offen sc1
    s_mov_b64 exec, 1
    buffer_store_dword v40, off, s[4:7], s27 sc1
    s_mov_b64 exec, -1
    s_endpgm
cf_dma:
    s_xor_b32 s74, s76, s81
    s_add_u32 m0, s74, s80
    s_add_u32 s76, s76, 4096
    buffer_load_dwordx4 v58, s[8:11], s78 offen lds
    s_add_u32 s78, s78, s79
    s_cmp_lt_u32 s76, s77
    s_cbranch_scc1 cf_dma
    s_setpc_b64 s[82:83]
L_chain_safe:
    s_mov_b64 s[48:49], s[50:51]
    s_mov_b64 s[50:51], s[52:53]
    s_mov_b64 s[52:53], s[54:55]
    s_mov_b64 s[54:55], s[56:57]
    s_mov_b64 s[56:57], s[58:59]
    v_lshrrev_b32 v54, 6, v0
    s_nop 0
    v_readfirstlane_b32 s13, v54
    v_and_b32 v57, 63, v0
    v_bfe_u32 v54, v57, 2, 1
    v_lshlrev_b32 v48, 13, v54
    v_bfe_u32 v54, v57, 3, 1
    v_lshl_add_u32 v48, v54, 15, v48
    v_bfe_u32 v54, v57, 4, 1
    v_lshl_add_u32 v48, v54, 14, v48
    v_bfe_u32 v54, v57, 5, 1
    v_lshl_add_u32 v48, v54, 16, v48
    v_lshrrev_b32 v55, 4, v57
    v_and_b32 v55, 2, v55
    v_xor_b32 v55, v55, v57
    v_and_b32 v55, 3, v55
    v_lshl_add_u32 v48, v55, 4, v48
    v_bfe_u32 v54, v57, 2, 1
    v_lshlrev_b32 v51, 6, v54
    v_bfe_u32 v54, v57, 3, 1
    v_lshl_add_u32 v51, v54, 9, v51
    v_bfe_u32 v54, v57, 4, 1
    v_lshl_add_u32 v51, v54, 7, v51
    v_bfe_u32 v54, v57, 5, 1
    v_lshl_add_u32 v51, v54, 12, v51
    v_bfe_u32 v54, v57, 0, 1
    v_lshl_add_u32 v51, v54, 3, v51
    v_bfe_u32 v54, v57, 1, 1
    v_lshl_add_u32 v51, v54, 4, v51
    v_bfe_u32 v54, v57, 3, 1
    v_lshl_add_u32 v51, v54, 5, v51
    v_lshrrev_b32 v55, 3, v57
    v_mul_u32_u24 v49, 1152, v55
    v_and_b32 v55, 7, v57
    v_lshl_add_u32 v49, v55, 4, v49
    v_bfe_u32 v54, v57, 4, 1
    v_lshlrev_b32 v52, 13, v54
    v_bfe_u32 v54, v57, 5, 1
    v_lshl_add_u32 v52, v54, 9, v52
    v_bfe_u32 v54, v57, 2, 1
    v_lshl_add_u32 v52, v54, 7, v52
    v_bfe_u32 v54, v57, 3, 1
    v_lshl_add_u32 v52, v54, 5, v52
    v_and_b32 v55, 3, v57
    v_lshl_add_u32 v52, v55, 3, v52
    v_lshrrev_b32 v55, 2, v57
    v_mul_u32_u24 v50, 1152, v55
    v_and_b32 v55, 3, v57
    v_lshl_add_u32 v50, v55, 4, v50
    v_bfe_u32 v54, v57, 4, 1
    v_lshlrev_b32 v53, 12, v54
    v_bfe_u32 v54, v57, 5, 1
    v_lshl_add_u32 v53, v54, 8, v53
    v_bfe_u32 v54, v57, 2, 1
    v_lshl_add_u32 v53, v54, 6, v53
    v_bfe_u32 v54, v57, 3, 1
    v_lshl_add_u32 v53, v54, 5, v53
    v_and_b32 v55, 3, v57
    v_lshl_add_u32 v53, v55, 3, v53
    s_lshl_b32 s66, s13, 10
    s_and_b32 s93, s13, 1
    s_lshl_b32 s93, s93, 14
    s_and_b32 s75, s13, 2
    s_lshl_b32 s75, s75, 19
    v_add_u32 v51, s66, v51
    v_add_u32 v52, s66, v52
    v_add_u32 v53, s66, v53
    v_mov_b32 v58, v48
    s_mov_b32 s10, 4718592
    s_mov_b32 s11, 0x20000
    s_lshl_b32 s67, s12, 8
    s_lshl_b32 s40, s13, 6
    s_add_u32 s67, s67, s40
    s_mul_i32 s92, s12, 147456
    s_lshr_b32 s73, s50, 8
    s_add_u32 s73, s73, s12
    s_and_b32 s73, s73, 31
    s_bitcmp1_b32 0xa2222222, s73
    s_cselect_b32 s88, 0, 0
    s_mov_b32 s72, 0
    s_add_u32 s73, s73, 1
    s_lshr_b32 s73, s73, 2
    s_xor_b32 s94, s13, 0
    s_mul_i32 s94, s94, 36864
    s_add_u32 s94, s94, s92
    s_lshl_b32 s74, s13, 7
    s_add_u32 s94, s94, s74
    s_add_u32 s78, s94, 0
    s_mov_b64 s[8:9], s[56:57]
    v_mov_b32 v58, v49
    s_mov_b32 s79, 9216
    s_mov_b32 s81, 0
    s_add_u32 s80, s66, 114688
    s_mov_b32 s76, 0
    s_mov_b32 s77, 8192
    s_call_b64 s[82:83], cs_dma
    s_mov_b32 s77, 16384
    s_call_b64 s[82:83], cs_dma
    s_xor_b32 s94, s13, 1
    s_mul_i32 s94, s94, 36864
    s_add_u32 s94, s94, s92
    s_lshl_b32 s74, s13, 7
    s_add_u32 s94, s94, s74
    s_add_u32 s78, s94, 0
    s_add_u32 s80, s66, 81920
    s_mov_b32 s76, 0
    s_mov_b32 s77, 8192
    s_call_b64 s[82:83], cs_dma
    s_mov_b32 s77, 16384
    s_call_b64 s[82:83], cs_dma
    s_xor_b32 s94, s13, 2
    s_mul_i32 s94, s94, 36864
    s_add_u32 s94, s94, s92
    s_lshl_b32 s74, s13, 7
    s_add_u32 s94, s94, s74
    s_add_u32 s78, s94, 0
    s_add_u32 s80, s66, 16384
    s_mov_b32 s76, 0
    s_mov_b32 s77, 8192
    s_call_b64 s[82:83], cs_dma
    s_mov_b32 s77, 16384
    s_call_b64 s[82:83], cs_dma
    s_xor_b32 s94, s13, 3
    s_mul_i32 s94, s94, 36864
    s_add_u32 s94, s94, s92
    s_lshl_b32 s74, s13, 7
    s_add_u32 s94, s94, s74
    s_add_u32 s78, s94, 0
    s_add_u32 s80, s66, 0
    s_mov_b32 s76, 0
    s_mov_b32 s77, 8192
    s_call_b64 s[82:83], cs_dma
    s_mov_b32 s77, 16384
    s_call_b64 s[82:83], cs_dma
    v_lshrrev_b32 v24, 6, v0
    v_lshlrev_b32 v61, 4, v0
    v_add_u32 v62, 57344, v61
    v_xor_b32 v63, 1024, v61
    v_add_u32 v63, 98304, v63
    v_xor_b32 v64, 2048, v61
    v_add_u32 v64, 98304, v64
    v_and_b32 v65, 1023, v61
    v_add_u32 v65, 98304, v65
    v_and_b32 v26, 15, v0
    v_bfe_u32 v27, v0, 4, 2
    v_mov_b32 v60, 0x4444
    v_mov_b32 v25, 0xeeee
    v_cmp_lt_u32 vcc, 7, v26
    s_nop 1
    v_cndmask_b32 v60, v60, v25, vcc
    s_nop 1
    v_and_b32 v67, 12, v26
    v_lshlrev_b32 v67, 3, v67
    v_and_b32 v25, 1, v26
    v_lshl_add_u32 v67, v25, 4, v67
    v_bfe_u32 v25, v26, 1, 1
    v_lshl_add_u32 v67, v25, 3, v67
    v_lshl_add_u32 v66, v27, 14, v67
    v_lshl_add_u32 v66, v24, 17, v66
    s_nop 1
    v_and_b32 v67, 63, v67
    v_lshrrev_b32 v25, 1, v24
    v_lshl_add_u32 v67, v25, 18, v67
    v_lshl_add_u32 v67, v27, 16, v67
    v_lshrrev_b32 v25, 3, v26
    v_lshl_add_u32 v67, v25, 15, v67
    v_and_b32 v25, 1, v24
    v_lshl_add_u32 v67, v25, 6, v67
    s_nop 1
    s_waitcnt vmcnt(12)
    v_add_u32 v55, 114688, v52
    ds_read_b64_tr_b16 v[160:161], v55 offset:0
    ds_read_b64_tr_b16 v[162:163], v55 offset:256
    ds_read_b64_tr_b16 v[164:165], v55 offset:4096
    ds_read_b64_tr_b16 v[166:167], v55 offset:4352
    s_xor_b32 s94, s13, 0
    s_mul_i32 s94, s94, 36864
    s_add_u32 s94, s94, s92
    s_lshl_b32 s74, s13, 7
    s_add_u32 s94, s94, s74
    s_add_u32 s78, s94, 512
    s_add_u32 s80, s66, 147456
    s_mov_b32 s76, 0
    s_mov_b32 s77, 8192
    s_call_b64 s[82:83], cs_dma
    ds_read_b64_tr_b16 v[192:193], v55 offset:64
    ds_read_b64_tr_b16 v[194:195], v55 offset:320
    ds_read_b64_tr_b16 v[196:197], v55 offset:4160
    ds_read_b64_tr_b16 v[198:199], v55 offset:4416
    s_mov_b32 s77, 16384
    s_call_b64 s[82:83], cs_dma
    v_and_b32 v25, 31, v0
    v_lshlrev_b32 v70, 4, v25
    v_lshlrev_b32 v28, 3, v25
    v_add_u32 v28, 108032, v28
    v_lshrrev_b32 v25, 1, v24
    v_lshl_add_u32 v70, v25, 9, v70
    v_and_b32 v25, 1, v24
    v_lshl_add_u32 v70, v25, 3, v70
    v_add_u32 v70, 109568, v70
    v_cmp_gt_u32 vcc, 2, v27
    s_nop 1
    v_cndmask_b32 v70, v70, v28, vcc
    s_nop 1
    s_waitcnt lgkmcnt(0)
    s_waitcnt vmcnt(12)
    v_add_u32 v55, 81920, v52
    ds_read_b64_tr_b16 v[168:169], v55 offset:0
    ds_read_b64_tr_b16 v[170:171], v55 offset:256
    ds_read_b64_tr_b16 v[172:173], v55 offset:4096
    ds_read_b64_tr_b16 v[174:175], v55 offset:4352
    s_xor_b32 s94, s13, 1
    s_mul_i32 s94, s94, 36864
    s_add_u32 s94, s94, s92
    s_lshl_b32 s74, s13, 7
    s_add_u32 s94, s94, s74
    s_add_u32 s78, s94, 512
    s_add_u32 s80, s66, 98304
    s_mov_b32 s76, 0
    s_mov_b32 s77, 8192
    s_call_b64 s[82:83], cs_dma
    ds_read_b64_tr_b16 v[200:201], v55 offset:64
    ds_read_b64_tr_b16 v[202:203], v55 offset:320
    ds_read_b64_tr_b16 v[204:205], v55 offset:4160
    ds_read_b64_tr_b16 v[206:207], v55 offset:4416
    s_mov_b32 s77, 16384
    s_call_b64 s[82:83], cs_dma
    v_xor_b32 v71, 2048, v63
    v_lshrrev_b32 v68, 4, v0
    v_lshlrev_b32 v68, 7, v68
    v_and_b32 v25, 7, v26
    v_lshl_add_u32 v68, v25, 4, v68
    v_add_u32 v68, 102400, v68
    v_xor_b32 v74, 512, v68
    v_xor_b32 v75, 1024, v68
    v_xor_b32 v76, 1536, v68
    v_lshrrev_b32 v25, 3, v26
    v_lshl_add_u32 v77, v25, 3, v68
    v_or_b32 v78, 512, v65
    v_lshlrev_b32 v79, 2, v61
    v_mov_b64 v[72:73], 0
    v_and_b32 v25, 1, v27
    v_lshlrev_b32 v69, 7, v25
    v_lshrrev_b32 v25, 1, v27
    v_lshl_add_u32 v69, v25, 3, v69
    v_and_b32 v25, 3, v26
    v_lshl_add_u32 v69, v25, 4, v69
    v_bfe_u32 v25, v26, 2, 1
    v_lshl_add_u32 v69, v25, 2, v69
    s_nop 1
    s_waitcnt lgkmcnt(0)
    s_waitcnt vmcnt(12)
    v_add_u32 v55, 16384, v52
    ds_read_b64_tr_b16 v[176:177], v55 offset:0
    ds_read_b64_tr_b16 v[178:179], v55 offset:256
    ds_read_b64_tr_b16 v[180:181], v55 offset:4096
    ds_read_b64_tr_b16 v[182:183], v55 offset:4352
    s_add_u32 s78, s67, 4194304
    s_mov_b64 s[8:9], s[54:55]
    v_mov_b32 v58, v48
    s_mov_b32 s79, 131072
    s_add_u32 s80, s66, 32768
    s_mov_b32 s76, 0
    s_mov_b32 s77, 8192
    s_call_b64 s[82:83], cs_dma
    ds_read_b64_tr_b16 v[208:209], v55 offset:64
    ds_read_b64_tr_b16 v[210:211], v55 offset:320
    ds_read_b64_tr_b16 v[212:213], v55 offset:4160
    ds_read_b64_tr_b16 v[214:215], v55 offset:4416
    s_mov_b32 s77, 16384
    s_call_b64 s[82:83], cs_dma
    s_mov_b32 s32, 0x00ff00ff
    s_mov_b32 s33, 0x00ff00ff
    s_not_b64 s[34:35], s[32:33]
    s_lshr_b32 s31, s12, 1
    s_lshl_b32 s31, s31, 8
    s_and_b32 s40, s12, 1
    s_lshl_b32 s40, s40, 6
    s_add_u32 s31, s31, s40
    s_and_b32 s40, s13, 1
    s_lshl_b32 s40, s40, 12
    s_add_u32 s31, s31, s40
    s_lshl_b32 s19, s12, 14
    s_add_u32 s19, s19, 68124672
    s_add_u32 s41, s19, 8192
    s_add_u32 s19, s19, s40
    s_and_b32 s40, s12, 1
    s_lshl_b32 s40, s40, 2
    s_or_b32 s40, s40, s13
    s_cmp_eq_u32 s40, 5
    s_cselect_b32 s64, 0, s13
    s_cmp_lg_u32 s13, 1
    s_cbranch_scc1 cs_notx
    s_mov_b32 s32, 0xff
    s_mov_b32 s33, 0xff
    s_mov_b32 s19, s41
    s_lshr_b32 s31, s12, 3
    s_lshl_b32 s31, s31, 8
    s_and_b32 s40, s12, 2
    s_lshl_b32 s40, s40, 6
    s_add_u32 s31, s31, s40
    s_and_b32 s40, s12, 4
    s_lshl_b32 s40, s40, 4
    s_add_u32 s31, s31, s40
    s_add_u32 s31, s31, 8192
cs_notx:
    s_cmp_lg_u32 s13, 0
    s_cbranch_scc1 cs_notp
    s_min_u32 s40, s12, 23
    s_mul_i32 s40, s40, 384
    s_add_u32 s40, s40, 98304
    v_add_u32 v69, s40, v61
    v_mov_b32 v25, 108288
    v_cmp_lt_u32 vcc, 23, v0
    s_nop 1
    v_cndmask_b32 v69, v69, v25, vcc
cs_notp:
    s_nop 1
    s_waitcnt lgkmcnt(0)
    s_waitcnt vmcnt(12)
    v_add_u32 v55, 0, v52
    ds_read_b64_tr_b16 v[184:185], v55 offset:0
    ds_read_b64_tr_b16 v[186:187], v55 offset:256
    ds_read_b64_tr_b16 v[188:189], v55 offset:4096
    ds_read_b64_tr_b16 v[190:191], v55 offset:4352
    s_xor_b32 s78, s75, 0
    s_add_u32 s78, s78, s67
    s_mov_b32 s81, s93
    s_add_u32 s80, s66, 114688
    s_mov_b32 s76, 0
    s_mov_b32 s77, 8192
    s_call_b64 s[82:83], cs_dma
    ds_read_b64_tr_b16 v[216:217], v55 offset:64
    ds_read_b64_tr_b16 v[218:219], v55 offset:320
    ds_read_b64_tr_b16 v[220:221], v55 offset:4160
    ds_read_b64_tr_b16 v[222:223], v55 offset:4416
    s_mov_b32 s77, 16384
    s_call_b64 s[82:83], cs_dma
    v_mov_b32 v28, 1
    v_mov_b32 v29, 1
    v_mov_b32 v30, 1
    v_mov_b32 v31, 1
    s_lshl_b32 s40, s12, 14
    s_add_u32 s40, s40, 68222976
    s_add_u32 s41, s40, 0
    buffer_store_dwordx4 v[28:31], v61, s[4:7], s41 offen sc1
    s_add_u32 s41, s40, 4096
    buffer_store_dwordx4 v[28:31], v61, s[4:7], s41 offen sc1
    s_add_u32 s41, s40, 8192
    buffer_store_dwordx4 v[28:31], v61, s[4:7], s41 offen sc1
    s_cmp_eq_u32 s64, 0
    s_cselect_b64 exec, 0, s[32:33]
    v_mov_b32 v27, -1
    s_add_u32 s41, s31, 68157440
    buffer_store_dword v27, v69, s[4:7], s41 offen sc1
    s_add_u32 s41, s31, 68173824
    buffer_store_dword v27, v69, s[4:7], s41 offen sc1
    s_add_u32 s41, s31, 68190208
    buffer_store_dword v27, v69, s[4:7], s41 offen sc1
    s_add_u32 s41, s31, 68206592
    buffer_store_dword v27, v69, s[4:7], s41 offen sc1
    s_mov_b64 exec, -1
    s_waitcnt lgkmcnt(0)
    s_waitcnt vmcnt(12)
    v_add_u32 v55, 147456, v52
    ds_read_b64_tr_b16 v[224:225], v55 offset:0
    ds_read_b64_tr_b16 v[226:227], v55 offset:256
    ds_read_b64_tr_b16 v[228:229], v55 offset:4096
    ds_read_b64_tr_b16 v[230:231], v55 offset:4352
    s_mov_b32 s77, 24576
    s_call_b64 s[82:83], cs_dma
    ds_read_b64_tr_b16 v[240:241], v55 offset:64
    ds_read_b64_tr_b16 v[242:243], v55 offset:320
    ds_read_b64_tr_b16 v[244:245], v55 offset:4160
    ds_read_b64_tr_b16 v[246:247], v55 offset:4416
    s_mov_b32 s77, 32768
    s_call_b64 s[82:83], cs_dma
    s_mov_b64 s[68:69], s[48:49]
    s_mov_b32 s70, 9216
    s_mov_b32 s71, 0x20000
    v_and_b32 v25, 7, v0
    v_mul_u32_u24 v25, 1152, v25
    v_lshrrev_b32 v26, 3, v0
    v_lshl_add_u32 v25, v26, 4, v25
    buffer_load_dwordx4 v[36:39], v25, s[68:71], 0 offen
    buffer_load_dwordx4 v[40:43], v25, s[68:71], 0 offen offset:512
    v_bfe_u32 v25, v0, 2, 3
    v_mul_u32_u24 v25, 1152, v25
    v_lshrrev_b32 v26, 5, v0
    v_lshl_add_u32 v25, v26, 4, v25
    v_and_b32 v26, 3, v0
    v_lshl_add_u32 v25, v26, 2, v25
    buffer_load_dword v44, v25, s[68:71], 0 offen offset:1024
    s_nop 0
    s_waitcnt lgkmcnt(0)
    s_waitcnt vmcnt(15)
    v_add_u32 v55, 98304, v52
    ds_read_b64_tr_b16 v[232:233], v55 offset:0
    ds_read_b64_tr_b16 v[234:235], v55 offset:256
    ds_read_b64_tr_b16 v[236:237], v55 offset:4096
    ds_read_b64_tr_b16 v[238:239], v55 offset:4352
    s_xor_b32 s78, s75, 1048576
    s_add_u32 s78, s78, s67
    s_add_u32 s80, s66, 65536
    s_mov_b32 s76, 0
    s_mov_b32 s77, 8192
    s_call_b64 s[82:83], cs_dma
    ds_read_b64_tr_b16 v[248:249], v55 offset:64
    ds_read_b64_tr_b16 v[250:251], v55 offset:320
    ds_read_b64_tr_b16 v[252:253], v55 offset:4160
    ds_read_b64_tr_b16 v[254:255], v55 offset:4416
    s_mov_b32 s77, 16384
    s_call_b64 s[82:83], cs_dma
    s_mov_b32 s44, 0x3e0293ee
    s_mov_b32 s45, s44
    s_mov_b32 s46, 0x42000000
    s_mov_b32 s60, 0x3f803f80
    s_mov_b32 s61, s60
    s_mov_b32 s62, 0x3e803e80
    s_mov_b32 s63, s62
    s_mov_b32 s28, 0
    s_lshl_b32 s58, s13, 10
    s_add_u32 s58, s58, 102400
    s_lshl_b32 s59, s13, 8
    s_add_u32 s59, s59, 106496
    s_lshl_b32 s24, s12, 14
    s_add_u32 s24, s24, 0
    s_add_u32 s47, s24, 33030144
    s_mul_i32 s40, s13, 3072
    s_add_u32 s23, s24, s40
    s_lshl_b32 s20, s12, 7
    s_add_u32 s20, s20, 68222976
    s_add_u32 s21, s20, 65536
    s_add_u32 s38, s20, 4096
    s_add_u32 s39, s21, 4096
    s_lshl_b32 s22, s12, 7
    s_add_u32 s22, s22, 68231168
    s_waitcnt lgkmcnt(0)
    s_waitcnt vmcnt(15)
    v_add_u32 v55, 32768, v51
    v_xor_b32 v56, 32, v55
    ds_read_b64_tr_b16 v[144:145], v55 offset:0
    ds_read_b64_tr_b16 v[146:147], v55 offset:256
    ds_read_b64_tr_b16 v[148:149], v55 offset:8192
    ds_read_b64_tr_b16 v[150:151], v55 offset:8448
    s_mov_b32 s77, 24576
    s_call_b64 s[82:83], cs_dma
    ds_read_b64_tr_b16 v[152:153], v56 offset:0
    ds_read_b64_tr_b16 v[154:155], v56 offset:256
    ds_read_b64_tr_b16 v[156:157], v56 offset:8192
    ds_read_b64_tr_b16 v[158:159], v56 offset:8448
    s_mov_b32 s77, 32768
    s_call_b64 s[82:83], cs_dma
    s_lshl_b32 s40, s12, 12
    s_add_u32 s25, s40, 79429632
    s_add_u32 s26, s40, 88866816
    s_lshl_b32 s65, s12, 9
    s_add_u32 s65, s65, 90177536
    s_lshl_b32 s40, s13, 5
    s_or_b32 s40, s40, s12
    s_cmp_lt_u32 s40, 24
    s_cselect_b32 s36, 0x1ffffff, 0
    s_mov_b32 s37, 0
    s_lshl_b32 s27, s12, 7
    s_add_u32 s27, s27, 125845504
    s_lshl_b32 s40, s13, 2
    s_add_u32 s27, s27, s40
    v_bfe_u32 v28, v61, 4, 4
    v_bfe_u32 v29, v61, 8, 1
    v_lshlrev_b32 v29, 2, v29
    v_sub_u32 v29, v28, v29
    v_mov_b32 v31, 0x3f80
    v_mov_b32 v32, 0x3f800000
    s_nop 1
    s_waitcnt lgkmcnt(0)
    s_waitcnt vmcnt(11)
    v_add_u32 v55, 114688, v51
    v_xor_b32 v56, 32, v55
    ds_read_b64_tr_b16 a[192:193], v55 offset:0
    ds_read_b64_tr_b16 a[194:195], v55 offset:256
    ds_read_b64_tr_b16 a[196:197], v55 offset:8192
    ds_read_b64_tr_b16 a[198:199], v55 offset:8448
    s_xor_b32 s78, s75, 2097152
    s_add_u32 s78, s78, s67
    s_add_u32 s80, s66, 0
    s_mov_b32 s76, 0
    s_mov_b32 s77, 8192
    s_call_b64 s[82:83], cs_dma
    ds_read_b64_tr_b16 a[200:201], v56 offset:0
    ds_read_b64_tr_b16 a[202:203], v56 offset:256
    ds_read_b64_tr_b16 a[204:205], v56 offset:8192
    ds_read_b64_tr_b16 a[206:207], v56 offset:8448
    s_mov_b32 s77, 16384
    s_call_b64 s[82:83], cs_dma
    v_cmp_eq_u32 vcc, 0, v29
    s_nop 1
    v_cndmask_b32 v16, 0, v31, vcc
    v_cmp_eq_u32 vcc, 1, v29
    s_nop 1
    v_cndmask_b32 v16, v16, v32, vcc
    v_cmp_eq_u32 vcc, 0, v28
    s_nop 1
    v_cndmask_b32 v20, 0, v31, vcc
    v_cmp_eq_u32 vcc, 1, v28
    s_nop 1
    v_cndmask_b32 v20, v20, v32, vcc
    s_nop 1
    s_waitcnt lgkmcnt(0)
    v_add_u32 v55, 131072, v51
    v_xor_b32 v56, 32, v55
    ds_read_b64_tr_b16 a[208:209], v55 offset:0
    ds_read_b64_tr_b16 a[210:211], v55 offset:256
    ds_read_b64_tr_b16 a[212:213], v55 offset:8192
    ds_read_b64_tr_b16 a[214:215], v55 offset:8448
    s_mov_b32 s77, 24576
    s_call_b64 s[82:83], cs_dma
    ds_read_b64_tr_b16 a[216:217], v56 offset:0
    ds_read_b64_tr_b16 a[218:219], v56 offset:256
    ds_read_b64_tr_b16 a[220:221], v56 offset:8192
    ds_read_b64_tr_b16 a[222:223], v56 offset:8448
    s_mov_b32 s77, 32768
    s_call_b64 s[82:83], cs_dma
    v_cmp_eq_u32 vcc, 2, v29
    s_nop 1
    v_cndmask_b32 v17, 0, v31, vcc
    v_cmp_eq_u32 vcc, 3, v29
    s_nop 1
    v_cndmask_b32 v17, v17, v32, vcc
    v_cmp_eq_u32 vcc, 2, v28
    s_nop 1
    v_cndmask_b32 v21, 0, v31, vcc
    v_cmp_eq_u32 vcc, 3, v28
    s_nop 1
    v_cndmask_b32 v21, v21, v32, vcc
    s_nop 1
    s_waitcnt lgkmcnt(0)
    s_waitcnt vmcnt(8)
    v_add_u32 v55, 65536, v51
    v_xor_b32 v56, 32, v55
    ds_read_b64_tr_b16 a[224:225], v55 offset:0
    ds_read_b64_tr_b16 a[226:227], v55 offset:256
    ds_read_b64_tr_b16 a[228:229], v55 offset:8192
    ds_read_b64_tr_b16 a[230:231], v55 offset:8448
    s_xor_b32 s78, s75, 3145728
    s_add_u32 s78, s78, s67
    s_add_u32 s80, s66, 32768
    s_mov_b32 s76, 0
    s_mov_b32 s77, 8192
    s_call_b64 s[82:83], cs_dma
    ds_read_b64_tr_b16 a[232:233], v56 offset:0
    ds_read_b64_tr_b16 a[234:235], v56 offset:256
    ds_read_b64_tr_b16 a[236:237], v56 offset:8192
    ds_read_b64_tr_b16 a[238:239], v56 offset:8448
    s_mov_b32 s77, 16384
    s_call_b64 s[82:83], cs_dma
    v_cmp_eq_u32 vcc, 8, v29
    s_nop 1
    v_cndmask_b32 v18, 0, v31, vcc
    v_cmp_eq_u32 vcc, 9, v29
    s_nop 1
    v_cndmask_b32 v18, v18, v32, vcc
    v_cmp_eq_u32 vcc, 4, v28
    s_nop 1
    v_cndmask_b32 v22, 0, v31, vcc
    v_cmp_eq_u32 vcc, 5, v28
    s_nop 1
    v_cndmask_b32 v22, v22, v32, vcc
    s_nop 1
    s_waitcnt lgkmcnt(0)
    v_add_u32 v55, 81920, v51
    v_xor_b32 v56, 32, v55
    ds_read_b64_tr_b16 a[240:241], v55 offset:0
    ds_read_b64_tr_b16 a[242:243], v55 offset:256
    ds_read_b64_tr_b16 a[244:245], v55 offset:8192
    ds_read_b64_tr_b16 a[246:247], v55 offset:8448
    s_mov_b32 s77, 24576
    s_call_b64 s[82:83], cs_dma
    ds_read_b64_tr_b16 a[248:249], v56 offset:0
    ds_read_b64_tr_b16 a[250:251], v56 offset:256
    ds_read_b64_tr_b16 a[252:253], v56 offset:8192
    ds_read_b64_tr_b16 a[254:255], v56 offset:8448
    s_mov_b32 s77, 32768
    s_call_b64 s[82:83], cs_dma
    v_cmp_eq_u32 vcc, 10, v29
    s_nop 1
    v_cndmask_b32 v19, 0, v31, vcc
    v_cmp_eq_u32 vcc, 11, v29
    s_nop 1
    v_cndmask_b32 v19, v19, v32, vcc
    v_cmp_eq_u32 vcc, 6, v28
    s_nop 1
    v_cndmask_b32 v23, 0, v31, vcc
    v_cmp_eq_u32 vcc, 7, v28
    s_nop 1
    v_cndmask_b32 v23, v23, v32, vcc
    s_nop 1
    s_waitcnt lgkmcnt(0)
    s_waitcnt vmcnt(8)
    v_add_u32 v55, 0, v51
    v_xor_b32 v56, 32, v55
    ds_read_b64_tr_b16 v[80:81], v55 offset:0
    ds_read_b64_tr_b16 v[82:83], v55 offset:256
    ds_read_b64_tr_b16 v[84:85], v55 offset:8192
    ds_read_b64_tr_b16 v[86:87], v55 offset:8448
    s_xor_b32 s78, s75, 2097152
    s_add_u32 s78, s78, s67
    s_mov_b64 s[8:9], s[52:53]
    s_add_u32 s80, s66, 131072
    s_mov_b32 s76, 0
    s_mov_b32 s77, 8192
    s_call_b64 s[82:83], cs_dma
    ds_read_b64_tr_b16 v[88:89], v56 offset:0
    ds_read_b64_tr_b16 v[90:91], v56 offset:256
    ds_read_b64_tr_b16 v[92:93], v56 offset:8192
    ds_read_b64_tr_b16 v[94:95], v56 offset:8448
    s_mov_b32 s77, 16384
    s_call_b64 s[82:83], cs_dma
    v_mov_b32 v46, 1
    s_mov_b64 exec, 1
    buffer_atomic_add v46, off, s[96:99], 0 offset:212 sc0
    s_mov_b64 exec, -1
    s_waitcnt lgkmcnt(0)
    v_add_u32 v55, 16384, v51
    v_xor_b32 v56, 32, v55
    ds_read_b64_tr_b16 v[96:97], v55 offset:0
    ds_read_b64_tr_b16 v[98:99], v55 offset:256
    ds_read_b64_tr_b16 v[100:101], v55 offset:8192
    ds_read_b64_tr_b16 v[102:103], v55 offset:8448
    s_mov_b32 s77, 24576
    s_call_b64 s[82:83], cs_dma
    ds_read_b64_tr_b16 v[104:105], v56 offset:0
    ds_read_b64_tr_b16 v[106:107], v56 offset:256
    ds_read_b64_tr_b16 v[108:109], v56 offset:8192
    ds_read_b64_tr_b16 v[110:111], v56 offset:8448
    s_mov_b32 s77, 32768
    s_call_b64 s[82:83], cs_dma
    s_waitcnt lgkmcnt(0)
    s_waitcnt vmcnt(9)
    v_add_u32 v55, 32768, v51
    v_xor_b32 v56, 32, v55
    ds_read_b64_tr_b16 v[112:113], v55 offset:0
    ds_read_b64_tr_b16 v[114:115], v55 offset:256
    ds_read_b64_tr_b16 v[116:117], v55 offset:8192
    ds_read_b64_tr_b16 v[118:119], v55 offset:8448
    s_xor_b32 s78, s75, 3145728
    s_add_u32 s78, s78, s67
    s_add_u32 s80, s66, 65536
    s_mov_b32 s76, 0
    s_mov_b32 s77, 8192
    s_call_b64 s[82:83], cs_dma
    ds_read_b64_tr_b16 v[120:121], v56 offset:0
    ds_read_b64_tr_b16 v[122:123], v56 offset:256
    ds_read_b64_tr_b16 v[124:125], v56 offset:8192
    ds_read_b64_tr_b16 v[126:127], v56 offset:8448
    s_mov_b32 s77, 16384
    s_call_b64 s[82:83], cs_dma
    s_waitcnt lgkmcnt(0)
    v_add_u32 v55, 49152, v51
    v_xor_b32 v56, 32, v55
    ds_read_b64_tr_b16 v[128:129], v55 offset:0
    ds_read_b64_tr_b16 v[130:131], v55 offset:256
    ds_read_b64_tr_b16 v[132:133], v55 offset:8192
    ds_read_b64_tr_b16 v[134:135], v55 offset:8448
    s_mov_b32 s77, 24576
    s_call_b64 s[82:83], cs_dma
    ds_read_b64_tr_b16 v[136:137], v56 offset:0
    ds_read_b64_tr_b16 v[138:139], v56 offset:256
    ds_read_b64_tr_b16 v[140:141], v56 offset:8192
    ds_read_b64_tr_b16 v[142:143], v56 offset:8448
    s_mov_b32 s77, 32768
    s_call_b64 s[82:83], cs_dma
    s_waitcnt lgkmcnt(0)
    s_waitcnt vmcnt(8)
    v_add_u32 v55, 131072, v51
    v_xor_b32 v56, 32, v55
    ds_read_b64_tr_b16 a[128:129], v55 offset:0
    ds_read_b64_tr_b16 a[130:131], v55 offset:256
    ds_read_b64_tr_b16 a[132:133], v55 offset:8192
    ds_read_b64_tr_b16 a[134:135], v55 offset:8448
    s_xor_b32 s78, s75, 2097152
    s_add_u32 s78, s78, s67
    s_mov_b64 s[8:9], s[50:51]
    s_add_u32 s80, s66, 0
    s_mov_b32 s76, 0
    s_mov_b32 s77, 8192
    s_call_b64 s[82:83], cs_dma
    ds_read_b64_tr_b16 a[136:137], v56 offset:0
    ds_read_b64_tr_b16 a[138:139], v56 offset:256
    ds_read_b64_tr_b16 a[140:141], v56 offset:8192
    ds_read_b64_tr_b16 a[142:143], v56 offset:8448
    s_mov_b32 s77, 16384
    s_call_b64 s[82:83], cs_dma
    s_waitcnt lgkmcnt(0)
    v_add_u32 v55, 147456, v51
    v_xor_b32 v56, 32, v55
    ds_read_b64_tr_b16 a[144:145], v55 offset:0
    ds_read_b64_tr_b16 a[146:147], v55 offset:256
    ds_read_b64_tr_b16 a[148:149], v55 offset:8192
    ds_read_b64_tr_b16 a[150:151], v55 offset:8448
    s_mov_b32 s77, 24576
    s_call_b64 s[82:83], cs_dma
    ds_read_b64_tr_b16 a[152:153], v56 offset:0
    ds_read_b64_tr_b16 a[154:155], v56 offset:256
    ds_read_b64_tr_b16 a[156:157], v56 offset:8192
    ds_read_b64_tr_b16 a[158:159], v56 offset:8448
    s_mov_b32 s77, 32768
    s_call_b64 s[82:83], cs_dma
    s_waitcnt lgkmcnt(0)
    s_waitcnt vmcnt(8)
    v_add_u32 v55, 65536, v51
    v_xor_b32 v56, 32, v55
    ds_read_b64_tr_b16 a[160:161], v55 offset:0
    ds_read_b64_tr_b16 a[162:163], v55 offset:256
    ds_read_b64_tr_b16 a[164:165], v55 offset:8192
    ds_read_b64_tr_b16 a[166:167], v55 offset:8448
    s_xor_b32 s78, s75, 3145728
    s_add_u32 s78, s78, s67
    s_add_u32 s80, s66, 32768
    s_mov_b32 s76, 0
    s_mov_b32 s77, 8192
    s_call_b64 s[82:83], cs_dma
    ds_read_b64_tr_b16 a[168:169], v56 offset:0
    ds_read_b64_tr_b16 a[170:171], v56 offset:256
    ds_read_b64_tr_b16 a[172:173], v56 offset:8192
    ds_read_b64_tr_b16 a[174:175], v56 offset:8448
    s_mov_b32 s77, 16384
    s_call_b64 s[82:83], cs_dma
    v_readfirstlane_b32 s41, v46
    v_mov_b32 v46, 1
    v_mov_b32 v47, 0
    s_cmp_eq_u32 s41, 127
    s_cselect_b64 exec, 1, 0
    buffer_atomic_cmpswap v[46:47], off, s[96:99], 0 offset:216
    s_mov_b64 exec, -1
    s_waitcnt lgkmcnt(0)
    v_add_u32 v55, 81920, v51
    v_xor_b32 v56, 32, v55
    ds_read_b64_tr_b16 a[176:177], v55 offset:0
    ds_read_b64_tr_b16 a[178:179], v55 offset:256
    ds_read_b64_tr_b16 a[180:181], v55 offset:8192
    ds_read_b64_tr_b16 a[182:183], v55 offset:8448
    s_mov_b32 s77, 24576
    s_call_b64 s[82:83], cs_dma
    ds_read_b64_tr_b16 a[184:185], v56 offset:0
    ds_read_b64_tr_b16 a[186:187], v56 offset:256
    ds_read_b64_tr_b16 a[188:189], v56 offset:8192
    ds_read_b64_tr_b16 a[190:191], v56 offset:8448
    s_mov_b32 s77, 32768
    s_call_b64 s[82:83], cs_dma
    s_waitcnt lgkmcnt(0)
    s_waitcnt vmcnt(8)
    v_add_u32 v55, 0, v51
    v_xor_b32 v56, 32, v55
    ds_read_b64_tr_b16 a[48:49], v55 offset:0
    ds_read_b64_tr_b16 a[50:51], v55 offset:256
    ds_read_b64_tr_b16 a[52:53], v55 offset:8192
    ds_read_b64_tr_b16 a[54:55], v55 offset:8448
    s_add_u32 s78, s67, 4194304
    s_mov_b32 s81, 0
    s_add_u32 s80, s66, 98304
    s_mov_b32 s76, 0
    s_mov_b32 s77, 8192
    s_call_b64 s[82:83], cs_dma
    ds_read_b64_tr_b16 a[56:57], v56 offset:0
    ds_read_b64_tr_b16 a[58:59], v56 offset:256
    ds_read_b64_tr_b16 a[60:61], v56 offset:8192
    ds_read_b64_tr_b16 a[62:63], v56 offset:8448
    s_mov_b32 s77, 16384
    s_call_b64 s[82:83], cs_dma
    s_waitcnt lgkmcnt(0)
    v_add_u32 v55, 16384, v51
    v_xor_b32 v56, 32, v55
    ds_read_b64_tr_b16 a[64:65], v55 offset:0
    ds_read_b64_tr_b16 a[66:67], v55 offset:256
    ds_read_b64_tr_b16 a[68:69], v55 offset:8192
    ds_read_b64_tr_b16 a[70:71], v55 offset:8448
    s_xor_b32 s78, s75, 1048576
    s_add_u32 s78, s78, s67
    s_mov_b32 s81, s93
    s_add_u32 s80, s66, 114688
    s_mov_b32 s76, 0
    s_mov_b32 s77, 8192
    s_call_b64 s[82:83], cs_dma
    ds_read_b64_tr_b16 a[72:73], v56 offset:0
    ds_read_b64_tr_b16 a[74:75], v56 offset:256
    ds_read_b64_tr_b16 a[76:77], v56 offset:8192
    ds_read_b64_tr_b16 a[78:79], v56 offset:8448
    s_mov_b32 s77, 16384
    s_call_b64 s[82:83], cs_dma
    s_waitcnt lgkmcnt(0)
    s_waitcnt vmcnt(8)
    v_add_u32 v55, 32768, v51
    v_xor_b32 v56, 32, v55
    ds_read_b64_tr_b16 a[80:81], v55 offset:0
    ds_read_b64_tr_b16 a[82:83], v55 offset:256
    ds_read_b64_tr_b16 a[84:85], v55 offset:8192
    ds_read_b64_tr_b16 a[86:87], v55 offset:8448
    s_mov_b32 s77, 24576
    s_call_b64 s[82:83], cs_dma
    ds_read_b64_tr_b16 a[88:89], v56 offset:0
    ds_read_b64_tr_b16 a[90:91], v56 offset:256
    ds_read_b64_tr_b16 a[92:93], v56 offset:8192
    ds_read_b64_tr_b16 a[94:95], v56 offset:8448
    s_mov_b32 s77, 32768
    s_call_b64 s[82:83], cs_dma
    s_waitcnt lgkmcnt(0)
    v_add_u32 v55, 49152, v51
    v_xor_b32 v56, 32, v55
    ds_read_b64_tr_b16 a[96:97], v55 offset:0
    ds_read_b64_tr_b16 a[98:99], v55 offset:256
    ds_read_b64_tr_b16 a[100:101], v55 offset:8192
    ds_read_b64_tr_b16 a[102:103], v55 offset:8448
    s_xor_b32 s78, s75, 0
    s_add_u32 s78, s78, s67
    s_add_u32 s80, s66, 65536
    s_mov_b32 s76, 0
    s_mov_b32 s77, 8192
    s_call_b64 s[82:83], cs_dma
    ds_read_b64_tr_b16 a[104:105], v56 offset:0
    ds_read_b64_tr_b16 a[106:107], v56 offset:256
    ds_read_b64_tr_b16 a[108:109], v56 offset:8192
    ds_read_b64_tr_b16 a[110:111], v56 offset:8448
    s_mov_b32 s77, 16384
    s_call_b64 s[82:83], cs_dma
    s_waitcnt lgkmcnt(0)
    s_waitcnt vmcnt(12)
    v_add_u32 v55, 98304, v51
    v_xor_b32 v56, 32, v55
    ds_read_b64_tr_b16 a[112:113], v55 offset:0
    ds_read_b64_tr_b16 a[114:115], v55 offset:256
    ds_read_b64_tr_b16 a[116:117], v55 offset:8192
    ds_read_b64_tr_b16 a[118:119], v55 offset:8448
    s_mov_b32 s77, 24576
    s_call_b64 s[82:83], cs_dma
    ds_read_b64_tr_b16 a[120:121], v56 offset:0
    ds_read_b64_tr_b16 a[122:123], v56 offset:256
    ds_read_b64_tr_b16 a[124:125], v56 offset:8192
    ds_read_b64_tr_b16 a[126:127], v56 offset:8448
    s_mov_b32 s77, 32768
    s_call_b64 s[82:83], cs_dma
    s_waitcnt lgkmcnt(0)
    s_waitcnt vmcnt(8)
    v_add_u32 v55, 114688, v51
    v_xor_b32 v56, 32, v55
    ds_read_b64_tr_b16 a[16:17], v55 offset:0
    ds_read_b64_tr_b16 a[18:19], v55 offset:256
    ds_read_b64_tr_b16 a[20:21], v55 offset:8192
    ds_read_b64_tr_b16 a[22:23], v55 offset:8448
    s_xor_b32 s78, s75, 0
    s_add_u32 s78, s78, s67
    s_mov_b64 s[8:9], s[52:53]
    s_add_u32 s80, s66, 0
    s_mov_b32 s76, 0
    s_mov_b32 s77, 8192
    s_call_b64 s[82:83], cs_dma
    ds_read_b64_tr_b16 a[24:25], v56 offset:0
    ds_read_b64_tr_b16 a[26:27], v56 offset:256
    ds_read_b64_tr_b16 a[28:29], v56 offset:8192
    ds_read_b64_tr_b16 a[30:31], v56 offset:8448
    s_mov_b32 s77, 16384
    s_call_b64 s[82:83], cs_dma
    s_waitcnt lgkmcnt(0)
    v_add_u32 v55, 131072, v51
    v_xor_b32 v56, 32, v55
    ds_read_b64_tr_b16 a[32:33], v55 offset:0
    ds_read_b64_tr_b16 a[34:35], v55 offset:256
    ds_read_b64_tr_b16 a[36:37], v55 offset:8192
    ds_read_b64_tr_b16 a[38:39], v55 offset:8448
    s_mov_b32 s77, 24576
    s_call_b64 s[82:83], cs_dma
    ds_read_b64_tr_b16 a[40:41], v56 offset:0
    ds_read_b64_tr_b16 a[42:43], v56 offset:256
    ds_read_b64_tr_b16 a[44:45], v56 offset:8192
    ds_read_b64_tr_b16 a[46:47], v56 offset:8448
    s_mov_b32 s77, 32768
    s_call_b64 s[82:83], cs_dma
    s_waitcnt lgkmcnt(0)
    s_waitcnt vmcnt(8)
    v_add_u32 v55, 65536, v51
    v_xor_b32 v56, 32, v55
    ds_read_b64_tr_b16 v[0:1], v55 offset:0
    ds_read_b64_tr_b16 v[2:3], v55 offset:256
    ds_read_b64_tr_b16 v[4:5], v55 offset:8192
    ds_read_b64_tr_b16 v[6:7], v55 offset:8448
    s_xor_b32 s78, s75, 1048576
    s_add_u32 s78, s78, s67
    s_add_u32 s80, s66, 32768
    s_mov_b32 s76, 0
    s_mov_b32 s77, 8192
    s_call_b64 s[82:83], cs_dma
    ds_read_b64_tr_b16 v[8:9], v56 offset:0
    ds_read_b64_tr_b16 v[10:11], v56 offset:256
    ds_read_b64_tr_b16 v[12:13], v56 offset:8192
    ds_read_b64_tr_b16 v[14:15], v56 offset:8448
    s_mov_b32 s77, 16384
    s_call_b64 s[82:83], cs_dma
    s_waitcnt lgkmcnt(0)
    ds_write_b128 v62, v[0:3] offset:8192
    ds_write_b128 v62, v[4:7] offset:12288
    ds_write_b128 v62, v[8:11] offset:16384
    ds_write_b128 v62, v[12:15] offset:20480
    s_waitcnt lgkmcnt(0)
    v_add_u32 v55, 81920, v51
    v_xor_b32 v56, 32, v55
    ds_read_b64_tr_b16 a[0:1], v55 offset:0
    ds_read_b64_tr_b16 a[2:3], v55 offset:256
    ds_read_b64_tr_b16 a[4:5], v55 offset:8192
    ds_read_b64_tr_b16 a[6:7], v55 offset:8448
    s_mov_b32 s77, 24576
    s_call_b64 s[82:83], cs_dma
    ds_read_b64_tr_b16 a[8:9], v56 offset:0
    ds_read_b64_tr_b16 a[10:11], v56 offset:256
    ds_read_b64_tr_b16 a[12:13], v56 offset:8192
    ds_read_b64_tr_b16 a[14:15], v56 offset:8448
    s_mov_b32 s77, 32768
    s_call_b64 s[82:83], cs_dma
    s_waitcnt lgkmcnt(0)
    s_waitcnt vmcnt(8)
    v_add_u32 v55, 0, v51
    v_xor_b32 v56, 32, v55
    ds_read_b64_tr_b16 v[0:1], v55 offset:0
    ds_read_b64_tr_b16 v[2:3], v55 offset:256
    ds_read_b64_tr_b16 v[4:5], v55 offset:8192
    ds_read_b64_tr_b16 v[6:7], v55 offset:8448
    s_xor_b32 s94, s13, 0
    s_mul_i32 s94, s94, 36864
    s_add_u32 s94, s94, s92
    s_lshr_b32 s74, s13, 1
    s_lshl_b32 s74, s74, 6
    s_add_u32 s94, s94, s74
    s_add_u32 s78, s94, 1024
    s_mov_b64 s[8:9], s[56:57]
    v_mov_b32 v58, v50
    s_mov_b32 s79, 18432
    s_mov_b32 s81, 0
    s_add_u32 s80, s66, 147456
    s_mov_b32 s76, 0
    s_mov_b32 s77, 8192
    s_call_b64 s[82:83], cs_dma
    ds_read_b64_tr_b16 v[8:9], v56 offset:0
    ds_read_b64_tr_b16 v[10:11], v56 offset:256
    ds_read_b64_tr_b16 v[12:13], v56 offset:8192
    ds_read_b64_tr_b16 v[14:15], v56 offset:8448
    s_xor_b32 s94, s13, 2
    s_mul_i32 s94, s94, 36864
    s_add_u32 s94, s94, s92
    s_lshr_b32 s74, s13, 1
    s_lshl_b32 s74, s74, 6
    s_add_u32 s94, s94, s74
    s_add_u32 s78, s94, 1024
    s_mov_b32 s77, 16384
    s_call_b64 s[82:83], cs_dma
    s_waitcnt lgkmcnt(0)
    ds_write_b128 v61, v[0:3] offset:0
    ds_write_b128 v61, v[4:7] offset:4096
    ds_write_b128 v61, v[8:11] offset:8192
    ds_write_b128 v61, v[12:15] offset:12288
    s_waitcnt lgkmcnt(0)
    v_add_u32 v55, 16384, v51
    v_xor_b32 v56, 32, v55
    ds_read_b64_tr_b16 v[0:1], v55 offset:0
    ds_read_b64_tr_b16 v[2:3], v55 offset:256
    ds_read_b64_tr_b16 v[4:5], v55 offset:8192
    ds_read_b64_tr_b16 v[6:7], v55 offset:8448
    s_xor_b32 s94, s13, 3
    s_mul_i32 s94, s94, 36864
    s_add_u32 s94, s94, s92
    s_lshl_b32 s74, s13, 7
    s_add_u32 s94, s94, s74
    s_add_u32 s78, s94, 512
    v_mov_b32 v58, v49
    s_mov_b32 s79, 9216
    s_add_u32 s80, s66, 131072
    s_mov_b32 s76, 0
    s_mov_b32 s77, 8192
    s_call_b64 s[82:83], cs_dma
    ds_read_b64_tr_b16 v[8:9], v56 offset:0
    ds_read_b64_tr_b16 v[10:11], v56 offset:256
    ds_read_b64_tr_b16 v[12:13], v56 offset:8192
    ds_read_b64_tr_b16 v[14:15], v56 offset:8448
    s_mov_b32 s77, 16384
    s_call_b64 s[82:83], cs_dma
    s_waitcnt lgkmcnt(0)
    ds_write_b128 v61, v[0:3] offset:16384
    ds_write_b128 v61, v[4:7] offset:20480
    ds_write_b128 v61, v[8:11] offset:24576
    ds_write_b128 v61, v[12:15] offset:28672
    s_waitcnt lgkmcnt(0)
    s_waitcnt vmcnt(8)
    v_add_u32 v55, 32768, v51
    v_xor_b32 v56, 32, v55
    ds_read_b64_tr_b16 v[0:1], v55 offset:0
    ds_read_b64_tr_b16 v[2:3], v55 offset:256
    ds_read_b64_tr_b16 v[4:5], v55 offset:8192
    ds_read_b64_tr_b16 v[6:7], v55 offset:8448
    s_xor_b32 s94, s13, 2
    s_mul_i32 s94, s94, 36864
    s_add_u32 s94, s94, s92
    s_lshl_b32 s74, s13, 7
    s_add_u32 s94, s94, s74
    s_add_u32 s78, s94, 512
    s_add_u32 s80, s66, 114688
    s_mov_b32 s76, 0
    s_mov_b32 s77, 8192
    s_call_b64 s[82:83], cs_dma
    ds_read_b64_tr_b16 v[8:9], v56 offset:0
    ds_read_b64_tr_b16 v[10:11], v56 offset:256
    ds_read_b64_tr_b16 v[12:13], v56 offset:8192
    ds_read_b64_tr_b16 v[14:15], v56 offset:8448
    s_mov_b32 s77, 16384
    s_call_b64 s[82:83], cs_dma
    s_waitcnt lgkmcnt(0)
    ds_write_b128 v61, v[0:3] offset:32768
    ds_write_b128 v61, v[4:7] offset:36864
    ds_write_b128 v61, v[8:11] offset:40960
    ds_write_b128 v61, v[12:15] offset:45056
    s_waitcnt lgkmcnt(0)
    v_add_u32 v55, 49152, v51
    v_xor_b32 v56, 32, v55
    ds_read_b64_tr_b16 v[0:1], v55 offset:0
    ds_read_b64_tr_b16 v[2:3], v55 offset:256
    ds_read_b64_tr_b16 v[4:5], v55 offset:8192
    ds_read_b64_tr_b16 v[6:7], v55 offset:8448
    s_add_u32 s78, s67, 4194304
    s_mov_b64 s[8:9], s[52:53]
    v_mov_b32 v58, v48
    s_mov_b32 s79, 131072
    s_add_u32 s80, s66, 81920
    s_mov_b32 s76, 0
    s_mov_b32 s77, 8192
    s_call_b64 s[82:83], cs_dma
    ds_read_b64_tr_b16 v[8:9], v56 offset:0
    ds_read_b64_tr_b16 v[10:11], v56 offset:256
    ds_read_b64_tr_b16 v[12:13], v56 offset:8192
    ds_read_b64_tr_b16 v[14:15], v56 offset:8448
    s_mov_b32 s77, 16384
    s_call_b64 s[82:83], cs_dma
    s_waitcnt lgkmcnt(0)
    ds_write_b128 v61, v[0:3] offset:49152
    ds_write_b128 v61, v[4:7] offset:53248
    ds_write_b128 v61, v[8:11] offset:57344
    ds_write_b128 v61, v[12:15] offset:61440
    s_waitcnt lgkmcnt(0)
    buffer_load_dword v24, off, s[96:99], 0 offset:216 sc1
    buffer_load_dword v25, off, s[96:99], 0 offset:64 sc1
    s_lshr_b32 s84, s12, 1
    s_lshl_b32 s84, s84, 8
    s_add_u32 s84, s84, 125829120
    v_bfe_u32 v26, v61, 4, 6
    v_min_u32 v26, 11, v26
    v_lshlrev_b32 v26, 2, v26
    buffer_load_dword v27, v26, s[4:7], s84 offen sc1
    s_waitcnt vmcnt(15)
    v_add_u32 v55, 147456, v53
    ds_read_b64_tr_b16 v[0:1], v55 offset:0
    ds_read_b64_tr_b16 v[2:3], v55 offset:128
    ds_read_b64_tr_b16 v[4:5], v55 offset:512
    ds_read_b64_tr_b16 v[6:7], v55 offset:640
    ds_read_b64_tr_b16 v[8:9], v55 offset:8192
    ds_read_b64_tr_b16 v[10:11], v55 offset:8320
    ds_read_b64_tr_b16 v[12:13], v55 offset:8704
    ds_read_b64_tr_b16 v[14:15], v55 offset:8832
    s_waitcnt lgkmcnt(0)
    s_barrier
    ds_write_b128 v63, v[0:3] offset:49152
    ds_write_b128 v63, v[4:7] offset:53248
    s_barrier
    ds_write_b128 v63, v[8:11] offset:57344
    ds_write_b128 v63, v[12:15] offset:61440
    s_waitcnt lgkmcnt(0)
    v_lshlrev_b32 v45, 3, v61
    s_lshl_b32 s40, s12, 14
    s_add_u32 s40, s40, 65536
    s_lshl_b32 s41, s12, 11
    s_sub_u32 s41, s41, 12288
    v_add_u32 v30, s40, v45
    v_add_u32 v45, s41, v45
    v_cmp_gt_u32 vcc, 1536, v61
    s_nop 1
    v_cndmask_b32 v45, v45, v30, vcc
    s_lshl_b32 s40, s12, 16
    s_add_u32 s40, s40, 24102912
    v_lshlrev_b32 v30, 3, v61
    v_add_u32 v30, s40, v30
    v_cmp_gt_u32 vcc, 1792, v61
    s_nop 1
    v_cndmask_b32 v45, v30, v45, vcc
    v_cmp_gt_u32 vcc, 2944, v61
    s_mov_b32 s40, 68157440
    s_mov_b64 exec, vcc
    buffer_load_dword v30, v45, s[4:7], s40 offen sc1
    s_mov_b64 exec, -1
    s_waitcnt vmcnt(11)
    v_add_u32 v55, 131072, v52
    ds_read_b64_tr_b16 v[0:1], v55 offset:0
    ds_read_b64_tr_b16 v[2:3], v55 offset:256
    ds_read_b64_tr_b16 v[4:5], v55 offset:4096
    ds_read_b64_tr_b16 v[6:7], v55 offset:4352
    ds_read_b64_tr_b16 v[8:9], v55 offset:64
    ds_read_b64_tr_b16 v[10:11], v55 offset:320
    ds_read_b64_tr_b16 v[12:13], v55 offset:4160
    ds_read_b64_tr_b16 v[14:15], v55 offset:4416
    s_waitcnt lgkmcnt(0)
    s_barrier
    ds_write_b128 v63, v[0:3] offset:32768
    ds_write_b128 v63, v[4:7] offset:36864
    s_barrier
    ds_write_b128 v63, v[8:11] offset:40960
    ds_write_b128 v63, v[12:15] offset:45056
    s_waitcnt lgkmcnt(0)
    s_waitcnt vmcnt(7)
    v_add_u32 v55, 114688, v52
    ds_read_b64_tr_b16 v[0:1], v55 offset:0
    ds_read_b64_tr_b16 v[2:3], v55 offset:256
    ds_read_b64_tr_b16 v[4:5], v55 offset:4096
    ds_read_b64_tr_b16 v[6:7], v55 offset:4352
    ds_read_b64_tr_b16 v[8:9], v55 offset:64
    ds_read_b64_tr_b16 v[10:11], v55 offset:320
    ds_read_b64_tr_b16 v[12:13], v55 offset:4160
    ds_read_b64_tr_b16 v[14:15], v55 offset:4416
    s_waitcnt lgkmcnt(0)
    s_barrier
    ds_write_b128 v63, v[0:3] offset:16384
    ds_write_b128 v63, v[4:7] offset:20480
    s_barrier
    ds_write_b128 v63, v[8:11] offset:24576
    ds_write_b128 v63, v[12:15] offset:28672
    s_waitcnt lgkmcnt(0)
    v_min_u32 v36, -2, v36
    v_min_u32 v37, -2, v37
    v_min_u32 v38, -2, v38
    v_min_u32 v39, -2, v39
    v_min_u32 v40, -2, v40
    v_min_u32 v41, -2, v41
    v_min_u32 v42, -2, v42
    v_min_u32 v43, -2, v43
    v_min_u32 v44, -2, v44
    s_lshl_b32 s14, s12, 16
    s_add_u32 s14, s14, 92274688
    s_add_u32 s41, s14, 4096
    s_add_u32 s42, s14, 8192
    v_lshrrev_b32 v45, 2, v61
    buffer_store_dwordx4 v[36:39], v61, s[4:7], s14 offen sc1
    buffer_store_dwordx4 v[40:43], v61, s[4:7], s41 offen sc1
    buffer_store_dword v44, v45, s[4:7], s42 offen sc1
    s_waitcnt vmcnt(1)
    v_readfirstlane_b32 s95, v25
    v_readfirstlane_b32 s85, v24
    s_add_u32 s86, s95, 2
    s_waitcnt vmcnt(0)
    v_subrev_u32 v27, s86, v27
    v_cmp_lt_u32 s[86:87], 64, v27
    s_cmp_eq_u32 s95, 0
    s_cselect_b64 s[86:87], -1, s[86:87]
    s_cmp_lg_u64 s[86:87], 0
    s_cbranch_scc1 cs_nt
    s_add_u32 s40, s24, 524288
    buffer_load_dword v30, v79, s[4:7], s24 offen sc1
    buffer_load_dword v30, v79, s[4:7], s40 offen sc1
cs_nt:
    s_waitcnt vmcnt(3)
    v_add_u32 v55, 81920, v51
    v_xor_b32 v56, 32, v55
    ds_read_b64_tr_b16 v[0:1], v55 offset:0
    ds_read_b64_tr_b16 v[2:3], v55 offset:256
    ds_read_b64_tr_b16 v[4:5], v55 offset:8192
    ds_read_b64_tr_b16 v[6:7], v55 offset:8448
    ds_read_b64_tr_b16 v[8:9], v56 offset:0
    ds_read_b64_tr_b16 v[10:11], v56 offset:256
    ds_read_b64_tr_b16 v[12:13], v56 offset:8192
    ds_read_b64_tr_b16 v[14:15], v56 offset:8448
    s_waitcnt lgkmcnt(0)
    ds_write_b128 v62, v[0:3] offset:24576
    ds_write_b128 v62, v[4:7] offset:28672
    ds_write_b128 v62, v[8:11] offset:32768
    ds_write_b128 v62, v[12:15] offset:36864
    s_waitcnt lgkmcnt(0)
    s_barrier
    s_mov_b32 s88, 4194304
gn3:
    s_cmp_lg_u32 s95, 0
    s_cbranch_scc1 gn3x
    buffer_load_dword v27, off, s[96:99], 0 offset:64 sc1
    s_sub_u32 s88, s88, 1
    s_cbranch_scc1 gn3x
    s_waitcnt vmcnt(0)
    v_readfirstlane_b32 s95, v27
    s_nop 1
    s_branch gn3
gn3x:
    ds_write_b128 v78, v[16:19] offset:8704
    ds_write_b128 v65, v[20:23] offset:10240
    v_mov_b32 v44, s95
    v_mov_b32 v45, s95
    v_mov_b32 v46, s95
    v_mov_b32 v47, s95
    v_mov_b32 v48, 108288
    ds_write_b128 v48, v[44:47]
    s_waitcnt vmcnt(0) lgkmcnt(0)
    s_cmp_eq_u32 s85, 1
    s_cbranch_scc1 cs_run
    s_mov_b32 s40, 16777216
cs_startpoll:
    buffer_load_dword v3, off, s[96:99], 0 offset:216 sc1
    s_waitcnt vmcnt(0)
    v_readfirstlane_b32 s85, v3
    s_nop 0
    s_cmp_eq_u32 s85, 1
    s_cbranch_scc1 cs_run
    s_sleep 1
    s_sub_u32 s40, s40, 1
    s_cbranch_scc0 cs_startpoll
    s_endpgm
cs_run:
    s_cmp_eq_u64 s[86:87], 0
    s_cbranch_scc1 cs_kvok
    s_lshr_b32 s92, s12, 1
    s_lshl_b32 s92, s92, 8
    s_add_u32 s92, s92, 125829120
    v_bfe_u32 v2, v61, 4, 6
    v_min_u32 v2, 11, v2
    v_lshlrev_b32 v2, 2, v2
    s_add_u32 s93, s95, 2
    s_mov_b32 s94, 4194304
cs_kv0:
    buffer_load_dword v3, v2, s[4:7], s92 offen sc1
    s_sub_u32 s94, s94, 1
    s_cbranch_scc1 cs_kv0_go
    s_waitcnt vmcnt(0)
    v_subrev_u32 v3, s93, v3
    v_cmp_lt_u32 vcc, 64, v3
    s_cbranch_vccz cs_kv0_go
    s_sleep 2
    s_branch cs_kv0
cs_kv0_go:
    s_add_u32 s40, s24, 524288
    buffer_load_dword v30, v79, s[4:7], s24 offen sc1
    buffer_load_dword v30, v79, s[4:7], s40 offen sc1
    s_waitcnt vmcnt(0)
cs_kvok:
    s_mov_b32 m0, 108032
    s_add_u32 s24, s24, 1048576
    s_mov_b32 s66, 0x201
    s_mov_b32 s67, 0xc0000000
    s_add_u32 s15, s14, 4096
    s_add_u32 s16, s14, 8192
    ds_read_b128 v[32:35], v62 offset:16384
    ds_read_b128 v[36:39], v62 offset:20480
    ds_read_b128 v[40:43], v61 offset:0
    ds_read_b128 v[44:47], v61 offset:4096
    ds_read_b128 v[48:51], v61 offset:8192
    ds_read_b128 v[52:55], v61 offset:12288
    s_add_u32 s18, s14, s31
    s_mov_b32 s29, 1048576
    buffer_load_dwordx4 v[24:27], v61, s[4:7], s14 offen sc1
.p2align 6
cs_loop:
    v_mov_b64 v[0:1], 0
    v_mov_b64 v[2:3], 0
    v_mov_b64 v[4:5], 0
    v_mov_b64 v[6:7], 0
    v_mov_b64 v[8:9], 0
    v_mov_b64 v[10:11], 0
    v_mov_b64 v[12:13], 0
    v_mov_b64 v[14:15], 0
cs_loop2:
    ds_read_b128 v[16:19], v62 offset:8192
    ds_read_b128 v[20:23], v62 offset:12288
    v_lshrrev_b32 v56, 2, v61
    v_add_u32 v58, 106496, v56
    s_mov_b32 s29, 1048576
    s_waitcnt lgkmcnt(0)
cs_chk0:
    s_waitcnt vmcnt(0)
cs_chk0b:
    v_max3_u32 v57, v24, v25, v26
    v_max_u32 v57, v57, v27
    v_cmp_eq_u32 vcc, -1, v57
    ds_write_b128 v62, v[24:27] offset:40960
    s_cbranch_vccnz cs_spin0
    v_smfmac_f32_16x16x64_bf16 v[0:3], v[24:27], v[16:23], v60
    buffer_load_dwordx4 v[28:31], v61, s[4:7], s15 offen sc1
    buffer_load_dword v59, v56, s[4:7], s16 offen sc1
    v_smfmac_f32_16x16x64_bf16 v[8:11], v[24:27], v[32:39], v60
    ds_read_b128 v[32:35], v61 offset:16384
    v_smfmac_f32_16x16x64_bf16 v[12:15], v[24:27], v[48:55], v60
    ds_read_b128 v[36:39], v61 offset:20480
    v_mfma_f32_16x16x16_bf16 v[16:19], v[72:73], v[72:73], 0
    s_waitcnt lgkmcnt(2)
    s_barrier
    ds_read_b128 v[48:51], v63 offset:0
    v_mfma_f32_16x16x16_bf16 v[20:23], v[72:73], v[72:73], 0
    ds_read_b128 v[52:55], v64 offset:0
    v_smfmac_f32_16x16x64_bf16 v[4:7], v[24:27], v[40:47], v60
    ds_read_b128 v[40:43], v61 offset:24576
    v_smfmac_f32_16x16x64_bf16 v[16:19], v[24:27], a[192:199], v60
    ds_read_b128 v[44:47], v61 offset:28672
    v_smfmac_f32_16x16x64_bf16 v[20:23], v[24:27], a[200:207], v60
    s_waitcnt lgkmcnt(3)
    v_smfmac_f32_16x16x64_bf16 v[0:3], v[48:51], a[0:7], v60
    s_add_u32 s43, s14, s31
    s_add_u32 s41, s14, 16384
    v_smfmac_f32_16x16x64_bf16 v[4:7], v[48:51], v[32:39], v60
    ds_read_b128 v[32:35], v61 offset:32768
    v_smfmac_f32_16x16x64_bf16 v[8:11], v[48:51], a[8:15], v60
    ds_read_b128 v[36:39], v61 offset:36864
    s_waitcnt lgkmcnt(2)
    v_smfmac_f32_16x16x64_bf16 v[12:15], v[48:51], v[40:47], v60
    ds_read_b128 v[40:43], v61 offset:40960
    v_smfmac_f32_16x16x64_bf16 v[0:3], v[52:55], a[16:23], v60
    ds_read_b128 v[44:47], v61 offset:45056
    v_smfmac_f32_16x16x64_bf16 v[8:11], v[52:55], a[24:31], v60
    ds_read_b128 v[48:51], v71 offset:0
    s_waitcnt lgkmcnt(3)
    v_smfmac_f32_16x16x64_bf16 v[4:7], v[52:55], v[32:39], v60
    s_waitcnt vmcnt(0)
    ds_write_b128 v62, v[28:31] offset:45056
    s_waitcnt lgkmcnt(2)
    v_smfmac_f32_16x16x64_bf16 v[12:15], v[52:55], v[40:47], v60
    ds_write_b32 v58, v59
    v_max3_u32 v57, v28, v29, v30
    s_waitcnt lgkmcnt(2)
    v_smfmac_f32_16x16x64_bf16 v[0:3], v[48:51], a[32:39], v60
    ds_read_b128 v[32:35], v61 offset:49152
    v_max3_u32 v57, v57, v31, v59
    v_smfmac_f32_16x16x64_bf16 v[8:11], v[48:51], a[40:47], v60
    ds_read_b128 v[36:39], v61 offset:53248
    v_cmp_eq_u32 vcc, -1, v57
    v_smfmac_f32_16x16x64_bf16 v[16:19], v[52:55], a[224:231], v60
    ds_read_b128 v[40:43], v61 offset:57344
    v_smfmac_f32_16x16x64_bf16 v[20:23], v[52:55], a[232:239], v60
    ds_read_b128 v[44:47], v61 offset:61440
    s_cbranch_vccnz cs_spin1
cs_go1:
    v_smfmac_f32_16x16x64_bf16 v[0:3], v[28:31], a[48:55], v60
    s_waitcnt lgkmcnt(4)
    s_barrier
    ds_read_b128 v[52:55], v63 offset:4096
    v_smfmac_f32_16x16x64_bf16 v[8:11], v[28:31], a[56:63], v60
    ds_read_b128 v[56:59], v71 offset:4096
    v_smfmac_f32_16x16x64_bf16 v[4:7], v[28:31], a[128:135], v60
    s_waitcnt lgkmcnt(2)
    v_smfmac_f32_16x16x64_bf16 v[4:7], v[48:51], v[32:39], v60
    buffer_load_dwordx4 v[32:35], v61, s[4:7], s23 offen offset:0 sc1
    v_smfmac_f32_16x16x64_bf16 v[12:15], v[48:51], v[40:47], v60
    ds_read_b128 v[48:51], v64 offset:4096
    v_smfmac_f32_16x16x64_bf16 v[12:15], v[28:31], a[136:143], v60
    ds_read_b128 v[24:27], v65 offset:8192
    s_and_b32 s41, s41, 65535
    s_add_u32 s41, s41, 68157440
    v_smfmac_f32_16x16x64_bf16 v[16:19], v[28:31], v[80:87], v60
    buffer_load_dwordx4 v[36:39], v61, s[4:7], s23 offen offset:1024 sc1
    v_smfmac_f32_16x16x64_bf16 v[20:23], v[28:31], v[88:95], v60
    s_add_u32 s17, s41, s31
    s_and_b32 s30, s28, 1
    s_waitcnt lgkmcnt(3)
    v_smfmac_f32_16x16x64_bf16 v[0:3], v[52:55], a[64:71], v60
    ds_read_b128 v[28:31], v78 offset:8704
    v_smfmac_f32_16x16x64_bf16 v[4:7], v[52:55], a[144:151], v60
    buffer_load_dwordx4 v[40:43], v61, s[4:7], s23 offen offset:2048 sc1
    v_smfmac_f32_16x16x64_bf16 v[8:11], v[52:55], a[72:79], v60
    v_smfmac_f32_16x16x64_bf16 v[12:15], v[52:55], a[152:159], v60
    v_smfmac_f32_16x16x64_bf16 v[16:19], v[52:55], v[96:103], v60
    buffer_load_dwordx4 v[44:47], v61, s[4:7], s23 offen offset:3072 sc1
    v_smfmac_f32_16x16x64_bf16 v[20:23], v[52:55], v[104:111], v60
    ds_read_b128 v[52:55], v62 offset:28672
    s_waitcnt lgkmcnt(3)
    v_smfmac_f32_16x16x64_bf16 v[0:3], v[48:51], a[80:87], v60
    v_smfmac_f32_16x16x64_bf16 v[4:7], v[48:51], a[160:167], v60
    v_smfmac_f32_16x16x64_bf16 v[8:11], v[48:51], a[88:95], v60
    v_smfmac_f32_16x16x64_bf16 v[12:15], v[48:51], a[168:175], v60
    v_smfmac_f32_16x16x64_bf16 v[16:19], v[48:51], v[112:119], v60
    buffer_load_dword v79, s[4:7], s24 offen sc1 lds
    v_smfmac_f32_16x16x64_bf16 v[20:23], v[48:51], v[120:127], v60
    ds_read_b128 v[48:51], v62 offset:24576
    v_smfmac_f32_16x16x64_bf16 v[0:3], v[56:59], a[96:103], v60
    s_bitcmp1_b64 s[66:67], s28
    v_smfmac_f32_16x16x64_bf16 v[8:11], v[56:59], a[104:111], v60
    s_waitcnt lgkmcnt(3)
    v_smfmac_f32_16x16x64_bf16 v[0:3], v[24:27], a[112:119], v60
    v_smfmac_f32_16x16x64_bf16 v[8:11], v[24:27], a[120:127], v60
    v_smfmac_f32_16x16x64_bf16 v[4:7], v[56:59], a[176:183], v60
    s_waitcnt lgkmcnt(0)
    v_cvt_pk_bf16_f32 v0, v0, v1
    v_smfmac_f32_16x16x64_bf16 v[4:7], v[24:27], v[48:55], v60
    ds_read_b128 v[48:51], v62 offset:32768
    v_cvt_pk_bf16_f32 v8, v8, v9
    v_smfmac_f32_16x16x64_bf16 v[12:15], v[56:59], a[184:191], v60
    ds_read_b128 v[52:55], v62 offset:36864
    v_cvt_pk_bf16_f32 v9, v10, v11
    v_smfmac_f32_16x16x64_bf16 v[16:19], v[56:59], v[128:135], v60
    v_cvt_pk_bf16_f32 v1, v2, v3
    v_mfma_f32_16x16x16_bf16 v[8:11], v[8:9], v[28:29], 0
    v_cvt_pk_bf16_f32 v2, v4, v5
    v_cvt_pk_bf16_f32 v3, v6, v7
    v_smfmac_f32_16x16x64_bf16 v[20:23], v[56:59], v[136:143], v60
    s_mov_b64 exec, s[36:37]
    ds_read_b128 v[56:59], v69
    s_mov_b64 exec, -1
    v_mfma_f32_16x16x32_bf16 v[4:7], v[0:3], v[28:31], 0
    v_cvt_pk_bf16_f32 v2, v8, v9
    s_waitcnt lgkmcnt(1)
    v_smfmac_f32_16x16x64_bf16 v[12:15], v[24:27], v[48:55], v60
    ds_read_b128 v[48:51], v63 offset:0
    v_cvt_pk_bf16_f32 v3, v10, v11
    s_waitcnt vmcnt(3)
    v_cvt_pk_bf16_f32 v0, v4, v5
    v_cvt_pk_bf16_f32 v1, v6, v7
    s_nop 1
    v_mfma_f32_16x16x32_bf16 v[4:7], v[36:39], v[0:3], 0
    v_cvt_pk_bf16_f32 v12, v12, v13
    v_cvt_pk_bf16_f32 v13, v14, v15
    s_nop 1
    v_mfma_f32_16x16x16_bf16 v[12:15], v[12:13], v[30:31], 0
    ds_read_b128 v[52:55], v71 offset:0
    ds_read_b128 v[36:39], v63 offset:53248
    v_mfma_f32_16x16x32_bf16 v[28:31], v[32:35], v[0:3], 0
    s_waitcnt vmcnt(1)
    ds_read_b128 v[32:35], v63 offset:49152
    s_mov_b64 exec, s[34:35]
    s_nop 0
    v_cvt_pk_bf16_f32 v2, v12, v13
    v_cvt_pk_bf16_f32 v3, v14, v15
    s_mov_b64 exec, -1
    s_nop 0
    v_mfma_f32_16x16x32_bf16 v[8:11], v[0:3], v[0:3], 0
    v_mov_b32_dpp v28, v4 row_ror:8 row_mask:0xf bank_mask:0xc
    v_mov_b32_dpp v29, v5 row_ror:8 row_mask:0xf bank_mask:0xc
    v_mov_b32_dpp v30, v6 row_ror:8 row_mask:0xf bank_mask:0xc
    v_mov_b32_dpp v31, v7 row_ror:8 row_mask:0xf bank_mask:0xc
    v_smfmac_f32_16x16x64_bf16 v[16:19], v[24:27], v[144:151], v60
    ds_write_b128 v62, v[28:31] offset:53248
    v_mov_b32_dpp v8, v10 row_ror:8 row_mask:0xf bank_mask:0xc
    v_mov_b32_dpp v9, v11 row_ror:8 row_mask:0xf bank_mask:0xc
    v_smfmac_f32_16x16x64_bf16 v[20:23], v[24:27], v[152:159], v60
    ds_write_b64 v70, v[8:9]
    s_waitcnt lgkmcnt(5)
    v_smfmac_f32_16x16x64_bf16 v[16:19], v[48:51], a[208:215], v60
    s_mov_b64 exec, s[36:37]
    s_cbranch_execz cs_np3683
    buffer_store_dwordx4 v[56:59], v61, s[4:7], s65 offen sc1
cs_np3683:
    s_mov_b64 exec, -1
    v_smfmac_f32_16x16x64_bf16 v[20:23], v[48:51], a[216:223], v60
    s_cbranch_scc1 cs_last
cs_back:
    s_waitcnt lgkmcnt(0)
    s_barrier
    ds_read_b128 v[56:59], v78 offset:10752
    v_smfmac_f32_16x16x64_bf16 v[16:19], v[52:55], a[240:247], v60
    ds_read_b128 v[12:15], v78 offset:11264
    ds_read_b128 v[4:7], v63 offset:12288
    v_smfmac_f32_16x16x64_bf16 v[20:23], v[52:55], a[248:255], v60
    ds_read_b128 v[8:11], v64 offset:12288
    ds_read_b128 v[0:3], v71 offset:12288
    v_mov_b64 v[24:25], s[62:63]
    v_mov_b64 v[26:27], s[60:61]
    v_cvt_pk_bf16_f32 v16, v16, v17
    v_cvt_pk_bf16_f32 v17, v18, v19
    v_pk_mul_f32 v[28:29], v[28:29], s[44:45]
    v_pk_mul_f32 v[30:31], v[30:31], s[44:45]
    s_waitcnt lgkmcnt(3)
    v_pk_add_f32 v[56:57], v[56:57], v[58:59]
    v_pk_add_f32 v[12:13], v[12:13], v[14:15]
    v_pk_add_f32 v[56:57], v[56:57], v[12:13]
    v_pk_mul_f32 v[56:57], v[56:57], s[44:45]
    v_exp_f32 v58, v56
    v_exp_f32 v59, v57
    s_waitcnt lgkmcnt(1)
    v_pk_fma_f32 v[28:29], v[4:5], s[44:45], v[28:29]
    v_pk_fma_f32 v[30:31], v[6:7], s[44:45], v[30:31]
    v_cvt_pk_bf16_f32 v6, v58, v59
    v_pk_fma_f32 v[28:29], v[8:9], s[44:45], v[28:29]
    v_pk_fma_f32 v[30:31], v[10:11], s[44:45], v[30:31]
    s_waitcnt lgkmcnt(0)
    v_pk_fma_f32 v[28:29], v[0:1], s[44:45], v[28:29]
    v_mov_b32_dpp v7, v6 row_ror:8 row_mask:0xf bank_mask:0xf
    v_pk_fma_f32 v[30:31], v[2:3], s[44:45], v[30:31]
    v_exp_f32 v0, v28
    v_mfma_f32_16x16x16_bf16 v[12:15], v[16:17], v[6:7], 0
    ds_read_b128 v[48:51], v63 offset:57344
    v_exp_f32 v1, v29
    v_cvt_pk_bf16_f32 v18, v20, v21
    v_exp_f32 v2, v30
    v_cvt_pk_bf16_f32 v19, v22, v23
    v_cvt_pk_bf16_f32 v8, v0, v1
    v_exp_f32 v3, v31
    v_mfma_f32_16x16x16_bf16 v[20:23], v[18:19], v[6:7], 0
    ds_read_b128 v[52:55], v63 offset:61440
    v_cvt_pk_bf16_f32 v9, v2, v3
    v_mov_b32_dpp v10, v8 row_ror:8 row_mask:0xf bank_mask:0xf
    v_max3_f32 v4, |v28|, |v29|, |v30|
    v_mov_b32_dpp v11, v9 row_ror:8 row_mask:0xf bank_mask:0xf
    v_mfma_f32_16x16x32_bf16 v[0:3], v[24:27], v[6:9], 0
    v_max3_f32 v4, v4, |v31|, |v56|
    v_max_f32_e64 v4, v4, |v57|
    v_mfma_f32_16x16x32_bf16 v[12:15], v[40:43], v[8:11], v[12:15]
    v_cmp_nge_f32 vcc, s46, v4
    v_mfma_f32_16x16x32_bf16 v[20:23], v[44:47], v[8:11], v[20:23]
    v_add_f32_dpp v0, v0, v0 row_ror:8 row_mask:0xf bank_mask:0xf
    v_rcp_f32 v0, v0
    s_cbranch_vccnz cs_guard
cs_norm:
    v_mfma_f32_16x16x16_bf16 v[28:31], v[72:73], v[72:73], 0
    v_mul_f32 v12, v12, v0
    v_mul_f32 v13, v13, v0
    v_mul_f32 v14, v14, v0
    v_mul_f32 v15, v15, v0
    v_mul_f32_dpp v12, v20, v0 row_ror:8 row_mask:0xf bank_mask:0xc
    v_mul_f32_dpp v13, v21, v0 row_ror:8 row_mask:0xf bank_mask:0xc
    v_mul_f32_dpp v14, v22, v0 row_ror:8 row_mask:0xf bank_mask:0xc
    v_mul_f32_dpp v15, v23, v0 row_ror:8 row_mask:0xf bank_mask:0xc
    v_cvt_pk_bf16_f32 v12, v12, v13
    v_cvt_pk_bf16_f32 v13, v14, v15
    v_mfma_f32_16x16x16_bf16 v[8:11], v[72:73], v[72:73], 0
    ds_write_b64 v77, v[12:13]
    v_mfma_f32_16x16x16_bf16 v[4:7], v[72:73], v[72:73], 0
    ds_read_b128 v[0:3], v68
    v_mfma_f32_16x16x16_bf16 v[16:19], v[72:73], v[72:73], 0
    ds_read_b128 v[40:43], v63 offset:16384
    v_mfma_f32_16x16x16_bf16 v[20:23], v[72:73], v[72:73], 0
    ds_read_b128 v[44:47], v63 offset:20480
    s_waitcnt lgkmcnt(3)
    s_barrier
    ds_read_b128 v[24:27], v74
    ds_read_b128 v[12:15], v75
    ds_read_b128 v[56:59], v76
    s_waitcnt lgkmcnt(5)
    v_smfmac_f32_16x16x64_bf16 v[28:31], v[0:3], v[160:167], v60
    v_smfmac_f32_16x16x64_bf16 v[8:11], v[0:3], v[192:199], v60
    v_smfmac_f32_16x16x64_bf16 v[4:7], v[0:3], v[32:39], v60
    ds_read_b128 v[32:35], v63 offset:32768
    v_smfmac_f32_16x16x64_bf16 v[16:19], v[0:3], v[224:231], v60
    ds_read_b128 v[36:39], v63 offset:36864
    s_waitcnt lgkmcnt(3)
    v_smfmac_f32_16x16x64_bf16 v[28:31], v[24:27], v[168:175], v60
    v_smfmac_f32_16x16x64_bf16 v[4:7], v[12:15], v[48:55], v60
    ds_read_b128 v[48:51], v63 offset:24576
    v_smfmac_f32_16x16x64_bf16 v[28:31], v[12:15], v[176:183], v60
    ds_read_b128 v[52:55], v63 offset:28672
    s_waitcnt lgkmcnt(4)
    v_smfmac_f32_16x16x64_bf16 v[28:31], v[56:59], v[184:191], v60
    v_cvt_pk_bf16_f32 v4, v4, v5
    v_smfmac_f32_16x16x64_bf16 v[16:19], v[12:15], v[40:47], v60
    ds_read_b128 v[40:43], v63 offset:40960
    v_and_or_b32 v4, v4, -2, s30
    v_smfmac_f32_16x16x64_bf16 v[8:11], v[24:27], v[200:207], v60
    ds_read_b128 v[44:47], v63 offset:45056
    v_cvt_pk_bf16_f32 v5, v6, v7
    v_smfmac_f32_16x16x64_bf16 v[8:11], v[12:15], v[208:215], v60
    buffer_store_dwordx2 v[4:5], v67, s[4:7], s22 offen sc1
    v_cvt_pk_bf16_f32 v28, v28, v29
    v_smfmac_f32_16x16x64_bf16 v[8:11], v[56:59], v[216:223], v60
    v_and_or_b32 v28, v28, -2, s30
    v_smfmac_f32_16x16x64_bf16 v[16:19], v[24:27], v[232:239], v60
    v_cvt_pk_bf16_f32 v29, v30, v31
    s_waitcnt lgkmcnt(4)
    v_smfmac_f32_16x16x64_bf16 v[16:19], v[56:59], v[32:39], v60
    buffer_store_dwordx2 v[28:29], v66, s[4:7], s20 offen sc1
    v_cvt_pk_bf16_f32 v8, v8, v9
    s_waitcnt lgkmcnt(0)
    v_smfmac_f32_16x16x64_bf16 v[20:23], v[0:3], v[240:247], v60
    v_and_or_b32 v8, v8, -2, s30
    v_smfmac_f32_16x16x64_bf16 v[20:23], v[24:27], v[248:255], v60
    v_cvt_pk_bf16_f32 v9, v10, v11
    v_smfmac_f32_16x16x64_bf16 v[20:23], v[12:15], v[48:55], v60
    buffer_store_dwordx2 v[8:9], v66, s[4:7], s21 offen sc1
    v_cvt_pk_bf16_f32 v16, v16, v17
    v_smfmac_f32_16x16x64_bf16 v[20:23], v[56:59], v[40:47], v60
    v_and_or_b32 v16, v16, -2, s30
    v_cvt_pk_bf16_f32 v17, v18, v19
    buffer_store_dwordx2 v[16:17], v66, s[4:7], s38 offen sc1
    s_cmp_lg_u32 s13, 2
    s_nop 1
    v_cvt_pk_bf16_f32 v20, v20, v21
    v_and_or_b32 v20, v20, -2, s30
    v_cvt_pk_bf16_f32 v21, v22, v23
    buffer_store_dwordx2 v[20:21], v66, s[4:7], s39 offen sc1
    s_cbranch_scc1 cs_w013
    v_mov_b32 v21, -1
    s_mov_b64 exec, s[32:33]
    buffer_store_dword v21, v69, s[4:7], s18 offen sc1
    s_mov_b64 exec, -1
    s_mov_b32 s18, s43
    s_nop 15
    s_nop 15
    s_nop 15
    s_nop 15
    s_nop 15
    s_nop 15
    s_nop 15
    s_nop 15
    s_nop 15
    s_nop 15
    s_nop 15
    s_nop 15
    s_nop 0
    buffer_load_dwordx4 v[40:43], v65, s[4:7], s19 offen offset:0 sc1
    buffer_load_dwordx4 v[44:47], v65, s[4:7], s19 offen offset:1024 sc1
    buffer_load_dwordx4 v[48:51], v65, s[4:7], s19 offen offset:2048 sc1
    buffer_load_dwordx4 v[52:55], v65, s[4:7], s19 offen offset:3072 sc1
    ds_read_b128 v[56:59], v65 offset:10240
    s_add_u32 s28, s28, 1
    s_mov_b32 s14, s41
    s_add_u32 s23, s23, 524288
    s_add_u32 s24, s24, 524288
    s_min_u32 s24, s24, s47
    s_add_u32 s15, s14, 4096
    s_add_u32 s16, s14, 8192
    s_add_u32 s65, s65, 12288
    s_mov_b32 s40, 1
    v_mov_b64 v[0:1], 0
    v_mov_b64 v[2:3], 0
    v_mov_b64 v[4:5], 0
    v_mov_b64 v[6:7], 0
    v_mov_b64 v[8:9], 0
    v_mov_b64 v[10:11], 0
    v_mov_b64 v[12:13], 0
    v_mov_b64 v[14:15], 0
cs_chkF:
    v_mov_b32 v20, 0
    s_waitcnt vmcnt(3)
    s_waitcnt lgkmcnt(0)
    v_mfma_f32_16x16x32_bf16 v[28:31], v[40:43], v[56:59], 0
    v_bitop3_b32 v20, v20, v40, s30 bitop3:0xf6
    v_bitop3_b32 v20, v20, v42, s30 bitop3:0xf6
    s_waitcnt vmcnt(2)
    v_mfma_f32_16x16x32_bf16 v[28:31], v[44:47], v[56:59], v[28:31]
    v_bitop3_b32 v20, v20, v44, s30 bitop3:0xf6
    v_bitop3_b32 v20, v20, v46, s30 bitop3:0xf6
    s_waitcnt vmcnt(1)
    v_mfma_f32_16x16x32_bf16 v[28:31], v[48:51], v[56:59], v[28:31]
    v_bitop3_b32 v20, v20, v48, s30 bitop3:0xf6
    v_bitop3_b32 v20, v20, v50, s30 bitop3:0xf6
    s_waitcnt vmcnt(0)
    v_mfma_f32_16x16x32_bf16 v[28:31], v[52:55], v[56:59], v[28:31]
    v_bitop3_b32 v20, v20, v52, s30 bitop3:0xf6
    v_bitop3_b32 v20, v20, v54, s30 bitop3:0xf6
    v_and_b32 v20, s40, v20
    v_cmp_ne_u32 vcc, 0, v20
    s_cbranch_vccnz cs_spinF
    v_permlane32_swap_b32 v28, v30
    v_permlane32_swap_b32 v29, v31
    v_add_f32 v28, v28, v30
    v_add_f32 v30, v29, v31
    v_cvt_pk_bf16_f32 v28, v28, v30
    s_mov_b64 exec, s[32:33]
    buffer_store_dword v28, v69, s[4:7], s17 offen sc1
    s_mov_b64 exec, -1
    ds_read_b128 v[32:35], v62 offset:16384
    ds_read_b128 v[36:39], v62 offset:20480
    ds_read_b128 v[40:43], v61 offset:0
    ds_read_b128 v[44:47], v61 offset:4096
    ds_read_b128 v[48:51], v61 offset:8192
    ds_read_b128 v[52:55], v61 offset:12288
    s_nop 15
    s_nop 15
    s_nop 15
    s_nop 15
    s_nop 15
    s_nop 15
    s_nop 3
    buffer_load_dwordx4 v[24:27], v61, s[4:7], s14 offen sc1
    s_branch cs_loop2
cs_w013:
    ds_read_b128 v[56:59], v65 offset:10240
    ds_read_b128 v[32:35], v62 offset:16384
    ds_read_b128 v[36:39], v62 offset:20480
    ds_read_b128 v[40:43], v61 offset:0
    ds_read_b128 v[44:47], v61 offset:4096
    ds_read_b128 v[48:51], v61 offset:8192
    ds_read_b128 v[52:55], v61 offset:12288
    s_add_u32 s28, s28, 1
    s_mov_b32 s14, s41
    s_add_u32 s23, s23, 524288
    s_add_u32 s24, s24, 524288
    s_min_u32 s24, s24, s47
    s_add_u32 s15, s14, 4096
    s_add_u32 s16, s14, 8192
    s_add_u32 s65, s65, 12288
    s_mov_b32 s40, 1
    s_cmp_eq_u32 s64, 0
    s_cbranch_scc1 cs_w0
    v_mov_b32 v21, -1
    s_mov_b64 exec, s[32:33]
    buffer_store_dword v21, v69, s[4:7], s18 offen sc1
    s_mov_b64 exec, -1
    s_mov_b32 s18, s43
    s_cmp_eq_u32 s13, 1
    s_cbranch_scc1 cs_sx
    s_nop 15
    s_nop 15
    s_nop 15
    s_nop 15
    s_nop 15
    s_nop 15
    s_nop 15
    s_nop 15
    s_nop 15
    s_nop 15
    s_nop 15
    s_nop 15
    s_nop 7
cs_sx:
    buffer_load_dwordx4 v[0:3], v65, s[4:7], s19 offen offset:0 sc1
    buffer_load_dwordx4 v[4:7], v65, s[4:7], s19 offen offset:1024 sc1
    buffer_load_dwordx4 v[8:11], v65, s[4:7], s19 offen offset:2048 sc1
    buffer_load_dwordx4 v[12:15], v65, s[4:7], s19 offen offset:3072 sc1
cs_chkG:
    v_mov_b32 v20, 0
    s_waitcnt vmcnt(3)
    s_waitcnt lgkmcnt(6)
    v_mfma_f32_16x16x32_bf16 v[28:31], v[0:3], v[56:59], 0
    v_bitop3_b32 v20, v20, v0, s30 bitop3:0xf6
    v_bitop3_b32 v20, v20, v2, s30 bitop3:0xf6
    s_waitcnt vmcnt(2)
    v_mfma_f32_16x16x32_bf16 v[28:31], v[4:7], v[56:59], v[28:31]
    v_bitop3_b32 v20, v20, v4, s30 bitop3:0xf6
    v_bitop3_b32 v20, v20, v6, s30 bitop3:0xf6
    s_waitcnt vmcnt(1)
    v_mfma_f32_16x16x32_bf16 v[28:31], v[8:11], v[56:59], v[28:31]
    v_bitop3_b32 v20, v20, v8, s30 bitop3:0xf6
    v_bitop3_b32 v20, v20, v10, s30 bitop3:0xf6
    s_waitcnt vmcnt(0)
    v_mfma_f32_16x16x32_bf16 v[28:31], v[12:15], v[56:59], v[28:31]
    v_bitop3_b32 v20, v20, v12, s30 bitop3:0xf6
    v_bitop3_b32 v20, v20, v14, s30 bitop3:0xf6
    v_and_b32 v20, s40, v20
    v_cmp_ne_u32 vcc, 0, v20
    s_cbranch_vccnz cs_spinG
    v_permlane32_swap_b32 v28, v30
    v_permlane32_swap_b32 v29, v31
    v_add_f32 v28, v28, v30
    v_add_f32 v30, v29, v31
    s_cmp_eq_u32 s13, 3
    s_cbranch_scc1 cs_w3
    v_mov_b32 v29, v28
    v_mov_b32 v31, v30
    s_nop 0
    v_permlane16_swap_b32 v28, v29
    v_permlane16_swap_b32 v30, v31
    v_add_f32 v28, v28, v29
    v_add_f32 v30, v30, v31
cs_w3:
    v_cvt_pk_bf16_f32 v28, v28, v30
    s_mov_b64 exec, s[32:33]
    buffer_store_dword v28, v69, s[4:7], s17 offen sc1
    s_mov_b64 exec, -1
    buffer_load_dwordx4 v[24:27], v61, s[4:7], s14 offen sc1
    s_branch cs_loop
cs_w0:
    v_mov_b64 v[0:1], 0
    v_mov_b64 v[2:3], 0
    v_mov_b64 v[4:5], 0
    v_mov_b64 v[6:7], 0
    v_mov_b64 v[8:9], 0
    v_mov_b64 v[10:11], 0
    v_mov_b64 v[12:13], 0
    v_mov_b64 v[14:15], 0
    s_nop 15
    s_nop 15
    s_nop 15
    s_nop 15
    s_nop 15
    s_nop 15
    s_nop 15
    s_nop 15
    s_nop 4
    s_cmp_lg_u32 s28, 10
    s_cbranch_scc1 cs_nokv
    s_lshr_b32 s92, s12, 1
    s_lshl_b32 s92, s92, 8
    s_add_u32 s92, s92, 125829120
    v_bfe_u32 v28, v61, 4, 6
    v_min_u32 v28, 11, v28
    v_lshlrev_b32 v28, 2, v28
    v_add_u32 v28, 108304, v28
    s_waitcnt vmcnt(0)
    ds_read_b32 v29, v28
    s_add_u32 s93, s95, 63
    s_waitcnt lgkmcnt(0)
    v_cmp_ne_u32 vcc, s93, v29
    s_cbranch_vccz cs_kv1_go
    s_lshr_b32 s92, s12, 1
    s_lshl_b32 s92, s92, 8
    s_add_u32 s92, s92, 125833216
    v_bfe_u32 v28, v61, 4, 6
    v_min_u32 v28, 11, v28
    v_lshlrev_b32 v28, 2, v28
    s_add_u32 s93, s95, 63
    s_mov_b32 s94, 4194304
cs_kv1:
    buffer_load_dword v29, v28, s[4:7], s92 offen sc1
    s_sub_u32 s94, s94, 1
    s_cbranch_scc1 cs_kv1_go
    s_waitcnt vmcnt(0)
    v_subrev_u32 v29, s93, v29
    v_cmp_lt_u32 vcc, 64, v29
    s_cbranch_vccz cs_kv1_go
    s_sleep 2
    s_branch cs_kv1
cs_kv1_go:
    s_branch cs_w0p
cs_nokv:
    s_nop 15
    s_nop 15
    s_nop 15
    s_nop 15
    s_nop 15
    s_nop 15
    s_nop 15
    s_nop 15
    s_nop 15
    s_nop 15
    s_nop 15
    s_nop 15
    s_nop 15
    s_nop 15
    s_nop 15
    s_nop 15
    s_nop 10
cs_w0p:
    buffer_load_dwordx4 v[24:27], v61, s[4:7], s14 offen sc1
    s_branch cs_loop2
cs_spinF:
    buffer_load_dwordx4 v[40:43], v65, s[4:7], s19 offen offset:0 sc1
    buffer_load_dwordx4 v[44:47], v65, s[4:7], s19 offen offset:1024 sc1
    buffer_load_dwordx4 v[48:51], v65, s[4:7], s19 offen offset:2048 sc1
    buffer_load_dwordx4 v[52:55], v65, s[4:7], s19 offen offset:3072 sc1
    s_sub_u32 s29, s29, 1
    s_cmp_lt_i32 s29, 0
    s_cselect_b32 s40, 0, 1
    s_branch cs_chkF
cs_spinG:
    buffer_load_dwordx4 v[0:3], v65, s[4:7], s19 offen offset:0 sc1
    buffer_load_dwordx4 v[4:7], v65, s[4:7], s19 offen offset:1024 sc1
    buffer_load_dwordx4 v[8:11], v65, s[4:7], s19 offen offset:2048 sc1
    buffer_load_dwordx4 v[12:15], v65, s[4:7], s19 offen offset:3072 sc1
    s_sub_u32 s29, s29, 1
    s_cmp_lt_i32 s29, 0
    s_cselect_b32 s40, 0, 1
    s_branch cs_chkG
cs_guard:
    s_cbranch_scc0 cs_guard2
    buffer_store_dwordx4 v[16:19], v61, s[4:7], s26 offen sc1
    s_add_u32 s26, s26, 131072
    s_add_u32 s40, s95, 63
    v_mov_b32 v5, s40
    s_mov_b64 exec, 1
    buffer_store_dword v5, off, s[4:7], s27 sc1
    s_mov_b64 exec, -1
cs_guard2:
    s_nop 7
    v_max3_f32 v6, v28, v29, v30
    v_max3_f32 v7, v31, v56, v57
    v_max_f32 v6, v6, v7
    s_nop 1
    v_max_f32_dpp v6, v6, v6 row_ror:8 row_mask:0xf bank_mask:0xf
    v_mov_b32 v7, v6
    s_nop 1
    v_permlane32_swap_b32 v6, v7
    v_max_f32 v6, v6, v7
    v_mov_b32 v7, v6
    s_nop 1
    v_permlane16_swap_b32 v6, v7
    v_max_f32 v6, v6, v7
    v_sub_f32 v28, v28, v6
    v_sub_f32 v29, v29, v6
    v_sub_f32 v30, v30, v6
    v_sub_f32 v31, v31, v6
    v_sub_f32 v56, v56, v6
    v_sub_f32 v57, v57, v6
    v_exp_f32 v58, v56
    v_exp_f32 v59, v57
    s_nop 0
    v_cvt_pk_bf16_f32 v6, v58, v59
    s_nop 1
    v_mov_b32_dpp v7, v6 row_ror:8 row_mask:0xf bank_mask:0xf
    v_exp_f32 v0, v28
    s_nop 0
    v_mfma_f32_16x16x16_bf16 v[12:15], v[16:17], v[6:7], 0
    v_exp_f32 v1, v29
    v_exp_f32 v2, v30
    v_cvt_pk_bf16_f32 v8, v0, v1
    v_exp_f32 v3, v31
    v_mfma_f32_16x16x16_bf16 v[20:23], v[18:19], v[6:7], 0
    v_cvt_pk_bf16_f32 v9, v2, v3
    v_mov_b32_dpp v10, v8 row_ror:8 row_mask:0xf bank_mask:0xf
    v_max3_f32 v4, |v28|, |v29|, |v30|
    v_mov_b32_dpp v11, v9 row_ror:8 row_mask:0xf bank_mask:0xf
    v_mfma_f32_16x16x32_bf16 v[0:3], v[24:27], v[6:9], 0
    v_max3_f32 v4, v4, |v31|, |v56|
    v_max_f32_e64 v4, v4, |v57|
    v_mfma_f32_16x16x32_bf16 v[12:15], v[40:43], v[8:11], v[12:15]
    v_cmp_nge_f32 vcc, s46, v4
    v_mfma_f32_16x16x32_bf16 v[20:23], v[44:47], v[8:11], v[20:23]
    v_add_f32_dpp v0, v0, v0 row_ror:8 row_mask:0xf bank_mask:0xf
    v_rcp_f32 v0, v0
    s_nop 4
    s_branch cs_norm
cs_spin0:
    buffer_load_dwordx4 v[24:27], v61, s[4:7], s14 offen sc1
    s_sub_u32 s29, s29, 1
    s_cmp_lt_i32 s29, 0
    s_cbranch_scc0 cs_chk0
    s_waitcnt vmcnt(0)
    v_min_u32 v24, -2, v24
    v_min_u32 v25, -2, v25
    v_min_u32 v26, -2, v26
    v_min_u32 v27, -2, v27
    s_branch cs_chk0
cs_spin1:
    buffer_load_dwordx4 v[28:31], v61, s[4:7], s15 offen sc1
    buffer_load_dword v59, v56, s[4:7], s16 offen sc1
    s_sub_u32 s29, s29, 1
    s_cmp_lt_i32 s29, 0
    s_waitcnt vmcnt(0)
    v_max3_u32 v57, v28, v29, v30
    v_max3_u32 v57, v57, v31, v59
    v_cmp_eq_u32 vcc, -1, v57
    ds_write_b128 v62, v[28:31] offset:45056
    ds_write_b32 v58, v59
    s_waitcnt lgkmcnt(0)
    s_cbranch_scc1 cs_go1
    s_cbranch_vccnz cs_spin1
    s_branch cs_go1
cs_last:
    s_nop 1
    s_cmp_ge_u32 s28, 2
    s_cbranch_scc1 cs_last0
    s_and_b32 s40, s12, 3
    s_lshl_b32 s40, s40, 14
    s_add_u32 s40, s40, 68157440
    s_lshr_b32 s42, s12, 2
    s_lshl_b32 s42, s42, 3
    s_lshl_b64 exec, 0x55, s42
    buffer_load_dword v79, s[4:7], s40 offen sc1 lds
    s_mov_b64 exec, -1
    s_cmp_eq_u32 0, 1
    s_branch cs_back
cs_last0:
    s_cmp_lg_u32 s28, 9
    s_cbranch_scc1 cs_last1
    s_lshr_b32 s92, s12, 1
    s_lshl_b32 s92, s92, 8
    s_add_u32 s92, s92, 125833216
    v_bfe_u32 v48, v61, 4, 6
    v_min_u32 v48, 11, v48
    v_lshlrev_b32 v48, 2, v48
    s_mov_b32 m0, 108304
    s_mov_b64 exec, 0xfff
    buffer_load_dword v48, s[4:7], s92 offen sc1 lds
    s_mov_b64 exec, -1
    s_mov_b32 m0, 108032
    s_cmp_eq_u32 0, 1
    s_branch cs_back
cs_last1:
    s_cmp_eq_u32 s28, 63
    s_cbranch_scc1 cs_last2
    s_mov_b64 exec, s[34:35]
    buffer_store_dwordx4 v[0:3], v61, s[4:7], s25 offen sc1
    s_mov_b64 exec, -1
    s_add_u32 s25, s25, 131072
    s_mov_b32 s46, 0xbf800000
    s_cmp_eq_u32 0, 0
    s_branch cs_back
cs_last2:
    s_waitcnt lgkmcnt(0)
    s_mov_b64 exec, s[34:35]
    buffer_store_dwordx4 v[0:3], v61, s[4:7], s25 offen sc1
    s_mov_b64 exec, -1
    s_add_u32 s40, s95, 64
    v_mov_b32 v40, s40
    v_smfmac_f32_16x16x64_bf16 v[16:19], v[52:55], a[240:247], v60
    v_smfmac_f32_16x16x64_bf16 v[20:23], v[52:55], a[248:255], v60
    s_nop 3
    v_cvt_pk_bf16_f32 v16, v16, v17
    v_cvt_pk_bf16_f32 v17, v18, v19
    s_nop 1
    v_cvt_pk_bf16_f32 v18, v20, v21
    v_cvt_pk_bf16_f32 v19, v22, v23
    buffer_store_dwordx4 v[16:19], v61, s[4:7], s26 offen sc1
    s_mov_b64 exec, 1
    buffer_store_dword v40, off, s[4:7], s27 sc1
    s_mov_b64 exec, -1
    s_endpgm
cs_dma:
    s_xor_b32 s74, s76, s81
    s_add_u32 m0, s74, s80
    s_add_u32 s76, s76, 4096
    buffer_load_dwordx4 v58, s[8:11], s78 offen lds
    s_add_u32 s78, s78, s79
    s_cmp_lt_u32 s76, s77
    s_cbranch_scc1 cs_dma
    s_setpc_b64 s[82:83]
L_helper:
    s_load_dwordx16 s[64:79], s[0:1], 64
    s_sub_u32 s33, s3, 4
    s_and_b32 s33, s33, 7
L_pool:
    s_lshl_b32 s35, s33, 2
    s_add_u32 s35, s35, 32
    s_mov_b32 s37, s35
    v_mov_b32 v250, 1
    v_mov_b32 v251, 163832
    v_cmp_eq_u32 vcc, 0, v0
    s_nop 0
    s_and_saveexec_b64 s[38:39], vcc
    s_cbranch_execz tk4
    buffer_atomic_add v250, off, s[96:99], s37 sc0
    s_waitcnt vmcnt(0)
    ds_write_b32 v251, v250
    s_waitcnt lgkmcnt(0)
tk4:
    s_mov_b64 exec, -1
    s_barrier
    ds_read_b32 v252, v251
    s_waitcnt lgkmcnt(0)
    v_readfirstlane_b32 s34, v252
    s_barrier
    s_nop 3
    s_mov_b32 s36, s33
    s_or_b32 s33, s34, s32
    s_cmp_lg_u32 s33, 0
    s_cbranch_scc1 L_helper1
    s_memrealtime s[90:91]
    s_waitcnt lgkmcnt(0)
    s_lshl_b32 s90, s90, 8
    s_or_b32 s90, s90, 1
    v_mov_b32 v250, s90
    v_mov_b32 v251, 0
    s_mov_b64 exec, 1
    buffer_atomic_cmpswap v[250:251], off, s[96:99], 0 offset:64
    s_mov_b64 exec, -1
L_helper1:
    s_cmp_ge_u32 s34, 32
    s_cbranch_scc1 L_qkv_next
    s_cmp_ge_u32 s36, 7
    s_cbranch_scc1 L_qkv_next
    s_max_u32 s37, s36, 4
    s_sub_u32 s37, s37, 4
    s_mul_i32 s37, s37, 6
    s_lshl_b32 s38, s36, 1
    s_add_u32 s38, s38, s37
    s_cmp_lt_u32 s36, 4
    s_cselect_b32 s39, 2, 8
    s_mul_i32 s36, s36, 30
    s_sub_u32 s36, s36, s37
    s_cmp_lt_u32 s34, s39
    s_cbranch_scc1 L_copy
    s_add_u32 s36, s36, s34
    s_sub_u32 s36, s36, s39
    s_mul_i32 s37, s36, 171
    s_lshr_b32 s37, s37, 10
    s_mul_i32 s38, s37, 6
    s_sub_u32 s36, s36, s38
    s_lshl_b32 s36, s36, 5
    s_add_u32 s36, s36, s37
    s_branch L_job
L_copy:
    s_add_u32 s36, s38, s34
    s_mul_i32 s36, s36, 11
    s_and_b32 s36, s36, 31
    s_cmp_ge_u32 s36, 27
    s_cbranch_scc1 L_qkv_next
    s_mul_i32 s33, s36, 57
    s_lshr_b32 s33, s33, 9
    s_mul_i32 s37, s33, 9
    s_sub_u32 s37, s36, s37
    s_lshl_b32 s36, s37, 2
    s_add_u32 s36, s36, 1
    s_min_u32 s36, s36, 31
    s_lshr_b32 s39, s52, 8
    s_sub_u32 s36, s36, s39
    s_and_b32 s36, s36, 31
    s_lshl_b32 s36, s36, 8
    s_mov_b32 s14, 4718592
    s_mov_b32 s15, 0x20000
    v_lshrrev_b32 v1, 4, v0
    v_lshlrev_b32 v1, 13, v1
    v_and_b32 v2, 15, v0
    v_lshl_add_u32 v1, v2, 4, v1
    v_lshlrev_b32 v2, 4, v0
    s_mul_i32 s40, s33, 2
    s_mul_i32 s39, s40, 49152
    s_lshl_b32 s41, s37, 19
    s_add_u32 s39, s39, s41
    s_add_u32 s39, s39, 96468992
    s_add_u32 s41, s40, 0
    s_cmp_lt_u32 s41, 3
    s_cselect_b64 s[12:13], s[52:53], s[54:55]
    s_cselect_b32 s42, 0, 3
    s_cmp_ge_u32 s41, 6
    s_cselect_b64 s[12:13], s[56:57], s[12:13]
    s_cselect_b32 s42, 6, s42
    s_sub_u32 s41, s41, s42
    s_mul_i32 s38, s41, 1572864
    s_add_u32 s38, s38, s36
    buffer_load_dwordx4 v[8:11], v1, s[12:15], s38 offen
    s_add_u32 s38, s38, 131072
    buffer_load_dwordx4 v[12:15], v1, s[12:15], s38 offen
    s_add_u32 s38, s38, 131072
    buffer_load_dwordx4 v[16:19], v1, s[12:15], s38 offen
    s_add_u32 s38, s38, 131072
    buffer_load_dwordx4 v[20:23], v1, s[12:15], s38 offen
    s_add_u32 s38, s38, 131072
    buffer_load_dwordx4 v[24:27], v1, s[12:15], s38 offen
    s_add_u32 s38, s38, 131072
    buffer_load_dwordx4 v[28:31], v1, s[12:15], s38 offen
    s_add_u32 s38, s38, 131072
    buffer_load_dwordx4 v[32:35], v1, s[12:15], s38 offen
    s_add_u32 s38, s38, 131072
    buffer_load_dwordx4 v[36:39], v1, s[12:15], s38 offen
    s_add_u32 s38, s38, 131072
    buffer_load_dwordx4 v[40:43], v1, s[12:15], s38 offen
    s_add_u32 s38, s38, 131072
    buffer_load_dwordx4 v[44:47], v1, s[12:15], s38 offen
    s_add_u32 s38, s38, 131072
    buffer_load_dwordx4 v[48:51], v1, s[12:15], s38 offen
    s_add_u32 s38, s38, 131072
    buffer_load_dwordx4 v[52:55], v1, s[12:15], s38 offen
    s_add_u32 s38, s38, 131072
    s_add_u32 s41, s40, 1
    s_cmp_lt_u32 s41, 3
    s_cselect_b64 s[12:13], s[52:53], s[54:55]
    s_cselect_b32 s42, 0, 3
    s_cmp_ge_u32 s41, 6
    s_cselect_b64 s[12:13], s[56:57], s[12:13]
    s_cselect_b32 s42, 6, s42
    s_sub_u32 s41, s41, s42
    s_mul_i32 s38, s41, 1572864
    s_add_u32 s38, s38, s36
    buffer_load_dwordx4 v[56:59], v1, s[12:15], s38 offen
    s_add_u32 s38, s38, 131072
    buffer_load_dwordx4 v[60:63], v1, s[12:15], s38 offen
    s_add_u32 s38, s38, 131072
    buffer_load_dwordx4 v[64:67], v1, s[12:15], s38 offen
    s_add_u32 s38, s38, 131072
    buffer_load_dwordx4 v[68:71], v1, s[12:15], s38 offen
    s_add_u32 s38, s38, 131072
    buffer_load_dwordx4 v[72:75], v1, s[12:15], s38 offen
    s_add_u32 s38, s38, 131072
    buffer_load_dwordx4 v[76:79], v1, s[12:15], s38 offen
    s_add_u32 s38, s38, 131072
    buffer_load_dwordx4 v[80:83], v1, s[12:15], s38 offen
    s_add_u32 s38, s38, 131072
    buffer_load_dwordx4 v[84:87], v1, s[12:15], s38 offen
    s_add_u32 s38, s38, 131072
    buffer_load_dwordx4 v[88:91], v1, s[12:15], s38 offen
    s_add_u32 s38, s38, 131072
    buffer_load_dwordx4 v[92:95], v1, s[12:15], s38 offen
    s_add_u32 s38, s38, 131072
    buffer_load_dwordx4 v[96:99], v1, s[12:15], s38 offen
    s_add_u32 s38, s38, 131072
    buffer_load_dwordx4 v[100:103], v1, s[12:15], s38 offen
    s_add_u32 s38, s38, 131072
    buffer_load_dword v3, off, s[96:99], 0 offset:64 sc1
    s_waitcnt vmcnt(0)
    buffer_store_dwordx4 v[8:11], v2, s[4:7], s39 offen sc1
    s_add_u32 s39, s39, 4096
    buffer_store_dwordx4 v[12:15], v2, s[4:7], s39 offen sc1
    s_add_u32 s39, s39, 4096
    buffer_store_dwordx4 v[16:19], v2, s[4:7], s39 offen sc1
    s_add_u32 s39, s39, 4096
    buffer_store_dwordx4 v[20:23], v2, s[4:7], s39 offen sc1
    s_add_u32 s39, s39, 4096
    buffer_store_dwordx4 v[24:27], v2, s[4:7], s39 offen sc1
    s_add_u32 s39, s39, 4096
    buffer_store_dwordx4 v[28:31], v2, s[4:7], s39 offen sc1
    s_add_u32 s39, s39, 4096
    buffer_store_dwordx4 v[32:35], v2, s[4:7], s39 offen sc1
    s_add_u32 s39, s39, 4096
    buffer_store_dwordx4 v[36:39], v2, s[4:7], s39 offen sc1
    s_add_u32 s39, s39, 4096
    buffer_store_dwordx4 v[40:43], v2, s[4:7], s39 offen sc1
    s_add_u32 s39, s39, 4096
    buffer_store_dwordx4 v[44:47], v2, s[4:7], s39 offen sc1
    s_add_u32 s39, s39, 4096
    buffer_store_dwordx4 v[48:51], v2, s[4:7], s39 offen sc1
    s_add_u32 s39, s39, 4096
    buffer_store_dwordx4 v[52:55], v2, s[4:7], s39 offen sc1
    s_add_u32 s39, s39, 4096
    buffer_store_dwordx4 v[56:59], v2, s[4:7], s39 offen sc1
    s_add_u32 s39, s39, 4096
    buffer_store_dwordx4 v[60:63], v2, s[4:7], s39 offen sc1
    s_add_u32 s39, s39, 4096
    buffer_store_dwordx4 v[64:67], v2, s[4:7], s39 offen sc1
    s_add_u32 s39, s39, 4096
    buffer_store_dwordx4 v[68:71], v2, s[4:7], s39 offen sc1
    s_add_u32 s39, s39, 4096
    buffer_store_dwordx4 v[72:75], v2, s[4:7], s39 offen sc1
    s_add_u32 s39, s39, 4096
    buffer_store_dwordx4 v[76:79], v2, s[4:7], s39 offen sc1
    s_add_u32 s39, s39, 4096
    buffer_store_dwordx4 v[80:83], v2, s[4:7], s39 offen sc1
    s_add_u32 s39, s39, 4096
    buffer_store_dwordx4 v[84:87], v2, s[4:7], s39 offen sc1
    s_add_u32 s39, s39, 4096
    buffer_store_dwordx4 v[88:91], v2, s[4:7], s39 offen sc1
    s_add_u32 s39, s39, 4096
    buffer_store_dwordx4 v[92:95], v2, s[4:7], s39 offen sc1
    s_add_u32 s39, s39, 4096
    buffer_store_dwordx4 v[96:99], v2, s[4:7], s39 offen sc1
    s_add_u32 s39, s39, 4096
    buffer_store_dwordx4 v[100:103], v2, s[4:7], s39 offen sc1
    s_add_u32 s39, s39, 4096
    v_readfirstlane_b32 s95, v3
    s_nop 4
    s_mov_b32 s88, 4194304
gn5:
    s_cmp_lg_u32 s95, 0
    s_cbranch_scc1 gn5x
    buffer_load_dword v3, off, s[96:99], 0 offset:64 sc1
    s_sub_u32 s88, s88, 1
    s_cbranch_scc1 gn5x
    s_waitcnt vmcnt(0)
    v_readfirstlane_b32 s95, v3
    s_nop 1
    s_branch gn5
gn5x:
    s_lshl_b32 s37, s37, 7
    s_lshl_b32 s36, s33, 2
    s_add_u32 s36, s36, s32
    s_lshl_b32 s36, s36, 2
    s_add_u32 s37, s37, s36
    s_add_u32 s37, s37, 125853696
    v_mov_b32 v3, s95
    s_waitcnt vmcnt(0)
    s_mov_b64 exec, 1
    buffer_store_dword v3, off, s[4:7], s37 sc1
    s_mov_b64 exec, -1
L_qkv_next:
    s_mov_b32 s37, 4
    v_mov_b32 v250, 1
    v_mov_b32 v251, 163832
    v_cmp_eq_u32 vcc, 0, v0
    s_nop 0
    s_and_saveexec_b64 s[38:39], vcc
    s_cbranch_execz tk6
    buffer_atomic_add v250, off, s[96:99], s37 sc0
    s_waitcnt vmcnt(0)
    ds_write_b32 v251, v250
    s_waitcnt lgkmcnt(0)
tk6:
    s_mov_b64 exec, -1
    s_barrier
    ds_read_b32 v252, v251
    s_waitcnt lgkmcnt(0)
    v_readfirstlane_b32 s36, v252
    s_barrier
    s_nop 3
    s_add_u32 s36, s36, 192
    s_cmp_ge_u32 s36, 320
    s_cbranch_scc1 L_ssm_next
L_job:
    s_and_b32 s17, s36, 15
    s_lshl_b32 s17, s17, 1
    s_bfe_u32 s16, s36, 0x10004
    s_lshr_b32 s19, s36, 5
    s_mul_i32 s33, s16, 6
    s_add_u32 s33, s33, s19
    s_add_u32 s16, s16, 1
    s_lshr_b32 s37, s36, 4
    s_sub_u32 s38, s37, 12
    s_cmp_ge_u32 s36, 192
    s_cselect_b32 s16, 0, s16
    s_cselect_b32 s19, s38, s19
    s_cselect_b32 s33, s37, s33
    s_cselect_b32 s20, 8, 6
    v_lshrrev_b32 v4, 6, v0
    s_nop 0
    v_readfirstlane_b32 s18, v4
    v_lshlrev_b32 v7, 4, v0
    v_and_b32 v4, 63, v0
    v_lshrrev_b32 v6, 2, v4
    v_lshlrev_b32 v6, 13, v6
    v_lshrrev_b32 v5, 4, v4
    v_and_b32 v5, 2, v5
    v_xor_b32 v5, v5, v4
    v_and_b32 v5, 3, v5
    v_lshl_add_u32 v6, v5, 4, v6
    v_lshrrev_b32 v24, 4, v4
    v_lshlrev_b32 v24, 9, v24
    v_bfe_u32 v5, v4, 2, 2
    v_lshl_add_u32 v24, v5, 6, v24
    v_bfe_u32 v5, v4, 4, 1
    v_lshl_add_u32 v24, v5, 5, v24
    v_and_b32 v5, 3, v4
    v_lshl_add_u32 v24, v5, 3, v24
    s_lshl_b32 s31, s18, 12
    v_add_u32 v24, s31, v24
    s_cmp_eq_u32 s16, 1
    s_cselect_b64 s[12:13], s[54:55], s[52:53]
    s_cmp_eq_u32 s16, 2
    s_cselect_b64 s[12:13], s[56:57], s[12:13]
    s_mov_b32 s14, 4718592
    s_mov_b32 s15, 0x20000
    s_lshl_b32 s28, s17, 8
    s_lshl_b32 s21, s18, 6
    s_add_u32 s28, s28, s21
    s_add_u32 s21, s28, 0
    s_add_u32 m0, s31, 40960
    s_nop 0
    buffer_load_dwordx4 v6, s[12:15], s21 offen lds
    s_add_u32 m0, s31, 41984
    s_add_u32 s21, s21, 131072
    buffer_load_dwordx4 v6, s[12:15], s21 offen lds
    s_add_u32 m0, s31, 43008
    s_add_u32 s21, s21, 131072
    buffer_load_dwordx4 v6, s[12:15], s21 offen lds
    s_add_u32 m0, s31, 44032
    s_add_u32 s21, s21, 131072
    buffer_load_dwordx4 v6, s[12:15], s21 offen lds
    s_add_u32 s21, s28, 256
    s_add_u32 m0, s31, 57344
    s_nop 0
    buffer_load_dwordx4 v6, s[12:15], s21 offen lds
    s_add_u32 m0, s31, 58368
    s_add_u32 s21, s21, 131072
    buffer_load_dwordx4 v6, s[12:15], s21 offen lds
    s_add_u32 m0, s31, 59392
    s_add_u32 s21, s21, 131072
    buffer_load_dwordx4 v6, s[12:15], s21 offen lds
    s_add_u32 m0, s31, 60416
    s_add_u32 s21, s21, 131072
    buffer_load_dwordx4 v6, s[12:15], s21 offen lds
    s_add_u32 s21, s28, 524288
    s_add_u32 m0, s31, 73728
    s_nop 0
    buffer_load_dwordx4 v6, s[12:15], s21 offen lds
    s_add_u32 m0, s31, 74752
    s_add_u32 s21, s21, 131072
    buffer_load_dwordx4 v6, s[12:15], s21 offen lds
    s_add_u32 m0, s31, 75776
    s_add_u32 s21, s21, 131072
    buffer_load_dwordx4 v6, s[12:15], s21 offen lds
    s_add_u32 m0, s31, 76800
    s_add_u32 s21, s21, 131072
    buffer_load_dwordx4 v6, s[12:15], s21 offen lds
    s_add_u32 s21, s28, 524544
    s_add_u32 m0, s31, 90112
    s_nop 0
    buffer_load_dwordx4 v6, s[12:15], s21 offen lds
    s_add_u32 m0, s31, 91136
    s_add_u32 s21, s21, 131072
    buffer_load_dwordx4 v6, s[12:15], s21 offen lds
    s_add_u32 m0, s31, 92160
    s_add_u32 s21, s21, 131072
    buffer_load_dwordx4 v6, s[12:15], s21 offen lds
    s_add_u32 m0, s31, 93184
    s_add_u32 s21, s21, 131072
    buffer_load_dwordx4 v6, s[12:15], s21 offen lds
    s_add_u32 s21, s28, 1048576
    s_add_u32 m0, s31, 106496
    s_nop 0
    buffer_load_dwordx4 v6, s[12:15], s21 offen lds
    s_add_u32 m0, s31, 107520
    s_add_u32 s21, s21, 131072
    buffer_load_dwordx4 v6, s[12:15], s21 offen lds
    s_add_u32 m0, s31, 108544
    s_add_u32 s21, s21, 131072
    buffer_load_dwordx4 v6, s[12:15], s21 offen lds
    s_add_u32 m0, s31, 109568
    s_add_u32 s21, s21, 131072
    buffer_load_dwordx4 v6, s[12:15], s21 offen lds
    s_add_u32 s21, s28, 1048832
    s_add_u32 m0, s31, 122880
    s_nop 0
    buffer_load_dwordx4 v6, s[12:15], s21 offen lds
    s_add_u32 m0, s31, 123904
    s_add_u32 s21, s21, 131072
    buffer_load_dwordx4 v6, s[12:15], s21 offen lds
    s_add_u32 m0, s31, 124928
    s_add_u32 s21, s21, 131072
    buffer_load_dwordx4 v6, s[12:15], s21 offen lds
    s_add_u32 m0, s31, 125952
    s_add_u32 s21, s21, 131072
    buffer_load_dwordx4 v6, s[12:15], s21 offen lds
    s_add_u32 s21, s28, 1572864
    s_add_u32 m0, s31, 139264
    s_nop 0
    buffer_load_dwordx4 v6, s[12:15], s21 offen lds
    s_add_u32 m0, s31, 140288
    s_add_u32 s21, s21, 131072
    buffer_load_dwordx4 v6, s[12:15], s21 offen lds
    s_add_u32 m0, s31, 141312
    s_add_u32 s21, s21, 131072
    buffer_load_dwordx4 v6, s[12:15], s21 offen lds
    s_add_u32 m0, s31, 142336
    s_add_u32 s21, s21, 131072
    buffer_load_dwordx4 v6, s[12:15], s21 offen lds
    v_and_b32 v5, 15, v4
    v_lshrrev_b32 v3, 4, v4
    v_lshrrev_b32 v2, 2, v5
    v_xor_b32 v3, v3, v2
    v_lshl_add_u32 v3, v5, 2, v3
    v_lshlrev_b32 v1, 4, v3
    v_lshrrev_b32 v5, 2, v4
    v_lshrrev_b32 v3, 4, v4
    v_and_b32 v4, 3, v4
    v_xor_b32 v4, v4, v3
    v_lshlrev_b32 v3, 3, v3
    v_and_b32 v5, 3, v5
    v_add_u32 v3, v3, v5
    v_mul_u32_u24 v2, 1152, v3
    v_lshl_add_u32 v2, v4, 4, v2
    s_mov_b32 s8, s48
    s_mov_b32 s9, s49
    s_mov_b32 s10, 2359296
    s_mov_b32 s11, 0x20000
    s_lshr_b32 s22, s18, 1
    s_mul_i32 s24, s22, 4608
    s_and_b32 s22, s18, 1
    s_mul_i32 s23, s22, 576
    s_add_u32 s24, s24, s23
    s_mul_i32 s25, s18, 9216
    s_mul_i32 s22, s19, 36864
    s_add_u32 s24, s24, s22
    s_mul_i32 s42, s20, 36864
    s_mov_b32 s27, 0
    s_add_u32 s23, s27, s25
    s_add_u32 m0, s23, 0
    s_nop 0
    buffer_load_dwordx4 v2, s[8:11], s24 offen offset:0 lds
    s_add_u32 m0, s23, 960
    s_nop 0
    buffer_load_dwordx4 v2, s[8:11], s24 offen offset:64 lds
    s_add_u32 m0, s23, 1920
    s_nop 0
    buffer_load_dwordx4 v2, s[8:11], s24 offen offset:128 lds
    s_add_u32 m0, s23, 2880
    s_nop 0
    buffer_load_dwordx4 v2, s[8:11], s24 offen offset:192 lds
    s_add_u32 m0, s23, 3840
    s_nop 0
    buffer_load_dwordx4 v2, s[8:11], s24 offen offset:256 lds
    s_add_u32 m0, s23, 4800
    s_nop 0
    buffer_load_dwordx4 v2, s[8:11], s24 offen offset:320 lds
    s_add_u32 m0, s23, 5760
    s_nop 0
    buffer_load_dwordx4 v2, s[8:11], s24 offen offset:384 lds
    s_add_u32 m0, s23, 6720
    s_nop 0
    buffer_load_dwordx4 v2, s[8:11], s24 offen offset:448 lds
    s_add_u32 m0, s23, 7680
    s_nop 0
    buffer_load_dwordx4 v2, s[8:11], s24 offen offset:512 lds
    s_add_u32 s24, s24, s42
    s_lshl_b32 s22, s19, 5
    s_add_u32 s22, s22, s17
    s_lshl_b32 s26, s22, 14
    s_mul_i32 s23, s18, 3072
    s_add_u32 s26, s26, s23
    s_lshl_b32 s23, s16, 11
    s_add_u32 s26, s26, s23
    s_add_u32 s26, s26, -2048
    s_lshl_b32 s22, s22, 13
    s_add_u32 s22, s22, 33554432
    s_cmp_eq_u32 s16, 0
    s_cselect_b32 s26, s22, s26
    s_cselect_b32 s40, 4, 1
    s_cselect_b32 s43, 1, 2
    s_lshl_b32 s40, s40, 10
    s_lshl_b32 s43, s43, 13
    s_lshl_b32 s41, s43, 5
    s_mul_i32 s41, s41, s20
    s_lshl_b32 s29, s17, 7
    s_lshl_b32 s22, s33, 2
    s_add_u32 s29, s29, s22
    s_add_u32 s29, s29, 125829120
    v_add_u32 v25, 40960, v24
    v_xor_b32 v26, 32, v25
    s_waitcnt vmcnt(33)
    ds_read_b64_tr_b16 v[64:65], v25 offset:0
    ds_read_b64_tr_b16 v[66:67], v25 offset:256
    ds_read_b64_tr_b16 v[136:137], v26 offset:0
    ds_read_b64_tr_b16 v[138:139], v26 offset:256
    ds_read_b64_tr_b16 v[68:69], v25 offset:2048
    ds_read_b64_tr_b16 v[70:71], v25 offset:2304
    ds_read_b64_tr_b16 v[140:141], v26 offset:2048
    ds_read_b64_tr_b16 v[142:143], v26 offset:2304
    s_waitcnt lgkmcnt(0)
    s_add_u32 s21, s28, 1573120
    s_add_u32 m0, s31, 40960
    s_nop 0
    buffer_load_dwordx4 v6, s[12:15], s21 offen lds
    s_add_u32 m0, s31, 41984
    s_add_u32 s21, s21, 131072
    buffer_load_dwordx4 v6, s[12:15], s21 offen lds
    s_add_u32 m0, s31, 43008
    s_add_u32 s21, s21, 131072
    buffer_load_dwordx4 v6, s[12:15], s21 offen lds
    s_add_u32 m0, s31, 44032
    s_add_u32 s21, s21, 131072
    buffer_load_dwordx4 v6, s[12:15], s21 offen lds
    v_add_u32 v25, 57344, v24
    v_xor_b32 v26, 32, v25
    s_waitcnt vmcnt(33)
    ds_read_b64_tr_b16 a[0:1], v25 offset:0
    ds_read_b64_tr_b16 a[2:3], v25 offset:256
    ds_read_b64_tr_b16 a[72:73], v26 offset:0
    ds_read_b64_tr_b16 a[74:75], v26 offset:256
    ds_read_b64_tr_b16 a[4:5], v25 offset:2048
    ds_read_b64_tr_b16 a[6:7], v25 offset:2304
    ds_read_b64_tr_b16 a[76:77], v26 offset:2048
    ds_read_b64_tr_b16 a[78:79], v26 offset:2304
    s_waitcnt lgkmcnt(0)
    s_add_u32 s21, s28, 2097152
    s_add_u32 m0, s31, 57344
    s_nop 0
    buffer_load_dwordx4 v6, s[12:15], s21 offen lds
    s_add_u32 m0, s31, 58368
    s_add_u32 s21, s21, 131072
    buffer_load_dwordx4 v6, s[12:15], s21 offen lds
    s_add_u32 m0, s31, 59392
    s_add_u32 s21, s21, 131072
    buffer_load_dwordx4 v6, s[12:15], s21 offen lds
    s_add_u32 m0, s31, 60416
    s_add_u32 s21, s21, 131072
    buffer_load_dwordx4 v6, s[12:15], s21 offen lds
    v_add_u32 v25, 73728, v24
    v_xor_b32 v26, 32, v25
    s_waitcnt vmcnt(33)
    ds_read_b64_tr_b16 v[72:73], v25 offset:0
    ds_read_b64_tr_b16 v[74:75], v25 offset:256
    ds_read_b64_tr_b16 v[144:145], v26 offset:0
    ds_read_b64_tr_b16 v[146:147], v26 offset:256
    ds_read_b64_tr_b16 v[76:77], v25 offset:2048
    ds_read_b64_tr_b16 v[78:79], v25 offset:2304
    ds_read_b64_tr_b16 v[148:149], v26 offset:2048
    ds_read_b64_tr_b16 v[150:151], v26 offset:2304
    s_waitcnt lgkmcnt(0)
    s_add_u32 s21, s28, 2097408
    s_add_u32 m0, s31, 73728
    s_nop 0
    buffer_load_dwordx4 v6, s[12:15], s21 offen lds
    s_add_u32 m0, s31, 74752
    s_add_u32 s21, s21, 131072
    buffer_load_dwordx4 v6, s[12:15], s21 offen lds
    s_add_u32 m0, s31, 75776
    s_add_u32 s21, s21, 131072
    buffer_load_dwordx4 v6, s[12:15], s21 offen lds
    s_add_u32 m0, s31, 76800
    s_add_u32 s21, s21, 131072
    buffer_load_dwordx4 v6, s[12:15], s21 offen lds
    v_add_u32 v25, 90112, v24
    v_xor_b32 v26, 32, v25
    s_waitcnt vmcnt(33)
    ds_read_b64_tr_b16 a[8:9], v25 offset:0
    ds_read_b64_tr_b16 a[10:11], v25 offset:256
    ds_read_b64_tr_b16 a[80:81], v26 offset:0
    ds_read_b64_tr_b16 a[82:83], v26 offset:256
    ds_read_b64_tr_b16 a[12:13], v25 offset:2048
    ds_read_b64_tr_b16 a[14:15], v25 offset:2304
    ds_read_b64_tr_b16 a[84:85], v26 offset:2048
    ds_read_b64_tr_b16 a[86:87], v26 offset:2304
    s_waitcnt lgkmcnt(0)
    s_add_u32 s21, s28, 2621440
    s_add_u32 m0, s31, 90112
    s_nop 0
    buffer_load_dwordx4 v6, s[12:15], s21 offen lds
    s_add_u32 m0, s31, 91136
    s_add_u32 s21, s21, 131072
    buffer_load_dwordx4 v6, s[12:15], s21 offen lds
    s_add_u32 m0, s31, 92160
    s_add_u32 s21, s21, 131072
    buffer_load_dwordx4 v6, s[12:15], s21 offen lds
    s_add_u32 m0, s31, 93184
    s_add_u32 s21, s21, 131072
    buffer_load_dwordx4 v6, s[12:15], s21 offen lds
    v_add_u32 v25, 106496, v24
    v_xor_b32 v26, 32, v25
    s_waitcnt vmcnt(33)
    ds_read_b64_tr_b16 v[80:81], v25 offset:0
    ds_read_b64_tr_b16 v[82:83], v25 offset:256
    ds_read_b64_tr_b16 v[152:153], v26 offset:0
    ds_read_b64_tr_b16 v[154:155], v26 offset:256
    ds_read_b64_tr_b16 v[84:85], v25 offset:2048
    ds_read_b64_tr_b16 v[86:87], v25 offset:2304
    ds_read_b64_tr_b16 v[156:157], v26 offset:2048
    ds_read_b64_tr_b16 v[158:159], v26 offset:2304
    s_waitcnt lgkmcnt(0)
    s_add_u32 s21, s28, 2621696
    s_add_u32 m0, s31, 106496
    s_nop 0
    buffer_load_dwordx4 v6, s[12:15], s21 offen lds
    s_add_u32 m0, s31, 107520
    s_add_u32 s21, s21, 131072
    buffer_load_dwordx4 v6, s[12:15], s21 offen lds
    s_add_u32 m0, s31, 108544
    s_add_u32 s21, s21, 131072
    buffer_load_dwordx4 v6, s[12:15], s21 offen lds
    s_add_u32 m0, s31, 109568
    s_add_u32 s21, s21, 131072
    buffer_load_dwordx4 v6, s[12:15], s21 offen lds
    v_add_u32 v25, 122880, v24
    v_xor_b32 v26, 32, v25
    s_waitcnt vmcnt(33)
    ds_read_b64_tr_b16 a[16:17], v25 offset:0
    ds_read_b64_tr_b16 a[18:19], v25 offset:256
    ds_read_b64_tr_b16 a[88:89], v26 offset:0
    ds_read_b64_tr_b16 a[90:91], v26 offset:256
    ds_read_b64_tr_b16 a[20:21], v25 offset:2048
    ds_read_b64_tr_b16 a[22:23], v25 offset:2304
    ds_read_b64_tr_b16 a[92:93], v26 offset:2048
    ds_read_b64_tr_b16 a[94:95], v26 offset:2304
    s_waitcnt lgkmcnt(0)
    s_add_u32 s21, s28, 3145728
    s_add_u32 m0, s31, 122880
    s_nop 0
    buffer_load_dwordx4 v6, s[12:15], s21 offen lds
    s_add_u32 m0, s31, 123904
    s_add_u32 s21, s21, 131072
    buffer_load_dwordx4 v6, s[12:15], s21 offen lds
    s_add_u32 m0, s31, 124928
    s_add_u32 s21, s21, 131072
    buffer_load_dwordx4 v6, s[12:15], s21 offen lds
    s_add_u32 m0, s31, 125952
    s_add_u32 s21, s21, 131072
    buffer_load_dwordx4 v6, s[12:15], s21 offen lds
    v_add_u32 v25, 139264, v24
    v_xor_b32 v26, 32, v25
    s_waitcnt vmcnt(33)
    ds_read_b64_tr_b16 v[88:89], v25 offset:0
    ds_read_b64_tr_b16 v[90:91], v25 offset:256
    ds_read_b64_tr_b16 v[160:161], v26 offset:0
    ds_read_b64_tr_b16 v[162:163], v26 offset:256
    ds_read_b64_tr_b16 v[92:93], v25 offset:2048
    ds_read_b64_tr_b16 v[94:95], v25 offset:2304
    ds_read_b64_tr_b16 v[164:165], v26 offset:2048
    ds_read_b64_tr_b16 v[166:167], v26 offset:2304
    s_waitcnt lgkmcnt(0)
    s_add_u32 s21, s28, 3145984
    s_add_u32 m0, s31, 139264
    s_nop 0
    buffer_load_dwordx4 v6, s[12:15], s21 offen lds
    s_add_u32 m0, s31, 140288
    s_add_u32 s21, s21, 131072
    buffer_load_dwordx4 v6, s[12:15], s21 offen lds
    s_add_u32 m0, s31, 141312
    s_add_u32 s21, s21, 131072
    buffer_load_dwordx4 v6, s[12:15], s21 offen lds
    s_add_u32 m0, s31, 142336
    s_add_u32 s21, s21, 131072
    buffer_load_dwordx4 v6, s[12:15], s21 offen lds
    v_add_u32 v25, 40960, v24
    v_xor_b32 v26, 32, v25
    s_waitcnt vmcnt(24)
    ds_read_b64_tr_b16 a[24:25], v25 offset:0
    ds_read_b64_tr_b16 a[26:27], v25 offset:256
    ds_read_b64_tr_b16 a[96:97], v26 offset:0
    ds_read_b64_tr_b16 a[98:99], v26 offset:256
    ds_read_b64_tr_b16 a[28:29], v25 offset:2048
    ds_read_b64_tr_b16 a[30:31], v25 offset:2304
    ds_read_b64_tr_b16 a[100:101], v26 offset:2048
    ds_read_b64_tr_b16 a[102:103], v26 offset:2304
    s_waitcnt lgkmcnt(0)
    s_add_u32 s21, s28, 3670016
    s_add_u32 m0, s31, 40960
    s_nop 0
    buffer_load_dwordx4 v6, s[12:15], s21 offen lds
    s_add_u32 m0, s31, 41984
    s_add_u32 s21, s21, 131072
    buffer_load_dwordx4 v6, s[12:15], s21 offen lds
    s_add_u32 m0, s31, 43008
    s_add_u32 s21, s21, 131072
    buffer_load_dwordx4 v6, s[12:15], s21 offen lds
    s_add_u32 m0, s31, 44032
    s_add_u32 s21, s21, 131072
    buffer_load_dwordx4 v6, s[12:15], s21 offen lds
    v_add_u32 v25, 57344, v24
    v_xor_b32 v26, 32, v25
    s_waitcnt vmcnt(24)
    ds_read_b64_tr_b16 v[96:97], v25 offset:0
    ds_read_b64_tr_b16 v[98:99], v25 offset:256
    ds_read_b64_tr_b16 v[168:169], v26 offset:0
    ds_read_b64_tr_b16 v[170:171], v26 offset:256
    ds_read_b64_tr_b16 v[100:101], v25 offset:2048
    ds_read_b64_tr_b16 v[102:103], v25 offset:2304
    ds_read_b64_tr_b16 v[172:173], v26 offset:2048
    ds_read_b64_tr_b16 v[174:175], v26 offset:2304
    s_waitcnt lgkmcnt(0)
    s_add_u32 s21, s28, 3670272
    s_add_u32 m0, s31, 57344
    s_nop 0
    buffer_load_dwordx4 v6, s[12:15], s21 offen lds
    s_add_u32 m0, s31, 58368
    s_add_u32 s21, s21, 131072
    buffer_load_dwordx4 v6, s[12:15], s21 offen lds
    s_add_u32 m0, s31, 59392
    s_add_u32 s21, s21, 131072
    buffer_load_dwordx4 v6, s[12:15], s21 offen lds
    s_add_u32 m0, s31, 60416
    s_add_u32 s21, s21, 131072
    buffer_load_dwordx4 v6, s[12:15], s21 offen lds
    v_add_u32 v25, 73728, v24
    v_xor_b32 v26, 32, v25
    s_waitcnt vmcnt(24)
    ds_read_b64_tr_b16 a[32:33], v25 offset:0
    ds_read_b64_tr_b16 a[34:35], v25 offset:256
    ds_read_b64_tr_b16 a[104:105], v26 offset:0
    ds_read_b64_tr_b16 a[106:107], v26 offset:256
    ds_read_b64_tr_b16 a[36:37], v25 offset:2048
    ds_read_b64_tr_b16 a[38:39], v25 offset:2304
    ds_read_b64_tr_b16 a[108:109], v26 offset:2048
    ds_read_b64_tr_b16 a[110:111], v26 offset:2304
    s_waitcnt lgkmcnt(0)
    s_add_u32 s21, s28, 4194304
    s_add_u32 m0, s31, 73728
    s_nop 0
    buffer_load_dwordx4 v6, s[12:15], s21 offen lds
    s_add_u32 m0, s31, 74752
    s_add_u32 s21, s21, 131072
    buffer_load_dwordx4 v6, s[12:15], s21 offen lds
    s_add_u32 m0, s31, 75776
    s_add_u32 s21, s21, 131072
    buffer_load_dwordx4 v6, s[12:15], s21 offen lds
    s_add_u32 m0, s31, 76800
    s_add_u32 s21, s21, 131072
    buffer_load_dwordx4 v6, s[12:15], s21 offen lds
    v_add_u32 v25, 90112, v24
    v_xor_b32 v26, 32, v25
    s_waitcnt vmcnt(24)
    ds_read_b64_tr_b16 v[104:105], v25 offset:0
    ds_read_b64_tr_b16 v[106:107], v25 offset:256
    ds_read_b64_tr_b16 v[176:177], v26 offset:0
    ds_read_b64_tr_b16 v[178:179], v26 offset:256
    ds_read_b64_tr_b16 v[108:109], v25 offset:2048
    ds_read_b64_tr_b16 v[110:111], v25 offset:2304
    ds_read_b64_tr_b16 v[180:181], v26 offset:2048
    ds_read_b64_tr_b16 v[182:183], v26 offset:2304
    s_waitcnt lgkmcnt(0)
    v_mov_b32 v28, s95
    s_cmp_lg_u32 s95, 0
    s_cbranch_scc1 L_ne
    buffer_load_dword v28, off, s[96:99], 0 offset:64 sc1
    s_cmp_ge_u32 s36, 192
    s_cbranch_scc1 L_ne
    s_mul_i32 s37, s36, 24576
    s_mov_b32 s46, 4718592
    s_mov_b32 s47, 0x20000
    v_lshlrev_b32 v29, 7, v0
    v_min_u32 v29, 24448, v29
    s_mov_b64 s[44:45], s[58:59]
    buffer_load_dword v30, v29, s[44:47], s37 offen
    s_mov_b64 s[44:45], s[52:53]
    buffer_load_dword v30, v29, s[44:47], s37 offen
L_ne:
    s_add_u32 s21, s28, 4194560
    s_add_u32 m0, s31, 90112
    s_nop 0
    buffer_load_dwordx4 v6, s[12:15], s21 offen lds
    s_add_u32 m0, s31, 91136
    s_add_u32 s21, s21, 131072
    buffer_load_dwordx4 v6, s[12:15], s21 offen lds
    s_add_u32 m0, s31, 92160
    s_add_u32 s21, s21, 131072
    buffer_load_dwordx4 v6, s[12:15], s21 offen lds
    s_add_u32 m0, s31, 93184
    s_add_u32 s21, s21, 131072
    buffer_load_dwordx4 v6, s[12:15], s21 offen lds
    v_add_u32 v25, 106496, v24
    v_xor_b32 v26, 32, v25
    s_waitcnt vmcnt(24)
    ds_read_b64_tr_b16 a[40:41], v25 offset:0
    ds_read_b64_tr_b16 a[42:43], v25 offset:256
    ds_read_b64_tr_b16 a[112:113], v26 offset:0
    ds_read_b64_tr_b16 a[114:115], v26 offset:256
    ds_read_b64_tr_b16 a[44:45], v25 offset:2048
    ds_read_b64_tr_b16 a[46:47], v25 offset:2304
    ds_read_b64_tr_b16 a[116:117], v26 offset:2048
    ds_read_b64_tr_b16 a[118:119], v26 offset:2304
    s_waitcnt lgkmcnt(0)
    v_add_u32 v25, 122880, v24
    v_xor_b32 v26, 32, v25
    s_waitcnt vmcnt(20)
    ds_read_b64_tr_b16 v[112:113], v25 offset:0
    ds_read_b64_tr_b16 v[114:115], v25 offset:256
    ds_read_b64_tr_b16 v[184:185], v26 offset:0
    ds_read_b64_tr_b16 v[186:187], v26 offset:256
    ds_read_b64_tr_b16 v[116:117], v25 offset:2048
    ds_read_b64_tr_b16 v[118:119], v25 offset:2304
    ds_read_b64_tr_b16 v[188:189], v26 offset:2048
    ds_read_b64_tr_b16 v[190:191], v26 offset:2304
    s_waitcnt lgkmcnt(0)
    v_add_u32 v25, 139264, v24
    v_xor_b32 v26, 32, v25
    s_waitcnt vmcnt(16)
    ds_read_b64_tr_b16 a[48:49], v25 offset:0
    ds_read_b64_tr_b16 a[50:51], v25 offset:256
    ds_read_b64_tr_b16 a[120:121], v26 offset:0
    ds_read_b64_tr_b16 a[122:123], v26 offset:256
    ds_read_b64_tr_b16 a[52:53], v25 offset:2048
    ds_read_b64_tr_b16 a[54:55], v25 offset:2304
    ds_read_b64_tr_b16 a[124:125], v26 offset:2048
    ds_read_b64_tr_b16 a[126:127], v26 offset:2304
    s_waitcnt lgkmcnt(0)
    v_add_u32 v25, 40960, v24
    v_xor_b32 v26, 32, v25
    s_waitcnt vmcnt(12)
    ds_read_b64_tr_b16 v[120:121], v25 offset:0
    ds_read_b64_tr_b16 v[122:123], v25 offset:256
    ds_read_b64_tr_b16 v[192:193], v26 offset:0
    ds_read_b64_tr_b16 v[194:195], v26 offset:256
    ds_read_b64_tr_b16 v[124:125], v25 offset:2048
    ds_read_b64_tr_b16 v[126:127], v25 offset:2304
    ds_read_b64_tr_b16 v[196:197], v26 offset:2048
    ds_read_b64_tr_b16 v[198:199], v26 offset:2304
    s_waitcnt lgkmcnt(0)
    v_add_u32 v25, 57344, v24
    v_xor_b32 v26, 32, v25
    s_waitcnt vmcnt(8)
    ds_read_b64_tr_b16 a[56:57], v25 offset:0
    ds_read_b64_tr_b16 a[58:59], v25 offset:256
    ds_read_b64_tr_b16 a[128:129], v26 offset:0
    ds_read_b64_tr_b16 a[130:131], v26 offset:256
    ds_read_b64_tr_b16 a[60:61], v25 offset:2048
    ds_read_b64_tr_b16 a[62:63], v25 offset:2304
    ds_read_b64_tr_b16 a[132:133], v26 offset:2048
    ds_read_b64_tr_b16 a[134:135], v26 offset:2304
    s_waitcnt lgkmcnt(0)
    v_add_u32 v25, 73728, v24
    v_xor_b32 v26, 32, v25
    s_waitcnt vmcnt(4)
    ds_read_b64_tr_b16 v[128:129], v25 offset:0
    ds_read_b64_tr_b16 v[130:131], v25 offset:256
    ds_read_b64_tr_b16 v[200:201], v26 offset:0
    ds_read_b64_tr_b16 v[202:203], v26 offset:256
    ds_read_b64_tr_b16 v[132:133], v25 offset:2048
    ds_read_b64_tr_b16 v[134:135], v25 offset:2304
    ds_read_b64_tr_b16 v[204:205], v26 offset:2048
    ds_read_b64_tr_b16 v[206:207], v26 offset:2304
    s_waitcnt lgkmcnt(0)
    v_add_u32 v25, 90112, v24
    v_xor_b32 v26, 32, v25
    s_waitcnt vmcnt(0)
    ds_read_b64_tr_b16 a[64:65], v25 offset:0
    ds_read_b64_tr_b16 a[66:67], v25 offset:256
    ds_read_b64_tr_b16 a[136:137], v26 offset:0
    ds_read_b64_tr_b16 a[138:139], v26 offset:256
    ds_read_b64_tr_b16 a[68:69], v25 offset:2048
    ds_read_b64_tr_b16 a[70:71], v25 offset:2304
    ds_read_b64_tr_b16 a[140:141], v26 offset:2048
    ds_read_b64_tr_b16 a[142:143], v26 offset:2304
    s_waitcnt lgkmcnt(0)
    s_lshr_b32 s21, s17, 3
    s_cmp_eq_u32 s21, 3
    s_cselect_b32 s21, 1, s33
    s_cmp_lg_u32 s21, 0
    s_cbranch_scc1 qk_noclr
    v_mov_b32 v8, -1
    v_mov_b32 v9, -1
    v_mov_b32 v10, -1
    v_mov_b32 v11, -1
    v_lshrrev_b32 v25, 6, v0
    v_mul_u32_u24 v25, 11264, v25
    v_add_u32 v25, v25, v7
    s_lshl_b32 s21, s17, 9
    s_add_u32 s21, s21, 90177536
    s_add_u32 s22, s21, 786432
qk_clr:
    buffer_store_dwordx4 v[8:11], v25, s[4:7], s21 offen sc1
    s_add_u32 s21, s21, 49152
    s_cmp_lt_u32 s21, s22
    s_cbranch_scc1 qk_clr
qk_noclr:
    s_and_b32 s21, s33, -2
    s_cmp_lg_u32 s21, 2
    s_cbranch_scc1 qk_noclr2
    v_mov_b32 v8, -1
    v_mov_b32 v9, -1
    v_mov_b32 v10, -1
    v_mov_b32 v11, -1
    s_add_u32 s21, s33, 60
    s_lshl_b32 s23, s17, 12
    s_lshl_b32 s22, s21, 17
    s_add_u32 s22, s22, s23
    s_add_u32 s22, s22, 71303168
    buffer_store_dwordx4 v[8:11], v7, s[4:7], s22 offen sc1
    s_add_u32 s22, s22, 4096
    buffer_store_dwordx4 v[8:11], v7, s[4:7], s22 offen sc1
    s_lshl_b32 s22, s21, 17
    s_add_u32 s22, s22, s23
    s_add_u32 s22, s22, 80740352
    buffer_store_dwordx4 v[8:11], v7, s[4:7], s22 offen sc1
    s_add_u32 s22, s22, 4096
    buffer_store_dwordx4 v[8:11], v7, s[4:7], s22 offen sc1
    s_lshl_b32 s22, s21, 18
    s_add_u32 s22, s22, s23
    s_add_u32 s22, s22, 50331648
    buffer_store_dwordx4 v[8:11], v7, s[4:7], s22 offen sc1
    s_add_u32 s22, s22, 4096
    buffer_store_dwordx4 v[8:11], v7, s[4:7], s22 offen sc1
    s_lshl_b32 s22, s21, 18
    s_add_u32 s22, s22, s23
    s_add_u32 s22, s22, 50462720
    buffer_store_dwordx4 v[8:11], v7, s[4:7], s22 offen sc1
    s_add_u32 s22, s22, 4096
    buffer_store_dwordx4 v[8:11], v7, s[4:7], s22 offen sc1
qk_noclr2:
    v_readfirstlane_b32 s95, v28
    s_nop 4
    s_mov_b32 s88, 4194304
gn7:
    s_cmp_lg_u32 s95, 0
    s_cbranch_scc1 gn7x
    buffer_load_dword v25, off, s[96:99], 0 offset:64 sc1
    s_sub_u32 s88, s88, 1
    s_cbranch_scc1 gn7x
    s_waitcnt vmcnt(0)
    v_readfirstlane_b32 s95, v25
    s_nop 1
    s_branch gn7
gn7x:
    s_barrier
    s_mov_b32 s27, 36864
    s_add_u32 s23, s27, s25
    s_add_u32 m0, s23, 0
    s_nop 0
    buffer_load_dwordx4 v2, s[8:11], s24 offen offset:0 lds
    s_add_u32 m0, s23, 960
    s_nop 0
    buffer_load_dwordx4 v2, s[8:11], s24 offen offset:64 lds
    s_add_u32 m0, s23, 1920
    s_nop 0
    buffer_load_dwordx4 v2, s[8:11], s24 offen offset:128 lds
    s_add_u32 m0, s23, 2880
    s_nop 0
    buffer_load_dwordx4 v2, s[8:11], s24 offen offset:192 lds
    s_add_u32 m0, s23, 3840
    s_nop 0
    buffer_load_dwordx4 v2, s[8:11], s24 offen offset:256 lds
    s_add_u32 m0, s23, 4800
    s_nop 0
    buffer_load_dwordx4 v2, s[8:11], s24 offen offset:320 lds
    s_add_u32 m0, s23, 5760
    s_nop 0
    buffer_load_dwordx4 v2, s[8:11], s24 offen offset:384 lds
    s_add_u32 m0, s23, 6720
    s_nop 0
    buffer_load_dwordx4 v2, s[8:11], s24 offen offset:448 lds
    s_add_u32 m0, s23, 7680
    s_nop 0
    buffer_load_dwordx4 v2, s[8:11], s24 offen offset:512 lds
    s_add_u32 s24, s24, s42
    s_mov_b32 s27, 0
    s_mov_b32 s30, s95
    s_cmp_eq_u32 s18, 0
    s_cselect_b32 s34, 1, 0
    s_mov_b32 s35, 0
    s_mov_b32 s31, 0x80000000
    v_mov_b32 v3, v1
    ds_read_b128 v[32:35], v3 offset:0
    ds_read_b128 v[36:39], v3 offset:18432
    ds_read_b128 v[40:43], v3 offset:1024
    ds_read_b128 v[44:47], v3 offset:19456
    s_cmp_eq_u32 s16, 2
    s_cbranch_scc1 qk_vloop
qk_loop:
    s_add_u32 s22, s27, 73728
    s_sub_u32 s21, s22, 147456
    s_cselect_b32 s22, s22, s21
    s_add_u32 s27, s27, 36864
    s_cmp_eq_u32 s27, 147456
    s_cselect_b32 s27, 0, s27
    s_waitcnt lgkmcnt(2)
    v_cvt_pk_bf16_f32 v8, v208, v209
    v_cvt_pk_bf16_f32 v9, v210, v211
    v_mfma_f32_16x16x32_bf16 v[208:211], v[64:67], v[32:35], 0
    ds_read_b128 v[48:51], v3 offset:2048
    ds_read_b128 v[52:55], v3 offset:20480
    v_cvt_pk_bf16_f32 v10, v212, v213
    v_cvt_pk_bf16_f32 v11, v214, v215
    v_mfma_f32_16x16x32_bf16 v[212:215], v[136:139], v[32:35], 0
    v_cvt_pk_bf16_f32 v12, v216, v217
    v_cvt_pk_bf16_f32 v13, v218, v219
    v_mfma_f32_16x16x32_bf16 v[216:219], v[64:67], v[36:39], 0
    v_cvt_pk_bf16_f32 v14, v220, v221
    v_cvt_pk_bf16_f32 v15, v222, v223
    v_mfma_f32_16x16x32_bf16 v[220:223], v[136:139], v[36:39], 0
    v_cvt_pk_bf16_f32 v16, v224, v225
    v_cvt_pk_bf16_f32 v17, v226, v227
    v_mfma_f32_16x16x32_bf16 v[224:227], a[0:3], v[32:35], 0
    v_cvt_pk_bf16_f32 v18, v228, v229
    v_cvt_pk_bf16_f32 v19, v230, v231
    v_mfma_f32_16x16x32_bf16 v[228:231], a[72:75], v[32:35], 0
    v_cvt_pk_bf16_f32 v20, v232, v233
    v_cvt_pk_bf16_f32 v21, v234, v235
    v_mfma_f32_16x16x32_bf16 v[232:235], a[0:3], v[36:39], 0
    v_cvt_pk_bf16_f32 v22, v236, v237
    v_cvt_pk_bf16_f32 v23, v238, v239
    v_mfma_f32_16x16x32_bf16 v[236:239], a[72:75], v[36:39], 0
    s_waitcnt lgkmcnt(2)
    v_mfma_f32_16x16x32_bf16 v[208:211], v[68:71], v[40:43], v[208:211]
    ds_read_b128 v[32:35], v3 offset:3072
    ds_read_b128 v[36:39], v3 offset:21504
    v_mfma_f32_16x16x32_bf16 v[212:215], v[140:143], v[40:43], v[212:215]
    v_mfma_f32_16x16x32_bf16 v[216:219], v[68:71], v[44:47], v[216:219]
    s_mov_b32 s28, s31
    buffer_store_dwordx4 v[8:11], v7, s[4:7], s28 offen sc1
    v_mfma_f32_16x16x32_bf16 v[220:223], v[140:143], v[44:47], v[220:223]
    v_mfma_f32_16x16x32_bf16 v[224:227], a[4:7], v[40:43], v[224:227]
    v_mfma_f32_16x16x32_bf16 v[228:231], a[76:79], v[40:43], v[228:231]
    v_mfma_f32_16x16x32_bf16 v[232:235], a[4:7], v[44:47], v[232:235]
    v_mfma_f32_16x16x32_bf16 v[236:239], a[76:79], v[44:47], v[236:239]
    s_waitcnt lgkmcnt(2)
    v_mfma_f32_16x16x32_bf16 v[208:211], v[72:75], v[48:51], v[208:211]
    ds_read_b128 v[40:43], v3 offset:4096
    ds_read_b128 v[44:47], v3 offset:22528
    v_mfma_f32_16x16x32_bf16 v[212:215], v[144:147], v[48:51], v[212:215]
    v_mfma_f32_16x16x32_bf16 v[216:219], v[72:75], v[52:55], v[216:219]
    s_add_u32 s28, s28, s40
    buffer_store_dwordx4 v[12:15], v7, s[4:7], s28 offen sc1
    v_mfma_f32_16x16x32_bf16 v[220:223], v[144:147], v[52:55], v[220:223]
    v_mfma_f32_16x16x32_bf16 v[224:227], a[8:11], v[48:51], v[224:227]
    v_mfma_f32_16x16x32_bf16 v[228:231], a[80:83], v[48:51], v[228:231]
    v_mfma_f32_16x16x32_bf16 v[232:235], a[8:11], v[52:55], v[232:235]
    v_mfma_f32_16x16x32_bf16 v[236:239], a[80:83], v[52:55], v[236:239]
    s_waitcnt lgkmcnt(2)
    v_mfma_f32_16x16x32_bf16 v[208:211], v[76:79], v[32:35], v[208:211]
    ds_read_b128 v[48:51], v3 offset:5120
    ds_read_b128 v[52:55], v3 offset:23552
    v_mfma_f32_16x16x32_bf16 v[212:215], v[148:151], v[32:35], v[212:215]
    v_mfma_f32_16x16x32_bf16 v[216:219], v[76:79], v[36:39], v[216:219]
    s_add_u32 s28, s31, s43
    buffer_store_dwordx4 v[16:19], v7, s[4:7], s28 offen sc1
    v_mfma_f32_16x16x32_bf16 v[220:223], v[148:151], v[36:39], v[220:223]
    v_mfma_f32_16x16x32_bf16 v[224:227], a[12:15], v[32:35], v[224:227]
    v_mfma_f32_16x16x32_bf16 v[228:231], a[84:87], v[32:35], v[228:231]
    v_mfma_f32_16x16x32_bf16 v[232:235], a[12:15], v[36:39], v[232:235]
    v_mfma_f32_16x16x32_bf16 v[236:239], a[84:87], v[36:39], v[236:239]
    s_waitcnt lgkmcnt(2)
    v_mfma_f32_16x16x32_bf16 v[208:211], v[80:83], v[40:43], v[208:211]
    ds_read_b128 v[32:35], v3 offset:6144
    ds_read_b128 v[36:39], v3 offset:24576
    v_mfma_f32_16x16x32_bf16 v[212:215], v[152:155], v[40:43], v[212:215]
    v_mfma_f32_16x16x32_bf16 v[216:219], v[80:83], v[44:47], v[216:219]
    s_add_u32 s28, s28, s40
    buffer_store_dwordx4 v[20:23], v7, s[4:7], s28 offen sc1
    v_mfma_f32_16x16x32_bf16 v[220:223], v[152:155], v[44:47], v[220:223]
    v_mfma_f32_16x16x32_bf16 v[224:227], a[16:19], v[40:43], v[224:227]
    v_mfma_f32_16x16x32_bf16 v[228:231], a[88:91], v[40:43], v[228:231]
    v_mfma_f32_16x16x32_bf16 v[232:235], a[16:19], v[44:47], v[232:235]
    v_mfma_f32_16x16x32_bf16 v[236:239], a[88:91], v[44:47], v[236:239]
    s_waitcnt lgkmcnt(2)
    v_mfma_f32_16x16x32_bf16 v[208:211], v[84:87], v[48:51], v[208:211]
    ds_read_b128 v[40:43], v3 offset:7168
    ds_read_b128 v[44:47], v3 offset:25600
    v_mfma_f32_16x16x32_bf16 v[212:215], v[156:159], v[48:51], v[212:215]
    v_mfma_f32_16x16x32_bf16 v[216:219], v[84:87], v[52:55], v[216:219]
    s_add_u32 s23, s22, s25
    s_add_u32 m0, s23, 0
    s_nop 0
    buffer_load_dwordx4 v2, s[8:11], s24 offen offset:0 lds
    v_mfma_f32_16x16x32_bf16 v[220:223], v[156:159], v[52:55], v[220:223]
    v_mfma_f32_16x16x32_bf16 v[224:227], a[20:23], v[48:51], v[224:227]
    v_mfma_f32_16x16x32_bf16 v[228:231], a[92:95], v[48:51], v[228:231]
    v_mfma_f32_16x16x32_bf16 v[232:235], a[20:23], v[52:55], v[232:235]
    v_mfma_f32_16x16x32_bf16 v[236:239], a[92:95], v[52:55], v[236:239]
    s_waitcnt lgkmcnt(2)
    v_mfma_f32_16x16x32_bf16 v[208:211], v[88:91], v[32:35], v[208:211]
    ds_read_b128 v[48:51], v3 offset:8192
    ds_read_b128 v[52:55], v3 offset:26624
    v_mfma_f32_16x16x32_bf16 v[212:215], v[160:163], v[32:35], v[212:215]
    v_mfma_f32_16x16x32_bf16 v[216:219], v[88:91], v[36:39], v[216:219]
    s_add_u32 m0, s23, 960
    s_nop 0
    buffer_load_dwordx4 v2, s[8:11], s24 offen offset:64 lds
    v_mfma_f32_16x16x32_bf16 v[220:223], v[160:163], v[36:39], v[220:223]
    v_mfma_f32_16x16x32_bf16 v[224:227], a[24:27], v[32:35], v[224:227]
    v_mfma_f32_16x16x32_bf16 v[228:231], a[96:99], v[32:35], v[228:231]
    v_mfma_f32_16x16x32_bf16 v[232:235], a[24:27], v[36:39], v[232:235]
    v_mfma_f32_16x16x32_bf16 v[236:239], a[96:99], v[36:39], v[236:239]
    s_waitcnt lgkmcnt(2)
    v_mfma_f32_16x16x32_bf16 v[208:211], v[92:95], v[40:43], v[208:211]
    ds_read_b128 v[32:35], v3 offset:9216
    ds_read_b128 v[36:39], v3 offset:27648
    v_mfma_f32_16x16x32_bf16 v[212:215], v[164:167], v[40:43], v[212:215]
    v_mfma_f32_16x16x32_bf16 v[216:219], v[92:95], v[44:47], v[216:219]
    s_add_u32 m0, s23, 1920
    s_nop 0
    buffer_load_dwordx4 v2, s[8:11], s24 offen offset:128 lds
    v_mfma_f32_16x16x32_bf16 v[220:223], v[164:167], v[44:47], v[220:223]
    v_mfma_f32_16x16x32_bf16 v[224:227], a[28:31], v[40:43], v[224:227]
    v_mfma_f32_16x16x32_bf16 v[228:231], a[100:103], v[40:43], v[228:231]
    v_mfma_f32_16x16x32_bf16 v[232:235], a[28:31], v[44:47], v[232:235]
    v_mfma_f32_16x16x32_bf16 v[236:239], a[100:103], v[44:47], v[236:239]
    s_waitcnt lgkmcnt(2)
    v_mfma_f32_16x16x32_bf16 v[208:211], v[96:99], v[48:51], v[208:211]
    ds_read_b128 v[40:43], v3 offset:10240
    ds_read_b128 v[44:47], v3 offset:28672
    v_mfma_f32_16x16x32_bf16 v[212:215], v[168:171], v[48:51], v[212:215]
    v_mfma_f32_16x16x32_bf16 v[216:219], v[96:99], v[52:55], v[216:219]
    s_add_u32 m0, s23, 2880
    s_nop 0
    buffer_load_dwordx4 v2, s[8:11], s24 offen offset:192 lds
    v_mfma_f32_16x16x32_bf16 v[220:223], v[168:171], v[52:55], v[220:223]
    v_mfma_f32_16x16x32_bf16 v[224:227], a[32:35], v[48:51], v[224:227]
    v_mfma_f32_16x16x32_bf16 v[228:231], a[104:107], v[48:51], v[228:231]
    v_mfma_f32_16x16x32_bf16 v[232:235], a[32:35], v[52:55], v[232:235]
    v_mfma_f32_16x16x32_bf16 v[236:239], a[104:107], v[52:55], v[236:239]
    s_waitcnt lgkmcnt(2)
    v_mfma_f32_16x16x32_bf16 v[208:211], v[100:103], v[32:35], v[208:211]
    ds_read_b128 v[48:51], v3 offset:11264
    ds_read_b128 v[52:55], v3 offset:29696
    v_mfma_f32_16x16x32_bf16 v[212:215], v[172:175], v[32:35], v[212:215]
    v_mfma_f32_16x16x32_bf16 v[216:219], v[100:103], v[36:39], v[216:219]
    s_add_u32 m0, s23, 3840
    s_nop 0
    buffer_load_dwordx4 v2, s[8:11], s24 offen offset:256 lds
    v_mfma_f32_16x16x32_bf16 v[220:223], v[172:175], v[36:39], v[220:223]
    v_mfma_f32_16x16x32_bf16 v[224:227], a[36:39], v[32:35], v[224:227]
    v_mfma_f32_16x16x32_bf16 v[228:231], a[108:111], v[32:35], v[228:231]
    v_mfma_f32_16x16x32_bf16 v[232:235], a[36:39], v[36:39], v[232:235]
    v_mfma_f32_16x16x32_bf16 v[236:239], a[108:111], v[36:39], v[236:239]
    s_waitcnt lgkmcnt(2)
    v_mfma_f32_16x16x32_bf16 v[208:211], v[104:107], v[40:43], v[208:211]
    ds_read_b128 v[32:35], v3 offset:12288
    ds_read_b128 v[36:39], v3 offset:30720
    v_mfma_f32_16x16x32_bf16 v[212:215], v[176:179], v[40:43], v[212:215]
    v_mfma_f32_16x16x32_bf16 v[216:219], v[104:107], v[44:47], v[216:219]
    s_add_u32 m0, s23, 4800
    s_nop 0
    buffer_load_dwordx4 v2, s[8:11], s24 offen offset:320 lds
    v_mfma_f32_16x16x32_bf16 v[220:223], v[176:179], v[44:47], v[220:223]
    v_mfma_f32_16x16x32_bf16 v[224:227], a[40:43], v[40:43], v[224:227]
    v_mfma_f32_16x16x32_bf16 v[228:231], a[112:115], v[40:43], v[228:231]
    v_mfma_f32_16x16x32_bf16 v[232:235], a[40:43], v[44:47], v[232:235]
    v_mfma_f32_16x16x32_bf16 v[236:239], a[112:115], v[44:47], v[236:239]
    s_waitcnt lgkmcnt(2)
    v_mfma_f32_16x16x32_bf16 v[208:211], v[108:111], v[48:51], v[208:211]
    ds_read_b128 v[40:43], v3 offset:13312
    ds_read_b128 v[44:47], v3 offset:31744
    v_mfma_f32_16x16x32_bf16 v[212:215], v[180:183], v[48:51], v[212:215]
    v_mfma_f32_16x16x32_bf16 v[216:219], v[108:111], v[52:55], v[216:219]
    s_add_u32 m0, s23, 5760
    s_nop 0
    buffer_load_dwordx4 v2, s[8:11], s24 offen offset:384 lds
    v_mfma_f32_16x16x32_bf16 v[220:223], v[180:183], v[52:55], v[220:223]
    v_mfma_f32_16x16x32_bf16 v[224:227], a[44:47], v[48:51], v[224:227]
    v_mfma_f32_16x16x32_bf16 v[228:231], a[116:119], v[48:51], v[228:231]
    v_mfma_f32_16x16x32_bf16 v[232:235], a[44:47], v[52:55], v[232:235]
    v_mfma_f32_16x16x32_bf16 v[236:239], a[116:119], v[52:55], v[236:239]
    s_waitcnt lgkmcnt(2)
    v_mfma_f32_16x16x32_bf16 v[208:211], v[112:115], v[32:35], v[208:211]
    ds_read_b128 v[48:51], v3 offset:14336
    ds_read_b128 v[52:55], v3 offset:32768
    v_mfma_f32_16x16x32_bf16 v[212:215], v[184:187], v[32:35], v[212:215]
    v_mfma_f32_16x16x32_bf16 v[216:219], v[112:115], v[36:39], v[216:219]
    s_add_u32 m0, s23, 6720
    s_nop 0
    buffer_load_dwordx4 v2, s[8:11], s24 offen offset:448 lds
    v_mfma_f32_16x16x32_bf16 v[220:223], v[184:187], v[36:39], v[220:223]
    v_mfma_f32_16x16x32_bf16 v[224:227], a[48:51], v[32:35], v[224:227]
    v_mfma_f32_16x16x32_bf16 v[228:231], a[120:123], v[32:35], v[228:231]
    v_mfma_f32_16x16x32_bf16 v[232:235], a[48:51], v[36:39], v[232:235]
    v_mfma_f32_16x16x32_bf16 v[236:239], a[120:123], v[36:39], v[236:239]
    s_waitcnt lgkmcnt(2)
    v_mfma_f32_16x16x32_bf16 v[208:211], v[116:119], v[40:43], v[208:211]
    ds_read_b128 v[32:35], v3 offset:15360
    ds_read_b128 v[36:39], v3 offset:33792
    v_mfma_f32_16x16x32_bf16 v[212:215], v[188:191], v[40:43], v[212:215]
    v_mfma_f32_16x16x32_bf16 v[216:219], v[116:119], v[44:47], v[216:219]
    s_add_u32 m0, s23, 7680
    s_nop 0
    buffer_load_dwordx4 v2, s[8:11], s24 offen offset:512 lds
    s_add_u32 s24, s24, s42
    v_mfma_f32_16x16x32_bf16 v[220:223], v[188:191], v[44:47], v[220:223]
    v_mfma_f32_16x16x32_bf16 v[224:227], a[52:55], v[40:43], v[224:227]
    v_mfma_f32_16x16x32_bf16 v[228:231], a[124:127], v[40:43], v[228:231]
    v_mfma_f32_16x16x32_bf16 v[232:235], a[52:55], v[44:47], v[232:235]
    v_mfma_f32_16x16x32_bf16 v[236:239], a[124:127], v[44:47], v[236:239]
    s_waitcnt lgkmcnt(2)
    v_mfma_f32_16x16x32_bf16 v[208:211], v[120:123], v[48:51], v[208:211]
    ds_read_b128 v[40:43], v3 offset:16384
    ds_read_b128 v[44:47], v3 offset:34816
    v_mfma_f32_16x16x32_bf16 v[212:215], v[192:195], v[48:51], v[212:215]
    v_mfma_f32_16x16x32_bf16 v[216:219], v[120:123], v[52:55], v[216:219]
    v_add_u32 v24, s27, v1
    v_mfma_f32_16x16x32_bf16 v[220:223], v[192:195], v[52:55], v[220:223]
    v_mfma_f32_16x16x32_bf16 v[224:227], a[56:59], v[48:51], v[224:227]
    v_mfma_f32_16x16x32_bf16 v[228:231], a[128:131], v[48:51], v[228:231]
    v_mfma_f32_16x16x32_bf16 v[232:235], a[56:59], v[52:55], v[232:235]
    v_mfma_f32_16x16x32_bf16 v[236:239], a[128:131], v[52:55], v[236:239]
    s_waitcnt lgkmcnt(2)
    v_mfma_f32_16x16x32_bf16 v[208:211], v[124:127], v[32:35], v[208:211]
    ds_read_b128 v[48:51], v3 offset:17408
    ds_read_b128 v[52:55], v3 offset:35840
    v_mfma_f32_16x16x32_bf16 v[212:215], v[196:199], v[32:35], v[212:215]
    v_mfma_f32_16x16x32_bf16 v[216:219], v[124:127], v[36:39], v[216:219]
    v_mfma_f32_16x16x32_bf16 v[220:223], v[196:199], v[36:39], v[220:223]
    v_mfma_f32_16x16x32_bf16 v[224:227], a[60:63], v[32:35], v[224:227]
    v_mfma_f32_16x16x32_bf16 v[228:231], a[132:135], v[32:35], v[228:231]
    s_waitcnt vmcnt(9)
    s_barrier
    v_mfma_f32_16x16x32_bf16 v[232:235], a[60:63], v[36:39], v[232:235]
    v_mfma_f32_16x16x32_bf16 v[236:239], a[132:135], v[36:39], v[236:239]
    s_waitcnt lgkmcnt(2)
    v_mfma_f32_16x16x32_bf16 v[208:211], v[128:131], v[40:43], v[208:211]
    ds_read_b128 v[32:35], v24 offset:0
    ds_read_b128 v[36:39], v24 offset:18432
    v_mfma_f32_16x16x32_bf16 v[212:215], v[200:203], v[40:43], v[212:215]
    v_mfma_f32_16x16x32_bf16 v[216:219], v[128:131], v[44:47], v[216:219]
    v_mov_b32 v4, s30
    s_mov_b64 exec, s[34:35]
    buffer_store_dword v4, off, s[4:7], s29 sc1
    s_mov_b64 exec, -1
    v_mfma_f32_16x16x32_bf16 v[220:223], v[200:203], v[44:47], v[220:223]
    v_mfma_f32_16x16x32_bf16 v[224:227], a[64:67], v[40:43], v[224:227]
    v_mfma_f32_16x16x32_bf16 v[228:231], a[136:139], v[40:43], v[228:231]
    v_mfma_f32_16x16x32_bf16 v[232:235], a[64:67], v[44:47], v[232:235]
    v_mfma_f32_16x16x32_bf16 v[236:239], a[136:139], v[44:47], v[236:239]
    s_waitcnt lgkmcnt(2)
    v_mfma_f32_16x16x32_bf16 v[208:211], v[132:135], v[48:51], v[208:211]
    ds_read_b128 v[40:43], v24 offset:1024
    ds_read_b128 v[44:47], v24 offset:19456
    v_mfma_f32_16x16x32_bf16 v[212:215], v[204:207], v[48:51], v[212:215]
    v_mfma_f32_16x16x32_bf16 v[216:219], v[132:135], v[52:55], v[216:219]
    v_mfma_f32_16x16x32_bf16 v[220:223], v[204:207], v[52:55], v[220:223]
    v_mfma_f32_16x16x32_bf16 v[224:227], a[68:71], v[48:51], v[224:227]
    v_mfma_f32_16x16x32_bf16 v[228:231], a[140:143], v[48:51], v[228:231]
    v_mfma_f32_16x16x32_bf16 v[232:235], a[68:71], v[52:55], v[232:235]
    v_mfma_f32_16x16x32_bf16 v[236:239], a[140:143], v[52:55], v[236:239]
    v_mov_b32 v3, v24
    s_mov_b32 s31, s26
    s_add_u32 s26, s26, s41
    s_add_u32 s30, s30, 1
    s_add_u32 s19, s19, s20
    s_cmp_lt_u32 s19, 64
    s_cbranch_scc1 qk_loop
    v_cvt_pk_bf16_f32 v8, v208, v209
    v_cvt_pk_bf16_f32 v9, v210, v211
    v_cvt_pk_bf16_f32 v10, v212, v213
    v_cvt_pk_bf16_f32 v11, v214, v215
    v_cvt_pk_bf16_f32 v12, v216, v217
    v_cvt_pk_bf16_f32 v13, v218, v219
    v_cvt_pk_bf16_f32 v14, v220, v221
    v_cvt_pk_bf16_f32 v15, v222, v223
    v_cvt_pk_bf16_f32 v16, v224, v225
    v_cvt_pk_bf16_f32 v17, v226, v227
    v_cvt_pk_bf16_f32 v18, v228, v229
    v_cvt_pk_bf16_f32 v19, v230, v231
    v_cvt_pk_bf16_f32 v20, v232, v233
    v_cvt_pk_bf16_f32 v21, v234, v235
    v_cvt_pk_bf16_f32 v22, v236, v237
    v_cvt_pk_bf16_f32 v23, v238, v239
    s_branch qk_done
    s_nop 0
qk_vloop:
    s_add_u32 s22, s27, 73728
    s_sub_u32 s21, s22, 147456
    s_cselect_b32 s22, s22, s21
    s_add_u32 s27, s27, 36864
    s_cmp_eq_u32 s27, 147456
    s_cselect_b32 s27, 0, s27
    s_waitcnt lgkmcnt(2)
    v_cvt_pk_bf16_f32 v8, v208, v209
    v_cvt_pk_bf16_f32 v9, v210, v211
    v_mfma_f32_16x16x32_bf16 v[208:211], v[32:35], v[64:67], 0
    ds_read_b128 v[48:51], v3 offset:2048
    ds_read_b128 v[52:55], v3 offset:20480
    v_cvt_pk_bf16_f32 v12, v212, v213
    v_cvt_pk_bf16_f32 v13, v214, v215
    v_mfma_f32_16x16x32_bf16 v[212:215], v[32:35], v[136:139], 0
    v_cvt_pk_bf16_f32 v10, v216, v217
    v_cvt_pk_bf16_f32 v11, v218, v219
    v_mfma_f32_16x16x32_bf16 v[216:219], v[36:39], v[64:67], 0
    v_cvt_pk_bf16_f32 v14, v220, v221
    v_cvt_pk_bf16_f32 v15, v222, v223
    v_mfma_f32_16x16x32_bf16 v[220:223], v[36:39], v[136:139], 0
    v_cvt_pk_bf16_f32 v16, v224, v225
    v_cvt_pk_bf16_f32 v17, v226, v227
    v_mfma_f32_16x16x32_bf16 v[224:227], v[32:35], a[0:3], 0
    v_cvt_pk_bf16_f32 v20, v228, v229
    v_cvt_pk_bf16_f32 v21, v230, v231
    v_mfma_f32_16x16x32_bf16 v[228:231], v[32:35], a[72:75], 0
    v_cvt_pk_bf16_f32 v18, v232, v233
    v_cvt_pk_bf16_f32 v19, v234, v235
    v_mfma_f32_16x16x32_bf16 v[232:235], v[36:39], a[0:3], 0
    v_cvt_pk_bf16_f32 v22, v236, v237
    v_cvt_pk_bf16_f32 v23, v238, v239
    v_mfma_f32_16x16x32_bf16 v[236:239], v[36:39], a[72:75], 0
    s_waitcnt lgkmcnt(2)
    v_mfma_f32_16x16x32_bf16 v[208:211], v[40:43], v[68:71], v[208:211]
    ds_read_b128 v[32:35], v3 offset:3072
    ds_read_b128 v[36:39], v3 offset:21504
    v_mfma_f32_16x16x32_bf16 v[212:215], v[40:43], v[140:143], v[212:215]
    v_mfma_f32_16x16x32_bf16 v[216:219], v[44:47], v[68:71], v[216:219]
    s_mov_b32 s28, s31
    buffer_store_dwordx4 v[8:11], v7, s[4:7], s28 offen sc1
    v_mfma_f32_16x16x32_bf16 v[220:223], v[44:47], v[140:143], v[220:223]
    v_mfma_f32_16x16x32_bf16 v[224:227], v[40:43], a[4:7], v[224:227]
    v_mfma_f32_16x16x32_bf16 v[228:231], v[40:43], a[76:79], v[228:231]
    v_mfma_f32_16x16x32_bf16 v[232:235], v[44:47], a[4:7], v[232:235]
    v_mfma_f32_16x16x32_bf16 v[236:239], v[44:47], a[76:79], v[236:239]
    s_waitcnt lgkmcnt(2)
    v_mfma_f32_16x16x32_bf16 v[208:211], v[48:51], v[72:75], v[208:211]
    ds_read_b128 v[40:43], v3 offset:4096
    ds_read_b128 v[44:47], v3 offset:22528
    v_mfma_f32_16x16x32_bf16 v[212:215], v[48:51], v[144:147], v[212:215]
    v_mfma_f32_16x16x32_bf16 v[216:219], v[52:55], v[72:75], v[216:219]
    s_add_u32 s28, s28, s40
    buffer_store_dwordx4 v[12:15], v7, s[4:7], s28 offen sc1
    v_mfma_f32_16x16x32_bf16 v[220:223], v[52:55], v[144:147], v[220:223]
    v_mfma_f32_16x16x32_bf16 v[224:227], v[48:51], a[8:11], v[224:227]
    v_mfma_f32_16x16x32_bf16 v[228:231], v[48:51], a[80:83], v[228:231]
    v_mfma_f32_16x16x32_bf16 v[232:235], v[52:55], a[8:11], v[232:235]
    v_mfma_f32_16x16x32_bf16 v[236:239], v[52:55], a[80:83], v[236:239]
    s_waitcnt lgkmcnt(2)
    v_mfma_f32_16x16x32_bf16 v[208:211], v[32:35], v[76:79], v[208:211]
    ds_read_b128 v[48:51], v3 offset:5120
    ds_read_b128 v[52:55], v3 offset:23552
    v_mfma_f32_16x16x32_bf16 v[212:215], v[32:35], v[148:151], v[212:215]
    v_mfma_f32_16x16x32_bf16 v[216:219], v[36:39], v[76:79], v[216:219]
    s_add_u32 s28, s31, s43
    buffer_store_dwordx4 v[16:19], v7, s[4:7], s28 offen sc1
    v_mfma_f32_16x16x32_bf16 v[220:223], v[36:39], v[148:151], v[220:223]
    v_mfma_f32_16x16x32_bf16 v[224:227], v[32:35], a[12:15], v[224:227]
    v_mfma_f32_16x16x32_bf16 v[228:231], v[32:35], a[84:87], v[228:231]
    v_mfma_f32_16x16x32_bf16 v[232:235], v[36:39], a[12:15], v[232:235]
    v_mfma_f32_16x16x32_bf16 v[236:239], v[36:39], a[84:87], v[236:239]
    s_waitcnt lgkmcnt(2)
    v_mfma_f32_16x16x32_bf16 v[208:211], v[40:43], v[80:83], v[208:211]
    ds_read_b128 v[32:35], v3 offset:6144
    ds_read_b128 v[36:39], v3 offset:24576
    v_mfma_f32_16x16x32_bf16 v[212:215], v[40:43], v[152:155], v[212:215]
    v_mfma_f32_16x16x32_bf16 v[216:219], v[44:47], v[80:83], v[216:219]
    s_add_u32 s28, s28, s40
    buffer_store_dwordx4 v[20:23], v7, s[4:7], s28 offen sc1
    v_mfma_f32_16x16x32_bf16 v[220:223], v[44:47], v[152:155], v[220:223]
    v_mfma_f32_16x16x32_bf16 v[224:227], v[40:43], a[16:19], v[224:227]
    v_mfma_f32_16x16x32_bf16 v[228:231], v[40:43], a[88:91], v[228:231]
    v_mfma_f32_16x16x32_bf16 v[232:235], v[44:47], a[16:19], v[232:235]
    v_mfma_f32_16x16x32_bf16 v[236:239], v[44:47], a[88:91], v[236:239]
    s_waitcnt lgkmcnt(2)
    v_mfma_f32_16x16x32_bf16 v[208:211], v[48:51], v[84:87], v[208:211]
    ds_read_b128 v[40:43], v3 offset:7168
    ds_read_b128 v[44:47], v3 offset:25600
    v_mfma_f32_16x16x32_bf16 v[212:215], v[48:51], v[156:159], v[212:215]
    v_mfma_f32_16x16x32_bf16 v[216:219], v[52:55], v[84:87], v[216:219]
    s_add_u32 s23, s22, s25
    s_add_u32 m0, s23, 0
    s_nop 0
    buffer_load_dwordx4 v2, s[8:11], s24 offen offset:0 lds
    v_mfma_f32_16x16x32_bf16 v[220:223], v[52:55], v[156:159], v[220:223]
    v_mfma_f32_16x16x32_bf16 v[224:227], v[48:51], a[20:23], v[224:227]
    v_mfma_f32_16x16x32_bf16 v[228:231], v[48:51], a[92:95], v[228:231]
    v_mfma_f32_16x16x32_bf16 v[232:235], v[52:55], a[20:23], v[232:235]
    v_mfma_f32_16x16x32_bf16 v[236:239], v[52:55], a[92:95], v[236:239]
    s_waitcnt lgkmcnt(2)
    v_mfma_f32_16x16x32_bf16 v[208:211], v[32:35], v[88:91], v[208:211]
    ds_read_b128 v[48:51], v3 offset:8192
    ds_read_b128 v[52:55], v3 offset:26624
    v_mfma_f32_16x16x32_bf16 v[212:215], v[32:35], v[160:163], v[212:215]
    v_mfma_f32_16x16x32_bf16 v[216:219], v[36:39], v[88:91], v[216:219]
    s_add_u32 m0, s23, 960
    s_nop 0
    buffer_load_dwordx4 v2, s[8:11], s24 offen offset:64 lds
    v_mfma_f32_16x16x32_bf16 v[220:223], v[36:39], v[160:163], v[220:223]
    v_mfma_f32_16x16x32_bf16 v[224:227], v[32:35], a[24:27], v[224:227]
    v_mfma_f32_16x16x32_bf16 v[228:231], v[32:35], a[96:99], v[228:231]
    v_mfma_f32_16x16x32_bf16 v[232:235], v[36:39], a[24:27], v[232:235]
    v_mfma_f32_16x16x32_bf16 v[236:239], v[36:39], a[96:99], v[236:239]
    s_waitcnt lgkmcnt(2)
    v_mfma_f32_16x16x32_bf16 v[208:211], v[40:43], v[92:95], v[208:211]
    ds_read_b128 v[32:35], v3 offset:9216
    ds_read_b128 v[36:39], v3 offset:27648
    v_mfma_f32_16x16x32_bf16 v[212:215], v[40:43], v[164:167], v[212:215]
    v_mfma_f32_16x16x32_bf16 v[216:219], v[44:47], v[92:95], v[216:219]
    s_add_u32 m0, s23, 1920
    s_nop 0
    buffer_load_dwordx4 v2, s[8:11], s24 offen offset:128 lds
    v_mfma_f32_16x16x32_bf16 v[220:223], v[44:47], v[164:167], v[220:223]
    v_mfma_f32_16x16x32_bf16 v[224:227], v[40:43], a[28:31], v[224:227]
    v_mfma_f32_16x16x32_bf16 v[228:231], v[40:43], a[100:103], v[228:231]
    v_mfma_f32_16x16x32_bf16 v[232:235], v[44:47], a[28:31], v[232:235]
    v_mfma_f32_16x16x32_bf16 v[236:239], v[44:47], a[100:103], v[236:239]
    s_waitcnt lgkmcnt(2)
    v_mfma_f32_16x16x32_bf16 v[208:211], v[48:51], v[96:99], v[208:211]
    ds_read_b128 v[40:43], v3 offset:10240
    ds_read_b128 v[44:47], v3 offset:28672
    v_mfma_f32_16x16x32_bf16 v[212:215], v[48:51], v[168:171], v[212:215]
    v_mfma_f32_16x16x32_bf16 v[216:219], v[52:55], v[96:99], v[216:219]
    s_add_u32 m0, s23, 2880
    s_nop 0
    buffer_load_dwordx4 v2, s[8:11], s24 offen offset:192 lds
    v_mfma_f32_16x16x32_bf16 v[220:223], v[52:55], v[168:171], v[220:223]
    v_mfma_f32_16x16x32_bf16 v[224:227], v[48:51], a[32:35], v[224:227]
    v_mfma_f32_16x16x32_bf16 v[228:231], v[48:51], a[104:107], v[228:231]
    v_mfma_f32_16x16x32_bf16 v[232:235], v[52:55], a[32:35], v[232:235]
    v_mfma_f32_16x16x32_bf16 v[236:239], v[52:55], a[104:107], v[236:239]
    s_waitcnt lgkmcnt(2)
    v_mfma_f32_16x16x32_bf16 v[208:211], v[32:35], v[100:103], v[208:211]
    ds_read_b128 v[48:51], v3 offset:11264
    ds_read_b128 v[52:55], v3 offset:29696
    v_mfma_f32_16x16x32_bf16 v[212:215], v[32:35], v[172:175], v[212:215]
    v_mfma_f32_16x16x32_bf16 v[216:219], v[36:39], v[100:103], v[216:219]
    s_add_u32 m0, s23, 3840
    s_nop 0
    buffer_load_dwordx4 v2, s[8:11], s24 offen offset:256 lds
    v_mfma_f32_16x16x32_bf16 v[220:223], v[36:39], v[172:175], v[220:223]
    v_mfma_f32_16x16x32_bf16 v[224:227], v[32:35], a[36:39], v[224:227]
    v_mfma_f32_16x16x32_bf16 v[228:231], v[32:35], a[108:111], v[228:231]
    v_mfma_f32_16x16x32_bf16 v[232:235], v[36:39], a[36:39], v[232:235]
    v_mfma_f32_16x16x32_bf16 v[236:239], v[36:39], a[108:111], v[236:239]
    s_waitcnt lgkmcnt(2)
    v_mfma_f32_16x16x32_bf16 v[208:211], v[40:43], v[104:107], v[208:211]
    ds_read_b128 v[32:35], v3 offset:12288
    ds_read_b128 v[36:39], v3 offset:30720
    v_mfma_f32_16x16x32_bf16 v[212:215], v[40:43], v[176:179], v[212:215]
    v_mfma_f32_16x16x32_bf16 v[216:219], v[44:47], v[104:107], v[216:219]
    s_add_u32 m0, s23, 4800
    s_nop 0
    buffer_load_dwordx4 v2, s[8:11], s24 offen offset:320 lds
    v_mfma_f32_16x16x32_bf16 v[220:223], v[44:47], v[176:179], v[220:223]
    v_mfma_f32_16x16x32_bf16 v[224:227], v[40:43], a[40:43], v[224:227]
    v_mfma_f32_16x16x32_bf16 v[228:231], v[40:43], a[112:115], v[228:231]
    v_mfma_f32_16x16x32_bf16 v[232:235], v[44:47], a[40:43], v[232:235]
    v_mfma_f32_16x16x32_bf16 v[236:239], v[44:47], a[112:115], v[236:239]
    s_waitcnt lgkmcnt(2)
    v_mfma_f32_16x16x32_bf16 v[208:211], v[48:51], v[108:111], v[208:211]
    ds_read_b128 v[40:43], v3 offset:13312
    ds_read_b128 v[44:47], v3 offset:31744
    v_mfma_f32_16x16x32_bf16 v[212:215], v[48:51], v[180:183], v[212:215]
    v_mfma_f32_16x16x32_bf16 v[216:219], v[52:55], v[108:111], v[216:219]
    s_add_u32 m0, s23, 5760
    s_nop 0
    buffer_load_dwordx4 v2, s[8:11], s24 offen offset:384 lds
    v_mfma_f32_16x16x32_bf16 v[220:223], v[52:55], v[180:183], v[220:223]
    v_mfma_f32_16x16x32_bf16 v[224:227], v[48:51], a[44:47], v[224:227]
    v_mfma_f32_16x16x32_bf16 v[228:231], v[48:51], a[116:119], v[228:231]
    v_mfma_f32_16x16x32_bf16 v[232:235], v[52:55], a[44:47], v[232:235]
    v_mfma_f32_16x16x32_bf16 v[236:239], v[52:55], a[116:119], v[236:239]
    s_waitcnt lgkmcnt(2)
    v_mfma_f32_16x16x32_bf16 v[208:211], v[32:35], v[112:115], v[208:211]
    ds_read_b128 v[48:51], v3 offset:14336
    ds_read_b128 v[52:55], v3 offset:32768
    v_mfma_f32_16x16x32_bf16 v[212:215], v[32:35], v[184:187], v[212:215]
    v_mfma_f32_16x16x32_bf16 v[216:219], v[36:39], v[112:115], v[216:219]
    s_add_u32 m0, s23, 6720
    s_nop 0
    buffer_load_dwordx4 v2, s[8:11], s24 offen offset:448 lds
    v_mfma_f32_16x16x32_bf16 v[220:223], v[36:39], v[184:187], v[220:223]
    v_mfma_f32_16x16x32_bf16 v[224:227], v[32:35], a[48:51], v[224:227]
    v_mfma_f32_16x16x32_bf16 v[228:231], v[32:35], a[120:123], v[228:231]
    v_mfma_f32_16x16x32_bf16 v[232:235], v[36:39], a[48:51], v[232:235]
    v_mfma_f32_16x16x32_bf16 v[236:239], v[36:39], a[120:123], v[236:239]
    s_waitcnt lgkmcnt(2)
    v_mfma_f32_16x16x32_bf16 v[208:211], v[40:43], v[116:119], v[208:211]
    ds_read_b128 v[32:35], v3 offset:15360
    ds_read_b128 v[36:39], v3 offset:33792
    v_mfma_f32_16x16x32_bf16 v[212:215], v[40:43], v[188:191], v[212:215]
    v_mfma_f32_16x16x32_bf16 v[216:219], v[44:47], v[116:119], v[216:219]
    s_add_u32 m0, s23, 7680
    s_nop 0
    buffer_load_dwordx4 v2, s[8:11], s24 offen offset:512 lds
    s_add_u32 s24, s24, s42
    v_mfma_f32_16x16x32_bf16 v[220:223], v[44:47], v[188:191], v[220:223]
    v_mfma_f32_16x16x32_bf16 v[224:227], v[40:43], a[52:55], v[224:227]
    v_mfma_f32_16x16x32_bf16 v[228:231], v[40:43], a[124:127], v[228:231]
    v_mfma_f32_16x16x32_bf16 v[232:235], v[44:47], a[52:55], v[232:235]
    v_mfma_f32_16x16x32_bf16 v[236:239], v[44:47], a[124:127], v[236:239]
    s_waitcnt lgkmcnt(2)
    v_mfma_f32_16x16x32_bf16 v[208:211], v[48:51], v[120:123], v[208:211]
    ds_read_b128 v[40:43], v3 offset:16384
    ds_read_b128 v[44:47], v3 offset:34816
    v_mfma_f32_16x16x32_bf16 v[212:215], v[48:51], v[192:195], v[212:215]
    v_mfma_f32_16x16x32_bf16 v[216:219], v[52:55], v[120:123], v[216:219]
    v_add_u32 v24, s27, v1
    v_mfma_f32_16x16x32_bf16 v[220:223], v[52:55], v[192:195], v[220:223]
    v_mfma_f32_16x16x32_bf16 v[224:227], v[48:51], a[56:59], v[224:227]
    v_mfma_f32_16x16x32_bf16 v[228:231], v[48:51], a[128:131], v[228:231]
    v_mfma_f32_16x16x32_bf16 v[232:235], v[52:55], a[56:59], v[232:235]
    v_mfma_f32_16x16x32_bf16 v[236:239], v[52:55], a[128:131], v[236:239]
    s_waitcnt lgkmcnt(2)
    v_mfma_f32_16x16x32_bf16 v[208:211], v[32:35], v[124:127], v[208:211]
    ds_read_b128 v[48:51], v3 offset:17408
    ds_read_b128 v[52:55], v3 offset:35840
    v_mfma_f32_16x16x32_bf16 v[212:215], v[32:35], v[196:199], v[212:215]
    v_mfma_f32_16x16x32_bf16 v[216:219], v[36:39], v[124:127], v[216:219]
    v_mfma_f32_16x16x32_bf16 v[220:223], v[36:39], v[196:199], v[220:223]
    v_mfma_f32_16x16x32_bf16 v[224:227], v[32:35], a[60:63], v[224:227]
    v_mfma_f32_16x16x32_bf16 v[228:231], v[32:35], a[132:135], v[228:231]
    s_waitcnt vmcnt(9)
    s_barrier
    v_mfma_f32_16x16x32_bf16 v[232:235], v[36:39], a[60:63], v[232:235]
    v_mfma_f32_16x16x32_bf16 v[236:239], v[36:39], a[132:135], v[236:239]
    s_waitcnt lgkmcnt(2)
    v_mfma_f32_16x16x32_bf16 v[208:211], v[40:43], v[128:131], v[208:211]
    ds_read_b128 v[32:35], v24 offset:0
    ds_read_b128 v[36:39], v24 offset:18432
    v_mfma_f32_16x16x32_bf16 v[212:215], v[40:43], v[200:203], v[212:215]
    v_mfma_f32_16x16x32_bf16 v[216:219], v[44:47], v[128:131], v[216:219]
    v_mov_b32 v4, s30
    s_mov_b64 exec, s[34:35]
    buffer_store_dword v4, off, s[4:7], s29 sc1
    s_mov_b64 exec, -1
    v_mfma_f32_16x16x32_bf16 v[220:223], v[44:47], v[200:203], v[220:223]
    v_mfma_f32_16x16x32_bf16 v[224:227], v[40:43], a[64:67], v[224:227]
    v_mfma_f32_16x16x32_bf16 v[228:231], v[40:43], a[136:139], v[228:231]
    v_mfma_f32_16x16x32_bf16 v[232:235], v[44:47], a[64:67], v[232:235]
    v_mfma_f32_16x16x32_bf16 v[236:239], v[44:47], a[136:139], v[236:239]
    s_waitcnt lgkmcnt(2)
    v_mfma_f32_16x16x32_bf16 v[208:211], v[48:51], v[132:135], v[208:211]
    ds_read_b128 v[40:43], v24 offset:1024
    ds_read_b128 v[44:47], v24 offset:19456
    v_mfma_f32_16x16x32_bf16 v[212:215], v[48:51], v[204:207], v[212:215]
    v_mfma_f32_16x16x32_bf16 v[216:219], v[52:55], v[132:135], v[216:219]
    v_mfma_f32_16x16x32_bf16 v[220:223], v[52:55], v[204:207], v[220:223]
    v_mfma_f32_16x16x32_bf16 v[224:227], v[48:51], a[68:71], v[224:227]
    v_mfma_f32_16x16x32_bf16 v[228:231], v[48:51], a[140:143], v[228:231]
    v_mfma_f32_16x16x32_bf16 v[232:235], v[52:55], a[68:71], v[232:235]
    v_mfma_f32_16x16x32_bf16 v[236:239], v[52:55], a[140:143], v[236:239]
    v_mov_b32 v3, v24
    s_mov_b32 s31, s26
    s_add_u32 s26, s26, s41
    s_add_u32 s30, s30, 1
    s_add_u32 s19, s19, s20
    s_cmp_lt_u32 s19, 64
    s_cbranch_scc1 qk_vloop
    v_cvt_pk_bf16_f32 v8, v208, v209
    v_cvt_pk_bf16_f32 v9, v210, v211
    v_cvt_pk_bf16_f32 v12, v212, v213
    v_cvt_pk_bf16_f32 v13, v214, v215
    v_cvt_pk_bf16_f32 v10, v216, v217
    v_cvt_pk_bf16_f32 v11, v218, v219
    v_cvt_pk_bf16_f32 v14, v220, v221
    v_cvt_pk_bf16_f32 v15, v222, v223
    v_cvt_pk_bf16_f32 v16, v224, v225
    v_cvt_pk_bf16_f32 v17, v226, v227
    v_cvt_pk_bf16_f32 v20, v228, v229
    v_cvt_pk_bf16_f32 v21, v230, v231
    v_cvt_pk_bf16_f32 v18, v232, v233
    v_cvt_pk_bf16_f32 v19, v234, v235
    v_cvt_pk_bf16_f32 v22, v236, v237
    v_cvt_pk_bf16_f32 v23, v238, v239
qk_done:
    s_mov_b32 s28, s31
    buffer_store_dwordx4 v[8:11], v7, s[4:7], s28 offen sc1
    s_add_u32 s28, s28, s40
    buffer_store_dwordx4 v[12:15], v7, s[4:7], s28 offen sc1
    s_add_u32 s28, s31, s43
    buffer_store_dwordx4 v[16:19], v7, s[4:7], s28 offen sc1
    s_add_u32 s28, s28, s40
    buffer_store_dwordx4 v[20:23], v7, s[4:7], s28 offen sc1
    s_waitcnt vmcnt(0) lgkmcnt(0)
    s_barrier
    s_add_u32 s22, s95, 63
    v_mov_b32 v4, s22
    s_mov_b64 exec, s[34:35]
    buffer_store_dword v4, off, s[4:7], s29 sc1
    s_mov_b64 exec, -1
    s_cmp_eq_u32 s16, 0
    s_cbranch_scc1 qk_nq
    s_add_u32 s29, s29, 4096
    v_mov_b32 v4, s22
    s_mov_b64 exec, s[34:35]
    buffer_store_dword v4, off, s[4:7], s29 sc1
    s_mov_b64 exec, -1
qk_nq:
    s_cmp_ge_u32 s36, 64
    s_cbranch_scc1 L_qkv_next
    s_lshr_b32 s33, s36, 5
    v_and_b32 v4, 63, v0
    v_lshrrev_b32 v5, 4, v4
    v_add_u32 v1, 0, v5
    v_mul_u32_u24 v6, 11, v1
    v_lshrrev_b32 v6, 5, v6
    v_add_u32 v1, v1, v6
    v_lshlrev_b32 v1, 7, v1
    v_and_b32 v6, 7, v4
    v_lshl_add_u32 v1, v6, 4, v1
    v_add_u32 v2, 4, v5
    v_mul_u32_u24 v6, 11, v2
    v_lshrrev_b32 v6, 5, v6
    v_add_u32 v2, v2, v6
    v_lshlrev_b32 v2, 7, v2
    v_and_b32 v6, 7, v4
    v_lshl_add_u32 v2, v6, 4, v2
    v_add_u32 v3, 8, v5
    v_mul_u32_u24 v6, 11, v3
    v_lshrrev_b32 v6, 5, v6
    v_add_u32 v3, v3, v6
    v_lshlrev_b32 v3, 7, v3
    v_and_b32 v6, 7, v4
    v_lshl_add_u32 v3, v6, 4, v3
    v_min_u32 v6, 23, v4
    v_lshlrev_b32 v6, 9, v6
    s_mov_b32 s19, s33
    s_mul_i32 s24, s19, 12288
    s_add_u32 s24, s24, 90177536
    s_lshl_b32 s26, s19, 5
    s_add_u32 s26, s26, s17
    s_lshl_b32 s26, s26, 12
    s_mov_b32 s21, 71303168
    s_cmp_eq_u32 s16, 2
    s_cselect_b32 s21, 80740352, s21
    s_add_u32 s26, s26, s21
    s_lshl_b32 s29, s17, 7
    s_lshl_b32 s21, s16, 1
    s_add_u32 s21, s21, s33
    s_lshl_b32 s21, s21, 2
    s_add_u32 s29, s29, s21
    s_add_u32 s29, s29, 125829240
mk_loop:
    s_cmp_lg_u32 s18, 0
    s_cbranch_scc1 mk_go
    s_mov_b32 s23, s24
    s_mov_b32 s21, 4194304
mk_wait:
    buffer_load_dword v4, v6, s[4:7], s23 offen offset:384 sc1
    s_sub_u32 s21, s21, 1
    s_cbranch_scc1 mk_go
    s_waitcnt vmcnt(0)
    v_cmp_ne_u32 vcc, s95, v4
    s_cbranch_vccz mk_go
    s_sleep 4
    s_branch mk_wait
mk_go:
    s_barrier
    s_mov_b32 s30, 4096
mk_again:
    v_mov_b32 v5, 0
    s_add_u32 s23, s24, 0
    buffer_load_dwordx4 v[24:27], v1, s[4:7], s23 offen offset:0 sc1
    buffer_load_dwordx4 v[28:31], v2, s[4:7], s23 offen offset:0 sc1
    buffer_load_dwordx4 v[32:35], v3, s[4:7], s23 offen offset:0 sc1
    buffer_load_dwordx4 v[36:39], v1, s[4:7], s23 offen offset:2048 sc1
    buffer_load_dwordx4 v[40:43], v2, s[4:7], s23 offen offset:2048 sc1
    buffer_load_dwordx4 v[44:47], v3, s[4:7], s23 offen offset:2048 sc1
    s_add_u32 s23, s24, 4096
    buffer_load_dwordx4 v[48:51], v1, s[4:7], s23 offen offset:0 sc1
    buffer_load_dwordx4 v[52:55], v2, s[4:7], s23 offen offset:0 sc1
    buffer_load_dwordx4 v[56:59], v3, s[4:7], s23 offen offset:0 sc1
    buffer_load_dwordx4 v[60:63], v1, s[4:7], s23 offen offset:2048 sc1
    buffer_load_dwordx4 v[208:211], v2, s[4:7], s23 offen offset:2048 sc1
    buffer_load_dwordx4 v[212:215], v3, s[4:7], s23 offen offset:2048 sc1
    s_add_u32 s23, s24, 8192
    buffer_load_dwordx4 v[216:219], v1, s[4:7], s23 offen offset:0 sc1
    buffer_load_dwordx4 v[220:223], v2, s[4:7], s23 offen offset:0 sc1
    buffer_load_dwordx4 v[224:227], v3, s[4:7], s23 offen offset:0 sc1
    buffer_load_dwordx4 v[228:231], v1, s[4:7], s23 offen offset:2048 sc1
    buffer_load_dwordx4 v[232:235], v2, s[4:7], s23 offen offset:2048 sc1
    buffer_load_dwordx4 v[236:239], v3, s[4:7], s23 offen offset:2048 sc1
    s_add_u32 s22, s19, s95
    s_add_u32 s22, s22, 1
    s_cmp_eq_u32 s16, 2
    s_cbranch_scc1 mk_v
    s_waitcnt vmcnt(17)
    v_mfma_f32_16x16x32_bf16 v[8:11], v[64:67], v[24:27], 0
    v_mfma_f32_16x16x32_bf16 v[12:15], v[136:139], v[24:27], 0
    v_max3_u32 v5, v5, v24, v25
    v_mfma_f32_16x16x32_bf16 v[16:19], a[0:3], v[24:27], 0
    v_mfma_f32_16x16x32_bf16 v[20:23], a[72:75], v[24:27], 0
    v_max3_u32 v5, v5, v26, v27
    s_waitcnt vmcnt(16)
    v_mfma_f32_16x16x32_bf16 v[8:11], v[68:71], v[28:31], v[8:11]
    v_mfma_f32_16x16x32_bf16 v[12:15], v[140:143], v[28:31], v[12:15]
    v_max3_u32 v5, v5, v28, v29
    v_mfma_f32_16x16x32_bf16 v[16:19], a[4:7], v[28:31], v[16:19]
    v_mfma_f32_16x16x32_bf16 v[20:23], a[76:79], v[28:31], v[20:23]
    v_max3_u32 v5, v5, v30, v31
    s_waitcnt vmcnt(15)
    v_mfma_f32_16x16x32_bf16 v[8:11], v[72:75], v[32:35], v[8:11]
    v_mfma_f32_16x16x32_bf16 v[12:15], v[144:147], v[32:35], v[12:15]
    v_max3_u32 v5, v5, v32, v33
    v_mfma_f32_16x16x32_bf16 v[16:19], a[8:11], v[32:35], v[16:19]
    v_mfma_f32_16x16x32_bf16 v[20:23], a[80:83], v[32:35], v[20:23]
    v_max3_u32 v5, v5, v34, v35
    s_waitcnt vmcnt(14)
    v_mfma_f32_16x16x32_bf16 v[8:11], v[76:79], v[36:39], v[8:11]
    v_mfma_f32_16x16x32_bf16 v[12:15], v[148:151], v[36:39], v[12:15]
    v_max3_u32 v5, v5, v36, v37
    v_mfma_f32_16x16x32_bf16 v[16:19], a[12:15], v[36:39], v[16:19]
    v_mfma_f32_16x16x32_bf16 v[20:23], a[84:87], v[36:39], v[20:23]
    v_max3_u32 v5, v5, v38, v39
    s_waitcnt vmcnt(13)
    v_mfma_f32_16x16x32_bf16 v[8:11], v[80:83], v[40:43], v[8:11]
    v_mfma_f32_16x16x32_bf16 v[12:15], v[152:155], v[40:43], v[12:15]
    v_max3_u32 v5, v5, v40, v41
    v_mfma_f32_16x16x32_bf16 v[16:19], a[16:19], v[40:43], v[16:19]
    v_mfma_f32_16x16x32_bf16 v[20:23], a[88:91], v[40:43], v[20:23]
    v_max3_u32 v5, v5, v42, v43
    s_waitcnt vmcnt(12)
    v_mfma_f32_16x16x32_bf16 v[8:11], v[84:87], v[44:47], v[8:11]
    v_mfma_f32_16x16x32_bf16 v[12:15], v[156:159], v[44:47], v[12:15]
    v_max3_u32 v5, v5, v44, v45
    v_mfma_f32_16x16x32_bf16 v[16:19], a[20:23], v[44:47], v[16:19]
    v_mfma_f32_16x16x32_bf16 v[20:23], a[92:95], v[44:47], v[20:23]
    v_max3_u32 v5, v5, v46, v47
    s_waitcnt vmcnt(11)
    v_mfma_f32_16x16x32_bf16 v[8:11], v[88:91], v[48:51], v[8:11]
    v_mfma_f32_16x16x32_bf16 v[12:15], v[160:163], v[48:51], v[12:15]
    v_max3_u32 v5, v5, v48, v49
    v_mfma_f32_16x16x32_bf16 v[16:19], a[24:27], v[48:51], v[16:19]
    v_mfma_f32_16x16x32_bf16 v[20:23], a[96:99], v[48:51], v[20:23]
    v_max3_u32 v5, v5, v50, v51
    s_waitcnt vmcnt(10)
    v_mfma_f32_16x16x32_bf16 v[8:11], v[92:95], v[52:55], v[8:11]
    v_mfma_f32_16x16x32_bf16 v[12:15], v[164:167], v[52:55], v[12:15]
    v_max3_u32 v5, v5, v52, v53
    v_mfma_f32_16x16x32_bf16 v[16:19], a[28:31], v[52:55], v[16:19]
    v_mfma_f32_16x16x32_bf16 v[20:23], a[100:103], v[52:55], v[20:23]
    v_max3_u32 v5, v5, v54, v55
    s_waitcnt vmcnt(9)
    v_mfma_f32_16x16x32_bf16 v[8:11], v[96:99], v[56:59], v[8:11]
    v_mfma_f32_16x16x32_bf16 v[12:15], v[168:171], v[56:59], v[12:15]
    v_max3_u32 v5, v5, v56, v57
    v_mfma_f32_16x16x32_bf16 v[16:19], a[32:35], v[56:59], v[16:19]
    v_mfma_f32_16x16x32_bf16 v[20:23], a[104:107], v[56:59], v[20:23]
    v_max3_u32 v5, v5, v58, v59
    s_waitcnt vmcnt(8)
    v_mfma_f32_16x16x32_bf16 v[8:11], v[100:103], v[60:63], v[8:11]
    v_mfma_f32_16x16x32_bf16 v[12:15], v[172:175], v[60:63], v[12:15]
    v_max3_u32 v5, v5, v60, v61
    v_mfma_f32_16x16x32_bf16 v[16:19], a[36:39], v[60:63], v[16:19]
    v_mfma_f32_16x16x32_bf16 v[20:23], a[108:111], v[60:63], v[20:23]
    v_max3_u32 v5, v5, v62, v63
    s_waitcnt vmcnt(7)
    v_mfma_f32_16x16x32_bf16 v[8:11], v[104:107], v[208:211], v[8:11]
    v_mfma_f32_16x16x32_bf16 v[12:15], v[176:179], v[208:211], v[12:15]
    v_max3_u32 v5, v5, v208, v209
    v_mfma_f32_16x16x32_bf16 v[16:19], a[40:43], v[208:211], v[16:19]
    v_mfma_f32_16x16x32_bf16 v[20:23], a[112:115], v[208:211], v[20:23]
    v_max3_u32 v5, v5, v210, v211
    s_waitcnt vmcnt(6)
    v_mfma_f32_16x16x32_bf16 v[8:11], v[108:111], v[212:215], v[8:11]
    v_mfma_f32_16x16x32_bf16 v[12:15], v[180:183], v[212:215], v[12:15]
    v_max3_u32 v5, v5, v212, v213
    v_mfma_f32_16x16x32_bf16 v[16:19], a[44:47], v[212:215], v[16:19]
    v_mfma_f32_16x16x32_bf16 v[20:23], a[116:119], v[212:215], v[20:23]
    v_max3_u32 v5, v5, v214, v215
    s_waitcnt vmcnt(5)
    v_mfma_f32_16x16x32_bf16 v[8:11], v[112:115], v[216:219], v[8:11]
    v_mfma_f32_16x16x32_bf16 v[12:15], v[184:187], v[216:219], v[12:15]
    v_max3_u32 v5, v5, v216, v217
    v_mfma_f32_16x16x32_bf16 v[16:19], a[48:51], v[216:219], v[16:19]
    v_mfma_f32_16x16x32_bf16 v[20:23], a[120:123], v[216:219], v[20:23]
    v_max3_u32 v5, v5, v218, v219
    s_waitcnt vmcnt(4)
    v_mfma_f32_16x16x32_bf16 v[8:11], v[116:119], v[220:223], v[8:11]
    v_mfma_f32_16x16x32_bf16 v[12:15], v[188:191], v[220:223], v[12:15]
    v_max3_u32 v5, v5, v220, v221
    v_mfma_f32_16x16x32_bf16 v[16:19], a[52:55], v[220:223], v[16:19]
    v_mfma_f32_16x16x32_bf16 v[20:23], a[124:127], v[220:223], v[20:23]
    v_max3_u32 v5, v5, v222, v223
    s_waitcnt vmcnt(3)
    v_mfma_f32_16x16x32_bf16 v[8:11], v[120:123], v[224:227], v[8:11]
    v_mfma_f32_16x16x32_bf16 v[12:15], v[192:195], v[224:227], v[12:15]
    v_max3_u32 v5, v5, v224, v225
    v_mfma_f32_16x16x32_bf16 v[16:19], a[56:59], v[224:227], v[16:19]
    v_mfma_f32_16x16x32_bf16 v[20:23], a[128:131], v[224:227], v[20:23]
    v_max3_u32 v5, v5, v226, v227
    s_waitcnt vmcnt(2)
    v_mfma_f32_16x16x32_bf16 v[8:11], v[124:127], v[228:231], v[8:11]
    v_mfma_f32_16x16x32_bf16 v[12:15], v[196:199], v[228:231], v[12:15]
    v_max3_u32 v5, v5, v228, v229
    v_mfma_f32_16x16x32_bf16 v[16:19], a[60:63], v[228:231], v[16:19]
    v_mfma_f32_16x16x32_bf16 v[20:23], a[132:135], v[228:231], v[20:23]
    v_max3_u32 v5, v5, v230, v231
    s_waitcnt vmcnt(1)
    v_mfma_f32_16x16x32_bf16 v[8:11], v[128:131], v[232:235], v[8:11]
    v_mfma_f32_16x16x32_bf16 v[12:15], v[200:203], v[232:235], v[12:15]
    v_max3_u32 v5, v5, v232, v233
    v_mfma_f32_16x16x32_bf16 v[16:19], a[64:67], v[232:235], v[16:19]
    v_mfma_f32_16x16x32_bf16 v[20:23], a[136:139], v[232:235], v[20:23]
    v_max3_u32 v5, v5, v234, v235
    s_waitcnt vmcnt(0)
    v_mfma_f32_16x16x32_bf16 v[8:11], v[132:135], v[236:239], v[8:11]
    v_mfma_f32_16x16x32_bf16 v[12:15], v[204:207], v[236:239], v[12:15]
    v_max3_u32 v5, v5, v236, v237
    v_mfma_f32_16x16x32_bf16 v[16:19], a[68:71], v[236:239], v[16:19]
    v_mfma_f32_16x16x32_bf16 v[20:23], a[140:143], v[236:239], v[20:23]
    v_max3_u32 v5, v5, v238, v239
    s_nop 5
    s_branch mk_st
mk_v:
    s_waitcnt vmcnt(17)
    v_mfma_f32_16x16x32_bf16 v[8:11], v[24:27], v[64:67], 0
    v_mfma_f32_16x16x32_bf16 v[12:15], v[24:27], v[136:139], 0
    v_max3_u32 v5, v5, v24, v25
    v_mfma_f32_16x16x32_bf16 v[16:19], v[24:27], a[0:3], 0
    v_mfma_f32_16x16x32_bf16 v[20:23], v[24:27], a[72:75], 0
    v_max3_u32 v5, v5, v26, v27
    s_waitcnt vmcnt(16)
    v_mfma_f32_16x16x32_bf16 v[8:11], v[28:31], v[68:71], v[8:11]
    v_mfma_f32_16x16x32_bf16 v[12:15], v[28:31], v[140:143], v[12:15]
    v_max3_u32 v5, v5, v28, v29
    v_mfma_f32_16x16x32_bf16 v[16:19], v[28:31], a[4:7], v[16:19]
    v_mfma_f32_16x16x32_bf16 v[20:23], v[28:31], a[76:79], v[20:23]
    v_max3_u32 v5, v5, v30, v31
    s_waitcnt vmcnt(15)
    v_mfma_f32_16x16x32_bf16 v[8:11], v[32:35], v[72:75], v[8:11]
    v_mfma_f32_16x16x32_bf16 v[12:15], v[32:35], v[144:147], v[12:15]
    v_max3_u32 v5, v5, v32, v33
    v_mfma_f32_16x16x32_bf16 v[16:19], v[32:35], a[8:11], v[16:19]
    v_mfma_f32_16x16x32_bf16 v[20:23], v[32:35], a[80:83], v[20:23]
    v_max3_u32 v5, v5, v34, v35
    s_waitcnt vmcnt(14)
    v_mfma_f32_16x16x32_bf16 v[8:11], v[36:39], v[76:79], v[8:11]
    v_mfma_f32_16x16x32_bf16 v[12:15], v[36:39], v[148:151], v[12:15]
    v_max3_u32 v5, v5, v36, v37
    v_mfma_f32_16x16x32_bf16 v[16:19], v[36:39], a[12:15], v[16:19]
    v_mfma_f32_16x16x32_bf16 v[20:23], v[36:39], a[84:87], v[20:23]
    v_max3_u32 v5, v5, v38, v39
    s_waitcnt vmcnt(13)
    v_mfma_f32_16x16x32_bf16 v[8:11], v[40:43], v[80:83], v[8:11]
    v_mfma_f32_16x16x32_bf16 v[12:15], v[40:43], v[152:155], v[12:15]
    v_max3_u32 v5, v5, v40, v41
    v_mfma_f32_16x16x32_bf16 v[16:19], v[40:43], a[16:19], v[16:19]
    v_mfma_f32_16x16x32_bf16 v[20:23], v[40:43], a[88:91], v[20:23]
    v_max3_u32 v5, v5, v42, v43
    s_waitcnt vmcnt(12)
    v_mfma_f32_16x16x32_bf16 v[8:11], v[44:47], v[84:87], v[8:11]
    v_mfma_f32_16x16x32_bf16 v[12:15], v[44:47], v[156:159], v[12:15]
    v_max3_u32 v5, v5, v44, v45
    v_mfma_f32_16x16x32_bf16 v[16:19], v[44:47], a[20:23], v[16:19]
    v_mfma_f32_16x16x32_bf16 v[20:23], v[44:47], a[92:95], v[20:23]
    v_max3_u32 v5, v5, v46, v47
    s_waitcnt vmcnt(11)
    v_mfma_f32_16x16x32_bf16 v[8:11], v[48:51], v[88:91], v[8:11]
    v_mfma_f32_16x16x32_bf16 v[12:15], v[48:51], v[160:163], v[12:15]
    v_max3_u32 v5, v5, v48, v49
    v_mfma_f32_16x16x32_bf16 v[16:19], v[48:51], a[24:27], v[16:19]
    v_mfma_f32_16x16x32_bf16 v[20:23], v[48:51], a[96:99], v[20:23]
    v_max3_u32 v5, v5, v50, v51
    s_waitcnt vmcnt(10)
    v_mfma_f32_16x16x32_bf16 v[8:11], v[52:55], v[92:95], v[8:11]
    v_mfma_f32_16x16x32_bf16 v[12:15], v[52:55], v[164:167], v[12:15]
    v_max3_u32 v5, v5, v52, v53
    v_mfma_f32_16x16x32_bf16 v[16:19], v[52:55], a[28:31], v[16:19]
    v_mfma_f32_16x16x32_bf16 v[20:23], v[52:55], a[100:103], v[20:23]
    v_max3_u32 v5, v5, v54, v55
    s_waitcnt vmcnt(9)
    v_mfma_f32_16x16x32_bf16 v[8:11], v[56:59], v[96:99], v[8:11]
    v_mfma_f32_16x16x32_bf16 v[12:15], v[56:59], v[168:171], v[12:15]
    v_max3_u32 v5, v5, v56, v57
    v_mfma_f32_16x16x32_bf16 v[16:19], v[56:59], a[32:35], v[16:19]
    v_mfma_f32_16x16x32_bf16 v[20:23], v[56:59], a[104:107], v[20:23]
    v_max3_u32 v5, v5, v58, v59
    s_waitcnt vmcnt(8)
    v_mfma_f32_16x16x32_bf16 v[8:11], v[60:63], v[100:103], v[8:11]
    v_mfma_f32_16x16x32_bf16 v[12:15], v[60:63], v[172:175], v[12:15]
    v_max3_u32 v5, v5, v60, v61
    v_mfma_f32_16x16x32_bf16 v[16:19], v[60:63], a[36:39], v[16:19]
    v_mfma_f32_16x16x32_bf16 v[20:23], v[60:63], a[108:111], v[20:23]
    v_max3_u32 v5, v5, v62, v63
    s_waitcnt vmcnt(7)
    v_mfma_f32_16x16x32_bf16 v[8:11], v[208:211], v[104:107], v[8:11]
    v_mfma_f32_16x16x32_bf16 v[12:15], v[208:211], v[176:179], v[12:15]
    v_max3_u32 v5, v5, v208, v209
    v_mfma_f32_16x16x32_bf16 v[16:19], v[208:211], a[40:43], v[16:19]
    v_mfma_f32_16x16x32_bf16 v[20:23], v[208:211], a[112:115], v[20:23]
    v_max3_u32 v5, v5, v210, v211
    s_waitcnt vmcnt(6)
    v_mfma_f32_16x16x32_bf16 v[8:11], v[212:215], v[108:111], v[8:11]
    v_mfma_f32_16x16x32_bf16 v[12:15], v[212:215], v[180:183], v[12:15]
    v_max3_u32 v5, v5, v212, v213
    v_mfma_f32_16x16x32_bf16 v[16:19], v[212:215], a[44:47], v[16:19]
    v_mfma_f32_16x16x32_bf16 v[20:23], v[212:215], a[116:119], v[20:23]
    v_max3_u32 v5, v5, v214, v215
    s_waitcnt vmcnt(5)
    v_mfma_f32_16x16x32_bf16 v[8:11], v[216:219], v[112:115], v[8:11]
    v_mfma_f32_16x16x32_bf16 v[12:15], v[216:219], v[184:187], v[12:15]
    v_max3_u32 v5, v5, v216, v217
    v_mfma_f32_16x16x32_bf16 v[16:19], v[216:219], a[48:51], v[16:19]
    v_mfma_f32_16x16x32_bf16 v[20:23], v[216:219], a[120:123], v[20:23]
    v_max3_u32 v5, v5, v218, v219
    s_waitcnt vmcnt(4)
    v_mfma_f32_16x16x32_bf16 v[8:11], v[220:223], v[116:119], v[8:11]
    v_mfma_f32_16x16x32_bf16 v[12:15], v[220:223], v[188:191], v[12:15]
    v_max3_u32 v5, v5, v220, v221
    v_mfma_f32_16x16x32_bf16 v[16:19], v[220:223], a[52:55], v[16:19]
    v_mfma_f32_16x16x32_bf16 v[20:23], v[220:223], a[124:127], v[20:23]
    v_max3_u32 v5, v5, v222, v223
    s_waitcnt vmcnt(3)
    v_mfma_f32_16x16x32_bf16 v[8:11], v[224:227], v[120:123], v[8:11]
    v_mfma_f32_16x16x32_bf16 v[12:15], v[224:227], v[192:195], v[12:15]
    v_max3_u32 v5, v5, v224, v225
    v_mfma_f32_16x16x32_bf16 v[16:19], v[224:227], a[56:59], v[16:19]
    v_mfma_f32_16x16x32_bf16 v[20:23], v[224:227], a[128:131], v[20:23]
    v_max3_u32 v5, v5, v226, v227
    s_waitcnt vmcnt(2)
    v_mfma_f32_16x16x32_bf16 v[8:11], v[228:231], v[124:127], v[8:11]
    v_mfma_f32_16x16x32_bf16 v[12:15], v[228:231], v[196:199], v[12:15]
    v_max3_u32 v5, v5, v228, v229
    v_mfma_f32_16x16x32_bf16 v[16:19], v[228:231], a[60:63], v[16:19]
    v_mfma_f32_16x16x32_bf16 v[20:23], v[228:231], a[132:135], v[20:23]
    v_max3_u32 v5, v5, v230, v231
    s_waitcnt vmcnt(1)
    v_mfma_f32_16x16x32_bf16 v[8:11], v[232:235], v[128:131], v[8:11]
    v_mfma_f32_16x16x32_bf16 v[12:15], v[232:235], v[200:203], v[12:15]
    v_max3_u32 v5, v5, v232, v233
    v_mfma_f32_16x16x32_bf16 v[16:19], v[232:235], a[64:67], v[16:19]
    v_mfma_f32_16x16x32_bf16 v[20:23], v[232:235], a[136:139], v[20:23]
    v_max3_u32 v5, v5, v234, v235
    s_waitcnt vmcnt(0)
    v_mfma_f32_16x16x32_bf16 v[8:11], v[236:239], v[132:135], v[8:11]
    v_mfma_f32_16x16x32_bf16 v[12:15], v[236:239], v[204:207], v[12:15]
    v_max3_u32 v5, v5, v236, v237
    v_mfma_f32_16x16x32_bf16 v[16:19], v[236:239], a[68:71], v[16:19]
    v_mfma_f32_16x16x32_bf16 v[20:23], v[236:239], a[140:143], v[20:23]
    v_max3_u32 v5, v5, v238, v239
    v_pk_mul_f32 v[8:9], v[8:9], 0.5 op_sel_hi:[1,0]
    v_pk_mul_f32 v[10:11], v[10:11], 0.5 op_sel_hi:[1,0]
    v_pk_mul_f32 v[12:13], v[12:13], 0.5 op_sel_hi:[1,0]
    v_pk_mul_f32 v[14:15], v[14:15], 0.5 op_sel_hi:[1,0]
    v_pk_mul_f32 v[16:17], v[16:17], 0.5 op_sel_hi:[1,0]
    v_pk_mul_f32 v[18:19], v[18:19], 0.5 op_sel_hi:[1,0]
    v_pk_mul_f32 v[20:21], v[20:21], 0.5 op_sel_hi:[1,0]
    v_pk_mul_f32 v[22:23], v[22:23], 0.5 op_sel_hi:[1,0]
    s_nop 1
mk_st:
    v_cmp_eq_u32 vcc, -1, v5
    s_sub_u32 s30, s30, 1
    s_cbranch_scc1 mk_ok
    s_cbranch_vccnz mk_again
mk_ok:
    s_add_u32 s24, s24, 24576
    v_cvt_pk_bf16_f32 v24, v8, v9
    v_cvt_pk_bf16_f32 v25, v10, v11
    v_cvt_pk_bf16_f32 v26, v12, v13
    v_cvt_pk_bf16_f32 v27, v14, v15
    v_cvt_pk_bf16_f32 v28, v16, v17
    v_cvt_pk_bf16_f32 v29, v18, v19
    v_cvt_pk_bf16_f32 v30, v20, v21
    v_cvt_pk_bf16_f32 v31, v22, v23
    s_add_u32 s21, s26, 4096
    buffer_store_dwordx4 v[24:27], v7, s[4:7], s26 offen sc1
    buffer_store_dwordx4 v[28:31], v7, s[4:7], s21 offen sc1
    s_waitcnt vmcnt(0)
    s_barrier
    v_mov_b32 v4, s22
    s_mov_b64 exec, s[34:35]
    buffer_store_dword v4, off, s[4:7], s29 sc1
    s_mov_b64 exec, -1
    s_add_u32 s19, s19, 2
    s_add_u32 s26, s26, 262144
    s_cmp_lt_u32 s19, 62
    s_cbranch_scc1 mk_loop
    s_endpgm
L_ssm_next:
    s_mov_b32 s37, 8
    v_mov_b32 v250, 1
    v_mov_b32 v251, 163832
    v_cmp_eq_u32 vcc, 0, v0
    s_nop 0
    s_and_saveexec_b64 s[38:39], vcc
    s_cbranch_execz tk8
    buffer_atomic_add v250, off, s[96:99], s37 sc0
    s_waitcnt vmcnt(0)
    ds_write_b32 v251, v250
    s_waitcnt lgkmcnt(0)
tk8:
    s_mov_b64 exec, -1
    s_barrier
    ds_read_b32 v252, v251
    s_waitcnt lgkmcnt(0)
    v_readfirstlane_b32 s20, v252
    s_barrier
    s_nop 3
    s_cmp_ge_u32 s20, 144
    s_cbranch_scc1 L_phase2
    s_lshl_b32 s20, s20, 2
    v_lshrrev_b32 v5, 6, v0
    s_nop 0
    v_readfirstlane_b32 s21, v5
    v_and_b32 v1, 63, v0
    v_and_b32 v2, 15, v1
    v_lshrrev_b32 v3, 4, v1
    v_lshlrev_b32 v4, 14, v5
    s_mov_b32 s8, s62
    s_mov_b32 s9, s63
    s_mov_b32 s10, 2359296
    s_mov_b32 s11, 0x20000
    s_mov_b32 s16, s76
    s_mov_b32 s17, s77
    s_mov_b32 s18, 4718592
    s_mov_b32 s19, 0x20000
    v_mul_u32_u24 v5, 9216, v0
    s_lshl_b32 s22, s20, 1
    s_add_u32 s23, s22, 0
    buffer_load_dwordx2 v[8:9], v5, s[8:11], s23 offen
    s_add_u32 s23, s22, 1152
    buffer_load_dwordx2 v[10:11], v5, s[8:11], s23 offen
    s_add_u32 s23, s22, 2304
    buffer_load_dwordx2 v[12:13], v5, s[8:11], s23 offen
    s_add_u32 s23, s22, 3456
    buffer_load_dwordx2 v[14:15], v5, s[8:11], s23 offen
    s_add_u32 s23, s22, 4608
    buffer_load_dwordx2 v[16:17], v5, s[8:11], s23 offen
    s_add_u32 s23, s22, 5760
    buffer_load_dwordx2 v[18:19], v5, s[8:11], s23 offen
    s_add_u32 s23, s22, 6912
    buffer_load_dwordx2 v[20:21], v5, s[8:11], s23 offen
    s_add_u32 s23, s22, 8064
    buffer_load_dwordx2 v[22:23], v5, s[8:11], s23 offen
    s_add_u32 s22, s20, s21
    s_lshl_b32 s23, s22, 8
    v_lshlrev_b32 v6, 3, v2
    v_lshl_add_u32 v6, v3, 1, v6
    s_mov_b32 s12, s64
    s_mov_b32 s13, s65
    s_mov_b32 s14, 147456
    s_mov_b32 s15, 0x20000
    buffer_load_ushort v24, v6, s[12:15], s23 offen offset:0
    buffer_load_ushort v28, v6, s[12:15], s23 offen offset:128
    s_mov_b32 s12, s66
    s_mov_b32 s13, s67
    s_mov_b32 s14, 147456
    s_mov_b32 s15, 0x20000
    buffer_load_ushort v25, v6, s[12:15], s23 offen offset:0
    buffer_load_ushort v29, v6, s[12:15], s23 offen offset:128
    s_mov_b32 s12, s68
    s_mov_b32 s13, s69
    s_mov_b32 s14, 147456
    s_mov_b32 s15, 0x20000
    buffer_load_ushort v26, v6, s[12:15], s23 offen offset:0
    buffer_load_ushort v30, v6, s[12:15], s23 offen offset:128
    s_mov_b32 s12, s70
    s_mov_b32 s13, s71
    s_mov_b32 s14, 147456
    s_mov_b32 s15, 0x20000
    buffer_load_ushort v27, v6, s[12:15], s23 offen offset:0
    buffer_load_ushort v31, v6, s[12:15], s23 offen offset:128
    s_mov_b32 s12, s72
    s_mov_b32 s13, s73
    s_mov_b32 s14, 1152
    s_mov_b32 s15, 0x20000
    s_lshl_b32 s23, s22, 1
    buffer_load_ushort v32, off, s[12:15], s23
    s_mov_b32 s26, 0x3fb8aa3b
    s_mov_b32 s27, 0x3e22f983
    v_mov_b32 v34, 0
    v_mov_b32 v35, 0
    v_lshl_add_u32 v6, v1, 3, v4
    ds_write_b64 v6, v[34:35] offset:0
    s_waitcnt vmcnt(0)
    v_mov_b32 v36, 0x05040100
    v_mov_b32 v37, 0x07060302
    v_lshlrev_b32 v6, 4, v0
    v_perm_b32 v40, v10, v8, v36
    v_perm_b32 v41, v14, v12, v36
    v_perm_b32 v42, v18, v16, v36
    v_perm_b32 v43, v22, v20, v36
    ds_write_b128 v6, v[40:43] offset:512
    s_nop 1
    v_perm_b32 v40, v10, v8, v37
    v_perm_b32 v41, v14, v12, v37
    v_perm_b32 v42, v18, v16, v37
    v_perm_b32 v43, v22, v20, v37
    ds_write_b128 v6, v[40:43] offset:16896
    s_nop 1
    v_perm_b32 v40, v11, v9, v36
    v_perm_b32 v41, v15, v13, v36
    v_perm_b32 v42, v19, v17, v36
    v_perm_b32 v43, v23, v21, v36
    ds_write_b128 v6, v[40:43] offset:33280
    s_nop 1
    v_perm_b32 v40, v11, v9, v37
    v_perm_b32 v41, v15, v13, v37
    v_perm_b32 v42, v19, v17, v37
    v_perm_b32 v43, v23, v21, v37
    ds_write_b128 v6, v[40:43] offset:49664
    s_nop 1
    v_lshlrev_b32 v32, 16, v32
    v_mul_f32 v32, s26, v32
    v_exp_f32 v32, v32
    s_nop 0
    v_cvt_pk_bf16_f32 v32, v32, v32
    v_and_b32 v32, 0xffff0000, v32
    v_add_f32 v33, v32, v32
    v_lshlrev_b32 v24, 16, v24
    v_mul_f32 v24, s26, v24
    v_exp_f32 v24, v24
    s_nop 0
    v_cvt_pk_bf16_f32 v24, v24, v24
    v_and_b32 v24, 0xffff0000, v24
    v_mul_f32 v24, v24, v32
    v_mul_f32 v24, s26, v24
    v_sub_f32 v24, 0, v24
    v_lshlrev_b32 v25, 16, v25
    v_mul_f32 v25, v25, v32
    v_mul_f32 v25, s27, v25
    v_lshlrev_b32 v26, 16, v26
    v_mul_f32 v26, v26, v33
    v_lshlrev_b32 v27, 16, v27
    v_mul_f32 v27, v27, v33
    v_lshlrev_b32 v28, 16, v28
    v_mul_f32 v28, s26, v28
    v_exp_f32 v28, v28
    s_nop 0
    v_cvt_pk_bf16_f32 v28, v28, v28
    v_and_b32 v28, 0xffff0000, v28
    v_mul_f32 v28, v28, v32
    v_mul_f32 v28, s26, v28
    v_sub_f32 v28, 0, v28
    v_lshlrev_b32 v29, 16, v29
    v_mul_f32 v29, v29, v32
    v_mul_f32 v29, s27, v29
    v_lshlrev_b32 v30, 16, v30
    v_mul_f32 v30, v30, v33
    v_lshlrev_b32 v31, 16, v31
    v_mul_f32 v31, v31, v33
    v_cvt_f32_u32 v47, v2
    v_mul_f32 v44, 0x41800000, v47
    v_and_b32 v5, 7, v2
    v_add_u32 v5, 8, v5
    v_cvt_f32_u32 v5, v5
    v_mul_f32 v45, 0x42000000, v5
    v_mul_f32 v6, 0x42800000, v5
    v_cmp_lt_u32 vcc, 7, v2
    s_nop 1
    v_cndmask_b32 v45, v45, v6, vcc
    v_add_f32 v5, 0x41000000, v47
    v_mul_f32 v46, 0x43000000, v5
    v_mov_b32 v48, 0
    v_mov_b32 v49, 0
    v_mov_b32 v50, 0
    v_mov_b32 v51, 0
    v_mov_b32 v52, 0
    v_mov_b32 v53, 0
    v_mov_b32 v54, 0
    v_mov_b32 v55, 0
    v_mov_b32 v56, 0
    v_mov_b32 v57, 0
    v_mov_b32 v58, 0
    v_mov_b32 v59, 0
    v_mov_b32 v60, 0
    v_mov_b32 v61, 0
    v_mov_b32 v62, 0
    v_mov_b32 v63, 0
    v_mov_b32_dpp v64, v24 row_newbcast:0 row_mask:0xf bank_mask:0xf
    v_mov_b32_dpp v65, v25 row_newbcast:0 row_mask:0xf bank_mask:0xf
    v_mov_b32_dpp v66, v26 row_newbcast:0 row_mask:0xf bank_mask:0xf
    v_mov_b32_dpp v67, v27 row_newbcast:0 row_mask:0xf bank_mask:0xf
    v_mul_f32 v82, v64, v47
    v_mul_f32 v83, v65, v47
    v_exp_f32 v82, v82
    v_fract_f32 v83, v83
    v_cos_f32 v74, v83
    v_sin_f32 v75, v83
    v_mul_f32 v74, v74, v82
    v_mul_f32 v75, v75, v82
    v_mul_f32 v84, v75, v75
    v_add_f32 v85, v74, v74
    v_fma_f32 v76, v74, v74, -v84
    v_mul_f32 v77, v85, v75
    v_mul_f32 v84, v77, v77
    v_add_f32 v85, v76, v76
    v_fma_f32 v78, v76, v76, -v84
    v_mul_f32 v79, v85, v77
    v_mul_f32 v84, v79, v79
    v_add_f32 v85, v78, v78
    v_fma_f32 v80, v78, v78, -v84
    v_mul_f32 v81, v85, v79
    v_mul_f32 v82, v64, v44
    v_mul_f32 v83, v65, v44
    v_exp_f32 v82, v82
    v_fract_f32 v83, v83
    v_cos_f32 v68, v83
    v_sin_f32 v69, v83
    v_mul_f32 v68, v68, v82
    v_mul_f32 v69, v69, v82
    v_mul_f32 v84, v67, v69
    v_mul_f32 v85, v67, v68
    v_fma_f32 v68, v66, v68, -v84
    v_fma_f32 v69, -v66, v69, -v85
    v_mul_f32 v82, v64, v45
    v_mul_f32 v83, v65, v45
    v_exp_f32 v82, v82
    v_fract_f32 v83, v83
    v_cos_f32 v70, v83
    v_sin_f32 v71, v83
    v_mul_f32 v70, v70, v82
    v_mul_f32 v71, v71, v82
    v_mul_f32 v84, v67, v71
    v_mul_f32 v85, v67, v70
    v_fma_f32 v70, v66, v70, -v84
    v_fma_f32 v71, -v66, v71, -v85
    v_mul_f32 v82, v64, v46
    v_mul_f32 v83, v65, v46
    v_exp_f32 v82, v82
    v_fract_f32 v83, v83
    v_cos_f32 v72, v83
    v_sin_f32 v73, v83
    v_mul_f32 v72, v72, v82
    v_mul_f32 v73, v73, v82
    v_mul_f32 v84, v67, v73
    v_mul_f32 v85, v67, v72
    v_fma_f32 v72, v66, v72, -v84
    v_fma_f32 v73, -v66, v73, -v85
    v_mfma_f32_16x16x4_f32 v[48:51], v68, v74, v[48:51]
    v_mfma_f32_16x16x4_f32 v[52:55], v70, v76, v[52:55]
    v_mfma_f32_16x16x4_f32 v[56:59], v70, v78, v[56:59]
    v_mfma_f32_16x16x4_f32 v[60:63], v72, v80, v[60:63]
    v_mfma_f32_16x16x4_f32 v[48:51], v69, v75, v[48:51]
    v_mfma_f32_16x16x4_f32 v[52:55], v71, v77, v[52:55]
    v_mfma_f32_16x16x4_f32 v[56:59], v71, v79, v[56:59]
    v_mfma_f32_16x16x4_f32 v[60:63], v73, v81, v[60:63]
    v_mov_b32_dpp v64, v24 row_newbcast:1 row_mask:0xf bank_mask:0xf
    v_mov_b32_dpp v65, v25 row_newbcast:1 row_mask:0xf bank_mask:0xf
    v_mov_b32_dpp v66, v26 row_newbcast:1 row_mask:0xf bank_mask:0xf
    v_mov_b32_dpp v67, v27 row_newbcast:1 row_mask:0xf bank_mask:0xf
    v_mul_f32 v82, v64, v47
    v_mul_f32 v83, v65, v47
    v_exp_f32 v82, v82
    v_fract_f32 v83, v83
    v_cos_f32 v74, v83
    v_sin_f32 v75, v83
    v_mul_f32 v74, v74, v82
    v_mul_f32 v75, v75, v82
    v_mul_f32 v84, v75, v75
    v_add_f32 v85, v74, v74
    v_fma_f32 v76, v74, v74, -v84
    v_mul_f32 v77, v85, v75
    v_mul_f32 v84, v77, v77
    v_add_f32 v85, v76, v76
    v_fma_f32 v78, v76, v76, -v84
    v_mul_f32 v79, v85, v77
    v_mul_f32 v84, v79, v79
    v_add_f32 v85, v78, v78
    v_fma_f32 v80, v78, v78, -v84
    v_mul_f32 v81, v85, v79
    v_mul_f32 v82, v64, v44
    v_mul_f32 v83, v65, v44
    v_exp_f32 v82, v82
    v_fract_f32 v83, v83
    v_cos_f32 v68, v83
    v_sin_f32 v69, v83
    v_mul_f32 v68, v68, v82
    v_mul_f32 v69, v69, v82
    v_mul_f32 v84, v67, v69
    v_mul_f32 v85, v67, v68
    v_fma_f32 v68, v66, v68, -v84
    v_fma_f32 v69, -v66, v69, -v85
    v_mul_f32 v82, v64, v45
    v_mul_f32 v83, v65, v45
    v_exp_f32 v82, v82
    v_fract_f32 v83, v83
    v_cos_f32 v70, v83
    v_sin_f32 v71, v83
    v_mul_f32 v70, v70, v82
    v_mul_f32 v71, v71, v82
    v_mul_f32 v84, v67, v71
    v_mul_f32 v85, v67, v70
    v_fma_f32 v70, v66, v70, -v84
    v_fma_f32 v71, -v66, v71, -v85
    v_mul_f32 v82, v64, v46
    v_mul_f32 v83, v65, v46
    v_exp_f32 v82, v82
    v_fract_f32 v83, v83
    v_cos_f32 v72, v83
    v_sin_f32 v73, v83
    v_mul_f32 v72, v72, v82
    v_mul_f32 v73, v73, v82
    v_mul_f32 v84, v67, v73
    v_mul_f32 v85, v67, v72
    v_fma_f32 v72, v66, v72, -v84
    v_fma_f32 v73, -v66, v73, -v85
    v_mfma_f32_16x16x4_f32 v[48:51], v68, v74, v[48:51]
    v_mfma_f32_16x16x4_f32 v[52:55], v70, v76, v[52:55]
    v_mfma_f32_16x16x4_f32 v[56:59], v70, v78, v[56:59]
    v_mfma_f32_16x16x4_f32 v[60:63], v72, v80, v[60:63]
    v_mfma_f32_16x16x4_f32 v[48:51], v69, v75, v[48:51]
    v_mfma_f32_16x16x4_f32 v[52:55], v71, v77, v[52:55]
    v_mfma_f32_16x16x4_f32 v[56:59], v71, v79, v[56:59]
    v_mfma_f32_16x16x4_f32 v[60:63], v73, v81, v[60:63]
    v_mov_b32_dpp v64, v24 row_newbcast:2 row_mask:0xf bank_mask:0xf
    v_mov_b32_dpp v65, v25 row_newbcast:2 row_mask:0xf bank_mask:0xf
    v_mov_b32_dpp v66, v26 row_newbcast:2 row_mask:0xf bank_mask:0xf
    v_mov_b32_dpp v67, v27 row_newbcast:2 row_mask:0xf bank_mask:0xf
    v_mul_f32 v82, v64, v47
    v_mul_f32 v83, v65, v47
    v_exp_f32 v82, v82
    v_fract_f32 v83, v83
    v_cos_f32 v74, v83
    v_sin_f32 v75, v83
    v_mul_f32 v74, v74, v82
    v_mul_f32 v75, v75, v82
    v_mul_f32 v84, v75, v75
    v_add_f32 v85, v74, v74
    v_fma_f32 v76, v74, v74, -v84
    v_mul_f32 v77, v85, v75
    v_mul_f32 v84, v77, v77
    v_add_f32 v85, v76, v76
    v_fma_f32 v78, v76, v76, -v84
    v_mul_f32 v79, v85, v77
    v_mul_f32 v84, v79, v79
    v_add_f32 v85, v78, v78
    v_fma_f32 v80, v78, v78, -v84
    v_mul_f32 v81, v85, v79
    v_mul_f32 v82, v64, v44
    v_mul_f32 v83, v65, v44
    v_exp_f32 v82, v82
    v_fract_f32 v83, v83
    v_cos_f32 v68, v83
    v_sin_f32 v69, v83
    v_mul_f32 v68, v68, v82
    v_mul_f32 v69, v69, v82
    v_mul_f32 v84, v67, v69
    v_mul_f32 v85, v67, v68
    v_fma_f32 v68, v66, v68, -v84
    v_fma_f32 v69, -v66, v69, -v85
    v_mul_f32 v82, v64, v45
    v_mul_f32 v83, v65, v45
    v_exp_f32 v82, v82
    v_fract_f32 v83, v83
    v_cos_f32 v70, v83
    v_sin_f32 v71, v83
    v_mul_f32 v70, v70, v82
    v_mul_f32 v71, v71, v82
    v_mul_f32 v84, v67, v71
    v_mul_f32 v85, v67, v70
    v_fma_f32 v70, v66, v70, -v84
    v_fma_f32 v71, -v66, v71, -v85
    v_mul_f32 v82, v64, v46
    v_mul_f32 v83, v65, v46
    v_exp_f32 v82, v82
    v_fract_f32 v83, v83
    v_cos_f32 v72, v83
    v_sin_f32 v73, v83
    v_mul_f32 v72, v72, v82
    v_mul_f32 v73, v73, v82
    v_mul_f32 v84, v67, v73
    v_mul_f32 v85, v67, v72
    v_fma_f32 v72, v66, v72, -v84
    v_fma_f32 v73, -v66, v73, -v85
    v_mfma_f32_16x16x4_f32 v[48:51], v68, v74, v[48:51]
    v_mfma_f32_16x16x4_f32 v[52:55], v70, v76, v[52:55]
    v_mfma_f32_16x16x4_f32 v[56:59], v70, v78, v[56:59]
    v_mfma_f32_16x16x4_f32 v[60:63], v72, v80, v[60:63]
    v_mfma_f32_16x16x4_f32 v[48:51], v69, v75, v[48:51]
    v_mfma_f32_16x16x4_f32 v[52:55], v71, v77, v[52:55]
    v_mfma_f32_16x16x4_f32 v[56:59], v71, v79, v[56:59]
    v_mfma_f32_16x16x4_f32 v[60:63], v73, v81, v[60:63]
    v_mov_b32_dpp v64, v24 row_newbcast:3 row_mask:0xf bank_mask:0xf
    v_mov_b32_dpp v65, v25 row_newbcast:3 row_mask:0xf bank_mask:0xf
    v_mov_b32_dpp v66, v26 row_newbcast:3 row_mask:0xf bank_mask:0xf
    v_mov_b32_dpp v67, v27 row_newbcast:3 row_mask:0xf bank_mask:0xf
    v_mul_f32 v82, v64, v47
    v_mul_f32 v83, v65, v47
    v_exp_f32 v82, v82
    v_fract_f32 v83, v83
    v_cos_f32 v74, v83
    v_sin_f32 v75, v83
    v_mul_f32 v74, v74, v82
    v_mul_f32 v75, v75, v82
    v_mul_f32 v84, v75, v75
    v_add_f32 v85, v74, v74
    v_fma_f32 v76, v74, v74, -v84
    v_mul_f32 v77, v85, v75
    v_mul_f32 v84, v77, v77
    v_add_f32 v85, v76, v76
    v_fma_f32 v78, v76, v76, -v84
    v_mul_f32 v79, v85, v77
    v_mul_f32 v84, v79, v79
    v_add_f32 v85, v78, v78
    v_fma_f32 v80, v78, v78, -v84
    v_mul_f32 v81, v85, v79
    v_mul_f32 v82, v64, v44
    v_mul_f32 v83, v65, v44
    v_exp_f32 v82, v82
    v_fract_f32 v83, v83
    v_cos_f32 v68, v83
    v_sin_f32 v69, v83
    v_mul_f32 v68, v68, v82
    v_mul_f32 v69, v69, v82
    v_mul_f32 v84, v67, v69
    v_mul_f32 v85, v67, v68
    v_fma_f32 v68, v66, v68, -v84
    v_fma_f32 v69, -v66, v69, -v85
    v_mul_f32 v82, v64, v45
    v_mul_f32 v83, v65, v45
    v_exp_f32 v82, v82
    v_fract_f32 v83, v83
    v_cos_f32 v70, v83
    v_sin_f32 v71, v83
    v_mul_f32 v70, v70, v82
    v_mul_f32 v71, v71, v82
    v_mul_f32 v84, v67, v71
    v_mul_f32 v85, v67, v70
    v_fma_f32 v70, v66, v70, -v84
    v_fma_f32 v71, -v66, v71, -v85
    v_mul_f32 v82, v64, v46
    v_mul_f32 v83, v65, v46
    v_exp_f32 v82, v82
    v_fract_f32 v83, v83
    v_cos_f32 v72, v83
    v_sin_f32 v73, v83
    v_mul_f32 v72, v72, v82
    v_mul_f32 v73, v73, v82
    v_mul_f32 v84, v67, v73
    v_mul_f32 v85, v67, v72
    v_fma_f32 v72, v66, v72, -v84
    v_fma_f32 v73, -v66, v73, -v85
    v_mfma_f32_16x16x4_f32 v[48:51], v68, v74, v[48:51]
    v_mfma_f32_16x16x4_f32 v[52:55], v70, v76, v[52:55]
    v_mfma_f32_16x16x4_f32 v[56:59], v70, v78, v[56:59]
    v_mfma_f32_16x16x4_f32 v[60:63], v72, v80, v[60:63]
    v_mfma_f32_16x16x4_f32 v[48:51], v69, v75, v[48:51]
    v_mfma_f32_16x16x4_f32 v[52:55], v71, v77, v[52:55]
    v_mfma_f32_16x16x4_f32 v[56:59], v71, v79, v[56:59]
    v_mfma_f32_16x16x4_f32 v[60:63], v73, v81, v[60:63]
    v_mov_b32_dpp v64, v24 row_newbcast:4 row_mask:0xf bank_mask:0xf
    v_mov_b32_dpp v65, v25 row_newbcast:4 row_mask:0xf bank_mask:0xf
    v_mov_b32_dpp v66, v26 row_newbcast:4 row_mask:0xf bank_mask:0xf
    v_mov_b32_dpp v67, v27 row_newbcast:4 row_mask:0xf bank_mask:0xf
    v_mul_f32 v82, v64, v47
    v_mul_f32 v83, v65, v47
    v_exp_f32 v82, v82
    v_fract_f32 v83, v83
    v_cos_f32 v74, v83
    v_sin_f32 v75, v83
    v_mul_f32 v74, v74, v82
    v_mul_f32 v75, v75, v82
    v_mul_f32 v84, v75, v75
    v_add_f32 v85, v74, v74
    v_fma_f32 v76, v74, v74, -v84
    v_mul_f32 v77, v85, v75
    v_mul_f32 v84, v77, v77
    v_add_f32 v85, v76, v76
    v_fma_f32 v78, v76, v76, -v84
    v_mul_f32 v79, v85, v77
    v_mul_f32 v84, v79, v79
    v_add_f32 v85, v78, v78
    v_fma_f32 v80, v78, v78, -v84
    v_mul_f32 v81, v85, v79
    v_mul_f32 v82, v64, v44
    v_mul_f32 v83, v65, v44
    v_exp_f32 v82, v82
    v_fract_f32 v83, v83
    v_cos_f32 v68, v83
    v_sin_f32 v69, v83
    v_mul_f32 v68, v68, v82
    v_mul_f32 v69, v69, v82
    v_mul_f32 v84, v67, v69
    v_mul_f32 v85, v67, v68
    v_fma_f32 v68, v66, v68, -v84
    v_fma_f32 v69, -v66, v69, -v85
    v_mul_f32 v82, v64, v45
    v_mul_f32 v83, v65, v45
    v_exp_f32 v82, v82
    v_fract_f32 v83, v83
    v_cos_f32 v70, v83
    v_sin_f32 v71, v83
    v_mul_f32 v70, v70, v82
    v_mul_f32 v71, v71, v82
    v_mul_f32 v84, v67, v71
    v_mul_f32 v85, v67, v70
    v_fma_f32 v70, v66, v70, -v84
    v_fma_f32 v71, -v66, v71, -v85
    v_mul_f32 v82, v64, v46
    v_mul_f32 v83, v65, v46
    v_exp_f32 v82, v82
    v_fract_f32 v83, v83
    v_cos_f32 v72, v83
    v_sin_f32 v73, v83
    v_mul_f32 v72, v72, v82
    v_mul_f32 v73, v73, v82
    v_mul_f32 v84, v67, v73
    v_mul_f32 v85, v67, v72
    v_fma_f32 v72, v66, v72, -v84
    v_fma_f32 v73, -v66, v73, -v85
    v_mfma_f32_16x16x4_f32 v[48:51], v68, v74, v[48:51]
    v_mfma_f32_16x16x4_f32 v[52:55], v70, v76, v[52:55]
    v_mfma_f32_16x16x4_f32 v[56:59], v70, v78, v[56:59]
    v_mfma_f32_16x16x4_f32 v[60:63], v72, v80, v[60:63]
    v_mfma_f32_16x16x4_f32 v[48:51], v69, v75, v[48:51]
    v_mfma_f32_16x16x4_f32 v[52:55], v71, v77, v[52:55]
    v_mfma_f32_16x16x4_f32 v[56:59], v71, v79, v[56:59]
    v_mfma_f32_16x16x4_f32 v[60:63], v73, v81, v[60:63]
    v_mov_b32_dpp v64, v24 row_newbcast:5 row_mask:0xf bank_mask:0xf
    v_mov_b32_dpp v65, v25 row_newbcast:5 row_mask:0xf bank_mask:0xf
    v_mov_b32_dpp v66, v26 row_newbcast:5 row_mask:0xf bank_mask:0xf
    v_mov_b32_dpp v67, v27 row_newbcast:5 row_mask:0xf bank_mask:0xf
    v_mul_f32 v82, v64, v47
    v_mul_f32 v83, v65, v47
    v_exp_f32 v82, v82
    v_fract_f32 v83, v83
    v_cos_f32 v74, v83
    v_sin_f32 v75, v83
    v_mul_f32 v74, v74, v82
    v_mul_f32 v75, v75, v82
    v_mul_f32 v84, v75, v75
    v_add_f32 v85, v74, v74
    v_fma_f32 v76, v74, v74, -v84
    v_mul_f32 v77, v85, v75
    v_mul_f32 v84, v77, v77
    v_add_f32 v85, v76, v76
    v_fma_f32 v78, v76, v76, -v84
    v_mul_f32 v79, v85, v77
    v_mul_f32 v84, v79, v79
    v_add_f32 v85, v78, v78
    v_fma_f32 v80, v78, v78, -v84
    v_mul_f32 v81, v85, v79
    v_mul_f32 v82, v64, v44
    v_mul_f32 v83, v65, v44
    v_exp_f32 v82, v82
    v_fract_f32 v83, v83
    v_cos_f32 v68, v83
    v_sin_f32 v69, v83
    v_mul_f32 v68, v68, v82
    v_mul_f32 v69, v69, v82
    v_mul_f32 v84, v67, v69
    v_mul_f32 v85, v67, v68
    v_fma_f32 v68, v66, v68, -v84
    v_fma_f32 v69, -v66, v69, -v85
    v_mul_f32 v82, v64, v45
    v_mul_f32 v83, v65, v45
    v_exp_f32 v82, v82
    v_fract_f32 v83, v83
    v_cos_f32 v70, v83
    v_sin_f32 v71, v83
    v_mul_f32 v70, v70, v82
    v_mul_f32 v71, v71, v82
    v_mul_f32 v84, v67, v71
    v_mul_f32 v85, v67, v70
    v_fma_f32 v70, v66, v70, -v84
    v_fma_f32 v71, -v66, v71, -v85
    v_mul_f32 v82, v64, v46
    v_mul_f32 v83, v65, v46
    v_exp_f32 v82, v82
    v_fract_f32 v83, v83
    v_cos_f32 v72, v83
    v_sin_f32 v73, v83
    v_mul_f32 v72, v72, v82
    v_mul_f32 v73, v73, v82
    v_mul_f32 v84, v67, v73
    v_mul_f32 v85, v67, v72
    v_fma_f32 v72, v66, v72, -v84
    v_fma_f32 v73, -v66, v73, -v85
    v_mfma_f32_16x16x4_f32 v[48:51], v68, v74, v[48:51]
    v_mfma_f32_16x16x4_f32 v[52:55], v70, v76, v[52:55]
    v_mfma_f32_16x16x4_f32 v[56:59], v70, v78, v[56:59]
    v_mfma_f32_16x16x4_f32 v[60:63], v72, v80, v[60:63]
    v_mfma_f32_16x16x4_f32 v[48:51], v69, v75, v[48:51]
    v_mfma_f32_16x16x4_f32 v[52:55], v71, v77, v[52:55]
    v_mfma_f32_16x16x4_f32 v[56:59], v71, v79, v[56:59]
    v_mfma_f32_16x16x4_f32 v[60:63], v73, v81, v[60:63]
    v_mov_b32_dpp v64, v24 row_newbcast:6 row_mask:0xf bank_mask:0xf
    v_mov_b32_dpp v65, v25 row_newbcast:6 row_mask:0xf bank_mask:0xf
    v_mov_b32_dpp v66, v26 row_newbcast:6 row_mask:0xf bank_mask:0xf
    v_mov_b32_dpp v67, v27 row_newbcast:6 row_mask:0xf bank_mask:0xf
    v_mul_f32 v82, v64, v47
    v_mul_f32 v83, v65, v47
    v_exp_f32 v82, v82
    v_fract_f32 v83, v83
    v_cos_f32 v74, v83
    v_sin_f32 v75, v83
    v_mul_f32 v74, v74, v82
    v_mul_f32 v75, v75, v82
    v_mul_f32 v84, v75, v75
    v_add_f32 v85, v74, v74
    v_fma_f32 v76, v74, v74, -v84
    v_mul_f32 v77, v85, v75
    v_mul_f32 v84, v77, v77
    v_add_f32 v85, v76, v76
    v_fma_f32 v78, v76, v76, -v84
    v_mul_f32 v79, v85, v77
    v_mul_f32 v84, v79, v79
    v_add_f32 v85, v78, v78
    v_fma_f32 v80, v78, v78, -v84
    v_mul_f32 v81, v85, v79
    v_mul_f32 v82, v64, v44
    v_mul_f32 v83, v65, v44
    v_exp_f32 v82, v82
    v_fract_f32 v83, v83
    v_cos_f32 v68, v83
    v_sin_f32 v69, v83
    v_mul_f32 v68, v68, v82
    v_mul_f32 v69, v69, v82
    v_mul_f32 v84, v67, v69
    v_mul_f32 v85, v67, v68
    v_fma_f32 v68, v66, v68, -v84
    v_fma_f32 v69, -v66, v69, -v85
    v_mul_f32 v82, v64, v45
    v_mul_f32 v83, v65, v45
    v_exp_f32 v82, v82
    v_fract_f32 v83, v83
    v_cos_f32 v70, v83
    v_sin_f32 v71, v83
    v_mul_f32 v70, v70, v82
    v_mul_f32 v71, v71, v82
    v_mul_f32 v84, v67, v71
    v_mul_f32 v85, v67, v70
    v_fma_f32 v70, v66, v70, -v84
    v_fma_f32 v71, -v66, v71, -v85
    v_mul_f32 v82, v64, v46
    v_mul_f32 v83, v65, v46
    v_exp_f32 v82, v82
    v_fract_f32 v83, v83
    v_cos_f32 v72, v83
    v_sin_f32 v73, v83
    v_mul_f32 v72, v72, v82
    v_mul_f32 v73, v73, v82
    v_mul_f32 v84, v67, v73
    v_mul_f32 v85, v67, v72
    v_fma_f32 v72, v66, v72, -v84
    v_fma_f32 v73, -v66, v73, -v85
    v_mfma_f32_16x16x4_f32 v[48:51], v68, v74, v[48:51]
    v_mfma_f32_16x16x4_f32 v[52:55], v70, v76, v[52:55]
    v_mfma_f32_16x16x4_f32 v[56:59], v70, v78, v[56:59]
    v_mfma_f32_16x16x4_f32 v[60:63], v72, v80, v[60:63]
    v_mfma_f32_16x16x4_f32 v[48:51], v69, v75, v[48:51]
    v_mfma_f32_16x16x4_f32 v[52:55], v71, v77, v[52:55]
    v_mfma_f32_16x16x4_f32 v[56:59], v71, v79, v[56:59]
    v_mfma_f32_16x16x4_f32 v[60:63], v73, v81, v[60:63]
    v_mov_b32_dpp v64, v24 row_newbcast:7 row_mask:0xf bank_mask:0xf
    v_mov_b32_dpp v65, v25 row_newbcast:7 row_mask:0xf bank_mask:0xf
    v_mov_b32_dpp v66, v26 row_newbcast:7 row_mask:0xf bank_mask:0xf
    v_mov_b32_dpp v67, v27 row_newbcast:7 row_mask:0xf bank_mask:0xf
    v_mul_f32 v82, v64, v47
    v_mul_f32 v83, v65, v47
    v_exp_f32 v82, v82
    v_fract_f32 v83, v83
    v_cos_f32 v74, v83
    v_sin_f32 v75, v83
    v_mul_f32 v74, v74, v82
    v_mul_f32 v75, v75, v82
    v_mul_f32 v84, v75, v75
    v_add_f32 v85, v74, v74
    v_fma_f32 v76, v74, v74, -v84
    v_mul_f32 v77, v85, v75
    v_mul_f32 v84, v77, v77
    v_add_f32 v85, v76, v76
    v_fma_f32 v78, v76, v76, -v84
    v_mul_f32 v79, v85, v77
    v_mul_f32 v84, v79, v79
    v_add_f32 v85, v78, v78
    v_fma_f32 v80, v78, v78, -v84
    v_mul_f32 v81, v85, v79
    v_mul_f32 v82, v64, v44
    v_mul_f32 v83, v65, v44
    v_exp_f32 v82, v82
    v_fract_f32 v83, v83
    v_cos_f32 v68, v83
    v_sin_f32 v69, v83
    v_mul_f32 v68, v68, v82
    v_mul_f32 v69, v69, v82
    v_mul_f32 v84, v67, v69
    v_mul_f32 v85, v67, v68
    v_fma_f32 v68, v66, v68, -v84
    v_fma_f32 v69, -v66, v69, -v85
    v_mul_f32 v82, v64, v45
    v_mul_f32 v83, v65, v45
    v_exp_f32 v82, v82
    v_fract_f32 v83, v83
    v_cos_f32 v70, v83
    v_sin_f32 v71, v83
    v_mul_f32 v70, v70, v82
    v_mul_f32 v71, v71, v82
    v_mul_f32 v84, v67, v71
    v_mul_f32 v85, v67, v70
    v_fma_f32 v70, v66, v70, -v84
    v_fma_f32 v71, -v66, v71, -v85
    v_mul_f32 v82, v64, v46
    v_mul_f32 v83, v65, v46
    v_exp_f32 v82, v82
    v_fract_f32 v83, v83
    v_cos_f32 v72, v83
    v_sin_f32 v73, v83
    v_mul_f32 v72, v72, v82
    v_mul_f32 v73, v73, v82
    v_mul_f32 v84, v67, v73
    v_mul_f32 v85, v67, v72
    v_fma_f32 v72, v66, v72, -v84
    v_fma_f32 v73, -v66, v73, -v85
    v_mfma_f32_16x16x4_f32 v[48:51], v68, v74, v[48:51]
    v_mfma_f32_16x16x4_f32 v[52:55], v70, v76, v[52:55]
    v_mfma_f32_16x16x4_f32 v[56:59], v70, v78, v[56:59]
    v_mfma_f32_16x16x4_f32 v[60:63], v72, v80, v[60:63]
    v_mfma_f32_16x16x4_f32 v[48:51], v69, v75, v[48:51]
    v_mfma_f32_16x16x4_f32 v[52:55], v71, v77, v[52:55]
    v_mfma_f32_16x16x4_f32 v[56:59], v71, v79, v[56:59]
    v_mfma_f32_16x16x4_f32 v[60:63], v73, v81, v[60:63]
    v_mov_b32_dpp v64, v24 row_newbcast:8 row_mask:0xf bank_mask:0xf
    v_mov_b32_dpp v65, v25 row_newbcast:8 row_mask:0xf bank_mask:0xf
    v_mov_b32_dpp v66, v26 row_newbcast:8 row_mask:0xf bank_mask:0xf
    v_mov_b32_dpp v67, v27 row_newbcast:8 row_mask:0xf bank_mask:0xf
    v_mul_f32 v82, v64, v47
    v_mul_f32 v83, v65, v47
    v_exp_f32 v82, v82
    v_fract_f32 v83, v83
    v_cos_f32 v74, v83
    v_sin_f32 v75, v83
    v_mul_f32 v74, v74, v82
    v_mul_f32 v75, v75, v82
    v_mul_f32 v84, v75, v75
    v_add_f32 v85, v74, v74
    v_fma_f32 v76, v74, v74, -v84
    v_mul_f32 v77, v85, v75
    v_mul_f32 v84, v77, v77
    v_add_f32 v85, v76, v76
    v_fma_f32 v78, v76, v76, -v84
    v_mul_f32 v79, v85, v77
    v_mul_f32 v84, v79, v79
    v_add_f32 v85, v78, v78
    v_fma_f32 v80, v78, v78, -v84
    v_mul_f32 v81, v85, v79
    v_mul_f32 v82, v64, v44
    v_mul_f32 v83, v65, v44
    v_exp_f32 v82, v82
    v_fract_f32 v83, v83
    v_cos_f32 v68, v83
    v_sin_f32 v69, v83
    v_mul_f32 v68, v68, v82
    v_mul_f32 v69, v69, v82
    v_mul_f32 v84, v67, v69
    v_mul_f32 v85, v67, v68
    v_fma_f32 v68, v66, v68, -v84
    v_fma_f32 v69, -v66, v69, -v85
    v_mul_f32 v82, v64, v45
    v_mul_f32 v83, v65, v45
    v_exp_f32 v82, v82
    v_fract_f32 v83, v83
    v_cos_f32 v70, v83
    v_sin_f32 v71, v83
    v_mul_f32 v70, v70, v82
    v_mul_f32 v71, v71, v82
    v_mul_f32 v84, v67, v71
    v_mul_f32 v85, v67, v70
    v_fma_f32 v70, v66, v70, -v84
    v_fma_f32 v71, -v66, v71, -v85
    v_mul_f32 v82, v64, v46
    v_mul_f32 v83, v65, v46
    v_exp_f32 v82, v82
    v_fract_f32 v83, v83
    v_cos_f32 v72, v83
    v_sin_f32 v73, v83
    v_mul_f32 v72, v72, v82
    v_mul_f32 v73, v73, v82
    v_mul_f32 v84, v67, v73
    v_mul_f32 v85, v67, v72
    v_fma_f32 v72, v66, v72, -v84
    v_fma_f32 v73, -v66, v73, -v85
    v_mfma_f32_16x16x4_f32 v[48:51], v68, v74, v[48:51]
    v_mfma_f32_16x16x4_f32 v[52:55], v70, v76, v[52:55]
    v_mfma_f32_16x16x4_f32 v[56:59], v70, v78, v[56:59]
    v_mfma_f32_16x16x4_f32 v[60:63], v72, v80, v[60:63]
    v_mfma_f32_16x16x4_f32 v[48:51], v69, v75, v[48:51]
    v_mfma_f32_16x16x4_f32 v[52:55], v71, v77, v[52:55]
    v_mfma_f32_16x16x4_f32 v[56:59], v71, v79, v[56:59]
    v_mfma_f32_16x16x4_f32 v[60:63], v73, v81, v[60:63]
    v_mov_b32_dpp v64, v24 row_newbcast:9 row_mask:0xf bank_mask:0xf
    v_mov_b32_dpp v65, v25 row_newbcast:9 row_mask:0xf bank_mask:0xf
    v_mov_b32_dpp v66, v26 row_newbcast:9 row_mask:0xf bank_mask:0xf
    v_mov_b32_dpp v67, v27 row_newbcast:9 row_mask:0xf bank_mask:0xf
    v_mul_f32 v82, v64, v47
    v_mul_f32 v83, v65, v47
    v_exp_f32 v82, v82
    v_fract_f32 v83, v83
    v_cos_f32 v74, v83
    v_sin_f32 v75, v83
    v_mul_f32 v74, v74, v82
    v_mul_f32 v75, v75, v82
    v_mul_f32 v84, v75, v75
    v_add_f32 v85, v74, v74
    v_fma_f32 v76, v74, v74, -v84
    v_mul_f32 v77, v85, v75
    v_mul_f32 v84, v77, v77
    v_add_f32 v85, v76, v76
    v_fma_f32 v78, v76, v76, -v84
    v_mul_f32 v79, v85, v77
    v_mul_f32 v84, v79, v79
    v_add_f32 v85, v78, v78
    v_fma_f32 v80, v78, v78, -v84
    v_mul_f32 v81, v85, v79
    v_mul_f32 v82, v64, v44
    v_mul_f32 v83, v65, v44
    v_exp_f32 v82, v82
    v_fract_f32 v83, v83
    v_cos_f32 v68, v83
    v_sin_f32 v69, v83
    v_mul_f32 v68, v68, v82
    v_mul_f32 v69, v69, v82
    v_mul_f32 v84, v67, v69
    v_mul_f32 v85, v67, v68
    v_fma_f32 v68, v66, v68, -v84
    v_fma_f32 v69, -v66, v69, -v85
    v_mul_f32 v82, v64, v45
    v_mul_f32 v83, v65, v45
    v_exp_f32 v82, v82
    v_fract_f32 v83, v83
    v_cos_f32 v70, v83
    v_sin_f32 v71, v83
    v_mul_f32 v70, v70, v82
    v_mul_f32 v71, v71, v82
    v_mul_f32 v84, v67, v71
    v_mul_f32 v85, v67, v70
    v_fma_f32 v70, v66, v70, -v84
    v_fma_f32 v71, -v66, v71, -v85
    v_mul_f32 v82, v64, v46
    v_mul_f32 v83, v65, v46
    v_exp_f32 v82, v82
    v_fract_f32 v83, v83
    v_cos_f32 v72, v83
    v_sin_f32 v73, v83
    v_mul_f32 v72, v72, v82
    v_mul_f32 v73, v73, v82
    v_mul_f32 v84, v67, v73
    v_mul_f32 v85, v67, v72
    v_fma_f32 v72, v66, v72, -v84
    v_fma_f32 v73, -v66, v73, -v85
    v_mfma_f32_16x16x4_f32 v[48:51], v68, v74, v[48:51]
    v_mfma_f32_16x16x4_f32 v[52:55], v70, v76, v[52:55]
    v_mfma_f32_16x16x4_f32 v[56:59], v70, v78, v[56:59]
    v_mfma_f32_16x16x4_f32 v[60:63], v72, v80, v[60:63]
    v_mfma_f32_16x16x4_f32 v[48:51], v69, v75, v[48:51]
    v_mfma_f32_16x16x4_f32 v[52:55], v71, v77, v[52:55]
    v_mfma_f32_16x16x4_f32 v[56:59], v71, v79, v[56:59]
    v_mfma_f32_16x16x4_f32 v[60:63], v73, v81, v[60:63]
    v_mov_b32_dpp v64, v24 row_newbcast:10 row_mask:0xf bank_mask:0xf
    v_mov_b32_dpp v65, v25 row_newbcast:10 row_mask:0xf bank_mask:0xf
    v_mov_b32_dpp v66, v26 row_newbcast:10 row_mask:0xf bank_mask:0xf
    v_mov_b32_dpp v67, v27 row_newbcast:10 row_mask:0xf bank_mask:0xf
    v_mul_f32 v82, v64, v47
    v_mul_f32 v83, v65, v47
    v_exp_f32 v82, v82
    v_fract_f32 v83, v83
    v_cos_f32 v74, v83
    v_sin_f32 v75, v83
    v_mul_f32 v74, v74, v82
    v_mul_f32 v75, v75, v82
    v_mul_f32 v84, v75, v75
    v_add_f32 v85, v74, v74
    v_fma_f32 v76, v74, v74, -v84
    v_mul_f32 v77, v85, v75
    v_mul_f32 v84, v77, v77
    v_add_f32 v85, v76, v76
    v_fma_f32 v78, v76, v76, -v84
    v_mul_f32 v79, v85, v77
    v_mul_f32 v84, v79, v79
    v_add_f32 v85, v78, v78
    v_fma_f32 v80, v78, v78, -v84
    v_mul_f32 v81, v85, v79
    v_mul_f32 v82, v64, v44
    v_mul_f32 v83, v65, v44
    v_exp_f32 v82, v82
    v_fract_f32 v83, v83
    v_cos_f32 v68, v83
    v_sin_f32 v69, v83
    v_mul_f32 v68, v68, v82
    v_mul_f32 v69, v69, v82
    v_mul_f32 v84, v67, v69
    v_mul_f32 v85, v67, v68
    v_fma_f32 v68, v66, v68, -v84
    v_fma_f32 v69, -v66, v69, -v85
    v_mul_f32 v82, v64, v45
    v_mul_f32 v83, v65, v45
    v_exp_f32 v82, v82
    v_fract_f32 v83, v83
    v_cos_f32 v70, v83
    v_sin_f32 v71, v83
    v_mul_f32 v70, v70, v82
    v_mul_f32 v71, v71, v82
    v_mul_f32 v84, v67, v71
    v_mul_f32 v85, v67, v70
    v_fma_f32 v70, v66, v70, -v84
    v_fma_f32 v71, -v66, v71, -v85
    v_mul_f32 v82, v64, v46
    v_mul_f32 v83, v65, v46
    v_exp_f32 v82, v82
    v_fract_f32 v83, v83
    v_cos_f32 v72, v83
    v_sin_f32 v73, v83
    v_mul_f32 v72, v72, v82
    v_mul_f32 v73, v73, v82
    v_mul_f32 v84, v67, v73
    v_mul_f32 v85, v67, v72
    v_fma_f32 v72, v66, v72, -v84
    v_fma_f32 v73, -v66, v73, -v85
    v_mfma_f32_16x16x4_f32 v[48:51], v68, v74, v[48:51]
    v_mfma_f32_16x16x4_f32 v[52:55], v70, v76, v[52:55]
    v_mfma_f32_16x16x4_f32 v[56:59], v70, v78, v[56:59]
    v_mfma_f32_16x16x4_f32 v[60:63], v72, v80, v[60:63]
    v_mfma_f32_16x16x4_f32 v[48:51], v69, v75, v[48:51]
    v_mfma_f32_16x16x4_f32 v[52:55], v71, v77, v[52:55]
    v_mfma_f32_16x16x4_f32 v[56:59], v71, v79, v[56:59]
    v_mfma_f32_16x16x4_f32 v[60:63], v73, v81, v[60:63]
    v_mov_b32_dpp v64, v24 row_newbcast:11 row_mask:0xf bank_mask:0xf
    v_mov_b32_dpp v65, v25 row_newbcast:11 row_mask:0xf bank_mask:0xf
    v_mov_b32_dpp v66, v26 row_newbcast:11 row_mask:0xf bank_mask:0xf
    v_mov_b32_dpp v67, v27 row_newbcast:11 row_mask:0xf bank_mask:0xf
    v_mul_f32 v82, v64, v47
    v_mul_f32 v83, v65, v47
    v_exp_f32 v82, v82
    v_fract_f32 v83, v83
    v_cos_f32 v74, v83
    v_sin_f32 v75, v83
    v_mul_f32 v74, v74, v82
    v_mul_f32 v75, v75, v82
    v_mul_f32 v84, v75, v75
    v_add_f32 v85, v74, v74
    v_fma_f32 v76, v74, v74, -v84
    v_mul_f32 v77, v85, v75
    v_mul_f32 v84, v77, v77
    v_add_f32 v85, v76, v76
    v_fma_f32 v78, v76, v76, -v84
    v_mul_f32 v79, v85, v77
    v_mul_f32 v84, v79, v79
    v_add_f32 v85, v78, v78
    v_fma_f32 v80, v78, v78, -v84
    v_mul_f32 v81, v85, v79
    v_mul_f32 v82, v64, v44
    v_mul_f32 v83, v65, v44
    v_exp_f32 v82, v82
    v_fract_f32 v83, v83
    v_cos_f32 v68, v83
    v_sin_f32 v69, v83
    v_mul_f32 v68, v68, v82
    v_mul_f32 v69, v69, v82
    v_mul_f32 v84, v67, v69
    v_mul_f32 v85, v67, v68
    v_fma_f32 v68, v66, v68, -v84
    v_fma_f32 v69, -v66, v69, -v85
    v_mul_f32 v82, v64, v45
    v_mul_f32 v83, v65, v45
    v_exp_f32 v82, v82
    v_fract_f32 v83, v83
    v_cos_f32 v70, v83
    v_sin_f32 v71, v83
    v_mul_f32 v70, v70, v82
    v_mul_f32 v71, v71, v82
    v_mul_f32 v84, v67, v71
    v_mul_f32 v85, v67, v70
    v_fma_f32 v70, v66, v70, -v84
    v_fma_f32 v71, -v66, v71, -v85
    v_mul_f32 v82, v64, v46
    v_mul_f32 v83, v65, v46
    v_exp_f32 v82, v82
    v_fract_f32 v83, v83
    v_cos_f32 v72, v83
    v_sin_f32 v73, v83
    v_mul_f32 v72, v72, v82
    v_mul_f32 v73, v73, v82
    v_mul_f32 v84, v67, v73
    v_mul_f32 v85, v67, v72
    v_fma_f32 v72, v66, v72, -v84
    v_fma_f32 v73, -v66, v73, -v85
    v_mfma_f32_16x16x4_f32 v[48:51], v68, v74, v[48:51]
    v_mfma_f32_16x16x4_f32 v[52:55], v70, v76, v[52:55]
    v_mfma_f32_16x16x4_f32 v[56:59], v70, v78, v[56:59]
    v_mfma_f32_16x16x4_f32 v[60:63], v72, v80, v[60:63]
    v_mfma_f32_16x16x4_f32 v[48:51], v69, v75, v[48:51]
    v_mfma_f32_16x16x4_f32 v[52:55], v71, v77, v[52:55]
    v_mfma_f32_16x16x4_f32 v[56:59], v71, v79, v[56:59]
    v_mfma_f32_16x16x4_f32 v[60:63], v73, v81, v[60:63]
    v_mov_b32_dpp v64, v24 row_newbcast:12 row_mask:0xf bank_mask:0xf
    v_mov_b32_dpp v65, v25 row_newbcast:12 row_mask:0xf bank_mask:0xf
    v_mov_b32_dpp v66, v26 row_newbcast:12 row_mask:0xf bank_mask:0xf
    v_mov_b32_dpp v67, v27 row_newbcast:12 row_mask:0xf bank_mask:0xf
    v_mul_f32 v82, v64, v47
    v_mul_f32 v83, v65, v47
    v_exp_f32 v82, v82
    v_fract_f32 v83, v83
    v_cos_f32 v74, v83
    v_sin_f32 v75, v83
    v_mul_f32 v74, v74, v82
    v_mul_f32 v75, v75, v82
    v_mul_f32 v84, v75, v75
    v_add_f32 v85, v74, v74
    v_fma_f32 v76, v74, v74, -v84
    v_mul_f32 v77, v85, v75
    v_mul_f32 v84, v77, v77
    v_add_f32 v85, v76, v76
    v_fma_f32 v78, v76, v76, -v84
    v_mul_f32 v79, v85, v77
    v_mul_f32 v84, v79, v79
    v_add_f32 v85, v78, v78
    v_fma_f32 v80, v78, v78, -v84
    v_mul_f32 v81, v85, v79
    v_mul_f32 v82, v64, v44
    v_mul_f32 v83, v65, v44
    v_exp_f32 v82, v82
    v_fract_f32 v83, v83
    v_cos_f32 v68, v83
    v_sin_f32 v69, v83
    v_mul_f32 v68, v68, v82
    v_mul_f32 v69, v69, v82
    v_mul_f32 v84, v67, v69
    v_mul_f32 v85, v67, v68
    v_fma_f32 v68, v66, v68, -v84
    v_fma_f32 v69, -v66, v69, -v85
    v_mul_f32 v82, v64, v45
    v_mul_f32 v83, v65, v45
    v_exp_f32 v82, v82
    v_fract_f32 v83, v83
    v_cos_f32 v70, v83
    v_sin_f32 v71, v83
    v_mul_f32 v70, v70, v82
    v_mul_f32 v71, v71, v82
    v_mul_f32 v84, v67, v71
    v_mul_f32 v85, v67, v70
    v_fma_f32 v70, v66, v70, -v84
    v_fma_f32 v71, -v66, v71, -v85
    v_mul_f32 v82, v64, v46
    v_mul_f32 v83, v65, v46
    v_exp_f32 v82, v82
    v_fract_f32 v83, v83
    v_cos_f32 v72, v83
    v_sin_f32 v73, v83
    v_mul_f32 v72, v72, v82
    v_mul_f32 v73, v73, v82
    v_mul_f32 v84, v67, v73
    v_mul_f32 v85, v67, v72
    v_fma_f32 v72, v66, v72, -v84
    v_fma_f32 v73, -v66, v73, -v85
    v_mfma_f32_16x16x4_f32 v[48:51], v68, v74, v[48:51]
    v_mfma_f32_16x16x4_f32 v[52:55], v70, v76, v[52:55]
    v_mfma_f32_16x16x4_f32 v[56:59], v70, v78, v[56:59]
    v_mfma_f32_16x16x4_f32 v[60:63], v72, v80, v[60:63]
    v_mfma_f32_16x16x4_f32 v[48:51], v69, v75, v[48:51]
    v_mfma_f32_16x16x4_f32 v[52:55], v71, v77, v[52:55]
    v_mfma_f32_16x16x4_f32 v[56:59], v71, v79, v[56:59]
    v_mfma_f32_16x16x4_f32 v[60:63], v73, v81, v[60:63]
    v_mov_b32_dpp v64, v24 row_newbcast:13 row_mask:0xf bank_mask:0xf
    v_mov_b32_dpp v65, v25 row_newbcast:13 row_mask:0xf bank_mask:0xf
    v_mov_b32_dpp v66, v26 row_newbcast:13 row_mask:0xf bank_mask:0xf
    v_mov_b32_dpp v67, v27 row_newbcast:13 row_mask:0xf bank_mask:0xf
    v_mul_f32 v82, v64, v47
    v_mul_f32 v83, v65, v47
    v_exp_f32 v82, v82
    v_fract_f32 v83, v83
    v_cos_f32 v74, v83
    v_sin_f32 v75, v83
    v_mul_f32 v74, v74, v82
    v_mul_f32 v75, v75, v82
    v_mul_f32 v84, v75, v75
    v_add_f32 v85, v74, v74
    v_fma_f32 v76, v74, v74, -v84
    v_mul_f32 v77, v85, v75
    v_mul_f32 v84, v77, v77
    v_add_f32 v85, v76, v76
    v_fma_f32 v78, v76, v76, -v84
    v_mul_f32 v79, v85, v77
    v_mul_f32 v84, v79, v79
    v_add_f32 v85, v78, v78
    v_fma_f32 v80, v78, v78, -v84
    v_mul_f32 v81, v85, v79
    v_mul_f32 v82, v64, v44
    v_mul_f32 v83, v65, v44
    v_exp_f32 v82, v82
    v_fract_f32 v83, v83
    v_cos_f32 v68, v83
    v_sin_f32 v69, v83
    v_mul_f32 v68, v68, v82
    v_mul_f32 v69, v69, v82
    v_mul_f32 v84, v67, v69
    v_mul_f32 v85, v67, v68
    v_fma_f32 v68, v66, v68, -v84
    v_fma_f32 v69, -v66, v69, -v85
    v_mul_f32 v82, v64, v45
    v_mul_f32 v83, v65, v45
    v_exp_f32 v82, v82
    v_fract_f32 v83, v83
    v_cos_f32 v70, v83
    v_sin_f32 v71, v83
    v_mul_f32 v70, v70, v82
    v_mul_f32 v71, v71, v82
    v_mul_f32 v84, v67, v71
    v_mul_f32 v85, v67, v70
    v_fma_f32 v70, v66, v70, -v84
    v_fma_f32 v71, -v66, v71, -v85
    v_mul_f32 v82, v64, v46
    v_mul_f32 v83, v65, v46
    v_exp_f32 v82, v82
    v_fract_f32 v83, v83
    v_cos_f32 v72, v83
    v_sin_f32 v73, v83
    v_mul_f32 v72, v72, v82
    v_mul_f32 v73, v73, v82
    v_mul_f32 v84, v67, v73
    v_mul_f32 v85, v67, v72
    v_fma_f32 v72, v66, v72, -v84
    v_fma_f32 v73, -v66, v73, -v85
    v_mfma_f32_16x16x4_f32 v[48:51], v68, v74, v[48:51]
    v_mfma_f32_16x16x4_f32 v[52:55], v70, v76, v[52:55]
    v_mfma_f32_16x16x4_f32 v[56:59], v70, v78, v[56:59]
    v_mfma_f32_16x16x4_f32 v[60:63], v72, v80, v[60:63]
    v_mfma_f32_16x16x4_f32 v[48:51], v69, v75, v[48:51]
    v_mfma_f32_16x16x4_f32 v[52:55], v71, v77, v[52:55]
    v_mfma_f32_16x16x4_f32 v[56:59], v71, v79, v[56:59]
    v_mfma_f32_16x16x4_f32 v[60:63], v73, v81, v[60:63]
    v_mov_b32_dpp v64, v24 row_newbcast:14 row_mask:0xf bank_mask:0xf
    v_mov_b32_dpp v65, v25 row_newbcast:14 row_mask:0xf bank_mask:0xf
    v_mov_b32_dpp v66, v26 row_newbcast:14 row_mask:0xf bank_mask:0xf
    v_mov_b32_dpp v67, v27 row_newbcast:14 row_mask:0xf bank_mask:0xf
    v_mul_f32 v82, v64, v47
    v_mul_f32 v83, v65, v47
    v_exp_f32 v82, v82
    v_fract_f32 v83, v83
    v_cos_f32 v74, v83
    v_sin_f32 v75, v83
    v_mul_f32 v74, v74, v82
    v_mul_f32 v75, v75, v82
    v_mul_f32 v84, v75, v75
    v_add_f32 v85, v74, v74
    v_fma_f32 v76, v74, v74, -v84
    v_mul_f32 v77, v85, v75
    v_mul_f32 v84, v77, v77
    v_add_f32 v85, v76, v76
    v_fma_f32 v78, v76, v76, -v84
    v_mul_f32 v79, v85, v77
    v_mul_f32 v84, v79, v79
    v_add_f32 v85, v78, v78
    v_fma_f32 v80, v78, v78, -v84
    v_mul_f32 v81, v85, v79
    v_mul_f32 v82, v64, v44
    v_mul_f32 v83, v65, v44
    v_exp_f32 v82, v82
    v_fract_f32 v83, v83
    v_cos_f32 v68, v83
    v_sin_f32 v69, v83
    v_mul_f32 v68, v68, v82
    v_mul_f32 v69, v69, v82
    v_mul_f32 v84, v67, v69
    v_mul_f32 v85, v67, v68
    v_fma_f32 v68, v66, v68, -v84
    v_fma_f32 v69, -v66, v69, -v85
    v_mul_f32 v82, v64, v45
    v_mul_f32 v83, v65, v45
    v_exp_f32 v82, v82
    v_fract_f32 v83, v83
    v_cos_f32 v70, v83
    v_sin_f32 v71, v83
    v_mul_f32 v70, v70, v82
    v_mul_f32 v71, v71, v82
    v_mul_f32 v84, v67, v71
    v_mul_f32 v85, v67, v70
    v_fma_f32 v70, v66, v70, -v84
    v_fma_f32 v71, -v66, v71, -v85
    v_mul_f32 v82, v64, v46
    v_mul_f32 v83, v65, v46
    v_exp_f32 v82, v82
    v_fract_f32 v83, v83
    v_cos_f32 v72, v83
    v_sin_f32 v73, v83
    v_mul_f32 v72, v72, v82
    v_mul_f32 v73, v73, v82
    v_mul_f32 v84, v67, v73
    v_mul_f32 v85, v67, v72
    v_fma_f32 v72, v66, v72, -v84
    v_fma_f32 v73, -v66, v73, -v85
    v_mfma_f32_16x16x4_f32 v[48:51], v68, v74, v[48:51]
    v_mfma_f32_16x16x4_f32 v[52:55], v70, v76, v[52:55]
    v_mfma_f32_16x16x4_f32 v[56:59], v70, v78, v[56:59]
    v_mfma_f32_16x16x4_f32 v[60:63], v72, v80, v[60:63]
    v_mfma_f32_16x16x4_f32 v[48:51], v69, v75, v[48:51]
    v_mfma_f32_16x16x4_f32 v[52:55], v71, v77, v[52:55]
    v_mfma_f32_16x16x4_f32 v[56:59], v71, v79, v[56:59]
    v_mfma_f32_16x16x4_f32 v[60:63], v73, v81, v[60:63]
    v_mov_b32_dpp v64, v24 row_newbcast:15 row_mask:0xf bank_mask:0xf
    v_mov_b32_dpp v65, v25 row_newbcast:15 row_mask:0xf bank_mask:0xf
    v_mov_b32_dpp v66, v26 row_newbcast:15 row_mask:0xf bank_mask:0xf
    v_mov_b32_dpp v67, v27 row_newbcast:15 row_mask:0xf bank_mask:0xf
    v_mul_f32 v82, v64, v47
    v_mul_f32 v83, v65, v47
    v_exp_f32 v82, v82
    v_fract_f32 v83, v83
    v_cos_f32 v74, v83
    v_sin_f32 v75, v83
    v_mul_f32 v74, v74, v82
    v_mul_f32 v75, v75, v82
    v_mul_f32 v84, v75, v75
    v_add_f32 v85, v74, v74
    v_fma_f32 v76, v74, v74, -v84
    v_mul_f32 v77, v85, v75
    v_mul_f32 v84, v77, v77
    v_add_f32 v85, v76, v76
    v_fma_f32 v78, v76, v76, -v84
    v_mul_f32 v79, v85, v77
    v_mul_f32 v84, v79, v79
    v_add_f32 v85, v78, v78
    v_fma_f32 v80, v78, v78, -v84
    v_mul_f32 v81, v85, v79
    v_mul_f32 v82, v64, v44
    v_mul_f32 v83, v65, v44
    v_exp_f32 v82, v82
    v_fract_f32 v83, v83
    v_cos_f32 v68, v83
    v_sin_f32 v69, v83
    v_mul_f32 v68, v68, v82
    v_mul_f32 v69, v69, v82
    v_mul_f32 v84, v67, v69
    v_mul_f32 v85, v67, v68
    v_fma_f32 v68, v66, v68, -v84
    v_fma_f32 v69, -v66, v69, -v85
    v_mul_f32 v82, v64, v45
    v_mul_f32 v83, v65, v45
    v_exp_f32 v82, v82
    v_fract_f32 v83, v83
    v_cos_f32 v70, v83
    v_sin_f32 v71, v83
    v_mul_f32 v70, v70, v82
    v_mul_f32 v71, v71, v82
    v_mul_f32 v84, v67, v71
    v_mul_f32 v85, v67, v70
    v_fma_f32 v70, v66, v70, -v84
    v_fma_f32 v71, -v66, v71, -v85
    v_mul_f32 v82, v64, v46
    v_mul_f32 v83, v65, v46
    v_exp_f32 v82, v82
    v_fract_f32 v83, v83
    v_cos_f32 v72, v83
    v_sin_f32 v73, v83
    v_mul_f32 v72, v72, v82
    v_mul_f32 v73, v73, v82
    v_mul_f32 v84, v67, v73
    v_mul_f32 v85, v67, v72
    v_fma_f32 v72, v66, v72, -v84
    v_fma_f32 v73, -v66, v73, -v85
    v_mfma_f32_16x16x4_f32 v[48:51], v68, v74, v[48:51]
    v_mfma_f32_16x16x4_f32 v[52:55], v70, v76, v[52:55]
    v_mfma_f32_16x16x4_f32 v[56:59], v70, v78, v[56:59]
    v_mfma_f32_16x16x4_f32 v[60:63], v72, v80, v[60:63]
    v_mfma_f32_16x16x4_f32 v[48:51], v69, v75, v[48:51]
    v_mfma_f32_16x16x4_f32 v[52:55], v71, v77, v[52:55]
    v_mfma_f32_16x16x4_f32 v[56:59], v71, v79, v[56:59]
    v_mfma_f32_16x16x4_f32 v[60:63], v73, v81, v[60:63]
    v_mov_b32_dpp v64, v28 row_newbcast:0 row_mask:0xf bank_mask:0xf
    v_mov_b32_dpp v65, v29 row_newbcast:0 row_mask:0xf bank_mask:0xf
    v_mov_b32_dpp v66, v30 row_newbcast:0 row_mask:0xf bank_mask:0xf
    v_mov_b32_dpp v67, v31 row_newbcast:0 row_mask:0xf bank_mask:0xf
    v_mul_f32 v82, v64, v47
    v_mul_f32 v83, v65, v47
    v_exp_f32 v82, v82
    v_fract_f32 v83, v83
    v_cos_f32 v74, v83
    v_sin_f32 v75, v83
    v_mul_f32 v74, v74, v82
    v_mul_f32 v75, v75, v82
    v_mul_f32 v84, v75, v75
    v_add_f32 v85, v74, v74
    v_fma_f32 v76, v74, v74, -v84
    v_mul_f32 v77, v85, v75
    v_mul_f32 v84, v77, v77
    v_add_f32 v85, v76, v76
    v_fma_f32 v78, v76, v76, -v84
    v_mul_f32 v79, v85, v77
    v_mul_f32 v84, v79, v79
    v_add_f32 v85, v78, v78
    v_fma_f32 v80, v78, v78, -v84
    v_mul_f32 v81, v85, v79
    v_mul_f32 v82, v64, v44
    v_mul_f32 v83, v65, v44
    v_exp_f32 v82, v82
    v_fract_f32 v83, v83
    v_cos_f32 v68, v83
    v_sin_f32 v69, v83
    v_mul_f32 v68, v68, v82
    v_mul_f32 v69, v69, v82
    v_mul_f32 v84, v67, v69
    v_mul_f32 v85, v67, v68
    v_fma_f32 v68, v66, v68, -v84
    v_fma_f32 v69, -v66, v69, -v85
    v_mul_f32 v82, v64, v45
    v_mul_f32 v83, v65, v45
    v_exp_f32 v82, v82
    v_fract_f32 v83, v83
    v_cos_f32 v70, v83
    v_sin_f32 v71, v83
    v_mul_f32 v70, v70, v82
    v_mul_f32 v71, v71, v82
    v_mul_f32 v84, v67, v71
    v_mul_f32 v85, v67, v70
    v_fma_f32 v70, v66, v70, -v84
    v_fma_f32 v71, -v66, v71, -v85
    v_mul_f32 v82, v64, v46
    v_mul_f32 v83, v65, v46
    v_exp_f32 v82, v82
    v_fract_f32 v83, v83
    v_cos_f32 v72, v83
    v_sin_f32 v73, v83
    v_mul_f32 v72, v72, v82
    v_mul_f32 v73, v73, v82
    v_mul_f32 v84, v67, v73
    v_mul_f32 v85, v67, v72
    v_fma_f32 v72, v66, v72, -v84
    v_fma_f32 v73, -v66, v73, -v85
    v_mfma_f32_16x16x4_f32 v[48:51], v68, v74, v[48:51]
    v_mfma_f32_16x16x4_f32 v[52:55], v70, v76, v[52:55]
    v_mfma_f32_16x16x4_f32 v[56:59], v70, v78, v[56:59]
    v_mfma_f32_16x16x4_f32 v[60:63], v72, v80, v[60:63]
    v_mfma_f32_16x16x4_f32 v[48:51], v69, v75, v[48:51]
    v_mfma_f32_16x16x4_f32 v[52:55], v71, v77, v[52:55]
    v_mfma_f32_16x16x4_f32 v[56:59], v71, v79, v[56:59]
    v_mfma_f32_16x16x4_f32 v[60:63], v73, v81, v[60:63]
    v_mov_b32_dpp v64, v28 row_newbcast:1 row_mask:0xf bank_mask:0xf
    v_mov_b32_dpp v65, v29 row_newbcast:1 row_mask:0xf bank_mask:0xf
    v_mov_b32_dpp v66, v30 row_newbcast:1 row_mask:0xf bank_mask:0xf
    v_mov_b32_dpp v67, v31 row_newbcast:1 row_mask:0xf bank_mask:0xf
    v_mul_f32 v82, v64, v47
    v_mul_f32 v83, v65, v47
    v_exp_f32 v82, v82
    v_fract_f32 v83, v83
    v_cos_f32 v74, v83
    v_sin_f32 v75, v83
    v_mul_f32 v74, v74, v82
    v_mul_f32 v75, v75, v82
    v_mul_f32 v84, v75, v75
    v_add_f32 v85, v74, v74
    v_fma_f32 v76, v74, v74, -v84
    v_mul_f32 v77, v85, v75
    v_mul_f32 v84, v77, v77
    v_add_f32 v85, v76, v76
    v_fma_f32 v78, v76, v76, -v84
    v_mul_f32 v79, v85, v77
    v_mul_f32 v84, v79, v79
    v_add_f32 v85, v78, v78
    v_fma_f32 v80, v78, v78, -v84
    v_mul_f32 v81, v85, v79
    v_mul_f32 v82, v64, v44
    v_mul_f32 v83, v65, v44
    v_exp_f32 v82, v82
    v_fract_f32 v83, v83
    v_cos_f32 v68, v83
    v_sin_f32 v69, v83
    v_mul_f32 v68, v68, v82
    v_mul_f32 v69, v69, v82
    v_mul_f32 v84, v67, v69
    v_mul_f32 v85, v67, v68
    v_fma_f32 v68, v66, v68, -v84
    v_fma_f32 v69, -v66, v69, -v85
    v_mul_f32 v82, v64, v45
    v_mul_f32 v83, v65, v45
    v_exp_f32 v82, v82
    v_fract_f32 v83, v83
    v_cos_f32 v70, v83
    v_sin_f32 v71, v83
    v_mul_f32 v70, v70, v82
    v_mul_f32 v71, v71, v82
    v_mul_f32 v84, v67, v71
    v_mul_f32 v85, v67, v70
    v_fma_f32 v70, v66, v70, -v84
    v_fma_f32 v71, -v66, v71, -v85
    v_mul_f32 v82, v64, v46
    v_mul_f32 v83, v65, v46
    v_exp_f32 v82, v82
    v_fract_f32 v83, v83
    v_cos_f32 v72, v83
    v_sin_f32 v73, v83
    v_mul_f32 v72, v72, v82
    v_mul_f32 v73, v73, v82
    v_mul_f32 v84, v67, v73
    v_mul_f32 v85, v67, v72
    v_fma_f32 v72, v66, v72, -v84
    v_fma_f32 v73, -v66, v73, -v85
    v_mfma_f32_16x16x4_f32 v[48:51], v68, v74, v[48:51]
    v_mfma_f32_16x16x4_f32 v[52:55], v70, v76, v[52:55]
    v_mfma_f32_16x16x4_f32 v[56:59], v70, v78, v[56:59]
    v_mfma_f32_16x16x4_f32 v[60:63], v72, v80, v[60:63]
    v_mfma_f32_16x16x4_f32 v[48:51], v69, v75, v[48:51]
    v_mfma_f32_16x16x4_f32 v[52:55], v71, v77, v[52:55]
    v_mfma_f32_16x16x4_f32 v[56:59], v71, v79, v[56:59]
    v_mfma_f32_16x16x4_f32 v[60:63], v73, v81, v[60:63]
    v_mov_b32_dpp v64, v28 row_newbcast:2 row_mask:0xf bank_mask:0xf
    v_mov_b32_dpp v65, v29 row_newbcast:2 row_mask:0xf bank_mask:0xf
    v_mov_b32_dpp v66, v30 row_newbcast:2 row_mask:0xf bank_mask:0xf
    v_mov_b32_dpp v67, v31 row_newbcast:2 row_mask:0xf bank_mask:0xf
    v_mul_f32 v82, v64, v47
    v_mul_f32 v83, v65, v47
    v_exp_f32 v82, v82
    v_fract_f32 v83, v83
    v_cos_f32 v74, v83
    v_sin_f32 v75, v83
    v_mul_f32 v74, v74, v82
    v_mul_f32 v75, v75, v82
    v_mul_f32 v84, v75, v75
    v_add_f32 v85, v74, v74
    v_fma_f32 v76, v74, v74, -v84
    v_mul_f32 v77, v85, v75
    v_mul_f32 v84, v77, v77
    v_add_f32 v85, v76, v76
    v_fma_f32 v78, v76, v76, -v84
    v_mul_f32 v79, v85, v77
    v_mul_f32 v84, v79, v79
    v_add_f32 v85, v78, v78
    v_fma_f32 v80, v78, v78, -v84
    v_mul_f32 v81, v85, v79
    v_mul_f32 v82, v64, v44
    v_mul_f32 v83, v65, v44
    v_exp_f32 v82, v82
    v_fract_f32 v83, v83
    v_cos_f32 v68, v83
    v_sin_f32 v69, v83
    v_mul_f32 v68, v68, v82
    v_mul_f32 v69, v69, v82
    v_mul_f32 v84, v67, v69
    v_mul_f32 v85, v67, v68
    v_fma_f32 v68, v66, v68, -v84
    v_fma_f32 v69, -v66, v69, -v85
    v_mul_f32 v82, v64, v45
    v_mul_f32 v83, v65, v45
    v_exp_f32 v82, v82
    v_fract_f32 v83, v83
    v_cos_f32 v70, v83
    v_sin_f32 v71, v83
    v_mul_f32 v70, v70, v82
    v_mul_f32 v71, v71, v82
    v_mul_f32 v84, v67, v71
    v_mul_f32 v85, v67, v70
    v_fma_f32 v70, v66, v70, -v84
    v_fma_f32 v71, -v66, v71, -v85
    v_mul_f32 v82, v64, v46
    v_mul_f32 v83, v65, v46
    v_exp_f32 v82, v82
    v_fract_f32 v83, v83
    v_cos_f32 v72, v83
    v_sin_f32 v73, v83
    v_mul_f32 v72, v72, v82
    v_mul_f32 v73, v73, v82
    v_mul_f32 v84, v67, v73
    v_mul_f32 v85, v67, v72
    v_fma_f32 v72, v66, v72, -v84
    v_fma_f32 v73, -v66, v73, -v85
    v_mfma_f32_16x16x4_f32 v[48:51], v68, v74, v[48:51]
    v_mfma_f32_16x16x4_f32 v[52:55], v70, v76, v[52:55]
    v_mfma_f32_16x16x4_f32 v[56:59], v70, v78, v[56:59]
    v_mfma_f32_16x16x4_f32 v[60:63], v72, v80, v[60:63]
    v_mfma_f32_16x16x4_f32 v[48:51], v69, v75, v[48:51]
    v_mfma_f32_16x16x4_f32 v[52:55], v71, v77, v[52:55]
    v_mfma_f32_16x16x4_f32 v[56:59], v71, v79, v[56:59]
    v_mfma_f32_16x16x4_f32 v[60:63], v73, v81, v[60:63]
    v_mov_b32_dpp v64, v28 row_newbcast:3 row_mask:0xf bank_mask:0xf
    v_mov_b32_dpp v65, v29 row_newbcast:3 row_mask:0xf bank_mask:0xf
    v_mov_b32_dpp v66, v30 row_newbcast:3 row_mask:0xf bank_mask:0xf
    v_mov_b32_dpp v67, v31 row_newbcast:3 row_mask:0xf bank_mask:0xf
    v_mul_f32 v82, v64, v47
    v_mul_f32 v83, v65, v47
    v_exp_f32 v82, v82
    v_fract_f32 v83, v83
    v_cos_f32 v74, v83
    v_sin_f32 v75, v83
    v_mul_f32 v74, v74, v82
    v_mul_f32 v75, v75, v82
    v_mul_f32 v84, v75, v75
    v_add_f32 v85, v74, v74
    v_fma_f32 v76, v74, v74, -v84
    v_mul_f32 v77, v85, v75
    v_mul_f32 v84, v77, v77
    v_add_f32 v85, v76, v76
    v_fma_f32 v78, v76, v76, -v84
    v_mul_f32 v79, v85, v77
    v_mul_f32 v84, v79, v79
    v_add_f32 v85, v78, v78
    v_fma_f32 v80, v78, v78, -v84
    v_mul_f32 v81, v85, v79
    v_mul_f32 v82, v64, v44
    v_mul_f32 v83, v65, v44
    v_exp_f32 v82, v82
    v_fract_f32 v83, v83
    v_cos_f32 v68, v83
    v_sin_f32 v69, v83
    v_mul_f32 v68, v68, v82
    v_mul_f32 v69, v69, v82
    v_mul_f32 v84, v67, v69
    v_mul_f32 v85, v67, v68
    v_fma_f32 v68, v66, v68, -v84
    v_fma_f32 v69, -v66, v69, -v85
    v_mul_f32 v82, v64, v45
    v_mul_f32 v83, v65, v45
    v_exp_f32 v82, v82
    v_fract_f32 v83, v83
    v_cos_f32 v70, v83
    v_sin_f32 v71, v83
    v_mul_f32 v70, v70, v82
    v_mul_f32 v71, v71, v82
    v_mul_f32 v84, v67, v71
    v_mul_f32 v85, v67, v70
    v_fma_f32 v70, v66, v70, -v84
    v_fma_f32 v71, -v66, v71, -v85
    v_mul_f32 v82, v64, v46
    v_mul_f32 v83, v65, v46
    v_exp_f32 v82, v82
    v_fract_f32 v83, v83
    v_cos_f32 v72, v83
    v_sin_f32 v73, v83
    v_mul_f32 v72, v72, v82
    v_mul_f32 v73, v73, v82
    v_mul_f32 v84, v67, v73
    v_mul_f32 v85, v67, v72
    v_fma_f32 v72, v66, v72, -v84
    v_fma_f32 v73, -v66, v73, -v85
    v_mfma_f32_16x16x4_f32 v[48:51], v68, v74, v[48:51]
    v_mfma_f32_16x16x4_f32 v[52:55], v70, v76, v[52:55]
    v_mfma_f32_16x16x4_f32 v[56:59], v70, v78, v[56:59]
    v_mfma_f32_16x16x4_f32 v[60:63], v72, v80, v[60:63]
    v_mfma_f32_16x16x4_f32 v[48:51], v69, v75, v[48:51]
    v_mfma_f32_16x16x4_f32 v[52:55], v71, v77, v[52:55]
    v_mfma_f32_16x16x4_f32 v[56:59], v71, v79, v[56:59]
    v_mfma_f32_16x16x4_f32 v[60:63], v73, v81, v[60:63]
    v_mov_b32_dpp v64, v28 row_newbcast:4 row_mask:0xf bank_mask:0xf
    v_mov_b32_dpp v65, v29 row_newbcast:4 row_mask:0xf bank_mask:0xf
    v_mov_b32_dpp v66, v30 row_newbcast:4 row_mask:0xf bank_mask:0xf
    v_mov_b32_dpp v67, v31 row_newbcast:4 row_mask:0xf bank_mask:0xf
    v_mul_f32 v82, v64, v47
    v_mul_f32 v83, v65, v47
    v_exp_f32 v82, v82
    v_fract_f32 v83, v83
    v_cos_f32 v74, v83
    v_sin_f32 v75, v83
    v_mul_f32 v74, v74, v82
    v_mul_f32 v75, v75, v82
    v_mul_f32 v84, v75, v75
    v_add_f32 v85, v74, v74
    v_fma_f32 v76, v74, v74, -v84
    v_mul_f32 v77, v85, v75
    v_mul_f32 v84, v77, v77
    v_add_f32 v85, v76, v76
    v_fma_f32 v78, v76, v76, -v84
    v_mul_f32 v79, v85, v77
    v_mul_f32 v84, v79, v79
    v_add_f32 v85, v78, v78
    v_fma_f32 v80, v78, v78, -v84
    v_mul_f32 v81, v85, v79
    v_mul_f32 v82, v64, v44
    v_mul_f32 v83, v65, v44
    v_exp_f32 v82, v82
    v_fract_f32 v83, v83
    v_cos_f32 v68, v83
    v_sin_f32 v69, v83
    v_mul_f32 v68, v68, v82
    v_mul_f32 v69, v69, v82
    v_mul_f32 v84, v67, v69
    v_mul_f32 v85, v67, v68
    v_fma_f32 v68, v66, v68, -v84
    v_fma_f32 v69, -v66, v69, -v85
    v_mul_f32 v82, v64, v45
    v_mul_f32 v83, v65, v45
    v_exp_f32 v82, v82
    v_fract_f32 v83, v83
    v_cos_f32 v70, v83
    v_sin_f32 v71, v83
    v_mul_f32 v70, v70, v82
    v_mul_f32 v71, v71, v82
    v_mul_f32 v84, v67, v71
    v_mul_f32 v85, v67, v70
    v_fma_f32 v70, v66, v70, -v84
    v_fma_f32 v71, -v66, v71, -v85
    v_mul_f32 v82, v64, v46
    v_mul_f32 v83, v65, v46
    v_exp_f32 v82, v82
    v_fract_f32 v83, v83
    v_cos_f32 v72, v83
    v_sin_f32 v73, v83
    v_mul_f32 v72, v72, v82
    v_mul_f32 v73, v73, v82
    v_mul_f32 v84, v67, v73
    v_mul_f32 v85, v67, v72
    v_fma_f32 v72, v66, v72, -v84
    v_fma_f32 v73, -v66, v73, -v85
    v_mfma_f32_16x16x4_f32 v[48:51], v68, v74, v[48:51]
    v_mfma_f32_16x16x4_f32 v[52:55], v70, v76, v[52:55]
    v_mfma_f32_16x16x4_f32 v[56:59], v70, v78, v[56:59]
    v_mfma_f32_16x16x4_f32 v[60:63], v72, v80, v[60:63]
    v_mfma_f32_16x16x4_f32 v[48:51], v69, v75, v[48:51]
    v_mfma_f32_16x16x4_f32 v[52:55], v71, v77, v[52:55]
    v_mfma_f32_16x16x4_f32 v[56:59], v71, v79, v[56:59]
    v_mfma_f32_16x16x4_f32 v[60:63], v73, v81, v[60:63]
    v_mov_b32_dpp v64, v28 row_newbcast:5 row_mask:0xf bank_mask:0xf
    v_mov_b32_dpp v65, v29 row_newbcast:5 row_mask:0xf bank_mask:0xf
    v_mov_b32_dpp v66, v30 row_newbcast:5 row_mask:0xf bank_mask:0xf
    v_mov_b32_dpp v67, v31 row_newbcast:5 row_mask:0xf bank_mask:0xf
    v_mul_f32 v82, v64, v47
    v_mul_f32 v83, v65, v47
    v_exp_f32 v82, v82
    v_fract_f32 v83, v83
    v_cos_f32 v74, v83
    v_sin_f32 v75, v83
    v_mul_f32 v74, v74, v82
    v_mul_f32 v75, v75, v82
    v_mul_f32 v84, v75, v75
    v_add_f32 v85, v74, v74
    v_fma_f32 v76, v74, v74, -v84
    v_mul_f32 v77, v85, v75
    v_mul_f32 v84, v77, v77
    v_add_f32 v85, v76, v76
    v_fma_f32 v78, v76, v76, -v84
    v_mul_f32 v79, v85, v77
    v_mul_f32 v84, v79, v79
    v_add_f32 v85, v78, v78
    v_fma_f32 v80, v78, v78, -v84
    v_mul_f32 v81, v85, v79
    v_mul_f32 v82, v64, v44
    v_mul_f32 v83, v65, v44
    v_exp_f32 v82, v82
    v_fract_f32 v83, v83
    v_cos_f32 v68, v83
    v_sin_f32 v69, v83
    v_mul_f32 v68, v68, v82
    v_mul_f32 v69, v69, v82
    v_mul_f32 v84, v67, v69
    v_mul_f32 v85, v67, v68
    v_fma_f32 v68, v66, v68, -v84
    v_fma_f32 v69, -v66, v69, -v85
    v_mul_f32 v82, v64, v45
    v_mul_f32 v83, v65, v45
    v_exp_f32 v82, v82
    v_fract_f32 v83, v83
    v_cos_f32 v70, v83
    v_sin_f32 v71, v83
    v_mul_f32 v70, v70, v82
    v_mul_f32 v71, v71, v82
    v_mul_f32 v84, v67, v71
    v_mul_f32 v85, v67, v70
    v_fma_f32 v70, v66, v70, -v84
    v_fma_f32 v71, -v66, v71, -v85
    v_mul_f32 v82, v64, v46
    v_mul_f32 v83, v65, v46
    v_exp_f32 v82, v82
    v_fract_f32 v83, v83
    v_cos_f32 v72, v83
    v_sin_f32 v73, v83
    v_mul_f32 v72, v72, v82
    v_mul_f32 v73, v73, v82
    v_mul_f32 v84, v67, v73
    v_mul_f32 v85, v67, v72
    v_fma_f32 v72, v66, v72, -v84
    v_fma_f32 v73, -v66, v73, -v85
    v_mfma_f32_16x16x4_f32 v[48:51], v68, v74, v[48:51]
    v_mfma_f32_16x16x4_f32 v[52:55], v70, v76, v[52:55]
    v_mfma_f32_16x16x4_f32 v[56:59], v70, v78, v[56:59]
    v_mfma_f32_16x16x4_f32 v[60:63], v72, v80, v[60:63]
    v_mfma_f32_16x16x4_f32 v[48:51], v69, v75, v[48:51]
    v_mfma_f32_16x16x4_f32 v[52:55], v71, v77, v[52:55]
    v_mfma_f32_16x16x4_f32 v[56:59], v71, v79, v[56:59]
    v_mfma_f32_16x16x4_f32 v[60:63], v73, v81, v[60:63]
    v_mov_b32_dpp v64, v28 row_newbcast:6 row_mask:0xf bank_mask:0xf
    v_mov_b32_dpp v65, v29 row_newbcast:6 row_mask:0xf bank_mask:0xf
    v_mov_b32_dpp v66, v30 row_newbcast:6 row_mask:0xf bank_mask:0xf
    v_mov_b32_dpp v67, v31 row_newbcast:6 row_mask:0xf bank_mask:0xf
    v_mul_f32 v82, v64, v47
    v_mul_f32 v83, v65, v47
    v_exp_f32 v82, v82
    v_fract_f32 v83, v83
    v_cos_f32 v74, v83
    v_sin_f32 v75, v83
    v_mul_f32 v74, v74, v82
    v_mul_f32 v75, v75, v82
    v_mul_f32 v84, v75, v75
    v_add_f32 v85, v74, v74
    v_fma_f32 v76, v74, v74, -v84
    v_mul_f32 v77, v85, v75
    v_mul_f32 v84, v77, v77
    v_add_f32 v85, v76, v76
    v_fma_f32 v78, v76, v76, -v84
    v_mul_f32 v79, v85, v77
    v_mul_f32 v84, v79, v79
    v_add_f32 v85, v78, v78
    v_fma_f32 v80, v78, v78, -v84
    v_mul_f32 v81, v85, v79
    v_mul_f32 v82, v64, v44
    v_mul_f32 v83, v65, v44
    v_exp_f32 v82, v82
    v_fract_f32 v83, v83
    v_cos_f32 v68, v83
    v_sin_f32 v69, v83
    v_mul_f32 v68, v68, v82
    v_mul_f32 v69, v69, v82
    v_mul_f32 v84, v67, v69
    v_mul_f32 v85, v67, v68
    v_fma_f32 v68, v66, v68, -v84
    v_fma_f32 v69, -v66, v69, -v85
    v_mul_f32 v82, v64, v45
    v_mul_f32 v83, v65, v45
    v_exp_f32 v82, v82
    v_fract_f32 v83, v83
    v_cos_f32 v70, v83
    v_sin_f32 v71, v83
    v_mul_f32 v70, v70, v82
    v_mul_f32 v71, v71, v82
    v_mul_f32 v84, v67, v71
    v_mul_f32 v85, v67, v70
    v_fma_f32 v70, v66, v70, -v84
    v_fma_f32 v71, -v66, v71, -v85
    v_mul_f32 v82, v64, v46
    v_mul_f32 v83, v65, v46
    v_exp_f32 v82, v82
    v_fract_f32 v83, v83
    v_cos_f32 v72, v83
    v_sin_f32 v73, v83
    v_mul_f32 v72, v72, v82
    v_mul_f32 v73, v73, v82
    v_mul_f32 v84, v67, v73
    v_mul_f32 v85, v67, v72
    v_fma_f32 v72, v66, v72, -v84
    v_fma_f32 v73, -v66, v73, -v85
    v_mfma_f32_16x16x4_f32 v[48:51], v68, v74, v[48:51]
    v_mfma_f32_16x16x4_f32 v[52:55], v70, v76, v[52:55]
    v_mfma_f32_16x16x4_f32 v[56:59], v70, v78, v[56:59]
    v_mfma_f32_16x16x4_f32 v[60:63], v72, v80, v[60:63]
    v_mfma_f32_16x16x4_f32 v[48:51], v69, v75, v[48:51]
    v_mfma_f32_16x16x4_f32 v[52:55], v71, v77, v[52:55]
    v_mfma_f32_16x16x4_f32 v[56:59], v71, v79, v[56:59]
    v_mfma_f32_16x16x4_f32 v[60:63], v73, v81, v[60:63]
    v_mov_b32_dpp v64, v28 row_newbcast:7 row_mask:0xf bank_mask:0xf
    v_mov_b32_dpp v65, v29 row_newbcast:7 row_mask:0xf bank_mask:0xf
    v_mov_b32_dpp v66, v30 row_newbcast:7 row_mask:0xf bank_mask:0xf
    v_mov_b32_dpp v67, v31 row_newbcast:7 row_mask:0xf bank_mask:0xf
    v_mul_f32 v82, v64, v47
    v_mul_f32 v83, v65, v47
    v_exp_f32 v82, v82
    v_fract_f32 v83, v83
    v_cos_f32 v74, v83
    v_sin_f32 v75, v83
    v_mul_f32 v74, v74, v82
    v_mul_f32 v75, v75, v82
    v_mul_f32 v84, v75, v75
    v_add_f32 v85, v74, v74
    v_fma_f32 v76, v74, v74, -v84
    v_mul_f32 v77, v85, v75
    v_mul_f32 v84, v77, v77
    v_add_f32 v85, v76, v76
    v_fma_f32 v78, v76, v76, -v84
    v_mul_f32 v79, v85, v77
    v_mul_f32 v84, v79, v79
    v_add_f32 v85, v78, v78
    v_fma_f32 v80, v78, v78, -v84
    v_mul_f32 v81, v85, v79
    v_mul_f32 v82, v64, v44
    v_mul_f32 v83, v65, v44
    v_exp_f32 v82, v82
    v_fract_f32 v83, v83
    v_cos_f32 v68, v83
    v_sin_f32 v69, v83
    v_mul_f32 v68, v68, v82
    v_mul_f32 v69, v69, v82
    v_mul_f32 v84, v67, v69
    v_mul_f32 v85, v67, v68
    v_fma_f32 v68, v66, v68, -v84
    v_fma_f32 v69, -v66, v69, -v85
    v_mul_f32 v82, v64, v45
    v_mul_f32 v83, v65, v45
    v_exp_f32 v82, v82
    v_fract_f32 v83, v83
    v_cos_f32 v70, v83
    v_sin_f32 v71, v83
    v_mul_f32 v70, v70, v82
    v_mul_f32 v71, v71, v82
    v_mul_f32 v84, v67, v71
    v_mul_f32 v85, v67, v70
    v_fma_f32 v70, v66, v70, -v84
    v_fma_f32 v71, -v66, v71, -v85
    v_mul_f32 v82, v64, v46
    v_mul_f32 v83, v65, v46
    v_exp_f32 v82, v82
    v_fract_f32 v83, v83
    v_cos_f32 v72, v83
    v_sin_f32 v73, v83
    v_mul_f32 v72, v72, v82
    v_mul_f32 v73, v73, v82
    v_mul_f32 v84, v67, v73
    v_mul_f32 v85, v67, v72
    v_fma_f32 v72, v66, v72, -v84
    v_fma_f32 v73, -v66, v73, -v85
    v_mfma_f32_16x16x4_f32 v[48:51], v68, v74, v[48:51]
    v_mfma_f32_16x16x4_f32 v[52:55], v70, v76, v[52:55]
    v_mfma_f32_16x16x4_f32 v[56:59], v70, v78, v[56:59]
    v_mfma_f32_16x16x4_f32 v[60:63], v72, v80, v[60:63]
    v_mfma_f32_16x16x4_f32 v[48:51], v69, v75, v[48:51]
    v_mfma_f32_16x16x4_f32 v[52:55], v71, v77, v[52:55]
    v_mfma_f32_16x16x4_f32 v[56:59], v71, v79, v[56:59]
    v_mfma_f32_16x16x4_f32 v[60:63], v73, v81, v[60:63]
    v_mov_b32_dpp v64, v28 row_newbcast:8 row_mask:0xf bank_mask:0xf
    v_mov_b32_dpp v65, v29 row_newbcast:8 row_mask:0xf bank_mask:0xf
    v_mov_b32_dpp v66, v30 row_newbcast:8 row_mask:0xf bank_mask:0xf
    v_mov_b32_dpp v67, v31 row_newbcast:8 row_mask:0xf bank_mask:0xf
    v_mul_f32 v82, v64, v47
    v_mul_f32 v83, v65, v47
    v_exp_f32 v82, v82
    v_fract_f32 v83, v83
    v_cos_f32 v74, v83
    v_sin_f32 v75, v83
    v_mul_f32 v74, v74, v82
    v_mul_f32 v75, v75, v82
    v_mul_f32 v84, v75, v75
    v_add_f32 v85, v74, v74
    v_fma_f32 v76, v74, v74, -v84
    v_mul_f32 v77, v85, v75
    v_mul_f32 v84, v77, v77
    v_add_f32 v85, v76, v76
    v_fma_f32 v78, v76, v76, -v84
    v_mul_f32 v79, v85, v77
    v_mul_f32 v84, v79, v79
    v_add_f32 v85, v78, v78
    v_fma_f32 v80, v78, v78, -v84
    v_mul_f32 v81, v85, v79
    v_mul_f32 v82, v64, v44
    v_mul_f32 v83, v65, v44
    v_exp_f32 v82, v82
    v_fract_f32 v83, v83
    v_cos_f32 v68, v83
    v_sin_f32 v69, v83
    v_mul_f32 v68, v68, v82
    v_mul_f32 v69, v69, v82
    v_mul_f32 v84, v67, v69
    v_mul_f32 v85, v67, v68
    v_fma_f32 v68, v66, v68, -v84
    v_fma_f32 v69, -v66, v69, -v85
    v_mul_f32 v82, v64, v45
    v_mul_f32 v83, v65, v45
    v_exp_f32 v82, v82
    v_fract_f32 v83, v83
    v_cos_f32 v70, v83
    v_sin_f32 v71, v83
    v_mul_f32 v70, v70, v82
    v_mul_f32 v71, v71, v82
    v_mul_f32 v84, v67, v71
    v_mul_f32 v85, v67, v70
    v_fma_f32 v70, v66, v70, -v84
    v_fma_f32 v71, -v66, v71, -v85
    v_mul_f32 v82, v64, v46
    v_mul_f32 v83, v65, v46
    v_exp_f32 v82, v82
    v_fract_f32 v83, v83
    v_cos_f32 v72, v83
    v_sin_f32 v73, v83
    v_mul_f32 v72, v72, v82
    v_mul_f32 v73, v73, v82
    v_mul_f32 v84, v67, v73
    v_mul_f32 v85, v67, v72
    v_fma_f32 v72, v66, v72, -v84
    v_fma_f32 v73, -v66, v73, -v85
    v_mfma_f32_16x16x4_f32 v[48:51], v68, v74, v[48:51]
    v_mfma_f32_16x16x4_f32 v[52:55], v70, v76, v[52:55]
    v_mfma_f32_16x16x4_f32 v[56:59], v70, v78, v[56:59]
    v_mfma_f32_16x16x4_f32 v[60:63], v72, v80, v[60:63]
    v_mfma_f32_16x16x4_f32 v[48:51], v69, v75, v[48:51]
    v_mfma_f32_16x16x4_f32 v[52:55], v71, v77, v[52:55]
    v_mfma_f32_16x16x4_f32 v[56:59], v71, v79, v[56:59]
    v_mfma_f32_16x16x4_f32 v[60:63], v73, v81, v[60:63]
    v_mov_b32_dpp v64, v28 row_newbcast:9 row_mask:0xf bank_mask:0xf
    v_mov_b32_dpp v65, v29 row_newbcast:9 row_mask:0xf bank_mask:0xf
    v_mov_b32_dpp v66, v30 row_newbcast:9 row_mask:0xf bank_mask:0xf
    v_mov_b32_dpp v67, v31 row_newbcast:9 row_mask:0xf bank_mask:0xf
    v_mul_f32 v82, v64, v47
    v_mul_f32 v83, v65, v47
    v_exp_f32 v82, v82
    v_fract_f32 v83, v83
    v_cos_f32 v74, v83
    v_sin_f32 v75, v83
    v_mul_f32 v74, v74, v82
    v_mul_f32 v75, v75, v82
    v_mul_f32 v84, v75, v75
    v_add_f32 v85, v74, v74
    v_fma_f32 v76, v74, v74, -v84
    v_mul_f32 v77, v85, v75
    v_mul_f32 v84, v77, v77
    v_add_f32 v85, v76, v76
    v_fma_f32 v78, v76, v76, -v84
    v_mul_f32 v79, v85, v77
    v_mul_f32 v84, v79, v79
    v_add_f32 v85, v78, v78
    v_fma_f32 v80, v78, v78, -v84
    v_mul_f32 v81, v85, v79
    v_mul_f32 v82, v64, v44
    v_mul_f32 v83, v65, v44
    v_exp_f32 v82, v82
    v_fract_f32 v83, v83
    v_cos_f32 v68, v83
    v_sin_f32 v69, v83
    v_mul_f32 v68, v68, v82
    v_mul_f32 v69, v69, v82
    v_mul_f32 v84, v67, v69
    v_mul_f32 v85, v67, v68
    v_fma_f32 v68, v66, v68, -v84
    v_fma_f32 v69, -v66, v69, -v85
    v_mul_f32 v82, v64, v45
    v_mul_f32 v83, v65, v45
    v_exp_f32 v82, v82
    v_fract_f32 v83, v83
    v_cos_f32 v70, v83
    v_sin_f32 v71, v83
    v_mul_f32 v70, v70, v82
    v_mul_f32 v71, v71, v82
    v_mul_f32 v84, v67, v71
    v_mul_f32 v85, v67, v70
    v_fma_f32 v70, v66, v70, -v84
    v_fma_f32 v71, -v66, v71, -v85
    v_mul_f32 v82, v64, v46
    v_mul_f32 v83, v65, v46
    v_exp_f32 v82, v82
    v_fract_f32 v83, v83
    v_cos_f32 v72, v83
    v_sin_f32 v73, v83
    v_mul_f32 v72, v72, v82
    v_mul_f32 v73, v73, v82
    v_mul_f32 v84, v67, v73
    v_mul_f32 v85, v67, v72
    v_fma_f32 v72, v66, v72, -v84
    v_fma_f32 v73, -v66, v73, -v85
    v_mfma_f32_16x16x4_f32 v[48:51], v68, v74, v[48:51]
    v_mfma_f32_16x16x4_f32 v[52:55], v70, v76, v[52:55]
    v_mfma_f32_16x16x4_f32 v[56:59], v70, v78, v[56:59]
    v_mfma_f32_16x16x4_f32 v[60:63], v72, v80, v[60:63]
    v_mfma_f32_16x16x4_f32 v[48:51], v69, v75, v[48:51]
    v_mfma_f32_16x16x4_f32 v[52:55], v71, v77, v[52:55]
    v_mfma_f32_16x16x4_f32 v[56:59], v71, v79, v[56:59]
    v_mfma_f32_16x16x4_f32 v[60:63], v73, v81, v[60:63]
    v_mov_b32_dpp v64, v28 row_newbcast:10 row_mask:0xf bank_mask:0xf
    v_mov_b32_dpp v65, v29 row_newbcast:10 row_mask:0xf bank_mask:0xf
    v_mov_b32_dpp v66, v30 row_newbcast:10 row_mask:0xf bank_mask:0xf
    v_mov_b32_dpp v67, v31 row_newbcast:10 row_mask:0xf bank_mask:0xf
    v_mul_f32 v82, v64, v47
    v_mul_f32 v83, v65, v47
    v_exp_f32 v82, v82
    v_fract_f32 v83, v83
    v_cos_f32 v74, v83
    v_sin_f32 v75, v83
    v_mul_f32 v74, v74, v82
    v_mul_f32 v75, v75, v82
    v_mul_f32 v84, v75, v75
    v_add_f32 v85, v74, v74
    v_fma_f32 v76, v74, v74, -v84
    v_mul_f32 v77, v85, v75
    v_mul_f32 v84, v77, v77
    v_add_f32 v85, v76, v76
    v_fma_f32 v78, v76, v76, -v84
    v_mul_f32 v79, v85, v77
    v_mul_f32 v84, v79, v79
    v_add_f32 v85, v78, v78
    v_fma_f32 v80, v78, v78, -v84
    v_mul_f32 v81, v85, v79
    v_mul_f32 v82, v64, v44
    v_mul_f32 v83, v65, v44
    v_exp_f32 v82, v82
    v_fract_f32 v83, v83
    v_cos_f32 v68, v83
    v_sin_f32 v69, v83
    v_mul_f32 v68, v68, v82
    v_mul_f32 v69, v69, v82
    v_mul_f32 v84, v67, v69
    v_mul_f32 v85, v67, v68
    v_fma_f32 v68, v66, v68, -v84
    v_fma_f32 v69, -v66, v69, -v85
    v_mul_f32 v82, v64, v45
    v_mul_f32 v83, v65, v45
    v_exp_f32 v82, v82
    v_fract_f32 v83, v83
    v_cos_f32 v70, v83
    v_sin_f32 v71, v83
    v_mul_f32 v70, v70, v82
    v_mul_f32 v71, v71, v82
    v_mul_f32 v84, v67, v71
    v_mul_f32 v85, v67, v70
    v_fma_f32 v70, v66, v70, -v84
    v_fma_f32 v71, -v66, v71, -v85
    v_mul_f32 v82, v64, v46
    v_mul_f32 v83, v65, v46
    v_exp_f32 v82, v82
    v_fract_f32 v83, v83
    v_cos_f32 v72, v83
    v_sin_f32 v73, v83
    v_mul_f32 v72, v72, v82
    v_mul_f32 v73, v73, v82
    v_mul_f32 v84, v67, v73
    v_mul_f32 v85, v67, v72
    v_fma_f32 v72, v66, v72, -v84
    v_fma_f32 v73, -v66, v73, -v85
    v_mfma_f32_16x16x4_f32 v[48:51], v68, v74, v[48:51]
    v_mfma_f32_16x16x4_f32 v[52:55], v70, v76, v[52:55]
    v_mfma_f32_16x16x4_f32 v[56:59], v70, v78, v[56:59]
    v_mfma_f32_16x16x4_f32 v[60:63], v72, v80, v[60:63]
    v_mfma_f32_16x16x4_f32 v[48:51], v69, v75, v[48:51]
    v_mfma_f32_16x16x4_f32 v[52:55], v71, v77, v[52:55]
    v_mfma_f32_16x16x4_f32 v[56:59], v71, v79, v[56:59]
    v_mfma_f32_16x16x4_f32 v[60:63], v73, v81, v[60:63]
    v_mov_b32_dpp v64, v28 row_newbcast:11 row_mask:0xf bank_mask:0xf
    v_mov_b32_dpp v65, v29 row_newbcast:11 row_mask:0xf bank_mask:0xf
    v_mov_b32_dpp v66, v30 row_newbcast:11 row_mask:0xf bank_mask:0xf
    v_mov_b32_dpp v67, v31 row_newbcast:11 row_mask:0xf bank_mask:0xf
    v_mul_f32 v82, v64, v47
    v_mul_f32 v83, v65, v47
    v_exp_f32 v82, v82
    v_fract_f32 v83, v83
    v_cos_f32 v74, v83
    v_sin_f32 v75, v83
    v_mul_f32 v74, v74, v82
    v_mul_f32 v75, v75, v82
    v_mul_f32 v84, v75, v75
    v_add_f32 v85, v74, v74
    v_fma_f32 v76, v74, v74, -v84
    v_mul_f32 v77, v85, v75
    v_mul_f32 v84, v77, v77
    v_add_f32 v85, v76, v76
    v_fma_f32 v78, v76, v76, -v84
    v_mul_f32 v79, v85, v77
    v_mul_f32 v84, v79, v79
    v_add_f32 v85, v78, v78
    v_fma_f32 v80, v78, v78, -v84
    v_mul_f32 v81, v85, v79
    v_mul_f32 v82, v64, v44
    v_mul_f32 v83, v65, v44
    v_exp_f32 v82, v82
    v_fract_f32 v83, v83
    v_cos_f32 v68, v83
    v_sin_f32 v69, v83
    v_mul_f32 v68, v68, v82
    v_mul_f32 v69, v69, v82
    v_mul_f32 v84, v67, v69
    v_mul_f32 v85, v67, v68
    v_fma_f32 v68, v66, v68, -v84
    v_fma_f32 v69, -v66, v69, -v85
    v_mul_f32 v82, v64, v45
    v_mul_f32 v83, v65, v45
    v_exp_f32 v82, v82
    v_fract_f32 v83, v83
    v_cos_f32 v70, v83
    v_sin_f32 v71, v83
    v_mul_f32 v70, v70, v82
    v_mul_f32 v71, v71, v82
    v_mul_f32 v84, v67, v71
    v_mul_f32 v85, v67, v70
    v_fma_f32 v70, v66, v70, -v84
    v_fma_f32 v71, -v66, v71, -v85
    v_mul_f32 v82, v64, v46
    v_mul_f32 v83, v65, v46
    v_exp_f32 v82, v82
    v_fract_f32 v83, v83
    v_cos_f32 v72, v83
    v_sin_f32 v73, v83
    v_mul_f32 v72, v72, v82
    v_mul_f32 v73, v73, v82
    v_mul_f32 v84, v67, v73
    v_mul_f32 v85, v67, v72
    v_fma_f32 v72, v66, v72, -v84
    v_fma_f32 v73, -v66, v73, -v85
    v_mfma_f32_16x16x4_f32 v[48:51], v68, v74, v[48:51]
    v_mfma_f32_16x16x4_f32 v[52:55], v70, v76, v[52:55]
    v_mfma_f32_16x16x4_f32 v[56:59], v70, v78, v[56:59]
    v_mfma_f32_16x16x4_f32 v[60:63], v72, v80, v[60:63]
    v_mfma_f32_16x16x4_f32 v[48:51], v69, v75, v[48:51]
    v_mfma_f32_16x16x4_f32 v[52:55], v71, v77, v[52:55]
    v_mfma_f32_16x16x4_f32 v[56:59], v71, v79, v[56:59]
    v_mfma_f32_16x16x4_f32 v[60:63], v73, v81, v[60:63]
    v_mov_b32_dpp v64, v28 row_newbcast:12 row_mask:0xf bank_mask:0xf
    v_mov_b32_dpp v65, v29 row_newbcast:12 row_mask:0xf bank_mask:0xf
    v_mov_b32_dpp v66, v30 row_newbcast:12 row_mask:0xf bank_mask:0xf
    v_mov_b32_dpp v67, v31 row_newbcast:12 row_mask:0xf bank_mask:0xf
    v_mul_f32 v82, v64, v47
    v_mul_f32 v83, v65, v47
    v_exp_f32 v82, v82
    v_fract_f32 v83, v83
    v_cos_f32 v74, v83
    v_sin_f32 v75, v83
    v_mul_f32 v74, v74, v82
    v_mul_f32 v75, v75, v82
    v_mul_f32 v84, v75, v75
    v_add_f32 v85, v74, v74
    v_fma_f32 v76, v74, v74, -v84
    v_mul_f32 v77, v85, v75
    v_mul_f32 v84, v77, v77
    v_add_f32 v85, v76, v76
    v_fma_f32 v78, v76, v76, -v84
    v_mul_f32 v79, v85, v77
    v_mul_f32 v84, v79, v79
    v_add_f32 v85, v78, v78
    v_fma_f32 v80, v78, v78, -v84
    v_mul_f32 v81, v85, v79
    v_mul_f32 v82, v64, v44
    v_mul_f32 v83, v65, v44
    v_exp_f32 v82, v82
    v_fract_f32 v83, v83
    v_cos_f32 v68, v83
    v_sin_f32 v69, v83
    v_mul_f32 v68, v68, v82
    v_mul_f32 v69, v69, v82
    v_mul_f32 v84, v67, v69
    v_mul_f32 v85, v67, v68
    v_fma_f32 v68, v66, v68, -v84
    v_fma_f32 v69, -v66, v69, -v85
    v_mul_f32 v82, v64, v45
    v_mul_f32 v83, v65, v45
    v_exp_f32 v82, v82
    v_fract_f32 v83, v83
    v_cos_f32 v70, v83
    v_sin_f32 v71, v83
    v_mul_f32 v70, v70, v82
    v_mul_f32 v71, v71, v82
    v_mul_f32 v84, v67, v71
    v_mul_f32 v85, v67, v70
    v_fma_f32 v70, v66, v70, -v84
    v_fma_f32 v71, -v66, v71, -v85
    v_mul_f32 v82, v64, v46
    v_mul_f32 v83, v65, v46
    v_exp_f32 v82, v82
    v_fract_f32 v83, v83
    v_cos_f32 v72, v83
    v_sin_f32 v73, v83
    v_mul_f32 v72, v72, v82
    v_mul_f32 v73, v73, v82
    v_mul_f32 v84, v67, v73
    v_mul_f32 v85, v67, v72
    v_fma_f32 v72, v66, v72, -v84
    v_fma_f32 v73, -v66, v73, -v85
    v_mfma_f32_16x16x4_f32 v[48:51], v68, v74, v[48:51]
    v_mfma_f32_16x16x4_f32 v[52:55], v70, v76, v[52:55]
    v_mfma_f32_16x16x4_f32 v[56:59], v70, v78, v[56:59]
    v_mfma_f32_16x16x4_f32 v[60:63], v72, v80, v[60:63]
    v_mfma_f32_16x16x4_f32 v[48:51], v69, v75, v[48:51]
    v_mfma_f32_16x16x4_f32 v[52:55], v71, v77, v[52:55]
    v_mfma_f32_16x16x4_f32 v[56:59], v71, v79, v[56:59]
    v_mfma_f32_16x16x4_f32 v[60:63], v73, v81, v[60:63]
    v_mov_b32_dpp v64, v28 row_newbcast:13 row_mask:0xf bank_mask:0xf
    v_mov_b32_dpp v65, v29 row_newbcast:13 row_mask:0xf bank_mask:0xf
    v_mov_b32_dpp v66, v30 row_newbcast:13 row_mask:0xf bank_mask:0xf
    v_mov_b32_dpp v67, v31 row_newbcast:13 row_mask:0xf bank_mask:0xf
    v_mul_f32 v82, v64, v47
    v_mul_f32 v83, v65, v47
    v_exp_f32 v82, v82
    v_fract_f32 v83, v83
    v_cos_f32 v74, v83
    v_sin_f32 v75, v83
    v_mul_f32 v74, v74, v82
    v_mul_f32 v75, v75, v82
    v_mul_f32 v84, v75, v75
    v_add_f32 v85, v74, v74
    v_fma_f32 v76, v74, v74, -v84
    v_mul_f32 v77, v85, v75
    v_mul_f32 v84, v77, v77
    v_add_f32 v85, v76, v76
    v_fma_f32 v78, v76, v76, -v84
    v_mul_f32 v79, v85, v77
    v_mul_f32 v84, v79, v79
    v_add_f32 v85, v78, v78
    v_fma_f32 v80, v78, v78, -v84
    v_mul_f32 v81, v85, v79
    v_mul_f32 v82, v64, v44
    v_mul_f32 v83, v65, v44
    v_exp_f32 v82, v82
    v_fract_f32 v83, v83
    v_cos_f32 v68, v83
    v_sin_f32 v69, v83
    v_mul_f32 v68, v68, v82
    v_mul_f32 v69, v69, v82
    v_mul_f32 v84, v67, v69
    v_mul_f32 v85, v67, v68
    v_fma_f32 v68, v66, v68, -v84
    v_fma_f32 v69, -v66, v69, -v85
    v_mul_f32 v82, v64, v45
    v_mul_f32 v83, v65, v45
    v_exp_f32 v82, v82
    v_fract_f32 v83, v83
    v_cos_f32 v70, v83
    v_sin_f32 v71, v83
    v_mul_f32 v70, v70, v82
    v_mul_f32 v71, v71, v82
    v_mul_f32 v84, v67, v71
    v_mul_f32 v85, v67, v70
    v_fma_f32 v70, v66, v70, -v84
    v_fma_f32 v71, -v66, v71, -v85
    v_mul_f32 v82, v64, v46
    v_mul_f32 v83, v65, v46
    v_exp_f32 v82, v82
    v_fract_f32 v83, v83
    v_cos_f32 v72, v83
    v_sin_f32 v73, v83
    v_mul_f32 v72, v72, v82
    v_mul_f32 v73, v73, v82
    v_mul_f32 v84, v67, v73
    v_mul_f32 v85, v67, v72
    v_fma_f32 v72, v66, v72, -v84
    v_fma_f32 v73, -v66, v73, -v85
    v_mfma_f32_16x16x4_f32 v[48:51], v68, v74, v[48:51]
    v_mfma_f32_16x16x4_f32 v[52:55], v70, v76, v[52:55]
    v_mfma_f32_16x16x4_f32 v[56:59], v70, v78, v[56:59]
    v_mfma_f32_16x16x4_f32 v[60:63], v72, v80, v[60:63]
    v_mfma_f32_16x16x4_f32 v[48:51], v69, v75, v[48:51]
    v_mfma_f32_16x16x4_f32 v[52:55], v71, v77, v[52:55]
    v_mfma_f32_16x16x4_f32 v[56:59], v71, v79, v[56:59]
    v_mfma_f32_16x16x4_f32 v[60:63], v73, v81, v[60:63]
    v_mov_b32_dpp v64, v28 row_newbcast:14 row_mask:0xf bank_mask:0xf
    v_mov_b32_dpp v65, v29 row_newbcast:14 row_mask:0xf bank_mask:0xf
    v_mov_b32_dpp v66, v30 row_newbcast:14 row_mask:0xf bank_mask:0xf
    v_mov_b32_dpp v67, v31 row_newbcast:14 row_mask:0xf bank_mask:0xf
    v_mul_f32 v82, v64, v47
    v_mul_f32 v83, v65, v47
    v_exp_f32 v82, v82
    v_fract_f32 v83, v83
    v_cos_f32 v74, v83
    v_sin_f32 v75, v83
    v_mul_f32 v74, v74, v82
    v_mul_f32 v75, v75, v82
    v_mul_f32 v84, v75, v75
    v_add_f32 v85, v74, v74
    v_fma_f32 v76, v74, v74, -v84
    v_mul_f32 v77, v85, v75
    v_mul_f32 v84, v77, v77
    v_add_f32 v85, v76, v76
    v_fma_f32 v78, v76, v76, -v84
    v_mul_f32 v79, v85, v77
    v_mul_f32 v84, v79, v79
    v_add_f32 v85, v78, v78
    v_fma_f32 v80, v78, v78, -v84
    v_mul_f32 v81, v85, v79
    v_mul_f32 v82, v64, v44
    v_mul_f32 v83, v65, v44
    v_exp_f32 v82, v82
    v_fract_f32 v83, v83
    v_cos_f32 v68, v83
    v_sin_f32 v69, v83
    v_mul_f32 v68, v68, v82
    v_mul_f32 v69, v69, v82
    v_mul_f32 v84, v67, v69
    v_mul_f32 v85, v67, v68
    v_fma_f32 v68, v66, v68, -v84
    v_fma_f32 v69, -v66, v69, -v85
    v_mul_f32 v82, v64, v45
    v_mul_f32 v83, v65, v45
    v_exp_f32 v82, v82
    v_fract_f32 v83, v83
    v_cos_f32 v70, v83
    v_sin_f32 v71, v83
    v_mul_f32 v70, v70, v82
    v_mul_f32 v71, v71, v82
    v_mul_f32 v84, v67, v71
    v_mul_f32 v85, v67, v70
    v_fma_f32 v70, v66, v70, -v84
    v_fma_f32 v71, -v66, v71, -v85
    v_mul_f32 v82, v64, v46
    v_mul_f32 v83, v65, v46
    v_exp_f32 v82, v82
    v_fract_f32 v83, v83
    v_cos_f32 v72, v83
    v_sin_f32 v73, v83
    v_mul_f32 v72, v72, v82
    v_mul_f32 v73, v73, v82
    v_mul_f32 v84, v67, v73
    v_mul_f32 v85, v67, v72
    v_fma_f32 v72, v66, v72, -v84
    v_fma_f32 v73, -v66, v73, -v85
    v_mfma_f32_16x16x4_f32 v[48:51], v68, v74, v[48:51]
    v_mfma_f32_16x16x4_f32 v[52:55], v70, v76, v[52:55]
    v_mfma_f32_16x16x4_f32 v[56:59], v70, v78, v[56:59]
    v_mfma_f32_16x16x4_f32 v[60:63], v72, v80, v[60:63]
    v_mfma_f32_16x16x4_f32 v[48:51], v69, v75, v[48:51]
    v_mfma_f32_16x16x4_f32 v[52:55], v71, v77, v[52:55]
    v_mfma_f32_16x16x4_f32 v[56:59], v71, v79, v[56:59]
    v_mfma_f32_16x16x4_f32 v[60:63], v73, v81, v[60:63]
    v_mov_b32_dpp v64, v28 row_newbcast:15 row_mask:0xf bank_mask:0xf
    v_mov_b32_dpp v65, v29 row_newbcast:15 row_mask:0xf bank_mask:0xf
    v_mov_b32_dpp v66, v30 row_newbcast:15 row_mask:0xf bank_mask:0xf
    v_mov_b32_dpp v67, v31 row_newbcast:15 row_mask:0xf bank_mask:0xf
    v_mul_f32 v82, v64, v47
    v_mul_f32 v83, v65, v47
    v_exp_f32 v82, v82
    v_fract_f32 v83, v83
    v_cos_f32 v74, v83
    v_sin_f32 v75, v83
    v_mul_f32 v74, v74, v82
    v_mul_f32 v75, v75, v82
    v_mul_f32 v84, v75, v75
    v_add_f32 v85, v74, v74
    v_fma_f32 v76, v74, v74, -v84
    v_mul_f32 v77, v85, v75
    v_mul_f32 v84, v77, v77
    v_add_f32 v85, v76, v76
    v_fma_f32 v78, v76, v76, -v84
    v_mul_f32 v79, v85, v77
    v_mul_f32 v84, v79, v79
    v_add_f32 v85, v78, v78
    v_fma_f32 v80, v78, v78, -v84
    v_mul_f32 v81, v85, v79
    v_mul_f32 v82, v64, v44
    v_mul_f32 v83, v65, v44
    v_exp_f32 v82, v82
    v_fract_f32 v83, v83
    v_cos_f32 v68, v83
    v_sin_f32 v69, v83
    v_mul_f32 v68, v68, v82
    v_mul_f32 v69, v69, v82
    v_mul_f32 v84, v67, v69
    v_mul_f32 v85, v67, v68
    v_fma_f32 v68, v66, v68, -v84
    v_fma_f32 v69, -v66, v69, -v85
    v_mul_f32 v82, v64, v45
    v_mul_f32 v83, v65, v45
    v_exp_f32 v82, v82
    v_fract_f32 v83, v83
    v_cos_f32 v70, v83
    v_sin_f32 v71, v83
    v_mul_f32 v70, v70, v82
    v_mul_f32 v71, v71, v82
    v_mul_f32 v84, v67, v71
    v_mul_f32 v85, v67, v70
    v_fma_f32 v70, v66, v70, -v84
    v_fma_f32 v71, -v66, v71, -v85
    v_mul_f32 v82, v64, v46
    v_mul_f32 v83, v65, v46
    v_exp_f32 v82, v82
    v_fract_f32 v83, v83
    v_cos_f32 v72, v83
    v_sin_f32 v73, v83
    v_mul_f32 v72, v72, v82
    v_mul_f32 v73, v73, v82
    v_mul_f32 v84, v67, v73
    v_mul_f32 v85, v67, v72
    v_fma_f32 v72, v66, v72, -v84
    v_fma_f32 v73, -v66, v73, -v85
    v_mfma_f32_16x16x4_f32 v[48:51], v68, v74, v[48:51]
    v_mfma_f32_16x16x4_f32 v[52:55], v70, v76, v[52:55]
    v_mfma_f32_16x16x4_f32 v[56:59], v70, v78, v[56:59]
    v_mfma_f32_16x16x4_f32 v[60:63], v72, v80, v[60:63]
    v_mfma_f32_16x16x4_f32 v[48:51], v69, v75, v[48:51]
    v_mfma_f32_16x16x4_f32 v[52:55], v71, v77, v[52:55]
    v_mfma_f32_16x16x4_f32 v[56:59], v71, v79, v[56:59]
    v_mfma_f32_16x16x4_f32 v[60:63], v73, v81, v[60:63]
    v_lshlrev_b32 v5, 8, v3
    v_lshl_add_u32 v5, v2, 2, v5
    v_add_u32 v5, v5, v4
    ds_write_b32 v5, v48 offset:4608
    ds_write_b32 v5, v49 offset:4672
    ds_write_b32 v5, v50 offset:4736
    ds_write_b32 v5, v51 offset:4800
    v_cmp_gt_u32 vcc, 2, v3
    s_nop 0
    s_mov_b64 exec, vcc
    ds_write_b32 v5, v52 offset:5632
    ds_write_b32 v5, v53 offset:5696
    ds_write_b32 v5, v54 offset:5760
    ds_write_b32 v5, v55 offset:5824
    ds_write_b32 v5, v60 offset:6656
    ds_write_b32 v5, v61 offset:6720
    ds_write_b32 v5, v62 offset:6784
    ds_write_b32 v5, v63 offset:6848
    s_not_b64 exec, exec
    ds_write_b32 v5, v56 offset:5632
    ds_write_b32 v5, v57 offset:5696
    ds_write_b32 v5, v58 offset:5760
    ds_write_b32 v5, v59 offset:5824
    s_mov_b32 exec_lo, 0
    s_mov_b32 exec_hi, 3
    v_cmp_eq_u32 vcc, 0, v2
    s_nop 1
    v_cndmask_b32 v6, 0, v60, vcc
    ds_write_b32 v5, v6 offset:6656
    s_mov_b64 exec, -1
    s_waitcnt lgkmcnt(0)
    v_lshlrev_b32 v7, 1, v1
    v_sub_u32 v7, 2065, v7
    v_lshl_add_u32 v64, v1, 2, v4
    v_mov_b32 v65, 641
    s_mov_b32 s25, 17
ss_exp:
    v_subrev_u32 v66, 0, v7
    v_cvt_f32_u32 v70, v66
    v_cvt_pk_bf16_f32 v70, v70, v70
    v_and_b32 v70, 0xffff, v70
    v_subrev_u32 v70, 0x4280, v70
    v_cmp_gt_u32 vcc, 256, v66
    s_nop 1
    v_cndmask_b32 v70, v70, v66, vcc
    v_cmp_gt_u32 vcc, 2048, v66
    s_nop 1
    v_cndmask_b32 v70, v65, v70, vcc
    v_lshl_add_u32 v70, v70, 2, v4
    ds_read_b32 v74, v70 offset:4608
    v_subrev_u32 v67, 1, v7
    v_cvt_f32_u32 v71, v67
    v_cvt_pk_bf16_f32 v71, v71, v71
    v_and_b32 v71, 0xffff, v71
    v_subrev_u32 v71, 0x4280, v71
    v_cmp_gt_u32 vcc, 256, v67
    s_nop 1
    v_cndmask_b32 v71, v71, v67, vcc
    v_cmp_gt_u32 vcc, 2048, v67
    s_nop 1
    v_cndmask_b32 v71, v65, v71, vcc
    v_lshl_add_u32 v71, v71, 2, v4
    ds_read_b32 v75, v71 offset:4608
    v_subrev_u32 v68, 2, v7
    v_cvt_f32_u32 v72, v68
    v_cvt_pk_bf16_f32 v72, v72, v72
    v_and_b32 v72, 0xffff, v72
    v_subrev_u32 v72, 0x4280, v72
    v_cmp_gt_u32 vcc, 256, v68
    s_nop 1
    v_cndmask_b32 v72, v72, v68, vcc
    v_cmp_gt_u32 vcc, 2048, v68
    s_nop 1
    v_cndmask_b32 v72, v65, v72, vcc
    v_lshl_add_u32 v72, v72, 2, v4
    ds_read_b32 v76, v72 offset:4608
    s_waitcnt lgkmcnt(0)
    v_cvt_pk_bf16_f32 v78, v75, v76
    v_cvt_pk_bf16_f32 v79, v74, v75
    ds_write_b32 v64, v78 offset:7424
    ds_write_b32 v64, v79 offset:11776
    v_subrev_u32 v7, 128, v7
    v_add_u32 v64, 256, v64
    s_sub_u32 s25, s25, 1
    s_cmp_lg_u32 s25, 0
    s_cbranch_scc1 ss_exp
    s_waitcnt lgkmcnt(0)
    s_barrier
    v_and_b32 v5, 1, v2
    v_mul_u32_u24 v64, 4352, v5
    v_sub_u32 v5, v5, v2
    v_lshl_add_u32 v5, v3, 3, v5
    v_lshl_add_u32 v64, v5, 1, v64
    v_add_u32 v64, 11520, v64
    v_add_u32 v64, v64, v4
    v_lshlrev_b32 v65, 5, v2
    v_lshl_add_u32 v65, v3, 4, v65
    v_add_u32 v65, 480, v65
    v_add_u32 v65, v65, v4
    v_mov_b32 v96, 0
    v_mov_b32 v97, 0
    v_mov_b32 v98, 0
    v_mov_b32 v99, 0
    v_mov_b32 v100, 0
    v_mov_b32 v101, 0
    v_mov_b32 v102, 0
    v_mov_b32 v103, 0
    v_mov_b32 v104, 0
    v_mov_b32 v105, 0
    v_mov_b32 v106, 0
    v_mov_b32 v107, 0
    v_mov_b32 v108, 0
    v_mov_b32 v109, 0
    v_mov_b32 v110, 0
    v_mov_b32 v111, 0
    v_mov_b32 v112, 0
    v_mov_b32 v113, 0
    v_mov_b32 v114, 0
    v_mov_b32 v115, 0
    v_mov_b32 v116, 0
    v_mov_b32 v117, 0
    v_mov_b32 v118, 0
    v_mov_b32 v119, 0
    v_mov_b32 v120, 0
    v_mov_b32 v121, 0
    v_mov_b32 v122, 0
    v_mov_b32 v123, 0
    v_mov_b32 v124, 0
    v_mov_b32 v125, 0
    v_mov_b32 v126, 0
    v_mov_b32 v127, 0
    s_mov_b32 s25, 8
ss_cv0:
    ds_read2_b32 v[68:69], v64 offset0:0 offset1:1
    ds_read2_b32 v[70:71], v64 offset0:2 offset1:3
    ds_read_b128 v[128:131], v65 offset:0
    ds_read_b128 v[132:135], v65 offset:512
    ds_read_b128 v[136:139], v65 offset:1024
    ds_read_b128 v[140:143], v65 offset:1536
    ds_read_b128 v[144:147], v65 offset:2048
    ds_read_b128 v[148:151], v65 offset:2560
    ds_read_b128 v[152:155], v65 offset:3072
    ds_read_b128 v[156:159], v65 offset:3584
    v_subrev_u32 v64, 64, v64
    v_subrev_u32 v65, 64, v65
    s_waitcnt lgkmcnt(7)
    v_mfma_f32_16x16x32_bf16 v[96:99], v[68:71], v[128:131], v[96:99]
    s_waitcnt lgkmcnt(6)
    v_mfma_f32_16x16x32_bf16 v[100:103], v[68:71], v[132:135], v[100:103]
    s_waitcnt lgkmcnt(5)
    v_mfma_f32_16x16x32_bf16 v[104:107], v[68:71], v[136:139], v[104:107]
    s_waitcnt lgkmcnt(4)
    v_mfma_f32_16x16x32_bf16 v[108:111], v[68:71], v[140:143], v[108:111]
    s_waitcnt lgkmcnt(3)
    v_mfma_f32_16x16x32_bf16 v[112:115], v[68:71], v[144:147], v[112:115]
    s_waitcnt lgkmcnt(2)
    v_mfma_f32_16x16x32_bf16 v[116:119], v[68:71], v[148:151], v[116:119]
    s_waitcnt lgkmcnt(1)
    v_mfma_f32_16x16x32_bf16 v[120:123], v[68:71], v[152:155], v[120:123]
    s_waitcnt lgkmcnt(0)
    v_mfma_f32_16x16x32_bf16 v[124:127], v[68:71], v[156:159], v[124:127]
    s_sub_u32 s25, s25, 1
    s_cmp_lg_u32 s25, 0
    s_cbranch_scc1 ss_cv0
    v_add_u32 v65, 512, v65
    s_mov_b32 s25, 8
ss_cv1:
    ds_read2_b32 v[68:69], v64 offset0:0 offset1:1
    ds_read2_b32 v[70:71], v64 offset0:2 offset1:3
    ds_read_b128 v[132:135], v65 offset:0
    ds_read_b128 v[136:139], v65 offset:512
    ds_read_b128 v[140:143], v65 offset:1024
    ds_read_b128 v[144:147], v65 offset:1536
    ds_read_b128 v[148:151], v65 offset:2048
    ds_read_b128 v[152:155], v65 offset:2560
    ds_read_b128 v[156:159], v65 offset:3072
    v_subrev_u32 v64, 64, v64
    v_subrev_u32 v65, 64, v65
    s_waitcnt lgkmcnt(6)
    v_mfma_f32_16x16x32_bf16 v[100:103], v[68:71], v[132:135], v[100:103]
    s_waitcnt lgkmcnt(5)
    v_mfma_f32_16x16x32_bf16 v[104:107], v[68:71], v[136:139], v[104:107]
    s_waitcnt lgkmcnt(4)
    v_mfma_f32_16x16x32_bf16 v[108:111], v[68:71], v[140:143], v[108:111]
    s_waitcnt lgkmcnt(3)
    v_mfma_f32_16x16x32_bf16 v[112:115], v[68:71], v[144:147], v[112:115]
    s_waitcnt lgkmcnt(2)
    v_mfma_f32_16x16x32_bf16 v[116:119], v[68:71], v[148:151], v[116:119]
    s_waitcnt lgkmcnt(1)
    v_mfma_f32_16x16x32_bf16 v[120:123], v[68:71], v[152:155], v[120:123]
    s_waitcnt lgkmcnt(0)
    v_mfma_f32_16x16x32_bf16 v[124:127], v[68:71], v[156:159], v[124:127]
    s_sub_u32 s25, s25, 1
    s_cmp_lg_u32 s25, 0
    s_cbranch_scc1 ss_cv1
    v_add_u32 v65, 512, v65
    s_mov_b32 s25, 8
ss_cv2:
    ds_read2_b32 v[68:69], v64 offset0:0 offset1:1
    ds_read2_b32 v[70:71], v64 offset0:2 offset1:3
    ds_read_b128 v[136:139], v65 offset:0
    ds_read_b128 v[140:143], v65 offset:512
    ds_read_b128 v[144:147], v65 offset:1024
    ds_read_b128 v[148:151], v65 offset:1536
    ds_read_b128 v[152:155], v65 offset:2048
    ds_read_b128 v[156:159], v65 offset:2560
    v_subrev_u32 v64, 64, v64
    v_subrev_u32 v65, 64, v65
    s_waitcnt lgkmcnt(5)
    v_mfma_f32_16x16x32_bf16 v[104:107], v[68:71], v[136:139], v[104:107]
    s_waitcnt lgkmcnt(4)
    v_mfma_f32_16x16x32_bf16 v[108:111], v[68:71], v[140:143], v[108:111]
    s_waitcnt lgkmcnt(3)
    v_mfma_f32_16x16x32_bf16 v[112:115], v[68:71], v[144:147], v[112:115]
    s_waitcnt lgkmcnt(2)
    v_mfma_f32_16x16x32_bf16 v[116:119], v[68:71], v[148:151], v[116:119]
    s_waitcnt lgkmcnt(1)
    v_mfma_f32_16x16x32_bf16 v[120:123], v[68:71], v[152:155], v[120:123]
    s_waitcnt lgkmcnt(0)
    v_mfma_f32_16x16x32_bf16 v[124:127], v[68:71], v[156:159], v[124:127]
    s_sub_u32 s25, s25, 1
    s_cmp_lg_u32 s25, 0
    s_cbranch_scc1 ss_cv2
    v_add_u32 v65, 512, v65
    s_mov_b32 s25, 8
ss_cv3:
    ds_read2_b32 v[68:69], v64 offset0:0 offset1:1
    ds_read2_b32 v[70:71], v64 offset0:2 offset1:3
    ds_read_b128 v[140:143], v65 offset:0
    ds_read_b128 v[144:147], v65 offset:512
    ds_read_b128 v[148:151], v65 offset:1024
    ds_read_b128 v[152:155], v65 offset:1536
    ds_read_b128 v[156:159], v65 offset:2048
    v_subrev_u32 v64, 64, v64
    v_subrev_u32 v65, 64, v65
    s_waitcnt lgkmcnt(4)
    v_mfma_f32_16x16x32_bf16 v[108:111], v[68:71], v[140:143], v[108:111]
    s_waitcnt lgkmcnt(3)
    v_mfma_f32_16x16x32_bf16 v[112:115], v[68:71], v[144:147], v[112:115]
    s_waitcnt lgkmcnt(2)
    v_mfma_f32_16x16x32_bf16 v[116:119], v[68:71], v[148:151], v[116:119]
    s_waitcnt lgkmcnt(1)
    v_mfma_f32_16x16x32_bf16 v[120:123], v[68:71], v[152:155], v[120:123]
    s_waitcnt lgkmcnt(0)
    v_mfma_f32_16x16x32_bf16 v[124:127], v[68:71], v[156:159], v[124:127]
    s_sub_u32 s25, s25, 1
    s_cmp_lg_u32 s25, 0
    s_cbranch_scc1 ss_cv3
    v_add_u32 v65, 512, v65
    s_mov_b32 s25, 8
ss_cv4:
    ds_read2_b32 v[68:69], v64 offset0:0 offset1:1
    ds_read2_b32 v[70:71], v64 offset0:2 offset1:3
    ds_read_b128 v[144:147], v65 offset:0
    ds_read_b128 v[148:151], v65 offset:512
    ds_read_b128 v[152:155], v65 offset:1024
    ds_read_b128 v[156:159], v65 offset:1536
    v_subrev_u32 v64, 64, v64
    v_subrev_u32 v65, 64, v65
    s_waitcnt lgkmcnt(3)
    v_mfma_f32_16x16x32_bf16 v[112:115], v[68:71], v[144:147], v[112:115]
    s_waitcnt lgkmcnt(2)
    v_mfma_f32_16x16x32_bf16 v[116:119], v[68:71], v[148:151], v[116:119]
    s_waitcnt lgkmcnt(1)
    v_mfma_f32_16x16x32_bf16 v[120:123], v[68:71], v[152:155], v[120:123]
    s_waitcnt lgkmcnt(0)
    v_mfma_f32_16x16x32_bf16 v[124:127], v[68:71], v[156:159], v[124:127]
    s_sub_u32 s25, s25, 1
    s_cmp_lg_u32 s25, 0
    s_cbranch_scc1 ss_cv4
    v_add_u32 v65, 512, v65
    s_mov_b32 s25, 8
ss_cv5:
    ds_read2_b32 v[68:69], v64 offset0:0 offset1:1
    ds_read2_b32 v[70:71], v64 offset0:2 offset1:3
    ds_read_b128 v[148:151], v65 offset:0
    ds_read_b128 v[152:155], v65 offset:512
    ds_read_b128 v[156:159], v65 offset:1024
    v_subrev_u32 v64, 64, v64
    v_subrev_u32 v65, 64, v65
    s_waitcnt lgkmcnt(2)
    v_mfma_f32_16x16x32_bf16 v[116:119], v[68:71], v[148:151], v[116:119]
    s_waitcnt lgkmcnt(1)
    v_mfma_f32_16x16x32_bf16 v[120:123], v[68:71], v[152:155], v[120:123]
    s_waitcnt lgkmcnt(0)
    v_mfma_f32_16x16x32_bf16 v[124:127], v[68:71], v[156:159], v[124:127]
    s_sub_u32 s25, s25, 1
    s_cmp_lg_u32 s25, 0
    s_cbranch_scc1 ss_cv5
    v_add_u32 v65, 512, v65
    s_mov_b32 s25, 8
ss_cv6:
    ds_read2_b32 v[68:69], v64 offset0:0 offset1:1
    ds_read2_b32 v[70:71], v64 offset0:2 offset1:3
    ds_read_b128 v[152:155], v65 offset:0
    ds_read_b128 v[156:159], v65 offset:512
    v_subrev_u32 v64, 64, v64
    v_subrev_u32 v65, 64, v65
    s_waitcnt lgkmcnt(1)
    v_mfma_f32_16x16x32_bf16 v[120:123], v[68:71], v[152:155], v[120:123]
    s_waitcnt lgkmcnt(0)
    v_mfma_f32_16x16x32_bf16 v[124:127], v[68:71], v[156:159], v[124:127]
    s_sub_u32 s25, s25, 1
    s_cmp_lg_u32 s25, 0
    s_cbranch_scc1 ss_cv6
    v_add_u32 v65, 512, v65
    s_mov_b32 s25, 8
ss_cv7:
    ds_read2_b32 v[68:69], v64 offset0:0 offset1:1
    ds_read2_b32 v[70:71], v64 offset0:2 offset1:3
    ds_read_b128 v[156:159], v65 offset:0
    v_subrev_u32 v64, 64, v64
    v_subrev_u32 v65, 64, v65
    s_waitcnt lgkmcnt(0)
    v_mfma_f32_16x16x32_bf16 v[124:127], v[68:71], v[156:159], v[124:127]
    s_sub_u32 s25, s25, 1
    s_cmp_lg_u32 s25, 0
    s_cbranch_scc1 ss_cv7
    v_add_u32 v65, 512, v65
    s_nop 3
    v_lshlrev_b32 v5, 6, v2
    v_lshl_add_u32 v5, v3, 4, v5
    v_add_u32 v5, v5, v4
    ds_write_b128 v5, v[96:99] offset:7424
    ds_write_b128 v5, v[100:103] offset:8448
    ds_write_b128 v5, v[104:107] offset:9472
    ds_write_b128 v5, v[108:111] offset:10496
    ds_write_b128 v5, v[112:115] offset:11520
    ds_write_b128 v5, v[116:119] offset:12544
    ds_write_b128 v5, v[120:123] offset:13568
    ds_write_b128 v5, v[124:127] offset:14592
    s_mov_b32 s12, s74
    s_mov_b32 s13, s75
    s_mov_b32 s14, 1152
    s_mov_b32 s15, 0x20000
    s_lshl_b32 s23, s20, 1
    buffer_load_dwordx2 v[24:25], off, s[12:15], s23
    s_waitcnt vmcnt(0) lgkmcnt(0)
    s_barrier
    v_lshlrev_b32 v26, 16, v24
    v_and_b32 v27, 0xffff0000, v24
    v_lshlrev_b32 v28, 16, v25
    v_and_b32 v29, 0xffff0000, v25
    v_lshlrev_b32 v5, 5, v0
    ds_read_b128 v[64:67], v5 offset:7424
    ds_read_b128 v[68:71], v5 offset:7440
    ds_read_b128 v[72:75], v5 offset:23808
    ds_read_b128 v[76:79], v5 offset:23824
    ds_read_b128 v[80:83], v5 offset:40192
    ds_read_b128 v[84:87], v5 offset:40208
    ds_read_b128 v[88:91], v5 offset:56576
    ds_read_b128 v[92:95], v5 offset:56592
    s_waitcnt lgkmcnt(0)
    v_mul_u32_u24 v5, 18432, v0
    s_lshl_b32 s22, s20, 1
    s_add_u32 s22, s22, 1152
    v_lshlrev_b32 v6, 16, v8
    v_fmac_f32 v64, v6, v26
    v_and_b32 v6, 0xffff0000, v8
    v_fmac_f32 v72, v6, v27
    v_lshlrev_b32 v6, 16, v9
    v_fmac_f32 v80, v6, v28
    v_and_b32 v6, 0xffff0000, v9
    v_fmac_f32 v88, v6, v29
    v_cvt_pk_bf16_f32 v8, v64, v72
    v_cvt_pk_bf16_f32 v9, v80, v88
    s_add_u32 s23, s22, 0
    buffer_store_dwordx2 v[8:9], v5, s[16:19], s23 offen
    v_lshlrev_b32 v6, 16, v10
    v_fmac_f32 v65, v6, v26
    v_and_b32 v6, 0xffff0000, v10
    v_fmac_f32 v73, v6, v27
    v_lshlrev_b32 v6, 16, v11
    v_fmac_f32 v81, v6, v28
    v_and_b32 v6, 0xffff0000, v11
    v_fmac_f32 v89, v6, v29
    v_cvt_pk_bf16_f32 v10, v65, v73
    v_cvt_pk_bf16_f32 v11, v81, v89
    s_add_u32 s23, s22, 2304
    buffer_store_dwordx2 v[10:11], v5, s[16:19], s23 offen
    v_lshlrev_b32 v6, 16, v12
    v_fmac_f32 v66, v6, v26
    v_and_b32 v6, 0xffff0000, v12
    v_fmac_f32 v74, v6, v27
    v_lshlrev_b32 v6, 16, v13
    v_fmac_f32 v82, v6, v28
    v_and_b32 v6, 0xffff0000, v13
    v_fmac_f32 v90, v6, v29
    v_cvt_pk_bf16_f32 v12, v66, v74
    v_cvt_pk_bf16_f32 v13, v82, v90
    s_add_u32 s23, s22, 4608
    buffer_store_dwordx2 v[12:13], v5, s[16:19], s23 offen
    v_lshlrev_b32 v6, 16, v14
    v_fmac_f32 v67, v6, v26
    v_and_b32 v6, 0xffff0000, v14
    v_fmac_f32 v75, v6, v27
    v_lshlrev_b32 v6, 16, v15
    v_fmac_f32 v83, v6, v28
    v_and_b32 v6, 0xffff0000, v15
    v_fmac_f32 v91, v6, v29
    v_cvt_pk_bf16_f32 v14, v67, v75
    v_cvt_pk_bf16_f32 v15, v83, v91
    s_add_u32 s23, s22, 6912
    buffer_store_dwordx2 v[14:15], v5, s[16:19], s23 offen
    v_lshlrev_b32 v6, 16, v16
    v_fmac_f32 v68, v6, v26
    v_and_b32 v6, 0xffff0000, v16
    v_fmac_f32 v76, v6, v27
    v_lshlrev_b32 v6, 16, v17
    v_fmac_f32 v84, v6, v28
    v_and_b32 v6, 0xffff0000, v17
    v_fmac_f32 v92, v6, v29
    v_cvt_pk_bf16_f32 v16, v68, v76
    v_cvt_pk_bf16_f32 v17, v84, v92
    s_add_u32 s23, s22, 9216
    buffer_store_dwordx2 v[16:17], v5, s[16:19], s23 offen
    v_lshlrev_b32 v6, 16, v18
    v_fmac_f32 v69, v6, v26
    v_and_b32 v6, 0xffff0000, v18
    v_fmac_f32 v77, v6, v27
    v_lshlrev_b32 v6, 16, v19
    v_fmac_f32 v85, v6, v28
    v_and_b32 v6, 0xffff0000, v19
    v_fmac_f32 v93, v6, v29
    v_cvt_pk_bf16_f32 v18, v69, v77
    v_cvt_pk_bf16_f32 v19, v85, v93
    s_add_u32 s23, s22, 11520
    buffer_store_dwordx2 v[18:19], v5, s[16:19], s23 offen
    v_lshlrev_b32 v6, 16, v20
    v_fmac_f32 v70, v6, v26
    v_and_b32 v6, 0xffff0000, v20
    v_fmac_f32 v78, v6, v27
    v_lshlrev_b32 v6, 16, v21
    v_fmac_f32 v86, v6, v28
    v_and_b32 v6, 0xffff0000, v21
    v_fmac_f32 v94, v6, v29
    v_cvt_pk_bf16_f32 v20, v70, v78
    v_cvt_pk_bf16_f32 v21, v86, v94
    s_add_u32 s23, s22, 13824
    buffer_store_dwordx2 v[20:21], v5, s[16:19], s23 offen
    v_lshlrev_b32 v6, 16, v22
    v_fmac_f32 v71, v6, v26
    v_and_b32 v6, 0xffff0000, v22
    v_fmac_f32 v79, v6, v27
    v_lshlrev_b32 v6, 16, v23
    v_fmac_f32 v87, v6, v28
    v_and_b32 v6, 0xffff0000, v23
    v_fmac_f32 v95, v6, v29
    v_cvt_pk_bf16_f32 v22, v71, v79
    v_cvt_pk_bf16_f32 v23, v87, v95
    s_add_u32 s23, s22, 16128
    buffer_store_dwordx2 v[22:23], v5, s[16:19], s23 offen
    s_branch L_ssm_next
L_phase2:
    v_and_b32 v1, 63, v0
    v_min_u32 v1, 6, v1
    v_lshlrev_b32 v2, 2, v1
    s_cmp_lg_u32 s32, 0
    v_mov_b32 v251, 163832
    s_cbranch_scc1 sw9
    buffer_load_dword v3, v2, s[96:99], 0 offen offset:32 sc1
    v_mov_b32 v4, 32
    s_waitcnt vmcnt(0)
    v_cmp_lt_u32 vcc, v3, v4
    s_nop 0
    s_ff1_i32_b64 s40, vcc
    v_mov_b32 v250, s40
    ds_write_b32 v251, v250
    s_waitcnt lgkmcnt(0)
sw9:
    s_barrier
    ds_read_b32 v252, v251
    s_waitcnt lgkmcnt(0)
    v_readfirstlane_b32 s33, v252
    s_barrier
    s_nop 1
    s_cmp_lt_u32 s33, 7
    s_cbranch_scc1 L_pool
    s_mov_b32 s88, 4194304
gn10:
    s_cmp_lg_u32 s95, 0
    s_cbranch_scc1 gn10x
    buffer_load_dword v250, off, s[96:99], 0 offset:64 sc1
    s_sub_u32 s88, s88, 1
    s_cbranch_scc1 gn10x
    s_waitcnt vmcnt(0)
    v_readfirstlane_b32 s95, v250
    s_nop 1
    s_branch gn10
gn10x:
    s_mov_b32 s40, 524288
mc2_w:
    buffer_load_dword v250, off, s[96:99], 0 offset:140 sc1
    s_waitcnt vmcnt(0)
    v_readfirstlane_b32 s41, v250
    s_nop 0
    s_cmp_lg_u32 s41, 0
    s_cbranch_scc1 mc2_known
    s_sub_u32 s40, s40, 1
    s_cbranch_scc1 mc2_force
    s_sleep 2
    s_branch mc2_w
mc2_force:
    v_mov_b32 v250, 2
    v_mov_b32 v251, 0
    s_mov_b64 exec, 1
    buffer_atomic_cmpswap v[250:251], off, s[96:99], 0 offset:140
    s_mov_b64 exec, -1
    s_waitcnt vmcnt(0)
    s_mov_b32 s40, 524288
    s_branch mc2_w
mc2_known:
    s_cmp_eq_u32 s41, 1
    s_cbranch_scc1 L_phase2b
    s_mov_b32 s37, 208
    v_mov_b32 v250, 1
    v_mov_b32 v251, 163832
    v_cmp_eq_u32 vcc, 0, v0
    s_nop 0
    s_and_saveexec_b64 s[38:39], vcc
    s_cbranch_execz tk11
    buffer_atomic_add v250, off, s[96:99], s37 sc0
    s_waitcnt vmcnt(0)
    ds_write_b32 v251, v250
    s_waitcnt lgkmcnt(0)
tk11:
    s_mov_b64 exec, -1
    s_barrier
    ds_read_b32 v252, v251
    s_waitcnt lgkmcnt(0)
    v_readfirstlane_b32 s12, v252
    s_barrier
    s_nop 3
    s_cmp_lt_u32 s12, 32
    s_cbranch_scc1 L_chain_safe
L_phase2b:
    s_mov_b32 s8, s76
    s_mov_b32 s9, s77
    s_mov_b32 s10, 4718592
    s_mov_b32 s11, 0x20000
    s_sub_u32 s33, s3, 4
    s_and_b32 s33, s33, 7
    s_cmp_eq_u32 s33, 7
    s_cbranch_scc1 L_p2scan
L_p2take:
    s_lshl_b32 s35, s33, 2
    s_add_u32 s35, s35, 160
    s_mov_b32 s37, s35
    v_mov_b32 v250, 1
    v_mov_b32 v251, 163832
    v_cmp_eq_u32 vcc, 0, v0
    s_nop 0
    s_and_saveexec_b64 s[38:39], vcc
    s_cbranch_execz tk12
    buffer_atomic_add v250, off, s[96:99], s37 sc0
    s_waitcnt vmcnt(0)
    ds_write_b32 v251, v250
    s_waitcnt lgkmcnt(0)
tk12:
    s_mov_b64 exec, -1
    s_barrier
    ds_read_b32 v252, v251
    s_waitcnt lgkmcnt(0)
    v_readfirstlane_b32 s34, v252
    s_barrier
    s_nop 3
    s_cmp_lt_u32 s33, 4
    s_cselect_b32 s36, 4, 6
    s_cmp_lt_u32 s34, s36
    s_cbranch_scc1 L_att0
    s_sub_u32 s34, s34, s36
    s_cmp_lt_u32 s34, 18
    s_cbranch_scc1 L_op_start
L_p2scan:
    v_and_b32 v1, 63, v0
    v_min_u32 v1, 6, v1
    v_lshlrev_b32 v2, 2, v1
    s_cmp_lg_u32 s32, 0
    v_mov_b32 v251, 163832
    s_cbranch_scc1 sw13
    buffer_load_dword v3, v2, s[96:99], 0 offen offset:160 sc1
    v_mov_b32 v4, 24
    v_cmp_gt_u32 vcc, 4, v1
    s_nop 1
    v_cndmask_b32 v4, v4, 22, vcc
    s_waitcnt vmcnt(0)
    v_cmp_lt_u32 vcc, v3, v4
    s_nop 0
    s_ff1_i32_b64 s40, vcc
    v_mov_b32 v250, s40
    ds_write_b32 v251, v250
    s_waitcnt lgkmcnt(0)
sw13:
    s_barrier
    ds_read_b32 v252, v251
    s_waitcnt lgkmcnt(0)
    v_readfirstlane_b32 s33, v252
    s_barrier
    s_nop 1
    s_cmp_lt_u32 s33, 7
    s_cbranch_scc1 L_p2take
    s_branch L_done
L_att0:
    s_mul_i32 s36, s34, 7
    s_mul_i32 s37, s34, 3
    s_add_u32 s37, s37, 12
    s_cmp_lt_u32 s34, 4
    s_cselect_b32 s34, s36, s37
    s_add_u32 s34, s34, s33
    s_cmp_ge_u32 s34, 32
    s_cbranch_scc1 L_done
L_att_next:
    s_lshr_b32 s16, s34, 3
    s_and_b32 s17, s34, 7
    s_lshl_b32 s17, s17, 2
    s_add_u32 s17, s17, s32
    s_lshr_b32 s36, s17, 1
    s_lshl_b32 s36, s36, 8
    s_add_u32 s36, s36, 125829120
    s_mul_i32 s37, s16, 43
    s_lshr_b32 s37, s37, 8
    s_mul_i32 s41, s37, 6
    s_sub_u32 s41, s16, s41
    v_and_b32 v1, 63, v0
    v_mul_u32_u24 v2, 6, v1
    v_add_u32 v2, s41, v2
    v_mov_b32 v4, s37
    s_and_b32 s41, s16, 7
    s_add_u32 s41, s41, 12
    s_lshr_b32 s37, s16, 3
    v_mov_b32 v5, s41
    v_mov_b32 v6, s37
    v_cmp_lt_u32 vcc, 1, v1
    s_nop 1
    v_cndmask_b32 v2, v2, v5, vcc
    v_cndmask_b32 v4, v4, v6, vcc
    v_lshlrev_b32 v2, 2, v2
    v_add3_u32 v4, v4, s95, 1
    s_mov_b32 s40, 4194304
L_aw1:
    buffer_load_dword v3, v2, s[4:7], s36 offen sc1
    s_sub_u32 s40, s40, 1
    s_cbranch_scc1 L_aw1_go
    s_waitcnt vmcnt(0)
    v_subrev_u32 v3, v4, v3
    v_cmp_lt_u32 vcc, 64, v3
    s_cbranch_vccz L_aw1_go
    s_sleep 4
    s_branch L_aw1
L_aw1_go:
    v_and_b32 v5, 63, v0
    v_lshlrev_b32 v1, 4, v5
    v_or_b32 v3, 128, v1
    v_lshrrev_b32 v4, 4, v5
    v_bfe_u32 v6, v5, 2, 2
    v_sub_u32 v4, v6, v4
    v_lshlrev_b32 v4, 3, v4
    v_and_b32 v6, 3, v5
    v_add_u32 v4, v4, v6
    v_mov_b32 v6, 0xf149f2ca
    s_mov_b32 s22, 0x3e0293ee
    s_lshl_b32 s18, s16, 5
    s_add_u32 s18, s18, s17
    s_lshl_b32 s19, s18, 13
    s_add_u32 s20, s19, 33554432
    buffer_load_dwordx4 v[8:11], v1, s[4:7], s20 offen offset:0 sc1
    s_add_u32 s20, s19, 33554432
    buffer_load_dwordx4 v[12:15], v1, s[4:7], s20 offen offset:1024 sc1
    s_add_u32 s20, s19, 33554432
    buffer_load_dwordx4 v[16:19], v1, s[4:7], s20 offen offset:2048 sc1
    s_add_u32 s20, s19, 33554432
    buffer_load_dwordx4 v[20:23], v1, s[4:7], s20 offen offset:3072 sc1
    s_add_u32 s20, s19, 33558528
    buffer_load_dwordx4 v[24:27], v1, s[4:7], s20 offen offset:0 sc1
    s_add_u32 s20, s19, 33558528
    buffer_load_dwordx4 v[28:31], v1, s[4:7], s20 offen offset:1024 sc1
    s_add_u32 s20, s19, 33558528
    buffer_load_dwordx4 v[32:35], v1, s[4:7], s20 offen offset:2048 sc1
    s_add_u32 s20, s19, 33558528
    buffer_load_dwordx4 v[36:39], v1, s[4:7], s20 offen offset:3072 sc1
    s_lshl_b32 s21, s18, 14
    s_add_u32 s20, s21, 0
    buffer_load_dwordx4 v[40:43], v1, s[4:7], s20 offen offset:0 sc1
    s_add_u32 s20, s21, 4096
    buffer_load_dwordx4 v[44:47], v1, s[4:7], s20 offen offset:0 sc1
    s_add_u32 s20, s21, 8192
    buffer_load_dwordx4 v[48:51], v1, s[4:7], s20 offen offset:0 sc1
    s_add_u32 s20, s21, 12288
    buffer_load_dwordx4 v[52:55], v1, s[4:7], s20 offen offset:0 sc1
    s_add_u32 s20, s21, 0
    buffer_load_dwordx4 v[56:59], v1, s[4:7], s20 offen offset:1024 sc1
    s_add_u32 s20, s21, 4096
    buffer_load_dwordx4 v[60:63], v1, s[4:7], s20 offen offset:1024 sc1
    s_add_u32 s20, s21, 8192
    buffer_load_dwordx4 v[64:67], v1, s[4:7], s20 offen offset:1024 sc1
    s_add_u32 s20, s21, 12288
    buffer_load_dwordx4 v[68:71], v1, s[4:7], s20 offen offset:1024 sc1
    s_add_u32 s20, s21, 0
    buffer_load_dwordx4 v[88:91], v1, s[4:7], s20 offen offset:2048 sc1
    s_add_u32 s20, s21, 4096
    buffer_load_dwordx4 v[92:95], v1, s[4:7], s20 offen offset:2048 sc1
    s_add_u32 s20, s21, 8192
    buffer_load_dwordx4 v[96:99], v1, s[4:7], s20 offen offset:2048 sc1
    s_add_u32 s20, s21, 12288
    buffer_load_dwordx4 v[100:103], v1, s[4:7], s20 offen offset:2048 sc1
    s_add_u32 s20, s21, 0
    buffer_load_dwordx4 v[104:107], v1, s[4:7], s20 offen offset:3072 sc1
    s_add_u32 s20, s21, 4096
    buffer_load_dwordx4 v[108:111], v1, s[4:7], s20 offen offset:3072 sc1
    s_add_u32 s20, s21, 8192
    buffer_load_dwordx4 v[112:115], v1, s[4:7], s20 offen offset:3072 sc1
    s_add_u32 s20, s21, 12288
    buffer_load_dwordx4 v[116:119], v1, s[4:7], s20 offen offset:3072 sc1
    v_mov_b32 v172, 0x3f803f80
    v_mov_b32 v173, 0x3f803f80
    v_mov_b32 v174, 0x3f803f80
    v_mov_b32 v175, 0x3f803f80
    v_mov_b32 v176, 0x3f003f00
    v_mov_b32 v177, 0x3f003f00
    s_waitcnt vmcnt(8)
    v_mfma_f32_16x16x32_bf16 v[136:139], v[40:43], v[8:11], 0
    v_mfma_f32_16x16x32_bf16 v[140:143], v[56:59], v[8:11], 0
    v_mfma_f32_16x16x32_bf16 v[148:151], v[40:43], v[24:27], 0
    v_mfma_f32_16x16x32_bf16 v[152:155], v[56:59], v[24:27], 0
    v_mfma_f32_16x16x32_bf16 v[136:139], v[44:47], v[12:15], v[136:139]
    v_mfma_f32_16x16x32_bf16 v[140:143], v[60:63], v[12:15], v[140:143]
    v_mfma_f32_16x16x32_bf16 v[148:151], v[44:47], v[28:31], v[148:151]
    v_mfma_f32_16x16x32_bf16 v[152:155], v[60:63], v[28:31], v[152:155]
    v_mfma_f32_16x16x32_bf16 v[136:139], v[48:51], v[16:19], v[136:139]
    v_mfma_f32_16x16x32_bf16 v[140:143], v[64:67], v[16:19], v[140:143]
    v_mfma_f32_16x16x32_bf16 v[148:151], v[48:51], v[32:35], v[148:151]
    v_mfma_f32_16x16x32_bf16 v[152:155], v[64:67], v[32:35], v[152:155]
    v_mfma_f32_16x16x32_bf16 v[136:139], v[52:55], v[20:23], v[136:139]
    v_mfma_f32_16x16x32_bf16 v[140:143], v[68:71], v[20:23], v[140:143]
    v_mfma_f32_16x16x32_bf16 v[148:151], v[52:55], v[36:39], v[148:151]
    v_mfma_f32_16x16x32_bf16 v[152:155], v[68:71], v[36:39], v[152:155]
    v_cmp_le_i32 vcc, 0, v4
    s_nop 1
    v_cndmask_b32 v136, v6, v136, vcc
    v_cmp_le_i32 vcc, 1, v4
    s_nop 1
    v_cndmask_b32 v137, v6, v137, vcc
    v_cmp_le_i32 vcc, 2, v4
    s_nop 1
    v_cndmask_b32 v138, v6, v138, vcc
    v_cmp_le_i32 vcc, 3, v4
    s_nop 1
    v_cndmask_b32 v139, v6, v139, vcc
    v_cmp_le_i32 vcc, 4, v4
    s_nop 1
    v_cndmask_b32 v140, v6, v140, vcc
    v_cmp_le_i32 vcc, 5, v4
    s_nop 1
    v_cndmask_b32 v141, v6, v141, vcc
    v_cmp_le_i32 vcc, 6, v4
    s_nop 1
    v_cndmask_b32 v142, v6, v142, vcc
    v_cmp_le_i32 vcc, 7, v4
    s_nop 1
    v_cndmask_b32 v143, v6, v143, vcc
    v_cmp_le_i32 vcc, -4, v4
    s_nop 1
    v_cndmask_b32 v148, v6, v148, vcc
    v_cmp_le_i32 vcc, -3, v4
    s_nop 1
    v_cndmask_b32 v149, v6, v149, vcc
    v_cmp_le_i32 vcc, -2, v4
    s_nop 1
    v_cndmask_b32 v150, v6, v150, vcc
    v_cmp_le_i32 vcc, -1, v4
    s_nop 1
    v_cndmask_b32 v151, v6, v151, vcc
    v_cmp_le_i32 vcc, 0, v4
    s_nop 1
    v_cndmask_b32 v152, v6, v152, vcc
    v_cmp_le_i32 vcc, 1, v4
    s_nop 1
    v_cndmask_b32 v153, v6, v153, vcc
    v_cmp_le_i32 vcc, 2, v4
    s_nop 1
    v_cndmask_b32 v154, v6, v154, vcc
    v_cmp_le_i32 vcc, 3, v4
    s_nop 1
    v_cndmask_b32 v155, v6, v155, vcc
    v_max3_f32 v196, v136, v137, v138
    v_max3_f32 v196, v196, v139, v140
    v_max3_f32 v196, v196, v141, v142
    v_max_f32 v196, v196, v143
    v_mov_b32 v197, v196
    s_nop 1
    v_permlane32_swap_b32 v196, v197
    v_max_f32 v196, v196, v197
    v_mov_b32 v197, v196
    s_nop 1
    v_permlane16_swap_b32 v196, v197
    v_max_f32 v196, v196, v197
    v_mul_f32 v192, s22, v196
    v_fma_f32 v136, v136, s22, -v192
    v_fma_f32 v137, v137, s22, -v192
    v_fma_f32 v138, v138, s22, -v192
    v_fma_f32 v139, v139, s22, -v192
    v_fma_f32 v140, v140, s22, -v192
    v_fma_f32 v141, v141, s22, -v192
    v_fma_f32 v142, v142, s22, -v192
    v_fma_f32 v143, v143, s22, -v192
    v_exp_f32 v136, v136
    v_exp_f32 v137, v137
    v_exp_f32 v138, v138
    v_exp_f32 v139, v139
    v_exp_f32 v140, v140
    v_exp_f32 v141, v141
    v_exp_f32 v142, v142
    v_exp_f32 v143, v143
    v_cvt_pk_bf16_f32 v160, v136, v137
    v_cvt_pk_bf16_f32 v161, v138, v139
    v_cvt_pk_bf16_f32 v162, v140, v141
    v_cvt_pk_bf16_f32 v163, v142, v143
    v_max3_f32 v196, v148, v149, v150
    v_max3_f32 v196, v196, v151, v152
    v_max3_f32 v196, v196, v153, v154
    v_max_f32 v196, v196, v155
    v_mov_b32 v197, v196
    s_nop 1
    v_permlane32_swap_b32 v196, v197
    v_max_f32 v196, v196, v197
    v_mov_b32 v197, v196
    s_nop 1
    v_permlane16_swap_b32 v196, v197
    v_max_f32 v196, v196, v197
    v_mul_f32 v193, s22, v196
    v_fma_f32 v148, v148, s22, -v193
    v_fma_f32 v149, v149, s22, -v193
    v_fma_f32 v150, v150, s22, -v193
    v_fma_f32 v151, v151, s22, -v193
    v_fma_f32 v152, v152, s22, -v193
    v_fma_f32 v153, v153, s22, -v193
    v_fma_f32 v154, v154, s22, -v193
    v_fma_f32 v155, v155, s22, -v193
    v_exp_f32 v148, v148
    v_exp_f32 v149, v149
    v_exp_f32 v150, v150
    v_exp_f32 v151, v151
    v_exp_f32 v152, v152
    v_exp_f32 v153, v153
    v_exp_f32 v154, v154
    v_exp_f32 v155, v155
    v_cvt_pk_bf16_f32 v166, v148, v149
    v_cvt_pk_bf16_f32 v167, v150, v151
    v_cvt_pk_bf16_f32 v168, v152, v153
    v_cvt_pk_bf16_f32 v169, v154, v155
    v_mfma_f32_16x16x32_bf16 v[180:183], v[172:175], v[160:163], 0
    v_mfma_f32_16x16x32_bf16 v[184:187], v[172:175], v[166:169], 0
    s_waitcnt vmcnt(7)
    v_mfma_f32_16x16x32_bf16 v[40:43], v[88:91], v[160:163], 0
    s_waitcnt vmcnt(3)
    v_mfma_f32_16x16x32_bf16 v[44:47], v[104:107], v[160:163], 0
    v_mfma_f32_16x16x32_bf16 v[48:51], v[88:91], v[166:169], 0
    v_mfma_f32_16x16x32_bf16 v[52:55], v[104:107], v[166:169], 0
    v_mfma_f32_16x16x32_bf16 v[56:59], v[92:95], v[160:163], 0
    s_waitcnt vmcnt(2)
    v_mfma_f32_16x16x32_bf16 v[60:63], v[108:111], v[160:163], 0
    v_mfma_f32_16x16x32_bf16 v[64:67], v[92:95], v[166:169], 0
    v_mfma_f32_16x16x32_bf16 v[68:71], v[108:111], v[166:169], 0
    v_mfma_f32_16x16x32_bf16 v[200:203], v[96:99], v[160:163], 0
    s_waitcnt vmcnt(1)
    v_mfma_f32_16x16x32_bf16 v[204:207], v[112:115], v[160:163], 0
    v_mfma_f32_16x16x32_bf16 v[208:211], v[96:99], v[166:169], 0
    v_mfma_f32_16x16x32_bf16 v[212:215], v[112:115], v[166:169], 0
    v_mfma_f32_16x16x32_bf16 v[216:219], v[100:103], v[160:163], 0
    s_waitcnt vmcnt(0)
    v_mfma_f32_16x16x32_bf16 v[220:223], v[116:119], v[160:163], 0
    v_mfma_f32_16x16x32_bf16 v[224:227], v[100:103], v[166:169], 0
    v_mfma_f32_16x16x32_bf16 v[228:231], v[116:119], v[166:169], 0
    s_nop 7
    s_mov_b32 s88, 65536
cw14:
    buffer_load_dword v199, off, s[4:7], s36 offset:128 sc1
    s_waitcnt vmcnt(0)
    v_readfirstlane_b32 s42, v199
    s_nop 0
    s_sub_u32 s42, s42, s95
    s_cmp_gt_u32 s42, 64
    s_cselect_b32 s42, 0, s42
    s_add_u32 s42, s42, 2
    s_cmp_ge_u32 s42, s16
    s_cbranch_scc1 cw14x
    s_sub_u32 s88, s88, 1
    s_cbranch_scc1 cw14x
    s_sub_u32 s42, s16, s42
    s_min_u32 s42, s42, 6
cw14s:
    s_sleep 24
    s_sub_u32 s42, s42, 1
    s_cmp_lg_u32 s42, 0
    s_cbranch_scc1 cw14s
    s_branch cw14
cw14x:
    s_and_b32 s37, s16, 1
    s_lshl_b32 s37, s37, 2
    s_add_u32 s37, s37, s36
    s_add_u32 s37, s37, 128
    s_add_u32 s41, s16, s95
    s_add_u32 s41, s41, 1
    s_lshl_b32 s42, s17, 7
    s_add_u32 s42, s42, 125845504
    s_cmp_ge_u32 s16, 62
    s_cselect_b32 s37, s42, s37
    s_cselect_b32 s42, 12, 8
    v_lshlrev_b32 v198, 2, v0
    v_and_b32 v198, s42, v198
    s_mov_b32 s40, 4194304
L_aw2:
    buffer_load_dword v199, v198, s[4:7], s37 offen sc1
    s_sub_u32 s40, s40, 1
    s_cbranch_scc1 L_aw2_go
    s_waitcnt vmcnt(0)
    v_subrev_u32 v199, s41, v199
    v_cmp_lt_u32 vcc, 64, v199
    s_cbranch_vccz L_aw2_go
    s_sleep 1
    s_branch L_aw2
L_aw2_go:
    s_mov_b32 s21, 4096
at_again:
    s_lshl_b32 s20, s18, 12
    s_add_u32 s20, s20, 71303168
    buffer_load_dwordx4 v[72:75], v3, s[4:7], s20 offen offset:0 sc1
    buffer_load_dwordx4 v[76:79], v3, s[4:7], s20 offen offset:1024 sc1
    buffer_load_dwordx4 v[80:83], v3, s[4:7], s20 offen offset:2048 sc1
    buffer_load_dwordx4 v[84:87], v3, s[4:7], s20 offen offset:3072 sc1
    s_lshl_b32 s20, s18, 12
    s_add_u32 s20, s20, 80740352
    buffer_load_dwordx4 v[120:123], v1, s[4:7], s20 offen offset:0 sc1
    buffer_load_dwordx4 v[124:127], v1, s[4:7], s20 offen offset:1024 sc1
    buffer_load_dwordx4 v[128:131], v1, s[4:7], s20 offen offset:2048 sc1
    buffer_load_dwordx4 v[132:135], v1, s[4:7], s20 offen offset:3072 sc1
    s_waitcnt vmcnt(7)
    v_mfma_f32_16x16x32_bf16 v[144:147], v[72:75], v[8:11], 0
    v_mfma_f32_16x16x32_bf16 v[156:159], v[72:75], v[24:27], 0
    s_waitcnt vmcnt(6)
    v_mfma_f32_16x16x32_bf16 v[144:147], v[76:79], v[12:15], v[144:147]
    v_mfma_f32_16x16x32_bf16 v[156:159], v[76:79], v[28:31], v[156:159]
    s_waitcnt vmcnt(5)
    v_mfma_f32_16x16x32_bf16 v[144:147], v[80:83], v[16:19], v[144:147]
    v_mfma_f32_16x16x32_bf16 v[156:159], v[80:83], v[32:35], v[156:159]
    s_waitcnt vmcnt(4)
    v_mfma_f32_16x16x32_bf16 v[144:147], v[84:87], v[20:23], v[144:147]
    v_mfma_f32_16x16x32_bf16 v[156:159], v[84:87], v[36:39], v[156:159]
    v_max3_u32 v196, v72, v76, v80
    s_waitcnt vmcnt(0)
    v_max3_u32 v196, v196, v84, v120
    v_max3_u32 v196, v196, v124, v128
    v_max_u32 v196, v196, v132
    v_cmp_eq_u32 vcc, -1, v196
    s_sub_u32 s21, s21, 1
    s_nop 3
    s_cbranch_scc1 at_ok
    s_cbranch_vccnz at_again
at_ok:
    v_max3_f32 v196, v144, v145, v146
    v_max_f32 v196, v196, v147
    v_mov_b32 v197, v196
    s_nop 1
    v_permlane16_swap_b32 v196, v197
    v_max_f32 v196, v196, v197
    v_mul_f32 v196, s22, v196
    v_max_f32 v196, v196, v192
    v_sub_f32 v192, v192, v196
    v_fma_f32 v144, v144, s22, -v196
    v_fma_f32 v145, v145, s22, -v196
    v_fma_f32 v146, v146, s22, -v196
    v_fma_f32 v147, v147, s22, -v196
    v_exp_f32 v192, v192
    v_exp_f32 v144, v144
    v_exp_f32 v145, v145
    v_exp_f32 v146, v146
    v_exp_f32 v147, v147
    v_add_f32 v196, v144, v145
    v_add_f32 v197, v146, v147
    v_add_f32 v196, v196, v197
    v_mov_b32 v197, v196
    s_nop 1
    v_permlane16_swap_b32 v196, v197
    v_add_f32 v196, v196, v197
    v_fmac_f32 v196, v192, v180
    v_rcp_f32 v196, v196
    s_nop 0
    v_mul_f32 v144, v144, v196
    v_mul_f32 v145, v145, v196
    v_mul_f32 v146, v146, v196
    v_mul_f32 v147, v147, v196
    v_mul_f32 v192, v192, v196
    v_cvt_pk_bf16_f32 v164, v144, v145
    v_cvt_pk_bf16_f32 v165, v146, v147
    v_max3_f32 v196, v156, v157, v158
    v_max_f32 v196, v196, v159
    v_mov_b32 v197, v196
    s_nop 1
    v_permlane16_swap_b32 v196, v197
    v_max_f32 v196, v196, v197
    v_mul_f32 v196, s22, v196
    v_max_f32 v196, v196, v193
    v_sub_f32 v193, v193, v196
    v_fma_f32 v156, v156, s22, -v196
    v_fma_f32 v157, v157, s22, -v196
    v_fma_f32 v158, v158, s22, -v196
    v_fma_f32 v159, v159, s22, -v196
    v_exp_f32 v193, v193
    v_exp_f32 v156, v156
    v_exp_f32 v157, v157
    v_exp_f32 v158, v158
    v_exp_f32 v159, v159
    v_add_f32 v196, v156, v157
    v_add_f32 v197, v158, v159
    v_add_f32 v196, v196, v197
    v_mov_b32 v197, v196
    s_nop 1
    v_permlane16_swap_b32 v196, v197
    v_add_f32 v196, v196, v197
    v_fmac_f32 v196, v193, v184
    v_rcp_f32 v196, v196
    s_nop 0
    v_mul_f32 v156, v156, v196
    v_mul_f32 v157, v157, v196
    v_mul_f32 v158, v158, v196
    v_mul_f32 v159, v159, v196
    v_mul_f32 v193, v193, v196
    v_cvt_pk_bf16_f32 v170, v156, v157
    v_cvt_pk_bf16_f32 v171, v158, v159
    s_lshl_b32 s18, s16, 18
    s_lshl_b32 s19, s17, 12
    s_add_u32 s18, s18, s19
    s_add_u32 s18, s18, 50331648
    s_add_u32 s19, s18, 131072
    v_mul_f32 v40, v40, v192
    v_mul_f32 v41, v41, v192
    v_mul_f32 v42, v42, v192
    v_mul_f32 v43, v43, v192
    v_mul_f32 v44, v44, v192
    v_mul_f32 v45, v45, v192
    v_mul_f32 v46, v46, v192
    v_mul_f32 v47, v47, v192
    v_mfma_f32_16x16x16_bf16 v[40:43], v[120:121], v[164:165], v[40:43]
    v_mfma_f32_16x16x16_bf16 v[44:47], v[122:123], v[164:165], v[44:47]
    v_mul_f32 v48, v48, v193
    v_mul_f32 v49, v49, v193
    v_mul_f32 v50, v50, v193
    v_mul_f32 v51, v51, v193
    v_mul_f32 v52, v52, v193
    v_mul_f32 v53, v53, v193
    v_mul_f32 v54, v54, v193
    v_mul_f32 v55, v55, v193
    v_mfma_f32_16x16x16_bf16 v[48:51], v[120:121], v[170:171], v[48:51]
    v_mfma_f32_16x16x16_bf16 v[52:55], v[122:123], v[170:171], v[52:55]
    v_cvt_pk_bf16_f32 v40, v40, v41
    v_cvt_pk_bf16_f32 v41, v42, v43
    v_cvt_pk_bf16_f32 v42, v44, v45
    v_cvt_pk_bf16_f32 v43, v46, v47
    buffer_store_dwordx4 v[40:43], v1, s[4:7], s18 offen offset:0 sc1
    v_mul_f32 v56, v56, v192
    v_mul_f32 v57, v57, v192
    v_mul_f32 v58, v58, v192
    v_mul_f32 v59, v59, v192
    v_mul_f32 v60, v60, v192
    v_mul_f32 v61, v61, v192
    v_mul_f32 v62, v62, v192
    v_mul_f32 v63, v63, v192
    v_mfma_f32_16x16x16_bf16 v[56:59], v[124:125], v[164:165], v[56:59]
    v_mfma_f32_16x16x16_bf16 v[60:63], v[126:127], v[164:165], v[60:63]
    v_cvt_pk_bf16_f32 v48, v48, v49
    v_cvt_pk_bf16_f32 v49, v50, v51
    v_cvt_pk_bf16_f32 v50, v52, v53
    v_cvt_pk_bf16_f32 v51, v54, v55
    buffer_store_dwordx4 v[48:51], v1, s[4:7], s19 offen offset:0 sc1
    v_mul_f32 v64, v64, v193
    v_mul_f32 v65, v65, v193
    v_mul_f32 v66, v66, v193
    v_mul_f32 v67, v67, v193
    v_mul_f32 v68, v68, v193
    v_mul_f32 v69, v69, v193
    v_mul_f32 v70, v70, v193
    v_mul_f32 v71, v71, v193
    v_mfma_f32_16x16x16_bf16 v[64:67], v[124:125], v[170:171], v[64:67]
    v_mfma_f32_16x16x16_bf16 v[68:71], v[126:127], v[170:171], v[68:71]
    v_cvt_pk_bf16_f32 v56, v56, v57
    v_cvt_pk_bf16_f32 v57, v58, v59
    v_cvt_pk_bf16_f32 v58, v60, v61
    v_cvt_pk_bf16_f32 v59, v62, v63
    buffer_store_dwordx4 v[56:59], v1, s[4:7], s18 offen offset:1024 sc1
    v_mul_f32 v200, v200, v192
    v_mul_f32 v201, v201, v192
    v_mul_f32 v202, v202, v192
    v_mul_f32 v203, v203, v192
    v_mul_f32 v204, v204, v192
    v_mul_f32 v205, v205, v192
    v_mul_f32 v206, v206, v192
    v_mul_f32 v207, v207, v192
    v_mfma_f32_16x16x16_bf16 v[200:203], v[128:129], v[164:165], v[200:203]
    v_mfma_f32_16x16x16_bf16 v[204:207], v[130:131], v[164:165], v[204:207]
    v_cvt_pk_bf16_f32 v64, v64, v65
    v_cvt_pk_bf16_f32 v65, v66, v67
    v_cvt_pk_bf16_f32 v66, v68, v69
    v_cvt_pk_bf16_f32 v67, v70, v71
    buffer_store_dwordx4 v[64:67], v1, s[4:7], s19 offen offset:1024 sc1
    v_mul_f32 v208, v208, v193
    v_mul_f32 v209, v209, v193
    v_mul_f32 v210, v210, v193
    v_mul_f32 v211, v211, v193
    v_mul_f32 v212, v212, v193
    v_mul_f32 v213, v213, v193
    v_mul_f32 v214, v214, v193
    v_mul_f32 v215, v215, v193
    v_mfma_f32_16x16x16_bf16 v[208:211], v[128:129], v[170:171], v[208:211]
    v_mfma_f32_16x16x16_bf16 v[212:215], v[130:131], v[170:171], v[212:215]
    v_cvt_pk_bf16_f32 v200, v200, v201
    v_cvt_pk_bf16_f32 v201, v202, v203
    v_cvt_pk_bf16_f32 v202, v204, v205
    v_cvt_pk_bf16_f32 v203, v206, v207
    buffer_store_dwordx4 v[200:203], v1, s[4:7], s18 offen offset:2048 sc1
    v_mul_f32 v216, v216, v192
    v_mul_f32 v217, v217, v192
    v_mul_f32 v218, v218, v192
    v_mul_f32 v219, v219, v192
    v_mul_f32 v220, v220, v192
    v_mul_f32 v221, v221, v192
    v_mul_f32 v222, v222, v192
    v_mul_f32 v223, v223, v192
    v_mfma_f32_16x16x16_bf16 v[216:219], v[132:133], v[164:165], v[216:219]
    v_mfma_f32_16x16x16_bf16 v[220:223], v[134:135], v[164:165], v[220:223]
    v_cvt_pk_bf16_f32 v208, v208, v209
    v_cvt_pk_bf16_f32 v209, v210, v211
    v_cvt_pk_bf16_f32 v210, v212, v213
    v_cvt_pk_bf16_f32 v211, v214, v215
    buffer_store_dwordx4 v[208:211], v1, s[4:7], s19 offen offset:2048 sc1
    v_mul_f32 v224, v224, v193
    v_mul_f32 v225, v225, v193
    v_mul_f32 v226, v226, v193
    v_mul_f32 v227, v227, v193
    v_mul_f32 v228, v228, v193
    v_mul_f32 v229, v229, v193
    v_mul_f32 v230, v230, v193
    v_mul_f32 v231, v231, v193
    v_mfma_f32_16x16x16_bf16 v[224:227], v[132:133], v[170:171], v[224:227]
    v_mfma_f32_16x16x16_bf16 v[228:231], v[134:135], v[170:171], v[228:231]
    v_cvt_pk_bf16_f32 v216, v216, v217
    v_cvt_pk_bf16_f32 v217, v218, v219
    v_cvt_pk_bf16_f32 v218, v220, v221
    v_cvt_pk_bf16_f32 v219, v222, v223
    buffer_store_dwordx4 v[216:219], v1, s[4:7], s18 offen offset:3072 sc1
    v_cvt_pk_bf16_f32 v224, v224, v225
    v_cvt_pk_bf16_f32 v225, v226, v227
    v_cvt_pk_bf16_f32 v226, v228, v229
    v_cvt_pk_bf16_f32 v227, v230, v231
    buffer_store_dwordx4 v[224:227], v1, s[4:7], s19 offen offset:3072 sc1
    s_lshr_b32 s40, s34, 1
    s_lshl_b32 s40, s40, 7
    s_and_b32 s41, s17, 7
    s_lshl_b32 s41, s41, 2
    s_add_u32 s40, s40, s41
    s_add_u32 s40, s40, 125894656
    v_mov_b32 v250, s95
    s_cmp_ge_u32 s16, 62
    s_cbranch_scc1 L_afl
    s_waitcnt vmcnt(0)
L_afl:
    s_mov_b64 exec, 1
    buffer_store_dword v250, off, s[4:7], s40 sc1
    s_mov_b64 exec, -1
    s_add_u32 s34, s34, 32
    s_cmp_lt_u32 s34, 512
    s_cbranch_scc1 L_att_next
    s_branch L_done
L_op_start:
    s_mov_b32 s16, s33
    s_mov_b32 s33, s34
    v_and_b32 v2, 63, v0
    v_lshlrev_b32 v1, 4, v2
    v_lshrrev_b32 v5, 2, v2
    v_mul_u32_u24 v3, 1152, v5
    v_and_b32 v5, 3, v2
    v_lshl_add_u32 v3, v5, 4, v3
    s_lshl_b32 s21, s32, 12
    v_add_u32 v4, s21, v1
    s_mov_b64 s[12:13], s[58:59]
    s_mov_b32 s14, 4718592
    s_mov_b32 s15, 0x20000
    s_mul_i32 s19, s32, 1179648
    s_lshl_b32 s18, s33, 6
    s_add_u32 s19, s19, s18
    s_add_u32 s18, s19, 0
    s_add_u32 m0, s21, 0
    s_nop 0
    buffer_load_dwordx4 v3, s[12:15], s18 offen lds
    s_add_u32 m0, s21, 1024
    s_add_u32 s18, s18, 18432
    buffer_load_dwordx4 v3, s[12:15], s18 offen lds
    s_add_u32 m0, s21, 2048
    s_add_u32 s18, s18, 18432
    buffer_load_dwordx4 v3, s[12:15], s18 offen lds
    s_add_u32 m0, s21, 3072
    s_add_u32 s18, s18, 18432
    buffer_load_dwordx4 v3, s[12:15], s18 offen lds
    s_add_u32 s18, s19, 73728
    s_add_u32 m0, s21, 16384
    s_nop 0
    buffer_load_dwordx4 v3, s[12:15], s18 offen lds
    s_add_u32 m0, s21, 17408
    s_add_u32 s18, s18, 18432
    buffer_load_dwordx4 v3, s[12:15], s18 offen lds
    s_add_u32 m0, s21, 18432
    s_add_u32 s18, s18, 18432
    buffer_load_dwordx4 v3, s[12:15], s18 offen lds
    s_add_u32 m0, s21, 19456
    s_add_u32 s18, s18, 18432
    buffer_load_dwordx4 v3, s[12:15], s18 offen lds
    s_add_u32 s18, s19, 147456
    s_add_u32 m0, s21, 32768
    s_nop 0
    buffer_load_dwordx4 v3, s[12:15], s18 offen lds
    s_add_u32 m0, s21, 33792
    s_add_u32 s18, s18, 18432
    buffer_load_dwordx4 v3, s[12:15], s18 offen lds
    s_add_u32 m0, s21, 34816
    s_add_u32 s18, s18, 18432
    buffer_load_dwordx4 v3, s[12:15], s18 offen lds
    s_add_u32 m0, s21, 35840
    s_add_u32 s18, s18, 18432
    buffer_load_dwordx4 v3, s[12:15], s18 offen lds
    s_add_u32 s18, s19, 221184
    s_add_u32 m0, s21, 49152
    s_nop 0
    buffer_load_dwordx4 v3, s[12:15], s18 offen lds
    s_add_u32 m0, s21, 50176
    s_add_u32 s18, s18, 18432
    buffer_load_dwordx4 v3, s[12:15], s18 offen lds
    s_add_u32 m0, s21, 51200
    s_add_u32 s18, s18, 18432
    buffer_load_dwordx4 v3, s[12:15], s18 offen lds
    s_add_u32 m0, s21, 52224
    s_add_u32 s18, s18, 18432
    buffer_load_dwordx4 v3, s[12:15], s18 offen lds
    s_add_u32 s18, s19, 294912
    s_add_u32 m0, s21, 65536
    s_nop 0
    buffer_load_dwordx4 v3, s[12:15], s18 offen lds
    s_add_u32 m0, s21, 66560
    s_add_u32 s18, s18, 18432
    buffer_load_dwordx4 v3, s[12:15], s18 offen lds
    s_add_u32 m0, s21, 67584
    s_add_u32 s18, s18, 18432
    buffer_load_dwordx4 v3, s[12:15], s18 offen lds
    s_add_u32 m0, s21, 68608
    s_add_u32 s18, s18, 18432
    buffer_load_dwordx4 v3, s[12:15], s18 offen lds
    s_add_u32 s18, s19, 368640
    s_add_u32 m0, s21, 81920
    s_nop 0
    buffer_load_dwordx4 v3, s[12:15], s18 offen lds
    s_add_u32 m0, s21, 82944
    s_add_u32 s18, s18, 18432
    buffer_load_dwordx4 v3, s[12:15], s18 offen lds
    s_add_u32 m0, s21, 83968
    s_add_u32 s18, s18, 18432
    buffer_load_dwordx4 v3, s[12:15], s18 offen lds
    s_add_u32 m0, s21, 84992
    s_add_u32 s18, s18, 18432
    buffer_load_dwordx4 v3, s[12:15], s18 offen lds
    s_add_u32 s18, s19, 442368
    s_add_u32 m0, s21, 98304
    s_nop 0
    buffer_load_dwordx4 v3, s[12:15], s18 offen lds
    s_add_u32 m0, s21, 99328
    s_add_u32 s18, s18, 18432
    buffer_load_dwordx4 v3, s[12:15], s18 offen lds
    s_add_u32 m0, s21, 100352
    s_add_u32 s18, s18, 18432
    buffer_load_dwordx4 v3, s[12:15], s18 offen lds
    s_add_u32 m0, s21, 101376
    s_add_u32 s18, s18, 18432
    buffer_load_dwordx4 v3, s[12:15], s18 offen lds
    s_add_u32 s18, s19, 516096
    s_add_u32 m0, s21, 114688
    s_nop 0
    buffer_load_dwordx4 v3, s[12:15], s18 offen lds
    s_add_u32 m0, s21, 115712
    s_add_u32 s18, s18, 18432
    buffer_load_dwordx4 v3, s[12:15], s18 offen lds
    s_add_u32 m0, s21, 116736
    s_add_u32 s18, s18, 18432
    buffer_load_dwordx4 v3, s[12:15], s18 offen lds
    s_add_u32 m0, s21, 117760
    s_add_u32 s18, s18, 18432
    buffer_load_dwordx4 v3, s[12:15], s18 offen lds
    s_add_u32 s18, s19, 589824
    s_add_u32 m0, s21, 131072
    s_nop 0
    buffer_load_dwordx4 v3, s[12:15], s18 offen lds
    s_add_u32 m0, s21, 132096
    s_add_u32 s18, s18, 18432
    buffer_load_dwordx4 v3, s[12:15], s18 offen lds
    s_add_u32 m0, s21, 133120
    s_add_u32 s18, s18, 18432
    buffer_load_dwordx4 v3, s[12:15], s18 offen lds
    s_add_u32 m0, s21, 134144
    s_add_u32 s18, s18, 18432
    buffer_load_dwordx4 v3, s[12:15], s18 offen lds
    v_add_u32 v6, 0, v4
    v_xor_b32 v7, 32, v6
    s_waitcnt vmcnt(32)
    ds_read_b64_tr_b16 a[0:1], v6 offset:0
    ds_read_b64_tr_b16 a[2:3], v6 offset:1024
    ds_read_b64_tr_b16 a[4:5], v6 offset:8
    ds_read_b64_tr_b16 a[6:7], v6 offset:1032
    ds_read_b64_tr_b16 a[8:9], v6 offset:2048
    ds_read_b64_tr_b16 a[10:11], v6 offset:3072
    ds_read_b64_tr_b16 a[12:13], v6 offset:2056
    ds_read_b64_tr_b16 a[14:15], v6 offset:3080
    s_waitcnt lgkmcnt(0)
    s_add_u32 s18, s19, 663552
    s_add_u32 m0, s21, 0
    s_nop 0
    buffer_load_dwordx4 v3, s[12:15], s18 offen lds
    s_add_u32 m0, s21, 1024
    s_add_u32 s18, s18, 18432
    buffer_load_dwordx4 v3, s[12:15], s18 offen lds
    s_add_u32 m0, s21, 2048
    s_add_u32 s18, s18, 18432
    buffer_load_dwordx4 v3, s[12:15], s18 offen lds
    s_add_u32 m0, s21, 3072
    s_add_u32 s18, s18, 18432
    buffer_load_dwordx4 v3, s[12:15], s18 offen lds
    v_add_u32 v6, 16384, v4
    v_xor_b32 v7, 32, v6
    s_waitcnt vmcnt(32)
    ds_read_b64_tr_b16 a[16:17], v6 offset:0
    ds_read_b64_tr_b16 a[18:19], v6 offset:1024
    ds_read_b64_tr_b16 a[20:21], v6 offset:8
    ds_read_b64_tr_b16 a[22:23], v6 offset:1032
    ds_read_b64_tr_b16 a[24:25], v6 offset:2048
    ds_read_b64_tr_b16 a[26:27], v6 offset:3072
    ds_read_b64_tr_b16 a[28:29], v6 offset:2056
    ds_read_b64_tr_b16 a[30:31], v6 offset:3080
    s_waitcnt lgkmcnt(0)
    s_add_u32 s18, s19, 737280
    s_add_u32 m0, s21, 16384
    s_nop 0
    buffer_load_dwordx4 v3, s[12:15], s18 offen lds
    s_add_u32 m0, s21, 17408
    s_add_u32 s18, s18, 18432
    buffer_load_dwordx4 v3, s[12:15], s18 offen lds
    s_add_u32 m0, s21, 18432
    s_add_u32 s18, s18, 18432
    buffer_load_dwordx4 v3, s[12:15], s18 offen lds
    s_add_u32 m0, s21, 19456
    s_add_u32 s18, s18, 18432
    buffer_load_dwordx4 v3, s[12:15], s18 offen lds
    v_add_u32 v6, 32768, v4
    v_xor_b32 v7, 32, v6
    s_waitcnt vmcnt(32)
    ds_read_b64_tr_b16 a[32:33], v6 offset:0
    ds_read_b64_tr_b16 a[34:35], v6 offset:1024
    ds_read_b64_tr_b16 a[36:37], v6 offset:8
    ds_read_b64_tr_b16 a[38:39], v6 offset:1032
    ds_read_b64_tr_b16 a[40:41], v6 offset:2048
    ds_read_b64_tr_b16 a[42:43], v6 offset:3072
    ds_read_b64_tr_b16 a[44:45], v6 offset:2056
    ds_read_b64_tr_b16 a[46:47], v6 offset:3080
    s_waitcnt lgkmcnt(0)
    s_add_u32 s18, s19, 811008
    s_add_u32 m0, s21, 32768
    s_nop 0
    buffer_load_dwordx4 v3, s[12:15], s18 offen lds
    s_add_u32 m0, s21, 33792
    s_add_u32 s18, s18, 18432
    buffer_load_dwordx4 v3, s[12:15], s18 offen lds
    s_add_u32 m0, s21, 34816
    s_add_u32 s18, s18, 18432
    buffer_load_dwordx4 v3, s[12:15], s18 offen lds
    s_add_u32 m0, s21, 35840
    s_add_u32 s18, s18, 18432
    buffer_load_dwordx4 v3, s[12:15], s18 offen lds
    v_add_u32 v6, 49152, v4
    v_xor_b32 v7, 32, v6
    s_waitcnt vmcnt(32)
    ds_read_b64_tr_b16 a[48:49], v6 offset:0
    ds_read_b64_tr_b16 a[50:51], v6 offset:1024
    ds_read_b64_tr_b16 a[52:53], v6 offset:8
    ds_read_b64_tr_b16 a[54:55], v6 offset:1032
    ds_read_b64_tr_b16 a[56:57], v6 offset:2048
    ds_read_b64_tr_b16 a[58:59], v6 offset:3072
    ds_read_b64_tr_b16 a[60:61], v6 offset:2056
    ds_read_b64_tr_b16 a[62:63], v6 offset:3080
    s_waitcnt lgkmcnt(0)
    s_add_u32 s18, s19, 884736
    s_add_u32 m0, s21, 49152
    s_nop 0
    buffer_load_dwordx4 v3, s[12:15], s18 offen lds
    s_add_u32 m0, s21, 50176
    s_add_u32 s18, s18, 18432
    buffer_load_dwordx4 v3, s[12:15], s18 offen lds
    s_add_u32 m0, s21, 51200
    s_add_u32 s18, s18, 18432
    buffer_load_dwordx4 v3, s[12:15], s18 offen lds
    s_add_u32 m0, s21, 52224
    s_add_u32 s18, s18, 18432
    buffer_load_dwordx4 v3, s[12:15], s18 offen lds
    v_add_u32 v6, 65536, v4
    v_xor_b32 v7, 32, v6
    s_waitcnt vmcnt(32)
    ds_read_b64_tr_b16 a[64:65], v6 offset:0
    ds_read_b64_tr_b16 a[66:67], v6 offset:1024
    ds_read_b64_tr_b16 a[68:69], v6 offset:8
    ds_read_b64_tr_b16 a[70:71], v6 offset:1032
    ds_read_b64_tr_b16 a[72:73], v6 offset:2048
    ds_read_b64_tr_b16 a[74:75], v6 offset:3072
    ds_read_b64_tr_b16 a[76:77], v6 offset:2056
    ds_read_b64_tr_b16 a[78:79], v6 offset:3080
    s_waitcnt lgkmcnt(0)
    s_add_u32 s18, s19, 958464
    s_add_u32 m0, s21, 65536
    s_nop 0
    buffer_load_dwordx4 v3, s[12:15], s18 offen lds
    s_add_u32 m0, s21, 66560
    s_add_u32 s18, s18, 18432
    buffer_load_dwordx4 v3, s[12:15], s18 offen lds
    s_add_u32 m0, s21, 67584
    s_add_u32 s18, s18, 18432
    buffer_load_dwordx4 v3, s[12:15], s18 offen lds
    s_add_u32 m0, s21, 68608
    s_add_u32 s18, s18, 18432
    buffer_load_dwordx4 v3, s[12:15], s18 offen lds
    v_add_u32 v6, 81920, v4
    v_xor_b32 v7, 32, v6
    s_waitcnt vmcnt(32)
    ds_read_b64_tr_b16 a[80:81], v6 offset:0
    ds_read_b64_tr_b16 a[82:83], v6 offset:1024
    ds_read_b64_tr_b16 a[84:85], v6 offset:8
    ds_read_b64_tr_b16 a[86:87], v6 offset:1032
    ds_read_b64_tr_b16 a[88:89], v6 offset:2048
    ds_read_b64_tr_b16 a[90:91], v6 offset:3072
    ds_read_b64_tr_b16 a[92:93], v6 offset:2056
    ds_read_b64_tr_b16 a[94:95], v6 offset:3080
    s_waitcnt lgkmcnt(0)
    s_add_u32 s18, s19, 1032192
    s_add_u32 m0, s21, 81920
    s_nop 0
    buffer_load_dwordx4 v3, s[12:15], s18 offen lds
    s_add_u32 m0, s21, 82944
    s_add_u32 s18, s18, 18432
    buffer_load_dwordx4 v3, s[12:15], s18 offen lds
    s_add_u32 m0, s21, 83968
    s_add_u32 s18, s18, 18432
    buffer_load_dwordx4 v3, s[12:15], s18 offen lds
    s_add_u32 m0, s21, 84992
    s_add_u32 s18, s18, 18432
    buffer_load_dwordx4 v3, s[12:15], s18 offen lds
    v_add_u32 v6, 98304, v4
    v_xor_b32 v7, 32, v6
    s_waitcnt vmcnt(32)
    ds_read_b64_tr_b16 a[96:97], v6 offset:0
    ds_read_b64_tr_b16 a[98:99], v6 offset:1024
    ds_read_b64_tr_b16 a[100:101], v6 offset:8
    ds_read_b64_tr_b16 a[102:103], v6 offset:1032
    ds_read_b64_tr_b16 a[104:105], v6 offset:2048
    ds_read_b64_tr_b16 a[106:107], v6 offset:3072
    ds_read_b64_tr_b16 a[108:109], v6 offset:2056
    ds_read_b64_tr_b16 a[110:111], v6 offset:3080
    s_waitcnt lgkmcnt(0)
    s_add_u32 s18, s19, 1105920
    s_add_u32 m0, s21, 98304
    s_nop 0
    buffer_load_dwordx4 v3, s[12:15], s18 offen lds
    s_add_u32 m0, s21, 99328
    s_add_u32 s18, s18, 18432
    buffer_load_dwordx4 v3, s[12:15], s18 offen lds
    s_add_u32 m0, s21, 100352
    s_add_u32 s18, s18, 18432
    buffer_load_dwordx4 v3, s[12:15], s18 offen lds
    s_add_u32 m0, s21, 101376
    s_add_u32 s18, s18, 18432
    buffer_load_dwordx4 v3, s[12:15], s18 offen lds
    v_add_u32 v6, 114688, v4
    v_xor_b32 v7, 32, v6
    s_waitcnt vmcnt(32)
    ds_read_b64_tr_b16 a[112:113], v6 offset:0
    ds_read_b64_tr_b16 a[114:115], v6 offset:1024
    ds_read_b64_tr_b16 a[116:117], v6 offset:8
    ds_read_b64_tr_b16 a[118:119], v6 offset:1032
    ds_read_b64_tr_b16 a[120:121], v6 offset:2048
    ds_read_b64_tr_b16 a[122:123], v6 offset:3072
    ds_read_b64_tr_b16 a[124:125], v6 offset:2056
    ds_read_b64_tr_b16 a[126:127], v6 offset:3080
    s_waitcnt lgkmcnt(0)
    v_add_u32 v6, 131072, v4
    v_xor_b32 v7, 32, v6
    s_waitcnt vmcnt(28)
    ds_read_b64_tr_b16 a[128:129], v6 offset:0
    ds_read_b64_tr_b16 a[130:131], v6 offset:1024
    ds_read_b64_tr_b16 a[132:133], v6 offset:8
    ds_read_b64_tr_b16 a[134:135], v6 offset:1032
    ds_read_b64_tr_b16 a[136:137], v6 offset:2048
    ds_read_b64_tr_b16 a[138:139], v6 offset:3072
    ds_read_b64_tr_b16 a[140:141], v6 offset:2056
    ds_read_b64_tr_b16 a[142:143], v6 offset:3080
    s_waitcnt lgkmcnt(0)
    v_add_u32 v6, 0, v4
    v_xor_b32 v7, 32, v6
    s_waitcnt vmcnt(24)
    ds_read_b64_tr_b16 a[144:145], v6 offset:0
    ds_read_b64_tr_b16 a[146:147], v6 offset:1024
    ds_read_b64_tr_b16 a[148:149], v6 offset:8
    ds_read_b64_tr_b16 a[150:151], v6 offset:1032
    ds_read_b64_tr_b16 a[152:153], v6 offset:2048
    ds_read_b64_tr_b16 a[154:155], v6 offset:3072
    ds_read_b64_tr_b16 a[156:157], v6 offset:2056
    ds_read_b64_tr_b16 a[158:159], v6 offset:3080
    s_waitcnt lgkmcnt(0)
    v_add_u32 v6, 16384, v4
    v_xor_b32 v7, 32, v6
    s_waitcnt vmcnt(20)
    ds_read_b64_tr_b16 a[160:161], v6 offset:0
    ds_read_b64_tr_b16 a[162:163], v6 offset:1024
    ds_read_b64_tr_b16 a[164:165], v6 offset:8
    ds_read_b64_tr_b16 a[166:167], v6 offset:1032
    ds_read_b64_tr_b16 a[168:169], v6 offset:2048
    ds_read_b64_tr_b16 a[170:171], v6 offset:3072
    ds_read_b64_tr_b16 a[172:173], v6 offset:2056
    ds_read_b64_tr_b16 a[174:175], v6 offset:3080
    s_waitcnt lgkmcnt(0)
    v_add_u32 v6, 32768, v4
    v_xor_b32 v7, 32, v6
    s_waitcnt vmcnt(16)
    ds_read_b64_tr_b16 a[176:177], v6 offset:0
    ds_read_b64_tr_b16 a[178:179], v6 offset:1024
    ds_read_b64_tr_b16 a[180:181], v6 offset:8
    ds_read_b64_tr_b16 a[182:183], v6 offset:1032
    ds_read_b64_tr_b16 a[184:185], v6 offset:2048
    ds_read_b64_tr_b16 a[186:187], v6 offset:3072
    ds_read_b64_tr_b16 a[188:189], v6 offset:2056
    ds_read_b64_tr_b16 a[190:191], v6 offset:3080
    s_waitcnt lgkmcnt(0)
    v_add_u32 v6, 49152, v4
    v_xor_b32 v7, 32, v6
    s_waitcnt vmcnt(12)
    ds_read_b64_tr_b16 a[192:193], v6 offset:0
    ds_read_b64_tr_b16 a[194:195], v6 offset:1024
    ds_read_b64_tr_b16 a[196:197], v6 offset:8
    ds_read_b64_tr_b16 a[198:199], v6 offset:1032
    ds_read_b64_tr_b16 a[200:201], v6 offset:2048
    ds_read_b64_tr_b16 a[202:203], v6 offset:3072
    ds_read_b64_tr_b16 a[204:205], v6 offset:2056
    ds_read_b64_tr_b16 a[206:207], v6 offset:3080
    s_waitcnt lgkmcnt(0)
    v_add_u32 v6, 65536, v4
    v_xor_b32 v7, 32, v6
    s_waitcnt vmcnt(8)
    ds_read_b64_tr_b16 a[208:209], v6 offset:0
    ds_read_b64_tr_b16 a[210:211], v6 offset:1024
    ds_read_b64_tr_b16 a[212:213], v6 offset:8
    ds_read_b64_tr_b16 a[214:215], v6 offset:1032
    ds_read_b64_tr_b16 a[216:217], v6 offset:2048
    ds_read_b64_tr_b16 a[218:219], v6 offset:3072
    ds_read_b64_tr_b16 a[220:221], v6 offset:2056
    ds_read_b64_tr_b16 a[222:223], v6 offset:3080
    s_waitcnt lgkmcnt(0)
    v_add_u32 v6, 81920, v4
    v_xor_b32 v7, 32, v6
    s_waitcnt vmcnt(4)
    ds_read_b64_tr_b16 a[224:225], v6 offset:0
    ds_read_b64_tr_b16 a[226:227], v6 offset:1024
    ds_read_b64_tr_b16 a[228:229], v6 offset:8
    ds_read_b64_tr_b16 a[230:231], v6 offset:1032
    ds_read_b64_tr_b16 a[232:233], v6 offset:2048
    ds_read_b64_tr_b16 a[234:235], v6 offset:3072
    ds_read_b64_tr_b16 a[236:237], v6 offset:2056
    ds_read_b64_tr_b16 a[238:239], v6 offset:3080
    s_waitcnt lgkmcnt(0)
    v_add_u32 v6, 98304, v4
    v_xor_b32 v7, 32, v6
    s_waitcnt vmcnt(0)
    ds_read_b64_tr_b16 a[240:241], v6 offset:0
    ds_read_b64_tr_b16 a[242:243], v6 offset:1024
    ds_read_b64_tr_b16 a[244:245], v6 offset:8
    ds_read_b64_tr_b16 a[246:247], v6 offset:1032
    ds_read_b64_tr_b16 a[248:249], v6 offset:2048
    ds_read_b64_tr_b16 a[250:251], v6 offset:3072
    ds_read_b64_tr_b16 a[252:253], v6 offset:2056
    ds_read_b64_tr_b16 a[254:255], v6 offset:3080
    s_waitcnt lgkmcnt(0)
    s_barrier
    s_mov_b32 s35, s16
L_op_seg:
    s_sub_u32 s40, s35, 126
    s_lshr_b32 s41, s40, 1
    s_add_u32 s41, s41, 126
    s_and_b32 s40, s40, 1
    s_lshl_b32 s40, s40, 3
    s_lshl_b32 s44, 0x00ff00ff, s40
    s_cmp_ge_u32 s35, 999
    s_cselect_b32 s16, s41, s35
    s_cselect_b32 s44, s44, -1
    s_mov_b32 s45, s44
    s_lshr_b32 s43, s16, 1
    s_add_u32 s43, s43, 1
    s_min_u32 s43, s43, 63
    s_and_b32 s36, s33, 15
    s_lshl_b32 s36, s36, 8
    s_add_u32 s36, s36, 125829120
    s_lshl_b32 s94, s33, 7
    s_add_u32 s94, s94, s16
    s_cmp_ge_u32 s16, 120
    s_cbranch_scc1 L_nocw
    s_mov_b32 s88, 65536
cw15:
    buffer_load_dword v3, off, s[4:7], s36 offset:128 sc1
    s_waitcnt vmcnt(0)
    v_readfirstlane_b32 s42, v3
    s_nop 0
    s_sub_u32 s42, s42, s95
    s_cmp_gt_u32 s42, 64
    s_cselect_b32 s42, 0, s42
    s_add_u32 s42, s42, 2
    s_cmp_ge_u32 s42, s43
    s_cbranch_scc1 cw15x
    s_sub_u32 s88, s88, 1
    s_cbranch_scc1 cw15x
    s_sub_u32 s42, s43, s42
    s_min_u32 s42, s42, 6
cw15s:
    s_sleep 24
    s_sub_u32 s42, s42, 1
    s_cmp_lg_u32 s42, 0
    s_cbranch_scc1 cw15s
    s_branch cw15
cw15x:
L_nocw:
    s_lshr_b32 s89, s16, 1
    s_lshl_b32 s89, s89, 2
    s_add_u32 s89, s89, s32
    s_lshl_b32 s89, s89, 7
    s_add_u32 s89, s89, 125894656
    v_mbcnt_lo_u32_b32 v2, -1, 0
    v_mbcnt_hi_u32_b32 v2, -1, v2
    v_min_u32 v2, 7, v2
    v_lshlrev_b32 v2, 2, v2
    s_mov_b32 s88, 4194304
fw16:
    buffer_load_dword v3, v2, s[4:7], s89 offen offset:0 sc1
    s_sub_u32 s88, s88, 1
    s_cbranch_scc1 fw16x
    s_waitcnt vmcnt(0)
    v_cmp_ne_u32 vcc, s95, v3
    s_cbranch_vccz fw16x
    s_sleep 2
    s_cmp_gt_u32 s88, 4194256
    s_cbranch_scc1 fw16
    s_sleep 40
    s_branch fw16
fw16x:
    s_mov_b32 s21, 4096
os_again:
    s_lshl_b32 s18, s16, 17
    s_lshl_b32 s19, s32, 15
    s_add_u32 s18, s18, s19
    s_add_u32 s18, s18, 50331648
    s_mov_b64 exec, s[44:45]
    buffer_load_dwordx4 v[32:35], v1, s[4:7], s18 offen offset:0 sc1
    buffer_load_dwordx4 v[36:39], v1, s[4:7], s18 offen offset:1024 sc1
    buffer_load_dwordx4 v[40:43], v1, s[4:7], s18 offen offset:2048 sc1
    buffer_load_dwordx4 v[44:47], v1, s[4:7], s18 offen offset:3072 sc1
    s_add_u32 s18, s18, 4096
    buffer_load_dwordx4 v[48:51], v1, s[4:7], s18 offen offset:0 sc1
    buffer_load_dwordx4 v[52:55], v1, s[4:7], s18 offen offset:1024 sc1
    buffer_load_dwordx4 v[56:59], v1, s[4:7], s18 offen offset:2048 sc1
    buffer_load_dwordx4 v[60:63], v1, s[4:7], s18 offen offset:3072 sc1
    s_add_u32 s18, s18, 4096
    buffer_load_dwordx4 v[64:67], v1, s[4:7], s18 offen offset:0 sc1
    buffer_load_dwordx4 v[68:71], v1, s[4:7], s18 offen offset:1024 sc1
    buffer_load_dwordx4 v[72:75], v1, s[4:7], s18 offen offset:2048 sc1
    buffer_load_dwordx4 v[76:79], v1, s[4:7], s18 offen offset:3072 sc1
    s_add_u32 s18, s18, 4096
    buffer_load_dwordx4 v[80:83], v1, s[4:7], s18 offen offset:0 sc1
    buffer_load_dwordx4 v[84:87], v1, s[4:7], s18 offen offset:1024 sc1
    buffer_load_dwordx4 v[88:91], v1, s[4:7], s18 offen offset:2048 sc1
    buffer_load_dwordx4 v[92:95], v1, s[4:7], s18 offen offset:3072 sc1
    s_add_u32 s18, s18, 4096
    buffer_load_dwordx4 v[96:99], v1, s[4:7], s18 offen offset:0 sc1
    buffer_load_dwordx4 v[100:103], v1, s[4:7], s18 offen offset:1024 sc1
    buffer_load_dwordx4 v[104:107], v1, s[4:7], s18 offen offset:2048 sc1
    buffer_load_dwordx4 v[108:111], v1, s[4:7], s18 offen offset:3072 sc1
    s_add_u32 s18, s18, 4096
    buffer_load_dwordx4 v[112:115], v1, s[4:7], s18 offen offset:0 sc1
    buffer_load_dwordx4 v[116:119], v1, s[4:7], s18 offen offset:1024 sc1
    buffer_load_dwordx4 v[120:123], v1, s[4:7], s18 offen offset:2048 sc1
    buffer_load_dwordx4 v[124:127], v1, s[4:7], s18 offen offset:3072 sc1
    s_add_u32 s18, s18, 4096
    buffer_load_dwordx4 v[128:131], v1, s[4:7], s18 offen offset:0 sc1
    buffer_load_dwordx4 v[132:135], v1, s[4:7], s18 offen offset:1024 sc1
    buffer_load_dwordx4 v[136:139], v1, s[4:7], s18 offen offset:2048 sc1
    buffer_load_dwordx4 v[140:143], v1, s[4:7], s18 offen offset:3072 sc1
    s_add_u32 s18, s18, 4096
    buffer_load_dwordx4 v[144:147], v1, s[4:7], s18 offen offset:0 sc1
    buffer_load_dwordx4 v[148:151], v1, s[4:7], s18 offen offset:1024 sc1
    buffer_load_dwordx4 v[152:155], v1, s[4:7], s18 offen offset:2048 sc1
    buffer_load_dwordx4 v[156:159], v1, s[4:7], s18 offen offset:3072 sc1
    s_mov_b64 exec, -1
    v_lshlrev_b32 v2, 4, v0
    v_and_b32 v3, 3072, v2
    v_lshl_add_u32 v2, v3, 1, v1
    s_waitcnt vmcnt(31)
    v_mfma_f32_16x16x32_bf16 v[8:11], a[0:3], v[32:35], 0
    v_mfma_f32_16x16x32_bf16 v[12:15], a[4:7], v[32:35], 0
    v_mov_b32 v4, v32
    s_waitcnt vmcnt(30)
    v_mfma_f32_16x16x32_bf16 v[8:11], a[8:11], v[36:39], v[8:11]
    v_mfma_f32_16x16x32_bf16 v[12:15], a[12:15], v[36:39], v[12:15]
    v_max_u32 v4, v4, v36
    s_waitcnt vmcnt(29)
    v_mfma_f32_16x16x32_bf16 v[8:11], a[16:19], v[40:43], v[8:11]
    v_mfma_f32_16x16x32_bf16 v[12:15], a[20:23], v[40:43], v[12:15]
    v_max_u32 v4, v4, v40
    s_waitcnt vmcnt(28)
    v_mfma_f32_16x16x32_bf16 v[8:11], a[24:27], v[44:47], v[8:11]
    v_mfma_f32_16x16x32_bf16 v[12:15], a[28:31], v[44:47], v[12:15]
    v_max_u32 v4, v4, v44
    s_waitcnt vmcnt(27)
    v_mfma_f32_16x16x32_bf16 v[8:11], a[32:35], v[48:51], v[8:11]
    v_mfma_f32_16x16x32_bf16 v[12:15], a[36:39], v[48:51], v[12:15]
    v_max_u32 v4, v4, v48
    s_waitcnt vmcnt(26)
    v_mfma_f32_16x16x32_bf16 v[8:11], a[40:43], v[52:55], v[8:11]
    v_mfma_f32_16x16x32_bf16 v[12:15], a[44:47], v[52:55], v[12:15]
    v_max_u32 v4, v4, v52
    s_waitcnt vmcnt(25)
    v_mfma_f32_16x16x32_bf16 v[8:11], a[48:51], v[56:59], v[8:11]
    v_mfma_f32_16x16x32_bf16 v[12:15], a[52:55], v[56:59], v[12:15]
    v_max_u32 v4, v4, v56
    s_waitcnt vmcnt(24)
    v_mfma_f32_16x16x32_bf16 v[8:11], a[56:59], v[60:63], v[8:11]
    v_mfma_f32_16x16x32_bf16 v[12:15], a[60:63], v[60:63], v[12:15]
    v_max_u32 v4, v4, v60
    s_waitcnt vmcnt(23)
    v_mfma_f32_16x16x32_bf16 v[8:11], a[64:67], v[64:67], v[8:11]
    v_mfma_f32_16x16x32_bf16 v[12:15], a[68:71], v[64:67], v[12:15]
    v_max_u32 v4, v4, v64
    s_waitcnt vmcnt(22)
    v_mfma_f32_16x16x32_bf16 v[8:11], a[72:75], v[68:71], v[8:11]
    v_mfma_f32_16x16x32_bf16 v[12:15], a[76:79], v[68:71], v[12:15]
    v_max_u32 v4, v4, v68
    s_waitcnt vmcnt(21)
    v_mfma_f32_16x16x32_bf16 v[8:11], a[80:83], v[72:75], v[8:11]
    v_mfma_f32_16x16x32_bf16 v[12:15], a[84:87], v[72:75], v[12:15]
    v_max_u32 v4, v4, v72
    s_waitcnt vmcnt(20)
    v_mfma_f32_16x16x32_bf16 v[8:11], a[88:91], v[76:79], v[8:11]
    v_mfma_f32_16x16x32_bf16 v[12:15], a[92:95], v[76:79], v[12:15]
    v_max_u32 v4, v4, v76
    s_waitcnt vmcnt(19)
    v_mfma_f32_16x16x32_bf16 v[8:11], a[96:99], v[80:83], v[8:11]
    v_mfma_f32_16x16x32_bf16 v[12:15], a[100:103], v[80:83], v[12:15]
    v_max_u32 v4, v4, v80
    s_waitcnt vmcnt(18)
    v_mfma_f32_16x16x32_bf16 v[8:11], a[104:107], v[84:87], v[8:11]
    v_mfma_f32_16x16x32_bf16 v[12:15], a[108:111], v[84:87], v[12:15]
    v_max_u32 v4, v4, v84
    s_waitcnt vmcnt(17)
    v_mfma_f32_16x16x32_bf16 v[8:11], a[112:115], v[88:91], v[8:11]
    v_mfma_f32_16x16x32_bf16 v[12:15], a[116:119], v[88:91], v[12:15]
    v_max_u32 v4, v4, v88
    s_waitcnt vmcnt(16)
    v_mfma_f32_16x16x32_bf16 v[8:11], a[120:123], v[92:95], v[8:11]
    v_mfma_f32_16x16x32_bf16 v[12:15], a[124:127], v[92:95], v[12:15]
    v_max_u32 v4, v4, v92
    s_waitcnt vmcnt(15)
    v_mfma_f32_16x16x32_bf16 v[8:11], a[128:131], v[96:99], v[8:11]
    v_mfma_f32_16x16x32_bf16 v[12:15], a[132:135], v[96:99], v[12:15]
    v_max_u32 v4, v4, v96
    s_waitcnt vmcnt(14)
    v_mfma_f32_16x16x32_bf16 v[8:11], a[136:139], v[100:103], v[8:11]
    v_mfma_f32_16x16x32_bf16 v[12:15], a[140:143], v[100:103], v[12:15]
    v_max_u32 v4, v4, v100
    s_waitcnt vmcnt(13)
    v_mfma_f32_16x16x32_bf16 v[8:11], a[144:147], v[104:107], v[8:11]
    v_mfma_f32_16x16x32_bf16 v[12:15], a[148:151], v[104:107], v[12:15]
    v_max_u32 v4, v4, v104
    s_waitcnt vmcnt(12)
    v_mfma_f32_16x16x32_bf16 v[8:11], a[152:155], v[108:111], v[8:11]
    v_mfma_f32_16x16x32_bf16 v[12:15], a[156:159], v[108:111], v[12:15]
    v_max_u32 v4, v4, v108
    s_waitcnt vmcnt(11)
    v_mfma_f32_16x16x32_bf16 v[8:11], a[160:163], v[112:115], v[8:11]
    v_mfma_f32_16x16x32_bf16 v[12:15], a[164:167], v[112:115], v[12:15]
    v_max_u32 v4, v4, v112
    s_waitcnt vmcnt(10)
    v_mfma_f32_16x16x32_bf16 v[8:11], a[168:171], v[116:119], v[8:11]
    v_mfma_f32_16x16x32_bf16 v[12:15], a[172:175], v[116:119], v[12:15]
    v_max_u32 v4, v4, v116
    s_waitcnt vmcnt(9)
    v_mfma_f32_16x16x32_bf16 v[8:11], a[176:179], v[120:123], v[8:11]
    v_mfma_f32_16x16x32_bf16 v[12:15], a[180:183], v[120:123], v[12:15]
    v_max_u32 v4, v4, v120
    s_waitcnt vmcnt(8)
    v_mfma_f32_16x16x32_bf16 v[8:11], a[184:187], v[124:127], v[8:11]
    v_mfma_f32_16x16x32_bf16 v[12:15], a[188:191], v[124:127], v[12:15]
    v_max_u32 v4, v4, v124
    s_waitcnt vmcnt(7)
    v_mfma_f32_16x16x32_bf16 v[8:11], a[192:195], v[128:131], v[8:11]
    v_mfma_f32_16x16x32_bf16 v[12:15], a[196:199], v[128:131], v[12:15]
    v_max_u32 v4, v4, v128
    s_waitcnt vmcnt(6)
    v_mfma_f32_16x16x32_bf16 v[8:11], a[200:203], v[132:135], v[8:11]
    v_mfma_f32_16x16x32_bf16 v[12:15], a[204:207], v[132:135], v[12:15]
    v_max_u32 v4, v4, v132
    s_waitcnt vmcnt(5)
    v_mfma_f32_16x16x32_bf16 v[8:11], a[208:211], v[136:139], v[8:11]
    v_mfma_f32_16x16x32_bf16 v[12:15], a[212:215], v[136:139], v[12:15]
    v_max_u32 v4, v4, v136
    s_waitcnt vmcnt(4)
    v_mfma_f32_16x16x32_bf16 v[8:11], a[216:219], v[140:143], v[8:11]
    v_mfma_f32_16x16x32_bf16 v[12:15], a[220:223], v[140:143], v[12:15]
    v_max_u32 v4, v4, v140
    s_waitcnt vmcnt(3)
    v_mfma_f32_16x16x32_bf16 v[8:11], a[224:227], v[144:147], v[8:11]
    v_mfma_f32_16x16x32_bf16 v[12:15], a[228:231], v[144:147], v[12:15]
    v_max_u32 v4, v4, v144
    s_waitcnt vmcnt(2)
    v_mfma_f32_16x16x32_bf16 v[8:11], a[232:235], v[148:151], v[8:11]
    v_mfma_f32_16x16x32_bf16 v[12:15], a[236:239], v[148:151], v[12:15]
    v_max_u32 v4, v4, v148
    s_waitcnt vmcnt(1)
    v_mfma_f32_16x16x32_bf16 v[8:11], a[240:243], v[152:155], v[8:11]
    v_mfma_f32_16x16x32_bf16 v[12:15], a[244:247], v[152:155], v[12:15]
    v_max_u32 v4, v4, v152
    s_waitcnt vmcnt(0)
    v_mfma_f32_16x16x32_bf16 v[8:11], a[248:251], v[156:159], v[8:11]
    v_mfma_f32_16x16x32_bf16 v[12:15], a[252:255], v[156:159], v[12:15]
    v_max_u32 v4, v4, v156
    v_cmp_eq_u32 vcc, -1, v4
    s_nop 0
    s_and_b64 vcc, vcc, s[44:45]
    s_sub_u32 s21, s21, 1
    s_nop 1
    s_cbranch_scc1 os_ok
    s_cbranch_vccnz os_again
os_ok:
    ds_write_b128 v2, v[8:11] offset:0
    ds_write_b128 v2, v[12:15] offset:1024
    s_waitcnt lgkmcnt(0)
    s_barrier
    s_cmp_lg_u32 s32, 0
    s_cbranch_scc1 os_skip
    ds_read_b128 v[40:43], v1 offset:2048
    ds_read_b128 v[44:47], v1 offset:3072
    ds_read_b128 v[48:51], v1 offset:4096
    ds_read_b128 v[52:55], v1 offset:5120
    ds_read_b128 v[56:59], v1 offset:6144
    ds_read_b128 v[60:63], v1 offset:7168
    v_lshrrev_b32 v3, 4, v1
    v_bfe_u32 v4, v3, 2, 2
    v_lshlrev_b32 v4, 3, v4
    v_and_b32 v2, 3, v3
    v_add_u32 v4, v4, v2
    v_mul_u32_u24 v4, 2304, v4
    v_lshrrev_b32 v3, 4, v3
    v_lshl_add_u32 v4, v3, 4, v4
    s_lshr_b32 s18, s16, 1
    s_lshl_b32 s18, s18, 3
    s_and_b32 s19, s16, 1
    s_add_u32 s18, s18, s19
    s_mul_i32 s18, s18, 9216
    s_lshl_b32 s19, s33, 6
    s_add_u32 s18, s18, s19
    s_waitcnt lgkmcnt(0)
    v_pk_add_f32 v[8:9], v[8:9], v[40:41]
    v_pk_add_f32 v[48:49], v[48:49], v[56:57]
    v_pk_add_f32 v[8:9], v[8:9], v[48:49]
    v_pk_add_f32 v[10:11], v[10:11], v[42:43]
    v_pk_add_f32 v[50:51], v[50:51], v[58:59]
    v_pk_add_f32 v[10:11], v[10:11], v[50:51]
    v_pk_add_f32 v[12:13], v[12:13], v[44:45]
    v_pk_add_f32 v[52:53], v[52:53], v[60:61]
    v_pk_add_f32 v[12:13], v[12:13], v[52:53]
    v_pk_add_f32 v[14:15], v[14:15], v[46:47]
    v_pk_add_f32 v[54:55], v[54:55], v[62:63]
    v_pk_add_f32 v[14:15], v[14:15], v[54:55]
    v_cvt_pk_bf16_f32 v32, v8, v9
    v_cvt_pk_bf16_f32 v33, v10, v11
    v_cvt_pk_bf16_f32 v34, v12, v13
    v_cvt_pk_bf16_f32 v35, v14, v15
    s_mov_b64 exec, s[44:45]
    buffer_store_dwordx4 v[32:35], v4, s[8:11], s18 offen sc1
    s_mov_b64 exec, -1
os_skip:
    s_nop 0
    s_add_u32 s35, s35, 7
    s_cmp_ge_u32 s35, 128
    s_cbranch_scc1 L_done
    s_barrier
    s_branch L_op_seg
L_done:
L_exit:
    s_endpgm
.section .rodata,"a"
.p2align 6
.amdhsa_kernel concat_heads__memory_aug_recurrent_mem_tr__ssm_conv_s4d__prompt_kernel
  .amdhsa_next_free_vgpr 512
  .amdhsa_next_free_sgpr 102
  .amdhsa_accum_offset 256
  .amdhsa_group_segment_fixed_size 0
  .amdhsa_kernarg_size 136
  .amdhsa_user_sgpr_count 2
  .amdhsa_user_sgpr_kernarg_segment_ptr 1
  .amdhsa_system_sgpr_workgroup_id_x 1
.end_amdhsa_kernel
.text
```

```asm
; @launch grid=(256,1,1) block=(256,1,1) lds=163840
.amdgcn_target "amdgcn-amd-amdhsa--gfx950"
.text
.globl concat_heads__memory_aug_recurrent_mem_tr__ssm_conv_s4d__prompt_kernel
.p2align 8
.type concat_heads__memory_aug_recurrent_mem_tr__ssm_conv_s4d__prompt_kernel,@function
concat_heads__memory_aug_recurrent_mem_tr__ssm_conv_s4d__prompt_kernel:
    s_cmp_ge_u32 s2, 256
    s_cbranch_scc1 L_exit
    s_load_dwordx4 s[84:87], s[0:1], 120
    s_load_dwordx16 s[48:63], s[0:1], 0
    v_lshrrev_b32 v1, 6, v0
    s_nop 0
    v_readfirstlane_b32 s32, v1
    s_getreg_b32 s3, hwreg(HW_REG_XCC_ID)
    s_and_b32 s3, s3, 15
    s_cmp_lg_u32 s32, 3
    s_cbranch_scc1 L_nowarm
    s_getpc_b64 s[44:45]
L_pcw:
    v_and_b32 v1, 63, v0
    v_lshlrev_b32 v1, 7, v1
    s_cmp_lg_u32 s3, 3
    s_cselect_b32 s33, L_helper-L_pcw, 0
    v_add_u32 v1, s33, v1
    v_min_u32 v2, L_exit-L_pcw, v1
    global_load_dword v240, v2, s[44:45]
    v_add_u32 v1, 8192, v1
    v_min_u32 v2, L_exit-L_pcw, v1
    global_load_dword v241, v2, s[44:45]
    v_add_u32 v1, 8192, v1
    s_cbranch_scc0 L_nowarm
    v_min_u32 v2, L_exit-L_pcw, v1
    global_load_dword v242, v2, s[44:45]
    v_add_u32 v1, 8192, v1
    v_min_u32 v2, L_exit-L_pcw, v1
    global_load_dword v243, v2, s[44:45]
    v_add_u32 v1, 8192, v1
L_nowarm:
    s_waitcnt lgkmcnt(0)
    s_mov_b32 s4, s86
    s_mov_b32 s5, s87
    s_mov_b32 s6, 268435456
    s_mov_b32 s7, 0x20000
    s_mov_b32 s96, s84
    s_mov_b32 s97, s85
    s_mov_b32 s98, 256
    s_mov_b32 s99, 0x20000
    s_mov_b32 s95, 0
    s_cmp_lg_u32 s3, 3
    s_cbranch_scc1 L_helper
    s_mov_b32 s37, 128
    v_mov_b32 v250, 1
    v_mov_b32 v251, 163832
    v_cmp_eq_u32 vcc, 0, v0
    s_nop 0
    s_and_saveexec_b64 s[38:39], vcc
    s_cbranch_execz tk1m
    buffer_atomic_add v250, off, s[96:99], s37 sc0
tk1m:
    s_mov_b64 s[38:39], exec
    s_mov_b64 exec, -1
    v_lshrrev_b32 v54, 6, v0
    s_nop 0
    v_readfirstlane_b32 s13, v54
    v_and_b32 v57, 63, v0
    v_bfe_u32 v54, v57, 2, 1
    v_lshlrev_b32 v48, 13, v54
    v_bfe_u32 v54, v57, 3, 1
    v_lshl_add_u32 v48, v54, 15, v48
    v_bfe_u32 v54, v57, 4, 1
    v_lshl_add_u32 v48, v54, 14, v48
    v_bfe_u32 v54, v57, 5, 1
    v_lshl_add_u32 v48, v54, 16, v48
    v_lshrrev_b32 v55, 4, v57
    v_and_b32 v55, 2, v55
    v_xor_b32 v55, v55, v57
    v_and_b32 v55, 3, v55
    v_lshl_add_u32 v48, v55, 4, v48
    v_bfe_u32 v54, v57, 2, 1
    v_lshlrev_b32 v51, 6, v54
    v_bfe_u32 v54, v57, 3, 1
    v_lshl_add_u32 v51, v54, 9, v51
    v_bfe_u32 v54, v57, 4, 1
    v_lshl_add_u32 v51, v54, 7, v51
    v_bfe_u32 v54, v57, 5, 1
    v_lshl_add_u32 v51, v54, 12, v51
    v_bfe_u32 v54, v57, 0, 1
    v_lshl_add_u32 v51, v54, 3, v51
    v_bfe_u32 v54, v57, 1, 1
    v_lshl_add_u32 v51, v54, 4, v51
    v_bfe_u32 v54, v57, 3, 1
    v_lshl_add_u32 v51, v54, 5, v51
    v_lshrrev_b32 v55, 3, v57
    v_mul_u32_u24 v49, 1152, v55
    v_and_b32 v55, 7, v57
    v_lshl_add_u32 v49, v55, 4, v49
    v_bfe_u32 v54, v57, 4, 1
    v_lshlrev_b32 v52, 13, v54
    v_bfe_u32 v54, v57, 5, 1
    v_lshl_add_u32 v52, v54, 9, v52
    v_bfe_u32 v54, v57, 2, 1
    v_lshl_add_u32 v52, v54, 7, v52
    v_bfe_u32 v54, v57, 3, 1
    v_lshl_add_u32 v52, v54, 5, v52
    v_and_b32 v55, 3, v57
    v_lshl_add_u32 v52, v55, 3, v52
    v_lshrrev_b32 v55, 2, v57
    v_mul_u32_u24 v50, 1152, v55
    v_and_b32 v55, 3, v57
    v_lshl_add_u32 v50, v55, 4, v50
    v_bfe_u32 v54, v57, 4, 1
    v_lshlrev_b32 v53, 12, v54
    v_bfe_u32 v54, v57, 5, 1
    v_lshl_add_u32 v53, v54, 8, v53
    v_bfe_u32 v54, v57, 2, 1
    v_lshl_add_u32 v53, v54, 6, v53
    v_bfe_u32 v54, v57, 3, 1
    v_lshl_add_u32 v53, v54, 5, v53
    v_and_b32 v55, 3, v57
    v_lshl_add_u32 v53, v55, 3, v53
    s_lshl_b32 s66, s13, 10
    s_and_b32 s93, s13, 1
    s_lshl_b32 s93, s93, 14
    s_and_b32 s75, s13, 2
    s_lshl_b32 s75, s75, 19
    v_add_u32 v51, s66, v51
    v_add_u32 v52, s66, v52
    v_add_u32 v53, s66, v53
    v_mov_b32 v58, v48
    s_mov_b32 s10, 4718592
    s_mov_b32 s11, 0x20000
    s_mov_b64 exec, s[38:39]
    s_cbranch_execz tk1
    s_waitcnt vmcnt(0)
    ds_write_b32 v251, v250
    s_waitcnt lgkmcnt(0)
tk1:
    s_mov_b64 exec, -1
    s_barrier
    ds_read_b32 v252, v251
    s_waitcnt lgkmcnt(0)
    v_readfirstlane_b32 s12, v252
    s_barrier
    s_nop 3
    s_cmp_ge_u32 s12, 32
    s_cbranch_scc1 L_helper
L_chain:
    s_mov_b64 s[48:49], s[50:51]
    s_mov_b64 s[50:51], s[52:53]
    s_mov_b64 s[52:53], s[54:55]
    s_mov_b64 s[54:55], s[56:57]
    s_mov_b64 s[56:57], s[58:59]
    s_lshl_b32 s67, s12, 8
    s_lshl_b32 s40, s13, 6
    s_add_u32 s67, s67, s40
    s_mul_i32 s92, s12, 147456
    s_lshr_b32 s73, s50, 8
    s_add_u32 s73, s73, s12
    s_and_b32 s73, s73, 31
    s_bitcmp1_b32 0xa2222222, s73
    s_cselect_b32 s88, 1, 0
    s_mov_b32 s72, 0
    s_add_u32 s73, s73, 1
    s_lshr_b32 s73, s73, 2
    s_xor_b32 s94, s13, 0
    s_mul_i32 s94, s94, 36864
    s_add_u32 s94, s94, s92
    s_lshl_b32 s74, s13, 7
    s_add_u32 s94, s94, s74
    s_add_u32 s78, s94, 0
    s_mov_b64 s[8:9], s[56:57]
    v_mov_b32 v58, v49
    s_mov_b32 s79, 9216
    s_mov_b32 s81, 0
    s_add_u32 s80, s66, 114688
    s_mov_b32 s76, 0
    s_mov_b32 s77, 8192
    s_call_b64 s[82:83], cf_dma
    s_mov_b32 s77, 16384
    s_call_b64 s[82:83], cf_dma
    s_xor_b32 s94, s13, 1
    s_mul_i32 s94, s94, 36864
    s_add_u32 s94, s94, s92
    s_lshl_b32 s74, s13, 7
    s_add_u32 s94, s94, s74
    s_add_u32 s78, s94, 0
    s_add_u32 s80, s66, 81920
    s_mov_b32 s76, 0
    s_mov_b32 s77, 8192
    s_call_b64 s[82:83], cf_dma
    s_mov_b32 s77, 16384
    s_call_b64 s[82:83], cf_dma
    s_xor_b32 s94, s13, 2
    s_mul_i32 s94, s94, 36864
    s_add_u32 s94, s94, s92
    s_lshl_b32 s74, s13, 7
    s_add_u32 s94, s94, s74
    s_add_u32 s78, s94, 0
    s_add_u32 s80, s66, 16384
    s_mov_b32 s76, 0
    s_mov_b32 s77, 8192
    s_call_b64 s[82:83], cf_dma
    s_mov_b32 s77, 16384
    s_call_b64 s[82:83], cf_dma
    s_xor_b32 s94, s13, 3
    s_mul_i32 s94, s94, 36864
    s_add_u32 s94, s94, s92
    s_lshl_b32 s74, s13, 7
    s_add_u32 s94, s94, s74
    s_add_u32 s78, s94, 0
    s_add_u32 s80, s66, 0
    s_mov_b32 s76, 0
    s_mov_b32 s77, 8192
    s_call_b64 s[82:83], cf_dma
    s_mov_b32 s77, 16384
    s_call_b64 s[82:83], cf_dma
    v_lshrrev_b32 v24, 6, v0
    v_lshlrev_b32 v61, 4, v0
    v_add_u32 v62, 57344, v61
    v_xor_b32 v63, 1024, v61
    v_add_u32 v63, 98304, v63
    v_xor_b32 v64, 2048, v61
    v_add_u32 v64, 98304, v64
    v_and_b32 v65, 1023, v61
    v_add_u32 v65, 98304, v65
    v_and_b32 v26, 15, v0
    v_bfe_u32 v27, v0, 4, 2
    v_mov_b32 v60, 0x4444
    v_mov_b32 v25, 0xeeee
    v_cmp_lt_u32 vcc, 7, v26
    s_nop 1
    v_cndmask_b32 v60, v60, v25, vcc
    s_nop 1
    v_and_b32 v67, 12, v26
    v_lshlrev_b32 v67, 3, v67
    v_and_b32 v25, 1, v26
    v_lshl_add_u32 v67, v25, 4, v67
    v_bfe_u32 v25, v26, 1, 1
    v_lshl_add_u32 v67, v25, 3, v67
    v_lshl_add_u32 v66, v27, 14, v67
    v_lshl_add_u32 v66, v24, 17, v66
    s_nop 1
    v_and_b32 v67, 63, v67
    v_lshrrev_b32 v25, 1, v24
    v_lshl_add_u32 v67, v25, 18, v67
    v_lshl_add_u32 v67, v27, 16, v67
    v_lshrrev_b32 v25, 3, v26
    v_lshl_add_u32 v67, v25, 15, v67
    v_and_b32 v25, 1, v24
    v_lshl_add_u32 v67, v25, 6, v67
    s_nop 1
    s_waitcnt vmcnt(12)
    v_add_u32 v55, 114688, v52
    ds_read_b64_tr_b16 v[160:161], v55 offset:0
    ds_read_b64_tr_b16 v[162:163], v55 offset:256
    ds_read_b64_tr_b16 v[164:165], v55 offset:4096
    ds_read_b64_tr_b16 v[166:167], v55 offset:4352
    s_xor_b32 s94, s13, 0
    s_mul_i32 s94, s94, 36864
    s_add_u32 s94, s94, s92
    s_lshl_b32 s74, s13, 7
    s_add_u32 s94, s94, s74
    s_add_u32 s78, s94, 512
    s_add_u32 s80, s66, 147456
    s_mov_b32 s76, 0
    s_mov_b32 s77, 8192
    s_call_b64 s[82:83], cf_dma
    ds_read_b64_tr_b16 v[192:193], v55 offset:64
    ds_read_b64_tr_b16 v[194:195], v55 offset:320
    ds_read_b64_tr_b16 v[196:197], v55 offset:4160
    ds_read_b64_tr_b16 v[198:199], v55 offset:4416
    s_mov_b32 s77, 16384
    s_call_b64 s[82:83], cf_dma
    v_and_b32 v25, 31, v0
    v_lshlrev_b32 v70, 4, v25
    v_lshlrev_b32 v28, 3, v25
    v_add_u32 v28, 108032, v28
    v_lshrrev_b32 v25, 1, v24
    v_lshl_add_u32 v70, v25, 9, v70
    v_and_b32 v25, 1, v24
    v_lshl_add_u32 v70, v25, 3, v70
    v_add_u32 v70, 109568, v70
    v_cmp_gt_u32 vcc, 2, v27
    s_nop 1
    v_cndmask_b32 v70, v70, v28, vcc
    s_nop 1
    s_waitcnt lgkmcnt(0)
    s_waitcnt vmcnt(12)
    v_add_u32 v55, 81920, v52
    ds_read_b64_tr_b16 v[168:169], v55 offset:0
    ds_read_b64_tr_b16 v[170:171], v55 offset:256
    ds_read_b64_tr_b16 v[172:173], v55 offset:4096
    ds_read_b64_tr_b16 v[174:175], v55 offset:4352
    s_xor_b32 s94, s13, 1
    s_mul_i32 s94, s94, 36864
    s_add_u32 s94, s94, s92
    s_lshl_b32 s74, s13, 7
    s_add_u32 s94, s94, s74
    s_add_u32 s78, s94, 512
    s_add_u32 s80, s66, 98304
    s_mov_b32 s76, 0
    s_mov_b32 s77, 8192
    s_call_b64 s[82:83], cf_dma
    ds_read_b64_tr_b16 v[200:201], v55 offset:64
    ds_read_b64_tr_b16 v[202:203], v55 offset:320
    ds_read_b64_tr_b16 v[204:205], v55 offset:4160
    ds_read_b64_tr_b16 v[206:207], v55 offset:4416
    s_mov_b32 s77, 16384
    s_call_b64 s[82:83], cf_dma
    v_xor_b32 v71, 2048, v63
    v_lshrrev_b32 v68, 4, v0
    v_lshlrev_b32 v68, 7, v68
    v_and_b32 v25, 7, v26
    v_lshl_add_u32 v68, v25, 4, v68
    v_add_u32 v68, 102400, v68
    v_xor_b32 v74, 512, v68
    v_xor_b32 v75, 1024, v68
    v_xor_b32 v76, 1536, v68
    v_lshrrev_b32 v25, 3, v26
    v_lshl_add_u32 v77, v25, 3, v68
    v_or_b32 v78, 512, v65
    v_lshlrev_b32 v79, 2, v61
    v_mov_b64 v[72:73], 0
    v_and_b32 v25, 1, v27
    v_lshlrev_b32 v69, 7, v25
    v_lshrrev_b32 v25, 1, v27
    v_lshl_add_u32 v69, v25, 3, v69
    v_and_b32 v25, 3, v26
    v_lshl_add_u32 v69, v25, 4, v69
    v_bfe_u32 v25, v26, 2, 1
    v_lshl_add_u32 v69, v25, 2, v69
    s_nop 1
    s_waitcnt lgkmcnt(0)
    s_waitcnt vmcnt(12)
    v_add_u32 v55, 16384, v52
    ds_read_b64_tr_b16 v[176:177], v55 offset:0
    ds_read_b64_tr_b16 v[178:179], v55 offset:256
    ds_read_b64_tr_b16 v[180:181], v55 offset:4096
    ds_read_b64_tr_b16 v[182:183], v55 offset:4352
    s_add_u32 s78, s67, 4194304
    s_mov_b64 s[8:9], s[54:55]
    v_mov_b32 v58, v48
    s_mov_b32 s79, 131072
    s_add_u32 s80, s66, 32768
    s_mov_b32 s76, 0
    s_mov_b32 s77, 8192
    s_call_b64 s[82:83], cf_dma
    ds_read_b64_tr_b16 v[208:209], v55 offset:64
    ds_read_b64_tr_b16 v[210:211], v55 offset:320
    ds_read_b64_tr_b16 v[212:213], v55 offset:4160
    ds_read_b64_tr_b16 v[214:215], v55 offset:4416
    s_mov_b32 s77, 16384
    s_call_b64 s[82:83], cf_dma
    s_mov_b32 s32, 0x00ff00ff
    s_mov_b32 s33, 0x00ff00ff
    s_not_b64 s[34:35], s[32:33]
    s_lshr_b32 s31, s12, 1
    s_lshl_b32 s31, s31, 8
    s_and_b32 s40, s12, 1
    s_lshl_b32 s40, s40, 6
    s_add_u32 s31, s31, s40
    s_and_b32 s40, s13, 1
    s_lshl_b32 s40, s40, 12
    s_add_u32 s31, s31, s40
    s_lshl_b32 s19, s12, 14
    s_add_u32 s19, s19, 67076096
    s_add_u32 s41, s19, 8192
    s_add_u32 s19, s19, s40
    s_and_b32 s40, s12, 1
    s_lshl_b32 s40, s40, 2
    s_or_b32 s40, s40, s13
    s_cmp_eq_u32 s40, 5
    s_cselect_b32 s64, 0, s13
    s_cmp_lg_u32 s13, 1
    s_cbranch_scc1 cf_notx
    s_mov_b32 s32, 0xff
    s_mov_b32 s33, 0xff
    s_mov_b32 s19, s41
    s_lshr_b32 s31, s12, 3
    s_lshl_b32 s31, s31, 8
    s_and_b32 s40, s12, 2
    s_lshl_b32 s40, s40, 6
    s_add_u32 s31, s31, s40
    s_and_b32 s40, s12, 4
    s_lshl_b32 s40, s40, 4
    s_add_u32 s31, s31, s40
    s_add_u32 s31, s31, 8192
cf_notx:
    s_cmp_lg_u32 s13, 0
    s_cbranch_scc1 cf_notp
    s_min_u32 s40, s12, 23
    s_mul_i32 s40, s40, 384
    s_add_u32 s40, s40, 98304
    v_add_u32 v69, s40, v61
    v_mov_b32 v25, 108288
    v_cmp_lt_u32 vcc, 23, v0
    s_nop 1
    v_cndmask_b32 v69, v69, v25, vcc
cf_notp:
    s_nop 1
    s_waitcnt lgkmcnt(0)
    s_waitcnt vmcnt(12)
    v_add_u32 v55, 0, v52
    ds_read_b64_tr_b16 v[184:185], v55 offset:0
    ds_read_b64_tr_b16 v[186:187], v55 offset:256
    ds_read_b64_tr_b16 v[188:189], v55 offset:4096
    ds_read_b64_tr_b16 v[190:191], v55 offset:4352
    s_xor_b32 s78, s75, 0
    s_add_u32 s78, s78, s67
    s_mov_b32 s81, s93
    s_add_u32 s80, s66, 114688
    s_mov_b32 s76, 0
    s_mov_b32 s77, 8192
    s_call_b64 s[82:83], cf_dma
    ds_read_b64_tr_b16 v[216:217], v55 offset:64
    ds_read_b64_tr_b16 v[218:219], v55 offset:320
    ds_read_b64_tr_b16 v[220:221], v55 offset:4160
    ds_read_b64_tr_b16 v[222:223], v55 offset:4416
    s_mov_b32 s77, 16384
    s_call_b64 s[82:83], cf_dma
    v_mov_b32 v28, 1
    v_mov_b32 v29, 1
    v_mov_b32 v30, 1
    v_mov_b32 v31, 1
    s_lshl_b32 s40, s12, 14
    s_add_u32 s40, s40, 67174400
    s_add_u32 s41, s40, 0
    buffer_store_dwordx4 v[28:31], v61, s[4:7], s41 offen
    s_add_u32 s41, s40, 4096
    buffer_store_dwordx4 v[28:31], v61, s[4:7], s41 offen
    s_add_u32 s41, s40, 8192
    buffer_store_dwordx4 v[28:31], v61, s[4:7], s41 offen
    s_cmp_eq_u32 s64, 0
    s_cselect_b64 exec, 0, s[32:33]
    v_mov_b32 v27, -1
    s_add_u32 s41, s31, 67108864
    buffer_store_dword v27, v69, s[4:7], s41 offen
    s_add_u32 s41, s31, 67125248
    buffer_store_dword v27, v69, s[4:7], s41 offen
    s_add_u32 s41, s31, 67141632
    buffer_store_dword v27, v69, s[4:7], s41 offen
    s_add_u32 s41, s31, 67158016
    buffer_store_dword v27, v69, s[4:7], s41 offen
    s_mov_b64 exec, -1
    s_waitcnt lgkmcnt(0)
    s_waitcnt vmcnt(12)
    v_add_u32 v55, 147456, v52
    ds_read_b64_tr_b16 v[224:225], v55 offset:0
    ds_read_b64_tr_b16 v[226:227], v55 offset:256
    ds_read_b64_tr_b16 v[228:229], v55 offset:4096
    ds_read_b64_tr_b16 v[230:231], v55 offset:4352
    s_mov_b32 s77, 24576
    s_call_b64 s[82:83], cf_dma
    ds_read_b64_tr_b16 v[240:241], v55 offset:64
    ds_read_b64_tr_b16 v[242:243], v55 offset:320
    ds_read_b64_tr_b16 v[244:245], v55 offset:4160
    ds_read_b64_tr_b16 v[246:247], v55 offset:4416
    s_mov_b32 s77, 32768
    s_call_b64 s[82:83], cf_dma
    s_mov_b64 s[68:69], s[48:49]
    s_mov_b32 s70, 9216
    s_mov_b32 s71, 0x20000
    v_and_b32 v25, 7, v0
    v_mul_u32_u24 v25, 1152, v25
    v_lshrrev_b32 v26, 3, v0
    v_lshl_add_u32 v25, v26, 4, v25
    buffer_load_dwordx4 v[36:39], v25, s[68:71], 0 offen
    buffer_load_dwordx4 v[40:43], v25, s[68:71], 0 offen offset:512
    v_bfe_u32 v25, v0, 2, 3
    v_mul_u32_u24 v25, 1152, v25
    v_lshrrev_b32 v26, 5, v0
    v_lshl_add_u32 v25, v26, 4, v25
    v_and_b32 v26, 3, v0
    v_lshl_add_u32 v25, v26, 2, v25
    buffer_load_dword v44, v25, s[68:71], 0 offen offset:1024
    s_nop 0
    s_waitcnt lgkmcnt(0)
    s_waitcnt vmcnt(15)
    v_add_u32 v55, 98304, v52
    ds_read_b64_tr_b16 v[232:233], v55 offset:0
    ds_read_b64_tr_b16 v[234:235], v55 offset:256
    ds_read_b64_tr_b16 v[236:237], v55 offset:4096
    ds_read_b64_tr_b16 v[238:239], v55 offset:4352
    s_xor_b32 s78, s75, 1048576
    s_add_u32 s78, s78, s67
    s_add_u32 s80, s66, 65536
    s_mov_b32 s76, 0
    s_mov_b32 s77, 8192
    s_call_b64 s[82:83], cf_dma
    ds_read_b64_tr_b16 v[248:249], v55 offset:64
    ds_read_b64_tr_b16 v[250:251], v55 offset:320
    ds_read_b64_tr_b16 v[252:253], v55 offset:4160
    ds_read_b64_tr_b16 v[254:255], v55 offset:4416
    s_mov_b32 s77, 16384
    s_call_b64 s[82:83], cf_dma
    s_mov_b32 s44, 0x3e0293ee
    s_mov_b32 s45, s44
    s_mov_b32 s46, 0x42000000
    s_mov_b32 s60, 0x3f803f80
    s_mov_b32 s61, s60
    s_mov_b32 s62, 0x3e803e80
    s_mov_b32 s63, s62
    s_mov_b32 s28, 0
    s_lshl_b32 s58, s13, 10
    s_add_u32 s58, s58, 102400
    s_lshl_b32 s59, s13, 8
    s_add_u32 s59, s59, 106496
    s_lshl_b32 s24, s12, 14
    s_add_u32 s24, s24, 0
    s_add_u32 s47, s24, 33030144
    s_mul_i32 s40, s13, 3072
    s_add_u32 s23, s24, s40
    s_lshl_b32 s20, s12, 7
    s_add_u32 s20, s20, 67174400
    s_add_u32 s21, s20, 65536
    s_add_u32 s38, s20, 4096
    s_add_u32 s39, s21, 4096
    s_lshl_b32 s22, s12, 7
    s_add_u32 s22, s22, 67182592
    s_waitcnt lgkmcnt(0)
    s_waitcnt vmcnt(15)
    v_add_u32 v55, 32768, v51
    v_xor_b32 v56, 32, v55
    ds_read_b64_tr_b16 v[144:145], v55 offset:0
    ds_read_b64_tr_b16 v[146:147], v55 offset:256
    ds_read_b64_tr_b16 v[148:149], v55 offset:8192
    ds_read_b64_tr_b16 v[150:151], v55 offset:8448
    s_mov_b32 s77, 24576
    s_call_b64 s[82:83], cf_dma
    ds_read_b64_tr_b16 v[152:153], v56 offset:0
    ds_read_b64_tr_b16 v[154:155], v56 offset:256
    ds_read_b64_tr_b16 v[156:157], v56 offset:8192
    ds_read_b64_tr_b16 v[158:159], v56 offset:8448
    s_mov_b32 s77, 32768
    s_call_b64 s[82:83], cf_dma
    s_lshl_b32 s40, s12, 12
    s_add_u32 s25, s40, 79429632
    s_add_u32 s26, s40, 88866816
    s_lshl_b32 s65, s12, 9
    s_add_u32 s65, s65, 90177536
    s_lshl_b32 s40, s13, 5
    s_or_b32 s40, s40, s12
    s_cmp_lt_u32 s40, 24
    s_cselect_b32 s36, 0x1ffffff, 0
    s_mov_b32 s37, 0
    s_lshl_b32 s27, s12, 7
    s_add_u32 s27, s27, 125845504
    s_lshl_b32 s40, s13, 2
    s_add_u32 s27, s27, s40
    v_bfe_u32 v28, v61, 4, 4
    v_bfe_u32 v29, v61, 8, 1
    v_lshlrev_b32 v29, 2, v29
    v_sub_u32 v29, v28, v29
    v_mov_b32 v31, 0x3f80
    v_mov_b32 v32, 0x3f800000
    s_nop 1
    s_waitcnt lgkmcnt(0)
    s_waitcnt vmcnt(11)
    v_add_u32 v55, 114688, v51
    v_xor_b32 v56, 32, v55
    ds_read_b64_tr_b16 a[192:193], v55 offset:0
    ds_read_b64_tr_b16 a[194:195], v55 offset:256
    ds_read_b64_tr_b16 a[196:197], v55 offset:8192
    ds_read_b64_tr_b16 a[198:199], v55 offset:8448
    s_xor_b32 s78, s75, 2097152
    s_add_u32 s78, s78, s67
    s_add_u32 s80, s66, 0
    s_mov_b32 s76, 0
    s_mov_b32 s77, 8192
    s_call_b64 s[82:83], cf_dma
    ds_read_b64_tr_b16 a[200:201], v56 offset:0
    ds_read_b64_tr_b16 a[202:203], v56 offset:256
    ds_read_b64_tr_b16 a[204:205], v56 offset:8192
    ds_read_b64_tr_b16 a[206:207], v56 offset:8448
    s_mov_b32 s77, 16384
    s_call_b64 s[82:83], cf_dma
    v_cmp_eq_u32 vcc, 0, v29
    s_nop 1
    v_cndmask_b32 v16, 0, v31, vcc
    v_cmp_eq_u32 vcc, 1, v29
    s_nop 1
    v_cndmask_b32 v16, v16, v32, vcc
    v_cmp_eq_u32 vcc, 0, v28
    s_nop 1
    v_cndmask_b32 v20, 0, v31, vcc
    v_cmp_eq_u32 vcc, 1, v28
    s_nop 1
    v_cndmask_b32 v20, v20, v32, vcc
    s_nop 1
    s_waitcnt lgkmcnt(0)
    v_add_u32 v55, 131072, v51
    v_xor_b32 v56, 32, v55
    ds_read_b64_tr_b16 a[208:209], v55 offset:0
    ds_read_b64_tr_b16 a[210:211], v55 offset:256
    ds_read_b64_tr_b16 a[212:213], v55 offset:8192
    ds_read_b64_tr_b16 a[214:215], v55 offset:8448
    s_mov_b32 s77, 24576
    s_call_b64 s[82:83], cf_dma
    ds_read_b64_tr_b16 a[216:217], v56 offset:0
    ds_read_b64_tr_b16 a[218:219], v56 offset:256
    ds_read_b64_tr_b16 a[220:221], v56 offset:8192
    ds_read_b64_tr_b16 a[222:223], v56 offset:8448
    s_mov_b32 s77, 32768
    s_call_b64 s[82:83], cf_dma
    v_cmp_eq_u32 vcc, 2, v29
    s_nop 1
    v_cndmask_b32 v17, 0, v31, vcc
    v_cmp_eq_u32 vcc, 3, v29
    s_nop 1
    v_cndmask_b32 v17, v17, v32, vcc
    v_cmp_eq_u32 vcc, 2, v28
    s_nop 1
    v_cndmask_b32 v21, 0, v31, vcc
    v_cmp_eq_u32 vcc, 3, v28
    s_nop 1
    v_cndmask_b32 v21, v21, v32, vcc
    s_nop 1
    s_waitcnt lgkmcnt(0)
    s_waitcnt vmcnt(8)
    v_add_u32 v55, 65536, v51
    v_xor_b32 v56, 32, v55
    ds_read_b64_tr_b16 a[224:225], v55 offset:0
    ds_read_b64_tr_b16 a[226:227], v55 offset:256
    ds_read_b64_tr_b16 a[228:229], v55 offset:8192
    ds_read_b64_tr_b16 a[230:231], v55 offset:8448
    s_cmp_eq_u32 s88, 0
    s_cbranch_scc1 cf_cpe623
    s_lshl_b32 s89, s73, 7
    s_add_u32 s89, s89, 125853696
    v_min_u32 v33, 11, v57
    v_lshlrev_b32 v33, 2, v33
    buffer_load_dword v34, off, s[96:99], 0 offset:64 sc1
    buffer_load_dword v35, v33, s[4:7], s89 offen sc1
cf_cpe623:
    s_xor_b32 s78, s75, 3145728
    s_add_u32 s78, s78, s67
    s_add_u32 s80, s66, 32768
    s_mov_b32 s76, 0
    s_mov_b32 s77, 8192
    s_call_b64 s[82:83], cf_dma
    ds_read_b64_tr_b16 a[232:233], v56 offset:0
    ds_read_b64_tr_b16 a[234:235], v56 offset:256
    ds_read_b64_tr_b16 a[236:237], v56 offset:8192
    ds_read_b64_tr_b16 a[238:239], v56 offset:8448
    s_mov_b32 s77, 16384
    s_call_b64 s[82:83], cf_dma
    v_cmp_eq_u32 vcc, 8, v29
    s_nop 1
    v_cndmask_b32 v18, 0, v31, vcc
    v_cmp_eq_u32 vcc, 9, v29
    s_nop 1
    v_cndmask_b32 v18, v18, v32, vcc
    v_cmp_eq_u32 vcc, 4, v28
    s_nop 1
    v_cndmask_b32 v22, 0, v31, vcc
    v_cmp_eq_u32 vcc, 5, v28
    s_nop 1
    v_cndmask_b32 v22, v22, v32, vcc
    s_nop 1
    s_waitcnt lgkmcnt(0)
    v_add_u32 v55, 81920, v51
    v_xor_b32 v56, 32, v55
    ds_read_b64_tr_b16 a[240:241], v55 offset:0
    ds_read_b64_tr_b16 a[242:243], v55 offset:256
    ds_read_b64_tr_b16 a[244:245], v55 offset:8192
    ds_read_b64_tr_b16 a[246:247], v55 offset:8448
    s_mov_b32 s77, 24576
    s_call_b64 s[82:83], cf_dma
    ds_read_b64_tr_b16 a[248:249], v56 offset:0
    ds_read_b64_tr_b16 a[250:251], v56 offset:256
    ds_read_b64_tr_b16 a[252:253], v56 offset:8192
    ds_read_b64_tr_b16 a[254:255], v56 offset:8448
    s_mov_b32 s77, 32768
    s_call_b64 s[82:83], cf_dma
    v_cmp_eq_u32 vcc, 10, v29
    s_nop 1
    v_cndmask_b32 v19, 0, v31, vcc
    v_cmp_eq_u32 vcc, 11, v29
    s_nop 1
    v_cndmask_b32 v19, v19, v32, vcc
    v_cmp_eq_u32 vcc, 6, v28
    s_nop 1
    v_cndmask_b32 v23, 0, v31, vcc
    v_cmp_eq_u32 vcc, 7, v28
    s_nop 1
    v_cndmask_b32 v23, v23, v32, vcc
    s_nop 1
    s_waitcnt lgkmcnt(0)
    s_waitcnt vmcnt(8)
    v_add_u32 v55, 0, v51
    v_xor_b32 v56, 32, v55
    ds_read_b64_tr_b16 v[80:81], v55 offset:0
    ds_read_b64_tr_b16 v[82:83], v55 offset:256
    ds_read_b64_tr_b16 v[84:85], v55 offset:8192
    ds_read_b64_tr_b16 v[86:87], v55 offset:8448
    s_cmp_eq_u32 s88, 0
    s_cbranch_scc1 cf_ncp693
    s_waitcnt vmcnt(8)
    v_max_u32 v34, 1, v34
    v_cmp_eq_u32 vcc, 1, v34
    s_cbranch_vccnz cf_ncp693
    v_cmp_ne_u32 vcc, v34, v35
    s_cbranch_vccnz cf_ncp693
    s_mov_b32 s88, 0
    s_mov_b32 s72, 5
    s_lshl_b32 s74, s73, 19
    s_add_u32 s74, s74, 96468992
    s_add_u32 s50, s4, s74
    s_addc_u32 s51, s5, 0
    s_add_u32 s52, s50, 147456
    s_addc_u32 s53, s51, 0
    s_lshl_b32 s67, s13, 6
    v_and_b32 v54, 63, v48
    v_lshrrev_b32 v48, 13, v48
    v_lshl_add_u32 v48, v48, 8, v54
cf_ncp693:
    s_cmp_eq_u32 s88, 0
    s_cbranch_scc1 cf_cpe714
    s_lshl_b32 s89, s73, 7
    s_add_u32 s89, s89, 125853696
    v_min_u32 v33, 11, v57
    v_lshlrev_b32 v33, 2, v33
    buffer_load_dword v34, off, s[96:99], 0 offset:64 sc1
    buffer_load_dword v35, v33, s[4:7], s89 offen sc1
cf_cpe714:
    s_xor_b32 s78, s75, 2097152
    s_lshr_b32 s78, s78, s72
    s_add_u32 s78, s78, s67
    s_mov_b64 s[8:9], s[52:53]
    v_mov_b32 v58, v48
    s_lshr_b32 s79, 131072, s72
    s_add_u32 s80, s66, 131072
    s_mov_b32 s76, 0
    s_mov_b32 s77, 8192
    s_call_b64 s[82:83], cf_dma
    ds_read_b64_tr_b16 v[88:89], v56 offset:0
    ds_read_b64_tr_b16 v[90:91], v56 offset:256
    ds_read_b64_tr_b16 v[92:93], v56 offset:8192
    ds_read_b64_tr_b16 v[94:95], v56 offset:8448
    s_mov_b32 s77, 16384
    s_call_b64 s[82:83], cf_dma
    v_mov_b32 v46, 1
    s_mov_b64 exec, 1
    buffer_atomic_add v46, off, s[96:99], 0 offset:132 sc0
    s_mov_b64 exec, -1
    s_waitcnt lgkmcnt(0)
    v_add_u32 v55, 16384, v51
    v_xor_b32 v56, 32, v55
    ds_read_b64_tr_b16 v[96:97], v55 offset:0
    ds_read_b64_tr_b16 v[98:99], v55 offset:256
    ds_read_b64_tr_b16 v[100:101], v55 offset:8192
    ds_read_b64_tr_b16 v[102:103], v55 offset:8448
    s_mov_b32 s77, 24576
    s_call_b64 s[82:83], cf_dma
    ds_read_b64_tr_b16 v[104:105], v56 offset:0
    ds_read_b64_tr_b16 v[106:107], v56 offset:256
    ds_read_b64_tr_b16 v[108:109], v56 offset:8192
    ds_read_b64_tr_b16 v[110:111], v56 offset:8448
    s_mov_b32 s77, 32768
    s_call_b64 s[82:83], cf_dma
    s_waitcnt lgkmcnt(0)
    s_waitcnt vmcnt(9)
    v_add_u32 v55, 32768, v51
    v_xor_b32 v56, 32, v55
    ds_read_b64_tr_b16 v[112:113], v55 offset:0
    ds_read_b64_tr_b16 v[114:115], v55 offset:256
    ds_read_b64_tr_b16 v[116:117], v55 offset:8192
    ds_read_b64_tr_b16 v[118:119], v55 offset:8448
    s_cmp_eq_u32 s88, 0
    s_cbranch_scc1 cf_ncp766
    s_waitcnt vmcnt(9)
    v_max_u32 v34, 1, v34
    v_cmp_eq_u32 vcc, 1, v34
    s_cbranch_vccnz cf_ncp766
    v_cmp_ne_u32 vcc, v34, v35
    s_cbranch_vccnz cf_ncp766
    s_mov_b32 s88, 0
    s_mov_b32 s72, 5
    s_lshl_b32 s74, s73, 19
    s_add_u32 s74, s74, 96468992
    s_add_u32 s50, s4, s74
    s_addc_u32 s51, s5, 0
    s_add_u32 s52, s50, 147456
    s_addc_u32 s53, s51, 0
    s_lshl_b32 s67, s13, 6
    v_and_b32 v54, 63, v48
    v_lshrrev_b32 v48, 13, v48
    v_lshl_add_u32 v48, v48, 8, v54
cf_ncp766:
    s_cmp_eq_u32 s88, 0
    s_cbranch_scc1 cf_cpe787
    s_lshl_b32 s89, s73, 7
    s_add_u32 s89, s89, 125853696
    v_min_u32 v33, 11, v57
    v_lshlrev_b32 v33, 2, v33
    buffer_load_dword v34, off, s[96:99], 0 offset:64 sc1
    buffer_load_dword v35, v33, s[4:7], s89 offen sc1
cf_cpe787:
    s_xor_b32 s78, s75, 3145728
    s_lshr_b32 s78, s78, s72
    s_add_u32 s78, s78, s67
    s_mov_b64 s[8:9], s[52:53]
    v_mov_b32 v58, v48
    s_lshr_b32 s79, 131072, s72
    s_add_u32 s80, s66, 65536
    s_mov_b32 s76, 0
    s_mov_b32 s77, 8192
    s_call_b64 s[82:83], cf_dma
    ds_read_b64_tr_b16 v[120:121], v56 offset:0
    ds_read_b64_tr_b16 v[122:123], v56 offset:256
    ds_read_b64_tr_b16 v[124:125], v56 offset:8192
    ds_read_b64_tr_b16 v[126:127], v56 offset:8448
    s_mov_b32 s77, 16384
    s_call_b64 s[82:83], cf_dma
    s_waitcnt lgkmcnt(0)
    v_add_u32 v55, 49152, v51
    v_xor_b32 v56, 32, v55
    ds_read_b64_tr_b16 v[128:129], v55 offset:0
    ds_read_b64_tr_b16 v[130:131], v55 offset:256
    ds_read_b64_tr_b16 v[132:133], v55 offset:8192
    ds_read_b64_tr_b16 v[134:135], v55 offset:8448
    s_mov_b32 s77, 24576
    s_call_b64 s[82:83], cf_dma
    ds_read_b64_tr_b16 v[136:137], v56 offset:0
    ds_read_b64_tr_b16 v[138:139], v56 offset:256
    ds_read_b64_tr_b16 v[140:141], v56 offset:8192
    ds_read_b64_tr_b16 v[142:143], v56 offset:8448
    s_mov_b32 s77, 32768
    s_call_b64 s[82:83], cf_dma
    s_waitcnt lgkmcnt(0)
    s_waitcnt vmcnt(8)
    v_add_u32 v55, 131072, v51
    v_xor_b32 v56, 32, v55
    ds_read_b64_tr_b16 a[128:129], v55 offset:0
    ds_read_b64_tr_b16 a[130:131], v55 offset:256
    ds_read_b64_tr_b16 a[132:133], v55 offset:8192
    ds_read_b64_tr_b16 a[134:135], v55 offset:8448
    s_cmp_eq_u32 s88, 0
    s_cbranch_scc1 cf_ncp835
    s_waitcnt vmcnt(8)
    v_max_u32 v34, 1, v34
    v_cmp_eq_u32 vcc, 1, v34
    s_cbranch_vccnz cf_ncp835
    v_cmp_ne_u32 vcc, v34, v35
    s_cbranch_vccnz cf_ncp835
    s_mov_b32 s88, 0
    s_mov_b32 s72, 5
    s_lshl_b32 s74, s73, 19
    s_add_u32 s74, s74, 96468992
    s_add_u32 s50, s4, s74
    s_addc_u32 s51, s5, 0
    s_add_u32 s52, s50, 147456
    s_addc_u32 s53, s51, 0
    s_lshl_b32 s67, s13, 6
    v_and_b32 v54, 63, v48
    v_lshrrev_b32 v48, 13, v48
    v_lshl_add_u32 v48, v48, 8, v54
cf_ncp835:
    s_cmp_eq_u32 s88, 0
    s_cbranch_scc1 cf_cpe856
    s_lshl_b32 s89, s73, 7
    s_add_u32 s89, s89, 125853696
    v_min_u32 v33, 11, v57
    v_lshlrev_b32 v33, 2, v33
    buffer_load_dword v34, off, s[96:99], 0 offset:64 sc1
    buffer_load_dword v35, v33, s[4:7], s89 offen sc1
cf_cpe856:
    s_xor_b32 s78, s75, 2097152
    s_lshr_b32 s78, s78, s72
    s_add_u32 s78, s78, s67
    s_mov_b64 s[8:9], s[50:51]
    v_mov_b32 v58, v48
    s_lshr_b32 s79, 131072, s72
    s_add_u32 s80, s66, 0
    s_mov_b32 s76, 0
    s_mov_b32 s77, 8192
    s_call_b64 s[82:83], cf_dma
    ds_read_b64_tr_b16 a[136:137], v56 offset:0
    ds_read_b64_tr_b16 a[138:139], v56 offset:256
    ds_read_b64_tr_b16 a[140:141], v56 offset:8192
    ds_read_b64_tr_b16 a[142:143], v56 offset:8448
    s_mov_b32 s77, 16384
    s_call_b64 s[82:83], cf_dma
    s_waitcnt lgkmcnt(0)
    v_add_u32 v55, 147456, v51
    v_xor_b32 v56, 32, v55
    ds_read_b64_tr_b16 a[144:145], v55 offset:0
    ds_read_b64_tr_b16 a[146:147], v55 offset:256
    ds_read_b64_tr_b16 a[148:149], v55 offset:8192
    ds_read_b64_tr_b16 a[150:151], v55 offset:8448
    s_mov_b32 s77, 24576
    s_call_b64 s[82:83], cf_dma
    ds_read_b64_tr_b16 a[152:153], v56 offset:0
    ds_read_b64_tr_b16 a[154:155], v56 offset:256
    ds_read_b64_tr_b16 a[156:157], v56 offset:8192
    ds_read_b64_tr_b16 a[158:159], v56 offset:8448
    s_mov_b32 s77, 32768
    s_call_b64 s[82:83], cf_dma
    s_waitcnt lgkmcnt(0)
    s_waitcnt vmcnt(8)
    v_add_u32 v55, 65536, v51
    v_xor_b32 v56, 32, v55
    ds_read_b64_tr_b16 a[160:161], v55 offset:0
    ds_read_b64_tr_b16 a[162:163], v55 offset:256
    ds_read_b64_tr_b16 a[164:165], v55 offset:8192
    ds_read_b64_tr_b16 a[166:167], v55 offset:8448
    s_cmp_eq_u32 s88, 0
    s_cbranch_scc1 cf_ncp904
    s_waitcnt vmcnt(8)
    v_max_u32 v34, 1, v34
    v_cmp_eq_u32 vcc, 1, v34
    s_cbranch_vccnz cf_ncp904
    v_cmp_ne_u32 vcc, v34, v35
    s_cbranch_vccnz cf_ncp904
    s_mov_b32 s88, 0
    s_mov_b32 s72, 5
    s_lshl_b32 s74, s73, 19
    s_add_u32 s74, s74, 96468992
    s_add_u32 s50, s4, s74
    s_addc_u32 s51, s5, 0
    s_add_u32 s52, s50, 147456
    s_addc_u32 s53, s51, 0
    s_lshl_b32 s67, s13, 6
    v_and_b32 v54, 63, v48
    v_lshrrev_b32 v48, 13, v48
    v_lshl_add_u32 v48, v48, 8, v54
cf_ncp904:
    s_cmp_eq_u32 s88, 0
    s_cbranch_scc1 cf_cpe925
    s_lshl_b32 s89, s73, 7
    s_add_u32 s89, s89, 125853696
    v_min_u32 v33, 11, v57
    v_lshlrev_b32 v33, 2, v33
    buffer_load_dword v34, off, s[96:99], 0 offset:64 sc1
    buffer_load_dword v35, v33, s[4:7], s89 offen sc1
cf_cpe925:
    s_xor_b32 s78, s75, 3145728
    s_lshr_b32 s78, s78, s72
    s_add_u32 s78, s78, s67
    s_mov_b64 s[8:9], s[50:51]
    v_mov_b32 v58, v48
    s_lshr_b32 s79, 131072, s72
    s_add_u32 s80, s66, 32768
    s_mov_b32 s76, 0
    s_mov_b32 s77, 8192
    s_call_b64 s[82:83], cf_dma
    ds_read_b64_tr_b16 a[168:169], v56 offset:0
    ds_read_b64_tr_b16 a[170:171], v56 offset:256
    ds_read_b64_tr_b16 a[172:173], v56 offset:8192
    ds_read_b64_tr_b16 a[174:175], v56 offset:8448
    s_mov_b32 s77, 16384
    s_call_b64 s[82:83], cf_dma
    v_readfirstlane_b32 s41, v46
    v_mov_b32 v46, 1
    v_mov_b32 v47, 0
    s_cmp_eq_u32 s41, 127
    s_cselect_b64 exec, 1, 0
    buffer_atomic_cmpswap v[46:47], off, s[96:99], 0 offset:140
    s_mov_b64 exec, -1
    s_waitcnt lgkmcnt(0)
    v_add_u32 v55, 81920, v51
    v_xor_b32 v56, 32, v55
    ds_read_b64_tr_b16 a[176:177], v55 offset:0
    ds_read_b64_tr_b16 a[178:179], v55 offset:256
    ds_read_b64_tr_b16 a[180:181], v55 offset:8192
    ds_read_b64_tr_b16 a[182:183], v55 offset:8448
    s_mov_b32 s77, 24576
    s_call_b64 s[82:83], cf_dma
    ds_read_b64_tr_b16 a[184:185], v56 offset:0
    ds_read_b64_tr_b16 a[186:187], v56 offset:256
    ds_read_b64_tr_b16 a[188:189], v56 offset:8192
    ds_read_b64_tr_b16 a[190:191], v56 offset:8448
    s_mov_b32 s77, 32768
    s_call_b64 s[82:83], cf_dma
    s_waitcnt lgkmcnt(0)
    s_waitcnt vmcnt(8)
    v_add_u32 v55, 0, v51
    v_xor_b32 v56, 32, v55
    ds_read_b64_tr_b16 a[48:49], v55 offset:0
    ds_read_b64_tr_b16 a[50:51], v55 offset:256
    ds_read_b64_tr_b16 a[52:53], v55 offset:8192
    ds_read_b64_tr_b16 a[54:55], v55 offset:8448
    s_lshr_b32 s78, 4194304, s72
    s_add_u32 s78, s78, s67
    s_mov_b32 s81, 0
    s_add_u32 s80, s66, 98304
    s_mov_b32 s76, 0
    s_mov_b32 s77, 8192
    s_call_b64 s[82:83], cf_dma
    ds_read_b64_tr_b16 a[56:57], v56 offset:0
    ds_read_b64_tr_b16 a[58:59], v56 offset:256
    ds_read_b64_tr_b16 a[60:61], v56 offset:8192
    ds_read_b64_tr_b16 a[62:63], v56 offset:8448
    s_mov_b32 s77, 16384
    s_call_b64 s[82:83], cf_dma
    s_waitcnt lgkmcnt(0)
    v_add_u32 v55, 16384, v51
    v_xor_b32 v56, 32, v55
    ds_read_b64_tr_b16 a[64:65], v55 offset:0
    ds_read_b64_tr_b16 a[66:67], v55 offset:256
    ds_read_b64_tr_b16 a[68:69], v55 offset:8192
    ds_read_b64_tr_b16 a[70:71], v55 offset:8448
    s_cmp_eq_u32 s88, 0
    s_cbranch_scc1 cf_ncp1000
    s_waitcnt vmcnt(12)
    v_max_u32 v34, 1, v34
    v_cmp_eq_u32 vcc, 1, v34
    s_cbranch_vccnz cf_ncp1000
    v_cmp_ne_u32 vcc, v34, v35
    s_cbranch_vccnz cf_ncp1000
    s_mov_b32 s88, 0
    s_mov_b32 s72, 5
    s_lshl_b32 s74, s73, 19
    s_add_u32 s74, s74, 96468992
    s_add_u32 s50, s4, s74
    s_addc_u32 s51, s5, 0
    s_add_u32 s52, s50, 147456
    s_addc_u32 s53, s51, 0
    s_lshl_b32 s67, s13, 6
    v_and_b32 v54, 63, v48
    v_lshrrev_b32 v48, 13, v48
    v_lshl_add_u32 v48, v48, 8, v54
cf_ncp1000:
    s_xor_b32 s78, s75, 1048576
    s_lshr_b32 s78, s78, s72
    s_add_u32 s78, s78, s67
    s_mov_b64 s[8:9], s[50:51]
    v_mov_b32 v58, v48
    s_lshr_b32 s79, 131072, s72
    s_mov_b32 s81, s93
    s_add_u32 s80, s66, 114688
    s_mov_b32 s76, 0
    s_mov_b32 s77, 8192
    s_call_b64 s[82:83], cf_dma
    ds_read_b64_tr_b16 a[72:73], v56 offset:0
    ds_read_b64_tr_b16 a[74:75], v56 offset:256
    ds_read_b64_tr_b16 a[76:77], v56 offset:8192
    ds_read_b64_tr_b16 a[78:79], v56 offset:8448
    s_mov_b32 s77, 16384
    s_call_b64 s[82:83], cf_dma
    s_waitcnt lgkmcnt(0)
    s_waitcnt vmcnt(8)
    v_add_u32 v55, 32768, v51
    v_xor_b32 v56, 32, v55
    ds_read_b64_tr_b16 a[80:81], v55 offset:0
    ds_read_b64_tr_b16 a[82:83], v55 offset:256
    ds_read_b64_tr_b16 a[84:85], v55 offset:8192
    ds_read_b64_tr_b16 a[86:87], v55 offset:8448
    s_mov_b32 s77, 24576
    s_call_b64 s[82:83], cf_dma
    ds_read_b64_tr_b16 a[88:89], v56 offset:0
    ds_read_b64_tr_b16 a[90:91], v56 offset:256
    ds_read_b64_tr_b16 a[92:93], v56 offset:8192
    ds_read_b64_tr_b16 a[94:95], v56 offset:8448
    s_mov_b32 s77, 32768
    s_call_b64 s[82:83], cf_dma
    s_waitcnt lgkmcnt(0)
    v_add_u32 v55, 49152, v51
    v_xor_b32 v56, 32, v55
    ds_read_b64_tr_b16 a[96:97], v55 offset:0
    ds_read_b64_tr_b16 a[98:99], v55 offset:256
    ds_read_b64_tr_b16 a[100:101], v55 offset:8192
    ds_read_b64_tr_b16 a[102:103], v55 offset:8448
    s_xor_b32 s78, s75, 0
    s_lshr_b32 s78, s78, s72
    s_add_u32 s78, s78, s67
    s_add_u32 s80, s66, 65536
    s_mov_b32 s76, 0
    s_mov_b32 s77, 8192
    s_call_b64 s[82:83], cf_dma
    ds_read_b64_tr_b16 a[104:105], v56 offset:0
    ds_read_b64_tr_b16 a[106:107], v56 offset:256
    ds_read_b64_tr_b16 a[108:109], v56 offset:8192
    ds_read_b64_tr_b16 a[110:111], v56 offset:8448
    s_mov_b32 s77, 16384
    s_call_b64 s[82:83], cf_dma
    s_waitcnt lgkmcnt(0)
    s_waitcnt vmcnt(12)
    v_add_u32 v55, 98304, v51
    v_xor_b32 v56, 32, v55
    ds_read_b64_tr_b16 a[112:113], v55 offset:0
    ds_read_b64_tr_b16 a[114:115], v55 offset:256
    ds_read_b64_tr_b16 a[116:117], v55 offset:8192
    ds_read_b64_tr_b16 a[118:119], v55 offset:8448
    s_mov_b32 s77, 24576
    s_call_b64 s[82:83], cf_dma
    ds_read_b64_tr_b16 a[120:121], v56 offset:0
    ds_read_b64_tr_b16 a[122:123], v56 offset:256
    ds_read_b64_tr_b16 a[124:125], v56 offset:8192
    ds_read_b64_tr_b16 a[126:127], v56 offset:8448
    s_mov_b32 s77, 32768
    s_call_b64 s[82:83], cf_dma
    s_waitcnt lgkmcnt(0)
    s_waitcnt vmcnt(8)
    v_add_u32 v55, 114688, v51
    v_xor_b32 v56, 32, v55
    ds_read_b64_tr_b16 a[16:17], v55 offset:0
    ds_read_b64_tr_b16 a[18:19], v55 offset:256
    ds_read_b64_tr_b16 a[20:21], v55 offset:8192
    ds_read_b64_tr_b16 a[22:23], v55 offset:8448
    s_xor_b32 s78, s75, 0
    s_lshr_b32 s78, s78, s72
    s_add_u32 s78, s78, s67
    s_mov_b64 s[8:9], s[52:53]
    s_add_u32 s80, s66, 0
    s_mov_b32 s76, 0
    s_mov_b32 s77, 8192
    s_call_b64 s[82:83], cf_dma
    ds_read_b64_tr_b16 a[24:25], v56 offset:0
    ds_read_b64_tr_b16 a[26:27], v56 offset:256
    ds_read_b64_tr_b16 a[28:29], v56 offset:8192
    ds_read_b64_tr_b16 a[30:31], v56 offset:8448
    s_mov_b32 s77, 16384
    s_call_b64 s[82:83], cf_dma
    s_waitcnt lgkmcnt(0)
    v_add_u32 v55, 131072, v51
    v_xor_b32 v56, 32, v55
    ds_read_b64_tr_b16 a[32:33], v55 offset:0
    ds_read_b64_tr_b16 a[34:35], v55 offset:256
    ds_read_b64_tr_b16 a[36:37], v55 offset:8192
    ds_read_b64_tr_b16 a[38:39], v55 offset:8448
    s_mov_b32 s77, 24576
    s_call_b64 s[82:83], cf_dma
    ds_read_b64_tr_b16 a[40:41], v56 offset:0
    ds_read_b64_tr_b16 a[42:43], v56 offset:256
    ds_read_b64_tr_b16 a[44:45], v56 offset:8192
    ds_read_b64_tr_b16 a[46:47], v56 offset:8448
    s_mov_b32 s77, 32768
    s_call_b64 s[82:83], cf_dma
    s_waitcnt lgkmcnt(0)
    s_waitcnt vmcnt(8)
    v_add_u32 v55, 65536, v51
    v_xor_b32 v56, 32, v55
    ds_read_b64_tr_b16 v[0:1], v55 offset:0
    ds_read_b64_tr_b16 v[2:3], v55 offset:256
    ds_read_b64_tr_b16 v[4:5], v55 offset:8192
    ds_read_b64_tr_b16 v[6:7], v55 offset:8448
    s_xor_b32 s78, s75, 1048576
    s_lshr_b32 s78, s78, s72
    s_add_u32 s78, s78, s67
    s_add_u32 s80, s66, 32768
    s_mov_b32 s76, 0
    s_mov_b32 s77, 8192
    s_call_b64 s[82:83], cf_dma
    ds_read_b64_tr_b16 v[8:9], v56 offset:0
    ds_read_b64_tr_b16 v[10:11], v56 offset:256
    ds_read_b64_tr_b16 v[12:13], v56 offset:8192
    ds_read_b64_tr_b16 v[14:15], v56 offset:8448
    s_mov_b32 s77, 16384
    s_call_b64 s[82:83], cf_dma
    s_waitcnt lgkmcnt(0)
    ds_write_b128 v62, v[0:3] offset:8192
    ds_write_b128 v62, v[4:7] offset:12288
    ds_write_b128 v62, v[8:11] offset:16384
    ds_write_b128 v62, v[12:15] offset:20480
    s_waitcnt lgkmcnt(0)
    v_add_u32 v55, 81920, v51
    v_xor_b32 v56, 32, v55
    ds_read_b64_tr_b16 a[0:1], v55 offset:0
    ds_read_b64_tr_b16 a[2:3], v55 offset:256
    ds_read_b64_tr_b16 a[4:5], v55 offset:8192
    ds_read_b64_tr_b16 a[6:7], v55 offset:8448
    s_mov_b32 s77, 24576
    s_call_b64 s[82:83], cf_dma
    ds_read_b64_tr_b16 a[8:9], v56 offset:0
    ds_read_b64_tr_b16 a[10:11], v56 offset:256
    ds_read_b64_tr_b16 a[12:13], v56 offset:8192
    ds_read_b64_tr_b16 a[14:15], v56 offset:8448
    s_mov_b32 s77, 32768
    s_call_b64 s[82:83], cf_dma
    s_waitcnt lgkmcnt(0)
    s_waitcnt vmcnt(8)
    v_add_u32 v55, 0, v51
    v_xor_b32 v56, 32, v55
    ds_read_b64_tr_b16 v[0:1], v55 offset:0
    ds_read_b64_tr_b16 v[2:3], v55 offset:256
    ds_read_b64_tr_b16 v[4:5], v55 offset:8192
    ds_read_b64_tr_b16 v[6:7], v55 offset:8448
    s_xor_b32 s94, s13, 0
    s_mul_i32 s94, s94, 36864
    s_add_u32 s94, s94, s92
    s_lshr_b32 s74, s13, 1
    s_lshl_b32 s74, s74, 6
    s_add_u32 s94, s94, s74
    s_add_u32 s78, s94, 1024
    s_mov_b64 s[8:9], s[56:57]
    v_mov_b32 v58, v50
    s_mov_b32 s79, 18432
    s_mov_b32 s81, 0
    s_add_u32 s80, s66, 147456
    s_mov_b32 s76, 0
    s_mov_b32 s77, 8192
    s_call_b64 s[82:83], cf_dma
    ds_read_b64_tr_b16 v[8:9], v56 offset:0
    ds_read_b64_tr_b16 v[10:11], v56 offset:256
    ds_read_b64_tr_b16 v[12:13], v56 offset:8192
    ds_read_b64_tr_b16 v[14:15], v56 offset:8448
    s_xor_b32 s94, s13, 2
    s_mul_i32 s94, s94, 36864
    s_add_u32 s94, s94, s92
    s_lshr_b32 s74, s13, 1
    s_lshl_b32 s74, s74, 6
    s_add_u32 s94, s94, s74
    s_add_u32 s78, s94, 1024
    s_mov_b32 s77, 16384
    s_call_b64 s[82:83], cf_dma
    s_waitcnt lgkmcnt(0)
    ds_write_b128 v61, v[0:3] offset:0
    ds_write_b128 v61, v[4:7] offset:4096
    ds_write_b128 v61, v[8:11] offset:8192
    ds_write_b128 v61, v[12:15] offset:12288
    s_waitcnt lgkmcnt(0)
    v_add_u32 v55, 16384, v51
    v_xor_b32 v56, 32, v55
    ds_read_b64_tr_b16 v[0:1], v55 offset:0
    ds_read_b64_tr_b16 v[2:3], v55 offset:256
    ds_read_b64_tr_b16 v[4:5], v55 offset:8192
    ds_read_b64_tr_b16 v[6:7], v55 offset:8448
    s_xor_b32 s94, s13, 3
    s_mul_i32 s94, s94, 36864
    s_add_u32 s94, s94, s92
    s_lshl_b32 s74, s13, 7
    s_add_u32 s94, s94, s74
    s_add_u32 s78, s94, 512
    v_mov_b32 v58, v49
    s_mov_b32 s79, 9216
    s_add_u32 s80, s66, 131072
    s_mov_b32 s76, 0
    s_mov_b32 s77, 8192
    s_call_b64 s[82:83], cf_dma
    ds_read_b64_tr_b16 v[8:9], v56 offset:0
    ds_read_b64_tr_b16 v[10:11], v56 offset:256
    ds_read_b64_tr_b16 v[12:13], v56 offset:8192
    ds_read_b64_tr_b16 v[14:15], v56 offset:8448
    s_mov_b32 s77, 16384
    s_call_b64 s[82:83], cf_dma
    s_waitcnt lgkmcnt(0)
    ds_write_b128 v61, v[0:3] offset:16384
    ds_write_b128 v61, v[4:7] offset:20480
    ds_write_b128 v61, v[8:11] offset:24576
    ds_write_b128 v61, v[12:15] offset:28672
    s_waitcnt lgkmcnt(0)
    s_waitcnt vmcnt(8)
    v_add_u32 v55, 32768, v51
    v_xor_b32 v56, 32, v55
    ds_read_b64_tr_b16 v[0:1], v55 offset:0
    ds_read_b64_tr_b16 v[2:3], v55 offset:256
    ds_read_b64_tr_b16 v[4:5], v55 offset:8192
    ds_read_b64_tr_b16 v[6:7], v55 offset:8448
    s_xor_b32 s94, s13, 2
    s_mul_i32 s94, s94, 36864
    s_add_u32 s94, s94, s92
    s_lshl_b32 s74, s13, 7
    s_add_u32 s94, s94, s74
    s_add_u32 s78, s94, 512
    s_add_u32 s80, s66, 114688
    s_mov_b32 s76, 0
    s_mov_b32 s77, 8192
    s_call_b64 s[82:83], cf_dma
    ds_read_b64_tr_b16 v[8:9], v56 offset:0
    ds_read_b64_tr_b16 v[10:11], v56 offset:256
    ds_read_b64_tr_b16 v[12:13], v56 offset:8192
    ds_read_b64_tr_b16 v[14:15], v56 offset:8448
    s_mov_b32 s77, 16384
    s_call_b64 s[82:83], cf_dma
    s_waitcnt lgkmcnt(0)
    ds_write_b128 v61, v[0:3] offset:32768
    ds_write_b128 v61, v[4:7] offset:36864
    ds_write_b128 v61, v[8:11] offset:40960
    ds_write_b128 v61, v[12:15] offset:45056
    s_waitcnt lgkmcnt(0)
    v_add_u32 v55, 49152, v51
    v_xor_b32 v56, 32, v55
    ds_read_b64_tr_b16 v[0:1], v55 offset:0
    ds_read_b64_tr_b16 v[2:3], v55 offset:256
    ds_read_b64_tr_b16 v[4:5], v55 offset:8192
    ds_read_b64_tr_b16 v[6:7], v55 offset:8448
    s_lshr_b32 s78, 4194304, s72
    s_add_u32 s78, s78, s67
    s_mov_b64 s[8:9], s[52:53]
    v_mov_b32 v58, v48
    s_lshr_b32 s79, 131072, s72
    s_add_u32 s80, s66, 81920
    s_mov_b32 s76, 0
    s_mov_b32 s77, 8192
    s_call_b64 s[82:83], cf_dma
    ds_read_b64_tr_b16 v[8:9], v56 offset:0
    ds_read_b64_tr_b16 v[10:11], v56 offset:256
    ds_read_b64_tr_b16 v[12:13], v56 offset:8192
    ds_read_b64_tr_b16 v[14:15], v56 offset:8448
    s_mov_b32 s77, 16384
    s_call_b64 s[82:83], cf_dma
    s_waitcnt lgkmcnt(0)
    ds_write_b128 v61, v[0:3] offset:49152
    ds_write_b128 v61, v[4:7] offset:53248
    ds_write_b128 v61, v[8:11] offset:57344
    ds_write_b128 v61, v[12:15] offset:61440
    s_waitcnt lgkmcnt(0)
    buffer_load_dword v24, off, s[96:99], 0 offset:140 sc1
    buffer_load_dword v25, off, s[96:99], 0 offset:64 sc1
    s_lshr_b32 s84, s12, 1
    s_lshl_b32 s84, s84, 8
    s_add_u32 s84, s84, 125829120
    v_bfe_u32 v26, v61, 4, 6
    v_min_u32 v26, 11, v26
    v_lshlrev_b32 v26, 2, v26
    buffer_load_dword v27, v26, s[4:7], s84 offen sc1
    s_waitcnt vmcnt(15)
    v_add_u32 v55, 147456, v53
    ds_read_b64_tr_b16 v[0:1], v55 offset:0
    ds_read_b64_tr_b16 v[2:3], v55 offset:128
    ds_read_b64_tr_b16 v[4:5], v55 offset:512
    ds_read_b64_tr_b16 v[6:7], v55 offset:640
    ds_read_b64_tr_b16 v[8:9], v55 offset:8192
    ds_read_b64_tr_b16 v[10:11], v55 offset:8320
    ds_read_b64_tr_b16 v[12:13], v55 offset:8704
    ds_read_b64_tr_b16 v[14:15], v55 offset:8832
    s_waitcnt lgkmcnt(0)
    s_barrier
    ds_write_b128 v63, v[0:3] offset:49152
    ds_write_b128 v63, v[4:7] offset:53248
    s_barrier
    ds_write_b128 v63, v[8:11] offset:57344
    ds_write_b128 v63, v[12:15] offset:61440
    s_waitcnt lgkmcnt(0)
    v_lshlrev_b32 v45, 3, v61
    s_lshl_b32 s40, s12, 14
    s_add_u32 s40, s40, 65536
    s_lshl_b32 s41, s12, 11
    s_sub_u32 s41, s41, 12288
    v_add_u32 v30, s40, v45
    v_add_u32 v45, s41, v45
    v_cmp_gt_u32 vcc, 1536, v61
    s_nop 1
    v_cndmask_b32 v45, v45, v30, vcc
    s_lshl_b32 s40, s12, 16
    s_add_u32 s40, s40, 25151488
    v_lshlrev_b32 v30, 3, v61
    v_add_u32 v30, s40, v30
    v_cmp_gt_u32 vcc, 1792, v61
    s_nop 1
    v_cndmask_b32 v45, v30, v45, vcc
    v_cmp_gt_u32 vcc, 2944, v61
    s_mov_b32 s40, 67108864
    s_mov_b64 exec, vcc
    buffer_load_dword v30, v45, s[4:7], s40 offen sc1
    s_mov_b64 exec, -1
    s_waitcnt vmcnt(11)
    v_add_u32 v55, 131072, v52
    ds_read_b64_tr_b16 v[0:1], v55 offset:0
    ds_read_b64_tr_b16 v[2:3], v55 offset:256
    ds_read_b64_tr_b16 v[4:5], v55 offset:4096
    ds_read_b64_tr_b16 v[6:7], v55 offset:4352
    ds_read_b64_tr_b16 v[8:9], v55 offset:64
    ds_read_b64_tr_b16 v[10:11], v55 offset:320
    ds_read_b64_tr_b16 v[12:13], v55 offset:4160
    ds_read_b64_tr_b16 v[14:15], v55 offset:4416
    s_waitcnt lgkmcnt(0)
    s_barrier
    ds_write_b128 v63, v[0:3] offset:32768
    ds_write_b128 v63, v[4:7] offset:36864
    s_barrier
    ds_write_b128 v63, v[8:11] offset:40960
    ds_write_b128 v63, v[12:15] offset:45056
    s_waitcnt lgkmcnt(0)
    s_waitcnt vmcnt(7)
    v_add_u32 v55, 114688, v52
    ds_read_b64_tr_b16 v[0:1], v55 offset:0
    ds_read_b64_tr_b16 v[2:3], v55 offset:256
    ds_read_b64_tr_b16 v[4:5], v55 offset:4096
    ds_read_b64_tr_b16 v[6:7], v55 offset:4352
    ds_read_b64_tr_b16 v[8:9], v55 offset:64
    ds_read_b64_tr_b16 v[10:11], v55 offset:320
    ds_read_b64_tr_b16 v[12:13], v55 offset:4160
    ds_read_b64_tr_b16 v[14:15], v55 offset:4416
    s_waitcnt lgkmcnt(0)
    s_barrier
    ds_write_b128 v63, v[0:3] offset:16384
    ds_write_b128 v63, v[4:7] offset:20480
    s_barrier
    ds_write_b128 v63, v[8:11] offset:24576
    ds_write_b128 v63, v[12:15] offset:28672
    s_waitcnt lgkmcnt(0)
    v_min_u32 v36, -2, v36
    v_min_u32 v37, -2, v37
    v_min_u32 v38, -2, v38
    v_min_u32 v39, -2, v39
    v_min_u32 v40, -2, v40
    v_min_u32 v41, -2, v41
    v_min_u32 v42, -2, v42
    v_min_u32 v43, -2, v43
    v_min_u32 v44, -2, v44
    s_lshl_b32 s14, s12, 16
    s_add_u32 s14, s14, 92274688
    s_add_u32 s41, s14, 4096
    s_add_u32 s42, s14, 8192
    v_lshrrev_b32 v45, 2, v61
    buffer_store_dwordx4 v[36:39], v61, s[4:7], s14 offen
    buffer_store_dwordx4 v[40:43], v61, s[4:7], s41 offen
    buffer_store_dword v44, v45, s[4:7], s42 offen
    s_waitcnt vmcnt(1)
    v_readfirstlane_b32 s95, v25
    v_readfirstlane_b32 s85, v24
    s_add_u32 s86, s95, 2
    s_waitcnt vmcnt(0)
    v_subrev_u32 v27, s86, v27
    v_cmp_lt_u32 s[86:87], 64, v27
    s_cmp_eq_u32 s95, 0
    s_cselect_b64 s[86:87], -1, s[86:87]
    s_cmp_lg_u64 s[86:87], 0
    s_cbranch_scc1 cf_nt
    s_add_u32 s40, s24, 524288
    buffer_load_dword v30, v79, s[4:7], s24 offen sc1
    buffer_load_dword v30, v79, s[4:7], s40 offen sc1
cf_nt:
    s_waitcnt vmcnt(3)
    v_add_u32 v55, 81920, v51
    v_xor_b32 v56, 32, v55
    ds_read_b64_tr_b16 v[0:1], v55 offset:0
    ds_read_b64_tr_b16 v[2:3], v55 offset:256
    ds_read_b64_tr_b16 v[4:5], v55 offset:8192
    ds_read_b64_tr_b16 v[6:7], v55 offset:8448
    ds_read_b64_tr_b16 v[8:9], v56 offset:0
    ds_read_b64_tr_b16 v[10:11], v56 offset:256
    ds_read_b64_tr_b16 v[12:13], v56 offset:8192
    ds_read_b64_tr_b16 v[14:15], v56 offset:8448
    s_waitcnt lgkmcnt(0)
    ds_write_b128 v62, v[0:3] offset:24576
    ds_write_b128 v62, v[4:7] offset:28672
    ds_write_b128 v62, v[8:11] offset:32768
    ds_write_b128 v62, v[12:15] offset:36864
    s_waitcnt lgkmcnt(0)
    s_barrier
    s_mov_b32 s88, 4194304
gn2:
    s_cmp_lg_u32 s95, 0
    s_cbranch_scc1 gn2x
    buffer_load_dword v27, off, s[96:99], 0 offset:64 sc1
    s_sub_u32 s88, s88, 1
    s_cbranch_scc1 gn2x
    s_waitcnt vmcnt(0)
    v_readfirstlane_b32 s95, v27
    s_nop 1
    s_branch gn2
gn2x:
    ds_write_b128 v78, v[16:19] offset:8704
    ds_write_b128 v65, v[20:23] offset:10240
    v_mov_b32 v44, s95
    v_mov_b32 v45, s95
    v_mov_b32 v46, s95
    v_mov_b32 v47, s95
    v_mov_b32 v48, 108288
    ds_write_b128 v48, v[44:47]
    s_waitcnt vmcnt(0) lgkmcnt(0)
    s_cmp_eq_u32 s85, 1
    s_cbranch_scc1 cf_run
    s_mov_b32 s40, 131072
cf_startpoll:
    buffer_load_dword v3, off, s[96:99], 0 offset:140 sc1
    s_waitcnt vmcnt(0)
    v_readfirstlane_b32 s85, v3
    s_nop 0
    s_cmp_eq_u32 s85, 1
    s_cbranch_scc1 cf_run
    s_cmp_eq_u32 s85, 2
    s_cbranch_scc1 cf_leave
    s_sleep 1
    s_sub_u32 s40, s40, 1
    s_cbranch_scc0 cf_startpoll
    v_mov_b32 v4, 2
    v_mov_b32 v5, 0
    s_mov_b64 exec, 1
    buffer_atomic_cmpswap v[4:5], off, s[96:99], 0 offset:140
    s_mov_b64 exec, -1
    s_mov_b32 s40, 1048576
    s_branch cf_startpoll
cf_leave:
    v_lshrrev_b32 v0, 4, v61
    s_mov_b32 s32, s13
    s_load_dwordx16 s[48:63], s[0:1], 0
    s_waitcnt lgkmcnt(0)
    s_branch L_helper
cf_run:
    s_cmp_eq_u64 s[86:87], 0
    s_cbranch_scc1 cf_kvok
    s_lshr_b32 s92, s12, 1
    s_lshl_b32 s92, s92, 8
    s_add_u32 s92, s92, 125829120
    v_bfe_u32 v2, v61, 4, 6
    v_min_u32 v2, 11, v2
    v_lshlrev_b32 v2, 2, v2
    s_add_u32 s93, s95, 2
    s_mov_b32 s94, 4194304
cf_kv0:
    buffer_load_dword v3, v2, s[4:7], s92 offen sc1
    s_sub_u32 s94, s94, 1
    s_cbranch_scc1 cf_kv0_go
    s_waitcnt vmcnt(0)
    v_subrev_u32 v3, s93, v3
    v_cmp_lt_u32 vcc, 64, v3
    s_cbranch_vccz cf_kv0_go
    s_sleep 2
    s_branch cf_kv0
cf_kv0_go:
    s_add_u32 s40, s24, 524288
    buffer_load_dword v30, v79, s[4:7], s24 offen sc1
    buffer_load_dword v30, v79, s[4:7], s40 offen sc1
    s_waitcnt vmcnt(0)
cf_kvok:
    s_mov_b32 m0, 108032
    s_add_u32 s24, s24, 1048576
    s_mov_b32 s66, 0x201
    s_mov_b32 s67, 0xc0000000
    s_add_u32 s15, s14, 4096
    s_add_u32 s16, s14, 8192
    ds_read_b128 v[32:35], v62 offset:16384
    ds_read_b128 v[36:39], v62 offset:20480
    ds_read_b128 v[40:43], v61 offset:0
    ds_read_b128 v[44:47], v61 offset:4096
    ds_read_b128 v[48:51], v61 offset:8192
    ds_read_b128 v[52:55], v61 offset:12288
    s_add_u32 s18, s14, s31
    s_mov_b32 s29, 1048576
    buffer_load_dwordx4 v[24:27], v61, s[4:7], s14 offen nt
.p2align 6
cf_loop:
    v_mov_b64 v[0:1], 0
    v_mov_b64 v[2:3], 0
    v_mov_b64 v[4:5], 0
    v_mov_b64 v[6:7], 0
    v_mov_b64 v[8:9], 0
    v_mov_b64 v[10:11], 0
    v_mov_b64 v[12:13], 0
    v_mov_b64 v[14:15], 0
cf_loop2:
    ds_read_b128 v[16:19], v62 offset:8192
    ds_read_b128 v[20:23], v62 offset:12288
    v_lshrrev_b32 v56, 2, v61
    v_add_u32 v58, 106496, v56
    s_mov_b32 s29, 1048576
    s_nop 13
    buffer_load_dwordx4 v[24:27], v61, s[4:7], s14 offen nt
    s_waitcnt lgkmcnt(0)
cf_chk0:
    s_waitcnt vmcnt(1)
cf_chk0b:
    v_max3_u32 v57, v24, v25, v26
    v_max_u32 v57, v57, v27
    v_cmp_eq_u32 vcc, -1, v57
    ds_write_b128 v62, v[24:27] offset:40960
    s_cbranch_vccnz cf_spin0
    v_smfmac_f32_16x16x64_bf16 v[0:3], v[24:27], v[16:23], v60
    s_mov_b32 m0, s58
    s_nop 0
    buffer_load_dwordx4 v61, s[4:7], s15 offen nt lds
    v_smfmac_f32_16x16x64_bf16 v[8:11], v[24:27], v[32:39], v60
    s_mov_b32 m0, s59
    s_nop 0
    buffer_load_dword v56, s[4:7], s16 offen nt lds
    v_smfmac_f32_16x16x64_bf16 v[12:15], v[24:27], v[48:55], v60
    ds_read_b128 v[32:35], v61 offset:16384
    v_mfma_f32_16x16x16_bf16 v[16:19], v[72:73], v[72:73], 0
    ds_read_b128 v[36:39], v61 offset:20480
    s_waitcnt lgkmcnt(2)
    s_barrier
    ds_read_b128 v[48:51], v63 offset:0
    v_mfma_f32_16x16x16_bf16 v[20:23], v[72:73], v[72:73], 0
    ds_read_b128 v[52:55], v64 offset:0
    v_smfmac_f32_16x16x64_bf16 v[4:7], v[24:27], v[40:47], v60
    ds_read_b128 v[40:43], v61 offset:24576
    v_smfmac_f32_16x16x64_bf16 v[16:19], v[24:27], a[192:199], v60
    ds_read_b128 v[44:47], v61 offset:28672
    v_smfmac_f32_16x16x64_bf16 v[20:23], v[24:27], a[200:207], v60
    s_mov_b32 m0, 108032
    s_waitcnt lgkmcnt(3)
    v_smfmac_f32_16x16x64_bf16 v[0:3], v[48:51], a[0:7], v60
    s_add_u32 s43, s14, s31
    s_add_u32 s41, s14, 16384
    v_smfmac_f32_16x16x64_bf16 v[4:7], v[48:51], v[32:39], v60
    ds_read_b128 v[32:35], v61 offset:32768
    v_smfmac_f32_16x16x64_bf16 v[8:11], v[48:51], a[8:15], v60
    ds_read_b128 v[36:39], v61 offset:36864
    s_waitcnt lgkmcnt(2)
    v_smfmac_f32_16x16x64_bf16 v[12:15], v[48:51], v[40:47], v60
    ds_read_b128 v[40:43], v61 offset:40960
    v_smfmac_f32_16x16x64_bf16 v[16:19], v[48:51], a[208:215], v60
    ds_read_b128 v[44:47], v61 offset:45056
    v_smfmac_f32_16x16x64_bf16 v[20:23], v[48:51], a[216:223], v60
    ds_read_b128 v[48:51], v71 offset:0
    v_smfmac_f32_16x16x64_bf16 v[0:3], v[52:55], a[16:23], v60
    s_waitcnt vmcnt(0)
    ds_read_b128 v[28:31], v62 offset:45056
    s_waitcnt lgkmcnt(4)
    v_smfmac_f32_16x16x64_bf16 v[4:7], v[52:55], v[32:39], v60
    ds_read_b32 v59, v58
    buffer_load_dwordx4 v[24:27], v61, s[4:7], s23 offen offset:0 sc1
    v_smfmac_f32_16x16x64_bf16 v[8:11], v[52:55], a[24:31], v60
    ds_read_b128 v[32:35], v61 offset:49152
    s_waitcnt lgkmcnt(4)
    v_smfmac_f32_16x16x64_bf16 v[12:15], v[52:55], v[40:47], v60
    ds_read_b128 v[36:39], v61 offset:53248
    v_smfmac_f32_16x16x64_bf16 v[16:19], v[52:55], a[224:231], v60
    ds_read_b128 v[40:43], v61 offset:57344
    v_smfmac_f32_16x16x64_bf16 v[20:23], v[52:55], a[232:239], v60
    ds_read_b128 v[44:47], v61 offset:61440
    s_waitcnt lgkmcnt(4)
    v_smfmac_f32_16x16x64_bf16 v[0:3], v[48:51], a[32:39], v60
    v_max3_u32 v57, v28, v29, v30
    v_smfmac_f32_16x16x64_bf16 v[8:11], v[48:51], a[40:47], v60
    v_max3_u32 v57, v57, v31, v59
    s_waitcnt lgkmcnt(2)
    v_smfmac_f32_16x16x64_bf16 v[4:7], v[48:51], v[32:39], v60
    buffer_load_dwordx4 v[32:35], v61, s[4:7], s23 offen offset:1024 sc1
    v_cmp_eq_u32 vcc, -1, v57
    v_smfmac_f32_16x16x64_bf16 v[16:19], v[48:51], a[240:247], v60
    v_smfmac_f32_16x16x64_bf16 v[20:23], v[48:51], a[248:255], v60
    s_cbranch_vccnz cf_spin1
cf_go1:
    s_barrier
    ds_read_b128 v[52:55], v63 offset:4096
    s_waitcnt lgkmcnt(1)
    v_smfmac_f32_16x16x64_bf16 v[12:15], v[48:51], v[40:47], v60
    ds_read_b128 v[48:51], v64 offset:4096
    v_smfmac_f32_16x16x64_bf16 v[0:3], v[28:31], a[48:55], v60
    buffer_load_dwordx4 v[40:43], v61, s[4:7], s23 offen offset:2048 sc1
    v_smfmac_f32_16x16x64_bf16 v[8:11], v[28:31], a[56:63], v60
    ds_read_b128 v[56:59], v71 offset:4096
    s_and_b32 s41, s41, 65535
    v_smfmac_f32_16x16x64_bf16 v[4:7], v[28:31], a[128:135], v60
    ds_read_b128 v[36:39], v65 offset:8192
    s_add_u32 s41, s41, 67108864
    v_smfmac_f32_16x16x64_bf16 v[12:15], v[28:31], a[136:143], v60
    s_add_u32 s17, s41, s31
    s_and_b32 s30, s28, 1
    s_waitcnt lgkmcnt(3)
    v_smfmac_f32_16x16x64_bf16 v[0:3], v[52:55], a[64:71], v60
    buffer_load_dwordx4 v[44:47], v61, s[4:7], s23 offen offset:3072 sc1
    v_smfmac_f32_16x16x64_bf16 v[4:7], v[52:55], a[144:151], v60
    ds_read_b128 v[28:31], v78 offset:8704
    v_smfmac_f32_16x16x64_bf16 v[8:11], v[52:55], a[72:79], v60
    v_smfmac_f32_16x16x64_bf16 v[12:15], v[52:55], a[152:159], v60
    ds_read_b128 v[52:55], v62 offset:28672
    s_waitcnt lgkmcnt(4)
    v_smfmac_f32_16x16x64_bf16 v[0:3], v[48:51], a[80:87], v60
    v_smfmac_f32_16x16x64_bf16 v[4:7], v[48:51], a[160:167], v60
    v_smfmac_f32_16x16x64_bf16 v[8:11], v[48:51], a[88:95], v60
    buffer_load_dword v79, s[4:7], s24 offen sc1 lds
    v_smfmac_f32_16x16x64_bf16 v[12:15], v[48:51], a[168:175], v60
    v_smfmac_f32_16x16x64_bf16 v[16:19], v[48:51], v[112:119], v60
    v_smfmac_f32_16x16x64_bf16 v[20:23], v[48:51], v[120:127], v60
    ds_read_b128 v[48:51], v62 offset:24576
    s_waitcnt lgkmcnt(4)
    v_smfmac_f32_16x16x64_bf16 v[0:3], v[56:59], a[96:103], v60
    s_bitcmp1_b64 s[66:67], s28
    v_smfmac_f32_16x16x64_bf16 v[8:11], v[56:59], a[104:111], v60
    s_waitcnt lgkmcnt(3)
    v_smfmac_f32_16x16x64_bf16 v[0:3], v[36:39], a[112:119], v60
    v_smfmac_f32_16x16x64_bf16 v[8:11], v[36:39], a[120:127], v60
    v_smfmac_f32_16x16x64_bf16 v[4:7], v[56:59], a[176:183], v60
    s_waitcnt lgkmcnt(0)
    v_cvt_pk_bf16_f32 v0, v0, v1
    v_smfmac_f32_16x16x64_bf16 v[4:7], v[36:39], v[48:55], v60
    ds_read_b128 v[48:51], v62 offset:32768
    v_cvt_pk_bf16_f32 v8, v8, v9
    v_smfmac_f32_16x16x64_bf16 v[12:15], v[56:59], a[184:191], v60
    ds_read_b128 v[52:55], v62 offset:36864
    v_cvt_pk_bf16_f32 v9, v10, v11
    v_smfmac_f32_16x16x64_bf16 v[16:19], v[56:59], v[128:135], v60
    v_cvt_pk_bf16_f32 v1, v2, v3
    v_mfma_f32_16x16x16_bf16 v[8:11], v[8:9], v[28:29], 0
    v_cvt_pk_bf16_f32 v2, v4, v5
    v_cvt_pk_bf16_f32 v3, v6, v7
    v_smfmac_f32_16x16x64_bf16 v[20:23], v[56:59], v[136:143], v60
    s_mov_b64 exec, s[36:37]
    ds_read_b128 v[56:59], v69
    s_mov_b64 exec, -1
    v_mfma_f32_16x16x32_bf16 v[4:7], v[0:3], v[28:31], 0
    v_cvt_pk_bf16_f32 v2, v8, v9
    s_waitcnt lgkmcnt(1)
    v_smfmac_f32_16x16x64_bf16 v[12:15], v[36:39], v[48:55], v60
    ds_read_b128 v[48:51], v63 offset:4096
    v_cvt_pk_bf16_f32 v3, v10, v11
    s_waitcnt vmcnt(3)
    v_cvt_pk_bf16_f32 v0, v4, v5
    v_cvt_pk_bf16_f32 v1, v6, v7
    s_nop 1
    v_mfma_f32_16x16x32_bf16 v[4:7], v[32:35], v[0:3], 0
    v_cvt_pk_bf16_f32 v12, v12, v13
    v_cvt_pk_bf16_f32 v13, v14, v15
    s_nop 1
    v_mfma_f32_16x16x16_bf16 v[12:15], v[12:13], v[30:31], 0
    ds_read_b128 v[52:55], v62 offset:45056
    ds_read_b128 v[32:35], v63 offset:49152
    v_mfma_f32_16x16x32_bf16 v[28:31], v[24:27], v[0:3], 0
    s_waitcnt vmcnt(1)
    s_mov_b64 exec, s[34:35]
    s_nop 1
    v_cvt_pk_bf16_f32 v2, v12, v13
    v_cvt_pk_bf16_f32 v3, v14, v15
    s_mov_b64 exec, -1
    s_nop 0
    v_mfma_f32_16x16x32_bf16 v[8:11], v[0:3], v[0:3], 0
    v_mov_b32_dpp v28, v4 row_ror:8 row_mask:0xf bank_mask:0xc
    v_mov_b32_dpp v29, v5 row_ror:8 row_mask:0xf bank_mask:0xc
    v_mov_b32_dpp v30, v6 row_ror:8 row_mask:0xf bank_mask:0xc
    v_mov_b32_dpp v31, v7 row_ror:8 row_mask:0xf bank_mask:0xc
    v_smfmac_f32_16x16x64_bf16 v[16:19], v[36:39], v[144:151], v60
    ds_write_b128 v62, v[28:31] offset:53248
    v_mov_b32_dpp v8, v10 row_ror:8 row_mask:0xf bank_mask:0xc
    v_mov_b32_dpp v9, v11 row_ror:8 row_mask:0xf bank_mask:0xc
    v_smfmac_f32_16x16x64_bf16 v[20:23], v[36:39], v[152:159], v60
    ds_write_b64 v70, v[8:9]
    s_waitcnt lgkmcnt(4)
    v_smfmac_f32_16x16x64_bf16 v[16:19], v[48:51], v[96:103], v60
    s_mov_b64 exec, s[36:37]
    buffer_store_dwordx4 v[56:59], v61, s[4:7], s65 offen sc1
    s_mov_b64 exec, -1
    v_smfmac_f32_16x16x64_bf16 v[20:23], v[48:51], v[104:111], v60
    s_cbranch_scc1 cf_last
cf_back:
    s_waitcnt lgkmcnt(0)
    s_barrier
    ds_read_b128 v[56:59], v78 offset:10752
    v_smfmac_f32_16x16x64_bf16 v[16:19], v[52:55], v[80:87], v60
    ds_read_b128 v[12:15], v78 offset:11264
    ds_read_b128 v[4:7], v63 offset:12288
    v_smfmac_f32_16x16x64_bf16 v[20:23], v[52:55], v[88:95], v60
    ds_read_b128 v[8:11], v64 offset:12288
    ds_read_b128 v[0:3], v71 offset:12288
    v_mov_b64 v[24:25], s[62:63]
    v_mov_b64 v[26:27], s[60:61]
    v_cvt_pk_bf16_f32 v16, v16, v17
    v_cvt_pk_bf16_f32 v17, v18, v19
    v_pk_mul_f32 v[28:29], v[28:29], s[44:45]
    v_pk_mul_f32 v[30:31], v[30:31], s[44:45]
    s_waitcnt lgkmcnt(3)
    v_pk_add_f32 v[56:57], v[56:57], v[58:59]
    v_pk_add_f32 v[12:13], v[12:13], v[14:15]
    v_pk_add_f32 v[56:57], v[56:57], v[12:13]
    v_pk_mul_f32 v[56:57], v[56:57], s[44:45]
    v_exp_f32 v58, v56
    v_exp_f32 v59, v57
    s_waitcnt lgkmcnt(1)
    v_pk_fma_f32 v[28:29], v[4:5], s[44:45], v[28:29]
    v_pk_fma_f32 v[30:31], v[6:7], s[44:45], v[30:31]
    v_cvt_pk_bf16_f32 v6, v58, v59
    v_pk_fma_f32 v[28:29], v[8:9], s[44:45], v[28:29]
    v_pk_fma_f32 v[30:31], v[10:11], s[44:45], v[30:31]
    s_waitcnt lgkmcnt(0)
    v_pk_fma_f32 v[28:29], v[0:1], s[44:45], v[28:29]
    v_mov_b32_dpp v7, v6 row_ror:8 row_mask:0xf bank_mask:0xf
    v_pk_fma_f32 v[30:31], v[2:3], s[44:45], v[30:31]
    v_exp_f32 v0, v28
    v_mfma_f32_16x16x16_bf16 v[12:15], v[16:17], v[6:7], 0
    ds_read_b128 v[48:51], v63 offset:57344
    v_exp_f32 v1, v29
    v_cvt_pk_bf16_f32 v18, v20, v21
    v_exp_f32 v2, v30
    v_cvt_pk_bf16_f32 v19, v22, v23
    v_cvt_pk_bf16_f32 v8, v0, v1
    v_exp_f32 v3, v31
    v_mfma_f32_16x16x16_bf16 v[20:23], v[18:19], v[6:7], 0
    ds_read_b128 v[52:55], v63 offset:61440
    v_cvt_pk_bf16_f32 v9, v2, v3
    v_mov_b32_dpp v10, v8 row_ror:8 row_mask:0xf bank_mask:0xf
    v_max3_f32 v4, |v28|, |v29|, |v30|
    v_mov_b32_dpp v11, v9 row_ror:8 row_mask:0xf bank_mask:0xf
    v_mfma_f32_16x16x32_bf16 v[0:3], v[24:27], v[6:9], 0
    ds_read_b128 v[36:39], v63 offset:53248
    v_max3_f32 v4, v4, |v31|, |v56|
    v_max_f32_e64 v4, v4, |v57|
    v_mfma_f32_16x16x32_bf16 v[12:15], v[40:43], v[8:11], v[12:15]
    v_cmp_nge_f32 vcc, s46, v4
    v_mfma_f32_16x16x32_bf16 v[20:23], v[44:47], v[8:11], v[20:23]
    v_add_f32_dpp v0, v0, v0 row_ror:8 row_mask:0xf bank_mask:0xf
    v_rcp_f32 v0, v0
    s_cbranch_vccnz cf_guard
cf_norm:
    v_mfma_f32_16x16x16_bf16 v[28:31], v[72:73], v[72:73], 0
    v_mul_f32 v12, v12, v0
    v_mul_f32 v13, v13, v0
    v_mul_f32 v14, v14, v0
    v_mul_f32 v15, v15, v0
    v_mul_f32_dpp v12, v20, v0 row_ror:8 row_mask:0xf bank_mask:0xc
    v_mul_f32_dpp v13, v21, v0 row_ror:8 row_mask:0xf bank_mask:0xc
    v_mul_f32_dpp v14, v22, v0 row_ror:8 row_mask:0xf bank_mask:0xc
    v_mul_f32_dpp v15, v23, v0 row_ror:8 row_mask:0xf bank_mask:0xc
    v_cvt_pk_bf16_f32 v12, v12, v13
    v_cvt_pk_bf16_f32 v13, v14, v15
    v_mfma_f32_16x16x16_bf16 v[8:11], v[72:73], v[72:73], 0
    ds_write_b64 v77, v[12:13]
    v_mfma_f32_16x16x16_bf16 v[4:7], v[72:73], v[72:73], 0
    ds_read_b128 v[0:3], v68
    v_mfma_f32_16x16x16_bf16 v[16:19], v[72:73], v[72:73], 0
    ds_read_b128 v[40:43], v63 offset:16384
    v_mfma_f32_16x16x16_bf16 v[20:23], v[72:73], v[72:73], 0
    ds_read_b128 v[44:47], v63 offset:20480
    s_waitcnt lgkmcnt(3)
    s_barrier
    ds_read_b128 v[24:27], v74
    ds_read_b128 v[12:15], v75
    ds_read_b128 v[56:59], v76
    s_waitcnt lgkmcnt(5)
    v_smfmac_f32_16x16x64_bf16 v[28:31], v[0:3], v[160:167], v60
    v_smfmac_f32_16x16x64_bf16 v[8:11], v[0:3], v[192:199], v60
    v_smfmac_f32_16x16x64_bf16 v[4:7], v[0:3], v[32:39], v60
    ds_read_b128 v[32:35], v63 offset:32768
    v_smfmac_f32_16x16x64_bf16 v[16:19], v[0:3], v[224:231], v60
    ds_read_b128 v[36:39], v63 offset:36864
    s_waitcnt lgkmcnt(3)
    v_smfmac_f32_16x16x64_bf16 v[28:31], v[24:27], v[168:175], v60
    v_smfmac_f32_16x16x64_bf16 v[4:7], v[12:15], v[48:55], v60
    ds_read_b128 v[48:51], v63 offset:24576
    v_smfmac_f32_16x16x64_bf16 v[28:31], v[12:15], v[176:183], v60
    ds_read_b128 v[52:55], v63 offset:28672
    s_waitcnt lgkmcnt(4)
    v_smfmac_f32_16x16x64_bf16 v[28:31], v[56:59], v[184:191], v60
    v_cvt_pk_bf16_f32 v4, v4, v5
    v_smfmac_f32_16x16x64_bf16 v[16:19], v[12:15], v[40:47], v60
    ds_read_b128 v[40:43], v63 offset:40960
    v_and_or_b32 v4, v4, -2, s30
    v_smfmac_f32_16x16x64_bf16 v[8:11], v[24:27], v[200:207], v60
    ds_read_b128 v[44:47], v63 offset:45056
    v_cvt_pk_bf16_f32 v5, v6, v7
    v_smfmac_f32_16x16x64_bf16 v[8:11], v[12:15], v[208:215], v60
    buffer_store_dwordx2 v[4:5], v67, s[4:7], s22 offen
    v_cvt_pk_bf16_f32 v28, v28, v29
    v_smfmac_f32_16x16x64_bf16 v[8:11], v[56:59], v[216:223], v60
    v_and_or_b32 v28, v28, -2, s30
    v_smfmac_f32_16x16x64_bf16 v[16:19], v[24:27], v[232:239], v60
    v_cvt_pk_bf16_f32 v29, v30, v31
    s_waitcnt lgkmcnt(4)
    v_smfmac_f32_16x16x64_bf16 v[16:19], v[56:59], v[32:39], v60
    buffer_store_dwordx2 v[28:29], v66, s[4:7], s20 offen
    v_cvt_pk_bf16_f32 v8, v8, v9
    s_waitcnt lgkmcnt(0)
    v_smfmac_f32_16x16x64_bf16 v[20:23], v[0:3], v[240:247], v60
    v_and_or_b32 v8, v8, -2, s30
    v_smfmac_f32_16x16x64_bf16 v[20:23], v[24:27], v[248:255], v60
    v_cvt_pk_bf16_f32 v9, v10, v11
    v_smfmac_f32_16x16x64_bf16 v[20:23], v[12:15], v[48:55], v60
    buffer_store_dwordx2 v[8:9], v66, s[4:7], s21 offen
    v_cvt_pk_bf16_f32 v16, v16, v17
    v_smfmac_f32_16x16x64_bf16 v[20:23], v[56:59], v[40:47], v60
    v_and_or_b32 v16, v16, -2, s30
    v_cvt_pk_bf16_f32 v17, v18, v19
    buffer_store_dwordx2 v[16:17], v66, s[4:7], s38 offen
    s_cmp_lg_u32 s13, 2
    s_nop 1
    v_cvt_pk_bf16_f32 v20, v20, v21
    v_and_or_b32 v20, v20, -2, s30
    v_cvt_pk_bf16_f32 v21, v22, v23
    buffer_store_dwordx2 v[20:21], v66, s[4:7], s39 offen
    s_cbranch_scc1 cf_w013
    v_mov_b32 v21, -1
    s_mov_b64 exec, s[32:33]
    buffer_store_dword v21, v69, s[4:7], s18 offen
    s_mov_b64 exec, -1
    s_mov_b32 s18, s43
    s_nop 15
    s_nop 15
    s_nop 15
    s_nop 14
    buffer_load_dwordx4 v[40:43], v65, s[4:7], s19 offen offset:0 nt
    buffer_load_dwordx4 v[44:47], v65, s[4:7], s19 offen offset:1024 nt
    buffer_load_dwordx4 v[48:51], v65, s[4:7], s19 offen offset:2048 nt
    buffer_load_dwordx4 v[52:55], v65, s[4:7], s19 offen offset:3072 nt
    ds_read_b128 v[56:59], v65 offset:10240
    s_add_u32 s28, s28, 1
    s_mov_b32 s14, s41
    s_add_u32 s23, s23, 524288
    s_add_u32 s24, s24, 524288
    s_min_u32 s24, s24, s47
    s_add_u32 s15, s14, 4096
    s_add_u32 s16, s14, 8192
    s_add_u32 s65, s65, 12288
    s_mov_b32 s40, 1
    v_mov_b64 v[0:1], 0
    v_mov_b64 v[2:3], 0
    v_mov_b64 v[4:5], 0
    v_mov_b64 v[6:7], 0
    v_mov_b64 v[8:9], 0
    v_mov_b64 v[10:11], 0
    v_mov_b64 v[12:13], 0
    v_mov_b64 v[14:15], 0
cf_chkF:
    v_mov_b32 v20, 0
    s_waitcnt vmcnt(3)
    s_waitcnt lgkmcnt(0)
    v_mfma_f32_16x16x32_bf16 v[28:31], v[40:43], v[56:59], 0
    v_bitop3_b32 v20, v20, v40, s30 bitop3:0xf6
    v_bitop3_b32 v20, v20, v42, s30 bitop3:0xf6
    s_waitcnt vmcnt(2)
    v_mfma_f32_16x16x32_bf16 v[28:31], v[44:47], v[56:59], v[28:31]
    v_bitop3_b32 v20, v20, v44, s30 bitop3:0xf6
    v_bitop3_b32 v20, v20, v46, s30 bitop3:0xf6
    s_waitcnt vmcnt(1)
    v_mfma_f32_16x16x32_bf16 v[28:31], v[48:51], v[56:59], v[28:31]
    v_bitop3_b32 v20, v20, v48, s30 bitop3:0xf6
    v_bitop3_b32 v20, v20, v50, s30 bitop3:0xf6
    s_waitcnt vmcnt(0)
    v_mfma_f32_16x16x32_bf16 v[28:31], v[52:55], v[56:59], v[28:31]
    v_bitop3_b32 v20, v20, v52, s30 bitop3:0xf6
    v_bitop3_b32 v20, v20, v54, s30 bitop3:0xf6
    v_and_b32 v20, s40, v20
    v_cmp_ne_u32 vcc, 0, v20
    s_cbranch_vccnz cf_spinF
    v_permlane32_swap_b32 v28, v30
    v_permlane32_swap_b32 v29, v31
    v_add_f32 v28, v28, v30
    v_add_f32 v30, v29, v31
    v_cvt_pk_bf16_f32 v28, v28, v30
    s_mov_b64 exec, s[32:33]
    buffer_store_dword v28, v69, s[4:7], s17 offen
    s_mov_b64 exec, -1
    ds_read_b128 v[32:35], v62 offset:16384
    ds_read_b128 v[36:39], v62 offset:20480
    ds_read_b128 v[40:43], v61 offset:0
    ds_read_b128 v[44:47], v61 offset:4096
    ds_read_b128 v[48:51], v61 offset:8192
    ds_read_b128 v[52:55], v61 offset:12288
    s_nop 15
    s_nop 1
    buffer_load_dwordx4 v[24:27], v61, s[4:7], s14 offen nt
    s_branch cf_loop2
cf_w013:
    ds_read_b128 v[56:59], v65 offset:10240
    ds_read_b128 v[32:35], v62 offset:16384
    ds_read_b128 v[36:39], v62 offset:20480
    ds_read_b128 v[40:43], v61 offset:0
    ds_read_b128 v[44:47], v61 offset:4096
    ds_read_b128 v[48:51], v61 offset:8192
    ds_read_b128 v[52:55], v61 offset:12288
    s_add_u32 s28, s28, 1
    s_mov_b32 s14, s41
    s_add_u32 s23, s23, 524288
    s_add_u32 s24, s24, 524288
    s_min_u32 s24, s24, s47
    s_add_u32 s15, s14, 4096
    s_add_u32 s16, s14, 8192
    s_add_u32 s65, s65, 12288
    s_mov_b32 s40, 1
    s_cmp_eq_u32 s64, 0
    s_cbranch_scc1 cf_w0
    v_mov_b32 v21, -1
    s_mov_b64 exec, s[32:33]
    buffer_store_dword v21, v69, s[4:7], s18 offen
    s_mov_b64 exec, -1
    s_mov_b32 s18, s43
    s_cmp_eq_u32 s13, 1
    s_nop 15
    s_nop 15
    s_nop 1
    s_cbranch_scc1 cf_sx
    s_nop 15
    s_nop 11
cf_sx:
    buffer_load_dwordx4 v[0:3], v65, s[4:7], s19 offen offset:0 nt
    buffer_load_dwordx4 v[4:7], v65, s[4:7], s19 offen offset:1024 nt
    buffer_load_dwordx4 v[8:11], v65, s[4:7], s19 offen offset:2048 nt
    buffer_load_dwordx4 v[12:15], v65, s[4:7], s19 offen offset:3072 nt
cf_chkG:
    v_mov_b32 v20, 0
    s_waitcnt vmcnt(3)
    s_waitcnt lgkmcnt(6)
    v_mfma_f32_16x16x32_bf16 v[28:31], v[0:3], v[56:59], 0
    v_bitop3_b32 v20, v20, v0, s30 bitop3:0xf6
    v_bitop3_b32 v20, v20, v2, s30 bitop3:0xf6
    s_waitcnt vmcnt(2)
    v_mfma_f32_16x16x32_bf16 v[28:31], v[4:7], v[56:59], v[28:31]
    v_bitop3_b32 v20, v20, v4, s30 bitop3:0xf6
    v_bitop3_b32 v20, v20, v6, s30 bitop3:0xf6
    s_waitcnt vmcnt(1)
    v_mfma_f32_16x16x32_bf16 v[28:31], v[8:11], v[56:59], v[28:31]
    v_bitop3_b32 v20, v20, v8, s30 bitop3:0xf6
    v_bitop3_b32 v20, v20, v10, s30 bitop3:0xf6
    s_waitcnt vmcnt(0)
    v_mfma_f32_16x16x32_bf16 v[28:31], v[12:15], v[56:59], v[28:31]
    v_bitop3_b32 v20, v20, v12, s30 bitop3:0xf6
    v_bitop3_b32 v20, v20, v14, s30 bitop3:0xf6
    v_and_b32 v20, s40, v20
    v_cmp_ne_u32 vcc, 0, v20
    s_cbranch_vccnz cf_spinG
    v_permlane32_swap_b32 v28, v30
    v_permlane32_swap_b32 v29, v31
    v_add_f32 v28, v28, v30
    v_add_f32 v30, v29, v31
    s_cmp_eq_u32 s13, 3
    s_cbranch_scc1 cf_w3
    v_mov_b32 v29, v28
    v_mov_b32 v31, v30
    s_nop 0
    v_permlane16_swap_b32 v28, v29
    v_permlane16_swap_b32 v30, v31
    v_add_f32 v28, v28, v29
    v_add_f32 v30, v30, v31
cf_w3:
    v_cvt_pk_bf16_f32 v28, v28, v30
    s_mov_b64 exec, s[32:33]
    buffer_store_dword v28, v69, s[4:7], s17 offen
    s_mov_b64 exec, -1
    buffer_load_dwordx4 v[24:27], v61, s[4:7], s14 offen nt
    s_branch cf_loop
cf_w0:
    v_mov_b64 v[0:1], 0
    v_mov_b64 v[2:3], 0
    v_mov_b64 v[4:5], 0
    v_mov_b64 v[6:7], 0
    v_mov_b64 v[8:9], 0
    v_mov_b64 v[10:11], 0
    v_mov_b64 v[12:13], 0
    v_mov_b64 v[14:15], 0
    s_nop 15
    s_nop 15
    s_nop 15
    s_nop 5
    s_cmp_lg_u32 s28, 10
    s_cbranch_scc1 cf_nokv
    s_lshr_b32 s92, s12, 1
    s_lshl_b32 s92, s92, 8
    s_add_u32 s92, s92, 125829120
    v_bfe_u32 v28, v61, 4, 6
    v_min_u32 v28, 11, v28
    v_lshlrev_b32 v28, 2, v28
    v_add_u32 v28, 108304, v28
    s_waitcnt vmcnt(0)
    ds_read_b32 v29, v28
    s_add_u32 s93, s95, 63
    s_waitcnt lgkmcnt(0)
    v_cmp_ne_u32 vcc, s93, v29
    s_cbranch_vccz cf_kv1_go
    s_lshr_b32 s92, s12, 1
    s_lshl_b32 s92, s92, 8
    s_add_u32 s92, s92, 125833216
    v_bfe_u32 v28, v61, 4, 6
    v_min_u32 v28, 11, v28
    v_lshlrev_b32 v28, 2, v28
    s_add_u32 s93, s95, 63
    s_mov_b32 s94, 4194304
cf_kv1:
    buffer_load_dword v29, v28, s[4:7], s92 offen sc1
    s_sub_u32 s94, s94, 1
    s_cbranch_scc1 cf_kv1_go
    s_waitcnt vmcnt(0)
    v_subrev_u32 v29, s93, v29
    v_cmp_lt_u32 vcc, 64, v29
    s_cbranch_vccz cf_kv1_go
    s_sleep 2
    s_branch cf_kv1
cf_kv1_go:
    s_branch cf_w0p
cf_nokv:
    s_nop 15
    s_nop 15
    s_nop 15
    s_nop 15
    s_nop 15
    s_nop 15
    s_nop 13
cf_w0p:
    buffer_load_dwordx4 v[24:27], v61, s[4:7], s14 offen nt
    s_branch cf_loop2
cf_spinF:
    buffer_load_dwordx4 v[40:43], v65, s[4:7], s19 offen offset:0 nt
    buffer_load_dwordx4 v[44:47], v65, s[4:7], s19 offen offset:1024 nt
    buffer_load_dwordx4 v[48:51], v65, s[4:7], s19 offen offset:2048 nt
    buffer_load_dwordx4 v[52:55], v65, s[4:7], s19 offen offset:3072 nt
    s_sub_u32 s29, s29, 1
    s_cmp_lt_i32 s29, 0
    s_cselect_b32 s40, 0, 1
    s_branch cf_chkF
cf_spinG:
    buffer_load_dwordx4 v[0:3], v65, s[4:7], s19 offen offset:0 nt
    buffer_load_dwordx4 v[4:7], v65, s[4:7], s19 offen offset:1024 nt
    buffer_load_dwordx4 v[8:11], v65, s[4:7], s19 offen offset:2048 nt
    buffer_load_dwordx4 v[12:15], v65, s[4:7], s19 offen offset:3072 nt
    s_sub_u32 s29, s29, 1
    s_cmp_lt_i32 s29, 0
    s_cselect_b32 s40, 0, 1
    s_branch cf_chkG
cf_guard:
    s_cbranch_scc0 cf_guard2
    buffer_store_dwordx4 v[16:19], v61, s[4:7], s26 offen sc1
    s_add_u32 s26, s26, 131072
    s_add_u32 s40, s95, 63
    v_mov_b32 v5, s40
    s_mov_b64 exec, 1
    buffer_store_dword v5, off, s[4:7], s27 sc1
    s_mov_b64 exec, -1
cf_guard2:
    s_nop 7
    v_max3_f32 v6, v28, v29, v30
    v_max3_f32 v7, v31, v56, v57
    v_max_f32 v6, v6, v7
    s_nop 1
    v_max_f32_dpp v6, v6, v6 row_ror:8 row_mask:0xf bank_mask:0xf
    v_mov_b32 v7, v6
    s_nop 1
    v_permlane32_swap_b32 v6, v7
    v_max_f32 v6, v6, v7
    v_mov_b32 v7, v6
    s_nop 1
    v_permlane16_swap_b32 v6, v7
    v_max_f32 v6, v6, v7
    v_sub_f32 v28, v28, v6
    v_sub_f32 v29, v29, v6
    v_sub_f32 v30, v30, v6
    v_sub_f32 v31, v31, v6
    v_sub_f32 v56, v56, v6
    v_sub_f32 v57, v57, v6
    v_exp_f32 v58, v56
    v_exp_f32 v59, v57
    s_nop 0
    v_cvt_pk_bf16_f32 v6, v58, v59
    s_nop 1
    v_mov_b32_dpp v7, v6 row_ror:8 row_mask:0xf bank_mask:0xf
    v_exp_f32 v0, v28
    s_nop 0
    v_mfma_f32_16x16x16_bf16 v[12:15], v[16:17], v[6:7], 0
    v_exp_f32 v1, v29
    v_exp_f32 v2, v30
    v_cvt_pk_bf16_f32 v8, v0, v1
    v_exp_f32 v3, v31
    v_mfma_f32_16x16x16_bf16 v[20:23], v[18:19], v[6:7], 0
    v_cvt_pk_bf16_f32 v9, v2, v3
    v_mov_b32_dpp v10, v8 row_ror:8 row_mask:0xf bank_mask:0xf
    v_max3_f32 v4, |v28|, |v29|, |v30|
    v_mov_b32_dpp v11, v9 row_ror:8 row_mask:0xf bank_mask:0xf
    v_mfma_f32_16x16x32_bf16 v[0:3], v[24:27], v[6:9], 0
    v_max3_f32 v4, v4, |v31|, |v56|
    v_max_f32_e64 v4, v4, |v57|
    v_mfma_f32_16x16x32_bf16 v[12:15], v[40:43], v[8:11], v[12:15]
    v_cmp_nge_f32 vcc, s46, v4
    v_mfma_f32_16x16x32_bf16 v[20:23], v[44:47], v[8:11], v[20:23]
    v_add_f32_dpp v0, v0, v0 row_ror:8 row_mask:0xf bank_mask:0xf
    v_rcp_f32 v0, v0
    s_nop 4
    s_branch cf_norm
cf_spin0:
    buffer_load_dwordx4 v[24:27], v61, s[4:7], s14 offen nt
    s_sub_u32 s29, s29, 1
    s_cmp_lt_i32 s29, 0
    s_cbranch_scc0 cf_chk0
    s_waitcnt vmcnt(0)
    v_min_u32 v24, -2, v24
    v_min_u32 v25, -2, v25
    v_min_u32 v26, -2, v26
    v_min_u32 v27, -2, v27
    s_branch cf_chk0
cf_spin1:
    s_mov_b32 m0, s58
    s_nop 0
    buffer_load_dwordx4 v61, s[4:7], s15 offen nt lds
    s_mov_b32 m0, s59
    s_nop 0
    buffer_load_dword v56, s[4:7], s16 offen nt lds
    s_mov_b32 m0, 108032
    s_sub_u32 s29, s29, 1
    s_cmp_lt_i32 s29, 0
    s_waitcnt vmcnt(0)
    ds_read_b128 v[28:31], v62 offset:45056
    ds_read_b32 v59, v58
    s_waitcnt lgkmcnt(0)
    v_max3_u32 v57, v28, v29, v30
    v_max3_u32 v57, v57, v31, v59
    v_cmp_eq_u32 vcc, -1, v57
    s_cbranch_scc1 cf_go1
    s_cbranch_vccnz cf_spin1
    s_branch cf_go1
cf_last:
    s_nop 1
    s_cmp_ge_u32 s28, 2
    s_cbranch_scc1 cf_last0
    s_and_b32 s40, s12, 3
    s_lshl_b32 s40, s40, 14
    s_add_u32 s40, s40, 67108864
    s_lshr_b32 s42, s12, 2
    s_lshl_b32 s42, s42, 3
    s_lshl_b64 exec, 0x55, s42
    buffer_load_dword v79, s[4:7], s40 offen sc1 lds
    s_mov_b64 exec, -1
    s_cmp_eq_u32 0, 1
    s_branch cf_back
cf_last0:
    s_cmp_lg_u32 s28, 9
    s_cbranch_scc1 cf_last1
    s_lshr_b32 s92, s12, 1
    s_lshl_b32 s92, s92, 8
    s_add_u32 s92, s92, 125833216
    v_bfe_u32 v48, v61, 4, 6
    v_min_u32 v48, 11, v48
    v_lshlrev_b32 v48, 2, v48
    s_mov_b32 m0, 108304
    s_mov_b64 exec, 0xfff
    buffer_load_dword v48, s[4:7], s92 offen sc1 lds
    s_mov_b64 exec, -1
    s_mov_b32 m0, 108032
    s_cmp_eq_u32 0, 1
    s_branch cf_back
cf_last1:
    s_cmp_eq_u32 s28, 63
    s_cbranch_scc1 cf_last2
    s_mov_b64 exec, s[34:35]
    buffer_store_dwordx4 v[0:3], v61, s[4:7], s25 offen sc1
    s_mov_b64 exec, -1
    s_add_u32 s25, s25, 131072
    s_mov_b32 s46, 0xbf800000
    s_cmp_eq_u32 0, 0
    s_branch cf_back
cf_last2:
    s_waitcnt lgkmcnt(0)
    s_mov_b64 exec, s[34:35]
    buffer_store_dwordx4 v[0:3], v61, s[4:7], s25 offen sc1
    s_mov_b64 exec, -1
    s_add_u32 s40, s95, 64
    v_mov_b32 v40, s40
    v_smfmac_f32_16x16x64_bf16 v[16:19], v[52:55], v[80:87], v60
    v_smfmac_f32_16x16x64_bf16 v[20:23], v[52:55], v[88:95], v60
    s_nop 3
    v_cvt_pk_bf16_f32 v16, v16, v17
    v_cvt_pk_bf16_f32 v17, v18, v19
    s_nop 1
    v_cvt_pk_bf16_f32 v18, v20, v21
    v_cvt_pk_bf16_f32 v19, v22, v23
    buffer_store_dwordx4 v[16:19], v61, s[4:7], s26 offen sc1
    s_mov_b64 exec, 1
    buffer_store_dword v40, off, s[4:7], s27 sc1
    s_mov_b64 exec, -1
    s_endpgm
cf_dma:
    s_xor_b32 s74, s76, s81
    s_add_u32 m0, s74, s80
    s_add_u32 s76, s76, 4096
    buffer_load_dwordx4 v58, s[8:11], s78 offen lds
    s_add_u32 s78, s78, s79
    s_cmp_lt_u32 s76, s77
    s_cbranch_scc1 cf_dma
    s_setpc_b64 s[82:83]
L_chain_safe:
    s_mov_b64 s[48:49], s[50:51]
    s_mov_b64 s[50:51], s[52:53]
    s_mov_b64 s[52:53], s[54:55]
    s_mov_b64 s[54:55], s[56:57]
    s_mov_b64 s[56:57], s[58:59]
    v_lshrrev_b32 v54, 6, v0
    s_nop 0
    v_readfirstlane_b32 s13, v54
    v_and_b32 v57, 63, v0
    v_bfe_u32 v54, v57, 2, 1
    v_lshlrev_b32 v48, 13, v54
    v_bfe_u32 v54, v57, 3, 1
    v_lshl_add_u32 v48, v54, 15, v48
    v_bfe_u32 v54, v57, 4, 1
    v_lshl_add_u32 v48, v54, 14, v48
    v_bfe_u32 v54, v57, 5, 1
    v_lshl_add_u32 v48, v54, 16, v48
    v_lshrrev_b32 v55, 4, v57
    v_and_b32 v55, 2, v55
    v_xor_b32 v55, v55, v57
    v_and_b32 v55, 3, v55
    v_lshl_add_u32 v48, v55, 4, v48
    v_bfe_u32 v54, v57, 2, 1
    v_lshlrev_b32 v51, 6, v54
    v_bfe_u32 v54, v57, 3, 1
    v_lshl_add_u32 v51, v54, 9, v51
    v_bfe_u32 v54, v57, 4, 1
    v_lshl_add_u32 v51, v54, 7, v51
    v_bfe_u32 v54, v57, 5, 1
    v_lshl_add_u32 v51, v54, 12, v51
    v_bfe_u32 v54, v57, 0, 1
    v_lshl_add_u32 v51, v54, 3, v51
    v_bfe_u32 v54, v57, 1, 1
    v_lshl_add_u32 v51, v54, 4, v51
    v_bfe_u32 v54, v57, 3, 1
    v_lshl_add_u32 v51, v54, 5, v51
    v_lshrrev_b32 v55, 3, v57
    v_mul_u32_u24 v49, 1152, v55
    v_and_b32 v55, 7, v57
    v_lshl_add_u32 v49, v55, 4, v49
    v_bfe_u32 v54, v57, 4, 1
    v_lshlrev_b32 v52, 13, v54
    v_bfe_u32 v54, v57, 5, 1
    v_lshl_add_u32 v52, v54, 9, v52
    v_bfe_u32 v54, v57, 2, 1
    v_lshl_add_u32 v52, v54, 7, v52
    v_bfe_u32 v54, v57, 3, 1
    v_lshl_add_u32 v52, v54, 5, v52
    v_and_b32 v55, 3, v57
    v_lshl_add_u32 v52, v55, 3, v52
    v_lshrrev_b32 v55, 2, v57
    v_mul_u32_u24 v50, 1152, v55
    v_and_b32 v55, 3, v57
    v_lshl_add_u32 v50, v55, 4, v50
    v_bfe_u32 v54, v57, 4, 1
    v_lshlrev_b32 v53, 12, v54
    v_bfe_u32 v54, v57, 5, 1
    v_lshl_add_u32 v53, v54, 8, v53
    v_bfe_u32 v54, v57, 2, 1
    v_lshl_add_u32 v53, v54, 6, v53
    v_bfe_u32 v54, v57, 3, 1
    v_lshl_add_u32 v53, v54, 5, v53
    v_and_b32 v55, 3, v57
    v_lshl_add_u32 v53, v55, 3, v53
    s_lshl_b32 s66, s13, 10
    s_and_b32 s93, s13, 1
    s_lshl_b32 s93, s93, 14
    s_and_b32 s75, s13, 2
    s_lshl_b32 s75, s75, 19
    v_add_u32 v51, s66, v51
    v_add_u32 v52, s66, v52
    v_add_u32 v53, s66, v53
    v_mov_b32 v58, v48
    s_mov_b32 s10, 4718592
    s_mov_b32 s11, 0x20000
    s_lshl_b32 s67, s12, 8
    s_lshl_b32 s40, s13, 6
    s_add_u32 s67, s67, s40
    s_mul_i32 s92, s12, 147456
    s_lshr_b32 s73, s50, 8
    s_add_u32 s73, s73, s12
    s_and_b32 s73, s73, 31
    s_bitcmp1_b32 0xa2222222, s73
    s_cselect_b32 s88, 0, 0
    s_mov_b32 s72, 0
    s_add_u32 s73, s73, 1
    s_lshr_b32 s73, s73, 2
    s_xor_b32 s94, s13, 0
    s_mul_i32 s94, s94, 36864
    s_add_u32 s94, s94, s92
    s_lshl_b32 s74, s13, 7
    s_add_u32 s94, s94, s74
    s_add_u32 s78, s94, 0
    s_mov_b64 s[8:9], s[56:57]
    v_mov_b32 v58, v49
    s_mov_b32 s79, 9216
    s_mov_b32 s81, 0
    s_add_u32 s80, s66, 114688
    s_mov_b32 s76, 0
    s_mov_b32 s77, 8192
    s_call_b64 s[82:83], cs_dma
    s_mov_b32 s77, 16384
    s_call_b64 s[82:83], cs_dma
    s_xor_b32 s94, s13, 1
    s_mul_i32 s94, s94, 36864
    s_add_u32 s94, s94, s92
    s_lshl_b32 s74, s13, 7
    s_add_u32 s94, s94, s74
    s_add_u32 s78, s94, 0
    s_add_u32 s80, s66, 81920
    s_mov_b32 s76, 0
    s_mov_b32 s77, 8192
    s_call_b64 s[82:83], cs_dma
    s_mov_b32 s77, 16384
    s_call_b64 s[82:83], cs_dma
    s_xor_b32 s94, s13, 2
    s_mul_i32 s94, s94, 36864
    s_add_u32 s94, s94, s92
    s_lshl_b32 s74, s13, 7
    s_add_u32 s94, s94, s74
    s_add_u32 s78, s94, 0
    s_add_u32 s80, s66, 16384
    s_mov_b32 s76, 0
    s_mov_b32 s77, 8192
    s_call_b64 s[82:83], cs_dma
    s_mov_b32 s77, 16384
    s_call_b64 s[82:83], cs_dma
    s_xor_b32 s94, s13, 3
    s_mul_i32 s94, s94, 36864
    s_add_u32 s94, s94, s92
    s_lshl_b32 s74, s13, 7
    s_add_u32 s94, s94, s74
    s_add_u32 s78, s94, 0
    s_add_u32 s80, s66, 0
    s_mov_b32 s76, 0
    s_mov_b32 s77, 8192
    s_call_b64 s[82:83], cs_dma
    s_mov_b32 s77, 16384
    s_call_b64 s[82:83], cs_dma
    v_lshrrev_b32 v24, 6, v0
    v_lshlrev_b32 v61, 4, v0
    v_add_u32 v62, 57344, v61
    v_xor_b32 v63, 1024, v61
    v_add_u32 v63, 98304, v63
    v_xor_b32 v64, 2048, v61
    v_add_u32 v64, 98304, v64
    v_and_b32 v65, 1023, v61
    v_add_u32 v65, 98304, v65
    v_and_b32 v26, 15, v0
    v_bfe_u32 v27, v0, 4, 2
    v_mov_b32 v60, 0x4444
    v_mov_b32 v25, 0xeeee
    v_cmp_lt_u32 vcc, 7, v26
    s_nop 1
    v_cndmask_b32 v60, v60, v25, vcc
    s_nop 1
    v_and_b32 v67, 12, v26
    v_lshlrev_b32 v67, 3, v67
    v_and_b32 v25, 1, v26
    v_lshl_add_u32 v67, v25, 4, v67
    v_bfe_u32 v25, v26, 1, 1
    v_lshl_add_u32 v67, v25, 3, v67
    v_lshl_add_u32 v66, v27, 14, v67
    v_lshl_add_u32 v66, v24, 17, v66
    s_nop 1
    v_and_b32 v67, 63, v67
    v_lshrrev_b32 v25, 1, v24
    v_lshl_add_u32 v67, v25, 18, v67
    v_lshl_add_u32 v67, v27, 16, v67
    v_lshrrev_b32 v25, 3, v26
    v_lshl_add_u32 v67, v25, 15, v67
    v_and_b32 v25, 1, v24
    v_lshl_add_u32 v67, v25, 6, v67
    s_nop 1
    s_waitcnt vmcnt(12)
    v_add_u32 v55, 114688, v52
    ds_read_b64_tr_b16 v[160:161], v55 offset:0
    ds_read_b64_tr_b16 v[162:163], v55 offset:256
    ds_read_b64_tr_b16 v[164:165], v55 offset:4096
    ds_read_b64_tr_b16 v[166:167], v55 offset:4352
    s_xor_b32 s94, s13, 0
    s_mul_i32 s94, s94, 36864
    s_add_u32 s94, s94, s92
    s_lshl_b32 s74, s13, 7
    s_add_u32 s94, s94, s74
    s_add_u32 s78, s94, 512
    s_add_u32 s80, s66, 147456
    s_mov_b32 s76, 0
    s_mov_b32 s77, 8192
    s_call_b64 s[82:83], cs_dma
    ds_read_b64_tr_b16 v[192:193], v55 offset:64
    ds_read_b64_tr_b16 v[194:195], v55 offset:320
    ds_read_b64_tr_b16 v[196:197], v55 offset:4160
    ds_read_b64_tr_b16 v[198:199], v55 offset:4416
    s_mov_b32 s77, 16384
    s_call_b64 s[82:83], cs_dma
    v_and_b32 v25, 31, v0
    v_lshlrev_b32 v70, 4, v25
    v_lshlrev_b32 v28, 3, v25
    v_add_u32 v28, 108032, v28
    v_lshrrev_b32 v25, 1, v24
    v_lshl_add_u32 v70, v25, 9, v70
    v_and_b32 v25, 1, v24
    v_lshl_add_u32 v70, v25, 3, v70
    v_add_u32 v70, 109568, v70
    v_cmp_gt_u32 vcc, 2, v27
    s_nop 1
    v_cndmask_b32 v70, v70, v28, vcc
    s_nop 1
    s_waitcnt lgkmcnt(0)
    s_waitcnt vmcnt(12)
    v_add_u32 v55, 81920, v52
    ds_read_b64_tr_b16 v[168:169], v55 offset:0
    ds_read_b64_tr_b16 v[170:171], v55 offset:256
    ds_read_b64_tr_b16 v[172:173], v55 offset:4096
    ds_read_b64_tr_b16 v[174:175], v55 offset:4352
    s_xor_b32 s94, s13, 1
    s_mul_i32 s94, s94, 36864
    s_add_u32 s94, s94, s92
    s_lshl_b32 s74, s13, 7
    s_add_u32 s94, s94, s74
    s_add_u32 s78, s94, 512
    s_add_u32 s80, s66, 98304
    s_mov_b32 s76, 0
    s_mov_b32 s77, 8192
    s_call_b64 s[82:83], cs_dma
    ds_read_b64_tr_b16 v[200:201], v55 offset:64
    ds_read_b64_tr_b16 v[202:203], v55 offset:320
    ds_read_b64_tr_b16 v[204:205], v55 offset:4160
    ds_read_b64_tr_b16 v[206:207], v55 offset:4416
    s_mov_b32 s77, 16384
    s_call_b64 s[82:83], cs_dma
    v_xor_b32 v71, 2048, v63
    v_lshrrev_b32 v68, 4, v0
    v_lshlrev_b32 v68, 7, v68
    v_and_b32 v25, 7, v26
    v_lshl_add_u32 v68, v25, 4, v68
    v_add_u32 v68, 102400, v68
    v_xor_b32 v74, 512, v68
    v_xor_b32 v75, 1024, v68
    v_xor_b32 v76, 1536, v68
    v_lshrrev_b32 v25, 3, v26
    v_lshl_add_u32 v77, v25, 3, v68
    v_or_b32 v78, 512, v65
    v_lshlrev_b32 v79, 2, v61
    v_mov_b64 v[72:73], 0
    v_and_b32 v25, 1, v27
    v_lshlrev_b32 v69, 7, v25
    v_lshrrev_b32 v25, 1, v27
    v_lshl_add_u32 v69, v25, 3, v69
    v_and_b32 v25, 3, v26
    v_lshl_add_u32 v69, v25, 4, v69
    v_bfe_u32 v25, v26, 2, 1
    v_lshl_add_u32 v69, v25, 2, v69
    s_nop 1
    s_waitcnt lgkmcnt(0)
    s_waitcnt vmcnt(12)
    v_add_u32 v55, 16384, v52
    ds_read_b64_tr_b16 v[176:177], v55 offset:0
    ds_read_b64_tr_b16 v[178:179], v55 offset:256
    ds_read_b64_tr_b16 v[180:181], v55 offset:4096
    ds_read_b64_tr_b16 v[182:183], v55 offset:4352
    s_add_u32 s78, s67, 4194304
    s_mov_b64 s[8:9], s[54:55]
    v_mov_b32 v58, v48
    s_mov_b32 s79, 131072
    s_add_u32 s80, s66, 32768
    s_mov_b32 s76, 0
    s_mov_b32 s77, 8192
    s_call_b64 s[82:83], cs_dma
    ds_read_b64_tr_b16 v[208:209], v55 offset:64
    ds_read_b64_tr_b16 v[210:211], v55 offset:320
    ds_read_b64_tr_b16 v[212:213], v55 offset:4160
    ds_read_b64_tr_b16 v[214:215], v55 offset:4416
    s_mov_b32 s77, 16384
    s_call_b64 s[82:83], cs_dma
    s_mov_b32 s32, 0x00ff00ff
    s_mov_b32 s33, 0x00ff00ff
    s_not_b64 s[34:35], s[32:33]
    s_lshr_b32 s31, s12, 1
    s_lshl_b32 s31, s31, 8
    s_and_b32 s40, s12, 1
    s_lshl_b32 s40, s40, 6
    s_add_u32 s31, s31, s40
    s_and_b32 s40, s13, 1
    s_lshl_b32 s40, s40, 12
    s_add_u32 s31, s31, s40
    s_lshl_b32 s19, s12, 14
    s_add_u32 s19, s19, 68124672
    s_add_u32 s41, s19, 8192
    s_add_u32 s19, s19, s40
    s_and_b32 s40, s12, 1
    s_lshl_b32 s40, s40, 2
    s_or_b32 s40, s40, s13
    s_cmp_eq_u32 s40, 5
    s_cselect_b32 s64, 0, s13
    s_cmp_lg_u32 s13, 1
    s_cbranch_scc1 cs_notx
    s_mov_b32 s32, 0xff
    s_mov_b32 s33, 0xff
    s_mov_b32 s19, s41
    s_lshr_b32 s31, s12, 3
    s_lshl_b32 s31, s31, 8
    s_and_b32 s40, s12, 2
    s_lshl_b32 s40, s40, 6
    s_add_u32 s31, s31, s40
    s_and_b32 s40, s12, 4
    s_lshl_b32 s40, s40, 4
    s_add_u32 s31, s31, s40
    s_add_u32 s31, s31, 8192
cs_notx:
    s_cmp_lg_u32 s13, 0
    s_cbranch_scc1 cs_notp
    s_min_u32 s40, s12, 23
    s_mul_i32 s40, s40, 384
    s_add_u32 s40, s40, 98304
    v_add_u32 v69, s40, v61
    v_mov_b32 v25, 108288
    v_cmp_lt_u32 vcc, 23, v0
    s_nop 1
    v_cndmask_b32 v69, v69, v25, vcc
cs_notp:
    s_nop 1
    s_waitcnt lgkmcnt(0)
    s_waitcnt vmcnt(12)
    v_add_u32 v55, 0, v52
    ds_read_b64_tr_b16 v[184:185], v55 offset:0
    ds_read_b64_tr_b16 v[186:187], v55 offset:256
    ds_read_b64_tr_b16 v[188:189], v55 offset:4096
    ds_read_b64_tr_b16 v[190:191], v55 offset:4352
    s_xor_b32 s78, s75, 0
    s_add_u32 s78, s78, s67
    s_mov_b32 s81, s93
    s_add_u32 s80, s66, 114688
    s_mov_b32 s76, 0
    s_mov_b32 s77, 8192
    s_call_b64 s[82:83], cs_dma
    ds_read_b64_tr_b16 v[216:217], v55 offset:64
    ds_read_b64_tr_b16 v[218:219], v55 offset:320
    ds_read_b64_tr_b16 v[220:221], v55 offset:4160
    ds_read_b64_tr_b16 v[222:223], v55 offset:4416
    s_mov_b32 s77, 16384
    s_call_b64 s[82:83], cs_dma
    v_mov_b32 v28, 1
    v_mov_b32 v29, 1
    v_mov_b32 v30, 1
    v_mov_b32 v31, 1
    s_lshl_b32 s40, s12, 14
    s_add_u32 s40, s40, 68222976
    s_add_u32 s41, s40, 0
    buffer_store_dwordx4 v[28:31], v61, s[4:7], s41 offen sc1
    s_add_u32 s41, s40, 4096
    buffer_store_dwordx4 v[28:31], v61, s[4:7], s41 offen sc1
    s_add_u32 s41, s40, 8192
    buffer_store_dwordx4 v[28:31], v61, s[4:7], s41 offen sc1
    s_cmp_eq_u32 s64, 0
    s_cselect_b64 exec, 0, s[32:33]
    v_mov_b32 v27, -1
    s_add_u32 s41, s31, 68157440
    buffer_store_dword v27, v69, s[4:7], s41 offen sc1
    s_add_u32 s41, s31, 68173824
    buffer_store_dword v27, v69, s[4:7], s41 offen sc1
    s_add_u32 s41, s31, 68190208
    buffer_store_dword v27, v69, s[4:7], s41 offen sc1
    s_add_u32 s41, s31, 68206592
    buffer_store_dword v27, v69, s[4:7], s41 offen sc1
    s_mov_b64 exec, -1
    s_waitcnt lgkmcnt(0)
    s_waitcnt vmcnt(12)
    v_add_u32 v55, 147456, v52
    ds_read_b64_tr_b16 v[224:225], v55 offset:0
    ds_read_b64_tr_b16 v[226:227], v55 offset:256
    ds_read_b64_tr_b16 v[228:229], v55 offset:4096
    ds_read_b64_tr_b16 v[230:231], v55 offset:4352
    s_mov_b32 s77, 24576
    s_call_b64 s[82:83], cs_dma
    ds_read_b64_tr_b16 v[240:241], v55 offset:64
    ds_read_b64_tr_b16 v[242:243], v55 offset:320
    ds_read_b64_tr_b16 v[244:245], v55 offset:4160
    ds_read_b64_tr_b16 v[246:247], v55 offset:4416
    s_mov_b32 s77, 32768
    s_call_b64 s[82:83], cs_dma
    s_mov_b64 s[68:69], s[48:49]
    s_mov_b32 s70, 9216
    s_mov_b32 s71, 0x20000
    v_and_b32 v25, 7, v0
    v_mul_u32_u24 v25, 1152, v25
    v_lshrrev_b32 v26, 3, v0
    v_lshl_add_u32 v25, v26, 4, v25
    buffer_load_dwordx4 v[36:39], v25, s[68:71], 0 offen
    buffer_load_dwordx4 v[40:43], v25, s[68:71], 0 offen offset:512
    v_bfe_u32 v25, v0, 2, 3
    v_mul_u32_u24 v25, 1152, v25
    v_lshrrev_b32 v26, 5, v0
    v_lshl_add_u32 v25, v26, 4, v25
    v_and_b32 v26, 3, v0
    v_lshl_add_u32 v25, v26, 2, v25
    buffer_load_dword v44, v25, s[68:71], 0 offen offset:1024
    s_nop 0
    s_waitcnt lgkmcnt(0)
    s_waitcnt vmcnt(15)
    v_add_u32 v55, 98304, v52
    ds_read_b64_tr_b16 v[232:233], v55 offset:0
    ds_read_b64_tr_b16 v[234:235], v55 offset:256
    ds_read_b64_tr_b16 v[236:237], v55 offset:4096
    ds_read_b64_tr_b16 v[238:239], v55 offset:4352
    s_xor_b32 s78, s75, 1048576
    s_add_u32 s78, s78, s67
    s_add_u32 s80, s66, 65536
    s_mov_b32 s76, 0
    s_mov_b32 s77, 8192
    s_call_b64 s[82:83], cs_dma
    ds_read_b64_tr_b16 v[248:249], v55 offset:64
    ds_read_b64_tr_b16 v[250:251], v55 offset:320
    ds_read_b64_tr_b16 v[252:253], v55 offset:4160
    ds_read_b64_tr_b16 v[254:255], v55 offset:4416
    s_mov_b32 s77, 16384
    s_call_b64 s[82:83], cs_dma
    s_mov_b32 s44, 0x3e0293ee
    s_mov_b32 s45, s44
    s_mov_b32 s46, 0x42000000
    s_mov_b32 s60, 0x3f803f80
    s_mov_b32 s61, s60
    s_mov_b32 s62, 0x3e803e80
    s_mov_b32 s63, s62
    s_mov_b32 s28, 0
    s_lshl_b32 s58, s13, 10
    s_add_u32 s58, s58, 102400
    s_lshl_b32 s59, s13, 8
    s_add_u32 s59, s59, 106496
    s_lshl_b32 s24, s12, 14
    s_add_u32 s24, s24, 0
    s_add_u32 s47, s24, 33030144
    s_mul_i32 s40, s13, 3072
    s_add_u32 s23, s24, s40
    s_lshl_b32 s20, s12, 7
    s_add_u32 s20, s20, 68222976
    s_add_u32 s21, s20, 65536
    s_add_u32 s38, s20, 4096
    s_add_u32 s39, s21, 4096
    s_lshl_b32 s22, s12, 7
    s_add_u32 s22, s22, 68231168
    s_waitcnt lgkmcnt(0)
    s_waitcnt vmcnt(15)
    v_add_u32 v55, 32768, v51
    v_xor_b32 v56, 32, v55
    ds_read_b64_tr_b16 v[144:145], v55 offset:0
    ds_read_b64_tr_b16 v[146:147], v55 offset:256
    ds_read_b64_tr_b16 v[148:149], v55 offset:8192
    ds_read_b64_tr_b16 v[150:151], v55 offset:8448
    s_mov_b32 s77, 24576
    s_call_b64 s[82:83], cs_dma
    ds_read_b64_tr_b16 v[152:153], v56 offset:0
    ds_read_b64_tr_b16 v[154:155], v56 offset:256
    ds_read_b64_tr_b16 v[156:157], v56 offset:8192
    ds_read_b64_tr_b16 v[158:159], v56 offset:8448
    s_mov_b32 s77, 32768
    s_call_b64 s[82:83], cs_dma
    s_lshl_b32 s40, s12, 12
    s_add_u32 s25, s40, 79429632
    s_add_u32 s26, s40, 88866816
    s_lshl_b32 s65, s12, 9
    s_add_u32 s65, s65, 90177536
    s_lshl_b32 s40, s13, 5
    s_or_b32 s40, s40, s12
    s_cmp_lt_u32 s40, 24
    s_cselect_b32 s36, 0x1ffffff, 0
    s_mov_b32 s37, 0
    s_lshl_b32 s27, s12, 7
    s_add_u32 s27, s27, 125845504
    s_lshl_b32 s40, s13, 2
    s_add_u32 s27, s27, s40
    v_bfe_u32 v28, v61, 4, 4
    v_bfe_u32 v29, v61, 8, 1
    v_lshlrev_b32 v29, 2, v29
    v_sub_u32 v29, v28, v29
    v_mov_b32 v31, 0x3f80
    v_mov_b32 v32, 0x3f800000
    s_nop 1
    s_waitcnt lgkmcnt(0)
    s_waitcnt vmcnt(11)
    v_add_u32 v55, 114688, v51
    v_xor_b32 v56, 32, v55
    ds_read_b64_tr_b16 a[192:193], v55 offset:0
    ds_read_b64_tr_b16 a[194:195], v55 offset:256
    ds_read_b64_tr_b16 a[196:197], v55 offset:8192
    ds_read_b64_tr_b16 a[198:199], v55 offset:8448
    s_xor_b32 s78, s75, 2097152
    s_add_u32 s78, s78, s67
    s_add_u32 s80, s66, 0
    s_mov_b32 s76, 0
    s_mov_b32 s77, 8192
    s_call_b64 s[82:83], cs_dma
    ds_read_b64_tr_b16 a[200:201], v56 offset:0
    ds_read_b64_tr_b16 a[202:203], v56 offset:256
    ds_read_b64_tr_b16 a[204:205], v56 offset:8192
    ds_read_b64_tr_b16 a[206:207], v56 offset:8448
    s_mov_b32 s77, 16384
    s_call_b64 s[82:83], cs_dma
    v_cmp_eq_u32 vcc, 0, v29
    s_nop 1
    v_cndmask_b32 v16, 0, v31, vcc
    v_cmp_eq_u32 vcc, 1, v29
    s_nop 1
    v_cndmask_b32 v16, v16, v32, vcc
    v_cmp_eq_u32 vcc, 0, v28
    s_nop 1
    v_cndmask_b32 v20, 0, v31, vcc
    v_cmp_eq_u32 vcc, 1, v28
    s_nop 1
    v_cndmask_b32 v20, v20, v32, vcc
    s_nop 1
    s_waitcnt lgkmcnt(0)
    v_add_u32 v55, 131072, v51
    v_xor_b32 v56, 32, v55
    ds_read_b64_tr_b16 a[208:209], v55 offset:0
    ds_read_b64_tr_b16 a[210:211], v55 offset:256
    ds_read_b64_tr_b16 a[212:213], v55 offset:8192
    ds_read_b64_tr_b16 a[214:215], v55 offset:8448
    s_mov_b32 s77, 24576
    s_call_b64 s[82:83], cs_dma
    ds_read_b64_tr_b16 a[216:217], v56 offset:0
    ds_read_b64_tr_b16 a[218:219], v56 offset:256
    ds_read_b64_tr_b16 a[220:221], v56 offset:8192
    ds_read_b64_tr_b16 a[222:223], v56 offset:8448
    s_mov_b32 s77, 32768
    s_call_b64 s[82:83], cs_dma
    v_cmp_eq_u32 vcc, 2, v29
    s_nop 1
    v_cndmask_b32 v17, 0, v31, vcc
    v_cmp_eq_u32 vcc, 3, v29
    s_nop 1
    v_cndmask_b32 v17, v17, v32, vcc
    v_cmp_eq_u32 vcc, 2, v28
    s_nop 1
    v_cndmask_b32 v21, 0, v31, vcc
    v_cmp_eq_u32 vcc, 3, v28
    s_nop 1
    v_cndmask_b32 v21, v21, v32, vcc
    s_nop 1
    s_waitcnt lgkmcnt(0)
    s_waitcnt vmcnt(8)
    v_add_u32 v55, 65536, v51
    v_xor_b32 v56, 32, v55
    ds_read_b64_tr_b16 a[224:225], v55 offset:0
    ds_read_b64_tr_b16 a[226:227], v55 offset:256
    ds_read_b64_tr_b16 a[228:229], v55 offset:8192
    ds_read_b64_tr_b16 a[230:231], v55 offset:8448
    s_xor_b32 s78, s75, 3145728
    s_add_u32 s78, s78, s67
    s_add_u32 s80, s66, 32768
    s_mov_b32 s76, 0
    s_mov_b32 s77, 8192
    s_call_b64 s[82:83], cs_dma
    ds_read_b64_tr_b16 a[232:233], v56 offset:0
    ds_read_b64_tr_b16 a[234:235], v56 offset:256
    ds_read_b64_tr_b16 a[236:237], v56 offset:8192
    ds_read_b64_tr_b16 a[238:239], v56 offset:8448
    s_mov_b32 s77, 16384
    s_call_b64 s[82:83], cs_dma
    v_cmp_eq_u32 vcc, 8, v29
    s_nop 1
    v_cndmask_b32 v18, 0, v31, vcc
    v_cmp_eq_u32 vcc, 9, v29
    s_nop 1
    v_cndmask_b32 v18, v18, v32, vcc
    v_cmp_eq_u32 vcc, 4, v28
    s_nop 1
    v_cndmask_b32 v22, 0, v31, vcc
    v_cmp_eq_u32 vcc, 5, v28
    s_nop 1
    v_cndmask_b32 v22, v22, v32, vcc
    s_nop 1
    s_waitcnt lgkmcnt(0)
    v_add_u32 v55, 81920, v51
    v_xor_b32 v56, 32, v55
    ds_read_b64_tr_b16 a[240:241], v55 offset:0
    ds_read_b64_tr_b16 a[242:243], v55 offset:256
    ds_read_b64_tr_b16 a[244:245], v55 offset:8192
    ds_read_b64_tr_b16 a[246:247], v55 offset:8448
    s_mov_b32 s77, 24576
    s_call_b64 s[82:83], cs_dma
    ds_read_b64_tr_b16 a[248:249], v56 offset:0
    ds_read_b64_tr_b16 a[250:251], v56 offset:256
    ds_read_b64_tr_b16 a[252:253], v56 offset:8192
    ds_read_b64_tr_b16 a[254:255], v56 offset:8448
    s_mov_b32 s77, 32768
    s_call_b64 s[82:83], cs_dma
    v_cmp_eq_u32 vcc, 10, v29
    s_nop 1
    v_cndmask_b32 v19, 0, v31, vcc
    v_cmp_eq_u32 vcc, 11, v29
    s_nop 1
    v_cndmask_b32 v19, v19, v32, vcc
    v_cmp_eq_u32 vcc, 6, v28
    s_nop 1
    v_cndmask_b32 v23, 0, v31, vcc
    v_cmp_eq_u32 vcc, 7, v28
    s_nop 1
    v_cndmask_b32 v23, v23, v32, vcc
    s_nop 1
    s_waitcnt lgkmcnt(0)
    s_waitcnt vmcnt(8)
    v_add_u32 v55, 0, v51
    v_xor_b32 v56, 32, v55
    ds_read_b64_tr_b16 v[80:81], v55 offset:0
    ds_read_b64_tr_b16 v[82:83], v55 offset:256
    ds_read_b64_tr_b16 v[84:85], v55 offset:8192
    ds_read_b64_tr_b16 v[86:87], v55 offset:8448
    s_xor_b32 s78, s75, 2097152
    s_add_u32 s78, s78, s67
    s_mov_b64 s[8:9], s[52:53]
    s_add_u32 s80, s66, 131072
    s_mov_b32 s76, 0
    s_mov_b32 s77, 8192
    s_call_b64 s[82:83], cs_dma
    ds_read_b64_tr_b16 v[88:89], v56 offset:0
    ds_read_b64_tr_b16 v[90:91], v56 offset:256
    ds_read_b64_tr_b16 v[92:93], v56 offset:8192
    ds_read_b64_tr_b16 v[94:95], v56 offset:8448
    s_mov_b32 s77, 16384
    s_call_b64 s[82:83], cs_dma
    v_mov_b32 v46, 1
    s_mov_b64 exec, 1
    buffer_atomic_add v46, off, s[96:99], 0 offset:212 sc0
    s_mov_b64 exec, -1
    s_waitcnt lgkmcnt(0)
    v_add_u32 v55, 16384, v51
    v_xor_b32 v56, 32, v55
    ds_read_b64_tr_b16 v[96:97], v55 offset:0
    ds_read_b64_tr_b16 v[98:99], v55 offset:256
    ds_read_b64_tr_b16 v[100:101], v55 offset:8192
    ds_read_b64_tr_b16 v[102:103], v55 offset:8448
    s_mov_b32 s77, 24576
    s_call_b64 s[82:83], cs_dma
    ds_read_b64_tr_b16 v[104:105], v56 offset:0
    ds_read_b64_tr_b16 v[106:107], v56 offset:256
    ds_read_b64_tr_b16 v[108:109], v56 offset:8192
    ds_read_b64_tr_b16 v[110:111], v56 offset:8448
    s_mov_b32 s77, 32768
    s_call_b64 s[82:83], cs_dma
    s_waitcnt lgkmcnt(0)
    s_waitcnt vmcnt(9)
    v_add_u32 v55, 32768, v51
    v_xor_b32 v56, 32, v55
    ds_read_b64_tr_b16 v[112:113], v55 offset:0
    ds_read_b64_tr_b16 v[114:115], v55 offset:256
    ds_read_b64_tr_b16 v[116:117], v55 offset:8192
    ds_read_b64_tr_b16 v[118:119], v55 offset:8448
    s_xor_b32 s78, s75, 3145728
    s_add_u32 s78, s78, s67
    s_add_u32 s80, s66, 65536
    s_mov_b32 s76, 0
    s_mov_b32 s77, 8192
    s_call_b64 s[82:83], cs_dma
    ds_read_b64_tr_b16 v[120:121], v56 offset:0
    ds_read_b64_tr_b16 v[122:123], v56 offset:256
    ds_read_b64_tr_b16 v[124:125], v56 offset:8192
    ds_read_b64_tr_b16 v[126:127], v56 offset:8448
    s_mov_b32 s77, 16384
    s_call_b64 s[82:83], cs_dma
    s_waitcnt lgkmcnt(0)
    v_add_u32 v55, 49152, v51
    v_xor_b32 v56, 32, v55
    ds_read_b64_tr_b16 v[128:129], v55 offset:0
    ds_read_b64_tr_b16 v[130:131], v55 offset:256
    ds_read_b64_tr_b16 v[132:133], v55 offset:8192
    ds_read_b64_tr_b16 v[134:135], v55 offset:8448
    s_mov_b32 s77, 24576
    s_call_b64 s[82:83], cs_dma
    ds_read_b64_tr_b16 v[136:137], v56 offset:0
    ds_read_b64_tr_b16 v[138:139], v56 offset:256
    ds_read_b64_tr_b16 v[140:141], v56 offset:8192
    ds_read_b64_tr_b16 v[142:143], v56 offset:8448
    s_mov_b32 s77, 32768
    s_call_b64 s[82:83], cs_dma
    s_waitcnt lgkmcnt(0)
    s_waitcnt vmcnt(8)
    v_add_u32 v55, 131072, v51
    v_xor_b32 v56, 32, v55
    ds_read_b64_tr_b16 a[128:129], v55 offset:0
    ds_read_b64_tr_b16 a[130:131], v55 offset:256
    ds_read_b64_tr_b16 a[132:133], v55 offset:8192
    ds_read_b64_tr_b16 a[134:135], v55 offset:8448
    s_xor_b32 s78, s75, 2097152
    s_add_u32 s78, s78, s67
    s_mov_b64 s[8:9], s[50:51]
    s_add_u32 s80, s66, 0
    s_mov_b32 s76, 0
    s_mov_b32 s77, 8192
    s_call_b64 s[82:83], cs_dma
    ds_read_b64_tr_b16 a[136:137], v56 offset:0
    ds_read_b64_tr_b16 a[138:139], v56 offset:256
    ds_read_b64_tr_b16 a[140:141], v56 offset:8192
    ds_read_b64_tr_b16 a[142:143], v56 offset:8448
    s_mov_b32 s77, 16384
    s_call_b64 s[82:83], cs_dma
    s_waitcnt lgkmcnt(0)
    v_add_u32 v55, 147456, v51
    v_xor_b32 v56, 32, v55
    ds_read_b64_tr_b16 a[144:145], v55 offset:0
    ds_read_b64_tr_b16 a[146:147], v55 offset:256
    ds_read_b64_tr_b16 a[148:149], v55 offset:8192
    ds_read_b64_tr_b16 a[150:151], v55 offset:8448
    s_mov_b32 s77, 24576
    s_call_b64 s[82:83], cs_dma
    ds_read_b64_tr_b16 a[152:153], v56 offset:0
    ds_read_b64_tr_b16 a[154:155], v56 offset:256
    ds_read_b64_tr_b16 a[156:157], v56 offset:8192
    ds_read_b64_tr_b16 a[158:159], v56 offset:8448
    s_mov_b32 s77, 32768
    s_call_b64 s[82:83], cs_dma
    s_waitcnt lgkmcnt(0)
    s_waitcnt vmcnt(8)
    v_add_u32 v55, 65536, v51
    v_xor_b32 v56, 32, v55
    ds_read_b64_tr_b16 a[160:161], v55 offset:0
    ds_read_b64_tr_b16 a[162:163], v55 offset:256
    ds_read_b64_tr_b16 a[164:165], v55 offset:8192
    ds_read_b64_tr_b16 a[166:167], v55 offset:8448
    s_xor_b32 s78, s75, 3145728
    s_add_u32 s78, s78, s67
    s_add_u32 s80, s66, 32768
    s_mov_b32 s76, 0
    s_mov_b32 s77, 8192
    s_call_b64 s[82:83], cs_dma
    ds_read_b64_tr_b16 a[168:169], v56 offset:0
    ds_read_b64_tr_b16 a[170:171], v56 offset:256
    ds_read_b64_tr_b16 a[172:173], v56 offset:8192
    ds_read_b64_tr_b16 a[174:175], v56 offset:8448
    s_mov_b32 s77, 16384
    s_call_b64 s[82:83], cs_dma
    v_readfirstlane_b32 s41, v46
    v_mov_b32 v46, 1
    v_mov_b32 v47, 0
    s_cmp_eq_u32 s41, 127
    s_cselect_b64 exec, 1, 0
    buffer_atomic_cmpswap v[46:47], off, s[96:99], 0 offset:216
    s_mov_b64 exec, -1
    s_waitcnt lgkmcnt(0)
    v_add_u32 v55, 81920, v51
    v_xor_b32 v56, 32, v55
    ds_read_b64_tr_b16 a[176:177], v55 offset:0
    ds_read_b64_tr_b16 a[178:179], v55 offset:256
    ds_read_b64_tr_b16 a[180:181], v55 offset:8192
    ds_read_b64_tr_b16 a[182:183], v55 offset:8448
    s_mov_b32 s77, 24576
    s_call_b64 s[82:83], cs_dma
    ds_read_b64_tr_b16 a[184:185], v56 offset:0
    ds_read_b64_tr_b16 a[186:187], v56 offset:256
    ds_read_b64_tr_b16 a[188:189], v56 offset:8192
    ds_read_b64_tr_b16 a[190:191], v56 offset:8448
    s_mov_b32 s77, 32768
    s_call_b64 s[82:83], cs_dma
    s_waitcnt lgkmcnt(0)
    s_waitcnt vmcnt(8)
    v_add_u32 v55, 0, v51
    v_xor_b32 v56, 32, v55
    ds_read_b64_tr_b16 a[48:49], v55 offset:0
    ds_read_b64_tr_b16 a[50:51], v55 offset:256
    ds_read_b64_tr_b16 a[52:53], v55 offset:8192
    ds_read_b64_tr_b16 a[54:55], v55 offset:8448
    s_add_u32 s78, s67, 4194304
    s_mov_b32 s81, 0
    s_add_u32 s80, s66, 98304
    s_mov_b32 s76, 0
    s_mov_b32 s77, 8192
    s_call_b64 s[82:83], cs_dma
    ds_read_b64_tr_b16 a[56:57], v56 offset:0
    ds_read_b64_tr_b16 a[58:59], v56 offset:256
    ds_read_b64_tr_b16 a[60:61], v56 offset:8192
    ds_read_b64_tr_b16 a[62:63], v56 offset:8448
    s_mov_b32 s77, 16384
    s_call_b64 s[82:83], cs_dma
    s_waitcnt lgkmcnt(0)
    v_add_u32 v55, 16384, v51
    v_xor_b32 v56, 32, v55
    ds_read_b64_tr_b16 a[64:65], v55 offset:0
    ds_read_b64_tr_b16 a[66:67], v55 offset:256
    ds_read_b64_tr_b16 a[68:69], v55 offset:8192
    ds_read_b64_tr_b16 a[70:71], v55 offset:8448
    s_xor_b32 s78, s75, 1048576
    s_add_u32 s78, s78, s67
    s_mov_b32 s81, s93
    s_add_u32 s80, s66, 114688
    s_mov_b32 s76, 0
    s_mov_b32 s77, 8192
    s_call_b64 s[82:83], cs_dma
    ds_read_b64_tr_b16 a[72:73], v56 offset:0
    ds_read_b64_tr_b16 a[74:75], v56 offset:256
    ds_read_b64_tr_b16 a[76:77], v56 offset:8192
    ds_read_b64_tr_b16 a[78:79], v56 offset:8448
    s_mov_b32 s77, 16384
    s_call_b64 s[82:83], cs_dma
    s_waitcnt lgkmcnt(0)
    s_waitcnt vmcnt(8)
    v_add_u32 v55, 32768, v51
    v_xor_b32 v56, 32, v55
    ds_read_b64_tr_b16 a[80:81], v55 offset:0
    ds_read_b64_tr_b16 a[82:83], v55 offset:256
    ds_read_b64_tr_b16 a[84:85], v55 offset:8192
    ds_read_b64_tr_b16 a[86:87], v55 offset:8448
    s_mov_b32 s77, 24576
    s_call_b64 s[82:83], cs_dma
    ds_read_b64_tr_b16 a[88:89], v56 offset:0
    ds_read_b64_tr_b16 a[90:91], v56 offset:256
    ds_read_b64_tr_b16 a[92:93], v56 offset:8192
    ds_read_b64_tr_b16 a[94:95], v56 offset:8448
    s_mov_b32 s77, 32768
    s_call_b64 s[82:83], cs_dma
    s_waitcnt lgkmcnt(0)
    v_add_u32 v55, 49152, v51
    v_xor_b32 v56, 32, v55
    ds_read_b64_tr_b16 a[96:97], v55 offset:0
    ds_read_b64_tr_b16 a[98:99], v55 offset:256
    ds_read_b64_tr_b16 a[100:101], v55 offset:8192
    ds_read_b64_tr_b16 a[102:103], v55 offset:8448
    s_xor_b32 s78, s75, 0
    s_add_u32 s78, s78, s67
    s_add_u32 s80, s66, 65536
    s_mov_b32 s76, 0
    s_mov_b32 s77, 8192
    s_call_b64 s[82:83], cs_dma
    ds_read_b64_tr_b16 a[104:105], v56 offset:0
    ds_read_b64_tr_b16 a[106:107], v56 offset:256
    ds_read_b64_tr_b16 a[108:109], v56 offset:8192
    ds_read_b64_tr_b16 a[110:111], v56 offset:8448
    s_mov_b32 s77, 16384
    s_call_b64 s[82:83], cs_dma
    s_waitcnt lgkmcnt(0)
    s_waitcnt vmcnt(12)
    v_add_u32 v55, 98304, v51
    v_xor_b32 v56, 32, v55
    ds_read_b64_tr_b16 a[112:113], v55 offset:0
    ds_read_b64_tr_b16 a[114:115], v55 offset:256
    ds_read_b64_tr_b16 a[116:117], v55 offset:8192
    ds_read_b64_tr_b16 a[118:119], v55 offset:8448
    s_mov_b32 s77, 24576
    s_call_b64 s[82:83], cs_dma
    ds_read_b64_tr_b16 a[120:121], v56 offset:0
    ds_read_b64_tr_b16 a[122:123], v56 offset:256
    ds_read_b64_tr_b16 a[124:125], v56 offset:8192
    ds_read_b64_tr_b16 a[126:127], v56 offset:8448
    s_mov_b32 s77, 32768
    s_call_b64 s[82:83], cs_dma
    s_waitcnt lgkmcnt(0)
    s_waitcnt vmcnt(8)
    v_add_u32 v55, 114688, v51
    v_xor_b32 v56, 32, v55
    ds_read_b64_tr_b16 a[16:17], v55 offset:0
    ds_read_b64_tr_b16 a[18:19], v55 offset:256
    ds_read_b64_tr_b16 a[20:21], v55 offset:8192
    ds_read_b64_tr_b16 a[22:23], v55 offset:8448
    s_xor_b32 s78, s75, 0
    s_add_u32 s78, s78, s67
    s_mov_b64 s[8:9], s[52:53]
    s_add_u32 s80, s66, 0
    s_mov_b32 s76, 0
    s_mov_b32 s77, 8192
    s_call_b64 s[82:83], cs_dma
    ds_read_b64_tr_b16 a[24:25], v56 offset:0
    ds_read_b64_tr_b16 a[26:27], v56 offset:256
    ds_read_b64_tr_b16 a[28:29], v56 offset:8192
    ds_read_b64_tr_b16 a[30:31], v56 offset:8448
    s_mov_b32 s77, 16384
    s_call_b64 s[82:83], cs_dma
    s_waitcnt lgkmcnt(0)
    v_add_u32 v55, 131072, v51
    v_xor_b32 v56, 32, v55
    ds_read_b64_tr_b16 a[32:33], v55 offset:0
    ds_read_b64_tr_b16 a[34:35], v55 offset:256
    ds_read_b64_tr_b16 a[36:37], v55 offset:8192
    ds_read_b64_tr_b16 a[38:39], v55 offset:8448
    s_mov_b32 s77, 24576
    s_call_b64 s[82:83], cs_dma
    ds_read_b64_tr_b16 a[40:41], v56 offset:0
    ds_read_b64_tr_b16 a[42:43], v56 offset:256
    ds_read_b64_tr_b16 a[44:45], v56 offset:8192
    ds_read_b64_tr_b16 a[46:47], v56 offset:8448
    s_mov_b32 s77, 32768
    s_call_b64 s[82:83], cs_dma
    s_waitcnt lgkmcnt(0)
    s_waitcnt vmcnt(8)
    v_add_u32 v55, 65536, v51
    v_xor_b32 v56, 32, v55
    ds_read_b64_tr_b16 v[0:1], v55 offset:0
    ds_read_b64_tr_b16 v[2:3], v55 offset:256
    ds_read_b64_tr_b16 v[4:5], v55 offset:8192
    ds_read_b64_tr_b16 v[6:7], v55 offset:8448
    s_xor_b32 s78, s75, 1048576
    s_add_u32 s78, s78, s67
    s_add_u32 s80, s66, 32768
    s_mov_b32 s76, 0
    s_mov_b32 s77, 8192
    s_call_b64 s[82:83], cs_dma
    ds_read_b64_tr_b16 v[8:9], v56 offset:0
    ds_read_b64_tr_b16 v[10:11], v56 offset:256
    ds_read_b64_tr_b16 v[12:13], v56 offset:8192
    ds_read_b64_tr_b16 v[14:15], v56 offset:8448
    s_mov_b32 s77, 16384
    s_call_b64 s[82:83], cs_dma
    s_waitcnt lgkmcnt(0)
    ds_write_b128 v62, v[0:3] offset:8192
    ds_write_b128 v62, v[4:7] offset:12288
    ds_write_b128 v62, v[8:11] offset:16384
    ds_write_b128 v62, v[12:15] offset:20480
    s_waitcnt lgkmcnt(0)
    v_add_u32 v55, 81920, v51
    v_xor_b32 v56, 32, v55
    ds_read_b64_tr_b16 a[0:1], v55 offset:0
    ds_read_b64_tr_b16 a[2:3], v55 offset:256
    ds_read_b64_tr_b16 a[4:5], v55 offset:8192
    ds_read_b64_tr_b16 a[6:7], v55 offset:8448
    s_mov_b32 s77, 24576
    s_call_b64 s[82:83], cs_dma
    ds_read_b64_tr_b16 a[8:9], v56 offset:0
    ds_read_b64_tr_b16 a[10:11], v56 offset:256
    ds_read_b64_tr_b16 a[12:13], v56 offset:8192
    ds_read_b64_tr_b16 a[14:15], v56 offset:8448
    s_mov_b32 s77, 32768
    s_call_b64 s[82:83], cs_dma
    s_waitcnt lgkmcnt(0)
    s_waitcnt vmcnt(8)
    v_add_u32 v55, 0, v51
    v_xor_b32 v56, 32, v55
    ds_read_b64_tr_b16 v[0:1], v55 offset:0
    ds_read_b64_tr_b16 v[2:3], v55 offset:256
    ds_read_b64_tr_b16 v[4:5], v55 offset:8192
    ds_read_b64_tr_b16 v[6:7], v55 offset:8448
    s_xor_b32 s94, s13, 0
    s_mul_i32 s94, s94, 36864
    s_add_u32 s94, s94, s92
    s_lshr_b32 s74, s13, 1
    s_lshl_b32 s74, s74, 6
    s_add_u32 s94, s94, s74
    s_add_u32 s78, s94, 1024
    s_mov_b64 s[8:9], s[56:57]
    v_mov_b32 v58, v50
    s_mov_b32 s79, 18432
    s_mov_b32 s81, 0
    s_add_u32 s80, s66, 147456
    s_mov_b32 s76, 0
    s_mov_b32 s77, 8192
    s_call_b64 s[82:83], cs_dma
    ds_read_b64_tr_b16 v[8:9], v56 offset:0
    ds_read_b64_tr_b16 v[10:11], v56 offset:256
    ds_read_b64_tr_b16 v[12:13], v56 offset:8192
    ds_read_b64_tr_b16 v[14:15], v56 offset:8448
    s_xor_b32 s94, s13, 2
    s_mul_i32 s94, s94, 36864
    s_add_u32 s94, s94, s92
    s_lshr_b32 s74, s13, 1
    s_lshl_b32 s74, s74, 6
    s_add_u32 s94, s94, s74
    s_add_u32 s78, s94, 1024
    s_mov_b32 s77, 16384
    s_call_b64 s[82:83], cs_dma
    s_waitcnt lgkmcnt(0)
    ds_write_b128 v61, v[0:3] offset:0
    ds_write_b128 v61, v[4:7] offset:4096
    ds_write_b128 v61, v[8:11] offset:8192
    ds_write_b128 v61, v[12:15] offset:12288
    s_waitcnt lgkmcnt(0)
    v_add_u32 v55, 16384, v51
    v_xor_b32 v56, 32, v55
    ds_read_b64_tr_b16 v[0:1], v55 offset:0
    ds_read_b64_tr_b16 v[2:3], v55 offset:256
    ds_read_b64_tr_b16 v[4:5], v55 offset:8192
    ds_read_b64_tr_b16 v[6:7], v55 offset:8448
    s_xor_b32 s94, s13, 3
    s_mul_i32 s94, s94, 36864
    s_add_u32 s94, s94, s92
    s_lshl_b32 s74, s13, 7
    s_add_u32 s94, s94, s74
    s_add_u32 s78, s94, 512
    v_mov_b32 v58, v49
    s_mov_b32 s79, 9216
    s_add_u32 s80, s66, 131072
    s_mov_b32 s76, 0
    s_mov_b32 s77, 8192
    s_call_b64 s[82:83], cs_dma
    ds_read_b64_tr_b16 v[8:9], v56 offset:0
    ds_read_b64_tr_b16 v[10:11], v56 offset:256
    ds_read_b64_tr_b16 v[12:13], v56 offset:8192
    ds_read_b64_tr_b16 v[14:15], v56 offset:8448
    s_mov_b32 s77, 16384
    s_call_b64 s[82:83], cs_dma
    s_waitcnt lgkmcnt(0)
    ds_write_b128 v61, v[0:3] offset:16384
    ds_write_b128 v61, v[4:7] offset:20480
    ds_write_b128 v61, v[8:11] offset:24576
    ds_write_b128 v61, v[12:15] offset:28672
    s_waitcnt lgkmcnt(0)
    s_waitcnt vmcnt(8)
    v_add_u32 v55, 32768, v51
    v_xor_b32 v56, 32, v55
    ds_read_b64_tr_b16 v[0:1], v55 offset:0
    ds_read_b64_tr_b16 v[2:3], v55 offset:256
    ds_read_b64_tr_b16 v[4:5], v55 offset:8192
    ds_read_b64_tr_b16 v[6:7], v55 offset:8448
    s_xor_b32 s94, s13, 2
    s_mul_i32 s94, s94, 36864
    s_add_u32 s94, s94, s92
    s_lshl_b32 s74, s13, 7
    s_add_u32 s94, s94, s74
    s_add_u32 s78, s94, 512
    s_add_u32 s80, s66, 114688
    s_mov_b32 s76, 0
    s_mov_b32 s77, 8192
    s_call_b64 s[82:83], cs_dma
    ds_read_b64_tr_b16 v[8:9], v56 offset:0
    ds_read_b64_tr_b16 v[10:11], v56 offset:256
    ds_read_b64_tr_b16 v[12:13], v56 offset:8192
    ds_read_b64_tr_b16 v[14:15], v56 offset:8448
    s_mov_b32 s77, 16384
    s_call_b64 s[82:83], cs_dma
    s_waitcnt lgkmcnt(0)
    ds_write_b128 v61, v[0:3] offset:32768
    ds_write_b128 v61, v[4:7] offset:36864
    ds_write_b128 v61, v[8:11] offset:40960
    ds_write_b128 v61, v[12:15] offset:45056
    s_waitcnt lgkmcnt(0)
    v_add_u32 v55, 49152, v51
    v_xor_b32 v56, 32, v55
    ds_read_b64_tr_b16 v[0:1], v55 offset:0
    ds_read_b64_tr_b16 v[2:3], v55 offset:256
    ds_read_b64_tr_b16 v[4:5], v55 offset:8192
    ds_read_b64_tr_b16 v[6:7], v55 offset:8448
    s_add_u32 s78, s67, 4194304
    s_mov_b64 s[8:9], s[52:53]
    v_mov_b32 v58, v48
    s_mov_b32 s79, 131072
    s_add_u32 s80, s66, 81920
    s_mov_b32 s76, 0
    s_mov_b32 s77, 8192
    s_call_b64 s[82:83], cs_dma
    ds_read_b64_tr_b16 v[8:9], v56 offset:0
    ds_read_b64_tr_b16 v[10:11], v56 offset:256
    ds_read_b64_tr_b16 v[12:13], v56 offset:8192
    ds_read_b64_tr_b16 v[14:15], v56 offset:8448
    s_mov_b32 s77, 16384
    s_call_b64 s[82:83], cs_dma
    s_waitcnt lgkmcnt(0)
    ds_write_b128 v61, v[0:3] offset:49152
    ds_write_b128 v61, v[4:7] offset:53248
    ds_write_b128 v61, v[8:11] offset:57344
    ds_write_b128 v61, v[12:15] offset:61440
    s_waitcnt lgkmcnt(0)
    buffer_load_dword v24, off, s[96:99], 0 offset:216 sc1
    buffer_load_dword v25, off, s[96:99], 0 offset:64 sc1
    s_lshr_b32 s84, s12, 1
    s_lshl_b32 s84, s84, 8
    s_add_u32 s84, s84, 125829120
    v_bfe_u32 v26, v61, 4, 6
    v_min_u32 v26, 11, v26
    v_lshlrev_b32 v26, 2, v26
    buffer_load_dword v27, v26, s[4:7], s84 offen sc1
    s_waitcnt vmcnt(15)
    v_add_u32 v55, 147456, v53
    ds_read_b64_tr_b16 v[0:1], v55 offset:0
    ds_read_b64_tr_b16 v[2:3], v55 offset:128
    ds_read_b64_tr_b16 v[4:5], v55 offset:512
    ds_read_b64_tr_b16 v[6:7], v55 offset:640
    ds_read_b64_tr_b16 v[8:9], v55 offset:8192
    ds_read_b64_tr_b16 v[10:11], v55 offset:8320
    ds_read_b64_tr_b16 v[12:13], v55 offset:8704
    ds_read_b64_tr_b16 v[14:15], v55 offset:8832
    s_waitcnt lgkmcnt(0)
    s_barrier
    ds_write_b128 v63, v[0:3] offset:49152
    ds_write_b128 v63, v[4:7] offset:53248
    s_barrier
    ds_write_b128 v63, v[8:11] offset:57344
    ds_write_b128 v63, v[12:15] offset:61440
    s_waitcnt lgkmcnt(0)
    v_lshlrev_b32 v45, 3, v61
    s_lshl_b32 s40, s12, 14
    s_add_u32 s40, s40, 65536
    s_lshl_b32 s41, s12, 11
    s_sub_u32 s41, s41, 12288
    v_add_u32 v30, s40, v45
    v_add_u32 v45, s41, v45
    v_cmp_gt_u32 vcc, 1536, v61
    s_nop 1
    v_cndmask_b32 v45, v45, v30, vcc
    s_lshl_b32 s40, s12, 16
    s_add_u32 s40, s40, 24102912
    v_lshlrev_b32 v30, 3, v61
    v_add_u32 v30, s40, v30
    v_cmp_gt_u32 vcc, 1792, v61
    s_nop 1
    v_cndmask_b32 v45, v30, v45, vcc
    v_cmp_gt_u32 vcc, 2944, v61
    s_mov_b32 s40, 68157440
    s_mov_b64 exec, vcc
    buffer_load_dword v30, v45, s[4:7], s40 offen sc1
    s_mov_b64 exec, -1
    s_waitcnt vmcnt(11)
    v_add_u32 v55, 131072, v52
    ds_read_b64_tr_b16 v[0:1], v55 offset:0
    ds_read_b64_tr_b16 v[2:3], v55 offset:256
    ds_read_b64_tr_b16 v[4:5], v55 offset:4096
    ds_read_b64_tr_b16 v[6:7], v55 offset:4352
    ds_read_b64_tr_b16 v[8:9], v55 offset:64
    ds_read_b64_tr_b16 v[10:11], v55 offset:320
    ds_read_b64_tr_b16 v[12:13], v55 offset:4160
    ds_read_b64_tr_b16 v[14:15], v55 offset:4416
    s_waitcnt lgkmcnt(0)
    s_barrier
    ds_write_b128 v63, v[0:3] offset:32768
    ds_write_b128 v63, v[4:7] offset:36864
    s_barrier
    ds_write_b128 v63, v[8:11] offset:40960
    ds_write_b128 v63, v[12:15] offset:45056
    s_waitcnt lgkmcnt(0)
    s_waitcnt vmcnt(7)
    v_add_u32 v55, 114688, v52
    ds_read_b64_tr_b16 v[0:1], v55 offset:0
    ds_read_b64_tr_b16 v[2:3], v55 offset:256
    ds_read_b64_tr_b16 v[4:5], v55 offset:4096
    ds_read_b64_tr_b16 v[6:7], v55 offset:4352
    ds_read_b64_tr_b16 v[8:9], v55 offset:64
    ds_read_b64_tr_b16 v[10:11], v55 offset:320
    ds_read_b64_tr_b16 v[12:13], v55 offset:4160
    ds_read_b64_tr_b16 v[14:15], v55 offset:4416
    s_waitcnt lgkmcnt(0)
    s_barrier
    ds_write_b128 v63, v[0:3] offset:16384
    ds_write_b128 v63, v[4:7] offset:20480
    s_barrier
    ds_write_b128 v63, v[8:11] offset:24576
    ds_write_b128 v63, v[12:15] offset:28672
    s_waitcnt lgkmcnt(0)
    v_min_u32 v36, -2, v36
    v_min_u32 v37, -2, v37
    v_min_u32 v38, -2, v38
    v_min_u32 v39, -2, v39
    v_min_u32 v40, -2, v40
    v_min_u32 v41, -2, v41
    v_min_u32 v42, -2, v42
    v_min_u32 v43, -2, v43
    v_min_u32 v44, -2, v44
    s_lshl_b32 s14, s12, 16
    s_add_u32 s14, s14, 92274688
    s_add_u32 s41, s14, 4096
    s_add_u32 s42, s14, 8192
    v_lshrrev_b32 v45, 2, v61
    buffer_store_dwordx4 v[36:39], v61, s[4:7], s14 offen sc1
    buffer_store_dwordx4 v[40:43], v61, s[4:7], s41 offen sc1
    buffer_store_dword v44, v45, s[4:7], s42 offen sc1
    s_waitcnt vmcnt(1)
    v_readfirstlane_b32 s95, v25
    v_readfirstlane_b32 s85, v24
    s_add_u32 s86, s95, 2
    s_waitcnt vmcnt(0)
    v_subrev_u32 v27, s86, v27
    v_cmp_lt_u32 s[86:87], 64, v27
    s_cmp_eq_u32 s95, 0
    s_cselect_b64 s[86:87], -1, s[86:87]
    s_cmp_lg_u64 s[86:87], 0
    s_cbranch_scc1 cs_nt
    s_add_u32 s40, s24, 524288
    buffer_load_dword v30, v79, s[4:7], s24 offen sc1
    buffer_load_dword v30, v79, s[4:7], s40 offen sc1
cs_nt:
    s_waitcnt vmcnt(3)
    v_add_u32 v55, 81920, v51
    v_xor_b32 v56, 32, v55
    ds_read_b64_tr_b16 v[0:1], v55 offset:0
    ds_read_b64_tr_b16 v[2:3], v55 offset:256
    ds_read_b64_tr_b16 v[4:5], v55 offset:8192
    ds_read_b64_tr_b16 v[6:7], v55 offset:8448
    ds_read_b64_tr_b16 v[8:9], v56 offset:0
    ds_read_b64_tr_b16 v[10:11], v56 offset:256
    ds_read_b64_tr_b16 v[12:13], v56 offset:8192
    ds_read_b64_tr_b16 v[14:15], v56 offset:8448
    s_waitcnt lgkmcnt(0)
    ds_write_b128 v62, v[0:3] offset:24576
    ds_write_b128 v62, v[4:7] offset:28672
    ds_write_b128 v62, v[8:11] offset:32768
    ds_write_b128 v62, v[12:15] offset:36864
    s_waitcnt lgkmcnt(0)
    s_barrier
    s_mov_b32 s88, 4194304
gn3:
    s_cmp_lg_u32 s95, 0
    s_cbranch_scc1 gn3x
    buffer_load_dword v27, off, s[96:99], 0 offset:64 sc1
    s_sub_u32 s88, s88, 1
    s_cbranch_scc1 gn3x
    s_waitcnt vmcnt(0)
    v_readfirstlane_b32 s95, v27
    s_nop 1
    s_branch gn3
gn3x:
    ds_write_b128 v78, v[16:19] offset:8704
    ds_write_b128 v65, v[20:23] offset:10240
    v_mov_b32 v44, s95
    v_mov_b32 v45, s95
    v_mov_b32 v46, s95
    v_mov_b32 v47, s95
    v_mov_b32 v48, 108288
    ds_write_b128 v48, v[44:47]
    s_waitcnt vmcnt(0) lgkmcnt(0)
    s_cmp_eq_u32 s85, 1
    s_cbranch_scc1 cs_run
    s_mov_b32 s40, 16777216
cs_startpoll:
    buffer_load_dword v3, off, s[96:99], 0 offset:216 sc1
    s_waitcnt vmcnt(0)
    v_readfirstlane_b32 s85, v3
    s_nop 0
    s_cmp_eq_u32 s85, 1
    s_cbranch_scc1 cs_run
    s_sleep 1
    s_sub_u32 s40, s40, 1
    s_cbranch_scc0 cs_startpoll
    s_endpgm
cs_run:
    s_cmp_eq_u64 s[86:87], 0
    s_cbranch_scc1 cs_kvok
    s_lshr_b32 s92, s12, 1
    s_lshl_b32 s92, s92, 8
    s_add_u32 s92, s92, 125829120
    v_bfe_u32 v2, v61, 4, 6
    v_min_u32 v2, 11, v2
    v_lshlrev_b32 v2, 2, v2
    s_add_u32 s93, s95, 2
    s_mov_b32 s94, 4194304
cs_kv0:
    buffer_load_dword v3, v2, s[4:7], s92 offen sc1
    s_sub_u32 s94, s94, 1
    s_cbranch_scc1 cs_kv0_go
    s_waitcnt vmcnt(0)
    v_subrev_u32 v3, s93, v3
    v_cmp_lt_u32 vcc, 64, v3
    s_cbranch_vccz cs_kv0_go
    s_sleep 2
    s_branch cs_kv0
cs_kv0_go:
    s_add_u32 s40, s24, 524288
    buffer_load_dword v30, v79, s[4:7], s24 offen sc1
    buffer_load_dword v30, v79, s[4:7], s40 offen sc1
    s_waitcnt vmcnt(0)
cs_kvok:
    s_mov_b32 m0, 108032
    s_add_u32 s24, s24, 1048576
    s_mov_b32 s66, 0x201
    s_mov_b32 s67, 0xc0000000
    s_add_u32 s15, s14, 4096
    s_add_u32 s16, s14, 8192
    ds_read_b128 v[32:35], v62 offset:16384
    ds_read_b128 v[36:39], v62 offset:20480
    ds_read_b128 v[40:43], v61 offset:0
    ds_read_b128 v[44:47], v61 offset:4096
    ds_read_b128 v[48:51], v61 offset:8192
    ds_read_b128 v[52:55], v61 offset:12288
    s_add_u32 s18, s14, s31
    s_mov_b32 s29, 1048576
    buffer_load_dwordx4 v[24:27], v61, s[4:7], s14 offen sc1
.p2align 6
cs_loop:
    v_mov_b64 v[0:1], 0
    v_mov_b64 v[2:3], 0
    v_mov_b64 v[4:5], 0
    v_mov_b64 v[6:7], 0
    v_mov_b64 v[8:9], 0
    v_mov_b64 v[10:11], 0
    v_mov_b64 v[12:13], 0
    v_mov_b64 v[14:15], 0
cs_loop2:
    ds_read_b128 v[16:19], v62 offset:8192
    ds_read_b128 v[20:23], v62 offset:12288
    v_lshrrev_b32 v56, 2, v61
    v_add_u32 v58, 106496, v56
    s_mov_b32 s29, 1048576
    s_waitcnt lgkmcnt(0)
cs_chk0:
    s_waitcnt vmcnt(0)
cs_chk0b:
    v_max3_u32 v57, v24, v25, v26
    v_max_u32 v57, v57, v27
    v_cmp_eq_u32 vcc, -1, v57
    ds_write_b128 v62, v[24:27] offset:40960
    s_cbranch_vccnz cs_spin0
    v_smfmac_f32_16x16x64_bf16 v[0:3], v[24:27], v[16:23], v60
    buffer_load_dwordx4 v[28:31], v61, s[4:7], s15 offen sc1
    buffer_load_dword v59, v56, s[4:7], s16 offen sc1
    v_smfmac_f32_16x16x64_bf16 v[8:11], v[24:27], v[32:39], v60
    ds_read_b128 v[32:35], v61 offset:16384
    v_smfmac_f32_16x16x64_bf16 v[12:15], v[24:27], v[48:55], v60
    ds_read_b128 v[36:39], v61 offset:20480
    v_mfma_f32_16x16x16_bf16 v[16:19], v[72:73], v[72:73], 0
    s_waitcnt lgkmcnt(2)
    s_barrier
    ds_read_b128 v[48:51], v63 offset:0
    v_mfma_f32_16x16x16_bf16 v[20:23], v[72:73], v[72:73], 0
    ds_read_b128 v[52:55], v64 offset:0
    v_smfmac_f32_16x16x64_bf16 v[4:7], v[24:27], v[40:47], v60
    ds_read_b128 v[40:43], v61 offset:24576
    v_smfmac_f32_16x16x64_bf16 v[16:19], v[24:27], a[192:199], v60
    ds_read_b128 v[44:47], v61 offset:28672
    v_smfmac_f32_16x16x64_bf16 v[20:23], v[24:27], a[200:207], v60
    s_waitcnt lgkmcnt(3)
    v_smfmac_f32_16x16x64_bf16 v[0:3], v[48:51], a[0:7], v60
    s_add_u32 s43, s14, s31
    s_add_u32 s41, s14, 16384
    v_smfmac_f32_16x16x64_bf16 v[4:7], v[48:51], v[32:39], v60
    ds_read_b128 v[32:35], v61 offset:32768
    v_smfmac_f32_16x16x64_bf16 v[8:11], v[48:51], a[8:15], v60
    ds_read_b128 v[36:39], v61 offset:36864
    s_waitcnt lgkmcnt(2)
    v_smfmac_f32_16x16x64_bf16 v[12:15], v[48:51], v[40:47], v60
    ds_read_b128 v[40:43], v61 offset:40960
    v_smfmac_f32_16x16x64_bf16 v[0:3], v[52:55], a[16:23], v60
    ds_read_b128 v[44:47], v61 offset:45056
    v_smfmac_f32_16x16x64_bf16 v[8:11], v[52:55], a[24:31], v60
    ds_read_b128 v[48:51], v71 offset:0
    s_waitcnt lgkmcnt(3)
    v_smfmac_f32_16x16x64_bf16 v[4:7], v[52:55], v[32:39], v60
    s_waitcnt vmcnt(0)
    ds_write_b128 v62, v[28:31] offset:45056
    s_waitcnt lgkmcnt(2)
    v_smfmac_f32_16x16x64_bf16 v[12:15], v[52:55], v[40:47], v60
    ds_write_b32 v58, v59
    v_max3_u32 v57, v28, v29, v30
    s_waitcnt lgkmcnt(2)
    v_smfmac_f32_16x16x64_bf16 v[0:3], v[48:51], a[32:39], v60
    ds_read_b128 v[32:35], v61 offset:49152
    v_max3_u32 v57, v57, v31, v59
    v_smfmac_f32_16x16x64_bf16 v[8:11], v[48:51], a[40:47], v60
    ds_read_b128 v[36:39], v61 offset:53248
    v_cmp_eq_u32 vcc, -1, v57
    v_smfmac_f32_16x16x64_bf16 v[16:19], v[52:55], a[224:231], v60
    ds_read_b128 v[40:43], v61 offset:57344
    v_smfmac_f32_16x16x64_bf16 v[20:23], v[52:55], a[232:239], v60
    ds_read_b128 v[44:47], v61 offset:61440
    s_cbranch_vccnz cs_spin1
cs_go1:
    v_smfmac_f32_16x16x64_bf16 v[0:3], v[28:31], a[48:55], v60
    s_waitcnt lgkmcnt(4)
    s_barrier
    ds_read_b128 v[52:55], v63 offset:4096
    v_smfmac_f32_16x16x64_bf16 v[8:11], v[28:31], a[56:63], v60
    ds_read_b128 v[56:59], v71 offset:4096
    v_smfmac_f32_16x16x64_bf16 v[4:7], v[28:31], a[128:135], v60
    s_waitcnt lgkmcnt(2)
    v_smfmac_f32_16x16x64_bf16 v[4:7], v[48:51], v[32:39], v60
    buffer_load_dwordx4 v[32:35], v61, s[4:7], s23 offen offset:0 sc1
    v_smfmac_f32_16x16x64_bf16 v[12:15], v[48:51], v[40:47], v60
    ds_read_b128 v[48:51], v64 offset:4096
    v_smfmac_f32_16x16x64_bf16 v[12:15], v[28:31], a[136:143], v60
    ds_read_b128 v[24:27], v65 offset:8192
    s_and_b32 s41, s41, 65535
    s_add_u32 s41, s41, 68157440
    v_smfmac_f32_16x16x64_bf16 v[16:19], v[28:31], v[80:87], v60
    buffer_load_dwordx4 v[36:39], v61, s[4:7], s23 offen offset:1024 sc1
    v_smfmac_f32_16x16x64_bf16 v[20:23], v[28:31], v[88:95], v60
    s_add_u32 s17, s41, s31
    s_and_b32 s30, s28, 1
    s_waitcnt lgkmcnt(3)
    v_smfmac_f32_16x16x64_bf16 v[0:3], v[52:55], a[64:71], v60
    ds_read_b128 v[28:31], v78 offset:8704
    v_smfmac_f32_16x16x64_bf16 v[4:7], v[52:55], a[144:151], v60
    buffer_load_dwordx4 v[40:43], v61, s[4:7], s23 offen offset:2048 sc1
    v_smfmac_f32_16x16x64_bf16 v[8:11], v[52:55], a[72:79], v60
    v_smfmac_f32_16x16x64_bf16 v[12:15], v[52:55], a[152:159], v60
    v_smfmac_f32_16x16x64_bf16 v[16:19], v[52:55], v[96:103], v60
    buffer_load_dwordx4 v[44:47], v61, s[4:7], s23 offen offset:3072 sc1
    v_smfmac_f32_16x16x64_bf16 v[20:23], v[52:55], v[104:111], v60
    ds_read_b128 v[52:55], v62 offset:28672
    s_waitcnt lgkmcnt(3)
    v_smfmac_f32_16x16x64_bf16 v[0:3], v[48:51], a[80:87], v60
    v_smfmac_f32_16x16x64_bf16 v[4:7], v[48:51], a[160:167], v60
    v_smfmac_f32_16x16x64_bf16 v[8:11], v[48:51], a[88:95], v60
    v_smfmac_f32_16x16x64_bf16 v[12:15], v[48:51], a[168:175], v60
    v_smfmac_f32_16x16x64_bf16 v[16:19], v[48:51], v[112:119], v60
    buffer_load_dword v79, s[4:7], s24 offen sc1 lds
    v_smfmac_f32_16x16x64_bf16 v[20:23], v[48:51], v[120:127], v60
    ds_read_b128 v[48:51], v62 offset:24576
    v_smfmac_f32_16x16x64_bf16 v[0:3], v[56:59], a[96:103], v60
    s_bitcmp1_b64 s[66:67], s28
    v_smfmac_f32_16x16x64_bf16 v[8:11], v[56:59], a[104:111], v60
    s_waitcnt lgkmcnt(3)
    v_smfmac_f32_16x16x64_bf16 v[0:3], v[24:27], a[112:119], v60
    v_smfmac_f32_16x16x64_bf16 v[8:11], v[24:27], a[120:127], v60
    v_smfmac_f32_16x16x64_bf16 v[4:7], v[56:59], a[176:183], v60
    s_waitcnt lgkmcnt(0)
    v_cvt_pk_bf16_f32 v0, v0, v1
    v_smfmac_f32_16x16x64_bf16 v[4:7], v[24:27], v[48:55], v60
    ds_read_b128 v[48:51], v62 offset:32768
    v_cvt_pk_bf16_f32 v8, v8, v9
    v_smfmac_f32_16x16x64_bf16 v[12:15], v[56:59], a[184:191], v60
    ds_read_b128 v[52:55], v62 offset:36864
    v_cvt_pk_bf16_f32 v9, v10, v11
    v_smfmac_f32_16x16x64_bf16 v[16:19], v[56:59], v[128:135], v60
    v_cvt_pk_bf16_f32 v1, v2, v3
    v_mfma_f32_16x16x16_bf16 v[8:11], v[8:9], v[28:29], 0
    v_cvt_pk_bf16_f32 v2, v4, v5
    v_cvt_pk_bf16_f32 v3, v6, v7
    v_smfmac_f32_16x16x64_bf16 v[20:23], v[56:59], v[136:143], v60
    s_mov_b64 exec, s[36:37]
    ds_read_b128 v[56:59], v69
    s_mov_b64 exec, -1
    v_mfma_f32_16x16x32_bf16 v[4:7], v[0:3], v[28:31], 0
    v_cvt_pk_bf16_f32 v2, v8, v9
    s_waitcnt lgkmcnt(1)
    v_smfmac_f32_16x16x64_bf16 v[12:15], v[24:27], v[48:55], v60
    ds_read_b128 v[48:51], v63 offset:0
    v_cvt_pk_bf16_f32 v3, v10, v11
    s_waitcnt vmcnt(3)
    v_cvt_pk_bf16_f32 v0, v4, v5
    v_cvt_pk_bf16_f32 v1, v6, v7
    s_nop 1
    v_mfma_f32_16x16x32_bf16 v[4:7], v[36:39], v[0:3], 0
    v_cvt_pk_bf16_f32 v12, v12, v13
    v_cvt_pk_bf16_f32 v13, v14, v15
    s_nop 1
    v_mfma_f32_16x16x16_bf16 v[12:15], v[12:13], v[30:31], 0
    ds_read_b128 v[52:55], v71 offset:0
    ds_read_b128 v[36:39], v63 offset:53248
    v_mfma_f32_16x16x32_bf16 v[28:31], v[32:35], v[0:3], 0
    s_waitcnt vmcnt(1)
    ds_read_b128 v[32:35], v63 offset:49152
    s_mov_b64 exec, s[34:35]
    s_nop 0
    v_cvt_pk_bf16_f32 v2, v12, v13
    v_cvt_pk_bf16_f32 v3, v14, v15
    s_mov_b64 exec, -1
    s_nop 0
    v_mfma_f32_16x16x32_bf16 v[8:11], v[0:3], v[0:3], 0
    v_mov_b32_dpp v28, v4 row_ror:8 row_mask:0xf bank_mask:0xc
    v_mov_b32_dpp v29, v5 row_ror:8 row_mask:0xf bank_mask:0xc
    v_mov_b32_dpp v30, v6 row_ror:8 row_mask:0xf bank_mask:0xc
    v_mov_b32_dpp v31, v7 row_ror:8 row_mask:0xf bank_mask:0xc
    v_smfmac_f32_16x16x64_bf16 v[16:19], v[24:27], v[144:151], v60
    ds_write_b128 v62, v[28:31] offset:53248
    v_mov_b32_dpp v8, v10 row_ror:8 row_mask:0xf bank_mask:0xc
    v_mov_b32_dpp v9, v11 row_ror:8 row_mask:0xf bank_mask:0xc
    v_smfmac_f32_16x16x64_bf16 v[20:23], v[24:27], v[152:159], v60
    ds_write_b64 v70, v[8:9]
    s_waitcnt lgkmcnt(5)
    v_smfmac_f32_16x16x64_bf16 v[16:19], v[48:51], a[208:215], v60
    s_mov_b64 exec, s[36:37]
    s_cbranch_execz cs_np3680
    buffer_store_dwordx4 v[56:59], v61, s[4:7], s65 offen sc1
cs_np3680:
    s_mov_b64 exec, -1
    v_smfmac_f32_16x16x64_bf16 v[20:23], v[48:51], a[216:223], v60
    s_cbranch_scc1 cs_last
cs_back:
    s_waitcnt lgkmcnt(0)
    s_barrier
    ds_read_b128 v[56:59], v78 offset:10752
    v_smfmac_f32_16x16x64_bf16 v[16:19], v[52:55], a[240:247], v60
    ds_read_b128 v[12:15], v78 offset:11264
    ds_read_b128 v[4:7], v63 offset:12288
    v_smfmac_f32_16x16x64_bf16 v[20:23], v[52:55], a[248:255], v60
    ds_read_b128 v[8:11], v64 offset:12288
    ds_read_b128 v[0:3], v71 offset:12288
    v_mov_b64 v[24:25], s[62:63]
    v_mov_b64 v[26:27], s[60:61]
    v_cvt_pk_bf16_f32 v16, v16, v17
    v_cvt_pk_bf16_f32 v17, v18, v19
    v_pk_mul_f32 v[28:29], v[28:29], s[44:45]
    v_pk_mul_f32 v[30:31], v[30:31], s[44:45]
    s_waitcnt lgkmcnt(3)
    v_pk_add_f32 v[56:57], v[56:57], v[58:59]
    v_pk_add_f32 v[12:13], v[12:13], v[14:15]
    v_pk_add_f32 v[56:57], v[56:57], v[12:13]
    v_pk_mul_f32 v[56:57], v[56:57], s[44:45]
    v_exp_f32 v58, v56
    v_exp_f32 v59, v57
    s_waitcnt lgkmcnt(1)
    v_pk_fma_f32 v[28:29], v[4:5], s[44:45], v[28:29]
    v_pk_fma_f32 v[30:31], v[6:7], s[44:45], v[30:31]
    v_cvt_pk_bf16_f32 v6, v58, v59
    v_pk_fma_f32 v[28:29], v[8:9], s[44:45], v[28:29]
    v_pk_fma_f32 v[30:31], v[10:11], s[44:45], v[30:31]
    s_waitcnt lgkmcnt(0)
    v_pk_fma_f32 v[28:29], v[0:1], s[44:45], v[28:29]
    v_mov_b32_dpp v7, v6 row_ror:8 row_mask:0xf bank_mask:0xf
    v_pk_fma_f32 v[30:31], v[2:3], s[44:45], v[30:31]
    v_exp_f32 v0, v28
    v_mfma_f32_16x16x16_bf16 v[12:15], v[16:17], v[6:7], 0
    ds_read_b128 v[48:51], v63 offset:57344
    v_exp_f32 v1, v29
    v_cvt_pk_bf16_f32 v18, v20, v21
    v_exp_f32 v2, v30
    v_cvt_pk_bf16_f32 v19, v22, v23
    v_cvt_pk_bf16_f32 v8, v0, v1
    v_exp_f32 v3, v31
    v_mfma_f32_16x16x16_bf16 v[20:23], v[18:19], v[6:7], 0
    ds_read_b128 v[52:55], v63 offset:61440
    v_cvt_pk_bf16_f32 v9, v2, v3
    v_mov_b32_dpp v10, v8 row_ror:8 row_mask:0xf bank_mask:0xf
    v_max3_f32 v4, |v28|, |v29|, |v30|
    v_mov_b32_dpp v11, v9 row_ror:8 row_mask:0xf bank_mask:0xf
    v_mfma_f32_16x16x32_bf16 v[0:3], v[24:27], v[6:9], 0
    v_max3_f32 v4, v4, |v31|, |v56|
    v_max_f32_e64 v4, v4, |v57|
    v_mfma_f32_16x16x32_bf16 v[12:15], v[40:43], v[8:11], v[12:15]
    v_cmp_nge_f32 vcc, s46, v4
    v_mfma_f32_16x16x32_bf16 v[20:23], v[44:47], v[8:11], v[20:23]
    v_add_f32_dpp v0, v0, v0 row_ror:8 row_mask:0xf bank_mask:0xf
    v_rcp_f32 v0, v0
    s_cbranch_vccnz cs_guard
cs_norm:
    v_mfma_f32_16x16x16_bf16 v[28:31], v[72:73], v[72:73], 0
    v_mul_f32 v12, v12, v0
    v_mul_f32 v13, v13, v0
    v_mul_f32 v14, v14, v0
    v_mul_f32 v15, v15, v0
    v_mul_f32_dpp v12, v20, v0 row_ror:8 row_mask:0xf bank_mask:0xc
    v_mul_f32_dpp v13, v21, v0 row_ror:8 row_mask:0xf bank_mask:0xc
    v_mul_f32_dpp v14, v22, v0 row_ror:8 row_mask:0xf bank_mask:0xc
    v_mul_f32_dpp v15, v23, v0 row_ror:8 row_mask:0xf bank_mask:0xc
    v_cvt_pk_bf16_f32 v12, v12, v13
    v_cvt_pk_bf16_f32 v13, v14, v15
    v_mfma_f32_16x16x16_bf16 v[8:11], v[72:73], v[72:73], 0
    ds_write_b64 v77, v[12:13]
    v_mfma_f32_16x16x16_bf16 v[4:7], v[72:73], v[72:73], 0
    ds_read_b128 v[0:3], v68
    v_mfma_f32_16x16x16_bf16 v[16:19], v[72:73], v[72:73], 0
    ds_read_b128 v[40:43], v63 offset:16384
    v_mfma_f32_16x16x16_bf16 v[20:23], v[72:73], v[72:73], 0
    ds_read_b128 v[44:47], v63 offset:20480
    s_waitcnt lgkmcnt(3)
    s_barrier
    ds_read_b128 v[24:27], v74
    ds_read_b128 v[12:15], v75
    ds_read_b128 v[56:59], v76
    s_waitcnt lgkmcnt(5)
    v_smfmac_f32_16x16x64_bf16 v[28:31], v[0:3], v[160:167], v60
    v_smfmac_f32_16x16x64_bf16 v[8:11], v[0:3], v[192:199], v60
    v_smfmac_f32_16x16x64_bf16 v[4:7], v[0:3], v[32:39], v60
    ds_read_b128 v[32:35], v63 offset:32768
    v_smfmac_f32_16x16x64_bf16 v[16:19], v[0:3], v[224:231], v60
    ds_read_b128 v[36:39], v63 offset:36864
    s_waitcnt lgkmcnt(3)
    v_smfmac_f32_16x16x64_bf16 v[28:31], v[24:27], v[168:175], v60
    v_smfmac_f32_16x16x64_bf16 v[4:7], v[12:15], v[48:55], v60
    ds_read_b128 v[48:51], v63 offset:24576
    v_smfmac_f32_16x16x64_bf16 v[28:31], v[12:15], v[176:183], v60
    ds_read_b128 v[52:55], v63 offset:28672
    s_waitcnt lgkmcnt(4)
    v_smfmac_f32_16x16x64_bf16 v[28:31], v[56:59], v[184:191], v60
    v_cvt_pk_bf16_f32 v4, v4, v5
    v_smfmac_f32_16x16x64_bf16 v[16:19], v[12:15], v[40:47], v60
    ds_read_b128 v[40:43], v63 offset:40960
    v_and_or_b32 v4, v4, -2, s30
    v_smfmac_f32_16x16x64_bf16 v[8:11], v[24:27], v[200:207], v60
    ds_read_b128 v[44:47], v63 offset:45056
    v_cvt_pk_bf16_f32 v5, v6, v7
    v_smfmac_f32_16x16x64_bf16 v[8:11], v[12:15], v[208:215], v60
    buffer_store_dwordx2 v[4:5], v67, s[4:7], s22 offen sc1
    v_cvt_pk_bf16_f32 v28, v28, v29
    v_smfmac_f32_16x16x64_bf16 v[8:11], v[56:59], v[216:223], v60
    v_and_or_b32 v28, v28, -2, s30
    v_smfmac_f32_16x16x64_bf16 v[16:19], v[24:27], v[232:239], v60
    v_cvt_pk_bf16_f32 v29, v30, v31
    s_waitcnt lgkmcnt(4)
    v_smfmac_f32_16x16x64_bf16 v[16:19], v[56:59], v[32:39], v60
    buffer_store_dwordx2 v[28:29], v66, s[4:7], s20 offen sc1
    v_cvt_pk_bf16_f32 v8, v8, v9
    s_waitcnt lgkmcnt(0)
    v_smfmac_f32_16x16x64_bf16 v[20:23], v[0:3], v[240:247], v60
    v_and_or_b32 v8, v8, -2, s30
    v_smfmac_f32_16x16x64_bf16 v[20:23], v[24:27], v[248:255], v60
    v_cvt_pk_bf16_f32 v9, v10, v11
    v_smfmac_f32_16x16x64_bf16 v[20:23], v[12:15], v[48:55], v60
    buffer_store_dwordx2 v[8:9], v66, s[4:7], s21 offen sc1
    v_cvt_pk_bf16_f32 v16, v16, v17
    v_smfmac_f32_16x16x64_bf16 v[20:23], v[56:59], v[40:47], v60
    v_and_or_b32 v16, v16, -2, s30
    v_cvt_pk_bf16_f32 v17, v18, v19
    buffer_store_dwordx2 v[16:17], v66, s[4:7], s38 offen sc1
    s_cmp_lg_u32 s13, 2
    s_nop 1
    v_cvt_pk_bf16_f32 v20, v20, v21
    v_and_or_b32 v20, v20, -2, s30
    v_cvt_pk_bf16_f32 v21, v22, v23
    buffer_store_dwordx2 v[20:21], v66, s[4:7], s39 offen sc1
    s_cbranch_scc1 cs_w013
    v_mov_b32 v21, -1
    s_mov_b64 exec, s[32:33]
    buffer_store_dword v21, v69, s[4:7], s18 offen sc1
    s_mov_b64 exec, -1
    s_mov_b32 s18, s43
    s_nop 15
    s_nop 15
    s_nop 15
    s_nop 15
    s_nop 15
    s_nop 15
    s_nop 15
    s_nop 15
    s_nop 15
    s_nop 15
    s_nop 15
    s_nop 15
    s_nop 0
    buffer_load_dwordx4 v[40:43], v65, s[4:7], s19 offen offset:0 sc1
    buffer_load_dwordx4 v[44:47], v65, s[4:7], s19 offen offset:1024 sc1
    buffer_load_dwordx4 v[48:51], v65, s[4:7], s19 offen offset:2048 sc1
    buffer_load_dwordx4 v[52:55], v65, s[4:7], s19 offen offset:3072 sc1
    ds_read_b128 v[56:59], v65 offset:10240
    s_add_u32 s28, s28, 1
    s_mov_b32 s14, s41
    s_add_u32 s23, s23, 524288
    s_add_u32 s24, s24, 524288
    s_min_u32 s24, s24, s47
    s_add_u32 s15, s14, 4096
    s_add_u32 s16, s14, 8192
    s_add_u32 s65, s65, 12288
    s_mov_b32 s40, 1
    v_mov_b64 v[0:1], 0
    v_mov_b64 v[2:3], 0
    v_mov_b64 v[4:5], 0
    v_mov_b64 v[6:7], 0
    v_mov_b64 v[8:9], 0
    v_mov_b64 v[10:11], 0
    v_mov_b64 v[12:13], 0
    v_mov_b64 v[14:15], 0
cs_chkF:
    v_mov_b32 v20, 0
    s_waitcnt vmcnt(3)
    s_waitcnt lgkmcnt(0)
    v_mfma_f32_16x16x32_bf16 v[28:31], v[40:43], v[56:59], 0
    v_bitop3_b32 v20, v20, v40, s30 bitop3:0xf6
    v_bitop3_b32 v20, v20, v42, s30 bitop3:0xf6
    s_waitcnt vmcnt(2)
    v_mfma_f32_16x16x32_bf16 v[28:31], v[44:47], v[56:59], v[28:31]
    v_bitop3_b32 v20, v20, v44, s30 bitop3:0xf6
    v_bitop3_b32 v20, v20, v46, s30 bitop3:0xf6
    s_waitcnt vmcnt(1)
    v_mfma_f32_16x16x32_bf16 v[28:31], v[48:51], v[56:59], v[28:31]
    v_bitop3_b32 v20, v20, v48, s30 bitop3:0xf6
    v_bitop3_b32 v20, v20, v50, s30 bitop3:0xf6
    s_waitcnt vmcnt(0)
    v_mfma_f32_16x16x32_bf16 v[28:31], v[52:55], v[56:59], v[28:31]
    v_bitop3_b32 v20, v20, v52, s30 bitop3:0xf6
    v_bitop3_b32 v20, v20, v54, s30 bitop3:0xf6
    v_and_b32 v20, s40, v20
    v_cmp_ne_u32 vcc, 0, v20
    s_cbranch_vccnz cs_spinF
    v_permlane32_swap_b32 v28, v30
    v_permlane32_swap_b32 v29, v31
    v_add_f32 v28, v28, v30
    v_add_f32 v30, v29, v31
    v_cvt_pk_bf16_f32 v28, v28, v30
    s_mov_b64 exec, s[32:33]
    buffer_store_dword v28, v69, s[4:7], s17 offen sc1
    s_mov_b64 exec, -1
    ds_read_b128 v[32:35], v62 offset:16384
    ds_read_b128 v[36:39], v62 offset:20480
    ds_read_b128 v[40:43], v61 offset:0
    ds_read_b128 v[44:47], v61 offset:4096
    ds_read_b128 v[48:51], v61 offset:8192
    ds_read_b128 v[52:55], v61 offset:12288
    s_nop 15
    s_nop 15
    s_nop 15
    s_nop 15
    s_nop 15
    s_nop 15
    s_nop 3
    buffer_load_dwordx4 v[24:27], v61, s[4:7], s14 offen sc1
    s_branch cs_loop2
cs_w013:
    ds_read_b128 v[56:59], v65 offset:10240
    ds_read_b128 v[32:35], v62 offset:16384
    ds_read_b128 v[36:39], v62 offset:20480
    ds_read_b128 v[40:43], v61 offset:0
    ds_read_b128 v[44:47], v61 offset:4096
    ds_read_b128 v[48:51], v61 offset:8192
    ds_read_b128 v[52:55], v61 offset:12288
    s_add_u32 s28, s28, 1
    s_mov_b32 s14, s41
    s_add_u32 s23, s23, 524288
    s_add_u32 s24, s24, 524288
    s_min_u32 s24, s24, s47
    s_add_u32 s15, s14, 4096
    s_add_u32 s16, s14, 8192
    s_add_u32 s65, s65, 12288
    s_mov_b32 s40, 1
    s_cmp_eq_u32 s64, 0
    s_cbranch_scc1 cs_w0
    v_mov_b32 v21, -1
    s_mov_b64 exec, s[32:33]
    buffer_store_dword v21, v69, s[4:7], s18 offen sc1
    s_mov_b64 exec, -1
    s_mov_b32 s18, s43
    s_cmp_eq_u32 s13, 1
    s_cbranch_scc1 cs_sx
    s_nop 15
    s_nop 15
    s_nop 15
    s_nop 15
    s_nop 15
    s_nop 15
    s_nop 15
    s_nop 15
    s_nop 15
    s_nop 15
    s_nop 15
    s_nop 15
    s_nop 7
cs_sx:
    buffer_load_dwordx4 v[0:3], v65, s[4:7], s19 offen offset:0 sc1
    buffer_load_dwordx4 v[4:7], v65, s[4:7], s19 offen offset:1024 sc1
    buffer_load_dwordx4 v[8:11], v65, s[4:7], s19 offen offset:2048 sc1
    buffer_load_dwordx4 v[12:15], v65, s[4:7], s19 offen offset:3072 sc1
cs_chkG:
    v_mov_b32 v20, 0
    s_waitcnt vmcnt(3)
    s_waitcnt lgkmcnt(6)
    v_mfma_f32_16x16x32_bf16 v[28:31], v[0:3], v[56:59], 0
    v_bitop3_b32 v20, v20, v0, s30 bitop3:0xf6
    v_bitop3_b32 v20, v20, v2, s30 bitop3:0xf6
    s_waitcnt vmcnt(2)
    v_mfma_f32_16x16x32_bf16 v[28:31], v[4:7], v[56:59], v[28:31]
    v_bitop3_b32 v20, v20, v4, s30 bitop3:0xf6
    v_bitop3_b32 v20, v20, v6, s30 bitop3:0xf6
    s_waitcnt vmcnt(1)
    v_mfma_f32_16x16x32_bf16 v[28:31], v[8:11], v[56:59], v[28:31]
    v_bitop3_b32 v20, v20, v8, s30 bitop3:0xf6
    v_bitop3_b32 v20, v20, v10, s30 bitop3:0xf6
    s_waitcnt vmcnt(0)
    v_mfma_f32_16x16x32_bf16 v[28:31], v[12:15], v[56:59], v[28:31]
    v_bitop3_b32 v20, v20, v12, s30 bitop3:0xf6
    v_bitop3_b32 v20, v20, v14, s30 bitop3:0xf6
    v_and_b32 v20, s40, v20
    v_cmp_ne_u32 vcc, 0, v20
    s_cbranch_vccnz cs_spinG
    v_permlane32_swap_b32 v28, v30
    v_permlane32_swap_b32 v29, v31
    v_add_f32 v28, v28, v30
    v_add_f32 v30, v29, v31
    s_cmp_eq_u32 s13, 3
    s_cbranch_scc1 cs_w3
    v_mov_b32 v29, v28
    v_mov_b32 v31, v30
    s_nop 0
    v_permlane16_swap_b32 v28, v29
    v_permlane16_swap_b32 v30, v31
    v_add_f32 v28, v28, v29
    v_add_f32 v30, v30, v31
cs_w3:
    v_cvt_pk_bf16_f32 v28, v28, v30
    s_mov_b64 exec, s[32:33]
    buffer_store_dword v28, v69, s[4:7], s17 offen sc1
    s_mov_b64 exec, -1
    buffer_load_dwordx4 v[24:27], v61, s[4:7], s14 offen sc1
    s_branch cs_loop
cs_w0:
    v_mov_b64 v[0:1], 0
    v_mov_b64 v[2:3], 0
    v_mov_b64 v[4:5], 0
    v_mov_b64 v[6:7], 0
    v_mov_b64 v[8:9], 0
    v_mov_b64 v[10:11], 0
    v_mov_b64 v[12:13], 0
    v_mov_b64 v[14:15], 0
    s_nop 15
    s_nop 15
    s_nop 15
    s_nop 15
    s_nop 15
    s_nop 15
    s_nop 15
    s_nop 15
    s_nop 4
    s_cmp_lg_u32 s28, 10
    s_cbranch_scc1 cs_nokv
    s_lshr_b32 s92, s12, 1
    s_lshl_b32 s92, s92, 8
    s_add_u32 s92, s92, 125829120
    v_bfe_u32 v28, v61, 4, 6
    v_min_u32 v28, 11, v28
    v_lshlrev_b32 v28, 2, v28
    v_add_u32 v28, 108304, v28
    s_waitcnt vmcnt(0)
    ds_read_b32 v29, v28
    s_add_u32 s93, s95, 63
    s_waitcnt lgkmcnt(0)
    v_cmp_ne_u32 vcc, s93, v29
    s_cbranch_vccz cs_kv1_go
    s_lshr_b32 s92, s12, 1
    s_lshl_b32 s92, s92, 8
    s_add_u32 s92, s92, 125833216
    v_bfe_u32 v28, v61, 4, 6
    v_min_u32 v28, 11, v28
    v_lshlrev_b32 v28, 2, v28
    s_add_u32 s93, s95, 63
    s_mov_b32 s94, 4194304
cs_kv1:
    buffer_load_dword v29, v28, s[4:7], s92 offen sc1
    s_sub_u32 s94, s94, 1
    s_cbranch_scc1 cs_kv1_go
    s_waitcnt vmcnt(0)
    v_subrev_u32 v29, s93, v29
    v_cmp_lt_u32 vcc, 64, v29
    s_cbranch_vccz cs_kv1_go
    s_sleep 2
    s_branch cs_kv1
cs_kv1_go:
    s_branch cs_w0p
cs_nokv:
    s_nop 15
    s_nop 15
    s_nop 15
    s_nop 15
    s_nop 15
    s_nop 15
    s_nop 15
    s_nop 15
    s_nop 15
    s_nop 15
    s_nop 15
    s_nop 15
    s_nop 15
    s_nop 15
    s_nop 15
    s_nop 15
    s_nop 10
cs_w0p:
    buffer_load_dwordx4 v[24:27], v61, s[4:7], s14 offen sc1
    s_branch cs_loop2
cs_spinF:
    buffer_load_dwordx4 v[40:43], v65, s[4:7], s19 offen offset:0 sc1
    buffer_load_dwordx4 v[44:47], v65, s[4:7], s19 offen offset:1024 sc1
    buffer_load_dwordx4 v[48:51], v65, s[4:7], s19 offen offset:2048 sc1
    buffer_load_dwordx4 v[52:55], v65, s[4:7], s19 offen offset:3072 sc1
    s_sub_u32 s29, s29, 1
    s_cmp_lt_i32 s29, 0
    s_cselect_b32 s40, 0, 1
    s_branch cs_chkF
cs_spinG:
    buffer_load_dwordx4 v[0:3], v65, s[4:7], s19 offen offset:0 sc1
    buffer_load_dwordx4 v[4:7], v65, s[4:7], s19 offen offset:1024 sc1
    buffer_load_dwordx4 v[8:11], v65, s[4:7], s19 offen offset:2048 sc1
    buffer_load_dwordx4 v[12:15], v65, s[4:7], s19 offen offset:3072 sc1
    s_sub_u32 s29, s29, 1
    s_cmp_lt_i32 s29, 0
    s_cselect_b32 s40, 0, 1
    s_branch cs_chkG
cs_guard:
    s_cbranch_scc0 cs_guard2
    buffer_store_dwordx4 v[16:19], v61, s[4:7], s26 offen sc1
    s_add_u32 s26, s26, 131072
    s_add_u32 s40, s95, 63
    v_mov_b32 v5, s40
    s_mov_b64 exec, 1
    buffer_store_dword v5, off, s[4:7], s27 sc1
    s_mov_b64 exec, -1
cs_guard2:
    s_nop 7
    v_max3_f32 v6, v28, v29, v30
    v_max3_f32 v7, v31, v56, v57
    v_max_f32 v6, v6, v7
    s_nop 1
    v_max_f32_dpp v6, v6, v6 row_ror:8 row_mask:0xf bank_mask:0xf
    v_mov_b32 v7, v6
    s_nop 1
    v_permlane32_swap_b32 v6, v7
    v_max_f32 v6, v6, v7
    v_mov_b32 v7, v6
    s_nop 1
    v_permlane16_swap_b32 v6, v7
    v_max_f32 v6, v6, v7
    v_sub_f32 v28, v28, v6
    v_sub_f32 v29, v29, v6
    v_sub_f32 v30, v30, v6
    v_sub_f32 v31, v31, v6
    v_sub_f32 v56, v56, v6
    v_sub_f32 v57, v57, v6
    v_exp_f32 v58, v56
    v_exp_f32 v59, v57
    s_nop 0
    v_cvt_pk_bf16_f32 v6, v58, v59
    s_nop 1
    v_mov_b32_dpp v7, v6 row_ror:8 row_mask:0xf bank_mask:0xf
    v_exp_f32 v0, v28
    s_nop 0
    v_mfma_f32_16x16x16_bf16 v[12:15], v[16:17], v[6:7], 0
    v_exp_f32 v1, v29
    v_exp_f32 v2, v30
    v_cvt_pk_bf16_f32 v8, v0, v1
    v_exp_f32 v3, v31
    v_mfma_f32_16x16x16_bf16 v[20:23], v[18:19], v[6:7], 0
    v_cvt_pk_bf16_f32 v9, v2, v3
    v_mov_b32_dpp v10, v8 row_ror:8 row_mask:0xf bank_mask:0xf
    v_max3_f32 v4, |v28|, |v29|, |v30|
    v_mov_b32_dpp v11, v9 row_ror:8 row_mask:0xf bank_mask:0xf
    v_mfma_f32_16x16x32_bf16 v[0:3], v[24:27], v[6:9], 0
    v_max3_f32 v4, v4, |v31|, |v56|
    v_max_f32_e64 v4, v4, |v57|
    v_mfma_f32_16x16x32_bf16 v[12:15], v[40:43], v[8:11], v[12:15]
    v_cmp_nge_f32 vcc, s46, v4
    v_mfma_f32_16x16x32_bf16 v[20:23], v[44:47], v[8:11], v[20:23]
    v_add_f32_dpp v0, v0, v0 row_ror:8 row_mask:0xf bank_mask:0xf
    v_rcp_f32 v0, v0
    s_nop 4
    s_branch cs_norm
cs_spin0:
    buffer_load_dwordx4 v[24:27], v61, s[4:7], s14 offen sc1
    s_sub_u32 s29, s29, 1
    s_cmp_lt_i32 s29, 0
    s_cbranch_scc0 cs_chk0
    s_waitcnt vmcnt(0)
    v_min_u32 v24, -2, v24
    v_min_u32 v25, -2, v25
    v_min_u32 v26, -2, v26
    v_min_u32 v27, -2, v27
    s_branch cs_chk0
cs_spin1:
    buffer_load_dwordx4 v[28:31], v61, s[4:7], s15 offen sc1
    buffer_load_dword v59, v56, s[4:7], s16 offen sc1
    s_sub_u32 s29, s29, 1
    s_cmp_lt_i32 s29, 0
    s_waitcnt vmcnt(0)
    v_max3_u32 v57, v28, v29, v30
    v_max3_u32 v57, v57, v31, v59
    v_cmp_eq_u32 vcc, -1, v57
    ds_write_b128 v62, v[28:31] offset:45056
    ds_write_b32 v58, v59
    s_waitcnt lgkmcnt(0)
    s_cbranch_scc1 cs_go1
    s_cbranch_vccnz cs_spin1
    s_branch cs_go1
cs_last:
    s_nop 1
    s_cmp_ge_u32 s28, 2
    s_cbranch_scc1 cs_last0
    s_and_b32 s40, s12, 3
    s_lshl_b32 s40, s40, 14
    s_add_u32 s40, s40, 68157440
    s_lshr_b32 s42, s12, 2
    s_lshl_b32 s42, s42, 3
    s_lshl_b64 exec, 0x55, s42
    buffer_load_dword v79, s[4:7], s40 offen sc1 lds
    s_mov_b64 exec, -1
    s_cmp_eq_u32 0, 1
    s_branch cs_back
cs_last0:
    s_cmp_lg_u32 s28, 9
    s_cbranch_scc1 cs_last1
    s_lshr_b32 s92, s12, 1
    s_lshl_b32 s92, s92, 8
    s_add_u32 s92, s92, 125833216
    v_bfe_u32 v48, v61, 4, 6
    v_min_u32 v48, 11, v48
    v_lshlrev_b32 v48, 2, v48
    s_mov_b32 m0, 108304
    s_mov_b64 exec, 0xfff
    buffer_load_dword v48, s[4:7], s92 offen sc1 lds
    s_mov_b64 exec, -1
    s_mov_b32 m0, 108032
    s_cmp_eq_u32 0, 1
    s_branch cs_back
cs_last1:
    s_cmp_eq_u32 s28, 63
    s_cbranch_scc1 cs_last2
    s_mov_b64 exec, s[34:35]
    buffer_store_dwordx4 v[0:3], v61, s[4:7], s25 offen sc1
    s_mov_b64 exec, -1
    s_add_u32 s25, s25, 131072
    s_mov_b32 s46, 0xbf800000
    s_cmp_eq_u32 0, 0
    s_branch cs_back
cs_last2:
    s_waitcnt lgkmcnt(0)
    s_mov_b64 exec, s[34:35]
    buffer_store_dwordx4 v[0:3], v61, s[4:7], s25 offen sc1
    s_mov_b64 exec, -1
    s_add_u32 s40, s95, 64
    v_mov_b32 v40, s40
    v_smfmac_f32_16x16x64_bf16 v[16:19], v[52:55], a[240:247], v60
    v_smfmac_f32_16x16x64_bf16 v[20:23], v[52:55], a[248:255], v60
    s_nop 3
    v_cvt_pk_bf16_f32 v16, v16, v17
    v_cvt_pk_bf16_f32 v17, v18, v19
    s_nop 1
    v_cvt_pk_bf16_f32 v18, v20, v21
    v_cvt_pk_bf16_f32 v19, v22, v23
    buffer_store_dwordx4 v[16:19], v61, s[4:7], s26 offen sc1
    s_mov_b64 exec, 1
    buffer_store_dword v40, off, s[4:7], s27 sc1
    s_mov_b64 exec, -1
    s_endpgm
cs_dma:
    s_xor_b32 s74, s76, s81
    s_add_u32 m0, s74, s80
    s_add_u32 s76, s76, 4096
    buffer_load_dwordx4 v58, s[8:11], s78 offen lds
    s_add_u32 s78, s78, s79
    s_cmp_lt_u32 s76, s77
    s_cbranch_scc1 cs_dma
    s_setpc_b64 s[82:83]
L_helper:
    s_load_dwordx16 s[64:79], s[0:1], 64
    s_sub_u32 s33, s3, 4
    s_and_b32 s33, s33, 7
L_pool:
    s_lshl_b32 s35, s33, 2
    s_add_u32 s35, s35, 32
    s_mov_b32 s37, s35
    v_mov_b32 v250, 1
    v_mov_b32 v251, 163832
    v_cmp_eq_u32 vcc, 0, v0
    s_nop 0
    s_and_saveexec_b64 s[38:39], vcc
    s_cbranch_execz tk4
    buffer_atomic_add v250, off, s[96:99], s37 sc0
    s_waitcnt vmcnt(0)
    ds_write_b32 v251, v250
    s_waitcnt lgkmcnt(0)
tk4:
    s_mov_b64 exec, -1
    s_barrier
    ds_read_b32 v252, v251
    s_waitcnt lgkmcnt(0)
    v_readfirstlane_b32 s34, v252
    s_barrier
    s_nop 3
    s_mov_b32 s36, s33
    s_or_b32 s33, s34, s32
    s_cmp_lg_u32 s33, 0
    s_cbranch_scc1 L_helper1
    s_memrealtime s[90:91]
    s_waitcnt lgkmcnt(0)
    s_lshl_b32 s90, s90, 8
    s_or_b32 s90, s90, 1
    v_mov_b32 v250, s90
    v_mov_b32 v251, 0
    s_mov_b64 exec, 1
    buffer_atomic_cmpswap v[250:251], off, s[96:99], 0 offset:64
    s_mov_b64 exec, -1
L_helper1:
    s_cmp_ge_u32 s34, 32
    s_cbranch_scc1 L_qkv_next
    s_cmp_ge_u32 s36, 7
    s_cbranch_scc1 L_qkv_next
    s_cmp_eq_u32 s36, 6
    s_cselect_b32 s36, s34, s36
    s_cbranch_scc1 L_job
    s_max_u32 s37, s36, 4
    s_sub_u32 s37, s37, 4
    s_mul_i32 s37, s37, 5
    s_mul_i32 s38, s36, 7
    s_sub_u32 s38, s38, s37
    s_cmp_lt_u32 s36, 4
    s_cselect_b32 s39, 7, 2
    s_mul_i32 s36, s36, 25
    s_add_u32 s36, s36, s37
    s_cmp_lt_u32 s34, s39
    s_cbranch_scc1 L_copy
    s_add_u32 s36, s36, s34
    s_sub_u32 s36, s36, s39
    s_mul_i32 s37, s36, 205
    s_lshr_b32 s37, s37, 10
    s_mul_i32 s38, s37, 5
    s_sub_u32 s36, s36, s38
    s_add_u32 s36, s36, 1
    s_lshl_b32 s36, s36, 5
    s_add_u32 s36, s36, s37
    s_branch L_job
L_copy:
    s_add_u32 s36, s38, s34
    s_mul_i32 s36, s36, 11
    s_and_b32 s36, s36, 31
    s_cmp_ge_u32 s36, 27
    s_cbranch_scc1 L_qkv_next
    s_mul_i32 s33, s36, 57
    s_lshr_b32 s33, s33, 9
    s_mul_i32 s37, s33, 9
    s_sub_u32 s37, s36, s37
    s_lshl_b32 s36, s37, 2
    s_add_u32 s36, s36, 1
    s_min_u32 s36, s36, 31
    s_lshr_b32 s39, s52, 8
    s_sub_u32 s36, s36, s39
    s_and_b32 s36, s36, 31
    s_lshl_b32 s36, s36, 8
    s_mov_b32 s14, 4718592
    s_mov_b32 s15, 0x20000
    v_lshrrev_b32 v1, 4, v0
    v_lshlrev_b32 v1, 13, v1
    v_and_b32 v2, 15, v0
    v_lshl_add_u32 v1, v2, 4, v1
    v_lshlrev_b32 v2, 4, v0
    s_mul_i32 s40, s33, 2
    s_mul_i32 s39, s40, 49152
    s_lshl_b32 s41, s37, 19
    s_add_u32 s39, s39, s41
    s_add_u32 s39, s39, 96468992
    s_add_u32 s41, s40, 0
    s_cmp_lt_u32 s41, 3
    s_cselect_b64 s[12:13], s[52:53], s[54:55]
    s_cselect_b32 s42, 0, 3
    s_cmp_ge_u32 s41, 6
    s_cselect_b64 s[12:13], s[56:57], s[12:13]
    s_cselect_b32 s42, 6, s42
    s_sub_u32 s41, s41, s42
    s_mul_i32 s38, s41, 1572864
    s_add_u32 s38, s38, s36
    buffer_load_dwordx4 v[8:11], v1, s[12:15], s38 offen
    s_add_u32 s38, s38, 131072
    buffer_load_dwordx4 v[12:15], v1, s[12:15], s38 offen
    s_add_u32 s38, s38, 131072
    buffer_load_dwordx4 v[16:19], v1, s[12:15], s38 offen
    s_add_u32 s38, s38, 131072
    buffer_load_dwordx4 v[20:23], v1, s[12:15], s38 offen
    s_add_u32 s38, s38, 131072
    buffer_load_dwordx4 v[24:27], v1, s[12:15], s38 offen
    s_add_u32 s38, s38, 131072
    buffer_load_dwordx4 v[28:31], v1, s[12:15], s38 offen
    s_add_u32 s38, s38, 131072
    buffer_load_dwordx4 v[32:35], v1, s[12:15], s38 offen
    s_add_u32 s38, s38, 131072
    buffer_load_dwordx4 v[36:39], v1, s[12:15], s38 offen
    s_add_u32 s38, s38, 131072
    buffer_load_dwordx4 v[40:43], v1, s[12:15], s38 offen
    s_add_u32 s38, s38, 131072
    buffer_load_dwordx4 v[44:47], v1, s[12:15], s38 offen
    s_add_u32 s38, s38, 131072
    buffer_load_dwordx4 v[48:51], v1, s[12:15], s38 offen
    s_add_u32 s38, s38, 131072
    buffer_load_dwordx4 v[52:55], v1, s[12:15], s38 offen
    s_add_u32 s38, s38, 131072
    s_add_u32 s41, s40, 1
    s_cmp_lt_u32 s41, 3
    s_cselect_b64 s[12:13], s[52:53], s[54:55]
    s_cselect_b32 s42, 0, 3
    s_cmp_ge_u32 s41, 6
    s_cselect_b64 s[12:13], s[56:57], s[12:13]
    s_cselect_b32 s42, 6, s42
    s_sub_u32 s41, s41, s42
    s_mul_i32 s38, s41, 1572864
    s_add_u32 s38, s38, s36
    buffer_load_dwordx4 v[56:59], v1, s[12:15], s38 offen
    s_add_u32 s38, s38, 131072
    buffer_load_dwordx4 v[60:63], v1, s[12:15], s38 offen
    s_add_u32 s38, s38, 131072
    buffer_load_dwordx4 v[64:67], v1, s[12:15], s38 offen
    s_add_u32 s38, s38, 131072
    buffer_load_dwordx4 v[68:71], v1, s[12:15], s38 offen
    s_add_u32 s38, s38, 131072
    buffer_load_dwordx4 v[72:75], v1, s[12:15], s38 offen
    s_add_u32 s38, s38, 131072
    buffer_load_dwordx4 v[76:79], v1, s[12:15], s38 offen
    s_add_u32 s38, s38, 131072
    buffer_load_dwordx4 v[80:83], v1, s[12:15], s38 offen
    s_add_u32 s38, s38, 131072
    buffer_load_dwordx4 v[84:87], v1, s[12:15], s38 offen
    s_add_u32 s38, s38, 131072
    buffer_load_dwordx4 v[88:91], v1, s[12:15], s38 offen
    s_add_u32 s38, s38, 131072
    buffer_load_dwordx4 v[92:95], v1, s[12:15], s38 offen
    s_add_u32 s38, s38, 131072
    buffer_load_dwordx4 v[96:99], v1, s[12:15], s38 offen
    s_add_u32 s38, s38, 131072
    buffer_load_dwordx4 v[100:103], v1, s[12:15], s38 offen
    s_add_u32 s38, s38, 131072
    buffer_load_dword v3, off, s[96:99], 0 offset:64 sc1
    s_waitcnt vmcnt(0)
    buffer_store_dwordx4 v[8:11], v2, s[4:7], s39 offen sc1
    s_add_u32 s39, s39, 4096
    buffer_store_dwordx4 v[12:15], v2, s[4:7], s39 offen sc1
    s_add_u32 s39, s39, 4096
    buffer_store_dwordx4 v[16:19], v2, s[4:7], s39 offen sc1
    s_add_u32 s39, s39, 4096
    buffer_store_dwordx4 v[20:23], v2, s[4:7], s39 offen sc1
    s_add_u32 s39, s39, 4096
    buffer_store_dwordx4 v[24:27], v2, s[4:7], s39 offen sc1
    s_add_u32 s39, s39, 4096
    buffer_store_dwordx4 v[28:31], v2, s[4:7], s39 offen sc1
    s_add_u32 s39, s39, 4096
    buffer_store_dwordx4 v[32:35], v2, s[4:7], s39 offen sc1
    s_add_u32 s39, s39, 4096
    buffer_store_dwordx4 v[36:39], v2, s[4:7], s39 offen sc1
    s_add_u32 s39, s39, 4096
    buffer_store_dwordx4 v[40:43], v2, s[4:7], s39 offen sc1
    s_add_u32 s39, s39, 4096
    buffer_store_dwordx4 v[44:47], v2, s[4:7], s39 offen sc1
    s_add_u32 s39, s39, 4096
    buffer_store_dwordx4 v[48:51], v2, s[4:7], s39 offen sc1
    s_add_u32 s39, s39, 4096
    buffer_store_dwordx4 v[52:55], v2, s[4:7], s39 offen sc1
    s_add_u32 s39, s39, 4096
    buffer_store_dwordx4 v[56:59], v2, s[4:7], s39 offen sc1
    s_add_u32 s39, s39, 4096
    buffer_store_dwordx4 v[60:63], v2, s[4:7], s39 offen sc1
    s_add_u32 s39, s39, 4096
    buffer_store_dwordx4 v[64:67], v2, s[4:7], s39 offen sc1
    s_add_u32 s39, s39, 4096
    buffer_store_dwordx4 v[68:71], v2, s[4:7], s39 offen sc1
    s_add_u32 s39, s39, 4096
    buffer_store_dwordx4 v[72:75], v2, s[4:7], s39 offen sc1
    s_add_u32 s39, s39, 4096
    buffer_store_dwordx4 v[76:79], v2, s[4:7], s39 offen sc1
    s_add_u32 s39, s39, 4096
    buffer_store_dwordx4 v[80:83], v2, s[4:7], s39 offen sc1
    s_add_u32 s39, s39, 4096
    buffer_store_dwordx4 v[84:87], v2, s[4:7], s39 offen sc1
    s_add_u32 s39, s39, 4096
    buffer_store_dwordx4 v[88:91], v2, s[4:7], s39 offen sc1
    s_add_u32 s39, s39, 4096
    buffer_store_dwordx4 v[92:95], v2, s[4:7], s39 offen sc1
    s_add_u32 s39, s39, 4096
    buffer_store_dwordx4 v[96:99], v2, s[4:7], s39 offen sc1
    s_add_u32 s39, s39, 4096
    buffer_store_dwordx4 v[100:103], v2, s[4:7], s39 offen sc1
    s_add_u32 s39, s39, 4096
    v_readfirstlane_b32 s95, v3
    s_nop 4
    s_mov_b32 s88, 4194304
gn5:
    s_cmp_lg_u32 s95, 0
    s_cbranch_scc1 gn5x
    buffer_load_dword v3, off, s[96:99], 0 offset:64 sc1
    s_sub_u32 s88, s88, 1
    s_cbranch_scc1 gn5x
    s_waitcnt vmcnt(0)
    v_readfirstlane_b32 s95, v3
    s_nop 1
    s_branch gn5
gn5x:
    s_lshl_b32 s37, s37, 7
    s_lshl_b32 s36, s33, 2
    s_add_u32 s36, s36, s32
    s_lshl_b32 s36, s36, 2
    s_add_u32 s37, s37, s36
    s_add_u32 s37, s37, 125853696
    v_mov_b32 v3, s95
    s_waitcnt vmcnt(0)
    s_mov_b64 exec, 1
    buffer_store_dword v3, off, s[4:7], s37 sc1
    s_mov_b64 exec, -1
L_qkv_next:
    s_mov_b32 s37, 4
    v_mov_b32 v250, 1
    v_mov_b32 v251, 163832
    v_cmp_eq_u32 vcc, 0, v0
    s_nop 0
    s_and_saveexec_b64 s[38:39], vcc
    s_cbranch_execz tk6
    buffer_atomic_add v250, off, s[96:99], s37 sc0
    s_waitcnt vmcnt(0)
    ds_write_b32 v251, v250
    s_waitcnt lgkmcnt(0)
tk6:
    s_mov_b64 exec, -1
    s_barrier
    ds_read_b32 v252, v251
    s_waitcnt lgkmcnt(0)
    v_readfirstlane_b32 s36, v252
    s_barrier
    s_nop 3
    s_add_u32 s36, s36, 192
    s_cmp_ge_u32 s36, 320
    s_cbranch_scc1 L_ssm_next
L_job:
    s_and_b32 s17, s36, 15
    s_lshl_b32 s17, s17, 1
    s_bfe_u32 s16, s36, 0x10004
    s_lshr_b32 s19, s36, 5
    s_mul_i32 s33, s16, 6
    s_add_u32 s33, s33, s19
    s_add_u32 s16, s16, 1
    s_lshr_b32 s37, s36, 4
    s_sub_u32 s38, s37, 12
    s_cmp_ge_u32 s36, 192
    s_cselect_b32 s16, 0, s16
    s_cselect_b32 s19, s38, s19
    s_cselect_b32 s33, s37, s33
    s_cselect_b32 s20, 8, 6
    v_lshrrev_b32 v4, 6, v0
    s_nop 0
    v_readfirstlane_b32 s18, v4
    v_lshlrev_b32 v7, 4, v0
    v_and_b32 v4, 63, v0
    v_lshrrev_b32 v6, 2, v4
    v_lshlrev_b32 v6, 13, v6
    v_lshrrev_b32 v5, 4, v4
    v_and_b32 v5, 2, v5
    v_xor_b32 v5, v5, v4
    v_and_b32 v5, 3, v5
    v_lshl_add_u32 v6, v5, 4, v6
    v_lshrrev_b32 v24, 4, v4
    v_lshlrev_b32 v24, 9, v24
    v_bfe_u32 v5, v4, 2, 2
    v_lshl_add_u32 v24, v5, 6, v24
    v_bfe_u32 v5, v4, 4, 1
    v_lshl_add_u32 v24, v5, 5, v24
    v_and_b32 v5, 3, v4
    v_lshl_add_u32 v24, v5, 3, v24
    s_lshl_b32 s31, s18, 12
    v_add_u32 v24, s31, v24
    s_cmp_eq_u32 s16, 1
    s_cselect_b64 s[12:13], s[54:55], s[52:53]
    s_cmp_eq_u32 s16, 2
    s_cselect_b64 s[12:13], s[56:57], s[12:13]
    s_mov_b32 s14, 4718592
    s_mov_b32 s15, 0x20000
    s_lshl_b32 s28, s17, 8
    s_lshl_b32 s21, s18, 6
    s_add_u32 s28, s28, s21
    s_add_u32 s21, s28, 0
    s_add_u32 m0, s31, 40960
    s_nop 0
    buffer_load_dwordx4 v6, s[12:15], s21 offen lds
    s_add_u32 m0, s31, 41984
    s_add_u32 s21, s21, 131072
    buffer_load_dwordx4 v6, s[12:15], s21 offen lds
    s_add_u32 m0, s31, 43008
    s_add_u32 s21, s21, 131072
    buffer_load_dwordx4 v6, s[12:15], s21 offen lds
    s_add_u32 m0, s31, 44032
    s_add_u32 s21, s21, 131072
    buffer_load_dwordx4 v6, s[12:15], s21 offen lds
    s_add_u32 s21, s28, 256
    s_add_u32 m0, s31, 57344
    s_nop 0
    buffer_load_dwordx4 v6, s[12:15], s21 offen lds
    s_add_u32 m0, s31, 58368
    s_add_u32 s21, s21, 131072
    buffer_load_dwordx4 v6, s[12:15], s21 offen lds
    s_add_u32 m0, s31, 59392
    s_add_u32 s21, s21, 131072
    buffer_load_dwordx4 v6, s[12:15], s21 offen lds
    s_add_u32 m0, s31, 60416
    s_add_u32 s21, s21, 131072
    buffer_load_dwordx4 v6, s[12:15], s21 offen lds
    s_add_u32 s21, s28, 524288
    s_add_u32 m0, s31, 73728
    s_nop 0
    buffer_load_dwordx4 v6, s[12:15], s21 offen lds
    s_add_u32 m0, s31, 74752
    s_add_u32 s21, s21, 131072
    buffer_load_dwordx4 v6, s[12:15], s21 offen lds
    s_add_u32 m0, s31, 75776
    s_add_u32 s21, s21, 131072
    buffer_load_dwordx4 v6, s[12:15], s21 offen lds
    s_add_u32 m0, s31, 76800
    s_add_u32 s21, s21, 131072
    buffer_load_dwordx4 v6, s[12:15], s21 offen lds
    s_add_u32 s21, s28, 524544
    s_add_u32 m0, s31, 90112
    s_nop 0
    buffer_load_dwordx4 v6, s[12:15], s21 offen lds
    s_add_u32 m0, s31, 91136
    s_add_u32 s21, s21, 131072
    buffer_load_dwordx4 v6, s[12:15], s21 offen lds
    s_add_u32 m0, s31, 92160
    s_add_u32 s21, s21, 131072
    buffer_load_dwordx4 v6, s[12:15], s21 offen lds
    s_add_u32 m0, s31, 93184
    s_add_u32 s21, s21, 131072
    buffer_load_dwordx4 v6, s[12:15], s21 offen lds
    s_add_u32 s21, s28, 1048576
    s_add_u32 m0, s31, 106496
    s_nop 0
    buffer_load_dwordx4 v6, s[12:15], s21 offen lds
    s_add_u32 m0, s31, 107520
    s_add_u32 s21, s21, 131072
    buffer_load_dwordx4 v6, s[12:15], s21 offen lds
    s_add_u32 m0, s31, 108544
    s_add_u32 s21, s21, 131072
    buffer_load_dwordx4 v6, s[12:15], s21 offen lds
    s_add_u32 m0, s31, 109568
    s_add_u32 s21, s21, 131072
    buffer_load_dwordx4 v6, s[12:15], s21 offen lds
    s_add_u32 s21, s28, 1048832
    s_add_u32 m0, s31, 122880
    s_nop 0
    buffer_load_dwordx4 v6, s[12:15], s21 offen lds
    s_add_u32 m0, s31, 123904
    s_add_u32 s21, s21, 131072
    buffer_load_dwordx4 v6, s[12:15], s21 offen lds
    s_add_u32 m0, s31, 124928
    s_add_u32 s21, s21, 131072
    buffer_load_dwordx4 v6, s[12:15], s21 offen lds
    s_add_u32 m0, s31, 125952
    s_add_u32 s21, s21, 131072
    buffer_load_dwordx4 v6, s[12:15], s21 offen lds
    s_add_u32 s21, s28, 1572864
    s_add_u32 m0, s31, 139264
    s_nop 0
    buffer_load_dwordx4 v6, s[12:15], s21 offen lds
    s_add_u32 m0, s31, 140288
    s_add_u32 s21, s21, 131072
    buffer_load_dwordx4 v6, s[12:15], s21 offen lds
    s_add_u32 m0, s31, 141312
    s_add_u32 s21, s21, 131072
    buffer_load_dwordx4 v6, s[12:15], s21 offen lds
    s_add_u32 m0, s31, 142336
    s_add_u32 s21, s21, 131072
    buffer_load_dwordx4 v6, s[12:15], s21 offen lds
    v_and_b32 v5, 15, v4
    v_lshrrev_b32 v3, 4, v4
    v_lshrrev_b32 v2, 2, v5
    v_xor_b32 v3, v3, v2
    v_lshl_add_u32 v3, v5, 2, v3
    v_lshlrev_b32 v1, 4, v3
    v_lshrrev_b32 v5, 2, v4
    v_lshrrev_b32 v3, 4, v4
    v_and_b32 v4, 3, v4
    v_xor_b32 v4, v4, v3
    v_lshlrev_b32 v3, 3, v3
    v_and_b32 v5, 3, v5
    v_add_u32 v3, v3, v5
    v_mul_u32_u24 v2, 1152, v3
    v_lshl_add_u32 v2, v4, 4, v2
    s_mov_b32 s8, s48
    s_mov_b32 s9, s49
    s_mov_b32 s10, 2359296
    s_mov_b32 s11, 0x20000
    s_lshr_b32 s22, s18, 1
    s_mul_i32 s24, s22, 4608
    s_and_b32 s22, s18, 1
    s_mul_i32 s23, s22, 576
    s_add_u32 s24, s24, s23
    s_mul_i32 s25, s18, 9216
    s_mul_i32 s22, s19, 36864
    s_add_u32 s24, s24, s22
    s_mul_i32 s42, s20, 36864
    s_mov_b32 s27, 0
    s_add_u32 s23, s27, s25
    s_add_u32 m0, s23, 0
    s_nop 0
    buffer_load_dwordx4 v2, s[8:11], s24 offen offset:0 lds
    s_add_u32 m0, s23, 960
    s_nop 0
    buffer_load_dwordx4 v2, s[8:11], s24 offen offset:64 lds
    s_add_u32 m0, s23, 1920
    s_nop 0
    buffer_load_dwordx4 v2, s[8:11], s24 offen offset:128 lds
    s_add_u32 m0, s23, 2880
    s_nop 0
    buffer_load_dwordx4 v2, s[8:11], s24 offen offset:192 lds
    s_add_u32 m0, s23, 3840
    s_nop 0
    buffer_load_dwordx4 v2, s[8:11], s24 offen offset:256 lds
    s_add_u32 m0, s23, 4800
    s_nop 0
    buffer_load_dwordx4 v2, s[8:11], s24 offen offset:320 lds
    s_add_u32 m0, s23, 5760
    s_nop 0
    buffer_load_dwordx4 v2, s[8:11], s24 offen offset:384 lds
    s_add_u32 m0, s23, 6720
    s_nop 0
    buffer_load_dwordx4 v2, s[8:11], s24 offen offset:448 lds
    s_add_u32 m0, s23, 7680
    s_nop 0
    buffer_load_dwordx4 v2, s[8:11], s24 offen offset:512 lds
    s_add_u32 s24, s24, s42
    s_lshl_b32 s22, s19, 5
    s_add_u32 s22, s22, s17
    s_lshl_b32 s26, s22, 14
    s_mul_i32 s23, s18, 3072
    s_add_u32 s26, s26, s23
    s_lshl_b32 s23, s16, 11
    s_add_u32 s26, s26, s23
    s_add_u32 s26, s26, -2048
    s_lshl_b32 s22, s22, 13
    s_add_u32 s22, s22, 33554432
    s_cmp_eq_u32 s16, 0
    s_cselect_b32 s26, s22, s26
    s_cselect_b32 s40, 4, 1
    s_cselect_b32 s43, 1, 2
    s_lshl_b32 s40, s40, 10
    s_lshl_b32 s43, s43, 13
    s_lshl_b32 s41, s43, 5
    s_mul_i32 s41, s41, s20
    s_lshl_b32 s29, s17, 7
    s_lshl_b32 s22, s33, 2
    s_add_u32 s29, s29, s22
    s_add_u32 s29, s29, 125829120
    v_add_u32 v25, 40960, v24
    v_xor_b32 v26, 32, v25
    s_waitcnt vmcnt(33)
    ds_read_b64_tr_b16 v[64:65], v25 offset:0
    ds_read_b64_tr_b16 v[66:67], v25 offset:256
    ds_read_b64_tr_b16 v[136:137], v26 offset:0
    ds_read_b64_tr_b16 v[138:139], v26 offset:256
    ds_read_b64_tr_b16 v[68:69], v25 offset:2048
    ds_read_b64_tr_b16 v[70:71], v25 offset:2304
    ds_read_b64_tr_b16 v[140:141], v26 offset:2048
    ds_read_b64_tr_b16 v[142:143], v26 offset:2304
    s_waitcnt lgkmcnt(0)
    s_add_u32 s21, s28, 1573120
    s_add_u32 m0, s31, 40960
    s_nop 0
    buffer_load_dwordx4 v6, s[12:15], s21 offen lds
    s_add_u32 m0, s31, 41984
    s_add_u32 s21, s21, 131072
    buffer_load_dwordx4 v6, s[12:15], s21 offen lds
    s_add_u32 m0, s31, 43008
    s_add_u32 s21, s21, 131072
    buffer_load_dwordx4 v6, s[12:15], s21 offen lds
    s_add_u32 m0, s31, 44032
    s_add_u32 s21, s21, 131072
    buffer_load_dwordx4 v6, s[12:15], s21 offen lds
    v_add_u32 v25, 57344, v24
    v_xor_b32 v26, 32, v25
    s_waitcnt vmcnt(33)
    ds_read_b64_tr_b16 a[0:1], v25 offset:0
    ds_read_b64_tr_b16 a[2:3], v25 offset:256
    ds_read_b64_tr_b16 a[72:73], v26 offset:0
    ds_read_b64_tr_b16 a[74:75], v26 offset:256
    ds_read_b64_tr_b16 a[4:5], v25 offset:2048
    ds_read_b64_tr_b16 a[6:7], v25 offset:2304
    ds_read_b64_tr_b16 a[76:77], v26 offset:2048
    ds_read_b64_tr_b16 a[78:79], v26 offset:2304
    s_waitcnt lgkmcnt(0)
    s_add_u32 s21, s28, 2097152
    s_add_u32 m0, s31, 57344
    s_nop 0
    buffer_load_dwordx4 v6, s[12:15], s21 offen lds
    s_add_u32 m0, s31, 58368
    s_add_u32 s21, s21, 131072
    buffer_load_dwordx4 v6, s[12:15], s21 offen lds
    s_add_u32 m0, s31, 59392
    s_add_u32 s21, s21, 131072
    buffer_load_dwordx4 v6, s[12:15], s21 offen lds
    s_add_u32 m0, s31, 60416
    s_add_u32 s21, s21, 131072
    buffer_load_dwordx4 v6, s[12:15], s21 offen lds
    v_add_u32 v25, 73728, v24
    v_xor_b32 v26, 32, v25
    s_waitcnt vmcnt(33)
    ds_read_b64_tr_b16 v[72:73], v25 offset:0
    ds_read_b64_tr_b16 v[74:75], v25 offset:256
    ds_read_b64_tr_b16 v[144:145], v26 offset:0
    ds_read_b64_tr_b16 v[146:147], v26 offset:256
    ds_read_b64_tr_b16 v[76:77], v25 offset:2048
    ds_read_b64_tr_b16 v[78:79], v25 offset:2304
    ds_read_b64_tr_b16 v[148:149], v26 offset:2048
    ds_read_b64_tr_b16 v[150:151], v26 offset:2304
    s_waitcnt lgkmcnt(0)
    s_add_u32 s21, s28, 2097408
    s_add_u32 m0, s31, 73728
    s_nop 0
    buffer_load_dwordx4 v6, s[12:15], s21 offen lds
    s_add_u32 m0, s31, 74752
    s_add_u32 s21, s21, 131072
    buffer_load_dwordx4 v6, s[12:15], s21 offen lds
    s_add_u32 m0, s31, 75776
    s_add_u32 s21, s21, 131072
    buffer_load_dwordx4 v6, s[12:15], s21 offen lds
    s_add_u32 m0, s31, 76800
    s_add_u32 s21, s21, 131072
    buffer_load_dwordx4 v6, s[12:15], s21 offen lds
    v_add_u32 v25, 90112, v24
    v_xor_b32 v26, 32, v25
    s_waitcnt vmcnt(33)
    ds_read_b64_tr_b16 a[8:9], v25 offset:0
    ds_read_b64_tr_b16 a[10:11], v25 offset:256
    ds_read_b64_tr_b16 a[80:81], v26 offset:0
    ds_read_b64_tr_b16 a[82:83], v26 offset:256
    ds_read_b64_tr_b16 a[12:13], v25 offset:2048
    ds_read_b64_tr_b16 a[14:15], v25 offset:2304
    ds_read_b64_tr_b16 a[84:85], v26 offset:2048
    ds_read_b64_tr_b16 a[86:87], v26 offset:2304
    s_waitcnt lgkmcnt(0)
    s_add_u32 s21, s28, 2621440
    s_add_u32 m0, s31, 90112
    s_nop 0
    buffer_load_dwordx4 v6, s[12:15], s21 offen lds
    s_add_u32 m0, s31, 91136
    s_add_u32 s21, s21, 131072
    buffer_load_dwordx4 v6, s[12:15], s21 offen lds
    s_add_u32 m0, s31, 92160
    s_add_u32 s21, s21, 131072
    buffer_load_dwordx4 v6, s[12:15], s21 offen lds
    s_add_u32 m0, s31, 93184
    s_add_u32 s21, s21, 131072
    buffer_load_dwordx4 v6, s[12:15], s21 offen lds
    v_add_u32 v25, 106496, v24
    v_xor_b32 v26, 32, v25
    s_waitcnt vmcnt(33)
    ds_read_b64_tr_b16 v[80:81], v25 offset:0
    ds_read_b64_tr_b16 v[82:83], v25 offset:256
    ds_read_b64_tr_b16 v[152:153], v26 offset:0
    ds_read_b64_tr_b16 v[154:155], v26 offset:256
    ds_read_b64_tr_b16 v[84:85], v25 offset:2048
    ds_read_b64_tr_b16 v[86:87], v25 offset:2304
    ds_read_b64_tr_b16 v[156:157], v26 offset:2048
    ds_read_b64_tr_b16 v[158:159], v26 offset:2304
    s_waitcnt lgkmcnt(0)
    s_add_u32 s21, s28, 2621696
    s_add_u32 m0, s31, 106496
    s_nop 0
    buffer_load_dwordx4 v6, s[12:15], s21 offen lds
    s_add_u32 m0, s31, 107520
    s_add_u32 s21, s21, 131072
    buffer_load_dwordx4 v6, s[12:15], s21 offen lds
    s_add_u32 m0, s31, 108544
    s_add_u32 s21, s21, 131072
    buffer_load_dwordx4 v6, s[12:15], s21 offen lds
    s_add_u32 m0, s31, 109568
    s_add_u32 s21, s21, 131072
    buffer_load_dwordx4 v6, s[12:15], s21 offen lds
    v_add_u32 v25, 122880, v24
    v_xor_b32 v26, 32, v25
    s_waitcnt vmcnt(33)
    ds_read_b64_tr_b16 a[16:17], v25 offset:0
    ds_read_b64_tr_b16 a[18:19], v25 offset:256
    ds_read_b64_tr_b16 a[88:89], v26 offset:0
    ds_read_b64_tr_b16 a[90:91], v26 offset:256
    ds_read_b64_tr_b16 a[20:21], v25 offset:2048
    ds_read_b64_tr_b16 a[22:23], v25 offset:2304
    ds_read_b64_tr_b16 a[92:93], v26 offset:2048
    ds_read_b64_tr_b16 a[94:95], v26 offset:2304
    s_waitcnt lgkmcnt(0)
    s_add_u32 s21, s28, 3145728
    s_add_u32 m0, s31, 122880
    s_nop 0
    buffer_load_dwordx4 v6, s[12:15], s21 offen lds
    s_add_u32 m0, s31, 123904
    s_add_u32 s21, s21, 131072
    buffer_load_dwordx4 v6, s[12:15], s21 offen lds
    s_add_u32 m0, s31, 124928
    s_add_u32 s21, s21, 131072
    buffer_load_dwordx4 v6, s[12:15], s21 offen lds
    s_add_u32 m0, s31, 125952
    s_add_u32 s21, s21, 131072
    buffer_load_dwordx4 v6, s[12:15], s21 offen lds
    v_add_u32 v25, 139264, v24
    v_xor_b32 v26, 32, v25
    s_waitcnt vmcnt(33)
    ds_read_b64_tr_b16 v[88:89], v25 offset:0
    ds_read_b64_tr_b16 v[90:91], v25 offset:256
    ds_read_b64_tr_b16 v[160:161], v26 offset:0
    ds_read_b64_tr_b16 v[162:163], v26 offset:256
    ds_read_b64_tr_b16 v[92:93], v25 offset:2048
    ds_read_b64_tr_b16 v[94:95], v25 offset:2304
    ds_read_b64_tr_b16 v[164:165], v26 offset:2048
    ds_read_b64_tr_b16 v[166:167], v26 offset:2304
    s_waitcnt lgkmcnt(0)
    s_add_u32 s21, s28, 3145984
    s_add_u32 m0, s31, 139264
    s_nop 0
    buffer_load_dwordx4 v6, s[12:15], s21 offen lds
    s_add_u32 m0, s31, 140288
    s_add_u32 s21, s21, 131072
    buffer_load_dwordx4 v6, s[12:15], s21 offen lds
    s_add_u32 m0, s31, 141312
    s_add_u32 s21, s21, 131072
    buffer_load_dwordx4 v6, s[12:15], s21 offen lds
    s_add_u32 m0, s31, 142336
    s_add_u32 s21, s21, 131072
    buffer_load_dwordx4 v6, s[12:15], s21 offen lds
    v_add_u32 v25, 40960, v24
    v_xor_b32 v26, 32, v25
    s_waitcnt vmcnt(24)
    ds_read_b64_tr_b16 a[24:25], v25 offset:0
    ds_read_b64_tr_b16 a[26:27], v25 offset:256
    ds_read_b64_tr_b16 a[96:97], v26 offset:0
    ds_read_b64_tr_b16 a[98:99], v26 offset:256
    ds_read_b64_tr_b16 a[28:29], v25 offset:2048
    ds_read_b64_tr_b16 a[30:31], v25 offset:2304
    ds_read_b64_tr_b16 a[100:101], v26 offset:2048
    ds_read_b64_tr_b16 a[102:103], v26 offset:2304
    s_waitcnt lgkmcnt(0)
    s_add_u32 s21, s28, 3670016
    s_add_u32 m0, s31, 40960
    s_nop 0
    buffer_load_dwordx4 v6, s[12:15], s21 offen lds
    s_add_u32 m0, s31, 41984
    s_add_u32 s21, s21, 131072
    buffer_load_dwordx4 v6, s[12:15], s21 offen lds
    s_add_u32 m0, s31, 43008
    s_add_u32 s21, s21, 131072
    buffer_load_dwordx4 v6, s[12:15], s21 offen lds
    s_add_u32 m0, s31, 44032
    s_add_u32 s21, s21, 131072
    buffer_load_dwordx4 v6, s[12:15], s21 offen lds
    v_add_u32 v25, 57344, v24
    v_xor_b32 v26, 32, v25
    s_waitcnt vmcnt(24)
    ds_read_b64_tr_b16 v[96:97], v25 offset:0
    ds_read_b64_tr_b16 v[98:99], v25 offset:256
    ds_read_b64_tr_b16 v[168:169], v26 offset:0
    ds_read_b64_tr_b16 v[170:171], v26 offset:256
    ds_read_b64_tr_b16 v[100:101], v25 offset:2048
    ds_read_b64_tr_b16 v[102:103], v25 offset:2304
    ds_read_b64_tr_b16 v[172:173], v26 offset:2048
    ds_read_b64_tr_b16 v[174:175], v26 offset:2304
    s_waitcnt lgkmcnt(0)
    s_add_u32 s21, s28, 3670272
    s_add_u32 m0, s31, 57344
    s_nop 0
    buffer_load_dwordx4 v6, s[12:15], s21 offen lds
    s_add_u32 m0, s31, 58368
    s_add_u32 s21, s21, 131072
    buffer_load_dwordx4 v6, s[12:15], s21 offen lds
    s_add_u32 m0, s31, 59392
    s_add_u32 s21, s21, 131072
    buffer_load_dwordx4 v6, s[12:15], s21 offen lds
    s_add_u32 m0, s31, 60416
    s_add_u32 s21, s21, 131072
    buffer_load_dwordx4 v6, s[12:15], s21 offen lds
    v_add_u32 v25, 73728, v24
    v_xor_b32 v26, 32, v25
    s_waitcnt vmcnt(24)
    ds_read_b64_tr_b16 a[32:33], v25 offset:0
    ds_read_b64_tr_b16 a[34:35], v25 offset:256
    ds_read_b64_tr_b16 a[104:105], v26 offset:0
    ds_read_b64_tr_b16 a[106:107], v26 offset:256
    ds_read_b64_tr_b16 a[36:37], v25 offset:2048
    ds_read_b64_tr_b16 a[38:39], v25 offset:2304
    ds_read_b64_tr_b16 a[108:109], v26 offset:2048
    ds_read_b64_tr_b16 a[110:111], v26 offset:2304
    s_waitcnt lgkmcnt(0)
    s_add_u32 s21, s28, 4194304
    s_add_u32 m0, s31, 73728
    s_nop 0
    buffer_load_dwordx4 v6, s[12:15], s21 offen lds
    s_add_u32 m0, s31, 74752
    s_add_u32 s21, s21, 131072
    buffer_load_dwordx4 v6, s[12:15], s21 offen lds
    s_add_u32 m0, s31, 75776
    s_add_u32 s21, s21, 131072
    buffer_load_dwordx4 v6, s[12:15], s21 offen lds
    s_add_u32 m0, s31, 76800
    s_add_u32 s21, s21, 131072
    buffer_load_dwordx4 v6, s[12:15], s21 offen lds
    v_add_u32 v25, 90112, v24
    v_xor_b32 v26, 32, v25
    s_waitcnt vmcnt(24)
    ds_read_b64_tr_b16 v[104:105], v25 offset:0
    ds_read_b64_tr_b16 v[106:107], v25 offset:256
    ds_read_b64_tr_b16 v[176:177], v26 offset:0
    ds_read_b64_tr_b16 v[178:179], v26 offset:256
    ds_read_b64_tr_b16 v[108:109], v25 offset:2048
    ds_read_b64_tr_b16 v[110:111], v25 offset:2304
    ds_read_b64_tr_b16 v[180:181], v26 offset:2048
    ds_read_b64_tr_b16 v[182:183], v26 offset:2304
    s_waitcnt lgkmcnt(0)
    v_mov_b32 v28, s95
    s_cmp_lg_u32 s95, 0
    s_cbranch_scc1 L_ne
    buffer_load_dword v28, off, s[96:99], 0 offset:64 sc1
    s_cmp_ge_u32 s36, 192
    s_cbranch_scc1 L_ne
    s_mul_i32 s37, s36, 24576
    s_mov_b32 s46, 4718592
    s_mov_b32 s47, 0x20000
    v_lshlrev_b32 v29, 7, v0
    v_min_u32 v29, 24448, v29
    s_mov_b64 s[44:45], s[58:59]
    buffer_load_dword v30, v29, s[44:47], s37 offen
    s_mov_b64 s[44:45], s[52:53]
    buffer_load_dword v30, v29, s[44:47], s37 offen
L_ne:
    s_add_u32 s21, s28, 4194560
    s_add_u32 m0, s31, 90112
    s_nop 0
    buffer_load_dwordx4 v6, s[12:15], s21 offen lds
    s_add_u32 m0, s31, 91136
    s_add_u32 s21, s21, 131072
    buffer_load_dwordx4 v6, s[12:15], s21 offen lds
    s_add_u32 m0, s31, 92160
    s_add_u32 s21, s21, 131072
    buffer_load_dwordx4 v6, s[12:15], s21 offen lds
    s_add_u32 m0, s31, 93184
    s_add_u32 s21, s21, 131072
    buffer_load_dwordx4 v6, s[12:15], s21 offen lds
    v_add_u32 v25, 106496, v24
    v_xor_b32 v26, 32, v25
    s_waitcnt vmcnt(24)
    ds_read_b64_tr_b16 a[40:41], v25 offset:0
    ds_read_b64_tr_b16 a[42:43], v25 offset:256
    ds_read_b64_tr_b16 a[112:113], v26 offset:0
    ds_read_b64_tr_b16 a[114:115], v26 offset:256
    ds_read_b64_tr_b16 a[44:45], v25 offset:2048
    ds_read_b64_tr_b16 a[46:47], v25 offset:2304
    ds_read_b64_tr_b16 a[116:117], v26 offset:2048
    ds_read_b64_tr_b16 a[118:119], v26 offset:2304
    s_waitcnt lgkmcnt(0)
    v_add_u32 v25, 122880, v24
    v_xor_b32 v26, 32, v25
    s_waitcnt vmcnt(20)
    ds_read_b64_tr_b16 v[112:113], v25 offset:0
    ds_read_b64_tr_b16 v[114:115], v25 offset:256
    ds_read_b64_tr_b16 v[184:185], v26 offset:0
    ds_read_b64_tr_b16 v[186:187], v26 offset:256
    ds_read_b64_tr_b16 v[116:117], v25 offset:2048
    ds_read_b64_tr_b16 v[118:119], v25 offset:2304
    ds_read_b64_tr_b16 v[188:189], v26 offset:2048
    ds_read_b64_tr_b16 v[190:191], v26 offset:2304
    s_waitcnt lgkmcnt(0)
    v_add_u32 v25, 139264, v24
    v_xor_b32 v26, 32, v25
    s_waitcnt vmcnt(16)
    ds_read_b64_tr_b16 a[48:49], v25 offset:0
    ds_read_b64_tr_b16 a[50:51], v25 offset:256
    ds_read_b64_tr_b16 a[120:121], v26 offset:0
    ds_read_b64_tr_b16 a[122:123], v26 offset:256
    ds_read_b64_tr_b16 a[52:53], v25 offset:2048
    ds_read_b64_tr_b16 a[54:55], v25 offset:2304
    ds_read_b64_tr_b16 a[124:125], v26 offset:2048
    ds_read_b64_tr_b16 a[126:127], v26 offset:2304
    s_waitcnt lgkmcnt(0)
    v_add_u32 v25, 40960, v24
    v_xor_b32 v26, 32, v25
    s_waitcnt vmcnt(12)
    ds_read_b64_tr_b16 v[120:121], v25 offset:0
    ds_read_b64_tr_b16 v[122:123], v25 offset:256
    ds_read_b64_tr_b16 v[192:193], v26 offset:0
    ds_read_b64_tr_b16 v[194:195], v26 offset:256
    ds_read_b64_tr_b16 v[124:125], v25 offset:2048
    ds_read_b64_tr_b16 v[126:127], v25 offset:2304
    ds_read_b64_tr_b16 v[196:197], v26 offset:2048
    ds_read_b64_tr_b16 v[198:199], v26 offset:2304
    s_waitcnt lgkmcnt(0)
    v_add_u32 v25, 57344, v24
    v_xor_b32 v26, 32, v25
    s_waitcnt vmcnt(8)
    ds_read_b64_tr_b16 a[56:57], v25 offset:0
    ds_read_b64_tr_b16 a[58:59], v25 offset:256
    ds_read_b64_tr_b16 a[128:129], v26 offset:0
    ds_read_b64_tr_b16 a[130:131], v26 offset:256
    ds_read_b64_tr_b16 a[60:61], v25 offset:2048
    ds_read_b64_tr_b16 a[62:63], v25 offset:2304
    ds_read_b64_tr_b16 a[132:133], v26 offset:2048
    ds_read_b64_tr_b16 a[134:135], v26 offset:2304
    s_waitcnt lgkmcnt(0)
    v_add_u32 v25, 73728, v24
    v_xor_b32 v26, 32, v25
    s_waitcnt vmcnt(4)
    ds_read_b64_tr_b16 v[128:129], v25 offset:0
    ds_read_b64_tr_b16 v[130:131], v25 offset:256
    ds_read_b64_tr_b16 v[200:201], v26 offset:0
    ds_read_b64_tr_b16 v[202:203], v26 offset:256
    ds_read_b64_tr_b16 v[132:133], v25 offset:2048
    ds_read_b64_tr_b16 v[134:135], v25 offset:2304
    ds_read_b64_tr_b16 v[204:205], v26 offset:2048
    ds_read_b64_tr_b16 v[206:207], v26 offset:2304
    s_waitcnt lgkmcnt(0)
    v_add_u32 v25, 90112, v24
    v_xor_b32 v26, 32, v25
    s_waitcnt vmcnt(0)
    ds_read_b64_tr_b16 a[64:65], v25 offset:0
    ds_read_b64_tr_b16 a[66:67], v25 offset:256
    ds_read_b64_tr_b16 a[136:137], v26 offset:0
    ds_read_b64_tr_b16 a[138:139], v26 offset:256
    ds_read_b64_tr_b16 a[68:69], v25 offset:2048
    ds_read_b64_tr_b16 a[70:71], v25 offset:2304
    ds_read_b64_tr_b16 a[140:141], v26 offset:2048
    ds_read_b64_tr_b16 a[142:143], v26 offset:2304
    s_waitcnt lgkmcnt(0)
    s_lshr_b32 s21, s17, 3
    s_cmp_eq_u32 s21, 3
    s_cselect_b32 s21, 1, s33
    s_cmp_lg_u32 s21, 0
    s_cbranch_scc1 qk_noclr
    v_mov_b32 v8, -1
    v_mov_b32 v9, -1
    v_mov_b32 v10, -1
    v_mov_b32 v11, -1
    v_lshrrev_b32 v25, 6, v0
    v_mul_u32_u24 v25, 11264, v25
    v_add_u32 v25, v25, v7
    s_lshl_b32 s21, s17, 9
    s_add_u32 s21, s21, 90177536
    s_add_u32 s22, s21, 786432
qk_clr:
    buffer_store_dwordx4 v[8:11], v25, s[4:7], s21 offen sc1
    s_add_u32 s21, s21, 49152
    s_cmp_lt_u32 s21, s22
    s_cbranch_scc1 qk_clr
qk_noclr:
    s_and_b32 s21, s33, -2
    s_cmp_lg_u32 s21, 2
    s_cbranch_scc1 qk_noclr2
    v_mov_b32 v8, -1
    v_mov_b32 v9, -1
    v_mov_b32 v10, -1
    v_mov_b32 v11, -1
    s_add_u32 s21, s33, 60
    s_lshl_b32 s23, s17, 12
    s_lshl_b32 s22, s21, 17
    s_add_u32 s22, s22, s23
    s_add_u32 s22, s22, 71303168
    buffer_store_dwordx4 v[8:11], v7, s[4:7], s22 offen sc1
    s_add_u32 s22, s22, 4096
    buffer_store_dwordx4 v[8:11], v7, s[4:7], s22 offen sc1
    s_lshl_b32 s22, s21, 17
    s_add_u32 s22, s22, s23
    s_add_u32 s22, s22, 80740352
    buffer_store_dwordx4 v[8:11], v7, s[4:7], s22 offen sc1
    s_add_u32 s22, s22, 4096
    buffer_store_dwordx4 v[8:11], v7, s[4:7], s22 offen sc1
    s_lshl_b32 s22, s21, 18
    s_add_u32 s22, s22, s23
    s_add_u32 s22, s22, 50331648
    buffer_store_dwordx4 v[8:11], v7, s[4:7], s22 offen sc1
    s_add_u32 s22, s22, 4096
    buffer_store_dwordx4 v[8:11], v7, s[4:7], s22 offen sc1
    s_lshl_b32 s22, s21, 18
    s_add_u32 s22, s22, s23
    s_add_u32 s22, s22, 50462720
    buffer_store_dwordx4 v[8:11], v7, s[4:7], s22 offen sc1
    s_add_u32 s22, s22, 4096
    buffer_store_dwordx4 v[8:11], v7, s[4:7], s22 offen sc1
qk_noclr2:
    v_readfirstlane_b32 s95, v28
    s_nop 4
    s_mov_b32 s88, 4194304
gn7:
    s_cmp_lg_u32 s95, 0
    s_cbranch_scc1 gn7x
    buffer_load_dword v25, off, s[96:99], 0 offset:64 sc1
    s_sub_u32 s88, s88, 1
    s_cbranch_scc1 gn7x
    s_waitcnt vmcnt(0)
    v_readfirstlane_b32 s95, v25
    s_nop 1
    s_branch gn7
gn7x:
    s_barrier
    s_mov_b32 s27, 36864
    s_add_u32 s23, s27, s25
    s_add_u32 m0, s23, 0
    s_nop 0
    buffer_load_dwordx4 v2, s[8:11], s24 offen offset:0 lds
    s_add_u32 m0, s23, 960
    s_nop 0
    buffer_load_dwordx4 v2, s[8:11], s24 offen offset:64 lds
    s_add_u32 m0, s23, 1920
    s_nop 0
    buffer_load_dwordx4 v2, s[8:11], s24 offen offset:128 lds
    s_add_u32 m0, s23, 2880
    s_nop 0
    buffer_load_dwordx4 v2, s[8:11], s24 offen offset:192 lds
    s_add_u32 m0, s23, 3840
    s_nop 0
    buffer_load_dwordx4 v2, s[8:11], s24 offen offset:256 lds
    s_add_u32 m0, s23, 4800
    s_nop 0
    buffer_load_dwordx4 v2, s[8:11], s24 offen offset:320 lds
    s_add_u32 m0, s23, 5760
    s_nop 0
    buffer_load_dwordx4 v2, s[8:11], s24 offen offset:384 lds
    s_add_u32 m0, s23, 6720
    s_nop 0
    buffer_load_dwordx4 v2, s[8:11], s24 offen offset:448 lds
    s_add_u32 m0, s23, 7680
    s_nop 0
    buffer_load_dwordx4 v2, s[8:11], s24 offen offset:512 lds
    s_add_u32 s24, s24, s42
    s_mov_b32 s27, 0
    s_mov_b32 s30, s95
    s_cmp_eq_u32 s18, 0
    s_cselect_b32 s34, 1, 0
    s_mov_b32 s35, 0
    s_mov_b32 s31, 0x80000000
    v_mov_b32 v3, v1
    ds_read_b128 v[32:35], v3 offset:0
    ds_read_b128 v[36:39], v3 offset:18432
    ds_read_b128 v[40:43], v3 offset:1024
    ds_read_b128 v[44:47], v3 offset:19456
    s_cmp_eq_u32 s16, 2
    s_cbranch_scc1 qk_vloop
qk_loop:
    s_add_u32 s22, s27, 73728
    s_sub_u32 s21, s22, 147456
    s_cselect_b32 s22, s22, s21
    s_add_u32 s27, s27, 36864
    s_cmp_eq_u32 s27, 147456
    s_cselect_b32 s27, 0, s27
    s_waitcnt lgkmcnt(2)
    v_cvt_pk_bf16_f32 v8, v208, v209
    v_cvt_pk_bf16_f32 v9, v210, v211
    v_mfma_f32_16x16x32_bf16 v[208:211], v[64:67], v[32:35], 0
    ds_read_b128 v[48:51], v3 offset:2048
    ds_read_b128 v[52:55], v3 offset:20480
    v_cvt_pk_bf16_f32 v10, v212, v213
    v_cvt_pk_bf16_f32 v11, v214, v215
    v_mfma_f32_16x16x32_bf16 v[212:215], v[136:139], v[32:35], 0
    v_cvt_pk_bf16_f32 v12, v216, v217
    v_cvt_pk_bf16_f32 v13, v218, v219
    v_mfma_f32_16x16x32_bf16 v[216:219], v[64:67], v[36:39], 0
    v_cvt_pk_bf16_f32 v14, v220, v221
    v_cvt_pk_bf16_f32 v15, v222, v223
    v_mfma_f32_16x16x32_bf16 v[220:223], v[136:139], v[36:39], 0
    v_cvt_pk_bf16_f32 v16, v224, v225
    v_cvt_pk_bf16_f32 v17, v226, v227
    v_mfma_f32_16x16x32_bf16 v[224:227], a[0:3], v[32:35], 0
    v_cvt_pk_bf16_f32 v18, v228, v229
    v_cvt_pk_bf16_f32 v19, v230, v231
    v_mfma_f32_16x16x32_bf16 v[228:231], a[72:75], v[32:35], 0
    v_cvt_pk_bf16_f32 v20, v232, v233
    v_cvt_pk_bf16_f32 v21, v234, v235
    v_mfma_f32_16x16x32_bf16 v[232:235], a[0:3], v[36:39], 0
    v_cvt_pk_bf16_f32 v22, v236, v237
    v_cvt_pk_bf16_f32 v23, v238, v239
    v_mfma_f32_16x16x32_bf16 v[236:239], a[72:75], v[36:39], 0
    s_waitcnt lgkmcnt(2)
    v_mfma_f32_16x16x32_bf16 v[208:211], v[68:71], v[40:43], v[208:211]
    ds_read_b128 v[32:35], v3 offset:3072
    ds_read_b128 v[36:39], v3 offset:21504
    v_mfma_f32_16x16x32_bf16 v[212:215], v[140:143], v[40:43], v[212:215]
    v_mfma_f32_16x16x32_bf16 v[216:219], v[68:71], v[44:47], v[216:219]
    s_mov_b32 s28, s31
    buffer_store_dwordx4 v[8:11], v7, s[4:7], s28 offen sc1
    v_mfma_f32_16x16x32_bf16 v[220:223], v[140:143], v[44:47], v[220:223]
    v_mfma_f32_16x16x32_bf16 v[224:227], a[4:7], v[40:43], v[224:227]
    v_mfma_f32_16x16x32_bf16 v[228:231], a[76:79], v[40:43], v[228:231]
    v_mfma_f32_16x16x32_bf16 v[232:235], a[4:7], v[44:47], v[232:235]
    v_mfma_f32_16x16x32_bf16 v[236:239], a[76:79], v[44:47], v[236:239]
    s_waitcnt lgkmcnt(2)
    v_mfma_f32_16x16x32_bf16 v[208:211], v[72:75], v[48:51], v[208:211]
    ds_read_b128 v[40:43], v3 offset:4096
    ds_read_b128 v[44:47], v3 offset:22528
    v_mfma_f32_16x16x32_bf16 v[212:215], v[144:147], v[48:51], v[212:215]
    v_mfma_f32_16x16x32_bf16 v[216:219], v[72:75], v[52:55], v[216:219]
    s_add_u32 s28, s28, s40
    buffer_store_dwordx4 v[12:15], v7, s[4:7], s28 offen sc1
    v_mfma_f32_16x16x32_bf16 v[220:223], v[144:147], v[52:55], v[220:223]
    v_mfma_f32_16x16x32_bf16 v[224:227], a[8:11], v[48:51], v[224:227]
    v_mfma_f32_16x16x32_bf16 v[228:231], a[80:83], v[48:51], v[228:231]
    v_mfma_f32_16x16x32_bf16 v[232:235], a[8:11], v[52:55], v[232:235]
    v_mfma_f32_16x16x32_bf16 v[236:239], a[80:83], v[52:55], v[236:239]
    s_waitcnt lgkmcnt(2)
    v_mfma_f32_16x16x32_bf16 v[208:211], v[76:79], v[32:35], v[208:211]
    ds_read_b128 v[48:51], v3 offset:5120
    ds_read_b128 v[52:55], v3 offset:23552
    v_mfma_f32_16x16x32_bf16 v[212:215], v[148:151], v[32:35], v[212:215]
    v_mfma_f32_16x16x32_bf16 v[216:219], v[76:79], v[36:39], v[216:219]
    s_add_u32 s28, s31, s43
    buffer_store_dwordx4 v[16:19], v7, s[4:7], s28 offen sc1
    v_mfma_f32_16x16x32_bf16 v[220:223], v[148:151], v[36:39], v[220:223]
    v_mfma_f32_16x16x32_bf16 v[224:227], a[12:15], v[32:35], v[224:227]
    v_mfma_f32_16x16x32_bf16 v[228:231], a[84:87], v[32:35], v[228:231]
    v_mfma_f32_16x16x32_bf16 v[232:235], a[12:15], v[36:39], v[232:235]
    v_mfma_f32_16x16x32_bf16 v[236:239], a[84:87], v[36:39], v[236:239]
    s_waitcnt lgkmcnt(2)
    v_mfma_f32_16x16x32_bf16 v[208:211], v[80:83], v[40:43], v[208:211]
    ds_read_b128 v[32:35], v3 offset:6144
    ds_read_b128 v[36:39], v3 offset:24576
    v_mfma_f32_16x16x32_bf16 v[212:215], v[152:155], v[40:43], v[212:215]
    v_mfma_f32_16x16x32_bf16 v[216:219], v[80:83], v[44:47], v[216:219]
    s_add_u32 s28, s28, s40
    buffer_store_dwordx4 v[20:23], v7, s[4:7], s28 offen sc1
    v_mfma_f32_16x16x32_bf16 v[220:223], v[152:155], v[44:47], v[220:223]
    v_mfma_f32_16x16x32_bf16 v[224:227], a[16:19], v[40:43], v[224:227]
    v_mfma_f32_16x16x32_bf16 v[228:231], a[88:91], v[40:43], v[228:231]
    v_mfma_f32_16x16x32_bf16 v[232:235], a[16:19], v[44:47], v[232:235]
    v_mfma_f32_16x16x32_bf16 v[236:239], a[88:91], v[44:47], v[236:239]
    s_waitcnt lgkmcnt(2)
    v_mfma_f32_16x16x32_bf16 v[208:211], v[84:87], v[48:51], v[208:211]
    ds_read_b128 v[40:43], v3 offset:7168
    ds_read_b128 v[44:47], v3 offset:25600
    v_mfma_f32_16x16x32_bf16 v[212:215], v[156:159], v[48:51], v[212:215]
    v_mfma_f32_16x16x32_bf16 v[216:219], v[84:87], v[52:55], v[216:219]
    s_add_u32 s23, s22, s25
    s_add_u32 m0, s23, 0
    s_nop 0
    buffer_load_dwordx4 v2, s[8:11], s24 offen offset:0 lds
    v_mfma_f32_16x16x32_bf16 v[220:223], v[156:159], v[52:55], v[220:223]
    v_mfma_f32_16x16x32_bf16 v[224:227], a[20:23], v[48:51], v[224:227]
    v_mfma_f32_16x16x32_bf16 v[228:231], a[92:95], v[48:51], v[228:231]
    v_mfma_f32_16x16x32_bf16 v[232:235], a[20:23], v[52:55], v[232:235]
    v_mfma_f32_16x16x32_bf16 v[236:239], a[92:95], v[52:55], v[236:239]
    s_waitcnt lgkmcnt(2)
    v_mfma_f32_16x16x32_bf16 v[208:211], v[88:91], v[32:35], v[208:211]
    ds_read_b128 v[48:51], v3 offset:8192
    ds_read_b128 v[52:55], v3 offset:26624
    v_mfma_f32_16x16x32_bf16 v[212:215], v[160:163], v[32:35], v[212:215]
    v_mfma_f32_16x16x32_bf16 v[216:219], v[88:91], v[36:39], v[216:219]
    s_add_u32 m0, s23, 960
    s_nop 0
    buffer_load_dwordx4 v2, s[8:11], s24 offen offset:64 lds
    v_mfma_f32_16x16x32_bf16 v[220:223], v[160:163], v[36:39], v[220:223]
    v_mfma_f32_16x16x32_bf16 v[224:227], a[24:27], v[32:35], v[224:227]
    v_mfma_f32_16x16x32_bf16 v[228:231], a[96:99], v[32:35], v[228:231]
    v_mfma_f32_16x16x32_bf16 v[232:235], a[24:27], v[36:39], v[232:235]
    v_mfma_f32_16x16x32_bf16 v[236:239], a[96:99], v[36:39], v[236:239]
    s_waitcnt lgkmcnt(2)
    v_mfma_f32_16x16x32_bf16 v[208:211], v[92:95], v[40:43], v[208:211]
    ds_read_b128 v[32:35], v3 offset:9216
    ds_read_b128 v[36:39], v3 offset:27648
    v_mfma_f32_16x16x32_bf16 v[212:215], v[164:167], v[40:43], v[212:215]
    v_mfma_f32_16x16x32_bf16 v[216:219], v[92:95], v[44:47], v[216:219]
    s_add_u32 m0, s23, 1920
    s_nop 0
    buffer_load_dwordx4 v2, s[8:11], s24 offen offset:128 lds
    v_mfma_f32_16x16x32_bf16 v[220:223], v[164:167], v[44:47], v[220:223]
    v_mfma_f32_16x16x32_bf16 v[224:227], a[28:31], v[40:43], v[224:227]
    v_mfma_f32_16x16x32_bf16 v[228:231], a[100:103], v[40:43], v[228:231]
    v_mfma_f32_16x16x32_bf16 v[232:235], a[28:31], v[44:47], v[232:235]
    v_mfma_f32_16x16x32_bf16 v[236:239], a[100:103], v[44:47], v[236:239]
    s_waitcnt lgkmcnt(2)
    v_mfma_f32_16x16x32_bf16 v[208:211], v[96:99], v[48:51], v[208:211]
    ds_read_b128 v[40:43], v3 offset:10240
    ds_read_b128 v[44:47], v3 offset:28672
    v_mfma_f32_16x16x32_bf16 v[212:215], v[168:171], v[48:51], v[212:215]
    v_mfma_f32_16x16x32_bf16 v[216:219], v[96:99], v[52:55], v[216:219]
    s_add_u32 m0, s23, 2880
    s_nop 0
    buffer_load_dwordx4 v2, s[8:11], s24 offen offset:192 lds
    v_mfma_f32_16x16x32_bf16 v[220:223], v[168:171], v[52:55], v[220:223]
    v_mfma_f32_16x16x32_bf16 v[224:227], a[32:35], v[48:51], v[224:227]
    v_mfma_f32_16x16x32_bf16 v[228:231], a[104:107], v[48:51], v[228:231]
    v_mfma_f32_16x16x32_bf16 v[232:235], a[32:35], v[52:55], v[232:235]
    v_mfma_f32_16x16x32_bf16 v[236:239], a[104:107], v[52:55], v[236:239]
    s_waitcnt lgkmcnt(2)
    v_mfma_f32_16x16x32_bf16 v[208:211], v[100:103], v[32:35], v[208:211]
    ds_read_b128 v[48:51], v3 offset:11264
    ds_read_b128 v[52:55], v3 offset:29696
    v_mfma_f32_16x16x32_bf16 v[212:215], v[172:175], v[32:35], v[212:215]
    v_mfma_f32_16x16x32_bf16 v[216:219], v[100:103], v[36:39], v[216:219]
    s_add_u32 m0, s23, 3840
    s_nop 0
    buffer_load_dwordx4 v2, s[8:11], s24 offen offset:256 lds
    v_mfma_f32_16x16x32_bf16 v[220:223], v[172:175], v[36:39], v[220:223]
    v_mfma_f32_16x16x32_bf16 v[224:227], a[36:39], v[32:35], v[224:227]
    v_mfma_f32_16x16x32_bf16 v[228:231], a[108:111], v[32:35], v[228:231]
    v_mfma_f32_16x16x32_bf16 v[232:235], a[36:39], v[36:39], v[232:235]
    v_mfma_f32_16x16x32_bf16 v[236:239], a[108:111], v[36:39], v[236:239]
    s_waitcnt lgkmcnt(2)
    v_mfma_f32_16x16x32_bf16 v[208:211], v[104:107], v[40:43], v[208:211]
    ds_read_b128 v[32:35], v3 offset:12288
    ds_read_b128 v[36:39], v3 offset:30720
    v_mfma_f32_16x16x32_bf16 v[212:215], v[176:179], v[40:43], v[212:215]
    v_mfma_f32_16x16x32_bf16 v[216:219], v[104:107], v[44:47], v[216:219]
    s_add_u32 m0, s23, 4800
    s_nop 0
    buffer_load_dwordx4 v2, s[8:11], s24 offen offset:320 lds
    v_mfma_f32_16x16x32_bf16 v[220:223], v[176:179], v[44:47], v[220:223]
    v_mfma_f32_16x16x32_bf16 v[224:227], a[40:43], v[40:43], v[224:227]
    v_mfma_f32_16x16x32_bf16 v[228:231], a[112:115], v[40:43], v[228:231]
    v_mfma_f32_16x16x32_bf16 v[232:235], a[40:43], v[44:47], v[232:235]
    v_mfma_f32_16x16x32_bf16 v[236:239], a[112:115], v[44:47], v[236:239]
    s_waitcnt lgkmcnt(2)
    v_mfma_f32_16x16x32_bf16 v[208:211], v[108:111], v[48:51], v[208:211]
    ds_read_b128 v[40:43], v3 offset:13312
    ds_read_b128 v[44:47], v3 offset:31744
    v_mfma_f32_16x16x32_bf16 v[212:215], v[180:183], v[48:51], v[212:215]
    v_mfma_f32_16x16x32_bf16 v[216:219], v[108:111], v[52:55], v[216:219]
    s_add_u32 m0, s23, 5760
    s_nop 0
    buffer_load_dwordx4 v2, s[8:11], s24 offen offset:384 lds
    v_mfma_f32_16x16x32_bf16 v[220:223], v[180:183], v[52:55], v[220:223]
    v_mfma_f32_16x16x32_bf16 v[224:227], a[44:47], v[48:51], v[224:227]
    v_mfma_f32_16x16x32_bf16 v[228:231], a[116:119], v[48:51], v[228:231]
    v_mfma_f32_16x16x32_bf16 v[232:235], a[44:47], v[52:55], v[232:235]
    v_mfma_f32_16x16x32_bf16 v[236:239], a[116:119], v[52:55], v[236:239]
    s_waitcnt lgkmcnt(2)
    v_mfma_f32_16x16x32_bf16 v[208:211], v[112:115], v[32:35], v[208:211]
    ds_read_b128 v[48:51], v3 offset:14336
    ds_read_b128 v[52:55], v3 offset:32768
    v_mfma_f32_16x16x32_bf16 v[212:215], v[184:187], v[32:35], v[212:215]
    v_mfma_f32_16x16x32_bf16 v[216:219], v[112:115], v[36:39], v[216:219]
    s_add_u32 m0, s23, 6720
    s_nop 0
    buffer_load_dwordx4 v2, s[8:11], s24 offen offset:448 lds
    v_mfma_f32_16x16x32_bf16 v[220:223], v[184:187], v[36:39], v[220:223]
    v_mfma_f32_16x16x32_bf16 v[224:227], a[48:51], v[32:35], v[224:227]
    v_mfma_f32_16x16x32_bf16 v[228:231], a[120:123], v[32:35], v[228:231]
    v_mfma_f32_16x16x32_bf16 v[232:235], a[48:51], v[36:39], v[232:235]
    v_mfma_f32_16x16x32_bf16 v[236:239], a[120:123], v[36:39], v[236:239]
    s_waitcnt lgkmcnt(2)
    v_mfma_f32_16x16x32_bf16 v[208:211], v[116:119], v[40:43], v[208:211]
    ds_read_b128 v[32:35], v3 offset:15360
    ds_read_b128 v[36:39], v3 offset:33792
    v_mfma_f32_16x16x32_bf16 v[212:215], v[188:191], v[40:43], v[212:215]
    v_mfma_f32_16x16x32_bf16 v[216:219], v[116:119], v[44:47], v[216:219]
    s_add_u32 m0, s23, 7680
    s_nop 0
    buffer_load_dwordx4 v2, s[8:11], s24 offen offset:512 lds
    s_add_u32 s24, s24, s42
    v_mfma_f32_16x16x32_bf16 v[220:223], v[188:191], v[44:47], v[220:223]
    v_mfma_f32_16x16x32_bf16 v[224:227], a[52:55], v[40:43], v[224:227]
    v_mfma_f32_16x16x32_bf16 v[228:231], a[124:127], v[40:43], v[228:231]
    v_mfma_f32_16x16x32_bf16 v[232:235], a[52:55], v[44:47], v[232:235]
    v_mfma_f32_16x16x32_bf16 v[236:239], a[124:127], v[44:47], v[236:239]
    s_waitcnt lgkmcnt(2)
    v_mfma_f32_16x16x32_bf16 v[208:211], v[120:123], v[48:51], v[208:211]
    ds_read_b128 v[40:43], v3 offset:16384
    ds_read_b128 v[44:47], v3 offset:34816
    v_mfma_f32_16x16x32_bf16 v[212:215], v[192:195], v[48:51], v[212:215]
    v_mfma_f32_16x16x32_bf16 v[216:219], v[120:123], v[52:55], v[216:219]
    v_add_u32 v24, s27, v1
    v_mfma_f32_16x16x32_bf16 v[220:223], v[192:195], v[52:55], v[220:223]
    v_mfma_f32_16x16x32_bf16 v[224:227], a[56:59], v[48:51], v[224:227]
    v_mfma_f32_16x16x32_bf16 v[228:231], a[128:131], v[48:51], v[228:231]
    v_mfma_f32_16x16x32_bf16 v[232:235], a[56:59], v[52:55], v[232:235]
    v_mfma_f32_16x16x32_bf16 v[236:239], a[128:131], v[52:55], v[236:239]
    s_waitcnt lgkmcnt(2)
    v_mfma_f32_16x16x32_bf16 v[208:211], v[124:127], v[32:35], v[208:211]
    ds_read_b128 v[48:51], v3 offset:17408
    ds_read_b128 v[52:55], v3 offset:35840
    v_mfma_f32_16x16x32_bf16 v[212:215], v[196:199], v[32:35], v[212:215]
    v_mfma_f32_16x16x32_bf16 v[216:219], v[124:127], v[36:39], v[216:219]
    v_mfma_f32_16x16x32_bf16 v[220:223], v[196:199], v[36:39], v[220:223]
    v_mfma_f32_16x16x32_bf16 v[224:227], a[60:63], v[32:35], v[224:227]
    v_mfma_f32_16x16x32_bf16 v[228:231], a[132:135], v[32:35], v[228:231]
    s_waitcnt vmcnt(9)
    s_barrier
    v_mfma_f32_16x16x32_bf16 v[232:235], a[60:63], v[36:39], v[232:235]
    v_mfma_f32_16x16x32_bf16 v[236:239], a[132:135], v[36:39], v[236:239]
    s_waitcnt lgkmcnt(2)
    v_mfma_f32_16x16x32_bf16 v[208:211], v[128:131], v[40:43], v[208:211]
    ds_read_b128 v[32:35], v24 offset:0
    ds_read_b128 v[36:39], v24 offset:18432
    v_mfma_f32_16x16x32_bf16 v[212:215], v[200:203], v[40:43], v[212:215]
    v_mfma_f32_16x16x32_bf16 v[216:219], v[128:131], v[44:47], v[216:219]
    v_mov_b32 v4, s30
    s_mov_b64 exec, s[34:35]
    buffer_store_dword v4, off, s[4:7], s29 sc1
    s_mov_b64 exec, -1
    v_mfma_f32_16x16x32_bf16 v[220:223], v[200:203], v[44:47], v[220:223]
    v_mfma_f32_16x16x32_bf16 v[224:227], a[64:67], v[40:43], v[224:227]
    v_mfma_f32_16x16x32_bf16 v[228:231], a[136:139], v[40:43], v[228:231]
    v_mfma_f32_16x16x32_bf16 v[232:235], a[64:67], v[44:47], v[232:235]
    v_mfma_f32_16x16x32_bf16 v[236:239], a[136:139], v[44:47], v[236:239]
    s_waitcnt lgkmcnt(2)
    v_mfma_f32_16x16x32_bf16 v[208:211], v[132:135], v[48:51], v[208:211]
    ds_read_b128 v[40:43], v24 offset:1024
    ds_read_b128 v[44:47], v24 offset:19456
    v_mfma_f32_16x16x32_bf16 v[212:215], v[204:207], v[48:51], v[212:215]
    v_mfma_f32_16x16x32_bf16 v[216:219], v[132:135], v[52:55], v[216:219]
    v_mfma_f32_16x16x32_bf16 v[220:223], v[204:207], v[52:55], v[220:223]
    v_mfma_f32_16x16x32_bf16 v[224:227], a[68:71], v[48:51], v[224:227]
    v_mfma_f32_16x16x32_bf16 v[228:231], a[140:143], v[48:51], v[228:231]
    v_mfma_f32_16x16x32_bf16 v[232:235], a[68:71], v[52:55], v[232:235]
    v_mfma_f32_16x16x32_bf16 v[236:239], a[140:143], v[52:55], v[236:239]
    v_mov_b32 v3, v24
    s_mov_b32 s31, s26
    s_add_u32 s26, s26, s41
    s_add_u32 s30, s30, 1
    s_add_u32 s19, s19, s20
    s_cmp_lt_u32 s19, 64
    s_cbranch_scc1 qk_loop
    v_cvt_pk_bf16_f32 v8, v208, v209
    v_cvt_pk_bf16_f32 v9, v210, v211
    v_cvt_pk_bf16_f32 v10, v212, v213
    v_cvt_pk_bf16_f32 v11, v214, v215
    v_cvt_pk_bf16_f32 v12, v216, v217
    v_cvt_pk_bf16_f32 v13, v218, v219
    v_cvt_pk_bf16_f32 v14, v220, v221
    v_cvt_pk_bf16_f32 v15, v222, v223
    v_cvt_pk_bf16_f32 v16, v224, v225
    v_cvt_pk_bf16_f32 v17, v226, v227
    v_cvt_pk_bf16_f32 v18, v228, v229
    v_cvt_pk_bf16_f32 v19, v230, v231
    v_cvt_pk_bf16_f32 v20, v232, v233
    v_cvt_pk_bf16_f32 v21, v234, v235
    v_cvt_pk_bf16_f32 v22, v236, v237
    v_cvt_pk_bf16_f32 v23, v238, v239
    s_branch qk_done
    s_nop 0
qk_vloop:
    s_add_u32 s22, s27, 73728
    s_sub_u32 s21, s22, 147456
    s_cselect_b32 s22, s22, s21
    s_add_u32 s27, s27, 36864
    s_cmp_eq_u32 s27, 147456
    s_cselect_b32 s27, 0, s27
    s_waitcnt lgkmcnt(2)
    v_cvt_pk_bf16_f32 v8, v208, v209
    v_cvt_pk_bf16_f32 v9, v210, v211
    v_mfma_f32_16x16x32_bf16 v[208:211], v[32:35], v[64:67], 0
    ds_read_b128 v[48:51], v3 offset:2048
    ds_read_b128 v[52:55], v3 offset:20480
    v_cvt_pk_bf16_f32 v12, v212, v213
    v_cvt_pk_bf16_f32 v13, v214, v215
    v_mfma_f32_16x16x32_bf16 v[212:215], v[32:35], v[136:139], 0
    v_cvt_pk_bf16_f32 v10, v216, v217
    v_cvt_pk_bf16_f32 v11, v218, v219
    v_mfma_f32_16x16x32_bf16 v[216:219], v[36:39], v[64:67], 0
    v_cvt_pk_bf16_f32 v14, v220, v221
    v_cvt_pk_bf16_f32 v15, v222, v223
    v_mfma_f32_16x16x32_bf16 v[220:223], v[36:39], v[136:139], 0
    v_cvt_pk_bf16_f32 v16, v224, v225
    v_cvt_pk_bf16_f32 v17, v226, v227
    v_mfma_f32_16x16x32_bf16 v[224:227], v[32:35], a[0:3], 0
    v_cvt_pk_bf16_f32 v20, v228, v229
    v_cvt_pk_bf16_f32 v21, v230, v231
    v_mfma_f32_16x16x32_bf16 v[228:231], v[32:35], a[72:75], 0
    v_cvt_pk_bf16_f32 v18, v232, v233
    v_cvt_pk_bf16_f32 v19, v234, v235
    v_mfma_f32_16x16x32_bf16 v[232:235], v[36:39], a[0:3], 0
    v_cvt_pk_bf16_f32 v22, v236, v237
    v_cvt_pk_bf16_f32 v23, v238, v239
    v_mfma_f32_16x16x32_bf16 v[236:239], v[36:39], a[72:75], 0
    s_waitcnt lgkmcnt(2)
    v_mfma_f32_16x16x32_bf16 v[208:211], v[40:43], v[68:71], v[208:211]
    ds_read_b128 v[32:35], v3 offset:3072
    ds_read_b128 v[36:39], v3 offset:21504
    v_mfma_f32_16x16x32_bf16 v[212:215], v[40:43], v[140:143], v[212:215]
    v_mfma_f32_16x16x32_bf16 v[216:219], v[44:47], v[68:71], v[216:219]
    s_mov_b32 s28, s31
    buffer_store_dwordx4 v[8:11], v7, s[4:7], s28 offen sc1
    v_mfma_f32_16x16x32_bf16 v[220:223], v[44:47], v[140:143], v[220:223]
    v_mfma_f32_16x16x32_bf16 v[224:227], v[40:43], a[4:7], v[224:227]
    v_mfma_f32_16x16x32_bf16 v[228:231], v[40:43], a[76:79], v[228:231]
    v_mfma_f32_16x16x32_bf16 v[232:235], v[44:47], a[4:7], v[232:235]
    v_mfma_f32_16x16x32_bf16 v[236:239], v[44:47], a[76:79], v[236:239]
    s_waitcnt lgkmcnt(2)
    v_mfma_f32_16x16x32_bf16 v[208:211], v[48:51], v[72:75], v[208:211]
    ds_read_b128 v[40:43], v3 offset:4096
    ds_read_b128 v[44:47], v3 offset:22528
    v_mfma_f32_16x16x32_bf16 v[212:215], v[48:51], v[144:147], v[212:215]
    v_mfma_f32_16x16x32_bf16 v[216:219], v[52:55], v[72:75], v[216:219]
    s_add_u32 s28, s28, s40
    buffer_store_dwordx4 v[12:15], v7, s[4:7], s28 offen sc1
    v_mfma_f32_16x16x32_bf16 v[220:223], v[52:55], v[144:147], v[220:223]
    v_mfma_f32_16x16x32_bf16 v[224:227], v[48:51], a[8:11], v[224:227]
    v_mfma_f32_16x16x32_bf16 v[228:231], v[48:51], a[80:83], v[228:231]
    v_mfma_f32_16x16x32_bf16 v[232:235], v[52:55], a[8:11], v[232:235]
    v_mfma_f32_16x16x32_bf16 v[236:239], v[52:55], a[80:83], v[236:239]
    s_waitcnt lgkmcnt(2)
    v_mfma_f32_16x16x32_bf16 v[208:211], v[32:35], v[76:79], v[208:211]
    ds_read_b128 v[48:51], v3 offset:5120
    ds_read_b128 v[52:55], v3 offset:23552
    v_mfma_f32_16x16x32_bf16 v[212:215], v[32:35], v[148:151], v[212:215]
    v_mfma_f32_16x16x32_bf16 v[216:219], v[36:39], v[76:79], v[216:219]
    s_add_u32 s28, s31, s43
    buffer_store_dwordx4 v[16:19], v7, s[4:7], s28 offen sc1
    v_mfma_f32_16x16x32_bf16 v[220:223], v[36:39], v[148:151], v[220:223]
    v_mfma_f32_16x16x32_bf16 v[224:227], v[32:35], a[12:15], v[224:227]
    v_mfma_f32_16x16x32_bf16 v[228:231], v[32:35], a[84:87], v[228:231]
    v_mfma_f32_16x16x32_bf16 v[232:235], v[36:39], a[12:15], v[232:235]
    v_mfma_f32_16x16x32_bf16 v[236:239], v[36:39], a[84:87], v[236:239]
    s_waitcnt lgkmcnt(2)
    v_mfma_f32_16x16x32_bf16 v[208:211], v[40:43], v[80:83], v[208:211]
    ds_read_b128 v[32:35], v3 offset:6144
    ds_read_b128 v[36:39], v3 offset:24576
    v_mfma_f32_16x16x32_bf16 v[212:215], v[40:43], v[152:155], v[212:215]
    v_mfma_f32_16x16x32_bf16 v[216:219], v[44:47], v[80:83], v[216:219]
    s_add_u32 s28, s28, s40
    buffer_store_dwordx4 v[20:23], v7, s[4:7], s28 offen sc1
    v_mfma_f32_16x16x32_bf16 v[220:223], v[44:47], v[152:155], v[220:223]
    v_mfma_f32_16x16x32_bf16 v[224:227], v[40:43], a[16:19], v[224:227]
    v_mfma_f32_16x16x32_bf16 v[228:231], v[40:43], a[88:91], v[228:231]
    v_mfma_f32_16x16x32_bf16 v[232:235], v[44:47], a[16:19], v[232:235]
    v_mfma_f32_16x16x32_bf16 v[236:239], v[44:47], a[88:91], v[236:239]
    s_waitcnt lgkmcnt(2)
    v_mfma_f32_16x16x32_bf16 v[208:211], v[48:51], v[84:87], v[208:211]
    ds_read_b128 v[40:43], v3 offset:7168
    ds_read_b128 v[44:47], v3 offset:25600
    v_mfma_f32_16x16x32_bf16 v[212:215], v[48:51], v[156:159], v[212:215]
    v_mfma_f32_16x16x32_bf16 v[216:219], v[52:55], v[84:87], v[216:219]
    s_add_u32 s23, s22, s25
    s_add_u32 m0, s23, 0
    s_nop 0
    buffer_load_dwordx4 v2, s[8:11], s24 offen offset:0 lds
    v_mfma_f32_16x16x32_bf16 v[220:223], v[52:55], v[156:159], v[220:223]
    v_mfma_f32_16x16x32_bf16 v[224:227], v[48:51], a[20:23], v[224:227]
    v_mfma_f32_16x16x32_bf16 v[228:231], v[48:51], a[92:95], v[228:231]
    v_mfma_f32_16x16x32_bf16 v[232:235], v[52:55], a[20:23], v[232:235]
    v_mfma_f32_16x16x32_bf16 v[236:239], v[52:55], a[92:95], v[236:239]
    s_waitcnt lgkmcnt(2)
    v_mfma_f32_16x16x32_bf16 v[208:211], v[32:35], v[88:91], v[208:211]
    ds_read_b128 v[48:51], v3 offset:8192
    ds_read_b128 v[52:55], v3 offset:26624
    v_mfma_f32_16x16x32_bf16 v[212:215], v[32:35], v[160:163], v[212:215]
    v_mfma_f32_16x16x32_bf16 v[216:219], v[36:39], v[88:91], v[216:219]
    s_add_u32 m0, s23, 960
    s_nop 0
    buffer_load_dwordx4 v2, s[8:11], s24 offen offset:64 lds
    v_mfma_f32_16x16x32_bf16 v[220:223], v[36:39], v[160:163], v[220:223]
    v_mfma_f32_16x16x32_bf16 v[224:227], v[32:35], a[24:27], v[224:227]
    v_mfma_f32_16x16x32_bf16 v[228:231], v[32:35], a[96:99], v[228:231]
    v_mfma_f32_16x16x32_bf16 v[232:235], v[36:39], a[24:27], v[232:235]
    v_mfma_f32_16x16x32_bf16 v[236:239], v[36:39], a[96:99], v[236:239]
    s_waitcnt lgkmcnt(2)
    v_mfma_f32_16x16x32_bf16 v[208:211], v[40:43], v[92:95], v[208:211]
    ds_read_b128 v[32:35], v3 offset:9216
    ds_read_b128 v[36:39], v3 offset:27648
    v_mfma_f32_16x16x32_bf16 v[212:215], v[40:43], v[164:167], v[212:215]
    v_mfma_f32_16x16x32_bf16 v[216:219], v[44:47], v[92:95], v[216:219]
    s_add_u32 m0, s23, 1920
    s_nop 0
    buffer_load_dwordx4 v2, s[8:11], s24 offen offset:128 lds
    v_mfma_f32_16x16x32_bf16 v[220:223], v[44:47], v[164:167], v[220:223]
    v_mfma_f32_16x16x32_bf16 v[224:227], v[40:43], a[28:31], v[224:227]
    v_mfma_f32_16x16x32_bf16 v[228:231], v[40:43], a[100:103], v[228:231]
    v_mfma_f32_16x16x32_bf16 v[232:235], v[44:47], a[28:31], v[232:235]
    v_mfma_f32_16x16x32_bf16 v[236:239], v[44:47], a[100:103], v[236:239]
    s_waitcnt lgkmcnt(2)
    v_mfma_f32_16x16x32_bf16 v[208:211], v[48:51], v[96:99], v[208:211]
    ds_read_b128 v[40:43], v3 offset:10240
    ds_read_b128 v[44:47], v3 offset:28672
    v_mfma_f32_16x16x32_bf16 v[212:215], v[48:51], v[168:171], v[212:215]
    v_mfma_f32_16x16x32_bf16 v[216:219], v[52:55], v[96:99], v[216:219]
    s_add_u32 m0, s23, 2880
    s_nop 0
    buffer_load_dwordx4 v2, s[8:11], s24 offen offset:192 lds
    v_mfma_f32_16x16x32_bf16 v[220:223], v[52:55], v[168:171], v[220:223]
    v_mfma_f32_16x16x32_bf16 v[224:227], v[48:51], a[32:35], v[224:227]
    v_mfma_f32_16x16x32_bf16 v[228:231], v[48:51], a[104:107], v[228:231]
    v_mfma_f32_16x16x32_bf16 v[232:235], v[52:55], a[32:35], v[232:235]
    v_mfma_f32_16x16x32_bf16 v[236:239], v[52:55], a[104:107], v[236:239]
    s_waitcnt lgkmcnt(2)
    v_mfma_f32_16x16x32_bf16 v[208:211], v[32:35], v[100:103], v[208:211]
    ds_read_b128 v[48:51], v3 offset:11264
    ds_read_b128 v[52:55], v3 offset:29696
    v_mfma_f32_16x16x32_bf16 v[212:215], v[32:35], v[172:175], v[212:215]
    v_mfma_f32_16x16x32_bf16 v[216:219], v[36:39], v[100:103], v[216:219]
    s_add_u32 m0, s23, 3840
    s_nop 0
    buffer_load_dwordx4 v2, s[8:11], s24 offen offset:256 lds
    v_mfma_f32_16x16x32_bf16 v[220:223], v[36:39], v[172:175], v[220:223]
    v_mfma_f32_16x16x32_bf16 v[224:227], v[32:35], a[36:39], v[224:227]
    v_mfma_f32_16x16x32_bf16 v[228:231], v[32:35], a[108:111], v[228:231]
    v_mfma_f32_16x16x32_bf16 v[232:235], v[36:39], a[36:39], v[232:235]
    v_mfma_f32_16x16x32_bf16 v[236:239], v[36:39], a[108:111], v[236:239]
    s_waitcnt lgkmcnt(2)
    v_mfma_f32_16x16x32_bf16 v[208:211], v[40:43], v[104:107], v[208:211]
    ds_read_b128 v[32:35], v3 offset:12288
    ds_read_b128 v[36:39], v3 offset:30720
    v_mfma_f32_16x16x32_bf16 v[212:215], v[40:43], v[176:179], v[212:215]
    v_mfma_f32_16x16x32_bf16 v[216:219], v[44:47], v[104:107], v[216:219]
    s_add_u32 m0, s23, 4800
    s_nop 0
    buffer_load_dwordx4 v2, s[8:11], s24 offen offset:320 lds
    v_mfma_f32_16x16x32_bf16 v[220:223], v[44:47], v[176:179], v[220:223]
    v_mfma_f32_16x16x32_bf16 v[224:227], v[40:43], a[40:43], v[224:227]
    v_mfma_f32_16x16x32_bf16 v[228:231], v[40:43], a[112:115], v[228:231]
    v_mfma_f32_16x16x32_bf16 v[232:235], v[44:47], a[40:43], v[232:235]
    v_mfma_f32_16x16x32_bf16 v[236:239], v[44:47], a[112:115], v[236:239]
    s_waitcnt lgkmcnt(2)
    v_mfma_f32_16x16x32_bf16 v[208:211], v[48:51], v[108:111], v[208:211]
    ds_read_b128 v[40:43], v3 offset:13312
    ds_read_b128 v[44:47], v3 offset:31744
    v_mfma_f32_16x16x32_bf16 v[212:215], v[48:51], v[180:183], v[212:215]
    v_mfma_f32_16x16x32_bf16 v[216:219], v[52:55], v[108:111], v[216:219]
    s_add_u32 m0, s23, 5760
    s_nop 0
    buffer_load_dwordx4 v2, s[8:11], s24 offen offset:384 lds
    v_mfma_f32_16x16x32_bf16 v[220:223], v[52:55], v[180:183], v[220:223]
    v_mfma_f32_16x16x32_bf16 v[224:227], v[48:51], a[44:47], v[224:227]
    v_mfma_f32_16x16x32_bf16 v[228:231], v[48:51], a[116:119], v[228:231]
    v_mfma_f32_16x16x32_bf16 v[232:235], v[52:55], a[44:47], v[232:235]
    v_mfma_f32_16x16x32_bf16 v[236:239], v[52:55], a[116:119], v[236:239]
    s_waitcnt lgkmcnt(2)
    v_mfma_f32_16x16x32_bf16 v[208:211], v[32:35], v[112:115], v[208:211]
    ds_read_b128 v[48:51], v3 offset:14336
    ds_read_b128 v[52:55], v3 offset:32768
    v_mfma_f32_16x16x32_bf16 v[212:215], v[32:35], v[184:187], v[212:215]
    v_mfma_f32_16x16x32_bf16 v[216:219], v[36:39], v[112:115], v[216:219]
    s_add_u32 m0, s23, 6720
    s_nop 0
    buffer_load_dwordx4 v2, s[8:11], s24 offen offset:448 lds
    v_mfma_f32_16x16x32_bf16 v[220:223], v[36:39], v[184:187], v[220:223]
    v_mfma_f32_16x16x32_bf16 v[224:227], v[32:35], a[48:51], v[224:227]
    v_mfma_f32_16x16x32_bf16 v[228:231], v[32:35], a[120:123], v[228:231]
    v_mfma_f32_16x16x32_bf16 v[232:235], v[36:39], a[48:51], v[232:235]
    v_mfma_f32_16x16x32_bf16 v[236:239], v[36:39], a[120:123], v[236:239]
    s_waitcnt lgkmcnt(2)
    v_mfma_f32_16x16x32_bf16 v[208:211], v[40:43], v[116:119], v[208:211]
    ds_read_b128 v[32:35], v3 offset:15360
    ds_read_b128 v[36:39], v3 offset:33792
    v_mfma_f32_16x16x32_bf16 v[212:215], v[40:43], v[188:191], v[212:215]
    v_mfma_f32_16x16x32_bf16 v[216:219], v[44:47], v[116:119], v[216:219]
    s_add_u32 m0, s23, 7680
    s_nop 0
    buffer_load_dwordx4 v2, s[8:11], s24 offen offset:512 lds
    s_add_u32 s24, s24, s42
    v_mfma_f32_16x16x32_bf16 v[220:223], v[44:47], v[188:191], v[220:223]
    v_mfma_f32_16x16x32_bf16 v[224:227], v[40:43], a[52:55], v[224:227]
    v_mfma_f32_16x16x32_bf16 v[228:231], v[40:43], a[124:127], v[228:231]
    v_mfma_f32_16x16x32_bf16 v[232:235], v[44:47], a[52:55], v[232:235]
    v_mfma_f32_16x16x32_bf16 v[236:239], v[44:47], a[124:127], v[236:239]
    s_waitcnt lgkmcnt(2)
    v_mfma_f32_16x16x32_bf16 v[208:211], v[48:51], v[120:123], v[208:211]
    ds_read_b128 v[40:43], v3 offset:16384
    ds_read_b128 v[44:47], v3 offset:34816
    v_mfma_f32_16x16x32_bf16 v[212:215], v[48:51], v[192:195], v[212:215]
    v_mfma_f32_16x16x32_bf16 v[216:219], v[52:55], v[120:123], v[216:219]
    v_add_u32 v24, s27, v1
    v_mfma_f32_16x16x32_bf16 v[220:223], v[52:55], v[192:195], v[220:223]
    v_mfma_f32_16x16x32_bf16 v[224:227], v[48:51], a[56:59], v[224:227]
    v_mfma_f32_16x16x32_bf16 v[228:231], v[48:51], a[128:131], v[228:231]
    v_mfma_f32_16x16x32_bf16 v[232:235], v[52:55], a[56:59], v[232:235]
    v_mfma_f32_16x16x32_bf16 v[236:239], v[52:55], a[128:131], v[236:239]
    s_waitcnt lgkmcnt(2)
    v_mfma_f32_16x16x32_bf16 v[208:211], v[32:35], v[124:127], v[208:211]
    ds_read_b128 v[48:51], v3 offset:17408
    ds_read_b128 v[52:55], v3 offset:35840
    v_mfma_f32_16x16x32_bf16 v[212:215], v[32:35], v[196:199], v[212:215]
    v_mfma_f32_16x16x32_bf16 v[216:219], v[36:39], v[124:127], v[216:219]
    v_mfma_f32_16x16x32_bf16 v[220:223], v[36:39], v[196:199], v[220:223]
    v_mfma_f32_16x16x32_bf16 v[224:227], v[32:35], a[60:63], v[224:227]
    v_mfma_f32_16x16x32_bf16 v[228:231], v[32:35], a[132:135], v[228:231]
    s_waitcnt vmcnt(9)
    s_barrier
    v_mfma_f32_16x16x32_bf16 v[232:235], v[36:39], a[60:63], v[232:235]
    v_mfma_f32_16x16x32_bf16 v[236:239], v[36:39], a[132:135], v[236:239]
    s_waitcnt lgkmcnt(2)
    v_mfma_f32_16x16x32_bf16 v[208:211], v[40:43], v[128:131], v[208:211]
    ds_read_b128 v[32:35], v24 offset:0
    ds_read_b128 v[36:39], v24 offset:18432
    v_mfma_f32_16x16x32_bf16 v[212:215], v[40:43], v[200:203], v[212:215]
    v_mfma_f32_16x16x32_bf16 v[216:219], v[44:47], v[128:131], v[216:219]
    v_mov_b32 v4, s30
    s_mov_b64 exec, s[34:35]
    buffer_store_dword v4, off, s[4:7], s29 sc1
    s_mov_b64 exec, -1
    v_mfma_f32_16x16x32_bf16 v[220:223], v[44:47], v[200:203], v[220:223]
    v_mfma_f32_16x16x32_bf16 v[224:227], v[40:43], a[64:67], v[224:227]
    v_mfma_f32_16x16x32_bf16 v[228:231], v[40:43], a[136:139], v[228:231]
    v_mfma_f32_16x16x32_bf16 v[232:235], v[44:47], a[64:67], v[232:235]
    v_mfma_f32_16x16x32_bf16 v[236:239], v[44:47], a[136:139], v[236:239]
    s_waitcnt lgkmcnt(2)
    v_mfma_f32_16x16x32_bf16 v[208:211], v[48:51], v[132:135], v[208:211]
    ds_read_b128 v[40:43], v24 offset:1024
    ds_read_b128 v[44:47], v24 offset:19456
    v_mfma_f32_16x16x32_bf16 v[212:215], v[48:51], v[204:207], v[212:215]
    v_mfma_f32_16x16x32_bf16 v[216:219], v[52:55], v[132:135], v[216:219]
    v_mfma_f32_16x16x32_bf16 v[220:223], v[52:55], v[204:207], v[220:223]
    v_mfma_f32_16x16x32_bf16 v[224:227], v[48:51], a[68:71], v[224:227]
    v_mfma_f32_16x16x32_bf16 v[228:231], v[48:51], a[140:143], v[228:231]
    v_mfma_f32_16x16x32_bf16 v[232:235], v[52:55], a[68:71], v[232:235]
    v_mfma_f32_16x16x32_bf16 v[236:239], v[52:55], a[140:143], v[236:239]
    v_mov_b32 v3, v24
    s_mov_b32 s31, s26
    s_add_u32 s26, s26, s41
    s_add_u32 s30, s30, 1
    s_add_u32 s19, s19, s20
    s_cmp_lt_u32 s19, 64
    s_cbranch_scc1 qk_vloop
    v_cvt_pk_bf16_f32 v8, v208, v209
    v_cvt_pk_bf16_f32 v9, v210, v211
    v_cvt_pk_bf16_f32 v12, v212, v213
    v_cvt_pk_bf16_f32 v13, v214, v215
    v_cvt_pk_bf16_f32 v10, v216, v217
    v_cvt_pk_bf16_f32 v11, v218, v219
    v_cvt_pk_bf16_f32 v14, v220, v221
    v_cvt_pk_bf16_f32 v15, v222, v223
    v_cvt_pk_bf16_f32 v16, v224, v225
    v_cvt_pk_bf16_f32 v17, v226, v227
    v_cvt_pk_bf16_f32 v20, v228, v229
    v_cvt_pk_bf16_f32 v21, v230, v231
    v_cvt_pk_bf16_f32 v18, v232, v233
    v_cvt_pk_bf16_f32 v19, v234, v235
    v_cvt_pk_bf16_f32 v22, v236, v237
    v_cvt_pk_bf16_f32 v23, v238, v239
qk_done:
    s_mov_b32 s28, s31
    buffer_store_dwordx4 v[8:11], v7, s[4:7], s28 offen sc1
    s_add_u32 s28, s28, s40
    buffer_store_dwordx4 v[12:15], v7, s[4:7], s28 offen sc1
    s_add_u32 s28, s31, s43
    buffer_store_dwordx4 v[16:19], v7, s[4:7], s28 offen sc1
    s_add_u32 s28, s28, s40
    buffer_store_dwordx4 v[20:23], v7, s[4:7], s28 offen sc1
    s_waitcnt vmcnt(0) lgkmcnt(0)
    s_barrier
    s_add_u32 s22, s95, 63
    v_mov_b32 v4, s22
    s_mov_b64 exec, s[34:35]
    buffer_store_dword v4, off, s[4:7], s29 sc1
    s_mov_b64 exec, -1
    s_cmp_eq_u32 s16, 0
    s_cbranch_scc1 qk_nq
    s_add_u32 s29, s29, 4096
    v_mov_b32 v4, s22
    s_mov_b64 exec, s[34:35]
    buffer_store_dword v4, off, s[4:7], s29 sc1
    s_mov_b64 exec, -1
qk_nq:
    s_cmp_ge_u32 s36, 64
    s_cbranch_scc1 L_qkv_next
    s_lshr_b32 s33, s36, 5
    v_and_b32 v4, 63, v0
    v_lshrrev_b32 v5, 4, v4
    v_add_u32 v1, 0, v5
    v_mul_u32_u24 v6, 11, v1
    v_lshrrev_b32 v6, 5, v6
    v_add_u32 v1, v1, v6
    v_lshlrev_b32 v1, 7, v1
    v_and_b32 v6, 7, v4
    v_lshl_add_u32 v1, v6, 4, v1
    v_add_u32 v2, 4, v5
    v_mul_u32_u24 v6, 11, v2
    v_lshrrev_b32 v6, 5, v6
    v_add_u32 v2, v2, v6
    v_lshlrev_b32 v2, 7, v2
    v_and_b32 v6, 7, v4
    v_lshl_add_u32 v2, v6, 4, v2
    v_add_u32 v3, 8, v5
    v_mul_u32_u24 v6, 11, v3
    v_lshrrev_b32 v6, 5, v6
    v_add_u32 v3, v3, v6
    v_lshlrev_b32 v3, 7, v3
    v_and_b32 v6, 7, v4
    v_lshl_add_u32 v3, v6, 4, v3
    v_min_u32 v6, 23, v4
    v_lshlrev_b32 v6, 9, v6
    s_mov_b32 s19, s33
    s_mul_i32 s24, s19, 12288
    s_add_u32 s24, s24, 90177536
    s_lshl_b32 s26, s19, 5
    s_add_u32 s26, s26, s17
    s_lshl_b32 s26, s26, 12
    s_mov_b32 s21, 71303168
    s_cmp_eq_u32 s16, 2
    s_cselect_b32 s21, 80740352, s21
    s_add_u32 s26, s26, s21
    s_lshl_b32 s29, s17, 7
    s_lshl_b32 s21, s16, 1
    s_add_u32 s21, s21, s33
    s_lshl_b32 s21, s21, 2
    s_add_u32 s29, s29, s21
    s_add_u32 s29, s29, 125829240
mk_loop:
    s_cmp_lg_u32 s18, 0
    s_cbranch_scc1 mk_go
    s_mov_b32 s23, s24
    s_mov_b32 s21, 4194304
mk_wait:
    buffer_load_dword v4, v6, s[4:7], s23 offen offset:384 sc1
    s_sub_u32 s21, s21, 1
    s_cbranch_scc1 mk_go
    s_waitcnt vmcnt(0)
    v_cmp_ne_u32 vcc, s95, v4
    s_cbranch_vccz mk_go
    s_sleep 4
    s_branch mk_wait
mk_go:
    s_barrier
    s_mov_b32 s30, 4096
mk_again:
    v_mov_b32 v5, 0
    s_add_u32 s23, s24, 0
    buffer_load_dwordx4 v[24:27], v1, s[4:7], s23 offen offset:0 sc1
    buffer_load_dwordx4 v[28:31], v2, s[4:7], s23 offen offset:0 sc1
    buffer_load_dwordx4 v[32:35], v3, s[4:7], s23 offen offset:0 sc1
    buffer_load_dwordx4 v[36:39], v1, s[4:7], s23 offen offset:2048 sc1
    buffer_load_dwordx4 v[40:43], v2, s[4:7], s23 offen offset:2048 sc1
    buffer_load_dwordx4 v[44:47], v3, s[4:7], s23 offen offset:2048 sc1
    s_add_u32 s23, s24, 4096
    buffer_load_dwordx4 v[48:51], v1, s[4:7], s23 offen offset:0 sc1
    buffer_load_dwordx4 v[52:55], v2, s[4:7], s23 offen offset:0 sc1
    buffer_load_dwordx4 v[56:59], v3, s[4:7], s23 offen offset:0 sc1
    buffer_load_dwordx4 v[60:63], v1, s[4:7], s23 offen offset:2048 sc1
    buffer_load_dwordx4 v[208:211], v2, s[4:7], s23 offen offset:2048 sc1
    buffer_load_dwordx4 v[212:215], v3, s[4:7], s23 offen offset:2048 sc1
    s_add_u32 s23, s24, 8192
    buffer_load_dwordx4 v[216:219], v1, s[4:7], s23 offen offset:0 sc1
    buffer_load_dwordx4 v[220:223], v2, s[4:7], s23 offen offset:0 sc1
    buffer_load_dwordx4 v[224:227], v3, s[4:7], s23 offen offset:0 sc1
    buffer_load_dwordx4 v[228:231], v1, s[4:7], s23 offen offset:2048 sc1
    buffer_load_dwordx4 v[232:235], v2, s[4:7], s23 offen offset:2048 sc1
    buffer_load_dwordx4 v[236:239], v3, s[4:7], s23 offen offset:2048 sc1
    s_add_u32 s22, s19, s95
    s_add_u32 s22, s22, 1
    s_cmp_eq_u32 s16, 2
    s_cbranch_scc1 mk_v
    s_waitcnt vmcnt(17)
    v_mfma_f32_16x16x32_bf16 v[8:11], v[64:67], v[24:27], 0
    v_mfma_f32_16x16x32_bf16 v[12:15], v[136:139], v[24:27], 0
    v_max3_u32 v5, v5, v24, v25
    v_mfma_f32_16x16x32_bf16 v[16:19], a[0:3], v[24:27], 0
    v_mfma_f32_16x16x32_bf16 v[20:23], a[72:75], v[24:27], 0
    v_max3_u32 v5, v5, v26, v27
    s_waitcnt vmcnt(16)
    v_mfma_f32_16x16x32_bf16 v[8:11], v[68:71], v[28:31], v[8:11]
    v_mfma_f32_16x16x32_bf16 v[12:15], v[140:143], v[28:31], v[12:15]
    v_max3_u32 v5, v5, v28, v29
    v_mfma_f32_16x16x32_bf16 v[16:19], a[4:7], v[28:31], v[16:19]
    v_mfma_f32_16x16x32_bf16 v[20:23], a[76:79], v[28:31], v[20:23]
    v_max3_u32 v5, v5, v30, v31
    s_waitcnt vmcnt(15)
    v_mfma_f32_16x16x32_bf16 v[8:11], v[72:75], v[32:35], v[8:11]
    v_mfma_f32_16x16x32_bf16 v[12:15], v[144:147], v[32:35], v[12:15]
    v_max3_u32 v5, v5, v32, v33
    v_mfma_f32_16x16x32_bf16 v[16:19], a[8:11], v[32:35], v[16:19]
    v_mfma_f32_16x16x32_bf16 v[20:23], a[80:83], v[32:35], v[20:23]
    v_max3_u32 v5, v5, v34, v35
    s_waitcnt vmcnt(14)
    v_mfma_f32_16x16x32_bf16 v[8:11], v[76:79], v[36:39], v[8:11]
    v_mfma_f32_16x16x32_bf16 v[12:15], v[148:151], v[36:39], v[12:15]
    v_max3_u32 v5, v5, v36, v37
    v_mfma_f32_16x16x32_bf16 v[16:19], a[12:15], v[36:39], v[16:19]
    v_mfma_f32_16x16x32_bf16 v[20:23], a[84:87], v[36:39], v[20:23]
    v_max3_u32 v5, v5, v38, v39
    s_waitcnt vmcnt(13)
    v_mfma_f32_16x16x32_bf16 v[8:11], v[80:83], v[40:43], v[8:11]
    v_mfma_f32_16x16x32_bf16 v[12:15], v[152:155], v[40:43], v[12:15]
    v_max3_u32 v5, v5, v40, v41
    v_mfma_f32_16x16x32_bf16 v[16:19], a[16:19], v[40:43], v[16:19]
    v_mfma_f32_16x16x32_bf16 v[20:23], a[88:91], v[40:43], v[20:23]
    v_max3_u32 v5, v5, v42, v43
    s_waitcnt vmcnt(12)
    v_mfma_f32_16x16x32_bf16 v[8:11], v[84:87], v[44:47], v[8:11]
    v_mfma_f32_16x16x32_bf16 v[12:15], v[156:159], v[44:47], v[12:15]
    v_max3_u32 v5, v5, v44, v45
    v_mfma_f32_16x16x32_bf16 v[16:19], a[20:23], v[44:47], v[16:19]
    v_mfma_f32_16x16x32_bf16 v[20:23], a[92:95], v[44:47], v[20:23]
    v_max3_u32 v5, v5, v46, v47
    s_waitcnt vmcnt(11)
    v_mfma_f32_16x16x32_bf16 v[8:11], v[88:91], v[48:51], v[8:11]
    v_mfma_f32_16x16x32_bf16 v[12:15], v[160:163], v[48:51], v[12:15]
    v_max3_u32 v5, v5, v48, v49
    v_mfma_f32_16x16x32_bf16 v[16:19], a[24:27], v[48:51], v[16:19]
    v_mfma_f32_16x16x32_bf16 v[20:23], a[96:99], v[48:51], v[20:23]
    v_max3_u32 v5, v5, v50, v51
    s_waitcnt vmcnt(10)
    v_mfma_f32_16x16x32_bf16 v[8:11], v[92:95], v[52:55], v[8:11]
    v_mfma_f32_16x16x32_bf16 v[12:15], v[164:167], v[52:55], v[12:15]
    v_max3_u32 v5, v5, v52, v53
    v_mfma_f32_16x16x32_bf16 v[16:19], a[28:31], v[52:55], v[16:19]
    v_mfma_f32_16x16x32_bf16 v[20:23], a[100:103], v[52:55], v[20:23]
    v_max3_u32 v5, v5, v54, v55
    s_waitcnt vmcnt(9)
    v_mfma_f32_16x16x32_bf16 v[8:11], v[96:99], v[56:59], v[8:11]
    v_mfma_f32_16x16x32_bf16 v[12:15], v[168:171], v[56:59], v[12:15]
    v_max3_u32 v5, v5, v56, v57
    v_mfma_f32_16x16x32_bf16 v[16:19], a[32:35], v[56:59], v[16:19]
    v_mfma_f32_16x16x32_bf16 v[20:23], a[104:107], v[56:59], v[20:23]
    v_max3_u32 v5, v5, v58, v59
    s_waitcnt vmcnt(8)
    v_mfma_f32_16x16x32_bf16 v[8:11], v[100:103], v[60:63], v[8:11]
    v_mfma_f32_16x16x32_bf16 v[12:15], v[172:175], v[60:63], v[12:15]
    v_max3_u32 v5, v5, v60, v61
    v_mfma_f32_16x16x32_bf16 v[16:19], a[36:39], v[60:63], v[16:19]
    v_mfma_f32_16x16x32_bf16 v[20:23], a[108:111], v[60:63], v[20:23]
    v_max3_u32 v5, v5, v62, v63
    s_waitcnt vmcnt(7)
    v_mfma_f32_16x16x32_bf16 v[8:11], v[104:107], v[208:211], v[8:11]
    v_mfma_f32_16x16x32_bf16 v[12:15], v[176:179], v[208:211], v[12:15]
    v_max3_u32 v5, v5, v208, v209
    v_mfma_f32_16x16x32_bf16 v[16:19], a[40:43], v[208:211], v[16:19]
    v_mfma_f32_16x16x32_bf16 v[20:23], a[112:115], v[208:211], v[20:23]
    v_max3_u32 v5, v5, v210, v211
    s_waitcnt vmcnt(6)
    v_mfma_f32_16x16x32_bf16 v[8:11], v[108:111], v[212:215], v[8:11]
    v_mfma_f32_16x16x32_bf16 v[12:15], v[180:183], v[212:215], v[12:15]
    v_max3_u32 v5, v5, v212, v213
    v_mfma_f32_16x16x32_bf16 v[16:19], a[44:47], v[212:215], v[16:19]
    v_mfma_f32_16x16x32_bf16 v[20:23], a[116:119], v[212:215], v[20:23]
    v_max3_u32 v5, v5, v214, v215
    s_waitcnt vmcnt(5)
    v_mfma_f32_16x16x32_bf16 v[8:11], v[112:115], v[216:219], v[8:11]
    v_mfma_f32_16x16x32_bf16 v[12:15], v[184:187], v[216:219], v[12:15]
    v_max3_u32 v5, v5, v216, v217
    v_mfma_f32_16x16x32_bf16 v[16:19], a[48:51], v[216:219], v[16:19]
    v_mfma_f32_16x16x32_bf16 v[20:23], a[120:123], v[216:219], v[20:23]
    v_max3_u32 v5, v5, v218, v219
    s_waitcnt vmcnt(4)
    v_mfma_f32_16x16x32_bf16 v[8:11], v[116:119], v[220:223], v[8:11]
    v_mfma_f32_16x16x32_bf16 v[12:15], v[188:191], v[220:223], v[12:15]
    v_max3_u32 v5, v5, v220, v221
    v_mfma_f32_16x16x32_bf16 v[16:19], a[52:55], v[220:223], v[16:19]
    v_mfma_f32_16x16x32_bf16 v[20:23], a[124:127], v[220:223], v[20:23]
    v_max3_u32 v5, v5, v222, v223
    s_waitcnt vmcnt(3)
    v_mfma_f32_16x16x32_bf16 v[8:11], v[120:123], v[224:227], v[8:11]
    v_mfma_f32_16x16x32_bf16 v[12:15], v[192:195], v[224:227], v[12:15]
    v_max3_u32 v5, v5, v224, v225
    v_mfma_f32_16x16x32_bf16 v[16:19], a[56:59], v[224:227], v[16:19]
    v_mfma_f32_16x16x32_bf16 v[20:23], a[128:131], v[224:227], v[20:23]
    v_max3_u32 v5, v5, v226, v227
    s_waitcnt vmcnt(2)
    v_mfma_f32_16x16x32_bf16 v[8:11], v[124:127], v[228:231], v[8:11]
    v_mfma_f32_16x16x32_bf16 v[12:15], v[196:199], v[228:231], v[12:15]
    v_max3_u32 v5, v5, v228, v229
    v_mfma_f32_16x16x32_bf16 v[16:19], a[60:63], v[228:231], v[16:19]
    v_mfma_f32_16x16x32_bf16 v[20:23], a[132:135], v[228:231], v[20:23]
    v_max3_u32 v5, v5, v230, v231
    s_waitcnt vmcnt(1)
    v_mfma_f32_16x16x32_bf16 v[8:11], v[128:131], v[232:235], v[8:11]
    v_mfma_f32_16x16x32_bf16 v[12:15], v[200:203], v[232:235], v[12:15]
    v_max3_u32 v5, v5, v232, v233
    v_mfma_f32_16x16x32_bf16 v[16:19], a[64:67], v[232:235], v[16:19]
    v_mfma_f32_16x16x32_bf16 v[20:23], a[136:139], v[232:235], v[20:23]
    v_max3_u32 v5, v5, v234, v235
    s_waitcnt vmcnt(0)
    v_mfma_f32_16x16x32_bf16 v[8:11], v[132:135], v[236:239], v[8:11]
    v_mfma_f32_16x16x32_bf16 v[12:15], v[204:207], v[236:239], v[12:15]
    v_max3_u32 v5, v5, v236, v237
    v_mfma_f32_16x16x32_bf16 v[16:19], a[68:71], v[236:239], v[16:19]
    v_mfma_f32_16x16x32_bf16 v[20:23], a[140:143], v[236:239], v[20:23]
    v_max3_u32 v5, v5, v238, v239
    s_nop 5
    s_branch mk_st
mk_v:
    s_waitcnt vmcnt(17)
    v_mfma_f32_16x16x32_bf16 v[8:11], v[24:27], v[64:67], 0
    v_mfma_f32_16x16x32_bf16 v[12:15], v[24:27], v[136:139], 0
    v_max3_u32 v5, v5, v24, v25
    v_mfma_f32_16x16x32_bf16 v[16:19], v[24:27], a[0:3], 0
    v_mfma_f32_16x16x32_bf16 v[20:23], v[24:27], a[72:75], 0
    v_max3_u32 v5, v5, v26, v27
    s_waitcnt vmcnt(16)
    v_mfma_f32_16x16x32_bf16 v[8:11], v[28:31], v[68:71], v[8:11]
    v_mfma_f32_16x16x32_bf16 v[12:15], v[28:31], v[140:143], v[12:15]
    v_max3_u32 v5, v5, v28, v29
    v_mfma_f32_16x16x32_bf16 v[16:19], v[28:31], a[4:7], v[16:19]
    v_mfma_f32_16x16x32_bf16 v[20:23], v[28:31], a[76:79], v[20:23]
    v_max3_u32 v5, v5, v30, v31
    s_waitcnt vmcnt(15)
    v_mfma_f32_16x16x32_bf16 v[8:11], v[32:35], v[72:75], v[8:11]
    v_mfma_f32_16x16x32_bf16 v[12:15], v[32:35], v[144:147], v[12:15]
    v_max3_u32 v5, v5, v32, v33
    v_mfma_f32_16x16x32_bf16 v[16:19], v[32:35], a[8:11], v[16:19]
    v_mfma_f32_16x16x32_bf16 v[20:23], v[32:35], a[80:83], v[20:23]
    v_max3_u32 v5, v5, v34, v35
    s_waitcnt vmcnt(14)
    v_mfma_f32_16x16x32_bf16 v[8:11], v[36:39], v[76:79], v[8:11]
    v_mfma_f32_16x16x32_bf16 v[12:15], v[36:39], v[148:151], v[12:15]
    v_max3_u32 v5, v5, v36, v37
    v_mfma_f32_16x16x32_bf16 v[16:19], v[36:39], a[12:15], v[16:19]
    v_mfma_f32_16x16x32_bf16 v[20:23], v[36:39], a[84:87], v[20:23]
    v_max3_u32 v5, v5, v38, v39
    s_waitcnt vmcnt(13)
    v_mfma_f32_16x16x32_bf16 v[8:11], v[40:43], v[80:83], v[8:11]
    v_mfma_f32_16x16x32_bf16 v[12:15], v[40:43], v[152:155], v[12:15]
    v_max3_u32 v5, v5, v40, v41
    v_mfma_f32_16x16x32_bf16 v[16:19], v[40:43], a[16:19], v[16:19]
    v_mfma_f32_16x16x32_bf16 v[20:23], v[40:43], a[88:91], v[20:23]
    v_max3_u32 v5, v5, v42, v43
    s_waitcnt vmcnt(12)
    v_mfma_f32_16x16x32_bf16 v[8:11], v[44:47], v[84:87], v[8:11]
    v_mfma_f32_16x16x32_bf16 v[12:15], v[44:47], v[156:159], v[12:15]
    v_max3_u32 v5, v5, v44, v45
    v_mfma_f32_16x16x32_bf16 v[16:19], v[44:47], a[20:23], v[16:19]
    v_mfma_f32_16x16x32_bf16 v[20:23], v[44:47], a[92:95], v[20:23]
    v_max3_u32 v5, v5, v46, v47
    s_waitcnt vmcnt(11)
    v_mfma_f32_16x16x32_bf16 v[8:11], v[48:51], v[88:91], v[8:11]
    v_mfma_f32_16x16x32_bf16 v[12:15], v[48:51], v[160:163], v[12:15]
    v_max3_u32 v5, v5, v48, v49
    v_mfma_f32_16x16x32_bf16 v[16:19], v[48:51], a[24:27], v[16:19]
    v_mfma_f32_16x16x32_bf16 v[20:23], v[48:51], a[96:99], v[20:23]
    v_max3_u32 v5, v5, v50, v51
    s_waitcnt vmcnt(10)
    v_mfma_f32_16x16x32_bf16 v[8:11], v[52:55], v[92:95], v[8:11]
    v_mfma_f32_16x16x32_bf16 v[12:15], v[52:55], v[164:167], v[12:15]
    v_max3_u32 v5, v5, v52, v53
    v_mfma_f32_16x16x32_bf16 v[16:19], v[52:55], a[28:31], v[16:19]
    v_mfma_f32_16x16x32_bf16 v[20:23], v[52:55], a[100:103], v[20:23]
    v_max3_u32 v5, v5, v54, v55
    s_waitcnt vmcnt(9)
    v_mfma_f32_16x16x32_bf16 v[8:11], v[56:59], v[96:99], v[8:11]
    v_mfma_f32_16x16x32_bf16 v[12:15], v[56:59], v[168:171], v[12:15]
    v_max3_u32 v5, v5, v56, v57
    v_mfma_f32_16x16x32_bf16 v[16:19], v[56:59], a[32:35], v[16:19]
    v_mfma_f32_16x16x32_bf16 v[20:23], v[56:59], a[104:107], v[20:23]
    v_max3_u32 v5, v5, v58, v59
    s_waitcnt vmcnt(8)
    v_mfma_f32_16x16x32_bf16 v[8:11], v[60:63], v[100:103], v[8:11]
    v_mfma_f32_16x16x32_bf16 v[12:15], v[60:63], v[172:175], v[12:15]
    v_max3_u32 v5, v5, v60, v61
    v_mfma_f32_16x16x32_bf16 v[16:19], v[60:63], a[36:39], v[16:19]
    v_mfma_f32_16x16x32_bf16 v[20:23], v[60:63], a[108:111], v[20:23]
    v_max3_u32 v5, v5, v62, v63
    s_waitcnt vmcnt(7)
    v_mfma_f32_16x16x32_bf16 v[8:11], v[208:211], v[104:107], v[8:11]
    v_mfma_f32_16x16x32_bf16 v[12:15], v[208:211], v[176:179], v[12:15]
    v_max3_u32 v5, v5, v208, v209
    v_mfma_f32_16x16x32_bf16 v[16:19], v[208:211], a[40:43], v[16:19]
    v_mfma_f32_16x16x32_bf16 v[20:23], v[208:211], a[112:115], v[20:23]
    v_max3_u32 v5, v5, v210, v211
    s_waitcnt vmcnt(6)
    v_mfma_f32_16x16x32_bf16 v[8:11], v[212:215], v[108:111], v[8:11]
    v_mfma_f32_16x16x32_bf16 v[12:15], v[212:215], v[180:183], v[12:15]
    v_max3_u32 v5, v5, v212, v213
    v_mfma_f32_16x16x32_bf16 v[16:19], v[212:215], a[44:47], v[16:19]
    v_mfma_f32_16x16x32_bf16 v[20:23], v[212:215], a[116:119], v[20:23]
    v_max3_u32 v5, v5, v214, v215
    s_waitcnt vmcnt(5)
    v_mfma_f32_16x16x32_bf16 v[8:11], v[216:219], v[112:115], v[8:11]
    v_mfma_f32_16x16x32_bf16 v[12:15], v[216:219], v[184:187], v[12:15]
    v_max3_u32 v5, v5, v216, v217
    v_mfma_f32_16x16x32_bf16 v[16:19], v[216:219], a[48:51], v[16:19]
    v_mfma_f32_16x16x32_bf16 v[20:23], v[216:219], a[120:123], v[20:23]
    v_max3_u32 v5, v5, v218, v219
    s_waitcnt vmcnt(4)
    v_mfma_f32_16x16x32_bf16 v[8:11], v[220:223], v[116:119], v[8:11]
    v_mfma_f32_16x16x32_bf16 v[12:15], v[220:223], v[188:191], v[12:15]
    v_max3_u32 v5, v5, v220, v221
    v_mfma_f32_16x16x32_bf16 v[16:19], v[220:223], a[52:55], v[16:19]
    v_mfma_f32_16x16x32_bf16 v[20:23], v[220:223], a[124:127], v[20:23]
    v_max3_u32 v5, v5, v222, v223
    s_waitcnt vmcnt(3)
    v_mfma_f32_16x16x32_bf16 v[8:11], v[224:227], v[120:123], v[8:11]
    v_mfma_f32_16x16x32_bf16 v[12:15], v[224:227], v[192:195], v[12:15]
    v_max3_u32 v5, v5, v224, v225
    v_mfma_f32_16x16x32_bf16 v[16:19], v[224:227], a[56:59], v[16:19]
    v_mfma_f32_16x16x32_bf16 v[20:23], v[224:227], a[128:131], v[20:23]
    v_max3_u32 v5, v5, v226, v227
    s_waitcnt vmcnt(2)
    v_mfma_f32_16x16x32_bf16 v[8:11], v[228:231], v[124:127], v[8:11]
    v_mfma_f32_16x16x32_bf16 v[12:15], v[228:231], v[196:199], v[12:15]
    v_max3_u32 v5, v5, v228, v229
    v_mfma_f32_16x16x32_bf16 v[16:19], v[228:231], a[60:63], v[16:19]
    v_mfma_f32_16x16x32_bf16 v[20:23], v[228:231], a[132:135], v[20:23]
    v_max3_u32 v5, v5, v230, v231
    s_waitcnt vmcnt(1)
    v_mfma_f32_16x16x32_bf16 v[8:11], v[232:235], v[128:131], v[8:11]
    v_mfma_f32_16x16x32_bf16 v[12:15], v[232:235], v[200:203], v[12:15]
    v_max3_u32 v5, v5, v232, v233
    v_mfma_f32_16x16x32_bf16 v[16:19], v[232:235], a[64:67], v[16:19]
    v_mfma_f32_16x16x32_bf16 v[20:23], v[232:235], a[136:139], v[20:23]
    v_max3_u32 v5, v5, v234, v235
    s_waitcnt vmcnt(0)
    v_mfma_f32_16x16x32_bf16 v[8:11], v[236:239], v[132:135], v[8:11]
    v_mfma_f32_16x16x32_bf16 v[12:15], v[236:239], v[204:207], v[12:15]
    v_max3_u32 v5, v5, v236, v237
    v_mfma_f32_16x16x32_bf16 v[16:19], v[236:239], a[68:71], v[16:19]
    v_mfma_f32_16x16x32_bf16 v[20:23], v[236:239], a[140:143], v[20:23]
    v_max3_u32 v5, v5, v238, v239
    v_pk_mul_f32 v[8:9], v[8:9], 0.5 op_sel_hi:[1,0]
    v_pk_mul_f32 v[10:11], v[10:11], 0.5 op_sel_hi:[1,0]
    v_pk_mul_f32 v[12:13], v[12:13], 0.5 op_sel_hi:[1,0]
    v_pk_mul_f32 v[14:15], v[14:15], 0.5 op_sel_hi:[1,0]
    v_pk_mul_f32 v[16:17], v[16:17], 0.5 op_sel_hi:[1,0]
    v_pk_mul_f32 v[18:19], v[18:19], 0.5 op_sel_hi:[1,0]
    v_pk_mul_f32 v[20:21], v[20:21], 0.5 op_sel_hi:[1,0]
    v_pk_mul_f32 v[22:23], v[22:23], 0.5 op_sel_hi:[1,0]
    s_nop 1
mk_st:
    v_cmp_eq_u32 vcc, -1, v5
    s_sub_u32 s30, s30, 1
    s_cbranch_scc1 mk_ok
    s_cbranch_vccnz mk_again
mk_ok:
    s_add_u32 s24, s24, 24576
    v_cvt_pk_bf16_f32 v24, v8, v9
    v_cvt_pk_bf16_f32 v25, v10, v11
    v_cvt_pk_bf16_f32 v26, v12, v13
    v_cvt_pk_bf16_f32 v27, v14, v15
    v_cvt_pk_bf16_f32 v28, v16, v17
    v_cvt_pk_bf16_f32 v29, v18, v19
    v_cvt_pk_bf16_f32 v30, v20, v21
    v_cvt_pk_bf16_f32 v31, v22, v23
    s_add_u32 s21, s26, 4096
    buffer_store_dwordx4 v[24:27], v7, s[4:7], s26 offen sc1
    buffer_store_dwordx4 v[28:31], v7, s[4:7], s21 offen sc1
    s_waitcnt vmcnt(0)
    s_barrier
    v_mov_b32 v4, s22
    s_mov_b64 exec, s[34:35]
    buffer_store_dword v4, off, s[4:7], s29 sc1
    s_mov_b64 exec, -1
    s_add_u32 s19, s19, 2
    s_add_u32 s26, s26, 262144
    s_cmp_lt_u32 s19, 62
    s_cbranch_scc1 mk_loop
    s_endpgm
L_ssm_next:
    s_sub_u32 s33, s3, 4
    s_and_b32 s33, s33, 7
    s_cmp_ge_u32 s33, 6
    s_cbranch_scc1 L_sscan
L_stake:
    s_lshl_b32 s35, s33, 2
    s_add_u32 s35, s35, 96
    s_mov_b32 s37, s35
    v_mov_b32 v250, 1
    v_mov_b32 v251, 163832
    v_cmp_eq_u32 vcc, 0, v0
    s_nop 0
    s_and_saveexec_b64 s[38:39], vcc
    s_cbranch_execz tk8
    buffer_atomic_add v250, off, s[96:99], s37 sc0
    s_waitcnt vmcnt(0)
    ds_write_b32 v251, v250
    s_waitcnt lgkmcnt(0)
tk8:
    s_mov_b64 exec, -1
    s_barrier
    ds_read_b32 v252, v251
    s_waitcnt lgkmcnt(0)
    v_readfirstlane_b32 s34, v252
    s_barrier
    s_nop 3
    s_mul_i32 s20, s33, 24
    s_add_u32 s20, s20, s34
    s_cmp_lt_u32 s34, 24
    s_cbranch_scc1 L_sjob
L_sscan:
    v_and_b32 v1, 63, v0
    v_min_u32 v1, 5, v1
    v_lshlrev_b32 v2, 2, v1
    s_cmp_lg_u32 s32, 0
    v_mov_b32 v251, 163832
    s_cbranch_scc1 sw9
    buffer_load_dword v3, v2, s[96:99], 0 offen offset:96 sc1
    v_mov_b32 v4, 24
    s_waitcnt vmcnt(0)
    v_cmp_lt_u32 vcc, v3, v4
    s_nop 0
    s_ff1_i32_b64 s40, vcc
    v_mov_b32 v250, s40
    ds_write_b32 v251, v250
    s_waitcnt lgkmcnt(0)
sw9:
    s_barrier
    ds_read_b32 v252, v251
    s_waitcnt lgkmcnt(0)
    v_readfirstlane_b32 s33, v252
    s_barrier
    s_nop 1
    s_cmp_lt_u32 s33, 7
    s_cbranch_scc1 L_stake
    s_branch L_phase2
L_sjob:
    s_lshl_b32 s20, s20, 2
    v_lshrrev_b32 v5, 6, v0
    s_nop 0
    v_readfirstlane_b32 s21, v5
    v_and_b32 v1, 63, v0
    v_and_b32 v2, 15, v1
    v_lshrrev_b32 v3, 4, v1
    v_lshlrev_b32 v4, 14, v5
    s_mov_b32 s8, s62
    s_mov_b32 s9, s63
    s_mov_b32 s10, 2359296
    s_mov_b32 s11, 0x20000
    s_mov_b32 s16, s76
    s_mov_b32 s17, s77
    s_mov_b32 s18, 4718592
    s_mov_b32 s19, 0x20000
    s_add_u32 s22, s20, s21
    s_lshl_b32 s23, s22, 8
    v_lshlrev_b32 v6, 3, v2
    v_lshl_add_u32 v6, v3, 1, v6
    s_mov_b32 s12, s64
    s_mov_b32 s13, s65
    s_mov_b32 s14, 147456
    s_mov_b32 s15, 0x20000
    buffer_load_ushort v24, v6, s[12:15], s23 offen offset:0
    buffer_load_ushort v28, v6, s[12:15], s23 offen offset:128
    s_mov_b32 s12, s66
    s_mov_b32 s13, s67
    s_mov_b32 s14, 147456
    s_mov_b32 s15, 0x20000
    buffer_load_ushort v25, v6, s[12:15], s23 offen offset:0
    buffer_load_ushort v29, v6, s[12:15], s23 offen offset:128
    s_mov_b32 s12, s68
    s_mov_b32 s13, s69
    s_mov_b32 s14, 147456
    s_mov_b32 s15, 0x20000
    buffer_load_ushort v26, v6, s[12:15], s23 offen offset:0
    buffer_load_ushort v30, v6, s[12:15], s23 offen offset:128
    s_mov_b32 s12, s70
    s_mov_b32 s13, s71
    s_mov_b32 s14, 147456
    s_mov_b32 s15, 0x20000
    buffer_load_ushort v27, v6, s[12:15], s23 offen offset:0
    buffer_load_ushort v31, v6, s[12:15], s23 offen offset:128
    s_mov_b32 s12, s72
    s_mov_b32 s13, s73
    s_mov_b32 s14, 1152
    s_mov_b32 s15, 0x20000
    s_lshl_b32 s23, s22, 1
    buffer_load_ushort v32, off, s[12:15], s23
    v_mul_u32_u24 v5, 9216, v0
    s_lshl_b32 s22, s20, 1
    s_add_u32 s23, s22, 0
    buffer_load_dwordx2 v[8:9], v5, s[8:11], s23 offen
    s_add_u32 s23, s22, 1152
    buffer_load_dwordx2 v[10:11], v5, s[8:11], s23 offen
    s_add_u32 s23, s22, 2304
    buffer_load_dwordx2 v[12:13], v5, s[8:11], s23 offen
    s_add_u32 s23, s22, 3456
    buffer_load_dwordx2 v[14:15], v5, s[8:11], s23 offen
    s_add_u32 s23, s22, 4608
    buffer_load_dwordx2 v[16:17], v5, s[8:11], s23 offen
    s_add_u32 s23, s22, 5760
    buffer_load_dwordx2 v[18:19], v5, s[8:11], s23 offen
    s_add_u32 s23, s22, 6912
    buffer_load_dwordx2 v[20:21], v5, s[8:11], s23 offen
    s_add_u32 s23, s22, 8064
    buffer_load_dwordx2 v[22:23], v5, s[8:11], s23 offen
    s_mov_b32 s26, 0x3fb8aa3b
    s_mov_b32 s27, 0x3e22f983
    v_mov_b32 v34, 0
    v_mov_b32 v35, 0
    v_lshl_add_u32 v6, v1, 3, v4
    ds_write_b64 v6, v[34:35] offset:0
    s_waitcnt vmcnt(8)
    v_lshlrev_b32 v32, 16, v32
    v_mul_f32 v32, s26, v32
    v_exp_f32 v32, v32
    s_nop 0
    v_cvt_pk_bf16_f32 v32, v32, v32
    v_and_b32 v32, 0xffff0000, v32
    v_add_f32 v33, v32, v32
    v_lshlrev_b32 v24, 16, v24
    v_mul_f32 v24, s26, v24
    v_exp_f32 v24, v24
    s_nop 0
    v_cvt_pk_bf16_f32 v24, v24, v24
    v_and_b32 v24, 0xffff0000, v24
    v_mul_f32 v24, v24, v32
    v_mul_f32 v24, s26, v24
    v_sub_f32 v24, 0, v24
    v_lshlrev_b32 v25, 16, v25
    v_mul_f32 v25, v25, v32
    v_mul_f32 v25, s27, v25
    v_lshlrev_b32 v26, 16, v26
    v_mul_f32 v26, v26, v33
    v_lshlrev_b32 v27, 16, v27
    v_mul_f32 v27, v27, v33
    v_lshlrev_b32 v28, 16, v28
    v_mul_f32 v28, s26, v28
    v_exp_f32 v28, v28
    s_nop 0
    v_cvt_pk_bf16_f32 v28, v28, v28
    v_and_b32 v28, 0xffff0000, v28
    v_mul_f32 v28, v28, v32
    v_mul_f32 v28, s26, v28
    v_sub_f32 v28, 0, v28
    v_lshlrev_b32 v29, 16, v29
    v_mul_f32 v29, v29, v32
    v_mul_f32 v29, s27, v29
    v_lshlrev_b32 v30, 16, v30
    v_mul_f32 v30, v30, v33
    v_lshlrev_b32 v31, 16, v31
    v_mul_f32 v31, v31, v33
    v_cvt_f32_u32 v47, v2
    v_mul_f32 v44, 0x41800000, v47
    v_and_b32 v5, 7, v2
    v_add_u32 v5, 8, v5
    v_cvt_f32_u32 v5, v5
    v_mul_f32 v45, 0x42000000, v5
    v_mul_f32 v6, 0x42800000, v5
    v_cmp_lt_u32 vcc, 7, v2
    s_nop 1
    v_cndmask_b32 v45, v45, v6, vcc
    v_add_f32 v5, 0x41000000, v47
    v_mul_f32 v46, 0x43000000, v5
    v_mov_b32 v48, 0
    v_mov_b32 v49, 0
    v_mov_b32 v50, 0
    v_mov_b32 v51, 0
    v_mov_b32 v52, 0
    v_mov_b32 v53, 0
    v_mov_b32 v54, 0
    v_mov_b32 v55, 0
    v_mov_b32 v56, 0
    v_mov_b32 v57, 0
    v_mov_b32 v58, 0
    v_mov_b32 v59, 0
    v_mov_b32 v60, 0
    v_mov_b32 v61, 0
    v_mov_b32 v62, 0
    v_mov_b32 v63, 0
    s_mov_b32 s25, 8
    s_nop 0
ss_kg:
    v_mov_b32_dpp v64, v24 row_newbcast:0 row_mask:0xf bank_mask:0xf
    v_mov_b32_dpp v65, v25 row_newbcast:0 row_mask:0xf bank_mask:0xf
    v_mov_b32_dpp v66, v26 row_newbcast:0 row_mask:0xf bank_mask:0xf
    v_mov_b32_dpp v67, v27 row_newbcast:0 row_mask:0xf bank_mask:0xf
    v_mul_f32 v82, v64, v47
    v_mul_f32 v83, v65, v47
    v_mul_f32 v84, v64, v45
    v_mul_f32 v85, v65, v45
    v_exp_f32 v82, v82
    v_fract_f32 v83, v83
    v_exp_f32 v84, v84
    v_fract_f32 v85, v85
    v_cos_f32 v74, v83
    v_sin_f32 v75, v83
    v_cos_f32 v70, v85
    v_sin_f32 v71, v85
    v_mul_f32 v74, v74, v82
    v_mul_f32 v75, v75, v82
    v_mul_f32 v70, v70, v84
    v_mul_f32 v71, v71, v84
    v_mul_f32 v82, v75, v75
    v_add_f32 v83, v74, v74
    v_fma_f32 v76, v74, v74, -v82
    v_mul_f32 v77, v83, v75
    v_mul_f32 v82, v77, v77
    v_add_f32 v83, v76, v76
    v_fma_f32 v78, v76, v76, -v82
    v_mul_f32 v79, v83, v77
    v_mul_f32 v82, v79, v79
    v_add_f32 v83, v78, v78
    v_fma_f32 v80, v78, v78, -v82
    v_mul_f32 v81, v83, v79
    v_mul_f32 v82, v81, v81
    v_add_f32 v83, v80, v80
    v_fma_f32 v68, v80, v80, -v82
    v_mul_f32 v69, v83, v81
    v_mul_f32 v84, v71, v71
    v_add_f32 v85, v70, v70
    v_fma_f32 v86, v70, v70, -v84
    v_mul_f32 v87, v85, v71
    v_mul_f32 v84, v87, v87
    v_add_f32 v85, v86, v86
    v_fma_f32 v72, v86, v86, -v84
    v_mul_f32 v73, v85, v87
    v_cvt_pk_bf16_f32 v108, v74, v75
    v_cvt_pk_bf16_f32 v112, v76, v77
    v_cvt_pk_bf16_f32 v116, v78, v79
    v_cvt_pk_bf16_f32 v120, v80, v81
    v_mul_f32 v84, v67, v69
    v_mul_f32 v85, v67, v68
    v_fma_f32 v68, v66, v68, -v84
    v_fma_f32 v69, -v66, v69, -v85
    v_cvt_pk_bf16_f32 v96, v68, v69
    v_mul_f32 v84, v67, v71
    v_mul_f32 v85, v67, v70
    v_fma_f32 v70, v66, v70, -v84
    v_fma_f32 v71, -v66, v71, -v85
    v_cvt_pk_bf16_f32 v100, v70, v71
    v_mul_f32 v84, v67, v73
    v_mul_f32 v85, v67, v72
    v_fma_f32 v72, v66, v72, -v84
    v_fma_f32 v73, -v66, v73, -v85
    v_cvt_pk_bf16_f32 v104, v72, v73
    v_mov_b32_dpp v64, v28 row_newbcast:0 row_mask:0xf bank_mask:0xf
    v_mov_b32_dpp v65, v29 row_newbcast:0 row_mask:0xf bank_mask:0xf
    v_mov_b32_dpp v66, v30 row_newbcast:0 row_mask:0xf bank_mask:0xf
    v_mov_b32_dpp v67, v31 row_newbcast:0 row_mask:0xf bank_mask:0xf
    v_mul_f32 v82, v64, v47
    v_mul_f32 v83, v65, v47
    v_mul_f32 v84, v64, v45
    v_mul_f32 v85, v65, v45
    v_exp_f32 v82, v82
    v_fract_f32 v83, v83
    v_exp_f32 v84, v84
    v_fract_f32 v85, v85
    v_cos_f32 v74, v83
    v_sin_f32 v75, v83
    v_cos_f32 v70, v85
    v_sin_f32 v71, v85
    v_mul_f32 v74, v74, v82
    v_mul_f32 v75, v75, v82
    v_mul_f32 v70, v70, v84
    v_mul_f32 v71, v71, v84
    v_mul_f32 v82, v75, v75
    v_add_f32 v83, v74, v74
    v_fma_f32 v76, v74, v74, -v82
    v_mul_f32 v77, v83, v75
    v_mul_f32 v82, v77, v77
    v_add_f32 v83, v76, v76
    v_fma_f32 v78, v76, v76, -v82
    v_mul_f32 v79, v83, v77
    v_mul_f32 v82, v79, v79
    v_add_f32 v83, v78, v78
    v_fma_f32 v80, v78, v78, -v82
    v_mul_f32 v81, v83, v79
    v_mul_f32 v82, v81, v81
    v_add_f32 v83, v80, v80
    v_fma_f32 v68, v80, v80, -v82
    v_mul_f32 v69, v83, v81
    v_mul_f32 v84, v71, v71
    v_add_f32 v85, v70, v70
    v_fma_f32 v86, v70, v70, -v84
    v_mul_f32 v87, v85, v71
    v_mul_f32 v84, v87, v87
    v_add_f32 v85, v86, v86
    v_fma_f32 v72, v86, v86, -v84
    v_mul_f32 v73, v85, v87
    v_cvt_pk_bf16_f32 v109, v74, v75
    v_cvt_pk_bf16_f32 v113, v76, v77
    v_cvt_pk_bf16_f32 v117, v78, v79
    v_cvt_pk_bf16_f32 v121, v80, v81
    v_mul_f32 v84, v67, v69
    v_mul_f32 v85, v67, v68
    v_fma_f32 v68, v66, v68, -v84
    v_fma_f32 v69, -v66, v69, -v85
    v_cvt_pk_bf16_f32 v97, v68, v69
    v_mul_f32 v84, v67, v71
    v_mul_f32 v85, v67, v70
    v_fma_f32 v70, v66, v70, -v84
    v_fma_f32 v71, -v66, v71, -v85
    v_cvt_pk_bf16_f32 v101, v70, v71
    v_mul_f32 v84, v67, v73
    v_mul_f32 v85, v67, v72
    v_fma_f32 v72, v66, v72, -v84
    v_fma_f32 v73, -v66, v73, -v85
    v_cvt_pk_bf16_f32 v105, v72, v73
    v_mov_b32_dpp v64, v24 row_newbcast:1 row_mask:0xf bank_mask:0xf
    v_mov_b32_dpp v65, v25 row_newbcast:1 row_mask:0xf bank_mask:0xf
    v_mov_b32_dpp v66, v26 row_newbcast:1 row_mask:0xf bank_mask:0xf
    v_mov_b32_dpp v67, v27 row_newbcast:1 row_mask:0xf bank_mask:0xf
    v_mul_f32 v82, v64, v47
    v_mul_f32 v83, v65, v47
    v_mul_f32 v84, v64, v45
    v_mul_f32 v85, v65, v45
    v_exp_f32 v82, v82
    v_fract_f32 v83, v83
    v_exp_f32 v84, v84
    v_fract_f32 v85, v85
    v_cos_f32 v74, v83
    v_sin_f32 v75, v83
    v_cos_f32 v70, v85
    v_sin_f32 v71, v85
    v_mov_b32_dpp v24, v24 row_ror:2 row_mask:0xf bank_mask:0xf
    v_mov_b32_dpp v25, v25 row_ror:2 row_mask:0xf bank_mask:0xf
    v_mov_b32_dpp v26, v26 row_ror:2 row_mask:0xf bank_mask:0xf
    v_mov_b32_dpp v27, v27 row_ror:2 row_mask:0xf bank_mask:0xf
    v_mul_f32 v74, v74, v82
    v_mul_f32 v75, v75, v82
    v_mul_f32 v70, v70, v84
    v_mul_f32 v71, v71, v84
    v_mul_f32 v82, v75, v75
    v_add_f32 v83, v74, v74
    v_fma_f32 v76, v74, v74, -v82
    v_mul_f32 v77, v83, v75
    v_mul_f32 v82, v77, v77
    v_add_f32 v83, v76, v76
    v_fma_f32 v78, v76, v76, -v82
    v_mul_f32 v79, v83, v77
    v_mul_f32 v82, v79, v79
    v_add_f32 v83, v78, v78
    v_fma_f32 v80, v78, v78, -v82
    v_mul_f32 v81, v83, v79
    v_mul_f32 v82, v81, v81
    v_add_f32 v83, v80, v80
    v_fma_f32 v68, v80, v80, -v82
    v_mul_f32 v69, v83, v81
    v_mul_f32 v84, v71, v71
    v_add_f32 v85, v70, v70
    v_fma_f32 v86, v70, v70, -v84
    v_mul_f32 v87, v85, v71
    v_mul_f32 v84, v87, v87
    v_add_f32 v85, v86, v86
    v_fma_f32 v72, v86, v86, -v84
    v_mul_f32 v73, v85, v87
    v_cvt_pk_bf16_f32 v110, v74, v75
    v_cvt_pk_bf16_f32 v114, v76, v77
    v_cvt_pk_bf16_f32 v118, v78, v79
    v_cvt_pk_bf16_f32 v122, v80, v81
    v_mul_f32 v84, v67, v69
    v_mul_f32 v85, v67, v68
    v_fma_f32 v68, v66, v68, -v84
    v_fma_f32 v69, -v66, v69, -v85
    v_cvt_pk_bf16_f32 v98, v68, v69
    v_mul_f32 v84, v67, v71
    v_mul_f32 v85, v67, v70
    v_fma_f32 v70, v66, v70, -v84
    v_fma_f32 v71, -v66, v71, -v85
    v_cvt_pk_bf16_f32 v102, v70, v71
    v_mul_f32 v84, v67, v73
    v_mul_f32 v85, v67, v72
    v_fma_f32 v72, v66, v72, -v84
    v_fma_f32 v73, -v66, v73, -v85
    v_cvt_pk_bf16_f32 v106, v72, v73
    v_mov_b32_dpp v64, v28 row_newbcast:1 row_mask:0xf bank_mask:0xf
    v_mov_b32_dpp v65, v29 row_newbcast:1 row_mask:0xf bank_mask:0xf
    v_mov_b32_dpp v66, v30 row_newbcast:1 row_mask:0xf bank_mask:0xf
    v_mov_b32_dpp v67, v31 row_newbcast:1 row_mask:0xf bank_mask:0xf
    v_mul_f32 v82, v64, v47
    v_mul_f32 v83, v65, v47
    v_mul_f32 v84, v64, v45
    v_mul_f32 v85, v65, v45
    v_exp_f32 v82, v82
    v_fract_f32 v83, v83
    v_exp_f32 v84, v84
    v_fract_f32 v85, v85
    v_cos_f32 v74, v83
    v_sin_f32 v75, v83
    v_cos_f32 v70, v85
    v_sin_f32 v71, v85
    v_mov_b32_dpp v28, v28 row_ror:2 row_mask:0xf bank_mask:0xf
    v_mov_b32_dpp v29, v29 row_ror:2 row_mask:0xf bank_mask:0xf
    v_mov_b32_dpp v30, v30 row_ror:2 row_mask:0xf bank_mask:0xf
    v_mov_b32_dpp v31, v31 row_ror:2 row_mask:0xf bank_mask:0xf
    v_mul_f32 v74, v74, v82
    v_mul_f32 v75, v75, v82
    v_mul_f32 v70, v70, v84
    v_mul_f32 v71, v71, v84
    v_mul_f32 v82, v75, v75
    v_add_f32 v83, v74, v74
    v_fma_f32 v76, v74, v74, -v82
    v_mul_f32 v77, v83, v75
    v_mul_f32 v82, v77, v77
    v_add_f32 v83, v76, v76
    v_fma_f32 v78, v76, v76, -v82
    v_mul_f32 v79, v83, v77
    v_mul_f32 v82, v79, v79
    v_add_f32 v83, v78, v78
    v_fma_f32 v80, v78, v78, -v82
    v_mul_f32 v81, v83, v79
    v_mul_f32 v82, v81, v81
    v_add_f32 v83, v80, v80
    v_fma_f32 v68, v80, v80, -v82
    v_mul_f32 v69, v83, v81
    v_mul_f32 v84, v71, v71
    v_add_f32 v85, v70, v70
    v_fma_f32 v86, v70, v70, -v84
    v_mul_f32 v87, v85, v71
    v_mul_f32 v84, v87, v87
    v_add_f32 v85, v86, v86
    v_fma_f32 v72, v86, v86, -v84
    v_mul_f32 v73, v85, v87
    v_cvt_pk_bf16_f32 v111, v74, v75
    v_cvt_pk_bf16_f32 v115, v76, v77
    v_cvt_pk_bf16_f32 v119, v78, v79
    v_cvt_pk_bf16_f32 v123, v80, v81
    v_mul_f32 v84, v67, v69
    v_mul_f32 v85, v67, v68
    v_fma_f32 v68, v66, v68, -v84
    v_fma_f32 v69, -v66, v69, -v85
    v_cvt_pk_bf16_f32 v99, v68, v69
    v_mul_f32 v84, v67, v71
    v_mul_f32 v85, v67, v70
    v_fma_f32 v70, v66, v70, -v84
    v_fma_f32 v71, -v66, v71, -v85
    v_cvt_pk_bf16_f32 v103, v70, v71
    v_mul_f32 v84, v67, v73
    v_mul_f32 v85, v67, v72
    v_fma_f32 v72, v66, v72, -v84
    v_fma_f32 v73, -v66, v73, -v85
    v_cvt_pk_bf16_f32 v107, v72, v73
    v_mfma_f32_16x16x32_bf16 v[48:51], v[96:99], v[108:111], v[48:51]
    v_mfma_f32_16x16x32_bf16 v[52:55], v[100:103], v[112:115], v[52:55]
    v_mfma_f32_16x16x32_bf16 v[56:59], v[100:103], v[116:119], v[56:59]
    v_mfma_f32_16x16x32_bf16 v[60:63], v[104:107], v[120:123], v[60:63]
    s_sub_u32 s25, s25, 1
    s_cmp_lg_u32 s25, 0
    s_cbranch_scc1 ss_kg
    s_waitcnt vmcnt(0)
    v_mov_b32 v36, 0x05040100
    v_mov_b32 v37, 0x07060302
    v_lshlrev_b32 v6, 4, v0
    v_perm_b32 v40, v10, v8, v36
    v_perm_b32 v41, v14, v12, v36
    v_perm_b32 v42, v18, v16, v36
    v_perm_b32 v43, v22, v20, v36
    ds_write_b128 v6, v[40:43] offset:512
    s_nop 1
    v_perm_b32 v40, v10, v8, v37
    v_perm_b32 v41, v14, v12, v37
    v_perm_b32 v42, v18, v16, v37
    v_perm_b32 v43, v22, v20, v37
    ds_write_b128 v6, v[40:43] offset:16896
    s_nop 1
    v_perm_b32 v40, v11, v9, v36
    v_perm_b32 v41, v15, v13, v36
    v_perm_b32 v42, v19, v17, v36
    v_perm_b32 v43, v23, v21, v36
    ds_write_b128 v6, v[40:43] offset:33280
    s_nop 1
    v_perm_b32 v40, v11, v9, v37
    v_perm_b32 v41, v15, v13, v37
    v_perm_b32 v42, v19, v17, v37
    v_perm_b32 v43, v23, v21, v37
    ds_write_b128 v6, v[40:43] offset:49664
    s_nop 1
    v_lshlrev_b32 v5, 8, v3
    v_lshl_add_u32 v5, v2, 2, v5
    v_add_u32 v5, v5, v4
    ds_write_b32 v5, v48 offset:4608
    ds_write_b32 v5, v49 offset:4672
    ds_write_b32 v5, v50 offset:4736
    ds_write_b32 v5, v51 offset:4800
    v_cmp_gt_u32 vcc, 2, v3
    s_nop 0
    s_mov_b64 exec, vcc
    ds_write_b32 v5, v52 offset:5632
    ds_write_b32 v5, v53 offset:5696
    ds_write_b32 v5, v54 offset:5760
    ds_write_b32 v5, v55 offset:5824
    ds_write_b32 v5, v60 offset:6656
    ds_write_b32 v5, v61 offset:6720
    ds_write_b32 v5, v62 offset:6784
    ds_write_b32 v5, v63 offset:6848
    s_not_b64 exec, exec
    ds_write_b32 v5, v56 offset:5632
    ds_write_b32 v5, v57 offset:5696
    ds_write_b32 v5, v58 offset:5760
    ds_write_b32 v5, v59 offset:5824
    s_mov_b32 exec_lo, 0
    s_mov_b32 exec_hi, 3
    v_cmp_eq_u32 vcc, 0, v2
    s_nop 1
    v_cndmask_b32 v6, 0, v60, vcc
    ds_write_b32 v5, v6 offset:6656
    s_mov_b64 exec, -1
    s_waitcnt lgkmcnt(0)
    v_lshlrev_b32 v7, 1, v1
    v_sub_u32 v7, 2065, v7
    v_lshl_add_u32 v64, v1, 2, v4
    v_mov_b32 v65, 641
    s_mov_b32 s25, 17
ss_exp:
    v_subrev_u32 v66, 0, v7
    v_cvt_f32_u32 v70, v66
    v_cvt_pk_bf16_f32 v70, v70, v70
    v_and_b32 v70, 0xffff, v70
    v_subrev_u32 v70, 0x4280, v70
    v_cmp_gt_u32 vcc, 256, v66
    s_nop 1
    v_cndmask_b32 v70, v70, v66, vcc
    v_cmp_gt_u32 vcc, 2048, v66
    s_nop 1
    v_cndmask_b32 v70, v65, v70, vcc
    v_lshl_add_u32 v70, v70, 2, v4
    ds_read_b32 v74, v70 offset:4608
    v_subrev_u32 v67, 1, v7
    v_cvt_f32_u32 v71, v67
    v_cvt_pk_bf16_f32 v71, v71, v71
    v_and_b32 v71, 0xffff, v71
    v_subrev_u32 v71, 0x4280, v71
    v_cmp_gt_u32 vcc, 256, v67
    s_nop 1
    v_cndmask_b32 v71, v71, v67, vcc
    v_cmp_gt_u32 vcc, 2048, v67
    s_nop 1
    v_cndmask_b32 v71, v65, v71, vcc
    v_lshl_add_u32 v71, v71, 2, v4
    ds_read_b32 v75, v71 offset:4608
    v_subrev_u32 v68, 2, v7
    v_cvt_f32_u32 v72, v68
    v_cvt_pk_bf16_f32 v72, v72, v72
    v_and_b32 v72, 0xffff, v72
    v_subrev_u32 v72, 0x4280, v72
    v_cmp_gt_u32 vcc, 256, v68
    s_nop 1
    v_cndmask_b32 v72, v72, v68, vcc
    v_cmp_gt_u32 vcc, 2048, v68
    s_nop 1
    v_cndmask_b32 v72, v65, v72, vcc
    v_lshl_add_u32 v72, v72, 2, v4
    ds_read_b32 v76, v72 offset:4608
    s_waitcnt lgkmcnt(0)
    v_cvt_pk_bf16_f32 v78, v75, v76
    v_cvt_pk_bf16_f32 v79, v74, v75
    ds_write_b32 v64, v78 offset:7424
    ds_write_b32 v64, v79 offset:11776
    v_subrev_u32 v7, 128, v7
    v_add_u32 v64, 256, v64
    s_sub_u32 s25, s25, 1
    s_cmp_lg_u32 s25, 0
    s_cbranch_scc1 ss_exp
    s_waitcnt lgkmcnt(0)
    s_barrier
    v_and_b32 v5, 1, v2
    v_mul_u32_u24 v64, 4352, v5
    v_sub_u32 v5, v5, v2
    v_lshl_add_u32 v5, v3, 3, v5
    v_lshl_add_u32 v64, v5, 1, v64
    v_add_u32 v64, 11520, v64
    v_add_u32 v64, v64, v4
    v_lshlrev_b32 v65, 5, v2
    v_lshl_add_u32 v65, v3, 4, v65
    v_add_u32 v65, 480, v65
    v_add_u32 v65, v65, v4
    v_mov_b32 v96, 0
    v_mov_b32 v97, 0
    v_mov_b32 v98, 0
    v_mov_b32 v99, 0
    v_mov_b32 v100, 0
    v_mov_b32 v101, 0
    v_mov_b32 v102, 0
    v_mov_b32 v103, 0
    v_mov_b32 v104, 0
    v_mov_b32 v105, 0
    v_mov_b32 v106, 0
    v_mov_b32 v107, 0
    v_mov_b32 v108, 0
    v_mov_b32 v109, 0
    v_mov_b32 v110, 0
    v_mov_b32 v111, 0
    v_mov_b32 v112, 0
    v_mov_b32 v113, 0
    v_mov_b32 v114, 0
    v_mov_b32 v115, 0
    v_mov_b32 v116, 0
    v_mov_b32 v117, 0
    v_mov_b32 v118, 0
    v_mov_b32 v119, 0
    v_mov_b32 v120, 0
    v_mov_b32 v121, 0
    v_mov_b32 v122, 0
    v_mov_b32 v123, 0
    v_mov_b32 v124, 0
    v_mov_b32 v125, 0
    v_mov_b32 v126, 0
    v_mov_b32 v127, 0
    v_subrev_u32 v66, 512, v64
    v_subrev_u32 v67, 1536, v64
    v_subrev_u32 v68, 2560, v64
    v_subrev_u32 v69, 3584, v64
    s_mov_b32 s25, 8
    s_nop 0
ss_cv:
    ds_read2_b32 v[160:161], v66 offset0:128 offset1:129
    ds_read2_b32 v[162:163], v66 offset0:130 offset1:131
    ds_read_b128 v[128:131], v65 offset:0
    ds_read_b128 v[132:135], v65 offset:512
    ds_read_b128 v[136:139], v65 offset:1024
    ds_read_b128 v[140:143], v65 offset:1536
    ds_read_b128 v[144:147], v65 offset:2048
    ds_read_b128 v[148:151], v65 offset:2560
    ds_read_b128 v[152:155], v65 offset:3072
    ds_read_b128 v[156:159], v65 offset:3584
    ds_read2_b32 v[164:165], v66 offset0:0 offset1:1
    ds_read2_b32 v[166:167], v66 offset0:2 offset1:3
    s_waitcnt lgkmcnt(9)
    v_mfma_f32_16x16x32_bf16 v[96:99], v[160:163], v[128:131], v[96:99]
    s_waitcnt lgkmcnt(8)
    v_mfma_f32_16x16x32_bf16 v[100:103], v[160:163], v[132:135], v[100:103]
    s_waitcnt lgkmcnt(7)
    v_mfma_f32_16x16x32_bf16 v[104:107], v[160:163], v[136:139], v[104:107]
    ds_read2_b32 v[168:169], v67 offset0:128 offset1:129
    ds_read2_b32 v[170:171], v67 offset0:130 offset1:131
    s_waitcnt lgkmcnt(8)
    v_mfma_f32_16x16x32_bf16 v[108:111], v[160:163], v[140:143], v[108:111]
    s_waitcnt lgkmcnt(7)
    v_mfma_f32_16x16x32_bf16 v[112:115], v[160:163], v[144:147], v[112:115]
    ds_read2_b32 v[172:173], v67 offset0:0 offset1:1
    ds_read2_b32 v[174:175], v67 offset0:2 offset1:3
    s_waitcnt lgkmcnt(8)
    v_mfma_f32_16x16x32_bf16 v[116:119], v[160:163], v[148:151], v[116:119]
    s_waitcnt lgkmcnt(7)
    v_mfma_f32_16x16x32_bf16 v[120:123], v[160:163], v[152:155], v[120:123]
    ds_read2_b32 v[176:177], v68 offset0:128 offset1:129
    ds_read2_b32 v[178:179], v68 offset0:130 offset1:131
    s_waitcnt lgkmcnt(8)
    v_mfma_f32_16x16x32_bf16 v[124:127], v[160:163], v[156:159], v[124:127]
    s_waitcnt lgkmcnt(6)
    v_mfma_f32_16x16x32_bf16 v[100:103], v[164:167], v[128:131], v[100:103]
    v_mfma_f32_16x16x32_bf16 v[104:107], v[164:167], v[132:135], v[104:107]
    ds_read2_b32 v[180:181], v68 offset0:0 offset1:1
    ds_read2_b32 v[182:183], v68 offset0:2 offset1:3
    v_mfma_f32_16x16x32_bf16 v[108:111], v[164:167], v[136:139], v[108:111]
    v_mfma_f32_16x16x32_bf16 v[112:115], v[164:167], v[140:143], v[112:115]
    ds_read2_b32 v[184:185], v69 offset0:128 offset1:129
    ds_read2_b32 v[186:187], v69 offset0:130 offset1:131
    v_mfma_f32_16x16x32_bf16 v[116:119], v[164:167], v[144:147], v[116:119]
    v_mfma_f32_16x16x32_bf16 v[120:123], v[164:167], v[148:151], v[120:123]
    ds_read2_b32 v[188:189], v69 offset0:0 offset1:1
    ds_read2_b32 v[190:191], v69 offset0:2 offset1:3
    v_mfma_f32_16x16x32_bf16 v[124:127], v[164:167], v[152:155], v[124:127]
    s_waitcnt lgkmcnt(10)
    v_mfma_f32_16x16x32_bf16 v[104:107], v[168:171], v[128:131], v[104:107]
    v_mfma_f32_16x16x32_bf16 v[108:111], v[168:171], v[132:135], v[108:111]
    v_mfma_f32_16x16x32_bf16 v[112:115], v[168:171], v[136:139], v[112:115]
    v_mfma_f32_16x16x32_bf16 v[116:119], v[168:171], v[140:143], v[116:119]
    v_mfma_f32_16x16x32_bf16 v[120:123], v[168:171], v[144:147], v[120:123]
    v_mfma_f32_16x16x32_bf16 v[124:127], v[168:171], v[148:151], v[124:127]
    s_waitcnt lgkmcnt(8)
    v_mfma_f32_16x16x32_bf16 v[108:111], v[172:175], v[128:131], v[108:111]
    v_subrev_u32 v66, 64, v66
    v_mfma_f32_16x16x32_bf16 v[112:115], v[172:175], v[132:135], v[112:115]
    v_subrev_u32 v67, 64, v67
    v_mfma_f32_16x16x32_bf16 v[116:119], v[172:175], v[136:139], v[116:119]
    v_subrev_u32 v68, 64, v68
    v_mfma_f32_16x16x32_bf16 v[120:123], v[172:175], v[140:143], v[120:123]
    v_subrev_u32 v69, 64, v69
    v_mfma_f32_16x16x32_bf16 v[124:127], v[172:175], v[144:147], v[124:127]
    v_subrev_u32 v65, 64, v65
    s_waitcnt lgkmcnt(6)
    v_mfma_f32_16x16x32_bf16 v[112:115], v[176:179], v[128:131], v[112:115]
    v_mfma_f32_16x16x32_bf16 v[116:119], v[176:179], v[132:135], v[116:119]
    v_mfma_f32_16x16x32_bf16 v[120:123], v[176:179], v[136:139], v[120:123]
    v_mfma_f32_16x16x32_bf16 v[124:127], v[176:179], v[140:143], v[124:127]
    s_waitcnt lgkmcnt(4)
    v_mfma_f32_16x16x32_bf16 v[116:119], v[180:183], v[128:131], v[116:119]
    v_mfma_f32_16x16x32_bf16 v[120:123], v[180:183], v[132:135], v[120:123]
    v_mfma_f32_16x16x32_bf16 v[124:127], v[180:183], v[136:139], v[124:127]
    s_waitcnt lgkmcnt(2)
    v_mfma_f32_16x16x32_bf16 v[120:123], v[184:187], v[128:131], v[120:123]
    v_mfma_f32_16x16x32_bf16 v[124:127], v[184:187], v[132:135], v[124:127]
    s_waitcnt lgkmcnt(0)
    v_mfma_f32_16x16x32_bf16 v[124:127], v[188:191], v[128:131], v[124:127]
    s_sub_u32 s25, s25, 1
    s_cmp_lg_u32 s25, 0
    s_cbranch_scc1 ss_cv
    s_nop 4
    v_lshlrev_b32 v5, 6, v2
    v_lshl_add_u32 v5, v3, 4, v5
    v_add_u32 v5, v5, v4
    ds_write_b128 v5, v[96:99] offset:7424
    ds_write_b128 v5, v[100:103] offset:8448
    ds_write_b128 v5, v[104:107] offset:9472
    ds_write_b128 v5, v[108:111] offset:10496
    ds_write_b128 v5, v[112:115] offset:11520
    ds_write_b128 v5, v[116:119] offset:12544
    ds_write_b128 v5, v[120:123] offset:13568
    ds_write_b128 v5, v[124:127] offset:14592
    s_mov_b32 s12, s74
    s_mov_b32 s13, s75
    s_mov_b32 s14, 1152
    s_mov_b32 s15, 0x20000
    s_lshl_b32 s23, s20, 1
    buffer_load_dwordx2 v[24:25], off, s[12:15], s23
    s_waitcnt vmcnt(0) lgkmcnt(0)
    s_barrier
    v_lshlrev_b32 v26, 16, v24
    v_and_b32 v27, 0xffff0000, v24
    v_lshlrev_b32 v28, 16, v25
    v_and_b32 v29, 0xffff0000, v25
    v_lshlrev_b32 v5, 5, v0
    ds_read_b128 v[64:67], v5 offset:7424
    ds_read_b128 v[68:71], v5 offset:7440
    ds_read_b128 v[72:75], v5 offset:23808
    ds_read_b128 v[76:79], v5 offset:23824
    ds_read_b128 v[80:83], v5 offset:40192
    ds_read_b128 v[84:87], v5 offset:40208
    ds_read_b128 v[88:91], v5 offset:56576
    ds_read_b128 v[92:95], v5 offset:56592
    s_waitcnt lgkmcnt(0)
    v_mul_u32_u24 v5, 18432, v0
    s_lshl_b32 s22, s20, 1
    s_add_u32 s22, s22, 1152
    v_lshlrev_b32 v6, 16, v8
    v_fmac_f32 v64, v6, v26
    v_and_b32 v6, 0xffff0000, v8
    v_fmac_f32 v72, v6, v27
    v_lshlrev_b32 v6, 16, v9
    v_fmac_f32 v80, v6, v28
    v_and_b32 v6, 0xffff0000, v9
    v_fmac_f32 v88, v6, v29
    v_cvt_pk_bf16_f32 v8, v64, v72
    v_cvt_pk_bf16_f32 v9, v80, v88
    s_add_u32 s23, s22, 0
    buffer_store_dwordx2 v[8:9], v5, s[16:19], s23 offen
    v_lshlrev_b32 v6, 16, v10
    v_fmac_f32 v65, v6, v26
    v_and_b32 v6, 0xffff0000, v10
    v_fmac_f32 v73, v6, v27
    v_lshlrev_b32 v6, 16, v11
    v_fmac_f32 v81, v6, v28
    v_and_b32 v6, 0xffff0000, v11
    v_fmac_f32 v89, v6, v29
    v_cvt_pk_bf16_f32 v10, v65, v73
    v_cvt_pk_bf16_f32 v11, v81, v89
    s_add_u32 s23, s22, 2304
    buffer_store_dwordx2 v[10:11], v5, s[16:19], s23 offen
    v_lshlrev_b32 v6, 16, v12
    v_fmac_f32 v66, v6, v26
    v_and_b32 v6, 0xffff0000, v12
    v_fmac_f32 v74, v6, v27
    v_lshlrev_b32 v6, 16, v13
    v_fmac_f32 v82, v6, v28
    v_and_b32 v6, 0xffff0000, v13
    v_fmac_f32 v90, v6, v29
    v_cvt_pk_bf16_f32 v12, v66, v74
    v_cvt_pk_bf16_f32 v13, v82, v90
    s_add_u32 s23, s22, 4608
    buffer_store_dwordx2 v[12:13], v5, s[16:19], s23 offen
    v_lshlrev_b32 v6, 16, v14
    v_fmac_f32 v67, v6, v26
    v_and_b32 v6, 0xffff0000, v14
    v_fmac_f32 v75, v6, v27
    v_lshlrev_b32 v6, 16, v15
    v_fmac_f32 v83, v6, v28
    v_and_b32 v6, 0xffff0000, v15
    v_fmac_f32 v91, v6, v29
    v_cvt_pk_bf16_f32 v14, v67, v75
    v_cvt_pk_bf16_f32 v15, v83, v91
    s_add_u32 s23, s22, 6912
    buffer_store_dwordx2 v[14:15], v5, s[16:19], s23 offen
    v_lshlrev_b32 v6, 16, v16
    v_fmac_f32 v68, v6, v26
    v_and_b32 v6, 0xffff0000, v16
    v_fmac_f32 v76, v6, v27
    v_lshlrev_b32 v6, 16, v17
    v_fmac_f32 v84, v6, v28
    v_and_b32 v6, 0xffff0000, v17
    v_fmac_f32 v92, v6, v29
    v_cvt_pk_bf16_f32 v16, v68, v76
    v_cvt_pk_bf16_f32 v17, v84, v92
    s_add_u32 s23, s22, 9216
    buffer_store_dwordx2 v[16:17], v5, s[16:19], s23 offen
    v_lshlrev_b32 v6, 16, v18
    v_fmac_f32 v69, v6, v26
    v_and_b32 v6, 0xffff0000, v18
    v_fmac_f32 v77, v6, v27
    v_lshlrev_b32 v6, 16, v19
    v_fmac_f32 v85, v6, v28
    v_and_b32 v6, 0xffff0000, v19
    v_fmac_f32 v93, v6, v29
    v_cvt_pk_bf16_f32 v18, v69, v77
    v_cvt_pk_bf16_f32 v19, v85, v93
    s_add_u32 s23, s22, 11520
    buffer_store_dwordx2 v[18:19], v5, s[16:19], s23 offen
    v_lshlrev_b32 v6, 16, v20
    v_fmac_f32 v70, v6, v26
    v_and_b32 v6, 0xffff0000, v20
    v_fmac_f32 v78, v6, v27
    v_lshlrev_b32 v6, 16, v21
    v_fmac_f32 v86, v6, v28
    v_and_b32 v6, 0xffff0000, v21
    v_fmac_f32 v94, v6, v29
    v_cvt_pk_bf16_f32 v20, v70, v78
    v_cvt_pk_bf16_f32 v21, v86, v94
    s_add_u32 s23, s22, 13824
    buffer_store_dwordx2 v[20:21], v5, s[16:19], s23 offen
    v_lshlrev_b32 v6, 16, v22
    v_fmac_f32 v71, v6, v26
    v_and_b32 v6, 0xffff0000, v22
    v_fmac_f32 v79, v6, v27
    v_lshlrev_b32 v6, 16, v23
    v_fmac_f32 v87, v6, v28
    v_and_b32 v6, 0xffff0000, v23
    v_fmac_f32 v95, v6, v29
    v_cvt_pk_bf16_f32 v22, v71, v79
    v_cvt_pk_bf16_f32 v23, v87, v95
    s_add_u32 s23, s22, 16128
    buffer_store_dwordx2 v[22:23], v5, s[16:19], s23 offen
    s_branch L_ssm_next
L_phase2:
    v_and_b32 v1, 63, v0
    v_min_u32 v1, 6, v1
    v_lshlrev_b32 v2, 2, v1
    s_cmp_lg_u32 s32, 0
    v_mov_b32 v251, 163832
    s_cbranch_scc1 sw10
    buffer_load_dword v3, v2, s[96:99], 0 offen offset:32 sc1
    v_mov_b32 v4, 32
    s_waitcnt vmcnt(0)
    v_cmp_lt_u32 vcc, v3, v4
    s_nop 0
    s_ff1_i32_b64 s40, vcc
    v_mov_b32 v250, s40
    ds_write_b32 v251, v250
    s_waitcnt lgkmcnt(0)
sw10:
    s_barrier
    ds_read_b32 v252, v251
    s_waitcnt lgkmcnt(0)
    v_readfirstlane_b32 s33, v252
    s_barrier
    s_nop 1
    s_cmp_lt_u32 s33, 7
    s_cbranch_scc1 L_pool
    s_mov_b32 s88, 4194304
gn11:
    s_cmp_lg_u32 s95, 0
    s_cbranch_scc1 gn11x
    buffer_load_dword v250, off, s[96:99], 0 offset:64 sc1
    s_sub_u32 s88, s88, 1
    s_cbranch_scc1 gn11x
    s_waitcnt vmcnt(0)
    v_readfirstlane_b32 s95, v250
    s_nop 1
    s_branch gn11
gn11x:
    s_mov_b32 s40, 524288
mc2_w:
    buffer_load_dword v250, off, s[96:99], 0 offset:140 sc1
    s_waitcnt vmcnt(0)
    v_readfirstlane_b32 s41, v250
    s_nop 0
    s_cmp_lg_u32 s41, 0
    s_cbranch_scc1 mc2_known
    s_sub_u32 s40, s40, 1
    s_cbranch_scc1 mc2_force
    s_sleep 2
    s_branch mc2_w
mc2_force:
    v_mov_b32 v250, 2
    v_mov_b32 v251, 0
    s_mov_b64 exec, 1
    buffer_atomic_cmpswap v[250:251], off, s[96:99], 0 offset:140
    s_mov_b64 exec, -1
    s_waitcnt vmcnt(0)
    s_mov_b32 s40, 524288
    s_branch mc2_w
mc2_known:
    s_cmp_eq_u32 s41, 1
    s_cbranch_scc1 L_phase2b
    s_mov_b32 s37, 208
    v_mov_b32 v250, 1
    v_mov_b32 v251, 163832
    v_cmp_eq_u32 vcc, 0, v0
    s_nop 0
    s_and_saveexec_b64 s[38:39], vcc
    s_cbranch_execz tk12
    buffer_atomic_add v250, off, s[96:99], s37 sc0
    s_waitcnt vmcnt(0)
    ds_write_b32 v251, v250
    s_waitcnt lgkmcnt(0)
tk12:
    s_mov_b64 exec, -1
    s_barrier
    ds_read_b32 v252, v251
    s_waitcnt lgkmcnt(0)
    v_readfirstlane_b32 s12, v252
    s_barrier
    s_nop 3
    s_cmp_lt_u32 s12, 32
    s_cbranch_scc1 L_chain_safe
L_phase2b:
    s_mov_b32 s8, s76
    s_mov_b32 s9, s77
    s_mov_b32 s10, 4718592
    s_mov_b32 s11, 0x20000
    s_sub_u32 s33, s3, 4
    s_and_b32 s33, s33, 7
    s_cmp_ge_u32 s33, 6
    s_cbranch_scc1 L_p2scan
L_p2take:
    s_lshl_b32 s35, s33, 2
    s_add_u32 s35, s35, 160
    s_mov_b32 s37, s35
    v_mov_b32 v250, 1
    v_mov_b32 v251, 163832
    v_cmp_eq_u32 vcc, 0, v0
    s_nop 0
    s_and_saveexec_b64 s[38:39], vcc
    s_cbranch_execz tk13
    buffer_atomic_add v250, off, s[96:99], s37 sc0
    s_waitcnt vmcnt(0)
    ds_write_b32 v251, v250
    s_waitcnt lgkmcnt(0)
tk13:
    s_mov_b64 exec, -1
    s_barrier
    ds_read_b32 v252, v251
    s_waitcnt lgkmcnt(0)
    v_readfirstlane_b32 s34, v252
    s_barrier
    s_nop 3
    s_cmp_lt_u32 s33, 4
    s_cselect_b32 s36, 9, 8
    s_cmp_lt_u32 s34, s36
    s_cbranch_scc1 L_att0
    s_sub_u32 s34, s34, s36
    s_cmp_ge_u32 s34, 18
    s_cbranch_scc1 L_p2scan
    s_branch L_op_start
    s_mul_i32 s36, s33, 3
    s_add_u32 s36, s36, s34
    s_sub_u32 s37, s34, 3
    s_cmp_lt_u32 s34, 3
    s_cselect_b32 s34, s36, s37
    s_cselect_b32 s33, 6, s33
    s_branch L_op_start
L_p2scan:
    v_and_b32 v1, 63, v0
    v_min_u32 v1, 5, v1
    v_lshlrev_b32 v2, 2, v1
    s_cmp_lg_u32 s32, 0
    v_mov_b32 v251, 163832
    s_cbranch_scc1 sw14
    buffer_load_dword v3, v2, s[96:99], 0 offen offset:160 sc1
    v_mov_b32 v4, 26
    v_cmp_gt_u32 vcc, 4, v1
    s_nop 1
    v_cndmask_b32 v4, v4, 27, vcc
    s_waitcnt vmcnt(0)
    v_cmp_lt_u32 vcc, v3, v4
    s_nop 0
    s_ff1_i32_b64 s40, vcc
    v_mov_b32 v250, s40
    ds_write_b32 v251, v250
    s_waitcnt lgkmcnt(0)
sw14:
    s_barrier
    ds_read_b32 v252, v251
    s_waitcnt lgkmcnt(0)
    v_readfirstlane_b32 s33, v252
    s_barrier
    s_nop 1
    s_cmp_lt_u32 s33, 7
    s_cbranch_scc1 L_p2take
    s_branch L_done
L_att0:
    s_mul_i32 s34, s34, 6
    s_add_u32 s34, s34, s33
    s_cmp_ge_u32 s34, 48
    s_cbranch_scc1 L_done
L_att_next:
    s_lshr_b32 s16, s34, 3
    s_and_b32 s17, s34, 7
    s_lshl_b32 s17, s17, 2
    s_add_u32 s17, s17, s32
    s_lshr_b32 s36, s17, 1
    s_lshl_b32 s36, s36, 8
    s_add_u32 s36, s36, 125829120
    s_mul_i32 s37, s16, 43
    s_lshr_b32 s37, s37, 8
    s_mul_i32 s41, s37, 6
    s_sub_u32 s41, s16, s41
    v_and_b32 v1, 63, v0
    v_mul_u32_u24 v2, 6, v1
    v_add_u32 v2, s41, v2
    v_mov_b32 v4, s37
    s_and_b32 s41, s16, 7
    s_add_u32 s41, s41, 12
    s_lshr_b32 s37, s16, 3
    v_mov_b32 v5, s41
    v_mov_b32 v6, s37
    v_cmp_lt_u32 vcc, 1, v1
    s_nop 1
    v_cndmask_b32 v2, v2, v5, vcc
    v_cndmask_b32 v4, v4, v6, vcc
    v_lshlrev_b32 v2, 2, v2
    v_add3_u32 v4, v4, s95, 1
    s_mov_b32 s40, 4194304
L_aw1:
    buffer_load_dword v3, v2, s[4:7], s36 offen sc1
    s_sub_u32 s40, s40, 1
    s_cbranch_scc1 L_aw1_go
    s_waitcnt vmcnt(0)
    v_subrev_u32 v3, v4, v3
    v_cmp_lt_u32 vcc, 64, v3
    s_cbranch_vccz L_aw1_go
    s_sleep 4
    s_branch L_aw1
L_aw1_go:
    v_and_b32 v5, 63, v0
    v_lshlrev_b32 v1, 4, v5
    v_or_b32 v3, 128, v1
    v_lshrrev_b32 v4, 4, v5
    v_bfe_u32 v6, v5, 2, 2
    v_sub_u32 v4, v6, v4
    v_lshlrev_b32 v4, 3, v4
    v_and_b32 v6, 3, v5
    v_add_u32 v4, v4, v6
    v_mov_b32 v6, 0xf149f2ca
    s_mov_b32 s22, 0x3e0293ee
    s_lshl_b32 s18, s16, 5
    s_add_u32 s18, s18, s17
    s_lshl_b32 s19, s18, 13
    s_add_u32 s20, s19, 33554432
    buffer_load_dwordx4 v[8:11], v1, s[4:7], s20 offen offset:0 sc1
    s_add_u32 s20, s19, 33554432
    buffer_load_dwordx4 v[12:15], v1, s[4:7], s20 offen offset:1024 sc1
    s_add_u32 s20, s19, 33554432
    buffer_load_dwordx4 v[16:19], v1, s[4:7], s20 offen offset:2048 sc1
    s_add_u32 s20, s19, 33554432
    buffer_load_dwordx4 v[20:23], v1, s[4:7], s20 offen offset:3072 sc1
    s_add_u32 s20, s19, 33558528
    buffer_load_dwordx4 v[24:27], v1, s[4:7], s20 offen offset:0 sc1
    s_add_u32 s20, s19, 33558528
    buffer_load_dwordx4 v[28:31], v1, s[4:7], s20 offen offset:1024 sc1
    s_add_u32 s20, s19, 33558528
    buffer_load_dwordx4 v[32:35], v1, s[4:7], s20 offen offset:2048 sc1
    s_add_u32 s20, s19, 33558528
    buffer_load_dwordx4 v[36:39], v1, s[4:7], s20 offen offset:3072 sc1
    s_lshl_b32 s21, s18, 14
    s_add_u32 s20, s21, 0
    buffer_load_dwordx4 v[40:43], v1, s[4:7], s20 offen offset:0 sc1
    s_add_u32 s20, s21, 4096
    buffer_load_dwordx4 v[44:47], v1, s[4:7], s20 offen offset:0 sc1
    s_add_u32 s20, s21, 8192
    buffer_load_dwordx4 v[48:51], v1, s[4:7], s20 offen offset:0 sc1
    s_add_u32 s20, s21, 12288
    buffer_load_dwordx4 v[52:55], v1, s[4:7], s20 offen offset:0 sc1
    s_add_u32 s20, s21, 0
    buffer_load_dwordx4 v[56:59], v1, s[4:7], s20 offen offset:1024 sc1
    s_add_u32 s20, s21, 4096
    buffer_load_dwordx4 v[60:63], v1, s[4:7], s20 offen offset:1024 sc1
    s_add_u32 s20, s21, 8192
    buffer_load_dwordx4 v[64:67], v1, s[4:7], s20 offen offset:1024 sc1
    s_add_u32 s20, s21, 12288
    buffer_load_dwordx4 v[68:71], v1, s[4:7], s20 offen offset:1024 sc1
    s_add_u32 s20, s21, 0
    buffer_load_dwordx4 v[88:91], v1, s[4:7], s20 offen offset:2048 sc1
    s_add_u32 s20, s21, 4096
    buffer_load_dwordx4 v[92:95], v1, s[4:7], s20 offen offset:2048 sc1
    s_add_u32 s20, s21, 8192
    buffer_load_dwordx4 v[96:99], v1, s[4:7], s20 offen offset:2048 sc1
    s_add_u32 s20, s21, 12288
    buffer_load_dwordx4 v[100:103], v1, s[4:7], s20 offen offset:2048 sc1
    s_add_u32 s20, s21, 0
    buffer_load_dwordx4 v[104:107], v1, s[4:7], s20 offen offset:3072 sc1
    s_add_u32 s20, s21, 4096
    buffer_load_dwordx4 v[108:111], v1, s[4:7], s20 offen offset:3072 sc1
    s_add_u32 s20, s21, 8192
    buffer_load_dwordx4 v[112:115], v1, s[4:7], s20 offen offset:3072 sc1
    s_add_u32 s20, s21, 12288
    buffer_load_dwordx4 v[116:119], v1, s[4:7], s20 offen offset:3072 sc1
    v_mov_b32 v172, 0x3f803f80
    v_mov_b32 v173, 0x3f803f80
    v_mov_b32 v174, 0x3f803f80
    v_mov_b32 v175, 0x3f803f80
    v_mov_b32 v176, 0x3f003f00
    v_mov_b32 v177, 0x3f003f00
    s_waitcnt vmcnt(8)
    v_mfma_f32_16x16x32_bf16 v[136:139], v[40:43], v[8:11], 0
    v_mfma_f32_16x16x32_bf16 v[140:143], v[56:59], v[8:11], 0
    v_mfma_f32_16x16x32_bf16 v[148:151], v[40:43], v[24:27], 0
    v_mfma_f32_16x16x32_bf16 v[152:155], v[56:59], v[24:27], 0
    v_mfma_f32_16x16x32_bf16 v[136:139], v[44:47], v[12:15], v[136:139]
    v_mfma_f32_16x16x32_bf16 v[140:143], v[60:63], v[12:15], v[140:143]
    v_mfma_f32_16x16x32_bf16 v[148:151], v[44:47], v[28:31], v[148:151]
    v_mfma_f32_16x16x32_bf16 v[152:155], v[60:63], v[28:31], v[152:155]
    v_mfma_f32_16x16x32_bf16 v[136:139], v[48:51], v[16:19], v[136:139]
    v_mfma_f32_16x16x32_bf16 v[140:143], v[64:67], v[16:19], v[140:143]
    v_mfma_f32_16x16x32_bf16 v[148:151], v[48:51], v[32:35], v[148:151]
    v_mfma_f32_16x16x32_bf16 v[152:155], v[64:67], v[32:35], v[152:155]
    v_mfma_f32_16x16x32_bf16 v[136:139], v[52:55], v[20:23], v[136:139]
    v_mfma_f32_16x16x32_bf16 v[140:143], v[68:71], v[20:23], v[140:143]
    v_mfma_f32_16x16x32_bf16 v[148:151], v[52:55], v[36:39], v[148:151]
    v_mfma_f32_16x16x32_bf16 v[152:155], v[68:71], v[36:39], v[152:155]
    v_cmp_le_i32 vcc, 0, v4
    s_nop 1
    v_cndmask_b32 v136, v6, v136, vcc
    v_cmp_le_i32 vcc, 1, v4
    s_nop 1
    v_cndmask_b32 v137, v6, v137, vcc
    v_cmp_le_i32 vcc, 2, v4
    s_nop 1
    v_cndmask_b32 v138, v6, v138, vcc
    v_cmp_le_i32 vcc, 3, v4
    s_nop 1
    v_cndmask_b32 v139, v6, v139, vcc
    v_cmp_le_i32 vcc, 4, v4
    s_nop 1
    v_cndmask_b32 v140, v6, v140, vcc
    v_cmp_le_i32 vcc, 5, v4
    s_nop 1
    v_cndmask_b32 v141, v6, v141, vcc
    v_cmp_le_i32 vcc, 6, v4
    s_nop 1
    v_cndmask_b32 v142, v6, v142, vcc
    v_cmp_le_i32 vcc, 7, v4
    s_nop 1
    v_cndmask_b32 v143, v6, v143, vcc
    v_cmp_le_i32 vcc, -4, v4
    s_nop 1
    v_cndmask_b32 v148, v6, v148, vcc
    v_cmp_le_i32 vcc, -3, v4
    s_nop 1
    v_cndmask_b32 v149, v6, v149, vcc
    v_cmp_le_i32 vcc, -2, v4
    s_nop 1
    v_cndmask_b32 v150, v6, v150, vcc
    v_cmp_le_i32 vcc, -1, v4
    s_nop 1
    v_cndmask_b32 v151, v6, v151, vcc
    v_cmp_le_i32 vcc, 0, v4
    s_nop 1
    v_cndmask_b32 v152, v6, v152, vcc
    v_cmp_le_i32 vcc, 1, v4
    s_nop 1
    v_cndmask_b32 v153, v6, v153, vcc
    v_cmp_le_i32 vcc, 2, v4
    s_nop 1
    v_cndmask_b32 v154, v6, v154, vcc
    v_cmp_le_i32 vcc, 3, v4
    s_nop 1
    v_cndmask_b32 v155, v6, v155, vcc
    v_max3_f32 v196, v136, v137, v138
    v_max3_f32 v196, v196, v139, v140
    v_max3_f32 v196, v196, v141, v142
    v_max_f32 v196, v196, v143
    v_mov_b32 v197, v196
    s_nop 1
    v_permlane32_swap_b32 v196, v197
    v_max_f32 v196, v196, v197
    v_mov_b32 v197, v196
    s_nop 1
    v_permlane16_swap_b32 v196, v197
    v_max_f32 v196, v196, v197
    v_mul_f32 v192, s22, v196
    v_fma_f32 v136, v136, s22, -v192
    v_fma_f32 v137, v137, s22, -v192
    v_fma_f32 v138, v138, s22, -v192
    v_fma_f32 v139, v139, s22, -v192
    v_fma_f32 v140, v140, s22, -v192
    v_fma_f32 v141, v141, s22, -v192
    v_fma_f32 v142, v142, s22, -v192
    v_fma_f32 v143, v143, s22, -v192
    v_exp_f32 v136, v136
    v_exp_f32 v137, v137
    v_exp_f32 v138, v138
    v_exp_f32 v139, v139
    v_exp_f32 v140, v140
    v_exp_f32 v141, v141
    v_exp_f32 v142, v142
    v_exp_f32 v143, v143
    v_cvt_pk_bf16_f32 v160, v136, v137
    v_cvt_pk_bf16_f32 v161, v138, v139
    v_cvt_pk_bf16_f32 v162, v140, v141
    v_cvt_pk_bf16_f32 v163, v142, v143
    v_max3_f32 v196, v148, v149, v150
    v_max3_f32 v196, v196, v151, v152
    v_max3_f32 v196, v196, v153, v154
    v_max_f32 v196, v196, v155
    v_mov_b32 v197, v196
    s_nop 1
    v_permlane32_swap_b32 v196, v197
    v_max_f32 v196, v196, v197
    v_mov_b32 v197, v196
    s_nop 1
    v_permlane16_swap_b32 v196, v197
    v_max_f32 v196, v196, v197
    v_mul_f32 v193, s22, v196
    v_fma_f32 v148, v148, s22, -v193
    v_fma_f32 v149, v149, s22, -v193
    v_fma_f32 v150, v150, s22, -v193
    v_fma_f32 v151, v151, s22, -v193
    v_fma_f32 v152, v152, s22, -v193
    v_fma_f32 v153, v153, s22, -v193
    v_fma_f32 v154, v154, s22, -v193
    v_fma_f32 v155, v155, s22, -v193
    v_exp_f32 v148, v148
    v_exp_f32 v149, v149
    v_exp_f32 v150, v150
    v_exp_f32 v151, v151
    v_exp_f32 v152, v152
    v_exp_f32 v153, v153
    v_exp_f32 v154, v154
    v_exp_f32 v155, v155
    v_cvt_pk_bf16_f32 v166, v148, v149
    v_cvt_pk_bf16_f32 v167, v150, v151
    v_cvt_pk_bf16_f32 v168, v152, v153
    v_cvt_pk_bf16_f32 v169, v154, v155
    v_mfma_f32_16x16x32_bf16 v[180:183], v[172:175], v[160:163], 0
    v_mfma_f32_16x16x32_bf16 v[184:187], v[172:175], v[166:169], 0
    s_waitcnt vmcnt(7)
    v_mfma_f32_16x16x32_bf16 v[40:43], v[88:91], v[160:163], 0
    s_waitcnt vmcnt(3)
    v_mfma_f32_16x16x32_bf16 v[44:47], v[104:107], v[160:163], 0
    v_mfma_f32_16x16x32_bf16 v[48:51], v[88:91], v[166:169], 0
    v_mfma_f32_16x16x32_bf16 v[52:55], v[104:107], v[166:169], 0
    v_mfma_f32_16x16x32_bf16 v[56:59], v[92:95], v[160:163], 0
    s_waitcnt vmcnt(2)
    v_mfma_f32_16x16x32_bf16 v[60:63], v[108:111], v[160:163], 0
    v_mfma_f32_16x16x32_bf16 v[64:67], v[92:95], v[166:169], 0
    v_mfma_f32_16x16x32_bf16 v[68:71], v[108:111], v[166:169], 0
    v_mfma_f32_16x16x32_bf16 v[200:203], v[96:99], v[160:163], 0
    s_waitcnt vmcnt(1)
    v_mfma_f32_16x16x32_bf16 v[204:207], v[112:115], v[160:163], 0
    v_mfma_f32_16x16x32_bf16 v[208:211], v[96:99], v[166:169], 0
    v_mfma_f32_16x16x32_bf16 v[212:215], v[112:115], v[166:169], 0
    v_mfma_f32_16x16x32_bf16 v[216:219], v[100:103], v[160:163], 0
    s_waitcnt vmcnt(0)
    v_mfma_f32_16x16x32_bf16 v[220:223], v[116:119], v[160:163], 0
    v_mfma_f32_16x16x32_bf16 v[224:227], v[100:103], v[166:169], 0
    v_mfma_f32_16x16x32_bf16 v[228:231], v[116:119], v[166:169], 0
    s_nop 7
    s_mov_b32 s88, 65536
cw15:
    buffer_load_dword v199, off, s[4:7], s36 offset:128 sc1
    s_waitcnt vmcnt(0)
    v_readfirstlane_b32 s42, v199
    s_nop 0
    s_sub_u32 s42, s42, s95
    s_cmp_gt_u32 s42, 64
    s_cselect_b32 s42, 0, s42
    s_add_u32 s42, s42, 2
    s_cmp_ge_u32 s42, s16
    s_cbranch_scc1 cw15x
    s_sub_u32 s88, s88, 1
    s_cbranch_scc1 cw15x
    s_sub_u32 s42, s16, s42
    s_min_u32 s42, s42, 6
cw15s:
    s_sleep 24
    s_sub_u32 s42, s42, 1
    s_cmp_lg_u32 s42, 0
    s_cbranch_scc1 cw15s
    s_branch cw15
cw15x:
    s_and_b32 s37, s16, 1
    s_lshl_b32 s37, s37, 2
    s_add_u32 s37, s37, s36
    s_add_u32 s37, s37, 128
    s_add_u32 s41, s16, s95
    s_add_u32 s41, s41, 1
    s_lshl_b32 s42, s17, 7
    s_add_u32 s42, s42, 125845504
    s_cmp_ge_u32 s16, 62
    s_cselect_b32 s37, s42, s37
    s_cselect_b32 s42, 12, 8
    v_lshlrev_b32 v198, 2, v0
    v_and_b32 v198, s42, v198
    s_mov_b32 s40, 4194304
L_aw2:
    buffer_load_dword v199, v198, s[4:7], s37 offen sc1
    s_sub_u32 s40, s40, 1
    s_cbranch_scc1 L_aw2_go
    s_waitcnt vmcnt(0)
    v_subrev_u32 v199, s41, v199
    v_cmp_lt_u32 vcc, 64, v199
    s_cbranch_vccz L_aw2_go
    s_sleep 1
    s_branch L_aw2
L_aw2_go:
    s_mov_b32 s21, 4096
at_again:
    s_lshl_b32 s20, s18, 12
    s_add_u32 s20, s20, 71303168
    buffer_load_dwordx4 v[72:75], v3, s[4:7], s20 offen offset:0 sc1
    buffer_load_dwordx4 v[76:79], v3, s[4:7], s20 offen offset:1024 sc1
    buffer_load_dwordx4 v[80:83], v3, s[4:7], s20 offen offset:2048 sc1
    buffer_load_dwordx4 v[84:87], v3, s[4:7], s20 offen offset:3072 sc1
    s_lshl_b32 s20, s18, 12
    s_add_u32 s20, s20, 80740352
    buffer_load_dwordx4 v[120:123], v1, s[4:7], s20 offen offset:0 sc1
    buffer_load_dwordx4 v[124:127], v1, s[4:7], s20 offen offset:1024 sc1
    buffer_load_dwordx4 v[128:131], v1, s[4:7], s20 offen offset:2048 sc1
    buffer_load_dwordx4 v[132:135], v1, s[4:7], s20 offen offset:3072 sc1
    s_waitcnt vmcnt(7)
    v_mfma_f32_16x16x32_bf16 v[144:147], v[72:75], v[8:11], 0
    v_mfma_f32_16x16x32_bf16 v[156:159], v[72:75], v[24:27], 0
    s_waitcnt vmcnt(6)
    v_mfma_f32_16x16x32_bf16 v[144:147], v[76:79], v[12:15], v[144:147]
    v_mfma_f32_16x16x32_bf16 v[156:159], v[76:79], v[28:31], v[156:159]
    s_waitcnt vmcnt(5)
    v_mfma_f32_16x16x32_bf16 v[144:147], v[80:83], v[16:19], v[144:147]
    v_mfma_f32_16x16x32_bf16 v[156:159], v[80:83], v[32:35], v[156:159]
    s_waitcnt vmcnt(4)
    v_mfma_f32_16x16x32_bf16 v[144:147], v[84:87], v[20:23], v[144:147]
    v_mfma_f32_16x16x32_bf16 v[156:159], v[84:87], v[36:39], v[156:159]
    v_max3_u32 v196, v72, v76, v80
    s_waitcnt vmcnt(0)
    v_max3_u32 v196, v196, v84, v120
    v_max3_u32 v196, v196, v124, v128
    v_max_u32 v196, v196, v132
    v_cmp_eq_u32 vcc, -1, v196
    s_sub_u32 s21, s21, 1
    s_nop 3
    s_cbranch_scc1 at_ok
    s_cbranch_vccnz at_again
at_ok:
    v_max3_f32 v196, v144, v145, v146
    v_max_f32 v196, v196, v147
    v_mov_b32 v197, v196
    s_nop 1
    v_permlane16_swap_b32 v196, v197
    v_max_f32 v196, v196, v197
    v_mul_f32 v196, s22, v196
    v_max_f32 v196, v196, v192
    v_sub_f32 v192, v192, v196
    v_fma_f32 v144, v144, s22, -v196
    v_fma_f32 v145, v145, s22, -v196
    v_fma_f32 v146, v146, s22, -v196
    v_fma_f32 v147, v147, s22, -v196
    v_exp_f32 v192, v192
    v_exp_f32 v144, v144
    v_exp_f32 v145, v145
    v_exp_f32 v146, v146
    v_exp_f32 v147, v147
    v_add_f32 v196, v144, v145
    v_add_f32 v197, v146, v147
    v_add_f32 v196, v196, v197
    v_mov_b32 v197, v196
    s_nop 1
    v_permlane16_swap_b32 v196, v197
    v_add_f32 v196, v196, v197
    v_fmac_f32 v196, v192, v180
    v_rcp_f32 v196, v196
    s_nop 0
    v_mul_f32 v144, v144, v196
    v_mul_f32 v145, v145, v196
    v_mul_f32 v146, v146, v196
    v_mul_f32 v147, v147, v196
    v_mul_f32 v192, v192, v196
    v_cvt_pk_bf16_f32 v164, v144, v145
    v_cvt_pk_bf16_f32 v165, v146, v147
    v_max3_f32 v196, v156, v157, v158
    v_max_f32 v196, v196, v159
    v_mov_b32 v197, v196
    s_nop 1
    v_permlane16_swap_b32 v196, v197
    v_max_f32 v196, v196, v197
    v_mul_f32 v196, s22, v196
    v_max_f32 v196, v196, v193
    v_sub_f32 v193, v193, v196
    v_fma_f32 v156, v156, s22, -v196
    v_fma_f32 v157, v157, s22, -v196
    v_fma_f32 v158, v158, s22, -v196
    v_fma_f32 v159, v159, s22, -v196
    v_exp_f32 v193, v193
    v_exp_f32 v156, v156
    v_exp_f32 v157, v157
    v_exp_f32 v158, v158
    v_exp_f32 v159, v159
    v_add_f32 v196, v156, v157
    v_add_f32 v197, v158, v159
    v_add_f32 v196, v196, v197
    v_mov_b32 v197, v196
    s_nop 1
    v_permlane16_swap_b32 v196, v197
    v_add_f32 v196, v196, v197
    v_fmac_f32 v196, v193, v184
    v_rcp_f32 v196, v196
    s_nop 0
    v_mul_f32 v156, v156, v196
    v_mul_f32 v157, v157, v196
    v_mul_f32 v158, v158, v196
    v_mul_f32 v159, v159, v196
    v_mul_f32 v193, v193, v196
    v_cvt_pk_bf16_f32 v170, v156, v157
    v_cvt_pk_bf16_f32 v171, v158, v159
    s_lshl_b32 s18, s16, 18
    s_lshl_b32 s19, s17, 12
    s_add_u32 s18, s18, s19
    s_add_u32 s18, s18, 50331648
    s_add_u32 s19, s18, 131072
    v_mul_f32 v40, v40, v192
    v_mul_f32 v41, v41, v192
    v_mul_f32 v42, v42, v192
    v_mul_f32 v43, v43, v192
    v_mul_f32 v44, v44, v192
    v_mul_f32 v45, v45, v192
    v_mul_f32 v46, v46, v192
    v_mul_f32 v47, v47, v192
    v_mfma_f32_16x16x16_bf16 v[40:43], v[120:121], v[164:165], v[40:43]
    v_mfma_f32_16x16x16_bf16 v[44:47], v[122:123], v[164:165], v[44:47]
    v_mul_f32 v48, v48, v193
    v_mul_f32 v49, v49, v193
    v_mul_f32 v50, v50, v193
    v_mul_f32 v51, v51, v193
    v_mul_f32 v52, v52, v193
    v_mul_f32 v53, v53, v193
    v_mul_f32 v54, v54, v193
    v_mul_f32 v55, v55, v193
    v_mfma_f32_16x16x16_bf16 v[48:51], v[120:121], v[170:171], v[48:51]
    v_mfma_f32_16x16x16_bf16 v[52:55], v[122:123], v[170:171], v[52:55]
    v_cvt_pk_bf16_f32 v40, v40, v41
    v_cvt_pk_bf16_f32 v41, v42, v43
    v_cvt_pk_bf16_f32 v42, v44, v45
    v_cvt_pk_bf16_f32 v43, v46, v47
    buffer_store_dwordx4 v[40:43], v1, s[4:7], s18 offen offset:0 sc1
    v_mul_f32 v56, v56, v192
    v_mul_f32 v57, v57, v192
    v_mul_f32 v58, v58, v192
    v_mul_f32 v59, v59, v192
    v_mul_f32 v60, v60, v192
    v_mul_f32 v61, v61, v192
    v_mul_f32 v62, v62, v192
    v_mul_f32 v63, v63, v192
    v_mfma_f32_16x16x16_bf16 v[56:59], v[124:125], v[164:165], v[56:59]
    v_mfma_f32_16x16x16_bf16 v[60:63], v[126:127], v[164:165], v[60:63]
    v_cvt_pk_bf16_f32 v48, v48, v49
    v_cvt_pk_bf16_f32 v49, v50, v51
    v_cvt_pk_bf16_f32 v50, v52, v53
    v_cvt_pk_bf16_f32 v51, v54, v55
    buffer_store_dwordx4 v[48:51], v1, s[4:7], s19 offen offset:0 sc1
    v_mul_f32 v64, v64, v193
    v_mul_f32 v65, v65, v193
    v_mul_f32 v66, v66, v193
    v_mul_f32 v67, v67, v193
    v_mul_f32 v68, v68, v193
    v_mul_f32 v69, v69, v193
    v_mul_f32 v70, v70, v193
    v_mul_f32 v71, v71, v193
    v_mfma_f32_16x16x16_bf16 v[64:67], v[124:125], v[170:171], v[64:67]
    v_mfma_f32_16x16x16_bf16 v[68:71], v[126:127], v[170:171], v[68:71]
    v_cvt_pk_bf16_f32 v56, v56, v57
    v_cvt_pk_bf16_f32 v57, v58, v59
    v_cvt_pk_bf16_f32 v58, v60, v61
    v_cvt_pk_bf16_f32 v59, v62, v63
    buffer_store_dwordx4 v[56:59], v1, s[4:7], s18 offen offset:1024 sc1
    v_mul_f32 v200, v200, v192
    v_mul_f32 v201, v201, v192
    v_mul_f32 v202, v202, v192
    v_mul_f32 v203, v203, v192
    v_mul_f32 v204, v204, v192
    v_mul_f32 v205, v205, v192
    v_mul_f32 v206, v206, v192
    v_mul_f32 v207, v207, v192
    v_mfma_f32_16x16x16_bf16 v[200:203], v[128:129], v[164:165], v[200:203]
    v_mfma_f32_16x16x16_bf16 v[204:207], v[130:131], v[164:165], v[204:207]
    v_cvt_pk_bf16_f32 v64, v64, v65
    v_cvt_pk_bf16_f32 v65, v66, v67
    v_cvt_pk_bf16_f32 v66, v68, v69
    v_cvt_pk_bf16_f32 v67, v70, v71
    buffer_store_dwordx4 v[64:67], v1, s[4:7], s19 offen offset:1024 sc1
    v_mul_f32 v208, v208, v193
    v_mul_f32 v209, v209, v193
    v_mul_f32 v210, v210, v193
    v_mul_f32 v211, v211, v193
    v_mul_f32 v212, v212, v193
    v_mul_f32 v213, v213, v193
    v_mul_f32 v214, v214, v193
    v_mul_f32 v215, v215, v193
    v_mfma_f32_16x16x16_bf16 v[208:211], v[128:129], v[170:171], v[208:211]
    v_mfma_f32_16x16x16_bf16 v[212:215], v[130:131], v[170:171], v[212:215]
    v_cvt_pk_bf16_f32 v200, v200, v201
    v_cvt_pk_bf16_f32 v201, v202, v203
    v_cvt_pk_bf16_f32 v202, v204, v205
    v_cvt_pk_bf16_f32 v203, v206, v207
    buffer_store_dwordx4 v[200:203], v1, s[4:7], s18 offen offset:2048 sc1
    v_mul_f32 v216, v216, v192
    v_mul_f32 v217, v217, v192
    v_mul_f32 v218, v218, v192
    v_mul_f32 v219, v219, v192
    v_mul_f32 v220, v220, v192
    v_mul_f32 v221, v221, v192
    v_mul_f32 v222, v222, v192
    v_mul_f32 v223, v223, v192
    v_mfma_f32_16x16x16_bf16 v[216:219], v[132:133], v[164:165], v[216:219]
    v_mfma_f32_16x16x16_bf16 v[220:223], v[134:135], v[164:165], v[220:223]
    v_cvt_pk_bf16_f32 v208, v208, v209
    v_cvt_pk_bf16_f32 v209, v210, v211
    v_cvt_pk_bf16_f32 v210, v212, v213
    v_cvt_pk_bf16_f32 v211, v214, v215
    buffer_store_dwordx4 v[208:211], v1, s[4:7], s19 offen offset:2048 sc1
    v_mul_f32 v224, v224, v193
    v_mul_f32 v225, v225, v193
    v_mul_f32 v226, v226, v193
    v_mul_f32 v227, v227, v193
    v_mul_f32 v228, v228, v193
    v_mul_f32 v229, v229, v193
    v_mul_f32 v230, v230, v193
    v_mul_f32 v231, v231, v193
    v_mfma_f32_16x16x16_bf16 v[224:227], v[132:133], v[170:171], v[224:227]
    v_mfma_f32_16x16x16_bf16 v[228:231], v[134:135], v[170:171], v[228:231]
    v_cvt_pk_bf16_f32 v216, v216, v217
    v_cvt_pk_bf16_f32 v217, v218, v219
    v_cvt_pk_bf16_f32 v218, v220, v221
    v_cvt_pk_bf16_f32 v219, v222, v223
    buffer_store_dwordx4 v[216:219], v1, s[4:7], s18 offen offset:3072 sc1
    v_cvt_pk_bf16_f32 v224, v224, v225
    v_cvt_pk_bf16_f32 v225, v226, v227
    v_cvt_pk_bf16_f32 v226, v228, v229
    v_cvt_pk_bf16_f32 v227, v230, v231
    buffer_store_dwordx4 v[224:227], v1, s[4:7], s19 offen offset:3072 sc1
    s_lshr_b32 s40, s34, 1
    s_lshl_b32 s40, s40, 7
    s_and_b32 s41, s17, 7
    s_lshl_b32 s41, s41, 2
    s_add_u32 s40, s40, s41
    s_add_u32 s40, s40, 125894656
    v_mov_b32 v250, s95
    s_cmp_ge_u32 s16, 62
    s_cbranch_scc1 L_afl
    s_waitcnt vmcnt(0)
L_afl:
    s_mov_b64 exec, 1
    buffer_store_dword v250, off, s[4:7], s40 sc1
    s_mov_b64 exec, -1
    s_add_u32 s34, s34, 48
    s_cmp_lt_u32 s34, 512
    s_cbranch_scc1 L_att_next
    s_branch L_done
L_op_start:
    s_mov_b32 s16, s33
    s_mov_b32 s33, s34
    v_and_b32 v2, 63, v0
    v_lshlrev_b32 v1, 4, v2
    v_lshrrev_b32 v5, 2, v2
    v_mul_u32_u24 v3, 1152, v5
    v_and_b32 v5, 3, v2
    v_lshl_add_u32 v3, v5, 4, v3
    s_lshl_b32 s21, s32, 12
    v_add_u32 v4, s21, v1
    s_mov_b64 s[12:13], s[58:59]
    s_mov_b32 s14, 4718592
    s_mov_b32 s15, 0x20000
    s_mul_i32 s19, s32, 1179648
    s_lshl_b32 s18, s33, 6
    s_add_u32 s19, s19, s18
    s_add_u32 s18, s19, 0
    s_add_u32 m0, s21, 0
    s_nop 0
    buffer_load_dwordx4 v3, s[12:15], s18 offen lds
    s_add_u32 m0, s21, 1024
    s_add_u32 s18, s18, 18432
    buffer_load_dwordx4 v3, s[12:15], s18 offen lds
    s_add_u32 m0, s21, 2048
    s_add_u32 s18, s18, 18432
    buffer_load_dwordx4 v3, s[12:15], s18 offen lds
    s_add_u32 m0, s21, 3072
    s_add_u32 s18, s18, 18432
    buffer_load_dwordx4 v3, s[12:15], s18 offen lds
    s_add_u32 s18, s19, 73728
    s_add_u32 m0, s21, 16384
    s_nop 0
    buffer_load_dwordx4 v3, s[12:15], s18 offen lds
    s_add_u32 m0, s21, 17408
    s_add_u32 s18, s18, 18432
    buffer_load_dwordx4 v3, s[12:15], s18 offen lds
    s_add_u32 m0, s21, 18432
    s_add_u32 s18, s18, 18432
    buffer_load_dwordx4 v3, s[12:15], s18 offen lds
    s_add_u32 m0, s21, 19456
    s_add_u32 s18, s18, 18432
    buffer_load_dwordx4 v3, s[12:15], s18 offen lds
    s_add_u32 s18, s19, 147456
    s_add_u32 m0, s21, 32768
    s_nop 0
    buffer_load_dwordx4 v3, s[12:15], s18 offen lds
    s_add_u32 m0, s21, 33792
    s_add_u32 s18, s18, 18432
    buffer_load_dwordx4 v3, s[12:15], s18 offen lds
    s_add_u32 m0, s21, 34816
    s_add_u32 s18, s18, 18432
    buffer_load_dwordx4 v3, s[12:15], s18 offen lds
    s_add_u32 m0, s21, 35840
    s_add_u32 s18, s18, 18432
    buffer_load_dwordx4 v3, s[12:15], s18 offen lds
    s_add_u32 s18, s19, 221184
    s_add_u32 m0, s21, 49152
    s_nop 0
    buffer_load_dwordx4 v3, s[12:15], s18 offen lds
    s_add_u32 m0, s21, 50176
    s_add_u32 s18, s18, 18432
    buffer_load_dwordx4 v3, s[12:15], s18 offen lds
    s_add_u32 m0, s21, 51200
    s_add_u32 s18, s18, 18432
    buffer_load_dwordx4 v3, s[12:15], s18 offen lds
    s_add_u32 m0, s21, 52224
    s_add_u32 s18, s18, 18432
    buffer_load_dwordx4 v3, s[12:15], s18 offen lds
    s_add_u32 s18, s19, 294912
    s_add_u32 m0, s21, 65536
    s_nop 0
    buffer_load_dwordx4 v3, s[12:15], s18 offen lds
    s_add_u32 m0, s21, 66560
    s_add_u32 s18, s18, 18432
    buffer_load_dwordx4 v3, s[12:15], s18 offen lds
    s_add_u32 m0, s21, 67584
    s_add_u32 s18, s18, 18432
    buffer_load_dwordx4 v3, s[12:15], s18 offen lds
    s_add_u32 m0, s21, 68608
    s_add_u32 s18, s18, 18432
    buffer_load_dwordx4 v3, s[12:15], s18 offen lds
    s_add_u32 s18, s19, 368640
    s_add_u32 m0, s21, 81920
    s_nop 0
    buffer_load_dwordx4 v3, s[12:15], s18 offen lds
    s_add_u32 m0, s21, 82944
    s_add_u32 s18, s18, 18432
    buffer_load_dwordx4 v3, s[12:15], s18 offen lds
    s_add_u32 m0, s21, 83968
    s_add_u32 s18, s18, 18432
    buffer_load_dwordx4 v3, s[12:15], s18 offen lds
    s_add_u32 m0, s21, 84992
    s_add_u32 s18, s18, 18432
    buffer_load_dwordx4 v3, s[12:15], s18 offen lds
    s_add_u32 s18, s19, 442368
    s_add_u32 m0, s21, 98304
    s_nop 0
    buffer_load_dwordx4 v3, s[12:15], s18 offen lds
    s_add_u32 m0, s21, 99328
    s_add_u32 s18, s18, 18432
    buffer_load_dwordx4 v3, s[12:15], s18 offen lds
    s_add_u32 m0, s21, 100352
    s_add_u32 s18, s18, 18432
    buffer_load_dwordx4 v3, s[12:15], s18 offen lds
    s_add_u32 m0, s21, 101376
    s_add_u32 s18, s18, 18432
    buffer_load_dwordx4 v3, s[12:15], s18 offen lds
    s_add_u32 s18, s19, 516096
    s_add_u32 m0, s21, 114688
    s_nop 0
    buffer_load_dwordx4 v3, s[12:15], s18 offen lds
    s_add_u32 m0, s21, 115712
    s_add_u32 s18, s18, 18432
    buffer_load_dwordx4 v3, s[12:15], s18 offen lds
    s_add_u32 m0, s21, 116736
    s_add_u32 s18, s18, 18432
    buffer_load_dwordx4 v3, s[12:15], s18 offen lds
    s_add_u32 m0, s21, 117760
    s_add_u32 s18, s18, 18432
    buffer_load_dwordx4 v3, s[12:15], s18 offen lds
    s_add_u32 s18, s19, 589824
    s_add_u32 m0, s21, 131072
    s_nop 0
    buffer_load_dwordx4 v3, s[12:15], s18 offen lds
    s_add_u32 m0, s21, 132096
    s_add_u32 s18, s18, 18432
    buffer_load_dwordx4 v3, s[12:15], s18 offen lds
    s_add_u32 m0, s21, 133120
    s_add_u32 s18, s18, 18432
    buffer_load_dwordx4 v3, s[12:15], s18 offen lds
    s_add_u32 m0, s21, 134144
    s_add_u32 s18, s18, 18432
    buffer_load_dwordx4 v3, s[12:15], s18 offen lds
    v_add_u32 v6, 0, v4
    v_xor_b32 v7, 32, v6
    s_waitcnt vmcnt(32)
    ds_read_b64_tr_b16 a[0:1], v6 offset:0
    ds_read_b64_tr_b16 a[2:3], v6 offset:1024
    ds_read_b64_tr_b16 a[4:5], v6 offset:8
    ds_read_b64_tr_b16 a[6:7], v6 offset:1032
    ds_read_b64_tr_b16 a[8:9], v6 offset:2048
    ds_read_b64_tr_b16 a[10:11], v6 offset:3072
    ds_read_b64_tr_b16 a[12:13], v6 offset:2056
    ds_read_b64_tr_b16 a[14:15], v6 offset:3080
    s_waitcnt lgkmcnt(0)
    s_add_u32 s18, s19, 663552
    s_add_u32 m0, s21, 0
    s_nop 0
    buffer_load_dwordx4 v3, s[12:15], s18 offen lds
    s_add_u32 m0, s21, 1024
    s_add_u32 s18, s18, 18432
    buffer_load_dwordx4 v3, s[12:15], s18 offen lds
    s_add_u32 m0, s21, 2048
    s_add_u32 s18, s18, 18432
    buffer_load_dwordx4 v3, s[12:15], s18 offen lds
    s_add_u32 m0, s21, 3072
    s_add_u32 s18, s18, 18432
    buffer_load_dwordx4 v3, s[12:15], s18 offen lds
    v_add_u32 v6, 16384, v4
    v_xor_b32 v7, 32, v6
    s_waitcnt vmcnt(32)
    ds_read_b64_tr_b16 a[16:17], v6 offset:0
    ds_read_b64_tr_b16 a[18:19], v6 offset:1024
    ds_read_b64_tr_b16 a[20:21], v6 offset:8
    ds_read_b64_tr_b16 a[22:23], v6 offset:1032
    ds_read_b64_tr_b16 a[24:25], v6 offset:2048
    ds_read_b64_tr_b16 a[26:27], v6 offset:3072
    ds_read_b64_tr_b16 a[28:29], v6 offset:2056
    ds_read_b64_tr_b16 a[30:31], v6 offset:3080
    s_waitcnt lgkmcnt(0)
    s_add_u32 s18, s19, 737280
    s_add_u32 m0, s21, 16384
    s_nop 0
    buffer_load_dwordx4 v3, s[12:15], s18 offen lds
    s_add_u32 m0, s21, 17408
    s_add_u32 s18, s18, 18432
    buffer_load_dwordx4 v3, s[12:15], s18 offen lds
    s_add_u32 m0, s21, 18432
    s_add_u32 s18, s18, 18432
    buffer_load_dwordx4 v3, s[12:15], s18 offen lds
    s_add_u32 m0, s21, 19456
    s_add_u32 s18, s18, 18432
    buffer_load_dwordx4 v3, s[12:15], s18 offen lds
    v_add_u32 v6, 32768, v4
    v_xor_b32 v7, 32, v6
    s_waitcnt vmcnt(32)
    ds_read_b64_tr_b16 a[32:33], v6 offset:0
    ds_read_b64_tr_b16 a[34:35], v6 offset:1024
    ds_read_b64_tr_b16 a[36:37], v6 offset:8
    ds_read_b64_tr_b16 a[38:39], v6 offset:1032
    ds_read_b64_tr_b16 a[40:41], v6 offset:2048
    ds_read_b64_tr_b16 a[42:43], v6 offset:3072
    ds_read_b64_tr_b16 a[44:45], v6 offset:2056
    ds_read_b64_tr_b16 a[46:47], v6 offset:3080
    s_waitcnt lgkmcnt(0)
    s_add_u32 s18, s19, 811008
    s_add_u32 m0, s21, 32768
    s_nop 0
    buffer_load_dwordx4 v3, s[12:15], s18 offen lds
    s_add_u32 m0, s21, 33792
    s_add_u32 s18, s18, 18432
    buffer_load_dwordx4 v3, s[12:15], s18 offen lds
    s_add_u32 m0, s21, 34816
    s_add_u32 s18, s18, 18432
    buffer_load_dwordx4 v3, s[12:15], s18 offen lds
    s_add_u32 m0, s21, 35840
    s_add_u32 s18, s18, 18432
    buffer_load_dwordx4 v3, s[12:15], s18 offen lds
    v_add_u32 v6, 49152, v4
    v_xor_b32 v7, 32, v6
    s_waitcnt vmcnt(32)
    ds_read_b64_tr_b16 a[48:49], v6 offset:0
    ds_read_b64_tr_b16 a[50:51], v6 offset:1024
    ds_read_b64_tr_b16 a[52:53], v6 offset:8
    ds_read_b64_tr_b16 a[54:55], v6 offset:1032
    ds_read_b64_tr_b16 a[56:57], v6 offset:2048
    ds_read_b64_tr_b16 a[58:59], v6 offset:3072
    ds_read_b64_tr_b16 a[60:61], v6 offset:2056
    ds_read_b64_tr_b16 a[62:63], v6 offset:3080
    s_waitcnt lgkmcnt(0)
    s_add_u32 s18, s19, 884736
    s_add_u32 m0, s21, 49152
    s_nop 0
    buffer_load_dwordx4 v3, s[12:15], s18 offen lds
    s_add_u32 m0, s21, 50176
    s_add_u32 s18, s18, 18432
    buffer_load_dwordx4 v3, s[12:15], s18 offen lds
    s_add_u32 m0, s21, 51200
    s_add_u32 s18, s18, 18432
    buffer_load_dwordx4 v3, s[12:15], s18 offen lds
    s_add_u32 m0, s21, 52224
    s_add_u32 s18, s18, 18432
    buffer_load_dwordx4 v3, s[12:15], s18 offen lds
    v_add_u32 v6, 65536, v4
    v_xor_b32 v7, 32, v6
    s_waitcnt vmcnt(32)
    ds_read_b64_tr_b16 a[64:65], v6 offset:0
    ds_read_b64_tr_b16 a[66:67], v6 offset:1024
    ds_read_b64_tr_b16 a[68:69], v6 offset:8
    ds_read_b64_tr_b16 a[70:71], v6 offset:1032
    ds_read_b64_tr_b16 a[72:73], v6 offset:2048
    ds_read_b64_tr_b16 a[74:75], v6 offset:3072
    ds_read_b64_tr_b16 a[76:77], v6 offset:2056
    ds_read_b64_tr_b16 a[78:79], v6 offset:3080
    s_waitcnt lgkmcnt(0)
    s_add_u32 s18, s19, 958464
    s_add_u32 m0, s21, 65536
    s_nop 0
    buffer_load_dwordx4 v3, s[12:15], s18 offen lds
    s_add_u32 m0, s21, 66560
    s_add_u32 s18, s18, 18432
    buffer_load_dwordx4 v3, s[12:15], s18 offen lds
    s_add_u32 m0, s21, 67584
    s_add_u32 s18, s18, 18432
    buffer_load_dwordx4 v3, s[12:15], s18 offen lds
    s_add_u32 m0, s21, 68608
    s_add_u32 s18, s18, 18432
    buffer_load_dwordx4 v3, s[12:15], s18 offen lds
    v_add_u32 v6, 81920, v4
    v_xor_b32 v7, 32, v6
    s_waitcnt vmcnt(32)
    ds_read_b64_tr_b16 a[80:81], v6 offset:0
    ds_read_b64_tr_b16 a[82:83], v6 offset:1024
    ds_read_b64_tr_b16 a[84:85], v6 offset:8
    ds_read_b64_tr_b16 a[86:87], v6 offset:1032
    ds_read_b64_tr_b16 a[88:89], v6 offset:2048
    ds_read_b64_tr_b16 a[90:91], v6 offset:3072
    ds_read_b64_tr_b16 a[92:93], v6 offset:2056
    ds_read_b64_tr_b16 a[94:95], v6 offset:3080
    s_waitcnt lgkmcnt(0)
    s_add_u32 s18, s19, 1032192
    s_add_u32 m0, s21, 81920
    s_nop 0
    buffer_load_dwordx4 v3, s[12:15], s18 offen lds
    s_add_u32 m0, s21, 82944
    s_add_u32 s18, s18, 18432
    buffer_load_dwordx4 v3, s[12:15], s18 offen lds
    s_add_u32 m0, s21, 83968
    s_add_u32 s18, s18, 18432
    buffer_load_dwordx4 v3, s[12:15], s18 offen lds
    s_add_u32 m0, s21, 84992
    s_add_u32 s18, s18, 18432
    buffer_load_dwordx4 v3, s[12:15], s18 offen lds
    v_add_u32 v6, 98304, v4
    v_xor_b32 v7, 32, v6
    s_waitcnt vmcnt(32)
    ds_read_b64_tr_b16 a[96:97], v6 offset:0
    ds_read_b64_tr_b16 a[98:99], v6 offset:1024
    ds_read_b64_tr_b16 a[100:101], v6 offset:8
    ds_read_b64_tr_b16 a[102:103], v6 offset:1032
    ds_read_b64_tr_b16 a[104:105], v6 offset:2048
    ds_read_b64_tr_b16 a[106:107], v6 offset:3072
    ds_read_b64_tr_b16 a[108:109], v6 offset:2056
    ds_read_b64_tr_b16 a[110:111], v6 offset:3080
    s_waitcnt lgkmcnt(0)
    s_add_u32 s18, s19, 1105920
    s_add_u32 m0, s21, 98304
    s_nop 0
    buffer_load_dwordx4 v3, s[12:15], s18 offen lds
    s_add_u32 m0, s21, 99328
    s_add_u32 s18, s18, 18432
    buffer_load_dwordx4 v3, s[12:15], s18 offen lds
    s_add_u32 m0, s21, 100352
    s_add_u32 s18, s18, 18432
    buffer_load_dwordx4 v3, s[12:15], s18 offen lds
    s_add_u32 m0, s21, 101376
    s_add_u32 s18, s18, 18432
    buffer_load_dwordx4 v3, s[12:15], s18 offen lds
    v_add_u32 v6, 114688, v4
    v_xor_b32 v7, 32, v6
    s_waitcnt vmcnt(32)
    ds_read_b64_tr_b16 a[112:113], v6 offset:0
    ds_read_b64_tr_b16 a[114:115], v6 offset:1024
    ds_read_b64_tr_b16 a[116:117], v6 offset:8
    ds_read_b64_tr_b16 a[118:119], v6 offset:1032
    ds_read_b64_tr_b16 a[120:121], v6 offset:2048
    ds_read_b64_tr_b16 a[122:123], v6 offset:3072
    ds_read_b64_tr_b16 a[124:125], v6 offset:2056
    ds_read_b64_tr_b16 a[126:127], v6 offset:3080
    s_waitcnt lgkmcnt(0)
    v_add_u32 v6, 131072, v4
    v_xor_b32 v7, 32, v6
    s_waitcnt vmcnt(28)
    ds_read_b64_tr_b16 a[128:129], v6 offset:0
    ds_read_b64_tr_b16 a[130:131], v6 offset:1024
    ds_read_b64_tr_b16 a[132:133], v6 offset:8
    ds_read_b64_tr_b16 a[134:135], v6 offset:1032
    ds_read_b64_tr_b16 a[136:137], v6 offset:2048
    ds_read_b64_tr_b16 a[138:139], v6 offset:3072
    ds_read_b64_tr_b16 a[140:141], v6 offset:2056
    ds_read_b64_tr_b16 a[142:143], v6 offset:3080
    s_waitcnt lgkmcnt(0)
    v_add_u32 v6, 0, v4
    v_xor_b32 v7, 32, v6
    s_waitcnt vmcnt(24)
    ds_read_b64_tr_b16 a[144:145], v6 offset:0
    ds_read_b64_tr_b16 a[146:147], v6 offset:1024
    ds_read_b64_tr_b16 a[148:149], v6 offset:8
    ds_read_b64_tr_b16 a[150:151], v6 offset:1032
    ds_read_b64_tr_b16 a[152:153], v6 offset:2048
    ds_read_b64_tr_b16 a[154:155], v6 offset:3072
    ds_read_b64_tr_b16 a[156:157], v6 offset:2056
    ds_read_b64_tr_b16 a[158:159], v6 offset:3080
    s_waitcnt lgkmcnt(0)
    v_add_u32 v6, 16384, v4
    v_xor_b32 v7, 32, v6
    s_waitcnt vmcnt(20)
    ds_read_b64_tr_b16 a[160:161], v6 offset:0
    ds_read_b64_tr_b16 a[162:163], v6 offset:1024
    ds_read_b64_tr_b16 a[164:165], v6 offset:8
    ds_read_b64_tr_b16 a[166:167], v6 offset:1032
    ds_read_b64_tr_b16 a[168:169], v6 offset:2048
    ds_read_b64_tr_b16 a[170:171], v6 offset:3072
    ds_read_b64_tr_b16 a[172:173], v6 offset:2056
    ds_read_b64_tr_b16 a[174:175], v6 offset:3080
    s_waitcnt lgkmcnt(0)
    v_add_u32 v6, 32768, v4
    v_xor_b32 v7, 32, v6
    s_waitcnt vmcnt(16)
    ds_read_b64_tr_b16 a[176:177], v6 offset:0
    ds_read_b64_tr_b16 a[178:179], v6 offset:1024
    ds_read_b64_tr_b16 a[180:181], v6 offset:8
    ds_read_b64_tr_b16 a[182:183], v6 offset:1032
    ds_read_b64_tr_b16 a[184:185], v6 offset:2048
    ds_read_b64_tr_b16 a[186:187], v6 offset:3072
    ds_read_b64_tr_b16 a[188:189], v6 offset:2056
    ds_read_b64_tr_b16 a[190:191], v6 offset:3080
    s_waitcnt lgkmcnt(0)
    v_add_u32 v6, 49152, v4
    v_xor_b32 v7, 32, v6
    s_waitcnt vmcnt(12)
    ds_read_b64_tr_b16 a[192:193], v6 offset:0
    ds_read_b64_tr_b16 a[194:195], v6 offset:1024
    ds_read_b64_tr_b16 a[196:197], v6 offset:8
    ds_read_b64_tr_b16 a[198:199], v6 offset:1032
    ds_read_b64_tr_b16 a[200:201], v6 offset:2048
    ds_read_b64_tr_b16 a[202:203], v6 offset:3072
    ds_read_b64_tr_b16 a[204:205], v6 offset:2056
    ds_read_b64_tr_b16 a[206:207], v6 offset:3080
    s_waitcnt lgkmcnt(0)
    v_add_u32 v6, 65536, v4
    v_xor_b32 v7, 32, v6
    s_waitcnt vmcnt(8)
    ds_read_b64_tr_b16 a[208:209], v6 offset:0
    ds_read_b64_tr_b16 a[210:211], v6 offset:1024
    ds_read_b64_tr_b16 a[212:213], v6 offset:8
    ds_read_b64_tr_b16 a[214:215], v6 offset:1032
    ds_read_b64_tr_b16 a[216:217], v6 offset:2048
    ds_read_b64_tr_b16 a[218:219], v6 offset:3072
    ds_read_b64_tr_b16 a[220:221], v6 offset:2056
    ds_read_b64_tr_b16 a[222:223], v6 offset:3080
    s_waitcnt lgkmcnt(0)
    v_add_u32 v6, 81920, v4
    v_xor_b32 v7, 32, v6
    s_waitcnt vmcnt(4)
    ds_read_b64_tr_b16 a[224:225], v6 offset:0
    ds_read_b64_tr_b16 a[226:227], v6 offset:1024
    ds_read_b64_tr_b16 a[228:229], v6 offset:8
    ds_read_b64_tr_b16 a[230:231], v6 offset:1032
    ds_read_b64_tr_b16 a[232:233], v6 offset:2048
    ds_read_b64_tr_b16 a[234:235], v6 offset:3072
    ds_read_b64_tr_b16 a[236:237], v6 offset:2056
    ds_read_b64_tr_b16 a[238:239], v6 offset:3080
    s_waitcnt lgkmcnt(0)
    v_add_u32 v6, 98304, v4
    v_xor_b32 v7, 32, v6
    s_waitcnt vmcnt(0)
    ds_read_b64_tr_b16 a[240:241], v6 offset:0
    ds_read_b64_tr_b16 a[242:243], v6 offset:1024
    ds_read_b64_tr_b16 a[244:245], v6 offset:8
    ds_read_b64_tr_b16 a[246:247], v6 offset:1032
    ds_read_b64_tr_b16 a[248:249], v6 offset:2048
    ds_read_b64_tr_b16 a[250:251], v6 offset:3072
    ds_read_b64_tr_b16 a[252:253], v6 offset:2056
    ds_read_b64_tr_b16 a[254:255], v6 offset:3080
    s_waitcnt lgkmcnt(0)
    s_barrier
    s_mov_b32 s35, s16
L_op_seg:
    s_sub_u32 s40, s35, 126
    s_lshr_b32 s41, s40, 1
    s_add_u32 s41, s41, 126
    s_and_b32 s40, s40, 1
    s_lshl_b32 s40, s40, 3
    s_lshl_b32 s44, 0x00ff00ff, s40
    s_cmp_ge_u32 s35, 999
    s_cselect_b32 s16, s41, s35
    s_cselect_b32 s44, s44, -1
    s_mov_b32 s45, s44
    s_lshr_b32 s43, s16, 1
    s_add_u32 s43, s43, 1
    s_min_u32 s43, s43, 63
    s_and_b32 s36, s33, 15
    s_lshl_b32 s36, s36, 8
    s_add_u32 s36, s36, 125829120
    s_lshl_b32 s94, s33, 7
    s_add_u32 s94, s94, s16
    s_cmp_ge_u32 s16, 120
    s_cbranch_scc1 L_nocw
    s_mov_b32 s88, 65536
cw16:
    buffer_load_dword v3, off, s[4:7], s36 offset:128 sc1
    s_waitcnt vmcnt(0)
    v_readfirstlane_b32 s42, v3
    s_nop 0
    s_sub_u32 s42, s42, s95
    s_cmp_gt_u32 s42, 64
    s_cselect_b32 s42, 0, s42
    s_add_u32 s42, s42, 2
    s_cmp_ge_u32 s42, s43
    s_cbranch_scc1 cw16x
    s_sub_u32 s88, s88, 1
    s_cbranch_scc1 cw16x
    s_sub_u32 s42, s43, s42
    s_min_u32 s42, s42, 6
cw16s:
    s_sleep 24
    s_sub_u32 s42, s42, 1
    s_cmp_lg_u32 s42, 0
    s_cbranch_scc1 cw16s
    s_branch cw16
cw16x:
L_nocw:
    s_lshr_b32 s89, s16, 1
    s_lshl_b32 s89, s89, 2
    s_add_u32 s89, s89, s32
    s_lshl_b32 s89, s89, 7
    s_add_u32 s89, s89, 125894656
    v_mbcnt_lo_u32_b32 v2, -1, 0
    v_mbcnt_hi_u32_b32 v2, -1, v2
    v_min_u32 v2, 7, v2
    v_lshlrev_b32 v2, 2, v2
    s_mov_b32 s88, 4194304
fw17:
    buffer_load_dword v3, v2, s[4:7], s89 offen offset:0 sc1
    s_sub_u32 s88, s88, 1
    s_cbranch_scc1 fw17x
    s_waitcnt vmcnt(0)
    v_cmp_ne_u32 vcc, s95, v3
    s_cbranch_vccz fw17x
    s_sleep 2
    s_cmp_gt_u32 s88, 4194256
    s_cbranch_scc1 fw17
    s_sleep 40
    s_branch fw17
fw17x:
    s_mov_b32 s21, 4096
os_again:
    s_lshl_b32 s18, s16, 17
    s_lshl_b32 s19, s32, 15
    s_add_u32 s18, s18, s19
    s_add_u32 s18, s18, 50331648
    s_mov_b64 exec, s[44:45]
    buffer_load_dwordx4 v[32:35], v1, s[4:7], s18 offen offset:0 sc1
    buffer_load_dwordx4 v[36:39], v1, s[4:7], s18 offen offset:1024 sc1
    buffer_load_dwordx4 v[40:43], v1, s[4:7], s18 offen offset:2048 sc1
    buffer_load_dwordx4 v[44:47], v1, s[4:7], s18 offen offset:3072 sc1
    s_add_u32 s18, s18, 4096
    buffer_load_dwordx4 v[48:51], v1, s[4:7], s18 offen offset:0 sc1
    buffer_load_dwordx4 v[52:55], v1, s[4:7], s18 offen offset:1024 sc1
    buffer_load_dwordx4 v[56:59], v1, s[4:7], s18 offen offset:2048 sc1
    buffer_load_dwordx4 v[60:63], v1, s[4:7], s18 offen offset:3072 sc1
    s_add_u32 s18, s18, 4096
    buffer_load_dwordx4 v[64:67], v1, s[4:7], s18 offen offset:0 sc1
    buffer_load_dwordx4 v[68:71], v1, s[4:7], s18 offen offset:1024 sc1
    buffer_load_dwordx4 v[72:75], v1, s[4:7], s18 offen offset:2048 sc1
    buffer_load_dwordx4 v[76:79], v1, s[4:7], s18 offen offset:3072 sc1
    s_add_u32 s18, s18, 4096
    buffer_load_dwordx4 v[80:83], v1, s[4:7], s18 offen offset:0 sc1
    buffer_load_dwordx4 v[84:87], v1, s[4:7], s18 offen offset:1024 sc1
    buffer_load_dwordx4 v[88:91], v1, s[4:7], s18 offen offset:2048 sc1
    buffer_load_dwordx4 v[92:95], v1, s[4:7], s18 offen offset:3072 sc1
    s_add_u32 s18, s18, 4096
    buffer_load_dwordx4 v[96:99], v1, s[4:7], s18 offen offset:0 sc1
    buffer_load_dwordx4 v[100:103], v1, s[4:7], s18 offen offset:1024 sc1
    buffer_load_dwordx4 v[104:107], v1, s[4:7], s18 offen offset:2048 sc1
    buffer_load_dwordx4 v[108:111], v1, s[4:7], s18 offen offset:3072 sc1
    s_add_u32 s18, s18, 4096
    buffer_load_dwordx4 v[112:115], v1, s[4:7], s18 offen offset:0 sc1
    buffer_load_dwordx4 v[116:119], v1, s[4:7], s18 offen offset:1024 sc1
    buffer_load_dwordx4 v[120:123], v1, s[4:7], s18 offen offset:2048 sc1
    buffer_load_dwordx4 v[124:127], v1, s[4:7], s18 offen offset:3072 sc1
    s_add_u32 s18, s18, 4096
    buffer_load_dwordx4 v[128:131], v1, s[4:7], s18 offen offset:0 sc1
    buffer_load_dwordx4 v[132:135], v1, s[4:7], s18 offen offset:1024 sc1
    buffer_load_dwordx4 v[136:139], v1, s[4:7], s18 offen offset:2048 sc1
    buffer_load_dwordx4 v[140:143], v1, s[4:7], s18 offen offset:3072 sc1
    s_add_u32 s18, s18, 4096
    buffer_load_dwordx4 v[144:147], v1, s[4:7], s18 offen offset:0 sc1
    buffer_load_dwordx4 v[148:151], v1, s[4:7], s18 offen offset:1024 sc1
    buffer_load_dwordx4 v[152:155], v1, s[4:7], s18 offen offset:2048 sc1
    buffer_load_dwordx4 v[156:159], v1, s[4:7], s18 offen offset:3072 sc1
    s_mov_b64 exec, -1
    v_lshlrev_b32 v2, 4, v0
    v_and_b32 v3, 3072, v2
    v_lshl_add_u32 v2, v3, 1, v1
    s_waitcnt vmcnt(31)
    v_mfma_f32_16x16x32_bf16 v[8:11], a[0:3], v[32:35], 0
    v_mfma_f32_16x16x32_bf16 v[12:15], a[4:7], v[32:35], 0
    v_mov_b32 v4, v32
    s_waitcnt vmcnt(30)
    v_mfma_f32_16x16x32_bf16 v[8:11], a[8:11], v[36:39], v[8:11]
    v_mfma_f32_16x16x32_bf16 v[12:15], a[12:15], v[36:39], v[12:15]
    v_max_u32 v4, v4, v36
    s_waitcnt vmcnt(29)
    v_mfma_f32_16x16x32_bf16 v[8:11], a[16:19], v[40:43], v[8:11]
    v_mfma_f32_16x16x32_bf16 v[12:15], a[20:23], v[40:43], v[12:15]
    v_max_u32 v4, v4, v40
    s_waitcnt vmcnt(28)
    v_mfma_f32_16x16x32_bf16 v[8:11], a[24:27], v[44:47], v[8:11]
    v_mfma_f32_16x16x32_bf16 v[12:15], a[28:31], v[44:47], v[12:15]
    v_max_u32 v4, v4, v44
    s_waitcnt vmcnt(27)
    v_mfma_f32_16x16x32_bf16 v[8:11], a[32:35], v[48:51], v[8:11]
    v_mfma_f32_16x16x32_bf16 v[12:15], a[36:39], v[48:51], v[12:15]
    v_max_u32 v4, v4, v48
    s_waitcnt vmcnt(26)
    v_mfma_f32_16x16x32_bf16 v[8:11], a[40:43], v[52:55], v[8:11]
    v_mfma_f32_16x16x32_bf16 v[12:15], a[44:47], v[52:55], v[12:15]
    v_max_u32 v4, v4, v52
    s_waitcnt vmcnt(25)
    v_mfma_f32_16x16x32_bf16 v[8:11], a[48:51], v[56:59], v[8:11]
    v_mfma_f32_16x16x32_bf16 v[12:15], a[52:55], v[56:59], v[12:15]
    v_max_u32 v4, v4, v56
    s_waitcnt vmcnt(24)
    v_mfma_f32_16x16x32_bf16 v[8:11], a[56:59], v[60:63], v[8:11]
    v_mfma_f32_16x16x32_bf16 v[12:15], a[60:63], v[60:63], v[12:15]
    v_max_u32 v4, v4, v60
    s_waitcnt vmcnt(23)
    v_mfma_f32_16x16x32_bf16 v[8:11], a[64:67], v[64:67], v[8:11]
    v_mfma_f32_16x16x32_bf16 v[12:15], a[68:71], v[64:67], v[12:15]
    v_max_u32 v4, v4, v64
    s_waitcnt vmcnt(22)
    v_mfma_f32_16x16x32_bf16 v[8:11], a[72:75], v[68:71], v[8:11]
    v_mfma_f32_16x16x32_bf16 v[12:15], a[76:79], v[68:71], v[12:15]
    v_max_u32 v4, v4, v68
    s_waitcnt vmcnt(21)
    v_mfma_f32_16x16x32_bf16 v[8:11], a[80:83], v[72:75], v[8:11]
    v_mfma_f32_16x16x32_bf16 v[12:15], a[84:87], v[72:75], v[12:15]
    v_max_u32 v4, v4, v72
    s_waitcnt vmcnt(20)
    v_mfma_f32_16x16x32_bf16 v[8:11], a[88:91], v[76:79], v[8:11]
    v_mfma_f32_16x16x32_bf16 v[12:15], a[92:95], v[76:79], v[12:15]
    v_max_u32 v4, v4, v76
    s_waitcnt vmcnt(19)
    v_mfma_f32_16x16x32_bf16 v[8:11], a[96:99], v[80:83], v[8:11]
    v_mfma_f32_16x16x32_bf16 v[12:15], a[100:103], v[80:83], v[12:15]
    v_max_u32 v4, v4, v80
    s_waitcnt vmcnt(18)
    v_mfma_f32_16x16x32_bf16 v[8:11], a[104:107], v[84:87], v[8:11]
    v_mfma_f32_16x16x32_bf16 v[12:15], a[108:111], v[84:87], v[12:15]
    v_max_u32 v4, v4, v84
    s_waitcnt vmcnt(17)
    v_mfma_f32_16x16x32_bf16 v[8:11], a[112:115], v[88:91], v[8:11]
    v_mfma_f32_16x16x32_bf16 v[12:15], a[116:119], v[88:91], v[12:15]
    v_max_u32 v4, v4, v88
    s_waitcnt vmcnt(16)
    v_mfma_f32_16x16x32_bf16 v[8:11], a[120:123], v[92:95], v[8:11]
    v_mfma_f32_16x16x32_bf16 v[12:15], a[124:127], v[92:95], v[12:15]
    v_max_u32 v4, v4, v92
    s_waitcnt vmcnt(15)
    v_mfma_f32_16x16x32_bf16 v[8:11], a[128:131], v[96:99], v[8:11]
    v_mfma_f32_16x16x32_bf16 v[12:15], a[132:135], v[96:99], v[12:15]
    v_max_u32 v4, v4, v96
    s_waitcnt vmcnt(14)
    v_mfma_f32_16x16x32_bf16 v[8:11], a[136:139], v[100:103], v[8:11]
    v_mfma_f32_16x16x32_bf16 v[12:15], a[140:143], v[100:103], v[12:15]
    v_max_u32 v4, v4, v100
    s_waitcnt vmcnt(13)
    v_mfma_f32_16x16x32_bf16 v[8:11], a[144:147], v[104:107], v[8:11]
    v_mfma_f32_16x16x32_bf16 v[12:15], a[148:151], v[104:107], v[12:15]
    v_max_u32 v4, v4, v104
    s_waitcnt vmcnt(12)
    v_mfma_f32_16x16x32_bf16 v[8:11], a[152:155], v[108:111], v[8:11]
    v_mfma_f32_16x16x32_bf16 v[12:15], a[156:159], v[108:111], v[12:15]
    v_max_u32 v4, v4, v108
    s_waitcnt vmcnt(11)
    v_mfma_f32_16x16x32_bf16 v[8:11], a[160:163], v[112:115], v[8:11]
    v_mfma_f32_16x16x32_bf16 v[12:15], a[164:167], v[112:115], v[12:15]
    v_max_u32 v4, v4, v112
    s_waitcnt vmcnt(10)
    v_mfma_f32_16x16x32_bf16 v[8:11], a[168:171], v[116:119], v[8:11]
    v_mfma_f32_16x16x32_bf16 v[12:15], a[172:175], v[116:119], v[12:15]
    v_max_u32 v4, v4, v116
    s_waitcnt vmcnt(9)
    v_mfma_f32_16x16x32_bf16 v[8:11], a[176:179], v[120:123], v[8:11]
    v_mfma_f32_16x16x32_bf16 v[12:15], a[180:183], v[120:123], v[12:15]
    v_max_u32 v4, v4, v120
    s_waitcnt vmcnt(8)
    v_mfma_f32_16x16x32_bf16 v[8:11], a[184:187], v[124:127], v[8:11]
    v_mfma_f32_16x16x32_bf16 v[12:15], a[188:191], v[124:127], v[12:15]
    v_max_u32 v4, v4, v124
    s_waitcnt vmcnt(7)
    v_mfma_f32_16x16x32_bf16 v[8:11], a[192:195], v[128:131], v[8:11]
    v_mfma_f32_16x16x32_bf16 v[12:15], a[196:199], v[128:131], v[12:15]
    v_max_u32 v4, v4, v128
    s_waitcnt vmcnt(6)
    v_mfma_f32_16x16x32_bf16 v[8:11], a[200:203], v[132:135], v[8:11]
    v_mfma_f32_16x16x32_bf16 v[12:15], a[204:207], v[132:135], v[12:15]
    v_max_u32 v4, v4, v132
    s_waitcnt vmcnt(5)
    v_mfma_f32_16x16x32_bf16 v[8:11], a[208:211], v[136:139], v[8:11]
    v_mfma_f32_16x16x32_bf16 v[12:15], a[212:215], v[136:139], v[12:15]
    v_max_u32 v4, v4, v136
    s_waitcnt vmcnt(4)
    v_mfma_f32_16x16x32_bf16 v[8:11], a[216:219], v[140:143], v[8:11]
    v_mfma_f32_16x16x32_bf16 v[12:15], a[220:223], v[140:143], v[12:15]
    v_max_u32 v4, v4, v140
    s_waitcnt vmcnt(3)
    v_mfma_f32_16x16x32_bf16 v[8:11], a[224:227], v[144:147], v[8:11]
    v_mfma_f32_16x16x32_bf16 v[12:15], a[228:231], v[144:147], v[12:15]
    v_max_u32 v4, v4, v144
    s_waitcnt vmcnt(2)
    v_mfma_f32_16x16x32_bf16 v[8:11], a[232:235], v[148:151], v[8:11]
    v_mfma_f32_16x16x32_bf16 v[12:15], a[236:239], v[148:151], v[12:15]
    v_max_u32 v4, v4, v148
    s_waitcnt vmcnt(1)
    v_mfma_f32_16x16x32_bf16 v[8:11], a[240:243], v[152:155], v[8:11]
    v_mfma_f32_16x16x32_bf16 v[12:15], a[244:247], v[152:155], v[12:15]
    v_max_u32 v4, v4, v152
    s_waitcnt vmcnt(0)
    v_mfma_f32_16x16x32_bf16 v[8:11], a[248:251], v[156:159], v[8:11]
    v_mfma_f32_16x16x32_bf16 v[12:15], a[252:255], v[156:159], v[12:15]
    v_max_u32 v4, v4, v156
    v_cmp_eq_u32 vcc, -1, v4
    s_nop 0
    s_and_b64 vcc, vcc, s[44:45]
    s_sub_u32 s21, s21, 1
    s_nop 1
    s_cbranch_scc1 os_ok
    s_cbranch_vccnz os_again
os_ok:
    ds_write_b128 v2, v[8:11] offset:0
    ds_write_b128 v2, v[12:15] offset:1024
    s_waitcnt lgkmcnt(0)
    s_barrier
    s_cmp_lg_u32 s32, 0
    s_cbranch_scc1 os_skip
    ds_read_b128 v[40:43], v1 offset:2048
    ds_read_b128 v[44:47], v1 offset:3072
    ds_read_b128 v[48:51], v1 offset:4096
    ds_read_b128 v[52:55], v1 offset:5120
    ds_read_b128 v[56:59], v1 offset:6144
    ds_read_b128 v[60:63], v1 offset:7168
    v_lshrrev_b32 v3, 4, v1
    v_bfe_u32 v4, v3, 2, 2
    v_lshlrev_b32 v4, 3, v4
    v_and_b32 v2, 3, v3
    v_add_u32 v4, v4, v2
    v_mul_u32_u24 v4, 2304, v4
    v_lshrrev_b32 v3, 4, v3
    v_lshl_add_u32 v4, v3, 4, v4
    s_lshr_b32 s18, s16, 1
    s_lshl_b32 s18, s18, 3
    s_and_b32 s19, s16, 1
    s_add_u32 s18, s18, s19
    s_mul_i32 s18, s18, 9216
    s_lshl_b32 s19, s33, 6
    s_add_u32 s18, s18, s19
    s_waitcnt lgkmcnt(0)
    v_pk_add_f32 v[8:9], v[8:9], v[40:41]
    v_pk_add_f32 v[48:49], v[48:49], v[56:57]
    v_pk_add_f32 v[8:9], v[8:9], v[48:49]
    v_pk_add_f32 v[10:11], v[10:11], v[42:43]
    v_pk_add_f32 v[50:51], v[50:51], v[58:59]
    v_pk_add_f32 v[10:11], v[10:11], v[50:51]
    v_pk_add_f32 v[12:13], v[12:13], v[44:45]
    v_pk_add_f32 v[52:53], v[52:53], v[60:61]
    v_pk_add_f32 v[12:13], v[12:13], v[52:53]
    v_pk_add_f32 v[14:15], v[14:15], v[46:47]
    v_pk_add_f32 v[54:55], v[54:55], v[62:63]
    v_pk_add_f32 v[14:15], v[14:15], v[54:55]
    v_cvt_pk_bf16_f32 v32, v8, v9
    v_cvt_pk_bf16_f32 v33, v10, v11
    v_cvt_pk_bf16_f32 v34, v12, v13
    v_cvt_pk_bf16_f32 v35, v14, v15
    s_mov_b64 exec, s[44:45]
    buffer_store_dwordx4 v[32:35], v4, s[8:11], s18 offen sc1
    s_mov_b64 exec, -1
os_skip:
    s_nop 0
    s_add_u32 s35, s35, 6
    s_cmp_ge_u32 s35, 128
    s_cbranch_scc1 L_done
    s_barrier
    s_branch L_op_seg
L_done:
L_exit:
    s_endpgm
.section .rodata,"a"
.p2align 6
.amdhsa_kernel concat_heads__memory_aug_recurrent_mem_tr__ssm_conv_s4d__prompt_kernel
  .amdhsa_next_free_vgpr 512
  .amdhsa_next_free_sgpr 102
  .amdhsa_accum_offset 256
  .amdhsa_group_segment_fixed_size 0
  .amdhsa_kernarg_size 136
  .amdhsa_user_sgpr_count 2
  .amdhsa_user_sgpr_kernarg_segment_ptr 1
  .amdhsa_system_sgpr_workgroup_id_x 1
.end_amdhsa_kernel
.text
```

```asm
; @launch grid=(256,1,1) block=(256,1,1) lds=163840
.amdgcn_target "amdgcn-amd-amdhsa--gfx950"
.text
.globl concat_heads__memory_aug_recurrent_mem_tr__ssm_conv_s4d__prompt_kernel
.p2align 8
.type concat_heads__memory_aug_recurrent_mem_tr__ssm_conv_s4d__prompt_kernel,@function
concat_heads__memory_aug_recurrent_mem_tr__ssm_conv_s4d__prompt_kernel:
    s_cmp_ge_u32 s2, 256
    s_cbranch_scc1 L_exit
    s_load_dwordx4 s[84:87], s[0:1], 120
    s_load_dwordx16 s[48:63], s[0:1], 0
    v_lshrrev_b32 v1, 6, v0
    s_nop 0
    v_readfirstlane_b32 s32, v1
    s_getreg_b32 s3, hwreg(HW_REG_XCC_ID)
    s_and_b32 s3, s3, 15
    s_cmp_lg_u32 s32, 3
    s_cbranch_scc1 L_nowarm
    s_getpc_b64 s[44:45]
L_pcw:
    v_and_b32 v1, 63, v0
    v_lshlrev_b32 v1, 7, v1
    s_cmp_lg_u32 s3, 3
    s_cselect_b32 s33, L_helper-L_pcw, 0
    v_add_u32 v1, s33, v1
    v_min_u32 v2, L_exit-L_pcw, v1
    global_load_dword v240, v2, s[44:45]
    v_add_u32 v1, 8192, v1
    v_min_u32 v2, L_exit-L_pcw, v1
    global_load_dword v241, v2, s[44:45]
    v_add_u32 v1, 8192, v1
    s_cbranch_scc0 L_nowarm
    v_min_u32 v2, L_exit-L_pcw, v1
    global_load_dword v242, v2, s[44:45]
    v_add_u32 v1, 8192, v1
    v_min_u32 v2, L_exit-L_pcw, v1
    global_load_dword v243, v2, s[44:45]
    v_add_u32 v1, 8192, v1
L_nowarm:
    s_waitcnt lgkmcnt(0)
    s_mov_b32 s4, s86
    s_mov_b32 s5, s87
    s_mov_b32 s6, 268435456
    s_mov_b32 s7, 0x20000
    s_mov_b32 s96, s84
    s_mov_b32 s97, s85
    s_mov_b32 s98, 256
    s_mov_b32 s99, 0x20000
    s_mov_b32 s95, 0
    s_cmp_lg_u32 s3, 3
    s_cbranch_scc1 L_helper
    s_mov_b32 s37, 128
    v_mov_b32 v250, 1
    v_mov_b32 v251, 163832
    v_cmp_eq_u32 vcc, 0, v0
    s_nop 0
    s_and_saveexec_b64 s[38:39], vcc
    s_cbranch_execz tk1m
    buffer_atomic_add v250, off, s[96:99], s37 sc0
tk1m:
    s_mov_b64 s[38:39], exec
    s_mov_b64 exec, -1
    v_lshrrev_b32 v54, 6, v0
    s_nop 0
    v_readfirstlane_b32 s13, v54
    v_and_b32 v57, 63, v0
    v_bfe_u32 v54, v57, 2, 1
    v_lshlrev_b32 v48, 13, v54
    v_bfe_u32 v54, v57, 3, 1
    v_lshl_add_u32 v48, v54, 15, v48
    v_bfe_u32 v54, v57, 4, 1
    v_lshl_add_u32 v48, v54, 14, v48
    v_bfe_u32 v54, v57, 5, 1
    v_lshl_add_u32 v48, v54, 16, v48
    v_lshrrev_b32 v55, 4, v57
    v_and_b32 v55, 2, v55
    v_xor_b32 v55, v55, v57
    v_and_b32 v55, 3, v55
    v_lshl_add_u32 v48, v55, 4, v48
    v_bfe_u32 v54, v57, 2, 1
    v_lshlrev_b32 v51, 6, v54
    v_bfe_u32 v54, v57, 3, 1
    v_lshl_add_u32 v51, v54, 9, v51
    v_bfe_u32 v54, v57, 4, 1
    v_lshl_add_u32 v51, v54, 7, v51
    v_bfe_u32 v54, v57, 5, 1
    v_lshl_add_u32 v51, v54, 12, v51
    v_bfe_u32 v54, v57, 0, 1
    v_lshl_add_u32 v51, v54, 3, v51
    v_bfe_u32 v54, v57, 1, 1
    v_lshl_add_u32 v51, v54, 4, v51
    v_bfe_u32 v54, v57, 3, 1
    v_lshl_add_u32 v51, v54, 5, v51
    v_lshrrev_b32 v55, 3, v57
    v_mul_u32_u24 v49, 1152, v55
    v_and_b32 v55, 7, v57
    v_lshl_add_u32 v49, v55, 4, v49
    v_bfe_u32 v54, v57, 4, 1
    v_lshlrev_b32 v52, 13, v54
    v_bfe_u32 v54, v57, 5, 1
    v_lshl_add_u32 v52, v54, 9, v52
    v_bfe_u32 v54, v57, 2, 1
    v_lshl_add_u32 v52, v54, 7, v52
    v_bfe_u32 v54, v57, 3, 1
    v_lshl_add_u32 v52, v54, 5, v52
    v_and_b32 v55, 3, v57
    v_lshl_add_u32 v52, v55, 3, v52
    v_lshrrev_b32 v55, 2, v57
    v_mul_u32_u24 v50, 1152, v55
    v_and_b32 v55, 3, v57
    v_lshl_add_u32 v50, v55, 4, v50
    v_bfe_u32 v54, v57, 4, 1
    v_lshlrev_b32 v53, 12, v54
    v_bfe_u32 v54, v57, 5, 1
    v_lshl_add_u32 v53, v54, 8, v53
    v_bfe_u32 v54, v57, 2, 1
    v_lshl_add_u32 v53, v54, 6, v53
    v_bfe_u32 v54, v57, 3, 1
    v_lshl_add_u32 v53, v54, 5, v53
    v_and_b32 v55, 3, v57
    v_lshl_add_u32 v53, v55, 3, v53
    s_lshl_b32 s66, s13, 10
    s_and_b32 s93, s13, 1
    s_lshl_b32 s93, s93, 14
    s_and_b32 s75, s13, 2
    s_lshl_b32 s75, s75, 19
    v_add_u32 v51, s66, v51
    v_add_u32 v52, s66, v52
    v_add_u32 v53, s66, v53
    v_mov_b32 v58, v48
    s_mov_b32 s10, 4718592
    s_mov_b32 s11, 0x20000
    s_mov_b64 exec, s[38:39]
    s_cbranch_execz tk1
    s_waitcnt vmcnt(0)
    ds_write_b32 v251, v250
    s_waitcnt lgkmcnt(0)
tk1:
    s_mov_b64 exec, -1
    s_barrier
    ds_read_b32 v252, v251
    s_waitcnt lgkmcnt(0)
    v_readfirstlane_b32 s12, v252
    s_barrier
    s_nop 3
    s_cmp_ge_u32 s12, 32
    s_cbranch_scc1 L_helper
L_chain:
    s_mov_b64 s[48:49], s[50:51]
    s_mov_b64 s[50:51], s[52:53]
    s_mov_b64 s[52:53], s[54:55]
    s_mov_b64 s[54:55], s[56:57]
    s_mov_b64 s[56:57], s[58:59]
    s_lshl_b32 s67, s12, 8
    s_lshl_b32 s40, s13, 6
    s_add_u32 s67, s67, s40
    s_mul_i32 s92, s12, 147456
    s_lshr_b32 s73, s50, 8
    s_add_u32 s73, s73, s12
    s_and_b32 s73, s73, 31
    s_bitcmp1_b32 0xa2222222, s73
    s_cselect_b32 s88, 1, 0
    s_mov_b32 s72, 0
    s_add_u32 s73, s73, 1
    s_lshr_b32 s73, s73, 2
    s_xor_b32 s94, s13, 0
    s_mul_i32 s94, s94, 36864
    s_add_u32 s94, s94, s92
    s_lshl_b32 s74, s13, 7
    s_add_u32 s94, s94, s74
    s_add_u32 s78, s94, 0
    s_mov_b64 s[8:9], s[56:57]
    v_mov_b32 v58, v49
    s_mov_b32 s79, 9216
    s_mov_b32 s81, 0
    s_add_u32 s80, s66, 114688
    s_mov_b32 s76, 0
    s_mov_b32 s77, 8192
    s_call_b64 s[82:83], cf_dma
    s_mov_b32 s77, 16384
    s_call_b64 s[82:83], cf_dma
    s_xor_b32 s94, s13, 1
    s_mul_i32 s94, s94, 36864
    s_add_u32 s94, s94, s92
    s_lshl_b32 s74, s13, 7
    s_add_u32 s94, s94, s74
    s_add_u32 s78, s94, 0
    s_add_u32 s80, s66, 81920
    s_mov_b32 s76, 0
    s_mov_b32 s77, 8192
    s_call_b64 s[82:83], cf_dma
    s_mov_b32 s77, 16384
    s_call_b64 s[82:83], cf_dma
    s_xor_b32 s94, s13, 2
    s_mul_i32 s94, s94, 36864
    s_add_u32 s94, s94, s92
    s_lshl_b32 s74, s13, 7
    s_add_u32 s94, s94, s74
    s_add_u32 s78, s94, 0
    s_add_u32 s80, s66, 16384
    s_mov_b32 s76, 0
    s_mov_b32 s77, 8192
    s_call_b64 s[82:83], cf_dma
    s_mov_b32 s77, 16384
    s_call_b64 s[82:83], cf_dma
    s_xor_b32 s94, s13, 3
    s_mul_i32 s94, s94, 36864
    s_add_u32 s94, s94, s92
    s_lshl_b32 s74, s13, 7
    s_add_u32 s94, s94, s74
    s_add_u32 s78, s94, 0
    s_add_u32 s80, s66, 0
    s_mov_b32 s76, 0
    s_mov_b32 s77, 8192
    s_call_b64 s[82:83], cf_dma
    s_mov_b32 s77, 16384
    s_call_b64 s[82:83], cf_dma
    v_lshrrev_b32 v24, 6, v0
    v_lshlrev_b32 v61, 4, v0
    v_add_u32 v62, 57344, v61
    v_xor_b32 v63, 1024, v61
    v_add_u32 v63, 98304, v63
    v_xor_b32 v64, 2048, v61
    v_add_u32 v64, 98304, v64
    v_and_b32 v65, 1023, v61
    v_add_u32 v65, 98304, v65
    v_and_b32 v26, 15, v0
    v_bfe_u32 v27, v0, 4, 2
    v_mov_b32 v60, 0x4444
    v_mov_b32 v25, 0xeeee
    v_cmp_lt_u32 vcc, 7, v26
    s_nop 1
    v_cndmask_b32 v60, v60, v25, vcc
    s_nop 1
    v_and_b32 v67, 12, v26
    v_lshlrev_b32 v67, 3, v67
    v_and_b32 v25, 1, v26
    v_lshl_add_u32 v67, v25, 4, v67
    v_bfe_u32 v25, v26, 1, 1
    v_lshl_add_u32 v67, v25, 3, v67
    v_lshl_add_u32 v66, v27, 14, v67
    v_lshl_add_u32 v66, v24, 17, v66
    s_nop 1
    v_and_b32 v67, 63, v67
    v_lshrrev_b32 v25, 1, v24
    v_lshl_add_u32 v67, v25, 18, v67
    v_lshl_add_u32 v67, v27, 16, v67
    v_lshrrev_b32 v25, 3, v26
    v_lshl_add_u32 v67, v25, 15, v67
    v_and_b32 v25, 1, v24
    v_lshl_add_u32 v67, v25, 6, v67
    s_nop 1
    s_waitcnt vmcnt(12)
    v_add_u32 v55, 114688, v52
    ds_read_b64_tr_b16 v[160:161], v55 offset:0
    ds_read_b64_tr_b16 v[162:163], v55 offset:256
    ds_read_b64_tr_b16 v[164:165], v55 offset:4096
    ds_read_b64_tr_b16 v[166:167], v55 offset:4352
    s_xor_b32 s94, s13, 0
    s_mul_i32 s94, s94, 36864
    s_add_u32 s94, s94, s92
    s_lshl_b32 s74, s13, 7
    s_add_u32 s94, s94, s74
    s_add_u32 s78, s94, 512
    s_add_u32 s80, s66, 147456
    s_mov_b32 s76, 0
    s_mov_b32 s77, 8192
    s_call_b64 s[82:83], cf_dma
    ds_read_b64_tr_b16 v[192:193], v55 offset:64
    ds_read_b64_tr_b16 v[194:195], v55 offset:320
    ds_read_b64_tr_b16 v[196:197], v55 offset:4160
    ds_read_b64_tr_b16 v[198:199], v55 offset:4416
    s_mov_b32 s77, 16384
    s_call_b64 s[82:83], cf_dma
    v_and_b32 v25, 31, v0
    v_lshlrev_b32 v70, 4, v25
    v_lshlrev_b32 v28, 3, v25
    v_add_u32 v28, 108032, v28
    v_lshrrev_b32 v25, 1, v24
    v_lshl_add_u32 v70, v25, 9, v70
    v_and_b32 v25, 1, v24
    v_lshl_add_u32 v70, v25, 3, v70
    v_add_u32 v70, 109568, v70
    v_cmp_gt_u32 vcc, 2, v27
    s_nop 1
    v_cndmask_b32 v70, v70, v28, vcc
    s_nop 1
    s_waitcnt lgkmcnt(0)
    s_waitcnt vmcnt(12)
    v_add_u32 v55, 81920, v52
    ds_read_b64_tr_b16 v[168:169], v55 offset:0
    ds_read_b64_tr_b16 v[170:171], v55 offset:256
    ds_read_b64_tr_b16 v[172:173], v55 offset:4096
    ds_read_b64_tr_b16 v[174:175], v55 offset:4352
    s_xor_b32 s94, s13, 1
    s_mul_i32 s94, s94, 36864
    s_add_u32 s94, s94, s92
    s_lshl_b32 s74, s13, 7
    s_add_u32 s94, s94, s74
    s_add_u32 s78, s94, 512
    s_add_u32 s80, s66, 98304
    s_mov_b32 s76, 0
    s_mov_b32 s77, 8192
    s_call_b64 s[82:83], cf_dma
    ds_read_b64_tr_b16 v[200:201], v55 offset:64
    ds_read_b64_tr_b16 v[202:203], v55 offset:320
    ds_read_b64_tr_b16 v[204:205], v55 offset:4160
    ds_read_b64_tr_b16 v[206:207], v55 offset:4416
    s_mov_b32 s77, 16384
    s_call_b64 s[82:83], cf_dma
    v_xor_b32 v71, 2048, v63
    v_lshrrev_b32 v68, 4, v0
    v_lshlrev_b32 v68, 7, v68
    v_and_b32 v25, 7, v26
    v_lshl_add_u32 v68, v25, 4, v68
    v_add_u32 v68, 102400, v68
    v_xor_b32 v74, 512, v68
    v_xor_b32 v75, 1024, v68
    v_xor_b32 v76, 1536, v68
    v_lshrrev_b32 v25, 3, v26
    v_lshl_add_u32 v77, v25, 3, v68
    v_or_b32 v78, 512, v65
    v_lshlrev_b32 v79, 2, v61
    v_mov_b64 v[72:73], 0
    v_and_b32 v25, 1, v27
    v_lshlrev_b32 v69, 7, v25
    v_lshrrev_b32 v25, 1, v27
    v_lshl_add_u32 v69, v25, 3, v69
    v_and_b32 v25, 3, v26
    v_lshl_add_u32 v69, v25, 4, v69
    v_bfe_u32 v25, v26, 2, 1
    v_lshl_add_u32 v69, v25, 2, v69
    s_nop 1
    s_waitcnt lgkmcnt(0)
    s_waitcnt vmcnt(12)
    v_add_u32 v55, 16384, v52
    ds_read_b64_tr_b16 v[176:177], v55 offset:0
    ds_read_b64_tr_b16 v[178:179], v55 offset:256
    ds_read_b64_tr_b16 v[180:181], v55 offset:4096
    ds_read_b64_tr_b16 v[182:183], v55 offset:4352
    s_add_u32 s78, s67, 4194304
    s_mov_b64 s[8:9], s[54:55]
    v_mov_b32 v58, v48
    s_mov_b32 s79, 131072
    s_add_u32 s80, s66, 32768
    s_mov_b32 s76, 0
    s_mov_b32 s77, 8192
    s_call_b64 s[82:83], cf_dma
    ds_read_b64_tr_b16 v[208:209], v55 offset:64
    ds_read_b64_tr_b16 v[210:211], v55 offset:320
    ds_read_b64_tr_b16 v[212:213], v55 offset:4160
    ds_read_b64_tr_b16 v[214:215], v55 offset:4416
    s_mov_b32 s77, 16384
    s_call_b64 s[82:83], cf_dma
    s_mov_b32 s32, 0x00ff00ff
    s_mov_b32 s33, 0x00ff00ff
    s_not_b64 s[34:35], s[32:33]
    s_lshr_b32 s31, s12, 1
    s_lshl_b32 s31, s31, 8
    s_and_b32 s40, s12, 1
    s_lshl_b32 s40, s40, 6
    s_add_u32 s31, s31, s40
    s_and_b32 s40, s13, 1
    s_lshl_b32 s40, s40, 12
    s_add_u32 s31, s31, s40
    s_lshl_b32 s19, s12, 14
    s_add_u32 s19, s19, 67076096
    s_add_u32 s41, s19, 8192
    s_add_u32 s19, s19, s40
    s_and_b32 s40, s12, 1
    s_lshl_b32 s40, s40, 2
    s_or_b32 s40, s40, s13
    s_cmp_eq_u32 s40, 5
    s_cselect_b32 s64, 0, s13
    s_cmp_lg_u32 s13, 1
    s_cbranch_scc1 cf_notx
    s_mov_b32 s32, 0xff
    s_mov_b32 s33, 0xff
    s_mov_b32 s19, s41
    s_lshr_b32 s31, s12, 3
    s_lshl_b32 s31, s31, 8
    s_and_b32 s40, s12, 2
    s_lshl_b32 s40, s40, 6
    s_add_u32 s31, s31, s40
    s_and_b32 s40, s12, 4
    s_lshl_b32 s40, s40, 4
    s_add_u32 s31, s31, s40
    s_add_u32 s31, s31, 8192
cf_notx:
    s_cmp_lg_u32 s13, 0
    s_cbranch_scc1 cf_notp
    s_min_u32 s40, s12, 23
    s_mul_i32 s40, s40, 384
    s_add_u32 s40, s40, 98304
    v_add_u32 v69, s40, v61
    v_mov_b32 v25, 108288
    v_cmp_lt_u32 vcc, 23, v0
    s_nop 1
    v_cndmask_b32 v69, v69, v25, vcc
cf_notp:
    s_nop 1
    s_waitcnt lgkmcnt(0)
    s_waitcnt vmcnt(12)
    v_add_u32 v55, 0, v52
    ds_read_b64_tr_b16 v[184:185], v55 offset:0
    ds_read_b64_tr_b16 v[186:187], v55 offset:256
    ds_read_b64_tr_b16 v[188:189], v55 offset:4096
    ds_read_b64_tr_b16 v[190:191], v55 offset:4352
    s_xor_b32 s78, s75, 0
    s_add_u32 s78, s78, s67
    s_mov_b32 s81, s93
    s_add_u32 s80, s66, 114688
    s_mov_b32 s76, 0
    s_mov_b32 s77, 8192
    s_call_b64 s[82:83], cf_dma
    ds_read_b64_tr_b16 v[216:217], v55 offset:64
    ds_read_b64_tr_b16 v[218:219], v55 offset:320
    ds_read_b64_tr_b16 v[220:221], v55 offset:4160
    ds_read_b64_tr_b16 v[222:223], v55 offset:4416
    s_mov_b32 s77, 16384
    s_call_b64 s[82:83], cf_dma
    v_mov_b32 v28, 1
    v_mov_b32 v29, 1
    v_mov_b32 v30, 1
    v_mov_b32 v31, 1
    s_lshl_b32 s40, s12, 14
    s_add_u32 s40, s40, 67174400
    s_add_u32 s41, s40, 0
    buffer_store_dwordx4 v[28:31], v61, s[4:7], s41 offen
    s_add_u32 s41, s40, 4096
    buffer_store_dwordx4 v[28:31], v61, s[4:7], s41 offen
    s_add_u32 s41, s40, 8192
    buffer_store_dwordx4 v[28:31], v61, s[4:7], s41 offen
    s_cmp_eq_u32 s64, 0
    s_cselect_b64 exec, 0, s[32:33]
    v_mov_b32 v27, -1
    s_add_u32 s41, s31, 67108864
    buffer_store_dword v27, v69, s[4:7], s41 offen
    s_add_u32 s41, s31, 67125248
    buffer_store_dword v27, v69, s[4:7], s41 offen
    s_add_u32 s41, s31, 67141632
    buffer_store_dword v27, v69, s[4:7], s41 offen
    s_add_u32 s41, s31, 67158016
    buffer_store_dword v27, v69, s[4:7], s41 offen
    s_mov_b64 exec, -1
    s_waitcnt lgkmcnt(0)
    s_waitcnt vmcnt(12)
    v_add_u32 v55, 147456, v52
    ds_read_b64_tr_b16 v[224:225], v55 offset:0
    ds_read_b64_tr_b16 v[226:227], v55 offset:256
    ds_read_b64_tr_b16 v[228:229], v55 offset:4096
    ds_read_b64_tr_b16 v[230:231], v55 offset:4352
    s_mov_b32 s77, 24576
    s_call_b64 s[82:83], cf_dma
    ds_read_b64_tr_b16 v[240:241], v55 offset:64
    ds_read_b64_tr_b16 v[242:243], v55 offset:320
    ds_read_b64_tr_b16 v[244:245], v55 offset:4160
    ds_read_b64_tr_b16 v[246:247], v55 offset:4416
    s_mov_b32 s77, 32768
    s_call_b64 s[82:83], cf_dma
    s_mov_b64 s[68:69], s[48:49]
    s_mov_b32 s70, 9216
    s_mov_b32 s71, 0x20000
    v_and_b32 v25, 7, v0
    v_mul_u32_u24 v25, 1152, v25
    v_lshrrev_b32 v26, 3, v0
    v_lshl_add_u32 v25, v26, 4, v25
    buffer_load_dwordx4 v[36:39], v25, s[68:71], 0 offen
    buffer_load_dwordx4 v[40:43], v25, s[68:71], 0 offen offset:512
    v_bfe_u32 v25, v0, 2, 3
    v_mul_u32_u24 v25, 1152, v25
    v_lshrrev_b32 v26, 5, v0
    v_lshl_add_u32 v25, v26, 4, v25
    v_and_b32 v26, 3, v0
    v_lshl_add_u32 v25, v26, 2, v25
    buffer_load_dword v44, v25, s[68:71], 0 offen offset:1024
    s_nop 0
    s_waitcnt lgkmcnt(0)
    s_waitcnt vmcnt(15)
    v_add_u32 v55, 98304, v52
    ds_read_b64_tr_b16 v[232:233], v55 offset:0
    ds_read_b64_tr_b16 v[234:235], v55 offset:256
    ds_read_b64_tr_b16 v[236:237], v55 offset:4096
    ds_read_b64_tr_b16 v[238:239], v55 offset:4352
    s_xor_b32 s78, s75, 1048576
    s_add_u32 s78, s78, s67
    s_add_u32 s80, s66, 65536
    s_mov_b32 s76, 0
    s_mov_b32 s77, 8192
    s_call_b64 s[82:83], cf_dma
    ds_read_b64_tr_b16 v[248:249], v55 offset:64
    ds_read_b64_tr_b16 v[250:251], v55 offset:320
    ds_read_b64_tr_b16 v[252:253], v55 offset:4160
    ds_read_b64_tr_b16 v[254:255], v55 offset:4416
    s_mov_b32 s77, 16384
    s_call_b64 s[82:83], cf_dma
    s_mov_b32 s44, 0x3e0293ee
    s_mov_b32 s45, s44
    s_mov_b32 s46, 0x42000000
    s_mov_b32 s60, 0x3f803f80
    s_mov_b32 s61, s60
    s_mov_b32 s62, 0x3e803e80
    s_mov_b32 s63, s62
    s_mov_b32 s28, 0
    s_lshl_b32 s58, s13, 10
    s_add_u32 s58, s58, 102400
    s_lshl_b32 s59, s13, 8
    s_add_u32 s59, s59, 106496
    s_lshl_b32 s24, s12, 14
    s_add_u32 s24, s24, 0
    s_add_u32 s47, s24, 33030144
    s_mul_i32 s40, s13, 3072
    s_add_u32 s23, s24, s40
    s_lshl_b32 s20, s12, 7
    s_add_u32 s20, s20, 67174400
    s_add_u32 s21, s20, 65536
    s_add_u32 s38, s20, 4096
    s_add_u32 s39, s21, 4096
    s_lshl_b32 s22, s12, 7
    s_add_u32 s22, s22, 67182592
    s_waitcnt lgkmcnt(0)
    s_waitcnt vmcnt(15)
    v_add_u32 v55, 32768, v51
    v_xor_b32 v56, 32, v55
    ds_read_b64_tr_b16 v[144:145], v55 offset:0
    ds_read_b64_tr_b16 v[146:147], v55 offset:256
    ds_read_b64_tr_b16 v[148:149], v55 offset:8192
    ds_read_b64_tr_b16 v[150:151], v55 offset:8448
    s_mov_b32 s77, 24576
    s_call_b64 s[82:83], cf_dma
    ds_read_b64_tr_b16 v[152:153], v56 offset:0
    ds_read_b64_tr_b16 v[154:155], v56 offset:256
    ds_read_b64_tr_b16 v[156:157], v56 offset:8192
    ds_read_b64_tr_b16 v[158:159], v56 offset:8448
    s_mov_b32 s77, 32768
    s_call_b64 s[82:83], cf_dma
    s_lshl_b32 s40, s12, 12
    s_add_u32 s25, s40, 79429632
    s_add_u32 s26, s40, 88866816
    s_lshl_b32 s65, s12, 9
    s_add_u32 s65, s65, 90177536
    s_lshl_b32 s40, s13, 5
    s_or_b32 s40, s40, s12
    s_cmp_lt_u32 s40, 24
    s_cselect_b32 s36, 0x1ffffff, 0
    s_mov_b32 s37, 0
    s_lshl_b32 s27, s12, 7
    s_add_u32 s27, s27, 125845504
    s_lshl_b32 s40, s13, 2
    s_add_u32 s27, s27, s40
    v_bfe_u32 v28, v61, 4, 4
    v_bfe_u32 v29, v61, 8, 1
    v_lshlrev_b32 v29, 2, v29
    v_sub_u32 v29, v28, v29
    v_mov_b32 v31, 0x3f80
    v_mov_b32 v32, 0x3f800000
    s_nop 1
    s_waitcnt lgkmcnt(0)
    s_waitcnt vmcnt(11)
    v_add_u32 v55, 114688, v51
    v_xor_b32 v56, 32, v55
    ds_read_b64_tr_b16 a[192:193], v55 offset:0
    ds_read_b64_tr_b16 a[194:195], v55 offset:256
    ds_read_b64_tr_b16 a[196:197], v55 offset:8192
    ds_read_b64_tr_b16 a[198:199], v55 offset:8448
    s_xor_b32 s78, s75, 2097152
    s_add_u32 s78, s78, s67
    s_add_u32 s80, s66, 0
    s_mov_b32 s76, 0
    s_mov_b32 s77, 8192
    s_call_b64 s[82:83], cf_dma
    ds_read_b64_tr_b16 a[200:201], v56 offset:0
    ds_read_b64_tr_b16 a[202:203], v56 offset:256
    ds_read_b64_tr_b16 a[204:205], v56 offset:8192
    ds_read_b64_tr_b16 a[206:207], v56 offset:8448
    s_mov_b32 s77, 16384
    s_call_b64 s[82:83], cf_dma
    v_cmp_eq_u32 vcc, 0, v29
    s_nop 1
    v_cndmask_b32 v16, 0, v31, vcc
    v_cmp_eq_u32 vcc, 1, v29
    s_nop 1
    v_cndmask_b32 v16, v16, v32, vcc
    v_cmp_eq_u32 vcc, 0, v28
    s_nop 1
    v_cndmask_b32 v20, 0, v31, vcc
    v_cmp_eq_u32 vcc, 1, v28
    s_nop 1
    v_cndmask_b32 v20, v20, v32, vcc
    s_nop 1
    s_waitcnt lgkmcnt(0)
    v_add_u32 v55, 131072, v51
    v_xor_b32 v56, 32, v55
    ds_read_b64_tr_b16 a[208:209], v55 offset:0
    ds_read_b64_tr_b16 a[210:211], v55 offset:256
    ds_read_b64_tr_b16 a[212:213], v55 offset:8192
    ds_read_b64_tr_b16 a[214:215], v55 offset:8448
    s_mov_b32 s77, 24576
    s_call_b64 s[82:83], cf_dma
    ds_read_b64_tr_b16 a[216:217], v56 offset:0
    ds_read_b64_tr_b16 a[218:219], v56 offset:256
    ds_read_b64_tr_b16 a[220:221], v56 offset:8192
    ds_read_b64_tr_b16 a[222:223], v56 offset:8448
    s_mov_b32 s77, 32768
    s_call_b64 s[82:83], cf_dma
    v_cmp_eq_u32 vcc, 2, v29
    s_nop 1
    v_cndmask_b32 v17, 0, v31, vcc
    v_cmp_eq_u32 vcc, 3, v29
    s_nop 1
    v_cndmask_b32 v17, v17, v32, vcc
    v_cmp_eq_u32 vcc, 2, v28
    s_nop 1
    v_cndmask_b32 v21, 0, v31, vcc
    v_cmp_eq_u32 vcc, 3, v28
    s_nop 1
    v_cndmask_b32 v21, v21, v32, vcc
    s_nop 1
    s_waitcnt lgkmcnt(0)
    s_waitcnt vmcnt(8)
    v_add_u32 v55, 65536, v51
    v_xor_b32 v56, 32, v55
    ds_read_b64_tr_b16 a[224:225], v55 offset:0
    ds_read_b64_tr_b16 a[226:227], v55 offset:256
    ds_read_b64_tr_b16 a[228:229], v55 offset:8192
    ds_read_b64_tr_b16 a[230:231], v55 offset:8448
    s_cmp_eq_u32 s88, 0
    s_cbranch_scc1 cf_cpe623
    s_lshl_b32 s89, s73, 7
    s_add_u32 s89, s89, 125853696
    v_min_u32 v33, 11, v57
    v_lshlrev_b32 v33, 2, v33
    buffer_load_dword v34, off, s[96:99], 0 offset:64 sc1
    buffer_load_dword v35, v33, s[4:7], s89 offen sc1
cf_cpe623:
    s_xor_b32 s78, s75, 3145728
    s_add_u32 s78, s78, s67
    s_add_u32 s80, s66, 32768
    s_mov_b32 s76, 0
    s_mov_b32 s77, 8192
    s_call_b64 s[82:83], cf_dma
    ds_read_b64_tr_b16 a[232:233], v56 offset:0
    ds_read_b64_tr_b16 a[234:235], v56 offset:256
    ds_read_b64_tr_b16 a[236:237], v56 offset:8192
    ds_read_b64_tr_b16 a[238:239], v56 offset:8448
    s_mov_b32 s77, 16384
    s_call_b64 s[82:83], cf_dma
    v_cmp_eq_u32 vcc, 8, v29
    s_nop 1
    v_cndmask_b32 v18, 0, v31, vcc
    v_cmp_eq_u32 vcc, 9, v29
    s_nop 1
    v_cndmask_b32 v18, v18, v32, vcc
    v_cmp_eq_u32 vcc, 4, v28
    s_nop 1
    v_cndmask_b32 v22, 0, v31, vcc
    v_cmp_eq_u32 vcc, 5, v28
    s_nop 1
    v_cndmask_b32 v22, v22, v32, vcc
    s_nop 1
    s_waitcnt lgkmcnt(0)
    v_add_u32 v55, 81920, v51
    v_xor_b32 v56, 32, v55
    ds_read_b64_tr_b16 a[240:241], v55 offset:0
    ds_read_b64_tr_b16 a[242:243], v55 offset:256
    ds_read_b64_tr_b16 a[244:245], v55 offset:8192
    ds_read_b64_tr_b16 a[246:247], v55 offset:8448
    s_mov_b32 s77, 24576
    s_call_b64 s[82:83], cf_dma
    ds_read_b64_tr_b16 a[248:249], v56 offset:0
    ds_read_b64_tr_b16 a[250:251], v56 offset:256
    ds_read_b64_tr_b16 a[252:253], v56 offset:8192
    ds_read_b64_tr_b16 a[254:255], v56 offset:8448
    s_mov_b32 s77, 32768
    s_call_b64 s[82:83], cf_dma
    v_cmp_eq_u32 vcc, 10, v29
    s_nop 1
    v_cndmask_b32 v19, 0, v31, vcc
    v_cmp_eq_u32 vcc, 11, v29
    s_nop 1
    v_cndmask_b32 v19, v19, v32, vcc
    v_cmp_eq_u32 vcc, 6, v28
    s_nop 1
    v_cndmask_b32 v23, 0, v31, vcc
    v_cmp_eq_u32 vcc, 7, v28
    s_nop 1
    v_cndmask_b32 v23, v23, v32, vcc
    s_nop 1
    s_waitcnt lgkmcnt(0)
    s_waitcnt vmcnt(8)
    v_add_u32 v55, 0, v51
    v_xor_b32 v56, 32, v55
    ds_read_b64_tr_b16 v[80:81], v55 offset:0
    ds_read_b64_tr_b16 v[82:83], v55 offset:256
    ds_read_b64_tr_b16 v[84:85], v55 offset:8192
    ds_read_b64_tr_b16 v[86:87], v55 offset:8448
    s_cmp_eq_u32 s88, 0
    s_cbranch_scc1 cf_ncp693
    s_waitcnt vmcnt(8)
    v_max_u32 v34, 1, v34
    v_cmp_eq_u32 vcc, 1, v34
    s_cbranch_vccnz cf_ncp693
    v_cmp_ne_u32 vcc, v34, v35
    s_cbranch_vccnz cf_ncp693
    s_mov_b32 s88, 0
    s_mov_b32 s72, 5
    s_lshl_b32 s74, s73, 19
    s_add_u32 s74, s74, 96468992
    s_add_u32 s50, s4, s74
    s_addc_u32 s51, s5, 0
    s_add_u32 s52, s50, 147456
    s_addc_u32 s53, s51, 0
    s_lshl_b32 s67, s13, 6
    v_and_b32 v54, 63, v48
    v_lshrrev_b32 v48, 13, v48
    v_lshl_add_u32 v48, v48, 8, v54
cf_ncp693:
    s_cmp_eq_u32 s88, 0
    s_cbranch_scc1 cf_cpe714
    s_lshl_b32 s89, s73, 7
    s_add_u32 s89, s89, 125853696
    v_min_u32 v33, 11, v57
    v_lshlrev_b32 v33, 2, v33
    buffer_load_dword v34, off, s[96:99], 0 offset:64 sc1
    buffer_load_dword v35, v33, s[4:7], s89 offen sc1
cf_cpe714:
    s_xor_b32 s78, s75, 2097152
    s_lshr_b32 s78, s78, s72
    s_add_u32 s78, s78, s67
    s_mov_b64 s[8:9], s[52:53]
    v_mov_b32 v58, v48
    s_lshr_b32 s79, 131072, s72
    s_add_u32 s80, s66, 131072
    s_mov_b32 s76, 0
    s_mov_b32 s77, 8192
    s_call_b64 s[82:83], cf_dma
    ds_read_b64_tr_b16 v[88:89], v56 offset:0
    ds_read_b64_tr_b16 v[90:91], v56 offset:256
    ds_read_b64_tr_b16 v[92:93], v56 offset:8192
    ds_read_b64_tr_b16 v[94:95], v56 offset:8448
    s_mov_b32 s77, 16384
    s_call_b64 s[82:83], cf_dma
    v_mov_b32 v46, 1
    s_mov_b64 exec, 1
    buffer_atomic_add v46, off, s[96:99], 0 offset:132 sc0
    s_mov_b64 exec, -1
    s_waitcnt lgkmcnt(0)
    v_add_u32 v55, 16384, v51
    v_xor_b32 v56, 32, v55
    ds_read_b64_tr_b16 v[96:97], v55 offset:0
    ds_read_b64_tr_b16 v[98:99], v55 offset:256
    ds_read_b64_tr_b16 v[100:101], v55 offset:8192
    ds_read_b64_tr_b16 v[102:103], v55 offset:8448
    s_mov_b32 s77, 24576
    s_call_b64 s[82:83], cf_dma
    ds_read_b64_tr_b16 v[104:105], v56 offset:0
    ds_read_b64_tr_b16 v[106:107], v56 offset:256
    ds_read_b64_tr_b16 v[108:109], v56 offset:8192
    ds_read_b64_tr_b16 v[110:111], v56 offset:8448
    s_mov_b32 s77, 32768
    s_call_b64 s[82:83], cf_dma
    s_waitcnt lgkmcnt(0)
    s_waitcnt vmcnt(9)
    v_add_u32 v55, 32768, v51
    v_xor_b32 v56, 32, v55
    ds_read_b64_tr_b16 v[112:113], v55 offset:0
    ds_read_b64_tr_b16 v[114:115], v55 offset:256
    ds_read_b64_tr_b16 v[116:117], v55 offset:8192
    ds_read_b64_tr_b16 v[118:119], v55 offset:8448
    s_cmp_eq_u32 s88, 0
    s_cbranch_scc1 cf_ncp766
    s_waitcnt vmcnt(9)
    v_max_u32 v34, 1, v34
    v_cmp_eq_u32 vcc, 1, v34
    s_cbranch_vccnz cf_ncp766
    v_cmp_ne_u32 vcc, v34, v35
    s_cbranch_vccnz cf_ncp766
    s_mov_b32 s88, 0
    s_mov_b32 s72, 5
    s_lshl_b32 s74, s73, 19
    s_add_u32 s74, s74, 96468992
    s_add_u32 s50, s4, s74
    s_addc_u32 s51, s5, 0
    s_add_u32 s52, s50, 147456
    s_addc_u32 s53, s51, 0
    s_lshl_b32 s67, s13, 6
    v_and_b32 v54, 63, v48
    v_lshrrev_b32 v48, 13, v48
    v_lshl_add_u32 v48, v48, 8, v54
cf_ncp766:
    s_cmp_eq_u32 s88, 0
    s_cbranch_scc1 cf_cpe787
    s_lshl_b32 s89, s73, 7
    s_add_u32 s89, s89, 125853696
    v_min_u32 v33, 11, v57
    v_lshlrev_b32 v33, 2, v33
    buffer_load_dword v34, off, s[96:99], 0 offset:64 sc1
    buffer_load_dword v35, v33, s[4:7], s89 offen sc1
cf_cpe787:
    s_xor_b32 s78, s75, 3145728
    s_lshr_b32 s78, s78, s72
    s_add_u32 s78, s78, s67
    s_mov_b64 s[8:9], s[52:53]
    v_mov_b32 v58, v48
    s_lshr_b32 s79, 131072, s72
    s_add_u32 s80, s66, 65536
    s_mov_b32 s76, 0
    s_mov_b32 s77, 8192
    s_call_b64 s[82:83], cf_dma
    ds_read_b64_tr_b16 v[120:121], v56 offset:0
    ds_read_b64_tr_b16 v[122:123], v56 offset:256
    ds_read_b64_tr_b16 v[124:125], v56 offset:8192
    ds_read_b64_tr_b16 v[126:127], v56 offset:8448
    s_mov_b32 s77, 16384
    s_call_b64 s[82:83], cf_dma
    s_waitcnt lgkmcnt(0)
    v_add_u32 v55, 49152, v51
    v_xor_b32 v56, 32, v55
    ds_read_b64_tr_b16 v[128:129], v55 offset:0
    ds_read_b64_tr_b16 v[130:131], v55 offset:256
    ds_read_b64_tr_b16 v[132:133], v55 offset:8192
    ds_read_b64_tr_b16 v[134:135], v55 offset:8448
    s_mov_b32 s77, 24576
    s_call_b64 s[82:83], cf_dma
    ds_read_b64_tr_b16 v[136:137], v56 offset:0
    ds_read_b64_tr_b16 v[138:139], v56 offset:256
    ds_read_b64_tr_b16 v[140:141], v56 offset:8192
    ds_read_b64_tr_b16 v[142:143], v56 offset:8448
    s_mov_b32 s77, 32768
    s_call_b64 s[82:83], cf_dma
    s_waitcnt lgkmcnt(0)
    s_waitcnt vmcnt(8)
    v_add_u32 v55, 131072, v51
    v_xor_b32 v56, 32, v55
    ds_read_b64_tr_b16 a[128:129], v55 offset:0
    ds_read_b64_tr_b16 a[130:131], v55 offset:256
    ds_read_b64_tr_b16 a[132:133], v55 offset:8192
    ds_read_b64_tr_b16 a[134:135], v55 offset:8448
    s_cmp_eq_u32 s88, 0
    s_cbranch_scc1 cf_ncp835
    s_waitcnt vmcnt(8)
    v_max_u32 v34, 1, v34
    v_cmp_eq_u32 vcc, 1, v34
    s_cbranch_vccnz cf_ncp835
    v_cmp_ne_u32 vcc, v34, v35
    s_cbranch_vccnz cf_ncp835
    s_mov_b32 s88, 0
    s_mov_b32 s72, 5
    s_lshl_b32 s74, s73, 19
    s_add_u32 s74, s74, 96468992
    s_add_u32 s50, s4, s74
    s_addc_u32 s51, s5, 0
    s_add_u32 s52, s50, 147456
    s_addc_u32 s53, s51, 0
    s_lshl_b32 s67, s13, 6
    v_and_b32 v54, 63, v48
    v_lshrrev_b32 v48, 13, v48
    v_lshl_add_u32 v48, v48, 8, v54
cf_ncp835:
    s_cmp_eq_u32 s88, 0
    s_cbranch_scc1 cf_cpe856
    s_lshl_b32 s89, s73, 7
    s_add_u32 s89, s89, 125853696
    v_min_u32 v33, 11, v57
    v_lshlrev_b32 v33, 2, v33
    buffer_load_dword v34, off, s[96:99], 0 offset:64 sc1
    buffer_load_dword v35, v33, s[4:7], s89 offen sc1
cf_cpe856:
    s_xor_b32 s78, s75, 2097152
    s_lshr_b32 s78, s78, s72
    s_add_u32 s78, s78, s67
    s_mov_b64 s[8:9], s[50:51]
    v_mov_b32 v58, v48
    s_lshr_b32 s79, 131072, s72
    s_add_u32 s80, s66, 0
    s_mov_b32 s76, 0
    s_mov_b32 s77, 8192
    s_call_b64 s[82:83], cf_dma
    ds_read_b64_tr_b16 a[136:137], v56 offset:0
    ds_read_b64_tr_b16 a[138:139], v56 offset:256
    ds_read_b64_tr_b16 a[140:141], v56 offset:8192
    ds_read_b64_tr_b16 a[142:143], v56 offset:8448
    s_mov_b32 s77, 16384
    s_call_b64 s[82:83], cf_dma
    s_waitcnt lgkmcnt(0)
    v_add_u32 v55, 147456, v51
    v_xor_b32 v56, 32, v55
    ds_read_b64_tr_b16 a[144:145], v55 offset:0
    ds_read_b64_tr_b16 a[146:147], v55 offset:256
    ds_read_b64_tr_b16 a[148:149], v55 offset:8192
    ds_read_b64_tr_b16 a[150:151], v55 offset:8448
    s_mov_b32 s77, 24576
    s_call_b64 s[82:83], cf_dma
    ds_read_b64_tr_b16 a[152:153], v56 offset:0
    ds_read_b64_tr_b16 a[154:155], v56 offset:256
    ds_read_b64_tr_b16 a[156:157], v56 offset:8192
    ds_read_b64_tr_b16 a[158:159], v56 offset:8448
    s_mov_b32 s77, 32768
    s_call_b64 s[82:83], cf_dma
    s_waitcnt lgkmcnt(0)
    s_waitcnt vmcnt(8)
    v_add_u32 v55, 65536, v51
    v_xor_b32 v56, 32, v55
    ds_read_b64_tr_b16 a[160:161], v55 offset:0
    ds_read_b64_tr_b16 a[162:163], v55 offset:256
    ds_read_b64_tr_b16 a[164:165], v55 offset:8192
    ds_read_b64_tr_b16 a[166:167], v55 offset:8448
    s_cmp_eq_u32 s88, 0
    s_cbranch_scc1 cf_ncp904
    s_waitcnt vmcnt(8)
    v_max_u32 v34, 1, v34
    v_cmp_eq_u32 vcc, 1, v34
    s_cbranch_vccnz cf_ncp904
    v_cmp_ne_u32 vcc, v34, v35
    s_cbranch_vccnz cf_ncp904
    s_mov_b32 s88, 0
    s_mov_b32 s72, 5
    s_lshl_b32 s74, s73, 19
    s_add_u32 s74, s74, 96468992
    s_add_u32 s50, s4, s74
    s_addc_u32 s51, s5, 0
    s_add_u32 s52, s50, 147456
    s_addc_u32 s53, s51, 0
    s_lshl_b32 s67, s13, 6
    v_and_b32 v54, 63, v48
    v_lshrrev_b32 v48, 13, v48
    v_lshl_add_u32 v48, v48, 8, v54
cf_ncp904:
    s_cmp_eq_u32 s88, 0
    s_cbranch_scc1 cf_cpe925
    s_lshl_b32 s89, s73, 7
    s_add_u32 s89, s89, 125853696
    v_min_u32 v33, 11, v57
    v_lshlrev_b32 v33, 2, v33
    buffer_load_dword v34, off, s[96:99], 0 offset:64 sc1
    buffer_load_dword v35, v33, s[4:7], s89 offen sc1
cf_cpe925:
    s_xor_b32 s78, s75, 3145728
    s_lshr_b32 s78, s78, s72
    s_add_u32 s78, s78, s67
    s_mov_b64 s[8:9], s[50:51]
    v_mov_b32 v58, v48
    s_lshr_b32 s79, 131072, s72
    s_add_u32 s80, s66, 32768
    s_mov_b32 s76, 0
    s_mov_b32 s77, 8192
    s_call_b64 s[82:83], cf_dma
    ds_read_b64_tr_b16 a[168:169], v56 offset:0
    ds_read_b64_tr_b16 a[170:171], v56 offset:256
    ds_read_b64_tr_b16 a[172:173], v56 offset:8192
    ds_read_b64_tr_b16 a[174:175], v56 offset:8448
    s_mov_b32 s77, 16384
    s_call_b64 s[82:83], cf_dma
    v_readfirstlane_b32 s41, v46
    v_mov_b32 v46, 1
    v_mov_b32 v47, 0
    s_cmp_eq_u32 s41, 127
    s_cselect_b64 exec, 1, 0
    buffer_atomic_cmpswap v[46:47], off, s[96:99], 0 offset:140
    s_mov_b64 exec, -1
    s_waitcnt lgkmcnt(0)
    v_add_u32 v55, 81920, v51
    v_xor_b32 v56, 32, v55
    ds_read_b64_tr_b16 a[176:177], v55 offset:0
    ds_read_b64_tr_b16 a[178:179], v55 offset:256
    ds_read_b64_tr_b16 a[180:181], v55 offset:8192
    ds_read_b64_tr_b16 a[182:183], v55 offset:8448
    s_mov_b32 s77, 24576
    s_call_b64 s[82:83], cf_dma
    ds_read_b64_tr_b16 a[184:185], v56 offset:0
    ds_read_b64_tr_b16 a[186:187], v56 offset:256
    ds_read_b64_tr_b16 a[188:189], v56 offset:8192
    ds_read_b64_tr_b16 a[190:191], v56 offset:8448
    s_mov_b32 s77, 32768
    s_call_b64 s[82:83], cf_dma
    s_waitcnt lgkmcnt(0)
    s_waitcnt vmcnt(8)
    v_add_u32 v55, 0, v51
    v_xor_b32 v56, 32, v55
    ds_read_b64_tr_b16 a[48:49], v55 offset:0
    ds_read_b64_tr_b16 a[50:51], v55 offset:256
    ds_read_b64_tr_b16 a[52:53], v55 offset:8192
    ds_read_b64_tr_b16 a[54:55], v55 offset:8448
    s_lshr_b32 s78, 4194304, s72
    s_add_u32 s78, s78, s67
    s_mov_b32 s81, 0
    s_add_u32 s80, s66, 98304
    s_mov_b32 s76, 0
    s_mov_b32 s77, 8192
    s_call_b64 s[82:83], cf_dma
    ds_read_b64_tr_b16 a[56:57], v56 offset:0
    ds_read_b64_tr_b16 a[58:59], v56 offset:256
    ds_read_b64_tr_b16 a[60:61], v56 offset:8192
    ds_read_b64_tr_b16 a[62:63], v56 offset:8448
    s_mov_b32 s77, 16384
    s_call_b64 s[82:83], cf_dma
    s_waitcnt lgkmcnt(0)
    v_add_u32 v55, 16384, v51
    v_xor_b32 v56, 32, v55
    ds_read_b64_tr_b16 a[64:65], v55 offset:0
    ds_read_b64_tr_b16 a[66:67], v55 offset:256
    ds_read_b64_tr_b16 a[68:69], v55 offset:8192
    ds_read_b64_tr_b16 a[70:71], v55 offset:8448
    s_cmp_eq_u32 s88, 0
    s_cbranch_scc1 cf_ncp1000
    s_waitcnt vmcnt(12)
    v_max_u32 v34, 1, v34
    v_cmp_eq_u32 vcc, 1, v34
    s_cbranch_vccnz cf_ncp1000
    v_cmp_ne_u32 vcc, v34, v35
    s_cbranch_vccnz cf_ncp1000
    s_mov_b32 s88, 0
    s_mov_b32 s72, 5
    s_lshl_b32 s74, s73, 19
    s_add_u32 s74, s74, 96468992
    s_add_u32 s50, s4, s74
    s_addc_u32 s51, s5, 0
    s_add_u32 s52, s50, 147456
    s_addc_u32 s53, s51, 0
    s_lshl_b32 s67, s13, 6
    v_and_b32 v54, 63, v48
    v_lshrrev_b32 v48, 13, v48
    v_lshl_add_u32 v48, v48, 8, v54
cf_ncp1000:
    s_xor_b32 s78, s75, 1048576
    s_lshr_b32 s78, s78, s72
    s_add_u32 s78, s78, s67
    s_mov_b64 s[8:9], s[50:51]
    v_mov_b32 v58, v48
    s_lshr_b32 s79, 131072, s72
    s_mov_b32 s81, s93
    s_add_u32 s80, s66, 114688
    s_mov_b32 s76, 0
    s_mov_b32 s77, 8192
    s_call_b64 s[82:83], cf_dma
    ds_read_b64_tr_b16 a[72:73], v56 offset:0
    ds_read_b64_tr_b16 a[74:75], v56 offset:256
    ds_read_b64_tr_b16 a[76:77], v56 offset:8192
    ds_read_b64_tr_b16 a[78:79], v56 offset:8448
    s_mov_b32 s77, 16384
    s_call_b64 s[82:83], cf_dma
    s_waitcnt lgkmcnt(0)
    s_waitcnt vmcnt(8)
    v_add_u32 v55, 32768, v51
    v_xor_b32 v56, 32, v55
    ds_read_b64_tr_b16 a[80:81], v55 offset:0
    ds_read_b64_tr_b16 a[82:83], v55 offset:256
    ds_read_b64_tr_b16 a[84:85], v55 offset:8192
    ds_read_b64_tr_b16 a[86:87], v55 offset:8448
    s_mov_b32 s77, 24576
    s_call_b64 s[82:83], cf_dma
    ds_read_b64_tr_b16 a[88:89], v56 offset:0
    ds_read_b64_tr_b16 a[90:91], v56 offset:256
    ds_read_b64_tr_b16 a[92:93], v56 offset:8192
    ds_read_b64_tr_b16 a[94:95], v56 offset:8448
    s_mov_b32 s77, 32768
    s_call_b64 s[82:83], cf_dma
    s_waitcnt lgkmcnt(0)
    v_add_u32 v55, 49152, v51
    v_xor_b32 v56, 32, v55
    ds_read_b64_tr_b16 a[96:97], v55 offset:0
    ds_read_b64_tr_b16 a[98:99], v55 offset:256
    ds_read_b64_tr_b16 a[100:101], v55 offset:8192
    ds_read_b64_tr_b16 a[102:103], v55 offset:8448
    s_xor_b32 s78, s75, 0
    s_lshr_b32 s78, s78, s72
    s_add_u32 s78, s78, s67
    s_add_u32 s80, s66, 65536
    s_mov_b32 s76, 0
    s_mov_b32 s77, 8192
    s_call_b64 s[82:83], cf_dma
    ds_read_b64_tr_b16 a[104:105], v56 offset:0
    ds_read_b64_tr_b16 a[106:107], v56 offset:256
    ds_read_b64_tr_b16 a[108:109], v56 offset:8192
    ds_read_b64_tr_b16 a[110:111], v56 offset:8448
    s_mov_b32 s77, 16384
    s_call_b64 s[82:83], cf_dma
    s_waitcnt lgkmcnt(0)
    s_waitcnt vmcnt(12)
    v_add_u32 v55, 98304, v51
    v_xor_b32 v56, 32, v55
    ds_read_b64_tr_b16 a[112:113], v55 offset:0
    ds_read_b64_tr_b16 a[114:115], v55 offset:256
    ds_read_b64_tr_b16 a[116:117], v55 offset:8192
    ds_read_b64_tr_b16 a[118:119], v55 offset:8448
    s_mov_b32 s77, 24576
    s_call_b64 s[82:83], cf_dma
    ds_read_b64_tr_b16 a[120:121], v56 offset:0
    ds_read_b64_tr_b16 a[122:123], v56 offset:256
    ds_read_b64_tr_b16 a[124:125], v56 offset:8192
    ds_read_b64_tr_b16 a[126:127], v56 offset:8448
    s_mov_b32 s77, 32768
    s_call_b64 s[82:83], cf_dma
    s_waitcnt lgkmcnt(0)
    s_waitcnt vmcnt(8)
    v_add_u32 v55, 114688, v51
    v_xor_b32 v56, 32, v55
    ds_read_b64_tr_b16 a[16:17], v55 offset:0
    ds_read_b64_tr_b16 a[18:19], v55 offset:256
    ds_read_b64_tr_b16 a[20:21], v55 offset:8192
    ds_read_b64_tr_b16 a[22:23], v55 offset:8448
    s_xor_b32 s78, s75, 0
    s_lshr_b32 s78, s78, s72
    s_add_u32 s78, s78, s67
    s_mov_b64 s[8:9], s[52:53]
    s_add_u32 s80, s66, 0
    s_mov_b32 s76, 0
    s_mov_b32 s77, 8192
    s_call_b64 s[82:83], cf_dma
    ds_read_b64_tr_b16 a[24:25], v56 offset:0
    ds_read_b64_tr_b16 a[26:27], v56 offset:256
    ds_read_b64_tr_b16 a[28:29], v56 offset:8192
    ds_read_b64_tr_b16 a[30:31], v56 offset:8448
    s_mov_b32 s77, 16384
    s_call_b64 s[82:83], cf_dma
    s_waitcnt lgkmcnt(0)
    v_add_u32 v55, 131072, v51
    v_xor_b32 v56, 32, v55
    ds_read_b64_tr_b16 a[32:33], v55 offset:0
    ds_read_b64_tr_b16 a[34:35], v55 offset:256
    ds_read_b64_tr_b16 a[36:37], v55 offset:8192
    ds_read_b64_tr_b16 a[38:39], v55 offset:8448
    s_mov_b32 s77, 24576
    s_call_b64 s[82:83], cf_dma
    ds_read_b64_tr_b16 a[40:41], v56 offset:0
    ds_read_b64_tr_b16 a[42:43], v56 offset:256
    ds_read_b64_tr_b16 a[44:45], v56 offset:8192
    ds_read_b64_tr_b16 a[46:47], v56 offset:8448
    s_mov_b32 s77, 32768
    s_call_b64 s[82:83], cf_dma
    s_waitcnt lgkmcnt(0)
    s_waitcnt vmcnt(8)
    v_add_u32 v55, 65536, v51
    v_xor_b32 v56, 32, v55
    ds_read_b64_tr_b16 v[0:1], v55 offset:0
    ds_read_b64_tr_b16 v[2:3], v55 offset:256
    ds_read_b64_tr_b16 v[4:5], v55 offset:8192
    ds_read_b64_tr_b16 v[6:7], v55 offset:8448
    s_xor_b32 s78, s75, 1048576
    s_lshr_b32 s78, s78, s72
    s_add_u32 s78, s78, s67
    s_add_u32 s80, s66, 32768
    s_mov_b32 s76, 0
    s_mov_b32 s77, 8192
    s_call_b64 s[82:83], cf_dma
    ds_read_b64_tr_b16 v[8:9], v56 offset:0
    ds_read_b64_tr_b16 v[10:11], v56 offset:256
    ds_read_b64_tr_b16 v[12:13], v56 offset:8192
    ds_read_b64_tr_b16 v[14:15], v56 offset:8448
    s_mov_b32 s77, 16384
    s_call_b64 s[82:83], cf_dma
    s_waitcnt lgkmcnt(0)
    ds_write_b128 v62, v[0:3] offset:8192
    ds_write_b128 v62, v[4:7] offset:12288
    ds_write_b128 v62, v[8:11] offset:16384
    ds_write_b128 v62, v[12:15] offset:20480
    s_waitcnt lgkmcnt(0)
    v_add_u32 v55, 81920, v51
    v_xor_b32 v56, 32, v55
    ds_read_b64_tr_b16 a[0:1], v55 offset:0
    ds_read_b64_tr_b16 a[2:3], v55 offset:256
    ds_read_b64_tr_b16 a[4:5], v55 offset:8192
    ds_read_b64_tr_b16 a[6:7], v55 offset:8448
    s_mov_b32 s77, 24576
    s_call_b64 s[82:83], cf_dma
    ds_read_b64_tr_b16 a[8:9], v56 offset:0
    ds_read_b64_tr_b16 a[10:11], v56 offset:256
    ds_read_b64_tr_b16 a[12:13], v56 offset:8192
    ds_read_b64_tr_b16 a[14:15], v56 offset:8448
    s_mov_b32 s77, 32768
    s_call_b64 s[82:83], cf_dma
    s_waitcnt lgkmcnt(0)
    s_waitcnt vmcnt(8)
    v_add_u32 v55, 0, v51
    v_xor_b32 v56, 32, v55
    ds_read_b64_tr_b16 v[0:1], v55 offset:0
    ds_read_b64_tr_b16 v[2:3], v55 offset:256
    ds_read_b64_tr_b16 v[4:5], v55 offset:8192
    ds_read_b64_tr_b16 v[6:7], v55 offset:8448
    s_xor_b32 s94, s13, 0
    s_mul_i32 s94, s94, 36864
    s_add_u32 s94, s94, s92
    s_lshr_b32 s74, s13, 1
    s_lshl_b32 s74, s74, 6
    s_add_u32 s94, s94, s74
    s_add_u32 s78, s94, 1024
    s_mov_b64 s[8:9], s[56:57]
    v_mov_b32 v58, v50
    s_mov_b32 s79, 18432
    s_mov_b32 s81, 0
    s_add_u32 s80, s66, 147456
    s_mov_b32 s76, 0
    s_mov_b32 s77, 8192
    s_call_b64 s[82:83], cf_dma
    ds_read_b64_tr_b16 v[8:9], v56 offset:0
    ds_read_b64_tr_b16 v[10:11], v56 offset:256
    ds_read_b64_tr_b16 v[12:13], v56 offset:8192
    ds_read_b64_tr_b16 v[14:15], v56 offset:8448
    s_xor_b32 s94, s13, 2
    s_mul_i32 s94, s94, 36864
    s_add_u32 s94, s94, s92
    s_lshr_b32 s74, s13, 1
    s_lshl_b32 s74, s74, 6
    s_add_u32 s94, s94, s74
    s_add_u32 s78, s94, 1024
    s_mov_b32 s77, 16384
    s_call_b64 s[82:83], cf_dma
    s_waitcnt lgkmcnt(0)
    ds_write_b128 v61, v[0:3] offset:0
    ds_write_b128 v61, v[4:7] offset:4096
    ds_write_b128 v61, v[8:11] offset:8192
    ds_write_b128 v61, v[12:15] offset:12288
    s_waitcnt lgkmcnt(0)
    v_add_u32 v55, 16384, v51
    v_xor_b32 v56, 32, v55
    ds_read_b64_tr_b16 v[0:1], v55 offset:0
    ds_read_b64_tr_b16 v[2:3], v55 offset:256
    ds_read_b64_tr_b16 v[4:5], v55 offset:8192
    ds_read_b64_tr_b16 v[6:7], v55 offset:8448
    s_xor_b32 s94, s13, 3
    s_mul_i32 s94, s94, 36864
    s_add_u32 s94, s94, s92
    s_lshl_b32 s74, s13, 7
    s_add_u32 s94, s94, s74
    s_add_u32 s78, s94, 512
    v_mov_b32 v58, v49
    s_mov_b32 s79, 9216
    s_add_u32 s80, s66, 131072
    s_mov_b32 s76, 0
    s_mov_b32 s77, 8192
    s_call_b64 s[82:83], cf_dma
    ds_read_b64_tr_b16 v[8:9], v56 offset:0
    ds_read_b64_tr_b16 v[10:11], v56 offset:256
    ds_read_b64_tr_b16 v[12:13], v56 offset:8192
    ds_read_b64_tr_b16 v[14:15], v56 offset:8448
    s_mov_b32 s77, 16384
    s_call_b64 s[82:83], cf_dma
    s_waitcnt lgkmcnt(0)
    ds_write_b128 v61, v[0:3] offset:16384
    ds_write_b128 v61, v[4:7] offset:20480
    ds_write_b128 v61, v[8:11] offset:24576
    ds_write_b128 v61, v[12:15] offset:28672
    s_waitcnt lgkmcnt(0)
    s_waitcnt vmcnt(8)
    v_add_u32 v55, 32768, v51
    v_xor_b32 v56, 32, v55
    ds_read_b64_tr_b16 v[0:1], v55 offset:0
    ds_read_b64_tr_b16 v[2:3], v55 offset:256
    ds_read_b64_tr_b16 v[4:5], v55 offset:8192
    ds_read_b64_tr_b16 v[6:7], v55 offset:8448
    s_xor_b32 s94, s13, 2
    s_mul_i32 s94, s94, 36864
    s_add_u32 s94, s94, s92
    s_lshl_b32 s74, s13, 7
    s_add_u32 s94, s94, s74
    s_add_u32 s78, s94, 512
    s_add_u32 s80, s66, 114688
    s_mov_b32 s76, 0
    s_mov_b32 s77, 8192
    s_call_b64 s[82:83], cf_dma
    ds_read_b64_tr_b16 v[8:9], v56 offset:0
    ds_read_b64_tr_b16 v[10:11], v56 offset:256
    ds_read_b64_tr_b16 v[12:13], v56 offset:8192
    ds_read_b64_tr_b16 v[14:15], v56 offset:8448
    s_mov_b32 s77, 16384
    s_call_b64 s[82:83], cf_dma
    s_waitcnt lgkmcnt(0)
    ds_write_b128 v61, v[0:3] offset:32768
    ds_write_b128 v61, v[4:7] offset:36864
    ds_write_b128 v61, v[8:11] offset:40960
    ds_write_b128 v61, v[12:15] offset:45056
    s_waitcnt lgkmcnt(0)
    v_add_u32 v55, 49152, v51
    v_xor_b32 v56, 32, v55
    ds_read_b64_tr_b16 v[0:1], v55 offset:0
    ds_read_b64_tr_b16 v[2:3], v55 offset:256
    ds_read_b64_tr_b16 v[4:5], v55 offset:8192
    ds_read_b64_tr_b16 v[6:7], v55 offset:8448
    s_lshr_b32 s78, 4194304, s72
    s_add_u32 s78, s78, s67
    s_mov_b64 s[8:9], s[52:53]
    v_mov_b32 v58, v48
    s_lshr_b32 s79, 131072, s72
    s_add_u32 s80, s66, 81920
    s_mov_b32 s76, 0
    s_mov_b32 s77, 8192
    s_call_b64 s[82:83], cf_dma
    ds_read_b64_tr_b16 v[8:9], v56 offset:0
    ds_read_b64_tr_b16 v[10:11], v56 offset:256
    ds_read_b64_tr_b16 v[12:13], v56 offset:8192
    ds_read_b64_tr_b16 v[14:15], v56 offset:8448
    s_mov_b32 s77, 16384
    s_call_b64 s[82:83], cf_dma
    s_waitcnt lgkmcnt(0)
    ds_write_b128 v61, v[0:3] offset:49152
    ds_write_b128 v61, v[4:7] offset:53248
    ds_write_b128 v61, v[8:11] offset:57344
    ds_write_b128 v61, v[12:15] offset:61440
    s_waitcnt lgkmcnt(0)
    buffer_load_dword v24, off, s[96:99], 0 offset:140 sc1
    buffer_load_dword v25, off, s[96:99], 0 offset:64 sc1
    s_lshr_b32 s84, s12, 1
    s_lshl_b32 s84, s84, 8
    s_add_u32 s84, s84, 125829120
    v_bfe_u32 v26, v61, 4, 6
    v_min_u32 v26, 11, v26
    v_lshlrev_b32 v26, 2, v26
    buffer_load_dword v27, v26, s[4:7], s84 offen sc1
    s_waitcnt vmcnt(15)
    v_add_u32 v55, 147456, v53
    ds_read_b64_tr_b16 v[0:1], v55 offset:0
    ds_read_b64_tr_b16 v[2:3], v55 offset:128
    ds_read_b64_tr_b16 v[4:5], v55 offset:512
    ds_read_b64_tr_b16 v[6:7], v55 offset:640
    ds_read_b64_tr_b16 v[8:9], v55 offset:8192
    ds_read_b64_tr_b16 v[10:11], v55 offset:8320
    ds_read_b64_tr_b16 v[12:13], v55 offset:8704
    ds_read_b64_tr_b16 v[14:15], v55 offset:8832
    s_waitcnt lgkmcnt(0)
    s_barrier
    ds_write_b128 v63, v[0:3] offset:49152
    ds_write_b128 v63, v[4:7] offset:53248
    s_barrier
    ds_write_b128 v63, v[8:11] offset:57344
    ds_write_b128 v63, v[12:15] offset:61440
    s_waitcnt lgkmcnt(0)
    v_lshlrev_b32 v45, 3, v61
    s_lshl_b32 s40, s12, 14
    s_add_u32 s40, s40, 65536
    s_lshl_b32 s41, s12, 11
    s_sub_u32 s41, s41, 12288
    v_add_u32 v30, s40, v45
    v_add_u32 v45, s41, v45
    v_cmp_gt_u32 vcc, 1536, v61
    s_nop 1
    v_cndmask_b32 v45, v45, v30, vcc
    s_lshl_b32 s40, s12, 16
    s_add_u32 s40, s40, 25151488
    v_lshlrev_b32 v30, 3, v61
    v_add_u32 v30, s40, v30
    v_cmp_gt_u32 vcc, 1792, v61
    s_nop 1
    v_cndmask_b32 v45, v30, v45, vcc
    v_cmp_gt_u32 vcc, 2944, v61
    s_mov_b32 s40, 67108864
    s_mov_b64 exec, vcc
    buffer_load_dword v30, v45, s[4:7], s40 offen sc1
    s_mov_b64 exec, -1
    s_waitcnt vmcnt(11)
    v_add_u32 v55, 131072, v52
    ds_read_b64_tr_b16 v[0:1], v55 offset:0
    ds_read_b64_tr_b16 v[2:3], v55 offset:256
    ds_read_b64_tr_b16 v[4:5], v55 offset:4096
    ds_read_b64_tr_b16 v[6:7], v55 offset:4352
    ds_read_b64_tr_b16 v[8:9], v55 offset:64
    ds_read_b64_tr_b16 v[10:11], v55 offset:320
    ds_read_b64_tr_b16 v[12:13], v55 offset:4160
    ds_read_b64_tr_b16 v[14:15], v55 offset:4416
    s_waitcnt lgkmcnt(0)
    s_barrier
    ds_write_b128 v63, v[0:3] offset:32768
    ds_write_b128 v63, v[4:7] offset:36864
    s_barrier
    ds_write_b128 v63, v[8:11] offset:40960
    ds_write_b128 v63, v[12:15] offset:45056
    s_waitcnt lgkmcnt(0)
    s_waitcnt vmcnt(7)
    v_add_u32 v55, 114688, v52
    ds_read_b64_tr_b16 v[0:1], v55 offset:0
    ds_read_b64_tr_b16 v[2:3], v55 offset:256
    ds_read_b64_tr_b16 v[4:5], v55 offset:4096
    ds_read_b64_tr_b16 v[6:7], v55 offset:4352
    ds_read_b64_tr_b16 v[8:9], v55 offset:64
    ds_read_b64_tr_b16 v[10:11], v55 offset:320
    ds_read_b64_tr_b16 v[12:13], v55 offset:4160
    ds_read_b64_tr_b16 v[14:15], v55 offset:4416
    s_waitcnt lgkmcnt(0)
    s_barrier
    ds_write_b128 v63, v[0:3] offset:16384
    ds_write_b128 v63, v[4:7] offset:20480
    s_barrier
    ds_write_b128 v63, v[8:11] offset:24576
    ds_write_b128 v63, v[12:15] offset:28672
    s_waitcnt lgkmcnt(0)
    v_min_u32 v36, -2, v36
    v_min_u32 v37, -2, v37
    v_min_u32 v38, -2, v38
    v_min_u32 v39, -2, v39
    v_min_u32 v40, -2, v40
    v_min_u32 v41, -2, v41
    v_min_u32 v42, -2, v42
    v_min_u32 v43, -2, v43
    v_min_u32 v44, -2, v44
    s_lshl_b32 s14, s12, 16
    s_add_u32 s14, s14, 92274688
    s_add_u32 s41, s14, 4096
    s_add_u32 s42, s14, 8192
    v_lshrrev_b32 v45, 2, v61
    buffer_store_dwordx4 v[36:39], v61, s[4:7], s14 offen
    buffer_store_dwordx4 v[40:43], v61, s[4:7], s41 offen
    buffer_store_dword v44, v45, s[4:7], s42 offen
    s_waitcnt vmcnt(1)
    v_readfirstlane_b32 s95, v25
    v_readfirstlane_b32 s85, v24
    s_add_u32 s86, s95, 2
    s_waitcnt vmcnt(0)
    v_subrev_u32 v27, s86, v27
    v_cmp_lt_u32 s[86:87], 64, v27
    s_cmp_eq_u32 s95, 0
    s_cselect_b64 s[86:87], -1, s[86:87]
    s_cmp_lg_u64 s[86:87], 0
    s_cbranch_scc1 cf_nt
    s_add_u32 s40, s24, 524288
    buffer_load_dword v30, v79, s[4:7], s24 offen sc1
    buffer_load_dword v30, v79, s[4:7], s40 offen sc1
cf_nt:
    s_waitcnt vmcnt(3)
    v_add_u32 v55, 81920, v51
    v_xor_b32 v56, 32, v55
    ds_read_b64_tr_b16 v[0:1], v55 offset:0
    ds_read_b64_tr_b16 v[2:3], v55 offset:256
    ds_read_b64_tr_b16 v[4:5], v55 offset:8192
    ds_read_b64_tr_b16 v[6:7], v55 offset:8448
    ds_read_b64_tr_b16 v[8:9], v56 offset:0
    ds_read_b64_tr_b16 v[10:11], v56 offset:256
    ds_read_b64_tr_b16 v[12:13], v56 offset:8192
    ds_read_b64_tr_b16 v[14:15], v56 offset:8448
    s_waitcnt lgkmcnt(0)
    ds_write_b128 v62, v[0:3] offset:24576
    ds_write_b128 v62, v[4:7] offset:28672
    ds_write_b128 v62, v[8:11] offset:32768
    ds_write_b128 v62, v[12:15] offset:36864
    s_waitcnt lgkmcnt(0)
    s_barrier
    s_mov_b32 s88, 4194304
gn2:
    s_cmp_lg_u32 s95, 0
    s_cbranch_scc1 gn2x
    buffer_load_dword v27, off, s[96:99], 0 offset:64 sc1
    s_sub_u32 s88, s88, 1
    s_cbranch_scc1 gn2x
    s_waitcnt vmcnt(0)
    v_readfirstlane_b32 s95, v27
    s_nop 1
    s_branch gn2
gn2x:
    ds_write_b128 v78, v[16:19] offset:8704
    ds_write_b128 v65, v[20:23] offset:10240
    v_mov_b32 v44, s95
    v_mov_b32 v45, s95
    v_mov_b32 v46, s95
    v_mov_b32 v47, s95
    v_mov_b32 v48, 108288
    ds_write_b128 v48, v[44:47]
    s_waitcnt vmcnt(0) lgkmcnt(0)
    s_cmp_eq_u32 s85, 1
    s_cbranch_scc1 cf_run
    s_mov_b32 s40, 131072
cf_startpoll:
    buffer_load_dword v3, off, s[96:99], 0 offset:140 sc1
    s_waitcnt vmcnt(0)
    v_readfirstlane_b32 s85, v3
    s_nop 0
    s_cmp_eq_u32 s85, 1
    s_cbranch_scc1 cf_run
    s_cmp_eq_u32 s85, 2
    s_cbranch_scc1 cf_leave
    s_sleep 1
    s_sub_u32 s40, s40, 1
    s_cbranch_scc0 cf_startpoll
    v_mov_b32 v4, 2
    v_mov_b32 v5, 0
    s_mov_b64 exec, 1
    buffer_atomic_cmpswap v[4:5], off, s[96:99], 0 offset:140
    s_mov_b64 exec, -1
    s_mov_b32 s40, 1048576
    s_branch cf_startpoll
cf_leave:
    v_lshrrev_b32 v0, 4, v61
    s_mov_b32 s32, s13
    s_load_dwordx16 s[48:63], s[0:1], 0
    s_waitcnt lgkmcnt(0)
    s_branch L_helper
cf_run:
    s_cmp_eq_u64 s[86:87], 0
    s_cbranch_scc1 cf_kvok
    s_lshr_b32 s92, s12, 1
    s_lshl_b32 s92, s92, 8
    s_add_u32 s92, s92, 125829120
    v_bfe_u32 v2, v61, 4, 6
    v_min_u32 v2, 11, v2
    v_lshlrev_b32 v2, 2, v2
    s_add_u32 s93, s95, 2
    s_mov_b32 s94, 4194304
cf_kv0:
    buffer_load_dword v3, v2, s[4:7], s92 offen sc1
    s_sub_u32 s94, s94, 1
    s_cbranch_scc1 cf_kv0_go
    s_waitcnt vmcnt(0)
    v_subrev_u32 v3, s93, v3
    v_cmp_lt_u32 vcc, 64, v3
    s_cbranch_vccz cf_kv0_go
    s_sleep 2
    s_branch cf_kv0
cf_kv0_go:
    s_add_u32 s40, s24, 524288
    buffer_load_dword v30, v79, s[4:7], s24 offen sc1
    buffer_load_dword v30, v79, s[4:7], s40 offen sc1
    s_waitcnt vmcnt(0)
cf_kvok:
    s_mov_b32 m0, 108032
    s_add_u32 s24, s24, 1048576
    s_mov_b32 s66, 0x201
    s_mov_b32 s67, 0xc0000000
    s_add_u32 s15, s14, 4096
    s_add_u32 s16, s14, 8192
    ds_read_b128 v[32:35], v62 offset:16384
    ds_read_b128 v[36:39], v62 offset:20480
    ds_read_b128 v[40:43], v61 offset:0
    ds_read_b128 v[44:47], v61 offset:4096
    ds_read_b128 v[48:51], v61 offset:8192
    ds_read_b128 v[52:55], v61 offset:12288
    s_add_u32 s18, s14, s31
    s_mov_b32 s29, 1048576
    buffer_load_dwordx4 v[24:27], v61, s[4:7], s14 offen nt
.p2align 6
cf_loop:
    v_mov_b64 v[0:1], 0
    v_mov_b64 v[2:3], 0
    v_mov_b64 v[4:5], 0
    v_mov_b64 v[6:7], 0
    v_mov_b64 v[8:9], 0
    v_mov_b64 v[10:11], 0
    v_mov_b64 v[12:13], 0
    v_mov_b64 v[14:15], 0
cf_loop2:
    ds_read_b128 v[16:19], v62 offset:8192
    ds_read_b128 v[20:23], v62 offset:12288
    v_lshrrev_b32 v56, 2, v61
    v_add_u32 v58, 106496, v56
    s_mov_b32 s29, 1048576
    s_nop 13
    buffer_load_dwordx4 v[24:27], v61, s[4:7], s14 offen nt
    s_waitcnt lgkmcnt(0)
cf_chk0:
    s_waitcnt vmcnt(1)
cf_chk0b:
    v_max3_u32 v57, v24, v25, v26
    v_max_u32 v57, v57, v27
    v_cmp_eq_u32 vcc, -1, v57
    ds_write_b128 v62, v[24:27] offset:40960
    s_cbranch_vccnz cf_spin0
    v_smfmac_f32_16x16x64_bf16 v[0:3], v[24:27], v[16:23], v60
    s_mov_b32 m0, s58
    s_nop 0
    buffer_load_dwordx4 v61, s[4:7], s15 offen nt lds
    v_smfmac_f32_16x16x64_bf16 v[8:11], v[24:27], v[32:39], v60
    s_mov_b32 m0, s59
    s_nop 0
    buffer_load_dword v56, s[4:7], s16 offen nt lds
    v_smfmac_f32_16x16x64_bf16 v[12:15], v[24:27], v[48:55], v60
    ds_read_b128 v[32:35], v61 offset:16384
    v_mfma_f32_16x16x16_bf16 v[16:19], v[72:73], v[72:73], 0
    ds_read_b128 v[36:39], v61 offset:20480
    s_waitcnt lgkmcnt(2)
    s_barrier
    ds_read_b128 v[48:51], v63 offset:0
    v_mfma_f32_16x16x16_bf16 v[20:23], v[72:73], v[72:73], 0
    ds_read_b128 v[52:55], v64 offset:0
    v_smfmac_f32_16x16x64_bf16 v[4:7], v[24:27], v[40:47], v60
    ds_read_b128 v[40:43], v61 offset:24576
    v_smfmac_f32_16x16x64_bf16 v[16:19], v[24:27], a[192:199], v60
    ds_read_b128 v[44:47], v61 offset:28672
    v_smfmac_f32_16x16x64_bf16 v[20:23], v[24:27], a[200:207], v60
    s_mov_b32 m0, 108032
    s_waitcnt lgkmcnt(3)
    v_smfmac_f32_16x16x64_bf16 v[0:3], v[48:51], a[0:7], v60
    s_add_u32 s43, s14, s31
    s_add_u32 s41, s14, 16384
    v_smfmac_f32_16x16x64_bf16 v[4:7], v[48:51], v[32:39], v60
    ds_read_b128 v[32:35], v61 offset:32768
    v_smfmac_f32_16x16x64_bf16 v[8:11], v[48:51], a[8:15], v60
    ds_read_b128 v[36:39], v61 offset:36864
    s_waitcnt lgkmcnt(2)
    v_smfmac_f32_16x16x64_bf16 v[12:15], v[48:51], v[40:47], v60
    ds_read_b128 v[40:43], v61 offset:40960
    v_smfmac_f32_16x16x64_bf16 v[16:19], v[48:51], a[208:215], v60
    ds_read_b128 v[44:47], v61 offset:45056
    v_smfmac_f32_16x16x64_bf16 v[20:23], v[48:51], a[216:223], v60
    ds_read_b128 v[48:51], v71 offset:0
    v_smfmac_f32_16x16x64_bf16 v[0:3], v[52:55], a[16:23], v60
    s_waitcnt vmcnt(0)
    ds_read_b128 v[28:31], v62 offset:45056
    s_waitcnt lgkmcnt(4)
    v_smfmac_f32_16x16x64_bf16 v[4:7], v[52:55], v[32:39], v60
    ds_read_b32 v59, v58
    buffer_load_dwordx4 v[24:27], v61, s[4:7], s23 offen offset:0 sc1
    v_smfmac_f32_16x16x64_bf16 v[8:11], v[52:55], a[24:31], v60
    ds_read_b128 v[32:35], v61 offset:49152
    s_waitcnt lgkmcnt(4)
    v_smfmac_f32_16x16x64_bf16 v[12:15], v[52:55], v[40:47], v60
    ds_read_b128 v[36:39], v61 offset:53248
    v_smfmac_f32_16x16x64_bf16 v[16:19], v[52:55], a[224:231], v60
    ds_read_b128 v[40:43], v61 offset:57344
    v_smfmac_f32_16x16x64_bf16 v[20:23], v[52:55], a[232:239], v60
    ds_read_b128 v[44:47], v61 offset:61440
    s_waitcnt lgkmcnt(4)
    v_smfmac_f32_16x16x64_bf16 v[0:3], v[48:51], a[32:39], v60
    v_max3_u32 v57, v28, v29, v30
    v_smfmac_f32_16x16x64_bf16 v[8:11], v[48:51], a[40:47], v60
    v_max3_u32 v57, v57, v31, v59
    s_waitcnt lgkmcnt(2)
    v_smfmac_f32_16x16x64_bf16 v[4:7], v[48:51], v[32:39], v60
    buffer_load_dwordx4 v[32:35], v61, s[4:7], s23 offen offset:1024 sc1
    v_cmp_eq_u32 vcc, -1, v57
    v_smfmac_f32_16x16x64_bf16 v[16:19], v[48:51], a[240:247], v60
    v_smfmac_f32_16x16x64_bf16 v[20:23], v[48:51], a[248:255], v60
    s_cbranch_vccnz cf_spin1
cf_go1:
    s_barrier
    ds_read_b128 v[52:55], v63 offset:4096
    s_waitcnt lgkmcnt(1)
    v_smfmac_f32_16x16x64_bf16 v[12:15], v[48:51], v[40:47], v60
    ds_read_b128 v[48:51], v64 offset:4096
    v_smfmac_f32_16x16x64_bf16 v[0:3], v[28:31], a[48:55], v60
    buffer_load_dwordx4 v[40:43], v61, s[4:7], s23 offen offset:2048 sc1
    v_smfmac_f32_16x16x64_bf16 v[8:11], v[28:31], a[56:63], v60
    ds_read_b128 v[56:59], v71 offset:4096
    s_and_b32 s41, s41, 65535
    v_smfmac_f32_16x16x64_bf16 v[4:7], v[28:31], a[128:135], v60
    ds_read_b128 v[36:39], v65 offset:8192
    s_add_u32 s41, s41, 67108864
    v_smfmac_f32_16x16x64_bf16 v[12:15], v[28:31], a[136:143], v60
    s_add_u32 s17, s41, s31
    s_and_b32 s30, s28, 1
    s_waitcnt lgkmcnt(3)
    v_smfmac_f32_16x16x64_bf16 v[0:3], v[52:55], a[64:71], v60
    buffer_load_dwordx4 v[44:47], v61, s[4:7], s23 offen offset:3072 sc1
    v_smfmac_f32_16x16x64_bf16 v[4:7], v[52:55], a[144:151], v60
    ds_read_b128 v[28:31], v78 offset:8704
    v_smfmac_f32_16x16x64_bf16 v[8:11], v[52:55], a[72:79], v60
    v_smfmac_f32_16x16x64_bf16 v[12:15], v[52:55], a[152:159], v60
    ds_read_b128 v[52:55], v62 offset:28672
    s_waitcnt lgkmcnt(4)
    v_smfmac_f32_16x16x64_bf16 v[0:3], v[48:51], a[80:87], v60
    v_smfmac_f32_16x16x64_bf16 v[4:7], v[48:51], a[160:167], v60
    v_smfmac_f32_16x16x64_bf16 v[8:11], v[48:51], a[88:95], v60
    buffer_load_dword v79, s[4:7], s24 offen sc1 lds
    v_smfmac_f32_16x16x64_bf16 v[12:15], v[48:51], a[168:175], v60
    v_smfmac_f32_16x16x64_bf16 v[16:19], v[48:51], v[112:119], v60
    v_smfmac_f32_16x16x64_bf16 v[20:23], v[48:51], v[120:127], v60
    ds_read_b128 v[48:51], v62 offset:24576
    s_waitcnt lgkmcnt(4)
    v_smfmac_f32_16x16x64_bf16 v[0:3], v[56:59], a[96:103], v60
    s_bitcmp1_b64 s[66:67], s28
    v_smfmac_f32_16x16x64_bf16 v[8:11], v[56:59], a[104:111], v60
    s_waitcnt lgkmcnt(3)
    v_smfmac_f32_16x16x64_bf16 v[0:3], v[36:39], a[112:119], v60
    v_smfmac_f32_16x16x64_bf16 v[8:11], v[36:39], a[120:127], v60
    v_smfmac_f32_16x16x64_bf16 v[4:7], v[56:59], a[176:183], v60
    s_waitcnt lgkmcnt(0)
    v_cvt_pk_bf16_f32 v0, v0, v1
    v_smfmac_f32_16x16x64_bf16 v[4:7], v[36:39], v[48:55], v60
    ds_read_b128 v[48:51], v62 offset:32768
    v_cvt_pk_bf16_f32 v8, v8, v9
    v_smfmac_f32_16x16x64_bf16 v[12:15], v[56:59], a[184:191], v60
    ds_read_b128 v[52:55], v62 offset:36864
    v_cvt_pk_bf16_f32 v9, v10, v11
    v_smfmac_f32_16x16x64_bf16 v[16:19], v[56:59], v[128:135], v60
    v_cvt_pk_bf16_f32 v1, v2, v3
    v_mfma_f32_16x16x16_bf16 v[8:11], v[8:9], v[28:29], 0
    v_cvt_pk_bf16_f32 v2, v4, v5
    v_cvt_pk_bf16_f32 v3, v6, v7
    v_smfmac_f32_16x16x64_bf16 v[20:23], v[56:59], v[136:143], v60
    s_mov_b64 exec, s[36:37]
    ds_read_b128 v[56:59], v69
    s_mov_b64 exec, -1
    v_mfma_f32_16x16x32_bf16 v[4:7], v[0:3], v[28:31], 0
    v_cvt_pk_bf16_f32 v2, v8, v9
    s_waitcnt lgkmcnt(1)
    v_smfmac_f32_16x16x64_bf16 v[12:15], v[36:39], v[48:55], v60
    ds_read_b128 v[48:51], v63 offset:4096
    v_cvt_pk_bf16_f32 v3, v10, v11
    s_waitcnt vmcnt(3)
    v_cvt_pk_bf16_f32 v0, v4, v5
    v_cvt_pk_bf16_f32 v1, v6, v7
    s_nop 1
    v_mfma_f32_16x16x32_bf16 v[4:7], v[32:35], v[0:3], 0
    v_cvt_pk_bf16_f32 v12, v12, v13
    v_cvt_pk_bf16_f32 v13, v14, v15
    s_nop 1
    v_mfma_f32_16x16x16_bf16 v[12:15], v[12:13], v[30:31], 0
    ds_read_b128 v[52:55], v62 offset:45056
    ds_read_b128 v[32:35], v63 offset:49152
    v_mfma_f32_16x16x32_bf16 v[28:31], v[24:27], v[0:3], 0
    s_waitcnt vmcnt(1)
    s_mov_b64 exec, s[34:35]
    s_nop 1
    v_cvt_pk_bf16_f32 v2, v12, v13
    v_cvt_pk_bf16_f32 v3, v14, v15
    s_mov_b64 exec, -1
    s_nop 0
    v_mfma_f32_16x16x32_bf16 v[8:11], v[0:3], v[0:3], 0
    v_mov_b32_dpp v28, v4 row_ror:8 row_mask:0xf bank_mask:0xc
    v_mov_b32_dpp v29, v5 row_ror:8 row_mask:0xf bank_mask:0xc
    v_mov_b32_dpp v30, v6 row_ror:8 row_mask:0xf bank_mask:0xc
    v_mov_b32_dpp v31, v7 row_ror:8 row_mask:0xf bank_mask:0xc
    v_smfmac_f32_16x16x64_bf16 v[16:19], v[36:39], v[144:151], v60
    ds_write_b128 v62, v[28:31] offset:53248
    v_mov_b32_dpp v8, v10 row_ror:8 row_mask:0xf bank_mask:0xc
    v_mov_b32_dpp v9, v11 row_ror:8 row_mask:0xf bank_mask:0xc
    v_smfmac_f32_16x16x64_bf16 v[20:23], v[36:39], v[152:159], v60
    ds_write_b64 v70, v[8:9]
    s_waitcnt lgkmcnt(4)
    v_smfmac_f32_16x16x64_bf16 v[16:19], v[48:51], v[96:103], v60
    s_mov_b64 exec, s[36:37]
    buffer_store_dwordx4 v[56:59], v61, s[4:7], s65 offen sc1
    s_mov_b64 exec, -1
    v_smfmac_f32_16x16x64_bf16 v[20:23], v[48:51], v[104:111], v60
    s_cbranch_scc1 cf_last
cf_back:
    s_waitcnt lgkmcnt(0)
    s_barrier
    ds_read_b128 v[56:59], v78 offset:10752
    v_smfmac_f32_16x16x64_bf16 v[16:19], v[52:55], v[80:87], v60
    ds_read_b128 v[12:15], v78 offset:11264
    ds_read_b128 v[4:7], v63 offset:12288
    v_smfmac_f32_16x16x64_bf16 v[20:23], v[52:55], v[88:95], v60
    ds_read_b128 v[8:11], v64 offset:12288
    ds_read_b128 v[0:3], v71 offset:12288
    v_mov_b64 v[24:25], s[62:63]
    v_mov_b64 v[26:27], s[60:61]
    v_cvt_pk_bf16_f32 v16, v16, v17
    v_cvt_pk_bf16_f32 v17, v18, v19
    v_pk_mul_f32 v[28:29], v[28:29], s[44:45]
    v_pk_mul_f32 v[30:31], v[30:31], s[44:45]
    s_waitcnt lgkmcnt(3)
    v_pk_add_f32 v[56:57], v[56:57], v[58:59]
    v_pk_add_f32 v[12:13], v[12:13], v[14:15]
    v_pk_add_f32 v[56:57], v[56:57], v[12:13]
    v_pk_mul_f32 v[56:57], v[56:57], s[44:45]
    v_exp_f32 v58, v56
    v_exp_f32 v59, v57
    s_waitcnt lgkmcnt(1)
    v_pk_fma_f32 v[28:29], v[4:5], s[44:45], v[28:29]
    v_pk_fma_f32 v[30:31], v[6:7], s[44:45], v[30:31]
    v_cvt_pk_bf16_f32 v6, v58, v59
    v_pk_fma_f32 v[28:29], v[8:9], s[44:45], v[28:29]
    v_pk_fma_f32 v[30:31], v[10:11], s[44:45], v[30:31]
    s_waitcnt lgkmcnt(0)
    v_pk_fma_f32 v[28:29], v[0:1], s[44:45], v[28:29]
    v_mov_b32_dpp v7, v6 row_ror:8 row_mask:0xf bank_mask:0xf
    v_pk_fma_f32 v[30:31], v[2:3], s[44:45], v[30:31]
    v_exp_f32 v0, v28
    v_mfma_f32_16x16x16_bf16 v[12:15], v[16:17], v[6:7], 0
    ds_read_b128 v[48:51], v63 offset:57344
    v_exp_f32 v1, v29
    v_cvt_pk_bf16_f32 v18, v20, v21
    v_exp_f32 v2, v30
    v_cvt_pk_bf16_f32 v19, v22, v23
    v_cvt_pk_bf16_f32 v8, v0, v1
    v_exp_f32 v3, v31
    v_mfma_f32_16x16x16_bf16 v[20:23], v[18:19], v[6:7], 0
    ds_read_b128 v[52:55], v63 offset:61440
    v_cvt_pk_bf16_f32 v9, v2, v3
    v_mov_b32_dpp v10, v8 row_ror:8 row_mask:0xf bank_mask:0xf
    v_max3_f32 v4, |v28|, |v29|, |v30|
    v_mov_b32_dpp v11, v9 row_ror:8 row_mask:0xf bank_mask:0xf
    v_mfma_f32_16x16x32_bf16 v[0:3], v[24:27], v[6:9], 0
    ds_read_b128 v[36:39], v63 offset:53248
    v_max3_f32 v4, v4, |v31|, |v56|
    v_max_f32_e64 v4, v4, |v57|
    v_mfma_f32_16x16x32_bf16 v[12:15], v[40:43], v[8:11], v[12:15]
    v_cmp_nge_f32 vcc, s46, v4
    v_mfma_f32_16x16x32_bf16 v[20:23], v[44:47], v[8:11], v[20:23]
    v_add_f32_dpp v0, v0, v0 row_ror:8 row_mask:0xf bank_mask:0xf
    v_rcp_f32 v0, v0
    s_cbranch_vccnz cf_guard
cf_norm:
    v_mfma_f32_16x16x16_bf16 v[28:31], v[72:73], v[72:73], 0
    v_mul_f32 v12, v12, v0
    v_mul_f32 v13, v13, v0
    v_mul_f32 v14, v14, v0
    v_mul_f32 v15, v15, v0
    v_mul_f32_dpp v12, v20, v0 row_ror:8 row_mask:0xf bank_mask:0xc
    v_mul_f32_dpp v13, v21, v0 row_ror:8 row_mask:0xf bank_mask:0xc
    v_mul_f32_dpp v14, v22, v0 row_ror:8 row_mask:0xf bank_mask:0xc
    v_mul_f32_dpp v15, v23, v0 row_ror:8 row_mask:0xf bank_mask:0xc
    v_cvt_pk_bf16_f32 v12, v12, v13
    v_cvt_pk_bf16_f32 v13, v14, v15
    v_mfma_f32_16x16x16_bf16 v[8:11], v[72:73], v[72:73], 0
    ds_write_b64 v77, v[12:13]
    v_mfma_f32_16x16x16_bf16 v[4:7], v[72:73], v[72:73], 0
    ds_read_b128 v[0:3], v68
    v_mfma_f32_16x16x16_bf16 v[16:19], v[72:73], v[72:73], 0
    ds_read_b128 v[40:43], v63 offset:16384
    v_mfma_f32_16x16x16_bf16 v[20:23], v[72:73], v[72:73], 0
    ds_read_b128 v[44:47], v63 offset:20480
    s_waitcnt lgkmcnt(3)
    s_barrier
    ds_read_b128 v[24:27], v74
    ds_read_b128 v[12:15], v75
    ds_read_b128 v[56:59], v76
    s_waitcnt lgkmcnt(5)
    v_smfmac_f32_16x16x64_bf16 v[28:31], v[0:3], v[160:167], v60
    v_smfmac_f32_16x16x64_bf16 v[8:11], v[0:3], v[192:199], v60
    v_smfmac_f32_16x16x64_bf16 v[4:7], v[0:3], v[32:39], v60
    ds_read_b128 v[32:35], v63 offset:32768
    v_smfmac_f32_16x16x64_bf16 v[16:19], v[0:3], v[224:231], v60
    ds_read_b128 v[36:39], v63 offset:36864
    s_waitcnt lgkmcnt(3)
    v_smfmac_f32_16x16x64_bf16 v[28:31], v[24:27], v[168:175], v60
    v_smfmac_f32_16x16x64_bf16 v[4:7], v[12:15], v[48:55], v60
    ds_read_b128 v[48:51], v63 offset:24576
    v_smfmac_f32_16x16x64_bf16 v[28:31], v[12:15], v[176:183], v60
    ds_read_b128 v[52:55], v63 offset:28672
    s_waitcnt lgkmcnt(4)
    v_smfmac_f32_16x16x64_bf16 v[28:31], v[56:59], v[184:191], v60
    v_cvt_pk_bf16_f32 v4, v4, v5
    v_smfmac_f32_16x16x64_bf16 v[16:19], v[12:15], v[40:47], v60
    ds_read_b128 v[40:43], v63 offset:40960
    v_and_or_b32 v4, v4, -2, s30
    v_smfmac_f32_16x16x64_bf16 v[8:11], v[24:27], v[200:207], v60
    ds_read_b128 v[44:47], v63 offset:45056
    v_cvt_pk_bf16_f32 v5, v6, v7
    v_smfmac_f32_16x16x64_bf16 v[8:11], v[12:15], v[208:215], v60
    buffer_store_dwordx2 v[4:5], v67, s[4:7], s22 offen
    v_cvt_pk_bf16_f32 v28, v28, v29
    v_smfmac_f32_16x16x64_bf16 v[8:11], v[56:59], v[216:223], v60
    v_and_or_b32 v28, v28, -2, s30
    v_smfmac_f32_16x16x64_bf16 v[16:19], v[24:27], v[232:239], v60
    v_cvt_pk_bf16_f32 v29, v30, v31
    s_waitcnt lgkmcnt(4)
    v_smfmac_f32_16x16x64_bf16 v[16:19], v[56:59], v[32:39], v60
    buffer_store_dwordx2 v[28:29], v66, s[4:7], s20 offen
    v_cvt_pk_bf16_f32 v8, v8, v9
    s_waitcnt lgkmcnt(0)
    v_smfmac_f32_16x16x64_bf16 v[20:23], v[0:3], v[240:247], v60
    v_and_or_b32 v8, v8, -2, s30
    v_smfmac_f32_16x16x64_bf16 v[20:23], v[24:27], v[248:255], v60
    v_cvt_pk_bf16_f32 v9, v10, v11
    v_smfmac_f32_16x16x64_bf16 v[20:23], v[12:15], v[48:55], v60
    buffer_store_dwordx2 v[8:9], v66, s[4:7], s21 offen
    v_cvt_pk_bf16_f32 v16, v16, v17
    v_smfmac_f32_16x16x64_bf16 v[20:23], v[56:59], v[40:47], v60
    v_and_or_b32 v16, v16, -2, s30
    v_cvt_pk_bf16_f32 v17, v18, v19
    buffer_store_dwordx2 v[16:17], v66, s[4:7], s38 offen
    s_cmp_lg_u32 s13, 2
    s_nop 1
    v_cvt_pk_bf16_f32 v20, v20, v21
    v_and_or_b32 v20, v20, -2, s30
    v_cvt_pk_bf16_f32 v21, v22, v23
    buffer_store_dwordx2 v[20:21], v66, s[4:7], s39 offen
    s_cbranch_scc1 cf_w013
    v_mov_b32 v21, -1
    s_mov_b64 exec, s[32:33]
    buffer_store_dword v21, v69, s[4:7], s18 offen
    s_mov_b64 exec, -1
    s_mov_b32 s18, s43
    s_nop 15
    s_nop 15
    s_nop 15
    s_nop 14
    buffer_load_dwordx4 v[40:43], v65, s[4:7], s19 offen offset:0 nt
    buffer_load_dwordx4 v[44:47], v65, s[4:7], s19 offen offset:1024 nt
    buffer_load_dwordx4 v[48:51], v65, s[4:7], s19 offen offset:2048 nt
    buffer_load_dwordx4 v[52:55], v65, s[4:7], s19 offen offset:3072 nt
    ds_read_b128 v[56:59], v65 offset:10240
    s_add_u32 s28, s28, 1
    s_mov_b32 s14, s41
    s_add_u32 s23, s23, 524288
    s_add_u32 s24, s24, 524288
    s_min_u32 s24, s24, s47
    s_add_u32 s15, s14, 4096
    s_add_u32 s16, s14, 8192
    s_add_u32 s65, s65, 12288
    s_mov_b32 s40, 1
    v_mov_b64 v[0:1], 0
    v_mov_b64 v[2:3], 0
    v_mov_b64 v[4:5], 0
    v_mov_b64 v[6:7], 0
    v_mov_b64 v[8:9], 0
    v_mov_b64 v[10:11], 0
    v_mov_b64 v[12:13], 0
    v_mov_b64 v[14:15], 0
cf_chkF:
    v_mov_b32 v20, 0
    s_waitcnt vmcnt(3)
    s_waitcnt lgkmcnt(0)
    v_mfma_f32_16x16x32_bf16 v[28:31], v[40:43], v[56:59], 0
    v_bitop3_b32 v20, v20, v40, s30 bitop3:0xf6
    v_bitop3_b32 v20, v20, v42, s30 bitop3:0xf6
    s_waitcnt vmcnt(2)
    v_mfma_f32_16x16x32_bf16 v[28:31], v[44:47], v[56:59], v[28:31]
    v_bitop3_b32 v20, v20, v44, s30 bitop3:0xf6
    v_bitop3_b32 v20, v20, v46, s30 bitop3:0xf6
    s_waitcnt vmcnt(1)
    v_mfma_f32_16x16x32_bf16 v[28:31], v[48:51], v[56:59], v[28:31]
    v_bitop3_b32 v20, v20, v48, s30 bitop3:0xf6
    v_bitop3_b32 v20, v20, v50, s30 bitop3:0xf6
    s_waitcnt vmcnt(0)
    v_mfma_f32_16x16x32_bf16 v[28:31], v[52:55], v[56:59], v[28:31]
    v_bitop3_b32 v20, v20, v52, s30 bitop3:0xf6
    v_bitop3_b32 v20, v20, v54, s30 bitop3:0xf6
    v_and_b32 v20, s40, v20
    v_cmp_ne_u32 vcc, 0, v20
    s_cbranch_vccnz cf_spinF
    v_permlane32_swap_b32 v28, v30
    v_permlane32_swap_b32 v29, v31
    v_add_f32 v28, v28, v30
    v_add_f32 v30, v29, v31
    v_cvt_pk_bf16_f32 v28, v28, v30
    s_mov_b64 exec, s[32:33]
    buffer_store_dword v28, v69, s[4:7], s17 offen
    s_mov_b64 exec, -1
    ds_read_b128 v[32:35], v62 offset:16384
    ds_read_b128 v[36:39], v62 offset:20480
    ds_read_b128 v[40:43], v61 offset:0
    ds_read_b128 v[44:47], v61 offset:4096
    ds_read_b128 v[48:51], v61 offset:8192
    ds_read_b128 v[52:55], v61 offset:12288
    s_nop 15
    s_nop 1
    buffer_load_dwordx4 v[24:27], v61, s[4:7], s14 offen nt
    s_branch cf_loop2
cf_w013:
    ds_read_b128 v[56:59], v65 offset:10240
    ds_read_b128 v[32:35], v62 offset:16384
    ds_read_b128 v[36:39], v62 offset:20480
    ds_read_b128 v[40:43], v61 offset:0
    ds_read_b128 v[44:47], v61 offset:4096
    ds_read_b128 v[48:51], v61 offset:8192
    ds_read_b128 v[52:55], v61 offset:12288
    s_add_u32 s28, s28, 1
    s_mov_b32 s14, s41
    s_add_u32 s23, s23, 524288
    s_add_u32 s24, s24, 524288
    s_min_u32 s24, s24, s47
    s_add_u32 s15, s14, 4096
    s_add_u32 s16, s14, 8192
    s_add_u32 s65, s65, 12288
    s_mov_b32 s40, 1
    s_cmp_eq_u32 s64, 0
    s_cbranch_scc1 cf_w0
    v_mov_b32 v21, -1
    s_mov_b64 exec, s[32:33]
    buffer_store_dword v21, v69, s[4:7], s18 offen
    s_mov_b64 exec, -1
    s_mov_b32 s18, s43
    s_cmp_eq_u32 s13, 1
    s_nop 15
    s_nop 15
    s_nop 1
    s_cbranch_scc1 cf_sx
    s_nop 15
    s_nop 11
cf_sx:
    buffer_load_dwordx4 v[0:3], v65, s[4:7], s19 offen offset:0 nt
    buffer_load_dwordx4 v[4:7], v65, s[4:7], s19 offen offset:1024 nt
    buffer_load_dwordx4 v[8:11], v65, s[4:7], s19 offen offset:2048 nt
    buffer_load_dwordx4 v[12:15], v65, s[4:7], s19 offen offset:3072 nt
cf_chkG:
    v_mov_b32 v20, 0
    s_waitcnt vmcnt(3)
    s_waitcnt lgkmcnt(6)
    v_mfma_f32_16x16x32_bf16 v[28:31], v[0:3], v[56:59], 0
    v_bitop3_b32 v20, v20, v0, s30 bitop3:0xf6
    v_bitop3_b32 v20, v20, v2, s30 bitop3:0xf6
    s_waitcnt vmcnt(2)
    v_mfma_f32_16x16x32_bf16 v[28:31], v[4:7], v[56:59], v[28:31]
    v_bitop3_b32 v20, v20, v4, s30 bitop3:0xf6
    v_bitop3_b32 v20, v20, v6, s30 bitop3:0xf6
    s_waitcnt vmcnt(1)
    v_mfma_f32_16x16x32_bf16 v[28:31], v[8:11], v[56:59], v[28:31]
    v_bitop3_b32 v20, v20, v8, s30 bitop3:0xf6
    v_bitop3_b32 v20, v20, v10, s30 bitop3:0xf6
    s_waitcnt vmcnt(0)
    v_mfma_f32_16x16x32_bf16 v[28:31], v[12:15], v[56:59], v[28:31]
    v_bitop3_b32 v20, v20, v12, s30 bitop3:0xf6
    v_bitop3_b32 v20, v20, v14, s30 bitop3:0xf6
    v_and_b32 v20, s40, v20
    v_cmp_ne_u32 vcc, 0, v20
    s_cbranch_vccnz cf_spinG
    v_permlane32_swap_b32 v28, v30
    v_permlane32_swap_b32 v29, v31
    v_add_f32 v28, v28, v30
    v_add_f32 v30, v29, v31
    s_cmp_eq_u32 s13, 3
    s_cbranch_scc1 cf_w3
    v_mov_b32 v29, v28
    v_mov_b32 v31, v30
    s_nop 0
    v_permlane16_swap_b32 v28, v29
    v_permlane16_swap_b32 v30, v31
    v_add_f32 v28, v28, v29
    v_add_f32 v30, v30, v31
cf_w3:
    v_cvt_pk_bf16_f32 v28, v28, v30
    s_mov_b64 exec, s[32:33]
    buffer_store_dword v28, v69, s[4:7], s17 offen
    s_mov_b64 exec, -1
    buffer_load_dwordx4 v[24:27], v61, s[4:7], s14 offen nt
    s_branch cf_loop
cf_w0:
    v_mov_b64 v[0:1], 0
    v_mov_b64 v[2:3], 0
    v_mov_b64 v[4:5], 0
    v_mov_b64 v[6:7], 0
    v_mov_b64 v[8:9], 0
    v_mov_b64 v[10:11], 0
    v_mov_b64 v[12:13], 0
    v_mov_b64 v[14:15], 0
    s_nop 15
    s_nop 15
    s_nop 15
    s_nop 5
    s_cmp_lg_u32 s28, 10
    s_cbranch_scc1 cf_nokv
    s_lshr_b32 s92, s12, 1
    s_lshl_b32 s92, s92, 8
    s_add_u32 s92, s92, 125829120
    v_bfe_u32 v28, v61, 4, 6
    v_min_u32 v28, 11, v28
    v_lshlrev_b32 v28, 2, v28
    v_add_u32 v28, 108304, v28
    s_waitcnt vmcnt(0)
    ds_read_b32 v29, v28
    s_add_u32 s93, s95, 63
    s_waitcnt lgkmcnt(0)
    v_cmp_ne_u32 vcc, s93, v29
    s_cbranch_vccz cf_kv1_go
    s_lshr_b32 s92, s12, 1
    s_lshl_b32 s92, s92, 8
    s_add_u32 s92, s92, 125833216
    v_bfe_u32 v28, v61, 4, 6
    v_min_u32 v28, 11, v28
    v_lshlrev_b32 v28, 2, v28
    s_add_u32 s93, s95, 63
    s_mov_b32 s94, 4194304
cf_kv1:
    buffer_load_dword v29, v28, s[4:7], s92 offen sc1
    s_sub_u32 s94, s94, 1
    s_cbranch_scc1 cf_kv1_go
    s_waitcnt vmcnt(0)
    v_subrev_u32 v29, s93, v29
    v_cmp_lt_u32 vcc, 64, v29
    s_cbranch_vccz cf_kv1_go
    s_sleep 2
    s_branch cf_kv1
cf_kv1_go:
    s_branch cf_w0p
cf_nokv:
    s_nop 15
    s_nop 15
    s_nop 15
    s_nop 15
    s_nop 15
    s_nop 15
    s_nop 13
cf_w0p:
    buffer_load_dwordx4 v[24:27], v61, s[4:7], s14 offen nt
    s_branch cf_loop2
cf_spinF:
    buffer_load_dwordx4 v[40:43], v65, s[4:7], s19 offen offset:0 nt
    buffer_load_dwordx4 v[44:47], v65, s[4:7], s19 offen offset:1024 nt
    buffer_load_dwordx4 v[48:51], v65, s[4:7], s19 offen offset:2048 nt
    buffer_load_dwordx4 v[52:55], v65, s[4:7], s19 offen offset:3072 nt
    s_sub_u32 s29, s29, 1
    s_cmp_lt_i32 s29, 0
    s_cselect_b32 s40, 0, 1
    s_branch cf_chkF
cf_spinG:
    buffer_load_dwordx4 v[0:3], v65, s[4:7], s19 offen offset:0 nt
    buffer_load_dwordx4 v[4:7], v65, s[4:7], s19 offen offset:1024 nt
    buffer_load_dwordx4 v[8:11], v65, s[4:7], s19 offen offset:2048 nt
    buffer_load_dwordx4 v[12:15], v65, s[4:7], s19 offen offset:3072 nt
    s_sub_u32 s29, s29, 1
    s_cmp_lt_i32 s29, 0
    s_cselect_b32 s40, 0, 1
    s_branch cf_chkG
cf_guard:
    s_cbranch_scc0 cf_guard2
    buffer_store_dwordx4 v[16:19], v61, s[4:7], s26 offen sc1
    s_add_u32 s26, s26, 131072
    s_add_u32 s40, s95, 63
    v_mov_b32 v5, s40
    s_mov_b64 exec, 1
    buffer_store_dword v5, off, s[4:7], s27 sc1
    s_mov_b64 exec, -1
cf_guard2:
    s_nop 7
    v_max3_f32 v6, v28, v29, v30
    v_max3_f32 v7, v31, v56, v57
    v_max_f32 v6, v6, v7
    s_nop 1
    v_max_f32_dpp v6, v6, v6 row_ror:8 row_mask:0xf bank_mask:0xf
    v_mov_b32 v7, v6
    s_nop 1
    v_permlane32_swap_b32 v6, v7
    v_max_f32 v6, v6, v7
    v_mov_b32 v7, v6
    s_nop 1
    v_permlane16_swap_b32 v6, v7
    v_max_f32 v6, v6, v7
    v_sub_f32 v28, v28, v6
    v_sub_f32 v29, v29, v6
    v_sub_f32 v30, v30, v6
    v_sub_f32 v31, v31, v6
    v_sub_f32 v56, v56, v6
    v_sub_f32 v57, v57, v6
    v_exp_f32 v58, v56
    v_exp_f32 v59, v57
    s_nop 0
    v_cvt_pk_bf16_f32 v6, v58, v59
    s_nop 1
    v_mov_b32_dpp v7, v6 row_ror:8 row_mask:0xf bank_mask:0xf
    v_exp_f32 v0, v28
    s_nop 0
    v_mfma_f32_16x16x16_bf16 v[12:15], v[16:17], v[6:7], 0
    v_exp_f32 v1, v29
    v_exp_f32 v2, v30
    v_cvt_pk_bf16_f32 v8, v0, v1
    v_exp_f32 v3, v31
    v_mfma_f32_16x16x16_bf16 v[20:23], v[18:19], v[6:7], 0
    v_cvt_pk_bf16_f32 v9, v2, v3
    v_mov_b32_dpp v10, v8 row_ror:8 row_mask:0xf bank_mask:0xf
    v_max3_f32 v4, |v28|, |v29|, |v30|
    v_mov_b32_dpp v11, v9 row_ror:8 row_mask:0xf bank_mask:0xf
    v_mfma_f32_16x16x32_bf16 v[0:3], v[24:27], v[6:9], 0
    v_max3_f32 v4, v4, |v31|, |v56|
    v_max_f32_e64 v4, v4, |v57|
    v_mfma_f32_16x16x32_bf16 v[12:15], v[40:43], v[8:11], v[12:15]
    v_cmp_nge_f32 vcc, s46, v4
    v_mfma_f32_16x16x32_bf16 v[20:23], v[44:47], v[8:11], v[20:23]
    v_add_f32_dpp v0, v0, v0 row_ror:8 row_mask:0xf bank_mask:0xf
    v_rcp_f32 v0, v0
    s_nop 4
    s_branch cf_norm
cf_spin0:
    buffer_load_dwordx4 v[24:27], v61, s[4:7], s14 offen nt
    s_sub_u32 s29, s29, 1
    s_cmp_lt_i32 s29, 0
    s_cbranch_scc0 cf_chk0
    s_waitcnt vmcnt(0)
    v_min_u32 v24, -2, v24
    v_min_u32 v25, -2, v25
    v_min_u32 v26, -2, v26
    v_min_u32 v27, -2, v27
    s_branch cf_chk0
cf_spin1:
    s_mov_b32 m0, s58
    s_nop 0
    buffer_load_dwordx4 v61, s[4:7], s15 offen nt lds
    s_mov_b32 m0, s59
    s_nop 0
    buffer_load_dword v56, s[4:7], s16 offen nt lds
    s_mov_b32 m0, 108032
    s_sub_u32 s29, s29, 1
    s_cmp_lt_i32 s29, 0
    s_waitcnt vmcnt(0)
    ds_read_b128 v[28:31], v62 offset:45056
    ds_read_b32 v59, v58
    s_waitcnt lgkmcnt(0)
    v_max3_u32 v57, v28, v29, v30
    v_max3_u32 v57, v57, v31, v59
    v_cmp_eq_u32 vcc, -1, v57
    s_cbranch_scc1 cf_go1
    s_cbranch_vccnz cf_spin1
    s_branch cf_go1
cf_last:
    s_nop 1
    s_cmp_ge_u32 s28, 2
    s_cbranch_scc1 cf_last0
    s_and_b32 s40, s12, 3
    s_lshl_b32 s40, s40, 14
    s_add_u32 s40, s40, 67108864
    s_lshr_b32 s42, s12, 2
    s_lshl_b32 s42, s42, 3
    s_lshl_b64 exec, 0x55, s42
    buffer_load_dword v79, s[4:7], s40 offen sc1 lds
    s_mov_b64 exec, -1
    s_cmp_eq_u32 0, 1
    s_branch cf_back
cf_last0:
    s_cmp_lg_u32 s28, 9
    s_cbranch_scc1 cf_last1
    s_lshr_b32 s92, s12, 1
    s_lshl_b32 s92, s92, 8
    s_add_u32 s92, s92, 125833216
    v_bfe_u32 v48, v61, 4, 6
    v_min_u32 v48, 11, v48
    v_lshlrev_b32 v48, 2, v48
    s_mov_b32 m0, 108304
    s_mov_b64 exec, 0xfff
    buffer_load_dword v48, s[4:7], s92 offen sc1 lds
    s_mov_b64 exec, -1
    s_mov_b32 m0, 108032
    s_cmp_eq_u32 0, 1
    s_branch cf_back
cf_last1:
    s_cmp_eq_u32 s28, 63
    s_cbranch_scc1 cf_last2
    s_mov_b64 exec, s[34:35]
    buffer_store_dwordx4 v[0:3], v61, s[4:7], s25 offen sc1
    s_mov_b64 exec, -1
    s_add_u32 s25, s25, 131072
    s_mov_b32 s46, 0xbf800000
    s_cmp_eq_u32 0, 0
    s_branch cf_back
cf_last2:
    s_waitcnt lgkmcnt(0)
    s_mov_b64 exec, s[34:35]
    buffer_store_dwordx4 v[0:3], v61, s[4:7], s25 offen sc1
    s_mov_b64 exec, -1
    s_add_u32 s40, s95, 64
    v_mov_b32 v40, s40
    v_smfmac_f32_16x16x64_bf16 v[16:19], v[52:55], v[80:87], v60
    v_smfmac_f32_16x16x64_bf16 v[20:23], v[52:55], v[88:95], v60
    s_nop 3
    v_cvt_pk_bf16_f32 v16, v16, v17
    v_cvt_pk_bf16_f32 v17, v18, v19
    s_nop 1
    v_cvt_pk_bf16_f32 v18, v20, v21
    v_cvt_pk_bf16_f32 v19, v22, v23
    buffer_store_dwordx4 v[16:19], v61, s[4:7], s26 offen sc1
    s_mov_b64 exec, 1
    buffer_store_dword v40, off, s[4:7], s27 sc1
    s_mov_b64 exec, -1
    s_endpgm
cf_dma:
    s_xor_b32 s74, s76, s81
    s_add_u32 m0, s74, s80
    s_add_u32 s76, s76, 4096
    buffer_load_dwordx4 v58, s[8:11], s78 offen lds
    s_add_u32 s78, s78, s79
    s_cmp_lt_u32 s76, s77
    s_cbranch_scc1 cf_dma
    s_setpc_b64 s[82:83]
L_chain_safe:
    s_mov_b64 s[48:49], s[50:51]
    s_mov_b64 s[50:51], s[52:53]
    s_mov_b64 s[52:53], s[54:55]
    s_mov_b64 s[54:55], s[56:57]
    s_mov_b64 s[56:57], s[58:59]
    v_lshrrev_b32 v54, 6, v0
    s_nop 0
    v_readfirstlane_b32 s13, v54
    v_and_b32 v57, 63, v0
    v_bfe_u32 v54, v57, 2, 1
    v_lshlrev_b32 v48, 13, v54
    v_bfe_u32 v54, v57, 3, 1
    v_lshl_add_u32 v48, v54, 15, v48
    v_bfe_u32 v54, v57, 4, 1
    v_lshl_add_u32 v48, v54, 14, v48
    v_bfe_u32 v54, v57, 5, 1
    v_lshl_add_u32 v48, v54, 16, v48
    v_lshrrev_b32 v55, 4, v57
    v_and_b32 v55, 2, v55
    v_xor_b32 v55, v55, v57
    v_and_b32 v55, 3, v55
    v_lshl_add_u32 v48, v55, 4, v48
    v_bfe_u32 v54, v57, 2, 1
    v_lshlrev_b32 v51, 6, v54
    v_bfe_u32 v54, v57, 3, 1
    v_lshl_add_u32 v51, v54, 9, v51
    v_bfe_u32 v54, v57, 4, 1
    v_lshl_add_u32 v51, v54, 7, v51
    v_bfe_u32 v54, v57, 5, 1
    v_lshl_add_u32 v51, v54, 12, v51
    v_bfe_u32 v54, v57, 0, 1
    v_lshl_add_u32 v51, v54, 3, v51
    v_bfe_u32 v54, v57, 1, 1
    v_lshl_add_u32 v51, v54, 4, v51
    v_bfe_u32 v54, v57, 3, 1
    v_lshl_add_u32 v51, v54, 5, v51
    v_lshrrev_b32 v55, 3, v57
    v_mul_u32_u24 v49, 1152, v55
    v_and_b32 v55, 7, v57
    v_lshl_add_u32 v49, v55, 4, v49
    v_bfe_u32 v54, v57, 4, 1
    v_lshlrev_b32 v52, 13, v54
    v_bfe_u32 v54, v57, 5, 1
    v_lshl_add_u32 v52, v54, 9, v52
    v_bfe_u32 v54, v57, 2, 1
    v_lshl_add_u32 v52, v54, 7, v52
    v_bfe_u32 v54, v57, 3, 1
    v_lshl_add_u32 v52, v54, 5, v52
    v_and_b32 v55, 3, v57
    v_lshl_add_u32 v52, v55, 3, v52
    v_lshrrev_b32 v55, 2, v57
    v_mul_u32_u24 v50, 1152, v55
    v_and_b32 v55, 3, v57
    v_lshl_add_u32 v50, v55, 4, v50
    v_bfe_u32 v54, v57, 4, 1
    v_lshlrev_b32 v53, 12, v54
    v_bfe_u32 v54, v57, 5, 1
    v_lshl_add_u32 v53, v54, 8, v53
    v_bfe_u32 v54, v57, 2, 1
    v_lshl_add_u32 v53, v54, 6, v53
    v_bfe_u32 v54, v57, 3, 1
    v_lshl_add_u32 v53, v54, 5, v53
    v_and_b32 v55, 3, v57
    v_lshl_add_u32 v53, v55, 3, v53
    s_lshl_b32 s66, s13, 10
    s_and_b32 s93, s13, 1
    s_lshl_b32 s93, s93, 14
    s_and_b32 s75, s13, 2
    s_lshl_b32 s75, s75, 19
    v_add_u32 v51, s66, v51
    v_add_u32 v52, s66, v52
    v_add_u32 v53, s66, v53
    v_mov_b32 v58, v48
    s_mov_b32 s10, 4718592
    s_mov_b32 s11, 0x20000
    s_lshl_b32 s67, s12, 8
    s_lshl_b32 s40, s13, 6
    s_add_u32 s67, s67, s40
    s_mul_i32 s92, s12, 147456
    s_lshr_b32 s73, s50, 8
    s_add_u32 s73, s73, s12
    s_and_b32 s73, s73, 31
    s_bitcmp1_b32 0xa2222222, s73
    s_cselect_b32 s88, 0, 0
    s_mov_b32 s72, 0
    s_add_u32 s73, s73, 1
    s_lshr_b32 s73, s73, 2
    s_xor_b32 s94, s13, 0
    s_mul_i32 s94, s94, 36864
    s_add_u32 s94, s94, s92
    s_lshl_b32 s74, s13, 7
    s_add_u32 s94, s94, s74
    s_add_u32 s78, s94, 0
    s_mov_b64 s[8:9], s[56:57]
    v_mov_b32 v58, v49
    s_mov_b32 s79, 9216
    s_mov_b32 s81, 0
    s_add_u32 s80, s66, 114688
    s_mov_b32 s76, 0
    s_mov_b32 s77, 8192
    s_call_b64 s[82:83], cs_dma
    s_mov_b32 s77, 16384
    s_call_b64 s[82:83], cs_dma
    s_xor_b32 s94, s13, 1
    s_mul_i32 s94, s94, 36864
    s_add_u32 s94, s94, s92
    s_lshl_b32 s74, s13, 7
    s_add_u32 s94, s94, s74
    s_add_u32 s78, s94, 0
    s_add_u32 s80, s66, 81920
    s_mov_b32 s76, 0
    s_mov_b32 s77, 8192
    s_call_b64 s[82:83], cs_dma
    s_mov_b32 s77, 16384
    s_call_b64 s[82:83], cs_dma
    s_xor_b32 s94, s13, 2
    s_mul_i32 s94, s94, 36864
    s_add_u32 s94, s94, s92
    s_lshl_b32 s74, s13, 7
    s_add_u32 s94, s94, s74
    s_add_u32 s78, s94, 0
    s_add_u32 s80, s66, 16384
    s_mov_b32 s76, 0
    s_mov_b32 s77, 8192
    s_call_b64 s[82:83], cs_dma
    s_mov_b32 s77, 16384
    s_call_b64 s[82:83], cs_dma
    s_xor_b32 s94, s13, 3
    s_mul_i32 s94, s94, 36864
    s_add_u32 s94, s94, s92
    s_lshl_b32 s74, s13, 7
    s_add_u32 s94, s94, s74
    s_add_u32 s78, s94, 0
    s_add_u32 s80, s66, 0
    s_mov_b32 s76, 0
    s_mov_b32 s77, 8192
    s_call_b64 s[82:83], cs_dma
    s_mov_b32 s77, 16384
    s_call_b64 s[82:83], cs_dma
    v_lshrrev_b32 v24, 6, v0
    v_lshlrev_b32 v61, 4, v0
    v_add_u32 v62, 57344, v61
    v_xor_b32 v63, 1024, v61
    v_add_u32 v63, 98304, v63
    v_xor_b32 v64, 2048, v61
    v_add_u32 v64, 98304, v64
    v_and_b32 v65, 1023, v61
    v_add_u32 v65, 98304, v65
    v_and_b32 v26, 15, v0
    v_bfe_u32 v27, v0, 4, 2
    v_mov_b32 v60, 0x4444
    v_mov_b32 v25, 0xeeee
    v_cmp_lt_u32 vcc, 7, v26
    s_nop 1
    v_cndmask_b32 v60, v60, v25, vcc
    s_nop 1
    v_and_b32 v67, 12, v26
    v_lshlrev_b32 v67, 3, v67
    v_and_b32 v25, 1, v26
    v_lshl_add_u32 v67, v25, 4, v67
    v_bfe_u32 v25, v26, 1, 1
    v_lshl_add_u32 v67, v25, 3, v67
    v_lshl_add_u32 v66, v27, 14, v67
    v_lshl_add_u32 v66, v24, 17, v66
    s_nop 1
    v_and_b32 v67, 63, v67
    v_lshrrev_b32 v25, 1, v24
    v_lshl_add_u32 v67, v25, 18, v67
    v_lshl_add_u32 v67, v27, 16, v67
    v_lshrrev_b32 v25, 3, v26
    v_lshl_add_u32 v67, v25, 15, v67
    v_and_b32 v25, 1, v24
    v_lshl_add_u32 v67, v25, 6, v67
    s_nop 1
    s_waitcnt vmcnt(12)
    v_add_u32 v55, 114688, v52
    ds_read_b64_tr_b16 v[160:161], v55 offset:0
    ds_read_b64_tr_b16 v[162:163], v55 offset:256
    ds_read_b64_tr_b16 v[164:165], v55 offset:4096
    ds_read_b64_tr_b16 v[166:167], v55 offset:4352
    s_xor_b32 s94, s13, 0
    s_mul_i32 s94, s94, 36864
    s_add_u32 s94, s94, s92
    s_lshl_b32 s74, s13, 7
    s_add_u32 s94, s94, s74
    s_add_u32 s78, s94, 512
    s_add_u32 s80, s66, 147456
    s_mov_b32 s76, 0
    s_mov_b32 s77, 8192
    s_call_b64 s[82:83], cs_dma
    ds_read_b64_tr_b16 v[192:193], v55 offset:64
    ds_read_b64_tr_b16 v[194:195], v55 offset:320
    ds_read_b64_tr_b16 v[196:197], v55 offset:4160
    ds_read_b64_tr_b16 v[198:199], v55 offset:4416
    s_mov_b32 s77, 16384
    s_call_b64 s[82:83], cs_dma
    v_and_b32 v25, 31, v0
    v_lshlrev_b32 v70, 4, v25
    v_lshlrev_b32 v28, 3, v25
    v_add_u32 v28, 108032, v28
    v_lshrrev_b32 v25, 1, v24
    v_lshl_add_u32 v70, v25, 9, v70
    v_and_b32 v25, 1, v24
    v_lshl_add_u32 v70, v25, 3, v70
    v_add_u32 v70, 109568, v70
    v_cmp_gt_u32 vcc, 2, v27
    s_nop 1
    v_cndmask_b32 v70, v70, v28, vcc
    s_nop 1
    s_waitcnt lgkmcnt(0)
    s_waitcnt vmcnt(12)
    v_add_u32 v55, 81920, v52
    ds_read_b64_tr_b16 v[168:169], v55 offset:0
    ds_read_b64_tr_b16 v[170:171], v55 offset:256
    ds_read_b64_tr_b16 v[172:173], v55 offset:4096
    ds_read_b64_tr_b16 v[174:175], v55 offset:4352
    s_xor_b32 s94, s13, 1
    s_mul_i32 s94, s94, 36864
    s_add_u32 s94, s94, s92
    s_lshl_b32 s74, s13, 7
    s_add_u32 s94, s94, s74
    s_add_u32 s78, s94, 512
    s_add_u32 s80, s66, 98304
    s_mov_b32 s76, 0
    s_mov_b32 s77, 8192
    s_call_b64 s[82:83], cs_dma
    ds_read_b64_tr_b16 v[200:201], v55 offset:64
    ds_read_b64_tr_b16 v[202:203], v55 offset:320
    ds_read_b64_tr_b16 v[204:205], v55 offset:4160
    ds_read_b64_tr_b16 v[206:207], v55 offset:4416
    s_mov_b32 s77, 16384
    s_call_b64 s[82:83], cs_dma
    v_xor_b32 v71, 2048, v63
    v_lshrrev_b32 v68, 4, v0
    v_lshlrev_b32 v68, 7, v68
    v_and_b32 v25, 7, v26
    v_lshl_add_u32 v68, v25, 4, v68
    v_add_u32 v68, 102400, v68
    v_xor_b32 v74, 512, v68
    v_xor_b32 v75, 1024, v68
    v_xor_b32 v76, 1536, v68
    v_lshrrev_b32 v25, 3, v26
    v_lshl_add_u32 v77, v25, 3, v68
    v_or_b32 v78, 512, v65
    v_lshlrev_b32 v79, 2, v61
    v_mov_b64 v[72:73], 0
    v_and_b32 v25, 1, v27
    v_lshlrev_b32 v69, 7, v25
    v_lshrrev_b32 v25, 1, v27
    v_lshl_add_u32 v69, v25, 3, v69
    v_and_b32 v25, 3, v26
    v_lshl_add_u32 v69, v25, 4, v69
    v_bfe_u32 v25, v26, 2, 1
    v_lshl_add_u32 v69, v25, 2, v69
    s_nop 1
    s_waitcnt lgkmcnt(0)
    s_waitcnt vmcnt(12)
    v_add_u32 v55, 16384, v52
    ds_read_b64_tr_b16 v[176:177], v55 offset:0
    ds_read_b64_tr_b16 v[178:179], v55 offset:256
    ds_read_b64_tr_b16 v[180:181], v55 offset:4096
    ds_read_b64_tr_b16 v[182:183], v55 offset:4352
    s_add_u32 s78, s67, 4194304
    s_mov_b64 s[8:9], s[54:55]
    v_mov_b32 v58, v48
    s_mov_b32 s79, 131072
    s_add_u32 s80, s66, 32768
    s_mov_b32 s76, 0
    s_mov_b32 s77, 8192
    s_call_b64 s[82:83], cs_dma
    ds_read_b64_tr_b16 v[208:209], v55 offset:64
    ds_read_b64_tr_b16 v[210:211], v55 offset:320
    ds_read_b64_tr_b16 v[212:213], v55 offset:4160
    ds_read_b64_tr_b16 v[214:215], v55 offset:4416
    s_mov_b32 s77, 16384
    s_call_b64 s[82:83], cs_dma
    s_mov_b32 s32, 0x00ff00ff
    s_mov_b32 s33, 0x00ff00ff
    s_not_b64 s[34:35], s[32:33]
    s_lshr_b32 s31, s12, 1
    s_lshl_b32 s31, s31, 8
    s_and_b32 s40, s12, 1
    s_lshl_b32 s40, s40, 6
    s_add_u32 s31, s31, s40
    s_and_b32 s40, s13, 1
    s_lshl_b32 s40, s40, 12
    s_add_u32 s31, s31, s40
    s_lshl_b32 s19, s12, 14
    s_add_u32 s19, s19, 68124672
    s_add_u32 s41, s19, 8192
    s_add_u32 s19, s19, s40
    s_and_b32 s40, s12, 1
    s_lshl_b32 s40, s40, 2
    s_or_b32 s40, s40, s13
    s_cmp_eq_u32 s40, 5
    s_cselect_b32 s64, 0, s13
    s_cmp_lg_u32 s13, 1
    s_cbranch_scc1 cs_notx
    s_mov_b32 s32, 0xff
    s_mov_b32 s33, 0xff
    s_mov_b32 s19, s41
    s_lshr_b32 s31, s12, 3
    s_lshl_b32 s31, s31, 8
    s_and_b32 s40, s12, 2
    s_lshl_b32 s40, s40, 6
    s_add_u32 s31, s31, s40
    s_and_b32 s40, s12, 4
    s_lshl_b32 s40, s40, 4
    s_add_u32 s31, s31, s40
    s_add_u32 s31, s31, 8192
cs_notx:
    s_cmp_lg_u32 s13, 0
    s_cbranch_scc1 cs_notp
    s_min_u32 s40, s12, 23
    s_mul_i32 s40, s40, 384
    s_add_u32 s40, s40, 98304
    v_add_u32 v69, s40, v61
    v_mov_b32 v25, 108288
    v_cmp_lt_u32 vcc, 23, v0
    s_nop 1
    v_cndmask_b32 v69, v69, v25, vcc
cs_notp:
    s_nop 1
    s_waitcnt lgkmcnt(0)
    s_waitcnt vmcnt(12)
    v_add_u32 v55, 0, v52
    ds_read_b64_tr_b16 v[184:185], v55 offset:0
    ds_read_b64_tr_b16 v[186:187], v55 offset:256
    ds_read_b64_tr_b16 v[188:189], v55 offset:4096
    ds_read_b64_tr_b16 v[190:191], v55 offset:4352
    s_xor_b32 s78, s75, 0
    s_add_u32 s78, s78, s67
    s_mov_b32 s81, s93
    s_add_u32 s80, s66, 114688
    s_mov_b32 s76, 0
    s_mov_b32 s77, 8192
    s_call_b64 s[82:83], cs_dma
    ds_read_b64_tr_b16 v[216:217], v55 offset:64
    ds_read_b64_tr_b16 v[218:219], v55 offset:320
    ds_read_b64_tr_b16 v[220:221], v55 offset:4160
    ds_read_b64_tr_b16 v[222:223], v55 offset:4416
    s_mov_b32 s77, 16384
    s_call_b64 s[82:83], cs_dma
    v_mov_b32 v28, 1
    v_mov_b32 v29, 1
    v_mov_b32 v30, 1
    v_mov_b32 v31, 1
    s_lshl_b32 s40, s12, 14
    s_add_u32 s40, s40, 68222976
    s_add_u32 s41, s40, 0
    buffer_store_dwordx4 v[28:31], v61, s[4:7], s41 offen sc1
    s_add_u32 s41, s40, 4096
    buffer_store_dwordx4 v[28:31], v61, s[4:7], s41 offen sc1
    s_add_u32 s41, s40, 8192
    buffer_store_dwordx4 v[28:31], v61, s[4:7], s41 offen sc1
    s_cmp_eq_u32 s64, 0
    s_cselect_b64 exec, 0, s[32:33]
    v_mov_b32 v27, -1
    s_add_u32 s41, s31, 68157440
    buffer_store_dword v27, v69, s[4:7], s41 offen sc1
    s_add_u32 s41, s31, 68173824
    buffer_store_dword v27, v69, s[4:7], s41 offen sc1
    s_add_u32 s41, s31, 68190208
    buffer_store_dword v27, v69, s[4:7], s41 offen sc1
    s_add_u32 s41, s31, 68206592
    buffer_store_dword v27, v69, s[4:7], s41 offen sc1
    s_mov_b64 exec, -1
    s_waitcnt lgkmcnt(0)
    s_waitcnt vmcnt(12)
    v_add_u32 v55, 147456, v52
    ds_read_b64_tr_b16 v[224:225], v55 offset:0
    ds_read_b64_tr_b16 v[226:227], v55 offset:256
    ds_read_b64_tr_b16 v[228:229], v55 offset:4096
    ds_read_b64_tr_b16 v[230:231], v55 offset:4352
    s_mov_b32 s77, 24576
    s_call_b64 s[82:83], cs_dma
    ds_read_b64_tr_b16 v[240:241], v55 offset:64
    ds_read_b64_tr_b16 v[242:243], v55 offset:320
    ds_read_b64_tr_b16 v[244:245], v55 offset:4160
    ds_read_b64_tr_b16 v[246:247], v55 offset:4416
    s_mov_b32 s77, 32768
    s_call_b64 s[82:83], cs_dma
    s_mov_b64 s[68:69], s[48:49]
    s_mov_b32 s70, 9216
    s_mov_b32 s71, 0x20000
    v_and_b32 v25, 7, v0
    v_mul_u32_u24 v25, 1152, v25
    v_lshrrev_b32 v26, 3, v0
    v_lshl_add_u32 v25, v26, 4, v25
    buffer_load_dwordx4 v[36:39], v25, s[68:71], 0 offen
    buffer_load_dwordx4 v[40:43], v25, s[68:71], 0 offen offset:512
    v_bfe_u32 v25, v0, 2, 3
    v_mul_u32_u24 v25, 1152, v25
    v_lshrrev_b32 v26, 5, v0
    v_lshl_add_u32 v25, v26, 4, v25
    v_and_b32 v26, 3, v0
    v_lshl_add_u32 v25, v26, 2, v25
    buffer_load_dword v44, v25, s[68:71], 0 offen offset:1024
    s_nop 0
    s_waitcnt lgkmcnt(0)
    s_waitcnt vmcnt(15)
    v_add_u32 v55, 98304, v52
    ds_read_b64_tr_b16 v[232:233], v55 offset:0
    ds_read_b64_tr_b16 v[234:235], v55 offset:256
    ds_read_b64_tr_b16 v[236:237], v55 offset:4096
    ds_read_b64_tr_b16 v[238:239], v55 offset:4352
    s_xor_b32 s78, s75, 1048576
    s_add_u32 s78, s78, s67
    s_add_u32 s80, s66, 65536
    s_mov_b32 s76, 0
    s_mov_b32 s77, 8192
    s_call_b64 s[82:83], cs_dma
    ds_read_b64_tr_b16 v[248:249], v55 offset:64
    ds_read_b64_tr_b16 v[250:251], v55 offset:320
    ds_read_b64_tr_b16 v[252:253], v55 offset:4160
    ds_read_b64_tr_b16 v[254:255], v55 offset:4416
    s_mov_b32 s77, 16384
    s_call_b64 s[82:83], cs_dma
    s_mov_b32 s44, 0x3e0293ee
    s_mov_b32 s45, s44
    s_mov_b32 s46, 0x42000000
    s_mov_b32 s60, 0x3f803f80
    s_mov_b32 s61, s60
    s_mov_b32 s62, 0x3e803e80
    s_mov_b32 s63, s62
    s_mov_b32 s28, 0
    s_lshl_b32 s58, s13, 10
    s_add_u32 s58, s58, 102400
    s_lshl_b32 s59, s13, 8
    s_add_u32 s59, s59, 106496
    s_lshl_b32 s24, s12, 14
    s_add_u32 s24, s24, 0
    s_add_u32 s47, s24, 33030144
    s_mul_i32 s40, s13, 3072
    s_add_u32 s23, s24, s40
    s_lshl_b32 s20, s12, 7
    s_add_u32 s20, s20, 68222976
    s_add_u32 s21, s20, 65536
    s_add_u32 s38, s20, 4096
    s_add_u32 s39, s21, 4096
    s_lshl_b32 s22, s12, 7
    s_add_u32 s22, s22, 68231168
    s_waitcnt lgkmcnt(0)
    s_waitcnt vmcnt(15)
    v_add_u32 v55, 32768, v51
    v_xor_b32 v56, 32, v55
    ds_read_b64_tr_b16 v[144:145], v55 offset:0
    ds_read_b64_tr_b16 v[146:147], v55 offset:256
    ds_read_b64_tr_b16 v[148:149], v55 offset:8192
    ds_read_b64_tr_b16 v[150:151], v55 offset:8448
    s_mov_b32 s77, 24576
    s_call_b64 s[82:83], cs_dma
    ds_read_b64_tr_b16 v[152:153], v56 offset:0
    ds_read_b64_tr_b16 v[154:155], v56 offset:256
    ds_read_b64_tr_b16 v[156:157], v56 offset:8192
    ds_read_b64_tr_b16 v[158:159], v56 offset:8448
    s_mov_b32 s77, 32768
    s_call_b64 s[82:83], cs_dma
    s_lshl_b32 s40, s12, 12
    s_add_u32 s25, s40, 79429632
    s_add_u32 s26, s40, 88866816
    s_lshl_b32 s65, s12, 9
    s_add_u32 s65, s65, 90177536
    s_lshl_b32 s40, s13, 5
    s_or_b32 s40, s40, s12
    s_cmp_lt_u32 s40, 24
    s_cselect_b32 s36, 0x1ffffff, 0
    s_mov_b32 s37, 0
    s_lshl_b32 s27, s12, 7
    s_add_u32 s27, s27, 125845504
    s_lshl_b32 s40, s13, 2
    s_add_u32 s27, s27, s40
    v_bfe_u32 v28, v61, 4, 4
    v_bfe_u32 v29, v61, 8, 1
    v_lshlrev_b32 v29, 2, v29
    v_sub_u32 v29, v28, v29
    v_mov_b32 v31, 0x3f80
    v_mov_b32 v32, 0x3f800000
    s_nop 1
    s_waitcnt lgkmcnt(0)
    s_waitcnt vmcnt(11)
    v_add_u32 v55, 114688, v51
    v_xor_b32 v56, 32, v55
    ds_read_b64_tr_b16 a[192:193], v55 offset:0
    ds_read_b64_tr_b16 a[194:195], v55 offset:256
    ds_read_b64_tr_b16 a[196:197], v55 offset:8192
    ds_read_b64_tr_b16 a[198:199], v55 offset:8448
    s_xor_b32 s78, s75, 2097152
    s_add_u32 s78, s78, s67
    s_add_u32 s80, s66, 0
    s_mov_b32 s76, 0
    s_mov_b32 s77, 8192
    s_call_b64 s[82:83], cs_dma
    ds_read_b64_tr_b16 a[200:201], v56 offset:0
    ds_read_b64_tr_b16 a[202:203], v56 offset:256
    ds_read_b64_tr_b16 a[204:205], v56 offset:8192
    ds_read_b64_tr_b16 a[206:207], v56 offset:8448
    s_mov_b32 s77, 16384
    s_call_b64 s[82:83], cs_dma
    v_cmp_eq_u32 vcc, 0, v29
    s_nop 1
    v_cndmask_b32 v16, 0, v31, vcc
    v_cmp_eq_u32 vcc, 1, v29
    s_nop 1
    v_cndmask_b32 v16, v16, v32, vcc
    v_cmp_eq_u32 vcc, 0, v28
    s_nop 1
    v_cndmask_b32 v20, 0, v31, vcc
    v_cmp_eq_u32 vcc, 1, v28
    s_nop 1
    v_cndmask_b32 v20, v20, v32, vcc
    s_nop 1
    s_waitcnt lgkmcnt(0)
    v_add_u32 v55, 131072, v51
    v_xor_b32 v56, 32, v55
    ds_read_b64_tr_b16 a[208:209], v55 offset:0
    ds_read_b64_tr_b16 a[210:211], v55 offset:256
    ds_read_b64_tr_b16 a[212:213], v55 offset:8192
    ds_read_b64_tr_b16 a[214:215], v55 offset:8448
    s_mov_b32 s77, 24576
    s_call_b64 s[82:83], cs_dma
    ds_read_b64_tr_b16 a[216:217], v56 offset:0
    ds_read_b64_tr_b16 a[218:219], v56 offset:256
    ds_read_b64_tr_b16 a[220:221], v56 offset:8192
    ds_read_b64_tr_b16 a[222:223], v56 offset:8448
    s_mov_b32 s77, 32768
    s_call_b64 s[82:83], cs_dma
    v_cmp_eq_u32 vcc, 2, v29
    s_nop 1
    v_cndmask_b32 v17, 0, v31, vcc
    v_cmp_eq_u32 vcc, 3, v29
    s_nop 1
    v_cndmask_b32 v17, v17, v32, vcc
    v_cmp_eq_u32 vcc, 2, v28
    s_nop 1
    v_cndmask_b32 v21, 0, v31, vcc
    v_cmp_eq_u32 vcc, 3, v28
    s_nop 1
    v_cndmask_b32 v21, v21, v32, vcc
    s_nop 1
    s_waitcnt lgkmcnt(0)
    s_waitcnt vmcnt(8)
    v_add_u32 v55, 65536, v51
    v_xor_b32 v56, 32, v55
    ds_read_b64_tr_b16 a[224:225], v55 offset:0
    ds_read_b64_tr_b16 a[226:227], v55 offset:256
    ds_read_b64_tr_b16 a[228:229], v55 offset:8192
    ds_read_b64_tr_b16 a[230:231], v55 offset:8448
    s_xor_b32 s78, s75, 3145728
    s_add_u32 s78, s78, s67
    s_add_u32 s80, s66, 32768
    s_mov_b32 s76, 0
    s_mov_b32 s77, 8192
    s_call_b64 s[82:83], cs_dma
    ds_read_b64_tr_b16 a[232:233], v56 offset:0
    ds_read_b64_tr_b16 a[234:235], v56 offset:256
    ds_read_b64_tr_b16 a[236:237], v56 offset:8192
    ds_read_b64_tr_b16 a[238:239], v56 offset:8448
    s_mov_b32 s77, 16384
    s_call_b64 s[82:83], cs_dma
    v_cmp_eq_u32 vcc, 8, v29
    s_nop 1
    v_cndmask_b32 v18, 0, v31, vcc
    v_cmp_eq_u32 vcc, 9, v29
    s_nop 1
    v_cndmask_b32 v18, v18, v32, vcc
    v_cmp_eq_u32 vcc, 4, v28
    s_nop 1
    v_cndmask_b32 v22, 0, v31, vcc
    v_cmp_eq_u32 vcc, 5, v28
    s_nop 1
    v_cndmask_b32 v22, v22, v32, vcc
    s_nop 1
    s_waitcnt lgkmcnt(0)
    v_add_u32 v55, 81920, v51
    v_xor_b32 v56, 32, v55
    ds_read_b64_tr_b16 a[240:241], v55 offset:0
    ds_read_b64_tr_b16 a[242:243], v55 offset:256
    ds_read_b64_tr_b16 a[244:245], v55 offset:8192
    ds_read_b64_tr_b16 a[246:247], v55 offset:8448
    s_mov_b32 s77, 24576
    s_call_b64 s[82:83], cs_dma
    ds_read_b64_tr_b16 a[248:249], v56 offset:0
    ds_read_b64_tr_b16 a[250:251], v56 offset:256
    ds_read_b64_tr_b16 a[252:253], v56 offset:8192
    ds_read_b64_tr_b16 a[254:255], v56 offset:8448
    s_mov_b32 s77, 32768
    s_call_b64 s[82:83], cs_dma
    v_cmp_eq_u32 vcc, 10, v29
    s_nop 1
    v_cndmask_b32 v19, 0, v31, vcc
    v_cmp_eq_u32 vcc, 11, v29
    s_nop 1
    v_cndmask_b32 v19, v19, v32, vcc
    v_cmp_eq_u32 vcc, 6, v28
    s_nop 1
    v_cndmask_b32 v23, 0, v31, vcc
    v_cmp_eq_u32 vcc, 7, v28
    s_nop 1
    v_cndmask_b32 v23, v23, v32, vcc
    s_nop 1
    s_waitcnt lgkmcnt(0)
    s_waitcnt vmcnt(8)
    v_add_u32 v55, 0, v51
    v_xor_b32 v56, 32, v55
    ds_read_b64_tr_b16 v[80:81], v55 offset:0
    ds_read_b64_tr_b16 v[82:83], v55 offset:256
    ds_read_b64_tr_b16 v[84:85], v55 offset:8192
    ds_read_b64_tr_b16 v[86:87], v55 offset:8448
    s_xor_b32 s78, s75, 2097152
    s_add_u32 s78, s78, s67
    s_mov_b64 s[8:9], s[52:53]
    s_add_u32 s80, s66, 131072
    s_mov_b32 s76, 0
    s_mov_b32 s77, 8192
    s_call_b64 s[82:83], cs_dma
    ds_read_b64_tr_b16 v[88:89], v56 offset:0
    ds_read_b64_tr_b16 v[90:91], v56 offset:256
    ds_read_b64_tr_b16 v[92:93], v56 offset:8192
    ds_read_b64_tr_b16 v[94:95], v56 offset:8448
    s_mov_b32 s77, 16384
    s_call_b64 s[82:83], cs_dma
    v_mov_b32 v46, 1
    s_mov_b64 exec, 1
    buffer_atomic_add v46, off, s[96:99], 0 offset:212 sc0
    s_mov_b64 exec, -1
    s_waitcnt lgkmcnt(0)
    v_add_u32 v55, 16384, v51
    v_xor_b32 v56, 32, v55
    ds_read_b64_tr_b16 v[96:97], v55 offset:0
    ds_read_b64_tr_b16 v[98:99], v55 offset:256
    ds_read_b64_tr_b16 v[100:101], v55 offset:8192
    ds_read_b64_tr_b16 v[102:103], v55 offset:8448
    s_mov_b32 s77, 24576
    s_call_b64 s[82:83], cs_dma
    ds_read_b64_tr_b16 v[104:105], v56 offset:0
    ds_read_b64_tr_b16 v[106:107], v56 offset:256
    ds_read_b64_tr_b16 v[108:109], v56 offset:8192
    ds_read_b64_tr_b16 v[110:111], v56 offset:8448
    s_mov_b32 s77, 32768
    s_call_b64 s[82:83], cs_dma
    s_waitcnt lgkmcnt(0)
    s_waitcnt vmcnt(9)
    v_add_u32 v55, 32768, v51
    v_xor_b32 v56, 32, v55
    ds_read_b64_tr_b16 v[112:113], v55 offset:0
    ds_read_b64_tr_b16 v[114:115], v55 offset:256
    ds_read_b64_tr_b16 v[116:117], v55 offset:8192
    ds_read_b64_tr_b16 v[118:119], v55 offset:8448
    s_xor_b32 s78, s75, 3145728
    s_add_u32 s78, s78, s67
    s_add_u32 s80, s66, 65536
    s_mov_b32 s76, 0
    s_mov_b32 s77, 8192
    s_call_b64 s[82:83], cs_dma
    ds_read_b64_tr_b16 v[120:121], v56 offset:0
    ds_read_b64_tr_b16 v[122:123], v56 offset:256
    ds_read_b64_tr_b16 v[124:125], v56 offset:8192
    ds_read_b64_tr_b16 v[126:127], v56 offset:8448
    s_mov_b32 s77, 16384
    s_call_b64 s[82:83], cs_dma
    s_waitcnt lgkmcnt(0)
    v_add_u32 v55, 49152, v51
    v_xor_b32 v56, 32, v55
    ds_read_b64_tr_b16 v[128:129], v55 offset:0
    ds_read_b64_tr_b16 v[130:131], v55 offset:256
    ds_read_b64_tr_b16 v[132:133], v55 offset:8192
    ds_read_b64_tr_b16 v[134:135], v55 offset:8448
    s_mov_b32 s77, 24576
    s_call_b64 s[82:83], cs_dma
    ds_read_b64_tr_b16 v[136:137], v56 offset:0
    ds_read_b64_tr_b16 v[138:139], v56 offset:256
    ds_read_b64_tr_b16 v[140:141], v56 offset:8192
    ds_read_b64_tr_b16 v[142:143], v56 offset:8448
    s_mov_b32 s77, 32768
    s_call_b64 s[82:83], cs_dma
    s_waitcnt lgkmcnt(0)
    s_waitcnt vmcnt(8)
    v_add_u32 v55, 131072, v51
    v_xor_b32 v56, 32, v55
    ds_read_b64_tr_b16 a[128:129], v55 offset:0
    ds_read_b64_tr_b16 a[130:131], v55 offset:256
    ds_read_b64_tr_b16 a[132:133], v55 offset:8192
    ds_read_b64_tr_b16 a[134:135], v55 offset:8448
    s_xor_b32 s78, s75, 2097152
    s_add_u32 s78, s78, s67
    s_mov_b64 s[8:9], s[50:51]
    s_add_u32 s80, s66, 0
    s_mov_b32 s76, 0
    s_mov_b32 s77, 8192
    s_call_b64 s[82:83], cs_dma
    ds_read_b64_tr_b16 a[136:137], v56 offset:0
    ds_read_b64_tr_b16 a[138:139], v56 offset:256
    ds_read_b64_tr_b16 a[140:141], v56 offset:8192
    ds_read_b64_tr_b16 a[142:143], v56 offset:8448
    s_mov_b32 s77, 16384
    s_call_b64 s[82:83], cs_dma
    s_waitcnt lgkmcnt(0)
    v_add_u32 v55, 147456, v51
    v_xor_b32 v56, 32, v55
    ds_read_b64_tr_b16 a[144:145], v55 offset:0
    ds_read_b64_tr_b16 a[146:147], v55 offset:256
    ds_read_b64_tr_b16 a[148:149], v55 offset:8192
    ds_read_b64_tr_b16 a[150:151], v55 offset:8448
    s_mov_b32 s77, 24576
    s_call_b64 s[82:83], cs_dma
    ds_read_b64_tr_b16 a[152:153], v56 offset:0
    ds_read_b64_tr_b16 a[154:155], v56 offset:256
    ds_read_b64_tr_b16 a[156:157], v56 offset:8192
    ds_read_b64_tr_b16 a[158:159], v56 offset:8448
    s_mov_b32 s77, 32768
    s_call_b64 s[82:83], cs_dma
    s_waitcnt lgkmcnt(0)
    s_waitcnt vmcnt(8)
    v_add_u32 v55, 65536, v51
    v_xor_b32 v56, 32, v55
    ds_read_b64_tr_b16 a[160:161], v55 offset:0
    ds_read_b64_tr_b16 a[162:163], v55 offset:256
    ds_read_b64_tr_b16 a[164:165], v55 offset:8192
    ds_read_b64_tr_b16 a[166:167], v55 offset:8448
    s_xor_b32 s78, s75, 3145728
    s_add_u32 s78, s78, s67
    s_add_u32 s80, s66, 32768
    s_mov_b32 s76, 0
    s_mov_b32 s77, 8192
    s_call_b64 s[82:83], cs_dma
    ds_read_b64_tr_b16 a[168:169], v56 offset:0
    ds_read_b64_tr_b16 a[170:171], v56 offset:256
    ds_read_b64_tr_b16 a[172:173], v56 offset:8192
    ds_read_b64_tr_b16 a[174:175], v56 offset:8448
    s_mov_b32 s77, 16384
    s_call_b64 s[82:83], cs_dma
    v_readfirstlane_b32 s41, v46
    v_mov_b32 v46, 1
    v_mov_b32 v47, 0
    s_cmp_eq_u32 s41, 127
    s_cselect_b64 exec, 1, 0
    buffer_atomic_cmpswap v[46:47], off, s[96:99], 0 offset:216
    s_mov_b64 exec, -1
    s_waitcnt lgkmcnt(0)
    v_add_u32 v55, 81920, v51
    v_xor_b32 v56, 32, v55
    ds_read_b64_tr_b16 a[176:177], v55 offset:0
    ds_read_b64_tr_b16 a[178:179], v55 offset:256
    ds_read_b64_tr_b16 a[180:181], v55 offset:8192
    ds_read_b64_tr_b16 a[182:183], v55 offset:8448
    s_mov_b32 s77, 24576
    s_call_b64 s[82:83], cs_dma
    ds_read_b64_tr_b16 a[184:185], v56 offset:0
    ds_read_b64_tr_b16 a[186:187], v56 offset:256
    ds_read_b64_tr_b16 a[188:189], v56 offset:8192
    ds_read_b64_tr_b16 a[190:191], v56 offset:8448
    s_mov_b32 s77, 32768
    s_call_b64 s[82:83], cs_dma
    s_waitcnt lgkmcnt(0)
    s_waitcnt vmcnt(8)
    v_add_u32 v55, 0, v51
    v_xor_b32 v56, 32, v55
    ds_read_b64_tr_b16 a[48:49], v55 offset:0
    ds_read_b64_tr_b16 a[50:51], v55 offset:256
    ds_read_b64_tr_b16 a[52:53], v55 offset:8192
    ds_read_b64_tr_b16 a[54:55], v55 offset:8448
    s_add_u32 s78, s67, 4194304
    s_mov_b32 s81, 0
    s_add_u32 s80, s66, 98304
    s_mov_b32 s76, 0
    s_mov_b32 s77, 8192
    s_call_b64 s[82:83], cs_dma
    ds_read_b64_tr_b16 a[56:57], v56 offset:0
    ds_read_b64_tr_b16 a[58:59], v56 offset:256
    ds_read_b64_tr_b16 a[60:61], v56 offset:8192
    ds_read_b64_tr_b16 a[62:63], v56 offset:8448
    s_mov_b32 s77, 16384
    s_call_b64 s[82:83], cs_dma
    s_waitcnt lgkmcnt(0)
    v_add_u32 v55, 16384, v51
    v_xor_b32 v56, 32, v55
    ds_read_b64_tr_b16 a[64:65], v55 offset:0
    ds_read_b64_tr_b16 a[66:67], v55 offset:256
    ds_read_b64_tr_b16 a[68:69], v55 offset:8192
    ds_read_b64_tr_b16 a[70:71], v55 offset:8448
    s_xor_b32 s78, s75, 1048576
    s_add_u32 s78, s78, s67
    s_mov_b32 s81, s93
    s_add_u32 s80, s66, 114688
    s_mov_b32 s76, 0
    s_mov_b32 s77, 8192
    s_call_b64 s[82:83], cs_dma
    ds_read_b64_tr_b16 a[72:73], v56 offset:0
    ds_read_b64_tr_b16 a[74:75], v56 offset:256
    ds_read_b64_tr_b16 a[76:77], v56 offset:8192
    ds_read_b64_tr_b16 a[78:79], v56 offset:8448
    s_mov_b32 s77, 16384
    s_call_b64 s[82:83], cs_dma
    s_waitcnt lgkmcnt(0)
    s_waitcnt vmcnt(8)
    v_add_u32 v55, 32768, v51
    v_xor_b32 v56, 32, v55
    ds_read_b64_tr_b16 a[80:81], v55 offset:0
    ds_read_b64_tr_b16 a[82:83], v55 offset:256
    ds_read_b64_tr_b16 a[84:85], v55 offset:8192
    ds_read_b64_tr_b16 a[86:87], v55 offset:8448
    s_mov_b32 s77, 24576
    s_call_b64 s[82:83], cs_dma
    ds_read_b64_tr_b16 a[88:89], v56 offset:0
    ds_read_b64_tr_b16 a[90:91], v56 offset:256
    ds_read_b64_tr_b16 a[92:93], v56 offset:8192
    ds_read_b64_tr_b16 a[94:95], v56 offset:8448
    s_mov_b32 s77, 32768
    s_call_b64 s[82:83], cs_dma
    s_waitcnt lgkmcnt(0)
    v_add_u32 v55, 49152, v51
    v_xor_b32 v56, 32, v55
    ds_read_b64_tr_b16 a[96:97], v55 offset:0
    ds_read_b64_tr_b16 a[98:99], v55 offset:256
    ds_read_b64_tr_b16 a[100:101], v55 offset:8192
    ds_read_b64_tr_b16 a[102:103], v55 offset:8448
    s_xor_b32 s78, s75, 0
    s_add_u32 s78, s78, s67
    s_add_u32 s80, s66, 65536
    s_mov_b32 s76, 0
    s_mov_b32 s77, 8192
    s_call_b64 s[82:83], cs_dma
    ds_read_b64_tr_b16 a[104:105], v56 offset:0
    ds_read_b64_tr_b16 a[106:107], v56 offset:256
    ds_read_b64_tr_b16 a[108:109], v56 offset:8192
    ds_read_b64_tr_b16 a[110:111], v56 offset:8448
    s_mov_b32 s77, 16384
    s_call_b64 s[82:83], cs_dma
    s_waitcnt lgkmcnt(0)
    s_waitcnt vmcnt(12)
    v_add_u32 v55, 98304, v51
    v_xor_b32 v56, 32, v55
    ds_read_b64_tr_b16 a[112:113], v55 offset:0
    ds_read_b64_tr_b16 a[114:115], v55 offset:256
    ds_read_b64_tr_b16 a[116:117], v55 offset:8192
    ds_read_b64_tr_b16 a[118:119], v55 offset:8448
    s_mov_b32 s77, 24576
    s_call_b64 s[82:83], cs_dma
    ds_read_b64_tr_b16 a[120:121], v56 offset:0
    ds_read_b64_tr_b16 a[122:123], v56 offset:256
    ds_read_b64_tr_b16 a[124:125], v56 offset:8192
    ds_read_b64_tr_b16 a[126:127], v56 offset:8448
    s_mov_b32 s77, 32768
    s_call_b64 s[82:83], cs_dma
    s_waitcnt lgkmcnt(0)
    s_waitcnt vmcnt(8)
    v_add_u32 v55, 114688, v51
    v_xor_b32 v56, 32, v55
    ds_read_b64_tr_b16 a[16:17], v55 offset:0
    ds_read_b64_tr_b16 a[18:19], v55 offset:256
    ds_read_b64_tr_b16 a[20:21], v55 offset:8192
    ds_read_b64_tr_b16 a[22:23], v55 offset:8448
    s_xor_b32 s78, s75, 0
    s_add_u32 s78, s78, s67
    s_mov_b64 s[8:9], s[52:53]
    s_add_u32 s80, s66, 0
    s_mov_b32 s76, 0
    s_mov_b32 s77, 8192
    s_call_b64 s[82:83], cs_dma
    ds_read_b64_tr_b16 a[24:25], v56 offset:0
    ds_read_b64_tr_b16 a[26:27], v56 offset:256
    ds_read_b64_tr_b16 a[28:29], v56 offset:8192
    ds_read_b64_tr_b16 a[30:31], v56 offset:8448
    s_mov_b32 s77, 16384
    s_call_b64 s[82:83], cs_dma
    s_waitcnt lgkmcnt(0)
    v_add_u32 v55, 131072, v51
    v_xor_b32 v56, 32, v55
    ds_read_b64_tr_b16 a[32:33], v55 offset:0
    ds_read_b64_tr_b16 a[34:35], v55 offset:256
    ds_read_b64_tr_b16 a[36:37], v55 offset:8192
    ds_read_b64_tr_b16 a[38:39], v55 offset:8448
    s_mov_b32 s77, 24576
    s_call_b64 s[82:83], cs_dma
    ds_read_b64_tr_b16 a[40:41], v56 offset:0
    ds_read_b64_tr_b16 a[42:43], v56 offset:256
    ds_read_b64_tr_b16 a[44:45], v56 offset:8192
    ds_read_b64_tr_b16 a[46:47], v56 offset:8448
    s_mov_b32 s77, 32768
    s_call_b64 s[82:83], cs_dma
    s_waitcnt lgkmcnt(0)
    s_waitcnt vmcnt(8)
    v_add_u32 v55, 65536, v51
    v_xor_b32 v56, 32, v55
    ds_read_b64_tr_b16 v[0:1], v55 offset:0
    ds_read_b64_tr_b16 v[2:3], v55 offset:256
    ds_read_b64_tr_b16 v[4:5], v55 offset:8192
    ds_read_b64_tr_b16 v[6:7], v55 offset:8448
    s_xor_b32 s78, s75, 1048576
    s_add_u32 s78, s78, s67
    s_add_u32 s80, s66, 32768
    s_mov_b32 s76, 0
    s_mov_b32 s77, 8192
    s_call_b64 s[82:83], cs_dma
    ds_read_b64_tr_b16 v[8:9], v56 offset:0
    ds_read_b64_tr_b16 v[10:11], v56 offset:256
    ds_read_b64_tr_b16 v[12:13], v56 offset:8192
    ds_read_b64_tr_b16 v[14:15], v56 offset:8448
    s_mov_b32 s77, 16384
    s_call_b64 s[82:83], cs_dma
    s_waitcnt lgkmcnt(0)
    ds_write_b128 v62, v[0:3] offset:8192
    ds_write_b128 v62, v[4:7] offset:12288
    ds_write_b128 v62, v[8:11] offset:16384
    ds_write_b128 v62, v[12:15] offset:20480
    s_waitcnt lgkmcnt(0)
    v_add_u32 v55, 81920, v51
    v_xor_b32 v56, 32, v55
    ds_read_b64_tr_b16 a[0:1], v55 offset:0
    ds_read_b64_tr_b16 a[2:3], v55 offset:256
    ds_read_b64_tr_b16 a[4:5], v55 offset:8192
    ds_read_b64_tr_b16 a[6:7], v55 offset:8448
    s_mov_b32 s77, 24576
    s_call_b64 s[82:83], cs_dma
    ds_read_b64_tr_b16 a[8:9], v56 offset:0
    ds_read_b64_tr_b16 a[10:11], v56 offset:256
    ds_read_b64_tr_b16 a[12:13], v56 offset:8192
    ds_read_b64_tr_b16 a[14:15], v56 offset:8448
    s_mov_b32 s77, 32768
    s_call_b64 s[82:83], cs_dma
    s_waitcnt lgkmcnt(0)
    s_waitcnt vmcnt(8)
    v_add_u32 v55, 0, v51
    v_xor_b32 v56, 32, v55
    ds_read_b64_tr_b16 v[0:1], v55 offset:0
    ds_read_b64_tr_b16 v[2:3], v55 offset:256
    ds_read_b64_tr_b16 v[4:5], v55 offset:8192
    ds_read_b64_tr_b16 v[6:7], v55 offset:8448
    s_xor_b32 s94, s13, 0
    s_mul_i32 s94, s94, 36864
    s_add_u32 s94, s94, s92
    s_lshr_b32 s74, s13, 1
    s_lshl_b32 s74, s74, 6
    s_add_u32 s94, s94, s74
    s_add_u32 s78, s94, 1024
    s_mov_b64 s[8:9], s[56:57]
    v_mov_b32 v58, v50
    s_mov_b32 s79, 18432
    s_mov_b32 s81, 0
    s_add_u32 s80, s66, 147456
    s_mov_b32 s76, 0
    s_mov_b32 s77, 8192
    s_call_b64 s[82:83], cs_dma
    ds_read_b64_tr_b16 v[8:9], v56 offset:0
    ds_read_b64_tr_b16 v[10:11], v56 offset:256
    ds_read_b64_tr_b16 v[12:13], v56 offset:8192
    ds_read_b64_tr_b16 v[14:15], v56 offset:8448
    s_xor_b32 s94, s13, 2
    s_mul_i32 s94, s94, 36864
    s_add_u32 s94, s94, s92
    s_lshr_b32 s74, s13, 1
    s_lshl_b32 s74, s74, 6
    s_add_u32 s94, s94, s74
    s_add_u32 s78, s94, 1024
    s_mov_b32 s77, 16384
    s_call_b64 s[82:83], cs_dma
    s_waitcnt lgkmcnt(0)
    ds_write_b128 v61, v[0:3] offset:0
    ds_write_b128 v61, v[4:7] offset:4096
    ds_write_b128 v61, v[8:11] offset:8192
    ds_write_b128 v61, v[12:15] offset:12288
    s_waitcnt lgkmcnt(0)
    v_add_u32 v55, 16384, v51
    v_xor_b32 v56, 32, v55
    ds_read_b64_tr_b16 v[0:1], v55 offset:0
    ds_read_b64_tr_b16 v[2:3], v55 offset:256
    ds_read_b64_tr_b16 v[4:5], v55 offset:8192
    ds_read_b64_tr_b16 v[6:7], v55 offset:8448
    s_xor_b32 s94, s13, 3
    s_mul_i32 s94, s94, 36864
    s_add_u32 s94, s94, s92
    s_lshl_b32 s74, s13, 7
    s_add_u32 s94, s94, s74
    s_add_u32 s78, s94, 512
    v_mov_b32 v58, v49
    s_mov_b32 s79, 9216
    s_add_u32 s80, s66, 131072
    s_mov_b32 s76, 0
    s_mov_b32 s77, 8192
    s_call_b64 s[82:83], cs_dma
    ds_read_b64_tr_b16 v[8:9], v56 offset:0
    ds_read_b64_tr_b16 v[10:11], v56 offset:256
    ds_read_b64_tr_b16 v[12:13], v56 offset:8192
    ds_read_b64_tr_b16 v[14:15], v56 offset:8448
    s_mov_b32 s77, 16384
    s_call_b64 s[82:83], cs_dma
    s_waitcnt lgkmcnt(0)
    ds_write_b128 v61, v[0:3] offset:16384
    ds_write_b128 v61, v[4:7] offset:20480
    ds_write_b128 v61, v[8:11] offset:24576
    ds_write_b128 v61, v[12:15] offset:28672
    s_waitcnt lgkmcnt(0)
    s_waitcnt vmcnt(8)
    v_add_u32 v55, 32768, v51
    v_xor_b32 v56, 32, v55
    ds_read_b64_tr_b16 v[0:1], v55 offset:0
    ds_read_b64_tr_b16 v[2:3], v55 offset:256
    ds_read_b64_tr_b16 v[4:5], v55 offset:8192
    ds_read_b64_tr_b16 v[6:7], v55 offset:8448
    s_xor_b32 s94, s13, 2
    s_mul_i32 s94, s94, 36864
    s_add_u32 s94, s94, s92
    s_lshl_b32 s74, s13, 7
    s_add_u32 s94, s94, s74
    s_add_u32 s78, s94, 512
    s_add_u32 s80, s66, 114688
    s_mov_b32 s76, 0
    s_mov_b32 s77, 8192
    s_call_b64 s[82:83], cs_dma
    ds_read_b64_tr_b16 v[8:9], v56 offset:0
    ds_read_b64_tr_b16 v[10:11], v56 offset:256
    ds_read_b64_tr_b16 v[12:13], v56 offset:8192
    ds_read_b64_tr_b16 v[14:15], v56 offset:8448
    s_mov_b32 s77, 16384
    s_call_b64 s[82:83], cs_dma
    s_waitcnt lgkmcnt(0)
    ds_write_b128 v61, v[0:3] offset:32768
    ds_write_b128 v61, v[4:7] offset:36864
    ds_write_b128 v61, v[8:11] offset:40960
    ds_write_b128 v61, v[12:15] offset:45056
    s_waitcnt lgkmcnt(0)
    v_add_u32 v55, 49152, v51
    v_xor_b32 v56, 32, v55
    ds_read_b64_tr_b16 v[0:1], v55 offset:0
    ds_read_b64_tr_b16 v[2:3], v55 offset:256
    ds_read_b64_tr_b16 v[4:5], v55 offset:8192
    ds_read_b64_tr_b16 v[6:7], v55 offset:8448
    s_add_u32 s78, s67, 4194304
    s_mov_b64 s[8:9], s[52:53]
    v_mov_b32 v58, v48
    s_mov_b32 s79, 131072
    s_add_u32 s80, s66, 81920
    s_mov_b32 s76, 0
    s_mov_b32 s77, 8192
    s_call_b64 s[82:83], cs_dma
    ds_read_b64_tr_b16 v[8:9], v56 offset:0
    ds_read_b64_tr_b16 v[10:11], v56 offset:256
    ds_read_b64_tr_b16 v[12:13], v56 offset:8192
    ds_read_b64_tr_b16 v[14:15], v56 offset:8448
    s_mov_b32 s77, 16384
    s_call_b64 s[82:83], cs_dma
    s_waitcnt lgkmcnt(0)
    ds_write_b128 v61, v[0:3] offset:49152
    ds_write_b128 v61, v[4:7] offset:53248
    ds_write_b128 v61, v[8:11] offset:57344
    ds_write_b128 v61, v[12:15] offset:61440
    s_waitcnt lgkmcnt(0)
    buffer_load_dword v24, off, s[96:99], 0 offset:216 sc1
    buffer_load_dword v25, off, s[96:99], 0 offset:64 sc1
    s_lshr_b32 s84, s12, 1
    s_lshl_b32 s84, s84, 8
    s_add_u32 s84, s84, 125829120
    v_bfe_u32 v26, v61, 4, 6
    v_min_u32 v26, 11, v26
    v_lshlrev_b32 v26, 2, v26
    buffer_load_dword v27, v26, s[4:7], s84 offen sc1
    s_waitcnt vmcnt(15)
    v_add_u32 v55, 147456, v53
    ds_read_b64_tr_b16 v[0:1], v55 offset:0
    ds_read_b64_tr_b16 v[2:3], v55 offset:128
    ds_read_b64_tr_b16 v[4:5], v55 offset:512
    ds_read_b64_tr_b16 v[6:7], v55 offset:640
    ds_read_b64_tr_b16 v[8:9], v55 offset:8192
    ds_read_b64_tr_b16 v[10:11], v55 offset:8320
    ds_read_b64_tr_b16 v[12:13], v55 offset:8704
    ds_read_b64_tr_b16 v[14:15], v55 offset:8832
    s_waitcnt lgkmcnt(0)
    s_barrier
    ds_write_b128 v63, v[0:3] offset:49152
    ds_write_b128 v63, v[4:7] offset:53248
    s_barrier
    ds_write_b128 v63, v[8:11] offset:57344
    ds_write_b128 v63, v[12:15] offset:61440
    s_waitcnt lgkmcnt(0)
    v_lshlrev_b32 v45, 3, v61
    s_lshl_b32 s40, s12, 14
    s_add_u32 s40, s40, 65536
    s_lshl_b32 s41, s12, 11
    s_sub_u32 s41, s41, 12288
    v_add_u32 v30, s40, v45
    v_add_u32 v45, s41, v45
    v_cmp_gt_u32 vcc, 1536, v61
    s_nop 1
    v_cndmask_b32 v45, v45, v30, vcc
    s_lshl_b32 s40, s12, 16
    s_add_u32 s40, s40, 24102912
    v_lshlrev_b32 v30, 3, v61
    v_add_u32 v30, s40, v30
    v_cmp_gt_u32 vcc, 1792, v61
    s_nop 1
    v_cndmask_b32 v45, v30, v45, vcc
    v_cmp_gt_u32 vcc, 2944, v61
    s_mov_b32 s40, 68157440
    s_mov_b64 exec, vcc
    buffer_load_dword v30, v45, s[4:7], s40 offen sc1
    s_mov_b64 exec, -1
    s_waitcnt vmcnt(11)
    v_add_u32 v55, 131072, v52
    ds_read_b64_tr_b16 v[0:1], v55 offset:0
    ds_read_b64_tr_b16 v[2:3], v55 offset:256
    ds_read_b64_tr_b16 v[4:5], v55 offset:4096
    ds_read_b64_tr_b16 v[6:7], v55 offset:4352
    ds_read_b64_tr_b16 v[8:9], v55 offset:64
    ds_read_b64_tr_b16 v[10:11], v55 offset:320
    ds_read_b64_tr_b16 v[12:13], v55 offset:4160
    ds_read_b64_tr_b16 v[14:15], v55 offset:4416
    s_waitcnt lgkmcnt(0)
    s_barrier
    ds_write_b128 v63, v[0:3] offset:32768
    ds_write_b128 v63, v[4:7] offset:36864
    s_barrier
    ds_write_b128 v63, v[8:11] offset:40960
    ds_write_b128 v63, v[12:15] offset:45056
    s_waitcnt lgkmcnt(0)
    s_waitcnt vmcnt(7)
    v_add_u32 v55, 114688, v52
    ds_read_b64_tr_b16 v[0:1], v55 offset:0
    ds_read_b64_tr_b16 v[2:3], v55 offset:256
    ds_read_b64_tr_b16 v[4:5], v55 offset:4096
    ds_read_b64_tr_b16 v[6:7], v55 offset:4352
    ds_read_b64_tr_b16 v[8:9], v55 offset:64
    ds_read_b64_tr_b16 v[10:11], v55 offset:320
    ds_read_b64_tr_b16 v[12:13], v55 offset:4160
    ds_read_b64_tr_b16 v[14:15], v55 offset:4416
    s_waitcnt lgkmcnt(0)
    s_barrier
    ds_write_b128 v63, v[0:3] offset:16384
    ds_write_b128 v63, v[4:7] offset:20480
    s_barrier
    ds_write_b128 v63, v[8:11] offset:24576
    ds_write_b128 v63, v[12:15] offset:28672
    s_waitcnt lgkmcnt(0)
    v_min_u32 v36, -2, v36
    v_min_u32 v37, -2, v37
    v_min_u32 v38, -2, v38
    v_min_u32 v39, -2, v39
    v_min_u32 v40, -2, v40
    v_min_u32 v41, -2, v41
    v_min_u32 v42, -2, v42
    v_min_u32 v43, -2, v43
    v_min_u32 v44, -2, v44
    s_lshl_b32 s14, s12, 16
    s_add_u32 s14, s14, 92274688
    s_add_u32 s41, s14, 4096
    s_add_u32 s42, s14, 8192
    v_lshrrev_b32 v45, 2, v61
    buffer_store_dwordx4 v[36:39], v61, s[4:7], s14 offen sc1
    buffer_store_dwordx4 v[40:43], v61, s[4:7], s41 offen sc1
    buffer_store_dword v44, v45, s[4:7], s42 offen sc1
    s_waitcnt vmcnt(1)
    v_readfirstlane_b32 s95, v25
    v_readfirstlane_b32 s85, v24
    s_add_u32 s86, s95, 2
    s_waitcnt vmcnt(0)
    v_subrev_u32 v27, s86, v27
    v_cmp_lt_u32 s[86:87], 64, v27
    s_cmp_eq_u32 s95, 0
    s_cselect_b64 s[86:87], -1, s[86:87]
    s_cmp_lg_u64 s[86:87], 0
    s_cbranch_scc1 cs_nt
    s_add_u32 s40, s24, 524288
    buffer_load_dword v30, v79, s[4:7], s24 offen sc1
    buffer_load_dword v30, v79, s[4:7], s40 offen sc1
cs_nt:
    s_waitcnt vmcnt(3)
    v_add_u32 v55, 81920, v51
    v_xor_b32 v56, 32, v55
    ds_read_b64_tr_b16 v[0:1], v55 offset:0
    ds_read_b64_tr_b16 v[2:3], v55 offset:256
    ds_read_b64_tr_b16 v[4:5], v55 offset:8192
    ds_read_b64_tr_b16 v[6:7], v55 offset:8448
    ds_read_b64_tr_b16 v[8:9], v56 offset:0
    ds_read_b64_tr_b16 v[10:11], v56 offset:256
    ds_read_b64_tr_b16 v[12:13], v56 offset:8192
    ds_read_b64_tr_b16 v[14:15], v56 offset:8448
    s_waitcnt lgkmcnt(0)
    ds_write_b128 v62, v[0:3] offset:24576
    ds_write_b128 v62, v[4:7] offset:28672
    ds_write_b128 v62, v[8:11] offset:32768
    ds_write_b128 v62, v[12:15] offset:36864
    s_waitcnt lgkmcnt(0)
    s_barrier
    s_mov_b32 s88, 4194304
gn3:
    s_cmp_lg_u32 s95, 0
    s_cbranch_scc1 gn3x
    buffer_load_dword v27, off, s[96:99], 0 offset:64 sc1
    s_sub_u32 s88, s88, 1
    s_cbranch_scc1 gn3x
    s_waitcnt vmcnt(0)
    v_readfirstlane_b32 s95, v27
    s_nop 1
    s_branch gn3
gn3x:
    ds_write_b128 v78, v[16:19] offset:8704
    ds_write_b128 v65, v[20:23] offset:10240
    v_mov_b32 v44, s95
    v_mov_b32 v45, s95
    v_mov_b32 v46, s95
    v_mov_b32 v47, s95
    v_mov_b32 v48, 108288
    ds_write_b128 v48, v[44:47]
    s_waitcnt vmcnt(0) lgkmcnt(0)
    s_cmp_eq_u32 s85, 1
    s_cbranch_scc1 cs_run
    s_mov_b32 s40, 16777216
cs_startpoll:
    buffer_load_dword v3, off, s[96:99], 0 offset:216 sc1
    s_waitcnt vmcnt(0)
    v_readfirstlane_b32 s85, v3
    s_nop 0
    s_cmp_eq_u32 s85, 1
    s_cbranch_scc1 cs_run
    s_sleep 1
    s_sub_u32 s40, s40, 1
    s_cbranch_scc0 cs_startpoll
    s_endpgm
cs_run:
    s_cmp_eq_u64 s[86:87], 0
    s_cbranch_scc1 cs_kvok
    s_lshr_b32 s92, s12, 1
    s_lshl_b32 s92, s92, 8
    s_add_u32 s92, s92, 125829120
    v_bfe_u32 v2, v61, 4, 6
    v_min_u32 v2, 11, v2
    v_lshlrev_b32 v2, 2, v2
    s_add_u32 s93, s95, 2
    s_mov_b32 s94, 4194304
cs_kv0:
    buffer_load_dword v3, v2, s[4:7], s92 offen sc1
    s_sub_u32 s94, s94, 1
    s_cbranch_scc1 cs_kv0_go
    s_waitcnt vmcnt(0)
    v_subrev_u32 v3, s93, v3
    v_cmp_lt_u32 vcc, 64, v3
    s_cbranch_vccz cs_kv0_go
    s_sleep 2
    s_branch cs_kv0
cs_kv0_go:
    s_add_u32 s40, s24, 524288
    buffer_load_dword v30, v79, s[4:7], s24 offen sc1
    buffer_load_dword v30, v79, s[4:7], s40 offen sc1
    s_waitcnt vmcnt(0)
cs_kvok:
    s_mov_b32 m0, 108032
    s_add_u32 s24, s24, 1048576
    s_mov_b32 s66, 0x201
    s_mov_b32 s67, 0xc0000000
    s_add_u32 s15, s14, 4096
    s_add_u32 s16, s14, 8192
    ds_read_b128 v[32:35], v62 offset:16384
    ds_read_b128 v[36:39], v62 offset:20480
    ds_read_b128 v[40:43], v61 offset:0
    ds_read_b128 v[44:47], v61 offset:4096
    ds_read_b128 v[48:51], v61 offset:8192
    ds_read_b128 v[52:55], v61 offset:12288
    s_add_u32 s18, s14, s31
    s_mov_b32 s29, 1048576
    buffer_load_dwordx4 v[24:27], v61, s[4:7], s14 offen sc1
.p2align 6
cs_loop:
    v_mov_b64 v[0:1], 0
    v_mov_b64 v[2:3], 0
    v_mov_b64 v[4:5], 0
    v_mov_b64 v[6:7], 0
    v_mov_b64 v[8:9], 0
    v_mov_b64 v[10:11], 0
    v_mov_b64 v[12:13], 0
    v_mov_b64 v[14:15], 0
cs_loop2:
    ds_read_b128 v[16:19], v62 offset:8192
    ds_read_b128 v[20:23], v62 offset:12288
    v_lshrrev_b32 v56, 2, v61
    v_add_u32 v58, 106496, v56
    s_mov_b32 s29, 1048576
    s_waitcnt lgkmcnt(0)
cs_chk0:
    s_waitcnt vmcnt(0)
cs_chk0b:
    v_max3_u32 v57, v24, v25, v26
    v_max_u32 v57, v57, v27
    v_cmp_eq_u32 vcc, -1, v57
    ds_write_b128 v62, v[24:27] offset:40960
    s_cbranch_vccnz cs_spin0
    v_smfmac_f32_16x16x64_bf16 v[0:3], v[24:27], v[16:23], v60
    buffer_load_dwordx4 v[28:31], v61, s[4:7], s15 offen sc1
    buffer_load_dword v59, v56, s[4:7], s16 offen sc1
    v_smfmac_f32_16x16x64_bf16 v[8:11], v[24:27], v[32:39], v60
    ds_read_b128 v[32:35], v61 offset:16384
    v_smfmac_f32_16x16x64_bf16 v[12:15], v[24:27], v[48:55], v60
    ds_read_b128 v[36:39], v61 offset:20480
    v_mfma_f32_16x16x16_bf16 v[16:19], v[72:73], v[72:73], 0
    s_waitcnt lgkmcnt(2)
    s_barrier
    ds_read_b128 v[48:51], v63 offset:0
    v_mfma_f32_16x16x16_bf16 v[20:23], v[72:73], v[72:73], 0
    ds_read_b128 v[52:55], v64 offset:0
    v_smfmac_f32_16x16x64_bf16 v[4:7], v[24:27], v[40:47], v60
    ds_read_b128 v[40:43], v61 offset:24576
    v_smfmac_f32_16x16x64_bf16 v[16:19], v[24:27], a[192:199], v60
    ds_read_b128 v[44:47], v61 offset:28672
    v_smfmac_f32_16x16x64_bf16 v[20:23], v[24:27], a[200:207], v60
    s_waitcnt lgkmcnt(3)
    v_smfmac_f32_16x16x64_bf16 v[0:3], v[48:51], a[0:7], v60
    s_add_u32 s43, s14, s31
    s_add_u32 s41, s14, 16384
    v_smfmac_f32_16x16x64_bf16 v[4:7], v[48:51], v[32:39], v60
    ds_read_b128 v[32:35], v61 offset:32768
    v_smfmac_f32_16x16x64_bf16 v[8:11], v[48:51], a[8:15], v60
    ds_read_b128 v[36:39], v61 offset:36864
    s_waitcnt lgkmcnt(2)
    v_smfmac_f32_16x16x64_bf16 v[12:15], v[48:51], v[40:47], v60
    ds_read_b128 v[40:43], v61 offset:40960
    v_smfmac_f32_16x16x64_bf16 v[0:3], v[52:55], a[16:23], v60
    ds_read_b128 v[44:47], v61 offset:45056
    v_smfmac_f32_16x16x64_bf16 v[8:11], v[52:55], a[24:31], v60
    ds_read_b128 v[48:51], v71 offset:0
    s_waitcnt lgkmcnt(3)
    v_smfmac_f32_16x16x64_bf16 v[4:7], v[52:55], v[32:39], v60
    s_waitcnt vmcnt(0)
    ds_write_b128 v62, v[28:31] offset:45056
    s_waitcnt lgkmcnt(2)
    v_smfmac_f32_16x16x64_bf16 v[12:15], v[52:55], v[40:47], v60
    ds_write_b32 v58, v59
    v_max3_u32 v57, v28, v29, v30
    s_waitcnt lgkmcnt(2)
    v_smfmac_f32_16x16x64_bf16 v[0:3], v[48:51], a[32:39], v60
    ds_read_b128 v[32:35], v61 offset:49152
    v_max3_u32 v57, v57, v31, v59
    v_smfmac_f32_16x16x64_bf16 v[8:11], v[48:51], a[40:47], v60
    ds_read_b128 v[36:39], v61 offset:53248
    v_cmp_eq_u32 vcc, -1, v57
    v_smfmac_f32_16x16x64_bf16 v[16:19], v[52:55], a[224:231], v60
    ds_read_b128 v[40:43], v61 offset:57344
    v_smfmac_f32_16x16x64_bf16 v[20:23], v[52:55], a[232:239], v60
    ds_read_b128 v[44:47], v61 offset:61440
    s_cbranch_vccnz cs_spin1
cs_go1:
    v_smfmac_f32_16x16x64_bf16 v[0:3], v[28:31], a[48:55], v60
    s_waitcnt lgkmcnt(4)
    s_barrier
    ds_read_b128 v[52:55], v63 offset:4096
    v_smfmac_f32_16x16x64_bf16 v[8:11], v[28:31], a[56:63], v60
    ds_read_b128 v[56:59], v71 offset:4096
    v_smfmac_f32_16x16x64_bf16 v[4:7], v[28:31], a[128:135], v60
    s_waitcnt lgkmcnt(2)
    v_smfmac_f32_16x16x64_bf16 v[4:7], v[48:51], v[32:39], v60
    buffer_load_dwordx4 v[32:35], v61, s[4:7], s23 offen offset:0 sc1
    v_smfmac_f32_16x16x64_bf16 v[12:15], v[48:51], v[40:47], v60
    ds_read_b128 v[48:51], v64 offset:4096
    v_smfmac_f32_16x16x64_bf16 v[12:15], v[28:31], a[136:143], v60
    ds_read_b128 v[24:27], v65 offset:8192
    s_and_b32 s41, s41, 65535
    s_add_u32 s41, s41, 68157440
    v_smfmac_f32_16x16x64_bf16 v[16:19], v[28:31], v[80:87], v60
    buffer_load_dwordx4 v[36:39], v61, s[4:7], s23 offen offset:1024 sc1
    v_smfmac_f32_16x16x64_bf16 v[20:23], v[28:31], v[88:95], v60
    s_add_u32 s17, s41, s31
    s_and_b32 s30, s28, 1
    s_waitcnt lgkmcnt(3)
    v_smfmac_f32_16x16x64_bf16 v[0:3], v[52:55], a[64:71], v60
    ds_read_b128 v[28:31], v78 offset:8704
    v_smfmac_f32_16x16x64_bf16 v[4:7], v[52:55], a[144:151], v60
    buffer_load_dwordx4 v[40:43], v61, s[4:7], s23 offen offset:2048 sc1
    v_smfmac_f32_16x16x64_bf16 v[8:11], v[52:55], a[72:79], v60
    v_smfmac_f32_16x16x64_bf16 v[12:15], v[52:55], a[152:159], v60
    v_smfmac_f32_16x16x64_bf16 v[16:19], v[52:55], v[96:103], v60
    buffer_load_dwordx4 v[44:47], v61, s[4:7], s23 offen offset:3072 sc1
    v_smfmac_f32_16x16x64_bf16 v[20:23], v[52:55], v[104:111], v60
    ds_read_b128 v[52:55], v62 offset:28672
    s_waitcnt lgkmcnt(3)
    v_smfmac_f32_16x16x64_bf16 v[0:3], v[48:51], a[80:87], v60
    v_smfmac_f32_16x16x64_bf16 v[4:7], v[48:51], a[160:167], v60
    v_smfmac_f32_16x16x64_bf16 v[8:11], v[48:51], a[88:95], v60
    v_smfmac_f32_16x16x64_bf16 v[12:15], v[48:51], a[168:175], v60
    v_smfmac_f32_16x16x64_bf16 v[16:19], v[48:51], v[112:119], v60
    buffer_load_dword v79, s[4:7], s24 offen sc1 lds
    v_smfmac_f32_16x16x64_bf16 v[20:23], v[48:51], v[120:127], v60
    ds_read_b128 v[48:51], v62 offset:24576
    v_smfmac_f32_16x16x64_bf16 v[0:3], v[56:59], a[96:103], v60
    s_bitcmp1_b64 s[66:67], s28
    v_smfmac_f32_16x16x64_bf16 v[8:11], v[56:59], a[104:111], v60
    s_waitcnt lgkmcnt(3)
    v_smfmac_f32_16x16x64_bf16 v[0:3], v[24:27], a[112:119], v60
    v_smfmac_f32_16x16x64_bf16 v[8:11], v[24:27], a[120:127], v60
    v_smfmac_f32_16x16x64_bf16 v[4:7], v[56:59], a[176:183], v60
    s_waitcnt lgkmcnt(0)
    v_cvt_pk_bf16_f32 v0, v0, v1
    v_smfmac_f32_16x16x64_bf16 v[4:7], v[24:27], v[48:55], v60
    ds_read_b128 v[48:51], v62 offset:32768
    v_cvt_pk_bf16_f32 v8, v8, v9
    v_smfmac_f32_16x16x64_bf16 v[12:15], v[56:59], a[184:191], v60
    ds_read_b128 v[52:55], v62 offset:36864
    v_cvt_pk_bf16_f32 v9, v10, v11
    v_smfmac_f32_16x16x64_bf16 v[16:19], v[56:59], v[128:135], v60
    v_cvt_pk_bf16_f32 v1, v2, v3
    v_mfma_f32_16x16x16_bf16 v[8:11], v[8:9], v[28:29], 0
    v_cvt_pk_bf16_f32 v2, v4, v5
    v_cvt_pk_bf16_f32 v3, v6, v7
    v_smfmac_f32_16x16x64_bf16 v[20:23], v[56:59], v[136:143], v60
    s_mov_b64 exec, s[36:37]
    ds_read_b128 v[56:59], v69
    s_mov_b64 exec, -1
    v_mfma_f32_16x16x32_bf16 v[4:7], v[0:3], v[28:31], 0
    v_cvt_pk_bf16_f32 v2, v8, v9
    s_waitcnt lgkmcnt(1)
    v_smfmac_f32_16x16x64_bf16 v[12:15], v[24:27], v[48:55], v60
    ds_read_b128 v[48:51], v63 offset:0
    v_cvt_pk_bf16_f32 v3, v10, v11
    s_waitcnt vmcnt(3)
    v_cvt_pk_bf16_f32 v0, v4, v5
    v_cvt_pk_bf16_f32 v1, v6, v7
    s_nop 1
    v_mfma_f32_16x16x32_bf16 v[4:7], v[36:39], v[0:3], 0
    v_cvt_pk_bf16_f32 v12, v12, v13
    v_cvt_pk_bf16_f32 v13, v14, v15
    s_nop 1
    v_mfma_f32_16x16x16_bf16 v[12:15], v[12:13], v[30:31], 0
    ds_read_b128 v[52:55], v71 offset:0
    ds_read_b128 v[36:39], v63 offset:53248
    v_mfma_f32_16x16x32_bf16 v[28:31], v[32:35], v[0:3], 0
    s_waitcnt vmcnt(1)
    ds_read_b128 v[32:35], v63 offset:49152
    s_mov_b64 exec, s[34:35]
    s_nop 0
    v_cvt_pk_bf16_f32 v2, v12, v13
    v_cvt_pk_bf16_f32 v3, v14, v15
    s_mov_b64 exec, -1
    s_nop 0
    v_mfma_f32_16x16x32_bf16 v[8:11], v[0:3], v[0:3], 0
    v_mov_b32_dpp v28, v4 row_ror:8 row_mask:0xf bank_mask:0xc
    v_mov_b32_dpp v29, v5 row_ror:8 row_mask:0xf bank_mask:0xc
    v_mov_b32_dpp v30, v6 row_ror:8 row_mask:0xf bank_mask:0xc
    v_mov_b32_dpp v31, v7 row_ror:8 row_mask:0xf bank_mask:0xc
    v_smfmac_f32_16x16x64_bf16 v[16:19], v[24:27], v[144:151], v60
    ds_write_b128 v62, v[28:31] offset:53248
    v_mov_b32_dpp v8, v10 row_ror:8 row_mask:0xf bank_mask:0xc
    v_mov_b32_dpp v9, v11 row_ror:8 row_mask:0xf bank_mask:0xc
    v_smfmac_f32_16x16x64_bf16 v[20:23], v[24:27], v[152:159], v60
    ds_write_b64 v70, v[8:9]
    s_waitcnt lgkmcnt(5)
    v_smfmac_f32_16x16x64_bf16 v[16:19], v[48:51], a[208:215], v60
    s_mov_b64 exec, s[36:37]
    s_cbranch_execz cs_np3680
    buffer_store_dwordx4 v[56:59], v61, s[4:7], s65 offen sc1
cs_np3680:
    s_mov_b64 exec, -1
    v_smfmac_f32_16x16x64_bf16 v[20:23], v[48:51], a[216:223], v60
    s_cbranch_scc1 cs_last
cs_back:
    s_waitcnt lgkmcnt(0)
    s_barrier
    ds_read_b128 v[56:59], v78 offset:10752
    v_smfmac_f32_16x16x64_bf16 v[16:19], v[52:55], a[240:247], v60
    ds_read_b128 v[12:15], v78 offset:11264
    ds_read_b128 v[4:7], v63 offset:12288
    v_smfmac_f32_16x16x64_bf16 v[20:23], v[52:55], a[248:255], v60
    ds_read_b128 v[8:11], v64 offset:12288
    ds_read_b128 v[0:3], v71 offset:12288
    v_mov_b64 v[24:25], s[62:63]
    v_mov_b64 v[26:27], s[60:61]
    v_cvt_pk_bf16_f32 v16, v16, v17
    v_cvt_pk_bf16_f32 v17, v18, v19
    v_pk_mul_f32 v[28:29], v[28:29], s[44:45]
    v_pk_mul_f32 v[30:31], v[30:31], s[44:45]
    s_waitcnt lgkmcnt(3)
    v_pk_add_f32 v[56:57], v[56:57], v[58:59]
    v_pk_add_f32 v[12:13], v[12:13], v[14:15]
    v_pk_add_f32 v[56:57], v[56:57], v[12:13]
    v_pk_mul_f32 v[56:57], v[56:57], s[44:45]
    v_exp_f32 v58, v56
    v_exp_f32 v59, v57
    s_waitcnt lgkmcnt(1)
    v_pk_fma_f32 v[28:29], v[4:5], s[44:45], v[28:29]
    v_pk_fma_f32 v[30:31], v[6:7], s[44:45], v[30:31]
    v_cvt_pk_bf16_f32 v6, v58, v59
    v_pk_fma_f32 v[28:29], v[8:9], s[44:45], v[28:29]
    v_pk_fma_f32 v[30:31], v[10:11], s[44:45], v[30:31]
    s_waitcnt lgkmcnt(0)
    v_pk_fma_f32 v[28:29], v[0:1], s[44:45], v[28:29]
    v_mov_b32_dpp v7, v6 row_ror:8 row_mask:0xf bank_mask:0xf
    v_pk_fma_f32 v[30:31], v[2:3], s[44:45], v[30:31]
    v_exp_f32 v0, v28
    v_mfma_f32_16x16x16_bf16 v[12:15], v[16:17], v[6:7], 0
    ds_read_b128 v[48:51], v63 offset:57344
    v_exp_f32 v1, v29
    v_cvt_pk_bf16_f32 v18, v20, v21
    v_exp_f32 v2, v30
    v_cvt_pk_bf16_f32 v19, v22, v23
    v_cvt_pk_bf16_f32 v8, v0, v1
    v_exp_f32 v3, v31
    v_mfma_f32_16x16x16_bf16 v[20:23], v[18:19], v[6:7], 0
    ds_read_b128 v[52:55], v63 offset:61440
    v_cvt_pk_bf16_f32 v9, v2, v3
    v_mov_b32_dpp v10, v8 row_ror:8 row_mask:0xf bank_mask:0xf
    v_max3_f32 v4, |v28|, |v29|, |v30|
    v_mov_b32_dpp v11, v9 row_ror:8 row_mask:0xf bank_mask:0xf
    v_mfma_f32_16x16x32_bf16 v[0:3], v[24:27], v[6:9], 0
    v_max3_f32 v4, v4, |v31|, |v56|
    v_max_f32_e64 v4, v4, |v57|
    v_mfma_f32_16x16x32_bf16 v[12:15], v[40:43], v[8:11], v[12:15]
    v_cmp_nge_f32 vcc, s46, v4
    v_mfma_f32_16x16x32_bf16 v[20:23], v[44:47], v[8:11], v[20:23]
    v_add_f32_dpp v0, v0, v0 row_ror:8 row_mask:0xf bank_mask:0xf
    v_rcp_f32 v0, v0
    s_cbranch_vccnz cs_guard
cs_norm:
    v_mfma_f32_16x16x16_bf16 v[28:31], v[72:73], v[72:73], 0
    v_mul_f32 v12, v12, v0
    v_mul_f32 v13, v13, v0
    v_mul_f32 v14, v14, v0
    v_mul_f32 v15, v15, v0
    v_mul_f32_dpp v12, v20, v0 row_ror:8 row_mask:0xf bank_mask:0xc
    v_mul_f32_dpp v13, v21, v0 row_ror:8 row_mask:0xf bank_mask:0xc
    v_mul_f32_dpp v14, v22, v0 row_ror:8 row_mask:0xf bank_mask:0xc
    v_mul_f32_dpp v15, v23, v0 row_ror:8 row_mask:0xf bank_mask:0xc
    v_cvt_pk_bf16_f32 v12, v12, v13
    v_cvt_pk_bf16_f32 v13, v14, v15
    v_mfma_f32_16x16x16_bf16 v[8:11], v[72:73], v[72:73], 0
    ds_write_b64 v77, v[12:13]
    v_mfma_f32_16x16x16_bf16 v[4:7], v[72:73], v[72:73], 0
    ds_read_b128 v[0:3], v68
    v_mfma_f32_16x16x16_bf16 v[16:19], v[72:73], v[72:73], 0
    ds_read_b128 v[40:43], v63 offset:16384
    v_mfma_f32_16x16x16_bf16 v[20:23], v[72:73], v[72:73], 0
    ds_read_b128 v[44:47], v63 offset:20480
    s_waitcnt lgkmcnt(3)
    s_barrier
    ds_read_b128 v[24:27], v74
    ds_read_b128 v[12:15], v75
    ds_read_b128 v[56:59], v76
    s_waitcnt lgkmcnt(5)
    v_smfmac_f32_16x16x64_bf16 v[28:31], v[0:3], v[160:167], v60
    v_smfmac_f32_16x16x64_bf16 v[8:11], v[0:3], v[192:199], v60
    v_smfmac_f32_16x16x64_bf16 v[4:7], v[0:3], v[32:39], v60
    ds_read_b128 v[32:35], v63 offset:32768
    v_smfmac_f32_16x16x64_bf16 v[16:19], v[0:3], v[224:231], v60
    ds_read_b128 v[36:39], v63 offset:36864
    s_waitcnt lgkmcnt(3)
    v_smfmac_f32_16x16x64_bf16 v[28:31], v[24:27], v[168:175], v60
    v_smfmac_f32_16x16x64_bf16 v[4:7], v[12:15], v[48:55], v60
    ds_read_b128 v[48:51], v63 offset:24576
    v_smfmac_f32_16x16x64_bf16 v[28:31], v[12:15], v[176:183], v60
    ds_read_b128 v[52:55], v63 offset:28672
    s_waitcnt lgkmcnt(4)
    v_smfmac_f32_16x16x64_bf16 v[28:31], v[56:59], v[184:191], v60
    v_cvt_pk_bf16_f32 v4, v4, v5
    v_smfmac_f32_16x16x64_bf16 v[16:19], v[12:15], v[40:47], v60
    ds_read_b128 v[40:43], v63 offset:40960
    v_and_or_b32 v4, v4, -2, s30
    v_smfmac_f32_16x16x64_bf16 v[8:11], v[24:27], v[200:207], v60
    ds_read_b128 v[44:47], v63 offset:45056
    v_cvt_pk_bf16_f32 v5, v6, v7
    v_smfmac_f32_16x16x64_bf16 v[8:11], v[12:15], v[208:215], v60
    buffer_store_dwordx2 v[4:5], v67, s[4:7], s22 offen sc1
    v_cvt_pk_bf16_f32 v28, v28, v29
    v_smfmac_f32_16x16x64_bf16 v[8:11], v[56:59], v[216:223], v60
    v_and_or_b32 v28, v28, -2, s30
    v_smfmac_f32_16x16x64_bf16 v[16:19], v[24:27], v[232:239], v60
    v_cvt_pk_bf16_f32 v29, v30, v31
    s_waitcnt lgkmcnt(4)
    v_smfmac_f32_16x16x64_bf16 v[16:19], v[56:59], v[32:39], v60
    buffer_store_dwordx2 v[28:29], v66, s[4:7], s20 offen sc1
    v_cvt_pk_bf16_f32 v8, v8, v9
    s_waitcnt lgkmcnt(0)
    v_smfmac_f32_16x16x64_bf16 v[20:23], v[0:3], v[240:247], v60
    v_and_or_b32 v8, v8, -2, s30
    v_smfmac_f32_16x16x64_bf16 v[20:23], v[24:27], v[248:255], v60
    v_cvt_pk_bf16_f32 v9, v10, v11
    v_smfmac_f32_16x16x64_bf16 v[20:23], v[12:15], v[48:55], v60
    buffer_store_dwordx2 v[8:9], v66, s[4:7], s21 offen sc1
    v_cvt_pk_bf16_f32 v16, v16, v17
    v_smfmac_f32_16x16x64_bf16 v[20:23], v[56:59], v[40:47], v60
    v_and_or_b32 v16, v16, -2, s30
    v_cvt_pk_bf16_f32 v17, v18, v19
    buffer_store_dwordx2 v[16:17], v66, s[4:7], s38 offen sc1
    s_cmp_lg_u32 s13, 2
    s_nop 1
    v_cvt_pk_bf16_f32 v20, v20, v21
    v_and_or_b32 v20, v20, -2, s30
    v_cvt_pk_bf16_f32 v21, v22, v23
    buffer_store_dwordx2 v[20:21], v66, s[4:7], s39 offen sc1
    s_cbranch_scc1 cs_w013
    v_mov_b32 v21, -1
    s_mov_b64 exec, s[32:33]
    buffer_store_dword v21, v69, s[4:7], s18 offen sc1
    s_mov_b64 exec, -1
    s_mov_b32 s18, s43
    s_nop 15
    s_nop 15
    s_nop 15
    s_nop 15
    s_nop 15
    s_nop 15
    s_nop 15
    s_nop 15
    s_nop 15
    s_nop 15
    s_nop 15
    s_nop 15
    s_nop 0
    buffer_load_dwordx4 v[40:43], v65, s[4:7], s19 offen offset:0 sc1
    buffer_load_dwordx4 v[44:47], v65, s[4:7], s19 offen offset:1024 sc1
    buffer_load_dwordx4 v[48:51], v65, s[4:7], s19 offen offset:2048 sc1
    buffer_load_dwordx4 v[52:55], v65, s[4:7], s19 offen offset:3072 sc1
    ds_read_b128 v[56:59], v65 offset:10240
    s_add_u32 s28, s28, 1
    s_mov_b32 s14, s41
    s_add_u32 s23, s23, 524288
    s_add_u32 s24, s24, 524288
    s_min_u32 s24, s24, s47
    s_add_u32 s15, s14, 4096
    s_add_u32 s16, s14, 8192
    s_add_u32 s65, s65, 12288
    s_mov_b32 s40, 1
    v_mov_b64 v[0:1], 0
    v_mov_b64 v[2:3], 0
    v_mov_b64 v[4:5], 0
    v_mov_b64 v[6:7], 0
    v_mov_b64 v[8:9], 0
    v_mov_b64 v[10:11], 0
    v_mov_b64 v[12:13], 0
    v_mov_b64 v[14:15], 0
cs_chkF:
    v_mov_b32 v20, 0
    s_waitcnt vmcnt(3)
    s_waitcnt lgkmcnt(0)
    v_mfma_f32_16x16x32_bf16 v[28:31], v[40:43], v[56:59], 0
    v_bitop3_b32 v20, v20, v40, s30 bitop3:0xf6
    v_bitop3_b32 v20, v20, v42, s30 bitop3:0xf6
    s_waitcnt vmcnt(2)
    v_mfma_f32_16x16x32_bf16 v[28:31], v[44:47], v[56:59], v[28:31]
    v_bitop3_b32 v20, v20, v44, s30 bitop3:0xf6
    v_bitop3_b32 v20, v20, v46, s30 bitop3:0xf6
    s_waitcnt vmcnt(1)
    v_mfma_f32_16x16x32_bf16 v[28:31], v[48:51], v[56:59], v[28:31]
    v_bitop3_b32 v20, v20, v48, s30 bitop3:0xf6
    v_bitop3_b32 v20, v20, v50, s30 bitop3:0xf6
    s_waitcnt vmcnt(0)
    v_mfma_f32_16x16x32_bf16 v[28:31], v[52:55], v[56:59], v[28:31]
    v_bitop3_b32 v20, v20, v52, s30 bitop3:0xf6
    v_bitop3_b32 v20, v20, v54, s30 bitop3:0xf6
    v_and_b32 v20, s40, v20
    v_cmp_ne_u32 vcc, 0, v20
    s_cbranch_vccnz cs_spinF
    v_permlane32_swap_b32 v28, v30
    v_permlane32_swap_b32 v29, v31
    v_add_f32 v28, v28, v30
    v_add_f32 v30, v29, v31
    v_cvt_pk_bf16_f32 v28, v28, v30
    s_mov_b64 exec, s[32:33]
    buffer_store_dword v28, v69, s[4:7], s17 offen sc1
    s_mov_b64 exec, -1
    ds_read_b128 v[32:35], v62 offset:16384
    ds_read_b128 v[36:39], v62 offset:20480
    ds_read_b128 v[40:43], v61 offset:0
    ds_read_b128 v[44:47], v61 offset:4096
    ds_read_b128 v[48:51], v61 offset:8192
    ds_read_b128 v[52:55], v61 offset:12288
    s_nop 15
    s_nop 15
    s_nop 15
    s_nop 15
    s_nop 15
    s_nop 15
    s_nop 3
    buffer_load_dwordx4 v[24:27], v61, s[4:7], s14 offen sc1
    s_branch cs_loop2
cs_w013:
    ds_read_b128 v[56:59], v65 offset:10240
    ds_read_b128 v[32:35], v62 offset:16384
    ds_read_b128 v[36:39], v62 offset:20480
    ds_read_b128 v[40:43], v61 offset:0
    ds_read_b128 v[44:47], v61 offset:4096
    ds_read_b128 v[48:51], v61 offset:8192
    ds_read_b128 v[52:55], v61 offset:12288
    s_add_u32 s28, s28, 1
    s_mov_b32 s14, s41
    s_add_u32 s23, s23, 524288
    s_add_u32 s24, s24, 524288
    s_min_u32 s24, s24, s47
    s_add_u32 s15, s14, 4096
    s_add_u32 s16, s14, 8192
    s_add_u32 s65, s65, 12288
    s_mov_b32 s40, 1
    s_cmp_eq_u32 s64, 0
    s_cbranch_scc1 cs_w0
    v_mov_b32 v21, -1
    s_mov_b64 exec, s[32:33]
    buffer_store_dword v21, v69, s[4:7], s18 offen sc1
    s_mov_b64 exec, -1
    s_mov_b32 s18, s43
    s_cmp_eq_u32 s13, 1
    s_cbranch_scc1 cs_sx
    s_nop 15
    s_nop 15
    s_nop 15
    s_nop 15
    s_nop 15
    s_nop 15
    s_nop 15
    s_nop 15
    s_nop 15
    s_nop 15
    s_nop 15
    s_nop 15
    s_nop 7
cs_sx:
    buffer_load_dwordx4 v[0:3], v65, s[4:7], s19 offen offset:0 sc1
    buffer_load_dwordx4 v[4:7], v65, s[4:7], s19 offen offset:1024 sc1
    buffer_load_dwordx4 v[8:11], v65, s[4:7], s19 offen offset:2048 sc1
    buffer_load_dwordx4 v[12:15], v65, s[4:7], s19 offen offset:3072 sc1
cs_chkG:
    v_mov_b32 v20, 0
    s_waitcnt vmcnt(3)
    s_waitcnt lgkmcnt(6)
    v_mfma_f32_16x16x32_bf16 v[28:31], v[0:3], v[56:59], 0
    v_bitop3_b32 v20, v20, v0, s30 bitop3:0xf6
    v_bitop3_b32 v20, v20, v2, s30 bitop3:0xf6
    s_waitcnt vmcnt(2)
    v_mfma_f32_16x16x32_bf16 v[28:31], v[4:7], v[56:59], v[28:31]
    v_bitop3_b32 v20, v20, v4, s30 bitop3:0xf6
    v_bitop3_b32 v20, v20, v6, s30 bitop3:0xf6
    s_waitcnt vmcnt(1)
    v_mfma_f32_16x16x32_bf16 v[28:31], v[8:11], v[56:59], v[28:31]
    v_bitop3_b32 v20, v20, v8, s30 bitop3:0xf6
    v_bitop3_b32 v20, v20, v10, s30 bitop3:0xf6
    s_waitcnt vmcnt(0)
    v_mfma_f32_16x16x32_bf16 v[28:31], v[12:15], v[56:59], v[28:31]
    v_bitop3_b32 v20, v20, v12, s30 bitop3:0xf6
    v_bitop3_b32 v20, v20, v14, s30 bitop3:0xf6
    v_and_b32 v20, s40, v20
    v_cmp_ne_u32 vcc, 0, v20
    s_cbranch_vccnz cs_spinG
    v_permlane32_swap_b32 v28, v30
    v_permlane32_swap_b32 v29, v31
    v_add_f32 v28, v28, v30
    v_add_f32 v30, v29, v31
    s_cmp_eq_u32 s13, 3
    s_cbranch_scc1 cs_w3
    v_mov_b32 v29, v28
    v_mov_b32 v31, v30
    s_nop 0
    v_permlane16_swap_b32 v28, v29
    v_permlane16_swap_b32 v30, v31
    v_add_f32 v28, v28, v29
    v_add_f32 v30, v30, v31
cs_w3:
    v_cvt_pk_bf16_f32 v28, v28, v30
    s_mov_b64 exec, s[32:33]
    buffer_store_dword v28, v69, s[4:7], s17 offen sc1
    s_mov_b64 exec, -1
    buffer_load_dwordx4 v[24:27], v61, s[4:7], s14 offen sc1
    s_branch cs_loop
cs_w0:
    v_mov_b64 v[0:1], 0
    v_mov_b64 v[2:3], 0
    v_mov_b64 v[4:5], 0
    v_mov_b64 v[6:7], 0
    v_mov_b64 v[8:9], 0
    v_mov_b64 v[10:11], 0
    v_mov_b64 v[12:13], 0
    v_mov_b64 v[14:15], 0
    s_nop 15
    s_nop 15
    s_nop 15
    s_nop 15
    s_nop 15
    s_nop 15
    s_nop 15
    s_nop 15
    s_nop 4
    s_cmp_lg_u32 s28, 10
    s_cbranch_scc1 cs_nokv
    s_lshr_b32 s92, s12, 1
    s_lshl_b32 s92, s92, 8
    s_add_u32 s92, s92, 125829120
    v_bfe_u32 v28, v61, 4, 6
    v_min_u32 v28, 11, v28
    v_lshlrev_b32 v28, 2, v28
    v_add_u32 v28, 108304, v28
    s_waitcnt vmcnt(0)
    ds_read_b32 v29, v28
    s_add_u32 s93, s95, 63
    s_waitcnt lgkmcnt(0)
    v_cmp_ne_u32 vcc, s93, v29
    s_cbranch_vccz cs_kv1_go
    s_lshr_b32 s92, s12, 1
    s_lshl_b32 s92, s92, 8
    s_add_u32 s92, s92, 125833216
    v_bfe_u32 v28, v61, 4, 6
    v_min_u32 v28, 11, v28
    v_lshlrev_b32 v28, 2, v28
    s_add_u32 s93, s95, 63
    s_mov_b32 s94, 4194304
cs_kv1:
    buffer_load_dword v29, v28, s[4:7], s92 offen sc1
    s_sub_u32 s94, s94, 1
    s_cbranch_scc1 cs_kv1_go
    s_waitcnt vmcnt(0)
    v_subrev_u32 v29, s93, v29
    v_cmp_lt_u32 vcc, 64, v29
    s_cbranch_vccz cs_kv1_go
    s_sleep 2
    s_branch cs_kv1
cs_kv1_go:
    s_branch cs_w0p
cs_nokv:
    s_nop 15
    s_nop 15
    s_nop 15
    s_nop 15
    s_nop 15
    s_nop 15
    s_nop 15
    s_nop 15
    s_nop 15
    s_nop 15
    s_nop 15
    s_nop 15
    s_nop 15
    s_nop 15
    s_nop 15
    s_nop 15
    s_nop 10
cs_w0p:
    buffer_load_dwordx4 v[24:27], v61, s[4:7], s14 offen sc1
    s_branch cs_loop2
cs_spinF:
    buffer_load_dwordx4 v[40:43], v65, s[4:7], s19 offen offset:0 sc1
    buffer_load_dwordx4 v[44:47], v65, s[4:7], s19 offen offset:1024 sc1
    buffer_load_dwordx4 v[48:51], v65, s[4:7], s19 offen offset:2048 sc1
    buffer_load_dwordx4 v[52:55], v65, s[4:7], s19 offen offset:3072 sc1
    s_sub_u32 s29, s29, 1
    s_cmp_lt_i32 s29, 0
    s_cselect_b32 s40, 0, 1
    s_branch cs_chkF
cs_spinG:
    buffer_load_dwordx4 v[0:3], v65, s[4:7], s19 offen offset:0 sc1
    buffer_load_dwordx4 v[4:7], v65, s[4:7], s19 offen offset:1024 sc1
    buffer_load_dwordx4 v[8:11], v65, s[4:7], s19 offen offset:2048 sc1
    buffer_load_dwordx4 v[12:15], v65, s[4:7], s19 offen offset:3072 sc1
    s_sub_u32 s29, s29, 1
    s_cmp_lt_i32 s29, 0
    s_cselect_b32 s40, 0, 1
    s_branch cs_chkG
cs_guard:
    s_cbranch_scc0 cs_guard2
    buffer_store_dwordx4 v[16:19], v61, s[4:7], s26 offen sc1
    s_add_u32 s26, s26, 131072
    s_add_u32 s40, s95, 63
    v_mov_b32 v5, s40
    s_mov_b64 exec, 1
    buffer_store_dword v5, off, s[4:7], s27 sc1
    s_mov_b64 exec, -1
cs_guard2:
    s_nop 7
    v_max3_f32 v6, v28, v29, v30
    v_max3_f32 v7, v31, v56, v57
    v_max_f32 v6, v6, v7
    s_nop 1
    v_max_f32_dpp v6, v6, v6 row_ror:8 row_mask:0xf bank_mask:0xf
    v_mov_b32 v7, v6
    s_nop 1
    v_permlane32_swap_b32 v6, v7
    v_max_f32 v6, v6, v7
    v_mov_b32 v7, v6
    s_nop 1
    v_permlane16_swap_b32 v6, v7
    v_max_f32 v6, v6, v7
    v_sub_f32 v28, v28, v6
    v_sub_f32 v29, v29, v6
    v_sub_f32 v30, v30, v6
    v_sub_f32 v31, v31, v6
    v_sub_f32 v56, v56, v6
    v_sub_f32 v57, v57, v6
    v_exp_f32 v58, v56
    v_exp_f32 v59, v57
    s_nop 0
    v_cvt_pk_bf16_f32 v6, v58, v59
    s_nop 1
    v_mov_b32_dpp v7, v6 row_ror:8 row_mask:0xf bank_mask:0xf
    v_exp_f32 v0, v28
    s_nop 0
    v_mfma_f32_16x16x16_bf16 v[12:15], v[16:17], v[6:7], 0
    v_exp_f32 v1, v29
    v_exp_f32 v2, v30
    v_cvt_pk_bf16_f32 v8, v0, v1
    v_exp_f32 v3, v31
    v_mfma_f32_16x16x16_bf16 v[20:23], v[18:19], v[6:7], 0
    v_cvt_pk_bf16_f32 v9, v2, v3
    v_mov_b32_dpp v10, v8 row_ror:8 row_mask:0xf bank_mask:0xf
    v_max3_f32 v4, |v28|, |v29|, |v30|
    v_mov_b32_dpp v11, v9 row_ror:8 row_mask:0xf bank_mask:0xf
    v_mfma_f32_16x16x32_bf16 v[0:3], v[24:27], v[6:9], 0
    v_max3_f32 v4, v4, |v31|, |v56|
    v_max_f32_e64 v4, v4, |v57|
    v_mfma_f32_16x16x32_bf16 v[12:15], v[40:43], v[8:11], v[12:15]
    v_cmp_nge_f32 vcc, s46, v4
    v_mfma_f32_16x16x32_bf16 v[20:23], v[44:47], v[8:11], v[20:23]
    v_add_f32_dpp v0, v0, v0 row_ror:8 row_mask:0xf bank_mask:0xf
    v_rcp_f32 v0, v0
    s_nop 4
    s_branch cs_norm
cs_spin0:
    buffer_load_dwordx4 v[24:27], v61, s[4:7], s14 offen sc1
    s_sub_u32 s29, s29, 1
    s_cmp_lt_i32 s29, 0
    s_cbranch_scc0 cs_chk0
    s_waitcnt vmcnt(0)
    v_min_u32 v24, -2, v24
    v_min_u32 v25, -2, v25
    v_min_u32 v26, -2, v26
    v_min_u32 v27, -2, v27
    s_branch cs_chk0
cs_spin1:
    buffer_load_dwordx4 v[28:31], v61, s[4:7], s15 offen sc1
    buffer_load_dword v59, v56, s[4:7], s16 offen sc1
    s_sub_u32 s29, s29, 1
    s_cmp_lt_i32 s29, 0
    s_waitcnt vmcnt(0)
    v_max3_u32 v57, v28, v29, v30
    v_max3_u32 v57, v57, v31, v59
    v_cmp_eq_u32 vcc, -1, v57
    ds_write_b128 v62, v[28:31] offset:45056
    ds_write_b32 v58, v59
    s_waitcnt lgkmcnt(0)
    s_cbranch_scc1 cs_go1
    s_cbranch_vccnz cs_spin1
    s_branch cs_go1
cs_last:
    s_nop 1
    s_cmp_ge_u32 s28, 2
    s_cbranch_scc1 cs_last0
    s_and_b32 s40, s12, 3
    s_lshl_b32 s40, s40, 14
    s_add_u32 s40, s40, 68157440
    s_lshr_b32 s42, s12, 2
    s_lshl_b32 s42, s42, 3
    s_lshl_b64 exec, 0x55, s42
    buffer_load_dword v79, s[4:7], s40 offen sc1 lds
    s_mov_b64 exec, -1
    s_cmp_eq_u32 0, 1
    s_branch cs_back
cs_last0:
    s_cmp_lg_u32 s28, 9
    s_cbranch_scc1 cs_last1
    s_lshr_b32 s92, s12, 1
    s_lshl_b32 s92, s92, 8
    s_add_u32 s92, s92, 125833216
    v_bfe_u32 v48, v61, 4, 6
    v_min_u32 v48, 11, v48
    v_lshlrev_b32 v48, 2, v48
    s_mov_b32 m0, 108304
    s_mov_b64 exec, 0xfff
    buffer_load_dword v48, s[4:7], s92 offen sc1 lds
    s_mov_b64 exec, -1
    s_mov_b32 m0, 108032
    s_cmp_eq_u32 0, 1
    s_branch cs_back
cs_last1:
    s_cmp_eq_u32 s28, 63
    s_cbranch_scc1 cs_last2
    s_mov_b64 exec, s[34:35]
    buffer_store_dwordx4 v[0:3], v61, s[4:7], s25 offen sc1
    s_mov_b64 exec, -1
    s_add_u32 s25, s25, 131072
    s_mov_b32 s46, 0xbf800000
    s_cmp_eq_u32 0, 0
    s_branch cs_back
cs_last2:
    s_waitcnt lgkmcnt(0)
    s_mov_b64 exec, s[34:35]
    buffer_store_dwordx4 v[0:3], v61, s[4:7], s25 offen sc1
    s_mov_b64 exec, -1
    s_add_u32 s40, s95, 64
    v_mov_b32 v40, s40
    v_smfmac_f32_16x16x64_bf16 v[16:19], v[52:55], a[240:247], v60
    v_smfmac_f32_16x16x64_bf16 v[20:23], v[52:55], a[248:255], v60
    s_nop 3
    v_cvt_pk_bf16_f32 v16, v16, v17
    v_cvt_pk_bf16_f32 v17, v18, v19
    s_nop 1
    v_cvt_pk_bf16_f32 v18, v20, v21
    v_cvt_pk_bf16_f32 v19, v22, v23
    buffer_store_dwordx4 v[16:19], v61, s[4:7], s26 offen sc1
    s_mov_b64 exec, 1
    buffer_store_dword v40, off, s[4:7], s27 sc1
    s_mov_b64 exec, -1
    s_endpgm
cs_dma:
    s_xor_b32 s74, s76, s81
    s_add_u32 m0, s74, s80
    s_add_u32 s76, s76, 4096
    buffer_load_dwordx4 v58, s[8:11], s78 offen lds
    s_add_u32 s78, s78, s79
    s_cmp_lt_u32 s76, s77
    s_cbranch_scc1 cs_dma
    s_setpc_b64 s[82:83]
L_helper:
    s_load_dwordx16 s[64:79], s[0:1], 64
    s_sub_u32 s33, s3, 4
    s_and_b32 s33, s33, 7
L_pool:
    s_lshl_b32 s35, s33, 2
    s_add_u32 s35, s35, 32
    s_mov_b32 s37, s35
    v_mov_b32 v250, 1
    v_mov_b32 v251, 163832
    v_cmp_eq_u32 vcc, 0, v0
    s_nop 0
    s_and_saveexec_b64 s[38:39], vcc
    s_cbranch_execz tk4
    buffer_atomic_add v250, off, s[96:99], s37 sc0
    s_waitcnt vmcnt(0)
    ds_write_b32 v251, v250
    s_waitcnt lgkmcnt(0)
tk4:
    s_mov_b64 exec, -1
    s_barrier
    ds_read_b32 v252, v251
    s_waitcnt lgkmcnt(0)
    v_readfirstlane_b32 s34, v252
    s_barrier
    s_nop 3
    s_mov_b32 s36, s33
    s_or_b32 s33, s34, s32
    s_cmp_lg_u32 s33, 0
    s_cbranch_scc1 L_helper1
    s_memrealtime s[90:91]
    s_waitcnt lgkmcnt(0)
    s_lshl_b32 s90, s90, 8
    s_or_b32 s90, s90, 1
    v_mov_b32 v250, s90
    v_mov_b32 v251, 0
    s_mov_b64 exec, 1
    buffer_atomic_cmpswap v[250:251], off, s[96:99], 0 offset:64
    s_mov_b64 exec, -1
L_helper1:
    s_cmp_ge_u32 s34, 32
    s_cbranch_scc1 L_qkv_next
    s_cmp_ge_u32 s36, 7
    s_cbranch_scc1 L_qkv_next
    s_cmp_eq_u32 s36, 6
    s_cselect_b32 s36, s34, s36
    s_cbranch_scc1 L_job
    s_max_u32 s37, s36, 4
    s_sub_u32 s37, s37, 4
    s_mul_i32 s37, s37, 5
    s_mul_i32 s38, s36, 7
    s_sub_u32 s38, s38, s37
    s_cmp_lt_u32 s36, 4
    s_cselect_b32 s39, 7, 2
    s_mul_i32 s36, s36, 25
    s_add_u32 s36, s36, s37
    s_cmp_lt_u32 s34, s39
    s_cbranch_scc1 L_copy
    s_add_u32 s36, s36, s34
    s_sub_u32 s36, s36, s39
    s_mul_i32 s37, s36, 205
    s_lshr_b32 s37, s37, 10
    s_mul_i32 s38, s37, 5
    s_sub_u32 s36, s36, s38
    s_add_u32 s36, s36, 1
    s_lshl_b32 s36, s36, 5
    s_add_u32 s36, s36, s37
    s_branch L_job
L_copy:
    s_add_u32 s36, s38, s34
    s_mul_i32 s36, s36, 11
    s_and_b32 s36, s36, 31
    s_cmp_ge_u32 s36, 27
    s_cbranch_scc1 L_qkv_next
    s_mul_i32 s33, s36, 57
    s_lshr_b32 s33, s33, 9
    s_mul_i32 s37, s33, 9
    s_sub_u32 s37, s36, s37
    s_lshl_b32 s36, s37, 2
    s_add_u32 s36, s36, 1
    s_min_u32 s36, s36, 31
    s_lshr_b32 s39, s52, 8
    s_sub_u32 s36, s36, s39
    s_and_b32 s36, s36, 31
    s_lshl_b32 s36, s36, 8
    s_mov_b32 s14, 4718592
    s_mov_b32 s15, 0x20000
    v_lshrrev_b32 v1, 4, v0
    v_lshlrev_b32 v1, 13, v1
    v_and_b32 v2, 15, v0
    v_lshl_add_u32 v1, v2, 4, v1
    v_lshlrev_b32 v2, 4, v0
    s_mul_i32 s40, s33, 2
    s_mul_i32 s39, s40, 49152
    s_lshl_b32 s41, s37, 19
    s_add_u32 s39, s39, s41
    s_add_u32 s39, s39, 96468992
    s_add_u32 s41, s40, 0
    s_cmp_lt_u32 s41, 3
    s_cselect_b64 s[12:13], s[52:53], s[54:55]
    s_cselect_b32 s42, 0, 3
    s_cmp_ge_u32 s41, 6
    s_cselect_b64 s[12:13], s[56:57], s[12:13]
    s_cselect_b32 s42, 6, s42
    s_sub_u32 s41, s41, s42
    s_mul_i32 s38, s41, 1572864
    s_add_u32 s38, s38, s36
    buffer_load_dwordx4 v[8:11], v1, s[12:15], s38 offen
    s_add_u32 s38, s38, 131072
    buffer_load_dwordx4 v[12:15], v1, s[12:15], s38 offen
    s_add_u32 s38, s38, 131072
    buffer_load_dwordx4 v[16:19], v1, s[12:15], s38 offen
    s_add_u32 s38, s38, 131072
    buffer_load_dwordx4 v[20:23], v1, s[12:15], s38 offen
    s_add_u32 s38, s38, 131072
    buffer_load_dwordx4 v[24:27], v1, s[12:15], s38 offen
    s_add_u32 s38, s38, 131072
    buffer_load_dwordx4 v[28:31], v1, s[12:15], s38 offen
    s_add_u32 s38, s38, 131072
    buffer_load_dwordx4 v[32:35], v1, s[12:15], s38 offen
    s_add_u32 s38, s38, 131072
    buffer_load_dwordx4 v[36:39], v1, s[12:15], s38 offen
    s_add_u32 s38, s38, 131072
    buffer_load_dwordx4 v[40:43], v1, s[12:15], s38 offen
    s_add_u32 s38, s38, 131072
    buffer_load_dwordx4 v[44:47], v1, s[12:15], s38 offen
    s_add_u32 s38, s38, 131072
    buffer_load_dwordx4 v[48:51], v1, s[12:15], s38 offen
    s_add_u32 s38, s38, 131072
    buffer_load_dwordx4 v[52:55], v1, s[12:15], s38 offen
    s_add_u32 s38, s38, 131072
    s_add_u32 s41, s40, 1
    s_cmp_lt_u32 s41, 3
    s_cselect_b64 s[12:13], s[52:53], s[54:55]
    s_cselect_b32 s42, 0, 3
    s_cmp_ge_u32 s41, 6
    s_cselect_b64 s[12:13], s[56:57], s[12:13]
    s_cselect_b32 s42, 6, s42
    s_sub_u32 s41, s41, s42
    s_mul_i32 s38, s41, 1572864
    s_add_u32 s38, s38, s36
    buffer_load_dwordx4 v[56:59], v1, s[12:15], s38 offen
    s_add_u32 s38, s38, 131072
    buffer_load_dwordx4 v[60:63], v1, s[12:15], s38 offen
    s_add_u32 s38, s38, 131072
    buffer_load_dwordx4 v[64:67], v1, s[12:15], s38 offen
    s_add_u32 s38, s38, 131072
    buffer_load_dwordx4 v[68:71], v1, s[12:15], s38 offen
    s_add_u32 s38, s38, 131072
    buffer_load_dwordx4 v[72:75], v1, s[12:15], s38 offen
    s_add_u32 s38, s38, 131072
    buffer_load_dwordx4 v[76:79], v1, s[12:15], s38 offen
    s_add_u32 s38, s38, 131072
    buffer_load_dwordx4 v[80:83], v1, s[12:15], s38 offen
    s_add_u32 s38, s38, 131072
    buffer_load_dwordx4 v[84:87], v1, s[12:15], s38 offen
    s_add_u32 s38, s38, 131072
    buffer_load_dwordx4 v[88:91], v1, s[12:15], s38 offen
    s_add_u32 s38, s38, 131072
    buffer_load_dwordx4 v[92:95], v1, s[12:15], s38 offen
    s_add_u32 s38, s38, 131072
    buffer_load_dwordx4 v[96:99], v1, s[12:15], s38 offen
    s_add_u32 s38, s38, 131072
    buffer_load_dwordx4 v[100:103], v1, s[12:15], s38 offen
    s_add_u32 s38, s38, 131072
    buffer_load_dword v3, off, s[96:99], 0 offset:64 sc1
    s_waitcnt vmcnt(0)
    buffer_store_dwordx4 v[8:11], v2, s[4:7], s39 offen sc1
    s_add_u32 s39, s39, 4096
    buffer_store_dwordx4 v[12:15], v2, s[4:7], s39 offen sc1
    s_add_u32 s39, s39, 4096
    buffer_store_dwordx4 v[16:19], v2, s[4:7], s39 offen sc1
    s_add_u32 s39, s39, 4096
    buffer_store_dwordx4 v[20:23], v2, s[4:7], s39 offen sc1
    s_add_u32 s39, s39, 4096
    buffer_store_dwordx4 v[24:27], v2, s[4:7], s39 offen sc1
    s_add_u32 s39, s39, 4096
    buffer_store_dwordx4 v[28:31], v2, s[4:7], s39 offen sc1
    s_add_u32 s39, s39, 4096
    buffer_store_dwordx4 v[32:35], v2, s[4:7], s39 offen sc1
    s_add_u32 s39, s39, 4096
    buffer_store_dwordx4 v[36:39], v2, s[4:7], s39 offen sc1
    s_add_u32 s39, s39, 4096
    buffer_store_dwordx4 v[40:43], v2, s[4:7], s39 offen sc1
    s_add_u32 s39, s39, 4096
    buffer_store_dwordx4 v[44:47], v2, s[4:7], s39 offen sc1
    s_add_u32 s39, s39, 4096
    buffer_store_dwordx4 v[48:51], v2, s[4:7], s39 offen sc1
    s_add_u32 s39, s39, 4096
    buffer_store_dwordx4 v[52:55], v2, s[4:7], s39 offen sc1
    s_add_u32 s39, s39, 4096
    buffer_store_dwordx4 v[56:59], v2, s[4:7], s39 offen sc1
    s_add_u32 s39, s39, 4096
    buffer_store_dwordx4 v[60:63], v2, s[4:7], s39 offen sc1
    s_add_u32 s39, s39, 4096
    buffer_store_dwordx4 v[64:67], v2, s[4:7], s39 offen sc1
    s_add_u32 s39, s39, 4096
    buffer_store_dwordx4 v[68:71], v2, s[4:7], s39 offen sc1
    s_add_u32 s39, s39, 4096
    buffer_store_dwordx4 v[72:75], v2, s[4:7], s39 offen sc1
    s_add_u32 s39, s39, 4096
    buffer_store_dwordx4 v[76:79], v2, s[4:7], s39 offen sc1
    s_add_u32 s39, s39, 4096
    buffer_store_dwordx4 v[80:83], v2, s[4:7], s39 offen sc1
    s_add_u32 s39, s39, 4096
    buffer_store_dwordx4 v[84:87], v2, s[4:7], s39 offen sc1
    s_add_u32 s39, s39, 4096
    buffer_store_dwordx4 v[88:91], v2, s[4:7], s39 offen sc1
    s_add_u32 s39, s39, 4096
    buffer_store_dwordx4 v[92:95], v2, s[4:7], s39 offen sc1
    s_add_u32 s39, s39, 4096
    buffer_store_dwordx4 v[96:99], v2, s[4:7], s39 offen sc1
    s_add_u32 s39, s39, 4096
    buffer_store_dwordx4 v[100:103], v2, s[4:7], s39 offen sc1
    s_add_u32 s39, s39, 4096
    v_readfirstlane_b32 s95, v3
    s_nop 4
    s_mov_b32 s88, 4194304
gn5:
    s_cmp_lg_u32 s95, 0
    s_cbranch_scc1 gn5x
    buffer_load_dword v3, off, s[96:99], 0 offset:64 sc1
    s_sub_u32 s88, s88, 1
    s_cbranch_scc1 gn5x
    s_waitcnt vmcnt(0)
    v_readfirstlane_b32 s95, v3
    s_nop 1
    s_branch gn5
gn5x:
    s_lshl_b32 s37, s37, 7
    s_lshl_b32 s36, s33, 2
    s_add_u32 s36, s36, s32
    s_lshl_b32 s36, s36, 2
    s_add_u32 s37, s37, s36
    s_add_u32 s37, s37, 125853696
    v_mov_b32 v3, s95
    s_waitcnt vmcnt(0)
    s_mov_b64 exec, 1
    buffer_store_dword v3, off, s[4:7], s37 sc1
    s_mov_b64 exec, -1
L_qkv_next:
    s_mov_b32 s37, 4
    v_mov_b32 v250, 1
    v_mov_b32 v251, 163832
    v_cmp_eq_u32 vcc, 0, v0
    s_nop 0
    s_and_saveexec_b64 s[38:39], vcc
    s_cbranch_execz tk6
    buffer_atomic_add v250, off, s[96:99], s37 sc0
    s_waitcnt vmcnt(0)
    ds_write_b32 v251, v250
    s_waitcnt lgkmcnt(0)
tk6:
    s_mov_b64 exec, -1
    s_barrier
    ds_read_b32 v252, v251
    s_waitcnt lgkmcnt(0)
    v_readfirstlane_b32 s36, v252
    s_barrier
    s_nop 3
    s_add_u32 s36, s36, 192
    s_cmp_ge_u32 s36, 320
    s_cbranch_scc1 L_ssm_next
L_job:
    s_and_b32 s17, s36, 15
    s_lshl_b32 s17, s17, 1
    s_bfe_u32 s16, s36, 0x10004
    s_lshr_b32 s19, s36, 5
    s_mul_i32 s33, s16, 6
    s_add_u32 s33, s33, s19
    s_add_u32 s16, s16, 1
    s_lshr_b32 s37, s36, 4
    s_sub_u32 s38, s37, 12
    s_cmp_ge_u32 s36, 192
    s_cselect_b32 s16, 0, s16
    s_cselect_b32 s19, s38, s19
    s_cselect_b32 s33, s37, s33
    s_cselect_b32 s20, 8, 6
    v_lshrrev_b32 v4, 6, v0
    s_nop 0
    v_readfirstlane_b32 s18, v4
    v_lshlrev_b32 v7, 4, v0
    v_and_b32 v4, 63, v0
    v_lshrrev_b32 v6, 2, v4
    v_lshlrev_b32 v6, 13, v6
    v_lshrrev_b32 v5, 4, v4
    v_and_b32 v5, 2, v5
    v_xor_b32 v5, v5, v4
    v_and_b32 v5, 3, v5
    v_lshl_add_u32 v6, v5, 4, v6
    v_lshrrev_b32 v24, 4, v4
    v_lshlrev_b32 v24, 9, v24
    v_bfe_u32 v5, v4, 2, 2
    v_lshl_add_u32 v24, v5, 6, v24
    v_bfe_u32 v5, v4, 4, 1
    v_lshl_add_u32 v24, v5, 5, v24
    v_and_b32 v5, 3, v4
    v_lshl_add_u32 v24, v5, 3, v24
    s_lshl_b32 s31, s18, 12
    v_add_u32 v24, s31, v24
    s_cmp_eq_u32 s16, 1
    s_cselect_b64 s[12:13], s[54:55], s[52:53]
    s_cmp_eq_u32 s16, 2
    s_cselect_b64 s[12:13], s[56:57], s[12:13]
    s_mov_b32 s14, 4718592
    s_mov_b32 s15, 0x20000
    s_lshl_b32 s28, s17, 8
    s_lshl_b32 s21, s18, 6
    s_add_u32 s28, s28, s21
    s_add_u32 s21, s28, 0
    s_add_u32 m0, s31, 40960
    s_nop 0
    buffer_load_dwordx4 v6, s[12:15], s21 offen lds
    s_add_u32 m0, s31, 41984
    s_add_u32 s21, s21, 131072
    buffer_load_dwordx4 v6, s[12:15], s21 offen lds
    s_add_u32 m0, s31, 43008
    s_add_u32 s21, s21, 131072
    buffer_load_dwordx4 v6, s[12:15], s21 offen lds
    s_add_u32 m0, s31, 44032
    s_add_u32 s21, s21, 131072
    buffer_load_dwordx4 v6, s[12:15], s21 offen lds
    s_add_u32 s21, s28, 256
    s_add_u32 m0, s31, 57344
    s_nop 0
    buffer_load_dwordx4 v6, s[12:15], s21 offen lds
    s_add_u32 m0, s31, 58368
    s_add_u32 s21, s21, 131072
    buffer_load_dwordx4 v6, s[12:15], s21 offen lds
    s_add_u32 m0, s31, 59392
    s_add_u32 s21, s21, 131072
    buffer_load_dwordx4 v6, s[12:15], s21 offen lds
    s_add_u32 m0, s31, 60416
    s_add_u32 s21, s21, 131072
    buffer_load_dwordx4 v6, s[12:15], s21 offen lds
    s_add_u32 s21, s28, 524288
    s_add_u32 m0, s31, 73728
    s_nop 0
    buffer_load_dwordx4 v6, s[12:15], s21 offen lds
    s_add_u32 m0, s31, 74752
    s_add_u32 s21, s21, 131072
    buffer_load_dwordx4 v6, s[12:15], s21 offen lds
    s_add_u32 m0, s31, 75776
    s_add_u32 s21, s21, 131072
    buffer_load_dwordx4 v6, s[12:15], s21 offen lds
    s_add_u32 m0, s31, 76800
    s_add_u32 s21, s21, 131072
    buffer_load_dwordx4 v6, s[12:15], s21 offen lds
    s_add_u32 s21, s28, 524544
    s_add_u32 m0, s31, 90112
    s_nop 0
    buffer_load_dwordx4 v6, s[12:15], s21 offen lds
    s_add_u32 m0, s31, 91136
    s_add_u32 s21, s21, 131072
    buffer_load_dwordx4 v6, s[12:15], s21 offen lds
    s_add_u32 m0, s31, 92160
    s_add_u32 s21, s21, 131072
    buffer_load_dwordx4 v6, s[12:15], s21 offen lds
    s_add_u32 m0, s31, 93184
    s_add_u32 s21, s21, 131072
    buffer_load_dwordx4 v6, s[12:15], s21 offen lds
    s_add_u32 s21, s28, 1048576
    s_add_u32 m0, s31, 106496
    s_nop 0
    buffer_load_dwordx4 v6, s[12:15], s21 offen lds
    s_add_u32 m0, s31, 107520
    s_add_u32 s21, s21, 131072
    buffer_load_dwordx4 v6, s[12:15], s21 offen lds
    s_add_u32 m0, s31, 108544
    s_add_u32 s21, s21, 131072
    buffer_load_dwordx4 v6, s[12:15], s21 offen lds
    s_add_u32 m0, s31, 109568
    s_add_u32 s21, s21, 131072
    buffer_load_dwordx4 v6, s[12:15], s21 offen lds
    s_add_u32 s21, s28, 1048832
    s_add_u32 m0, s31, 122880
    s_nop 0
    buffer_load_dwordx4 v6, s[12:15], s21 offen lds
    s_add_u32 m0, s31, 123904
    s_add_u32 s21, s21, 131072
    buffer_load_dwordx4 v6, s[12:15], s21 offen lds
    s_add_u32 m0, s31, 124928
    s_add_u32 s21, s21, 131072
    buffer_load_dwordx4 v6, s[12:15], s21 offen lds
    s_add_u32 m0, s31, 125952
    s_add_u32 s21, s21, 131072
    buffer_load_dwordx4 v6, s[12:15], s21 offen lds
    s_add_u32 s21, s28, 1572864
    s_add_u32 m0, s31, 139264
    s_nop 0
    buffer_load_dwordx4 v6, s[12:15], s21 offen lds
    s_add_u32 m0, s31, 140288
    s_add_u32 s21, s21, 131072
    buffer_load_dwordx4 v6, s[12:15], s21 offen lds
    s_add_u32 m0, s31, 141312
    s_add_u32 s21, s21, 131072
    buffer_load_dwordx4 v6, s[12:15], s21 offen lds
    s_add_u32 m0, s31, 142336
    s_add_u32 s21, s21, 131072
    buffer_load_dwordx4 v6, s[12:15], s21 offen lds
    v_and_b32 v5, 15, v4
    v_lshrrev_b32 v3, 4, v4
    v_lshrrev_b32 v2, 2, v5
    v_xor_b32 v3, v3, v2
    v_lshl_add_u32 v3, v5, 2, v3
    v_lshlrev_b32 v1, 4, v3
    v_lshrrev_b32 v5, 2, v4
    v_lshrrev_b32 v3, 4, v4
    v_and_b32 v4, 3, v4
    v_xor_b32 v4, v4, v3
    v_lshlrev_b32 v3, 3, v3
    v_and_b32 v5, 3, v5
    v_add_u32 v3, v3, v5
    v_mul_u32_u24 v2, 1152, v3
    v_lshl_add_u32 v2, v4, 4, v2
    s_mov_b32 s8, s48
    s_mov_b32 s9, s49
    s_mov_b32 s10, 2359296
    s_mov_b32 s11, 0x20000
    s_lshr_b32 s22, s18, 1
    s_mul_i32 s24, s22, 4608
    s_and_b32 s22, s18, 1
    s_mul_i32 s23, s22, 576
    s_add_u32 s24, s24, s23
    s_mul_i32 s25, s18, 9216
    s_mul_i32 s22, s19, 36864
    s_add_u32 s24, s24, s22
    s_mul_i32 s42, s20, 36864
    s_mov_b32 s27, 0
    s_add_u32 s23, s27, s25
    s_add_u32 m0, s23, 0
    s_nop 0
    buffer_load_dwordx4 v2, s[8:11], s24 offen offset:0 lds
    s_add_u32 m0, s23, 960
    s_nop 0
    buffer_load_dwordx4 v2, s[8:11], s24 offen offset:64 lds
    s_add_u32 m0, s23, 1920
    s_nop 0
    buffer_load_dwordx4 v2, s[8:11], s24 offen offset:128 lds
    s_add_u32 m0, s23, 2880
    s_nop 0
    buffer_load_dwordx4 v2, s[8:11], s24 offen offset:192 lds
    s_add_u32 m0, s23, 3840
    s_nop 0
    buffer_load_dwordx4 v2, s[8:11], s24 offen offset:256 lds
    s_add_u32 m0, s23, 4800
    s_nop 0
    buffer_load_dwordx4 v2, s[8:11], s24 offen offset:320 lds
    s_add_u32 m0, s23, 5760
    s_nop 0
    buffer_load_dwordx4 v2, s[8:11], s24 offen offset:384 lds
    s_add_u32 m0, s23, 6720
    s_nop 0
    buffer_load_dwordx4 v2, s[8:11], s24 offen offset:448 lds
    s_add_u32 m0, s23, 7680
    s_nop 0
    buffer_load_dwordx4 v2, s[8:11], s24 offen offset:512 lds
    s_add_u32 s24, s24, s42
    s_lshl_b32 s22, s19, 5
    s_add_u32 s22, s22, s17
    s_lshl_b32 s26, s22, 14
    s_mul_i32 s23, s18, 3072
    s_add_u32 s26, s26, s23
    s_lshl_b32 s23, s16, 11
    s_add_u32 s26, s26, s23
    s_add_u32 s26, s26, -2048
    s_lshl_b32 s22, s22, 13
    s_add_u32 s22, s22, 33554432
    s_cmp_eq_u32 s16, 0
    s_cselect_b32 s26, s22, s26
    s_cselect_b32 s40, 4, 1
    s_cselect_b32 s43, 1, 2
    s_lshl_b32 s40, s40, 10
    s_lshl_b32 s43, s43, 13
    s_lshl_b32 s41, s43, 5
    s_mul_i32 s41, s41, s20
    s_lshl_b32 s29, s17, 7
    s_lshl_b32 s22, s33, 2
    s_add_u32 s29, s29, s22
    s_add_u32 s29, s29, 125829120
    v_add_u32 v25, 40960, v24
    v_xor_b32 v26, 32, v25
    s_waitcnt vmcnt(33)
    ds_read_b64_tr_b16 v[64:65], v25 offset:0
    ds_read_b64_tr_b16 v[66:67], v25 offset:256
    ds_read_b64_tr_b16 v[136:137], v26 offset:0
    ds_read_b64_tr_b16 v[138:139], v26 offset:256
    ds_read_b64_tr_b16 v[68:69], v25 offset:2048
    ds_read_b64_tr_b16 v[70:71], v25 offset:2304
    ds_read_b64_tr_b16 v[140:141], v26 offset:2048
    ds_read_b64_tr_b16 v[142:143], v26 offset:2304
    s_waitcnt lgkmcnt(0)
    s_add_u32 s21, s28, 1573120
    s_add_u32 m0, s31, 40960
    s_nop 0
    buffer_load_dwordx4 v6, s[12:15], s21 offen lds
    s_add_u32 m0, s31, 41984
    s_add_u32 s21, s21, 131072
    buffer_load_dwordx4 v6, s[12:15], s21 offen lds
    s_add_u32 m0, s31, 43008
    s_add_u32 s21, s21, 131072
    buffer_load_dwordx4 v6, s[12:15], s21 offen lds
    s_add_u32 m0, s31, 44032
    s_add_u32 s21, s21, 131072
    buffer_load_dwordx4 v6, s[12:15], s21 offen lds
    v_add_u32 v25, 57344, v24
    v_xor_b32 v26, 32, v25
    s_waitcnt vmcnt(33)
    ds_read_b64_tr_b16 a[0:1], v25 offset:0
    ds_read_b64_tr_b16 a[2:3], v25 offset:256
    ds_read_b64_tr_b16 a[72:73], v26 offset:0
    ds_read_b64_tr_b16 a[74:75], v26 offset:256
    ds_read_b64_tr_b16 a[4:5], v25 offset:2048
    ds_read_b64_tr_b16 a[6:7], v25 offset:2304
    ds_read_b64_tr_b16 a[76:77], v26 offset:2048
    ds_read_b64_tr_b16 a[78:79], v26 offset:2304
    s_waitcnt lgkmcnt(0)
    s_add_u32 s21, s28, 2097152
    s_add_u32 m0, s31, 57344
    s_nop 0
    buffer_load_dwordx4 v6, s[12:15], s21 offen lds
    s_add_u32 m0, s31, 58368
    s_add_u32 s21, s21, 131072
    buffer_load_dwordx4 v6, s[12:15], s21 offen lds
    s_add_u32 m0, s31, 59392
    s_add_u32 s21, s21, 131072
    buffer_load_dwordx4 v6, s[12:15], s21 offen lds
    s_add_u32 m0, s31, 60416
    s_add_u32 s21, s21, 131072
    buffer_load_dwordx4 v6, s[12:15], s21 offen lds
    v_add_u32 v25, 73728, v24
    v_xor_b32 v26, 32, v25
    s_waitcnt vmcnt(33)
    ds_read_b64_tr_b16 v[72:73], v25 offset:0
    ds_read_b64_tr_b16 v[74:75], v25 offset:256
    ds_read_b64_tr_b16 v[144:145], v26 offset:0
    ds_read_b64_tr_b16 v[146:147], v26 offset:256
    ds_read_b64_tr_b16 v[76:77], v25 offset:2048
    ds_read_b64_tr_b16 v[78:79], v25 offset:2304
    ds_read_b64_tr_b16 v[148:149], v26 offset:2048
    ds_read_b64_tr_b16 v[150:151], v26 offset:2304
    s_waitcnt lgkmcnt(0)
    s_add_u32 s21, s28, 2097408
    s_add_u32 m0, s31, 73728
    s_nop 0
    buffer_load_dwordx4 v6, s[12:15], s21 offen lds
    s_add_u32 m0, s31, 74752
    s_add_u32 s21, s21, 131072
    buffer_load_dwordx4 v6, s[12:15], s21 offen lds
    s_add_u32 m0, s31, 75776
    s_add_u32 s21, s21, 131072
    buffer_load_dwordx4 v6, s[12:15], s21 offen lds
    s_add_u32 m0, s31, 76800
    s_add_u32 s21, s21, 131072
    buffer_load_dwordx4 v6, s[12:15], s21 offen lds
    v_add_u32 v25, 90112, v24
    v_xor_b32 v26, 32, v25
    s_waitcnt vmcnt(33)
    ds_read_b64_tr_b16 a[8:9], v25 offset:0
    ds_read_b64_tr_b16 a[10:11], v25 offset:256
    ds_read_b64_tr_b16 a[80:81], v26 offset:0
    ds_read_b64_tr_b16 a[82:83], v26 offset:256
    ds_read_b64_tr_b16 a[12:13], v25 offset:2048
    ds_read_b64_tr_b16 a[14:15], v25 offset:2304
    ds_read_b64_tr_b16 a[84:85], v26 offset:2048
    ds_read_b64_tr_b16 a[86:87], v26 offset:2304
    s_waitcnt lgkmcnt(0)
    s_add_u32 s21, s28, 2621440
    s_add_u32 m0, s31, 90112
    s_nop 0
    buffer_load_dwordx4 v6, s[12:15], s21 offen lds
    s_add_u32 m0, s31, 91136
    s_add_u32 s21, s21, 131072
    buffer_load_dwordx4 v6, s[12:15], s21 offen lds
    s_add_u32 m0, s31, 92160
    s_add_u32 s21, s21, 131072
    buffer_load_dwordx4 v6, s[12:15], s21 offen lds
    s_add_u32 m0, s31, 93184
    s_add_u32 s21, s21, 131072
    buffer_load_dwordx4 v6, s[12:15], s21 offen lds
    v_add_u32 v25, 106496, v24
    v_xor_b32 v26, 32, v25
    s_waitcnt vmcnt(33)
    ds_read_b64_tr_b16 v[80:81], v25 offset:0
    ds_read_b64_tr_b16 v[82:83], v25 offset:256
    ds_read_b64_tr_b16 v[152:153], v26 offset:0
    ds_read_b64_tr_b16 v[154:155], v26 offset:256
    ds_read_b64_tr_b16 v[84:85], v25 offset:2048
    ds_read_b64_tr_b16 v[86:87], v25 offset:2304
    ds_read_b64_tr_b16 v[156:157], v26 offset:2048
    ds_read_b64_tr_b16 v[158:159], v26 offset:2304
    s_waitcnt lgkmcnt(0)
    s_add_u32 s21, s28, 2621696
    s_add_u32 m0, s31, 106496
    s_nop 0
    buffer_load_dwordx4 v6, s[12:15], s21 offen lds
    s_add_u32 m0, s31, 107520
    s_add_u32 s21, s21, 131072
    buffer_load_dwordx4 v6, s[12:15], s21 offen lds
    s_add_u32 m0, s31, 108544
    s_add_u32 s21, s21, 131072
    buffer_load_dwordx4 v6, s[12:15], s21 offen lds
    s_add_u32 m0, s31, 109568
    s_add_u32 s21, s21, 131072
    buffer_load_dwordx4 v6, s[12:15], s21 offen lds
    v_add_u32 v25, 122880, v24
    v_xor_b32 v26, 32, v25
    s_waitcnt vmcnt(33)
    ds_read_b64_tr_b16 a[16:17], v25 offset:0
    ds_read_b64_tr_b16 a[18:19], v25 offset:256
    ds_read_b64_tr_b16 a[88:89], v26 offset:0
    ds_read_b64_tr_b16 a[90:91], v26 offset:256
    ds_read_b64_tr_b16 a[20:21], v25 offset:2048
    ds_read_b64_tr_b16 a[22:23], v25 offset:2304
    ds_read_b64_tr_b16 a[92:93], v26 offset:2048
    ds_read_b64_tr_b16 a[94:95], v26 offset:2304
    s_waitcnt lgkmcnt(0)
    s_add_u32 s21, s28, 3145728
    s_add_u32 m0, s31, 122880
    s_nop 0
    buffer_load_dwordx4 v6, s[12:15], s21 offen lds
    s_add_u32 m0, s31, 123904
    s_add_u32 s21, s21, 131072
    buffer_load_dwordx4 v6, s[12:15], s21 offen lds
    s_add_u32 m0, s31, 124928
    s_add_u32 s21, s21, 131072
    buffer_load_dwordx4 v6, s[12:15], s21 offen lds
    s_add_u32 m0, s31, 125952
    s_add_u32 s21, s21, 131072
    buffer_load_dwordx4 v6, s[12:15], s21 offen lds
    v_add_u32 v25, 139264, v24
    v_xor_b32 v26, 32, v25
    s_waitcnt vmcnt(33)
    ds_read_b64_tr_b16 v[88:89], v25 offset:0
    ds_read_b64_tr_b16 v[90:91], v25 offset:256
    ds_read_b64_tr_b16 v[160:161], v26 offset:0
    ds_read_b64_tr_b16 v[162:163], v26 offset:256
    ds_read_b64_tr_b16 v[92:93], v25 offset:2048
    ds_read_b64_tr_b16 v[94:95], v25 offset:2304
    ds_read_b64_tr_b16 v[164:165], v26 offset:2048
    ds_read_b64_tr_b16 v[166:167], v26 offset:2304
    s_waitcnt lgkmcnt(0)
    s_add_u32 s21, s28, 3145984
    s_add_u32 m0, s31, 139264
    s_nop 0
    buffer_load_dwordx4 v6, s[12:15], s21 offen lds
    s_add_u32 m0, s31, 140288
    s_add_u32 s21, s21, 131072
    buffer_load_dwordx4 v6, s[12:15], s21 offen lds
    s_add_u32 m0, s31, 141312
    s_add_u32 s21, s21, 131072
    buffer_load_dwordx4 v6, s[12:15], s21 offen lds
    s_add_u32 m0, s31, 142336
    s_add_u32 s21, s21, 131072
    buffer_load_dwordx4 v6, s[12:15], s21 offen lds
    v_add_u32 v25, 40960, v24
    v_xor_b32 v26, 32, v25
    s_waitcnt vmcnt(24)
    ds_read_b64_tr_b16 a[24:25], v25 offset:0
    ds_read_b64_tr_b16 a[26:27], v25 offset:256
    ds_read_b64_tr_b16 a[96:97], v26 offset:0
    ds_read_b64_tr_b16 a[98:99], v26 offset:256
    ds_read_b64_tr_b16 a[28:29], v25 offset:2048
    ds_read_b64_tr_b16 a[30:31], v25 offset:2304
    ds_read_b64_tr_b16 a[100:101], v26 offset:2048
    ds_read_b64_tr_b16 a[102:103], v26 offset:2304
    s_waitcnt lgkmcnt(0)
    s_add_u32 s21, s28, 3670016
    s_add_u32 m0, s31, 40960
    s_nop 0
    buffer_load_dwordx4 v6, s[12:15], s21 offen lds
    s_add_u32 m0, s31, 41984
    s_add_u32 s21, s21, 131072
    buffer_load_dwordx4 v6, s[12:15], s21 offen lds
    s_add_u32 m0, s31, 43008
    s_add_u32 s21, s21, 131072
    buffer_load_dwordx4 v6, s[12:15], s21 offen lds
    s_add_u32 m0, s31, 44032
    s_add_u32 s21, s21, 131072
    buffer_load_dwordx4 v6, s[12:15], s21 offen lds
    v_add_u32 v25, 57344, v24
    v_xor_b32 v26, 32, v25
    s_waitcnt vmcnt(24)
    ds_read_b64_tr_b16 v[96:97], v25 offset:0
    ds_read_b64_tr_b16 v[98:99], v25 offset:256
    ds_read_b64_tr_b16 v[168:169], v26 offset:0
    ds_read_b64_tr_b16 v[170:171], v26 offset:256
    ds_read_b64_tr_b16 v[100:101], v25 offset:2048
    ds_read_b64_tr_b16 v[102:103], v25 offset:2304
    ds_read_b64_tr_b16 v[172:173], v26 offset:2048
    ds_read_b64_tr_b16 v[174:175], v26 offset:2304
    s_waitcnt lgkmcnt(0)
    s_add_u32 s21, s28, 3670272
    s_add_u32 m0, s31, 57344
    s_nop 0
    buffer_load_dwordx4 v6, s[12:15], s21 offen lds
    s_add_u32 m0, s31, 58368
    s_add_u32 s21, s21, 131072
    buffer_load_dwordx4 v6, s[12:15], s21 offen lds
    s_add_u32 m0, s31, 59392
    s_add_u32 s21, s21, 131072
    buffer_load_dwordx4 v6, s[12:15], s21 offen lds
    s_add_u32 m0, s31, 60416
    s_add_u32 s21, s21, 131072
    buffer_load_dwordx4 v6, s[12:15], s21 offen lds
    v_add_u32 v25, 73728, v24
    v_xor_b32 v26, 32, v25
    s_waitcnt vmcnt(24)
    ds_read_b64_tr_b16 a[32:33], v25 offset:0
    ds_read_b64_tr_b16 a[34:35], v25 offset:256
    ds_read_b64_tr_b16 a[104:105], v26 offset:0
    ds_read_b64_tr_b16 a[106:107], v26 offset:256
    ds_read_b64_tr_b16 a[36:37], v25 offset:2048
    ds_read_b64_tr_b16 a[38:39], v25 offset:2304
    ds_read_b64_tr_b16 a[108:109], v26 offset:2048
    ds_read_b64_tr_b16 a[110:111], v26 offset:2304
    s_waitcnt lgkmcnt(0)
    s_add_u32 s21, s28, 4194304
    s_add_u32 m0, s31, 73728
    s_nop 0
    buffer_load_dwordx4 v6, s[12:15], s21 offen lds
    s_add_u32 m0, s31, 74752
    s_add_u32 s21, s21, 131072
    buffer_load_dwordx4 v6, s[12:15], s21 offen lds
    s_add_u32 m0, s31, 75776
    s_add_u32 s21, s21, 131072
    buffer_load_dwordx4 v6, s[12:15], s21 offen lds
    s_add_u32 m0, s31, 76800
    s_add_u32 s21, s21, 131072
    buffer_load_dwordx4 v6, s[12:15], s21 offen lds
    v_add_u32 v25, 90112, v24
    v_xor_b32 v26, 32, v25
    s_waitcnt vmcnt(24)
    ds_read_b64_tr_b16 v[104:105], v25 offset:0
    ds_read_b64_tr_b16 v[106:107], v25 offset:256
    ds_read_b64_tr_b16 v[176:177], v26 offset:0
    ds_read_b64_tr_b16 v[178:179], v26 offset:256
    ds_read_b64_tr_b16 v[108:109], v25 offset:2048
    ds_read_b64_tr_b16 v[110:111], v25 offset:2304
    ds_read_b64_tr_b16 v[180:181], v26 offset:2048
    ds_read_b64_tr_b16 v[182:183], v26 offset:2304
    s_waitcnt lgkmcnt(0)
    v_mov_b32 v28, s95
    s_cmp_lg_u32 s95, 0
    s_cbranch_scc1 L_ne
    buffer_load_dword v28, off, s[96:99], 0 offset:64 sc1
    s_cmp_ge_u32 s36, 192
    s_cbranch_scc1 L_ne
    s_mul_i32 s37, s36, 24576
    s_mov_b32 s46, 4718592
    s_mov_b32 s47, 0x20000
    v_lshlrev_b32 v29, 7, v0
    v_min_u32 v29, 24448, v29
    s_mov_b64 s[44:45], s[58:59]
    buffer_load_dword v30, v29, s[44:47], s37 offen
    s_mov_b64 s[44:45], s[52:53]
    buffer_load_dword v30, v29, s[44:47], s37 offen
L_ne:
    s_add_u32 s21, s28, 4194560
    s_add_u32 m0, s31, 90112
    s_nop 0
    buffer_load_dwordx4 v6, s[12:15], s21 offen lds
    s_add_u32 m0, s31, 91136
    s_add_u32 s21, s21, 131072
    buffer_load_dwordx4 v6, s[12:15], s21 offen lds
    s_add_u32 m0, s31, 92160
    s_add_u32 s21, s21, 131072
    buffer_load_dwordx4 v6, s[12:15], s21 offen lds
    s_add_u32 m0, s31, 93184
    s_add_u32 s21, s21, 131072
    buffer_load_dwordx4 v6, s[12:15], s21 offen lds
    v_add_u32 v25, 106496, v24
    v_xor_b32 v26, 32, v25
    s_waitcnt vmcnt(24)
    ds_read_b64_tr_b16 a[40:41], v25 offset:0
    ds_read_b64_tr_b16 a[42:43], v25 offset:256
    ds_read_b64_tr_b16 a[112:113], v26 offset:0
    ds_read_b64_tr_b16 a[114:115], v26 offset:256
    ds_read_b64_tr_b16 a[44:45], v25 offset:2048
    ds_read_b64_tr_b16 a[46:47], v25 offset:2304
    ds_read_b64_tr_b16 a[116:117], v26 offset:2048
    ds_read_b64_tr_b16 a[118:119], v26 offset:2304
    s_waitcnt lgkmcnt(0)
    v_add_u32 v25, 122880, v24
    v_xor_b32 v26, 32, v25
    s_waitcnt vmcnt(20)
    ds_read_b64_tr_b16 v[112:113], v25 offset:0
    ds_read_b64_tr_b16 v[114:115], v25 offset:256
    ds_read_b64_tr_b16 v[184:185], v26 offset:0
    ds_read_b64_tr_b16 v[186:187], v26 offset:256
    ds_read_b64_tr_b16 v[116:117], v25 offset:2048
    ds_read_b64_tr_b16 v[118:119], v25 offset:2304
    ds_read_b64_tr_b16 v[188:189], v26 offset:2048
    ds_read_b64_tr_b16 v[190:191], v26 offset:2304
    s_waitcnt lgkmcnt(0)
    v_add_u32 v25, 139264, v24
    v_xor_b32 v26, 32, v25
    s_waitcnt vmcnt(16)
    ds_read_b64_tr_b16 a[48:49], v25 offset:0
    ds_read_b64_tr_b16 a[50:51], v25 offset:256
    ds_read_b64_tr_b16 a[120:121], v26 offset:0
    ds_read_b64_tr_b16 a[122:123], v26 offset:256
    ds_read_b64_tr_b16 a[52:53], v25 offset:2048
    ds_read_b64_tr_b16 a[54:55], v25 offset:2304
    ds_read_b64_tr_b16 a[124:125], v26 offset:2048
    ds_read_b64_tr_b16 a[126:127], v26 offset:2304
    s_waitcnt lgkmcnt(0)
    v_add_u32 v25, 40960, v24
    v_xor_b32 v26, 32, v25
    s_waitcnt vmcnt(12)
    ds_read_b64_tr_b16 v[120:121], v25 offset:0
    ds_read_b64_tr_b16 v[122:123], v25 offset:256
    ds_read_b64_tr_b16 v[192:193], v26 offset:0
    ds_read_b64_tr_b16 v[194:195], v26 offset:256
    ds_read_b64_tr_b16 v[124:125], v25 offset:2048
    ds_read_b64_tr_b16 v[126:127], v25 offset:2304
    ds_read_b64_tr_b16 v[196:197], v26 offset:2048
    ds_read_b64_tr_b16 v[198:199], v26 offset:2304
    s_waitcnt lgkmcnt(0)
    v_add_u32 v25, 57344, v24
    v_xor_b32 v26, 32, v25
    s_waitcnt vmcnt(8)
    ds_read_b64_tr_b16 a[56:57], v25 offset:0
    ds_read_b64_tr_b16 a[58:59], v25 offset:256
    ds_read_b64_tr_b16 a[128:129], v26 offset:0
    ds_read_b64_tr_b16 a[130:131], v26 offset:256
    ds_read_b64_tr_b16 a[60:61], v25 offset:2048
    ds_read_b64_tr_b16 a[62:63], v25 offset:2304
    ds_read_b64_tr_b16 a[132:133], v26 offset:2048
    ds_read_b64_tr_b16 a[134:135], v26 offset:2304
    s_waitcnt lgkmcnt(0)
    v_add_u32 v25, 73728, v24
    v_xor_b32 v26, 32, v25
    s_waitcnt vmcnt(4)
    ds_read_b64_tr_b16 v[128:129], v25 offset:0
    ds_read_b64_tr_b16 v[130:131], v25 offset:256
    ds_read_b64_tr_b16 v[200:201], v26 offset:0
    ds_read_b64_tr_b16 v[202:203], v26 offset:256
    ds_read_b64_tr_b16 v[132:133], v25 offset:2048
    ds_read_b64_tr_b16 v[134:135], v25 offset:2304
    ds_read_b64_tr_b16 v[204:205], v26 offset:2048
    ds_read_b64_tr_b16 v[206:207], v26 offset:2304
    s_waitcnt lgkmcnt(0)
    v_add_u32 v25, 90112, v24
    v_xor_b32 v26, 32, v25
    s_waitcnt vmcnt(0)
    ds_read_b64_tr_b16 a[64:65], v25 offset:0
    ds_read_b64_tr_b16 a[66:67], v25 offset:256
    ds_read_b64_tr_b16 a[136:137], v26 offset:0
    ds_read_b64_tr_b16 a[138:139], v26 offset:256
    ds_read_b64_tr_b16 a[68:69], v25 offset:2048
    ds_read_b64_tr_b16 a[70:71], v25 offset:2304
    ds_read_b64_tr_b16 a[140:141], v26 offset:2048
    ds_read_b64_tr_b16 a[142:143], v26 offset:2304
    s_waitcnt lgkmcnt(0)
    s_lshr_b32 s21, s17, 3
    s_cmp_eq_u32 s21, 3
    s_cselect_b32 s21, 1, s33
    s_cmp_lg_u32 s21, 0
    s_cbranch_scc1 qk_noclr
    v_mov_b32 v8, -1
    v_mov_b32 v9, -1
    v_mov_b32 v10, -1
    v_mov_b32 v11, -1
    v_lshrrev_b32 v25, 6, v0
    v_mul_u32_u24 v25, 11264, v25
    v_add_u32 v25, v25, v7
    s_lshl_b32 s21, s17, 9
    s_add_u32 s21, s21, 90177536
    s_add_u32 s22, s21, 786432
qk_clr:
    buffer_store_dwordx4 v[8:11], v25, s[4:7], s21 offen sc1
    s_add_u32 s21, s21, 49152
    s_cmp_lt_u32 s21, s22
    s_cbranch_scc1 qk_clr
qk_noclr:
    s_cmp_ge_u32 s33, 6
    s_cbranch_scc1 qk_noclr2
    v_mov_b32 v8, -1
    v_mov_b32 v9, -1
    v_mov_b32 v10, -1
    v_mov_b32 v11, -1
    s_cmp_lt_u32 s33, 4
    s_cselect_b32 s21, 60, 54
    s_add_u32 s21, s21, s33
    s_lshl_b32 s23, s17, 12
    s_lshl_b32 s22, s21, 17
    s_add_u32 s22, s22, s23
    s_add_u32 s22, s22, 71303168
    buffer_store_dwordx4 v[8:11], v7, s[4:7], s22 offen sc1
    s_add_u32 s22, s22, 4096
    buffer_store_dwordx4 v[8:11], v7, s[4:7], s22 offen sc1
    s_lshl_b32 s22, s21, 17
    s_add_u32 s22, s22, s23
    s_add_u32 s22, s22, 80740352
    buffer_store_dwordx4 v[8:11], v7, s[4:7], s22 offen sc1
    s_add_u32 s22, s22, 4096
    buffer_store_dwordx4 v[8:11], v7, s[4:7], s22 offen sc1
    s_lshl_b32 s22, s21, 18
    s_add_u32 s22, s22, s23
    s_add_u32 s22, s22, 50331648
    buffer_store_dwordx4 v[8:11], v7, s[4:7], s22 offen sc1
    s_add_u32 s22, s22, 4096
    buffer_store_dwordx4 v[8:11], v7, s[4:7], s22 offen sc1
    s_lshl_b32 s22, s21, 18
    s_add_u32 s22, s22, s23
    s_add_u32 s22, s22, 50462720
    buffer_store_dwordx4 v[8:11], v7, s[4:7], s22 offen sc1
    s_add_u32 s22, s22, 4096
    buffer_store_dwordx4 v[8:11], v7, s[4:7], s22 offen sc1
qk_noclr2:
    v_readfirstlane_b32 s95, v28
    s_nop 4
    s_mov_b32 s88, 4194304
gn7:
    s_cmp_lg_u32 s95, 0
    s_cbranch_scc1 gn7x
    buffer_load_dword v25, off, s[96:99], 0 offset:64 sc1
    s_sub_u32 s88, s88, 1
    s_cbranch_scc1 gn7x
    s_waitcnt vmcnt(0)
    v_readfirstlane_b32 s95, v25
    s_nop 1
    s_branch gn7
gn7x:
    s_barrier
    s_mov_b32 s27, 36864
    s_add_u32 s23, s27, s25
    s_add_u32 m0, s23, 0
    s_nop 0
    buffer_load_dwordx4 v2, s[8:11], s24 offen offset:0 lds
    s_add_u32 m0, s23, 960
    s_nop 0
    buffer_load_dwordx4 v2, s[8:11], s24 offen offset:64 lds
    s_add_u32 m0, s23, 1920
    s_nop 0
    buffer_load_dwordx4 v2, s[8:11], s24 offen offset:128 lds
    s_add_u32 m0, s23, 2880
    s_nop 0
    buffer_load_dwordx4 v2, s[8:11], s24 offen offset:192 lds
    s_add_u32 m0, s23, 3840
    s_nop 0
    buffer_load_dwordx4 v2, s[8:11], s24 offen offset:256 lds
    s_add_u32 m0, s23, 4800
    s_nop 0
    buffer_load_dwordx4 v2, s[8:11], s24 offen offset:320 lds
    s_add_u32 m0, s23, 5760
    s_nop 0
    buffer_load_dwordx4 v2, s[8:11], s24 offen offset:384 lds
    s_add_u32 m0, s23, 6720
    s_nop 0
    buffer_load_dwordx4 v2, s[8:11], s24 offen offset:448 lds
    s_add_u32 m0, s23, 7680
    s_nop 0
    buffer_load_dwordx4 v2, s[8:11], s24 offen offset:512 lds
    s_add_u32 s24, s24, s42
    s_mov_b32 s27, 0
    s_mov_b32 s30, s95
    s_cmp_eq_u32 s18, 0
    s_cselect_b32 s34, 1, 0
    s_mov_b32 s35, 0
    s_mov_b32 s31, 0x80000000
    v_mov_b32 v3, v1
    ds_read_b128 v[32:35], v3 offset:0
    ds_read_b128 v[36:39], v3 offset:18432
    ds_read_b128 v[40:43], v3 offset:1024
    ds_read_b128 v[44:47], v3 offset:19456
    s_cmp_eq_u32 s16, 2
    s_cbranch_scc1 qk_vloop
qk_loop:
    s_add_u32 s22, s27, 73728
    s_sub_u32 s21, s22, 147456
    s_cselect_b32 s22, s22, s21
    s_add_u32 s27, s27, 36864
    s_cmp_eq_u32 s27, 147456
    s_cselect_b32 s27, 0, s27
    s_waitcnt lgkmcnt(2)
    v_cvt_pk_bf16_f32 v8, v208, v209
    v_cvt_pk_bf16_f32 v9, v210, v211
    v_mfma_f32_16x16x32_bf16 v[208:211], v[64:67], v[32:35], 0
    ds_read_b128 v[48:51], v3 offset:2048
    ds_read_b128 v[52:55], v3 offset:20480
    v_cvt_pk_bf16_f32 v10, v212, v213
    v_cvt_pk_bf16_f32 v11, v214, v215
    v_mfma_f32_16x16x32_bf16 v[212:215], v[136:139], v[32:35], 0
    v_cvt_pk_bf16_f32 v12, v216, v217
    v_cvt_pk_bf16_f32 v13, v218, v219
    v_mfma_f32_16x16x32_bf16 v[216:219], v[64:67], v[36:39], 0
    v_cvt_pk_bf16_f32 v14, v220, v221
    v_cvt_pk_bf16_f32 v15, v222, v223
    v_mfma_f32_16x16x32_bf16 v[220:223], v[136:139], v[36:39], 0
    v_cvt_pk_bf16_f32 v16, v224, v225
    v_cvt_pk_bf16_f32 v17, v226, v227
    v_mfma_f32_16x16x32_bf16 v[224:227], a[0:3], v[32:35], 0
    v_cvt_pk_bf16_f32 v18, v228, v229
    v_cvt_pk_bf16_f32 v19, v230, v231
    v_mfma_f32_16x16x32_bf16 v[228:231], a[72:75], v[32:35], 0
    v_cvt_pk_bf16_f32 v20, v232, v233
    v_cvt_pk_bf16_f32 v21, v234, v235
    v_mfma_f32_16x16x32_bf16 v[232:235], a[0:3], v[36:39], 0
    v_cvt_pk_bf16_f32 v22, v236, v237
    v_cvt_pk_bf16_f32 v23, v238, v239
    v_mfma_f32_16x16x32_bf16 v[236:239], a[72:75], v[36:39], 0
    s_waitcnt lgkmcnt(2)
    v_mfma_f32_16x16x32_bf16 v[208:211], v[68:71], v[40:43], v[208:211]
    ds_read_b128 v[32:35], v3 offset:3072
    ds_read_b128 v[36:39], v3 offset:21504
    v_mfma_f32_16x16x32_bf16 v[212:215], v[140:143], v[40:43], v[212:215]
    v_mfma_f32_16x16x32_bf16 v[216:219], v[68:71], v[44:47], v[216:219]
    s_mov_b32 s28, s31
    buffer_store_dwordx4 v[8:11], v7, s[4:7], s28 offen sc1
    v_mfma_f32_16x16x32_bf16 v[220:223], v[140:143], v[44:47], v[220:223]
    v_mfma_f32_16x16x32_bf16 v[224:227], a[4:7], v[40:43], v[224:227]
    v_mfma_f32_16x16x32_bf16 v[228:231], a[76:79], v[40:43], v[228:231]
    v_mfma_f32_16x16x32_bf16 v[232:235], a[4:7], v[44:47], v[232:235]
    v_mfma_f32_16x16x32_bf16 v[236:239], a[76:79], v[44:47], v[236:239]
    s_waitcnt lgkmcnt(2)
    v_mfma_f32_16x16x32_bf16 v[208:211], v[72:75], v[48:51], v[208:211]
    ds_read_b128 v[40:43], v3 offset:4096
    ds_read_b128 v[44:47], v3 offset:22528
    v_mfma_f32_16x16x32_bf16 v[212:215], v[144:147], v[48:51], v[212:215]
    v_mfma_f32_16x16x32_bf16 v[216:219], v[72:75], v[52:55], v[216:219]
    s_add_u32 s28, s28, s40
    buffer_store_dwordx4 v[12:15], v7, s[4:7], s28 offen sc1
    v_mfma_f32_16x16x32_bf16 v[220:223], v[144:147], v[52:55], v[220:223]
    v_mfma_f32_16x16x32_bf16 v[224:227], a[8:11], v[48:51], v[224:227]
    v_mfma_f32_16x16x32_bf16 v[228:231], a[80:83], v[48:51], v[228:231]
    v_mfma_f32_16x16x32_bf16 v[232:235], a[8:11], v[52:55], v[232:235]
    v_mfma_f32_16x16x32_bf16 v[236:239], a[80:83], v[52:55], v[236:239]
    s_waitcnt lgkmcnt(2)
    v_mfma_f32_16x16x32_bf16 v[208:211], v[76:79], v[32:35], v[208:211]
    ds_read_b128 v[48:51], v3 offset:5120
    ds_read_b128 v[52:55], v3 offset:23552
    v_mfma_f32_16x16x32_bf16 v[212:215], v[148:151], v[32:35], v[212:215]
    v_mfma_f32_16x16x32_bf16 v[216:219], v[76:79], v[36:39], v[216:219]
    s_add_u32 s28, s31, s43
    buffer_store_dwordx4 v[16:19], v7, s[4:7], s28 offen sc1
    v_mfma_f32_16x16x32_bf16 v[220:223], v[148:151], v[36:39], v[220:223]
    v_mfma_f32_16x16x32_bf16 v[224:227], a[12:15], v[32:35], v[224:227]
    v_mfma_f32_16x16x32_bf16 v[228:231], a[84:87], v[32:35], v[228:231]
    v_mfma_f32_16x16x32_bf16 v[232:235], a[12:15], v[36:39], v[232:235]
    v_mfma_f32_16x16x32_bf16 v[236:239], a[84:87], v[36:39], v[236:239]
    s_waitcnt lgkmcnt(2)
    v_mfma_f32_16x16x32_bf16 v[208:211], v[80:83], v[40:43], v[208:211]
    ds_read_b128 v[32:35], v3 offset:6144
    ds_read_b128 v[36:39], v3 offset:24576
    v_mfma_f32_16x16x32_bf16 v[212:215], v[152:155], v[40:43], v[212:215]
    v_mfma_f32_16x16x32_bf16 v[216:219], v[80:83], v[44:47], v[216:219]
    s_add_u32 s28, s28, s40
    buffer_store_dwordx4 v[20:23], v7, s[4:7], s28 offen sc1
    v_mfma_f32_16x16x32_bf16 v[220:223], v[152:155], v[44:47], v[220:223]
    v_mfma_f32_16x16x32_bf16 v[224:227], a[16:19], v[40:43], v[224:227]
    v_mfma_f32_16x16x32_bf16 v[228:231], a[88:91], v[40:43], v[228:231]
    v_mfma_f32_16x16x32_bf16 v[232:235], a[16:19], v[44:47], v[232:235]
    v_mfma_f32_16x16x32_bf16 v[236:239], a[88:91], v[44:47], v[236:239]
    s_waitcnt lgkmcnt(2)
    v_mfma_f32_16x16x32_bf16 v[208:211], v[84:87], v[48:51], v[208:211]
    ds_read_b128 v[40:43], v3 offset:7168
    ds_read_b128 v[44:47], v3 offset:25600
    v_mfma_f32_16x16x32_bf16 v[212:215], v[156:159], v[48:51], v[212:215]
    v_mfma_f32_16x16x32_bf16 v[216:219], v[84:87], v[52:55], v[216:219]
    s_add_u32 s23, s22, s25
    s_add_u32 m0, s23, 0
    s_nop 0
    buffer_load_dwordx4 v2, s[8:11], s24 offen offset:0 lds
    v_mfma_f32_16x16x32_bf16 v[220:223], v[156:159], v[52:55], v[220:223]
    v_mfma_f32_16x16x32_bf16 v[224:227], a[20:23], v[48:51], v[224:227]
    v_mfma_f32_16x16x32_bf16 v[228:231], a[92:95], v[48:51], v[228:231]
    v_mfma_f32_16x16x32_bf16 v[232:235], a[20:23], v[52:55], v[232:235]
    v_mfma_f32_16x16x32_bf16 v[236:239], a[92:95], v[52:55], v[236:239]
    s_waitcnt lgkmcnt(2)
    v_mfma_f32_16x16x32_bf16 v[208:211], v[88:91], v[32:35], v[208:211]
    ds_read_b128 v[48:51], v3 offset:8192
    ds_read_b128 v[52:55], v3 offset:26624
    v_mfma_f32_16x16x32_bf16 v[212:215], v[160:163], v[32:35], v[212:215]
    v_mfma_f32_16x16x32_bf16 v[216:219], v[88:91], v[36:39], v[216:219]
    s_add_u32 m0, s23, 960
    s_nop 0
    buffer_load_dwordx4 v2, s[8:11], s24 offen offset:64 lds
    v_mfma_f32_16x16x32_bf16 v[220:223], v[160:163], v[36:39], v[220:223]
    v_mfma_f32_16x16x32_bf16 v[224:227], a[24:27], v[32:35], v[224:227]
    v_mfma_f32_16x16x32_bf16 v[228:231], a[96:99], v[32:35], v[228:231]
    v_mfma_f32_16x16x32_bf16 v[232:235], a[24:27], v[36:39], v[232:235]
    v_mfma_f32_16x16x32_bf16 v[236:239], a[96:99], v[36:39], v[236:239]
    s_waitcnt lgkmcnt(2)
    v_mfma_f32_16x16x32_bf16 v[208:211], v[92:95], v[40:43], v[208:211]
    ds_read_b128 v[32:35], v3 offset:9216
    ds_read_b128 v[36:39], v3 offset:27648
    v_mfma_f32_16x16x32_bf16 v[212:215], v[164:167], v[40:43], v[212:215]
    v_mfma_f32_16x16x32_bf16 v[216:219], v[92:95], v[44:47], v[216:219]
    s_add_u32 m0, s23, 1920
    s_nop 0
    buffer_load_dwordx4 v2, s[8:11], s24 offen offset:128 lds
    v_mfma_f32_16x16x32_bf16 v[220:223], v[164:167], v[44:47], v[220:223]
    v_mfma_f32_16x16x32_bf16 v[224:227], a[28:31], v[40:43], v[224:227]
    v_mfma_f32_16x16x32_bf16 v[228:231], a[100:103], v[40:43], v[228:231]
    v_mfma_f32_16x16x32_bf16 v[232:235], a[28:31], v[44:47], v[232:235]
    v_mfma_f32_16x16x32_bf16 v[236:239], a[100:103], v[44:47], v[236:239]
    s_waitcnt lgkmcnt(2)
    v_mfma_f32_16x16x32_bf16 v[208:211], v[96:99], v[48:51], v[208:211]
    ds_read_b128 v[40:43], v3 offset:10240
    ds_read_b128 v[44:47], v3 offset:28672
    v_mfma_f32_16x16x32_bf16 v[212:215], v[168:171], v[48:51], v[212:215]
    v_mfma_f32_16x16x32_bf16 v[216:219], v[96:99], v[52:55], v[216:219]
    s_add_u32 m0, s23, 2880
    s_nop 0
    buffer_load_dwordx4 v2, s[8:11], s24 offen offset:192 lds
    v_mfma_f32_16x16x32_bf16 v[220:223], v[168:171], v[52:55], v[220:223]
    v_mfma_f32_16x16x32_bf16 v[224:227], a[32:35], v[48:51], v[224:227]
    v_mfma_f32_16x16x32_bf16 v[228:231], a[104:107], v[48:51], v[228:231]
    v_mfma_f32_16x16x32_bf16 v[232:235], a[32:35], v[52:55], v[232:235]
    v_mfma_f32_16x16x32_bf16 v[236:239], a[104:107], v[52:55], v[236:239]
    s_waitcnt lgkmcnt(2)
    v_mfma_f32_16x16x32_bf16 v[208:211], v[100:103], v[32:35], v[208:211]
    ds_read_b128 v[48:51], v3 offset:11264
    ds_read_b128 v[52:55], v3 offset:29696
    v_mfma_f32_16x16x32_bf16 v[212:215], v[172:175], v[32:35], v[212:215]
    v_mfma_f32_16x16x32_bf16 v[216:219], v[100:103], v[36:39], v[216:219]
    s_add_u32 m0, s23, 3840
    s_nop 0
    buffer_load_dwordx4 v2, s[8:11], s24 offen offset:256 lds
    v_mfma_f32_16x16x32_bf16 v[220:223], v[172:175], v[36:39], v[220:223]
    v_mfma_f32_16x16x32_bf16 v[224:227], a[36:39], v[32:35], v[224:227]
    v_mfma_f32_16x16x32_bf16 v[228:231], a[108:111], v[32:35], v[228:231]
    v_mfma_f32_16x16x32_bf16 v[232:235], a[36:39], v[36:39], v[232:235]
    v_mfma_f32_16x16x32_bf16 v[236:239], a[108:111], v[36:39], v[236:239]
    s_waitcnt lgkmcnt(2)
    v_mfma_f32_16x16x32_bf16 v[208:211], v[104:107], v[40:43], v[208:211]
    ds_read_b128 v[32:35], v3 offset:12288
    ds_read_b128 v[36:39], v3 offset:30720
    v_mfma_f32_16x16x32_bf16 v[212:215], v[176:179], v[40:43], v[212:215]
    v_mfma_f32_16x16x32_bf16 v[216:219], v[104:107], v[44:47], v[216:219]
    s_add_u32 m0, s23, 4800
    s_nop 0
    buffer_load_dwordx4 v2, s[8:11], s24 offen offset:320 lds
    v_mfma_f32_16x16x32_bf16 v[220:223], v[176:179], v[44:47], v[220:223]
    v_mfma_f32_16x16x32_bf16 v[224:227], a[40:43], v[40:43], v[224:227]
    v_mfma_f32_16x16x32_bf16 v[228:231], a[112:115], v[40:43], v[228:231]
    v_mfma_f32_16x16x32_bf16 v[232:235], a[40:43], v[44:47], v[232:235]
    v_mfma_f32_16x16x32_bf16 v[236:239], a[112:115], v[44:47], v[236:239]
    s_waitcnt lgkmcnt(2)
    v_mfma_f32_16x16x32_bf16 v[208:211], v[108:111], v[48:51], v[208:211]
    ds_read_b128 v[40:43], v3 offset:13312
    ds_read_b128 v[44:47], v3 offset:31744
    v_mfma_f32_16x16x32_bf16 v[212:215], v[180:183], v[48:51], v[212:215]
    v_mfma_f32_16x16x32_bf16 v[216:219], v[108:111], v[52:55], v[216:219]
    s_add_u32 m0, s23, 5760
    s_nop 0
    buffer_load_dwordx4 v2, s[8:11], s24 offen offset:384 lds
    v_mfma_f32_16x16x32_bf16 v[220:223], v[180:183], v[52:55], v[220:223]
    v_mfma_f32_16x16x32_bf16 v[224:227], a[44:47], v[48:51], v[224:227]
    v_mfma_f32_16x16x32_bf16 v[228:231], a[116:119], v[48:51], v[228:231]
    v_mfma_f32_16x16x32_bf16 v[232:235], a[44:47], v[52:55], v[232:235]
    v_mfma_f32_16x16x32_bf16 v[236:239], a[116:119], v[52:55], v[236:239]
    s_waitcnt lgkmcnt(2)
    v_mfma_f32_16x16x32_bf16 v[208:211], v[112:115], v[32:35], v[208:211]
    ds_read_b128 v[48:51], v3 offset:14336
    ds_read_b128 v[52:55], v3 offset:32768
    v_mfma_f32_16x16x32_bf16 v[212:215], v[184:187], v[32:35], v[212:215]
    v_mfma_f32_16x16x32_bf16 v[216:219], v[112:115], v[36:39], v[216:219]
    s_add_u32 m0, s23, 6720
    s_nop 0
    buffer_load_dwordx4 v2, s[8:11], s24 offen offset:448 lds
    v_mfma_f32_16x16x32_bf16 v[220:223], v[184:187], v[36:39], v[220:223]
    v_mfma_f32_16x16x32_bf16 v[224:227], a[48:51], v[32:35], v[224:227]
    v_mfma_f32_16x16x32_bf16 v[228:231], a[120:123], v[32:35], v[228:231]
    v_mfma_f32_16x16x32_bf16 v[232:235], a[48:51], v[36:39], v[232:235]
    v_mfma_f32_16x16x32_bf16 v[236:239], a[120:123], v[36:39], v[236:239]
    s_waitcnt lgkmcnt(2)
    v_mfma_f32_16x16x32_bf16 v[208:211], v[116:119], v[40:43], v[208:211]
    ds_read_b128 v[32:35], v3 offset:15360
    ds_read_b128 v[36:39], v3 offset:33792
    v_mfma_f32_16x16x32_bf16 v[212:215], v[188:191], v[40:43], v[212:215]
    v_mfma_f32_16x16x32_bf16 v[216:219], v[116:119], v[44:47], v[216:219]
    s_add_u32 m0, s23, 7680
    s_nop 0
    buffer_load_dwordx4 v2, s[8:11], s24 offen offset:512 lds
    s_add_u32 s24, s24, s42
    v_mfma_f32_16x16x32_bf16 v[220:223], v[188:191], v[44:47], v[220:223]
    v_mfma_f32_16x16x32_bf16 v[224:227], a[52:55], v[40:43], v[224:227]
    v_mfma_f32_16x16x32_bf16 v[228:231], a[124:127], v[40:43], v[228:231]
    v_mfma_f32_16x16x32_bf16 v[232:235], a[52:55], v[44:47], v[232:235]
    v_mfma_f32_16x16x32_bf16 v[236:239], a[124:127], v[44:47], v[236:239]
    s_waitcnt lgkmcnt(2)
    v_mfma_f32_16x16x32_bf16 v[208:211], v[120:123], v[48:51], v[208:211]
    ds_read_b128 v[40:43], v3 offset:16384
    ds_read_b128 v[44:47], v3 offset:34816
    v_mfma_f32_16x16x32_bf16 v[212:215], v[192:195], v[48:51], v[212:215]
    v_mfma_f32_16x16x32_bf16 v[216:219], v[120:123], v[52:55], v[216:219]
    v_add_u32 v24, s27, v1
    v_mfma_f32_16x16x32_bf16 v[220:223], v[192:195], v[52:55], v[220:223]
    v_mfma_f32_16x16x32_bf16 v[224:227], a[56:59], v[48:51], v[224:227]
    v_mfma_f32_16x16x32_bf16 v[228:231], a[128:131], v[48:51], v[228:231]
    v_mfma_f32_16x16x32_bf16 v[232:235], a[56:59], v[52:55], v[232:235]
    v_mfma_f32_16x16x32_bf16 v[236:239], a[128:131], v[52:55], v[236:239]
    s_waitcnt lgkmcnt(2)
    v_mfma_f32_16x16x32_bf16 v[208:211], v[124:127], v[32:35], v[208:211]
    ds_read_b128 v[48:51], v3 offset:17408
    ds_read_b128 v[52:55], v3 offset:35840
    v_mfma_f32_16x16x32_bf16 v[212:215], v[196:199], v[32:35], v[212:215]
    v_mfma_f32_16x16x32_bf16 v[216:219], v[124:127], v[36:39], v[216:219]
    v_mfma_f32_16x16x32_bf16 v[220:223], v[196:199], v[36:39], v[220:223]
    v_mfma_f32_16x16x32_bf16 v[224:227], a[60:63], v[32:35], v[224:227]
    v_mfma_f32_16x16x32_bf16 v[228:231], a[132:135], v[32:35], v[228:231]
    s_waitcnt vmcnt(9)
    s_barrier
    v_mfma_f32_16x16x32_bf16 v[232:235], a[60:63], v[36:39], v[232:235]
    v_mfma_f32_16x16x32_bf16 v[236:239], a[132:135], v[36:39], v[236:239]
    s_waitcnt lgkmcnt(2)
    v_mfma_f32_16x16x32_bf16 v[208:211], v[128:131], v[40:43], v[208:211]
    ds_read_b128 v[32:35], v24 offset:0
    ds_read_b128 v[36:39], v24 offset:18432
    v_mfma_f32_16x16x32_bf16 v[212:215], v[200:203], v[40:43], v[212:215]
    v_mfma_f32_16x16x32_bf16 v[216:219], v[128:131], v[44:47], v[216:219]
    v_mov_b32 v4, s30
    s_mov_b64 exec, s[34:35]
    buffer_store_dword v4, off, s[4:7], s29 sc1
    s_mov_b64 exec, -1
    v_mfma_f32_16x16x32_bf16 v[220:223], v[200:203], v[44:47], v[220:223]
    v_mfma_f32_16x16x32_bf16 v[224:227], a[64:67], v[40:43], v[224:227]
    v_mfma_f32_16x16x32_bf16 v[228:231], a[136:139], v[40:43], v[228:231]
    v_mfma_f32_16x16x32_bf16 v[232:235], a[64:67], v[44:47], v[232:235]
    v_mfma_f32_16x16x32_bf16 v[236:239], a[136:139], v[44:47], v[236:239]
    s_waitcnt lgkmcnt(2)
    v_mfma_f32_16x16x32_bf16 v[208:211], v[132:135], v[48:51], v[208:211]
    ds_read_b128 v[40:43], v24 offset:1024
    ds_read_b128 v[44:47], v24 offset:19456
    v_mfma_f32_16x16x32_bf16 v[212:215], v[204:207], v[48:51], v[212:215]
    v_mfma_f32_16x16x32_bf16 v[216:219], v[132:135], v[52:55], v[216:219]
    v_mfma_f32_16x16x32_bf16 v[220:223], v[204:207], v[52:55], v[220:223]
    v_mfma_f32_16x16x32_bf16 v[224:227], a[68:71], v[48:51], v[224:227]
    v_mfma_f32_16x16x32_bf16 v[228:231], a[140:143], v[48:51], v[228:231]
    v_mfma_f32_16x16x32_bf16 v[232:235], a[68:71], v[52:55], v[232:235]
    v_mfma_f32_16x16x32_bf16 v[236:239], a[140:143], v[52:55], v[236:239]
    v_mov_b32 v3, v24
    s_mov_b32 s31, s26
    s_add_u32 s26, s26, s41
    s_add_u32 s30, s30, 1
    s_add_u32 s19, s19, s20
    s_cmp_lt_u32 s19, 64
    s_cbranch_scc1 qk_loop
    v_cvt_pk_bf16_f32 v8, v208, v209
    v_cvt_pk_bf16_f32 v9, v210, v211
    v_cvt_pk_bf16_f32 v10, v212, v213
    v_cvt_pk_bf16_f32 v11, v214, v215
    v_cvt_pk_bf16_f32 v12, v216, v217
    v_cvt_pk_bf16_f32 v13, v218, v219
    v_cvt_pk_bf16_f32 v14, v220, v221
    v_cvt_pk_bf16_f32 v15, v222, v223
    v_cvt_pk_bf16_f32 v16, v224, v225
    v_cvt_pk_bf16_f32 v17, v226, v227
    v_cvt_pk_bf16_f32 v18, v228, v229
    v_cvt_pk_bf16_f32 v19, v230, v231
    v_cvt_pk_bf16_f32 v20, v232, v233
    v_cvt_pk_bf16_f32 v21, v234, v235
    v_cvt_pk_bf16_f32 v22, v236, v237
    v_cvt_pk_bf16_f32 v23, v238, v239
    s_branch qk_done
    s_nop 0
qk_vloop:
    s_add_u32 s22, s27, 73728
    s_sub_u32 s21, s22, 147456
    s_cselect_b32 s22, s22, s21
    s_add_u32 s27, s27, 36864
    s_cmp_eq_u32 s27, 147456
    s_cselect_b32 s27, 0, s27
    s_waitcnt lgkmcnt(2)
    v_cvt_pk_bf16_f32 v8, v208, v209
    v_cvt_pk_bf16_f32 v9, v210, v211
    v_mfma_f32_16x16x32_bf16 v[208:211], v[32:35], v[64:67], 0
    ds_read_b128 v[48:51], v3 offset:2048
    ds_read_b128 v[52:55], v3 offset:20480
    v_cvt_pk_bf16_f32 v12, v212, v213
    v_cvt_pk_bf16_f32 v13, v214, v215
    v_mfma_f32_16x16x32_bf16 v[212:215], v[32:35], v[136:139], 0
    v_cvt_pk_bf16_f32 v10, v216, v217
    v_cvt_pk_bf16_f32 v11, v218, v219
    v_mfma_f32_16x16x32_bf16 v[216:219], v[36:39], v[64:67], 0
    v_cvt_pk_bf16_f32 v14, v220, v221
    v_cvt_pk_bf16_f32 v15, v222, v223
    v_mfma_f32_16x16x32_bf16 v[220:223], v[36:39], v[136:139], 0
    v_cvt_pk_bf16_f32 v16, v224, v225
    v_cvt_pk_bf16_f32 v17, v226, v227
    v_mfma_f32_16x16x32_bf16 v[224:227], v[32:35], a[0:3], 0
    v_cvt_pk_bf16_f32 v20, v228, v229
    v_cvt_pk_bf16_f32 v21, v230, v231
    v_mfma_f32_16x16x32_bf16 v[228:231], v[32:35], a[72:75], 0
    v_cvt_pk_bf16_f32 v18, v232, v233
    v_cvt_pk_bf16_f32 v19, v234, v235
    v_mfma_f32_16x16x32_bf16 v[232:235], v[36:39], a[0:3], 0
    v_cvt_pk_bf16_f32 v22, v236, v237
    v_cvt_pk_bf16_f32 v23, v238, v239
    v_mfma_f32_16x16x32_bf16 v[236:239], v[36:39], a[72:75], 0
    s_waitcnt lgkmcnt(2)
    v_mfma_f32_16x16x32_bf16 v[208:211], v[40:43], v[68:71], v[208:211]
    ds_read_b128 v[32:35], v3 offset:3072
    ds_read_b128 v[36:39], v3 offset:21504
    v_mfma_f32_16x16x32_bf16 v[212:215], v[40:43], v[140:143], v[212:215]
    v_mfma_f32_16x16x32_bf16 v[216:219], v[44:47], v[68:71], v[216:219]
    s_mov_b32 s28, s31
    buffer_store_dwordx4 v[8:11], v7, s[4:7], s28 offen sc1
    v_mfma_f32_16x16x32_bf16 v[220:223], v[44:47], v[140:143], v[220:223]
    v_mfma_f32_16x16x32_bf16 v[224:227], v[40:43], a[4:7], v[224:227]
    v_mfma_f32_16x16x32_bf16 v[228:231], v[40:43], a[76:79], v[228:231]
    v_mfma_f32_16x16x32_bf16 v[232:235], v[44:47], a[4:7], v[232:235]
    v_mfma_f32_16x16x32_bf16 v[236:239], v[44:47], a[76:79], v[236:239]
    s_waitcnt lgkmcnt(2)
    v_mfma_f32_16x16x32_bf16 v[208:211], v[48:51], v[72:75], v[208:211]
    ds_read_b128 v[40:43], v3 offset:4096
    ds_read_b128 v[44:47], v3 offset:22528
    v_mfma_f32_16x16x32_bf16 v[212:215], v[48:51], v[144:147], v[212:215]
    v_mfma_f32_16x16x32_bf16 v[216:219], v[52:55], v[72:75], v[216:219]
    s_add_u32 s28, s28, s40
    buffer_store_dwordx4 v[12:15], v7, s[4:7], s28 offen sc1
    v_mfma_f32_16x16x32_bf16 v[220:223], v[52:55], v[144:147], v[220:223]
    v_mfma_f32_16x16x32_bf16 v[224:227], v[48:51], a[8:11], v[224:227]
    v_mfma_f32_16x16x32_bf16 v[228:231], v[48:51], a[80:83], v[228:231]
    v_mfma_f32_16x16x32_bf16 v[232:235], v[52:55], a[8:11], v[232:235]
    v_mfma_f32_16x16x32_bf16 v[236:239], v[52:55], a[80:83], v[236:239]
    s_waitcnt lgkmcnt(2)
    v_mfma_f32_16x16x32_bf16 v[208:211], v[32:35], v[76:79], v[208:211]
    ds_read_b128 v[48:51], v3 offset:5120
    ds_read_b128 v[52:55], v3 offset:23552
    v_mfma_f32_16x16x32_bf16 v[212:215], v[32:35], v[148:151], v[212:215]
    v_mfma_f32_16x16x32_bf16 v[216:219], v[36:39], v[76:79], v[216:219]
    s_add_u32 s28, s31, s43
    buffer_store_dwordx4 v[16:19], v7, s[4:7], s28 offen sc1
    v_mfma_f32_16x16x32_bf16 v[220:223], v[36:39], v[148:151], v[220:223]
    v_mfma_f32_16x16x32_bf16 v[224:227], v[32:35], a[12:15], v[224:227]
    v_mfma_f32_16x16x32_bf16 v[228:231], v[32:35], a[84:87], v[228:231]
    v_mfma_f32_16x16x32_bf16 v[232:235], v[36:39], a[12:15], v[232:235]
    v_mfma_f32_16x16x32_bf16 v[236:239], v[36:39], a[84:87], v[236:239]
    s_waitcnt lgkmcnt(2)
    v_mfma_f32_16x16x32_bf16 v[208:211], v[40:43], v[80:83], v[208:211]
    ds_read_b128 v[32:35], v3 offset:6144
    ds_read_b128 v[36:39], v3 offset:24576
    v_mfma_f32_16x16x32_bf16 v[212:215], v[40:43], v[152:155], v[212:215]
    v_mfma_f32_16x16x32_bf16 v[216:219], v[44:47], v[80:83], v[216:219]
    s_add_u32 s28, s28, s40
    buffer_store_dwordx4 v[20:23], v7, s[4:7], s28 offen sc1
    v_mfma_f32_16x16x32_bf16 v[220:223], v[44:47], v[152:155], v[220:223]
    v_mfma_f32_16x16x32_bf16 v[224:227], v[40:43], a[16:19], v[224:227]
    v_mfma_f32_16x16x32_bf16 v[228:231], v[40:43], a[88:91], v[228:231]
    v_mfma_f32_16x16x32_bf16 v[232:235], v[44:47], a[16:19], v[232:235]
    v_mfma_f32_16x16x32_bf16 v[236:239], v[44:47], a[88:91], v[236:239]
    s_waitcnt lgkmcnt(2)
    v_mfma_f32_16x16x32_bf16 v[208:211], v[48:51], v[84:87], v[208:211]
    ds_read_b128 v[40:43], v3 offset:7168
    ds_read_b128 v[44:47], v3 offset:25600
    v_mfma_f32_16x16x32_bf16 v[212:215], v[48:51], v[156:159], v[212:215]
    v_mfma_f32_16x16x32_bf16 v[216:219], v[52:55], v[84:87], v[216:219]
    s_add_u32 s23, s22, s25
    s_add_u32 m0, s23, 0
    s_nop 0
    buffer_load_dwordx4 v2, s[8:11], s24 offen offset:0 lds
    v_mfma_f32_16x16x32_bf16 v[220:223], v[52:55], v[156:159], v[220:223]
    v_mfma_f32_16x16x32_bf16 v[224:227], v[48:51], a[20:23], v[224:227]
    v_mfma_f32_16x16x32_bf16 v[228:231], v[48:51], a[92:95], v[228:231]
    v_mfma_f32_16x16x32_bf16 v[232:235], v[52:55], a[20:23], v[232:235]
    v_mfma_f32_16x16x32_bf16 v[236:239], v[52:55], a[92:95], v[236:239]
    s_waitcnt lgkmcnt(2)
    v_mfma_f32_16x16x32_bf16 v[208:211], v[32:35], v[88:91], v[208:211]
    ds_read_b128 v[48:51], v3 offset:8192
    ds_read_b128 v[52:55], v3 offset:26624
    v_mfma_f32_16x16x32_bf16 v[212:215], v[32:35], v[160:163], v[212:215]
    v_mfma_f32_16x16x32_bf16 v[216:219], v[36:39], v[88:91], v[216:219]
    s_add_u32 m0, s23, 960
    s_nop 0
    buffer_load_dwordx4 v2, s[8:11], s24 offen offset:64 lds
    v_mfma_f32_16x16x32_bf16 v[220:223], v[36:39], v[160:163], v[220:223]
    v_mfma_f32_16x16x32_bf16 v[224:227], v[32:35], a[24:27], v[224:227]
    v_mfma_f32_16x16x32_bf16 v[228:231], v[32:35], a[96:99], v[228:231]
    v_mfma_f32_16x16x32_bf16 v[232:235], v[36:39], a[24:27], v[232:235]
    v_mfma_f32_16x16x32_bf16 v[236:239], v[36:39], a[96:99], v[236:239]
    s_waitcnt lgkmcnt(2)
    v_mfma_f32_16x16x32_bf16 v[208:211], v[40:43], v[92:95], v[208:211]
    ds_read_b128 v[32:35], v3 offset:9216
    ds_read_b128 v[36:39], v3 offset:27648
    v_mfma_f32_16x16x32_bf16 v[212:215], v[40:43], v[164:167], v[212:215]
    v_mfma_f32_16x16x32_bf16 v[216:219], v[44:47], v[92:95], v[216:219]
    s_add_u32 m0, s23, 1920
    s_nop 0
    buffer_load_dwordx4 v2, s[8:11], s24 offen offset:128 lds
    v_mfma_f32_16x16x32_bf16 v[220:223], v[44:47], v[164:167], v[220:223]
    v_mfma_f32_16x16x32_bf16 v[224:227], v[40:43], a[28:31], v[224:227]
    v_mfma_f32_16x16x32_bf16 v[228:231], v[40:43], a[100:103], v[228:231]
    v_mfma_f32_16x16x32_bf16 v[232:235], v[44:47], a[28:31], v[232:235]
    v_mfma_f32_16x16x32_bf16 v[236:239], v[44:47], a[100:103], v[236:239]
    s_waitcnt lgkmcnt(2)
    v_mfma_f32_16x16x32_bf16 v[208:211], v[48:51], v[96:99], v[208:211]
    ds_read_b128 v[40:43], v3 offset:10240
    ds_read_b128 v[44:47], v3 offset:28672
    v_mfma_f32_16x16x32_bf16 v[212:215], v[48:51], v[168:171], v[212:215]
    v_mfma_f32_16x16x32_bf16 v[216:219], v[52:55], v[96:99], v[216:219]
    s_add_u32 m0, s23, 2880
    s_nop 0
    buffer_load_dwordx4 v2, s[8:11], s24 offen offset:192 lds
    v_mfma_f32_16x16x32_bf16 v[220:223], v[52:55], v[168:171], v[220:223]
    v_mfma_f32_16x16x32_bf16 v[224:227], v[48:51], a[32:35], v[224:227]
    v_mfma_f32_16x16x32_bf16 v[228:231], v[48:51], a[104:107], v[228:231]
    v_mfma_f32_16x16x32_bf16 v[232:235], v[52:55], a[32:35], v[232:235]
    v_mfma_f32_16x16x32_bf16 v[236:239], v[52:55], a[104:107], v[236:239]
    s_waitcnt lgkmcnt(2)
    v_mfma_f32_16x16x32_bf16 v[208:211], v[32:35], v[100:103], v[208:211]
    ds_read_b128 v[48:51], v3 offset:11264
    ds_read_b128 v[52:55], v3 offset:29696
    v_mfma_f32_16x16x32_bf16 v[212:215], v[32:35], v[172:175], v[212:215]
    v_mfma_f32_16x16x32_bf16 v[216:219], v[36:39], v[100:103], v[216:219]
    s_add_u32 m0, s23, 3840
    s_nop 0
    buffer_load_dwordx4 v2, s[8:11], s24 offen offset:256 lds
    v_mfma_f32_16x16x32_bf16 v[220:223], v[36:39], v[172:175], v[220:223]
    v_mfma_f32_16x16x32_bf16 v[224:227], v[32:35], a[36:39], v[224:227]
    v_mfma_f32_16x16x32_bf16 v[228:231], v[32:35], a[108:111], v[228:231]
    v_mfma_f32_16x16x32_bf16 v[232:235], v[36:39], a[36:39], v[232:235]
    v_mfma_f32_16x16x32_bf16 v[236:239], v[36:39], a[108:111], v[236:239]
    s_waitcnt lgkmcnt(2)
    v_mfma_f32_16x16x32_bf16 v[208:211], v[40:43], v[104:107], v[208:211]
    ds_read_b128 v[32:35], v3 offset:12288
    ds_read_b128 v[36:39], v3 offset:30720
    v_mfma_f32_16x16x32_bf16 v[212:215], v[40:43], v[176:179], v[212:215]
    v_mfma_f32_16x16x32_bf16 v[216:219], v[44:47], v[104:107], v[216:219]
    s_add_u32 m0, s23, 4800
    s_nop 0
    buffer_load_dwordx4 v2, s[8:11], s24 offen offset:320 lds
    v_mfma_f32_16x16x32_bf16 v[220:223], v[44:47], v[176:179], v[220:223]
    v_mfma_f32_16x16x32_bf16 v[224:227], v[40:43], a[40:43], v[224:227]
    v_mfma_f32_16x16x32_bf16 v[228:231], v[40:43], a[112:115], v[228:231]
    v_mfma_f32_16x16x32_bf16 v[232:235], v[44:47], a[40:43], v[232:235]
    v_mfma_f32_16x16x32_bf16 v[236:239], v[44:47], a[112:115], v[236:239]
    s_waitcnt lgkmcnt(2)
    v_mfma_f32_16x16x32_bf16 v[208:211], v[48:51], v[108:111], v[208:211]
    ds_read_b128 v[40:43], v3 offset:13312
    ds_read_b128 v[44:47], v3 offset:31744
    v_mfma_f32_16x16x32_bf16 v[212:215], v[48:51], v[180:183], v[212:215]
    v_mfma_f32_16x16x32_bf16 v[216:219], v[52:55], v[108:111], v[216:219]
    s_add_u32 m0, s23, 5760
    s_nop 0
    buffer_load_dwordx4 v2, s[8:11], s24 offen offset:384 lds
    v_mfma_f32_16x16x32_bf16 v[220:223], v[52:55], v[180:183], v[220:223]
    v_mfma_f32_16x16x32_bf16 v[224:227], v[48:51], a[44:47], v[224:227]
    v_mfma_f32_16x16x32_bf16 v[228:231], v[48:51], a[116:119], v[228:231]
    v_mfma_f32_16x16x32_bf16 v[232:235], v[52:55], a[44:47], v[232:235]
    v_mfma_f32_16x16x32_bf16 v[236:239], v[52:55], a[116:119], v[236:239]
    s_waitcnt lgkmcnt(2)
    v_mfma_f32_16x16x32_bf16 v[208:211], v[32:35], v[112:115], v[208:211]
    ds_read_b128 v[48:51], v3 offset:14336
    ds_read_b128 v[52:55], v3 offset:32768
    v_mfma_f32_16x16x32_bf16 v[212:215], v[32:35], v[184:187], v[212:215]
    v_mfma_f32_16x16x32_bf16 v[216:219], v[36:39], v[112:115], v[216:219]
    s_add_u32 m0, s23, 6720
    s_nop 0
    buffer_load_dwordx4 v2, s[8:11], s24 offen offset:448 lds
    v_mfma_f32_16x16x32_bf16 v[220:223], v[36:39], v[184:187], v[220:223]
    v_mfma_f32_16x16x32_bf16 v[224:227], v[32:35], a[48:51], v[224:227]
    v_mfma_f32_16x16x32_bf16 v[228:231], v[32:35], a[120:123], v[228:231]
    v_mfma_f32_16x16x32_bf16 v[232:235], v[36:39], a[48:51], v[232:235]
    v_mfma_f32_16x16x32_bf16 v[236:239], v[36:39], a[120:123], v[236:239]
    s_waitcnt lgkmcnt(2)
    v_mfma_f32_16x16x32_bf16 v[208:211], v[40:43], v[116:119], v[208:211]
    ds_read_b128 v[32:35], v3 offset:15360
    ds_read_b128 v[36:39], v3 offset:33792
    v_mfma_f32_16x16x32_bf16 v[212:215], v[40:43], v[188:191], v[212:215]
    v_mfma_f32_16x16x32_bf16 v[216:219], v[44:47], v[116:119], v[216:219]
    s_add_u32 m0, s23, 7680
    s_nop 0
    buffer_load_dwordx4 v2, s[8:11], s24 offen offset:512 lds
    s_add_u32 s24, s24, s42
    v_mfma_f32_16x16x32_bf16 v[220:223], v[44:47], v[188:191], v[220:223]
    v_mfma_f32_16x16x32_bf16 v[224:227], v[40:43], a[52:55], v[224:227]
    v_mfma_f32_16x16x32_bf16 v[228:231], v[40:43], a[124:127], v[228:231]
    v_mfma_f32_16x16x32_bf16 v[232:235], v[44:47], a[52:55], v[232:235]
    v_mfma_f32_16x16x32_bf16 v[236:239], v[44:47], a[124:127], v[236:239]
    s_waitcnt lgkmcnt(2)
    v_mfma_f32_16x16x32_bf16 v[208:211], v[48:51], v[120:123], v[208:211]
    ds_read_b128 v[40:43], v3 offset:16384
    ds_read_b128 v[44:47], v3 offset:34816
    v_mfma_f32_16x16x32_bf16 v[212:215], v[48:51], v[192:195], v[212:215]
    v_mfma_f32_16x16x32_bf16 v[216:219], v[52:55], v[120:123], v[216:219]
    v_add_u32 v24, s27, v1
    v_mfma_f32_16x16x32_bf16 v[220:223], v[52:55], v[192:195], v[220:223]
    v_mfma_f32_16x16x32_bf16 v[224:227], v[48:51], a[56:59], v[224:227]
    v_mfma_f32_16x16x32_bf16 v[228:231], v[48:51], a[128:131], v[228:231]
    v_mfma_f32_16x16x32_bf16 v[232:235], v[52:55], a[56:59], v[232:235]
    v_mfma_f32_16x16x32_bf16 v[236:239], v[52:55], a[128:131], v[236:239]
    s_waitcnt lgkmcnt(2)
    v_mfma_f32_16x16x32_bf16 v[208:211], v[32:35], v[124:127], v[208:211]
    ds_read_b128 v[48:51], v3 offset:17408
    ds_read_b128 v[52:55], v3 offset:35840
    v_mfma_f32_16x16x32_bf16 v[212:215], v[32:35], v[196:199], v[212:215]
    v_mfma_f32_16x16x32_bf16 v[216:219], v[36:39], v[124:127], v[216:219]
    v_mfma_f32_16x16x32_bf16 v[220:223], v[36:39], v[196:199], v[220:223]
    v_mfma_f32_16x16x32_bf16 v[224:227], v[32:35], a[60:63], v[224:227]
    v_mfma_f32_16x16x32_bf16 v[228:231], v[32:35], a[132:135], v[228:231]
    s_waitcnt vmcnt(9)
    s_barrier
    v_mfma_f32_16x16x32_bf16 v[232:235], v[36:39], a[60:63], v[232:235]
    v_mfma_f32_16x16x32_bf16 v[236:239], v[36:39], a[132:135], v[236:239]
    s_waitcnt lgkmcnt(2)
    v_mfma_f32_16x16x32_bf16 v[208:211], v[40:43], v[128:131], v[208:211]
    ds_read_b128 v[32:35], v24 offset:0
    ds_read_b128 v[36:39], v24 offset:18432
    v_mfma_f32_16x16x32_bf16 v[212:215], v[40:43], v[200:203], v[212:215]
    v_mfma_f32_16x16x32_bf16 v[216:219], v[44:47], v[128:131], v[216:219]
    v_mov_b32 v4, s30
    s_mov_b64 exec, s[34:35]
    buffer_store_dword v4, off, s[4:7], s29 sc1
    s_mov_b64 exec, -1
    v_mfma_f32_16x16x32_bf16 v[220:223], v[44:47], v[200:203], v[220:223]
    v_mfma_f32_16x16x32_bf16 v[224:227], v[40:43], a[64:67], v[224:227]
    v_mfma_f32_16x16x32_bf16 v[228:231], v[40:43], a[136:139], v[228:231]
    v_mfma_f32_16x16x32_bf16 v[232:235], v[44:47], a[64:67], v[232:235]
    v_mfma_f32_16x16x32_bf16 v[236:239], v[44:47], a[136:139], v[236:239]
    s_waitcnt lgkmcnt(2)
    v_mfma_f32_16x16x32_bf16 v[208:211], v[48:51], v[132:135], v[208:211]
    ds_read_b128 v[40:43], v24 offset:1024
    ds_read_b128 v[44:47], v24 offset:19456
    v_mfma_f32_16x16x32_bf16 v[212:215], v[48:51], v[204:207], v[212:215]
    v_mfma_f32_16x16x32_bf16 v[216:219], v[52:55], v[132:135], v[216:219]
    v_mfma_f32_16x16x32_bf16 v[220:223], v[52:55], v[204:207], v[220:223]
    v_mfma_f32_16x16x32_bf16 v[224:227], v[48:51], a[68:71], v[224:227]
    v_mfma_f32_16x16x32_bf16 v[228:231], v[48:51], a[140:143], v[228:231]
    v_mfma_f32_16x16x32_bf16 v[232:235], v[52:55], a[68:71], v[232:235]
    v_mfma_f32_16x16x32_bf16 v[236:239], v[52:55], a[140:143], v[236:239]
    v_mov_b32 v3, v24
    s_mov_b32 s31, s26
    s_add_u32 s26, s26, s41
    s_add_u32 s30, s30, 1
    s_add_u32 s19, s19, s20
    s_cmp_lt_u32 s19, 64
    s_cbranch_scc1 qk_vloop
    v_cvt_pk_bf16_f32 v8, v208, v209
    v_cvt_pk_bf16_f32 v9, v210, v211
    v_cvt_pk_bf16_f32 v12, v212, v213
    v_cvt_pk_bf16_f32 v13, v214, v215
    v_cvt_pk_bf16_f32 v10, v216, v217
    v_cvt_pk_bf16_f32 v11, v218, v219
    v_cvt_pk_bf16_f32 v14, v220, v221
    v_cvt_pk_bf16_f32 v15, v222, v223
    v_cvt_pk_bf16_f32 v16, v224, v225
    v_cvt_pk_bf16_f32 v17, v226, v227
    v_cvt_pk_bf16_f32 v20, v228, v229
    v_cvt_pk_bf16_f32 v21, v230, v231
    v_cvt_pk_bf16_f32 v18, v232, v233
    v_cvt_pk_bf16_f32 v19, v234, v235
    v_cvt_pk_bf16_f32 v22, v236, v237
    v_cvt_pk_bf16_f32 v23, v238, v239
qk_done:
    s_mov_b32 s28, s31
    buffer_store_dwordx4 v[8:11], v7, s[4:7], s28 offen sc1
    s_add_u32 s28, s28, s40
    buffer_store_dwordx4 v[12:15], v7, s[4:7], s28 offen sc1
    s_add_u32 s28, s31, s43
    buffer_store_dwordx4 v[16:19], v7, s[4:7], s28 offen sc1
    s_add_u32 s28, s28, s40
    buffer_store_dwordx4 v[20:23], v7, s[4:7], s28 offen sc1
    s_waitcnt vmcnt(0) lgkmcnt(0)
    s_barrier
    s_add_u32 s22, s95, 63
    v_mov_b32 v4, s22
    s_mov_b64 exec, s[34:35]
    buffer_store_dword v4, off, s[4:7], s29 sc1
    s_mov_b64 exec, -1
    s_cmp_eq_u32 s16, 0
    s_cbranch_scc1 qk_nq
    s_add_u32 s29, s29, 4096
    v_mov_b32 v4, s22
    s_mov_b64 exec, s[34:35]
    buffer_store_dword v4, off, s[4:7], s29 sc1
    s_mov_b64 exec, -1
qk_nq:
    s_cmp_ge_u32 s36, 64
    s_cbranch_scc1 L_qkv_next
    s_cmp_lt_u32 s36, 32
    s_cbranch_scc1 L_exit
    v_and_b32 v4, 63, v0
    v_lshrrev_b32 v5, 4, v4
    v_bfe_u32 v240, v4, 3, 1
    v_lshlrev_b32 v243, 17, v240
    v_mul_u32_u24 v240, 12288, v240
    v_add_u32 v1, 0, v5
    v_mul_u32_u24 v6, 11, v1
    v_lshrrev_b32 v6, 5, v6
    v_add_u32 v1, v1, v6
    v_lshlrev_b32 v1, 7, v1
    v_and_b32 v6, 7, v4
    v_lshl_add_u32 v1, v6, 4, v1
    v_add_u32 v1, v1, v240
    v_add_u32 v2, 4, v5
    v_mul_u32_u24 v6, 11, v2
    v_lshrrev_b32 v6, 5, v6
    v_add_u32 v2, v2, v6
    v_lshlrev_b32 v2, 7, v2
    v_and_b32 v6, 7, v4
    v_lshl_add_u32 v2, v6, 4, v2
    v_add_u32 v2, v2, v240
    v_add_u32 v3, 8, v5
    v_mul_u32_u24 v6, 11, v3
    v_lshrrev_b32 v6, 5, v6
    v_add_u32 v3, v3, v6
    v_lshlrev_b32 v3, 7, v3
    v_and_b32 v6, 7, v4
    v_lshl_add_u32 v3, v6, 4, v3
    v_add_u32 v3, v3, v240
    v_min_u32 v6, 23, v4
    v_lshlrev_b32 v6, 9, v6
    v_or_b32 v241, 128, v7
    v_mov_b32 v242, v241
    s_cmp_lg_u32 s16, 2
    s_cbranch_scc1 mk_isk
    v_lshrrev_b32 v243, 5, v4
    v_lshlrev_b32 v243, 17, v243
    v_mov_b32 v241, v7
    v_xor_b32 v242, 512, v7
mk_isk:
    v_add_u32 v241, v241, v243
    v_add_u32 v242, v242, v243
    s_mov_b32 s19, 0
    s_mov_b32 s27, 2
    s_mov_b32 s24, 90177536
    s_lshl_b32 s26, s17, 12
    s_mov_b32 s21, 71303168
    s_cmp_eq_u32 s16, 2
    s_cselect_b32 s21, 80740352, s21
    s_add_u32 s26, s26, s21
    s_lshl_b32 s29, s17, 7
    s_lshl_b32 s21, s16, 3
    s_add_u32 s29, s29, s21
    s_add_u32 s29, s29, 125829240
mk_loop:
    s_cmp_lg_u32 s19, 58
    s_cbranch_scc1 mk_same
    s_mov_b32 s27, 1
    v_sub_u32 v1, v1, v240
    v_sub_u32 v2, v2, v240
    v_sub_u32 v3, v3, v240
    v_sub_u32 v241, v241, v243
    v_sub_u32 v242, v242, v243
mk_same:
    s_cmp_lg_u32 s18, 0
    s_cbranch_scc1 mk_go
    s_mul_i32 s23, s27, 12288
    s_add_u32 s23, s23, s24
    s_sub_u32 s23, s23, 12288
    s_mov_b32 s21, 4194304
mk_wait:
    buffer_load_dword v4, v6, s[4:7], s23 offen offset:384 sc1
    s_sub_u32 s21, s21, 1
    s_cbranch_scc1 mk_go
    s_waitcnt vmcnt(0)
    v_cmp_ne_u32 vcc, s95, v4
    s_cbranch_vccz mk_go
    s_sleep 4
    s_branch mk_wait
mk_go:
    s_barrier
    s_mov_b32 s30, 4096
mk_again:
    v_mov_b32 v5, 0
    s_add_u32 s23, s24, 0
    buffer_load_dwordx4 v[24:27], v1, s[4:7], s23 offen offset:0 sc1
    buffer_load_dwordx4 v[28:31], v2, s[4:7], s23 offen offset:0 sc1
    buffer_load_dwordx4 v[32:35], v3, s[4:7], s23 offen offset:0 sc1
    buffer_load_dwordx4 v[36:39], v1, s[4:7], s23 offen offset:2048 sc1
    buffer_load_dwordx4 v[40:43], v2, s[4:7], s23 offen offset:2048 sc1
    buffer_load_dwordx4 v[44:47], v3, s[4:7], s23 offen offset:2048 sc1
    s_add_u32 s23, s24, 4096
    buffer_load_dwordx4 v[48:51], v1, s[4:7], s23 offen offset:0 sc1
    buffer_load_dwordx4 v[52:55], v2, s[4:7], s23 offen offset:0 sc1
    buffer_load_dwordx4 v[56:59], v3, s[4:7], s23 offen offset:0 sc1
    buffer_load_dwordx4 v[60:63], v1, s[4:7], s23 offen offset:2048 sc1
    buffer_load_dwordx4 v[208:211], v2, s[4:7], s23 offen offset:2048 sc1
    buffer_load_dwordx4 v[212:215], v3, s[4:7], s23 offen offset:2048 sc1
    s_add_u32 s23, s24, 8192
    buffer_load_dwordx4 v[216:219], v1, s[4:7], s23 offen offset:0 sc1
    buffer_load_dwordx4 v[220:223], v2, s[4:7], s23 offen offset:0 sc1
    buffer_load_dwordx4 v[224:227], v3, s[4:7], s23 offen offset:0 sc1
    buffer_load_dwordx4 v[228:231], v1, s[4:7], s23 offen offset:2048 sc1
    buffer_load_dwordx4 v[232:235], v2, s[4:7], s23 offen offset:2048 sc1
    buffer_load_dwordx4 v[236:239], v3, s[4:7], s23 offen offset:2048 sc1
    s_cmp_eq_u32 s16, 2
    s_cbranch_scc1 mk_v
    s_waitcnt vmcnt(17)
    v_mfma_f32_16x16x32_bf16 v[8:11], v[64:67], v[24:27], 0
    v_mfma_f32_16x16x32_bf16 v[12:15], v[136:139], v[24:27], 0
    v_max3_u32 v5, v5, v24, v25
    v_mfma_f32_16x16x32_bf16 v[16:19], a[0:3], v[24:27], 0
    v_mfma_f32_16x16x32_bf16 v[20:23], a[72:75], v[24:27], 0
    v_max3_u32 v5, v5, v26, v27
    s_waitcnt vmcnt(16)
    v_mfma_f32_16x16x32_bf16 v[8:11], v[68:71], v[28:31], v[8:11]
    v_mfma_f32_16x16x32_bf16 v[12:15], v[140:143], v[28:31], v[12:15]
    v_max3_u32 v5, v5, v28, v29
    v_mfma_f32_16x16x32_bf16 v[16:19], a[4:7], v[28:31], v[16:19]
    v_mfma_f32_16x16x32_bf16 v[20:23], a[76:79], v[28:31], v[20:23]
    v_max3_u32 v5, v5, v30, v31
    s_waitcnt vmcnt(15)
    v_mfma_f32_16x16x32_bf16 v[8:11], v[72:75], v[32:35], v[8:11]
    v_mfma_f32_16x16x32_bf16 v[12:15], v[144:147], v[32:35], v[12:15]
    v_max3_u32 v5, v5, v32, v33
    v_mfma_f32_16x16x32_bf16 v[16:19], a[8:11], v[32:35], v[16:19]
    v_mfma_f32_16x16x32_bf16 v[20:23], a[80:83], v[32:35], v[20:23]
    v_max3_u32 v5, v5, v34, v35
    s_waitcnt vmcnt(14)
    v_mfma_f32_16x16x32_bf16 v[8:11], v[76:79], v[36:39], v[8:11]
    v_mfma_f32_16x16x32_bf16 v[12:15], v[148:151], v[36:39], v[12:15]
    v_max3_u32 v5, v5, v36, v37
    v_mfma_f32_16x16x32_bf16 v[16:19], a[12:15], v[36:39], v[16:19]
    v_mfma_f32_16x16x32_bf16 v[20:23], a[84:87], v[36:39], v[20:23]
    v_max3_u32 v5, v5, v38, v39
    s_waitcnt vmcnt(13)
    v_mfma_f32_16x16x32_bf16 v[8:11], v[80:83], v[40:43], v[8:11]
    v_mfma_f32_16x16x32_bf16 v[12:15], v[152:155], v[40:43], v[12:15]
    v_max3_u32 v5, v5, v40, v41
    v_mfma_f32_16x16x32_bf16 v[16:19], a[16:19], v[40:43], v[16:19]
    v_mfma_f32_16x16x32_bf16 v[20:23], a[88:91], v[40:43], v[20:23]
    v_max3_u32 v5, v5, v42, v43
    s_waitcnt vmcnt(12)
    v_mfma_f32_16x16x32_bf16 v[8:11], v[84:87], v[44:47], v[8:11]
    v_mfma_f32_16x16x32_bf16 v[12:15], v[156:159], v[44:47], v[12:15]
    v_max3_u32 v5, v5, v44, v45
    v_mfma_f32_16x16x32_bf16 v[16:19], a[20:23], v[44:47], v[16:19]
    v_mfma_f32_16x16x32_bf16 v[20:23], a[92:95], v[44:47], v[20:23]
    v_max3_u32 v5, v5, v46, v47
    s_waitcnt vmcnt(11)
    v_mfma_f32_16x16x32_bf16 v[8:11], v[88:91], v[48:51], v[8:11]
    v_mfma_f32_16x16x32_bf16 v[12:15], v[160:163], v[48:51], v[12:15]
    v_max3_u32 v5, v5, v48, v49
    v_mfma_f32_16x16x32_bf16 v[16:19], a[24:27], v[48:51], v[16:19]
    v_mfma_f32_16x16x32_bf16 v[20:23], a[96:99], v[48:51], v[20:23]
    v_max3_u32 v5, v5, v50, v51
    s_waitcnt vmcnt(10)
    v_mfma_f32_16x16x32_bf16 v[8:11], v[92:95], v[52:55], v[8:11]
    v_mfma_f32_16x16x32_bf16 v[12:15], v[164:167], v[52:55], v[12:15]
    v_max3_u32 v5, v5, v52, v53
    v_mfma_f32_16x16x32_bf16 v[16:19], a[28:31], v[52:55], v[16:19]
    v_mfma_f32_16x16x32_bf16 v[20:23], a[100:103], v[52:55], v[20:23]
    v_max3_u32 v5, v5, v54, v55
    s_waitcnt vmcnt(9)
    v_mfma_f32_16x16x32_bf16 v[8:11], v[96:99], v[56:59], v[8:11]
    v_mfma_f32_16x16x32_bf16 v[12:15], v[168:171], v[56:59], v[12:15]
    v_max3_u32 v5, v5, v56, v57
    v_mfma_f32_16x16x32_bf16 v[16:19], a[32:35], v[56:59], v[16:19]
    v_mfma_f32_16x16x32_bf16 v[20:23], a[104:107], v[56:59], v[20:23]
    v_max3_u32 v5, v5, v58, v59
    s_waitcnt vmcnt(8)
    v_mfma_f32_16x16x32_bf16 v[8:11], v[100:103], v[60:63], v[8:11]
    v_mfma_f32_16x16x32_bf16 v[12:15], v[172:175], v[60:63], v[12:15]
    v_max3_u32 v5, v5, v60, v61
    v_mfma_f32_16x16x32_bf16 v[16:19], a[36:39], v[60:63], v[16:19]
    v_mfma_f32_16x16x32_bf16 v[20:23], a[108:111], v[60:63], v[20:23]
    v_max3_u32 v5, v5, v62, v63
    s_waitcnt vmcnt(7)
    v_mfma_f32_16x16x32_bf16 v[8:11], v[104:107], v[208:211], v[8:11]
    v_mfma_f32_16x16x32_bf16 v[12:15], v[176:179], v[208:211], v[12:15]
    v_max3_u32 v5, v5, v208, v209
    v_mfma_f32_16x16x32_bf16 v[16:19], a[40:43], v[208:211], v[16:19]
    v_mfma_f32_16x16x32_bf16 v[20:23], a[112:115], v[208:211], v[20:23]
    v_max3_u32 v5, v5, v210, v211
    s_waitcnt vmcnt(6)
    v_mfma_f32_16x16x32_bf16 v[8:11], v[108:111], v[212:215], v[8:11]
    v_mfma_f32_16x16x32_bf16 v[12:15], v[180:183], v[212:215], v[12:15]
    v_max3_u32 v5, v5, v212, v213
    v_mfma_f32_16x16x32_bf16 v[16:19], a[44:47], v[212:215], v[16:19]
    v_mfma_f32_16x16x32_bf16 v[20:23], a[116:119], v[212:215], v[20:23]
    v_max3_u32 v5, v5, v214, v215
    s_waitcnt vmcnt(5)
    v_mfma_f32_16x16x32_bf16 v[8:11], v[112:115], v[216:219], v[8:11]
    v_mfma_f32_16x16x32_bf16 v[12:15], v[184:187], v[216:219], v[12:15]
    v_max3_u32 v5, v5, v216, v217
    v_mfma_f32_16x16x32_bf16 v[16:19], a[48:51], v[216:219], v[16:19]
    v_mfma_f32_16x16x32_bf16 v[20:23], a[120:123], v[216:219], v[20:23]
    v_max3_u32 v5, v5, v218, v219
    s_waitcnt vmcnt(4)
    v_mfma_f32_16x16x32_bf16 v[8:11], v[116:119], v[220:223], v[8:11]
    v_mfma_f32_16x16x32_bf16 v[12:15], v[188:191], v[220:223], v[12:15]
    v_max3_u32 v5, v5, v220, v221
    v_mfma_f32_16x16x32_bf16 v[16:19], a[52:55], v[220:223], v[16:19]
    v_mfma_f32_16x16x32_bf16 v[20:23], a[124:127], v[220:223], v[20:23]
    v_max3_u32 v5, v5, v222, v223
    s_waitcnt vmcnt(3)
    v_mfma_f32_16x16x32_bf16 v[8:11], v[120:123], v[224:227], v[8:11]
    v_mfma_f32_16x16x32_bf16 v[12:15], v[192:195], v[224:227], v[12:15]
    v_max3_u32 v5, v5, v224, v225
    v_mfma_f32_16x16x32_bf16 v[16:19], a[56:59], v[224:227], v[16:19]
    v_mfma_f32_16x16x32_bf16 v[20:23], a[128:131], v[224:227], v[20:23]
    v_max3_u32 v5, v5, v226, v227
    s_waitcnt vmcnt(2)
    v_mfma_f32_16x16x32_bf16 v[8:11], v[124:127], v[228:231], v[8:11]
    v_mfma_f32_16x16x32_bf16 v[12:15], v[196:199], v[228:231], v[12:15]
    v_max3_u32 v5, v5, v228, v229
    v_mfma_f32_16x16x32_bf16 v[16:19], a[60:63], v[228:231], v[16:19]
    v_mfma_f32_16x16x32_bf16 v[20:23], a[132:135], v[228:231], v[20:23]
    v_max3_u32 v5, v5, v230, v231
    s_waitcnt vmcnt(1)
    v_mfma_f32_16x16x32_bf16 v[8:11], v[128:131], v[232:235], v[8:11]
    v_mfma_f32_16x16x32_bf16 v[12:15], v[200:203], v[232:235], v[12:15]
    v_max3_u32 v5, v5, v232, v233
    v_mfma_f32_16x16x32_bf16 v[16:19], a[64:67], v[232:235], v[16:19]
    v_mfma_f32_16x16x32_bf16 v[20:23], a[136:139], v[232:235], v[20:23]
    v_max3_u32 v5, v5, v234, v235
    s_waitcnt vmcnt(0)
    v_mfma_f32_16x16x32_bf16 v[8:11], v[132:135], v[236:239], v[8:11]
    v_mfma_f32_16x16x32_bf16 v[12:15], v[204:207], v[236:239], v[12:15]
    v_max3_u32 v5, v5, v236, v237
    v_mfma_f32_16x16x32_bf16 v[16:19], a[68:71], v[236:239], v[16:19]
    v_mfma_f32_16x16x32_bf16 v[20:23], a[140:143], v[236:239], v[20:23]
    v_max3_u32 v5, v5, v238, v239
    s_nop 5
    s_branch mk_st
mk_v:
    s_waitcnt vmcnt(17)
    v_mfma_f32_16x16x32_bf16 v[8:11], v[24:27], v[64:67], 0
    v_mfma_f32_16x16x32_bf16 v[12:15], v[24:27], v[136:139], 0
    v_max3_u32 v5, v5, v24, v25
    v_mfma_f32_16x16x32_bf16 v[16:19], v[24:27], a[0:3], 0
    v_mfma_f32_16x16x32_bf16 v[20:23], v[24:27], a[72:75], 0
    v_max3_u32 v5, v5, v26, v27
    s_waitcnt vmcnt(16)
    v_mfma_f32_16x16x32_bf16 v[8:11], v[28:31], v[68:71], v[8:11]
    v_mfma_f32_16x16x32_bf16 v[12:15], v[28:31], v[140:143], v[12:15]
    v_max3_u32 v5, v5, v28, v29
    v_mfma_f32_16x16x32_bf16 v[16:19], v[28:31], a[4:7], v[16:19]
    v_mfma_f32_16x16x32_bf16 v[20:23], v[28:31], a[76:79], v[20:23]
    v_max3_u32 v5, v5, v30, v31
    s_waitcnt vmcnt(15)
    v_mfma_f32_16x16x32_bf16 v[8:11], v[32:35], v[72:75], v[8:11]
    v_mfma_f32_16x16x32_bf16 v[12:15], v[32:35], v[144:147], v[12:15]
    v_max3_u32 v5, v5, v32, v33
    v_mfma_f32_16x16x32_bf16 v[16:19], v[32:35], a[8:11], v[16:19]
    v_mfma_f32_16x16x32_bf16 v[20:23], v[32:35], a[80:83], v[20:23]
    v_max3_u32 v5, v5, v34, v35
    s_waitcnt vmcnt(14)
    v_mfma_f32_16x16x32_bf16 v[8:11], v[36:39], v[76:79], v[8:11]
    v_mfma_f32_16x16x32_bf16 v[12:15], v[36:39], v[148:151], v[12:15]
    v_max3_u32 v5, v5, v36, v37
    v_mfma_f32_16x16x32_bf16 v[16:19], v[36:39], a[12:15], v[16:19]
    v_mfma_f32_16x16x32_bf16 v[20:23], v[36:39], a[84:87], v[20:23]
    v_max3_u32 v5, v5, v38, v39
    s_waitcnt vmcnt(13)
    v_mfma_f32_16x16x32_bf16 v[8:11], v[40:43], v[80:83], v[8:11]
    v_mfma_f32_16x16x32_bf16 v[12:15], v[40:43], v[152:155], v[12:15]
    v_max3_u32 v5, v5, v40, v41
    v_mfma_f32_16x16x32_bf16 v[16:19], v[40:43], a[16:19], v[16:19]
    v_mfma_f32_16x16x32_bf16 v[20:23], v[40:43], a[88:91], v[20:23]
    v_max3_u32 v5, v5, v42, v43
    s_waitcnt vmcnt(12)
    v_mfma_f32_16x16x32_bf16 v[8:11], v[44:47], v[84:87], v[8:11]
    v_mfma_f32_16x16x32_bf16 v[12:15], v[44:47], v[156:159], v[12:15]
    v_max3_u32 v5, v5, v44, v45
    v_mfma_f32_16x16x32_bf16 v[16:19], v[44:47], a[20:23], v[16:19]
    v_mfma_f32_16x16x32_bf16 v[20:23], v[44:47], a[92:95], v[20:23]
    v_max3_u32 v5, v5, v46, v47
    s_waitcnt vmcnt(11)
    v_mfma_f32_16x16x32_bf16 v[8:11], v[48:51], v[88:91], v[8:11]
    v_mfma_f32_16x16x32_bf16 v[12:15], v[48:51], v[160:163], v[12:15]
    v_max3_u32 v5, v5, v48, v49
    v_mfma_f32_16x16x32_bf16 v[16:19], v[48:51], a[24:27], v[16:19]
    v_mfma_f32_16x16x32_bf16 v[20:23], v[48:51], a[96:99], v[20:23]
    v_max3_u32 v5, v5, v50, v51
    s_waitcnt vmcnt(10)
    v_mfma_f32_16x16x32_bf16 v[8:11], v[52:55], v[92:95], v[8:11]
    v_mfma_f32_16x16x32_bf16 v[12:15], v[52:55], v[164:167], v[12:15]
    v_max3_u32 v5, v5, v52, v53
    v_mfma_f32_16x16x32_bf16 v[16:19], v[52:55], a[28:31], v[16:19]
    v_mfma_f32_16x16x32_bf16 v[20:23], v[52:55], a[100:103], v[20:23]
    v_max3_u32 v5, v5, v54, v55
    s_waitcnt vmcnt(9)
    v_mfma_f32_16x16x32_bf16 v[8:11], v[56:59], v[96:99], v[8:11]
    v_mfma_f32_16x16x32_bf16 v[12:15], v[56:59], v[168:171], v[12:15]
    v_max3_u32 v5, v5, v56, v57
    v_mfma_f32_16x16x32_bf16 v[16:19], v[56:59], a[32:35], v[16:19]
    v_mfma_f32_16x16x32_bf16 v[20:23], v[56:59], a[104:107], v[20:23]
    v_max3_u32 v5, v5, v58, v59
    s_waitcnt vmcnt(8)
    v_mfma_f32_16x16x32_bf16 v[8:11], v[60:63], v[100:103], v[8:11]
    v_mfma_f32_16x16x32_bf16 v[12:15], v[60:63], v[172:175], v[12:15]
    v_max3_u32 v5, v5, v60, v61
    v_mfma_f32_16x16x32_bf16 v[16:19], v[60:63], a[36:39], v[16:19]
    v_mfma_f32_16x16x32_bf16 v[20:23], v[60:63], a[108:111], v[20:23]
    v_max3_u32 v5, v5, v62, v63
    s_waitcnt vmcnt(7)
    v_mfma_f32_16x16x32_bf16 v[8:11], v[208:211], v[104:107], v[8:11]
    v_mfma_f32_16x16x32_bf16 v[12:15], v[208:211], v[176:179], v[12:15]
    v_max3_u32 v5, v5, v208, v209
    v_mfma_f32_16x16x32_bf16 v[16:19], v[208:211], a[40:43], v[16:19]
    v_mfma_f32_16x16x32_bf16 v[20:23], v[208:211], a[112:115], v[20:23]
    v_max3_u32 v5, v5, v210, v211
    s_waitcnt vmcnt(6)
    v_mfma_f32_16x16x32_bf16 v[8:11], v[212:215], v[108:111], v[8:11]
    v_mfma_f32_16x16x32_bf16 v[12:15], v[212:215], v[180:183], v[12:15]
    v_max3_u32 v5, v5, v212, v213
    v_mfma_f32_16x16x32_bf16 v[16:19], v[212:215], a[44:47], v[16:19]
    v_mfma_f32_16x16x32_bf16 v[20:23], v[212:215], a[116:119], v[20:23]
    v_max3_u32 v5, v5, v214, v215
    s_waitcnt vmcnt(5)
    v_mfma_f32_16x16x32_bf16 v[8:11], v[216:219], v[112:115], v[8:11]
    v_mfma_f32_16x16x32_bf16 v[12:15], v[216:219], v[184:187], v[12:15]
    v_max3_u32 v5, v5, v216, v217
    v_mfma_f32_16x16x32_bf16 v[16:19], v[216:219], a[48:51], v[16:19]
    v_mfma_f32_16x16x32_bf16 v[20:23], v[216:219], a[120:123], v[20:23]
    v_max3_u32 v5, v5, v218, v219
    s_waitcnt vmcnt(4)
    v_mfma_f32_16x16x32_bf16 v[8:11], v[220:223], v[116:119], v[8:11]
    v_mfma_f32_16x16x32_bf16 v[12:15], v[220:223], v[188:191], v[12:15]
    v_max3_u32 v5, v5, v220, v221
    v_mfma_f32_16x16x32_bf16 v[16:19], v[220:223], a[52:55], v[16:19]
    v_mfma_f32_16x16x32_bf16 v[20:23], v[220:223], a[124:127], v[20:23]
    v_max3_u32 v5, v5, v222, v223
    s_waitcnt vmcnt(3)
    v_mfma_f32_16x16x32_bf16 v[8:11], v[224:227], v[120:123], v[8:11]
    v_mfma_f32_16x16x32_bf16 v[12:15], v[224:227], v[192:195], v[12:15]
    v_max3_u32 v5, v5, v224, v225
    v_mfma_f32_16x16x32_bf16 v[16:19], v[224:227], a[56:59], v[16:19]
    v_mfma_f32_16x16x32_bf16 v[20:23], v[224:227], a[128:131], v[20:23]
    v_max3_u32 v5, v5, v226, v227
    s_waitcnt vmcnt(2)
    v_mfma_f32_16x16x32_bf16 v[8:11], v[228:231], v[124:127], v[8:11]
    v_mfma_f32_16x16x32_bf16 v[12:15], v[228:231], v[196:199], v[12:15]
    v_max3_u32 v5, v5, v228, v229
    v_mfma_f32_16x16x32_bf16 v[16:19], v[228:231], a[60:63], v[16:19]
    v_mfma_f32_16x16x32_bf16 v[20:23], v[228:231], a[132:135], v[20:23]
    v_max3_u32 v5, v5, v230, v231
    s_waitcnt vmcnt(1)
    v_mfma_f32_16x16x32_bf16 v[8:11], v[232:235], v[128:131], v[8:11]
    v_mfma_f32_16x16x32_bf16 v[12:15], v[232:235], v[200:203], v[12:15]
    v_max3_u32 v5, v5, v232, v233
    v_mfma_f32_16x16x32_bf16 v[16:19], v[232:235], a[64:67], v[16:19]
    v_mfma_f32_16x16x32_bf16 v[20:23], v[232:235], a[136:139], v[20:23]
    v_max3_u32 v5, v5, v234, v235
    s_waitcnt vmcnt(0)
    v_mfma_f32_16x16x32_bf16 v[8:11], v[236:239], v[132:135], v[8:11]
    v_mfma_f32_16x16x32_bf16 v[12:15], v[236:239], v[204:207], v[12:15]
    v_max3_u32 v5, v5, v236, v237
    v_mfma_f32_16x16x32_bf16 v[16:19], v[236:239], a[68:71], v[16:19]
    v_mfma_f32_16x16x32_bf16 v[20:23], v[236:239], a[140:143], v[20:23]
    v_max3_u32 v5, v5, v238, v239
    v_pk_mul_f32 v[8:9], v[8:9], 0.5 op_sel_hi:[1,0]
    v_pk_mul_f32 v[10:11], v[10:11], 0.5 op_sel_hi:[1,0]
    v_pk_mul_f32 v[12:13], v[12:13], 0.5 op_sel_hi:[1,0]
    v_pk_mul_f32 v[14:15], v[14:15], 0.5 op_sel_hi:[1,0]
    v_pk_mul_f32 v[16:17], v[16:17], 0.5 op_sel_hi:[1,0]
    v_pk_mul_f32 v[18:19], v[18:19], 0.5 op_sel_hi:[1,0]
    v_pk_mul_f32 v[20:21], v[20:21], 0.5 op_sel_hi:[1,0]
    v_pk_mul_f32 v[22:23], v[22:23], 0.5 op_sel_hi:[1,0]
    s_nop 1
mk_st:
    v_cmp_eq_u32 vcc, -1, v5
    s_sub_u32 s30, s30, 1
    s_cbranch_scc1 mk_ok
    s_cbranch_vccnz mk_again
mk_ok:
    v_cvt_pk_bf16_f32 v24, v8, v9
    v_cvt_pk_bf16_f32 v25, v10, v11
    v_cvt_pk_bf16_f32 v26, v12, v13
    v_cvt_pk_bf16_f32 v27, v14, v15
    v_cvt_pk_bf16_f32 v28, v16, v17
    v_cvt_pk_bf16_f32 v29, v18, v19
    v_cvt_pk_bf16_f32 v30, v20, v21
    v_cvt_pk_bf16_f32 v31, v22, v23
    s_add_u32 s21, s26, 4096
    buffer_store_dwordx4 v[24:27], v241, s[4:7], s26 offen sc1
    buffer_store_dwordx4 v[28:31], v241, s[4:7], s21 offen sc1
    s_add_u32 s19, s19, s27
    s_cmp_eq_u32 s27, 1
    s_cbranch_scc1 mk_fl
    s_cmp_lg_u32 s16, 2
    s_cbranch_scc1 mk_wt
    buffer_store_dwordx4 v[24:27], v242, s[4:7], s26 offen sc1
    buffer_store_dwordx4 v[28:31], v242, s[4:7], s21 offen sc1
mk_wt:
    s_waitcnt vmcnt(0)
mk_fl:
    s_barrier
    s_add_u32 s22, s19, s95
    v_mov_b32 v4, s22
    s_mov_b64 exec, s[34:35]
    buffer_store_dword v4, off, s[4:7], s29 sc1
    s_mov_b64 exec, -1
    s_mul_i32 s21, s27, 12288
    s_add_u32 s24, s24, s21
    s_lshl_b32 s21, s27, 17
    s_add_u32 s26, s26, s21
    s_cmp_lt_u32 s19, 62
    s_cbranch_scc1 mk_loop
    s_endpgm
L_ssm_next:
    s_sub_u32 s33, s3, 4
    s_and_b32 s33, s33, 7
    s_cmp_ge_u32 s33, 6
    s_cbranch_scc1 L_sscan
L_stake:
    s_lshl_b32 s35, s33, 2
    s_add_u32 s35, s35, 96
    s_mov_b32 s37, s35
    v_mov_b32 v250, 1
    v_mov_b32 v251, 163832
    v_cmp_eq_u32 vcc, 0, v0
    s_nop 0
    s_and_saveexec_b64 s[38:39], vcc
    s_cbranch_execz tk8
    buffer_atomic_add v250, off, s[96:99], s37 sc0
    s_waitcnt vmcnt(0)
    ds_write_b32 v251, v250
    s_waitcnt lgkmcnt(0)
tk8:
    s_mov_b64 exec, -1
    s_barrier
    ds_read_b32 v252, v251
    s_waitcnt lgkmcnt(0)
    v_readfirstlane_b32 s34, v252
    s_barrier
    s_nop 3
    s_mul_i32 s20, s33, 24
    s_add_u32 s20, s20, s34
    s_cmp_lt_u32 s34, 24
    s_cbranch_scc1 L_sjob
L_sscan:
    v_and_b32 v1, 63, v0
    v_min_u32 v1, 5, v1
    v_lshlrev_b32 v2, 2, v1
    s_cmp_lg_u32 s32, 0
    v_mov_b32 v251, 163832
    s_cbranch_scc1 sw9
    buffer_load_dword v3, v2, s[96:99], 0 offen offset:96 sc1
    v_mov_b32 v4, 24
    s_waitcnt vmcnt(0)
    v_cmp_lt_u32 vcc, v3, v4
    s_nop 0
    s_ff1_i32_b64 s40, vcc
    v_mov_b32 v250, s40
    ds_write_b32 v251, v250
    s_waitcnt lgkmcnt(0)
sw9:
    s_barrier
    ds_read_b32 v252, v251
    s_waitcnt lgkmcnt(0)
    v_readfirstlane_b32 s33, v252
    s_barrier
    s_nop 1
    s_cmp_lt_u32 s33, 7
    s_cbranch_scc1 L_stake
    s_branch L_phase2
L_sjob:
    s_lshl_b32 s20, s20, 2
    v_lshrrev_b32 v5, 6, v0
    s_nop 0
    v_readfirstlane_b32 s21, v5
    v_and_b32 v1, 63, v0
    v_and_b32 v2, 15, v1
    v_lshrrev_b32 v3, 4, v1
    v_lshlrev_b32 v4, 14, v5
    s_mov_b32 s8, s62
    s_mov_b32 s9, s63
    s_mov_b32 s10, 2359296
    s_mov_b32 s11, 0x20000
    s_mov_b32 s16, s76
    s_mov_b32 s17, s77
    s_mov_b32 s18, 4718592
    s_mov_b32 s19, 0x20000
    s_add_u32 s22, s20, s21
    s_lshl_b32 s23, s22, 8
    v_lshlrev_b32 v6, 3, v2
    v_lshl_add_u32 v6, v3, 1, v6
    s_mov_b32 s12, s64
    s_mov_b32 s13, s65
    s_mov_b32 s14, 147456
    s_mov_b32 s15, 0x20000
    buffer_load_ushort v24, v6, s[12:15], s23 offen offset:0
    buffer_load_ushort v28, v6, s[12:15], s23 offen offset:128
    s_mov_b32 s12, s66
    s_mov_b32 s13, s67
    s_mov_b32 s14, 147456
    s_mov_b32 s15, 0x20000
    buffer_load_ushort v25, v6, s[12:15], s23 offen offset:0
    buffer_load_ushort v29, v6, s[12:15], s23 offen offset:128
    s_mov_b32 s12, s68
    s_mov_b32 s13, s69
    s_mov_b32 s14, 147456
    s_mov_b32 s15, 0x20000
    buffer_load_ushort v26, v6, s[12:15], s23 offen offset:0
    buffer_load_ushort v30, v6, s[12:15], s23 offen offset:128
    s_mov_b32 s12, s70
    s_mov_b32 s13, s71
    s_mov_b32 s14, 147456
    s_mov_b32 s15, 0x20000
    buffer_load_ushort v27, v6, s[12:15], s23 offen offset:0
    buffer_load_ushort v31, v6, s[12:15], s23 offen offset:128
    s_mov_b32 s12, s72
    s_mov_b32 s13, s73
    s_mov_b32 s14, 1152
    s_mov_b32 s15, 0x20000
    s_lshl_b32 s23, s22, 1
    buffer_load_ushort v32, off, s[12:15], s23
    v_mul_u32_u24 v5, 9216, v0
    s_lshl_b32 s22, s20, 1
    s_add_u32 s23, s22, 0
    buffer_load_dwordx2 v[8:9], v5, s[8:11], s23 offen
    s_add_u32 s23, s22, 1152
    buffer_load_dwordx2 v[10:11], v5, s[8:11], s23 offen
    s_add_u32 s23, s22, 2304
    buffer_load_dwordx2 v[12:13], v5, s[8:11], s23 offen
    s_add_u32 s23, s22, 3456
    buffer_load_dwordx2 v[14:15], v5, s[8:11], s23 offen
    s_add_u32 s23, s22, 4608
    buffer_load_dwordx2 v[16:17], v5, s[8:11], s23 offen
    s_add_u32 s23, s22, 5760
    buffer_load_dwordx2 v[18:19], v5, s[8:11], s23 offen
    s_add_u32 s23, s22, 6912
    buffer_load_dwordx2 v[20:21], v5, s[8:11], s23 offen
    s_add_u32 s23, s22, 8064
    buffer_load_dwordx2 v[22:23], v5, s[8:11], s23 offen
    s_mov_b32 s26, 0x3fb8aa3b
    s_mov_b32 s27, 0x3e22f983
    v_mov_b32 v34, 0
    v_mov_b32 v35, 0
    v_lshl_add_u32 v6, v1, 3, v4
    ds_write_b64 v6, v[34:35] offset:0
    s_waitcnt vmcnt(8)
    v_lshlrev_b32 v32, 16, v32
    v_mul_f32 v32, s26, v32
    v_exp_f32 v32, v32
    s_nop 0
    v_cvt_pk_bf16_f32 v32, v32, v32
    v_and_b32 v32, 0xffff0000, v32
    v_add_f32 v33, v32, v32
    v_lshlrev_b32 v24, 16, v24
    v_mul_f32 v24, s26, v24
    v_exp_f32 v24, v24
    s_nop 0
    v_cvt_pk_bf16_f32 v24, v24, v24
    v_and_b32 v24, 0xffff0000, v24
    v_mul_f32 v24, v24, v32
    v_mul_f32 v24, s26, v24
    v_sub_f32 v24, 0, v24
    v_lshlrev_b32 v25, 16, v25
    v_mul_f32 v25, v25, v32
    v_mul_f32 v25, s27, v25
    v_lshlrev_b32 v26, 16, v26
    v_mul_f32 v26, v26, v33
    v_lshlrev_b32 v27, 16, v27
    v_mul_f32 v27, v27, v33
    v_lshlrev_b32 v28, 16, v28
    v_mul_f32 v28, s26, v28
    v_exp_f32 v28, v28
    s_nop 0
    v_cvt_pk_bf16_f32 v28, v28, v28
    v_and_b32 v28, 0xffff0000, v28
    v_mul_f32 v28, v28, v32
    v_mul_f32 v28, s26, v28
    v_sub_f32 v28, 0, v28
    v_lshlrev_b32 v29, 16, v29
    v_mul_f32 v29, v29, v32
    v_mul_f32 v29, s27, v29
    v_lshlrev_b32 v30, 16, v30
    v_mul_f32 v30, v30, v33
    v_lshlrev_b32 v31, 16, v31
    v_mul_f32 v31, v31, v33
    v_cvt_f32_u32 v47, v2
    v_mul_f32 v44, 0x41800000, v47
    v_and_b32 v5, 7, v2
    v_add_u32 v5, 8, v5
    v_cvt_f32_u32 v5, v5
    v_mul_f32 v45, 0x42000000, v5
    v_mul_f32 v6, 0x42800000, v5
    v_cmp_lt_u32 vcc, 7, v2
    s_nop 1
    v_cndmask_b32 v45, v45, v6, vcc
    v_add_f32 v5, 0x41000000, v47
    v_mul_f32 v46, 0x43000000, v5
    v_mov_b32 v48, 0
    v_mov_b32 v49, 0
    v_mov_b32 v50, 0
    v_mov_b32 v51, 0
    v_mov_b32 v52, 0
    v_mov_b32 v53, 0
    v_mov_b32 v54, 0
    v_mov_b32 v55, 0
    v_mov_b32 v56, 0
    v_mov_b32 v57, 0
    v_mov_b32 v58, 0
    v_mov_b32 v59, 0
    v_mov_b32 v60, 0
    v_mov_b32 v61, 0
    v_mov_b32 v62, 0
    v_mov_b32 v63, 0
    s_mov_b32 s25, 8
    s_nop 0
ss_kg:
    v_mov_b32_dpp v64, v24 row_newbcast:0 row_mask:0xf bank_mask:0xf
    v_mov_b32_dpp v65, v25 row_newbcast:0 row_mask:0xf bank_mask:0xf
    v_mov_b32_dpp v66, v26 row_newbcast:0 row_mask:0xf bank_mask:0xf
    v_mov_b32_dpp v67, v27 row_newbcast:0 row_mask:0xf bank_mask:0xf
    v_mul_f32 v82, v64, v47
    v_mul_f32 v83, v65, v47
    v_mul_f32 v84, v64, v45
    v_mul_f32 v85, v65, v45
    v_exp_f32 v82, v82
    v_fract_f32 v83, v83
    v_exp_f32 v84, v84
    v_fract_f32 v85, v85
    v_cos_f32 v74, v83
    v_sin_f32 v75, v83
    v_cos_f32 v70, v85
    v_sin_f32 v71, v85
    v_mul_f32 v74, v74, v82
    v_mul_f32 v75, v75, v82
    v_mul_f32 v70, v70, v84
    v_mul_f32 v71, v71, v84
    v_mul_f32 v82, v75, v75
    v_add_f32 v83, v74, v74
    v_fma_f32 v76, v74, v74, -v82
    v_mul_f32 v77, v83, v75
    v_mul_f32 v82, v77, v77
    v_add_f32 v83, v76, v76
    v_fma_f32 v78, v76, v76, -v82
    v_mul_f32 v79, v83, v77
    v_mul_f32 v82, v79, v79
    v_add_f32 v83, v78, v78
    v_fma_f32 v80, v78, v78, -v82
    v_mul_f32 v81, v83, v79
    v_mul_f32 v82, v81, v81
    v_add_f32 v83, v80, v80
    v_fma_f32 v68, v80, v80, -v82
    v_mul_f32 v69, v83, v81
    v_mul_f32 v84, v71, v71
    v_add_f32 v85, v70, v70
    v_fma_f32 v86, v70, v70, -v84
    v_mul_f32 v87, v85, v71
    v_mul_f32 v84, v87, v87
    v_add_f32 v85, v86, v86
    v_fma_f32 v72, v86, v86, -v84
    v_mul_f32 v73, v85, v87
    v_cvt_pk_bf16_f32 v108, v74, v75
    v_cvt_pk_bf16_f32 v112, v76, v77
    v_cvt_pk_bf16_f32 v116, v78, v79
    v_cvt_pk_bf16_f32 v120, v80, v81
    v_mul_f32 v84, v67, v69
    v_mul_f32 v85, v67, v68
    v_fma_f32 v68, v66, v68, -v84
    v_fma_f32 v69, -v66, v69, -v85
    v_cvt_pk_bf16_f32 v96, v68, v69
    v_mul_f32 v84, v67, v71
    v_mul_f32 v85, v67, v70
    v_fma_f32 v70, v66, v70, -v84
    v_fma_f32 v71, -v66, v71, -v85
    v_cvt_pk_bf16_f32 v100, v70, v71
    v_mul_f32 v84, v67, v73
    v_mul_f32 v85, v67, v72
    v_fma_f32 v72, v66, v72, -v84
    v_fma_f32 v73, -v66, v73, -v85
    v_cvt_pk_bf16_f32 v104, v72, v73
    v_mov_b32_dpp v64, v28 row_newbcast:0 row_mask:0xf bank_mask:0xf
    v_mov_b32_dpp v65, v29 row_newbcast:0 row_mask:0xf bank_mask:0xf
    v_mov_b32_dpp v66, v30 row_newbcast:0 row_mask:0xf bank_mask:0xf
    v_mov_b32_dpp v67, v31 row_newbcast:0 row_mask:0xf bank_mask:0xf
    v_mul_f32 v82, v64, v47
    v_mul_f32 v83, v65, v47
    v_mul_f32 v84, v64, v45
    v_mul_f32 v85, v65, v45
    v_exp_f32 v82, v82
    v_fract_f32 v83, v83
    v_exp_f32 v84, v84
    v_fract_f32 v85, v85
    v_cos_f32 v74, v83
    v_sin_f32 v75, v83
    v_cos_f32 v70, v85
    v_sin_f32 v71, v85
    v_mul_f32 v74, v74, v82
    v_mul_f32 v75, v75, v82
    v_mul_f32 v70, v70, v84
    v_mul_f32 v71, v71, v84
    v_mul_f32 v82, v75, v75
    v_add_f32 v83, v74, v74
    v_fma_f32 v76, v74, v74, -v82
    v_mul_f32 v77, v83, v75
    v_mul_f32 v82, v77, v77
    v_add_f32 v83, v76, v76
    v_fma_f32 v78, v76, v76, -v82
    v_mul_f32 v79, v83, v77
    v_mul_f32 v82, v79, v79
    v_add_f32 v83, v78, v78
    v_fma_f32 v80, v78, v78, -v82
    v_mul_f32 v81, v83, v79
    v_mul_f32 v82, v81, v81
    v_add_f32 v83, v80, v80
    v_fma_f32 v68, v80, v80, -v82
    v_mul_f32 v69, v83, v81
    v_mul_f32 v84, v71, v71
    v_add_f32 v85, v70, v70
    v_fma_f32 v86, v70, v70, -v84
    v_mul_f32 v87, v85, v71
    v_mul_f32 v84, v87, v87
    v_add_f32 v85, v86, v86
    v_fma_f32 v72, v86, v86, -v84
    v_mul_f32 v73, v85, v87
    v_cvt_pk_bf16_f32 v109, v74, v75
    v_cvt_pk_bf16_f32 v113, v76, v77
    v_cvt_pk_bf16_f32 v117, v78, v79
    v_cvt_pk_bf16_f32 v121, v80, v81
    v_mul_f32 v84, v67, v69
    v_mul_f32 v85, v67, v68
    v_fma_f32 v68, v66, v68, -v84
    v_fma_f32 v69, -v66, v69, -v85
    v_cvt_pk_bf16_f32 v97, v68, v69
    v_mul_f32 v84, v67, v71
    v_mul_f32 v85, v67, v70
    v_fma_f32 v70, v66, v70, -v84
    v_fma_f32 v71, -v66, v71, -v85
    v_cvt_pk_bf16_f32 v101, v70, v71
    v_mul_f32 v84, v67, v73
    v_mul_f32 v85, v67, v72
    v_fma_f32 v72, v66, v72, -v84
    v_fma_f32 v73, -v66, v73, -v85
    v_cvt_pk_bf16_f32 v105, v72, v73
    v_mov_b32_dpp v64, v24 row_newbcast:1 row_mask:0xf bank_mask:0xf
    v_mov_b32_dpp v65, v25 row_newbcast:1 row_mask:0xf bank_mask:0xf
    v_mov_b32_dpp v66, v26 row_newbcast:1 row_mask:0xf bank_mask:0xf
    v_mov_b32_dpp v67, v27 row_newbcast:1 row_mask:0xf bank_mask:0xf
    v_mul_f32 v82, v64, v47
    v_mul_f32 v83, v65, v47
    v_mul_f32 v84, v64, v45
    v_mul_f32 v85, v65, v45
    v_exp_f32 v82, v82
    v_fract_f32 v83, v83
    v_exp_f32 v84, v84
    v_fract_f32 v85, v85
    v_cos_f32 v74, v83
    v_sin_f32 v75, v83
    v_cos_f32 v70, v85
    v_sin_f32 v71, v85
    v_mov_b32_dpp v24, v24 row_ror:2 row_mask:0xf bank_mask:0xf
    v_mov_b32_dpp v25, v25 row_ror:2 row_mask:0xf bank_mask:0xf
    v_mov_b32_dpp v26, v26 row_ror:2 row_mask:0xf bank_mask:0xf
    v_mov_b32_dpp v27, v27 row_ror:2 row_mask:0xf bank_mask:0xf
    v_mul_f32 v74, v74, v82
    v_mul_f32 v75, v75, v82
    v_mul_f32 v70, v70, v84
    v_mul_f32 v71, v71, v84
    v_mul_f32 v82, v75, v75
    v_add_f32 v83, v74, v74
    v_fma_f32 v76, v74, v74, -v82
    v_mul_f32 v77, v83, v75
    v_mul_f32 v82, v77, v77
    v_add_f32 v83, v76, v76
    v_fma_f32 v78, v76, v76, -v82
    v_mul_f32 v79, v83, v77
    v_mul_f32 v82, v79, v79
    v_add_f32 v83, v78, v78
    v_fma_f32 v80, v78, v78, -v82
    v_mul_f32 v81, v83, v79
    v_mul_f32 v82, v81, v81
    v_add_f32 v83, v80, v80
    v_fma_f32 v68, v80, v80, -v82
    v_mul_f32 v69, v83, v81
    v_mul_f32 v84, v71, v71
    v_add_f32 v85, v70, v70
    v_fma_f32 v86, v70, v70, -v84
    v_mul_f32 v87, v85, v71
    v_mul_f32 v84, v87, v87
    v_add_f32 v85, v86, v86
    v_fma_f32 v72, v86, v86, -v84
    v_mul_f32 v73, v85, v87
    v_cvt_pk_bf16_f32 v110, v74, v75
    v_cvt_pk_bf16_f32 v114, v76, v77
    v_cvt_pk_bf16_f32 v118, v78, v79
    v_cvt_pk_bf16_f32 v122, v80, v81
    v_mul_f32 v84, v67, v69
    v_mul_f32 v85, v67, v68
    v_fma_f32 v68, v66, v68, -v84
    v_fma_f32 v69, -v66, v69, -v85
    v_cvt_pk_bf16_f32 v98, v68, v69
    v_mul_f32 v84, v67, v71
    v_mul_f32 v85, v67, v70
    v_fma_f32 v70, v66, v70, -v84
    v_fma_f32 v71, -v66, v71, -v85
    v_cvt_pk_bf16_f32 v102, v70, v71
    v_mul_f32 v84, v67, v73
    v_mul_f32 v85, v67, v72
    v_fma_f32 v72, v66, v72, -v84
    v_fma_f32 v73, -v66, v73, -v85
    v_cvt_pk_bf16_f32 v106, v72, v73
    v_mov_b32_dpp v64, v28 row_newbcast:1 row_mask:0xf bank_mask:0xf
    v_mov_b32_dpp v65, v29 row_newbcast:1 row_mask:0xf bank_mask:0xf
    v_mov_b32_dpp v66, v30 row_newbcast:1 row_mask:0xf bank_mask:0xf
    v_mov_b32_dpp v67, v31 row_newbcast:1 row_mask:0xf bank_mask:0xf
    v_mul_f32 v82, v64, v47
    v_mul_f32 v83, v65, v47
    v_mul_f32 v84, v64, v45
    v_mul_f32 v85, v65, v45
    v_exp_f32 v82, v82
    v_fract_f32 v83, v83
    v_exp_f32 v84, v84
    v_fract_f32 v85, v85
    v_cos_f32 v74, v83
    v_sin_f32 v75, v83
    v_cos_f32 v70, v85
    v_sin_f32 v71, v85
    v_mov_b32_dpp v28, v28 row_ror:2 row_mask:0xf bank_mask:0xf
    v_mov_b32_dpp v29, v29 row_ror:2 row_mask:0xf bank_mask:0xf
    v_mov_b32_dpp v30, v30 row_ror:2 row_mask:0xf bank_mask:0xf
    v_mov_b32_dpp v31, v31 row_ror:2 row_mask:0xf bank_mask:0xf
    v_mul_f32 v74, v74, v82
    v_mul_f32 v75, v75, v82
    v_mul_f32 v70, v70, v84
    v_mul_f32 v71, v71, v84
    v_mul_f32 v82, v75, v75
    v_add_f32 v83, v74, v74
    v_fma_f32 v76, v74, v74, -v82
    v_mul_f32 v77, v83, v75
    v_mul_f32 v82, v77, v77
    v_add_f32 v83, v76, v76
    v_fma_f32 v78, v76, v76, -v82
    v_mul_f32 v79, v83, v77
    v_mul_f32 v82, v79, v79
    v_add_f32 v83, v78, v78
    v_fma_f32 v80, v78, v78, -v82
    v_mul_f32 v81, v83, v79
    v_mul_f32 v82, v81, v81
    v_add_f32 v83, v80, v80
    v_fma_f32 v68, v80, v80, -v82
    v_mul_f32 v69, v83, v81
    v_mul_f32 v84, v71, v71
    v_add_f32 v85, v70, v70
    v_fma_f32 v86, v70, v70, -v84
    v_mul_f32 v87, v85, v71
    v_mul_f32 v84, v87, v87
    v_add_f32 v85, v86, v86
    v_fma_f32 v72, v86, v86, -v84
    v_mul_f32 v73, v85, v87
    v_cvt_pk_bf16_f32 v111, v74, v75
    v_cvt_pk_bf16_f32 v115, v76, v77
    v_cvt_pk_bf16_f32 v119, v78, v79
    v_cvt_pk_bf16_f32 v123, v80, v81
    v_mul_f32 v84, v67, v69
    v_mul_f32 v85, v67, v68
    v_fma_f32 v68, v66, v68, -v84
    v_fma_f32 v69, -v66, v69, -v85
    v_cvt_pk_bf16_f32 v99, v68, v69
    v_mul_f32 v84, v67, v71
    v_mul_f32 v85, v67, v70
    v_fma_f32 v70, v66, v70, -v84
    v_fma_f32 v71, -v66, v71, -v85
    v_cvt_pk_bf16_f32 v103, v70, v71
    v_mul_f32 v84, v67, v73
    v_mul_f32 v85, v67, v72
    v_fma_f32 v72, v66, v72, -v84
    v_fma_f32 v73, -v66, v73, -v85
    v_cvt_pk_bf16_f32 v107, v72, v73
    v_mfma_f32_16x16x32_bf16 v[48:51], v[96:99], v[108:111], v[48:51]
    v_mfma_f32_16x16x32_bf16 v[52:55], v[100:103], v[112:115], v[52:55]
    v_mfma_f32_16x16x32_bf16 v[56:59], v[100:103], v[116:119], v[56:59]
    v_mfma_f32_16x16x32_bf16 v[60:63], v[104:107], v[120:123], v[60:63]
    s_sub_u32 s25, s25, 1
    s_cmp_lg_u32 s25, 0
    s_cbranch_scc1 ss_kg
    s_waitcnt vmcnt(0)
    v_mov_b32 v36, 0x05040100
    v_mov_b32 v37, 0x07060302
    v_lshlrev_b32 v6, 4, v0
    v_perm_b32 v40, v10, v8, v36
    v_perm_b32 v41, v14, v12, v36
    v_perm_b32 v42, v18, v16, v36
    v_perm_b32 v43, v22, v20, v36
    ds_write_b128 v6, v[40:43] offset:512
    s_nop 1
    v_perm_b32 v40, v10, v8, v37
    v_perm_b32 v41, v14, v12, v37
    v_perm_b32 v42, v18, v16, v37
    v_perm_b32 v43, v22, v20, v37
    ds_write_b128 v6, v[40:43] offset:16896
    s_nop 1
    v_perm_b32 v40, v11, v9, v36
    v_perm_b32 v41, v15, v13, v36
    v_perm_b32 v42, v19, v17, v36
    v_perm_b32 v43, v23, v21, v36
    ds_write_b128 v6, v[40:43] offset:33280
    s_nop 1
    v_perm_b32 v40, v11, v9, v37
    v_perm_b32 v41, v15, v13, v37
    v_perm_b32 v42, v19, v17, v37
    v_perm_b32 v43, v23, v21, v37
    ds_write_b128 v6, v[40:43] offset:49664
    s_nop 1
    v_lshlrev_b32 v5, 8, v3
    v_lshl_add_u32 v5, v2, 2, v5
    v_add_u32 v5, v5, v4
    ds_write_b32 v5, v48 offset:4608
    ds_write_b32 v5, v49 offset:4672
    ds_write_b32 v5, v50 offset:4736
    ds_write_b32 v5, v51 offset:4800
    v_cmp_gt_u32 vcc, 2, v3
    s_nop 0
    s_mov_b64 exec, vcc
    ds_write_b32 v5, v52 offset:5632
    ds_write_b32 v5, v53 offset:5696
    ds_write_b32 v5, v54 offset:5760
    ds_write_b32 v5, v55 offset:5824
    ds_write_b32 v5, v60 offset:6656
    ds_write_b32 v5, v61 offset:6720
    ds_write_b32 v5, v62 offset:6784
    ds_write_b32 v5, v63 offset:6848
    s_not_b64 exec, exec
    ds_write_b32 v5, v56 offset:5632
    ds_write_b32 v5, v57 offset:5696
    ds_write_b32 v5, v58 offset:5760
    ds_write_b32 v5, v59 offset:5824
    s_mov_b32 exec_lo, 0
    s_mov_b32 exec_hi, 3
    v_cmp_eq_u32 vcc, 0, v2
    s_nop 1
    v_cndmask_b32 v6, 0, v60, vcc
    ds_write_b32 v5, v6 offset:6656
    s_mov_b64 exec, -1
    s_waitcnt lgkmcnt(0)
    v_lshlrev_b32 v7, 1, v1
    v_sub_u32 v7, 2065, v7
    v_lshl_add_u32 v64, v1, 2, v4
    v_mov_b32 v65, 641
    s_mov_b32 s25, 17
ss_exp:
    v_subrev_u32 v66, 0, v7
    v_cvt_f32_u32 v70, v66
    v_cvt_pk_bf16_f32 v70, v70, v70
    v_and_b32 v70, 0xffff, v70
    v_subrev_u32 v70, 0x4280, v70
    v_cmp_gt_u32 vcc, 256, v66
    s_nop 1
    v_cndmask_b32 v70, v70, v66, vcc
    v_cmp_gt_u32 vcc, 2048, v66
    s_nop 1
    v_cndmask_b32 v70, v65, v70, vcc
    v_lshl_add_u32 v70, v70, 2, v4
    ds_read_b32 v74, v70 offset:4608
    v_subrev_u32 v67, 1, v7
    v_cvt_f32_u32 v71, v67
    v_cvt_pk_bf16_f32 v71, v71, v71
    v_and_b32 v71, 0xffff, v71
    v_subrev_u32 v71, 0x4280, v71
    v_cmp_gt_u32 vcc, 256, v67
    s_nop 1
    v_cndmask_b32 v71, v71, v67, vcc
    v_cmp_gt_u32 vcc, 2048, v67
    s_nop 1
    v_cndmask_b32 v71, v65, v71, vcc
    v_lshl_add_u32 v71, v71, 2, v4
    ds_read_b32 v75, v71 offset:4608
    v_subrev_u32 v68, 2, v7
    v_cvt_f32_u32 v72, v68
    v_cvt_pk_bf16_f32 v72, v72, v72
    v_and_b32 v72, 0xffff, v72
    v_subrev_u32 v72, 0x4280, v72
    v_cmp_gt_u32 vcc, 256, v68
    s_nop 1
    v_cndmask_b32 v72, v72, v68, vcc
    v_cmp_gt_u32 vcc, 2048, v68
    s_nop 1
    v_cndmask_b32 v72, v65, v72, vcc
    v_lshl_add_u32 v72, v72, 2, v4
    ds_read_b32 v76, v72 offset:4608
    s_waitcnt lgkmcnt(0)
    v_cvt_pk_bf16_f32 v78, v75, v76
    v_cvt_pk_bf16_f32 v79, v74, v75
    ds_write_b32 v64, v78 offset:7424
    ds_write_b32 v64, v79 offset:11776
    v_subrev_u32 v7, 128, v7
    v_add_u32 v64, 256, v64
    s_sub_u32 s25, s25, 1
    s_cmp_lg_u32 s25, 0
    s_cbranch_scc1 ss_exp
    s_waitcnt lgkmcnt(0)
    s_barrier
    v_and_b32 v5, 1, v2
    v_mul_u32_u24 v64, 4352, v5
    v_sub_u32 v5, v5, v2
    v_lshl_add_u32 v5, v3, 3, v5
    v_lshl_add_u32 v64, v5, 1, v64
    v_add_u32 v64, 11520, v64
    v_add_u32 v64, v64, v4
    v_lshlrev_b32 v65, 5, v2
    v_lshl_add_u32 v65, v3, 4, v65
    v_add_u32 v65, 480, v65
    v_add_u32 v65, v65, v4
    v_mov_b32 v96, 0
    v_mov_b32 v97, 0
    v_mov_b32 v98, 0
    v_mov_b32 v99, 0
    v_mov_b32 v100, 0
    v_mov_b32 v101, 0
    v_mov_b32 v102, 0
    v_mov_b32 v103, 0
    v_mov_b32 v104, 0
    v_mov_b32 v105, 0
    v_mov_b32 v106, 0
    v_mov_b32 v107, 0
    v_mov_b32 v108, 0
    v_mov_b32 v109, 0
    v_mov_b32 v110, 0
    v_mov_b32 v111, 0
    v_mov_b32 v112, 0
    v_mov_b32 v113, 0
    v_mov_b32 v114, 0
    v_mov_b32 v115, 0
    v_mov_b32 v116, 0
    v_mov_b32 v117, 0
    v_mov_b32 v118, 0
    v_mov_b32 v119, 0
    v_mov_b32 v120, 0
    v_mov_b32 v121, 0
    v_mov_b32 v122, 0
    v_mov_b32 v123, 0
    v_mov_b32 v124, 0
    v_mov_b32 v125, 0
    v_mov_b32 v126, 0
    v_mov_b32 v127, 0
    v_subrev_u32 v66, 512, v64
    v_subrev_u32 v67, 1536, v64
    v_subrev_u32 v68, 2560, v64
    v_subrev_u32 v69, 3584, v64
    s_mov_b32 s25, 8
    s_nop 0
ss_cv:
    ds_read2_b32 v[160:161], v66 offset0:128 offset1:129
    ds_read2_b32 v[162:163], v66 offset0:130 offset1:131
    ds_read_b128 v[128:131], v65 offset:0
    ds_read_b128 v[132:135], v65 offset:512
    ds_read_b128 v[136:139], v65 offset:1024
    ds_read_b128 v[140:143], v65 offset:1536
    ds_read_b128 v[144:147], v65 offset:2048
    ds_read_b128 v[148:151], v65 offset:2560
    ds_read_b128 v[152:155], v65 offset:3072
    ds_read_b128 v[156:159], v65 offset:3584
    ds_read2_b32 v[164:165], v66 offset0:0 offset1:1
    ds_read2_b32 v[166:167], v66 offset0:2 offset1:3
    s_waitcnt lgkmcnt(9)
    v_mfma_f32_16x16x32_bf16 v[96:99], v[160:163], v[128:131], v[96:99]
    s_waitcnt lgkmcnt(8)
    v_mfma_f32_16x16x32_bf16 v[100:103], v[160:163], v[132:135], v[100:103]
    s_waitcnt lgkmcnt(7)
    v_mfma_f32_16x16x32_bf16 v[104:107], v[160:163], v[136:139], v[104:107]
    ds_read2_b32 v[168:169], v67 offset0:128 offset1:129
    ds_read2_b32 v[170:171], v67 offset0:130 offset1:131
    s_waitcnt lgkmcnt(8)
    v_mfma_f32_16x16x32_bf16 v[108:111], v[160:163], v[140:143], v[108:111]
    s_waitcnt lgkmcnt(7)
    v_mfma_f32_16x16x32_bf16 v[112:115], v[160:163], v[144:147], v[112:115]
    ds_read2_b32 v[172:173], v67 offset0:0 offset1:1
    ds_read2_b32 v[174:175], v67 offset0:2 offset1:3
    s_waitcnt lgkmcnt(8)
    v_mfma_f32_16x16x32_bf16 v[116:119], v[160:163], v[148:151], v[116:119]
    s_waitcnt lgkmcnt(7)
    v_mfma_f32_16x16x32_bf16 v[120:123], v[160:163], v[152:155], v[120:123]
    ds_read2_b32 v[176:177], v68 offset0:128 offset1:129
    ds_read2_b32 v[178:179], v68 offset0:130 offset1:131
    s_waitcnt lgkmcnt(8)
    v_mfma_f32_16x16x32_bf16 v[124:127], v[160:163], v[156:159], v[124:127]
    s_waitcnt lgkmcnt(6)
    v_mfma_f32_16x16x32_bf16 v[100:103], v[164:167], v[128:131], v[100:103]
    v_mfma_f32_16x16x32_bf16 v[104:107], v[164:167], v[132:135], v[104:107]
    ds_read2_b32 v[180:181], v68 offset0:0 offset1:1
    ds_read2_b32 v[182:183], v68 offset0:2 offset1:3
    v_mfma_f32_16x16x32_bf16 v[108:111], v[164:167], v[136:139], v[108:111]
    v_mfma_f32_16x16x32_bf16 v[112:115], v[164:167], v[140:143], v[112:115]
    ds_read2_b32 v[184:185], v69 offset0:128 offset1:129
    ds_read2_b32 v[186:187], v69 offset0:130 offset1:131
    v_mfma_f32_16x16x32_bf16 v[116:119], v[164:167], v[144:147], v[116:119]
    v_mfma_f32_16x16x32_bf16 v[120:123], v[164:167], v[148:151], v[120:123]
    ds_read2_b32 v[188:189], v69 offset0:0 offset1:1
    ds_read2_b32 v[190:191], v69 offset0:2 offset1:3
    v_mfma_f32_16x16x32_bf16 v[124:127], v[164:167], v[152:155], v[124:127]
    s_waitcnt lgkmcnt(10)
    v_mfma_f32_16x16x32_bf16 v[104:107], v[168:171], v[128:131], v[104:107]
    v_mfma_f32_16x16x32_bf16 v[108:111], v[168:171], v[132:135], v[108:111]
    v_mfma_f32_16x16x32_bf16 v[112:115], v[168:171], v[136:139], v[112:115]
    v_mfma_f32_16x16x32_bf16 v[116:119], v[168:171], v[140:143], v[116:119]
    v_mfma_f32_16x16x32_bf16 v[120:123], v[168:171], v[144:147], v[120:123]
    v_mfma_f32_16x16x32_bf16 v[124:127], v[168:171], v[148:151], v[124:127]
    s_waitcnt lgkmcnt(8)
    v_mfma_f32_16x16x32_bf16 v[108:111], v[172:175], v[128:131], v[108:111]
    v_subrev_u32 v66, 64, v66
    v_mfma_f32_16x16x32_bf16 v[112:115], v[172:175], v[132:135], v[112:115]
    v_subrev_u32 v67, 64, v67
    v_mfma_f32_16x16x32_bf16 v[116:119], v[172:175], v[136:139], v[116:119]
    v_subrev_u32 v68, 64, v68
    v_mfma_f32_16x16x32_bf16 v[120:123], v[172:175], v[140:143], v[120:123]
    v_subrev_u32 v69, 64, v69
    v_mfma_f32_16x16x32_bf16 v[124:127], v[172:175], v[144:147], v[124:127]
    v_subrev_u32 v65, 64, v65
    s_waitcnt lgkmcnt(6)
    v_mfma_f32_16x16x32_bf16 v[112:115], v[176:179], v[128:131], v[112:115]
    v_mfma_f32_16x16x32_bf16 v[116:119], v[176:179], v[132:135], v[116:119]
    v_mfma_f32_16x16x32_bf16 v[120:123], v[176:179], v[136:139], v[120:123]
    v_mfma_f32_16x16x32_bf16 v[124:127], v[176:179], v[140:143], v[124:127]
    s_waitcnt lgkmcnt(4)
    v_mfma_f32_16x16x32_bf16 v[116:119], v[180:183], v[128:131], v[116:119]
    v_mfma_f32_16x16x32_bf16 v[120:123], v[180:183], v[132:135], v[120:123]
    v_mfma_f32_16x16x32_bf16 v[124:127], v[180:183], v[136:139], v[124:127]
    s_waitcnt lgkmcnt(2)
    v_mfma_f32_16x16x32_bf16 v[120:123], v[184:187], v[128:131], v[120:123]
    v_mfma_f32_16x16x32_bf16 v[124:127], v[184:187], v[132:135], v[124:127]
    s_waitcnt lgkmcnt(0)
    v_mfma_f32_16x16x32_bf16 v[124:127], v[188:191], v[128:131], v[124:127]
    s_sub_u32 s25, s25, 1
    s_cmp_lg_u32 s25, 0
    s_cbranch_scc1 ss_cv
    s_nop 4
    v_lshlrev_b32 v5, 6, v2
    v_lshl_add_u32 v5, v3, 4, v5
    v_add_u32 v5, v5, v4
    ds_write_b128 v5, v[96:99] offset:7424
    ds_write_b128 v5, v[100:103] offset:8448
    ds_write_b128 v5, v[104:107] offset:9472
    ds_write_b128 v5, v[108:111] offset:10496
    ds_write_b128 v5, v[112:115] offset:11520
    ds_write_b128 v5, v[116:119] offset:12544
    ds_write_b128 v5, v[120:123] offset:13568
    ds_write_b128 v5, v[124:127] offset:14592
    s_mov_b32 s12, s74
    s_mov_b32 s13, s75
    s_mov_b32 s14, 1152
    s_mov_b32 s15, 0x20000
    s_lshl_b32 s23, s20, 1
    buffer_load_dwordx2 v[24:25], off, s[12:15], s23
    s_waitcnt vmcnt(0) lgkmcnt(0)
    s_barrier
    v_lshlrev_b32 v26, 16, v24
    v_and_b32 v27, 0xffff0000, v24
    v_lshlrev_b32 v28, 16, v25
    v_and_b32 v29, 0xffff0000, v25
    v_lshlrev_b32 v5, 5, v0
    ds_read_b128 v[64:67], v5 offset:7424
    ds_read_b128 v[68:71], v5 offset:7440
    ds_read_b128 v[72:75], v5 offset:23808
    ds_read_b128 v[76:79], v5 offset:23824
    ds_read_b128 v[80:83], v5 offset:40192
    ds_read_b128 v[84:87], v5 offset:40208
    ds_read_b128 v[88:91], v5 offset:56576
    ds_read_b128 v[92:95], v5 offset:56592
    s_waitcnt lgkmcnt(0)
    v_mul_u32_u24 v5, 18432, v0
    s_lshl_b32 s22, s20, 1
    s_add_u32 s22, s22, 1152
    v_lshlrev_b32 v6, 16, v8
    v_fmac_f32 v64, v6, v26
    v_and_b32 v6, 0xffff0000, v8
    v_fmac_f32 v72, v6, v27
    v_lshlrev_b32 v6, 16, v9
    v_fmac_f32 v80, v6, v28
    v_and_b32 v6, 0xffff0000, v9
    v_fmac_f32 v88, v6, v29
    v_cvt_pk_bf16_f32 v8, v64, v72
    v_cvt_pk_bf16_f32 v9, v80, v88
    s_add_u32 s23, s22, 0
    buffer_store_dwordx2 v[8:9], v5, s[16:19], s23 offen
    v_lshlrev_b32 v6, 16, v10
    v_fmac_f32 v65, v6, v26
    v_and_b32 v6, 0xffff0000, v10
    v_fmac_f32 v73, v6, v27
    v_lshlrev_b32 v6, 16, v11
    v_fmac_f32 v81, v6, v28
    v_and_b32 v6, 0xffff0000, v11
    v_fmac_f32 v89, v6, v29
    v_cvt_pk_bf16_f32 v10, v65, v73
    v_cvt_pk_bf16_f32 v11, v81, v89
    s_add_u32 s23, s22, 2304
    buffer_store_dwordx2 v[10:11], v5, s[16:19], s23 offen
    v_lshlrev_b32 v6, 16, v12
    v_fmac_f32 v66, v6, v26
    v_and_b32 v6, 0xffff0000, v12
    v_fmac_f32 v74, v6, v27
    v_lshlrev_b32 v6, 16, v13
    v_fmac_f32 v82, v6, v28
    v_and_b32 v6, 0xffff0000, v13
    v_fmac_f32 v90, v6, v29
    v_cvt_pk_bf16_f32 v12, v66, v74
    v_cvt_pk_bf16_f32 v13, v82, v90
    s_add_u32 s23, s22, 4608
    buffer_store_dwordx2 v[12:13], v5, s[16:19], s23 offen
    v_lshlrev_b32 v6, 16, v14
    v_fmac_f32 v67, v6, v26
    v_and_b32 v6, 0xffff0000, v14
    v_fmac_f32 v75, v6, v27
    v_lshlrev_b32 v6, 16, v15
    v_fmac_f32 v83, v6, v28
    v_and_b32 v6, 0xffff0000, v15
    v_fmac_f32 v91, v6, v29
    v_cvt_pk_bf16_f32 v14, v67, v75
    v_cvt_pk_bf16_f32 v15, v83, v91
    s_add_u32 s23, s22, 6912
    buffer_store_dwordx2 v[14:15], v5, s[16:19], s23 offen
    v_lshlrev_b32 v6, 16, v16
    v_fmac_f32 v68, v6, v26
    v_and_b32 v6, 0xffff0000, v16
    v_fmac_f32 v76, v6, v27
    v_lshlrev_b32 v6, 16, v17
    v_fmac_f32 v84, v6, v28
    v_and_b32 v6, 0xffff0000, v17
    v_fmac_f32 v92, v6, v29
    v_cvt_pk_bf16_f32 v16, v68, v76
    v_cvt_pk_bf16_f32 v17, v84, v92
    s_add_u32 s23, s22, 9216
    buffer_store_dwordx2 v[16:17], v5, s[16:19], s23 offen
    v_lshlrev_b32 v6, 16, v18
    v_fmac_f32 v69, v6, v26
    v_and_b32 v6, 0xffff0000, v18
    v_fmac_f32 v77, v6, v27
    v_lshlrev_b32 v6, 16, v19
    v_fmac_f32 v85, v6, v28
    v_and_b32 v6, 0xffff0000, v19
    v_fmac_f32 v93, v6, v29
    v_cvt_pk_bf16_f32 v18, v69, v77
    v_cvt_pk_bf16_f32 v19, v85, v93
    s_add_u32 s23, s22, 11520
    buffer_store_dwordx2 v[18:19], v5, s[16:19], s23 offen
    v_lshlrev_b32 v6, 16, v20
    v_fmac_f32 v70, v6, v26
    v_and_b32 v6, 0xffff0000, v20
    v_fmac_f32 v78, v6, v27
    v_lshlrev_b32 v6, 16, v21
    v_fmac_f32 v86, v6, v28
    v_and_b32 v6, 0xffff0000, v21
    v_fmac_f32 v94, v6, v29
    v_cvt_pk_bf16_f32 v20, v70, v78
    v_cvt_pk_bf16_f32 v21, v86, v94
    s_add_u32 s23, s22, 13824
    buffer_store_dwordx2 v[20:21], v5, s[16:19], s23 offen
    v_lshlrev_b32 v6, 16, v22
    v_fmac_f32 v71, v6, v26
    v_and_b32 v6, 0xffff0000, v22
    v_fmac_f32 v79, v6, v27
    v_lshlrev_b32 v6, 16, v23
    v_fmac_f32 v87, v6, v28
    v_and_b32 v6, 0xffff0000, v23
    v_fmac_f32 v95, v6, v29
    v_cvt_pk_bf16_f32 v22, v71, v79
    v_cvt_pk_bf16_f32 v23, v87, v95
    s_add_u32 s23, s22, 16128
    buffer_store_dwordx2 v[22:23], v5, s[16:19], s23 offen
    s_branch L_ssm_next
L_phase2:
    v_and_b32 v1, 63, v0
    v_min_u32 v1, 6, v1
    v_lshlrev_b32 v2, 2, v1
    s_cmp_lg_u32 s32, 0
    v_mov_b32 v251, 163832
    s_cbranch_scc1 sw10
    buffer_load_dword v3, v2, s[96:99], 0 offen offset:32 sc1
    v_mov_b32 v4, 32
    s_waitcnt vmcnt(0)
    v_cmp_lt_u32 vcc, v3, v4
    s_nop 0
    s_ff1_i32_b64 s40, vcc
    v_mov_b32 v250, s40
    ds_write_b32 v251, v250
    s_waitcnt lgkmcnt(0)
sw10:
    s_barrier
    ds_read_b32 v252, v251
    s_waitcnt lgkmcnt(0)
    v_readfirstlane_b32 s33, v252
    s_barrier
    s_nop 1
    s_cmp_lt_u32 s33, 7
    s_cbranch_scc1 L_pool
    s_mov_b32 s88, 4194304
gn11:
    s_cmp_lg_u32 s95, 0
    s_cbranch_scc1 gn11x
    buffer_load_dword v250, off, s[96:99], 0 offset:64 sc1
    s_sub_u32 s88, s88, 1
    s_cbranch_scc1 gn11x
    s_waitcnt vmcnt(0)
    v_readfirstlane_b32 s95, v250
    s_nop 1
    s_branch gn11
gn11x:
    s_mov_b32 s40, 524288
mc2_w:
    buffer_load_dword v250, off, s[96:99], 0 offset:140 sc1
    s_waitcnt vmcnt(0)
    v_readfirstlane_b32 s41, v250
    s_nop 0
    s_cmp_lg_u32 s41, 0
    s_cbranch_scc1 mc2_known
    s_sub_u32 s40, s40, 1
    s_cbranch_scc1 mc2_force
    s_sleep 2
    s_branch mc2_w
mc2_force:
    v_mov_b32 v250, 2
    v_mov_b32 v251, 0
    s_mov_b64 exec, 1
    buffer_atomic_cmpswap v[250:251], off, s[96:99], 0 offset:140
    s_mov_b64 exec, -1
    s_waitcnt vmcnt(0)
    s_mov_b32 s40, 524288
    s_branch mc2_w
mc2_known:
    s_cmp_eq_u32 s41, 1
    s_cbranch_scc1 L_phase2b
    s_mov_b32 s37, 208
    v_mov_b32 v250, 1
    v_mov_b32 v251, 163832
    v_cmp_eq_u32 vcc, 0, v0
    s_nop 0
    s_and_saveexec_b64 s[38:39], vcc
    s_cbranch_execz tk12
    buffer_atomic_add v250, off, s[96:99], s37 sc0
    s_waitcnt vmcnt(0)
    ds_write_b32 v251, v250
    s_waitcnt lgkmcnt(0)
tk12:
    s_mov_b64 exec, -1
    s_barrier
    ds_read_b32 v252, v251
    s_waitcnt lgkmcnt(0)
    v_readfirstlane_b32 s12, v252
    s_barrier
    s_nop 3
    s_cmp_lt_u32 s12, 32
    s_cbranch_scc1 L_chain_safe
L_phase2b:
    s_mov_b32 s47, 0
    s_mov_b32 s46, 0
    s_mov_b32 s8, s76
    s_mov_b32 s9, s77
    s_mov_b32 s10, 4718592
    s_mov_b32 s11, 0x20000
    s_sub_u32 s33, s3, 4
    s_and_b32 s33, s33, 7
    s_cmp_ge_u32 s33, 6
    s_cbranch_scc1 L_p2scan
L_p2take:
    s_lshl_b32 s35, s33, 2
    s_add_u32 s35, s35, 160
    s_mov_b32 s37, s35
    v_mov_b32 v250, 1
    v_mov_b32 v251, 163832
    v_cmp_eq_u32 vcc, 0, v0
    s_nop 0
    s_and_saveexec_b64 s[38:39], vcc
    s_cbranch_execz tk13
    buffer_atomic_add v250, off, s[96:99], s37 sc0
    s_waitcnt vmcnt(0)
    ds_write_b32 v251, v250
    s_waitcnt lgkmcnt(0)
tk13:
    s_mov_b64 exec, -1
    s_barrier
    ds_read_b32 v252, v251
    s_waitcnt lgkmcnt(0)
    v_readfirstlane_b32 s34, v252
    s_barrier
    s_nop 3
    s_cmp_lt_u32 s33, 4
    s_cselect_b32 s36, 9, 8
    s_cmp_lt_u32 s34, s36
    s_cbranch_scc1 L_att0
    s_sub_u32 s34, s34, s36
    s_cmp_ge_u32 s34, 18
    s_cbranch_scc1 L_p2scan
    s_branch L_op_start
    s_mul_i32 s36, s33, 3
    s_add_u32 s36, s36, s34
    s_sub_u32 s37, s34, 3
    s_cmp_lt_u32 s34, 3
    s_cselect_b32 s34, s36, s37
    s_cselect_b32 s33, 6, s33
    s_branch L_op_start
L_p2scan:
    v_and_b32 v1, 63, v0
    v_min_u32 v1, 5, v1
    v_lshlrev_b32 v2, 2, v1
    s_cmp_lg_u32 s32, 0
    v_mov_b32 v251, 163832
    s_cbranch_scc1 sw14
    buffer_load_dword v3, v2, s[96:99], 0 offen offset:160 sc1
    v_mov_b32 v4, 26
    v_cmp_gt_u32 vcc, 4, v1
    s_nop 1
    v_cndmask_b32 v4, v4, 27, vcc
    s_waitcnt vmcnt(0)
    v_cmp_lt_u32 vcc, v3, v4
    s_nop 0
    s_ff1_i32_b64 s40, vcc
    v_mov_b32 v250, s40
    ds_write_b32 v251, v250
    s_waitcnt lgkmcnt(0)
sw14:
    s_barrier
    ds_read_b32 v252, v251
    s_waitcnt lgkmcnt(0)
    v_readfirstlane_b32 s33, v252
    s_barrier
    s_nop 1
    s_cmp_lt_u32 s33, 7
    s_cbranch_scc1 L_p2take
    s_branch L_done
L_att0:
    s_mul_i32 s34, s34, 6
    s_add_u32 s34, s34, s33
    s_cmp_ge_u32 s34, 48
    s_cbranch_scc1 L_done
L_att_next:
    s_lshr_b32 s16, s34, 3
    s_and_b32 s17, s34, 7
    s_lshl_b32 s17, s17, 2
    s_add_u32 s17, s17, s32
    s_lshr_b32 s36, s17, 1
    s_lshl_b32 s36, s36, 8
    s_add_u32 s36, s36, 125829120
    s_mul_i32 s37, s16, 43
    s_lshr_b32 s37, s37, 8
    s_mul_i32 s41, s37, 6
    s_sub_u32 s41, s16, s41
    v_and_b32 v1, 63, v0
    v_mul_u32_u24 v2, 6, v1
    v_add_u32 v2, s41, v2
    v_mov_b32 v4, s37
    s_and_b32 s41, s16, 7
    s_add_u32 s41, s41, 12
    s_lshr_b32 s37, s16, 3
    v_mov_b32 v5, s41
    v_mov_b32 v6, s37
    v_cmp_lt_u32 vcc, 1, v1
    s_nop 1
    v_cndmask_b32 v2, v2, v5, vcc
    v_cndmask_b32 v4, v4, v6, vcc
    v_lshlrev_b32 v2, 2, v2
    v_add3_u32 v4, v4, s95, 1
    s_mov_b32 s40, 4194304
L_aw1:
    buffer_load_dword v3, v2, s[4:7], s36 offen sc1
    s_sub_u32 s40, s40, 1
    s_cbranch_scc1 L_aw1_go
    s_waitcnt vmcnt(0)
    v_subrev_u32 v3, v4, v3
    v_cmp_lt_u32 vcc, 64, v3
    s_cbranch_vccz L_aw1_go
    s_sleep 4
    s_branch L_aw1
L_aw1_go:
    v_and_b32 v5, 63, v0
    v_lshlrev_b32 v1, 4, v5
    v_or_b32 v3, 128, v1
    v_lshrrev_b32 v4, 4, v5
    v_bfe_u32 v6, v5, 2, 2
    v_sub_u32 v4, v6, v4
    v_lshlrev_b32 v4, 3, v4
    v_and_b32 v6, 3, v5
    v_add_u32 v4, v4, v6
    v_mov_b32 v6, 0xf149f2ca
    s_mov_b32 s22, 0x3e0293ee
    s_lshl_b32 s18, s16, 5
    s_add_u32 s18, s18, s17
    s_lshl_b32 s19, s18, 13
    s_add_u32 s20, s19, 33554432
    buffer_load_dwordx4 v[8:11], v1, s[4:7], s20 offen offset:0 sc1
    s_add_u32 s20, s19, 33554432
    buffer_load_dwordx4 v[12:15], v1, s[4:7], s20 offen offset:1024 sc1
    s_add_u32 s20, s19, 33554432
    buffer_load_dwordx4 v[16:19], v1, s[4:7], s20 offen offset:2048 sc1
    s_add_u32 s20, s19, 33554432
    buffer_load_dwordx4 v[20:23], v1, s[4:7], s20 offen offset:3072 sc1
    s_add_u32 s20, s19, 33558528
    buffer_load_dwordx4 v[24:27], v1, s[4:7], s20 offen offset:0 sc1
    s_add_u32 s20, s19, 33558528
    buffer_load_dwordx4 v[28:31], v1, s[4:7], s20 offen offset:1024 sc1
    s_add_u32 s20, s19, 33558528
    buffer_load_dwordx4 v[32:35], v1, s[4:7], s20 offen offset:2048 sc1
    s_add_u32 s20, s19, 33558528
    buffer_load_dwordx4 v[36:39], v1, s[4:7], s20 offen offset:3072 sc1
    s_lshl_b32 s21, s18, 14
    s_add_u32 s20, s21, 0
    buffer_load_dwordx4 v[40:43], v1, s[4:7], s20 offen offset:0 sc1
    s_add_u32 s20, s21, 4096
    buffer_load_dwordx4 v[44:47], v1, s[4:7], s20 offen offset:0 sc1
    s_add_u32 s20, s21, 8192
    buffer_load_dwordx4 v[48:51], v1, s[4:7], s20 offen offset:0 sc1
    s_add_u32 s20, s21, 12288
    buffer_load_dwordx4 v[52:55], v1, s[4:7], s20 offen offset:0 sc1
    s_add_u32 s20, s21, 0
    buffer_load_dwordx4 v[56:59], v1, s[4:7], s20 offen offset:1024 sc1
    s_add_u32 s20, s21, 4096
    buffer_load_dwordx4 v[60:63], v1, s[4:7], s20 offen offset:1024 sc1
    s_add_u32 s20, s21, 8192
    buffer_load_dwordx4 v[64:67], v1, s[4:7], s20 offen offset:1024 sc1
    s_add_u32 s20, s21, 12288
    buffer_load_dwordx4 v[68:71], v1, s[4:7], s20 offen offset:1024 sc1
    s_add_u32 s20, s21, 0
    buffer_load_dwordx4 v[88:91], v1, s[4:7], s20 offen offset:2048 sc1
    s_add_u32 s20, s21, 4096
    buffer_load_dwordx4 v[92:95], v1, s[4:7], s20 offen offset:2048 sc1
    s_add_u32 s20, s21, 8192
    buffer_load_dwordx4 v[96:99], v1, s[4:7], s20 offen offset:2048 sc1
    s_add_u32 s20, s21, 12288
    buffer_load_dwordx4 v[100:103], v1, s[4:7], s20 offen offset:2048 sc1
    s_add_u32 s20, s21, 0
    buffer_load_dwordx4 v[104:107], v1, s[4:7], s20 offen offset:3072 sc1
    s_add_u32 s20, s21, 4096
    buffer_load_dwordx4 v[108:111], v1, s[4:7], s20 offen offset:3072 sc1
    s_add_u32 s20, s21, 8192
    buffer_load_dwordx4 v[112:115], v1, s[4:7], s20 offen offset:3072 sc1
    s_add_u32 s20, s21, 12288
    buffer_load_dwordx4 v[116:119], v1, s[4:7], s20 offen offset:3072 sc1
    v_mov_b32 v172, 0x3f803f80
    v_mov_b32 v173, 0x3f803f80
    v_mov_b32 v174, 0x3f803f80
    v_mov_b32 v175, 0x3f803f80
    v_mov_b32 v176, 0x3f003f00
    v_mov_b32 v177, 0x3f003f00
    s_waitcnt vmcnt(8)
    v_mfma_f32_16x16x32_bf16 v[136:139], v[40:43], v[8:11], 0
    v_mfma_f32_16x16x32_bf16 v[140:143], v[56:59], v[8:11], 0
    v_mfma_f32_16x16x32_bf16 v[148:151], v[40:43], v[24:27], 0
    v_mfma_f32_16x16x32_bf16 v[152:155], v[56:59], v[24:27], 0
    v_mfma_f32_16x16x32_bf16 v[136:139], v[44:47], v[12:15], v[136:139]
    v_mfma_f32_16x16x32_bf16 v[140:143], v[60:63], v[12:15], v[140:143]
    v_mfma_f32_16x16x32_bf16 v[148:151], v[44:47], v[28:31], v[148:151]
    v_mfma_f32_16x16x32_bf16 v[152:155], v[60:63], v[28:31], v[152:155]
    v_mfma_f32_16x16x32_bf16 v[136:139], v[48:51], v[16:19], v[136:139]
    v_mfma_f32_16x16x32_bf16 v[140:143], v[64:67], v[16:19], v[140:143]
    v_mfma_f32_16x16x32_bf16 v[148:151], v[48:51], v[32:35], v[148:151]
    v_mfma_f32_16x16x32_bf16 v[152:155], v[64:67], v[32:35], v[152:155]
    v_mfma_f32_16x16x32_bf16 v[136:139], v[52:55], v[20:23], v[136:139]
    v_mfma_f32_16x16x32_bf16 v[140:143], v[68:71], v[20:23], v[140:143]
    v_mfma_f32_16x16x32_bf16 v[148:151], v[52:55], v[36:39], v[148:151]
    v_mfma_f32_16x16x32_bf16 v[152:155], v[68:71], v[36:39], v[152:155]
    v_cmp_le_i32 vcc, 0, v4
    s_nop 1
    v_cndmask_b32 v136, v6, v136, vcc
    v_cmp_le_i32 vcc, 1, v4
    s_nop 1
    v_cndmask_b32 v137, v6, v137, vcc
    v_cmp_le_i32 vcc, 2, v4
    s_nop 1
    v_cndmask_b32 v138, v6, v138, vcc
    v_cmp_le_i32 vcc, 3, v4
    s_nop 1
    v_cndmask_b32 v139, v6, v139, vcc
    v_cmp_le_i32 vcc, 4, v4
    s_nop 1
    v_cndmask_b32 v140, v6, v140, vcc
    v_cmp_le_i32 vcc, 5, v4
    s_nop 1
    v_cndmask_b32 v141, v6, v141, vcc
    v_cmp_le_i32 vcc, 6, v4
    s_nop 1
    v_cndmask_b32 v142, v6, v142, vcc
    v_cmp_le_i32 vcc, 7, v4
    s_nop 1
    v_cndmask_b32 v143, v6, v143, vcc
    v_cmp_le_i32 vcc, -4, v4
    s_nop 1
    v_cndmask_b32 v148, v6, v148, vcc
    v_cmp_le_i32 vcc, -3, v4
    s_nop 1
    v_cndmask_b32 v149, v6, v149, vcc
    v_cmp_le_i32 vcc, -2, v4
    s_nop 1
    v_cndmask_b32 v150, v6, v150, vcc
    v_cmp_le_i32 vcc, -1, v4
    s_nop 1
    v_cndmask_b32 v151, v6, v151, vcc
    v_cmp_le_i32 vcc, 0, v4
    s_nop 1
    v_cndmask_b32 v152, v6, v152, vcc
    v_cmp_le_i32 vcc, 1, v4
    s_nop 1
    v_cndmask_b32 v153, v6, v153, vcc
    v_cmp_le_i32 vcc, 2, v4
    s_nop 1
    v_cndmask_b32 v154, v6, v154, vcc
    v_cmp_le_i32 vcc, 3, v4
    s_nop 1
    v_cndmask_b32 v155, v6, v155, vcc
    v_max3_f32 v196, v136, v137, v138
    v_max3_f32 v196, v196, v139, v140
    v_max3_f32 v196, v196, v141, v142
    v_max_f32 v196, v196, v143
    v_mov_b32 v197, v196
    s_nop 1
    v_permlane32_swap_b32 v196, v197
    v_max_f32 v196, v196, v197
    v_mov_b32 v197, v196
    s_nop 1
    v_permlane16_swap_b32 v196, v197
    v_max_f32 v196, v196, v197
    v_mul_f32 v192, s22, v196
    v_fma_f32 v136, v136, s22, -v192
    v_fma_f32 v137, v137, s22, -v192
    v_fma_f32 v138, v138, s22, -v192
    v_fma_f32 v139, v139, s22, -v192
    v_fma_f32 v140, v140, s22, -v192
    v_fma_f32 v141, v141, s22, -v192
    v_fma_f32 v142, v142, s22, -v192
    v_fma_f32 v143, v143, s22, -v192
    v_exp_f32 v136, v136
    v_exp_f32 v137, v137
    v_exp_f32 v138, v138
    v_exp_f32 v139, v139
    v_exp_f32 v140, v140
    v_exp_f32 v141, v141
    v_exp_f32 v142, v142
    v_exp_f32 v143, v143
    v_cvt_pk_bf16_f32 v160, v136, v137
    v_cvt_pk_bf16_f32 v161, v138, v139
    v_cvt_pk_bf16_f32 v162, v140, v141
    v_cvt_pk_bf16_f32 v163, v142, v143
    v_max3_f32 v196, v148, v149, v150
    v_max3_f32 v196, v196, v151, v152
    v_max3_f32 v196, v196, v153, v154
    v_max_f32 v196, v196, v155
    v_mov_b32 v197, v196
    s_nop 1
    v_permlane32_swap_b32 v196, v197
    v_max_f32 v196, v196, v197
    v_mov_b32 v197, v196
    s_nop 1
    v_permlane16_swap_b32 v196, v197
    v_max_f32 v196, v196, v197
    v_mul_f32 v193, s22, v196
    v_fma_f32 v148, v148, s22, -v193
    v_fma_f32 v149, v149, s22, -v193
    v_fma_f32 v150, v150, s22, -v193
    v_fma_f32 v151, v151, s22, -v193
    v_fma_f32 v152, v152, s22, -v193
    v_fma_f32 v153, v153, s22, -v193
    v_fma_f32 v154, v154, s22, -v193
    v_fma_f32 v155, v155, s22, -v193
    v_exp_f32 v148, v148
    v_exp_f32 v149, v149
    v_exp_f32 v150, v150
    v_exp_f32 v151, v151
    v_exp_f32 v152, v152
    v_exp_f32 v153, v153
    v_exp_f32 v154, v154
    v_exp_f32 v155, v155
    v_cvt_pk_bf16_f32 v166, v148, v149
    v_cvt_pk_bf16_f32 v167, v150, v151
    v_cvt_pk_bf16_f32 v168, v152, v153
    v_cvt_pk_bf16_f32 v169, v154, v155
    v_mfma_f32_16x16x32_bf16 v[180:183], v[172:175], v[160:163], 0
    v_mfma_f32_16x16x32_bf16 v[184:187], v[172:175], v[166:169], 0
    s_waitcnt vmcnt(7)
    v_mfma_f32_16x16x32_bf16 v[40:43], v[88:91], v[160:163], 0
    s_waitcnt vmcnt(3)
    v_mfma_f32_16x16x32_bf16 v[44:47], v[104:107], v[160:163], 0
    v_mfma_f32_16x16x32_bf16 v[48:51], v[88:91], v[166:169], 0
    v_mfma_f32_16x16x32_bf16 v[52:55], v[104:107], v[166:169], 0
    v_mfma_f32_16x16x32_bf16 v[56:59], v[92:95], v[160:163], 0
    s_waitcnt vmcnt(2)
    v_mfma_f32_16x16x32_bf16 v[60:63], v[108:111], v[160:163], 0
    v_mfma_f32_16x16x32_bf16 v[64:67], v[92:95], v[166:169], 0
    v_mfma_f32_16x16x32_bf16 v[68:71], v[108:111], v[166:169], 0
    v_mfma_f32_16x16x32_bf16 v[200:203], v[96:99], v[160:163], 0
    s_waitcnt vmcnt(1)
    v_mfma_f32_16x16x32_bf16 v[204:207], v[112:115], v[160:163], 0
    v_mfma_f32_16x16x32_bf16 v[208:211], v[96:99], v[166:169], 0
    v_mfma_f32_16x16x32_bf16 v[212:215], v[112:115], v[166:169], 0
    v_mfma_f32_16x16x32_bf16 v[216:219], v[100:103], v[160:163], 0
    s_waitcnt vmcnt(0)
    v_mfma_f32_16x16x32_bf16 v[220:223], v[116:119], v[160:163], 0
    v_mfma_f32_16x16x32_bf16 v[224:227], v[100:103], v[166:169], 0
    v_mfma_f32_16x16x32_bf16 v[228:231], v[116:119], v[166:169], 0
    s_nop 7
    s_mov_b32 s88, 65536
    s_cmp_ge_u32 s47, s16
    s_cbranch_scc1 cw15x
cw15:
    buffer_load_dword v199, off, s[4:7], s36 offset:128 sc1
    s_waitcnt vmcnt(0)
    v_readfirstlane_b32 s42, v199
    s_nop 0
    s_sub_u32 s42, s42, s95
    s_cmp_gt_u32 s42, 64
    s_cselect_b32 s42, 0, s42
    s_add_u32 s42, s42, 2
    s_mov_b32 s47, s42
    s_cmp_ge_u32 s42, s16
    s_cbranch_scc1 cw15x
    s_sub_u32 s88, s88, 1
    s_cbranch_scc1 cw15x
    s_sub_u32 s42, s16, s42
    s_min_u32 s42, s42, 6
cw15s:
    s_sleep 24
    s_sub_u32 s42, s42, 1
    s_cmp_lg_u32 s42, 0
    s_cbranch_scc1 cw15s
    s_branch cw15
cw15x:
    s_add_u32 s37, s36, 128
    s_add_u32 s41, s16, s95
    s_add_u32 s41, s41, 1
    s_lshl_b32 s42, s17, 7
    s_add_u32 s42, s42, 125845504
    s_cmp_ge_u32 s16, 62
    s_cselect_b32 s37, s42, s37
    s_cselect_b32 s42, 12, 8
    v_lshlrev_b32 v198, 2, v0
    v_and_b32 v198, s42, v198
    s_mov_b32 s40, 4194304
L_aw2:
    buffer_load_dword v199, v198, s[4:7], s37 offen sc1
    s_sub_u32 s40, s40, 1
    s_cbranch_scc1 L_aw2_go
    s_waitcnt vmcnt(0)
    v_subrev_u32 v199, s41, v199
    v_cmp_lt_u32 vcc, 64, v199
    s_cbranch_vccz L_aw2_go
    s_sleep 1
    s_branch L_aw2
L_aw2_go:
    s_mov_b32 s21, 4096
at_again:
    s_lshl_b32 s20, s18, 12
    s_add_u32 s20, s20, 71303168
    buffer_load_dwordx4 v[72:75], v3, s[4:7], s20 offen offset:0 sc1
    buffer_load_dwordx4 v[76:79], v3, s[4:7], s20 offen offset:1024 sc1
    buffer_load_dwordx4 v[80:83], v3, s[4:7], s20 offen offset:2048 sc1
    buffer_load_dwordx4 v[84:87], v3, s[4:7], s20 offen offset:3072 sc1
    s_lshl_b32 s20, s18, 12
    s_add_u32 s20, s20, 80740352
    buffer_load_dwordx4 v[120:123], v1, s[4:7], s20 offen offset:0 sc1
    buffer_load_dwordx4 v[124:127], v1, s[4:7], s20 offen offset:1024 sc1
    buffer_load_dwordx4 v[128:131], v1, s[4:7], s20 offen offset:2048 sc1
    buffer_load_dwordx4 v[132:135], v1, s[4:7], s20 offen offset:3072 sc1
    s_waitcnt vmcnt(7)
    v_mfma_f32_16x16x32_bf16 v[144:147], v[72:75], v[8:11], 0
    v_mfma_f32_16x16x32_bf16 v[156:159], v[72:75], v[24:27], 0
    s_waitcnt vmcnt(6)
    v_mfma_f32_16x16x32_bf16 v[144:147], v[76:79], v[12:15], v[144:147]
    v_mfma_f32_16x16x32_bf16 v[156:159], v[76:79], v[28:31], v[156:159]
    s_waitcnt vmcnt(5)
    v_mfma_f32_16x16x32_bf16 v[144:147], v[80:83], v[16:19], v[144:147]
    v_mfma_f32_16x16x32_bf16 v[156:159], v[80:83], v[32:35], v[156:159]
    s_waitcnt vmcnt(4)
    v_mfma_f32_16x16x32_bf16 v[144:147], v[84:87], v[20:23], v[144:147]
    v_mfma_f32_16x16x32_bf16 v[156:159], v[84:87], v[36:39], v[156:159]
    v_max3_u32 v196, v72, v76, v80
    s_waitcnt vmcnt(0)
    v_max3_u32 v196, v196, v84, v120
    v_max3_u32 v196, v196, v124, v128
    v_max_u32 v196, v196, v132
    v_cmp_eq_u32 vcc, -1, v196
    s_sub_u32 s21, s21, 1
    s_nop 3
    s_cbranch_scc1 at_ok
    s_cbranch_vccnz at_again
at_ok:
    v_max3_f32 v196, v144, v145, v146
    v_max_f32 v196, v196, v147
    v_mov_b32 v197, v196
    s_nop 1
    v_permlane16_swap_b32 v196, v197
    v_max_f32 v196, v196, v197
    v_mul_f32 v196, s22, v196
    v_max_f32 v196, v196, v192
    v_sub_f32 v192, v192, v196
    v_fma_f32 v144, v144, s22, -v196
    v_fma_f32 v145, v145, s22, -v196
    v_fma_f32 v146, v146, s22, -v196
    v_fma_f32 v147, v147, s22, -v196
    v_exp_f32 v192, v192
    v_exp_f32 v144, v144
    v_exp_f32 v145, v145
    v_exp_f32 v146, v146
    v_exp_f32 v147, v147
    v_add_f32 v196, v144, v145
    v_add_f32 v197, v146, v147
    v_add_f32 v196, v196, v197
    v_mov_b32 v197, v196
    s_nop 1
    v_permlane16_swap_b32 v196, v197
    v_add_f32 v196, v196, v197
    v_fmac_f32 v196, v192, v180
    v_rcp_f32 v196, v196
    s_nop 0
    v_mul_f32 v144, v144, v196
    v_mul_f32 v145, v145, v196
    v_mul_f32 v146, v146, v196
    v_mul_f32 v147, v147, v196
    v_mul_f32 v192, v192, v196
    v_cvt_pk_bf16_f32 v164, v144, v145
    v_cvt_pk_bf16_f32 v165, v146, v147
    v_max3_f32 v196, v156, v157, v158
    v_max_f32 v196, v196, v159
    v_mov_b32 v197, v196
    s_nop 1
    v_permlane16_swap_b32 v196, v197
    v_max_f32 v196, v196, v197
    v_mul_f32 v196, s22, v196
    v_max_f32 v196, v196, v193
    v_sub_f32 v193, v193, v196
    v_fma_f32 v156, v156, s22, -v196
    v_fma_f32 v157, v157, s22, -v196
    v_fma_f32 v158, v158, s22, -v196
    v_fma_f32 v159, v159, s22, -v196
    v_exp_f32 v193, v193
    v_exp_f32 v156, v156
    v_exp_f32 v157, v157
    v_exp_f32 v158, v158
    v_exp_f32 v159, v159
    v_add_f32 v196, v156, v157
    v_add_f32 v197, v158, v159
    v_add_f32 v196, v196, v197
    v_mov_b32 v197, v196
    s_nop 1
    v_permlane16_swap_b32 v196, v197
    v_add_f32 v196, v196, v197
    v_fmac_f32 v196, v193, v184
    v_rcp_f32 v196, v196
    s_nop 0
    v_mul_f32 v156, v156, v196
    v_mul_f32 v157, v157, v196
    v_mul_f32 v158, v158, v196
    v_mul_f32 v159, v159, v196
    v_mul_f32 v193, v193, v196
    v_cvt_pk_bf16_f32 v170, v156, v157
    v_cvt_pk_bf16_f32 v171, v158, v159
    s_lshl_b32 s18, s16, 18
    s_lshl_b32 s19, s17, 12
    s_add_u32 s18, s18, s19
    s_add_u32 s18, s18, 50331648
    s_add_u32 s19, s18, 131072
    v_mul_f32 v40, v40, v192
    v_mul_f32 v41, v41, v192
    v_mul_f32 v42, v42, v192
    v_mul_f32 v43, v43, v192
    v_mul_f32 v44, v44, v192
    v_mul_f32 v45, v45, v192
    v_mul_f32 v46, v46, v192
    v_mul_f32 v47, v47, v192
    v_mfma_f32_16x16x16_bf16 v[40:43], v[120:121], v[164:165], v[40:43]
    v_mfma_f32_16x16x16_bf16 v[44:47], v[122:123], v[164:165], v[44:47]
    v_mul_f32 v48, v48, v193
    v_mul_f32 v49, v49, v193
    v_mul_f32 v50, v50, v193
    v_mul_f32 v51, v51, v193
    v_mul_f32 v52, v52, v193
    v_mul_f32 v53, v53, v193
    v_mul_f32 v54, v54, v193
    v_mul_f32 v55, v55, v193
    v_mfma_f32_16x16x16_bf16 v[48:51], v[120:121], v[170:171], v[48:51]
    v_mfma_f32_16x16x16_bf16 v[52:55], v[122:123], v[170:171], v[52:55]
    v_cvt_pk_bf16_f32 v40, v40, v41
    v_cvt_pk_bf16_f32 v41, v42, v43
    v_cvt_pk_bf16_f32 v42, v44, v45
    v_cvt_pk_bf16_f32 v43, v46, v47
    buffer_store_dwordx4 v[40:43], v1, s[4:7], s18 offen offset:0 sc1
    v_mul_f32 v56, v56, v192
    v_mul_f32 v57, v57, v192
    v_mul_f32 v58, v58, v192
    v_mul_f32 v59, v59, v192
    v_mul_f32 v60, v60, v192
    v_mul_f32 v61, v61, v192
    v_mul_f32 v62, v62, v192
    v_mul_f32 v63, v63, v192
    v_mfma_f32_16x16x16_bf16 v[56:59], v[124:125], v[164:165], v[56:59]
    v_mfma_f32_16x16x16_bf16 v[60:63], v[126:127], v[164:165], v[60:63]
    v_cvt_pk_bf16_f32 v48, v48, v49
    v_cvt_pk_bf16_f32 v49, v50, v51
    v_cvt_pk_bf16_f32 v50, v52, v53
    v_cvt_pk_bf16_f32 v51, v54, v55
    buffer_store_dwordx4 v[48:51], v1, s[4:7], s19 offen offset:0 sc1
    v_mul_f32 v64, v64, v193
    v_mul_f32 v65, v65, v193
    v_mul_f32 v66, v66, v193
    v_mul_f32 v67, v67, v193
    v_mul_f32 v68, v68, v193
    v_mul_f32 v69, v69, v193
    v_mul_f32 v70, v70, v193
    v_mul_f32 v71, v71, v193
    v_mfma_f32_16x16x16_bf16 v[64:67], v[124:125], v[170:171], v[64:67]
    v_mfma_f32_16x16x16_bf16 v[68:71], v[126:127], v[170:171], v[68:71]
    v_cvt_pk_bf16_f32 v56, v56, v57
    v_cvt_pk_bf16_f32 v57, v58, v59
    v_cvt_pk_bf16_f32 v58, v60, v61
    v_cvt_pk_bf16_f32 v59, v62, v63
    buffer_store_dwordx4 v[56:59], v1, s[4:7], s18 offen offset:1024 sc1
    v_mul_f32 v200, v200, v192
    v_mul_f32 v201, v201, v192
    v_mul_f32 v202, v202, v192
    v_mul_f32 v203, v203, v192
    v_mul_f32 v204, v204, v192
    v_mul_f32 v205, v205, v192
    v_mul_f32 v206, v206, v192
    v_mul_f32 v207, v207, v192
    v_mfma_f32_16x16x16_bf16 v[200:203], v[128:129], v[164:165], v[200:203]
    v_mfma_f32_16x16x16_bf16 v[204:207], v[130:131], v[164:165], v[204:207]
    v_cvt_pk_bf16_f32 v64, v64, v65
    v_cvt_pk_bf16_f32 v65, v66, v67
    v_cvt_pk_bf16_f32 v66, v68, v69
    v_cvt_pk_bf16_f32 v67, v70, v71
    buffer_store_dwordx4 v[64:67], v1, s[4:7], s19 offen offset:1024 sc1
    v_mul_f32 v208, v208, v193
    v_mul_f32 v209, v209, v193
    v_mul_f32 v210, v210, v193
    v_mul_f32 v211, v211, v193
    v_mul_f32 v212, v212, v193
    v_mul_f32 v213, v213, v193
    v_mul_f32 v214, v214, v193
    v_mul_f32 v215, v215, v193
    v_mfma_f32_16x16x16_bf16 v[208:211], v[128:129], v[170:171], v[208:211]
    v_mfma_f32_16x16x16_bf16 v[212:215], v[130:131], v[170:171], v[212:215]
    v_cvt_pk_bf16_f32 v200, v200, v201
    v_cvt_pk_bf16_f32 v201, v202, v203
    v_cvt_pk_bf16_f32 v202, v204, v205
    v_cvt_pk_bf16_f32 v203, v206, v207
    buffer_store_dwordx4 v[200:203], v1, s[4:7], s18 offen offset:2048 sc1
    v_mul_f32 v216, v216, v192
    v_mul_f32 v217, v217, v192
    v_mul_f32 v218, v218, v192
    v_mul_f32 v219, v219, v192
    v_mul_f32 v220, v220, v192
    v_mul_f32 v221, v221, v192
    v_mul_f32 v222, v222, v192
    v_mul_f32 v223, v223, v192
    v_mfma_f32_16x16x16_bf16 v[216:219], v[132:133], v[164:165], v[216:219]
    v_mfma_f32_16x16x16_bf16 v[220:223], v[134:135], v[164:165], v[220:223]
    v_cvt_pk_bf16_f32 v208, v208, v209
    v_cvt_pk_bf16_f32 v209, v210, v211
    v_cvt_pk_bf16_f32 v210, v212, v213
    v_cvt_pk_bf16_f32 v211, v214, v215
    buffer_store_dwordx4 v[208:211], v1, s[4:7], s19 offen offset:2048 sc1
    v_mul_f32 v224, v224, v193
    v_mul_f32 v225, v225, v193
    v_mul_f32 v226, v226, v193
    v_mul_f32 v227, v227, v193
    v_mul_f32 v228, v228, v193
    v_mul_f32 v229, v229, v193
    v_mul_f32 v230, v230, v193
    v_mul_f32 v231, v231, v193
    v_mfma_f32_16x16x16_bf16 v[224:227], v[132:133], v[170:171], v[224:227]
    v_mfma_f32_16x16x16_bf16 v[228:231], v[134:135], v[170:171], v[228:231]
    v_cvt_pk_bf16_f32 v216, v216, v217
    v_cvt_pk_bf16_f32 v217, v218, v219
    v_cvt_pk_bf16_f32 v218, v220, v221
    v_cvt_pk_bf16_f32 v219, v222, v223
    buffer_store_dwordx4 v[216:219], v1, s[4:7], s18 offen offset:3072 sc1
    v_cvt_pk_bf16_f32 v224, v224, v225
    v_cvt_pk_bf16_f32 v225, v226, v227
    v_cvt_pk_bf16_f32 v226, v228, v229
    v_cvt_pk_bf16_f32 v227, v230, v231
    buffer_store_dwordx4 v[224:227], v1, s[4:7], s19 offen offset:3072 sc1
    s_lshr_b32 s40, s34, 1
    s_lshl_b32 s40, s40, 7
    s_and_b32 s41, s17, 7
    s_lshl_b32 s41, s41, 2
    s_add_u32 s40, s40, s41
    s_add_u32 s40, s40, 125894656
    v_mov_b32 v250, s95
    s_cmp_ge_u32 s16, 58
    s_cbranch_scc1 L_afl
    s_waitcnt vmcnt(0)
L_afl:
    s_mov_b64 exec, 1
    buffer_store_dword v250, off, s[4:7], s40 sc1
    s_mov_b64 exec, -1
    s_add_u32 s34, s34, 48
    s_cmp_lt_u32 s34, 512
    s_cbranch_scc1 L_att_next
    s_branch L_done
L_op_start:
    s_mov_b32 s16, s33
    s_mov_b32 s33, s34
    v_and_b32 v2, 63, v0
    v_lshlrev_b32 v1, 4, v2
    v_lshrrev_b32 v5, 2, v2
    v_mul_u32_u24 v3, 1152, v5
    v_and_b32 v5, 3, v2
    v_lshl_add_u32 v3, v5, 4, v3
    s_lshl_b32 s21, s32, 12
    v_add_u32 v4, s21, v1
    s_mov_b64 s[12:13], s[58:59]
    s_mov_b32 s14, 4718592
    s_mov_b32 s15, 0x20000
    s_mul_i32 s19, s32, 1179648
    s_lshl_b32 s18, s33, 6
    s_add_u32 s19, s19, s18
    s_add_u32 s18, s19, 0
    s_add_u32 m0, s21, 0
    s_nop 0
    buffer_load_dwordx4 v3, s[12:15], s18 offen lds
    s_add_u32 m0, s21, 1024
    s_add_u32 s18, s18, 18432
    buffer_load_dwordx4 v3, s[12:15], s18 offen lds
    s_add_u32 m0, s21, 2048
    s_add_u32 s18, s18, 18432
    buffer_load_dwordx4 v3, s[12:15], s18 offen lds
    s_add_u32 m0, s21, 3072
    s_add_u32 s18, s18, 18432
    buffer_load_dwordx4 v3, s[12:15], s18 offen lds
    s_add_u32 s18, s19, 73728
    s_add_u32 m0, s21, 16384
    s_nop 0
    buffer_load_dwordx4 v3, s[12:15], s18 offen lds
    s_add_u32 m0, s21, 17408
    s_add_u32 s18, s18, 18432
    buffer_load_dwordx4 v3, s[12:15], s18 offen lds
    s_add_u32 m0, s21, 18432
    s_add_u32 s18, s18, 18432
    buffer_load_dwordx4 v3, s[12:15], s18 offen lds
    s_add_u32 m0, s21, 19456
    s_add_u32 s18, s18, 18432
    buffer_load_dwordx4 v3, s[12:15], s18 offen lds
    s_add_u32 s18, s19, 147456
    s_add_u32 m0, s21, 32768
    s_nop 0
    buffer_load_dwordx4 v3, s[12:15], s18 offen lds
    s_add_u32 m0, s21, 33792
    s_add_u32 s18, s18, 18432
    buffer_load_dwordx4 v3, s[12:15], s18 offen lds
    s_add_u32 m0, s21, 34816
    s_add_u32 s18, s18, 18432
    buffer_load_dwordx4 v3, s[12:15], s18 offen lds
    s_add_u32 m0, s21, 35840
    s_add_u32 s18, s18, 18432
    buffer_load_dwordx4 v3, s[12:15], s18 offen lds
    s_add_u32 s18, s19, 221184
    s_add_u32 m0, s21, 49152
    s_nop 0
    buffer_load_dwordx4 v3, s[12:15], s18 offen lds
    s_add_u32 m0, s21, 50176
    s_add_u32 s18, s18, 18432
    buffer_load_dwordx4 v3, s[12:15], s18 offen lds
    s_add_u32 m0, s21, 51200
    s_add_u32 s18, s18, 18432
    buffer_load_dwordx4 v3, s[12:15], s18 offen lds
    s_add_u32 m0, s21, 52224
    s_add_u32 s18, s18, 18432
    buffer_load_dwordx4 v3, s[12:15], s18 offen lds
    s_add_u32 s18, s19, 294912
    s_add_u32 m0, s21, 65536
    s_nop 0
    buffer_load_dwordx4 v3, s[12:15], s18 offen lds
    s_add_u32 m0, s21, 66560
    s_add_u32 s18, s18, 18432
    buffer_load_dwordx4 v3, s[12:15], s18 offen lds
    s_add_u32 m0, s21, 67584
    s_add_u32 s18, s18, 18432
    buffer_load_dwordx4 v3, s[12:15], s18 offen lds
    s_add_u32 m0, s21, 68608
    s_add_u32 s18, s18, 18432
    buffer_load_dwordx4 v3, s[12:15], s18 offen lds
    s_add_u32 s18, s19, 368640
    s_add_u32 m0, s21, 81920
    s_nop 0
    buffer_load_dwordx4 v3, s[12:15], s18 offen lds
    s_add_u32 m0, s21, 82944
    s_add_u32 s18, s18, 18432
    buffer_load_dwordx4 v3, s[12:15], s18 offen lds
    s_add_u32 m0, s21, 83968
    s_add_u32 s18, s18, 18432
    buffer_load_dwordx4 v3, s[12:15], s18 offen lds
    s_add_u32 m0, s21, 84992
    s_add_u32 s18, s18, 18432
    buffer_load_dwordx4 v3, s[12:15], s18 offen lds
    s_add_u32 s18, s19, 442368
    s_add_u32 m0, s21, 98304
    s_nop 0
    buffer_load_dwordx4 v3, s[12:15], s18 offen lds
    s_add_u32 m0, s21, 99328
    s_add_u32 s18, s18, 18432
    buffer_load_dwordx4 v3, s[12:15], s18 offen lds
    s_add_u32 m0, s21, 100352
    s_add_u32 s18, s18, 18432
    buffer_load_dwordx4 v3, s[12:15], s18 offen lds
    s_add_u32 m0, s21, 101376
    s_add_u32 s18, s18, 18432
    buffer_load_dwordx4 v3, s[12:15], s18 offen lds
    s_add_u32 s18, s19, 516096
    s_add_u32 m0, s21, 114688
    s_nop 0
    buffer_load_dwordx4 v3, s[12:15], s18 offen lds
    s_add_u32 m0, s21, 115712
    s_add_u32 s18, s18, 18432
    buffer_load_dwordx4 v3, s[12:15], s18 offen lds
    s_add_u32 m0, s21, 116736
    s_add_u32 s18, s18, 18432
    buffer_load_dwordx4 v3, s[12:15], s18 offen lds
    s_add_u32 m0, s21, 117760
    s_add_u32 s18, s18, 18432
    buffer_load_dwordx4 v3, s[12:15], s18 offen lds
    s_add_u32 s18, s19, 589824
    s_add_u32 m0, s21, 131072
    s_nop 0
    buffer_load_dwordx4 v3, s[12:15], s18 offen lds
    s_add_u32 m0, s21, 132096
    s_add_u32 s18, s18, 18432
    buffer_load_dwordx4 v3, s[12:15], s18 offen lds
    s_add_u32 m0, s21, 133120
    s_add_u32 s18, s18, 18432
    buffer_load_dwordx4 v3, s[12:15], s18 offen lds
    s_add_u32 m0, s21, 134144
    s_add_u32 s18, s18, 18432
    buffer_load_dwordx4 v3, s[12:15], s18 offen lds
    v_add_u32 v6, 0, v4
    v_xor_b32 v7, 32, v6
    s_waitcnt vmcnt(32)
    ds_read_b64_tr_b16 a[0:1], v6 offset:0
    ds_read_b64_tr_b16 a[2:3], v6 offset:1024
    ds_read_b64_tr_b16 a[4:5], v6 offset:8
    ds_read_b64_tr_b16 a[6:7], v6 offset:1032
    ds_read_b64_tr_b16 a[8:9], v6 offset:2048
    ds_read_b64_tr_b16 a[10:11], v6 offset:3072
    ds_read_b64_tr_b16 a[12:13], v6 offset:2056
    ds_read_b64_tr_b16 a[14:15], v6 offset:3080
    s_waitcnt lgkmcnt(0)
    s_add_u32 s18, s19, 663552
    s_add_u32 m0, s21, 0
    s_nop 0
    buffer_load_dwordx4 v3, s[12:15], s18 offen lds
    s_add_u32 m0, s21, 1024
    s_add_u32 s18, s18, 18432
    buffer_load_dwordx4 v3, s[12:15], s18 offen lds
    s_add_u32 m0, s21, 2048
    s_add_u32 s18, s18, 18432
    buffer_load_dwordx4 v3, s[12:15], s18 offen lds
    s_add_u32 m0, s21, 3072
    s_add_u32 s18, s18, 18432
    buffer_load_dwordx4 v3, s[12:15], s18 offen lds
    v_add_u32 v6, 16384, v4
    v_xor_b32 v7, 32, v6
    s_waitcnt vmcnt(32)
    ds_read_b64_tr_b16 a[16:17], v6 offset:0
    ds_read_b64_tr_b16 a[18:19], v6 offset:1024
    ds_read_b64_tr_b16 a[20:21], v6 offset:8
    ds_read_b64_tr_b16 a[22:23], v6 offset:1032
    ds_read_b64_tr_b16 a[24:25], v6 offset:2048
    ds_read_b64_tr_b16 a[26:27], v6 offset:3072
    ds_read_b64_tr_b16 a[28:29], v6 offset:2056
    ds_read_b64_tr_b16 a[30:31], v6 offset:3080
    s_waitcnt lgkmcnt(0)
    s_add_u32 s18, s19, 737280
    s_add_u32 m0, s21, 16384
    s_nop 0
    buffer_load_dwordx4 v3, s[12:15], s18 offen lds
    s_add_u32 m0, s21, 17408
    s_add_u32 s18, s18, 18432
    buffer_load_dwordx4 v3, s[12:15], s18 offen lds
    s_add_u32 m0, s21, 18432
    s_add_u32 s18, s18, 18432
    buffer_load_dwordx4 v3, s[12:15], s18 offen lds
    s_add_u32 m0, s21, 19456
    s_add_u32 s18, s18, 18432
    buffer_load_dwordx4 v3, s[12:15], s18 offen lds
    v_add_u32 v6, 32768, v4
    v_xor_b32 v7, 32, v6
    s_waitcnt vmcnt(32)
    ds_read_b64_tr_b16 a[32:33], v6 offset:0
    ds_read_b64_tr_b16 a[34:35], v6 offset:1024
    ds_read_b64_tr_b16 a[36:37], v6 offset:8
    ds_read_b64_tr_b16 a[38:39], v6 offset:1032
    ds_read_b64_tr_b16 a[40:41], v6 offset:2048
    ds_read_b64_tr_b16 a[42:43], v6 offset:3072
    ds_read_b64_tr_b16 a[44:45], v6 offset:2056
    ds_read_b64_tr_b16 a[46:47], v6 offset:3080
    s_waitcnt lgkmcnt(0)
    s_add_u32 s18, s19, 811008
    s_add_u32 m0, s21, 32768
    s_nop 0
    buffer_load_dwordx4 v3, s[12:15], s18 offen lds
    s_add_u32 m0, s21, 33792
    s_add_u32 s18, s18, 18432
    buffer_load_dwordx4 v3, s[12:15], s18 offen lds
    s_add_u32 m0, s21, 34816
    s_add_u32 s18, s18, 18432
    buffer_load_dwordx4 v3, s[12:15], s18 offen lds
    s_add_u32 m0, s21, 35840
    s_add_u32 s18, s18, 18432
    buffer_load_dwordx4 v3, s[12:15], s18 offen lds
    v_add_u32 v6, 49152, v4
    v_xor_b32 v7, 32, v6
    s_waitcnt vmcnt(32)
    ds_read_b64_tr_b16 a[48:49], v6 offset:0
    ds_read_b64_tr_b16 a[50:51], v6 offset:1024
    ds_read_b64_tr_b16 a[52:53], v6 offset:8
    ds_read_b64_tr_b16 a[54:55], v6 offset:1032
    ds_read_b64_tr_b16 a[56:57], v6 offset:2048
    ds_read_b64_tr_b16 a[58:59], v6 offset:3072
    ds_read_b64_tr_b16 a[60:61], v6 offset:2056
    ds_read_b64_tr_b16 a[62:63], v6 offset:3080
    s_waitcnt lgkmcnt(0)
    s_add_u32 s18, s19, 884736
    s_add_u32 m0, s21, 49152
    s_nop 0
    buffer_load_dwordx4 v3, s[12:15], s18 offen lds
    s_add_u32 m0, s21, 50176
    s_add_u32 s18, s18, 18432
    buffer_load_dwordx4 v3, s[12:15], s18 offen lds
    s_add_u32 m0, s21, 51200
    s_add_u32 s18, s18, 18432
    buffer_load_dwordx4 v3, s[12:15], s18 offen lds
    s_add_u32 m0, s21, 52224
    s_add_u32 s18, s18, 18432
    buffer_load_dwordx4 v3, s[12:15], s18 offen lds
    v_add_u32 v6, 65536, v4
    v_xor_b32 v7, 32, v6
    s_waitcnt vmcnt(32)
    ds_read_b64_tr_b16 a[64:65], v6 offset:0
    ds_read_b64_tr_b16 a[66:67], v6 offset:1024
    ds_read_b64_tr_b16 a[68:69], v6 offset:8
    ds_read_b64_tr_b16 a[70:71], v6 offset:1032
    ds_read_b64_tr_b16 a[72:73], v6 offset:2048
    ds_read_b64_tr_b16 a[74:75], v6 offset:3072
    ds_read_b64_tr_b16 a[76:77], v6 offset:2056
    ds_read_b64_tr_b16 a[78:79], v6 offset:3080
    s_waitcnt lgkmcnt(0)
    s_add_u32 s18, s19, 958464
    s_add_u32 m0, s21, 65536
    s_nop 0
    buffer_load_dwordx4 v3, s[12:15], s18 offen lds
    s_add_u32 m0, s21, 66560
    s_add_u32 s18, s18, 18432
    buffer_load_dwordx4 v3, s[12:15], s18 offen lds
    s_add_u32 m0, s21, 67584
    s_add_u32 s18, s18, 18432
    buffer_load_dwordx4 v3, s[12:15], s18 offen lds
    s_add_u32 m0, s21, 68608
    s_add_u32 s18, s18, 18432
    buffer_load_dwordx4 v3, s[12:15], s18 offen lds
    v_add_u32 v6, 81920, v4
    v_xor_b32 v7, 32, v6
    s_waitcnt vmcnt(32)
    ds_read_b64_tr_b16 a[80:81], v6 offset:0
    ds_read_b64_tr_b16 a[82:83], v6 offset:1024
    ds_read_b64_tr_b16 a[84:85], v6 offset:8
    ds_read_b64_tr_b16 a[86:87], v6 offset:1032
    ds_read_b64_tr_b16 a[88:89], v6 offset:2048
    ds_read_b64_tr_b16 a[90:91], v6 offset:3072
    ds_read_b64_tr_b16 a[92:93], v6 offset:2056
    ds_read_b64_tr_b16 a[94:95], v6 offset:3080
    s_waitcnt lgkmcnt(0)
    s_add_u32 s18, s19, 1032192
    s_add_u32 m0, s21, 81920
    s_nop 0
    buffer_load_dwordx4 v3, s[12:15], s18 offen lds
    s_add_u32 m0, s21, 82944
    s_add_u32 s18, s18, 18432
    buffer_load_dwordx4 v3, s[12:15], s18 offen lds
    s_add_u32 m0, s21, 83968
    s_add_u32 s18, s18, 18432
    buffer_load_dwordx4 v3, s[12:15], s18 offen lds
    s_add_u32 m0, s21, 84992
    s_add_u32 s18, s18, 18432
    buffer_load_dwordx4 v3, s[12:15], s18 offen lds
    v_add_u32 v6, 98304, v4
    v_xor_b32 v7, 32, v6
    s_waitcnt vmcnt(32)
    ds_read_b64_tr_b16 a[96:97], v6 offset:0
    ds_read_b64_tr_b16 a[98:99], v6 offset:1024
    ds_read_b64_tr_b16 a[100:101], v6 offset:8
    ds_read_b64_tr_b16 a[102:103], v6 offset:1032
    ds_read_b64_tr_b16 a[104:105], v6 offset:2048
    ds_read_b64_tr_b16 a[106:107], v6 offset:3072
    ds_read_b64_tr_b16 a[108:109], v6 offset:2056
    ds_read_b64_tr_b16 a[110:111], v6 offset:3080
    s_waitcnt lgkmcnt(0)
    s_add_u32 s18, s19, 1105920
    s_add_u32 m0, s21, 98304
    s_nop 0
    buffer_load_dwordx4 v3, s[12:15], s18 offen lds
    s_add_u32 m0, s21, 99328
    s_add_u32 s18, s18, 18432
    buffer_load_dwordx4 v3, s[12:15], s18 offen lds
    s_add_u32 m0, s21, 100352
    s_add_u32 s18, s18, 18432
    buffer_load_dwordx4 v3, s[12:15], s18 offen lds
    s_add_u32 m0, s21, 101376
    s_add_u32 s18, s18, 18432
    buffer_load_dwordx4 v3, s[12:15], s18 offen lds
    v_add_u32 v6, 114688, v4
    v_xor_b32 v7, 32, v6
    s_waitcnt vmcnt(32)
    ds_read_b64_tr_b16 a[112:113], v6 offset:0
    ds_read_b64_tr_b16 a[114:115], v6 offset:1024
    ds_read_b64_tr_b16 a[116:117], v6 offset:8
    ds_read_b64_tr_b16 a[118:119], v6 offset:1032
    ds_read_b64_tr_b16 a[120:121], v6 offset:2048
    ds_read_b64_tr_b16 a[122:123], v6 offset:3072
    ds_read_b64_tr_b16 a[124:125], v6 offset:2056
    ds_read_b64_tr_b16 a[126:127], v6 offset:3080
    s_waitcnt lgkmcnt(0)
    v_add_u32 v6, 131072, v4
    v_xor_b32 v7, 32, v6
    s_waitcnt vmcnt(28)
    ds_read_b64_tr_b16 a[128:129], v6 offset:0
    ds_read_b64_tr_b16 a[130:131], v6 offset:1024
    ds_read_b64_tr_b16 a[132:133], v6 offset:8
    ds_read_b64_tr_b16 a[134:135], v6 offset:1032
    ds_read_b64_tr_b16 a[136:137], v6 offset:2048
    ds_read_b64_tr_b16 a[138:139], v6 offset:3072
    ds_read_b64_tr_b16 a[140:141], v6 offset:2056
    ds_read_b64_tr_b16 a[142:143], v6 offset:3080
    s_waitcnt lgkmcnt(0)
    v_add_u32 v6, 0, v4
    v_xor_b32 v7, 32, v6
    s_waitcnt vmcnt(24)
    ds_read_b64_tr_b16 a[144:145], v6 offset:0
    ds_read_b64_tr_b16 a[146:147], v6 offset:1024
    ds_read_b64_tr_b16 a[148:149], v6 offset:8
    ds_read_b64_tr_b16 a[150:151], v6 offset:1032
    ds_read_b64_tr_b16 a[152:153], v6 offset:2048
    ds_read_b64_tr_b16 a[154:155], v6 offset:3072
    ds_read_b64_tr_b16 a[156:157], v6 offset:2056
    ds_read_b64_tr_b16 a[158:159], v6 offset:3080
    s_waitcnt lgkmcnt(0)
    v_add_u32 v6, 16384, v4
    v_xor_b32 v7, 32, v6
    s_waitcnt vmcnt(20)
    ds_read_b64_tr_b16 a[160:161], v6 offset:0
    ds_read_b64_tr_b16 a[162:163], v6 offset:1024
    ds_read_b64_tr_b16 a[164:165], v6 offset:8
    ds_read_b64_tr_b16 a[166:167], v6 offset:1032
    ds_read_b64_tr_b16 a[168:169], v6 offset:2048
    ds_read_b64_tr_b16 a[170:171], v6 offset:3072
    ds_read_b64_tr_b16 a[172:173], v6 offset:2056
    ds_read_b64_tr_b16 a[174:175], v6 offset:3080
    s_waitcnt lgkmcnt(0)
    v_add_u32 v6, 32768, v4
    v_xor_b32 v7, 32, v6
    s_waitcnt vmcnt(16)
    ds_read_b64_tr_b16 a[176:177], v6 offset:0
    ds_read_b64_tr_b16 a[178:179], v6 offset:1024
    ds_read_b64_tr_b16 a[180:181], v6 offset:8
    ds_read_b64_tr_b16 a[182:183], v6 offset:1032
    ds_read_b64_tr_b16 a[184:185], v6 offset:2048
    ds_read_b64_tr_b16 a[186:187], v6 offset:3072
    ds_read_b64_tr_b16 a[188:189], v6 offset:2056
    ds_read_b64_tr_b16 a[190:191], v6 offset:3080
    s_waitcnt lgkmcnt(0)
    v_add_u32 v6, 49152, v4
    v_xor_b32 v7, 32, v6
    s_waitcnt vmcnt(12)
    ds_read_b64_tr_b16 a[192:193], v6 offset:0
    ds_read_b64_tr_b16 a[194:195], v6 offset:1024
    ds_read_b64_tr_b16 a[196:197], v6 offset:8
    ds_read_b64_tr_b16 a[198:199], v6 offset:1032
    ds_read_b64_tr_b16 a[200:201], v6 offset:2048
    ds_read_b64_tr_b16 a[202:203], v6 offset:3072
    ds_read_b64_tr_b16 a[204:205], v6 offset:2056
    ds_read_b64_tr_b16 a[206:207], v6 offset:3080
    s_waitcnt lgkmcnt(0)
    v_add_u32 v6, 65536, v4
    v_xor_b32 v7, 32, v6
    s_waitcnt vmcnt(8)
    ds_read_b64_tr_b16 a[208:209], v6 offset:0
    ds_read_b64_tr_b16 a[210:211], v6 offset:1024
    ds_read_b64_tr_b16 a[212:213], v6 offset:8
    ds_read_b64_tr_b16 a[214:215], v6 offset:1032
    ds_read_b64_tr_b16 a[216:217], v6 offset:2048
    ds_read_b64_tr_b16 a[218:219], v6 offset:3072
    ds_read_b64_tr_b16 a[220:221], v6 offset:2056
    ds_read_b64_tr_b16 a[222:223], v6 offset:3080
    s_waitcnt lgkmcnt(0)
    v_add_u32 v6, 81920, v4
    v_xor_b32 v7, 32, v6
    s_waitcnt vmcnt(4)
    ds_read_b64_tr_b16 a[224:225], v6 offset:0
    ds_read_b64_tr_b16 a[226:227], v6 offset:1024
    ds_read_b64_tr_b16 a[228:229], v6 offset:8
    ds_read_b64_tr_b16 a[230:231], v6 offset:1032
    ds_read_b64_tr_b16 a[232:233], v6 offset:2048
    ds_read_b64_tr_b16 a[234:235], v6 offset:3072
    ds_read_b64_tr_b16 a[236:237], v6 offset:2056
    ds_read_b64_tr_b16 a[238:239], v6 offset:3080
    s_waitcnt lgkmcnt(0)
    v_add_u32 v6, 98304, v4
    v_xor_b32 v7, 32, v6
    s_waitcnt vmcnt(0)
    ds_read_b64_tr_b16 a[240:241], v6 offset:0
    ds_read_b64_tr_b16 a[242:243], v6 offset:1024
    ds_read_b64_tr_b16 a[244:245], v6 offset:8
    ds_read_b64_tr_b16 a[246:247], v6 offset:1032
    ds_read_b64_tr_b16 a[248:249], v6 offset:2048
    ds_read_b64_tr_b16 a[250:251], v6 offset:3072
    ds_read_b64_tr_b16 a[252:253], v6 offset:2056
    ds_read_b64_tr_b16 a[254:255], v6 offset:3080
    s_waitcnt lgkmcnt(0)
    s_barrier
    s_mov_b32 s35, s16
L_op_seg:
    s_sub_u32 s40, s35, 126
    s_lshr_b32 s41, s40, 1
    s_add_u32 s41, s41, 126
    s_and_b32 s40, s40, 1
    s_lshl_b32 s40, s40, 3
    s_lshl_b32 s44, 0x00ff00ff, s40
    s_cmp_ge_u32 s35, 999
    s_cselect_b32 s16, s41, s35
    s_cselect_b32 s44, s44, -1
    s_mov_b32 s45, s44
    s_lshr_b32 s43, s16, 1
    s_add_u32 s43, s43, 1
    s_min_u32 s43, s43, 63
    s_and_b32 s36, s33, 15
    s_lshl_b32 s36, s36, 8
    s_add_u32 s36, s36, 125829120
    s_lshl_b32 s94, s33, 7
    s_add_u32 s94, s94, s16
    s_cmp_ge_u32 s16, 120
    s_cbranch_scc1 L_nocw
    s_mov_b32 s88, 65536
    s_cmp_ge_u32 s47, s43
    s_cbranch_scc1 cw16x
cw16:
    buffer_load_dword v3, off, s[4:7], s36 offset:128 sc1
    s_waitcnt vmcnt(0)
    v_readfirstlane_b32 s42, v3
    s_nop 0
    s_sub_u32 s42, s42, s95
    s_cmp_gt_u32 s42, 64
    s_cselect_b32 s42, 0, s42
    s_add_u32 s42, s42, 2
    s_mov_b32 s47, s42
    s_cmp_ge_u32 s42, s43
    s_cbranch_scc1 cw16x
    s_sub_u32 s88, s88, 1
    s_cbranch_scc1 cw16x
    s_sub_u32 s42, s43, s42
    s_min_u32 s42, s42, 6
cw16s:
    s_sleep 24
    s_sub_u32 s42, s42, 1
    s_cmp_lg_u32 s42, 0
    s_cbranch_scc1 cw16s
    s_branch cw16
cw16x:
L_nocw:
    s_lshr_b32 s89, s16, 1
    s_lshl_b32 s89, s89, 2
    s_add_u32 s89, s89, s32
    s_lshl_b32 s89, s89, 7
    s_add_u32 s89, s89, 125894656
    s_cmp_lg_u32 s46, 0
    s_cbranch_scc1 L_opgo
    v_mbcnt_lo_u32_b32 v2, -1, 0
    v_mbcnt_hi_u32_b32 v2, -1, v2
    v_min_u32 v2, 7, v2
    v_lshlrev_b32 v2, 2, v2
    s_mov_b32 s88, 4194304
fw17:
    buffer_load_dword v3, v2, s[4:7], s89 offen offset:0 sc1
    s_sub_u32 s88, s88, 1
    s_cbranch_scc1 fw17x
    s_waitcnt vmcnt(0)
    v_cmp_ne_u32 vcc, s95, v3
    s_cbranch_vccz fw17x
    s_sleep 2
    s_cmp_gt_u32 s88, 4194256
    s_cbranch_scc1 fw17
    s_sleep 40
    s_branch fw17
fw17x:
L_opgo:
    v_lshrrev_b32 v5, 2, v1
    v_and_b32 v5, 28, v5
    s_add_u32 s89, s89, 1536
    s_mov_b32 s21, 4096
os_again:
    s_lshl_b32 s18, s16, 17
    s_lshl_b32 s19, s32, 15
    s_add_u32 s18, s18, s19
    s_add_u32 s18, s18, 50331648
    s_mov_b64 exec, s[44:45]
    buffer_load_dwordx4 v[32:35], v1, s[4:7], s18 offen offset:0 sc1
    buffer_load_dwordx4 v[36:39], v1, s[4:7], s18 offen offset:1024 sc1
    buffer_load_dwordx4 v[40:43], v1, s[4:7], s18 offen offset:2048 sc1
    buffer_load_dwordx4 v[44:47], v1, s[4:7], s18 offen offset:3072 sc1
    s_add_u32 s18, s18, 4096
    buffer_load_dwordx4 v[48:51], v1, s[4:7], s18 offen offset:0 sc1
    buffer_load_dwordx4 v[52:55], v1, s[4:7], s18 offen offset:1024 sc1
    buffer_load_dwordx4 v[56:59], v1, s[4:7], s18 offen offset:2048 sc1
    buffer_load_dwordx4 v[60:63], v1, s[4:7], s18 offen offset:3072 sc1
    s_add_u32 s18, s18, 4096
    buffer_load_dwordx4 v[64:67], v1, s[4:7], s18 offen offset:0 sc1
    buffer_load_dwordx4 v[68:71], v1, s[4:7], s18 offen offset:1024 sc1
    buffer_load_dwordx4 v[72:75], v1, s[4:7], s18 offen offset:2048 sc1
    buffer_load_dwordx4 v[76:79], v1, s[4:7], s18 offen offset:3072 sc1
    s_add_u32 s18, s18, 4096
    buffer_load_dwordx4 v[80:83], v1, s[4:7], s18 offen offset:0 sc1
    buffer_load_dwordx4 v[84:87], v1, s[4:7], s18 offen offset:1024 sc1
    buffer_load_dwordx4 v[88:91], v1, s[4:7], s18 offen offset:2048 sc1
    buffer_load_dwordx4 v[92:95], v1, s[4:7], s18 offen offset:3072 sc1
    s_add_u32 s18, s18, 4096
    buffer_load_dwordx4 v[96:99], v1, s[4:7], s18 offen offset:0 sc1
    buffer_load_dwordx4 v[100:103], v1, s[4:7], s18 offen offset:1024 sc1
    buffer_load_dwordx4 v[104:107], v1, s[4:7], s18 offen offset:2048 sc1
    buffer_load_dwordx4 v[108:111], v1, s[4:7], s18 offen offset:3072 sc1
    s_add_u32 s18, s18, 4096
    buffer_load_dwordx4 v[112:115], v1, s[4:7], s18 offen offset:0 sc1
    buffer_load_dwordx4 v[116:119], v1, s[4:7], s18 offen offset:1024 sc1
    buffer_load_dwordx4 v[120:123], v1, s[4:7], s18 offen offset:2048 sc1
    buffer_load_dwordx4 v[124:127], v1, s[4:7], s18 offen offset:3072 sc1
    s_add_u32 s18, s18, 4096
    buffer_load_dwordx4 v[128:131], v1, s[4:7], s18 offen offset:0 sc1
    buffer_load_dwordx4 v[132:135], v1, s[4:7], s18 offen offset:1024 sc1
    buffer_load_dwordx4 v[136:139], v1, s[4:7], s18 offen offset:2048 sc1
    buffer_load_dwordx4 v[140:143], v1, s[4:7], s18 offen offset:3072 sc1
    s_add_u32 s18, s18, 4096
    buffer_load_dwordx4 v[144:147], v1, s[4:7], s18 offen offset:0 sc1
    buffer_load_dwordx4 v[148:151], v1, s[4:7], s18 offen offset:1024 sc1
    buffer_load_dwordx4 v[152:155], v1, s[4:7], s18 offen offset:2048 sc1
    buffer_load_dwordx4 v[156:159], v1, s[4:7], s18 offen offset:3072 sc1
    s_mov_b64 exec, -1
    buffer_load_dword v6, v5, s[4:7], s89 offen sc1
    v_lshlrev_b32 v2, 4, v0
    v_and_b32 v3, 3072, v2
    v_lshl_add_u32 v2, v3, 1, v1
    s_waitcnt vmcnt(32)
    v_mfma_f32_16x16x32_bf16 v[8:11], a[0:3], v[32:35], 0
    v_mfma_f32_16x16x32_bf16 v[12:15], a[4:7], v[32:35], 0
    v_mov_b32 v4, v32
    s_waitcnt vmcnt(31)
    v_mfma_f32_16x16x32_bf16 v[8:11], a[8:11], v[36:39], v[8:11]
    v_mfma_f32_16x16x32_bf16 v[12:15], a[12:15], v[36:39], v[12:15]
    v_max_u32 v4, v4, v36
    s_waitcnt vmcnt(30)
    v_mfma_f32_16x16x32_bf16 v[8:11], a[16:19], v[40:43], v[8:11]
    v_mfma_f32_16x16x32_bf16 v[12:15], a[20:23], v[40:43], v[12:15]
    v_max_u32 v4, v4, v40
    s_waitcnt vmcnt(29)
    v_mfma_f32_16x16x32_bf16 v[8:11], a[24:27], v[44:47], v[8:11]
    v_mfma_f32_16x16x32_bf16 v[12:15], a[28:31], v[44:47], v[12:15]
    v_max_u32 v4, v4, v44
    s_waitcnt vmcnt(28)
    v_mfma_f32_16x16x32_bf16 v[8:11], a[32:35], v[48:51], v[8:11]
    v_mfma_f32_16x16x32_bf16 v[12:15], a[36:39], v[48:51], v[12:15]
    v_max_u32 v4, v4, v48
    s_waitcnt vmcnt(27)
    v_mfma_f32_16x16x32_bf16 v[8:11], a[40:43], v[52:55], v[8:11]
    v_mfma_f32_16x16x32_bf16 v[12:15], a[44:47], v[52:55], v[12:15]
    v_max_u32 v4, v4, v52
    s_waitcnt vmcnt(26)
    v_mfma_f32_16x16x32_bf16 v[8:11], a[48:51], v[56:59], v[8:11]
    v_mfma_f32_16x16x32_bf16 v[12:15], a[52:55], v[56:59], v[12:15]
    v_max_u32 v4, v4, v56
    s_waitcnt vmcnt(25)
    v_mfma_f32_16x16x32_bf16 v[8:11], a[56:59], v[60:63], v[8:11]
    v_mfma_f32_16x16x32_bf16 v[12:15], a[60:63], v[60:63], v[12:15]
    v_max_u32 v4, v4, v60
    s_waitcnt vmcnt(24)
    v_mfma_f32_16x16x32_bf16 v[8:11], a[64:67], v[64:67], v[8:11]
    v_mfma_f32_16x16x32_bf16 v[12:15], a[68:71], v[64:67], v[12:15]
    v_max_u32 v4, v4, v64
    s_waitcnt vmcnt(23)
    v_mfma_f32_16x16x32_bf16 v[8:11], a[72:75], v[68:71], v[8:11]
    v_mfma_f32_16x16x32_bf16 v[12:15], a[76:79], v[68:71], v[12:15]
    v_max_u32 v4, v4, v68
    s_waitcnt vmcnt(22)
    v_mfma_f32_16x16x32_bf16 v[8:11], a[80:83], v[72:75], v[8:11]
    v_mfma_f32_16x16x32_bf16 v[12:15], a[84:87], v[72:75], v[12:15]
    v_max_u32 v4, v4, v72
    s_waitcnt vmcnt(21)
    v_mfma_f32_16x16x32_bf16 v[8:11], a[88:91], v[76:79], v[8:11]
    v_mfma_f32_16x16x32_bf16 v[12:15], a[92:95], v[76:79], v[12:15]
    v_max_u32 v4, v4, v76
    s_waitcnt vmcnt(20)
    v_mfma_f32_16x16x32_bf16 v[8:11], a[96:99], v[80:83], v[8:11]
    v_mfma_f32_16x16x32_bf16 v[12:15], a[100:103], v[80:83], v[12:15]
    v_max_u32 v4, v4, v80
    s_waitcnt vmcnt(19)
    v_mfma_f32_16x16x32_bf16 v[8:11], a[104:107], v[84:87], v[8:11]
    v_mfma_f32_16x16x32_bf16 v[12:15], a[108:111], v[84:87], v[12:15]
    v_max_u32 v4, v4, v84
    s_waitcnt vmcnt(18)
    v_mfma_f32_16x16x32_bf16 v[8:11], a[112:115], v[88:91], v[8:11]
    v_mfma_f32_16x16x32_bf16 v[12:15], a[116:119], v[88:91], v[12:15]
    v_max_u32 v4, v4, v88
    s_waitcnt vmcnt(17)
    v_mfma_f32_16x16x32_bf16 v[8:11], a[120:123], v[92:95], v[8:11]
    v_mfma_f32_16x16x32_bf16 v[12:15], a[124:127], v[92:95], v[12:15]
    v_max_u32 v4, v4, v92
    s_waitcnt vmcnt(16)
    v_mfma_f32_16x16x32_bf16 v[8:11], a[128:131], v[96:99], v[8:11]
    v_mfma_f32_16x16x32_bf16 v[12:15], a[132:135], v[96:99], v[12:15]
    v_max_u32 v4, v4, v96
    s_waitcnt vmcnt(15)
    v_mfma_f32_16x16x32_bf16 v[8:11], a[136:139], v[100:103], v[8:11]
    v_mfma_f32_16x16x32_bf16 v[12:15], a[140:143], v[100:103], v[12:15]
    v_max_u32 v4, v4, v100
    s_waitcnt vmcnt(14)
    v_mfma_f32_16x16x32_bf16 v[8:11], a[144:147], v[104:107], v[8:11]
    v_mfma_f32_16x16x32_bf16 v[12:15], a[148:151], v[104:107], v[12:15]
    v_max_u32 v4, v4, v104
    s_waitcnt vmcnt(13)
    v_mfma_f32_16x16x32_bf16 v[8:11], a[152:155], v[108:111], v[8:11]
    v_mfma_f32_16x16x32_bf16 v[12:15], a[156:159], v[108:111], v[12:15]
    v_max_u32 v4, v4, v108
    s_waitcnt vmcnt(12)
    v_mfma_f32_16x16x32_bf16 v[8:11], a[160:163], v[112:115], v[8:11]
    v_mfma_f32_16x16x32_bf16 v[12:15], a[164:167], v[112:115], v[12:15]
    v_max_u32 v4, v4, v112
    s_waitcnt vmcnt(11)
    v_mfma_f32_16x16x32_bf16 v[8:11], a[168:171], v[116:119], v[8:11]
    v_mfma_f32_16x16x32_bf16 v[12:15], a[172:175], v[116:119], v[12:15]
    v_max_u32 v4, v4, v116
    s_waitcnt vmcnt(10)
    v_mfma_f32_16x16x32_bf16 v[8:11], a[176:179], v[120:123], v[8:11]
    v_mfma_f32_16x16x32_bf16 v[12:15], a[180:183], v[120:123], v[12:15]
    v_max_u32 v4, v4, v120
    s_waitcnt vmcnt(9)
    v_mfma_f32_16x16x32_bf16 v[8:11], a[184:187], v[124:127], v[8:11]
    v_mfma_f32_16x16x32_bf16 v[12:15], a[188:191], v[124:127], v[12:15]
    v_max_u32 v4, v4, v124
    s_waitcnt vmcnt(8)
    v_mfma_f32_16x16x32_bf16 v[8:11], a[192:195], v[128:131], v[8:11]
    v_mfma_f32_16x16x32_bf16 v[12:15], a[196:199], v[128:131], v[12:15]
    v_max_u32 v4, v4, v128
    s_waitcnt vmcnt(7)
    v_mfma_f32_16x16x32_bf16 v[8:11], a[200:203], v[132:135], v[8:11]
    v_mfma_f32_16x16x32_bf16 v[12:15], a[204:207], v[132:135], v[12:15]
    v_max_u32 v4, v4, v132
    s_waitcnt vmcnt(6)
    v_mfma_f32_16x16x32_bf16 v[8:11], a[208:211], v[136:139], v[8:11]
    v_mfma_f32_16x16x32_bf16 v[12:15], a[212:215], v[136:139], v[12:15]
    v_max_u32 v4, v4, v136
    s_waitcnt vmcnt(5)
    v_mfma_f32_16x16x32_bf16 v[8:11], a[216:219], v[140:143], v[8:11]
    v_mfma_f32_16x16x32_bf16 v[12:15], a[220:223], v[140:143], v[12:15]
    v_max_u32 v4, v4, v140
    s_waitcnt vmcnt(4)
    v_mfma_f32_16x16x32_bf16 v[8:11], a[224:227], v[144:147], v[8:11]
    v_mfma_f32_16x16x32_bf16 v[12:15], a[228:231], v[144:147], v[12:15]
    v_max_u32 v4, v4, v144
    s_waitcnt vmcnt(3)
    v_mfma_f32_16x16x32_bf16 v[8:11], a[232:235], v[148:151], v[8:11]
    v_mfma_f32_16x16x32_bf16 v[12:15], a[236:239], v[148:151], v[12:15]
    v_max_u32 v4, v4, v148
    s_waitcnt vmcnt(2)
    v_mfma_f32_16x16x32_bf16 v[8:11], a[240:243], v[152:155], v[8:11]
    v_mfma_f32_16x16x32_bf16 v[12:15], a[244:247], v[152:155], v[12:15]
    v_max_u32 v4, v4, v152
    s_waitcnt vmcnt(1)
    v_mfma_f32_16x16x32_bf16 v[8:11], a[248:251], v[156:159], v[8:11]
    v_mfma_f32_16x16x32_bf16 v[12:15], a[252:255], v[156:159], v[12:15]
    v_max_u32 v4, v4, v156
    v_cmp_eq_u32 vcc, -1, v4
    s_nop 0
    s_and_b64 vcc, vcc, s[44:45]
    s_sub_u32 s21, s21, 1
    s_nop 1
    s_cbranch_scc1 os_ok
    s_cbranch_vccnz os_again
os_ok:
    ds_write_b128 v2, v[8:11] offset:0
    ds_write_b128 v2, v[12:15] offset:1024
    s_waitcnt lgkmcnt(0)
    s_barrier
    s_waitcnt vmcnt(0)
    v_cmp_ne_u32 vcc, s95, v6
    s_nop 0
    s_cmp_eq_u64 vcc, 0
    s_cselect_b32 s46, 1, 0
    s_cmp_lg_u32 s32, 0
    s_cbranch_scc1 os_skip
    ds_read_b128 v[40:43], v1 offset:2048
    ds_read_b128 v[44:47], v1 offset:3072
    ds_read_b128 v[48:51], v1 offset:4096
    ds_read_b128 v[52:55], v1 offset:5120
    ds_read_b128 v[56:59], v1 offset:6144
    ds_read_b128 v[60:63], v1 offset:7168
    v_lshrrev_b32 v3, 4, v1
    v_bfe_u32 v4, v3, 2, 2
    v_lshlrev_b32 v4, 3, v4
    v_and_b32 v2, 3, v3
    v_add_u32 v4, v4, v2
    v_mul_u32_u24 v4, 2304, v4
    v_lshrrev_b32 v3, 4, v3
    v_lshl_add_u32 v4, v3, 4, v4
    s_lshr_b32 s18, s16, 1
    s_lshl_b32 s18, s18, 3
    s_and_b32 s19, s16, 1
    s_add_u32 s18, s18, s19
    s_mul_i32 s18, s18, 9216
    s_lshl_b32 s19, s33, 6
    s_add_u32 s18, s18, s19
    s_waitcnt lgkmcnt(0)
    v_pk_add_f32 v[8:9], v[8:9], v[40:41]
    v_pk_add_f32 v[48:49], v[48:49], v[56:57]
    v_pk_add_f32 v[8:9], v[8:9], v[48:49]
    v_pk_add_f32 v[10:11], v[10:11], v[42:43]
    v_pk_add_f32 v[50:51], v[50:51], v[58:59]
    v_pk_add_f32 v[10:11], v[10:11], v[50:51]
    v_pk_add_f32 v[12:13], v[12:13], v[44:45]
    v_pk_add_f32 v[52:53], v[52:53], v[60:61]
    v_pk_add_f32 v[12:13], v[12:13], v[52:53]
    v_pk_add_f32 v[14:15], v[14:15], v[46:47]
    v_pk_add_f32 v[54:55], v[54:55], v[62:63]
    v_pk_add_f32 v[14:15], v[14:15], v[54:55]
    v_cvt_pk_bf16_f32 v32, v8, v9
    v_cvt_pk_bf16_f32 v33, v10, v11
    v_cvt_pk_bf16_f32 v34, v12, v13
    v_cvt_pk_bf16_f32 v35, v14, v15
    s_mov_b64 exec, s[44:45]
    buffer_store_dwordx4 v[32:35], v4, s[8:11], s18 offen sc1
    s_mov_b64 exec, -1
os_skip:
    s_nop 0
    s_add_u32 s35, s35, 6
    s_cmp_ge_u32 s35, 128
    s_cbranch_scc1 L_done
    s_barrier
    s_branch L_op_seg
L_done:
L_exit:
    s_endpgm
.section .rodata,"a"
.p2align 6
.amdhsa_kernel concat_heads__memory_aug_recurrent_mem_tr__ssm_conv_s4d__prompt_kernel
  .amdhsa_next_free_vgpr 512
  .amdhsa_next_free_sgpr 102
  .amdhsa_accum_offset 256
  .amdhsa_group_segment_fixed_size 0
  .amdhsa_kernarg_size 136
  .amdhsa_user_sgpr_count 2
  .amdhsa_user_sgpr_kernarg_segment_ptr 1
  .amdhsa_system_sgpr_workgroup_id_x 1
.end_amdhsa_kernel
.text
```

```asm
; @launch grid=(256,1,1) block=(256,1,1) lds=163840
.amdgcn_target "amdgcn-amd-amdhsa--gfx950"
.text
.globl concat_heads__memory_aug_recurrent_mem_tr__ssm_conv_s4d__prompt_kernel
.p2align 8
.type concat_heads__memory_aug_recurrent_mem_tr__ssm_conv_s4d__prompt_kernel,@function
concat_heads__memory_aug_recurrent_mem_tr__ssm_conv_s4d__prompt_kernel:
    s_cmp_ge_u32 s2, 256
    s_cbranch_scc1 L_exit
    s_load_dwordx4 s[84:87], s[0:1], 120
    s_load_dwordx16 s[48:63], s[0:1], 0
    v_lshrrev_b32 v1, 6, v0
    s_nop 0
    v_readfirstlane_b32 s32, v1
    s_getreg_b32 s3, hwreg(HW_REG_XCC_ID)
    s_and_b32 s3, s3, 15
    s_cmp_lg_u32 s32, 3
    s_cbranch_scc1 L_nowarm
    s_getpc_b64 s[44:45]
L_pcw:
    v_and_b32 v1, 63, v0
    v_lshlrev_b32 v1, 7, v1
    s_cmp_lg_u32 s3, 3
    s_cselect_b32 s33, L_helper-L_pcw, 0
    v_add_u32 v1, s33, v1
    v_min_u32 v2, L_exit-L_pcw, v1
    global_load_dword v240, v2, s[44:45]
    v_add_u32 v1, 8192, v1
    v_min_u32 v2, L_exit-L_pcw, v1
    global_load_dword v241, v2, s[44:45]
    v_add_u32 v1, 8192, v1
    s_cbranch_scc0 L_nowarm
    v_min_u32 v2, L_exit-L_pcw, v1
    global_load_dword v242, v2, s[44:45]
    v_add_u32 v1, 8192, v1
    v_min_u32 v2, L_exit-L_pcw, v1
    global_load_dword v243, v2, s[44:45]
    v_add_u32 v1, 8192, v1
L_nowarm:
    s_waitcnt lgkmcnt(0)
    s_mov_b32 s4, s86
    s_mov_b32 s5, s87
    s_mov_b32 s6, 268435456
    s_mov_b32 s7, 0x20000
    s_mov_b32 s96, s84
    s_mov_b32 s97, s85
    s_mov_b32 s98, 256
    s_mov_b32 s99, 0x20000
    s_mov_b32 s95, 0
    s_cmp_lg_u32 s3, 3
    s_cbranch_scc1 L_helper
    s_mov_b32 s37, 128
    v_mov_b32 v250, 1
    v_mov_b32 v251, 163832
    v_cmp_eq_u32 vcc, 0, v0
    s_nop 0
    s_and_saveexec_b64 s[38:39], vcc
    s_cbranch_execz tk1m
    buffer_atomic_add v250, off, s[96:99], s37 sc0
tk1m:
    s_mov_b64 s[38:39], exec
    s_mov_b64 exec, -1
    v_lshrrev_b32 v54, 6, v0
    s_nop 0
    v_readfirstlane_b32 s13, v54
    v_and_b32 v57, 63, v0
    v_bfe_u32 v54, v57, 2, 1
    v_lshlrev_b32 v48, 13, v54
    v_bfe_u32 v54, v57, 3, 1
    v_lshl_add_u32 v48, v54, 15, v48
    v_bfe_u32 v54, v57, 4, 1
    v_lshl_add_u32 v48, v54, 14, v48
    v_bfe_u32 v54, v57, 5, 1
    v_lshl_add_u32 v48, v54, 16, v48
    v_lshrrev_b32 v55, 4, v57
    v_and_b32 v55, 2, v55
    v_xor_b32 v55, v55, v57
    v_and_b32 v55, 3, v55
    v_lshl_add_u32 v48, v55, 4, v48
    v_bfe_u32 v54, v57, 2, 1
    v_lshlrev_b32 v51, 6, v54
    v_bfe_u32 v54, v57, 3, 1
    v_lshl_add_u32 v51, v54, 9, v51
    v_bfe_u32 v54, v57, 4, 1
    v_lshl_add_u32 v51, v54, 7, v51
    v_bfe_u32 v54, v57, 5, 1
    v_lshl_add_u32 v51, v54, 12, v51
    v_bfe_u32 v54, v57, 0, 1
    v_lshl_add_u32 v51, v54, 3, v51
    v_bfe_u32 v54, v57, 1, 1
    v_lshl_add_u32 v51, v54, 4, v51
    v_bfe_u32 v54, v57, 3, 1
    v_lshl_add_u32 v51, v54, 5, v51
    v_lshrrev_b32 v55, 3, v57
    v_mul_u32_u24 v49, 1152, v55
    v_and_b32 v55, 7, v57
    v_lshl_add_u32 v49, v55, 4, v49
    v_bfe_u32 v54, v57, 4, 1
    v_lshlrev_b32 v52, 13, v54
    v_bfe_u32 v54, v57, 5, 1
    v_lshl_add_u32 v52, v54, 9, v52
    v_bfe_u32 v54, v57, 2, 1
    v_lshl_add_u32 v52, v54, 7, v52
    v_bfe_u32 v54, v57, 3, 1
    v_lshl_add_u32 v52, v54, 5, v52
    v_and_b32 v55, 3, v57
    v_lshl_add_u32 v52, v55, 3, v52
    v_lshrrev_b32 v55, 2, v57
    v_mul_u32_u24 v50, 1152, v55
    v_and_b32 v55, 3, v57
    v_lshl_add_u32 v50, v55, 4, v50
    v_bfe_u32 v54, v57, 4, 1
    v_lshlrev_b32 v53, 12, v54
    v_bfe_u32 v54, v57, 5, 1
    v_lshl_add_u32 v53, v54, 8, v53
    v_bfe_u32 v54, v57, 2, 1
    v_lshl_add_u32 v53, v54, 6, v53
    v_bfe_u32 v54, v57, 3, 1
    v_lshl_add_u32 v53, v54, 5, v53
    v_and_b32 v55, 3, v57
    v_lshl_add_u32 v53, v55, 3, v53
    s_lshl_b32 s66, s13, 10
    s_and_b32 s93, s13, 1
    s_lshl_b32 s93, s93, 14
    s_and_b32 s75, s13, 2
    s_lshl_b32 s75, s75, 19
    v_add_u32 v51, s66, v51
    v_add_u32 v52, s66, v52
    v_add_u32 v53, s66, v53
    v_mov_b32 v58, v48
    s_mov_b32 s10, 4718592
    s_mov_b32 s11, 0x20000
    s_mov_b64 exec, s[38:39]
    s_cbranch_execz tk1
    s_waitcnt vmcnt(0)
    ds_write_b32 v251, v250
    s_waitcnt lgkmcnt(0)
tk1:
    s_mov_b64 exec, -1
    s_barrier
    ds_read_b32 v252, v251
    s_waitcnt lgkmcnt(0)
    v_readfirstlane_b32 s12, v252
    s_barrier
    s_nop 3
    s_cmp_ge_u32 s12, 32
    s_cbranch_scc1 L_helper
L_chain:
    s_mov_b64 s[48:49], s[50:51]
    s_mov_b64 s[50:51], s[52:53]
    s_mov_b64 s[52:53], s[54:55]
    s_mov_b64 s[54:55], s[56:57]
    s_mov_b64 s[56:57], s[58:59]
    s_lshl_b32 s67, s12, 8
    s_lshl_b32 s40, s13, 6
    s_add_u32 s67, s67, s40
    s_mul_i32 s92, s12, 147456
    s_lshr_b32 s73, s50, 8
    s_add_u32 s73, s73, s12
    s_and_b32 s73, s73, 31
    s_bitcmp1_b32 0xa2222222, s73
    s_cselect_b32 s88, 1, 0
    s_mov_b32 s72, 0
    s_add_u32 s73, s73, 1
    s_lshr_b32 s73, s73, 2
    s_xor_b32 s94, s13, 0
    s_mul_i32 s94, s94, 36864
    s_add_u32 s94, s94, s92
    s_lshl_b32 s74, s13, 7
    s_add_u32 s94, s94, s74
    s_add_u32 s78, s94, 0
    s_mov_b64 s[8:9], s[56:57]
    v_mov_b32 v58, v49
    s_mov_b32 s79, 9216
    s_mov_b32 s81, 0
    s_add_u32 s80, s66, 114688
    s_mov_b32 s76, 0
    s_mov_b32 s77, 8192
    s_call_b64 s[82:83], cf_dma
    s_mov_b32 s77, 16384
    s_call_b64 s[82:83], cf_dma
    s_xor_b32 s94, s13, 1
    s_mul_i32 s94, s94, 36864
    s_add_u32 s94, s94, s92
    s_lshl_b32 s74, s13, 7
    s_add_u32 s94, s94, s74
    s_add_u32 s78, s94, 0
    s_add_u32 s80, s66, 81920
    s_mov_b32 s76, 0
    s_mov_b32 s77, 8192
    s_call_b64 s[82:83], cf_dma
    s_mov_b32 s77, 16384
    s_call_b64 s[82:83], cf_dma
    s_xor_b32 s94, s13, 2
    s_mul_i32 s94, s94, 36864
    s_add_u32 s94, s94, s92
    s_lshl_b32 s74, s13, 7
    s_add_u32 s94, s94, s74
    s_add_u32 s78, s94, 0
    s_add_u32 s80, s66, 16384
    s_mov_b32 s76, 0
    s_mov_b32 s77, 8192
    s_call_b64 s[82:83], cf_dma
    s_mov_b32 s77, 16384
    s_call_b64 s[82:83], cf_dma
    s_xor_b32 s94, s13, 3
    s_mul_i32 s94, s94, 36864
    s_add_u32 s94, s94, s92
    s_lshl_b32 s74, s13, 7
    s_add_u32 s94, s94, s74
    s_add_u32 s78, s94, 0
    s_add_u32 s80, s66, 0
    s_mov_b32 s76, 0
    s_mov_b32 s77, 8192
    s_call_b64 s[82:83], cf_dma
    s_mov_b32 s77, 16384
    s_call_b64 s[82:83], cf_dma
    v_lshrrev_b32 v24, 6, v0
    v_lshlrev_b32 v61, 4, v0
    v_add_u32 v62, 57344, v61
    v_xor_b32 v63, 1024, v61
    v_add_u32 v63, 98304, v63
    v_xor_b32 v64, 2048, v61
    v_add_u32 v64, 98304, v64
    v_and_b32 v65, 1023, v61
    v_add_u32 v65, 98304, v65
    v_and_b32 v26, 15, v0
    v_bfe_u32 v27, v0, 4, 2
    v_mov_b32 v60, 0x4444
    v_mov_b32 v25, 0xeeee
    v_cmp_lt_u32 vcc, 7, v26
    s_nop 1
    v_cndmask_b32 v60, v60, v25, vcc
    s_nop 1
    v_and_b32 v67, 12, v26
    v_lshlrev_b32 v67, 3, v67
    v_and_b32 v25, 1, v26
    v_lshl_add_u32 v67, v25, 4, v67
    v_bfe_u32 v25, v26, 1, 1
    v_lshl_add_u32 v67, v25, 3, v67
    v_lshl_add_u32 v66, v27, 14, v67
    v_lshl_add_u32 v66, v24, 17, v66
    s_nop 1
    v_and_b32 v67, 63, v67
    v_lshrrev_b32 v25, 1, v24
    v_lshl_add_u32 v67, v25, 18, v67
    v_lshl_add_u32 v67, v27, 16, v67
    v_lshrrev_b32 v25, 3, v26
    v_lshl_add_u32 v67, v25, 15, v67
    v_and_b32 v25, 1, v24
    v_lshl_add_u32 v67, v25, 6, v67
    s_nop 1
    s_waitcnt vmcnt(12)
    v_add_u32 v55, 114688, v52
    ds_read_b64_tr_b16 v[160:161], v55 offset:0
    ds_read_b64_tr_b16 v[162:163], v55 offset:256
    ds_read_b64_tr_b16 v[164:165], v55 offset:4096
    ds_read_b64_tr_b16 v[166:167], v55 offset:4352
    s_xor_b32 s94, s13, 0
    s_mul_i32 s94, s94, 36864
    s_add_u32 s94, s94, s92
    s_lshl_b32 s74, s13, 7
    s_add_u32 s94, s94, s74
    s_add_u32 s78, s94, 512
    s_add_u32 s80, s66, 147456
    s_mov_b32 s76, 0
    s_mov_b32 s77, 8192
    s_call_b64 s[82:83], cf_dma
    ds_read_b64_tr_b16 v[192:193], v55 offset:64
    ds_read_b64_tr_b16 v[194:195], v55 offset:320
    ds_read_b64_tr_b16 v[196:197], v55 offset:4160
    ds_read_b64_tr_b16 v[198:199], v55 offset:4416
    s_mov_b32 s77, 16384
    s_call_b64 s[82:83], cf_dma
    v_and_b32 v25, 31, v0
    v_lshlrev_b32 v70, 4, v25
    v_lshlrev_b32 v28, 3, v25
    v_add_u32 v28, 108032, v28
    v_lshrrev_b32 v25, 1, v24
    v_lshl_add_u32 v70, v25, 9, v70
    v_and_b32 v25, 1, v24
    v_lshl_add_u32 v70, v25, 3, v70
    v_add_u32 v70, 109568, v70
    v_cmp_gt_u32 vcc, 2, v27
    s_nop 1
    v_cndmask_b32 v70, v70, v28, vcc
    s_nop 1
    s_waitcnt lgkmcnt(0)
    s_waitcnt vmcnt(12)
    v_add_u32 v55, 81920, v52
    ds_read_b64_tr_b16 v[168:169], v55 offset:0
    ds_read_b64_tr_b16 v[170:171], v55 offset:256
    ds_read_b64_tr_b16 v[172:173], v55 offset:4096
    ds_read_b64_tr_b16 v[174:175], v55 offset:4352
    s_xor_b32 s94, s13, 1
    s_mul_i32 s94, s94, 36864
    s_add_u32 s94, s94, s92
    s_lshl_b32 s74, s13, 7
    s_add_u32 s94, s94, s74
    s_add_u32 s78, s94, 512
    s_add_u32 s80, s66, 98304
    s_mov_b32 s76, 0
    s_mov_b32 s77, 8192
    s_call_b64 s[82:83], cf_dma
    ds_read_b64_tr_b16 v[200:201], v55 offset:64
    ds_read_b64_tr_b16 v[202:203], v55 offset:320
    ds_read_b64_tr_b16 v[204:205], v55 offset:4160
    ds_read_b64_tr_b16 v[206:207], v55 offset:4416
    s_mov_b32 s77, 16384
    s_call_b64 s[82:83], cf_dma
    v_xor_b32 v71, 2048, v63
    v_lshrrev_b32 v68, 4, v0
    v_lshlrev_b32 v68, 7, v68
    v_and_b32 v25, 7, v26
    v_lshl_add_u32 v68, v25, 4, v68
    v_add_u32 v68, 102400, v68
    v_xor_b32 v74, 512, v68
    v_xor_b32 v75, 1024, v68
    v_xor_b32 v76, 1536, v68
    v_lshrrev_b32 v25, 3, v26
    v_lshl_add_u32 v77, v25, 3, v68
    v_or_b32 v78, 512, v65
    v_lshlrev_b32 v79, 2, v61
    v_mov_b64 v[72:73], 0
    v_and_b32 v25, 1, v27
    v_lshlrev_b32 v69, 7, v25
    v_lshrrev_b32 v25, 1, v27
    v_lshl_add_u32 v69, v25, 3, v69
    v_and_b32 v25, 3, v26
    v_lshl_add_u32 v69, v25, 4, v69
    v_bfe_u32 v25, v26, 2, 1
    v_lshl_add_u32 v69, v25, 2, v69
    s_nop 1
    s_waitcnt lgkmcnt(0)
    s_waitcnt vmcnt(12)
    v_add_u32 v55, 16384, v52
    ds_read_b64_tr_b16 v[176:177], v55 offset:0
    ds_read_b64_tr_b16 v[178:179], v55 offset:256
    ds_read_b64_tr_b16 v[180:181], v55 offset:4096
    ds_read_b64_tr_b16 v[182:183], v55 offset:4352
    s_add_u32 s78, s67, 4194304
    s_mov_b64 s[8:9], s[54:55]
    v_mov_b32 v58, v48
    s_mov_b32 s79, 131072
    s_add_u32 s80, s66, 32768
    s_mov_b32 s76, 0
    s_mov_b32 s77, 8192
    s_call_b64 s[82:83], cf_dma
    ds_read_b64_tr_b16 v[208:209], v55 offset:64
    ds_read_b64_tr_b16 v[210:211], v55 offset:320
    ds_read_b64_tr_b16 v[212:213], v55 offset:4160
    ds_read_b64_tr_b16 v[214:215], v55 offset:4416
    s_mov_b32 s77, 16384
    s_call_b64 s[82:83], cf_dma
    s_mov_b32 s32, 0x00ff00ff
    s_mov_b32 s33, 0x00ff00ff
    s_not_b64 s[34:35], s[32:33]
    s_lshr_b32 s31, s12, 1
    s_lshl_b32 s31, s31, 8
    s_and_b32 s40, s12, 1
    s_lshl_b32 s40, s40, 6
    s_add_u32 s31, s31, s40
    s_and_b32 s40, s13, 1
    s_lshl_b32 s40, s40, 12
    s_add_u32 s31, s31, s40
    s_lshl_b32 s19, s12, 14
    s_add_u32 s19, s19, 67076096
    s_add_u32 s41, s19, 8192
    s_add_u32 s19, s19, s40
    s_and_b32 s40, s12, 1
    s_lshl_b32 s40, s40, 2
    s_or_b32 s40, s40, s13
    s_cmp_eq_u32 s40, 5
    s_cselect_b32 s64, 0, s13
    s_cmp_lg_u32 s13, 1
    s_cbranch_scc1 cf_notx
    s_mov_b32 s32, 0xff
    s_mov_b32 s33, 0xff
    s_mov_b32 s19, s41
    s_lshr_b32 s31, s12, 3
    s_lshl_b32 s31, s31, 8
    s_and_b32 s40, s12, 2
    s_lshl_b32 s40, s40, 6
    s_add_u32 s31, s31, s40
    s_and_b32 s40, s12, 4
    s_lshl_b32 s40, s40, 4
    s_add_u32 s31, s31, s40
    s_add_u32 s31, s31, 8192
cf_notx:
    s_cmp_lg_u32 s13, 0
    s_cbranch_scc1 cf_notp
    s_min_u32 s40, s12, 23
    s_mul_i32 s40, s40, 384
    s_add_u32 s40, s40, 98304
    v_add_u32 v69, s40, v61
    v_mov_b32 v25, 108288
    v_cmp_lt_u32 vcc, 23, v0
    s_nop 1
    v_cndmask_b32 v69, v69, v25, vcc
cf_notp:
    s_nop 1
    s_waitcnt lgkmcnt(0)
    s_waitcnt vmcnt(12)
    v_add_u32 v55, 0, v52
    ds_read_b64_tr_b16 v[184:185], v55 offset:0
    ds_read_b64_tr_b16 v[186:187], v55 offset:256
    ds_read_b64_tr_b16 v[188:189], v55 offset:4096
    ds_read_b64_tr_b16 v[190:191], v55 offset:4352
    s_xor_b32 s78, s75, 0
    s_add_u32 s78, s78, s67
    s_mov_b32 s81, s93
    s_add_u32 s80, s66, 114688
    s_mov_b32 s76, 0
    s_mov_b32 s77, 8192
    s_call_b64 s[82:83], cf_dma
    ds_read_b64_tr_b16 v[216:217], v55 offset:64
    ds_read_b64_tr_b16 v[218:219], v55 offset:320
    ds_read_b64_tr_b16 v[220:221], v55 offset:4160
    ds_read_b64_tr_b16 v[222:223], v55 offset:4416
    s_mov_b32 s77, 16384
    s_call_b64 s[82:83], cf_dma
    v_mov_b32 v28, 1
    v_mov_b32 v29, 1
    v_mov_b32 v30, 1
    v_mov_b32 v31, 1
    s_lshl_b32 s40, s12, 14
    s_add_u32 s40, s40, 67174400
    s_add_u32 s41, s40, 0
    buffer_store_dwordx4 v[28:31], v61, s[4:7], s41 offen
    s_add_u32 s41, s40, 4096
    buffer_store_dwordx4 v[28:31], v61, s[4:7], s41 offen
    s_add_u32 s41, s40, 8192
    buffer_store_dwordx4 v[28:31], v61, s[4:7], s41 offen
    s_cmp_eq_u32 s64, 0
    s_cselect_b64 exec, 0, s[32:33]
    v_mov_b32 v27, -1
    s_add_u32 s41, s31, 67108864
    buffer_store_dword v27, v69, s[4:7], s41 offen
    s_add_u32 s41, s31, 67125248
    buffer_store_dword v27, v69, s[4:7], s41 offen
    s_add_u32 s41, s31, 67141632
    buffer_store_dword v27, v69, s[4:7], s41 offen
    s_add_u32 s41, s31, 67158016
    buffer_store_dword v27, v69, s[4:7], s41 offen
    s_mov_b64 exec, -1
    s_waitcnt lgkmcnt(0)
    s_waitcnt vmcnt(12)
    v_add_u32 v55, 147456, v52
    ds_read_b64_tr_b16 v[224:225], v55 offset:0
    ds_read_b64_tr_b16 v[226:227], v55 offset:256
    ds_read_b64_tr_b16 v[228:229], v55 offset:4096
    ds_read_b64_tr_b16 v[230:231], v55 offset:4352
    s_mov_b32 s77, 24576
    s_call_b64 s[82:83], cf_dma
    ds_read_b64_tr_b16 v[240:241], v55 offset:64
    ds_read_b64_tr_b16 v[242:243], v55 offset:320
    ds_read_b64_tr_b16 v[244:245], v55 offset:4160
    ds_read_b64_tr_b16 v[246:247], v55 offset:4416
    s_mov_b32 s77, 32768
    s_call_b64 s[82:83], cf_dma
    s_mov_b64 s[68:69], s[48:49]
    s_mov_b32 s70, 9216
    s_mov_b32 s71, 0x20000
    v_and_b32 v25, 7, v0
    v_mul_u32_u24 v25, 1152, v25
    v_lshrrev_b32 v26, 3, v0
    v_lshl_add_u32 v25, v26, 4, v25
    buffer_load_dwordx4 v[36:39], v25, s[68:71], 0 offen
    buffer_load_dwordx4 v[40:43], v25, s[68:71], 0 offen offset:512
    v_bfe_u32 v25, v0, 2, 3
    v_mul_u32_u24 v25, 1152, v25
    v_lshrrev_b32 v26, 5, v0
    v_lshl_add_u32 v25, v26, 4, v25
    v_and_b32 v26, 3, v0
    v_lshl_add_u32 v25, v26, 2, v25
    buffer_load_dword v44, v25, s[68:71], 0 offen offset:1024
    s_nop 0
    s_waitcnt lgkmcnt(0)
    s_waitcnt vmcnt(15)
    v_add_u32 v55, 98304, v52
    ds_read_b64_tr_b16 v[232:233], v55 offset:0
    ds_read_b64_tr_b16 v[234:235], v55 offset:256
    ds_read_b64_tr_b16 v[236:237], v55 offset:4096
    ds_read_b64_tr_b16 v[238:239], v55 offset:4352
    s_xor_b32 s78, s75, 1048576
    s_add_u32 s78, s78, s67
    s_add_u32 s80, s66, 65536
    s_mov_b32 s76, 0
    s_mov_b32 s77, 8192
    s_call_b64 s[82:83], cf_dma
    ds_read_b64_tr_b16 v[248:249], v55 offset:64
    ds_read_b64_tr_b16 v[250:251], v55 offset:320
    ds_read_b64_tr_b16 v[252:253], v55 offset:4160
    ds_read_b64_tr_b16 v[254:255], v55 offset:4416
    s_mov_b32 s77, 16384
    s_call_b64 s[82:83], cf_dma
    s_mov_b32 s44, 0x3e0293ee
    s_mov_b32 s45, s44
    s_mov_b32 s46, 0x42000000
    s_mov_b32 s60, 0x3f803f80
    s_mov_b32 s61, s60
    s_mov_b32 s62, 0x3e803e80
    s_mov_b32 s63, s62
    s_mov_b32 s28, 0
    s_lshl_b32 s58, s13, 10
    s_add_u32 s58, s58, 102400
    s_lshl_b32 s59, s13, 8
    s_add_u32 s59, s59, 106496
    s_lshl_b32 s24, s12, 14
    s_add_u32 s24, s24, 0
    s_add_u32 s47, s24, 33030144
    s_mul_i32 s40, s13, 3072
    s_add_u32 s23, s24, s40
    s_lshl_b32 s20, s12, 7
    s_add_u32 s20, s20, 67174400
    s_add_u32 s21, s20, 65536
    s_add_u32 s38, s20, 4096
    s_add_u32 s39, s21, 4096
    s_lshl_b32 s22, s12, 7
    s_add_u32 s22, s22, 67182592
    s_waitcnt lgkmcnt(0)
    s_waitcnt vmcnt(15)
    v_add_u32 v55, 32768, v51
    v_xor_b32 v56, 32, v55
    ds_read_b64_tr_b16 v[144:145], v55 offset:0
    ds_read_b64_tr_b16 v[146:147], v55 offset:256
    ds_read_b64_tr_b16 v[148:149], v55 offset:8192
    ds_read_b64_tr_b16 v[150:151], v55 offset:8448
    s_mov_b32 s77, 24576
    s_call_b64 s[82:83], cf_dma
    ds_read_b64_tr_b16 v[152:153], v56 offset:0
    ds_read_b64_tr_b16 v[154:155], v56 offset:256
    ds_read_b64_tr_b16 v[156:157], v56 offset:8192
    ds_read_b64_tr_b16 v[158:159], v56 offset:8448
    s_mov_b32 s77, 32768
    s_call_b64 s[82:83], cf_dma
    s_lshl_b32 s40, s12, 12
    s_add_u32 s25, s40, 79429632
    s_add_u32 s26, s40, 88866816
    s_lshl_b32 s65, s12, 9
    s_add_u32 s65, s65, 90177536
    s_lshl_b32 s40, s13, 5
    s_or_b32 s40, s40, s12
    s_cmp_lt_u32 s40, 24
    s_cselect_b32 s36, 0x1ffffff, 0
    s_mov_b32 s37, 0
    s_lshl_b32 s27, s12, 7
    s_add_u32 s27, s27, 125845504
    s_lshl_b32 s40, s13, 2
    s_add_u32 s27, s27, s40
    v_bfe_u32 v28, v61, 4, 4
    v_bfe_u32 v29, v61, 8, 1
    v_lshlrev_b32 v29, 2, v29
    v_sub_u32 v29, v28, v29
    v_mov_b32 v31, 0x3f80
    v_mov_b32 v32, 0x3f800000
    s_nop 1
    s_waitcnt lgkmcnt(0)
    s_waitcnt vmcnt(11)
    v_add_u32 v55, 114688, v51
    v_xor_b32 v56, 32, v55
    ds_read_b64_tr_b16 a[192:193], v55 offset:0
    ds_read_b64_tr_b16 a[194:195], v55 offset:256
    ds_read_b64_tr_b16 a[196:197], v55 offset:8192
    ds_read_b64_tr_b16 a[198:199], v55 offset:8448
    s_xor_b32 s78, s75, 2097152
    s_add_u32 s78, s78, s67
    s_add_u32 s80, s66, 0
    s_mov_b32 s76, 0
    s_mov_b32 s77, 8192
    s_call_b64 s[82:83], cf_dma
    ds_read_b64_tr_b16 a[200:201], v56 offset:0
    ds_read_b64_tr_b16 a[202:203], v56 offset:256
    ds_read_b64_tr_b16 a[204:205], v56 offset:8192
    ds_read_b64_tr_b16 a[206:207], v56 offset:8448
    s_mov_b32 s77, 16384
    s_call_b64 s[82:83], cf_dma
    v_cmp_eq_u32 vcc, 0, v29
    s_nop 1
    v_cndmask_b32 v16, 0, v31, vcc
    v_cmp_eq_u32 vcc, 1, v29
    s_nop 1
    v_cndmask_b32 v16, v16, v32, vcc
    v_cmp_eq_u32 vcc, 0, v28
    s_nop 1
    v_cndmask_b32 v20, 0, v31, vcc
    v_cmp_eq_u32 vcc, 1, v28
    s_nop 1
    v_cndmask_b32 v20, v20, v32, vcc
    s_nop 1
    s_waitcnt lgkmcnt(0)
    v_add_u32 v55, 131072, v51
    v_xor_b32 v56, 32, v55
    ds_read_b64_tr_b16 a[208:209], v55 offset:0
    ds_read_b64_tr_b16 a[210:211], v55 offset:256
    ds_read_b64_tr_b16 a[212:213], v55 offset:8192
    ds_read_b64_tr_b16 a[214:215], v55 offset:8448
    s_mov_b32 s77, 24576
    s_call_b64 s[82:83], cf_dma
    ds_read_b64_tr_b16 a[216:217], v56 offset:0
    ds_read_b64_tr_b16 a[218:219], v56 offset:256
    ds_read_b64_tr_b16 a[220:221], v56 offset:8192
    ds_read_b64_tr_b16 a[222:223], v56 offset:8448
    s_mov_b32 s77, 32768
    s_call_b64 s[82:83], cf_dma
    v_cmp_eq_u32 vcc, 2, v29
    s_nop 1
    v_cndmask_b32 v17, 0, v31, vcc
    v_cmp_eq_u32 vcc, 3, v29
    s_nop 1
    v_cndmask_b32 v17, v17, v32, vcc
    v_cmp_eq_u32 vcc, 2, v28
    s_nop 1
    v_cndmask_b32 v21, 0, v31, vcc
    v_cmp_eq_u32 vcc, 3, v28
    s_nop 1
    v_cndmask_b32 v21, v21, v32, vcc
    s_nop 1
    s_waitcnt lgkmcnt(0)
    s_waitcnt vmcnt(8)
    v_add_u32 v55, 65536, v51
    v_xor_b32 v56, 32, v55
    ds_read_b64_tr_b16 a[224:225], v55 offset:0
    ds_read_b64_tr_b16 a[226:227], v55 offset:256
    ds_read_b64_tr_b16 a[228:229], v55 offset:8192
    ds_read_b64_tr_b16 a[230:231], v55 offset:8448
    s_cmp_eq_u32 s88, 0
    s_cbranch_scc1 cf_cpe623
    s_lshl_b32 s89, s73, 7
    s_add_u32 s89, s89, 125853696
    v_min_u32 v33, 11, v57
    v_lshlrev_b32 v33, 2, v33
    buffer_load_dword v34, off, s[96:99], 0 offset:64 sc1
    buffer_load_dword v35, v33, s[4:7], s89 offen sc1
cf_cpe623:
    s_xor_b32 s78, s75, 3145728
    s_add_u32 s78, s78, s67
    s_add_u32 s80, s66, 32768
    s_mov_b32 s76, 0
    s_mov_b32 s77, 8192
    s_call_b64 s[82:83], cf_dma
    ds_read_b64_tr_b16 a[232:233], v56 offset:0
    ds_read_b64_tr_b16 a[234:235], v56 offset:256
    ds_read_b64_tr_b16 a[236:237], v56 offset:8192
    ds_read_b64_tr_b16 a[238:239], v56 offset:8448
    s_mov_b32 s77, 16384
    s_call_b64 s[82:83], cf_dma
    v_cmp_eq_u32 vcc, 8, v29
    s_nop 1
    v_cndmask_b32 v18, 0, v31, vcc
    v_cmp_eq_u32 vcc, 9, v29
    s_nop 1
    v_cndmask_b32 v18, v18, v32, vcc
    v_cmp_eq_u32 vcc, 4, v28
    s_nop 1
    v_cndmask_b32 v22, 0, v31, vcc
    v_cmp_eq_u32 vcc, 5, v28
    s_nop 1
    v_cndmask_b32 v22, v22, v32, vcc
    s_nop 1
    s_waitcnt lgkmcnt(0)
    v_add_u32 v55, 81920, v51
    v_xor_b32 v56, 32, v55
    ds_read_b64_tr_b16 a[240:241], v55 offset:0
    ds_read_b64_tr_b16 a[242:243], v55 offset:256
    ds_read_b64_tr_b16 a[244:245], v55 offset:8192
    ds_read_b64_tr_b16 a[246:247], v55 offset:8448
    s_mov_b32 s77, 24576
    s_call_b64 s[82:83], cf_dma
    ds_read_b64_tr_b16 a[248:249], v56 offset:0
    ds_read_b64_tr_b16 a[250:251], v56 offset:256
    ds_read_b64_tr_b16 a[252:253], v56 offset:8192
    ds_read_b64_tr_b16 a[254:255], v56 offset:8448
    s_mov_b32 s77, 32768
    s_call_b64 s[82:83], cf_dma
    v_cmp_eq_u32 vcc, 10, v29
    s_nop 1
    v_cndmask_b32 v19, 0, v31, vcc
    v_cmp_eq_u32 vcc, 11, v29
    s_nop 1
    v_cndmask_b32 v19, v19, v32, vcc
    v_cmp_eq_u32 vcc, 6, v28
    s_nop 1
    v_cndmask_b32 v23, 0, v31, vcc
    v_cmp_eq_u32 vcc, 7, v28
    s_nop 1
    v_cndmask_b32 v23, v23, v32, vcc
    s_nop 1
    s_waitcnt lgkmcnt(0)
    s_waitcnt vmcnt(8)
    v_add_u32 v55, 0, v51
    v_xor_b32 v56, 32, v55
    ds_read_b64_tr_b16 v[80:81], v55 offset:0
    ds_read_b64_tr_b16 v[82:83], v55 offset:256
    ds_read_b64_tr_b16 v[84:85], v55 offset:8192
    ds_read_b64_tr_b16 v[86:87], v55 offset:8448
    s_cmp_eq_u32 s88, 0
    s_cbranch_scc1 cf_ncp693
    s_waitcnt vmcnt(8)
    v_max_u32 v34, 1, v34
    v_cmp_eq_u32 vcc, 1, v34
    s_cbranch_vccnz cf_ncp693
    v_cmp_ne_u32 vcc, v34, v35
    s_cbranch_vccnz cf_ncp693
    s_mov_b32 s88, 0
    s_mov_b32 s72, 5
    s_lshl_b32 s74, s73, 19
    s_add_u32 s74, s74, 96468992
    s_add_u32 s50, s4, s74
    s_addc_u32 s51, s5, 0
    s_add_u32 s52, s50, 147456
    s_addc_u32 s53, s51, 0
    s_lshl_b32 s67, s13, 6
    v_and_b32 v54, 63, v48
    v_lshrrev_b32 v48, 13, v48
    v_lshl_add_u32 v48, v48, 8, v54
cf_ncp693:
    s_cmp_eq_u32 s88, 0
    s_cbranch_scc1 cf_cpe714
    s_lshl_b32 s89, s73, 7
    s_add_u32 s89, s89, 125853696
    v_min_u32 v33, 11, v57
    v_lshlrev_b32 v33, 2, v33
    buffer_load_dword v34, off, s[96:99], 0 offset:64 sc1
    buffer_load_dword v35, v33, s[4:7], s89 offen sc1
cf_cpe714:
    s_xor_b32 s78, s75, 2097152
    s_lshr_b32 s78, s78, s72
    s_add_u32 s78, s78, s67
    s_mov_b64 s[8:9], s[52:53]
    v_mov_b32 v58, v48
    s_lshr_b32 s79, 131072, s72
    s_add_u32 s80, s66, 131072
    s_mov_b32 s76, 0
    s_mov_b32 s77, 8192
    s_call_b64 s[82:83], cf_dma
    ds_read_b64_tr_b16 v[88:89], v56 offset:0
    ds_read_b64_tr_b16 v[90:91], v56 offset:256
    ds_read_b64_tr_b16 v[92:93], v56 offset:8192
    ds_read_b64_tr_b16 v[94:95], v56 offset:8448
    s_mov_b32 s77, 16384
    s_call_b64 s[82:83], cf_dma
    v_mov_b32 v46, 1
    s_mov_b64 exec, 1
    buffer_atomic_add v46, off, s[96:99], 0 offset:132 sc0
    s_mov_b64 exec, -1
    s_waitcnt lgkmcnt(0)
    v_add_u32 v55, 16384, v51
    v_xor_b32 v56, 32, v55
    ds_read_b64_tr_b16 v[96:97], v55 offset:0
    ds_read_b64_tr_b16 v[98:99], v55 offset:256
    ds_read_b64_tr_b16 v[100:101], v55 offset:8192
    ds_read_b64_tr_b16 v[102:103], v55 offset:8448
    s_mov_b32 s77, 24576
    s_call_b64 s[82:83], cf_dma
    ds_read_b64_tr_b16 v[104:105], v56 offset:0
    ds_read_b64_tr_b16 v[106:107], v56 offset:256
    ds_read_b64_tr_b16 v[108:109], v56 offset:8192
    ds_read_b64_tr_b16 v[110:111], v56 offset:8448
    s_mov_b32 s77, 32768
    s_call_b64 s[82:83], cf_dma
    s_waitcnt lgkmcnt(0)
    s_waitcnt vmcnt(9)
    v_add_u32 v55, 32768, v51
    v_xor_b32 v56, 32, v55
    ds_read_b64_tr_b16 v[112:113], v55 offset:0
    ds_read_b64_tr_b16 v[114:115], v55 offset:256
    ds_read_b64_tr_b16 v[116:117], v55 offset:8192
    ds_read_b64_tr_b16 v[118:119], v55 offset:8448
    s_cmp_eq_u32 s88, 0
    s_cbranch_scc1 cf_ncp766
    s_waitcnt vmcnt(9)
    v_max_u32 v34, 1, v34
    v_cmp_eq_u32 vcc, 1, v34
    s_cbranch_vccnz cf_ncp766
    v_cmp_ne_u32 vcc, v34, v35
    s_cbranch_vccnz cf_ncp766
    s_mov_b32 s88, 0
    s_mov_b32 s72, 5
    s_lshl_b32 s74, s73, 19
    s_add_u32 s74, s74, 96468992
    s_add_u32 s50, s4, s74
    s_addc_u32 s51, s5, 0
    s_add_u32 s52, s50, 147456
    s_addc_u32 s53, s51, 0
    s_lshl_b32 s67, s13, 6
    v_and_b32 v54, 63, v48
    v_lshrrev_b32 v48, 13, v48
    v_lshl_add_u32 v48, v48, 8, v54
cf_ncp766:
    s_cmp_eq_u32 s88, 0
    s_cbranch_scc1 cf_cpe787
    s_lshl_b32 s89, s73, 7
    s_add_u32 s89, s89, 125853696
    v_min_u32 v33, 11, v57
    v_lshlrev_b32 v33, 2, v33
    buffer_load_dword v34, off, s[96:99], 0 offset:64 sc1
    buffer_load_dword v35, v33, s[4:7], s89 offen sc1
cf_cpe787:
    s_xor_b32 s78, s75, 3145728
    s_lshr_b32 s78, s78, s72
    s_add_u32 s78, s78, s67
    s_mov_b64 s[8:9], s[52:53]
    v_mov_b32 v58, v48
    s_lshr_b32 s79, 131072, s72
    s_add_u32 s80, s66, 65536
    s_mov_b32 s76, 0
    s_mov_b32 s77, 8192
    s_call_b64 s[82:83], cf_dma
    ds_read_b64_tr_b16 v[120:121], v56 offset:0
    ds_read_b64_tr_b16 v[122:123], v56 offset:256
    ds_read_b64_tr_b16 v[124:125], v56 offset:8192
    ds_read_b64_tr_b16 v[126:127], v56 offset:8448
    s_mov_b32 s77, 16384
    s_call_b64 s[82:83], cf_dma
    s_waitcnt lgkmcnt(0)
    v_add_u32 v55, 49152, v51
    v_xor_b32 v56, 32, v55
    ds_read_b64_tr_b16 v[128:129], v55 offset:0
    ds_read_b64_tr_b16 v[130:131], v55 offset:256
    ds_read_b64_tr_b16 v[132:133], v55 offset:8192
    ds_read_b64_tr_b16 v[134:135], v55 offset:8448
    s_mov_b32 s77, 24576
    s_call_b64 s[82:83], cf_dma
    ds_read_b64_tr_b16 v[136:137], v56 offset:0
    ds_read_b64_tr_b16 v[138:139], v56 offset:256
    ds_read_b64_tr_b16 v[140:141], v56 offset:8192
    ds_read_b64_tr_b16 v[142:143], v56 offset:8448
    s_mov_b32 s77, 32768
    s_call_b64 s[82:83], cf_dma
    s_waitcnt lgkmcnt(0)
    s_waitcnt vmcnt(8)
    v_add_u32 v55, 131072, v51
    v_xor_b32 v56, 32, v55
    ds_read_b64_tr_b16 a[128:129], v55 offset:0
    ds_read_b64_tr_b16 a[130:131], v55 offset:256
    ds_read_b64_tr_b16 a[132:133], v55 offset:8192
    ds_read_b64_tr_b16 a[134:135], v55 offset:8448
    s_cmp_eq_u32 s88, 0
    s_cbranch_scc1 cf_ncp835
    s_waitcnt vmcnt(8)
    v_max_u32 v34, 1, v34
    v_cmp_eq_u32 vcc, 1, v34
    s_cbranch_vccnz cf_ncp835
    v_cmp_ne_u32 vcc, v34, v35
    s_cbranch_vccnz cf_ncp835
    s_mov_b32 s88, 0
    s_mov_b32 s72, 5
    s_lshl_b32 s74, s73, 19
    s_add_u32 s74, s74, 96468992
    s_add_u32 s50, s4, s74
    s_addc_u32 s51, s5, 0
    s_add_u32 s52, s50, 147456
    s_addc_u32 s53, s51, 0
    s_lshl_b32 s67, s13, 6
    v_and_b32 v54, 63, v48
    v_lshrrev_b32 v48, 13, v48
    v_lshl_add_u32 v48, v48, 8, v54
cf_ncp835:
    s_cmp_eq_u32 s88, 0
    s_cbranch_scc1 cf_cpe856
    s_lshl_b32 s89, s73, 7
    s_add_u32 s89, s89, 125853696
    v_min_u32 v33, 11, v57
    v_lshlrev_b32 v33, 2, v33
    buffer_load_dword v34, off, s[96:99], 0 offset:64 sc1
    buffer_load_dword v35, v33, s[4:7], s89 offen sc1
cf_cpe856:
    s_xor_b32 s78, s75, 2097152
    s_lshr_b32 s78, s78, s72
    s_add_u32 s78, s78, s67
    s_mov_b64 s[8:9], s[50:51]
    v_mov_b32 v58, v48
    s_lshr_b32 s79, 131072, s72
    s_add_u32 s80, s66, 0
    s_mov_b32 s76, 0
    s_mov_b32 s77, 8192
    s_call_b64 s[82:83], cf_dma
    ds_read_b64_tr_b16 a[136:137], v56 offset:0
    ds_read_b64_tr_b16 a[138:139], v56 offset:256
    ds_read_b64_tr_b16 a[140:141], v56 offset:8192
    ds_read_b64_tr_b16 a[142:143], v56 offset:8448
    s_mov_b32 s77, 16384
    s_call_b64 s[82:83], cf_dma
    s_waitcnt lgkmcnt(0)
    v_add_u32 v55, 147456, v51
    v_xor_b32 v56, 32, v55
    ds_read_b64_tr_b16 a[144:145], v55 offset:0
    ds_read_b64_tr_b16 a[146:147], v55 offset:256
    ds_read_b64_tr_b16 a[148:149], v55 offset:8192
    ds_read_b64_tr_b16 a[150:151], v55 offset:8448
    s_mov_b32 s77, 24576
    s_call_b64 s[82:83], cf_dma
    ds_read_b64_tr_b16 a[152:153], v56 offset:0
    ds_read_b64_tr_b16 a[154:155], v56 offset:256
    ds_read_b64_tr_b16 a[156:157], v56 offset:8192
    ds_read_b64_tr_b16 a[158:159], v56 offset:8448
    s_mov_b32 s77, 32768
    s_call_b64 s[82:83], cf_dma
    s_waitcnt lgkmcnt(0)
    s_waitcnt vmcnt(8)
    v_add_u32 v55, 65536, v51
    v_xor_b32 v56, 32, v55
    ds_read_b64_tr_b16 a[160:161], v55 offset:0
    ds_read_b64_tr_b16 a[162:163], v55 offset:256
    ds_read_b64_tr_b16 a[164:165], v55 offset:8192
    ds_read_b64_tr_b16 a[166:167], v55 offset:8448
    s_cmp_eq_u32 s88, 0
    s_cbranch_scc1 cf_ncp904
    s_waitcnt vmcnt(8)
    v_max_u32 v34, 1, v34
    v_cmp_eq_u32 vcc, 1, v34
    s_cbranch_vccnz cf_ncp904
    v_cmp_ne_u32 vcc, v34, v35
    s_cbranch_vccnz cf_ncp904
    s_mov_b32 s88, 0
    s_mov_b32 s72, 5
    s_lshl_b32 s74, s73, 19
    s_add_u32 s74, s74, 96468992
    s_add_u32 s50, s4, s74
    s_addc_u32 s51, s5, 0
    s_add_u32 s52, s50, 147456
    s_addc_u32 s53, s51, 0
    s_lshl_b32 s67, s13, 6
    v_and_b32 v54, 63, v48
    v_lshrrev_b32 v48, 13, v48
    v_lshl_add_u32 v48, v48, 8, v54
cf_ncp904:
    s_cmp_eq_u32 s88, 0
    s_cbranch_scc1 cf_cpe925
    s_lshl_b32 s89, s73, 7
    s_add_u32 s89, s89, 125853696
    v_min_u32 v33, 11, v57
    v_lshlrev_b32 v33, 2, v33
    buffer_load_dword v34, off, s[96:99], 0 offset:64 sc1
    buffer_load_dword v35, v33, s[4:7], s89 offen sc1
cf_cpe925:
    s_xor_b32 s78, s75, 3145728
    s_lshr_b32 s78, s78, s72
    s_add_u32 s78, s78, s67
    s_mov_b64 s[8:9], s[50:51]
    v_mov_b32 v58, v48
    s_lshr_b32 s79, 131072, s72
    s_add_u32 s80, s66, 32768
    s_mov_b32 s76, 0
    s_mov_b32 s77, 8192
    s_call_b64 s[82:83], cf_dma
    ds_read_b64_tr_b16 a[168:169], v56 offset:0
    ds_read_b64_tr_b16 a[170:171], v56 offset:256
    ds_read_b64_tr_b16 a[172:173], v56 offset:8192
    ds_read_b64_tr_b16 a[174:175], v56 offset:8448
    s_mov_b32 s77, 16384
    s_call_b64 s[82:83], cf_dma
    v_readfirstlane_b32 s41, v46
    v_mov_b32 v46, 1
    v_mov_b32 v47, 0
    s_cmp_eq_u32 s41, 127
    s_cselect_b64 exec, 1, 0
    buffer_atomic_cmpswap v[46:47], off, s[96:99], 0 offset:140
    s_mov_b64 exec, -1
    s_waitcnt lgkmcnt(0)
    v_add_u32 v55, 81920, v51
    v_xor_b32 v56, 32, v55
    ds_read_b64_tr_b16 a[176:177], v55 offset:0
    ds_read_b64_tr_b16 a[178:179], v55 offset:256
    ds_read_b64_tr_b16 a[180:181], v55 offset:8192
    ds_read_b64_tr_b16 a[182:183], v55 offset:8448
    s_mov_b32 s77, 24576
    s_call_b64 s[82:83], cf_dma
    ds_read_b64_tr_b16 a[184:185], v56 offset:0
    ds_read_b64_tr_b16 a[186:187], v56 offset:256
    ds_read_b64_tr_b16 a[188:189], v56 offset:8192
    ds_read_b64_tr_b16 a[190:191], v56 offset:8448
    s_mov_b32 s77, 32768
    s_call_b64 s[82:83], cf_dma
    s_waitcnt lgkmcnt(0)
    s_waitcnt vmcnt(8)
    v_add_u32 v55, 0, v51
    v_xor_b32 v56, 32, v55
    ds_read_b64_tr_b16 a[48:49], v55 offset:0
    ds_read_b64_tr_b16 a[50:51], v55 offset:256
    ds_read_b64_tr_b16 a[52:53], v55 offset:8192
    ds_read_b64_tr_b16 a[54:55], v55 offset:8448
    s_lshr_b32 s78, 4194304, s72
    s_add_u32 s78, s78, s67
    s_mov_b32 s81, 0
    s_add_u32 s80, s66, 98304
    s_mov_b32 s76, 0
    s_mov_b32 s77, 8192
    s_call_b64 s[82:83], cf_dma
    ds_read_b64_tr_b16 a[56:57], v56 offset:0
    ds_read_b64_tr_b16 a[58:59], v56 offset:256
    ds_read_b64_tr_b16 a[60:61], v56 offset:8192
    ds_read_b64_tr_b16 a[62:63], v56 offset:8448
    s_mov_b32 s77, 16384
    s_call_b64 s[82:83], cf_dma
    s_waitcnt lgkmcnt(0)
    v_add_u32 v55, 16384, v51
    v_xor_b32 v56, 32, v55
    ds_read_b64_tr_b16 a[64:65], v55 offset:0
    ds_read_b64_tr_b16 a[66:67], v55 offset:256
    ds_read_b64_tr_b16 a[68:69], v55 offset:8192
    ds_read_b64_tr_b16 a[70:71], v55 offset:8448
    s_cmp_eq_u32 s88, 0
    s_cbranch_scc1 cf_ncp1000
    s_waitcnt vmcnt(12)
    v_max_u32 v34, 1, v34
    v_cmp_eq_u32 vcc, 1, v34
    s_cbranch_vccnz cf_ncp1000
    v_cmp_ne_u32 vcc, v34, v35
    s_cbranch_vccnz cf_ncp1000
    s_mov_b32 s88, 0
    s_mov_b32 s72, 5
    s_lshl_b32 s74, s73, 19
    s_add_u32 s74, s74, 96468992
    s_add_u32 s50, s4, s74
    s_addc_u32 s51, s5, 0
    s_add_u32 s52, s50, 147456
    s_addc_u32 s53, s51, 0
    s_lshl_b32 s67, s13, 6
    v_and_b32 v54, 63, v48
    v_lshrrev_b32 v48, 13, v48
    v_lshl_add_u32 v48, v48, 8, v54
cf_ncp1000:
    s_xor_b32 s78, s75, 1048576
    s_lshr_b32 s78, s78, s72
    s_add_u32 s78, s78, s67
    s_mov_b64 s[8:9], s[50:51]
    v_mov_b32 v58, v48
    s_lshr_b32 s79, 131072, s72
    s_mov_b32 s81, s93
    s_add_u32 s80, s66, 114688
    s_mov_b32 s76, 0
    s_mov_b32 s77, 8192
    s_call_b64 s[82:83], cf_dma
    ds_read_b64_tr_b16 a[72:73], v56 offset:0
    ds_read_b64_tr_b16 a[74:75], v56 offset:256
    ds_read_b64_tr_b16 a[76:77], v56 offset:8192
    ds_read_b64_tr_b16 a[78:79], v56 offset:8448
    s_mov_b32 s77, 16384
    s_call_b64 s[82:83], cf_dma
    s_waitcnt lgkmcnt(0)
    s_waitcnt vmcnt(8)
    v_add_u32 v55, 32768, v51
    v_xor_b32 v56, 32, v55
    ds_read_b64_tr_b16 a[80:81], v55 offset:0
    ds_read_b64_tr_b16 a[82:83], v55 offset:256
    ds_read_b64_tr_b16 a[84:85], v55 offset:8192
    ds_read_b64_tr_b16 a[86:87], v55 offset:8448
    s_mov_b32 s77, 24576
    s_call_b64 s[82:83], cf_dma
    ds_read_b64_tr_b16 a[88:89], v56 offset:0
    ds_read_b64_tr_b16 a[90:91], v56 offset:256
    ds_read_b64_tr_b16 a[92:93], v56 offset:8192
    ds_read_b64_tr_b16 a[94:95], v56 offset:8448
    s_mov_b32 s77, 32768
    s_call_b64 s[82:83], cf_dma
    s_waitcnt lgkmcnt(0)
    v_add_u32 v55, 49152, v51
    v_xor_b32 v56, 32, v55
    ds_read_b64_tr_b16 a[96:97], v55 offset:0
    ds_read_b64_tr_b16 a[98:99], v55 offset:256
    ds_read_b64_tr_b16 a[100:101], v55 offset:8192
    ds_read_b64_tr_b16 a[102:103], v55 offset:8448
    s_xor_b32 s78, s75, 0
    s_lshr_b32 s78, s78, s72
    s_add_u32 s78, s78, s67
    s_add_u32 s80, s66, 65536
    s_mov_b32 s76, 0
    s_mov_b32 s77, 8192
    s_call_b64 s[82:83], cf_dma
    ds_read_b64_tr_b16 a[104:105], v56 offset:0
    ds_read_b64_tr_b16 a[106:107], v56 offset:256
    ds_read_b64_tr_b16 a[108:109], v56 offset:8192
    ds_read_b64_tr_b16 a[110:111], v56 offset:8448
    s_mov_b32 s77, 16384
    s_call_b64 s[82:83], cf_dma
    s_waitcnt lgkmcnt(0)
    s_waitcnt vmcnt(12)
    v_add_u32 v55, 98304, v51
    v_xor_b32 v56, 32, v55
    ds_read_b64_tr_b16 a[112:113], v55 offset:0
    ds_read_b64_tr_b16 a[114:115], v55 offset:256
    ds_read_b64_tr_b16 a[116:117], v55 offset:8192
    ds_read_b64_tr_b16 a[118:119], v55 offset:8448
    s_mov_b32 s77, 24576
    s_call_b64 s[82:83], cf_dma
    ds_read_b64_tr_b16 a[120:121], v56 offset:0
    ds_read_b64_tr_b16 a[122:123], v56 offset:256
    ds_read_b64_tr_b16 a[124:125], v56 offset:8192
    ds_read_b64_tr_b16 a[126:127], v56 offset:8448
    s_mov_b32 s77, 32768
    s_call_b64 s[82:83], cf_dma
    s_waitcnt lgkmcnt(0)
    s_waitcnt vmcnt(8)
    v_add_u32 v55, 114688, v51
    v_xor_b32 v56, 32, v55
    ds_read_b64_tr_b16 a[16:17], v55 offset:0
    ds_read_b64_tr_b16 a[18:19], v55 offset:256
    ds_read_b64_tr_b16 a[20:21], v55 offset:8192
    ds_read_b64_tr_b16 a[22:23], v55 offset:8448
    s_xor_b32 s78, s75, 0
    s_lshr_b32 s78, s78, s72
    s_add_u32 s78, s78, s67
    s_mov_b64 s[8:9], s[52:53]
    s_add_u32 s80, s66, 0
    s_mov_b32 s76, 0
    s_mov_b32 s77, 8192
    s_call_b64 s[82:83], cf_dma
    ds_read_b64_tr_b16 a[24:25], v56 offset:0
    ds_read_b64_tr_b16 a[26:27], v56 offset:256
    ds_read_b64_tr_b16 a[28:29], v56 offset:8192
    ds_read_b64_tr_b16 a[30:31], v56 offset:8448
    s_mov_b32 s77, 16384
    s_call_b64 s[82:83], cf_dma
    s_waitcnt lgkmcnt(0)
    v_add_u32 v55, 131072, v51
    v_xor_b32 v56, 32, v55
    ds_read_b64_tr_b16 a[32:33], v55 offset:0
    ds_read_b64_tr_b16 a[34:35], v55 offset:256
    ds_read_b64_tr_b16 a[36:37], v55 offset:8192
    ds_read_b64_tr_b16 a[38:39], v55 offset:8448
    s_mov_b32 s77, 24576
    s_call_b64 s[82:83], cf_dma
    ds_read_b64_tr_b16 a[40:41], v56 offset:0
    ds_read_b64_tr_b16 a[42:43], v56 offset:256
    ds_read_b64_tr_b16 a[44:45], v56 offset:8192
    ds_read_b64_tr_b16 a[46:47], v56 offset:8448
    s_mov_b32 s77, 32768
    s_call_b64 s[82:83], cf_dma
    s_waitcnt lgkmcnt(0)
    s_waitcnt vmcnt(8)
    v_add_u32 v55, 65536, v51
    v_xor_b32 v56, 32, v55
    ds_read_b64_tr_b16 v[0:1], v55 offset:0
    ds_read_b64_tr_b16 v[2:3], v55 offset:256
    ds_read_b64_tr_b16 v[4:5], v55 offset:8192
    ds_read_b64_tr_b16 v[6:7], v55 offset:8448
    s_xor_b32 s78, s75, 1048576
    s_lshr_b32 s78, s78, s72
    s_add_u32 s78, s78, s67
    s_add_u32 s80, s66, 32768
    s_mov_b32 s76, 0
    s_mov_b32 s77, 8192
    s_call_b64 s[82:83], cf_dma
    ds_read_b64_tr_b16 v[8:9], v56 offset:0
    ds_read_b64_tr_b16 v[10:11], v56 offset:256
    ds_read_b64_tr_b16 v[12:13], v56 offset:8192
    ds_read_b64_tr_b16 v[14:15], v56 offset:8448
    s_mov_b32 s77, 16384
    s_call_b64 s[82:83], cf_dma
    s_waitcnt lgkmcnt(0)
    ds_write_b128 v62, v[0:3] offset:8192
    ds_write_b128 v62, v[4:7] offset:12288
    ds_write_b128 v62, v[8:11] offset:16384
    ds_write_b128 v62, v[12:15] offset:20480
    s_waitcnt lgkmcnt(0)
    v_add_u32 v55, 81920, v51
    v_xor_b32 v56, 32, v55
    ds_read_b64_tr_b16 a[0:1], v55 offset:0
    ds_read_b64_tr_b16 a[2:3], v55 offset:256
    ds_read_b64_tr_b16 a[4:5], v55 offset:8192
    ds_read_b64_tr_b16 a[6:7], v55 offset:8448
    s_mov_b32 s77, 24576
    s_call_b64 s[82:83], cf_dma
    ds_read_b64_tr_b16 a[8:9], v56 offset:0
    ds_read_b64_tr_b16 a[10:11], v56 offset:256
    ds_read_b64_tr_b16 a[12:13], v56 offset:8192
    ds_read_b64_tr_b16 a[14:15], v56 offset:8448
    s_mov_b32 s77, 32768
    s_call_b64 s[82:83], cf_dma
    s_waitcnt lgkmcnt(0)
    s_waitcnt vmcnt(8)
    v_add_u32 v55, 0, v51
    v_xor_b32 v56, 32, v55
    ds_read_b64_tr_b16 v[0:1], v55 offset:0
    ds_read_b64_tr_b16 v[2:3], v55 offset:256
    ds_read_b64_tr_b16 v[4:5], v55 offset:8192
    ds_read_b64_tr_b16 v[6:7], v55 offset:8448
    s_xor_b32 s94, s13, 0
    s_mul_i32 s94, s94, 36864
    s_add_u32 s94, s94, s92
    s_lshr_b32 s74, s13, 1
    s_lshl_b32 s74, s74, 6
    s_add_u32 s94, s94, s74
    s_add_u32 s78, s94, 1024
    s_mov_b64 s[8:9], s[56:57]
    v_mov_b32 v58, v50
    s_mov_b32 s79, 18432
    s_mov_b32 s81, 0
    s_add_u32 s80, s66, 147456
    s_mov_b32 s76, 0
    s_mov_b32 s77, 8192
    s_call_b64 s[82:83], cf_dma
    ds_read_b64_tr_b16 v[8:9], v56 offset:0
    ds_read_b64_tr_b16 v[10:11], v56 offset:256
    ds_read_b64_tr_b16 v[12:13], v56 offset:8192
    ds_read_b64_tr_b16 v[14:15], v56 offset:8448
    s_xor_b32 s94, s13, 2
    s_mul_i32 s94, s94, 36864
    s_add_u32 s94, s94, s92
    s_lshr_b32 s74, s13, 1
    s_lshl_b32 s74, s74, 6
    s_add_u32 s94, s94, s74
    s_add_u32 s78, s94, 1024
    s_mov_b32 s77, 16384
    s_call_b64 s[82:83], cf_dma
    s_waitcnt lgkmcnt(0)
    ds_write_b128 v61, v[0:3] offset:0
    ds_write_b128 v61, v[4:7] offset:4096
    ds_write_b128 v61, v[8:11] offset:8192
    ds_write_b128 v61, v[12:15] offset:12288
    s_waitcnt lgkmcnt(0)
    v_add_u32 v55, 16384, v51
    v_xor_b32 v56, 32, v55
    ds_read_b64_tr_b16 v[0:1], v55 offset:0
    ds_read_b64_tr_b16 v[2:3], v55 offset:256
    ds_read_b64_tr_b16 v[4:5], v55 offset:8192
    ds_read_b64_tr_b16 v[6:7], v55 offset:8448
    s_xor_b32 s94, s13, 3
    s_mul_i32 s94, s94, 36864
    s_add_u32 s94, s94, s92
    s_lshl_b32 s74, s13, 7
    s_add_u32 s94, s94, s74
    s_add_u32 s78, s94, 512
    v_mov_b32 v58, v49
    s_mov_b32 s79, 9216
    s_add_u32 s80, s66, 131072
    s_mov_b32 s76, 0
    s_mov_b32 s77, 8192
    s_call_b64 s[82:83], cf_dma
    ds_read_b64_tr_b16 v[8:9], v56 offset:0
    ds_read_b64_tr_b16 v[10:11], v56 offset:256
    ds_read_b64_tr_b16 v[12:13], v56 offset:8192
    ds_read_b64_tr_b16 v[14:15], v56 offset:8448
    s_mov_b32 s77, 16384
    s_call_b64 s[82:83], cf_dma
    s_waitcnt lgkmcnt(0)
    ds_write_b128 v61, v[0:3] offset:16384
    ds_write_b128 v61, v[4:7] offset:20480
    ds_write_b128 v61, v[8:11] offset:24576
    ds_write_b128 v61, v[12:15] offset:28672
    s_waitcnt lgkmcnt(0)
    s_waitcnt vmcnt(8)
    v_add_u32 v55, 32768, v51
    v_xor_b32 v56, 32, v55
    ds_read_b64_tr_b16 v[0:1], v55 offset:0
    ds_read_b64_tr_b16 v[2:3], v55 offset:256
    ds_read_b64_tr_b16 v[4:5], v55 offset:8192
    ds_read_b64_tr_b16 v[6:7], v55 offset:8448
    s_xor_b32 s94, s13, 2
    s_mul_i32 s94, s94, 36864
    s_add_u32 s94, s94, s92
    s_lshl_b32 s74, s13, 7
    s_add_u32 s94, s94, s74
    s_add_u32 s78, s94, 512
    s_add_u32 s80, s66, 114688
    s_mov_b32 s76, 0
    s_mov_b32 s77, 8192
    s_call_b64 s[82:83], cf_dma
    ds_read_b64_tr_b16 v[8:9], v56 offset:0
    ds_read_b64_tr_b16 v[10:11], v56 offset:256
    ds_read_b64_tr_b16 v[12:13], v56 offset:8192
    ds_read_b64_tr_b16 v[14:15], v56 offset:8448
    s_mov_b32 s77, 16384
    s_call_b64 s[82:83], cf_dma
    s_waitcnt lgkmcnt(0)
    ds_write_b128 v61, v[0:3] offset:32768
    ds_write_b128 v61, v[4:7] offset:36864
    ds_write_b128 v61, v[8:11] offset:40960
    ds_write_b128 v61, v[12:15] offset:45056
    s_waitcnt lgkmcnt(0)
    v_add_u32 v55, 49152, v51
    v_xor_b32 v56, 32, v55
    ds_read_b64_tr_b16 v[0:1], v55 offset:0
    ds_read_b64_tr_b16 v[2:3], v55 offset:256
    ds_read_b64_tr_b16 v[4:5], v55 offset:8192
    ds_read_b64_tr_b16 v[6:7], v55 offset:8448
    s_lshr_b32 s78, 4194304, s72
    s_add_u32 s78, s78, s67
    s_mov_b64 s[8:9], s[52:53]
    v_mov_b32 v58, v48
    s_lshr_b32 s79, 131072, s72
    s_add_u32 s80, s66, 81920
    s_mov_b32 s76, 0
    s_mov_b32 s77, 8192
    s_call_b64 s[82:83], cf_dma
    ds_read_b64_tr_b16 v[8:9], v56 offset:0
    ds_read_b64_tr_b16 v[10:11], v56 offset:256
    ds_read_b64_tr_b16 v[12:13], v56 offset:8192
    ds_read_b64_tr_b16 v[14:15], v56 offset:8448
    s_mov_b32 s77, 16384
    s_call_b64 s[82:83], cf_dma
    s_waitcnt lgkmcnt(0)
    ds_write_b128 v61, v[0:3] offset:49152
    ds_write_b128 v61, v[4:7] offset:53248
    ds_write_b128 v61, v[8:11] offset:57344
    ds_write_b128 v61, v[12:15] offset:61440
    s_waitcnt lgkmcnt(0)
    buffer_load_dword v24, off, s[96:99], 0 offset:140 sc1
    buffer_load_dword v25, off, s[96:99], 0 offset:64 sc1
    s_lshr_b32 s84, s12, 1
    s_lshl_b32 s84, s84, 8
    s_add_u32 s84, s84, 125829120
    v_bfe_u32 v26, v61, 4, 6
    v_min_u32 v26, 11, v26
    v_lshlrev_b32 v26, 2, v26
    buffer_load_dword v27, v26, s[4:7], s84 offen sc1
    s_waitcnt vmcnt(15)
    v_add_u32 v55, 147456, v53
    ds_read_b64_tr_b16 v[0:1], v55 offset:0
    ds_read_b64_tr_b16 v[2:3], v55 offset:128
    ds_read_b64_tr_b16 v[4:5], v55 offset:512
    ds_read_b64_tr_b16 v[6:7], v55 offset:640
    ds_read_b64_tr_b16 v[8:9], v55 offset:8192
    ds_read_b64_tr_b16 v[10:11], v55 offset:8320
    ds_read_b64_tr_b16 v[12:13], v55 offset:8704
    ds_read_b64_tr_b16 v[14:15], v55 offset:8832
    s_waitcnt lgkmcnt(0)
    s_barrier
    ds_write_b128 v63, v[0:3] offset:49152
    ds_write_b128 v63, v[4:7] offset:53248
    s_barrier
    ds_write_b128 v63, v[8:11] offset:57344
    ds_write_b128 v63, v[12:15] offset:61440
    s_waitcnt lgkmcnt(0)
    v_lshlrev_b32 v45, 3, v61
    s_lshl_b32 s40, s12, 14
    s_add_u32 s40, s40, 65536
    s_lshl_b32 s41, s12, 11
    s_sub_u32 s41, s41, 12288
    v_add_u32 v30, s40, v45
    v_add_u32 v45, s41, v45
    v_cmp_gt_u32 vcc, 1536, v61
    s_nop 1
    v_cndmask_b32 v45, v45, v30, vcc
    s_lshl_b32 s40, s12, 16
    s_add_u32 s40, s40, 25151488
    v_lshlrev_b32 v30, 3, v61
    v_add_u32 v30, s40, v30
    v_cmp_gt_u32 vcc, 1792, v61
    s_nop 1
    v_cndmask_b32 v45, v30, v45, vcc
    v_cmp_gt_u32 vcc, 2944, v61
    s_mov_b32 s40, 67108864
    s_mov_b64 exec, vcc
    buffer_load_dword v30, v45, s[4:7], s40 offen sc1
    s_mov_b64 exec, -1
    s_waitcnt vmcnt(11)
    v_add_u32 v55, 131072, v52
    ds_read_b64_tr_b16 v[0:1], v55 offset:0
    ds_read_b64_tr_b16 v[2:3], v55 offset:256
    ds_read_b64_tr_b16 v[4:5], v55 offset:4096
    ds_read_b64_tr_b16 v[6:7], v55 offset:4352
    ds_read_b64_tr_b16 v[8:9], v55 offset:64
    ds_read_b64_tr_b16 v[10:11], v55 offset:320
    ds_read_b64_tr_b16 v[12:13], v55 offset:4160
    ds_read_b64_tr_b16 v[14:15], v55 offset:4416
    s_waitcnt lgkmcnt(0)
    s_barrier
    ds_write_b128 v63, v[0:3] offset:32768
    ds_write_b128 v63, v[4:7] offset:36864
    s_barrier
    ds_write_b128 v63, v[8:11] offset:40960
    ds_write_b128 v63, v[12:15] offset:45056
    s_waitcnt lgkmcnt(0)
    s_waitcnt vmcnt(7)
    v_add_u32 v55, 114688, v52
    ds_read_b64_tr_b16 v[0:1], v55 offset:0
    ds_read_b64_tr_b16 v[2:3], v55 offset:256
    ds_read_b64_tr_b16 v[4:5], v55 offset:4096
    ds_read_b64_tr_b16 v[6:7], v55 offset:4352
    ds_read_b64_tr_b16 v[8:9], v55 offset:64
    ds_read_b64_tr_b16 v[10:11], v55 offset:320
    ds_read_b64_tr_b16 v[12:13], v55 offset:4160
    ds_read_b64_tr_b16 v[14:15], v55 offset:4416
    s_waitcnt lgkmcnt(0)
    s_barrier
    ds_write_b128 v63, v[0:3] offset:16384
    ds_write_b128 v63, v[4:7] offset:20480
    s_barrier
    ds_write_b128 v63, v[8:11] offset:24576
    ds_write_b128 v63, v[12:15] offset:28672
    s_waitcnt lgkmcnt(0)
    v_min_u32 v36, -2, v36
    v_min_u32 v37, -2, v37
    v_min_u32 v38, -2, v38
    v_min_u32 v39, -2, v39
    v_min_u32 v40, -2, v40
    v_min_u32 v41, -2, v41
    v_min_u32 v42, -2, v42
    v_min_u32 v43, -2, v43
    v_min_u32 v44, -2, v44
    s_lshl_b32 s14, s12, 16
    s_add_u32 s14, s14, 92274688
    s_add_u32 s41, s14, 4096
    s_add_u32 s42, s14, 8192
    v_lshrrev_b32 v45, 2, v61
    buffer_store_dwordx4 v[36:39], v61, s[4:7], s14 offen
    buffer_store_dwordx4 v[40:43], v61, s[4:7], s41 offen
    buffer_store_dword v44, v45, s[4:7], s42 offen
    s_waitcnt vmcnt(1)
    v_readfirstlane_b32 s95, v25
    v_readfirstlane_b32 s85, v24
    s_add_u32 s86, s95, 2
    s_waitcnt vmcnt(0)
    v_subrev_u32 v27, s86, v27
    v_cmp_lt_u32 s[86:87], 64, v27
    s_cmp_eq_u32 s95, 0
    s_cselect_b64 s[86:87], -1, s[86:87]
    s_cmp_lg_u64 s[86:87], 0
    s_cbranch_scc1 cf_nt
    s_add_u32 s40, s24, 524288
    buffer_load_dword v30, v79, s[4:7], s24 offen sc1
    buffer_load_dword v30, v79, s[4:7], s40 offen sc1
cf_nt:
    s_waitcnt vmcnt(3)
    v_add_u32 v55, 81920, v51
    v_xor_b32 v56, 32, v55
    ds_read_b64_tr_b16 v[0:1], v55 offset:0
    ds_read_b64_tr_b16 v[2:3], v55 offset:256
    ds_read_b64_tr_b16 v[4:5], v55 offset:8192
    ds_read_b64_tr_b16 v[6:7], v55 offset:8448
    ds_read_b64_tr_b16 v[8:9], v56 offset:0
    ds_read_b64_tr_b16 v[10:11], v56 offset:256
    ds_read_b64_tr_b16 v[12:13], v56 offset:8192
    ds_read_b64_tr_b16 v[14:15], v56 offset:8448
    s_waitcnt lgkmcnt(0)
    ds_write_b128 v62, v[0:3] offset:24576
    ds_write_b128 v62, v[4:7] offset:28672
    ds_write_b128 v62, v[8:11] offset:32768
    ds_write_b128 v62, v[12:15] offset:36864
    s_waitcnt lgkmcnt(0)
    s_barrier
    s_mov_b32 s88, 4194304
gn2:
    s_cmp_lg_u32 s95, 0
    s_cbranch_scc1 gn2x
    buffer_load_dword v27, off, s[96:99], 0 offset:64 sc1
    s_sub_u32 s88, s88, 1
    s_cbranch_scc1 gn2x
    s_waitcnt vmcnt(0)
    v_readfirstlane_b32 s95, v27
    s_nop 1
    s_branch gn2
gn2x:
    ds_write_b128 v78, v[16:19] offset:8704
    ds_write_b128 v65, v[20:23] offset:10240
    v_mov_b32 v44, s95
    v_mov_b32 v45, s95
    v_mov_b32 v46, s95
    v_mov_b32 v47, s95
    v_mov_b32 v48, 108288
    ds_write_b128 v48, v[44:47]
    s_waitcnt vmcnt(0) lgkmcnt(0)
    s_cmp_eq_u32 s85, 1
    s_cbranch_scc1 cf_run
    s_mov_b32 s40, 131072
cf_startpoll:
    buffer_load_dword v3, off, s[96:99], 0 offset:140 sc1
    s_waitcnt vmcnt(0)
    v_readfirstlane_b32 s85, v3
    s_nop 0
    s_cmp_eq_u32 s85, 1
    s_cbranch_scc1 cf_run
    s_cmp_eq_u32 s85, 2
    s_cbranch_scc1 cf_leave
    s_sleep 1
    s_sub_u32 s40, s40, 1
    s_cbranch_scc0 cf_startpoll
    v_mov_b32 v4, 2
    v_mov_b32 v5, 0
    s_mov_b64 exec, 1
    buffer_atomic_cmpswap v[4:5], off, s[96:99], 0 offset:140
    s_mov_b64 exec, -1
    s_mov_b32 s40, 1048576
    s_branch cf_startpoll
cf_leave:
    v_lshrrev_b32 v0, 4, v61
    s_mov_b32 s32, s13
    s_load_dwordx16 s[48:63], s[0:1], 0
    s_waitcnt lgkmcnt(0)
    s_branch L_helper
cf_run:
    s_cmp_eq_u64 s[86:87], 0
    s_cbranch_scc1 cf_kvok
    s_lshr_b32 s92, s12, 1
    s_lshl_b32 s92, s92, 8
    s_add_u32 s92, s92, 125829120
    v_bfe_u32 v2, v61, 4, 6
    v_min_u32 v2, 11, v2
    v_lshlrev_b32 v2, 2, v2
    s_add_u32 s93, s95, 2
    s_mov_b32 s94, 4194304
cf_kv0:
    buffer_load_dword v3, v2, s[4:7], s92 offen sc1
    s_sub_u32 s94, s94, 1
    s_cbranch_scc1 cf_kv0_go
    s_waitcnt vmcnt(0)
    v_subrev_u32 v3, s93, v3
    v_cmp_lt_u32 vcc, 64, v3
    s_cbranch_vccz cf_kv0_go
    s_sleep 2
    s_branch cf_kv0
cf_kv0_go:
    s_add_u32 s40, s24, 524288
    buffer_load_dword v30, v79, s[4:7], s24 offen sc1
    buffer_load_dword v30, v79, s[4:7], s40 offen sc1
    s_waitcnt vmcnt(0)
cf_kvok:
    s_mov_b32 m0, 108032
    s_add_u32 s24, s24, 1048576
    s_mov_b32 s66, 0x201
    s_mov_b32 s67, 0xc0000000
    s_add_u32 s15, s14, 4096
    s_add_u32 s16, s14, 8192
    ds_read_b128 v[32:35], v62 offset:16384
    ds_read_b128 v[36:39], v62 offset:20480
    ds_read_b128 v[40:43], v61 offset:0
    ds_read_b128 v[44:47], v61 offset:4096
    ds_read_b128 v[48:51], v61 offset:8192
    ds_read_b128 v[52:55], v61 offset:12288
    s_add_u32 s18, s14, s31
    s_mov_b32 s29, 1048576
    buffer_load_dwordx4 v[24:27], v61, s[4:7], s14 offen nt
.p2align 6
cf_loop:
    v_mov_b64 v[0:1], 0
    v_mov_b64 v[2:3], 0
    v_mov_b64 v[4:5], 0
    v_mov_b64 v[6:7], 0
    v_mov_b64 v[8:9], 0
    v_mov_b64 v[10:11], 0
    v_mov_b64 v[12:13], 0
    v_mov_b64 v[14:15], 0
cf_loop2:
    ds_read_b128 v[16:19], v62 offset:8192
    ds_read_b128 v[20:23], v62 offset:12288
    v_lshrrev_b32 v56, 2, v61
    v_add_u32 v58, 106496, v56
    s_mov_b32 s29, 1048576
    s_nop 13
    buffer_load_dwordx4 v[24:27], v61, s[4:7], s14 offen nt
    s_waitcnt lgkmcnt(0)
cf_chk0:
    s_waitcnt vmcnt(1)
cf_chk0b:
    v_max3_u32 v57, v24, v25, v26
    v_max_u32 v57, v57, v27
    v_cmp_eq_u32 vcc, -1, v57
    ds_write_b128 v62, v[24:27] offset:40960
    s_cbranch_vccnz cf_spin0
    v_smfmac_f32_16x16x64_bf16 v[0:3], v[24:27], v[16:23], v60
    s_mov_b32 m0, s58
    s_nop 0
    buffer_load_dwordx4 v61, s[4:7], s15 offen nt lds
    v_smfmac_f32_16x16x64_bf16 v[8:11], v[24:27], v[32:39], v60
    s_mov_b32 m0, s59
    s_nop 0
    buffer_load_dword v56, s[4:7], s16 offen nt lds
    v_smfmac_f32_16x16x64_bf16 v[12:15], v[24:27], v[48:55], v60
    ds_read_b128 v[32:35], v61 offset:16384
    v_mfma_f32_16x16x16_bf16 v[16:19], v[72:73], v[72:73], 0
    ds_read_b128 v[36:39], v61 offset:20480
    s_waitcnt lgkmcnt(2)
    s_barrier
    ds_read_b128 v[48:51], v63 offset:0
    v_mfma_f32_16x16x16_bf16 v[20:23], v[72:73], v[72:73], 0
    ds_read_b128 v[52:55], v64 offset:0
    v_smfmac_f32_16x16x64_bf16 v[4:7], v[24:27], v[40:47], v60
    ds_read_b128 v[40:43], v61 offset:24576
    v_smfmac_f32_16x16x64_bf16 v[16:19], v[24:27], a[192:199], v60
    ds_read_b128 v[44:47], v61 offset:28672
    v_smfmac_f32_16x16x64_bf16 v[20:23], v[24:27], a[200:207], v60
    s_mov_b32 m0, 108032
    s_waitcnt lgkmcnt(3)
    v_smfmac_f32_16x16x64_bf16 v[0:3], v[48:51], a[0:7], v60
    s_add_u32 s43, s14, s31
    s_add_u32 s41, s14, 16384
    v_smfmac_f32_16x16x64_bf16 v[4:7], v[48:51], v[32:39], v60
    ds_read_b128 v[32:35], v61 offset:32768
    v_smfmac_f32_16x16x64_bf16 v[8:11], v[48:51], a[8:15], v60
    ds_read_b128 v[36:39], v61 offset:36864
    s_waitcnt lgkmcnt(2)
    v_smfmac_f32_16x16x64_bf16 v[12:15], v[48:51], v[40:47], v60
    ds_read_b128 v[40:43], v61 offset:40960
    v_smfmac_f32_16x16x64_bf16 v[16:19], v[48:51], a[208:215], v60
    ds_read_b128 v[44:47], v61 offset:45056
    v_smfmac_f32_16x16x64_bf16 v[20:23], v[48:51], a[216:223], v60
    ds_read_b128 v[48:51], v71 offset:0
    v_smfmac_f32_16x16x64_bf16 v[0:3], v[52:55], a[16:23], v60
    s_waitcnt vmcnt(0)
    ds_read_b128 v[28:31], v62 offset:45056
    s_waitcnt lgkmcnt(4)
    v_smfmac_f32_16x16x64_bf16 v[4:7], v[52:55], v[32:39], v60
    ds_read_b32 v59, v58
    buffer_load_dwordx4 v[24:27], v61, s[4:7], s23 offen offset:0 sc1
    v_smfmac_f32_16x16x64_bf16 v[8:11], v[52:55], a[24:31], v60
    ds_read_b128 v[32:35], v61 offset:49152
    s_waitcnt lgkmcnt(4)
    v_smfmac_f32_16x16x64_bf16 v[12:15], v[52:55], v[40:47], v60
    ds_read_b128 v[36:39], v61 offset:53248
    v_smfmac_f32_16x16x64_bf16 v[16:19], v[52:55], a[224:231], v60
    ds_read_b128 v[40:43], v61 offset:57344
    v_smfmac_f32_16x16x64_bf16 v[20:23], v[52:55], a[232:239], v60
    ds_read_b128 v[44:47], v61 offset:61440
    s_waitcnt lgkmcnt(4)
    v_smfmac_f32_16x16x64_bf16 v[0:3], v[48:51], a[32:39], v60
    v_max3_u32 v57, v28, v29, v30
    v_smfmac_f32_16x16x64_bf16 v[8:11], v[48:51], a[40:47], v60
    v_max3_u32 v57, v57, v31, v59
    s_waitcnt lgkmcnt(2)
    v_smfmac_f32_16x16x64_bf16 v[4:7], v[48:51], v[32:39], v60
    buffer_load_dwordx4 v[32:35], v61, s[4:7], s23 offen offset:1024 sc1
    v_cmp_eq_u32 vcc, -1, v57
    v_smfmac_f32_16x16x64_bf16 v[16:19], v[48:51], a[240:247], v60
    v_smfmac_f32_16x16x64_bf16 v[20:23], v[48:51], a[248:255], v60
    s_cbranch_vccnz cf_spin1
cf_go1:
    s_barrier
    ds_read_b128 v[52:55], v63 offset:4096
    s_waitcnt lgkmcnt(1)
    v_smfmac_f32_16x16x64_bf16 v[12:15], v[48:51], v[40:47], v60
    ds_read_b128 v[48:51], v64 offset:4096
    v_smfmac_f32_16x16x64_bf16 v[0:3], v[28:31], a[48:55], v60
    buffer_load_dwordx4 v[40:43], v61, s[4:7], s23 offen offset:2048 sc1
    v_smfmac_f32_16x16x64_bf16 v[8:11], v[28:31], a[56:63], v60
    ds_read_b128 v[56:59], v71 offset:4096
    s_and_b32 s41, s41, 65535
    v_smfmac_f32_16x16x64_bf16 v[4:7], v[28:31], a[128:135], v60
    ds_read_b128 v[36:39], v65 offset:8192
    s_add_u32 s41, s41, 67108864
    v_smfmac_f32_16x16x64_bf16 v[12:15], v[28:31], a[136:143], v60
    s_add_u32 s17, s41, s31
    s_and_b32 s30, s28, 1
    s_waitcnt lgkmcnt(3)
    v_smfmac_f32_16x16x64_bf16 v[0:3], v[52:55], a[64:71], v60
    buffer_load_dwordx4 v[44:47], v61, s[4:7], s23 offen offset:3072 sc1
    v_smfmac_f32_16x16x64_bf16 v[4:7], v[52:55], a[144:151], v60
    ds_read_b128 v[28:31], v78 offset:8704
    v_smfmac_f32_16x16x64_bf16 v[8:11], v[52:55], a[72:79], v60
    v_smfmac_f32_16x16x64_bf16 v[12:15], v[52:55], a[152:159], v60
    ds_read_b128 v[52:55], v62 offset:28672
    s_waitcnt lgkmcnt(4)
    v_smfmac_f32_16x16x64_bf16 v[0:3], v[48:51], a[80:87], v60
    v_smfmac_f32_16x16x64_bf16 v[4:7], v[48:51], a[160:167], v60
    v_smfmac_f32_16x16x64_bf16 v[8:11], v[48:51], a[88:95], v60
    buffer_load_dword v79, s[4:7], s24 offen sc1 lds
    v_smfmac_f32_16x16x64_bf16 v[12:15], v[48:51], a[168:175], v60
    v_smfmac_f32_16x16x64_bf16 v[16:19], v[48:51], v[112:119], v60
    v_smfmac_f32_16x16x64_bf16 v[20:23], v[48:51], v[120:127], v60
    ds_read_b128 v[48:51], v62 offset:24576
    s_waitcnt lgkmcnt(4)
    v_smfmac_f32_16x16x64_bf16 v[0:3], v[56:59], a[96:103], v60
    s_bitcmp1_b64 s[66:67], s28
    v_smfmac_f32_16x16x64_bf16 v[8:11], v[56:59], a[104:111], v60
    s_waitcnt lgkmcnt(3)
    v_smfmac_f32_16x16x64_bf16 v[0:3], v[36:39], a[112:119], v60
    v_smfmac_f32_16x16x64_bf16 v[8:11], v[36:39], a[120:127], v60
    v_smfmac_f32_16x16x64_bf16 v[4:7], v[56:59], a[176:183], v60
    s_waitcnt lgkmcnt(0)
    v_cvt_pk_bf16_f32 v0, v0, v1
    v_smfmac_f32_16x16x64_bf16 v[4:7], v[36:39], v[48:55], v60
    ds_read_b128 v[48:51], v62 offset:32768
    v_cvt_pk_bf16_f32 v8, v8, v9
    v_smfmac_f32_16x16x64_bf16 v[12:15], v[56:59], a[184:191], v60
    ds_read_b128 v[52:55], v62 offset:36864
    v_cvt_pk_bf16_f32 v9, v10, v11
    v_smfmac_f32_16x16x64_bf16 v[16:19], v[56:59], v[128:135], v60
    v_cvt_pk_bf16_f32 v1, v2, v3
    v_mfma_f32_16x16x16_bf16 v[8:11], v[8:9], v[28:29], 0
    v_cvt_pk_bf16_f32 v2, v4, v5
    v_cvt_pk_bf16_f32 v3, v6, v7
    v_smfmac_f32_16x16x64_bf16 v[20:23], v[56:59], v[136:143], v60
    s_mov_b64 exec, s[36:37]
    ds_read_b128 v[56:59], v69
    s_mov_b64 exec, -1
    v_mfma_f32_16x16x32_bf16 v[4:7], v[0:3], v[28:31], 0
    v_cvt_pk_bf16_f32 v2, v8, v9
    s_waitcnt lgkmcnt(1)
    v_smfmac_f32_16x16x64_bf16 v[12:15], v[36:39], v[48:55], v60
    ds_read_b128 v[48:51], v63 offset:4096
    v_cvt_pk_bf16_f32 v3, v10, v11
    s_waitcnt vmcnt(3)
    v_cvt_pk_bf16_f32 v0, v4, v5
    v_cvt_pk_bf16_f32 v1, v6, v7
    s_nop 1
    v_mfma_f32_16x16x32_bf16 v[4:7], v[32:35], v[0:3], 0
    v_cvt_pk_bf16_f32 v12, v12, v13
    v_cvt_pk_bf16_f32 v13, v14, v15
    s_nop 1
    v_mfma_f32_16x16x16_bf16 v[12:15], v[12:13], v[30:31], 0
    ds_read_b128 v[52:55], v62 offset:45056
    ds_read_b128 v[32:35], v63 offset:49152
    v_mfma_f32_16x16x32_bf16 v[28:31], v[24:27], v[0:3], 0
    s_waitcnt vmcnt(1)
    s_mov_b64 exec, s[34:35]
    s_nop 1
    v_cvt_pk_bf16_f32 v2, v12, v13
    v_cvt_pk_bf16_f32 v3, v14, v15
    s_mov_b64 exec, -1
    s_nop 0
    v_mfma_f32_16x16x32_bf16 v[8:11], v[0:3], v[0:3], 0
    v_mov_b32_dpp v28, v4 row_ror:8 row_mask:0xf bank_mask:0xc
    v_mov_b32_dpp v29, v5 row_ror:8 row_mask:0xf bank_mask:0xc
    v_mov_b32_dpp v30, v6 row_ror:8 row_mask:0xf bank_mask:0xc
    v_mov_b32_dpp v31, v7 row_ror:8 row_mask:0xf bank_mask:0xc
    v_smfmac_f32_16x16x64_bf16 v[16:19], v[36:39], v[144:151], v60
    ds_write_b128 v62, v[28:31] offset:53248
    v_mov_b32_dpp v8, v10 row_ror:8 row_mask:0xf bank_mask:0xc
    v_mov_b32_dpp v9, v11 row_ror:8 row_mask:0xf bank_mask:0xc
    v_smfmac_f32_16x16x64_bf16 v[20:23], v[36:39], v[152:159], v60
    ds_write_b64 v70, v[8:9]
    s_waitcnt lgkmcnt(4)
    v_smfmac_f32_16x16x64_bf16 v[16:19], v[48:51], v[96:103], v60
    s_mov_b64 exec, s[36:37]
    buffer_store_dwordx4 v[56:59], v61, s[4:7], s65 offen sc1
    s_mov_b64 exec, -1
    v_smfmac_f32_16x16x64_bf16 v[20:23], v[48:51], v[104:111], v60
    s_cbranch_scc1 cf_last
cf_back:
    s_waitcnt lgkmcnt(0)
    s_barrier
    ds_read_b128 v[56:59], v78 offset:10752
    v_smfmac_f32_16x16x64_bf16 v[16:19], v[52:55], v[80:87], v60
    ds_read_b128 v[12:15], v78 offset:11264
    ds_read_b128 v[4:7], v63 offset:12288
    v_smfmac_f32_16x16x64_bf16 v[20:23], v[52:55], v[88:95], v60
    ds_read_b128 v[8:11], v64 offset:12288
    ds_read_b128 v[0:3], v71 offset:12288
    v_mov_b64 v[24:25], s[62:63]
    v_mov_b64 v[26:27], s[60:61]
    v_cvt_pk_bf16_f32 v16, v16, v17
    v_cvt_pk_bf16_f32 v17, v18, v19
    v_pk_mul_f32 v[28:29], v[28:29], s[44:45]
    v_pk_mul_f32 v[30:31], v[30:31], s[44:45]
    s_waitcnt lgkmcnt(3)
    v_pk_add_f32 v[56:57], v[56:57], v[58:59]
    v_pk_add_f32 v[12:13], v[12:13], v[14:15]
    v_pk_add_f32 v[56:57], v[56:57], v[12:13]
    v_pk_mul_f32 v[56:57], v[56:57], s[44:45]
    v_exp_f32 v58, v56
    v_exp_f32 v59, v57
    s_waitcnt lgkmcnt(1)
    v_pk_fma_f32 v[28:29], v[4:5], s[44:45], v[28:29]
    v_pk_fma_f32 v[30:31], v[6:7], s[44:45], v[30:31]
    v_cvt_pk_bf16_f32 v6, v58, v59
    v_pk_fma_f32 v[28:29], v[8:9], s[44:45], v[28:29]
    v_pk_fma_f32 v[30:31], v[10:11], s[44:45], v[30:31]
    s_waitcnt lgkmcnt(0)
    v_pk_fma_f32 v[28:29], v[0:1], s[44:45], v[28:29]
    v_mov_b32_dpp v7, v6 row_ror:8 row_mask:0xf bank_mask:0xf
    v_pk_fma_f32 v[30:31], v[2:3], s[44:45], v[30:31]
    v_exp_f32 v0, v28
    v_mfma_f32_16x16x16_bf16 v[12:15], v[16:17], v[6:7], 0
    ds_read_b128 v[48:51], v63 offset:57344
    v_exp_f32 v1, v29
    v_cvt_pk_bf16_f32 v18, v20, v21
    v_exp_f32 v2, v30
    v_cvt_pk_bf16_f32 v19, v22, v23
    v_cvt_pk_bf16_f32 v8, v0, v1
    v_exp_f32 v3, v31
    v_mfma_f32_16x16x16_bf16 v[20:23], v[18:19], v[6:7], 0
    ds_read_b128 v[52:55], v63 offset:61440
    v_cvt_pk_bf16_f32 v9, v2, v3
    v_mov_b32_dpp v10, v8 row_ror:8 row_mask:0xf bank_mask:0xf
    v_max3_f32 v4, |v28|, |v29|, |v30|
    v_mov_b32_dpp v11, v9 row_ror:8 row_mask:0xf bank_mask:0xf
    v_mfma_f32_16x16x32_bf16 v[0:3], v[24:27], v[6:9], 0
    ds_read_b128 v[36:39], v63 offset:53248
    v_max3_f32 v4, v4, |v31|, |v56|
    v_max_f32_e64 v4, v4, |v57|
    v_mfma_f32_16x16x32_bf16 v[12:15], v[40:43], v[8:11], v[12:15]
    v_cmp_nge_f32 vcc, s46, v4
    v_mfma_f32_16x16x32_bf16 v[20:23], v[44:47], v[8:11], v[20:23]
    v_add_f32_dpp v0, v0, v0 row_ror:8 row_mask:0xf bank_mask:0xf
    v_rcp_f32 v0, v0
    s_cbranch_vccnz cf_guard
cf_norm:
    v_mfma_f32_16x16x16_bf16 v[28:31], v[72:73], v[72:73], 0
    v_mul_f32 v12, v12, v0
    v_mul_f32 v13, v13, v0
    v_mul_f32 v14, v14, v0
    v_mul_f32 v15, v15, v0
    v_mul_f32_dpp v12, v20, v0 row_ror:8 row_mask:0xf bank_mask:0xc
    v_mul_f32_dpp v13, v21, v0 row_ror:8 row_mask:0xf bank_mask:0xc
    v_mul_f32_dpp v14, v22, v0 row_ror:8 row_mask:0xf bank_mask:0xc
    v_mul_f32_dpp v15, v23, v0 row_ror:8 row_mask:0xf bank_mask:0xc
    v_cvt_pk_bf16_f32 v12, v12, v13
    v_cvt_pk_bf16_f32 v13, v14, v15
    v_mfma_f32_16x16x16_bf16 v[8:11], v[72:73], v[72:73], 0
    ds_write_b64 v77, v[12:13]
    v_mfma_f32_16x16x16_bf16 v[4:7], v[72:73], v[72:73], 0
    ds_read_b128 v[0:3], v68
    v_mfma_f32_16x16x16_bf16 v[16:19], v[72:73], v[72:73], 0
    ds_read_b128 v[40:43], v63 offset:16384
    v_mfma_f32_16x16x16_bf16 v[20:23], v[72:73], v[72:73], 0
    ds_read_b128 v[44:47], v63 offset:20480
    s_waitcnt lgkmcnt(3)
    s_barrier
    ds_read_b128 v[24:27], v74
    ds_read_b128 v[12:15], v75
    ds_read_b128 v[56:59], v76
    s_waitcnt lgkmcnt(5)
    v_smfmac_f32_16x16x64_bf16 v[28:31], v[0:3], v[160:167], v60
    v_smfmac_f32_16x16x64_bf16 v[8:11], v[0:3], v[192:199], v60
    v_smfmac_f32_16x16x64_bf16 v[4:7], v[0:3], v[32:39], v60
    ds_read_b128 v[32:35], v63 offset:32768
    v_smfmac_f32_16x16x64_bf16 v[16:19], v[0:3], v[224:231], v60
    ds_read_b128 v[36:39], v63 offset:36864
    s_waitcnt lgkmcnt(3)
    v_smfmac_f32_16x16x64_bf16 v[28:31], v[24:27], v[168:175], v60
    v_smfmac_f32_16x16x64_bf16 v[4:7], v[12:15], v[48:55], v60
    ds_read_b128 v[48:51], v63 offset:24576
    v_smfmac_f32_16x16x64_bf16 v[28:31], v[12:15], v[176:183], v60
    ds_read_b128 v[52:55], v63 offset:28672
    s_waitcnt lgkmcnt(4)
    v_smfmac_f32_16x16x64_bf16 v[28:31], v[56:59], v[184:191], v60
    v_cvt_pk_bf16_f32 v4, v4, v5
    v_smfmac_f32_16x16x64_bf16 v[16:19], v[12:15], v[40:47], v60
    ds_read_b128 v[40:43], v63 offset:40960
    v_and_or_b32 v4, v4, -2, s30
    v_smfmac_f32_16x16x64_bf16 v[8:11], v[24:27], v[200:207], v60
    ds_read_b128 v[44:47], v63 offset:45056
    v_cvt_pk_bf16_f32 v5, v6, v7
    v_smfmac_f32_16x16x64_bf16 v[8:11], v[12:15], v[208:215], v60
    buffer_store_dwordx2 v[4:5], v67, s[4:7], s22 offen
    v_cvt_pk_bf16_f32 v28, v28, v29
    v_smfmac_f32_16x16x64_bf16 v[8:11], v[56:59], v[216:223], v60
    v_and_or_b32 v28, v28, -2, s30
    v_smfmac_f32_16x16x64_bf16 v[16:19], v[24:27], v[232:239], v60
    v_cvt_pk_bf16_f32 v29, v30, v31
    s_waitcnt lgkmcnt(4)
    v_smfmac_f32_16x16x64_bf16 v[16:19], v[56:59], v[32:39], v60
    buffer_store_dwordx2 v[28:29], v66, s[4:7], s20 offen
    v_cvt_pk_bf16_f32 v8, v8, v9
    s_waitcnt lgkmcnt(0)
    v_smfmac_f32_16x16x64_bf16 v[20:23], v[0:3], v[240:247], v60
    v_and_or_b32 v8, v8, -2, s30
    v_smfmac_f32_16x16x64_bf16 v[20:23], v[24:27], v[248:255], v60
    v_cvt_pk_bf16_f32 v9, v10, v11
    v_smfmac_f32_16x16x64_bf16 v[20:23], v[12:15], v[48:55], v60
    buffer_store_dwordx2 v[8:9], v66, s[4:7], s21 offen
    v_cvt_pk_bf16_f32 v16, v16, v17
    v_smfmac_f32_16x16x64_bf16 v[20:23], v[56:59], v[40:47], v60
    v_and_or_b32 v16, v16, -2, s30
    v_cvt_pk_bf16_f32 v17, v18, v19
    buffer_store_dwordx2 v[16:17], v66, s[4:7], s38 offen
    s_cmp_lg_u32 s13, 2
    s_nop 1
    v_cvt_pk_bf16_f32 v20, v20, v21
    v_and_or_b32 v20, v20, -2, s30
    v_cvt_pk_bf16_f32 v21, v22, v23
    buffer_store_dwordx2 v[20:21], v66, s[4:7], s39 offen
    s_cbranch_scc1 cf_w013
    v_mov_b32 v21, -1
    s_mov_b64 exec, s[32:33]
    buffer_store_dword v21, v69, s[4:7], s18 offen
    s_mov_b64 exec, -1
    s_mov_b32 s18, s43
    s_nop 15
    s_nop 15
    s_nop 15
    s_nop 14
    buffer_load_dwordx4 v[40:43], v65, s[4:7], s19 offen offset:0 nt
    buffer_load_dwordx4 v[44:47], v65, s[4:7], s19 offen offset:1024 nt
    buffer_load_dwordx4 v[48:51], v65, s[4:7], s19 offen offset:2048 nt
    buffer_load_dwordx4 v[52:55], v65, s[4:7], s19 offen offset:3072 nt
    ds_read_b128 v[56:59], v65 offset:10240
    s_add_u32 s28, s28, 1
    s_mov_b32 s14, s41
    s_add_u32 s23, s23, 524288
    s_add_u32 s24, s24, 524288
    s_min_u32 s24, s24, s47
    s_add_u32 s15, s14, 4096
    s_add_u32 s16, s14, 8192
    s_add_u32 s65, s65, 12288
    s_mov_b32 s40, 1
    v_mov_b64 v[0:1], 0
    v_mov_b64 v[2:3], 0
    v_mov_b64 v[4:5], 0
    v_mov_b64 v[6:7], 0
    v_mov_b64 v[8:9], 0
    v_mov_b64 v[10:11], 0
    v_mov_b64 v[12:13], 0
    v_mov_b64 v[14:15], 0
cf_chkF:
    v_mov_b32 v20, 0
    s_waitcnt vmcnt(3)
    s_waitcnt lgkmcnt(0)
    v_mfma_f32_16x16x32_bf16 v[28:31], v[40:43], v[56:59], 0
    v_bitop3_b32 v20, v20, v40, s30 bitop3:0xf6
    v_bitop3_b32 v20, v20, v42, s30 bitop3:0xf6
    s_waitcnt vmcnt(2)
    v_mfma_f32_16x16x32_bf16 v[28:31], v[44:47], v[56:59], v[28:31]
    v_bitop3_b32 v20, v20, v44, s30 bitop3:0xf6
    v_bitop3_b32 v20, v20, v46, s30 bitop3:0xf6
    s_waitcnt vmcnt(1)
    v_mfma_f32_16x16x32_bf16 v[28:31], v[48:51], v[56:59], v[28:31]
    v_bitop3_b32 v20, v20, v48, s30 bitop3:0xf6
    v_bitop3_b32 v20, v20, v50, s30 bitop3:0xf6
    s_waitcnt vmcnt(0)
    v_mfma_f32_16x16x32_bf16 v[28:31], v[52:55], v[56:59], v[28:31]
    v_bitop3_b32 v20, v20, v52, s30 bitop3:0xf6
    v_bitop3_b32 v20, v20, v54, s30 bitop3:0xf6
    v_and_b32 v20, s40, v20
    v_cmp_ne_u32 vcc, 0, v20
    s_cbranch_vccnz cf_spinF
    v_permlane32_swap_b32 v28, v30
    v_permlane32_swap_b32 v29, v31
    v_add_f32 v28, v28, v30
    v_add_f32 v30, v29, v31
    v_cvt_pk_bf16_f32 v28, v28, v30
    s_mov_b64 exec, s[32:33]
    buffer_store_dword v28, v69, s[4:7], s17 offen
    s_mov_b64 exec, -1
    ds_read_b128 v[32:35], v62 offset:16384
    ds_read_b128 v[36:39], v62 offset:20480
    ds_read_b128 v[40:43], v61 offset:0
    ds_read_b128 v[44:47], v61 offset:4096
    ds_read_b128 v[48:51], v61 offset:8192
    ds_read_b128 v[52:55], v61 offset:12288
    s_nop 15
    s_nop 1
    buffer_load_dwordx4 v[24:27], v61, s[4:7], s14 offen nt
    s_branch cf_loop2
cf_w013:
    ds_read_b128 v[56:59], v65 offset:10240
    ds_read_b128 v[32:35], v62 offset:16384
    ds_read_b128 v[36:39], v62 offset:20480
    ds_read_b128 v[40:43], v61 offset:0
    ds_read_b128 v[44:47], v61 offset:4096
    ds_read_b128 v[48:51], v61 offset:8192
    ds_read_b128 v[52:55], v61 offset:12288
    s_add_u32 s28, s28, 1
    s_mov_b32 s14, s41
    s_add_u32 s23, s23, 524288
    s_add_u32 s24, s24, 524288
    s_min_u32 s24, s24, s47
    s_add_u32 s15, s14, 4096
    s_add_u32 s16, s14, 8192
    s_add_u32 s65, s65, 12288
    s_mov_b32 s40, 1
    s_cmp_eq_u32 s64, 0
    s_cbranch_scc1 cf_w0
    v_mov_b32 v21, -1
    s_mov_b64 exec, s[32:33]
    buffer_store_dword v21, v69, s[4:7], s18 offen
    s_mov_b64 exec, -1
    s_mov_b32 s18, s43
    s_cmp_eq_u32 s13, 1
    s_nop 15
    s_nop 15
    s_nop 1
    s_cbranch_scc1 cf_sx
    s_nop 15
    s_nop 11
cf_sx:
    buffer_load_dwordx4 v[0:3], v65, s[4:7], s19 offen offset:0 nt
    buffer_load_dwordx4 v[4:7], v65, s[4:7], s19 offen offset:1024 nt
    buffer_load_dwordx4 v[8:11], v65, s[4:7], s19 offen offset:2048 nt
    buffer_load_dwordx4 v[12:15], v65, s[4:7], s19 offen offset:3072 nt
cf_chkG:
    v_mov_b32 v20, 0
    s_waitcnt vmcnt(3)
    s_waitcnt lgkmcnt(6)
    v_mfma_f32_16x16x32_bf16 v[28:31], v[0:3], v[56:59], 0
    v_bitop3_b32 v20, v20, v0, s30 bitop3:0xf6
    v_bitop3_b32 v20, v20, v2, s30 bitop3:0xf6
    s_waitcnt vmcnt(2)
    v_mfma_f32_16x16x32_bf16 v[28:31], v[4:7], v[56:59], v[28:31]
    v_bitop3_b32 v20, v20, v4, s30 bitop3:0xf6
    v_bitop3_b32 v20, v20, v6, s30 bitop3:0xf6
    s_waitcnt vmcnt(1)
    v_mfma_f32_16x16x32_bf16 v[28:31], v[8:11], v[56:59], v[28:31]
    v_bitop3_b32 v20, v20, v8, s30 bitop3:0xf6
    v_bitop3_b32 v20, v20, v10, s30 bitop3:0xf6
    s_waitcnt vmcnt(0)
    v_mfma_f32_16x16x32_bf16 v[28:31], v[12:15], v[56:59], v[28:31]
    v_bitop3_b32 v20, v20, v12, s30 bitop3:0xf6
    v_bitop3_b32 v20, v20, v14, s30 bitop3:0xf6
    v_and_b32 v20, s40, v20
    v_cmp_ne_u32 vcc, 0, v20
    s_cbranch_vccnz cf_spinG
    v_permlane32_swap_b32 v28, v30
    v_permlane32_swap_b32 v29, v31
    v_add_f32 v28, v28, v30
    v_add_f32 v30, v29, v31
    s_cmp_eq_u32 s13, 3
    s_cbranch_scc1 cf_w3
    v_mov_b32 v29, v28
    v_mov_b32 v31, v30
    s_nop 0
    v_permlane16_swap_b32 v28, v29
    v_permlane16_swap_b32 v30, v31
    v_add_f32 v28, v28, v29
    v_add_f32 v30, v30, v31
cf_w3:
    v_cvt_pk_bf16_f32 v28, v28, v30
    s_mov_b64 exec, s[32:33]
    buffer_store_dword v28, v69, s[4:7], s17 offen
    s_mov_b64 exec, -1
    buffer_load_dwordx4 v[24:27], v61, s[4:7], s14 offen nt
    s_branch cf_loop
cf_w0:
    v_mov_b64 v[0:1], 0
    v_mov_b64 v[2:3], 0
    v_mov_b64 v[4:5], 0
    v_mov_b64 v[6:7], 0
    v_mov_b64 v[8:9], 0
    v_mov_b64 v[10:11], 0
    v_mov_b64 v[12:13], 0
    v_mov_b64 v[14:15], 0
    s_nop 15
    s_nop 15
    s_nop 15
    s_nop 5
    s_cmp_lg_u32 s28, 10
    s_cbranch_scc1 cf_nokv
    s_lshr_b32 s92, s12, 1
    s_lshl_b32 s92, s92, 8
    s_add_u32 s92, s92, 125829120
    v_bfe_u32 v28, v61, 4, 6
    v_min_u32 v28, 11, v28
    v_lshlrev_b32 v28, 2, v28
    v_add_u32 v28, 108304, v28
    s_waitcnt vmcnt(0)
    ds_read_b32 v29, v28
    s_add_u32 s93, s95, 63
    s_waitcnt lgkmcnt(0)
    v_cmp_ne_u32 vcc, s93, v29
    s_cbranch_vccz cf_kv1_go
    s_lshr_b32 s92, s12, 1
    s_lshl_b32 s92, s92, 8
    s_add_u32 s92, s92, 125833216
    v_bfe_u32 v28, v61, 4, 6
    v_min_u32 v28, 11, v28
    v_lshlrev_b32 v28, 2, v28
    s_add_u32 s93, s95, 63
    s_mov_b32 s94, 4194304
cf_kv1:
    buffer_load_dword v29, v28, s[4:7], s92 offen sc1
    s_sub_u32 s94, s94, 1
    s_cbranch_scc1 cf_kv1_go
    s_waitcnt vmcnt(0)
    v_subrev_u32 v29, s93, v29
    v_cmp_lt_u32 vcc, 64, v29
    s_cbranch_vccz cf_kv1_go
    s_sleep 2
    s_branch cf_kv1
cf_kv1_go:
    s_branch cf_w0p
cf_nokv:
    s_nop 15
    s_nop 15
    s_nop 15
    s_nop 15
    s_nop 15
    s_nop 15
    s_nop 13
cf_w0p:
    buffer_load_dwordx4 v[24:27], v61, s[4:7], s14 offen nt
    s_branch cf_loop2
cf_spinF:
    buffer_load_dwordx4 v[40:43], v65, s[4:7], s19 offen offset:0 nt
    buffer_load_dwordx4 v[44:47], v65, s[4:7], s19 offen offset:1024 nt
    buffer_load_dwordx4 v[48:51], v65, s[4:7], s19 offen offset:2048 nt
    buffer_load_dwordx4 v[52:55], v65, s[4:7], s19 offen offset:3072 nt
    s_sub_u32 s29, s29, 1
    s_cmp_lt_i32 s29, 0
    s_cselect_b32 s40, 0, 1
    s_branch cf_chkF
cf_spinG:
    buffer_load_dwordx4 v[0:3], v65, s[4:7], s19 offen offset:0 nt
    buffer_load_dwordx4 v[4:7], v65, s[4:7], s19 offen offset:1024 nt
    buffer_load_dwordx4 v[8:11], v65, s[4:7], s19 offen offset:2048 nt
    buffer_load_dwordx4 v[12:15], v65, s[4:7], s19 offen offset:3072 nt
    s_sub_u32 s29, s29, 1
    s_cmp_lt_i32 s29, 0
    s_cselect_b32 s40, 0, 1
    s_branch cf_chkG
cf_guard:
    s_cbranch_scc0 cf_guard2
    buffer_store_dwordx4 v[16:19], v61, s[4:7], s26 offen sc1
    s_add_u32 s26, s26, 131072
    s_add_u32 s40, s95, 63
    v_mov_b32 v5, s40
    s_mov_b64 exec, 1
    buffer_store_dword v5, off, s[4:7], s27 sc1
    s_mov_b64 exec, -1
cf_guard2:
    s_nop 7
    v_max3_f32 v6, v28, v29, v30
    v_max3_f32 v7, v31, v56, v57
    v_max_f32 v6, v6, v7
    s_nop 1
    v_max_f32_dpp v6, v6, v6 row_ror:8 row_mask:0xf bank_mask:0xf
    v_mov_b32 v7, v6
    s_nop 1
    v_permlane32_swap_b32 v6, v7
    v_max_f32 v6, v6, v7
    v_mov_b32 v7, v6
    s_nop 1
    v_permlane16_swap_b32 v6, v7
    v_max_f32 v6, v6, v7
    v_sub_f32 v28, v28, v6
    v_sub_f32 v29, v29, v6
    v_sub_f32 v30, v30, v6
    v_sub_f32 v31, v31, v6
    v_sub_f32 v56, v56, v6
    v_sub_f32 v57, v57, v6
    v_exp_f32 v58, v56
    v_exp_f32 v59, v57
    s_nop 0
    v_cvt_pk_bf16_f32 v6, v58, v59
    s_nop 1
    v_mov_b32_dpp v7, v6 row_ror:8 row_mask:0xf bank_mask:0xf
    v_exp_f32 v0, v28
    s_nop 0
    v_mfma_f32_16x16x16_bf16 v[12:15], v[16:17], v[6:7], 0
    v_exp_f32 v1, v29
    v_exp_f32 v2, v30
    v_cvt_pk_bf16_f32 v8, v0, v1
    v_exp_f32 v3, v31
    v_mfma_f32_16x16x16_bf16 v[20:23], v[18:19], v[6:7], 0
    v_cvt_pk_bf16_f32 v9, v2, v3
    v_mov_b32_dpp v10, v8 row_ror:8 row_mask:0xf bank_mask:0xf
    v_max3_f32 v4, |v28|, |v29|, |v30|
    v_mov_b32_dpp v11, v9 row_ror:8 row_mask:0xf bank_mask:0xf
    v_mfma_f32_16x16x32_bf16 v[0:3], v[24:27], v[6:9], 0
    v_max3_f32 v4, v4, |v31|, |v56|
    v_max_f32_e64 v4, v4, |v57|
    v_mfma_f32_16x16x32_bf16 v[12:15], v[40:43], v[8:11], v[12:15]
    v_cmp_nge_f32 vcc, s46, v4
    v_mfma_f32_16x16x32_bf16 v[20:23], v[44:47], v[8:11], v[20:23]
    v_add_f32_dpp v0, v0, v0 row_ror:8 row_mask:0xf bank_mask:0xf
    v_rcp_f32 v0, v0
    s_nop 4
    s_branch cf_norm
cf_spin0:
    buffer_load_dwordx4 v[24:27], v61, s[4:7], s14 offen nt
    s_sub_u32 s29, s29, 1
    s_cmp_lt_i32 s29, 0
    s_cbranch_scc0 cf_chk0
    s_waitcnt vmcnt(0)
    v_min_u32 v24, -2, v24
    v_min_u32 v25, -2, v25
    v_min_u32 v26, -2, v26
    v_min_u32 v27, -2, v27
    s_branch cf_chk0
cf_spin1:
    s_mov_b32 m0, s58
    s_nop 0
    buffer_load_dwordx4 v61, s[4:7], s15 offen nt lds
    s_mov_b32 m0, s59
    s_nop 0
    buffer_load_dword v56, s[4:7], s16 offen nt lds
    s_mov_b32 m0, 108032
    s_sub_u32 s29, s29, 1
    s_cmp_lt_i32 s29, 0
    s_waitcnt vmcnt(0)
    ds_read_b128 v[28:31], v62 offset:45056
    ds_read_b32 v59, v58
    s_waitcnt lgkmcnt(0)
    v_max3_u32 v57, v28, v29, v30
    v_max3_u32 v57, v57, v31, v59
    v_cmp_eq_u32 vcc, -1, v57
    s_cbranch_scc1 cf_go1
    s_cbranch_vccnz cf_spin1
    s_branch cf_go1
cf_last:
    s_nop 1
    s_cmp_ge_u32 s28, 2
    s_cbranch_scc1 cf_last0
    s_and_b32 s40, s12, 3
    s_lshl_b32 s40, s40, 14
    s_add_u32 s40, s40, 67108864
    s_lshr_b32 s42, s12, 2
    s_lshl_b32 s42, s42, 3
    s_lshl_b64 exec, 0x55, s42
    buffer_load_dword v79, s[4:7], s40 offen sc1 lds
    s_mov_b64 exec, -1
    s_cmp_eq_u32 0, 1
    s_branch cf_back
cf_last0:
    s_cmp_lg_u32 s28, 9
    s_cbranch_scc1 cf_last1
    s_lshr_b32 s92, s12, 1
    s_lshl_b32 s92, s92, 8
    s_add_u32 s92, s92, 125833216
    v_bfe_u32 v48, v61, 4, 6
    v_min_u32 v48, 11, v48
    v_lshlrev_b32 v48, 2, v48
    s_mov_b32 m0, 108304
    s_mov_b64 exec, 0xfff
    buffer_load_dword v48, s[4:7], s92 offen sc1 lds
    s_mov_b64 exec, -1
    s_mov_b32 m0, 108032
    s_cmp_eq_u32 0, 1
    s_branch cf_back
cf_last1:
    s_cmp_eq_u32 s28, 63
    s_cbranch_scc1 cf_last2
    s_mov_b64 exec, s[34:35]
    buffer_store_dwordx4 v[0:3], v61, s[4:7], s25 offen sc1
    s_mov_b64 exec, -1
    s_add_u32 s25, s25, 131072
    s_mov_b32 s46, 0xbf800000
    s_cmp_eq_u32 0, 0
    s_branch cf_back
cf_last2:
    s_waitcnt lgkmcnt(0)
    s_mov_b64 exec, s[34:35]
    buffer_store_dwordx4 v[0:3], v61, s[4:7], s25 offen sc1
    s_mov_b64 exec, -1
    s_add_u32 s40, s95, 64
    v_mov_b32 v40, s40
    v_smfmac_f32_16x16x64_bf16 v[16:19], v[52:55], v[80:87], v60
    v_smfmac_f32_16x16x64_bf16 v[20:23], v[52:55], v[88:95], v60
    s_nop 3
    v_cvt_pk_bf16_f32 v16, v16, v17
    v_cvt_pk_bf16_f32 v17, v18, v19
    s_nop 1
    v_cvt_pk_bf16_f32 v18, v20, v21
    v_cvt_pk_bf16_f32 v19, v22, v23
    buffer_store_dwordx4 v[16:19], v61, s[4:7], s26 offen sc1
    s_mov_b64 exec, 1
    buffer_store_dword v40, off, s[4:7], s27 sc1
    s_mov_b64 exec, -1
    s_endpgm
cf_dma:
    s_xor_b32 s74, s76, s81
    s_add_u32 m0, s74, s80
    s_add_u32 s76, s76, 4096
    buffer_load_dwordx4 v58, s[8:11], s78 offen lds
    s_add_u32 s78, s78, s79
    s_cmp_lt_u32 s76, s77
    s_cbranch_scc1 cf_dma
    s_setpc_b64 s[82:83]
L_chain_safe:
    s_mov_b64 s[48:49], s[50:51]
    s_mov_b64 s[50:51], s[52:53]
    s_mov_b64 s[52:53], s[54:55]
    s_mov_b64 s[54:55], s[56:57]
    s_mov_b64 s[56:57], s[58:59]
    v_lshrrev_b32 v54, 6, v0
    s_nop 0
    v_readfirstlane_b32 s13, v54
    v_and_b32 v57, 63, v0
    v_bfe_u32 v54, v57, 2, 1
    v_lshlrev_b32 v48, 13, v54
    v_bfe_u32 v54, v57, 3, 1
    v_lshl_add_u32 v48, v54, 15, v48
    v_bfe_u32 v54, v57, 4, 1
    v_lshl_add_u32 v48, v54, 14, v48
    v_bfe_u32 v54, v57, 5, 1
    v_lshl_add_u32 v48, v54, 16, v48
    v_lshrrev_b32 v55, 4, v57
    v_and_b32 v55, 2, v55
    v_xor_b32 v55, v55, v57
    v_and_b32 v55, 3, v55
    v_lshl_add_u32 v48, v55, 4, v48
    v_bfe_u32 v54, v57, 2, 1
    v_lshlrev_b32 v51, 6, v54
    v_bfe_u32 v54, v57, 3, 1
    v_lshl_add_u32 v51, v54, 9, v51
    v_bfe_u32 v54, v57, 4, 1
    v_lshl_add_u32 v51, v54, 7, v51
    v_bfe_u32 v54, v57, 5, 1
    v_lshl_add_u32 v51, v54, 12, v51
    v_bfe_u32 v54, v57, 0, 1
    v_lshl_add_u32 v51, v54, 3, v51
    v_bfe_u32 v54, v57, 1, 1
    v_lshl_add_u32 v51, v54, 4, v51
    v_bfe_u32 v54, v57, 3, 1
    v_lshl_add_u32 v51, v54, 5, v51
    v_lshrrev_b32 v55, 3, v57
    v_mul_u32_u24 v49, 1152, v55
    v_and_b32 v55, 7, v57
    v_lshl_add_u32 v49, v55, 4, v49
    v_bfe_u32 v54, v57, 4, 1
    v_lshlrev_b32 v52, 13, v54
    v_bfe_u32 v54, v57, 5, 1
    v_lshl_add_u32 v52, v54, 9, v52
    v_bfe_u32 v54, v57, 2, 1
    v_lshl_add_u32 v52, v54, 7, v52
    v_bfe_u32 v54, v57, 3, 1
    v_lshl_add_u32 v52, v54, 5, v52
    v_and_b32 v55, 3, v57
    v_lshl_add_u32 v52, v55, 3, v52
    v_lshrrev_b32 v55, 2, v57
    v_mul_u32_u24 v50, 1152, v55
    v_and_b32 v55, 3, v57
    v_lshl_add_u32 v50, v55, 4, v50
    v_bfe_u32 v54, v57, 4, 1
    v_lshlrev_b32 v53, 12, v54
    v_bfe_u32 v54, v57, 5, 1
    v_lshl_add_u32 v53, v54, 8, v53
    v_bfe_u32 v54, v57, 2, 1
    v_lshl_add_u32 v53, v54, 6, v53
    v_bfe_u32 v54, v57, 3, 1
    v_lshl_add_u32 v53, v54, 5, v53
    v_and_b32 v55, 3, v57
    v_lshl_add_u32 v53, v55, 3, v53
    s_lshl_b32 s66, s13, 10
    s_and_b32 s93, s13, 1
    s_lshl_b32 s93, s93, 14
    s_and_b32 s75, s13, 2
    s_lshl_b32 s75, s75, 19
    v_add_u32 v51, s66, v51
    v_add_u32 v52, s66, v52
    v_add_u32 v53, s66, v53
    v_mov_b32 v58, v48
    s_mov_b32 s10, 4718592
    s_mov_b32 s11, 0x20000
    s_lshl_b32 s67, s12, 8
    s_lshl_b32 s40, s13, 6
    s_add_u32 s67, s67, s40
    s_mul_i32 s92, s12, 147456
    s_lshr_b32 s73, s50, 8
    s_add_u32 s73, s73, s12
    s_and_b32 s73, s73, 31
    s_bitcmp1_b32 0xa2222222, s73
    s_cselect_b32 s88, 0, 0
    s_mov_b32 s72, 0
    s_add_u32 s73, s73, 1
    s_lshr_b32 s73, s73, 2
    s_xor_b32 s94, s13, 0
    s_mul_i32 s94, s94, 36864
    s_add_u32 s94, s94, s92
    s_lshl_b32 s74, s13, 7
    s_add_u32 s94, s94, s74
    s_add_u32 s78, s94, 0
    s_mov_b64 s[8:9], s[56:57]
    v_mov_b32 v58, v49
    s_mov_b32 s79, 9216
    s_mov_b32 s81, 0
    s_add_u32 s80, s66, 114688
    s_mov_b32 s76, 0
    s_mov_b32 s77, 8192
    s_call_b64 s[82:83], cs_dma
    s_mov_b32 s77, 16384
    s_call_b64 s[82:83], cs_dma
    s_xor_b32 s94, s13, 1
    s_mul_i32 s94, s94, 36864
    s_add_u32 s94, s94, s92
    s_lshl_b32 s74, s13, 7
    s_add_u32 s94, s94, s74
    s_add_u32 s78, s94, 0
    s_add_u32 s80, s66, 81920
    s_mov_b32 s76, 0
    s_mov_b32 s77, 8192
    s_call_b64 s[82:83], cs_dma
    s_mov_b32 s77, 16384
    s_call_b64 s[82:83], cs_dma
    s_xor_b32 s94, s13, 2
    s_mul_i32 s94, s94, 36864
    s_add_u32 s94, s94, s92
    s_lshl_b32 s74, s13, 7
    s_add_u32 s94, s94, s74
    s_add_u32 s78, s94, 0
    s_add_u32 s80, s66, 16384
    s_mov_b32 s76, 0
    s_mov_b32 s77, 8192
    s_call_b64 s[82:83], cs_dma
    s_mov_b32 s77, 16384
    s_call_b64 s[82:83], cs_dma
    s_xor_b32 s94, s13, 3
    s_mul_i32 s94, s94, 36864
    s_add_u32 s94, s94, s92
    s_lshl_b32 s74, s13, 7
    s_add_u32 s94, s94, s74
    s_add_u32 s78, s94, 0
    s_add_u32 s80, s66, 0
    s_mov_b32 s76, 0
    s_mov_b32 s77, 8192
    s_call_b64 s[82:83], cs_dma
    s_mov_b32 s77, 16384
    s_call_b64 s[82:83], cs_dma
    v_lshrrev_b32 v24, 6, v0
    v_lshlrev_b32 v61, 4, v0
    v_add_u32 v62, 57344, v61
    v_xor_b32 v63, 1024, v61
    v_add_u32 v63, 98304, v63
    v_xor_b32 v64, 2048, v61
    v_add_u32 v64, 98304, v64
    v_and_b32 v65, 1023, v61
    v_add_u32 v65, 98304, v65
    v_and_b32 v26, 15, v0
    v_bfe_u32 v27, v0, 4, 2
    v_mov_b32 v60, 0x4444
    v_mov_b32 v25, 0xeeee
    v_cmp_lt_u32 vcc, 7, v26
    s_nop 1
    v_cndmask_b32 v60, v60, v25, vcc
    s_nop 1
    v_and_b32 v67, 12, v26
    v_lshlrev_b32 v67, 3, v67
    v_and_b32 v25, 1, v26
    v_lshl_add_u32 v67, v25, 4, v67
    v_bfe_u32 v25, v26, 1, 1
    v_lshl_add_u32 v67, v25, 3, v67
    v_lshl_add_u32 v66, v27, 14, v67
    v_lshl_add_u32 v66, v24, 17, v66
    s_nop 1
    v_and_b32 v67, 63, v67
    v_lshrrev_b32 v25, 1, v24
    v_lshl_add_u32 v67, v25, 18, v67
    v_lshl_add_u32 v67, v27, 16, v67
    v_lshrrev_b32 v25, 3, v26
    v_lshl_add_u32 v67, v25, 15, v67
    v_and_b32 v25, 1, v24
    v_lshl_add_u32 v67, v25, 6, v67
    s_nop 1
    s_waitcnt vmcnt(12)
    v_add_u32 v55, 114688, v52
    ds_read_b64_tr_b16 v[160:161], v55 offset:0
    ds_read_b64_tr_b16 v[162:163], v55 offset:256
    ds_read_b64_tr_b16 v[164:165], v55 offset:4096
    ds_read_b64_tr_b16 v[166:167], v55 offset:4352
    s_xor_b32 s94, s13, 0
    s_mul_i32 s94, s94, 36864
    s_add_u32 s94, s94, s92
    s_lshl_b32 s74, s13, 7
    s_add_u32 s94, s94, s74
    s_add_u32 s78, s94, 512
    s_add_u32 s80, s66, 147456
    s_mov_b32 s76, 0
    s_mov_b32 s77, 8192
    s_call_b64 s[82:83], cs_dma
    ds_read_b64_tr_b16 v[192:193], v55 offset:64
    ds_read_b64_tr_b16 v[194:195], v55 offset:320
    ds_read_b64_tr_b16 v[196:197], v55 offset:4160
    ds_read_b64_tr_b16 v[198:199], v55 offset:4416
    s_mov_b32 s77, 16384
    s_call_b64 s[82:83], cs_dma
    v_and_b32 v25, 31, v0
    v_lshlrev_b32 v70, 4, v25
    v_lshlrev_b32 v28, 3, v25
    v_add_u32 v28, 108032, v28
    v_lshrrev_b32 v25, 1, v24
    v_lshl_add_u32 v70, v25, 9, v70
    v_and_b32 v25, 1, v24
    v_lshl_add_u32 v70, v25, 3, v70
    v_add_u32 v70, 109568, v70
    v_cmp_gt_u32 vcc, 2, v27
    s_nop 1
    v_cndmask_b32 v70, v70, v28, vcc
    s_nop 1
    s_waitcnt lgkmcnt(0)
    s_waitcnt vmcnt(12)
    v_add_u32 v55, 81920, v52
    ds_read_b64_tr_b16 v[168:169], v55 offset:0
    ds_read_b64_tr_b16 v[170:171], v55 offset:256
    ds_read_b64_tr_b16 v[172:173], v55 offset:4096
    ds_read_b64_tr_b16 v[174:175], v55 offset:4352
    s_xor_b32 s94, s13, 1
    s_mul_i32 s94, s94, 36864
    s_add_u32 s94, s94, s92
    s_lshl_b32 s74, s13, 7
    s_add_u32 s94, s94, s74
    s_add_u32 s78, s94, 512
    s_add_u32 s80, s66, 98304
    s_mov_b32 s76, 0
    s_mov_b32 s77, 8192
    s_call_b64 s[82:83], cs_dma
    ds_read_b64_tr_b16 v[200:201], v55 offset:64
    ds_read_b64_tr_b16 v[202:203], v55 offset:320
    ds_read_b64_tr_b16 v[204:205], v55 offset:4160
    ds_read_b64_tr_b16 v[206:207], v55 offset:4416
    s_mov_b32 s77, 16384
    s_call_b64 s[82:83], cs_dma
    v_xor_b32 v71, 2048, v63
    v_lshrrev_b32 v68, 4, v0
    v_lshlrev_b32 v68, 7, v68
    v_and_b32 v25, 7, v26
    v_lshl_add_u32 v68, v25, 4, v68
    v_add_u32 v68, 102400, v68
    v_xor_b32 v74, 512, v68
    v_xor_b32 v75, 1024, v68
    v_xor_b32 v76, 1536, v68
    v_lshrrev_b32 v25, 3, v26
    v_lshl_add_u32 v77, v25, 3, v68
    v_or_b32 v78, 512, v65
    v_lshlrev_b32 v79, 2, v61
    v_mov_b64 v[72:73], 0
    v_and_b32 v25, 1, v27
    v_lshlrev_b32 v69, 7, v25
    v_lshrrev_b32 v25, 1, v27
    v_lshl_add_u32 v69, v25, 3, v69
    v_and_b32 v25, 3, v26
    v_lshl_add_u32 v69, v25, 4, v69
    v_bfe_u32 v25, v26, 2, 1
    v_lshl_add_u32 v69, v25, 2, v69
    s_nop 1
    s_waitcnt lgkmcnt(0)
    s_waitcnt vmcnt(12)
    v_add_u32 v55, 16384, v52
    ds_read_b64_tr_b16 v[176:177], v55 offset:0
    ds_read_b64_tr_b16 v[178:179], v55 offset:256
    ds_read_b64_tr_b16 v[180:181], v55 offset:4096
    ds_read_b64_tr_b16 v[182:183], v55 offset:4352
    s_add_u32 s78, s67, 4194304
    s_mov_b64 s[8:9], s[54:55]
    v_mov_b32 v58, v48
    s_mov_b32 s79, 131072
    s_add_u32 s80, s66, 32768
    s_mov_b32 s76, 0
    s_mov_b32 s77, 8192
    s_call_b64 s[82:83], cs_dma
    ds_read_b64_tr_b16 v[208:209], v55 offset:64
    ds_read_b64_tr_b16 v[210:211], v55 offset:320
    ds_read_b64_tr_b16 v[212:213], v55 offset:4160
    ds_read_b64_tr_b16 v[214:215], v55 offset:4416
    s_mov_b32 s77, 16384
    s_call_b64 s[82:83], cs_dma
    s_mov_b32 s32, 0x00ff00ff
    s_mov_b32 s33, 0x00ff00ff
    s_not_b64 s[34:35], s[32:33]
    s_lshr_b32 s31, s12, 1
    s_lshl_b32 s31, s31, 8
    s_and_b32 s40, s12, 1
    s_lshl_b32 s40, s40, 6
    s_add_u32 s31, s31, s40
    s_and_b32 s40, s13, 1
    s_lshl_b32 s40, s40, 12
    s_add_u32 s31, s31, s40
    s_lshl_b32 s19, s12, 14
    s_add_u32 s19, s19, 68124672
    s_add_u32 s41, s19, 8192
    s_add_u32 s19, s19, s40
    s_and_b32 s40, s12, 1
    s_lshl_b32 s40, s40, 2
    s_or_b32 s40, s40, s13
    s_cmp_eq_u32 s40, 5
    s_cselect_b32 s64, 0, s13
    s_cmp_lg_u32 s13, 1
    s_cbranch_scc1 cs_notx
    s_mov_b32 s32, 0xff
    s_mov_b32 s33, 0xff
    s_mov_b32 s19, s41
    s_lshr_b32 s31, s12, 3
    s_lshl_b32 s31, s31, 8
    s_and_b32 s40, s12, 2
    s_lshl_b32 s40, s40, 6
    s_add_u32 s31, s31, s40
    s_and_b32 s40, s12, 4
    s_lshl_b32 s40, s40, 4
    s_add_u32 s31, s31, s40
    s_add_u32 s31, s31, 8192
cs_notx:
    s_cmp_lg_u32 s13, 0
    s_cbranch_scc1 cs_notp
    s_min_u32 s40, s12, 23
    s_mul_i32 s40, s40, 384
    s_add_u32 s40, s40, 98304
    v_add_u32 v69, s40, v61
    v_mov_b32 v25, 108288
    v_cmp_lt_u32 vcc, 23, v0
    s_nop 1
    v_cndmask_b32 v69, v69, v25, vcc
cs_notp:
    s_nop 1
    s_waitcnt lgkmcnt(0)
    s_waitcnt vmcnt(12)
    v_add_u32 v55, 0, v52
    ds_read_b64_tr_b16 v[184:185], v55 offset:0
    ds_read_b64_tr_b16 v[186:187], v55 offset:256
    ds_read_b64_tr_b16 v[188:189], v55 offset:4096
    ds_read_b64_tr_b16 v[190:191], v55 offset:4352
    s_xor_b32 s78, s75, 0
    s_add_u32 s78, s78, s67
    s_mov_b32 s81, s93
    s_add_u32 s80, s66, 114688
    s_mov_b32 s76, 0
    s_mov_b32 s77, 8192
    s_call_b64 s[82:83], cs_dma
    ds_read_b64_tr_b16 v[216:217], v55 offset:64
    ds_read_b64_tr_b16 v[218:219], v55 offset:320
    ds_read_b64_tr_b16 v[220:221], v55 offset:4160
    ds_read_b64_tr_b16 v[222:223], v55 offset:4416
    s_mov_b32 s77, 16384
    s_call_b64 s[82:83], cs_dma
    v_mov_b32 v28, 1
    v_mov_b32 v29, 1
    v_mov_b32 v30, 1
    v_mov_b32 v31, 1
    s_lshl_b32 s40, s12, 14
    s_add_u32 s40, s40, 68222976
    s_add_u32 s41, s40, 0
    buffer_store_dwordx4 v[28:31], v61, s[4:7], s41 offen sc1
    s_add_u32 s41, s40, 4096
    buffer_store_dwordx4 v[28:31], v61, s[4:7], s41 offen sc1
    s_add_u32 s41, s40, 8192
    buffer_store_dwordx4 v[28:31], v61, s[4:7], s41 offen sc1
    s_cmp_eq_u32 s64, 0
    s_cselect_b64 exec, 0, s[32:33]
    v_mov_b32 v27, -1
    s_add_u32 s41, s31, 68157440
    buffer_store_dword v27, v69, s[4:7], s41 offen sc1
    s_add_u32 s41, s31, 68173824
    buffer_store_dword v27, v69, s[4:7], s41 offen sc1
    s_add_u32 s41, s31, 68190208
    buffer_store_dword v27, v69, s[4:7], s41 offen sc1
    s_add_u32 s41, s31, 68206592
    buffer_store_dword v27, v69, s[4:7], s41 offen sc1
    s_mov_b64 exec, -1
    s_waitcnt lgkmcnt(0)
    s_waitcnt vmcnt(12)
    v_add_u32 v55, 147456, v52
    ds_read_b64_tr_b16 v[224:225], v55 offset:0
    ds_read_b64_tr_b16 v[226:227], v55 offset:256
    ds_read_b64_tr_b16 v[228:229], v55 offset:4096
    ds_read_b64_tr_b16 v[230:231], v55 offset:4352
    s_mov_b32 s77, 24576
    s_call_b64 s[82:83], cs_dma
    ds_read_b64_tr_b16 v[240:241], v55 offset:64
    ds_read_b64_tr_b16 v[242:243], v55 offset:320
    ds_read_b64_tr_b16 v[244:245], v55 offset:4160
    ds_read_b64_tr_b16 v[246:247], v55 offset:4416
    s_mov_b32 s77, 32768
    s_call_b64 s[82:83], cs_dma
    s_mov_b64 s[68:69], s[48:49]
    s_mov_b32 s70, 9216
    s_mov_b32 s71, 0x20000
    v_and_b32 v25, 7, v0
    v_mul_u32_u24 v25, 1152, v25
    v_lshrrev_b32 v26, 3, v0
    v_lshl_add_u32 v25, v26, 4, v25
    buffer_load_dwordx4 v[36:39], v25, s[68:71], 0 offen
    buffer_load_dwordx4 v[40:43], v25, s[68:71], 0 offen offset:512
    v_bfe_u32 v25, v0, 2, 3
    v_mul_u32_u24 v25, 1152, v25
    v_lshrrev_b32 v26, 5, v0
    v_lshl_add_u32 v25, v26, 4, v25
    v_and_b32 v26, 3, v0
    v_lshl_add_u32 v25, v26, 2, v25
    buffer_load_dword v44, v25, s[68:71], 0 offen offset:1024
    s_nop 0
    s_waitcnt lgkmcnt(0)
    s_waitcnt vmcnt(15)
    v_add_u32 v55, 98304, v52
    ds_read_b64_tr_b16 v[232:233], v55 offset:0
    ds_read_b64_tr_b16 v[234:235], v55 offset:256
    ds_read_b64_tr_b16 v[236:237], v55 offset:4096
    ds_read_b64_tr_b16 v[238:239], v55 offset:4352
    s_xor_b32 s78, s75, 1048576
    s_add_u32 s78, s78, s67
    s_add_u32 s80, s66, 65536
    s_mov_b32 s76, 0
    s_mov_b32 s77, 8192
    s_call_b64 s[82:83], cs_dma
    ds_read_b64_tr_b16 v[248:249], v55 offset:64
    ds_read_b64_tr_b16 v[250:251], v55 offset:320
    ds_read_b64_tr_b16 v[252:253], v55 offset:4160
    ds_read_b64_tr_b16 v[254:255], v55 offset:4416
    s_mov_b32 s77, 16384
    s_call_b64 s[82:83], cs_dma
    s_mov_b32 s44, 0x3e0293ee
    s_mov_b32 s45, s44
    s_mov_b32 s46, 0x42000000
    s_mov_b32 s60, 0x3f803f80
    s_mov_b32 s61, s60
    s_mov_b32 s62, 0x3e803e80
    s_mov_b32 s63, s62
    s_mov_b32 s28, 0
    s_lshl_b32 s58, s13, 10
    s_add_u32 s58, s58, 102400
    s_lshl_b32 s59, s13, 8
    s_add_u32 s59, s59, 106496
    s_lshl_b32 s24, s12, 14
    s_add_u32 s24, s24, 0
    s_add_u32 s47, s24, 33030144
    s_mul_i32 s40, s13, 3072
    s_add_u32 s23, s24, s40
    s_lshl_b32 s20, s12, 7
    s_add_u32 s20, s20, 68222976
    s_add_u32 s21, s20, 65536
    s_add_u32 s38, s20, 4096
    s_add_u32 s39, s21, 4096
    s_lshl_b32 s22, s12, 7
    s_add_u32 s22, s22, 68231168
    s_waitcnt lgkmcnt(0)
    s_waitcnt vmcnt(15)
    v_add_u32 v55, 32768, v51
    v_xor_b32 v56, 32, v55
    ds_read_b64_tr_b16 v[144:145], v55 offset:0
    ds_read_b64_tr_b16 v[146:147], v55 offset:256
    ds_read_b64_tr_b16 v[148:149], v55 offset:8192
    ds_read_b64_tr_b16 v[150:151], v55 offset:8448
    s_mov_b32 s77, 24576
    s_call_b64 s[82:83], cs_dma
    ds_read_b64_tr_b16 v[152:153], v56 offset:0
    ds_read_b64_tr_b16 v[154:155], v56 offset:256
    ds_read_b64_tr_b16 v[156:157], v56 offset:8192
    ds_read_b64_tr_b16 v[158:159], v56 offset:8448
    s_mov_b32 s77, 32768
    s_call_b64 s[82:83], cs_dma
    s_lshl_b32 s40, s12, 12
    s_add_u32 s25, s40, 79429632
    s_add_u32 s26, s40, 88866816
    s_lshl_b32 s65, s12, 9
    s_add_u32 s65, s65, 90177536
    s_lshl_b32 s40, s13, 5
    s_or_b32 s40, s40, s12
    s_cmp_lt_u32 s40, 24
    s_cselect_b32 s36, 0x1ffffff, 0
    s_mov_b32 s37, 0
    s_lshl_b32 s27, s12, 7
    s_add_u32 s27, s27, 125845504
    s_lshl_b32 s40, s13, 2
    s_add_u32 s27, s27, s40
    v_bfe_u32 v28, v61, 4, 4
    v_bfe_u32 v29, v61, 8, 1
    v_lshlrev_b32 v29, 2, v29
    v_sub_u32 v29, v28, v29
    v_mov_b32 v31, 0x3f80
    v_mov_b32 v32, 0x3f800000
    s_nop 1
    s_waitcnt lgkmcnt(0)
    s_waitcnt vmcnt(11)
    v_add_u32 v55, 114688, v51
    v_xor_b32 v56, 32, v55
    ds_read_b64_tr_b16 a[192:193], v55 offset:0
    ds_read_b64_tr_b16 a[194:195], v55 offset:256
    ds_read_b64_tr_b16 a[196:197], v55 offset:8192
    ds_read_b64_tr_b16 a[198:199], v55 offset:8448
    s_xor_b32 s78, s75, 2097152
    s_add_u32 s78, s78, s67
    s_add_u32 s80, s66, 0
    s_mov_b32 s76, 0
    s_mov_b32 s77, 8192
    s_call_b64 s[82:83], cs_dma
    ds_read_b64_tr_b16 a[200:201], v56 offset:0
    ds_read_b64_tr_b16 a[202:203], v56 offset:256
    ds_read_b64_tr_b16 a[204:205], v56 offset:8192
    ds_read_b64_tr_b16 a[206:207], v56 offset:8448
    s_mov_b32 s77, 16384
    s_call_b64 s[82:83], cs_dma
    v_cmp_eq_u32 vcc, 0, v29
    s_nop 1
    v_cndmask_b32 v16, 0, v31, vcc
    v_cmp_eq_u32 vcc, 1, v29
    s_nop 1
    v_cndmask_b32 v16, v16, v32, vcc
    v_cmp_eq_u32 vcc, 0, v28
    s_nop 1
    v_cndmask_b32 v20, 0, v31, vcc
    v_cmp_eq_u32 vcc, 1, v28
    s_nop 1
    v_cndmask_b32 v20, v20, v32, vcc
    s_nop 1
    s_waitcnt lgkmcnt(0)
    v_add_u32 v55, 131072, v51
    v_xor_b32 v56, 32, v55
    ds_read_b64_tr_b16 a[208:209], v55 offset:0
    ds_read_b64_tr_b16 a[210:211], v55 offset:256
    ds_read_b64_tr_b16 a[212:213], v55 offset:8192
    ds_read_b64_tr_b16 a[214:215], v55 offset:8448
    s_mov_b32 s77, 24576
    s_call_b64 s[82:83], cs_dma
    ds_read_b64_tr_b16 a[216:217], v56 offset:0
    ds_read_b64_tr_b16 a[218:219], v56 offset:256
    ds_read_b64_tr_b16 a[220:221], v56 offset:8192
    ds_read_b64_tr_b16 a[222:223], v56 offset:8448
    s_mov_b32 s77, 32768
    s_call_b64 s[82:83], cs_dma
    v_cmp_eq_u32 vcc, 2, v29
    s_nop 1
    v_cndmask_b32 v17, 0, v31, vcc
    v_cmp_eq_u32 vcc, 3, v29
    s_nop 1
    v_cndmask_b32 v17, v17, v32, vcc
    v_cmp_eq_u32 vcc, 2, v28
    s_nop 1
    v_cndmask_b32 v21, 0, v31, vcc
    v_cmp_eq_u32 vcc, 3, v28
    s_nop 1
    v_cndmask_b32 v21, v21, v32, vcc
    s_nop 1
    s_waitcnt lgkmcnt(0)
    s_waitcnt vmcnt(8)
    v_add_u32 v55, 65536, v51
    v_xor_b32 v56, 32, v55
    ds_read_b64_tr_b16 a[224:225], v55 offset:0
    ds_read_b64_tr_b16 a[226:227], v55 offset:256
    ds_read_b64_tr_b16 a[228:229], v55 offset:8192
    ds_read_b64_tr_b16 a[230:231], v55 offset:8448
    s_xor_b32 s78, s75, 3145728
    s_add_u32 s78, s78, s67
    s_add_u32 s80, s66, 32768
    s_mov_b32 s76, 0
    s_mov_b32 s77, 8192
    s_call_b64 s[82:83], cs_dma
    ds_read_b64_tr_b16 a[232:233], v56 offset:0
    ds_read_b64_tr_b16 a[234:235], v56 offset:256
    ds_read_b64_tr_b16 a[236:237], v56 offset:8192
    ds_read_b64_tr_b16 a[238:239], v56 offset:8448
    s_mov_b32 s77, 16384
    s_call_b64 s[82:83], cs_dma
    v_cmp_eq_u32 vcc, 8, v29
    s_nop 1
    v_cndmask_b32 v18, 0, v31, vcc
    v_cmp_eq_u32 vcc, 9, v29
    s_nop 1
    v_cndmask_b32 v18, v18, v32, vcc
    v_cmp_eq_u32 vcc, 4, v28
    s_nop 1
    v_cndmask_b32 v22, 0, v31, vcc
    v_cmp_eq_u32 vcc, 5, v28
    s_nop 1
    v_cndmask_b32 v22, v22, v32, vcc
    s_nop 1
    s_waitcnt lgkmcnt(0)
    v_add_u32 v55, 81920, v51
    v_xor_b32 v56, 32, v55
    ds_read_b64_tr_b16 a[240:241], v55 offset:0
    ds_read_b64_tr_b16 a[242:243], v55 offset:256
    ds_read_b64_tr_b16 a[244:245], v55 offset:8192
    ds_read_b64_tr_b16 a[246:247], v55 offset:8448
    s_mov_b32 s77, 24576
    s_call_b64 s[82:83], cs_dma
    ds_read_b64_tr_b16 a[248:249], v56 offset:0
    ds_read_b64_tr_b16 a[250:251], v56 offset:256
    ds_read_b64_tr_b16 a[252:253], v56 offset:8192
    ds_read_b64_tr_b16 a[254:255], v56 offset:8448
    s_mov_b32 s77, 32768
    s_call_b64 s[82:83], cs_dma
    v_cmp_eq_u32 vcc, 10, v29
    s_nop 1
    v_cndmask_b32 v19, 0, v31, vcc
    v_cmp_eq_u32 vcc, 11, v29
    s_nop 1
    v_cndmask_b32 v19, v19, v32, vcc
    v_cmp_eq_u32 vcc, 6, v28
    s_nop 1
    v_cndmask_b32 v23, 0, v31, vcc
    v_cmp_eq_u32 vcc, 7, v28
    s_nop 1
    v_cndmask_b32 v23, v23, v32, vcc
    s_nop 1
    s_waitcnt lgkmcnt(0)
    s_waitcnt vmcnt(8)
    v_add_u32 v55, 0, v51
    v_xor_b32 v56, 32, v55
    ds_read_b64_tr_b16 v[80:81], v55 offset:0
    ds_read_b64_tr_b16 v[82:83], v55 offset:256
    ds_read_b64_tr_b16 v[84:85], v55 offset:8192
    ds_read_b64_tr_b16 v[86:87], v55 offset:8448
    s_xor_b32 s78, s75, 2097152
    s_add_u32 s78, s78, s67
    s_mov_b64 s[8:9], s[52:53]
    s_add_u32 s80, s66, 131072
    s_mov_b32 s76, 0
    s_mov_b32 s77, 8192
    s_call_b64 s[82:83], cs_dma
    ds_read_b64_tr_b16 v[88:89], v56 offset:0
    ds_read_b64_tr_b16 v[90:91], v56 offset:256
    ds_read_b64_tr_b16 v[92:93], v56 offset:8192
    ds_read_b64_tr_b16 v[94:95], v56 offset:8448
    s_mov_b32 s77, 16384
    s_call_b64 s[82:83], cs_dma
    v_mov_b32 v46, 1
    s_mov_b64 exec, 1
    buffer_atomic_add v46, off, s[96:99], 0 offset:212 sc0
    s_mov_b64 exec, -1
    s_waitcnt lgkmcnt(0)
    v_add_u32 v55, 16384, v51
    v_xor_b32 v56, 32, v55
    ds_read_b64_tr_b16 v[96:97], v55 offset:0
    ds_read_b64_tr_b16 v[98:99], v55 offset:256
    ds_read_b64_tr_b16 v[100:101], v55 offset:8192
    ds_read_b64_tr_b16 v[102:103], v55 offset:8448
    s_mov_b32 s77, 24576
    s_call_b64 s[82:83], cs_dma
    ds_read_b64_tr_b16 v[104:105], v56 offset:0
    ds_read_b64_tr_b16 v[106:107], v56 offset:256
    ds_read_b64_tr_b16 v[108:109], v56 offset:8192
    ds_read_b64_tr_b16 v[110:111], v56 offset:8448
    s_mov_b32 s77, 32768
    s_call_b64 s[82:83], cs_dma
    s_waitcnt lgkmcnt(0)
    s_waitcnt vmcnt(9)
    v_add_u32 v55, 32768, v51
    v_xor_b32 v56, 32, v55
    ds_read_b64_tr_b16 v[112:113], v55 offset:0
    ds_read_b64_tr_b16 v[114:115], v55 offset:256
    ds_read_b64_tr_b16 v[116:117], v55 offset:8192
    ds_read_b64_tr_b16 v[118:119], v55 offset:8448
    s_xor_b32 s78, s75, 3145728
    s_add_u32 s78, s78, s67
    s_add_u32 s80, s66, 65536
    s_mov_b32 s76, 0
    s_mov_b32 s77, 8192
    s_call_b64 s[82:83], cs_dma
    ds_read_b64_tr_b16 v[120:121], v56 offset:0
    ds_read_b64_tr_b16 v[122:123], v56 offset:256
    ds_read_b64_tr_b16 v[124:125], v56 offset:8192
    ds_read_b64_tr_b16 v[126:127], v56 offset:8448
    s_mov_b32 s77, 16384
    s_call_b64 s[82:83], cs_dma
    s_waitcnt lgkmcnt(0)
    v_add_u32 v55, 49152, v51
    v_xor_b32 v56, 32, v55
    ds_read_b64_tr_b16 v[128:129], v55 offset:0
    ds_read_b64_tr_b16 v[130:131], v55 offset:256
    ds_read_b64_tr_b16 v[132:133], v55 offset:8192
    ds_read_b64_tr_b16 v[134:135], v55 offset:8448
    s_mov_b32 s77, 24576
    s_call_b64 s[82:83], cs_dma
    ds_read_b64_tr_b16 v[136:137], v56 offset:0
    ds_read_b64_tr_b16 v[138:139], v56 offset:256
    ds_read_b64_tr_b16 v[140:141], v56 offset:8192
    ds_read_b64_tr_b16 v[142:143], v56 offset:8448
    s_mov_b32 s77, 32768
    s_call_b64 s[82:83], cs_dma
    s_waitcnt lgkmcnt(0)
    s_waitcnt vmcnt(8)
    v_add_u32 v55, 131072, v51
    v_xor_b32 v56, 32, v55
    ds_read_b64_tr_b16 a[128:129], v55 offset:0
    ds_read_b64_tr_b16 a[130:131], v55 offset:256
    ds_read_b64_tr_b16 a[132:133], v55 offset:8192
    ds_read_b64_tr_b16 a[134:135], v55 offset:8448
    s_xor_b32 s78, s75, 2097152
    s_add_u32 s78, s78, s67
    s_mov_b64 s[8:9], s[50:51]
    s_add_u32 s80, s66, 0
    s_mov_b32 s76, 0
    s_mov_b32 s77, 8192
    s_call_b64 s[82:83], cs_dma
    ds_read_b64_tr_b16 a[136:137], v56 offset:0
    ds_read_b64_tr_b16 a[138:139], v56 offset:256
    ds_read_b64_tr_b16 a[140:141], v56 offset:8192
    ds_read_b64_tr_b16 a[142:143], v56 offset:8448
    s_mov_b32 s77, 16384
    s_call_b64 s[82:83], cs_dma
    s_waitcnt lgkmcnt(0)
    v_add_u32 v55, 147456, v51
    v_xor_b32 v56, 32, v55
    ds_read_b64_tr_b16 a[144:145], v55 offset:0
    ds_read_b64_tr_b16 a[146:147], v55 offset:256
    ds_read_b64_tr_b16 a[148:149], v55 offset:8192
    ds_read_b64_tr_b16 a[150:151], v55 offset:8448
    s_mov_b32 s77, 24576
    s_call_b64 s[82:83], cs_dma
    ds_read_b64_tr_b16 a[152:153], v56 offset:0
    ds_read_b64_tr_b16 a[154:155], v56 offset:256
    ds_read_b64_tr_b16 a[156:157], v56 offset:8192
    ds_read_b64_tr_b16 a[158:159], v56 offset:8448
    s_mov_b32 s77, 32768
    s_call_b64 s[82:83], cs_dma
    s_waitcnt lgkmcnt(0)
    s_waitcnt vmcnt(8)
    v_add_u32 v55, 65536, v51
    v_xor_b32 v56, 32, v55
    ds_read_b64_tr_b16 a[160:161], v55 offset:0
    ds_read_b64_tr_b16 a[162:163], v55 offset:256
    ds_read_b64_tr_b16 a[164:165], v55 offset:8192
    ds_read_b64_tr_b16 a[166:167], v55 offset:8448
    s_xor_b32 s78, s75, 3145728
    s_add_u32 s78, s78, s67
    s_add_u32 s80, s66, 32768
    s_mov_b32 s76, 0
    s_mov_b32 s77, 8192
    s_call_b64 s[82:83], cs_dma
    ds_read_b64_tr_b16 a[168:169], v56 offset:0
    ds_read_b64_tr_b16 a[170:171], v56 offset:256
    ds_read_b64_tr_b16 a[172:173], v56 offset:8192
    ds_read_b64_tr_b16 a[174:175], v56 offset:8448
    s_mov_b32 s77, 16384
    s_call_b64 s[82:83], cs_dma
    v_readfirstlane_b32 s41, v46
    v_mov_b32 v46, 1
    v_mov_b32 v47, 0
    s_cmp_eq_u32 s41, 127
    s_cselect_b64 exec, 1, 0
    buffer_atomic_cmpswap v[46:47], off, s[96:99], 0 offset:216
    s_mov_b64 exec, -1
    s_waitcnt lgkmcnt(0)
    v_add_u32 v55, 81920, v51
    v_xor_b32 v56, 32, v55
    ds_read_b64_tr_b16 a[176:177], v55 offset:0
    ds_read_b64_tr_b16 a[178:179], v55 offset:256
    ds_read_b64_tr_b16 a[180:181], v55 offset:8192
    ds_read_b64_tr_b16 a[182:183], v55 offset:8448
    s_mov_b32 s77, 24576
    s_call_b64 s[82:83], cs_dma
    ds_read_b64_tr_b16 a[184:185], v56 offset:0
    ds_read_b64_tr_b16 a[186:187], v56 offset:256
    ds_read_b64_tr_b16 a[188:189], v56 offset:8192
    ds_read_b64_tr_b16 a[190:191], v56 offset:8448
    s_mov_b32 s77, 32768
    s_call_b64 s[82:83], cs_dma
    s_waitcnt lgkmcnt(0)
    s_waitcnt vmcnt(8)
    v_add_u32 v55, 0, v51
    v_xor_b32 v56, 32, v55
    ds_read_b64_tr_b16 a[48:49], v55 offset:0
    ds_read_b64_tr_b16 a[50:51], v55 offset:256
    ds_read_b64_tr_b16 a[52:53], v55 offset:8192
    ds_read_b64_tr_b16 a[54:55], v55 offset:8448
    s_add_u32 s78, s67, 4194304
    s_mov_b32 s81, 0
    s_add_u32 s80, s66, 98304
    s_mov_b32 s76, 0
    s_mov_b32 s77, 8192
    s_call_b64 s[82:83], cs_dma
    ds_read_b64_tr_b16 a[56:57], v56 offset:0
    ds_read_b64_tr_b16 a[58:59], v56 offset:256
    ds_read_b64_tr_b16 a[60:61], v56 offset:8192
    ds_read_b64_tr_b16 a[62:63], v56 offset:8448
    s_mov_b32 s77, 16384
    s_call_b64 s[82:83], cs_dma
    s_waitcnt lgkmcnt(0)
    v_add_u32 v55, 16384, v51
    v_xor_b32 v56, 32, v55
    ds_read_b64_tr_b16 a[64:65], v55 offset:0
    ds_read_b64_tr_b16 a[66:67], v55 offset:256
    ds_read_b64_tr_b16 a[68:69], v55 offset:8192
    ds_read_b64_tr_b16 a[70:71], v55 offset:8448
    s_xor_b32 s78, s75, 1048576
    s_add_u32 s78, s78, s67
    s_mov_b32 s81, s93
    s_add_u32 s80, s66, 114688
    s_mov_b32 s76, 0
    s_mov_b32 s77, 8192
    s_call_b64 s[82:83], cs_dma
    ds_read_b64_tr_b16 a[72:73], v56 offset:0
    ds_read_b64_tr_b16 a[74:75], v56 offset:256
    ds_read_b64_tr_b16 a[76:77], v56 offset:8192
    ds_read_b64_tr_b16 a[78:79], v56 offset:8448
    s_mov_b32 s77, 16384
    s_call_b64 s[82:83], cs_dma
    s_waitcnt lgkmcnt(0)
    s_waitcnt vmcnt(8)
    v_add_u32 v55, 32768, v51
    v_xor_b32 v56, 32, v55
    ds_read_b64_tr_b16 a[80:81], v55 offset:0
    ds_read_b64_tr_b16 a[82:83], v55 offset:256
    ds_read_b64_tr_b16 a[84:85], v55 offset:8192
    ds_read_b64_tr_b16 a[86:87], v55 offset:8448
    s_mov_b32 s77, 24576
    s_call_b64 s[82:83], cs_dma
    ds_read_b64_tr_b16 a[88:89], v56 offset:0
    ds_read_b64_tr_b16 a[90:91], v56 offset:256
    ds_read_b64_tr_b16 a[92:93], v56 offset:8192
    ds_read_b64_tr_b16 a[94:95], v56 offset:8448
    s_mov_b32 s77, 32768
    s_call_b64 s[82:83], cs_dma
    s_waitcnt lgkmcnt(0)
    v_add_u32 v55, 49152, v51
    v_xor_b32 v56, 32, v55
    ds_read_b64_tr_b16 a[96:97], v55 offset:0
    ds_read_b64_tr_b16 a[98:99], v55 offset:256
    ds_read_b64_tr_b16 a[100:101], v55 offset:8192
    ds_read_b64_tr_b16 a[102:103], v55 offset:8448
    s_xor_b32 s78, s75, 0
    s_add_u32 s78, s78, s67
    s_add_u32 s80, s66, 65536
    s_mov_b32 s76, 0
    s_mov_b32 s77, 8192
    s_call_b64 s[82:83], cs_dma
    ds_read_b64_tr_b16 a[104:105], v56 offset:0
    ds_read_b64_tr_b16 a[106:107], v56 offset:256
    ds_read_b64_tr_b16 a[108:109], v56 offset:8192
    ds_read_b64_tr_b16 a[110:111], v56 offset:8448
    s_mov_b32 s77, 16384
    s_call_b64 s[82:83], cs_dma
    s_waitcnt lgkmcnt(0)
    s_waitcnt vmcnt(12)
    v_add_u32 v55, 98304, v51
    v_xor_b32 v56, 32, v55
    ds_read_b64_tr_b16 a[112:113], v55 offset:0
    ds_read_b64_tr_b16 a[114:115], v55 offset:256
    ds_read_b64_tr_b16 a[116:117], v55 offset:8192
    ds_read_b64_tr_b16 a[118:119], v55 offset:8448
    s_mov_b32 s77, 24576
    s_call_b64 s[82:83], cs_dma
    ds_read_b64_tr_b16 a[120:121], v56 offset:0
    ds_read_b64_tr_b16 a[122:123], v56 offset:256
    ds_read_b64_tr_b16 a[124:125], v56 offset:8192
    ds_read_b64_tr_b16 a[126:127], v56 offset:8448
    s_mov_b32 s77, 32768
    s_call_b64 s[82:83], cs_dma
    s_waitcnt lgkmcnt(0)
    s_waitcnt vmcnt(8)
    v_add_u32 v55, 114688, v51
    v_xor_b32 v56, 32, v55
    ds_read_b64_tr_b16 a[16:17], v55 offset:0
    ds_read_b64_tr_b16 a[18:19], v55 offset:256
    ds_read_b64_tr_b16 a[20:21], v55 offset:8192
    ds_read_b64_tr_b16 a[22:23], v55 offset:8448
    s_xor_b32 s78, s75, 0
    s_add_u32 s78, s78, s67
    s_mov_b64 s[8:9], s[52:53]
    s_add_u32 s80, s66, 0
    s_mov_b32 s76, 0
    s_mov_b32 s77, 8192
    s_call_b64 s[82:83], cs_dma
    ds_read_b64_tr_b16 a[24:25], v56 offset:0
    ds_read_b64_tr_b16 a[26:27], v56 offset:256
    ds_read_b64_tr_b16 a[28:29], v56 offset:8192
    ds_read_b64_tr_b16 a[30:31], v56 offset:8448
    s_mov_b32 s77, 16384
    s_call_b64 s[82:83], cs_dma
    s_waitcnt lgkmcnt(0)
    v_add_u32 v55, 131072, v51
    v_xor_b32 v56, 32, v55
    ds_read_b64_tr_b16 a[32:33], v55 offset:0
    ds_read_b64_tr_b16 a[34:35], v55 offset:256
    ds_read_b64_tr_b16 a[36:37], v55 offset:8192
    ds_read_b64_tr_b16 a[38:39], v55 offset:8448
    s_mov_b32 s77, 24576
    s_call_b64 s[82:83], cs_dma
    ds_read_b64_tr_b16 a[40:41], v56 offset:0
    ds_read_b64_tr_b16 a[42:43], v56 offset:256
    ds_read_b64_tr_b16 a[44:45], v56 offset:8192
    ds_read_b64_tr_b16 a[46:47], v56 offset:8448
    s_mov_b32 s77, 32768
    s_call_b64 s[82:83], cs_dma
    s_waitcnt lgkmcnt(0)
    s_waitcnt vmcnt(8)
    v_add_u32 v55, 65536, v51
    v_xor_b32 v56, 32, v55
    ds_read_b64_tr_b16 v[0:1], v55 offset:0
    ds_read_b64_tr_b16 v[2:3], v55 offset:256
    ds_read_b64_tr_b16 v[4:5], v55 offset:8192
    ds_read_b64_tr_b16 v[6:7], v55 offset:8448
    s_xor_b32 s78, s75, 1048576
    s_add_u32 s78, s78, s67
    s_add_u32 s80, s66, 32768
    s_mov_b32 s76, 0
    s_mov_b32 s77, 8192
    s_call_b64 s[82:83], cs_dma
    ds_read_b64_tr_b16 v[8:9], v56 offset:0
    ds_read_b64_tr_b16 v[10:11], v56 offset:256
    ds_read_b64_tr_b16 v[12:13], v56 offset:8192
    ds_read_b64_tr_b16 v[14:15], v56 offset:8448
    s_mov_b32 s77, 16384
    s_call_b64 s[82:83], cs_dma
    s_waitcnt lgkmcnt(0)
    ds_write_b128 v62, v[0:3] offset:8192
    ds_write_b128 v62, v[4:7] offset:12288
    ds_write_b128 v62, v[8:11] offset:16384
    ds_write_b128 v62, v[12:15] offset:20480
    s_waitcnt lgkmcnt(0)
    v_add_u32 v55, 81920, v51
    v_xor_b32 v56, 32, v55
    ds_read_b64_tr_b16 a[0:1], v55 offset:0
    ds_read_b64_tr_b16 a[2:3], v55 offset:256
    ds_read_b64_tr_b16 a[4:5], v55 offset:8192
    ds_read_b64_tr_b16 a[6:7], v55 offset:8448
    s_mov_b32 s77, 24576
    s_call_b64 s[82:83], cs_dma
    ds_read_b64_tr_b16 a[8:9], v56 offset:0
    ds_read_b64_tr_b16 a[10:11], v56 offset:256
    ds_read_b64_tr_b16 a[12:13], v56 offset:8192
    ds_read_b64_tr_b16 a[14:15], v56 offset:8448
    s_mov_b32 s77, 32768
    s_call_b64 s[82:83], cs_dma
    s_waitcnt lgkmcnt(0)
    s_waitcnt vmcnt(8)
    v_add_u32 v55, 0, v51
    v_xor_b32 v56, 32, v55
    ds_read_b64_tr_b16 v[0:1], v55 offset:0
    ds_read_b64_tr_b16 v[2:3], v55 offset:256
    ds_read_b64_tr_b16 v[4:5], v55 offset:8192
    ds_read_b64_tr_b16 v[6:7], v55 offset:8448
    s_xor_b32 s94, s13, 0
    s_mul_i32 s94, s94, 36864
    s_add_u32 s94, s94, s92
    s_lshr_b32 s74, s13, 1
    s_lshl_b32 s74, s74, 6
    s_add_u32 s94, s94, s74
    s_add_u32 s78, s94, 1024
    s_mov_b64 s[8:9], s[56:57]
    v_mov_b32 v58, v50
    s_mov_b32 s79, 18432
    s_mov_b32 s81, 0
    s_add_u32 s80, s66, 147456
    s_mov_b32 s76, 0
    s_mov_b32 s77, 8192
    s_call_b64 s[82:83], cs_dma
    ds_read_b64_tr_b16 v[8:9], v56 offset:0
    ds_read_b64_tr_b16 v[10:11], v56 offset:256
    ds_read_b64_tr_b16 v[12:13], v56 offset:8192
    ds_read_b64_tr_b16 v[14:15], v56 offset:8448
    s_xor_b32 s94, s13, 2
    s_mul_i32 s94, s94, 36864
    s_add_u32 s94, s94, s92
    s_lshr_b32 s74, s13, 1
    s_lshl_b32 s74, s74, 6
    s_add_u32 s94, s94, s74
    s_add_u32 s78, s94, 1024
    s_mov_b32 s77, 16384
    s_call_b64 s[82:83], cs_dma
    s_waitcnt lgkmcnt(0)
    ds_write_b128 v61, v[0:3] offset:0
    ds_write_b128 v61, v[4:7] offset:4096
    ds_write_b128 v61, v[8:11] offset:8192
    ds_write_b128 v61, v[12:15] offset:12288
    s_waitcnt lgkmcnt(0)
    v_add_u32 v55, 16384, v51
    v_xor_b32 v56, 32, v55
    ds_read_b64_tr_b16 v[0:1], v55 offset:0
    ds_read_b64_tr_b16 v[2:3], v55 offset:256
    ds_read_b64_tr_b16 v[4:5], v55 offset:8192
    ds_read_b64_tr_b16 v[6:7], v55 offset:8448
    s_xor_b32 s94, s13, 3
    s_mul_i32 s94, s94, 36864
    s_add_u32 s94, s94, s92
    s_lshl_b32 s74, s13, 7
    s_add_u32 s94, s94, s74
    s_add_u32 s78, s94, 512
    v_mov_b32 v58, v49
    s_mov_b32 s79, 9216
    s_add_u32 s80, s66, 131072
    s_mov_b32 s76, 0
    s_mov_b32 s77, 8192
    s_call_b64 s[82:83], cs_dma
    ds_read_b64_tr_b16 v[8:9], v56 offset:0
    ds_read_b64_tr_b16 v[10:11], v56 offset:256
    ds_read_b64_tr_b16 v[12:13], v56 offset:8192
    ds_read_b64_tr_b16 v[14:15], v56 offset:8448
    s_mov_b32 s77, 16384
    s_call_b64 s[82:83], cs_dma
    s_waitcnt lgkmcnt(0)
    ds_write_b128 v61, v[0:3] offset:16384
    ds_write_b128 v61, v[4:7] offset:20480
    ds_write_b128 v61, v[8:11] offset:24576
    ds_write_b128 v61, v[12:15] offset:28672
    s_waitcnt lgkmcnt(0)
    s_waitcnt vmcnt(8)
    v_add_u32 v55, 32768, v51
    v_xor_b32 v56, 32, v55
    ds_read_b64_tr_b16 v[0:1], v55 offset:0
    ds_read_b64_tr_b16 v[2:3], v55 offset:256
    ds_read_b64_tr_b16 v[4:5], v55 offset:8192
    ds_read_b64_tr_b16 v[6:7], v55 offset:8448
    s_xor_b32 s94, s13, 2
    s_mul_i32 s94, s94, 36864
    s_add_u32 s94, s94, s92
    s_lshl_b32 s74, s13, 7
    s_add_u32 s94, s94, s74
    s_add_u32 s78, s94, 512
    s_add_u32 s80, s66, 114688
    s_mov_b32 s76, 0
    s_mov_b32 s77, 8192
    s_call_b64 s[82:83], cs_dma
    ds_read_b64_tr_b16 v[8:9], v56 offset:0
    ds_read_b64_tr_b16 v[10:11], v56 offset:256
    ds_read_b64_tr_b16 v[12:13], v56 offset:8192
    ds_read_b64_tr_b16 v[14:15], v56 offset:8448
    s_mov_b32 s77, 16384
    s_call_b64 s[82:83], cs_dma
    s_waitcnt lgkmcnt(0)
    ds_write_b128 v61, v[0:3] offset:32768
    ds_write_b128 v61, v[4:7] offset:36864
    ds_write_b128 v61, v[8:11] offset:40960
    ds_write_b128 v61, v[12:15] offset:45056
    s_waitcnt lgkmcnt(0)
    v_add_u32 v55, 49152, v51
    v_xor_b32 v56, 32, v55
    ds_read_b64_tr_b16 v[0:1], v55 offset:0
    ds_read_b64_tr_b16 v[2:3], v55 offset:256
    ds_read_b64_tr_b16 v[4:5], v55 offset:8192
    ds_read_b64_tr_b16 v[6:7], v55 offset:8448
    s_add_u32 s78, s67, 4194304
    s_mov_b64 s[8:9], s[52:53]
    v_mov_b32 v58, v48
    s_mov_b32 s79, 131072
    s_add_u32 s80, s66, 81920
    s_mov_b32 s76, 0
    s_mov_b32 s77, 8192
    s_call_b64 s[82:83], cs_dma
    ds_read_b64_tr_b16 v[8:9], v56 offset:0
    ds_read_b64_tr_b16 v[10:11], v56 offset:256
    ds_read_b64_tr_b16 v[12:13], v56 offset:8192
    ds_read_b64_tr_b16 v[14:15], v56 offset:8448
    s_mov_b32 s77, 16384
    s_call_b64 s[82:83], cs_dma
    s_waitcnt lgkmcnt(0)
    ds_write_b128 v61, v[0:3] offset:49152
    ds_write_b128 v61, v[4:7] offset:53248
    ds_write_b128 v61, v[8:11] offset:57344
    ds_write_b128 v61, v[12:15] offset:61440
    s_waitcnt lgkmcnt(0)
    buffer_load_dword v24, off, s[96:99], 0 offset:216 sc1
    buffer_load_dword v25, off, s[96:99], 0 offset:64 sc1
    s_lshr_b32 s84, s12, 1
    s_lshl_b32 s84, s84, 8
    s_add_u32 s84, s84, 125829120
    v_bfe_u32 v26, v61, 4, 6
    v_min_u32 v26, 11, v26
    v_lshlrev_b32 v26, 2, v26
    buffer_load_dword v27, v26, s[4:7], s84 offen sc1
    s_waitcnt vmcnt(15)
    v_add_u32 v55, 147456, v53
    ds_read_b64_tr_b16 v[0:1], v55 offset:0
    ds_read_b64_tr_b16 v[2:3], v55 offset:128
    ds_read_b64_tr_b16 v[4:5], v55 offset:512
    ds_read_b64_tr_b16 v[6:7], v55 offset:640
    ds_read_b64_tr_b16 v[8:9], v55 offset:8192
    ds_read_b64_tr_b16 v[10:11], v55 offset:8320
    ds_read_b64_tr_b16 v[12:13], v55 offset:8704
    ds_read_b64_tr_b16 v[14:15], v55 offset:8832
    s_waitcnt lgkmcnt(0)
    s_barrier
    ds_write_b128 v63, v[0:3] offset:49152
    ds_write_b128 v63, v[4:7] offset:53248
    s_barrier
    ds_write_b128 v63, v[8:11] offset:57344
    ds_write_b128 v63, v[12:15] offset:61440
    s_waitcnt lgkmcnt(0)
    v_lshlrev_b32 v45, 3, v61
    s_lshl_b32 s40, s12, 14
    s_add_u32 s40, s40, 65536
    s_lshl_b32 s41, s12, 11
    s_sub_u32 s41, s41, 12288
    v_add_u32 v30, s40, v45
    v_add_u32 v45, s41, v45
    v_cmp_gt_u32 vcc, 1536, v61
    s_nop 1
    v_cndmask_b32 v45, v45, v30, vcc
    s_lshl_b32 s40, s12, 16
    s_add_u32 s40, s40, 24102912
    v_lshlrev_b32 v30, 3, v61
    v_add_u32 v30, s40, v30
    v_cmp_gt_u32 vcc, 1792, v61
    s_nop 1
    v_cndmask_b32 v45, v30, v45, vcc
    v_cmp_gt_u32 vcc, 2944, v61
    s_mov_b32 s40, 68157440
    s_mov_b64 exec, vcc
    buffer_load_dword v30, v45, s[4:7], s40 offen sc1
    s_mov_b64 exec, -1
    s_waitcnt vmcnt(11)
    v_add_u32 v55, 131072, v52
    ds_read_b64_tr_b16 v[0:1], v55 offset:0
    ds_read_b64_tr_b16 v[2:3], v55 offset:256
    ds_read_b64_tr_b16 v[4:5], v55 offset:4096
    ds_read_b64_tr_b16 v[6:7], v55 offset:4352
    ds_read_b64_tr_b16 v[8:9], v55 offset:64
    ds_read_b64_tr_b16 v[10:11], v55 offset:320
    ds_read_b64_tr_b16 v[12:13], v55 offset:4160
    ds_read_b64_tr_b16 v[14:15], v55 offset:4416
    s_waitcnt lgkmcnt(0)
    s_barrier
    ds_write_b128 v63, v[0:3] offset:32768
    ds_write_b128 v63, v[4:7] offset:36864
    s_barrier
    ds_write_b128 v63, v[8:11] offset:40960
    ds_write_b128 v63, v[12:15] offset:45056
    s_waitcnt lgkmcnt(0)
    s_waitcnt vmcnt(7)
    v_add_u32 v55, 114688, v52
    ds_read_b64_tr_b16 v[0:1], v55 offset:0
    ds_read_b64_tr_b16 v[2:3], v55 offset:256
    ds_read_b64_tr_b16 v[4:5], v55 offset:4096
    ds_read_b64_tr_b16 v[6:7], v55 offset:4352
    ds_read_b64_tr_b16 v[8:9], v55 offset:64
    ds_read_b64_tr_b16 v[10:11], v55 offset:320
    ds_read_b64_tr_b16 v[12:13], v55 offset:4160
    ds_read_b64_tr_b16 v[14:15], v55 offset:4416
    s_waitcnt lgkmcnt(0)
    s_barrier
    ds_write_b128 v63, v[0:3] offset:16384
    ds_write_b128 v63, v[4:7] offset:20480
    s_barrier
    ds_write_b128 v63, v[8:11] offset:24576
    ds_write_b128 v63, v[12:15] offset:28672
    s_waitcnt lgkmcnt(0)
    v_min_u32 v36, -2, v36
    v_min_u32 v37, -2, v37
    v_min_u32 v38, -2, v38
    v_min_u32 v39, -2, v39
    v_min_u32 v40, -2, v40
    v_min_u32 v41, -2, v41
    v_min_u32 v42, -2, v42
    v_min_u32 v43, -2, v43
    v_min_u32 v44, -2, v44
    s_lshl_b32 s14, s12, 16
    s_add_u32 s14, s14, 92274688
    s_add_u32 s41, s14, 4096
    s_add_u32 s42, s14, 8192
    v_lshrrev_b32 v45, 2, v61
    buffer_store_dwordx4 v[36:39], v61, s[4:7], s14 offen sc1
    buffer_store_dwordx4 v[40:43], v61, s[4:7], s41 offen sc1
    buffer_store_dword v44, v45, s[4:7], s42 offen sc1
    s_waitcnt vmcnt(1)
    v_readfirstlane_b32 s95, v25
    v_readfirstlane_b32 s85, v24
    s_add_u32 s86, s95, 2
    s_waitcnt vmcnt(0)
    v_subrev_u32 v27, s86, v27
    v_cmp_lt_u32 s[86:87], 64, v27
    s_cmp_eq_u32 s95, 0
    s_cselect_b64 s[86:87], -1, s[86:87]
    s_cmp_lg_u64 s[86:87], 0
    s_cbranch_scc1 cs_nt
    s_add_u32 s40, s24, 524288
    buffer_load_dword v30, v79, s[4:7], s24 offen sc1
    buffer_load_dword v30, v79, s[4:7], s40 offen sc1
cs_nt:
    s_waitcnt vmcnt(3)
    v_add_u32 v55, 81920, v51
    v_xor_b32 v56, 32, v55
    ds_read_b64_tr_b16 v[0:1], v55 offset:0
    ds_read_b64_tr_b16 v[2:3], v55 offset:256
    ds_read_b64_tr_b16 v[4:5], v55 offset:8192
    ds_read_b64_tr_b16 v[6:7], v55 offset:8448
    ds_read_b64_tr_b16 v[8:9], v56 offset:0
    ds_read_b64_tr_b16 v[10:11], v56 offset:256
    ds_read_b64_tr_b16 v[12:13], v56 offset:8192
    ds_read_b64_tr_b16 v[14:15], v56 offset:8448
    s_waitcnt lgkmcnt(0)
    ds_write_b128 v62, v[0:3] offset:24576
    ds_write_b128 v62, v[4:7] offset:28672
    ds_write_b128 v62, v[8:11] offset:32768
    ds_write_b128 v62, v[12:15] offset:36864
    s_waitcnt lgkmcnt(0)
    s_barrier
    s_mov_b32 s88, 4194304
gn3:
    s_cmp_lg_u32 s95, 0
    s_cbranch_scc1 gn3x
    buffer_load_dword v27, off, s[96:99], 0 offset:64 sc1
    s_sub_u32 s88, s88, 1
    s_cbranch_scc1 gn3x
    s_waitcnt vmcnt(0)
    v_readfirstlane_b32 s95, v27
    s_nop 1
    s_branch gn3
gn3x:
    ds_write_b128 v78, v[16:19] offset:8704
    ds_write_b128 v65, v[20:23] offset:10240
    v_mov_b32 v44, s95
    v_mov_b32 v45, s95
    v_mov_b32 v46, s95
    v_mov_b32 v47, s95
    v_mov_b32 v48, 108288
    ds_write_b128 v48, v[44:47]
    s_waitcnt vmcnt(0) lgkmcnt(0)
    s_cmp_eq_u32 s85, 1
    s_cbranch_scc1 cs_run
    s_mov_b32 s40, 16777216
cs_startpoll:
    buffer_load_dword v3, off, s[96:99], 0 offset:216 sc1
    s_waitcnt vmcnt(0)
    v_readfirstlane_b32 s85, v3
    s_nop 0
    s_cmp_eq_u32 s85, 1
    s_cbranch_scc1 cs_run
    s_sleep 1
    s_sub_u32 s40, s40, 1
    s_cbranch_scc0 cs_startpoll
    s_endpgm
cs_run:
    s_cmp_eq_u64 s[86:87], 0
    s_cbranch_scc1 cs_kvok
    s_lshr_b32 s92, s12, 1
    s_lshl_b32 s92, s92, 8
    s_add_u32 s92, s92, 125829120
    v_bfe_u32 v2, v61, 4, 6
    v_min_u32 v2, 11, v2
    v_lshlrev_b32 v2, 2, v2
    s_add_u32 s93, s95, 2
    s_mov_b32 s94, 4194304
cs_kv0:
    buffer_load_dword v3, v2, s[4:7], s92 offen sc1
    s_sub_u32 s94, s94, 1
    s_cbranch_scc1 cs_kv0_go
    s_waitcnt vmcnt(0)
    v_subrev_u32 v3, s93, v3
    v_cmp_lt_u32 vcc, 64, v3
    s_cbranch_vccz cs_kv0_go
    s_sleep 2
    s_branch cs_kv0
cs_kv0_go:
    s_add_u32 s40, s24, 524288
    buffer_load_dword v30, v79, s[4:7], s24 offen sc1
    buffer_load_dword v30, v79, s[4:7], s40 offen sc1
    s_waitcnt vmcnt(0)
cs_kvok:
    s_mov_b32 m0, 108032
    s_add_u32 s24, s24, 1048576
    s_mov_b32 s66, 0x201
    s_mov_b32 s67, 0xc0000000
    s_add_u32 s15, s14, 4096
    s_add_u32 s16, s14, 8192
    ds_read_b128 v[32:35], v62 offset:16384
    ds_read_b128 v[36:39], v62 offset:20480
    ds_read_b128 v[40:43], v61 offset:0
    ds_read_b128 v[44:47], v61 offset:4096
    ds_read_b128 v[48:51], v61 offset:8192
    ds_read_b128 v[52:55], v61 offset:12288
    s_add_u32 s18, s14, s31
    s_mov_b32 s29, 1048576
    buffer_load_dwordx4 v[24:27], v61, s[4:7], s14 offen sc1
.p2align 6
cs_loop:
    v_mov_b64 v[0:1], 0
    v_mov_b64 v[2:3], 0
    v_mov_b64 v[4:5], 0
    v_mov_b64 v[6:7], 0
    v_mov_b64 v[8:9], 0
    v_mov_b64 v[10:11], 0
    v_mov_b64 v[12:13], 0
    v_mov_b64 v[14:15], 0
cs_loop2:
    ds_read_b128 v[16:19], v62 offset:8192
    ds_read_b128 v[20:23], v62 offset:12288
    v_lshrrev_b32 v56, 2, v61
    v_add_u32 v58, 106496, v56
    s_mov_b32 s29, 1048576
    s_waitcnt lgkmcnt(0)
cs_chk0:
    s_waitcnt vmcnt(0)
cs_chk0b:
    v_max3_u32 v57, v24, v25, v26
    v_max_u32 v57, v57, v27
    v_cmp_eq_u32 vcc, -1, v57
    ds_write_b128 v62, v[24:27] offset:40960
    s_cbranch_vccnz cs_spin0
    v_smfmac_f32_16x16x64_bf16 v[0:3], v[24:27], v[16:23], v60
    buffer_load_dwordx4 v[28:31], v61, s[4:7], s15 offen sc1
    buffer_load_dword v59, v56, s[4:7], s16 offen sc1
    v_smfmac_f32_16x16x64_bf16 v[8:11], v[24:27], v[32:39], v60
    ds_read_b128 v[32:35], v61 offset:16384
    v_smfmac_f32_16x16x64_bf16 v[12:15], v[24:27], v[48:55], v60
    ds_read_b128 v[36:39], v61 offset:20480
    v_mfma_f32_16x16x16_bf16 v[16:19], v[72:73], v[72:73], 0
    s_waitcnt lgkmcnt(2)
    s_barrier
    ds_read_b128 v[48:51], v63 offset:0
    v_mfma_f32_16x16x16_bf16 v[20:23], v[72:73], v[72:73], 0
    ds_read_b128 v[52:55], v64 offset:0
    v_smfmac_f32_16x16x64_bf16 v[4:7], v[24:27], v[40:47], v60
    ds_read_b128 v[40:43], v61 offset:24576
    v_smfmac_f32_16x16x64_bf16 v[16:19], v[24:27], a[192:199], v60
    ds_read_b128 v[44:47], v61 offset:28672
    v_smfmac_f32_16x16x64_bf16 v[20:23], v[24:27], a[200:207], v60
    s_waitcnt lgkmcnt(3)
    v_smfmac_f32_16x16x64_bf16 v[0:3], v[48:51], a[0:7], v60
    s_add_u32 s43, s14, s31
    s_add_u32 s41, s14, 16384
    v_smfmac_f32_16x16x64_bf16 v[4:7], v[48:51], v[32:39], v60
    ds_read_b128 v[32:35], v61 offset:32768
    v_smfmac_f32_16x16x64_bf16 v[8:11], v[48:51], a[8:15], v60
    ds_read_b128 v[36:39], v61 offset:36864
    s_waitcnt lgkmcnt(2)
    v_smfmac_f32_16x16x64_bf16 v[12:15], v[48:51], v[40:47], v60
    ds_read_b128 v[40:43], v61 offset:40960
    v_smfmac_f32_16x16x64_bf16 v[0:3], v[52:55], a[16:23], v60
    ds_read_b128 v[44:47], v61 offset:45056
    v_smfmac_f32_16x16x64_bf16 v[8:11], v[52:55], a[24:31], v60
    ds_read_b128 v[48:51], v71 offset:0
    s_waitcnt lgkmcnt(3)
    v_smfmac_f32_16x16x64_bf16 v[4:7], v[52:55], v[32:39], v60
    s_waitcnt vmcnt(0)
    ds_write_b128 v62, v[28:31] offset:45056
    s_waitcnt lgkmcnt(2)
    v_smfmac_f32_16x16x64_bf16 v[12:15], v[52:55], v[40:47], v60
    ds_write_b32 v58, v59
    v_max3_u32 v57, v28, v29, v30
    s_waitcnt lgkmcnt(2)
    v_smfmac_f32_16x16x64_bf16 v[0:3], v[48:51], a[32:39], v60
    ds_read_b128 v[32:35], v61 offset:49152
    v_max3_u32 v57, v57, v31, v59
    v_smfmac_f32_16x16x64_bf16 v[8:11], v[48:51], a[40:47], v60
    ds_read_b128 v[36:39], v61 offset:53248
    v_cmp_eq_u32 vcc, -1, v57
    v_smfmac_f32_16x16x64_bf16 v[16:19], v[52:55], a[224:231], v60
    ds_read_b128 v[40:43], v61 offset:57344
    v_smfmac_f32_16x16x64_bf16 v[20:23], v[52:55], a[232:239], v60
    ds_read_b128 v[44:47], v61 offset:61440
    s_cbranch_vccnz cs_spin1
cs_go1:
    v_smfmac_f32_16x16x64_bf16 v[0:3], v[28:31], a[48:55], v60
    s_waitcnt lgkmcnt(4)
    s_barrier
    ds_read_b128 v[52:55], v63 offset:4096
    v_smfmac_f32_16x16x64_bf16 v[8:11], v[28:31], a[56:63], v60
    ds_read_b128 v[56:59], v71 offset:4096
    v_smfmac_f32_16x16x64_bf16 v[4:7], v[28:31], a[128:135], v60
    s_waitcnt lgkmcnt(2)
    v_smfmac_f32_16x16x64_bf16 v[4:7], v[48:51], v[32:39], v60
    buffer_load_dwordx4 v[32:35], v61, s[4:7], s23 offen offset:0 sc1
    v_smfmac_f32_16x16x64_bf16 v[12:15], v[48:51], v[40:47], v60
    ds_read_b128 v[48:51], v64 offset:4096
    v_smfmac_f32_16x16x64_bf16 v[12:15], v[28:31], a[136:143], v60
    ds_read_b128 v[24:27], v65 offset:8192
    s_and_b32 s41, s41, 65535
    s_add_u32 s41, s41, 68157440
    v_smfmac_f32_16x16x64_bf16 v[16:19], v[28:31], v[80:87], v60
    buffer_load_dwordx4 v[36:39], v61, s[4:7], s23 offen offset:1024 sc1
    v_smfmac_f32_16x16x64_bf16 v[20:23], v[28:31], v[88:95], v60
    s_add_u32 s17, s41, s31
    s_and_b32 s30, s28, 1
    s_waitcnt lgkmcnt(3)
    v_smfmac_f32_16x16x64_bf16 v[0:3], v[52:55], a[64:71], v60
    ds_read_b128 v[28:31], v78 offset:8704
    v_smfmac_f32_16x16x64_bf16 v[4:7], v[52:55], a[144:151], v60
    buffer_load_dwordx4 v[40:43], v61, s[4:7], s23 offen offset:2048 sc1
    v_smfmac_f32_16x16x64_bf16 v[8:11], v[52:55], a[72:79], v60
    v_smfmac_f32_16x16x64_bf16 v[12:15], v[52:55], a[152:159], v60
    v_smfmac_f32_16x16x64_bf16 v[16:19], v[52:55], v[96:103], v60
    buffer_load_dwordx4 v[44:47], v61, s[4:7], s23 offen offset:3072 sc1
    v_smfmac_f32_16x16x64_bf16 v[20:23], v[52:55], v[104:111], v60
    ds_read_b128 v[52:55], v62 offset:28672
    s_waitcnt lgkmcnt(3)
    v_smfmac_f32_16x16x64_bf16 v[0:3], v[48:51], a[80:87], v60
    v_smfmac_f32_16x16x64_bf16 v[4:7], v[48:51], a[160:167], v60
    v_smfmac_f32_16x16x64_bf16 v[8:11], v[48:51], a[88:95], v60
    v_smfmac_f32_16x16x64_bf16 v[12:15], v[48:51], a[168:175], v60
    v_smfmac_f32_16x16x64_bf16 v[16:19], v[48:51], v[112:119], v60
    buffer_load_dword v79, s[4:7], s24 offen sc1 lds
    v_smfmac_f32_16x16x64_bf16 v[20:23], v[48:51], v[120:127], v60
    ds_read_b128 v[48:51], v62 offset:24576
    v_smfmac_f32_16x16x64_bf16 v[0:3], v[56:59], a[96:103], v60
    s_bitcmp1_b64 s[66:67], s28
    v_smfmac_f32_16x16x64_bf16 v[8:11], v[56:59], a[104:111], v60
    s_waitcnt lgkmcnt(3)
    v_smfmac_f32_16x16x64_bf16 v[0:3], v[24:27], a[112:119], v60
    v_smfmac_f32_16x16x64_bf16 v[8:11], v[24:27], a[120:127], v60
    v_smfmac_f32_16x16x64_bf16 v[4:7], v[56:59], a[176:183], v60
    s_waitcnt lgkmcnt(0)
    v_cvt_pk_bf16_f32 v0, v0, v1
    v_smfmac_f32_16x16x64_bf16 v[4:7], v[24:27], v[48:55], v60
    ds_read_b128 v[48:51], v62 offset:32768
    v_cvt_pk_bf16_f32 v8, v8, v9
    v_smfmac_f32_16x16x64_bf16 v[12:15], v[56:59], a[184:191], v60
    ds_read_b128 v[52:55], v62 offset:36864
    v_cvt_pk_bf16_f32 v9, v10, v11
    v_smfmac_f32_16x16x64_bf16 v[16:19], v[56:59], v[128:135], v60
    v_cvt_pk_bf16_f32 v1, v2, v3
    v_mfma_f32_16x16x16_bf16 v[8:11], v[8:9], v[28:29], 0
    v_cvt_pk_bf16_f32 v2, v4, v5
    v_cvt_pk_bf16_f32 v3, v6, v7
    v_smfmac_f32_16x16x64_bf16 v[20:23], v[56:59], v[136:143], v60
    s_mov_b64 exec, s[36:37]
    ds_read_b128 v[56:59], v69
    s_mov_b64 exec, -1
    v_mfma_f32_16x16x32_bf16 v[4:7], v[0:3], v[28:31], 0
    v_cvt_pk_bf16_f32 v2, v8, v9
    s_waitcnt lgkmcnt(1)
    v_smfmac_f32_16x16x64_bf16 v[12:15], v[24:27], v[48:55], v60
    ds_read_b128 v[48:51], v63 offset:0
    v_cvt_pk_bf16_f32 v3, v10, v11
    s_waitcnt vmcnt(3)
    v_cvt_pk_bf16_f32 v0, v4, v5
    v_cvt_pk_bf16_f32 v1, v6, v7
    s_nop 1
    v_mfma_f32_16x16x32_bf16 v[4:7], v[36:39], v[0:3], 0
    v_cvt_pk_bf16_f32 v12, v12, v13
    v_cvt_pk_bf16_f32 v13, v14, v15
    s_nop 1
    v_mfma_f32_16x16x16_bf16 v[12:15], v[12:13], v[30:31], 0
    ds_read_b128 v[52:55], v71 offset:0
    ds_read_b128 v[36:39], v63 offset:53248
    v_mfma_f32_16x16x32_bf16 v[28:31], v[32:35], v[0:3], 0
    s_waitcnt vmcnt(1)
    ds_read_b128 v[32:35], v63 offset:49152
    s_mov_b64 exec, s[34:35]
    s_nop 0
    v_cvt_pk_bf16_f32 v2, v12, v13
    v_cvt_pk_bf16_f32 v3, v14, v15
    s_mov_b64 exec, -1
    s_nop 0
    v_mfma_f32_16x16x32_bf16 v[8:11], v[0:3], v[0:3], 0
    v_mov_b32_dpp v28, v4 row_ror:8 row_mask:0xf bank_mask:0xc
    v_mov_b32_dpp v29, v5 row_ror:8 row_mask:0xf bank_mask:0xc
    v_mov_b32_dpp v30, v6 row_ror:8 row_mask:0xf bank_mask:0xc
    v_mov_b32_dpp v31, v7 row_ror:8 row_mask:0xf bank_mask:0xc
    v_smfmac_f32_16x16x64_bf16 v[16:19], v[24:27], v[144:151], v60
    ds_write_b128 v62, v[28:31] offset:53248
    v_mov_b32_dpp v8, v10 row_ror:8 row_mask:0xf bank_mask:0xc
    v_mov_b32_dpp v9, v11 row_ror:8 row_mask:0xf bank_mask:0xc
    v_smfmac_f32_16x16x64_bf16 v[20:23], v[24:27], v[152:159], v60
    ds_write_b64 v70, v[8:9]
    s_waitcnt lgkmcnt(5)
    v_smfmac_f32_16x16x64_bf16 v[16:19], v[48:51], a[208:215], v60
    s_mov_b64 exec, s[36:37]
    s_cbranch_execz cs_np3680
    buffer_store_dwordx4 v[56:59], v61, s[4:7], s65 offen sc1
cs_np3680:
    s_mov_b64 exec, -1
    v_smfmac_f32_16x16x64_bf16 v[20:23], v[48:51], a[216:223], v60
    s_cbranch_scc1 cs_last
cs_back:
    s_waitcnt lgkmcnt(0)
    s_barrier
    ds_read_b128 v[56:59], v78 offset:10752
    v_smfmac_f32_16x16x64_bf16 v[16:19], v[52:55], a[240:247], v60
    ds_read_b128 v[12:15], v78 offset:11264
    ds_read_b128 v[4:7], v63 offset:12288
    v_smfmac_f32_16x16x64_bf16 v[20:23], v[52:55], a[248:255], v60
    ds_read_b128 v[8:11], v64 offset:12288
    ds_read_b128 v[0:3], v71 offset:12288
    v_mov_b64 v[24:25], s[62:63]
    v_mov_b64 v[26:27], s[60:61]
    v_cvt_pk_bf16_f32 v16, v16, v17
    v_cvt_pk_bf16_f32 v17, v18, v19
    v_pk_mul_f32 v[28:29], v[28:29], s[44:45]
    v_pk_mul_f32 v[30:31], v[30:31], s[44:45]
    s_waitcnt lgkmcnt(3)
    v_pk_add_f32 v[56:57], v[56:57], v[58:59]
    v_pk_add_f32 v[12:13], v[12:13], v[14:15]
    v_pk_add_f32 v[56:57], v[56:57], v[12:13]
    v_pk_mul_f32 v[56:57], v[56:57], s[44:45]
    v_exp_f32 v58, v56
    v_exp_f32 v59, v57
    s_waitcnt lgkmcnt(1)
    v_pk_fma_f32 v[28:29], v[4:5], s[44:45], v[28:29]
    v_pk_fma_f32 v[30:31], v[6:7], s[44:45], v[30:31]
    v_cvt_pk_bf16_f32 v6, v58, v59
    v_pk_fma_f32 v[28:29], v[8:9], s[44:45], v[28:29]
    v_pk_fma_f32 v[30:31], v[10:11], s[44:45], v[30:31]
    s_waitcnt lgkmcnt(0)
    v_pk_fma_f32 v[28:29], v[0:1], s[44:45], v[28:29]
    v_mov_b32_dpp v7, v6 row_ror:8 row_mask:0xf bank_mask:0xf
    v_pk_fma_f32 v[30:31], v[2:3], s[44:45], v[30:31]
    v_exp_f32 v0, v28
    v_mfma_f32_16x16x16_bf16 v[12:15], v[16:17], v[6:7], 0
    ds_read_b128 v[48:51], v63 offset:57344
    v_exp_f32 v1, v29
    v_cvt_pk_bf16_f32 v18, v20, v21
    v_exp_f32 v2, v30
    v_cvt_pk_bf16_f32 v19, v22, v23
    v_cvt_pk_bf16_f32 v8, v0, v1
    v_exp_f32 v3, v31
    v_mfma_f32_16x16x16_bf16 v[20:23], v[18:19], v[6:7], 0
    ds_read_b128 v[52:55], v63 offset:61440
    v_cvt_pk_bf16_f32 v9, v2, v3
    v_mov_b32_dpp v10, v8 row_ror:8 row_mask:0xf bank_mask:0xf
    v_max3_f32 v4, |v28|, |v29|, |v30|
    v_mov_b32_dpp v11, v9 row_ror:8 row_mask:0xf bank_mask:0xf
    v_mfma_f32_16x16x32_bf16 v[0:3], v[24:27], v[6:9], 0
    v_max3_f32 v4, v4, |v31|, |v56|
    v_max_f32_e64 v4, v4, |v57|
    v_mfma_f32_16x16x32_bf16 v[12:15], v[40:43], v[8:11], v[12:15]
    v_cmp_nge_f32 vcc, s46, v4
    v_mfma_f32_16x16x32_bf16 v[20:23], v[44:47], v[8:11], v[20:23]
    v_add_f32_dpp v0, v0, v0 row_ror:8 row_mask:0xf bank_mask:0xf
    v_rcp_f32 v0, v0
    s_cbranch_vccnz cs_guard
cs_norm:
    v_mfma_f32_16x16x16_bf16 v[28:31], v[72:73], v[72:73], 0
    v_mul_f32 v12, v12, v0
    v_mul_f32 v13, v13, v0
    v_mul_f32 v14, v14, v0
    v_mul_f32 v15, v15, v0
    v_mul_f32_dpp v12, v20, v0 row_ror:8 row_mask:0xf bank_mask:0xc
    v_mul_f32_dpp v13, v21, v0 row_ror:8 row_mask:0xf bank_mask:0xc
    v_mul_f32_dpp v14, v22, v0 row_ror:8 row_mask:0xf bank_mask:0xc
    v_mul_f32_dpp v15, v23, v0 row_ror:8 row_mask:0xf bank_mask:0xc
    v_cvt_pk_bf16_f32 v12, v12, v13
    v_cvt_pk_bf16_f32 v13, v14, v15
    v_mfma_f32_16x16x16_bf16 v[8:11], v[72:73], v[72:73], 0
    ds_write_b64 v77, v[12:13]
    v_mfma_f32_16x16x16_bf16 v[4:7], v[72:73], v[72:73], 0
    ds_read_b128 v[0:3], v68
    v_mfma_f32_16x16x16_bf16 v[16:19], v[72:73], v[72:73], 0
    ds_read_b128 v[40:43], v63 offset:16384
    v_mfma_f32_16x16x16_bf16 v[20:23], v[72:73], v[72:73], 0
    ds_read_b128 v[44:47], v63 offset:20480
    s_waitcnt lgkmcnt(3)
    s_barrier
    ds_read_b128 v[24:27], v74
    ds_read_b128 v[12:15], v75
    ds_read_b128 v[56:59], v76
    s_waitcnt lgkmcnt(5)
    v_smfmac_f32_16x16x64_bf16 v[28:31], v[0:3], v[160:167], v60
    v_smfmac_f32_16x16x64_bf16 v[8:11], v[0:3], v[192:199], v60
    v_smfmac_f32_16x16x64_bf16 v[4:7], v[0:3], v[32:39], v60
    ds_read_b128 v[32:35], v63 offset:32768
    v_smfmac_f32_16x16x64_bf16 v[16:19], v[0:3], v[224:231], v60
    ds_read_b128 v[36:39], v63 offset:36864
    s_waitcnt lgkmcnt(3)
    v_smfmac_f32_16x16x64_bf16 v[28:31], v[24:27], v[168:175], v60
    v_smfmac_f32_16x16x64_bf16 v[4:7], v[12:15], v[48:55], v60
    ds_read_b128 v[48:51], v63 offset:24576
    v_smfmac_f32_16x16x64_bf16 v[28:31], v[12:15], v[176:183], v60
    ds_read_b128 v[52:55], v63 offset:28672
    s_waitcnt lgkmcnt(4)
    v_smfmac_f32_16x16x64_bf16 v[28:31], v[56:59], v[184:191], v60
    v_cvt_pk_bf16_f32 v4, v4, v5
    v_smfmac_f32_16x16x64_bf16 v[16:19], v[12:15], v[40:47], v60
    ds_read_b128 v[40:43], v63 offset:40960
    v_and_or_b32 v4, v4, -2, s30
    v_smfmac_f32_16x16x64_bf16 v[8:11], v[24:27], v[200:207], v60
    ds_read_b128 v[44:47], v63 offset:45056
    v_cvt_pk_bf16_f32 v5, v6, v7
    v_smfmac_f32_16x16x64_bf16 v[8:11], v[12:15], v[208:215], v60
    buffer_store_dwordx2 v[4:5], v67, s[4:7], s22 offen sc1
    v_cvt_pk_bf16_f32 v28, v28, v29
    v_smfmac_f32_16x16x64_bf16 v[8:11], v[56:59], v[216:223], v60
    v_and_or_b32 v28, v28, -2, s30
    v_smfmac_f32_16x16x64_bf16 v[16:19], v[24:27], v[232:239], v60
    v_cvt_pk_bf16_f32 v29, v30, v31
    s_waitcnt lgkmcnt(4)
    v_smfmac_f32_16x16x64_bf16 v[16:19], v[56:59], v[32:39], v60
    buffer_store_dwordx2 v[28:29], v66, s[4:7], s20 offen sc1
    v_cvt_pk_bf16_f32 v8, v8, v9
    s_waitcnt lgkmcnt(0)
    v_smfmac_f32_16x16x64_bf16 v[20:23], v[0:3], v[240:247], v60
    v_and_or_b32 v8, v8, -2, s30
    v_smfmac_f32_16x16x64_bf16 v[20:23], v[24:27], v[248:255], v60
    v_cvt_pk_bf16_f32 v9, v10, v11
    v_smfmac_f32_16x16x64_bf16 v[20:23], v[12:15], v[48:55], v60
    buffer_store_dwordx2 v[8:9], v66, s[4:7], s21 offen sc1
    v_cvt_pk_bf16_f32 v16, v16, v17
    v_smfmac_f32_16x16x64_bf16 v[20:23], v[56:59], v[40:47], v60
    v_and_or_b32 v16, v16, -2, s30
    v_cvt_pk_bf16_f32 v17, v18, v19
    buffer_store_dwordx2 v[16:17], v66, s[4:7], s38 offen sc1
    s_cmp_lg_u32 s13, 2
    s_nop 1
    v_cvt_pk_bf16_f32 v20, v20, v21
    v_and_or_b32 v20, v20, -2, s30
    v_cvt_pk_bf16_f32 v21, v22, v23
    buffer_store_dwordx2 v[20:21], v66, s[4:7], s39 offen sc1
    s_cbranch_scc1 cs_w013
    v_mov_b32 v21, -1
    s_mov_b64 exec, s[32:33]
    buffer_store_dword v21, v69, s[4:7], s18 offen sc1
    s_mov_b64 exec, -1
    s_mov_b32 s18, s43
    s_nop 15
    s_nop 15
    s_nop 15
    s_nop 15
    s_nop 15
    s_nop 15
    s_nop 15
    s_nop 15
    s_nop 15
    s_nop 15
    s_nop 15
    s_nop 15
    s_nop 0
    buffer_load_dwordx4 v[40:43], v65, s[4:7], s19 offen offset:0 sc1
    buffer_load_dwordx4 v[44:47], v65, s[4:7], s19 offen offset:1024 sc1
    buffer_load_dwordx4 v[48:51], v65, s[4:7], s19 offen offset:2048 sc1
    buffer_load_dwordx4 v[52:55], v65, s[4:7], s19 offen offset:3072 sc1
    ds_read_b128 v[56:59], v65 offset:10240
    s_add_u32 s28, s28, 1
    s_mov_b32 s14, s41
    s_add_u32 s23, s23, 524288
    s_add_u32 s24, s24, 524288
    s_min_u32 s24, s24, s47
    s_add_u32 s15, s14, 4096
    s_add_u32 s16, s14, 8192
    s_add_u32 s65, s65, 12288
    s_mov_b32 s40, 1
    v_mov_b64 v[0:1], 0
    v_mov_b64 v[2:3], 0
    v_mov_b64 v[4:5], 0
    v_mov_b64 v[6:7], 0
    v_mov_b64 v[8:9], 0
    v_mov_b64 v[10:11], 0
    v_mov_b64 v[12:13], 0
    v_mov_b64 v[14:15], 0
cs_chkF:
    v_mov_b32 v20, 0
    s_waitcnt vmcnt(3)
    s_waitcnt lgkmcnt(0)
    v_mfma_f32_16x16x32_bf16 v[28:31], v[40:43], v[56:59], 0
    v_bitop3_b32 v20, v20, v40, s30 bitop3:0xf6
    v_bitop3_b32 v20, v20, v42, s30 bitop3:0xf6
    s_waitcnt vmcnt(2)
    v_mfma_f32_16x16x32_bf16 v[28:31], v[44:47], v[56:59], v[28:31]
    v_bitop3_b32 v20, v20, v44, s30 bitop3:0xf6
    v_bitop3_b32 v20, v20, v46, s30 bitop3:0xf6
    s_waitcnt vmcnt(1)
    v_mfma_f32_16x16x32_bf16 v[28:31], v[48:51], v[56:59], v[28:31]
    v_bitop3_b32 v20, v20, v48, s30 bitop3:0xf6
    v_bitop3_b32 v20, v20, v50, s30 bitop3:0xf6
    s_waitcnt vmcnt(0)
    v_mfma_f32_16x16x32_bf16 v[28:31], v[52:55], v[56:59], v[28:31]
    v_bitop3_b32 v20, v20, v52, s30 bitop3:0xf6
    v_bitop3_b32 v20, v20, v54, s30 bitop3:0xf6
    v_and_b32 v20, s40, v20
    v_cmp_ne_u32 vcc, 0, v20
    s_cbranch_vccnz cs_spinF
    v_permlane32_swap_b32 v28, v30
    v_permlane32_swap_b32 v29, v31
    v_add_f32 v28, v28, v30
    v_add_f32 v30, v29, v31
    v_cvt_pk_bf16_f32 v28, v28, v30
    s_mov_b64 exec, s[32:33]
    buffer_store_dword v28, v69, s[4:7], s17 offen sc1
    s_mov_b64 exec, -1
    ds_read_b128 v[32:35], v62 offset:16384
    ds_read_b128 v[36:39], v62 offset:20480
    ds_read_b128 v[40:43], v61 offset:0
    ds_read_b128 v[44:47], v61 offset:4096
    ds_read_b128 v[48:51], v61 offset:8192
    ds_read_b128 v[52:55], v61 offset:12288
    s_nop 15
    s_nop 15
    s_nop 15
    s_nop 15
    s_nop 15
    s_nop 15
    s_nop 3
    buffer_load_dwordx4 v[24:27], v61, s[4:7], s14 offen sc1
    s_branch cs_loop2
cs_w013:
    ds_read_b128 v[56:59], v65 offset:10240
    ds_read_b128 v[32:35], v62 offset:16384
    ds_read_b128 v[36:39], v62 offset:20480
    ds_read_b128 v[40:43], v61 offset:0
    ds_read_b128 v[44:47], v61 offset:4096
    ds_read_b128 v[48:51], v61 offset:8192
    ds_read_b128 v[52:55], v61 offset:12288
    s_add_u32 s28, s28, 1
    s_mov_b32 s14, s41
    s_add_u32 s23, s23, 524288
    s_add_u32 s24, s24, 524288
    s_min_u32 s24, s24, s47
    s_add_u32 s15, s14, 4096
    s_add_u32 s16, s14, 8192
    s_add_u32 s65, s65, 12288
    s_mov_b32 s40, 1
    s_cmp_eq_u32 s64, 0
    s_cbranch_scc1 cs_w0
    v_mov_b32 v21, -1
    s_mov_b64 exec, s[32:33]
    buffer_store_dword v21, v69, s[4:7], s18 offen sc1
    s_mov_b64 exec, -1
    s_mov_b32 s18, s43
    s_cmp_eq_u32 s13, 1
    s_cbranch_scc1 cs_sx
    s_nop 15
    s_nop 15
    s_nop 15
    s_nop 15
    s_nop 15
    s_nop 15
    s_nop 15
    s_nop 15
    s_nop 15
    s_nop 15
    s_nop 15
    s_nop 15
    s_nop 7
cs_sx:
    buffer_load_dwordx4 v[0:3], v65, s[4:7], s19 offen offset:0 sc1
    buffer_load_dwordx4 v[4:7], v65, s[4:7], s19 offen offset:1024 sc1
    buffer_load_dwordx4 v[8:11], v65, s[4:7], s19 offen offset:2048 sc1
    buffer_load_dwordx4 v[12:15], v65, s[4:7], s19 offen offset:3072 sc1
cs_chkG:
    v_mov_b32 v20, 0
    s_waitcnt vmcnt(3)
    s_waitcnt lgkmcnt(6)
    v_mfma_f32_16x16x32_bf16 v[28:31], v[0:3], v[56:59], 0
    v_bitop3_b32 v20, v20, v0, s30 bitop3:0xf6
    v_bitop3_b32 v20, v20, v2, s30 bitop3:0xf6
    s_waitcnt vmcnt(2)
    v_mfma_f32_16x16x32_bf16 v[28:31], v[4:7], v[56:59], v[28:31]
    v_bitop3_b32 v20, v20, v4, s30 bitop3:0xf6
    v_bitop3_b32 v20, v20, v6, s30 bitop3:0xf6
    s_waitcnt vmcnt(1)
    v_mfma_f32_16x16x32_bf16 v[28:31], v[8:11], v[56:59], v[28:31]
    v_bitop3_b32 v20, v20, v8, s30 bitop3:0xf6
    v_bitop3_b32 v20, v20, v10, s30 bitop3:0xf6
    s_waitcnt vmcnt(0)
    v_mfma_f32_16x16x32_bf16 v[28:31], v[12:15], v[56:59], v[28:31]
    v_bitop3_b32 v20, v20, v12, s30 bitop3:0xf6
    v_bitop3_b32 v20, v20, v14, s30 bitop3:0xf6
    v_and_b32 v20, s40, v20
    v_cmp_ne_u32 vcc, 0, v20
    s_cbranch_vccnz cs_spinG
    v_permlane32_swap_b32 v28, v30
    v_permlane32_swap_b32 v29, v31
    v_add_f32 v28, v28, v30
    v_add_f32 v30, v29, v31
    s_cmp_eq_u32 s13, 3
    s_cbranch_scc1 cs_w3
    v_mov_b32 v29, v28
    v_mov_b32 v31, v30
    s_nop 0
    v_permlane16_swap_b32 v28, v29
    v_permlane16_swap_b32 v30, v31
    v_add_f32 v28, v28, v29
    v_add_f32 v30, v30, v31
cs_w3:
    v_cvt_pk_bf16_f32 v28, v28, v30
    s_mov_b64 exec, s[32:33]
    buffer_store_dword v28, v69, s[4:7], s17 offen sc1
    s_mov_b64 exec, -1
    buffer_load_dwordx4 v[24:27], v61, s[4:7], s14 offen sc1
    s_branch cs_loop
cs_w0:
    v_mov_b64 v[0:1], 0
    v_mov_b64 v[2:3], 0
    v_mov_b64 v[4:5], 0
    v_mov_b64 v[6:7], 0
    v_mov_b64 v[8:9], 0
    v_mov_b64 v[10:11], 0
    v_mov_b64 v[12:13], 0
    v_mov_b64 v[14:15], 0
    s_nop 15
    s_nop 15
    s_nop 15
    s_nop 15
    s_nop 15
    s_nop 15
    s_nop 15
    s_nop 15
    s_nop 4
    s_cmp_lg_u32 s28, 10
    s_cbranch_scc1 cs_nokv
    s_lshr_b32 s92, s12, 1
    s_lshl_b32 s92, s92, 8
    s_add_u32 s92, s92, 125829120
    v_bfe_u32 v28, v61, 4, 6
    v_min_u32 v28, 11, v28
    v_lshlrev_b32 v28, 2, v28
    v_add_u32 v28, 108304, v28
    s_waitcnt vmcnt(0)
    ds_read_b32 v29, v28
    s_add_u32 s93, s95, 63
    s_waitcnt lgkmcnt(0)
    v_cmp_ne_u32 vcc, s93, v29
    s_cbranch_vccz cs_kv1_go
    s_lshr_b32 s92, s12, 1
    s_lshl_b32 s92, s92, 8
    s_add_u32 s92, s92, 125833216
    v_bfe_u32 v28, v61, 4, 6
    v_min_u32 v28, 11, v28
    v_lshlrev_b32 v28, 2, v28
    s_add_u32 s93, s95, 63
    s_mov_b32 s94, 4194304
cs_kv1:
    buffer_load_dword v29, v28, s[4:7], s92 offen sc1
    s_sub_u32 s94, s94, 1
    s_cbranch_scc1 cs_kv1_go
    s_waitcnt vmcnt(0)
    v_subrev_u32 v29, s93, v29
    v_cmp_lt_u32 vcc, 64, v29
    s_cbranch_vccz cs_kv1_go
    s_sleep 2
    s_branch cs_kv1
cs_kv1_go:
    s_branch cs_w0p
cs_nokv:
    s_nop 15
    s_nop 15
    s_nop 15
    s_nop 15
    s_nop 15
    s_nop 15
    s_nop 15
    s_nop 15
    s_nop 15
    s_nop 15
    s_nop 15
    s_nop 15
    s_nop 15
    s_nop 15
    s_nop 15
    s_nop 15
    s_nop 10
cs_w0p:
    buffer_load_dwordx4 v[24:27], v61, s[4:7], s14 offen sc1
    s_branch cs_loop2
cs_spinF:
    buffer_load_dwordx4 v[40:43], v65, s[4:7], s19 offen offset:0 sc1
    buffer_load_dwordx4 v[44:47], v65, s[4:7], s19 offen offset:1024 sc1
    buffer_load_dwordx4 v[48:51], v65, s[4:7], s19 offen offset:2048 sc1
    buffer_load_dwordx4 v[52:55], v65, s[4:7], s19 offen offset:3072 sc1
    s_sub_u32 s29, s29, 1
    s_cmp_lt_i32 s29, 0
    s_cselect_b32 s40, 0, 1
    s_branch cs_chkF
cs_spinG:
    buffer_load_dwordx4 v[0:3], v65, s[4:7], s19 offen offset:0 sc1
    buffer_load_dwordx4 v[4:7], v65, s[4:7], s19 offen offset:1024 sc1
    buffer_load_dwordx4 v[8:11], v65, s[4:7], s19 offen offset:2048 sc1
    buffer_load_dwordx4 v[12:15], v65, s[4:7], s19 offen offset:3072 sc1
    s_sub_u32 s29, s29, 1
    s_cmp_lt_i32 s29, 0
    s_cselect_b32 s40, 0, 1
    s_branch cs_chkG
cs_guard:
    s_cbranch_scc0 cs_guard2
    buffer_store_dwordx4 v[16:19], v61, s[4:7], s26 offen sc1
    s_add_u32 s26, s26, 131072
    s_add_u32 s40, s95, 63
    v_mov_b32 v5, s40
    s_mov_b64 exec, 1
    buffer_store_dword v5, off, s[4:7], s27 sc1
    s_mov_b64 exec, -1
cs_guard2:
    s_nop 7
    v_max3_f32 v6, v28, v29, v30
    v_max3_f32 v7, v31, v56, v57
    v_max_f32 v6, v6, v7
    s_nop 1
    v_max_f32_dpp v6, v6, v6 row_ror:8 row_mask:0xf bank_mask:0xf
    v_mov_b32 v7, v6
    s_nop 1
    v_permlane32_swap_b32 v6, v7
    v_max_f32 v6, v6, v7
    v_mov_b32 v7, v6
    s_nop 1
    v_permlane16_swap_b32 v6, v7
    v_max_f32 v6, v6, v7
    v_sub_f32 v28, v28, v6
    v_sub_f32 v29, v29, v6
    v_sub_f32 v30, v30, v6
    v_sub_f32 v31, v31, v6
    v_sub_f32 v56, v56, v6
    v_sub_f32 v57, v57, v6
    v_exp_f32 v58, v56
    v_exp_f32 v59, v57
    s_nop 0
    v_cvt_pk_bf16_f32 v6, v58, v59
    s_nop 1
    v_mov_b32_dpp v7, v6 row_ror:8 row_mask:0xf bank_mask:0xf
    v_exp_f32 v0, v28
    s_nop 0
    v_mfma_f32_16x16x16_bf16 v[12:15], v[16:17], v[6:7], 0
    v_exp_f32 v1, v29
    v_exp_f32 v2, v30
    v_cvt_pk_bf16_f32 v8, v0, v1
    v_exp_f32 v3, v31
    v_mfma_f32_16x16x16_bf16 v[20:23], v[18:19], v[6:7], 0
    v_cvt_pk_bf16_f32 v9, v2, v3
    v_mov_b32_dpp v10, v8 row_ror:8 row_mask:0xf bank_mask:0xf
    v_max3_f32 v4, |v28|, |v29|, |v30|
    v_mov_b32_dpp v11, v9 row_ror:8 row_mask:0xf bank_mask:0xf
    v_mfma_f32_16x16x32_bf16 v[0:3], v[24:27], v[6:9], 0
    v_max3_f32 v4, v4, |v31|, |v56|
    v_max_f32_e64 v4, v4, |v57|
    v_mfma_f32_16x16x32_bf16 v[12:15], v[40:43], v[8:11], v[12:15]
    v_cmp_nge_f32 vcc, s46, v4
    v_mfma_f32_16x16x32_bf16 v[20:23], v[44:47], v[8:11], v[20:23]
    v_add_f32_dpp v0, v0, v0 row_ror:8 row_mask:0xf bank_mask:0xf
    v_rcp_f32 v0, v0
    s_nop 4
    s_branch cs_norm
cs_spin0:
    buffer_load_dwordx4 v[24:27], v61, s[4:7], s14 offen sc1
    s_sub_u32 s29, s29, 1
    s_cmp_lt_i32 s29, 0
    s_cbranch_scc0 cs_chk0
    s_waitcnt vmcnt(0)
    v_min_u32 v24, -2, v24
    v_min_u32 v25, -2, v25
    v_min_u32 v26, -2, v26
    v_min_u32 v27, -2, v27
    s_branch cs_chk0
cs_spin1:
    buffer_load_dwordx4 v[28:31], v61, s[4:7], s15 offen sc1
    buffer_load_dword v59, v56, s[4:7], s16 offen sc1
    s_sub_u32 s29, s29, 1
    s_cmp_lt_i32 s29, 0
    s_waitcnt vmcnt(0)
    v_max3_u32 v57, v28, v29, v30
    v_max3_u32 v57, v57, v31, v59
    v_cmp_eq_u32 vcc, -1, v57
    ds_write_b128 v62, v[28:31] offset:45056
    ds_write_b32 v58, v59
    s_waitcnt lgkmcnt(0)
    s_cbranch_scc1 cs_go1
    s_cbranch_vccnz cs_spin1
    s_branch cs_go1
cs_last:
    s_nop 1
    s_cmp_ge_u32 s28, 2
    s_cbranch_scc1 cs_last0
    s_and_b32 s40, s12, 3
    s_lshl_b32 s40, s40, 14
    s_add_u32 s40, s40, 68157440
    s_lshr_b32 s42, s12, 2
    s_lshl_b32 s42, s42, 3
    s_lshl_b64 exec, 0x55, s42
    buffer_load_dword v79, s[4:7], s40 offen sc1 lds
    s_mov_b64 exec, -1
    s_cmp_eq_u32 0, 1
    s_branch cs_back
cs_last0:
    s_cmp_lg_u32 s28, 9
    s_cbranch_scc1 cs_last1
    s_lshr_b32 s92, s12, 1
    s_lshl_b32 s92, s92, 8
    s_add_u32 s92, s92, 125833216
    v_bfe_u32 v48, v61, 4, 6
    v_min_u32 v48, 11, v48
    v_lshlrev_b32 v48, 2, v48
    s_mov_b32 m0, 108304
    s_mov_b64 exec, 0xfff
    buffer_load_dword v48, s[4:7], s92 offen sc1 lds
    s_mov_b64 exec, -1
    s_mov_b32 m0, 108032
    s_cmp_eq_u32 0, 1
    s_branch cs_back
cs_last1:
    s_cmp_eq_u32 s28, 63
    s_cbranch_scc1 cs_last2
    s_mov_b64 exec, s[34:35]
    buffer_store_dwordx4 v[0:3], v61, s[4:7], s25 offen sc1
    s_mov_b64 exec, -1
    s_add_u32 s25, s25, 131072
    s_mov_b32 s46, 0xbf800000
    s_cmp_eq_u32 0, 0
    s_branch cs_back
cs_last2:
    s_waitcnt lgkmcnt(0)
    s_mov_b64 exec, s[34:35]
    buffer_store_dwordx4 v[0:3], v61, s[4:7], s25 offen sc1
    s_mov_b64 exec, -1
    s_add_u32 s40, s95, 64
    v_mov_b32 v40, s40
    v_smfmac_f32_16x16x64_bf16 v[16:19], v[52:55], a[240:247], v60
    v_smfmac_f32_16x16x64_bf16 v[20:23], v[52:55], a[248:255], v60
    s_nop 3
    v_cvt_pk_bf16_f32 v16, v16, v17
    v_cvt_pk_bf16_f32 v17, v18, v19
    s_nop 1
    v_cvt_pk_bf16_f32 v18, v20, v21
    v_cvt_pk_bf16_f32 v19, v22, v23
    buffer_store_dwordx4 v[16:19], v61, s[4:7], s26 offen sc1
    s_mov_b64 exec, 1
    buffer_store_dword v40, off, s[4:7], s27 sc1
    s_mov_b64 exec, -1
    s_endpgm
cs_dma:
    s_xor_b32 s74, s76, s81
    s_add_u32 m0, s74, s80
    s_add_u32 s76, s76, 4096
    buffer_load_dwordx4 v58, s[8:11], s78 offen lds
    s_add_u32 s78, s78, s79
    s_cmp_lt_u32 s76, s77
    s_cbranch_scc1 cs_dma
    s_setpc_b64 s[82:83]
L_helper:
    s_load_dwordx16 s[64:79], s[0:1], 64
    s_sub_u32 s33, s3, 4
    s_and_b32 s33, s33, 7
L_pool:
    s_lshl_b32 s35, s33, 2
    s_add_u32 s35, s35, 32
    s_mov_b32 s37, s35
    v_mov_b32 v250, 1
    v_mov_b32 v251, 163832
    v_cmp_eq_u32 vcc, 0, v0
    s_nop 0
    s_and_saveexec_b64 s[38:39], vcc
    s_cbranch_execz tk4
    buffer_atomic_add v250, off, s[96:99], s37 sc0
    s_waitcnt vmcnt(0)
    ds_write_b32 v251, v250
    s_waitcnt lgkmcnt(0)
tk4:
    s_mov_b64 exec, -1
    s_barrier
    ds_read_b32 v252, v251
    s_waitcnt lgkmcnt(0)
    v_readfirstlane_b32 s34, v252
    s_barrier
    s_nop 3
    s_mov_b32 s36, s33
    s_or_b32 s33, s34, s32
    s_cmp_lg_u32 s33, 0
    s_cbranch_scc1 L_helper1
    s_memrealtime s[90:91]
    s_waitcnt lgkmcnt(0)
    s_lshl_b32 s90, s90, 8
    s_or_b32 s90, s90, 1
    v_mov_b32 v250, s90
    v_mov_b32 v251, 0
    s_mov_b64 exec, 1
    buffer_atomic_cmpswap v[250:251], off, s[96:99], 0 offset:64
    s_mov_b64 exec, -1
L_helper1:
    s_cmp_ge_u32 s34, 32
    s_cbranch_scc1 L_qkv_next
    s_cmp_ge_u32 s36, 7
    s_cbranch_scc1 L_qkv_next
    s_mov_b32 s38, 0
    s_cmp_eq_u32 s36, 6
    s_cbranch_scc1 L_copy
    s_lshl_b32 s36, s36, 5
    s_add_u32 s36, s36, s34
    s_mul_i32 s37, s36, 171
    s_lshr_b32 s37, s37, 10
    s_mul_i32 s38, s37, 6
    s_sub_u32 s36, s36, s38
    s_lshl_b32 s36, s36, 5
    s_add_u32 s36, s36, s37
    s_branch L_job
    s_cmp_eq_u32 s36, 6
    s_cselect_b32 s36, s34, s36
    s_cbranch_scc1 L_job
    s_max_u32 s37, s36, 4
    s_sub_u32 s37, s37, 4
    s_mul_i32 s37, s37, 5
    s_mul_i32 s38, s36, 7
    s_sub_u32 s38, s38, s37
    s_cmp_lt_u32 s36, 4
    s_cselect_b32 s39, 7, 2
    s_mul_i32 s36, s36, 25
    s_add_u32 s36, s36, s37
    s_cmp_lt_u32 s34, s39
    s_cbranch_scc1 L_copy
    s_add_u32 s36, s36, s34
    s_sub_u32 s36, s36, s39
    s_mul_i32 s37, s36, 205
    s_lshr_b32 s37, s37, 10
    s_mul_i32 s38, s37, 5
    s_sub_u32 s36, s36, s38
    s_add_u32 s36, s36, 1
    s_lshl_b32 s36, s36, 5
    s_add_u32 s36, s36, s37
    s_branch L_job
L_copy:
    s_add_u32 s36, s38, s34
    s_mul_i32 s36, s36, 11
    s_and_b32 s36, s36, 31
    s_cmp_ge_u32 s36, 27
    s_cbranch_scc1 L_cdone
    s_mul_i32 s33, s36, 57
    s_lshr_b32 s33, s33, 9
    s_mul_i32 s37, s33, 9
    s_sub_u32 s37, s36, s37
    s_lshl_b32 s36, s37, 2
    s_add_u32 s36, s36, 1
    s_min_u32 s36, s36, 31
    s_lshr_b32 s39, s52, 8
    s_sub_u32 s36, s36, s39
    s_and_b32 s36, s36, 31
    s_lshl_b32 s36, s36, 8
    s_mov_b32 s14, 4718592
    s_mov_b32 s15, 0x20000
    v_lshrrev_b32 v1, 4, v0
    v_lshlrev_b32 v1, 13, v1
    v_and_b32 v2, 15, v0
    v_lshl_add_u32 v1, v2, 4, v1
    v_lshlrev_b32 v2, 4, v0
    s_mul_i32 s40, s33, 2
    s_mul_i32 s39, s40, 49152
    s_lshl_b32 s41, s37, 19
    s_add_u32 s39, s39, s41
    s_add_u32 s39, s39, 96468992
    s_add_u32 s41, s40, 0
    s_cmp_lt_u32 s41, 3
    s_cselect_b64 s[12:13], s[52:53], s[54:55]
    s_cselect_b32 s42, 0, 3
    s_cmp_ge_u32 s41, 6
    s_cselect_b64 s[12:13], s[56:57], s[12:13]
    s_cselect_b32 s42, 6, s42
    s_sub_u32 s41, s41, s42
    s_mul_i32 s38, s41, 1572864
    s_add_u32 s38, s38, s36
    buffer_load_dwordx4 v[8:11], v1, s[12:15], s38 offen
    s_add_u32 s38, s38, 131072
    buffer_load_dwordx4 v[12:15], v1, s[12:15], s38 offen
    s_add_u32 s38, s38, 131072
    buffer_load_dwordx4 v[16:19], v1, s[12:15], s38 offen
    s_add_u32 s38, s38, 131072
    buffer_load_dwordx4 v[20:23], v1, s[12:15], s38 offen
    s_add_u32 s38, s38, 131072
    buffer_load_dwordx4 v[24:27], v1, s[12:15], s38 offen
    s_add_u32 s38, s38, 131072
    buffer_load_dwordx4 v[28:31], v1, s[12:15], s38 offen
    s_add_u32 s38, s38, 131072
    buffer_load_dwordx4 v[32:35], v1, s[12:15], s38 offen
    s_add_u32 s38, s38, 131072
    buffer_load_dwordx4 v[36:39], v1, s[12:15], s38 offen
    s_add_u32 s38, s38, 131072
    buffer_load_dwordx4 v[40:43], v1, s[12:15], s38 offen
    s_add_u32 s38, s38, 131072
    buffer_load_dwordx4 v[44:47], v1, s[12:15], s38 offen
    s_add_u32 s38, s38, 131072
    buffer_load_dwordx4 v[48:51], v1, s[12:15], s38 offen
    s_add_u32 s38, s38, 131072
    buffer_load_dwordx4 v[52:55], v1, s[12:15], s38 offen
    s_add_u32 s38, s38, 131072
    s_add_u32 s41, s40, 1
    s_cmp_lt_u32 s41, 3
    s_cselect_b64 s[12:13], s[52:53], s[54:55]
    s_cselect_b32 s42, 0, 3
    s_cmp_ge_u32 s41, 6
    s_cselect_b64 s[12:13], s[56:57], s[12:13]
    s_cselect_b32 s42, 6, s42
    s_sub_u32 s41, s41, s42
    s_mul_i32 s38, s41, 1572864
    s_add_u32 s38, s38, s36
    buffer_load_dwordx4 v[56:59], v1, s[12:15], s38 offen
    s_add_u32 s38, s38, 131072
    buffer_load_dwordx4 v[60:63], v1, s[12:15], s38 offen
    s_add_u32 s38, s38, 131072
    buffer_load_dwordx4 v[64:67], v1, s[12:15], s38 offen
    s_add_u32 s38, s38, 131072
    buffer_load_dwordx4 v[68:71], v1, s[12:15], s38 offen
    s_add_u32 s38, s38, 131072
    buffer_load_dwordx4 v[72:75], v1, s[12:15], s38 offen
    s_add_u32 s38, s38, 131072
    buffer_load_dwordx4 v[76:79], v1, s[12:15], s38 offen
    s_add_u32 s38, s38, 131072
    buffer_load_dwordx4 v[80:83], v1, s[12:15], s38 offen
    s_add_u32 s38, s38, 131072
    buffer_load_dwordx4 v[84:87], v1, s[12:15], s38 offen
    s_add_u32 s38, s38, 131072
    buffer_load_dwordx4 v[88:91], v1, s[12:15], s38 offen
    s_add_u32 s38, s38, 131072
    buffer_load_dwordx4 v[92:95], v1, s[12:15], s38 offen
    s_add_u32 s38, s38, 131072
    buffer_load_dwordx4 v[96:99], v1, s[12:15], s38 offen
    s_add_u32 s38, s38, 131072
    buffer_load_dwordx4 v[100:103], v1, s[12:15], s38 offen
    s_add_u32 s38, s38, 131072
    buffer_load_dword v3, off, s[96:99], 0 offset:64 sc1
    s_waitcnt vmcnt(0)
    buffer_store_dwordx4 v[8:11], v2, s[4:7], s39 offen sc1
    s_add_u32 s39, s39, 4096
    buffer_store_dwordx4 v[12:15], v2, s[4:7], s39 offen sc1
    s_add_u32 s39, s39, 4096
    buffer_store_dwordx4 v[16:19], v2, s[4:7], s39 offen sc1
    s_add_u32 s39, s39, 4096
    buffer_store_dwordx4 v[20:23], v2, s[4:7], s39 offen sc1
    s_add_u32 s39, s39, 4096
    buffer_store_dwordx4 v[24:27], v2, s[4:7], s39 offen sc1
    s_add_u32 s39, s39, 4096
    buffer_store_dwordx4 v[28:31], v2, s[4:7], s39 offen sc1
    s_add_u32 s39, s39, 4096
    buffer_store_dwordx4 v[32:35], v2, s[4:7], s39 offen sc1
    s_add_u32 s39, s39, 4096
    buffer_store_dwordx4 v[36:39], v2, s[4:7], s39 offen sc1
    s_add_u32 s39, s39, 4096
    buffer_store_dwordx4 v[40:43], v2, s[4:7], s39 offen sc1
    s_add_u32 s39, s39, 4096
    buffer_store_dwordx4 v[44:47], v2, s[4:7], s39 offen sc1
    s_add_u32 s39, s39, 4096
    buffer_store_dwordx4 v[48:51], v2, s[4:7], s39 offen sc1
    s_add_u32 s39, s39, 4096
    buffer_store_dwordx4 v[52:55], v2, s[4:7], s39 offen sc1
    s_add_u32 s39, s39, 4096
    buffer_store_dwordx4 v[56:59], v2, s[4:7], s39 offen sc1
    s_add_u32 s39, s39, 4096
    buffer_store_dwordx4 v[60:63], v2, s[4:7], s39 offen sc1
    s_add_u32 s39, s39, 4096
    buffer_store_dwordx4 v[64:67], v2, s[4:7], s39 offen sc1
    s_add_u32 s39, s39, 4096
    buffer_store_dwordx4 v[68:71], v2, s[4:7], s39 offen sc1
    s_add_u32 s39, s39, 4096
    buffer_store_dwordx4 v[72:75], v2, s[4:7], s39 offen sc1
    s_add_u32 s39, s39, 4096
    buffer_store_dwordx4 v[76:79], v2, s[4:7], s39 offen sc1
    s_add_u32 s39, s39, 4096
    buffer_store_dwordx4 v[80:83], v2, s[4:7], s39 offen sc1
    s_add_u32 s39, s39, 4096
    buffer_store_dwordx4 v[84:87], v2, s[4:7], s39 offen sc1
    s_add_u32 s39, s39, 4096
    buffer_store_dwordx4 v[88:91], v2, s[4:7], s39 offen sc1
    s_add_u32 s39, s39, 4096
    buffer_store_dwordx4 v[92:95], v2, s[4:7], s39 offen sc1
    s_add_u32 s39, s39, 4096
    buffer_store_dwordx4 v[96:99], v2, s[4:7], s39 offen sc1
    s_add_u32 s39, s39, 4096
    buffer_store_dwordx4 v[100:103], v2, s[4:7], s39 offen sc1
    s_add_u32 s39, s39, 4096
    v_readfirstlane_b32 s95, v3
    s_nop 4
    s_mov_b32 s88, 4194304
gn5:
    s_cmp_lg_u32 s95, 0
    s_cbranch_scc1 gn5x
    buffer_load_dword v3, off, s[96:99], 0 offset:64 sc1
    s_sub_u32 s88, s88, 1
    s_cbranch_scc1 gn5x
    s_waitcnt vmcnt(0)
    v_readfirstlane_b32 s95, v3
    s_nop 1
    s_branch gn5
gn5x:
    s_lshl_b32 s37, s37, 7
    s_lshl_b32 s36, s33, 2
    s_add_u32 s36, s36, s32
    s_lshl_b32 s36, s36, 2
    s_add_u32 s37, s37, s36
    s_add_u32 s37, s37, 125853696
    v_mov_b32 v3, s95
    s_waitcnt vmcnt(0)
    s_mov_b64 exec, 1
    buffer_store_dword v3, off, s[4:7], s37 sc1
    s_mov_b64 exec, -1
L_cdone:
    s_add_u32 s20, s34, 112
    s_waitcnt lgkmcnt(0)
    s_branch L_sjob
L_qkv_next:
    s_mov_b32 s37, 4
    v_mov_b32 v250, 1
    v_mov_b32 v251, 163832
    v_cmp_eq_u32 vcc, 0, v0
    s_nop 0
    s_and_saveexec_b64 s[38:39], vcc
    s_cbranch_execz tk6
    buffer_atomic_add v250, off, s[96:99], s37 sc0
    s_waitcnt vmcnt(0)
    ds_write_b32 v251, v250
    s_waitcnt lgkmcnt(0)
tk6:
    s_mov_b64 exec, -1
    s_barrier
    ds_read_b32 v252, v251
    s_waitcnt lgkmcnt(0)
    v_readfirstlane_b32 s36, v252
    s_barrier
    s_nop 3
    s_add_u32 s36, s36, 192
    s_cmp_ge_u32 s36, 320
    s_cbranch_scc1 L_ssm_next
L_job:
    s_and_b32 s17, s36, 15
    s_lshl_b32 s17, s17, 1
    s_bfe_u32 s16, s36, 0x10004
    s_lshr_b32 s19, s36, 5
    s_mul_i32 s33, s16, 6
    s_add_u32 s33, s33, s19
    s_add_u32 s16, s16, 1
    s_lshr_b32 s37, s36, 4
    s_sub_u32 s38, s37, 12
    s_cmp_ge_u32 s36, 192
    s_cselect_b32 s16, 0, s16
    s_cselect_b32 s19, s38, s19
    s_cselect_b32 s33, s37, s33
    s_cselect_b32 s20, 8, 6
    v_lshrrev_b32 v4, 6, v0
    s_nop 0
    v_readfirstlane_b32 s18, v4
    v_lshlrev_b32 v7, 4, v0
    v_and_b32 v4, 63, v0
    v_lshrrev_b32 v6, 2, v4
    v_lshlrev_b32 v6, 13, v6
    v_lshrrev_b32 v5, 4, v4
    v_and_b32 v5, 2, v5
    v_xor_b32 v5, v5, v4
    v_and_b32 v5, 3, v5
    v_lshl_add_u32 v6, v5, 4, v6
    v_lshrrev_b32 v24, 4, v4
    v_lshlrev_b32 v24, 9, v24
    v_bfe_u32 v5, v4, 2, 2
    v_lshl_add_u32 v24, v5, 6, v24
    v_bfe_u32 v5, v4, 4, 1
    v_lshl_add_u32 v24, v5, 5, v24
    v_and_b32 v5, 3, v4
    v_lshl_add_u32 v24, v5, 3, v24
    s_lshl_b32 s31, s18, 12
    v_add_u32 v24, s31, v24
    s_cmp_eq_u32 s16, 1
    s_cselect_b64 s[12:13], s[54:55], s[52:53]
    s_cmp_eq_u32 s16, 2
    s_cselect_b64 s[12:13], s[56:57], s[12:13]
    s_mov_b32 s14, 4718592
    s_mov_b32 s15, 0x20000
    s_lshl_b32 s28, s17, 8
    s_lshl_b32 s21, s18, 6
    s_add_u32 s28, s28, s21
    s_add_u32 s21, s28, 0
    s_add_u32 m0, s31, 40960
    s_nop 0
    buffer_load_dwordx4 v6, s[12:15], s21 offen lds
    s_add_u32 m0, s31, 41984
    s_add_u32 s21, s21, 131072
    buffer_load_dwordx4 v6, s[12:15], s21 offen lds
    s_add_u32 m0, s31, 43008
    s_add_u32 s21, s21, 131072
    buffer_load_dwordx4 v6, s[12:15], s21 offen lds
    s_add_u32 m0, s31, 44032
    s_add_u32 s21, s21, 131072
    buffer_load_dwordx4 v6, s[12:15], s21 offen lds
    s_add_u32 s21, s28, 256
    s_add_u32 m0, s31, 57344
    s_nop 0
    buffer_load_dwordx4 v6, s[12:15], s21 offen lds
    s_add_u32 m0, s31, 58368
    s_add_u32 s21, s21, 131072
    buffer_load_dwordx4 v6, s[12:15], s21 offen lds
    s_add_u32 m0, s31, 59392
    s_add_u32 s21, s21, 131072
    buffer_load_dwordx4 v6, s[12:15], s21 offen lds
    s_add_u32 m0, s31, 60416
    s_add_u32 s21, s21, 131072
    buffer_load_dwordx4 v6, s[12:15], s21 offen lds
    s_add_u32 s21, s28, 524288
    s_add_u32 m0, s31, 73728
    s_nop 0
    buffer_load_dwordx4 v6, s[12:15], s21 offen lds
    s_add_u32 m0, s31, 74752
    s_add_u32 s21, s21, 131072
    buffer_load_dwordx4 v6, s[12:15], s21 offen lds
    s_add_u32 m0, s31, 75776
    s_add_u32 s21, s21, 131072
    buffer_load_dwordx4 v6, s[12:15], s21 offen lds
    s_add_u32 m0, s31, 76800
    s_add_u32 s21, s21, 131072
    buffer_load_dwordx4 v6, s[12:15], s21 offen lds
    s_add_u32 s21, s28, 524544
    s_add_u32 m0, s31, 90112
    s_nop 0
    buffer_load_dwordx4 v6, s[12:15], s21 offen lds
    s_add_u32 m0, s31, 91136
    s_add_u32 s21, s21, 131072
    buffer_load_dwordx4 v6, s[12:15], s21 offen lds
    s_add_u32 m0, s31, 92160
    s_add_u32 s21, s21, 131072
    buffer_load_dwordx4 v6, s[12:15], s21 offen lds
    s_add_u32 m0, s31, 93184
    s_add_u32 s21, s21, 131072
    buffer_load_dwordx4 v6, s[12:15], s21 offen lds
    s_add_u32 s21, s28, 1048576
    s_add_u32 m0, s31, 106496
    s_nop 0
    buffer_load_dwordx4 v6, s[12:15], s21 offen lds
    s_add_u32 m0, s31, 107520
    s_add_u32 s21, s21, 131072
    buffer_load_dwordx4 v6, s[12:15], s21 offen lds
    s_add_u32 m0, s31, 108544
    s_add_u32 s21, s21, 131072
    buffer_load_dwordx4 v6, s[12:15], s21 offen lds
    s_add_u32 m0, s31, 109568
    s_add_u32 s21, s21, 131072
    buffer_load_dwordx4 v6, s[12:15], s21 offen lds
    s_add_u32 s21, s28, 1048832
    s_add_u32 m0, s31, 122880
    s_nop 0
    buffer_load_dwordx4 v6, s[12:15], s21 offen lds
    s_add_u32 m0, s31, 123904
    s_add_u32 s21, s21, 131072
    buffer_load_dwordx4 v6, s[12:15], s21 offen lds
    s_add_u32 m0, s31, 124928
    s_add_u32 s21, s21, 131072
    buffer_load_dwordx4 v6, s[12:15], s21 offen lds
    s_add_u32 m0, s31, 125952
    s_add_u32 s21, s21, 131072
    buffer_load_dwordx4 v6, s[12:15], s21 offen lds
    s_add_u32 s21, s28, 1572864
    s_add_u32 m0, s31, 139264
    s_nop 0
    buffer_load_dwordx4 v6, s[12:15], s21 offen lds
    s_add_u32 m0, s31, 140288
    s_add_u32 s21, s21, 131072
    buffer_load_dwordx4 v6, s[12:15], s21 offen lds
    s_add_u32 m0, s31, 141312
    s_add_u32 s21, s21, 131072
    buffer_load_dwordx4 v6, s[12:15], s21 offen lds
    s_add_u32 m0, s31, 142336
    s_add_u32 s21, s21, 131072
    buffer_load_dwordx4 v6, s[12:15], s21 offen lds
    v_and_b32 v5, 15, v4
    v_lshrrev_b32 v3, 4, v4
    v_lshrrev_b32 v2, 2, v5
    v_xor_b32 v3, v3, v2
    v_lshl_add_u32 v3, v5, 2, v3
    v_lshlrev_b32 v1, 4, v3
    v_lshrrev_b32 v5, 2, v4
    v_lshrrev_b32 v3, 4, v4
    v_and_b32 v4, 3, v4
    v_xor_b32 v4, v4, v3
    v_lshlrev_b32 v3, 3, v3
    v_and_b32 v5, 3, v5
    v_add_u32 v3, v3, v5
    v_mul_u32_u24 v2, 1152, v3
    v_lshl_add_u32 v2, v4, 4, v2
    s_mov_b32 s8, s48
    s_mov_b32 s9, s49
    s_mov_b32 s10, 2359296
    s_mov_b32 s11, 0x20000
    s_lshr_b32 s22, s18, 1
    s_mul_i32 s24, s22, 4608
    s_and_b32 s22, s18, 1
    s_mul_i32 s23, s22, 576
    s_add_u32 s24, s24, s23
    s_mul_i32 s25, s18, 9216
    s_mul_i32 s22, s19, 36864
    s_add_u32 s24, s24, s22
    s_mul_i32 s42, s20, 36864
    s_mov_b32 s27, 0
    s_add_u32 s23, s27, s25
    s_add_u32 m0, s23, 0
    s_nop 0
    buffer_load_dwordx4 v2, s[8:11], s24 offen offset:0 lds
    s_add_u32 m0, s23, 960
    s_nop 0
    buffer_load_dwordx4 v2, s[8:11], s24 offen offset:64 lds
    s_add_u32 m0, s23, 1920
    s_nop 0
    buffer_load_dwordx4 v2, s[8:11], s24 offen offset:128 lds
    s_add_u32 m0, s23, 2880
    s_nop 0
    buffer_load_dwordx4 v2, s[8:11], s24 offen offset:192 lds
    s_add_u32 m0, s23, 3840
    s_nop 0
    buffer_load_dwordx4 v2, s[8:11], s24 offen offset:256 lds
    s_add_u32 m0, s23, 4800
    s_nop 0
    buffer_load_dwordx4 v2, s[8:11], s24 offen offset:320 lds
    s_add_u32 m0, s23, 5760
    s_nop 0
    buffer_load_dwordx4 v2, s[8:11], s24 offen offset:384 lds
    s_add_u32 m0, s23, 6720
    s_nop 0
    buffer_load_dwordx4 v2, s[8:11], s24 offen offset:448 lds
    s_add_u32 m0, s23, 7680
    s_nop 0
    buffer_load_dwordx4 v2, s[8:11], s24 offen offset:512 lds
    s_add_u32 s24, s24, s42
    s_lshl_b32 s22, s19, 5
    s_add_u32 s22, s22, s17
    s_lshl_b32 s26, s22, 14
    s_mul_i32 s23, s18, 3072
    s_add_u32 s26, s26, s23
    s_lshl_b32 s23, s16, 11
    s_add_u32 s26, s26, s23
    s_add_u32 s26, s26, -2048
    s_lshl_b32 s22, s22, 13
    s_add_u32 s22, s22, 33554432
    s_cmp_eq_u32 s16, 0
    s_cselect_b32 s26, s22, s26
    s_cselect_b32 s40, 4, 1
    s_cselect_b32 s43, 1, 2
    s_lshl_b32 s40, s40, 10
    s_lshl_b32 s43, s43, 13
    s_lshl_b32 s41, s43, 5
    s_mul_i32 s41, s41, s20
    s_lshl_b32 s29, s17, 7
    s_lshl_b32 s22, s33, 2
    s_add_u32 s29, s29, s22
    s_add_u32 s29, s29, 125829120
    v_add_u32 v25, 40960, v24
    v_xor_b32 v26, 32, v25
    s_waitcnt vmcnt(33)
    ds_read_b64_tr_b16 v[64:65], v25 offset:0
    ds_read_b64_tr_b16 v[66:67], v25 offset:256
    ds_read_b64_tr_b16 v[136:137], v26 offset:0
    ds_read_b64_tr_b16 v[138:139], v26 offset:256
    ds_read_b64_tr_b16 v[68:69], v25 offset:2048
    ds_read_b64_tr_b16 v[70:71], v25 offset:2304
    ds_read_b64_tr_b16 v[140:141], v26 offset:2048
    ds_read_b64_tr_b16 v[142:143], v26 offset:2304
    s_waitcnt lgkmcnt(0)
    s_add_u32 s21, s28, 1573120
    s_add_u32 m0, s31, 40960
    s_nop 0
    buffer_load_dwordx4 v6, s[12:15], s21 offen lds
    s_add_u32 m0, s31, 41984
    s_add_u32 s21, s21, 131072
    buffer_load_dwordx4 v6, s[12:15], s21 offen lds
    s_add_u32 m0, s31, 43008
    s_add_u32 s21, s21, 131072
    buffer_load_dwordx4 v6, s[12:15], s21 offen lds
    s_add_u32 m0, s31, 44032
    s_add_u32 s21, s21, 131072
    buffer_load_dwordx4 v6, s[12:15], s21 offen lds
    v_add_u32 v25, 57344, v24
    v_xor_b32 v26, 32, v25
    s_waitcnt vmcnt(33)
    ds_read_b64_tr_b16 a[0:1], v25 offset:0
    ds_read_b64_tr_b16 a[2:3], v25 offset:256
    ds_read_b64_tr_b16 a[72:73], v26 offset:0
    ds_read_b64_tr_b16 a[74:75], v26 offset:256
    ds_read_b64_tr_b16 a[4:5], v25 offset:2048
    ds_read_b64_tr_b16 a[6:7], v25 offset:2304
    ds_read_b64_tr_b16 a[76:77], v26 offset:2048
    ds_read_b64_tr_b16 a[78:79], v26 offset:2304
    s_waitcnt lgkmcnt(0)
    s_add_u32 s21, s28, 2097152
    s_add_u32 m0, s31, 57344
    s_nop 0
    buffer_load_dwordx4 v6, s[12:15], s21 offen lds
    s_add_u32 m0, s31, 58368
    s_add_u32 s21, s21, 131072
    buffer_load_dwordx4 v6, s[12:15], s21 offen lds
    s_add_u32 m0, s31, 59392
    s_add_u32 s21, s21, 131072
    buffer_load_dwordx4 v6, s[12:15], s21 offen lds
    s_add_u32 m0, s31, 60416
    s_add_u32 s21, s21, 131072
    buffer_load_dwordx4 v6, s[12:15], s21 offen lds
    v_add_u32 v25, 73728, v24
    v_xor_b32 v26, 32, v25
    s_waitcnt vmcnt(33)
    ds_read_b64_tr_b16 v[72:73], v25 offset:0
    ds_read_b64_tr_b16 v[74:75], v25 offset:256
    ds_read_b64_tr_b16 v[144:145], v26 offset:0
    ds_read_b64_tr_b16 v[146:147], v26 offset:256
    ds_read_b64_tr_b16 v[76:77], v25 offset:2048
    ds_read_b64_tr_b16 v[78:79], v25 offset:2304
    ds_read_b64_tr_b16 v[148:149], v26 offset:2048
    ds_read_b64_tr_b16 v[150:151], v26 offset:2304
    s_waitcnt lgkmcnt(0)
    s_add_u32 s21, s28, 2097408
    s_add_u32 m0, s31, 73728
    s_nop 0
    buffer_load_dwordx4 v6, s[12:15], s21 offen lds
    s_add_u32 m0, s31, 74752
    s_add_u32 s21, s21, 131072
    buffer_load_dwordx4 v6, s[12:15], s21 offen lds
    s_add_u32 m0, s31, 75776
    s_add_u32 s21, s21, 131072
    buffer_load_dwordx4 v6, s[12:15], s21 offen lds
    s_add_u32 m0, s31, 76800
    s_add_u32 s21, s21, 131072
    buffer_load_dwordx4 v6, s[12:15], s21 offen lds
    v_add_u32 v25, 90112, v24
    v_xor_b32 v26, 32, v25
    s_waitcnt vmcnt(33)
    ds_read_b64_tr_b16 a[8:9], v25 offset:0
    ds_read_b64_tr_b16 a[10:11], v25 offset:256
    ds_read_b64_tr_b16 a[80:81], v26 offset:0
    ds_read_b64_tr_b16 a[82:83], v26 offset:256
    ds_read_b64_tr_b16 a[12:13], v25 offset:2048
    ds_read_b64_tr_b16 a[14:15], v25 offset:2304
    ds_read_b64_tr_b16 a[84:85], v26 offset:2048
    ds_read_b64_tr_b16 a[86:87], v26 offset:2304
    s_waitcnt lgkmcnt(0)
    s_add_u32 s21, s28, 2621440
    s_add_u32 m0, s31, 90112
    s_nop 0
    buffer_load_dwordx4 v6, s[12:15], s21 offen lds
    s_add_u32 m0, s31, 91136
    s_add_u32 s21, s21, 131072
    buffer_load_dwordx4 v6, s[12:15], s21 offen lds
    s_add_u32 m0, s31, 92160
    s_add_u32 s21, s21, 131072
    buffer_load_dwordx4 v6, s[12:15], s21 offen lds
    s_add_u32 m0, s31, 93184
    s_add_u32 s21, s21, 131072
    buffer_load_dwordx4 v6, s[12:15], s21 offen lds
    v_add_u32 v25, 106496, v24
    v_xor_b32 v26, 32, v25
    s_waitcnt vmcnt(33)
    ds_read_b64_tr_b16 v[80:81], v25 offset:0
    ds_read_b64_tr_b16 v[82:83], v25 offset:256
    ds_read_b64_tr_b16 v[152:153], v26 offset:0
    ds_read_b64_tr_b16 v[154:155], v26 offset:256
    ds_read_b64_tr_b16 v[84:85], v25 offset:2048
    ds_read_b64_tr_b16 v[86:87], v25 offset:2304
    ds_read_b64_tr_b16 v[156:157], v26 offset:2048
    ds_read_b64_tr_b16 v[158:159], v26 offset:2304
    s_waitcnt lgkmcnt(0)
    s_add_u32 s21, s28, 2621696
    s_add_u32 m0, s31, 106496
    s_nop 0
    buffer_load_dwordx4 v6, s[12:15], s21 offen lds
    s_add_u32 m0, s31, 107520
    s_add_u32 s21, s21, 131072
    buffer_load_dwordx4 v6, s[12:15], s21 offen lds
    s_add_u32 m0, s31, 108544
    s_add_u32 s21, s21, 131072
    buffer_load_dwordx4 v6, s[12:15], s21 offen lds
    s_add_u32 m0, s31, 109568
    s_add_u32 s21, s21, 131072
    buffer_load_dwordx4 v6, s[12:15], s21 offen lds
    v_add_u32 v25, 122880, v24
    v_xor_b32 v26, 32, v25
    s_waitcnt vmcnt(33)
    ds_read_b64_tr_b16 a[16:17], v25 offset:0
    ds_read_b64_tr_b16 a[18:19], v25 offset:256
    ds_read_b64_tr_b16 a[88:89], v26 offset:0
    ds_read_b64_tr_b16 a[90:91], v26 offset:256
    ds_read_b64_tr_b16 a[20:21], v25 offset:2048
    ds_read_b64_tr_b16 a[22:23], v25 offset:2304
    ds_read_b64_tr_b16 a[92:93], v26 offset:2048
    ds_read_b64_tr_b16 a[94:95], v26 offset:2304
    s_waitcnt lgkmcnt(0)
    s_add_u32 s21, s28, 3145728
    s_add_u32 m0, s31, 122880
    s_nop 0
    buffer_load_dwordx4 v6, s[12:15], s21 offen lds
    s_add_u32 m0, s31, 123904
    s_add_u32 s21, s21, 131072
    buffer_load_dwordx4 v6, s[12:15], s21 offen lds
    s_add_u32 m0, s31, 124928
    s_add_u32 s21, s21, 131072
    buffer_load_dwordx4 v6, s[12:15], s21 offen lds
    s_add_u32 m0, s31, 125952
    s_add_u32 s21, s21, 131072
    buffer_load_dwordx4 v6, s[12:15], s21 offen lds
    v_add_u32 v25, 139264, v24
    v_xor_b32 v26, 32, v25
    s_waitcnt vmcnt(33)
    ds_read_b64_tr_b16 v[88:89], v25 offset:0
    ds_read_b64_tr_b16 v[90:91], v25 offset:256
    ds_read_b64_tr_b16 v[160:161], v26 offset:0
    ds_read_b64_tr_b16 v[162:163], v26 offset:256
    ds_read_b64_tr_b16 v[92:93], v25 offset:2048
    ds_read_b64_tr_b16 v[94:95], v25 offset:2304
    ds_read_b64_tr_b16 v[164:165], v26 offset:2048
    ds_read_b64_tr_b16 v[166:167], v26 offset:2304
    s_waitcnt lgkmcnt(0)
    s_add_u32 s21, s28, 3145984
    s_add_u32 m0, s31, 139264
    s_nop 0
    buffer_load_dwordx4 v6, s[12:15], s21 offen lds
    s_add_u32 m0, s31, 140288
    s_add_u32 s21, s21, 131072
    buffer_load_dwordx4 v6, s[12:15], s21 offen lds
    s_add_u32 m0, s31, 141312
    s_add_u32 s21, s21, 131072
    buffer_load_dwordx4 v6, s[12:15], s21 offen lds
    s_add_u32 m0, s31, 142336
    s_add_u32 s21, s21, 131072
    buffer_load_dwordx4 v6, s[12:15], s21 offen lds
    v_add_u32 v25, 40960, v24
    v_xor_b32 v26, 32, v25
    s_waitcnt vmcnt(24)
    ds_read_b64_tr_b16 a[24:25], v25 offset:0
    ds_read_b64_tr_b16 a[26:27], v25 offset:256
    ds_read_b64_tr_b16 a[96:97], v26 offset:0
    ds_read_b64_tr_b16 a[98:99], v26 offset:256
    ds_read_b64_tr_b16 a[28:29], v25 offset:2048
    ds_read_b64_tr_b16 a[30:31], v25 offset:2304
    ds_read_b64_tr_b16 a[100:101], v26 offset:2048
    ds_read_b64_tr_b16 a[102:103], v26 offset:2304
    s_waitcnt lgkmcnt(0)
    s_add_u32 s21, s28, 3670016
    s_add_u32 m0, s31, 40960
    s_nop 0
    buffer_load_dwordx4 v6, s[12:15], s21 offen lds
    s_add_u32 m0, s31, 41984
    s_add_u32 s21, s21, 131072
    buffer_load_dwordx4 v6, s[12:15], s21 offen lds
    s_add_u32 m0, s31, 43008
    s_add_u32 s21, s21, 131072
    buffer_load_dwordx4 v6, s[12:15], s21 offen lds
    s_add_u32 m0, s31, 44032
    s_add_u32 s21, s21, 131072
    buffer_load_dwordx4 v6, s[12:15], s21 offen lds
    v_add_u32 v25, 57344, v24
    v_xor_b32 v26, 32, v25
    s_waitcnt vmcnt(24)
    ds_read_b64_tr_b16 v[96:97], v25 offset:0
    ds_read_b64_tr_b16 v[98:99], v25 offset:256
    ds_read_b64_tr_b16 v[168:169], v26 offset:0
    ds_read_b64_tr_b16 v[170:171], v26 offset:256
    ds_read_b64_tr_b16 v[100:101], v25 offset:2048
    ds_read_b64_tr_b16 v[102:103], v25 offset:2304
    ds_read_b64_tr_b16 v[172:173], v26 offset:2048
    ds_read_b64_tr_b16 v[174:175], v26 offset:2304
    s_waitcnt lgkmcnt(0)
    s_add_u32 s21, s28, 3670272
    s_add_u32 m0, s31, 57344
    s_nop 0
    buffer_load_dwordx4 v6, s[12:15], s21 offen lds
    s_add_u32 m0, s31, 58368
    s_add_u32 s21, s21, 131072
    buffer_load_dwordx4 v6, s[12:15], s21 offen lds
    s_add_u32 m0, s31, 59392
    s_add_u32 s21, s21, 131072
    buffer_load_dwordx4 v6, s[12:15], s21 offen lds
    s_add_u32 m0, s31, 60416
    s_add_u32 s21, s21, 131072
    buffer_load_dwordx4 v6, s[12:15], s21 offen lds
    v_add_u32 v25, 73728, v24
    v_xor_b32 v26, 32, v25
    s_waitcnt vmcnt(24)
    ds_read_b64_tr_b16 a[32:33], v25 offset:0
    ds_read_b64_tr_b16 a[34:35], v25 offset:256
    ds_read_b64_tr_b16 a[104:105], v26 offset:0
    ds_read_b64_tr_b16 a[106:107], v26 offset:256
    ds_read_b64_tr_b16 a[36:37], v25 offset:2048
    ds_read_b64_tr_b16 a[38:39], v25 offset:2304
    ds_read_b64_tr_b16 a[108:109], v26 offset:2048
    ds_read_b64_tr_b16 a[110:111], v26 offset:2304
    s_waitcnt lgkmcnt(0)
    s_add_u32 s21, s28, 4194304
    s_add_u32 m0, s31, 73728
    s_nop 0
    buffer_load_dwordx4 v6, s[12:15], s21 offen lds
    s_add_u32 m0, s31, 74752
    s_add_u32 s21, s21, 131072
    buffer_load_dwordx4 v6, s[12:15], s21 offen lds
    s_add_u32 m0, s31, 75776
    s_add_u32 s21, s21, 131072
    buffer_load_dwordx4 v6, s[12:15], s21 offen lds
    s_add_u32 m0, s31, 76800
    s_add_u32 s21, s21, 131072
    buffer_load_dwordx4 v6, s[12:15], s21 offen lds
    v_add_u32 v25, 90112, v24
    v_xor_b32 v26, 32, v25
    s_waitcnt vmcnt(24)
    ds_read_b64_tr_b16 v[104:105], v25 offset:0
    ds_read_b64_tr_b16 v[106:107], v25 offset:256
    ds_read_b64_tr_b16 v[176:177], v26 offset:0
    ds_read_b64_tr_b16 v[178:179], v26 offset:256
    ds_read_b64_tr_b16 v[108:109], v25 offset:2048
    ds_read_b64_tr_b16 v[110:111], v25 offset:2304
    ds_read_b64_tr_b16 v[180:181], v26 offset:2048
    ds_read_b64_tr_b16 v[182:183], v26 offset:2304
    s_waitcnt lgkmcnt(0)
    v_mov_b32 v28, s95
    s_cmp_lg_u32 s95, 0
    s_cbranch_scc1 L_ne
    buffer_load_dword v28, off, s[96:99], 0 offset:64 sc1
    s_cmp_ge_u32 s36, 192
    s_cbranch_scc1 L_ne
    s_mul_i32 s37, s36, 24576
    s_mov_b32 s46, 4718592
    s_mov_b32 s47, 0x20000
    v_lshlrev_b32 v29, 7, v0
    v_min_u32 v29, 24448, v29
    s_mov_b64 s[44:45], s[58:59]
    buffer_load_dword v30, v29, s[44:47], s37 offen
    s_mov_b64 s[44:45], s[52:53]
    buffer_load_dword v30, v29, s[44:47], s37 offen
L_ne:
    s_add_u32 s21, s28, 4194560
    s_add_u32 m0, s31, 90112
    s_nop 0
    buffer_load_dwordx4 v6, s[12:15], s21 offen lds
    s_add_u32 m0, s31, 91136
    s_add_u32 s21, s21, 131072
    buffer_load_dwordx4 v6, s[12:15], s21 offen lds
    s_add_u32 m0, s31, 92160
    s_add_u32 s21, s21, 131072
    buffer_load_dwordx4 v6, s[12:15], s21 offen lds
    s_add_u32 m0, s31, 93184
    s_add_u32 s21, s21, 131072
    buffer_load_dwordx4 v6, s[12:15], s21 offen lds
    v_add_u32 v25, 106496, v24
    v_xor_b32 v26, 32, v25
    s_waitcnt vmcnt(24)
    ds_read_b64_tr_b16 a[40:41], v25 offset:0
    ds_read_b64_tr_b16 a[42:43], v25 offset:256
    ds_read_b64_tr_b16 a[112:113], v26 offset:0
    ds_read_b64_tr_b16 a[114:115], v26 offset:256
    ds_read_b64_tr_b16 a[44:45], v25 offset:2048
    ds_read_b64_tr_b16 a[46:47], v25 offset:2304
    ds_read_b64_tr_b16 a[116:117], v26 offset:2048
    ds_read_b64_tr_b16 a[118:119], v26 offset:2304
    s_waitcnt lgkmcnt(0)
    v_add_u32 v25, 122880, v24
    v_xor_b32 v26, 32, v25
    s_waitcnt vmcnt(20)
    ds_read_b64_tr_b16 v[112:113], v25 offset:0
    ds_read_b64_tr_b16 v[114:115], v25 offset:256
    ds_read_b64_tr_b16 v[184:185], v26 offset:0
    ds_read_b64_tr_b16 v[186:187], v26 offset:256
    ds_read_b64_tr_b16 v[116:117], v25 offset:2048
    ds_read_b64_tr_b16 v[118:119], v25 offset:2304
    ds_read_b64_tr_b16 v[188:189], v26 offset:2048
    ds_read_b64_tr_b16 v[190:191], v26 offset:2304
    s_waitcnt lgkmcnt(0)
    v_add_u32 v25, 139264, v24
    v_xor_b32 v26, 32, v25
    s_waitcnt vmcnt(16)
    ds_read_b64_tr_b16 a[48:49], v25 offset:0
    ds_read_b64_tr_b16 a[50:51], v25 offset:256
    ds_read_b64_tr_b16 a[120:121], v26 offset:0
    ds_read_b64_tr_b16 a[122:123], v26 offset:256
    ds_read_b64_tr_b16 a[52:53], v25 offset:2048
    ds_read_b64_tr_b16 a[54:55], v25 offset:2304
    ds_read_b64_tr_b16 a[124:125], v26 offset:2048
    ds_read_b64_tr_b16 a[126:127], v26 offset:2304
    s_waitcnt lgkmcnt(0)
    v_add_u32 v25, 40960, v24
    v_xor_b32 v26, 32, v25
    s_waitcnt vmcnt(12)
    ds_read_b64_tr_b16 v[120:121], v25 offset:0
    ds_read_b64_tr_b16 v[122:123], v25 offset:256
    ds_read_b64_tr_b16 v[192:193], v26 offset:0
    ds_read_b64_tr_b16 v[194:195], v26 offset:256
    ds_read_b64_tr_b16 v[124:125], v25 offset:2048
    ds_read_b64_tr_b16 v[126:127], v25 offset:2304
    ds_read_b64_tr_b16 v[196:197], v26 offset:2048
    ds_read_b64_tr_b16 v[198:199], v26 offset:2304
    s_waitcnt lgkmcnt(0)
    v_add_u32 v25, 57344, v24
    v_xor_b32 v26, 32, v25
    s_waitcnt vmcnt(8)
    ds_read_b64_tr_b16 a[56:57], v25 offset:0
    ds_read_b64_tr_b16 a[58:59], v25 offset:256
    ds_read_b64_tr_b16 a[128:129], v26 offset:0
    ds_read_b64_tr_b16 a[130:131], v26 offset:256
    ds_read_b64_tr_b16 a[60:61], v25 offset:2048
    ds_read_b64_tr_b16 a[62:63], v25 offset:2304
    ds_read_b64_tr_b16 a[132:133], v26 offset:2048
    ds_read_b64_tr_b16 a[134:135], v26 offset:2304
    s_waitcnt lgkmcnt(0)
    v_add_u32 v25, 73728, v24
    v_xor_b32 v26, 32, v25
    s_waitcnt vmcnt(4)
    ds_read_b64_tr_b16 v[128:129], v25 offset:0
    ds_read_b64_tr_b16 v[130:131], v25 offset:256
    ds_read_b64_tr_b16 v[200:201], v26 offset:0
    ds_read_b64_tr_b16 v[202:203], v26 offset:256
    ds_read_b64_tr_b16 v[132:133], v25 offset:2048
    ds_read_b64_tr_b16 v[134:135], v25 offset:2304
    ds_read_b64_tr_b16 v[204:205], v26 offset:2048
    ds_read_b64_tr_b16 v[206:207], v26 offset:2304
    s_waitcnt lgkmcnt(0)
    v_add_u32 v25, 90112, v24
    v_xor_b32 v26, 32, v25
    s_waitcnt vmcnt(0)
    ds_read_b64_tr_b16 a[64:65], v25 offset:0
    ds_read_b64_tr_b16 a[66:67], v25 offset:256
    ds_read_b64_tr_b16 a[136:137], v26 offset:0
    ds_read_b64_tr_b16 a[138:139], v26 offset:256
    ds_read_b64_tr_b16 a[68:69], v25 offset:2048
    ds_read_b64_tr_b16 a[70:71], v25 offset:2304
    ds_read_b64_tr_b16 a[140:141], v26 offset:2048
    ds_read_b64_tr_b16 a[142:143], v26 offset:2304
    s_waitcnt lgkmcnt(0)
    s_lshr_b32 s21, s17, 3
    s_cmp_eq_u32 s21, 3
    s_cselect_b32 s21, 1, s33
    s_cmp_lg_u32 s21, 0
    s_cbranch_scc1 qk_noclr
    v_mov_b32 v8, -1
    v_mov_b32 v9, -1
    v_mov_b32 v10, -1
    v_mov_b32 v11, -1
    v_lshrrev_b32 v25, 6, v0
    v_mul_u32_u24 v25, 11264, v25
    v_add_u32 v25, v25, v7
    s_lshl_b32 s21, s17, 9
    s_add_u32 s21, s21, 90177536
    s_add_u32 s22, s21, 786432
qk_clr:
    buffer_store_dwordx4 v[8:11], v25, s[4:7], s21 offen sc1
    s_add_u32 s21, s21, 49152
    s_cmp_lt_u32 s21, s22
    s_cbranch_scc1 qk_clr
qk_noclr:
    s_cmp_ge_u32 s33, 6
    s_cbranch_scc1 qk_noclr2
    v_mov_b32 v8, -1
    v_mov_b32 v9, -1
    v_mov_b32 v10, -1
    v_mov_b32 v11, -1
    s_cmp_lt_u32 s33, 4
    s_cselect_b32 s21, 60, 54
    s_add_u32 s21, s21, s33
    s_lshl_b32 s23, s17, 12
    s_lshl_b32 s22, s21, 17
    s_add_u32 s22, s22, s23
    s_add_u32 s22, s22, 71303168
    buffer_store_dwordx4 v[8:11], v7, s[4:7], s22 offen sc1
    s_add_u32 s22, s22, 4096
    buffer_store_dwordx4 v[8:11], v7, s[4:7], s22 offen sc1
    s_lshl_b32 s22, s21, 17
    s_add_u32 s22, s22, s23
    s_add_u32 s22, s22, 80740352
    buffer_store_dwordx4 v[8:11], v7, s[4:7], s22 offen sc1
    s_add_u32 s22, s22, 4096
    buffer_store_dwordx4 v[8:11], v7, s[4:7], s22 offen sc1
    s_lshl_b32 s22, s21, 18
    s_add_u32 s22, s22, s23
    s_add_u32 s22, s22, 50331648
    buffer_store_dwordx4 v[8:11], v7, s[4:7], s22 offen sc1
    s_add_u32 s22, s22, 4096
    buffer_store_dwordx4 v[8:11], v7, s[4:7], s22 offen sc1
    s_lshl_b32 s22, s21, 18
    s_add_u32 s22, s22, s23
    s_add_u32 s22, s22, 50462720
    buffer_store_dwordx4 v[8:11], v7, s[4:7], s22 offen sc1
    s_add_u32 s22, s22, 4096
    buffer_store_dwordx4 v[8:11], v7, s[4:7], s22 offen sc1
qk_noclr2:
    v_readfirstlane_b32 s95, v28
    s_nop 4
    s_mov_b32 s88, 4194304
gn7:
    s_cmp_lg_u32 s95, 0
    s_cbranch_scc1 gn7x
    buffer_load_dword v25, off, s[96:99], 0 offset:64 sc1
    s_sub_u32 s88, s88, 1
    s_cbranch_scc1 gn7x
    s_waitcnt vmcnt(0)
    v_readfirstlane_b32 s95, v25
    s_nop 1
    s_branch gn7
gn7x:
    s_barrier
    s_mov_b32 s27, 36864
    s_add_u32 s23, s27, s25
    s_add_u32 m0, s23, 0
    s_nop 0
    buffer_load_dwordx4 v2, s[8:11], s24 offen offset:0 lds
    s_add_u32 m0, s23, 960
    s_nop 0
    buffer_load_dwordx4 v2, s[8:11], s24 offen offset:64 lds
    s_add_u32 m0, s23, 1920
    s_nop 0
    buffer_load_dwordx4 v2, s[8:11], s24 offen offset:128 lds
    s_add_u32 m0, s23, 2880
    s_nop 0
    buffer_load_dwordx4 v2, s[8:11], s24 offen offset:192 lds
    s_add_u32 m0, s23, 3840
    s_nop 0
    buffer_load_dwordx4 v2, s[8:11], s24 offen offset:256 lds
    s_add_u32 m0, s23, 4800
    s_nop 0
    buffer_load_dwordx4 v2, s[8:11], s24 offen offset:320 lds
    s_add_u32 m0, s23, 5760
    s_nop 0
    buffer_load_dwordx4 v2, s[8:11], s24 offen offset:384 lds
    s_add_u32 m0, s23, 6720
    s_nop 0
    buffer_load_dwordx4 v2, s[8:11], s24 offen offset:448 lds
    s_add_u32 m0, s23, 7680
    s_nop 0
    buffer_load_dwordx4 v2, s[8:11], s24 offen offset:512 lds
    s_add_u32 s24, s24, s42
    s_mov_b32 s27, 0
    s_mov_b32 s30, s95
    s_cmp_eq_u32 s18, 0
    s_cselect_b32 s34, 1, 0
    s_mov_b32 s35, 0
    s_mov_b32 s31, 0x80000000
    v_mov_b32 v3, v1
    ds_read_b128 v[32:35], v3 offset:0
    ds_read_b128 v[36:39], v3 offset:18432
    ds_read_b128 v[40:43], v3 offset:1024
    ds_read_b128 v[44:47], v3 offset:19456
    s_cmp_eq_u32 s16, 2
    s_cbranch_scc1 qk_vloop
qk_loop:
    s_add_u32 s22, s27, 73728
    s_sub_u32 s21, s22, 147456
    s_cselect_b32 s22, s22, s21
    s_add_u32 s27, s27, 36864
    s_cmp_eq_u32 s27, 147456
    s_cselect_b32 s27, 0, s27
    s_waitcnt lgkmcnt(2)
    v_cvt_pk_bf16_f32 v8, v208, v209
    v_cvt_pk_bf16_f32 v9, v210, v211
    v_mfma_f32_16x16x32_bf16 v[208:211], v[64:67], v[32:35], 0
    ds_read_b128 v[48:51], v3 offset:2048
    ds_read_b128 v[52:55], v3 offset:20480
    v_cvt_pk_bf16_f32 v10, v212, v213
    v_cvt_pk_bf16_f32 v11, v214, v215
    v_mfma_f32_16x16x32_bf16 v[212:215], v[136:139], v[32:35], 0
    v_cvt_pk_bf16_f32 v12, v216, v217
    v_cvt_pk_bf16_f32 v13, v218, v219
    v_mfma_f32_16x16x32_bf16 v[216:219], v[64:67], v[36:39], 0
    v_cvt_pk_bf16_f32 v14, v220, v221
    v_cvt_pk_bf16_f32 v15, v222, v223
    v_mfma_f32_16x16x32_bf16 v[220:223], v[136:139], v[36:39], 0
    v_cvt_pk_bf16_f32 v16, v224, v225
    v_cvt_pk_bf16_f32 v17, v226, v227
    v_mfma_f32_16x16x32_bf16 v[224:227], a[0:3], v[32:35], 0
    v_cvt_pk_bf16_f32 v18, v228, v229
    v_cvt_pk_bf16_f32 v19, v230, v231
    v_mfma_f32_16x16x32_bf16 v[228:231], a[72:75], v[32:35], 0
    v_cvt_pk_bf16_f32 v20, v232, v233
    v_cvt_pk_bf16_f32 v21, v234, v235
    v_mfma_f32_16x16x32_bf16 v[232:235], a[0:3], v[36:39], 0
    v_cvt_pk_bf16_f32 v22, v236, v237
    v_cvt_pk_bf16_f32 v23, v238, v239
    v_mfma_f32_16x16x32_bf16 v[236:239], a[72:75], v[36:39], 0
    s_waitcnt lgkmcnt(2)
    v_mfma_f32_16x16x32_bf16 v[208:211], v[68:71], v[40:43], v[208:211]
    ds_read_b128 v[32:35], v3 offset:3072
    ds_read_b128 v[36:39], v3 offset:21504
    v_mfma_f32_16x16x32_bf16 v[212:215], v[140:143], v[40:43], v[212:215]
    v_mfma_f32_16x16x32_bf16 v[216:219], v[68:71], v[44:47], v[216:219]
    s_mov_b32 s28, s31
    buffer_store_dwordx4 v[8:11], v7, s[4:7], s28 offen sc1
    v_mfma_f32_16x16x32_bf16 v[220:223], v[140:143], v[44:47], v[220:223]
    v_mfma_f32_16x16x32_bf16 v[224:227], a[4:7], v[40:43], v[224:227]
    v_mfma_f32_16x16x32_bf16 v[228:231], a[76:79], v[40:43], v[228:231]
    v_mfma_f32_16x16x32_bf16 v[232:235], a[4:7], v[44:47], v[232:235]
    v_mfma_f32_16x16x32_bf16 v[236:239], a[76:79], v[44:47], v[236:239]
    s_waitcnt lgkmcnt(2)
    v_mfma_f32_16x16x32_bf16 v[208:211], v[72:75], v[48:51], v[208:211]
    ds_read_b128 v[40:43], v3 offset:4096
    ds_read_b128 v[44:47], v3 offset:22528
    v_mfma_f32_16x16x32_bf16 v[212:215], v[144:147], v[48:51], v[212:215]
    v_mfma_f32_16x16x32_bf16 v[216:219], v[72:75], v[52:55], v[216:219]
    s_add_u32 s28, s28, s40
    buffer_store_dwordx4 v[12:15], v7, s[4:7], s28 offen sc1
    v_mfma_f32_16x16x32_bf16 v[220:223], v[144:147], v[52:55], v[220:223]
    v_mfma_f32_16x16x32_bf16 v[224:227], a[8:11], v[48:51], v[224:227]
    v_mfma_f32_16x16x32_bf16 v[228:231], a[80:83], v[48:51], v[228:231]
    v_mfma_f32_16x16x32_bf16 v[232:235], a[8:11], v[52:55], v[232:235]
    v_mfma_f32_16x16x32_bf16 v[236:239], a[80:83], v[52:55], v[236:239]
    s_waitcnt lgkmcnt(2)
    v_mfma_f32_16x16x32_bf16 v[208:211], v[76:79], v[32:35], v[208:211]
    ds_read_b128 v[48:51], v3 offset:5120
    ds_read_b128 v[52:55], v3 offset:23552
    v_mfma_f32_16x16x32_bf16 v[212:215], v[148:151], v[32:35], v[212:215]
    v_mfma_f32_16x16x32_bf16 v[216:219], v[76:79], v[36:39], v[216:219]
    s_add_u32 s28, s31, s43
    buffer_store_dwordx4 v[16:19], v7, s[4:7], s28 offen sc1
    v_mfma_f32_16x16x32_bf16 v[220:223], v[148:151], v[36:39], v[220:223]
    v_mfma_f32_16x16x32_bf16 v[224:227], a[12:15], v[32:35], v[224:227]
    v_mfma_f32_16x16x32_bf16 v[228:231], a[84:87], v[32:35], v[228:231]
    v_mfma_f32_16x16x32_bf16 v[232:235], a[12:15], v[36:39], v[232:235]
    v_mfma_f32_16x16x32_bf16 v[236:239], a[84:87], v[36:39], v[236:239]
    s_waitcnt lgkmcnt(2)
    v_mfma_f32_16x16x32_bf16 v[208:211], v[80:83], v[40:43], v[208:211]
    ds_read_b128 v[32:35], v3 offset:6144
    ds_read_b128 v[36:39], v3 offset:24576
    v_mfma_f32_16x16x32_bf16 v[212:215], v[152:155], v[40:43], v[212:215]
    v_mfma_f32_16x16x32_bf16 v[216:219], v[80:83], v[44:47], v[216:219]
    s_add_u32 s28, s28, s40
    buffer_store_dwordx4 v[20:23], v7, s[4:7], s28 offen sc1
    v_mfma_f32_16x16x32_bf16 v[220:223], v[152:155], v[44:47], v[220:223]
    v_mfma_f32_16x16x32_bf16 v[224:227], a[16:19], v[40:43], v[224:227]
    v_mfma_f32_16x16x32_bf16 v[228:231], a[88:91], v[40:43], v[228:231]
    v_mfma_f32_16x16x32_bf16 v[232:235], a[16:19], v[44:47], v[232:235]
    v_mfma_f32_16x16x32_bf16 v[236:239], a[88:91], v[44:47], v[236:239]
    s_waitcnt lgkmcnt(2)
    v_mfma_f32_16x16x32_bf16 v[208:211], v[84:87], v[48:51], v[208:211]
    ds_read_b128 v[40:43], v3 offset:7168
    ds_read_b128 v[44:47], v3 offset:25600
    v_mfma_f32_16x16x32_bf16 v[212:215], v[156:159], v[48:51], v[212:215]
    v_mfma_f32_16x16x32_bf16 v[216:219], v[84:87], v[52:55], v[216:219]
    s_add_u32 s23, s22, s25
    s_add_u32 m0, s23, 0
    s_nop 0
    buffer_load_dwordx4 v2, s[8:11], s24 offen offset:0 lds
    v_mfma_f32_16x16x32_bf16 v[220:223], v[156:159], v[52:55], v[220:223]
    v_mfma_f32_16x16x32_bf16 v[224:227], a[20:23], v[48:51], v[224:227]
    v_mfma_f32_16x16x32_bf16 v[228:231], a[92:95], v[48:51], v[228:231]
    v_mfma_f32_16x16x32_bf16 v[232:235], a[20:23], v[52:55], v[232:235]
    v_mfma_f32_16x16x32_bf16 v[236:239], a[92:95], v[52:55], v[236:239]
    s_waitcnt lgkmcnt(2)
    v_mfma_f32_16x16x32_bf16 v[208:211], v[88:91], v[32:35], v[208:211]
    ds_read_b128 v[48:51], v3 offset:8192
    ds_read_b128 v[52:55], v3 offset:26624
    v_mfma_f32_16x16x32_bf16 v[212:215], v[160:163], v[32:35], v[212:215]
    v_mfma_f32_16x16x32_bf16 v[216:219], v[88:91], v[36:39], v[216:219]
    s_add_u32 m0, s23, 960
    s_nop 0
    buffer_load_dwordx4 v2, s[8:11], s24 offen offset:64 lds
    v_mfma_f32_16x16x32_bf16 v[220:223], v[160:163], v[36:39], v[220:223]
    v_mfma_f32_16x16x32_bf16 v[224:227], a[24:27], v[32:35], v[224:227]
    v_mfma_f32_16x16x32_bf16 v[228:231], a[96:99], v[32:35], v[228:231]
    v_mfma_f32_16x16x32_bf16 v[232:235], a[24:27], v[36:39], v[232:235]
    v_mfma_f32_16x16x32_bf16 v[236:239], a[96:99], v[36:39], v[236:239]
    s_waitcnt lgkmcnt(2)
    v_mfma_f32_16x16x32_bf16 v[208:211], v[92:95], v[40:43], v[208:211]
    ds_read_b128 v[32:35], v3 offset:9216
    ds_read_b128 v[36:39], v3 offset:27648
    v_mfma_f32_16x16x32_bf16 v[212:215], v[164:167], v[40:43], v[212:215]
    v_mfma_f32_16x16x32_bf16 v[216:219], v[92:95], v[44:47], v[216:219]
    s_add_u32 m0, s23, 1920
    s_nop 0
    buffer_load_dwordx4 v2, s[8:11], s24 offen offset:128 lds
    v_mfma_f32_16x16x32_bf16 v[220:223], v[164:167], v[44:47], v[220:223]
    v_mfma_f32_16x16x32_bf16 v[224:227], a[28:31], v[40:43], v[224:227]
    v_mfma_f32_16x16x32_bf16 v[228:231], a[100:103], v[40:43], v[228:231]
    v_mfma_f32_16x16x32_bf16 v[232:235], a[28:31], v[44:47], v[232:235]
    v_mfma_f32_16x16x32_bf16 v[236:239], a[100:103], v[44:47], v[236:239]
    s_waitcnt lgkmcnt(2)
    v_mfma_f32_16x16x32_bf16 v[208:211], v[96:99], v[48:51], v[208:211]
    ds_read_b128 v[40:43], v3 offset:10240
    ds_read_b128 v[44:47], v3 offset:28672
    v_mfma_f32_16x16x32_bf16 v[212:215], v[168:171], v[48:51], v[212:215]
    v_mfma_f32_16x16x32_bf16 v[216:219], v[96:99], v[52:55], v[216:219]
    s_add_u32 m0, s23, 2880
    s_nop 0
    buffer_load_dwordx4 v2, s[8:11], s24 offen offset:192 lds
    v_mfma_f32_16x16x32_bf16 v[220:223], v[168:171], v[52:55], v[220:223]
    v_mfma_f32_16x16x32_bf16 v[224:227], a[32:35], v[48:51], v[224:227]
    v_mfma_f32_16x16x32_bf16 v[228:231], a[104:107], v[48:51], v[228:231]
    v_mfma_f32_16x16x32_bf16 v[232:235], a[32:35], v[52:55], v[232:235]
    v_mfma_f32_16x16x32_bf16 v[236:239], a[104:107], v[52:55], v[236:239]
    s_waitcnt lgkmcnt(2)
    v_mfma_f32_16x16x32_bf16 v[208:211], v[100:103], v[32:35], v[208:211]
    ds_read_b128 v[48:51], v3 offset:11264
    ds_read_b128 v[52:55], v3 offset:29696
    v_mfma_f32_16x16x32_bf16 v[212:215], v[172:175], v[32:35], v[212:215]
    v_mfma_f32_16x16x32_bf16 v[216:219], v[100:103], v[36:39], v[216:219]
    s_add_u32 m0, s23, 3840
    s_nop 0
    buffer_load_dwordx4 v2, s[8:11], s24 offen offset:256 lds
    v_mfma_f32_16x16x32_bf16 v[220:223], v[172:175], v[36:39], v[220:223]
    v_mfma_f32_16x16x32_bf16 v[224:227], a[36:39], v[32:35], v[224:227]
    v_mfma_f32_16x16x32_bf16 v[228:231], a[108:111], v[32:35], v[228:231]
    v_mfma_f32_16x16x32_bf16 v[232:235], a[36:39], v[36:39], v[232:235]
    v_mfma_f32_16x16x32_bf16 v[236:239], a[108:111], v[36:39], v[236:239]
    s_waitcnt lgkmcnt(2)
    v_mfma_f32_16x16x32_bf16 v[208:211], v[104:107], v[40:43], v[208:211]
    ds_read_b128 v[32:35], v3 offset:12288
    ds_read_b128 v[36:39], v3 offset:30720
    v_mfma_f32_16x16x32_bf16 v[212:215], v[176:179], v[40:43], v[212:215]
    v_mfma_f32_16x16x32_bf16 v[216:219], v[104:107], v[44:47], v[216:219]
    s_add_u32 m0, s23, 4800
    s_nop 0
    buffer_load_dwordx4 v2, s[8:11], s24 offen offset:320 lds
    v_mfma_f32_16x16x32_bf16 v[220:223], v[176:179], v[44:47], v[220:223]
    v_mfma_f32_16x16x32_bf16 v[224:227], a[40:43], v[40:43], v[224:227]
    v_mfma_f32_16x16x32_bf16 v[228:231], a[112:115], v[40:43], v[228:231]
    v_mfma_f32_16x16x32_bf16 v[232:235], a[40:43], v[44:47], v[232:235]
    v_mfma_f32_16x16x32_bf16 v[236:239], a[112:115], v[44:47], v[236:239]
    s_waitcnt lgkmcnt(2)
    v_mfma_f32_16x16x32_bf16 v[208:211], v[108:111], v[48:51], v[208:211]
    ds_read_b128 v[40:43], v3 offset:13312
    ds_read_b128 v[44:47], v3 offset:31744
    v_mfma_f32_16x16x32_bf16 v[212:215], v[180:183], v[48:51], v[212:215]
    v_mfma_f32_16x16x32_bf16 v[216:219], v[108:111], v[52:55], v[216:219]
    s_add_u32 m0, s23, 5760
    s_nop 0
    buffer_load_dwordx4 v2, s[8:11], s24 offen offset:384 lds
    v_mfma_f32_16x16x32_bf16 v[220:223], v[180:183], v[52:55], v[220:223]
    v_mfma_f32_16x16x32_bf16 v[224:227], a[44:47], v[48:51], v[224:227]
    v_mfma_f32_16x16x32_bf16 v[228:231], a[116:119], v[48:51], v[228:231]
    v_mfma_f32_16x16x32_bf16 v[232:235], a[44:47], v[52:55], v[232:235]
    v_mfma_f32_16x16x32_bf16 v[236:239], a[116:119], v[52:55], v[236:239]
    s_waitcnt lgkmcnt(2)
    v_mfma_f32_16x16x32_bf16 v[208:211], v[112:115], v[32:35], v[208:211]
    ds_read_b128 v[48:51], v3 offset:14336
    ds_read_b128 v[52:55], v3 offset:32768
    v_mfma_f32_16x16x32_bf16 v[212:215], v[184:187], v[32:35], v[212:215]
    v_mfma_f32_16x16x32_bf16 v[216:219], v[112:115], v[36:39], v[216:219]
    s_add_u32 m0, s23, 6720
    s_nop 0
    buffer_load_dwordx4 v2, s[8:11], s24 offen offset:448 lds
    v_mfma_f32_16x16x32_bf16 v[220:223], v[184:187], v[36:39], v[220:223]
    v_mfma_f32_16x16x32_bf16 v[224:227], a[48:51], v[32:35], v[224:227]
    v_mfma_f32_16x16x32_bf16 v[228:231], a[120:123], v[32:35], v[228:231]
    v_mfma_f32_16x16x32_bf16 v[232:235], a[48:51], v[36:39], v[232:235]
    v_mfma_f32_16x16x32_bf16 v[236:239], a[120:123], v[36:39], v[236:239]
    s_waitcnt lgkmcnt(2)
    v_mfma_f32_16x16x32_bf16 v[208:211], v[116:119], v[40:43], v[208:211]
    ds_read_b128 v[32:35], v3 offset:15360
    ds_read_b128 v[36:39], v3 offset:33792
    v_mfma_f32_16x16x32_bf16 v[212:215], v[188:191], v[40:43], v[212:215]
    v_mfma_f32_16x16x32_bf16 v[216:219], v[116:119], v[44:47], v[216:219]
    s_add_u32 m0, s23, 7680
    s_nop 0
    buffer_load_dwordx4 v2, s[8:11], s24 offen offset:512 lds
    s_add_u32 s24, s24, s42
    v_mfma_f32_16x16x32_bf16 v[220:223], v[188:191], v[44:47], v[220:223]
    v_mfma_f32_16x16x32_bf16 v[224:227], a[52:55], v[40:43], v[224:227]
    v_mfma_f32_16x16x32_bf16 v[228:231], a[124:127], v[40:43], v[228:231]
    v_mfma_f32_16x16x32_bf16 v[232:235], a[52:55], v[44:47], v[232:235]
    v_mfma_f32_16x16x32_bf16 v[236:239], a[124:127], v[44:47], v[236:239]
    s_waitcnt lgkmcnt(2)
    v_mfma_f32_16x16x32_bf16 v[208:211], v[120:123], v[48:51], v[208:211]
    ds_read_b128 v[40:43], v3 offset:16384
    ds_read_b128 v[44:47], v3 offset:34816
    v_mfma_f32_16x16x32_bf16 v[212:215], v[192:195], v[48:51], v[212:215]
    v_mfma_f32_16x16x32_bf16 v[216:219], v[120:123], v[52:55], v[216:219]
    v_add_u32 v24, s27, v1
    v_mfma_f32_16x16x32_bf16 v[220:223], v[192:195], v[52:55], v[220:223]
    v_mfma_f32_16x16x32_bf16 v[224:227], a[56:59], v[48:51], v[224:227]
    v_mfma_f32_16x16x32_bf16 v[228:231], a[128:131], v[48:51], v[228:231]
    v_mfma_f32_16x16x32_bf16 v[232:235], a[56:59], v[52:55], v[232:235]
    v_mfma_f32_16x16x32_bf16 v[236:239], a[128:131], v[52:55], v[236:239]
    s_waitcnt lgkmcnt(2)
    v_mfma_f32_16x16x32_bf16 v[208:211], v[124:127], v[32:35], v[208:211]
    ds_read_b128 v[48:51], v3 offset:17408
    ds_read_b128 v[52:55], v3 offset:35840
    v_mfma_f32_16x16x32_bf16 v[212:215], v[196:199], v[32:35], v[212:215]
    v_mfma_f32_16x16x32_bf16 v[216:219], v[124:127], v[36:39], v[216:219]
    v_mfma_f32_16x16x32_bf16 v[220:223], v[196:199], v[36:39], v[220:223]
    v_mfma_f32_16x16x32_bf16 v[224:227], a[60:63], v[32:35], v[224:227]
    v_mfma_f32_16x16x32_bf16 v[228:231], a[132:135], v[32:35], v[228:231]
    s_waitcnt vmcnt(9)
    s_barrier
    v_mfma_f32_16x16x32_bf16 v[232:235], a[60:63], v[36:39], v[232:235]
    v_mfma_f32_16x16x32_bf16 v[236:239], a[132:135], v[36:39], v[236:239]
    s_waitcnt lgkmcnt(2)
    v_mfma_f32_16x16x32_bf16 v[208:211], v[128:131], v[40:43], v[208:211]
    ds_read_b128 v[32:35], v24 offset:0
    ds_read_b128 v[36:39], v24 offset:18432
    v_mfma_f32_16x16x32_bf16 v[212:215], v[200:203], v[40:43], v[212:215]
    v_mfma_f32_16x16x32_bf16 v[216:219], v[128:131], v[44:47], v[216:219]
    v_mov_b32 v4, s30
    s_mov_b64 exec, s[34:35]
    buffer_store_dword v4, off, s[4:7], s29 sc1
    s_mov_b64 exec, -1
    v_mfma_f32_16x16x32_bf16 v[220:223], v[200:203], v[44:47], v[220:223]
    v_mfma_f32_16x16x32_bf16 v[224:227], a[64:67], v[40:43], v[224:227]
    v_mfma_f32_16x16x32_bf16 v[228:231], a[136:139], v[40:43], v[228:231]
    v_mfma_f32_16x16x32_bf16 v[232:235], a[64:67], v[44:47], v[232:235]
    v_mfma_f32_16x16x32_bf16 v[236:239], a[136:139], v[44:47], v[236:239]
    s_waitcnt lgkmcnt(2)
    v_mfma_f32_16x16x32_bf16 v[208:211], v[132:135], v[48:51], v[208:211]
    ds_read_b128 v[40:43], v24 offset:1024
    ds_read_b128 v[44:47], v24 offset:19456
    v_mfma_f32_16x16x32_bf16 v[212:215], v[204:207], v[48:51], v[212:215]
    v_mfma_f32_16x16x32_bf16 v[216:219], v[132:135], v[52:55], v[216:219]
    v_mfma_f32_16x16x32_bf16 v[220:223], v[204:207], v[52:55], v[220:223]
    v_mfma_f32_16x16x32_bf16 v[224:227], a[68:71], v[48:51], v[224:227]
    v_mfma_f32_16x16x32_bf16 v[228:231], a[140:143], v[48:51], v[228:231]
    v_mfma_f32_16x16x32_bf16 v[232:235], a[68:71], v[52:55], v[232:235]
    v_mfma_f32_16x16x32_bf16 v[236:239], a[140:143], v[52:55], v[236:239]
    v_mov_b32 v3, v24
    s_mov_b32 s31, s26
    s_add_u32 s26, s26, s41
    s_add_u32 s30, s30, 1
    s_add_u32 s19, s19, s20
    s_cmp_lt_u32 s19, 64
    s_cbranch_scc1 qk_loop
    v_cvt_pk_bf16_f32 v8, v208, v209
    v_cvt_pk_bf16_f32 v9, v210, v211
    v_cvt_pk_bf16_f32 v10, v212, v213
    v_cvt_pk_bf16_f32 v11, v214, v215
    v_cvt_pk_bf16_f32 v12, v216, v217
    v_cvt_pk_bf16_f32 v13, v218, v219
    v_cvt_pk_bf16_f32 v14, v220, v221
    v_cvt_pk_bf16_f32 v15, v222, v223
    v_cvt_pk_bf16_f32 v16, v224, v225
    v_cvt_pk_bf16_f32 v17, v226, v227
    v_cvt_pk_bf16_f32 v18, v228, v229
    v_cvt_pk_bf16_f32 v19, v230, v231
    v_cvt_pk_bf16_f32 v20, v232, v233
    v_cvt_pk_bf16_f32 v21, v234, v235
    v_cvt_pk_bf16_f32 v22, v236, v237
    v_cvt_pk_bf16_f32 v23, v238, v239
    s_branch qk_done
    s_nop 0
qk_vloop:
    s_add_u32 s22, s27, 73728
    s_sub_u32 s21, s22, 147456
    s_cselect_b32 s22, s22, s21
    s_add_u32 s27, s27, 36864
    s_cmp_eq_u32 s27, 147456
    s_cselect_b32 s27, 0, s27
    s_waitcnt lgkmcnt(2)
    v_cvt_pk_bf16_f32 v8, v208, v209
    v_cvt_pk_bf16_f32 v9, v210, v211
    v_mfma_f32_16x16x32_bf16 v[208:211], v[32:35], v[64:67], 0
    ds_read_b128 v[48:51], v3 offset:2048
    ds_read_b128 v[52:55], v3 offset:20480
    v_cvt_pk_bf16_f32 v12, v212, v213
    v_cvt_pk_bf16_f32 v13, v214, v215
    v_mfma_f32_16x16x32_bf16 v[212:215], v[32:35], v[136:139], 0
    v_cvt_pk_bf16_f32 v10, v216, v217
    v_cvt_pk_bf16_f32 v11, v218, v219
    v_mfma_f32_16x16x32_bf16 v[216:219], v[36:39], v[64:67], 0
    v_cvt_pk_bf16_f32 v14, v220, v221
    v_cvt_pk_bf16_f32 v15, v222, v223
    v_mfma_f32_16x16x32_bf16 v[220:223], v[36:39], v[136:139], 0
    v_cvt_pk_bf16_f32 v16, v224, v225
    v_cvt_pk_bf16_f32 v17, v226, v227
    v_mfma_f32_16x16x32_bf16 v[224:227], v[32:35], a[0:3], 0
    v_cvt_pk_bf16_f32 v20, v228, v229
    v_cvt_pk_bf16_f32 v21, v230, v231
    v_mfma_f32_16x16x32_bf16 v[228:231], v[32:35], a[72:75], 0
    v_cvt_pk_bf16_f32 v18, v232, v233
    v_cvt_pk_bf16_f32 v19, v234, v235
    v_mfma_f32_16x16x32_bf16 v[232:235], v[36:39], a[0:3], 0
    v_cvt_pk_bf16_f32 v22, v236, v237
    v_cvt_pk_bf16_f32 v23, v238, v239
    v_mfma_f32_16x16x32_bf16 v[236:239], v[36:39], a[72:75], 0
    s_waitcnt lgkmcnt(2)
    v_mfma_f32_16x16x32_bf16 v[208:211], v[40:43], v[68:71], v[208:211]
    ds_read_b128 v[32:35], v3 offset:3072
    ds_read_b128 v[36:39], v3 offset:21504
    v_mfma_f32_16x16x32_bf16 v[212:215], v[40:43], v[140:143], v[212:215]
    v_mfma_f32_16x16x32_bf16 v[216:219], v[44:47], v[68:71], v[216:219]
    s_mov_b32 s28, s31
    buffer_store_dwordx4 v[8:11], v7, s[4:7], s28 offen sc1
    v_mfma_f32_16x16x32_bf16 v[220:223], v[44:47], v[140:143], v[220:223]
    v_mfma_f32_16x16x32_bf16 v[224:227], v[40:43], a[4:7], v[224:227]
    v_mfma_f32_16x16x32_bf16 v[228:231], v[40:43], a[76:79], v[228:231]
    v_mfma_f32_16x16x32_bf16 v[232:235], v[44:47], a[4:7], v[232:235]
    v_mfma_f32_16x16x32_bf16 v[236:239], v[44:47], a[76:79], v[236:239]
    s_waitcnt lgkmcnt(2)
    v_mfma_f32_16x16x32_bf16 v[208:211], v[48:51], v[72:75], v[208:211]
    ds_read_b128 v[40:43], v3 offset:4096
    ds_read_b128 v[44:47], v3 offset:22528
    v_mfma_f32_16x16x32_bf16 v[212:215], v[48:51], v[144:147], v[212:215]
    v_mfma_f32_16x16x32_bf16 v[216:219], v[52:55], v[72:75], v[216:219]
    s_add_u32 s28, s28, s40
    buffer_store_dwordx4 v[12:15], v7, s[4:7], s28 offen sc1
    v_mfma_f32_16x16x32_bf16 v[220:223], v[52:55], v[144:147], v[220:223]
    v_mfma_f32_16x16x32_bf16 v[224:227], v[48:51], a[8:11], v[224:227]
    v_mfma_f32_16x16x32_bf16 v[228:231], v[48:51], a[80:83], v[228:231]
    v_mfma_f32_16x16x32_bf16 v[232:235], v[52:55], a[8:11], v[232:235]
    v_mfma_f32_16x16x32_bf16 v[236:239], v[52:55], a[80:83], v[236:239]
    s_waitcnt lgkmcnt(2)
    v_mfma_f32_16x16x32_bf16 v[208:211], v[32:35], v[76:79], v[208:211]
    ds_read_b128 v[48:51], v3 offset:5120
    ds_read_b128 v[52:55], v3 offset:23552
    v_mfma_f32_16x16x32_bf16 v[212:215], v[32:35], v[148:151], v[212:215]
    v_mfma_f32_16x16x32_bf16 v[216:219], v[36:39], v[76:79], v[216:219]
    s_add_u32 s28, s31, s43
    buffer_store_dwordx4 v[16:19], v7, s[4:7], s28 offen sc1
    v_mfma_f32_16x16x32_bf16 v[220:223], v[36:39], v[148:151], v[220:223]
    v_mfma_f32_16x16x32_bf16 v[224:227], v[32:35], a[12:15], v[224:227]
    v_mfma_f32_16x16x32_bf16 v[228:231], v[32:35], a[84:87], v[228:231]
    v_mfma_f32_16x16x32_bf16 v[232:235], v[36:39], a[12:15], v[232:235]
    v_mfma_f32_16x16x32_bf16 v[236:239], v[36:39], a[84:87], v[236:239]
    s_waitcnt lgkmcnt(2)
    v_mfma_f32_16x16x32_bf16 v[208:211], v[40:43], v[80:83], v[208:211]
    ds_read_b128 v[32:35], v3 offset:6144
    ds_read_b128 v[36:39], v3 offset:24576
    v_mfma_f32_16x16x32_bf16 v[212:215], v[40:43], v[152:155], v[212:215]
    v_mfma_f32_16x16x32_bf16 v[216:219], v[44:47], v[80:83], v[216:219]
    s_add_u32 s28, s28, s40
    buffer_store_dwordx4 v[20:23], v7, s[4:7], s28 offen sc1
    v_mfma_f32_16x16x32_bf16 v[220:223], v[44:47], v[152:155], v[220:223]
    v_mfma_f32_16x16x32_bf16 v[224:227], v[40:43], a[16:19], v[224:227]
    v_mfma_f32_16x16x32_bf16 v[228:231], v[40:43], a[88:91], v[228:231]
    v_mfma_f32_16x16x32_bf16 v[232:235], v[44:47], a[16:19], v[232:235]
    v_mfma_f32_16x16x32_bf16 v[236:239], v[44:47], a[88:91], v[236:239]
    s_waitcnt lgkmcnt(2)
    v_mfma_f32_16x16x32_bf16 v[208:211], v[48:51], v[84:87], v[208:211]
    ds_read_b128 v[40:43], v3 offset:7168
    ds_read_b128 v[44:47], v3 offset:25600
    v_mfma_f32_16x16x32_bf16 v[212:215], v[48:51], v[156:159], v[212:215]
    v_mfma_f32_16x16x32_bf16 v[216:219], v[52:55], v[84:87], v[216:219]
    s_add_u32 s23, s22, s25
    s_add_u32 m0, s23, 0
    s_nop 0
    buffer_load_dwordx4 v2, s[8:11], s24 offen offset:0 lds
    v_mfma_f32_16x16x32_bf16 v[220:223], v[52:55], v[156:159], v[220:223]
    v_mfma_f32_16x16x32_bf16 v[224:227], v[48:51], a[20:23], v[224:227]
    v_mfma_f32_16x16x32_bf16 v[228:231], v[48:51], a[92:95], v[228:231]
    v_mfma_f32_16x16x32_bf16 v[232:235], v[52:55], a[20:23], v[232:235]
    v_mfma_f32_16x16x32_bf16 v[236:239], v[52:55], a[92:95], v[236:239]
    s_waitcnt lgkmcnt(2)
    v_mfma_f32_16x16x32_bf16 v[208:211], v[32:35], v[88:91], v[208:211]
    ds_read_b128 v[48:51], v3 offset:8192
    ds_read_b128 v[52:55], v3 offset:26624
    v_mfma_f32_16x16x32_bf16 v[212:215], v[32:35], v[160:163], v[212:215]
    v_mfma_f32_16x16x32_bf16 v[216:219], v[36:39], v[88:91], v[216:219]
    s_add_u32 m0, s23, 960
    s_nop 0
    buffer_load_dwordx4 v2, s[8:11], s24 offen offset:64 lds
    v_mfma_f32_16x16x32_bf16 v[220:223], v[36:39], v[160:163], v[220:223]
    v_mfma_f32_16x16x32_bf16 v[224:227], v[32:35], a[24:27], v[224:227]
    v_mfma_f32_16x16x32_bf16 v[228:231], v[32:35], a[96:99], v[228:231]
    v_mfma_f32_16x16x32_bf16 v[232:235], v[36:39], a[24:27], v[232:235]
    v_mfma_f32_16x16x32_bf16 v[236:239], v[36:39], a[96:99], v[236:239]
    s_waitcnt lgkmcnt(2)
    v_mfma_f32_16x16x32_bf16 v[208:211], v[40:43], v[92:95], v[208:211]
    ds_read_b128 v[32:35], v3 offset:9216
    ds_read_b128 v[36:39], v3 offset:27648
    v_mfma_f32_16x16x32_bf16 v[212:215], v[40:43], v[164:167], v[212:215]
    v_mfma_f32_16x16x32_bf16 v[216:219], v[44:47], v[92:95], v[216:219]
    s_add_u32 m0, s23, 1920
    s_nop 0
    buffer_load_dwordx4 v2, s[8:11], s24 offen offset:128 lds
    v_mfma_f32_16x16x32_bf16 v[220:223], v[44:47], v[164:167], v[220:223]
    v_mfma_f32_16x16x32_bf16 v[224:227], v[40:43], a[28:31], v[224:227]
    v_mfma_f32_16x16x32_bf16 v[228:231], v[40:43], a[100:103], v[228:231]
    v_mfma_f32_16x16x32_bf16 v[232:235], v[44:47], a[28:31], v[232:235]
    v_mfma_f32_16x16x32_bf16 v[236:239], v[44:47], a[100:103], v[236:239]
    s_waitcnt lgkmcnt(2)
    v_mfma_f32_16x16x32_bf16 v[208:211], v[48:51], v[96:99], v[208:211]
    ds_read_b128 v[40:43], v3 offset:10240
    ds_read_b128 v[44:47], v3 offset:28672
    v_mfma_f32_16x16x32_bf16 v[212:215], v[48:51], v[168:171], v[212:215]
    v_mfma_f32_16x16x32_bf16 v[216:219], v[52:55], v[96:99], v[216:219]
    s_add_u32 m0, s23, 2880
    s_nop 0
    buffer_load_dwordx4 v2, s[8:11], s24 offen offset:192 lds
    v_mfma_f32_16x16x32_bf16 v[220:223], v[52:55], v[168:171], v[220:223]
    v_mfma_f32_16x16x32_bf16 v[224:227], v[48:51], a[32:35], v[224:227]
    v_mfma_f32_16x16x32_bf16 v[228:231], v[48:51], a[104:107], v[228:231]
    v_mfma_f32_16x16x32_bf16 v[232:235], v[52:55], a[32:35], v[232:235]
    v_mfma_f32_16x16x32_bf16 v[236:239], v[52:55], a[104:107], v[236:239]
    s_waitcnt lgkmcnt(2)
    v_mfma_f32_16x16x32_bf16 v[208:211], v[32:35], v[100:103], v[208:211]
    ds_read_b128 v[48:51], v3 offset:11264
    ds_read_b128 v[52:55], v3 offset:29696
    v_mfma_f32_16x16x32_bf16 v[212:215], v[32:35], v[172:175], v[212:215]
    v_mfma_f32_16x16x32_bf16 v[216:219], v[36:39], v[100:103], v[216:219]
    s_add_u32 m0, s23, 3840
    s_nop 0
    buffer_load_dwordx4 v2, s[8:11], s24 offen offset:256 lds
    v_mfma_f32_16x16x32_bf16 v[220:223], v[36:39], v[172:175], v[220:223]
    v_mfma_f32_16x16x32_bf16 v[224:227], v[32:35], a[36:39], v[224:227]
    v_mfma_f32_16x16x32_bf16 v[228:231], v[32:35], a[108:111], v[228:231]
    v_mfma_f32_16x16x32_bf16 v[232:235], v[36:39], a[36:39], v[232:235]
    v_mfma_f32_16x16x32_bf16 v[236:239], v[36:39], a[108:111], v[236:239]
    s_waitcnt lgkmcnt(2)
    v_mfma_f32_16x16x32_bf16 v[208:211], v[40:43], v[104:107], v[208:211]
    ds_read_b128 v[32:35], v3 offset:12288
    ds_read_b128 v[36:39], v3 offset:30720
    v_mfma_f32_16x16x32_bf16 v[212:215], v[40:43], v[176:179], v[212:215]
    v_mfma_f32_16x16x32_bf16 v[216:219], v[44:47], v[104:107], v[216:219]
    s_add_u32 m0, s23, 4800
    s_nop 0
    buffer_load_dwordx4 v2, s[8:11], s24 offen offset:320 lds
    v_mfma_f32_16x16x32_bf16 v[220:223], v[44:47], v[176:179], v[220:223]
    v_mfma_f32_16x16x32_bf16 v[224:227], v[40:43], a[40:43], v[224:227]
    v_mfma_f32_16x16x32_bf16 v[228:231], v[40:43], a[112:115], v[228:231]
    v_mfma_f32_16x16x32_bf16 v[232:235], v[44:47], a[40:43], v[232:235]
    v_mfma_f32_16x16x32_bf16 v[236:239], v[44:47], a[112:115], v[236:239]
    s_waitcnt lgkmcnt(2)
    v_mfma_f32_16x16x32_bf16 v[208:211], v[48:51], v[108:111], v[208:211]
    ds_read_b128 v[40:43], v3 offset:13312
    ds_read_b128 v[44:47], v3 offset:31744
    v_mfma_f32_16x16x32_bf16 v[212:215], v[48:51], v[180:183], v[212:215]
    v_mfma_f32_16x16x32_bf16 v[216:219], v[52:55], v[108:111], v[216:219]
    s_add_u32 m0, s23, 5760
    s_nop 0
    buffer_load_dwordx4 v2, s[8:11], s24 offen offset:384 lds
    v_mfma_f32_16x16x32_bf16 v[220:223], v[52:55], v[180:183], v[220:223]
    v_mfma_f32_16x16x32_bf16 v[224:227], v[48:51], a[44:47], v[224:227]
    v_mfma_f32_16x16x32_bf16 v[228:231], v[48:51], a[116:119], v[228:231]
    v_mfma_f32_16x16x32_bf16 v[232:235], v[52:55], a[44:47], v[232:235]
    v_mfma_f32_16x16x32_bf16 v[236:239], v[52:55], a[116:119], v[236:239]
    s_waitcnt lgkmcnt(2)
    v_mfma_f32_16x16x32_bf16 v[208:211], v[32:35], v[112:115], v[208:211]
    ds_read_b128 v[48:51], v3 offset:14336
    ds_read_b128 v[52:55], v3 offset:32768
    v_mfma_f32_16x16x32_bf16 v[212:215], v[32:35], v[184:187], v[212:215]
    v_mfma_f32_16x16x32_bf16 v[216:219], v[36:39], v[112:115], v[216:219]
    s_add_u32 m0, s23, 6720
    s_nop 0
    buffer_load_dwordx4 v2, s[8:11], s24 offen offset:448 lds
    v_mfma_f32_16x16x32_bf16 v[220:223], v[36:39], v[184:187], v[220:223]
    v_mfma_f32_16x16x32_bf16 v[224:227], v[32:35], a[48:51], v[224:227]
    v_mfma_f32_16x16x32_bf16 v[228:231], v[32:35], a[120:123], v[228:231]
    v_mfma_f32_16x16x32_bf16 v[232:235], v[36:39], a[48:51], v[232:235]
    v_mfma_f32_16x16x32_bf16 v[236:239], v[36:39], a[120:123], v[236:239]
    s_waitcnt lgkmcnt(2)
    v_mfma_f32_16x16x32_bf16 v[208:211], v[40:43], v[116:119], v[208:211]
    ds_read_b128 v[32:35], v3 offset:15360
    ds_read_b128 v[36:39], v3 offset:33792
    v_mfma_f32_16x16x32_bf16 v[212:215], v[40:43], v[188:191], v[212:215]
    v_mfma_f32_16x16x32_bf16 v[216:219], v[44:47], v[116:119], v[216:219]
    s_add_u32 m0, s23, 7680
    s_nop 0
    buffer_load_dwordx4 v2, s[8:11], s24 offen offset:512 lds
    s_add_u32 s24, s24, s42
    v_mfma_f32_16x16x32_bf16 v[220:223], v[44:47], v[188:191], v[220:223]
    v_mfma_f32_16x16x32_bf16 v[224:227], v[40:43], a[52:55], v[224:227]
    v_mfma_f32_16x16x32_bf16 v[228:231], v[40:43], a[124:127], v[228:231]
    v_mfma_f32_16x16x32_bf16 v[232:235], v[44:47], a[52:55], v[232:235]
    v_mfma_f32_16x16x32_bf16 v[236:239], v[44:47], a[124:127], v[236:239]
    s_waitcnt lgkmcnt(2)
    v_mfma_f32_16x16x32_bf16 v[208:211], v[48:51], v[120:123], v[208:211]
    ds_read_b128 v[40:43], v3 offset:16384
    ds_read_b128 v[44:47], v3 offset:34816
    v_mfma_f32_16x16x32_bf16 v[212:215], v[48:51], v[192:195], v[212:215]
    v_mfma_f32_16x16x32_bf16 v[216:219], v[52:55], v[120:123], v[216:219]
    v_add_u32 v24, s27, v1
    v_mfma_f32_16x16x32_bf16 v[220:223], v[52:55], v[192:195], v[220:223]
    v_mfma_f32_16x16x32_bf16 v[224:227], v[48:51], a[56:59], v[224:227]
    v_mfma_f32_16x16x32_bf16 v[228:231], v[48:51], a[128:131], v[228:231]
    v_mfma_f32_16x16x32_bf16 v[232:235], v[52:55], a[56:59], v[232:235]
    v_mfma_f32_16x16x32_bf16 v[236:239], v[52:55], a[128:131], v[236:239]
    s_waitcnt lgkmcnt(2)
    v_mfma_f32_16x16x32_bf16 v[208:211], v[32:35], v[124:127], v[208:211]
    ds_read_b128 v[48:51], v3 offset:17408
    ds_read_b128 v[52:55], v3 offset:35840
    v_mfma_f32_16x16x32_bf16 v[212:215], v[32:35], v[196:199], v[212:215]
    v_mfma_f32_16x16x32_bf16 v[216:219], v[36:39], v[124:127], v[216:219]
    v_mfma_f32_16x16x32_bf16 v[220:223], v[36:39], v[196:199], v[220:223]
    v_mfma_f32_16x16x32_bf16 v[224:227], v[32:35], a[60:63], v[224:227]
    v_mfma_f32_16x16x32_bf16 v[228:231], v[32:35], a[132:135], v[228:231]
    s_waitcnt vmcnt(9)
    s_barrier
    v_mfma_f32_16x16x32_bf16 v[232:235], v[36:39], a[60:63], v[232:235]
    v_mfma_f32_16x16x32_bf16 v[236:239], v[36:39], a[132:135], v[236:239]
    s_waitcnt lgkmcnt(2)
    v_mfma_f32_16x16x32_bf16 v[208:211], v[40:43], v[128:131], v[208:211]
    ds_read_b128 v[32:35], v24 offset:0
    ds_read_b128 v[36:39], v24 offset:18432
    v_mfma_f32_16x16x32_bf16 v[212:215], v[40:43], v[200:203], v[212:215]
    v_mfma_f32_16x16x32_bf16 v[216:219], v[44:47], v[128:131], v[216:219]
    v_mov_b32 v4, s30
    s_mov_b64 exec, s[34:35]
    buffer_store_dword v4, off, s[4:7], s29 sc1
    s_mov_b64 exec, -1
    v_mfma_f32_16x16x32_bf16 v[220:223], v[44:47], v[200:203], v[220:223]
    v_mfma_f32_16x16x32_bf16 v[224:227], v[40:43], a[64:67], v[224:227]
    v_mfma_f32_16x16x32_bf16 v[228:231], v[40:43], a[136:139], v[228:231]
    v_mfma_f32_16x16x32_bf16 v[232:235], v[44:47], a[64:67], v[232:235]
    v_mfma_f32_16x16x32_bf16 v[236:239], v[44:47], a[136:139], v[236:239]
    s_waitcnt lgkmcnt(2)
    v_mfma_f32_16x16x32_bf16 v[208:211], v[48:51], v[132:135], v[208:211]
    ds_read_b128 v[40:43], v24 offset:1024
    ds_read_b128 v[44:47], v24 offset:19456
    v_mfma_f32_16x16x32_bf16 v[212:215], v[48:51], v[204:207], v[212:215]
    v_mfma_f32_16x16x32_bf16 v[216:219], v[52:55], v[132:135], v[216:219]
    v_mfma_f32_16x16x32_bf16 v[220:223], v[52:55], v[204:207], v[220:223]
    v_mfma_f32_16x16x32_bf16 v[224:227], v[48:51], a[68:71], v[224:227]
    v_mfma_f32_16x16x32_bf16 v[228:231], v[48:51], a[140:143], v[228:231]
    v_mfma_f32_16x16x32_bf16 v[232:235], v[52:55], a[68:71], v[232:235]
    v_mfma_f32_16x16x32_bf16 v[236:239], v[52:55], a[140:143], v[236:239]
    v_mov_b32 v3, v24
    s_mov_b32 s31, s26
    s_add_u32 s26, s26, s41
    s_add_u32 s30, s30, 1
    s_add_u32 s19, s19, s20
    s_cmp_lt_u32 s19, 64
    s_cbranch_scc1 qk_vloop
    v_cvt_pk_bf16_f32 v8, v208, v209
    v_cvt_pk_bf16_f32 v9, v210, v211
    v_cvt_pk_bf16_f32 v12, v212, v213
    v_cvt_pk_bf16_f32 v13, v214, v215
    v_cvt_pk_bf16_f32 v10, v216, v217
    v_cvt_pk_bf16_f32 v11, v218, v219
    v_cvt_pk_bf16_f32 v14, v220, v221
    v_cvt_pk_bf16_f32 v15, v222, v223
    v_cvt_pk_bf16_f32 v16, v224, v225
    v_cvt_pk_bf16_f32 v17, v226, v227
    v_cvt_pk_bf16_f32 v20, v228, v229
    v_cvt_pk_bf16_f32 v21, v230, v231
    v_cvt_pk_bf16_f32 v18, v232, v233
    v_cvt_pk_bf16_f32 v19, v234, v235
    v_cvt_pk_bf16_f32 v22, v236, v237
    v_cvt_pk_bf16_f32 v23, v238, v239
qk_done:
    s_mov_b32 s28, s31
    buffer_store_dwordx4 v[8:11], v7, s[4:7], s28 offen sc1
    s_add_u32 s28, s28, s40
    buffer_store_dwordx4 v[12:15], v7, s[4:7], s28 offen sc1
    s_add_u32 s28, s31, s43
    buffer_store_dwordx4 v[16:19], v7, s[4:7], s28 offen sc1
    s_add_u32 s28, s28, s40
    buffer_store_dwordx4 v[20:23], v7, s[4:7], s28 offen sc1
    s_waitcnt vmcnt(0) lgkmcnt(0)
    s_barrier
    s_add_u32 s22, s95, 63
    v_mov_b32 v4, s22
    s_mov_b64 exec, s[34:35]
    buffer_store_dword v4, off, s[4:7], s29 sc1
    s_mov_b64 exec, -1
    s_cmp_eq_u32 s16, 0
    s_cbranch_scc1 qk_nq
    s_add_u32 s29, s29, 4096
    v_mov_b32 v4, s22
    s_mov_b64 exec, s[34:35]
    buffer_store_dword v4, off, s[4:7], s29 sc1
    s_mov_b64 exec, -1
qk_nq:
    s_cmp_ge_u32 s36, 64
    s_cbranch_scc1 L_qkv_next
    s_cmp_lt_u32 s36, 32
    s_cbranch_scc1 L_qkv_next
    v_and_b32 v4, 63, v0
    v_lshrrev_b32 v5, 4, v4
    v_bfe_u32 v240, v4, 3, 1
    v_lshlrev_b32 v243, 17, v240
    v_mul_u32_u24 v240, 12288, v240
    v_add_u32 v1, 0, v5
    v_mul_u32_u24 v6, 11, v1
    v_lshrrev_b32 v6, 5, v6
    v_add_u32 v1, v1, v6
    v_lshlrev_b32 v1, 7, v1
    v_and_b32 v6, 7, v4
    v_lshl_add_u32 v1, v6, 4, v1
    v_add_u32 v1, v1, v240
    v_add_u32 v2, 4, v5
    v_mul_u32_u24 v6, 11, v2
    v_lshrrev_b32 v6, 5, v6
    v_add_u32 v2, v2, v6
    v_lshlrev_b32 v2, 7, v2
    v_and_b32 v6, 7, v4
    v_lshl_add_u32 v2, v6, 4, v2
    v_add_u32 v2, v2, v240
    v_add_u32 v3, 8, v5
    v_mul_u32_u24 v6, 11, v3
    v_lshrrev_b32 v6, 5, v6
    v_add_u32 v3, v3, v6
    v_lshlrev_b32 v3, 7, v3
    v_and_b32 v6, 7, v4
    v_lshl_add_u32 v3, v6, 4, v3
    v_add_u32 v3, v3, v240
    v_min_u32 v6, 23, v4
    v_lshlrev_b32 v6, 9, v6
    v_or_b32 v241, 128, v7
    v_mov_b32 v242, v241
    s_cmp_lg_u32 s16, 2
    s_cbranch_scc1 mk_isk
    v_lshrrev_b32 v243, 5, v4
    v_lshlrev_b32 v243, 17, v243
    v_mov_b32 v241, v7
    v_xor_b32 v242, 512, v7
mk_isk:
    v_add_u32 v241, v241, v243
    v_add_u32 v242, v242, v243
    s_mov_b32 s19, 0
    s_mov_b32 s27, 2
    s_mov_b32 s24, 90177536
    s_lshl_b32 s26, s17, 12
    s_mov_b32 s21, 71303168
    s_cmp_eq_u32 s16, 2
    s_cselect_b32 s21, 80740352, s21
    s_add_u32 s26, s26, s21
    s_lshl_b32 s29, s17, 7
    s_lshl_b32 s21, s16, 3
    s_add_u32 s29, s29, s21
    s_add_u32 s29, s29, 125829240
mk_loop:
    s_cmp_lg_u32 s19, 58
    s_cbranch_scc1 mk_same
    s_mov_b32 s27, 1
    v_sub_u32 v1, v1, v240
    v_sub_u32 v2, v2, v240
    v_sub_u32 v3, v3, v240
    v_sub_u32 v241, v241, v243
    v_sub_u32 v242, v242, v243
mk_same:
    s_cmp_lg_u32 s18, 0
    s_cbranch_scc1 mk_go
    s_mul_i32 s23, s27, 12288
    s_add_u32 s23, s23, s24
    s_sub_u32 s23, s23, 12288
    s_mov_b32 s21, 4194304
mk_wait:
    buffer_load_dword v4, v6, s[4:7], s23 offen offset:384 sc1
    s_sub_u32 s21, s21, 1
    s_cbranch_scc1 mk_go
    s_waitcnt vmcnt(0)
    v_cmp_ne_u32 vcc, s95, v4
    s_cbranch_vccz mk_go
    s_sleep 4
    s_branch mk_wait
mk_go:
    s_barrier
    s_mov_b32 s30, 4096
mk_again:
    v_mov_b32 v5, 0
    s_add_u32 s23, s24, 0
    buffer_load_dwordx4 v[24:27], v1, s[4:7], s23 offen offset:0 sc1
    buffer_load_dwordx4 v[28:31], v2, s[4:7], s23 offen offset:0 sc1
    buffer_load_dwordx4 v[32:35], v3, s[4:7], s23 offen offset:0 sc1
    buffer_load_dwordx4 v[36:39], v1, s[4:7], s23 offen offset:2048 sc1
    buffer_load_dwordx4 v[40:43], v2, s[4:7], s23 offen offset:2048 sc1
    buffer_load_dwordx4 v[44:47], v3, s[4:7], s23 offen offset:2048 sc1
    s_add_u32 s23, s24, 4096
    buffer_load_dwordx4 v[48:51], v1, s[4:7], s23 offen offset:0 sc1
    buffer_load_dwordx4 v[52:55], v2, s[4:7], s23 offen offset:0 sc1
    buffer_load_dwordx4 v[56:59], v3, s[4:7], s23 offen offset:0 sc1
    buffer_load_dwordx4 v[60:63], v1, s[4:7], s23 offen offset:2048 sc1
    buffer_load_dwordx4 v[208:211], v2, s[4:7], s23 offen offset:2048 sc1
    buffer_load_dwordx4 v[212:215], v3, s[4:7], s23 offen offset:2048 sc1
    s_add_u32 s23, s24, 8192
    buffer_load_dwordx4 v[216:219], v1, s[4:7], s23 offen offset:0 sc1
    buffer_load_dwordx4 v[220:223], v2, s[4:7], s23 offen offset:0 sc1
    buffer_load_dwordx4 v[224:227], v3, s[4:7], s23 offen offset:0 sc1
    buffer_load_dwordx4 v[228:231], v1, s[4:7], s23 offen offset:2048 sc1
    buffer_load_dwordx4 v[232:235], v2, s[4:7], s23 offen offset:2048 sc1
    buffer_load_dwordx4 v[236:239], v3, s[4:7], s23 offen offset:2048 sc1
    s_cmp_eq_u32 s16, 2
    s_cbranch_scc1 mk_v
    s_waitcnt vmcnt(17)
    v_mfma_f32_16x16x32_bf16 v[8:11], v[64:67], v[24:27], 0
    v_mfma_f32_16x16x32_bf16 v[12:15], v[136:139], v[24:27], 0
    v_max3_u32 v5, v5, v24, v25
    v_mfma_f32_16x16x32_bf16 v[16:19], a[0:3], v[24:27], 0
    v_mfma_f32_16x16x32_bf16 v[20:23], a[72:75], v[24:27], 0
    v_max3_u32 v5, v5, v26, v27
    s_waitcnt vmcnt(16)
    v_mfma_f32_16x16x32_bf16 v[8:11], v[68:71], v[28:31], v[8:11]
    v_mfma_f32_16x16x32_bf16 v[12:15], v[140:143], v[28:31], v[12:15]
    v_max3_u32 v5, v5, v28, v29
    v_mfma_f32_16x16x32_bf16 v[16:19], a[4:7], v[28:31], v[16:19]
    v_mfma_f32_16x16x32_bf16 v[20:23], a[76:79], v[28:31], v[20:23]
    v_max3_u32 v5, v5, v30, v31
    s_waitcnt vmcnt(15)
    v_mfma_f32_16x16x32_bf16 v[8:11], v[72:75], v[32:35], v[8:11]
    v_mfma_f32_16x16x32_bf16 v[12:15], v[144:147], v[32:35], v[12:15]
    v_max3_u32 v5, v5, v32, v33
    v_mfma_f32_16x16x32_bf16 v[16:19], a[8:11], v[32:35], v[16:19]
    v_mfma_f32_16x16x32_bf16 v[20:23], a[80:83], v[32:35], v[20:23]
    v_max3_u32 v5, v5, v34, v35
    s_waitcnt vmcnt(14)
    v_mfma_f32_16x16x32_bf16 v[8:11], v[76:79], v[36:39], v[8:11]
    v_mfma_f32_16x16x32_bf16 v[12:15], v[148:151], v[36:39], v[12:15]
    v_max3_u32 v5, v5, v36, v37
    v_mfma_f32_16x16x32_bf16 v[16:19], a[12:15], v[36:39], v[16:19]
    v_mfma_f32_16x16x32_bf16 v[20:23], a[84:87], v[36:39], v[20:23]
    v_max3_u32 v5, v5, v38, v39
    s_waitcnt vmcnt(13)
    v_mfma_f32_16x16x32_bf16 v[8:11], v[80:83], v[40:43], v[8:11]
    v_mfma_f32_16x16x32_bf16 v[12:15], v[152:155], v[40:43], v[12:15]
    v_max3_u32 v5, v5, v40, v41
    v_mfma_f32_16x16x32_bf16 v[16:19], a[16:19], v[40:43], v[16:19]
    v_mfma_f32_16x16x32_bf16 v[20:23], a[88:91], v[40:43], v[20:23]
    v_max3_u32 v5, v5, v42, v43
    s_waitcnt vmcnt(12)
    v_mfma_f32_16x16x32_bf16 v[8:11], v[84:87], v[44:47], v[8:11]
    v_mfma_f32_16x16x32_bf16 v[12:15], v[156:159], v[44:47], v[12:15]
    v_max3_u32 v5, v5, v44, v45
    v_mfma_f32_16x16x32_bf16 v[16:19], a[20:23], v[44:47], v[16:19]
    v_mfma_f32_16x16x32_bf16 v[20:23], a[92:95], v[44:47], v[20:23]
    v_max3_u32 v5, v5, v46, v47
    s_waitcnt vmcnt(11)
    v_mfma_f32_16x16x32_bf16 v[8:11], v[88:91], v[48:51], v[8:11]
    v_mfma_f32_16x16x32_bf16 v[12:15], v[160:163], v[48:51], v[12:15]
    v_max3_u32 v5, v5, v48, v49
    v_mfma_f32_16x16x32_bf16 v[16:19], a[24:27], v[48:51], v[16:19]
    v_mfma_f32_16x16x32_bf16 v[20:23], a[96:99], v[48:51], v[20:23]
    v_max3_u32 v5, v5, v50, v51
    s_waitcnt vmcnt(10)
    v_mfma_f32_16x16x32_bf16 v[8:11], v[92:95], v[52:55], v[8:11]
    v_mfma_f32_16x16x32_bf16 v[12:15], v[164:167], v[52:55], v[12:15]
    v_max3_u32 v5, v5, v52, v53
    v_mfma_f32_16x16x32_bf16 v[16:19], a[28:31], v[52:55], v[16:19]
    v_mfma_f32_16x16x32_bf16 v[20:23], a[100:103], v[52:55], v[20:23]
    v_max3_u32 v5, v5, v54, v55
    s_waitcnt vmcnt(9)
    v_mfma_f32_16x16x32_bf16 v[8:11], v[96:99], v[56:59], v[8:11]
    v_mfma_f32_16x16x32_bf16 v[12:15], v[168:171], v[56:59], v[12:15]
    v_max3_u32 v5, v5, v56, v57
    v_mfma_f32_16x16x32_bf16 v[16:19], a[32:35], v[56:59], v[16:19]
    v_mfma_f32_16x16x32_bf16 v[20:23], a[104:107], v[56:59], v[20:23]
    v_max3_u32 v5, v5, v58, v59
    s_waitcnt vmcnt(8)
    v_mfma_f32_16x16x32_bf16 v[8:11], v[100:103], v[60:63], v[8:11]
    v_mfma_f32_16x16x32_bf16 v[12:15], v[172:175], v[60:63], v[12:15]
    v_max3_u32 v5, v5, v60, v61
    v_mfma_f32_16x16x32_bf16 v[16:19], a[36:39], v[60:63], v[16:19]
    v_mfma_f32_16x16x32_bf16 v[20:23], a[108:111], v[60:63], v[20:23]
    v_max3_u32 v5, v5, v62, v63
    s_waitcnt vmcnt(7)
    v_mfma_f32_16x16x32_bf16 v[8:11], v[104:107], v[208:211], v[8:11]
    v_mfma_f32_16x16x32_bf16 v[12:15], v[176:179], v[208:211], v[12:15]
    v_max3_u32 v5, v5, v208, v209
    v_mfma_f32_16x16x32_bf16 v[16:19], a[40:43], v[208:211], v[16:19]
    v_mfma_f32_16x16x32_bf16 v[20:23], a[112:115], v[208:211], v[20:23]
    v_max3_u32 v5, v5, v210, v211
    s_waitcnt vmcnt(6)
    v_mfma_f32_16x16x32_bf16 v[8:11], v[108:111], v[212:215], v[8:11]
    v_mfma_f32_16x16x32_bf16 v[12:15], v[180:183], v[212:215], v[12:15]
    v_max3_u32 v5, v5, v212, v213
    v_mfma_f32_16x16x32_bf16 v[16:19], a[44:47], v[212:215], v[16:19]
    v_mfma_f32_16x16x32_bf16 v[20:23], a[116:119], v[212:215], v[20:23]
    v_max3_u32 v5, v5, v214, v215
    s_waitcnt vmcnt(5)
    v_mfma_f32_16x16x32_bf16 v[8:11], v[112:115], v[216:219], v[8:11]
    v_mfma_f32_16x16x32_bf16 v[12:15], v[184:187], v[216:219], v[12:15]
    v_max3_u32 v5, v5, v216, v217
    v_mfma_f32_16x16x32_bf16 v[16:19], a[48:51], v[216:219], v[16:19]
    v_mfma_f32_16x16x32_bf16 v[20:23], a[120:123], v[216:219], v[20:23]
    v_max3_u32 v5, v5, v218, v219
    s_waitcnt vmcnt(4)
    v_mfma_f32_16x16x32_bf16 v[8:11], v[116:119], v[220:223], v[8:11]
    v_mfma_f32_16x16x32_bf16 v[12:15], v[188:191], v[220:223], v[12:15]
    v_max3_u32 v5, v5, v220, v221
    v_mfma_f32_16x16x32_bf16 v[16:19], a[52:55], v[220:223], v[16:19]
    v_mfma_f32_16x16x32_bf16 v[20:23], a[124:127], v[220:223], v[20:23]
    v_max3_u32 v5, v5, v222, v223
    s_waitcnt vmcnt(3)
    v_mfma_f32_16x16x32_bf16 v[8:11], v[120:123], v[224:227], v[8:11]
    v_mfma_f32_16x16x32_bf16 v[12:15], v[192:195], v[224:227], v[12:15]
    v_max3_u32 v5, v5, v224, v225
    v_mfma_f32_16x16x32_bf16 v[16:19], a[56:59], v[224:227], v[16:19]
    v_mfma_f32_16x16x32_bf16 v[20:23], a[128:131], v[224:227], v[20:23]
    v_max3_u32 v5, v5, v226, v227
    s_waitcnt vmcnt(2)
    v_mfma_f32_16x16x32_bf16 v[8:11], v[124:127], v[228:231], v[8:11]
    v_mfma_f32_16x16x32_bf16 v[12:15], v[196:199], v[228:231], v[12:15]
    v_max3_u32 v5, v5, v228, v229
    v_mfma_f32_16x16x32_bf16 v[16:19], a[60:63], v[228:231], v[16:19]
    v_mfma_f32_16x16x32_bf16 v[20:23], a[132:135], v[228:231], v[20:23]
    v_max3_u32 v5, v5, v230, v231
    s_waitcnt vmcnt(1)
    v_mfma_f32_16x16x32_bf16 v[8:11], v[128:131], v[232:235], v[8:11]
    v_mfma_f32_16x16x32_bf16 v[12:15], v[200:203], v[232:235], v[12:15]
    v_max3_u32 v5, v5, v232, v233
    v_mfma_f32_16x16x32_bf16 v[16:19], a[64:67], v[232:235], v[16:19]
    v_mfma_f32_16x16x32_bf16 v[20:23], a[136:139], v[232:235], v[20:23]
    v_max3_u32 v5, v5, v234, v235
    s_waitcnt vmcnt(0)
    v_mfma_f32_16x16x32_bf16 v[8:11], v[132:135], v[236:239], v[8:11]
    v_mfma_f32_16x16x32_bf16 v[12:15], v[204:207], v[236:239], v[12:15]
    v_max3_u32 v5, v5, v236, v237
    v_mfma_f32_16x16x32_bf16 v[16:19], a[68:71], v[236:239], v[16:19]
    v_mfma_f32_16x16x32_bf16 v[20:23], a[140:143], v[236:239], v[20:23]
    v_max3_u32 v5, v5, v238, v239
    s_nop 5
    s_branch mk_st
mk_v:
    s_waitcnt vmcnt(17)
    v_mfma_f32_16x16x32_bf16 v[8:11], v[24:27], v[64:67], 0
    v_mfma_f32_16x16x32_bf16 v[12:15], v[24:27], v[136:139], 0
    v_max3_u32 v5, v5, v24, v25
    v_mfma_f32_16x16x32_bf16 v[16:19], v[24:27], a[0:3], 0
    v_mfma_f32_16x16x32_bf16 v[20:23], v[24:27], a[72:75], 0
    v_max3_u32 v5, v5, v26, v27
    s_waitcnt vmcnt(16)
    v_mfma_f32_16x16x32_bf16 v[8:11], v[28:31], v[68:71], v[8:11]
    v_mfma_f32_16x16x32_bf16 v[12:15], v[28:31], v[140:143], v[12:15]
    v_max3_u32 v5, v5, v28, v29
    v_mfma_f32_16x16x32_bf16 v[16:19], v[28:31], a[4:7], v[16:19]
    v_mfma_f32_16x16x32_bf16 v[20:23], v[28:31], a[76:79], v[20:23]
    v_max3_u32 v5, v5, v30, v31
    s_waitcnt vmcnt(15)
    v_mfma_f32_16x16x32_bf16 v[8:11], v[32:35], v[72:75], v[8:11]
    v_mfma_f32_16x16x32_bf16 v[12:15], v[32:35], v[144:147], v[12:15]
    v_max3_u32 v5, v5, v32, v33
    v_mfma_f32_16x16x32_bf16 v[16:19], v[32:35], a[8:11], v[16:19]
    v_mfma_f32_16x16x32_bf16 v[20:23], v[32:35], a[80:83], v[20:23]
    v_max3_u32 v5, v5, v34, v35
    s_waitcnt vmcnt(14)
    v_mfma_f32_16x16x32_bf16 v[8:11], v[36:39], v[76:79], v[8:11]
    v_mfma_f32_16x16x32_bf16 v[12:15], v[36:39], v[148:151], v[12:15]
    v_max3_u32 v5, v5, v36, v37
    v_mfma_f32_16x16x32_bf16 v[16:19], v[36:39], a[12:15], v[16:19]
    v_mfma_f32_16x16x32_bf16 v[20:23], v[36:39], a[84:87], v[20:23]
    v_max3_u32 v5, v5, v38, v39
    s_waitcnt vmcnt(13)
    v_mfma_f32_16x16x32_bf16 v[8:11], v[40:43], v[80:83], v[8:11]
    v_mfma_f32_16x16x32_bf16 v[12:15], v[40:43], v[152:155], v[12:15]
    v_max3_u32 v5, v5, v40, v41
    v_mfma_f32_16x16x32_bf16 v[16:19], v[40:43], a[16:19], v[16:19]
    v_mfma_f32_16x16x32_bf16 v[20:23], v[40:43], a[88:91], v[20:23]
    v_max3_u32 v5, v5, v42, v43
    s_waitcnt vmcnt(12)
    v_mfma_f32_16x16x32_bf16 v[8:11], v[44:47], v[84:87], v[8:11]
    v_mfma_f32_16x16x32_bf16 v[12:15], v[44:47], v[156:159], v[12:15]
    v_max3_u32 v5, v5, v44, v45
    v_mfma_f32_16x16x32_bf16 v[16:19], v[44:47], a[20:23], v[16:19]
    v_mfma_f32_16x16x32_bf16 v[20:23], v[44:47], a[92:95], v[20:23]
    v_max3_u32 v5, v5, v46, v47
    s_waitcnt vmcnt(11)
    v_mfma_f32_16x16x32_bf16 v[8:11], v[48:51], v[88:91], v[8:11]
    v_mfma_f32_16x16x32_bf16 v[12:15], v[48:51], v[160:163], v[12:15]
    v_max3_u32 v5, v5, v48, v49
    v_mfma_f32_16x16x32_bf16 v[16:19], v[48:51], a[24:27], v[16:19]
    v_mfma_f32_16x16x32_bf16 v[20:23], v[48:51], a[96:99], v[20:23]
    v_max3_u32 v5, v5, v50, v51
    s_waitcnt vmcnt(10)
    v_mfma_f32_16x16x32_bf16 v[8:11], v[52:55], v[92:95], v[8:11]
    v_mfma_f32_16x16x32_bf16 v[12:15], v[52:55], v[164:167], v[12:15]
    v_max3_u32 v5, v5, v52, v53
    v_mfma_f32_16x16x32_bf16 v[16:19], v[52:55], a[28:31], v[16:19]
    v_mfma_f32_16x16x32_bf16 v[20:23], v[52:55], a[100:103], v[20:23]
    v_max3_u32 v5, v5, v54, v55
    s_waitcnt vmcnt(9)
    v_mfma_f32_16x16x32_bf16 v[8:11], v[56:59], v[96:99], v[8:11]
    v_mfma_f32_16x16x32_bf16 v[12:15], v[56:59], v[168:171], v[12:15]
    v_max3_u32 v5, v5, v56, v57
    v_mfma_f32_16x16x32_bf16 v[16:19], v[56:59], a[32:35], v[16:19]
    v_mfma_f32_16x16x32_bf16 v[20:23], v[56:59], a[104:107], v[20:23]
    v_max3_u32 v5, v5, v58, v59
    s_waitcnt vmcnt(8)
    v_mfma_f32_16x16x32_bf16 v[8:11], v[60:63], v[100:103], v[8:11]
    v_mfma_f32_16x16x32_bf16 v[12:15], v[60:63], v[172:175], v[12:15]
    v_max3_u32 v5, v5, v60, v61
    v_mfma_f32_16x16x32_bf16 v[16:19], v[60:63], a[36:39], v[16:19]
    v_mfma_f32_16x16x32_bf16 v[20:23], v[60:63], a[108:111], v[20:23]
    v_max3_u32 v5, v5, v62, v63
    s_waitcnt vmcnt(7)
    v_mfma_f32_16x16x32_bf16 v[8:11], v[208:211], v[104:107], v[8:11]
    v_mfma_f32_16x16x32_bf16 v[12:15], v[208:211], v[176:179], v[12:15]
    v_max3_u32 v5, v5, v208, v209
    v_mfma_f32_16x16x32_bf16 v[16:19], v[208:211], a[40:43], v[16:19]
    v_mfma_f32_16x16x32_bf16 v[20:23], v[208:211], a[112:115], v[20:23]
    v_max3_u32 v5, v5, v210, v211
    s_waitcnt vmcnt(6)
    v_mfma_f32_16x16x32_bf16 v[8:11], v[212:215], v[108:111], v[8:11]
    v_mfma_f32_16x16x32_bf16 v[12:15], v[212:215], v[180:183], v[12:15]
    v_max3_u32 v5, v5, v212, v213
    v_mfma_f32_16x16x32_bf16 v[16:19], v[212:215], a[44:47], v[16:19]
    v_mfma_f32_16x16x32_bf16 v[20:23], v[212:215], a[116:119], v[20:23]
    v_max3_u32 v5, v5, v214, v215
    s_waitcnt vmcnt(5)
    v_mfma_f32_16x16x32_bf16 v[8:11], v[216:219], v[112:115], v[8:11]
    v_mfma_f32_16x16x32_bf16 v[12:15], v[216:219], v[184:187], v[12:15]
    v_max3_u32 v5, v5, v216, v217
    v_mfma_f32_16x16x32_bf16 v[16:19], v[216:219], a[48:51], v[16:19]
    v_mfma_f32_16x16x32_bf16 v[20:23], v[216:219], a[120:123], v[20:23]
    v_max3_u32 v5, v5, v218, v219
    s_waitcnt vmcnt(4)
    v_mfma_f32_16x16x32_bf16 v[8:11], v[220:223], v[116:119], v[8:11]
    v_mfma_f32_16x16x32_bf16 v[12:15], v[220:223], v[188:191], v[12:15]
    v_max3_u32 v5, v5, v220, v221
    v_mfma_f32_16x16x32_bf16 v[16:19], v[220:223], a[52:55], v[16:19]
    v_mfma_f32_16x16x32_bf16 v[20:23], v[220:223], a[124:127], v[20:23]
    v_max3_u32 v5, v5, v222, v223
    s_waitcnt vmcnt(3)
    v_mfma_f32_16x16x32_bf16 v[8:11], v[224:227], v[120:123], v[8:11]
    v_mfma_f32_16x16x32_bf16 v[12:15], v[224:227], v[192:195], v[12:15]
    v_max3_u32 v5, v5, v224, v225
    v_mfma_f32_16x16x32_bf16 v[16:19], v[224:227], a[56:59], v[16:19]
    v_mfma_f32_16x16x32_bf16 v[20:23], v[224:227], a[128:131], v[20:23]
    v_max3_u32 v5, v5, v226, v227
    s_waitcnt vmcnt(2)
    v_mfma_f32_16x16x32_bf16 v[8:11], v[228:231], v[124:127], v[8:11]
    v_mfma_f32_16x16x32_bf16 v[12:15], v[228:231], v[196:199], v[12:15]
    v_max3_u32 v5, v5, v228, v229
    v_mfma_f32_16x16x32_bf16 v[16:19], v[228:231], a[60:63], v[16:19]
    v_mfma_f32_16x16x32_bf16 v[20:23], v[228:231], a[132:135], v[20:23]
    v_max3_u32 v5, v5, v230, v231
    s_waitcnt vmcnt(1)
    v_mfma_f32_16x16x32_bf16 v[8:11], v[232:235], v[128:131], v[8:11]
    v_mfma_f32_16x16x32_bf16 v[12:15], v[232:235], v[200:203], v[12:15]
    v_max3_u32 v5, v5, v232, v233
    v_mfma_f32_16x16x32_bf16 v[16:19], v[232:235], a[64:67], v[16:19]
    v_mfma_f32_16x16x32_bf16 v[20:23], v[232:235], a[136:139], v[20:23]
    v_max3_u32 v5, v5, v234, v235
    s_waitcnt vmcnt(0)
    v_mfma_f32_16x16x32_bf16 v[8:11], v[236:239], v[132:135], v[8:11]
    v_mfma_f32_16x16x32_bf16 v[12:15], v[236:239], v[204:207], v[12:15]
    v_max3_u32 v5, v5, v236, v237
    v_mfma_f32_16x16x32_bf16 v[16:19], v[236:239], a[68:71], v[16:19]
    v_mfma_f32_16x16x32_bf16 v[20:23], v[236:239], a[140:143], v[20:23]
    v_max3_u32 v5, v5, v238, v239
    v_pk_mul_f32 v[8:9], v[8:9], 0.5 op_sel_hi:[1,0]
    v_pk_mul_f32 v[10:11], v[10:11], 0.5 op_sel_hi:[1,0]
    v_pk_mul_f32 v[12:13], v[12:13], 0.5 op_sel_hi:[1,0]
    v_pk_mul_f32 v[14:15], v[14:15], 0.5 op_sel_hi:[1,0]
    v_pk_mul_f32 v[16:17], v[16:17], 0.5 op_sel_hi:[1,0]
    v_pk_mul_f32 v[18:19], v[18:19], 0.5 op_sel_hi:[1,0]
    v_pk_mul_f32 v[20:21], v[20:21], 0.5 op_sel_hi:[1,0]
    v_pk_mul_f32 v[22:23], v[22:23], 0.5 op_sel_hi:[1,0]
    s_nop 1
mk_st:
    v_cmp_eq_u32 vcc, -1, v5
    s_sub_u32 s30, s30, 1
    s_cbranch_scc1 mk_ok
    s_cbranch_vccnz mk_again
mk_ok:
    v_cvt_pk_bf16_f32 v24, v8, v9
    v_cvt_pk_bf16_f32 v25, v10, v11
    v_cvt_pk_bf16_f32 v26, v12, v13
    v_cvt_pk_bf16_f32 v27, v14, v15
    v_cvt_pk_bf16_f32 v28, v16, v17
    v_cvt_pk_bf16_f32 v29, v18, v19
    v_cvt_pk_bf16_f32 v30, v20, v21
    v_cvt_pk_bf16_f32 v31, v22, v23
    s_add_u32 s21, s26, 4096
    buffer_store_dwordx4 v[24:27], v241, s[4:7], s26 offen sc1
    buffer_store_dwordx4 v[28:31], v241, s[4:7], s21 offen sc1
    s_add_u32 s19, s19, s27
    s_cmp_eq_u32 s27, 1
    s_cbranch_scc1 mk_fl
    s_cmp_lg_u32 s16, 2
    s_cbranch_scc1 mk_wt
    buffer_store_dwordx4 v[24:27], v242, s[4:7], s26 offen sc1
    buffer_store_dwordx4 v[28:31], v242, s[4:7], s21 offen sc1
mk_wt:
    s_waitcnt vmcnt(0)
mk_fl:
    s_barrier
    s_add_u32 s22, s19, s95
    v_mov_b32 v4, s22
    s_mov_b64 exec, s[34:35]
    buffer_store_dword v4, off, s[4:7], s29 sc1
    s_mov_b64 exec, -1
    s_mul_i32 s21, s27, 12288
    s_add_u32 s24, s24, s21
    s_lshl_b32 s21, s27, 17
    s_add_u32 s26, s26, s21
    s_cmp_lt_u32 s19, 62
    s_cbranch_scc1 mk_loop
    s_endpgm
L_ssm_next:
    s_sub_u32 s33, s3, 4
    s_and_b32 s33, s33, 7
    s_cmp_ge_u32 s33, 6
    s_cbranch_scc1 L_sscan
L_stake:
    s_lshl_b32 s35, s33, 2
    s_add_u32 s35, s35, 96
    s_mov_b32 s37, s35
    v_mov_b32 v250, 1
    v_mov_b32 v251, 163832
    v_cmp_eq_u32 vcc, 0, v0
    s_nop 0
    s_and_saveexec_b64 s[38:39], vcc
    s_cbranch_execz tk8
    buffer_atomic_add v250, off, s[96:99], s37 sc0
    s_waitcnt vmcnt(0)
    ds_write_b32 v251, v250
    s_waitcnt lgkmcnt(0)
tk8:
    s_mov_b64 exec, -1
    s_barrier
    ds_read_b32 v252, v251
    s_waitcnt lgkmcnt(0)
    v_readfirstlane_b32 s34, v252
    s_barrier
    s_nop 3
    s_mul_i32 s20, s33, 19
    s_add_u32 s20, s20, s34
    s_cmp_ge_u32 s20, 112
    s_cselect_b32 s34, 99, s34
    s_cmp_lt_u32 s34, 19
    s_cbranch_scc1 L_sjob
L_sscan:
    v_and_b32 v1, 63, v0
    v_min_u32 v1, 5, v1
    v_lshlrev_b32 v2, 2, v1
    s_cmp_lg_u32 s32, 0
    v_mov_b32 v251, 163832
    s_cbranch_scc1 sw9
    buffer_load_dword v3, v2, s[96:99], 0 offen offset:96 sc1
    v_mov_b32 v4, 19
    v_cmp_eq_u32 vcc, 5, v1
    s_nop 1
    v_cndmask_b32 v4, v4, 17, vcc
    s_waitcnt vmcnt(0)
    v_cmp_lt_u32 vcc, v3, v4
    s_nop 0
    s_ff1_i32_b64 s40, vcc
    v_mov_b32 v250, s40
    ds_write_b32 v251, v250
    s_waitcnt lgkmcnt(0)
sw9:
    s_barrier
    ds_read_b32 v252, v251
    s_waitcnt lgkmcnt(0)
    v_readfirstlane_b32 s33, v252
    s_barrier
    s_nop 1
    s_cmp_lt_u32 s33, 7
    s_cbranch_scc1 L_stake
    s_branch L_phase2
L_sjob:
    s_lshl_b32 s20, s20, 2
    v_lshrrev_b32 v5, 6, v0
    s_nop 0
    v_readfirstlane_b32 s21, v5
    v_and_b32 v1, 63, v0
    v_and_b32 v2, 15, v1
    v_lshrrev_b32 v3, 4, v1
    v_lshlrev_b32 v4, 14, v5
    s_mov_b32 s8, s62
    s_mov_b32 s9, s63
    s_mov_b32 s10, 2359296
    s_mov_b32 s11, 0x20000
    s_mov_b32 s16, s76
    s_mov_b32 s17, s77
    s_mov_b32 s18, 4718592
    s_mov_b32 s19, 0x20000
    s_add_u32 s22, s20, s21
    s_lshl_b32 s23, s22, 8
    v_lshlrev_b32 v6, 3, v2
    v_lshl_add_u32 v6, v3, 1, v6
    s_mov_b32 s12, s64
    s_mov_b32 s13, s65
    s_mov_b32 s14, 147456
    s_mov_b32 s15, 0x20000
    buffer_load_ushort v24, v6, s[12:15], s23 offen offset:0
    buffer_load_ushort v28, v6, s[12:15], s23 offen offset:128
    s_mov_b32 s12, s66
    s_mov_b32 s13, s67
    s_mov_b32 s14, 147456
    s_mov_b32 s15, 0x20000
    buffer_load_ushort v25, v6, s[12:15], s23 offen offset:0
    buffer_load_ushort v29, v6, s[12:15], s23 offen offset:128
    s_mov_b32 s12, s68
    s_mov_b32 s13, s69
    s_mov_b32 s14, 147456
    s_mov_b32 s15, 0x20000
    buffer_load_ushort v26, v6, s[12:15], s23 offen offset:0
    buffer_load_ushort v30, v6, s[12:15], s23 offen offset:128
    s_mov_b32 s12, s70
    s_mov_b32 s13, s71
    s_mov_b32 s14, 147456
    s_mov_b32 s15, 0x20000
    buffer_load_ushort v27, v6, s[12:15], s23 offen offset:0
    buffer_load_ushort v31, v6, s[12:15], s23 offen offset:128
    s_mov_b32 s12, s72
    s_mov_b32 s13, s73
    s_mov_b32 s14, 1152
    s_mov_b32 s15, 0x20000
    s_lshl_b32 s23, s22, 1
    buffer_load_ushort v32, off, s[12:15], s23
    v_mul_u32_u24 v5, 9216, v0
    s_lshl_b32 s22, s20, 1
    s_add_u32 s23, s22, 0
    buffer_load_dwordx2 v[8:9], v5, s[8:11], s23 offen
    s_add_u32 s23, s22, 1152
    buffer_load_dwordx2 v[10:11], v5, s[8:11], s23 offen
    s_add_u32 s23, s22, 2304
    buffer_load_dwordx2 v[12:13], v5, s[8:11], s23 offen
    s_add_u32 s23, s22, 3456
    buffer_load_dwordx2 v[14:15], v5, s[8:11], s23 offen
    s_add_u32 s23, s22, 4608
    buffer_load_dwordx2 v[16:17], v5, s[8:11], s23 offen
    s_add_u32 s23, s22, 5760
    buffer_load_dwordx2 v[18:19], v5, s[8:11], s23 offen
    s_add_u32 s23, s22, 6912
    buffer_load_dwordx2 v[20:21], v5, s[8:11], s23 offen
    s_add_u32 s23, s22, 8064
    buffer_load_dwordx2 v[22:23], v5, s[8:11], s23 offen
    s_mov_b32 s26, 0x3fb8aa3b
    s_mov_b32 s27, 0x3e22f983
    v_mov_b32 v34, 0
    v_mov_b32 v35, 0
    v_lshl_add_u32 v6, v1, 3, v4
    ds_write_b64 v6, v[34:35] offset:0
    s_waitcnt vmcnt(8)
    v_lshlrev_b32 v32, 16, v32
    v_mul_f32 v32, s26, v32
    v_exp_f32 v32, v32
    s_nop 0
    v_cvt_pk_bf16_f32 v32, v32, v32
    v_and_b32 v32, 0xffff0000, v32
    v_add_f32 v33, v32, v32
    v_lshlrev_b32 v24, 16, v24
    v_mul_f32 v24, s26, v24
    v_exp_f32 v24, v24
    s_nop 0
    v_cvt_pk_bf16_f32 v24, v24, v24
    v_and_b32 v24, 0xffff0000, v24
    v_mul_f32 v24, v24, v32
    v_mul_f32 v24, s26, v24
    v_sub_f32 v24, 0, v24
    v_lshlrev_b32 v25, 16, v25
    v_mul_f32 v25, v25, v32
    v_mul_f32 v25, s27, v25
    v_lshlrev_b32 v26, 16, v26
    v_mul_f32 v26, v26, v33
    v_lshlrev_b32 v27, 16, v27
    v_mul_f32 v27, v27, v33
    v_lshlrev_b32 v28, 16, v28
    v_mul_f32 v28, s26, v28
    v_exp_f32 v28, v28
    s_nop 0
    v_cvt_pk_bf16_f32 v28, v28, v28
    v_and_b32 v28, 0xffff0000, v28
    v_mul_f32 v28, v28, v32
    v_mul_f32 v28, s26, v28
    v_sub_f32 v28, 0, v28
    v_lshlrev_b32 v29, 16, v29
    v_mul_f32 v29, v29, v32
    v_mul_f32 v29, s27, v29
    v_lshlrev_b32 v30, 16, v30
    v_mul_f32 v30, v30, v33
    v_lshlrev_b32 v31, 16, v31
    v_mul_f32 v31, v31, v33
    v_cvt_f32_u32 v47, v2
    v_mul_f32 v44, 0x41800000, v47
    v_and_b32 v5, 7, v2
    v_add_u32 v5, 8, v5
    v_cvt_f32_u32 v5, v5
    v_mul_f32 v45, 0x42000000, v5
    v_mul_f32 v6, 0x42800000, v5
    v_cmp_lt_u32 vcc, 7, v2
    s_nop 1
    v_cndmask_b32 v45, v45, v6, vcc
    v_add_f32 v5, 0x41000000, v47
    v_mul_f32 v46, 0x43000000, v5
    v_mov_b32 v48, 0
    v_mov_b32 v49, 0
    v_mov_b32 v50, 0
    v_mov_b32 v51, 0
    v_mov_b32 v52, 0
    v_mov_b32 v53, 0
    v_mov_b32 v54, 0
    v_mov_b32 v55, 0
    v_mov_b32 v56, 0
    v_mov_b32 v57, 0
    v_mov_b32 v58, 0
    v_mov_b32 v59, 0
    v_mov_b32 v60, 0
    v_mov_b32 v61, 0
    v_mov_b32 v62, 0
    v_mov_b32 v63, 0
    s_mov_b32 s25, 8
    s_nop 0
ss_kg:
    v_mov_b32_dpp v64, v24 row_newbcast:0 row_mask:0xf bank_mask:0xf
    v_mov_b32_dpp v65, v25 row_newbcast:0 row_mask:0xf bank_mask:0xf
    v_mov_b32_dpp v66, v26 row_newbcast:0 row_mask:0xf bank_mask:0xf
    v_mov_b32_dpp v67, v27 row_newbcast:0 row_mask:0xf bank_mask:0xf
    v_mul_f32 v82, v64, v47
    v_mul_f32 v83, v65, v47
    v_mul_f32 v84, v64, v45
    v_mul_f32 v85, v65, v45
    v_exp_f32 v82, v82
    v_fract_f32 v83, v83
    v_exp_f32 v84, v84
    v_fract_f32 v85, v85
    v_cos_f32 v74, v83
    v_sin_f32 v75, v83
    v_cos_f32 v70, v85
    v_sin_f32 v71, v85
    v_mul_f32 v74, v74, v82
    v_mul_f32 v75, v75, v82
    v_mul_f32 v70, v70, v84
    v_mul_f32 v71, v71, v84
    v_mul_f32 v82, v75, v75
    v_add_f32 v83, v74, v74
    v_fma_f32 v76, v74, v74, -v82
    v_mul_f32 v77, v83, v75
    v_mul_f32 v82, v77, v77
    v_add_f32 v83, v76, v76
    v_fma_f32 v78, v76, v76, -v82
    v_mul_f32 v79, v83, v77
    v_mul_f32 v82, v79, v79
    v_add_f32 v83, v78, v78
    v_fma_f32 v80, v78, v78, -v82
    v_mul_f32 v81, v83, v79
    v_mul_f32 v82, v81, v81
    v_add_f32 v83, v80, v80
    v_fma_f32 v68, v80, v80, -v82
    v_mul_f32 v69, v83, v81
    v_mul_f32 v84, v71, v71
    v_add_f32 v85, v70, v70
    v_fma_f32 v86, v70, v70, -v84
    v_mul_f32 v87, v85, v71
    v_mul_f32 v84, v87, v87
    v_add_f32 v85, v86, v86
    v_fma_f32 v72, v86, v86, -v84
    v_mul_f32 v73, v85, v87
    v_cvt_pk_bf16_f32 v108, v74, v75
    v_cvt_pk_bf16_f32 v112, v76, v77
    v_cvt_pk_bf16_f32 v116, v78, v79
    v_cvt_pk_bf16_f32 v120, v80, v81
    v_mul_f32 v84, v67, v69
    v_mul_f32 v85, v67, v68
    v_fma_f32 v68, v66, v68, -v84
    v_fma_f32 v69, -v66, v69, -v85
    v_cvt_pk_bf16_f32 v96, v68, v69
    v_mul_f32 v84, v67, v71
    v_mul_f32 v85, v67, v70
    v_fma_f32 v70, v66, v70, -v84
    v_fma_f32 v71, -v66, v71, -v85
    v_cvt_pk_bf16_f32 v100, v70, v71
    v_mul_f32 v84, v67, v73
    v_mul_f32 v85, v67, v72
    v_fma_f32 v72, v66, v72, -v84
    v_fma_f32 v73, -v66, v73, -v85
    v_cvt_pk_bf16_f32 v104, v72, v73
    v_mov_b32_dpp v64, v28 row_newbcast:0 row_mask:0xf bank_mask:0xf
    v_mov_b32_dpp v65, v29 row_newbcast:0 row_mask:0xf bank_mask:0xf
    v_mov_b32_dpp v66, v30 row_newbcast:0 row_mask:0xf bank_mask:0xf
    v_mov_b32_dpp v67, v31 row_newbcast:0 row_mask:0xf bank_mask:0xf
    v_mul_f32 v82, v64, v47
    v_mul_f32 v83, v65, v47
    v_mul_f32 v84, v64, v45
    v_mul_f32 v85, v65, v45
    v_exp_f32 v82, v82
    v_fract_f32 v83, v83
    v_exp_f32 v84, v84
    v_fract_f32 v85, v85
    v_cos_f32 v74, v83
    v_sin_f32 v75, v83
    v_cos_f32 v70, v85
    v_sin_f32 v71, v85
    v_mul_f32 v74, v74, v82
    v_mul_f32 v75, v75, v82
    v_mul_f32 v70, v70, v84
    v_mul_f32 v71, v71, v84
    v_mul_f32 v82, v75, v75
    v_add_f32 v83, v74, v74
    v_fma_f32 v76, v74, v74, -v82
    v_mul_f32 v77, v83, v75
    v_mul_f32 v82, v77, v77
    v_add_f32 v83, v76, v76
    v_fma_f32 v78, v76, v76, -v82
    v_mul_f32 v79, v83, v77
    v_mul_f32 v82, v79, v79
    v_add_f32 v83, v78, v78
    v_fma_f32 v80, v78, v78, -v82
    v_mul_f32 v81, v83, v79
    v_mul_f32 v82, v81, v81
    v_add_f32 v83, v80, v80
    v_fma_f32 v68, v80, v80, -v82
    v_mul_f32 v69, v83, v81
    v_mul_f32 v84, v71, v71
    v_add_f32 v85, v70, v70
    v_fma_f32 v86, v70, v70, -v84
    v_mul_f32 v87, v85, v71
    v_mul_f32 v84, v87, v87
    v_add_f32 v85, v86, v86
    v_fma_f32 v72, v86, v86, -v84
    v_mul_f32 v73, v85, v87
    v_cvt_pk_bf16_f32 v109, v74, v75
    v_cvt_pk_bf16_f32 v113, v76, v77
    v_cvt_pk_bf16_f32 v117, v78, v79
    v_cvt_pk_bf16_f32 v121, v80, v81
    v_mul_f32 v84, v67, v69
    v_mul_f32 v85, v67, v68
    v_fma_f32 v68, v66, v68, -v84
    v_fma_f32 v69, -v66, v69, -v85
    v_cvt_pk_bf16_f32 v97, v68, v69
    v_mul_f32 v84, v67, v71
    v_mul_f32 v85, v67, v70
    v_fma_f32 v70, v66, v70, -v84
    v_fma_f32 v71, -v66, v71, -v85
    v_cvt_pk_bf16_f32 v101, v70, v71
    v_mul_f32 v84, v67, v73
    v_mul_f32 v85, v67, v72
    v_fma_f32 v72, v66, v72, -v84
    v_fma_f32 v73, -v66, v73, -v85
    v_cvt_pk_bf16_f32 v105, v72, v73
    v_mov_b32_dpp v64, v24 row_newbcast:1 row_mask:0xf bank_mask:0xf
    v_mov_b32_dpp v65, v25 row_newbcast:1 row_mask:0xf bank_mask:0xf
    v_mov_b32_dpp v66, v26 row_newbcast:1 row_mask:0xf bank_mask:0xf
    v_mov_b32_dpp v67, v27 row_newbcast:1 row_mask:0xf bank_mask:0xf
    v_mul_f32 v82, v64, v47
    v_mul_f32 v83, v65, v47
    v_mul_f32 v84, v64, v45
    v_mul_f32 v85, v65, v45
    v_exp_f32 v82, v82
    v_fract_f32 v83, v83
    v_exp_f32 v84, v84
    v_fract_f32 v85, v85
    v_cos_f32 v74, v83
    v_sin_f32 v75, v83
    v_cos_f32 v70, v85
    v_sin_f32 v71, v85
    v_mov_b32_dpp v24, v24 row_ror:2 row_mask:0xf bank_mask:0xf
    v_mov_b32_dpp v25, v25 row_ror:2 row_mask:0xf bank_mask:0xf
    v_mov_b32_dpp v26, v26 row_ror:2 row_mask:0xf bank_mask:0xf
    v_mov_b32_dpp v27, v27 row_ror:2 row_mask:0xf bank_mask:0xf
    v_mul_f32 v74, v74, v82
    v_mul_f32 v75, v75, v82
    v_mul_f32 v70, v70, v84
    v_mul_f32 v71, v71, v84
    v_mul_f32 v82, v75, v75
    v_add_f32 v83, v74, v74
    v_fma_f32 v76, v74, v74, -v82
    v_mul_f32 v77, v83, v75
    v_mul_f32 v82, v77, v77
    v_add_f32 v83, v76, v76
    v_fma_f32 v78, v76, v76, -v82
    v_mul_f32 v79, v83, v77
    v_mul_f32 v82, v79, v79
    v_add_f32 v83, v78, v78
    v_fma_f32 v80, v78, v78, -v82
    v_mul_f32 v81, v83, v79
    v_mul_f32 v82, v81, v81
    v_add_f32 v83, v80, v80
    v_fma_f32 v68, v80, v80, -v82
    v_mul_f32 v69, v83, v81
    v_mul_f32 v84, v71, v71
    v_add_f32 v85, v70, v70
    v_fma_f32 v86, v70, v70, -v84
    v_mul_f32 v87, v85, v71
    v_mul_f32 v84, v87, v87
    v_add_f32 v85, v86, v86
    v_fma_f32 v72, v86, v86, -v84
    v_mul_f32 v73, v85, v87
    v_cvt_pk_bf16_f32 v110, v74, v75
    v_cvt_pk_bf16_f32 v114, v76, v77
    v_cvt_pk_bf16_f32 v118, v78, v79
    v_cvt_pk_bf16_f32 v122, v80, v81
    v_mul_f32 v84, v67, v69
    v_mul_f32 v85, v67, v68
    v_fma_f32 v68, v66, v68, -v84
    v_fma_f32 v69, -v66, v69, -v85
    v_cvt_pk_bf16_f32 v98, v68, v69
    v_mul_f32 v84, v67, v71
    v_mul_f32 v85, v67, v70
    v_fma_f32 v70, v66, v70, -v84
    v_fma_f32 v71, -v66, v71, -v85
    v_cvt_pk_bf16_f32 v102, v70, v71
    v_mul_f32 v84, v67, v73
    v_mul_f32 v85, v67, v72
    v_fma_f32 v72, v66, v72, -v84
    v_fma_f32 v73, -v66, v73, -v85
    v_cvt_pk_bf16_f32 v106, v72, v73
    v_mov_b32_dpp v64, v28 row_newbcast:1 row_mask:0xf bank_mask:0xf
    v_mov_b32_dpp v65, v29 row_newbcast:1 row_mask:0xf bank_mask:0xf
    v_mov_b32_dpp v66, v30 row_newbcast:1 row_mask:0xf bank_mask:0xf
    v_mov_b32_dpp v67, v31 row_newbcast:1 row_mask:0xf bank_mask:0xf
    v_mul_f32 v82, v64, v47
    v_mul_f32 v83, v65, v47
    v_mul_f32 v84, v64, v45
    v_mul_f32 v85, v65, v45
    v_exp_f32 v82, v82
    v_fract_f32 v83, v83
    v_exp_f32 v84, v84
    v_fract_f32 v85, v85
    v_cos_f32 v74, v83
    v_sin_f32 v75, v83
    v_cos_f32 v70, v85
    v_sin_f32 v71, v85
    v_mov_b32_dpp v28, v28 row_ror:2 row_mask:0xf bank_mask:0xf
    v_mov_b32_dpp v29, v29 row_ror:2 row_mask:0xf bank_mask:0xf
    v_mov_b32_dpp v30, v30 row_ror:2 row_mask:0xf bank_mask:0xf
    v_mov_b32_dpp v31, v31 row_ror:2 row_mask:0xf bank_mask:0xf
    v_mul_f32 v74, v74, v82
    v_mul_f32 v75, v75, v82
    v_mul_f32 v70, v70, v84
    v_mul_f32 v71, v71, v84
    v_mul_f32 v82, v75, v75
    v_add_f32 v83, v74, v74
    v_fma_f32 v76, v74, v74, -v82
    v_mul_f32 v77, v83, v75
    v_mul_f32 v82, v77, v77
    v_add_f32 v83, v76, v76
    v_fma_f32 v78, v76, v76, -v82
    v_mul_f32 v79, v83, v77
    v_mul_f32 v82, v79, v79
    v_add_f32 v83, v78, v78
    v_fma_f32 v80, v78, v78, -v82
    v_mul_f32 v81, v83, v79
    v_mul_f32 v82, v81, v81
    v_add_f32 v83, v80, v80
    v_fma_f32 v68, v80, v80, -v82
    v_mul_f32 v69, v83, v81
    v_mul_f32 v84, v71, v71
    v_add_f32 v85, v70, v70
    v_fma_f32 v86, v70, v70, -v84
    v_mul_f32 v87, v85, v71
    v_mul_f32 v84, v87, v87
    v_add_f32 v85, v86, v86
    v_fma_f32 v72, v86, v86, -v84
    v_mul_f32 v73, v85, v87
    v_cvt_pk_bf16_f32 v111, v74, v75
    v_cvt_pk_bf16_f32 v115, v76, v77
    v_cvt_pk_bf16_f32 v119, v78, v79
    v_cvt_pk_bf16_f32 v123, v80, v81
    v_mul_f32 v84, v67, v69
    v_mul_f32 v85, v67, v68
    v_fma_f32 v68, v66, v68, -v84
    v_fma_f32 v69, -v66, v69, -v85
    v_cvt_pk_bf16_f32 v99, v68, v69
    v_mul_f32 v84, v67, v71
    v_mul_f32 v85, v67, v70
    v_fma_f32 v70, v66, v70, -v84
    v_fma_f32 v71, -v66, v71, -v85
    v_cvt_pk_bf16_f32 v103, v70, v71
    v_mul_f32 v84, v67, v73
    v_mul_f32 v85, v67, v72
    v_fma_f32 v72, v66, v72, -v84
    v_fma_f32 v73, -v66, v73, -v85
    v_cvt_pk_bf16_f32 v107, v72, v73
    v_mfma_f32_16x16x32_bf16 v[48:51], v[96:99], v[108:111], v[48:51]
    v_mfma_f32_16x16x32_bf16 v[52:55], v[100:103], v[112:115], v[52:55]
    v_mfma_f32_16x16x32_bf16 v[56:59], v[100:103], v[116:119], v[56:59]
    v_mfma_f32_16x16x32_bf16 v[60:63], v[104:107], v[120:123], v[60:63]
    s_sub_u32 s25, s25, 1
    s_cmp_lg_u32 s25, 0
    s_cbranch_scc1 ss_kg
    s_waitcnt vmcnt(0)
    v_mov_b32 v36, 0x05040100
    v_mov_b32 v37, 0x07060302
    v_lshlrev_b32 v6, 4, v0
    v_perm_b32 v40, v10, v8, v36
    v_perm_b32 v41, v14, v12, v36
    v_perm_b32 v42, v18, v16, v36
    v_perm_b32 v43, v22, v20, v36
    ds_write_b128 v6, v[40:43] offset:512
    s_nop 1
    v_perm_b32 v40, v10, v8, v37
    v_perm_b32 v41, v14, v12, v37
    v_perm_b32 v42, v18, v16, v37
    v_perm_b32 v43, v22, v20, v37
    ds_write_b128 v6, v[40:43] offset:16896
    s_nop 1
    v_perm_b32 v40, v11, v9, v36
    v_perm_b32 v41, v15, v13, v36
    v_perm_b32 v42, v19, v17, v36
    v_perm_b32 v43, v23, v21, v36
    ds_write_b128 v6, v[40:43] offset:33280
    s_nop 1
    v_perm_b32 v40, v11, v9, v37
    v_perm_b32 v41, v15, v13, v37
    v_perm_b32 v42, v19, v17, v37
    v_perm_b32 v43, v23, v21, v37
    ds_write_b128 v6, v[40:43] offset:49664
    s_nop 1
    v_lshlrev_b32 v5, 8, v3
    v_lshl_add_u32 v5, v2, 2, v5
    v_add_u32 v5, v5, v4
    ds_write_b32 v5, v48 offset:4608
    ds_write_b32 v5, v49 offset:4672
    ds_write_b32 v5, v50 offset:4736
    ds_write_b32 v5, v51 offset:4800
    v_cmp_gt_u32 vcc, 2, v3
    s_nop 0
    s_mov_b64 exec, vcc
    ds_write_b32 v5, v52 offset:5632
    ds_write_b32 v5, v53 offset:5696
    ds_write_b32 v5, v54 offset:5760
    ds_write_b32 v5, v55 offset:5824
    ds_write_b32 v5, v60 offset:6656
    ds_write_b32 v5, v61 offset:6720
    ds_write_b32 v5, v62 offset:6784
    ds_write_b32 v5, v63 offset:6848
    s_not_b64 exec, exec
    ds_write_b32 v5, v56 offset:5632
    ds_write_b32 v5, v57 offset:5696
    ds_write_b32 v5, v58 offset:5760
    ds_write_b32 v5, v59 offset:5824
    s_mov_b32 exec_lo, 0
    s_mov_b32 exec_hi, 3
    v_cmp_eq_u32 vcc, 0, v2
    s_nop 1
    v_cndmask_b32 v6, 0, v60, vcc
    ds_write_b32 v5, v6 offset:6656
    s_mov_b64 exec, -1
    s_waitcnt lgkmcnt(0)
    v_lshlrev_b32 v7, 1, v1
    v_sub_u32 v7, 2065, v7
    v_lshl_add_u32 v64, v1, 2, v4
    v_mov_b32 v65, 641
    s_mov_b32 s25, 17
ss_exp:
    v_subrev_u32 v66, 0, v7
    v_cvt_f32_u32 v70, v66
    v_cvt_pk_bf16_f32 v70, v70, v70
    v_and_b32 v70, 0xffff, v70
    v_subrev_u32 v70, 0x4280, v70
    v_cmp_gt_u32 vcc, 256, v66
    s_nop 1
    v_cndmask_b32 v70, v70, v66, vcc
    v_cmp_gt_u32 vcc, 2048, v66
    s_nop 1
    v_cndmask_b32 v70, v65, v70, vcc
    v_lshl_add_u32 v70, v70, 2, v4
    ds_read_b32 v74, v70 offset:4608
    v_subrev_u32 v67, 1, v7
    v_cvt_f32_u32 v71, v67
    v_cvt_pk_bf16_f32 v71, v71, v71
    v_and_b32 v71, 0xffff, v71
    v_subrev_u32 v71, 0x4280, v71
    v_cmp_gt_u32 vcc, 256, v67
    s_nop 1
    v_cndmask_b32 v71, v71, v67, vcc
    v_cmp_gt_u32 vcc, 2048, v67
    s_nop 1
    v_cndmask_b32 v71, v65, v71, vcc
    v_lshl_add_u32 v71, v71, 2, v4
    ds_read_b32 v75, v71 offset:4608
    v_subrev_u32 v68, 2, v7
    v_cvt_f32_u32 v72, v68
    v_cvt_pk_bf16_f32 v72, v72, v72
    v_and_b32 v72, 0xffff, v72
    v_subrev_u32 v72, 0x4280, v72
    v_cmp_gt_u32 vcc, 256, v68
    s_nop 1
    v_cndmask_b32 v72, v72, v68, vcc
    v_cmp_gt_u32 vcc, 2048, v68
    s_nop 1
    v_cndmask_b32 v72, v65, v72, vcc
    v_lshl_add_u32 v72, v72, 2, v4
    ds_read_b32 v76, v72 offset:4608
    s_waitcnt lgkmcnt(0)
    v_cvt_pk_bf16_f32 v78, v75, v76
    v_cvt_pk_bf16_f32 v79, v74, v75
    ds_write_b32 v64, v78 offset:7424
    ds_write_b32 v64, v79 offset:11776
    v_subrev_u32 v7, 128, v7
    v_add_u32 v64, 256, v64
    s_sub_u32 s25, s25, 1
    s_cmp_lg_u32 s25, 0
    s_cbranch_scc1 ss_exp
    s_waitcnt lgkmcnt(0)
    s_barrier
    v_and_b32 v5, 1, v2
    v_mul_u32_u24 v64, 4352, v5
    v_sub_u32 v5, v5, v2
    v_lshl_add_u32 v5, v3, 3, v5
    v_lshl_add_u32 v64, v5, 1, v64
    v_add_u32 v64, 11520, v64
    v_add_u32 v64, v64, v4
    v_lshlrev_b32 v65, 5, v2
    v_lshl_add_u32 v65, v3, 4, v65
    v_add_u32 v65, 480, v65
    v_add_u32 v65, v65, v4
    v_mov_b32 v96, 0
    v_mov_b32 v97, 0
    v_mov_b32 v98, 0
    v_mov_b32 v99, 0
    v_mov_b32 v100, 0
    v_mov_b32 v101, 0
    v_mov_b32 v102, 0
    v_mov_b32 v103, 0
    v_mov_b32 v104, 0
    v_mov_b32 v105, 0
    v_mov_b32 v106, 0
    v_mov_b32 v107, 0
    v_mov_b32 v108, 0
    v_mov_b32 v109, 0
    v_mov_b32 v110, 0
    v_mov_b32 v111, 0
    v_mov_b32 v112, 0
    v_mov_b32 v113, 0
    v_mov_b32 v114, 0
    v_mov_b32 v115, 0
    v_mov_b32 v116, 0
    v_mov_b32 v117, 0
    v_mov_b32 v118, 0
    v_mov_b32 v119, 0
    v_mov_b32 v120, 0
    v_mov_b32 v121, 0
    v_mov_b32 v122, 0
    v_mov_b32 v123, 0
    v_mov_b32 v124, 0
    v_mov_b32 v125, 0
    v_mov_b32 v126, 0
    v_mov_b32 v127, 0
    v_subrev_u32 v66, 512, v64
    v_subrev_u32 v67, 1536, v64
    v_subrev_u32 v68, 2560, v64
    v_subrev_u32 v69, 3584, v64
    s_mov_b32 s25, 8
    s_nop 0
ss_cv:
    ds_read2_b32 v[160:161], v66 offset0:128 offset1:129
    ds_read2_b32 v[162:163], v66 offset0:130 offset1:131
    ds_read_b128 v[128:131], v65 offset:0
    ds_read_b128 v[132:135], v65 offset:512
    ds_read_b128 v[136:139], v65 offset:1024
    ds_read_b128 v[140:143], v65 offset:1536
    ds_read_b128 v[144:147], v65 offset:2048
    ds_read_b128 v[148:151], v65 offset:2560
    ds_read_b128 v[152:155], v65 offset:3072
    ds_read_b128 v[156:159], v65 offset:3584
    ds_read2_b32 v[164:165], v66 offset0:0 offset1:1
    ds_read2_b32 v[166:167], v66 offset0:2 offset1:3
    s_waitcnt lgkmcnt(9)
    v_mfma_f32_16x16x32_bf16 v[96:99], v[160:163], v[128:131], v[96:99]
    s_waitcnt lgkmcnt(8)
    v_mfma_f32_16x16x32_bf16 v[100:103], v[160:163], v[132:135], v[100:103]
    s_waitcnt lgkmcnt(7)
    v_mfma_f32_16x16x32_bf16 v[104:107], v[160:163], v[136:139], v[104:107]
    ds_read2_b32 v[168:169], v67 offset0:128 offset1:129
    ds_read2_b32 v[170:171], v67 offset0:130 offset1:131
    s_waitcnt lgkmcnt(8)
    v_mfma_f32_16x16x32_bf16 v[108:111], v[160:163], v[140:143], v[108:111]
    s_waitcnt lgkmcnt(7)
    v_mfma_f32_16x16x32_bf16 v[112:115], v[160:163], v[144:147], v[112:115]
    ds_read2_b32 v[172:173], v67 offset0:0 offset1:1
    ds_read2_b32 v[174:175], v67 offset0:2 offset1:3
    s_waitcnt lgkmcnt(8)
    v_mfma_f32_16x16x32_bf16 v[116:119], v[160:163], v[148:151], v[116:119]
    s_waitcnt lgkmcnt(7)
    v_mfma_f32_16x16x32_bf16 v[120:123], v[160:163], v[152:155], v[120:123]
    ds_read2_b32 v[176:177], v68 offset0:128 offset1:129
    ds_read2_b32 v[178:179], v68 offset0:130 offset1:131
    s_waitcnt lgkmcnt(8)
    v_mfma_f32_16x16x32_bf16 v[124:127], v[160:163], v[156:159], v[124:127]
    s_waitcnt lgkmcnt(6)
    v_mfma_f32_16x16x32_bf16 v[100:103], v[164:167], v[128:131], v[100:103]
    v_mfma_f32_16x16x32_bf16 v[104:107], v[164:167], v[132:135], v[104:107]
    ds_read2_b32 v[180:181], v68 offset0:0 offset1:1
    ds_read2_b32 v[182:183], v68 offset0:2 offset1:3
    v_mfma_f32_16x16x32_bf16 v[108:111], v[164:167], v[136:139], v[108:111]
    v_mfma_f32_16x16x32_bf16 v[112:115], v[164:167], v[140:143], v[112:115]
    ds_read2_b32 v[184:185], v69 offset0:128 offset1:129
    ds_read2_b32 v[186:187], v69 offset0:130 offset1:131
    v_mfma_f32_16x16x32_bf16 v[116:119], v[164:167], v[144:147], v[116:119]
    v_mfma_f32_16x16x32_bf16 v[120:123], v[164:167], v[148:151], v[120:123]
    ds_read2_b32 v[188:189], v69 offset0:0 offset1:1
    ds_read2_b32 v[190:191], v69 offset0:2 offset1:3
    v_mfma_f32_16x16x32_bf16 v[124:127], v[164:167], v[152:155], v[124:127]
    s_waitcnt lgkmcnt(10)
    v_mfma_f32_16x16x32_bf16 v[104:107], v[168:171], v[128:131], v[104:107]
    v_mfma_f32_16x16x32_bf16 v[108:111], v[168:171], v[132:135], v[108:111]
    v_mfma_f32_16x16x32_bf16 v[112:115], v[168:171], v[136:139], v[112:115]
    v_mfma_f32_16x16x32_bf16 v[116:119], v[168:171], v[140:143], v[116:119]
    v_mfma_f32_16x16x32_bf16 v[120:123], v[168:171], v[144:147], v[120:123]
    v_mfma_f32_16x16x32_bf16 v[124:127], v[168:171], v[148:151], v[124:127]
    s_waitcnt lgkmcnt(8)
    v_mfma_f32_16x16x32_bf16 v[108:111], v[172:175], v[128:131], v[108:111]
    v_subrev_u32 v66, 64, v66
    v_mfma_f32_16x16x32_bf16 v[112:115], v[172:175], v[132:135], v[112:115]
    v_subrev_u32 v67, 64, v67
    v_mfma_f32_16x16x32_bf16 v[116:119], v[172:175], v[136:139], v[116:119]
    v_subrev_u32 v68, 64, v68
    v_mfma_f32_16x16x32_bf16 v[120:123], v[172:175], v[140:143], v[120:123]
    v_subrev_u32 v69, 64, v69
    v_mfma_f32_16x16x32_bf16 v[124:127], v[172:175], v[144:147], v[124:127]
    v_subrev_u32 v65, 64, v65
    s_waitcnt lgkmcnt(6)
    v_mfma_f32_16x16x32_bf16 v[112:115], v[176:179], v[128:131], v[112:115]
    v_mfma_f32_16x16x32_bf16 v[116:119], v[176:179], v[132:135], v[116:119]
    v_mfma_f32_16x16x32_bf16 v[120:123], v[176:179], v[136:139], v[120:123]
    v_mfma_f32_16x16x32_bf16 v[124:127], v[176:179], v[140:143], v[124:127]
    s_waitcnt lgkmcnt(4)
    v_mfma_f32_16x16x32_bf16 v[116:119], v[180:183], v[128:131], v[116:119]
    v_mfma_f32_16x16x32_bf16 v[120:123], v[180:183], v[132:135], v[120:123]
    v_mfma_f32_16x16x32_bf16 v[124:127], v[180:183], v[136:139], v[124:127]
    s_waitcnt lgkmcnt(2)
    v_mfma_f32_16x16x32_bf16 v[120:123], v[184:187], v[128:131], v[120:123]
    v_mfma_f32_16x16x32_bf16 v[124:127], v[184:187], v[132:135], v[124:127]
    s_waitcnt lgkmcnt(0)
    v_mfma_f32_16x16x32_bf16 v[124:127], v[188:191], v[128:131], v[124:127]
    s_sub_u32 s25, s25, 1
    s_cmp_lg_u32 s25, 0
    s_cbranch_scc1 ss_cv
    s_nop 4
    v_lshlrev_b32 v5, 6, v2
    v_lshl_add_u32 v5, v3, 4, v5
    v_add_u32 v5, v5, v4
    ds_write_b128 v5, v[96:99] offset:7424
    ds_write_b128 v5, v[100:103] offset:8448
    ds_write_b128 v5, v[104:107] offset:9472
    ds_write_b128 v5, v[108:111] offset:10496
    ds_write_b128 v5, v[112:115] offset:11520
    ds_write_b128 v5, v[116:119] offset:12544
    ds_write_b128 v5, v[120:123] offset:13568
    ds_write_b128 v5, v[124:127] offset:14592
    s_mov_b32 s12, s74
    s_mov_b32 s13, s75
    s_mov_b32 s14, 1152
    s_mov_b32 s15, 0x20000
    s_lshl_b32 s23, s20, 1
    buffer_load_dwordx2 v[24:25], off, s[12:15], s23
    s_waitcnt vmcnt(0) lgkmcnt(0)
    s_barrier
    v_lshlrev_b32 v26, 16, v24
    v_and_b32 v27, 0xffff0000, v24
    v_lshlrev_b32 v28, 16, v25
    v_and_b32 v29, 0xffff0000, v25
    v_lshlrev_b32 v5, 5, v0
    ds_read_b128 v[64:67], v5 offset:7424
    ds_read_b128 v[68:71], v5 offset:7440
    ds_read_b128 v[72:75], v5 offset:23808
    ds_read_b128 v[76:79], v5 offset:23824
    ds_read_b128 v[80:83], v5 offset:40192
    ds_read_b128 v[84:87], v5 offset:40208
    ds_read_b128 v[88:91], v5 offset:56576
    ds_read_b128 v[92:95], v5 offset:56592
    s_waitcnt lgkmcnt(0)
    v_mul_u32_u24 v5, 18432, v0
    s_lshl_b32 s22, s20, 1
    s_add_u32 s22, s22, 1152
    v_lshlrev_b32 v6, 16, v8
    v_fmac_f32 v64, v6, v26
    v_and_b32 v6, 0xffff0000, v8
    v_fmac_f32 v72, v6, v27
    v_lshlrev_b32 v6, 16, v9
    v_fmac_f32 v80, v6, v28
    v_and_b32 v6, 0xffff0000, v9
    v_fmac_f32 v88, v6, v29
    v_cvt_pk_bf16_f32 v8, v64, v72
    v_cvt_pk_bf16_f32 v9, v80, v88
    s_add_u32 s23, s22, 0
    buffer_store_dwordx2 v[8:9], v5, s[16:19], s23 offen
    v_lshlrev_b32 v6, 16, v10
    v_fmac_f32 v65, v6, v26
    v_and_b32 v6, 0xffff0000, v10
    v_fmac_f32 v73, v6, v27
    v_lshlrev_b32 v6, 16, v11
    v_fmac_f32 v81, v6, v28
    v_and_b32 v6, 0xffff0000, v11
    v_fmac_f32 v89, v6, v29
    v_cvt_pk_bf16_f32 v10, v65, v73
    v_cvt_pk_bf16_f32 v11, v81, v89
    s_add_u32 s23, s22, 2304
    buffer_store_dwordx2 v[10:11], v5, s[16:19], s23 offen
    v_lshlrev_b32 v6, 16, v12
    v_fmac_f32 v66, v6, v26
    v_and_b32 v6, 0xffff0000, v12
    v_fmac_f32 v74, v6, v27
    v_lshlrev_b32 v6, 16, v13
    v_fmac_f32 v82, v6, v28
    v_and_b32 v6, 0xffff0000, v13
    v_fmac_f32 v90, v6, v29
    v_cvt_pk_bf16_f32 v12, v66, v74
    v_cvt_pk_bf16_f32 v13, v82, v90
    s_add_u32 s23, s22, 4608
    buffer_store_dwordx2 v[12:13], v5, s[16:19], s23 offen
    v_lshlrev_b32 v6, 16, v14
    v_fmac_f32 v67, v6, v26
    v_and_b32 v6, 0xffff0000, v14
    v_fmac_f32 v75, v6, v27
    v_lshlrev_b32 v6, 16, v15
    v_fmac_f32 v83, v6, v28
    v_and_b32 v6, 0xffff0000, v15
    v_fmac_f32 v91, v6, v29
    v_cvt_pk_bf16_f32 v14, v67, v75
    v_cvt_pk_bf16_f32 v15, v83, v91
    s_add_u32 s23, s22, 6912
    buffer_store_dwordx2 v[14:15], v5, s[16:19], s23 offen
    v_lshlrev_b32 v6, 16, v16
    v_fmac_f32 v68, v6, v26
    v_and_b32 v6, 0xffff0000, v16
    v_fmac_f32 v76, v6, v27
    v_lshlrev_b32 v6, 16, v17
    v_fmac_f32 v84, v6, v28
    v_and_b32 v6, 0xffff0000, v17
    v_fmac_f32 v92, v6, v29
    v_cvt_pk_bf16_f32 v16, v68, v76
    v_cvt_pk_bf16_f32 v17, v84, v92
    s_add_u32 s23, s22, 9216
    buffer_store_dwordx2 v[16:17], v5, s[16:19], s23 offen
    v_lshlrev_b32 v6, 16, v18
    v_fmac_f32 v69, v6, v26
    v_and_b32 v6, 0xffff0000, v18
    v_fmac_f32 v77, v6, v27
    v_lshlrev_b32 v6, 16, v19
    v_fmac_f32 v85, v6, v28
    v_and_b32 v6, 0xffff0000, v19
    v_fmac_f32 v93, v6, v29
    v_cvt_pk_bf16_f32 v18, v69, v77
    v_cvt_pk_bf16_f32 v19, v85, v93
    s_add_u32 s23, s22, 11520
    buffer_store_dwordx2 v[18:19], v5, s[16:19], s23 offen
    v_lshlrev_b32 v6, 16, v20
    v_fmac_f32 v70, v6, v26
    v_and_b32 v6, 0xffff0000, v20
    v_fmac_f32 v78, v6, v27
    v_lshlrev_b32 v6, 16, v21
    v_fmac_f32 v86, v6, v28
    v_and_b32 v6, 0xffff0000, v21
    v_fmac_f32 v94, v6, v29
    v_cvt_pk_bf16_f32 v20, v70, v78
    v_cvt_pk_bf16_f32 v21, v86, v94
    s_add_u32 s23, s22, 13824
    buffer_store_dwordx2 v[20:21], v5, s[16:19], s23 offen
    v_lshlrev_b32 v6, 16, v22
    v_fmac_f32 v71, v6, v26
    v_and_b32 v6, 0xffff0000, v22
    v_fmac_f32 v79, v6, v27
    v_lshlrev_b32 v6, 16, v23
    v_fmac_f32 v87, v6, v28
    v_and_b32 v6, 0xffff0000, v23
    v_fmac_f32 v95, v6, v29
    v_cvt_pk_bf16_f32 v22, v71, v79
    v_cvt_pk_bf16_f32 v23, v87, v95
    s_add_u32 s23, s22, 16128
    buffer_store_dwordx2 v[22:23], v5, s[16:19], s23 offen
    s_cmp_ge_u32 s20, 448
    s_cbranch_scc1 L_exit
    s_branch L_ssm_next
L_phase2:
    v_and_b32 v1, 63, v0
    v_min_u32 v1, 6, v1
    v_lshlrev_b32 v2, 2, v1
    s_cmp_lg_u32 s32, 0
    v_mov_b32 v251, 163832
    s_cbranch_scc1 sw10
    buffer_load_dword v3, v2, s[96:99], 0 offen offset:32 sc1
    v_mov_b32 v4, 32
    s_waitcnt vmcnt(0)
    v_cmp_lt_u32 vcc, v3, v4
    s_nop 0
    s_ff1_i32_b64 s40, vcc
    v_mov_b32 v250, s40
    ds_write_b32 v251, v250
    s_waitcnt lgkmcnt(0)
sw10:
    s_barrier
    ds_read_b32 v252, v251
    s_waitcnt lgkmcnt(0)
    v_readfirstlane_b32 s33, v252
    s_barrier
    s_nop 1
    s_cmp_lt_u32 s33, 7
    s_cbranch_scc1 L_pool
    s_mov_b32 s88, 4194304
gn11:
    s_cmp_lg_u32 s95, 0
    s_cbranch_scc1 gn11x
    buffer_load_dword v250, off, s[96:99], 0 offset:64 sc1
    s_sub_u32 s88, s88, 1
    s_cbranch_scc1 gn11x
    s_waitcnt vmcnt(0)
    v_readfirstlane_b32 s95, v250
    s_nop 1
    s_branch gn11
gn11x:
    s_mov_b32 s40, 524288
mc2_w:
    buffer_load_dword v250, off, s[96:99], 0 offset:140 sc1
    s_waitcnt vmcnt(0)
    v_readfirstlane_b32 s41, v250
    s_nop 0
    s_cmp_lg_u32 s41, 0
    s_cbranch_scc1 mc2_known
    s_sub_u32 s40, s40, 1
    s_cbranch_scc1 mc2_force
    s_sleep 2
    s_branch mc2_w
mc2_force:
    v_mov_b32 v250, 2
    v_mov_b32 v251, 0
    s_mov_b64 exec, 1
    buffer_atomic_cmpswap v[250:251], off, s[96:99], 0 offset:140
    s_mov_b64 exec, -1
    s_waitcnt vmcnt(0)
    s_mov_b32 s40, 524288
    s_branch mc2_w
mc2_known:
    s_cmp_eq_u32 s41, 1
    s_cbranch_scc1 L_phase2b
    s_mov_b32 s37, 208
    v_mov_b32 v250, 1
    v_mov_b32 v251, 163832
    v_cmp_eq_u32 vcc, 0, v0
    s_nop 0
    s_and_saveexec_b64 s[38:39], vcc
    s_cbranch_execz tk12
    buffer_atomic_add v250, off, s[96:99], s37 sc0
    s_waitcnt vmcnt(0)
    ds_write_b32 v251, v250
    s_waitcnt lgkmcnt(0)
tk12:
    s_mov_b64 exec, -1
    s_barrier
    ds_read_b32 v252, v251
    s_waitcnt lgkmcnt(0)
    v_readfirstlane_b32 s12, v252
    s_barrier
    s_nop 3
    s_cmp_lt_u32 s12, 32
    s_cbranch_scc1 L_chain_safe
L_phase2b:
    s_mov_b32 s47, 0
    s_mov_b32 s46, 0
    s_mov_b32 s8, s76
    s_mov_b32 s9, s77
    s_mov_b32 s10, 4718592
    s_mov_b32 s11, 0x20000
    s_sub_u32 s33, s3, 4
    s_and_b32 s33, s33, 7
    s_cmp_ge_u32 s33, 6
    s_cbranch_scc1 L_p2scan
L_p2take:
    s_lshl_b32 s35, s33, 2
    s_add_u32 s35, s35, 160
    s_mov_b32 s37, s35
    v_mov_b32 v250, 1
    v_mov_b32 v251, 163832
    v_cmp_eq_u32 vcc, 0, v0
    s_nop 0
    s_and_saveexec_b64 s[38:39], vcc
    s_cbranch_execz tk13
    buffer_atomic_add v250, off, s[96:99], s37 sc0
    s_waitcnt vmcnt(0)
    ds_write_b32 v251, v250
    s_waitcnt lgkmcnt(0)
tk13:
    s_mov_b64 exec, -1
    s_barrier
    ds_read_b32 v252, v251
    s_waitcnt lgkmcnt(0)
    v_readfirstlane_b32 s34, v252
    s_barrier
    s_nop 3
    s_bitcmp1_b32 54, s33
    s_cselect_b32 s36, 9, 8
    s_cmp_lt_u32 s34, s36
    s_cbranch_scc1 L_att0
    s_sub_u32 s34, s34, s36
    s_cmp_ge_u32 s34, 18
    s_cbranch_scc1 L_p2scan
    s_branch L_op_start
    s_mul_i32 s36, s33, 3
    s_add_u32 s36, s36, s34
    s_sub_u32 s37, s34, 3
    s_cmp_lt_u32 s34, 3
    s_cselect_b32 s34, s36, s37
    s_cselect_b32 s33, 6, s33
    s_branch L_op_start
L_p2scan:
    v_and_b32 v1, 63, v0
    v_min_u32 v1, 5, v1
    v_lshlrev_b32 v2, 2, v1
    s_cmp_lg_u32 s32, 0
    v_mov_b32 v251, 163832
    s_cbranch_scc1 sw14
    buffer_load_dword v3, v2, s[96:99], 0 offen offset:160 sc1
    v_mov_b32 v4, 26
    v_lshrrev_b32 v5, v1, 54
    v_and_b32 v5, 1, v5
    v_add_u32 v4, v4, v5
    s_waitcnt vmcnt(0)
    v_cmp_lt_u32 vcc, v3, v4
    s_nop 0
    s_ff1_i32_b64 s40, vcc
    v_mov_b32 v250, s40
    ds_write_b32 v251, v250
    s_waitcnt lgkmcnt(0)
sw14:
    s_barrier
    ds_read_b32 v252, v251
    s_waitcnt lgkmcnt(0)
    v_readfirstlane_b32 s33, v252
    s_barrier
    s_nop 1
    s_cmp_lt_u32 s33, 7
    s_cbranch_scc1 L_p2take
    s_branch L_done
L_att0:
    s_mul_i32 s34, s34, 6
    s_add_u32 s34, s34, s33
    s_cmp_ge_u32 s34, 48
    s_cbranch_scc1 L_done
L_att_next:
    s_lshr_b32 s16, s34, 3
    s_and_b32 s17, s34, 7
    s_lshl_b32 s17, s17, 2
    s_add_u32 s17, s17, s32
    s_lshr_b32 s36, s17, 1
    s_lshl_b32 s36, s36, 8
    s_add_u32 s36, s36, 125829120
    s_mul_i32 s37, s16, 43
    s_lshr_b32 s37, s37, 8
    s_mul_i32 s41, s37, 6
    s_sub_u32 s41, s16, s41
    v_and_b32 v1, 63, v0
    v_mul_u32_u24 v2, 6, v1
    v_add_u32 v2, s41, v2
    v_mov_b32 v4, s37
    s_and_b32 s41, s16, 7
    s_add_u32 s41, s41, 12
    s_lshr_b32 s37, s16, 3
    v_mov_b32 v5, s41
    v_mov_b32 v6, s37
    v_cmp_lt_u32 vcc, 1, v1
    s_nop 1
    v_cndmask_b32 v2, v2, v5, vcc
    v_cndmask_b32 v4, v4, v6, vcc
    v_lshlrev_b32 v2, 2, v2
    v_add3_u32 v4, v4, s95, 1
    s_mov_b32 s40, 4194304
L_aw1:
    buffer_load_dword v3, v2, s[4:7], s36 offen sc1
    s_sub_u32 s40, s40, 1
    s_cbranch_scc1 L_aw1_go
    s_waitcnt vmcnt(0)
    v_subrev_u32 v3, v4, v3
    v_cmp_lt_u32 vcc, 64, v3
    s_cbranch_vccz L_aw1_go
    s_sleep 4
    s_branch L_aw1
L_aw1_go:
    v_and_b32 v5, 63, v0
    v_lshlrev_b32 v1, 4, v5
    v_or_b32 v3, 128, v1
    v_lshrrev_b32 v4, 4, v5
    v_bfe_u32 v6, v5, 2, 2
    v_sub_u32 v4, v6, v4
    v_lshlrev_b32 v4, 3, v4
    v_and_b32 v6, 3, v5
    v_add_u32 v4, v4, v6
    v_mov_b32 v6, 0xf149f2ca
    s_mov_b32 s22, 0x3e0293ee
    s_lshl_b32 s18, s16, 5
    s_add_u32 s18, s18, s17
    s_lshl_b32 s19, s18, 13
    s_add_u32 s20, s19, 33554432
    buffer_load_dwordx4 v[8:11], v1, s[4:7], s20 offen offset:0 sc1
    s_add_u32 s20, s19, 33554432
    buffer_load_dwordx4 v[12:15], v1, s[4:7], s20 offen offset:1024 sc1
    s_add_u32 s20, s19, 33554432
    buffer_load_dwordx4 v[16:19], v1, s[4:7], s20 offen offset:2048 sc1
    s_add_u32 s20, s19, 33554432
    buffer_load_dwordx4 v[20:23], v1, s[4:7], s20 offen offset:3072 sc1
    s_add_u32 s20, s19, 33558528
    buffer_load_dwordx4 v[24:27], v1, s[4:7], s20 offen offset:0 sc1
    s_add_u32 s20, s19, 33558528
    buffer_load_dwordx4 v[28:31], v1, s[4:7], s20 offen offset:1024 sc1
    s_add_u32 s20, s19, 33558528
    buffer_load_dwordx4 v[32:35], v1, s[4:7], s20 offen offset:2048 sc1
    s_add_u32 s20, s19, 33558528
    buffer_load_dwordx4 v[36:39], v1, s[4:7], s20 offen offset:3072 sc1
    s_lshl_b32 s21, s18, 14
    s_add_u32 s20, s21, 0
    buffer_load_dwordx4 v[40:43], v1, s[4:7], s20 offen offset:0 sc1
    s_add_u32 s20, s21, 4096
    buffer_load_dwordx4 v[44:47], v1, s[4:7], s20 offen offset:0 sc1
    s_add_u32 s20, s21, 8192
    buffer_load_dwordx4 v[48:51], v1, s[4:7], s20 offen offset:0 sc1
    s_add_u32 s20, s21, 12288
    buffer_load_dwordx4 v[52:55], v1, s[4:7], s20 offen offset:0 sc1
    s_add_u32 s20, s21, 0
    buffer_load_dwordx4 v[56:59], v1, s[4:7], s20 offen offset:1024 sc1
    s_add_u32 s20, s21, 4096
    buffer_load_dwordx4 v[60:63], v1, s[4:7], s20 offen offset:1024 sc1
    s_add_u32 s20, s21, 8192
    buffer_load_dwordx4 v[64:67], v1, s[4:7], s20 offen offset:1024 sc1
    s_add_u32 s20, s21, 12288
    buffer_load_dwordx4 v[68:71], v1, s[4:7], s20 offen offset:1024 sc1
    s_add_u32 s20, s21, 0
    buffer_load_dwordx4 v[88:91], v1, s[4:7], s20 offen offset:2048 sc1
    s_add_u32 s20, s21, 4096
    buffer_load_dwordx4 v[92:95], v1, s[4:7], s20 offen offset:2048 sc1
    s_add_u32 s20, s21, 8192
    buffer_load_dwordx4 v[96:99], v1, s[4:7], s20 offen offset:2048 sc1
    s_add_u32 s20, s21, 12288
    buffer_load_dwordx4 v[100:103], v1, s[4:7], s20 offen offset:2048 sc1
    s_add_u32 s20, s21, 0
    buffer_load_dwordx4 v[104:107], v1, s[4:7], s20 offen offset:3072 sc1
    s_add_u32 s20, s21, 4096
    buffer_load_dwordx4 v[108:111], v1, s[4:7], s20 offen offset:3072 sc1
    s_add_u32 s20, s21, 8192
    buffer_load_dwordx4 v[112:115], v1, s[4:7], s20 offen offset:3072 sc1
    s_add_u32 s20, s21, 12288
    buffer_load_dwordx4 v[116:119], v1, s[4:7], s20 offen offset:3072 sc1
    v_mov_b32 v172, 0x3f803f80
    v_mov_b32 v173, 0x3f803f80
    v_mov_b32 v174, 0x3f803f80
    v_mov_b32 v175, 0x3f803f80
    v_mov_b32 v176, 0x3f003f00
    v_mov_b32 v177, 0x3f003f00
    s_waitcnt vmcnt(8)
    v_mfma_f32_16x16x32_bf16 v[136:139], v[40:43], v[8:11], 0
    v_mfma_f32_16x16x32_bf16 v[140:143], v[56:59], v[8:11], 0
    v_mfma_f32_16x16x32_bf16 v[148:151], v[40:43], v[24:27], 0
    v_mfma_f32_16x16x32_bf16 v[152:155], v[56:59], v[24:27], 0
    v_mfma_f32_16x16x32_bf16 v[136:139], v[44:47], v[12:15], v[136:139]
    v_mfma_f32_16x16x32_bf16 v[140:143], v[60:63], v[12:15], v[140:143]
    v_mfma_f32_16x16x32_bf16 v[148:151], v[44:47], v[28:31], v[148:151]
    v_mfma_f32_16x16x32_bf16 v[152:155], v[60:63], v[28:31], v[152:155]
    v_mfma_f32_16x16x32_bf16 v[136:139], v[48:51], v[16:19], v[136:139]
    v_mfma_f32_16x16x32_bf16 v[140:143], v[64:67], v[16:19], v[140:143]
    v_mfma_f32_16x16x32_bf16 v[148:151], v[48:51], v[32:35], v[148:151]
    v_mfma_f32_16x16x32_bf16 v[152:155], v[64:67], v[32:35], v[152:155]
    v_mfma_f32_16x16x32_bf16 v[136:139], v[52:55], v[20:23], v[136:139]
    v_mfma_f32_16x16x32_bf16 v[140:143], v[68:71], v[20:23], v[140:143]
    v_mfma_f32_16x16x32_bf16 v[148:151], v[52:55], v[36:39], v[148:151]
    v_mfma_f32_16x16x32_bf16 v[152:155], v[68:71], v[36:39], v[152:155]
    v_cmp_le_i32 vcc, 0, v4
    s_nop 1
    v_cndmask_b32 v136, v6, v136, vcc
    v_cmp_le_i32 vcc, 1, v4
    s_nop 1
    v_cndmask_b32 v137, v6, v137, vcc
    v_cmp_le_i32 vcc, 2, v4
    s_nop 1
    v_cndmask_b32 v138, v6, v138, vcc
    v_cmp_le_i32 vcc, 3, v4
    s_nop 1
    v_cndmask_b32 v139, v6, v139, vcc
    v_cmp_le_i32 vcc, 4, v4
    s_nop 1
    v_cndmask_b32 v140, v6, v140, vcc
    v_cmp_le_i32 vcc, 5, v4
    s_nop 1
    v_cndmask_b32 v141, v6, v141, vcc
    v_cmp_le_i32 vcc, 6, v4
    s_nop 1
    v_cndmask_b32 v142, v6, v142, vcc
    v_cmp_le_i32 vcc, 7, v4
    s_nop 1
    v_cndmask_b32 v143, v6, v143, vcc
    v_cmp_le_i32 vcc, -4, v4
    s_nop 1
    v_cndmask_b32 v148, v6, v148, vcc
    v_cmp_le_i32 vcc, -3, v4
    s_nop 1
    v_cndmask_b32 v149, v6, v149, vcc
    v_cmp_le_i32 vcc, -2, v4
    s_nop 1
    v_cndmask_b32 v150, v6, v150, vcc
    v_cmp_le_i32 vcc, -1, v4
    s_nop 1
    v_cndmask_b32 v151, v6, v151, vcc
    v_cmp_le_i32 vcc, 0, v4
    s_nop 1
    v_cndmask_b32 v152, v6, v152, vcc
    v_cmp_le_i32 vcc, 1, v4
    s_nop 1
    v_cndmask_b32 v153, v6, v153, vcc
    v_cmp_le_i32 vcc, 2, v4
    s_nop 1
    v_cndmask_b32 v154, v6, v154, vcc
    v_cmp_le_i32 vcc, 3, v4
    s_nop 1
    v_cndmask_b32 v155, v6, v155, vcc
    v_max3_f32 v196, v136, v137, v138
    v_max3_f32 v196, v196, v139, v140
    v_max3_f32 v196, v196, v141, v142
    v_max_f32 v196, v196, v143
    v_mov_b32 v197, v196
    s_nop 1
    v_permlane32_swap_b32 v196, v197
    v_max_f32 v196, v196, v197
    v_mov_b32 v197, v196
    s_nop 1
    v_permlane16_swap_b32 v196, v197
    v_max_f32 v196, v196, v197
    v_mul_f32 v192, s22, v196
    v_fma_f32 v136, v136, s22, -v192
    v_fma_f32 v137, v137, s22, -v192
    v_fma_f32 v138, v138, s22, -v192
    v_fma_f32 v139, v139, s22, -v192
    v_fma_f32 v140, v140, s22, -v192
    v_fma_f32 v141, v141, s22, -v192
    v_fma_f32 v142, v142, s22, -v192
    v_fma_f32 v143, v143, s22, -v192
    v_exp_f32 v136, v136
    v_exp_f32 v137, v137
    v_exp_f32 v138, v138
    v_exp_f32 v139, v139
    v_exp_f32 v140, v140
    v_exp_f32 v141, v141
    v_exp_f32 v142, v142
    v_exp_f32 v143, v143
    v_cvt_pk_bf16_f32 v160, v136, v137
    v_cvt_pk_bf16_f32 v161, v138, v139
    v_cvt_pk_bf16_f32 v162, v140, v141
    v_cvt_pk_bf16_f32 v163, v142, v143
    v_max3_f32 v196, v148, v149, v150
    v_max3_f32 v196, v196, v151, v152
    v_max3_f32 v196, v196, v153, v154
    v_max_f32 v196, v196, v155
    v_mov_b32 v197, v196
    s_nop 1
    v_permlane32_swap_b32 v196, v197
    v_max_f32 v196, v196, v197
    v_mov_b32 v197, v196
    s_nop 1
    v_permlane16_swap_b32 v196, v197
    v_max_f32 v196, v196, v197
    v_mul_f32 v193, s22, v196
    v_fma_f32 v148, v148, s22, -v193
    v_fma_f32 v149, v149, s22, -v193
    v_fma_f32 v150, v150, s22, -v193
    v_fma_f32 v151, v151, s22, -v193
    v_fma_f32 v152, v152, s22, -v193
    v_fma_f32 v153, v153, s22, -v193
    v_fma_f32 v154, v154, s22, -v193
    v_fma_f32 v155, v155, s22, -v193
    v_exp_f32 v148, v148
    v_exp_f32 v149, v149
    v_exp_f32 v150, v150
    v_exp_f32 v151, v151
    v_exp_f32 v152, v152
    v_exp_f32 v153, v153
    v_exp_f32 v154, v154
    v_exp_f32 v155, v155
    v_cvt_pk_bf16_f32 v166, v148, v149
    v_cvt_pk_bf16_f32 v167, v150, v151
    v_cvt_pk_bf16_f32 v168, v152, v153
    v_cvt_pk_bf16_f32 v169, v154, v155
    v_mfma_f32_16x16x32_bf16 v[180:183], v[172:175], v[160:163], 0
    v_mfma_f32_16x16x32_bf16 v[184:187], v[172:175], v[166:169], 0
    s_waitcnt vmcnt(7)
    v_mfma_f32_16x16x32_bf16 v[40:43], v[88:91], v[160:163], 0
    s_waitcnt vmcnt(3)
    v_mfma_f32_16x16x32_bf16 v[44:47], v[104:107], v[160:163], 0
    v_mfma_f32_16x16x32_bf16 v[48:51], v[88:91], v[166:169], 0
    v_mfma_f32_16x16x32_bf16 v[52:55], v[104:107], v[166:169], 0
    v_mfma_f32_16x16x32_bf16 v[56:59], v[92:95], v[160:163], 0
    s_waitcnt vmcnt(2)
    v_mfma_f32_16x16x32_bf16 v[60:63], v[108:111], v[160:163], 0
    v_mfma_f32_16x16x32_bf16 v[64:67], v[92:95], v[166:169], 0
    v_mfma_f32_16x16x32_bf16 v[68:71], v[108:111], v[166:169], 0
    v_mfma_f32_16x16x32_bf16 v[200:203], v[96:99], v[160:163], 0
    s_waitcnt vmcnt(1)
    v_mfma_f32_16x16x32_bf16 v[204:207], v[112:115], v[160:163], 0
    v_mfma_f32_16x16x32_bf16 v[208:211], v[96:99], v[166:169], 0
    v_mfma_f32_16x16x32_bf16 v[212:215], v[112:115], v[166:169], 0
    v_mfma_f32_16x16x32_bf16 v[216:219], v[100:103], v[160:163], 0
    s_waitcnt vmcnt(0)
    v_mfma_f32_16x16x32_bf16 v[220:223], v[116:119], v[160:163], 0
    v_mfma_f32_16x16x32_bf16 v[224:227], v[100:103], v[166:169], 0
    v_mfma_f32_16x16x32_bf16 v[228:231], v[116:119], v[166:169], 0
    s_nop 7
    s_mov_b32 s88, 65536
    s_cmp_ge_u32 s47, s16
    s_cbranch_scc1 cw15x
cw15:
    buffer_load_dword v199, off, s[4:7], s36 offset:128 sc1
    s_waitcnt vmcnt(0)
    v_readfirstlane_b32 s42, v199
    s_nop 0
    s_sub_u32 s42, s42, s95
    s_cmp_gt_u32 s42, 64
    s_cselect_b32 s42, 0, s42
    s_add_u32 s42, s42, 2
    s_mov_b32 s47, s42
    s_cmp_ge_u32 s42, s16
    s_cbranch_scc1 cw15x
    s_sub_u32 s88, s88, 1
    s_cbranch_scc1 cw15x
    s_sub_u32 s42, s16, s42
    s_min_u32 s42, s42, 6
cw15s:
    s_sleep 24
    s_sub_u32 s42, s42, 1
    s_cmp_lg_u32 s42, 0
    s_cbranch_scc1 cw15s
    s_branch cw15
cw15x:
    s_add_u32 s37, s36, 128
    s_add_u32 s41, s16, s95
    s_add_u32 s41, s41, 1
    s_lshl_b32 s42, s17, 7
    s_add_u32 s42, s42, 125845504
    s_cmp_ge_u32 s16, 62
    s_cselect_b32 s37, s42, s37
    s_cselect_b32 s42, 12, 8
    v_lshlrev_b32 v198, 2, v0
    v_and_b32 v198, s42, v198
    s_mov_b32 s40, 4194304
L_aw2:
    buffer_load_dword v199, v198, s[4:7], s37 offen sc1
    s_sub_u32 s40, s40, 1
    s_cbranch_scc1 L_aw2_go
    s_waitcnt vmcnt(0)
    v_subrev_u32 v199, s41, v199
    v_cmp_lt_u32 vcc, 64, v199
    s_cbranch_vccz L_aw2_go
    s_sleep 1
    s_branch L_aw2
L_aw2_go:
    s_mov_b32 s21, 4096
at_again:
    s_lshl_b32 s20, s18, 12
    s_add_u32 s20, s20, 71303168
    buffer_load_dwordx4 v[72:75], v3, s[4:7], s20 offen offset:0 sc1
    buffer_load_dwordx4 v[76:79], v3, s[4:7], s20 offen offset:1024 sc1
    buffer_load_dwordx4 v[80:83], v3, s[4:7], s20 offen offset:2048 sc1
    buffer_load_dwordx4 v[84:87], v3, s[4:7], s20 offen offset:3072 sc1
    s_lshl_b32 s20, s18, 12
    s_add_u32 s20, s20, 80740352
    buffer_load_dwordx4 v[120:123], v1, s[4:7], s20 offen offset:0 sc1
    buffer_load_dwordx4 v[124:127], v1, s[4:7], s20 offen offset:1024 sc1
    buffer_load_dwordx4 v[128:131], v1, s[4:7], s20 offen offset:2048 sc1
    buffer_load_dwordx4 v[132:135], v1, s[4:7], s20 offen offset:3072 sc1
    s_waitcnt vmcnt(7)
    v_mfma_f32_16x16x32_bf16 v[144:147], v[72:75], v[8:11], 0
    v_mfma_f32_16x16x32_bf16 v[156:159], v[72:75], v[24:27], 0
    s_waitcnt vmcnt(6)
    v_mfma_f32_16x16x32_bf16 v[144:147], v[76:79], v[12:15], v[144:147]
    v_mfma_f32_16x16x32_bf16 v[156:159], v[76:79], v[28:31], v[156:159]
    s_waitcnt vmcnt(5)
    v_mfma_f32_16x16x32_bf16 v[144:147], v[80:83], v[16:19], v[144:147]
    v_mfma_f32_16x16x32_bf16 v[156:159], v[80:83], v[32:35], v[156:159]
    s_waitcnt vmcnt(4)
    v_mfma_f32_16x16x32_bf16 v[144:147], v[84:87], v[20:23], v[144:147]
    v_mfma_f32_16x16x32_bf16 v[156:159], v[84:87], v[36:39], v[156:159]
    v_max3_u32 v196, v72, v76, v80
    s_waitcnt vmcnt(0)
    v_max3_u32 v196, v196, v84, v120
    v_max3_u32 v196, v196, v124, v128
    v_max_u32 v196, v196, v132
    v_cmp_eq_u32 vcc, -1, v196
    s_sub_u32 s21, s21, 1
    s_nop 3
    s_cbranch_scc1 at_ok
    s_cbranch_vccnz at_again
at_ok:
    v_max3_f32 v196, v144, v145, v146
    v_max_f32 v196, v196, v147
    v_mov_b32 v197, v196
    s_nop 1
    v_permlane16_swap_b32 v196, v197
    v_max_f32 v196, v196, v197
    v_mul_f32 v196, s22, v196
    v_max_f32 v196, v196, v192
    v_sub_f32 v192, v192, v196
    v_fma_f32 v144, v144, s22, -v196
    v_fma_f32 v145, v145, s22, -v196
    v_fma_f32 v146, v146, s22, -v196
    v_fma_f32 v147, v147, s22, -v196
    v_exp_f32 v192, v192
    v_exp_f32 v144, v144
    v_exp_f32 v145, v145
    v_exp_f32 v146, v146
    v_exp_f32 v147, v147
    v_add_f32 v196, v144, v145
    v_add_f32 v197, v146, v147
    v_add_f32 v196, v196, v197
    v_mov_b32 v197, v196
    s_nop 1
    v_permlane16_swap_b32 v196, v197
    v_add_f32 v196, v196, v197
    v_fmac_f32 v196, v192, v180
    v_rcp_f32 v196, v196
    s_nop 0
    v_mul_f32 v144, v144, v196
    v_mul_f32 v145, v145, v196
    v_mul_f32 v146, v146, v196
    v_mul_f32 v147, v147, v196
    v_mul_f32 v192, v192, v196
    v_cvt_pk_bf16_f32 v164, v144, v145
    v_cvt_pk_bf16_f32 v165, v146, v147
    v_max3_f32 v196, v156, v157, v158
    v_max_f32 v196, v196, v159
    v_mov_b32 v197, v196
    s_nop 1
    v_permlane16_swap_b32 v196, v197
    v_max_f32 v196, v196, v197
    v_mul_f32 v196, s22, v196
    v_max_f32 v196, v196, v193
    v_sub_f32 v193, v193, v196
    v_fma_f32 v156, v156, s22, -v196
    v_fma_f32 v157, v157, s22, -v196
    v_fma_f32 v158, v158, s22, -v196
    v_fma_f32 v159, v159, s22, -v196
    v_exp_f32 v193, v193
    v_exp_f32 v156, v156
    v_exp_f32 v157, v157
    v_exp_f32 v158, v158
    v_exp_f32 v159, v159
    v_add_f32 v196, v156, v157
    v_add_f32 v197, v158, v159
    v_add_f32 v196, v196, v197
    v_mov_b32 v197, v196
    s_nop 1
    v_permlane16_swap_b32 v196, v197
    v_add_f32 v196, v196, v197
    v_fmac_f32 v196, v193, v184
    v_rcp_f32 v196, v196
    s_nop 0
    v_mul_f32 v156, v156, v196
    v_mul_f32 v157, v157, v196
    v_mul_f32 v158, v158, v196
    v_mul_f32 v159, v159, v196
    v_mul_f32 v193, v193, v196
    v_cvt_pk_bf16_f32 v170, v156, v157
    v_cvt_pk_bf16_f32 v171, v158, v159
    s_lshl_b32 s18, s16, 18
    s_lshl_b32 s19, s17, 12
    s_add_u32 s18, s18, s19
    s_add_u32 s18, s18, 50331648
    s_add_u32 s19, s18, 131072
    v_mul_f32 v40, v40, v192
    v_mul_f32 v41, v41, v192
    v_mul_f32 v42, v42, v192
    v_mul_f32 v43, v43, v192
    v_mul_f32 v44, v44, v192
    v_mul_f32 v45, v45, v192
    v_mul_f32 v46, v46, v192
    v_mul_f32 v47, v47, v192
    v_mfma_f32_16x16x16_bf16 v[40:43], v[120:121], v[164:165], v[40:43]
    v_mfma_f32_16x16x16_bf16 v[44:47], v[122:123], v[164:165], v[44:47]
    v_mul_f32 v48, v48, v193
    v_mul_f32 v49, v49, v193
    v_mul_f32 v50, v50, v193
    v_mul_f32 v51, v51, v193
    v_mul_f32 v52, v52, v193
    v_mul_f32 v53, v53, v193
    v_mul_f32 v54, v54, v193
    v_mul_f32 v55, v55, v193
    v_mfma_f32_16x16x16_bf16 v[48:51], v[120:121], v[170:171], v[48:51]
    v_mfma_f32_16x16x16_bf16 v[52:55], v[122:123], v[170:171], v[52:55]
    v_cvt_pk_bf16_f32 v40, v40, v41
    v_cvt_pk_bf16_f32 v41, v42, v43
    v_cvt_pk_bf16_f32 v42, v44, v45
    v_cvt_pk_bf16_f32 v43, v46, v47
    buffer_store_dwordx4 v[40:43], v1, s[4:7], s18 offen offset:0 sc1
    v_mul_f32 v56, v56, v192
    v_mul_f32 v57, v57, v192
    v_mul_f32 v58, v58, v192
    v_mul_f32 v59, v59, v192
    v_mul_f32 v60, v60, v192
    v_mul_f32 v61, v61, v192
    v_mul_f32 v62, v62, v192
    v_mul_f32 v63, v63, v192
    v_mfma_f32_16x16x16_bf16 v[56:59], v[124:125], v[164:165], v[56:59]
    v_mfma_f32_16x16x16_bf16 v[60:63], v[126:127], v[164:165], v[60:63]
    v_cvt_pk_bf16_f32 v48, v48, v49
    v_cvt_pk_bf16_f32 v49, v50, v51
    v_cvt_pk_bf16_f32 v50, v52, v53
    v_cvt_pk_bf16_f32 v51, v54, v55
    buffer_store_dwordx4 v[48:51], v1, s[4:7], s19 offen offset:0 sc1
    v_mul_f32 v64, v64, v193
    v_mul_f32 v65, v65, v193
    v_mul_f32 v66, v66, v193
    v_mul_f32 v67, v67, v193
    v_mul_f32 v68, v68, v193
    v_mul_f32 v69, v69, v193
    v_mul_f32 v70, v70, v193
    v_mul_f32 v71, v71, v193
    v_mfma_f32_16x16x16_bf16 v[64:67], v[124:125], v[170:171], v[64:67]
    v_mfma_f32_16x16x16_bf16 v[68:71], v[126:127], v[170:171], v[68:71]
    v_cvt_pk_bf16_f32 v56, v56, v57
    v_cvt_pk_bf16_f32 v57, v58, v59
    v_cvt_pk_bf16_f32 v58, v60, v61
    v_cvt_pk_bf16_f32 v59, v62, v63
    buffer_store_dwordx4 v[56:59], v1, s[4:7], s18 offen offset:1024 sc1
    v_mul_f32 v200, v200, v192
    v_mul_f32 v201, v201, v192
    v_mul_f32 v202, v202, v192
    v_mul_f32 v203, v203, v192
    v_mul_f32 v204, v204, v192
    v_mul_f32 v205, v205, v192
    v_mul_f32 v206, v206, v192
    v_mul_f32 v207, v207, v192
    v_mfma_f32_16x16x16_bf16 v[200:203], v[128:129], v[164:165], v[200:203]
    v_mfma_f32_16x16x16_bf16 v[204:207], v[130:131], v[164:165], v[204:207]
    v_cvt_pk_bf16_f32 v64, v64, v65
    v_cvt_pk_bf16_f32 v65, v66, v67
    v_cvt_pk_bf16_f32 v66, v68, v69
    v_cvt_pk_bf16_f32 v67, v70, v71
    buffer_store_dwordx4 v[64:67], v1, s[4:7], s19 offen offset:1024 sc1
    v_mul_f32 v208, v208, v193
    v_mul_f32 v209, v209, v193
    v_mul_f32 v210, v210, v193
    v_mul_f32 v211, v211, v193
    v_mul_f32 v212, v212, v193
    v_mul_f32 v213, v213, v193
    v_mul_f32 v214, v214, v193
    v_mul_f32 v215, v215, v193
    v_mfma_f32_16x16x16_bf16 v[208:211], v[128:129], v[170:171], v[208:211]
    v_mfma_f32_16x16x16_bf16 v[212:215], v[130:131], v[170:171], v[212:215]
    v_cvt_pk_bf16_f32 v200, v200, v201
    v_cvt_pk_bf16_f32 v201, v202, v203
    v_cvt_pk_bf16_f32 v202, v204, v205
    v_cvt_pk_bf16_f32 v203, v206, v207
    buffer_store_dwordx4 v[200:203], v1, s[4:7], s18 offen offset:2048 sc1
    v_mul_f32 v216, v216, v192
    v_mul_f32 v217, v217, v192
    v_mul_f32 v218, v218, v192
    v_mul_f32 v219, v219, v192
    v_mul_f32 v220, v220, v192
    v_mul_f32 v221, v221, v192
    v_mul_f32 v222, v222, v192
    v_mul_f32 v223, v223, v192
    v_mfma_f32_16x16x16_bf16 v[216:219], v[132:133], v[164:165], v[216:219]
    v_mfma_f32_16x16x16_bf16 v[220:223], v[134:135], v[164:165], v[220:223]
    v_cvt_pk_bf16_f32 v208, v208, v209
    v_cvt_pk_bf16_f32 v209, v210, v211
    v_cvt_pk_bf16_f32 v210, v212, v213
    v_cvt_pk_bf16_f32 v211, v214, v215
    buffer_store_dwordx4 v[208:211], v1, s[4:7], s19 offen offset:2048 sc1
    v_mul_f32 v224, v224, v193
    v_mul_f32 v225, v225, v193
    v_mul_f32 v226, v226, v193
    v_mul_f32 v227, v227, v193
    v_mul_f32 v228, v228, v193
    v_mul_f32 v229, v229, v193
    v_mul_f32 v230, v230, v193
    v_mul_f32 v231, v231, v193
    v_mfma_f32_16x16x16_bf16 v[224:227], v[132:133], v[170:171], v[224:227]
    v_mfma_f32_16x16x16_bf16 v[228:231], v[134:135], v[170:171], v[228:231]
    v_cvt_pk_bf16_f32 v216, v216, v217
    v_cvt_pk_bf16_f32 v217, v218, v219
    v_cvt_pk_bf16_f32 v218, v220, v221
    v_cvt_pk_bf16_f32 v219, v222, v223
    buffer_store_dwordx4 v[216:219], v1, s[4:7], s18 offen offset:3072 sc1
    v_cvt_pk_bf16_f32 v224, v224, v225
    v_cvt_pk_bf16_f32 v225, v226, v227
    v_cvt_pk_bf16_f32 v226, v228, v229
    v_cvt_pk_bf16_f32 v227, v230, v231
    buffer_store_dwordx4 v[224:227], v1, s[4:7], s19 offen offset:3072 sc1
    s_lshr_b32 s40, s34, 1
    s_lshl_b32 s40, s40, 7
    s_and_b32 s41, s17, 7
    s_lshl_b32 s41, s41, 2
    s_add_u32 s40, s40, s41
    s_add_u32 s40, s40, 125894656
    v_mov_b32 v250, s95
    s_cmp_ge_u32 s16, 58
    s_cbranch_scc1 L_afl
    s_waitcnt vmcnt(0)
L_afl:
    s_mov_b64 exec, 1
    buffer_store_dword v250, off, s[4:7], s40 sc1
    s_mov_b64 exec, -1
    s_add_u32 s34, s34, 48
    s_cmp_lt_u32 s34, 512
    s_cbranch_scc1 L_att_next
    s_branch L_done
L_op_start:
    s_mov_b32 s16, s33
    s_mov_b32 s33, s34
    v_and_b32 v2, 63, v0
    v_lshlrev_b32 v1, 4, v2
    v_lshrrev_b32 v5, 2, v2
    v_mul_u32_u24 v3, 1152, v5
    v_and_b32 v5, 3, v2
    v_lshl_add_u32 v3, v5, 4, v3
    s_lshl_b32 s21, s32, 12
    v_add_u32 v4, s21, v1
    s_mov_b64 s[12:13], s[58:59]
    s_mov_b32 s14, 4718592
    s_mov_b32 s15, 0x20000
    s_mul_i32 s19, s32, 1179648
    s_lshl_b32 s18, s33, 6
    s_add_u32 s19, s19, s18
    s_add_u32 s18, s19, 0
    s_add_u32 m0, s21, 0
    s_nop 0
    buffer_load_dwordx4 v3, s[12:15], s18 offen lds
    s_add_u32 m0, s21, 1024
    s_add_u32 s18, s18, 18432
    buffer_load_dwordx4 v3, s[12:15], s18 offen lds
    s_add_u32 m0, s21, 2048
    s_add_u32 s18, s18, 18432
    buffer_load_dwordx4 v3, s[12:15], s18 offen lds
    s_add_u32 m0, s21, 3072
    s_add_u32 s18, s18, 18432
    buffer_load_dwordx4 v3, s[12:15], s18 offen lds
    s_add_u32 s18, s19, 73728
    s_add_u32 m0, s21, 16384
    s_nop 0
    buffer_load_dwordx4 v3, s[12:15], s18 offen lds
    s_add_u32 m0, s21, 17408
    s_add_u32 s18, s18, 18432
    buffer_load_dwordx4 v3, s[12:15], s18 offen lds
    s_add_u32 m0, s21, 18432
    s_add_u32 s18, s18, 18432
    buffer_load_dwordx4 v3, s[12:15], s18 offen lds
    s_add_u32 m0, s21, 19456
    s_add_u32 s18, s18, 18432
    buffer_load_dwordx4 v3, s[12:15], s18 offen lds
    s_add_u32 s18, s19, 147456
    s_add_u32 m0, s21, 32768
    s_nop 0
    buffer_load_dwordx4 v3, s[12:15], s18 offen lds
    s_add_u32 m0, s21, 33792
    s_add_u32 s18, s18, 18432
    buffer_load_dwordx4 v3, s[12:15], s18 offen lds
    s_add_u32 m0, s21, 34816
    s_add_u32 s18, s18, 18432
    buffer_load_dwordx4 v3, s[12:15], s18 offen lds
    s_add_u32 m0, s21, 35840
    s_add_u32 s18, s18, 18432
    buffer_load_dwordx4 v3, s[12:15], s18 offen lds
    s_add_u32 s18, s19, 221184
    s_add_u32 m0, s21, 49152
    s_nop 0
    buffer_load_dwordx4 v3, s[12:15], s18 offen lds
    s_add_u32 m0, s21, 50176
    s_add_u32 s18, s18, 18432
    buffer_load_dwordx4 v3, s[12:15], s18 offen lds
    s_add_u32 m0, s21, 51200
    s_add_u32 s18, s18, 18432
    buffer_load_dwordx4 v3, s[12:15], s18 offen lds
    s_add_u32 m0, s21, 52224
    s_add_u32 s18, s18, 18432
    buffer_load_dwordx4 v3, s[12:15], s18 offen lds
    s_add_u32 s18, s19, 294912
    s_add_u32 m0, s21, 65536
    s_nop 0
    buffer_load_dwordx4 v3, s[12:15], s18 offen lds
    s_add_u32 m0, s21, 66560
    s_add_u32 s18, s18, 18432
    buffer_load_dwordx4 v3, s[12:15], s18 offen lds
    s_add_u32 m0, s21, 67584
    s_add_u32 s18, s18, 18432
    buffer_load_dwordx4 v3, s[12:15], s18 offen lds
    s_add_u32 m0, s21, 68608
    s_add_u32 s18, s18, 18432
    buffer_load_dwordx4 v3, s[12:15], s18 offen lds
    s_add_u32 s18, s19, 368640
    s_add_u32 m0, s21, 81920
    s_nop 0
    buffer_load_dwordx4 v3, s[12:15], s18 offen lds
    s_add_u32 m0, s21, 82944
    s_add_u32 s18, s18, 18432
    buffer_load_dwordx4 v3, s[12:15], s18 offen lds
    s_add_u32 m0, s21, 83968
    s_add_u32 s18, s18, 18432
    buffer_load_dwordx4 v3, s[12:15], s18 offen lds
    s_add_u32 m0, s21, 84992
    s_add_u32 s18, s18, 18432
    buffer_load_dwordx4 v3, s[12:15], s18 offen lds
    s_add_u32 s18, s19, 442368
    s_add_u32 m0, s21, 98304
    s_nop 0
    buffer_load_dwordx4 v3, s[12:15], s18 offen lds
    s_add_u32 m0, s21, 99328
    s_add_u32 s18, s18, 18432
    buffer_load_dwordx4 v3, s[12:15], s18 offen lds
    s_add_u32 m0, s21, 100352
    s_add_u32 s18, s18, 18432
    buffer_load_dwordx4 v3, s[12:15], s18 offen lds
    s_add_u32 m0, s21, 101376
    s_add_u32 s18, s18, 18432
    buffer_load_dwordx4 v3, s[12:15], s18 offen lds
    s_add_u32 s18, s19, 516096
    s_add_u32 m0, s21, 114688
    s_nop 0
    buffer_load_dwordx4 v3, s[12:15], s18 offen lds
    s_add_u32 m0, s21, 115712
    s_add_u32 s18, s18, 18432
    buffer_load_dwordx4 v3, s[12:15], s18 offen lds
    s_add_u32 m0, s21, 116736
    s_add_u32 s18, s18, 18432
    buffer_load_dwordx4 v3, s[12:15], s18 offen lds
    s_add_u32 m0, s21, 117760
    s_add_u32 s18, s18, 18432
    buffer_load_dwordx4 v3, s[12:15], s18 offen lds
    s_add_u32 s18, s19, 589824
    s_add_u32 m0, s21, 131072
    s_nop 0
    buffer_load_dwordx4 v3, s[12:15], s18 offen lds
    s_add_u32 m0, s21, 132096
    s_add_u32 s18, s18, 18432
    buffer_load_dwordx4 v3, s[12:15], s18 offen lds
    s_add_u32 m0, s21, 133120
    s_add_u32 s18, s18, 18432
    buffer_load_dwordx4 v3, s[12:15], s18 offen lds
    s_add_u32 m0, s21, 134144
    s_add_u32 s18, s18, 18432
    buffer_load_dwordx4 v3, s[12:15], s18 offen lds
    v_add_u32 v6, 0, v4
    v_xor_b32 v7, 32, v6
    s_waitcnt vmcnt(32)
    ds_read_b64_tr_b16 a[0:1], v6 offset:0
    ds_read_b64_tr_b16 a[2:3], v6 offset:1024
    ds_read_b64_tr_b16 a[4:5], v6 offset:8
    ds_read_b64_tr_b16 a[6:7], v6 offset:1032
    ds_read_b64_tr_b16 a[8:9], v6 offset:2048
    ds_read_b64_tr_b16 a[10:11], v6 offset:3072
    ds_read_b64_tr_b16 a[12:13], v6 offset:2056
    ds_read_b64_tr_b16 a[14:15], v6 offset:3080
    s_waitcnt lgkmcnt(0)
    s_add_u32 s18, s19, 663552
    s_add_u32 m0, s21, 0
    s_nop 0
    buffer_load_dwordx4 v3, s[12:15], s18 offen lds
    s_add_u32 m0, s21, 1024
    s_add_u32 s18, s18, 18432
    buffer_load_dwordx4 v3, s[12:15], s18 offen lds
    s_add_u32 m0, s21, 2048
    s_add_u32 s18, s18, 18432
    buffer_load_dwordx4 v3, s[12:15], s18 offen lds
    s_add_u32 m0, s21, 3072
    s_add_u32 s18, s18, 18432
    buffer_load_dwordx4 v3, s[12:15], s18 offen lds
    v_add_u32 v6, 16384, v4
    v_xor_b32 v7, 32, v6
    s_waitcnt vmcnt(32)
    ds_read_b64_tr_b16 a[16:17], v6 offset:0
    ds_read_b64_tr_b16 a[18:19], v6 offset:1024
    ds_read_b64_tr_b16 a[20:21], v6 offset:8
    ds_read_b64_tr_b16 a[22:23], v6 offset:1032
    ds_read_b64_tr_b16 a[24:25], v6 offset:2048
    ds_read_b64_tr_b16 a[26:27], v6 offset:3072
    ds_read_b64_tr_b16 a[28:29], v6 offset:2056
    ds_read_b64_tr_b16 a[30:31], v6 offset:3080
    s_waitcnt lgkmcnt(0)
    s_add_u32 s18, s19, 737280
    s_add_u32 m0, s21, 16384
    s_nop 0
    buffer_load_dwordx4 v3, s[12:15], s18 offen lds
    s_add_u32 m0, s21, 17408
    s_add_u32 s18, s18, 18432
    buffer_load_dwordx4 v3, s[12:15], s18 offen lds
    s_add_u32 m0, s21, 18432
    s_add_u32 s18, s18, 18432
    buffer_load_dwordx4 v3, s[12:15], s18 offen lds
    s_add_u32 m0, s21, 19456
    s_add_u32 s18, s18, 18432
    buffer_load_dwordx4 v3, s[12:15], s18 offen lds
    v_add_u32 v6, 32768, v4
    v_xor_b32 v7, 32, v6
    s_waitcnt vmcnt(32)
    ds_read_b64_tr_b16 a[32:33], v6 offset:0
    ds_read_b64_tr_b16 a[34:35], v6 offset:1024
    ds_read_b64_tr_b16 a[36:37], v6 offset:8
    ds_read_b64_tr_b16 a[38:39], v6 offset:1032
    ds_read_b64_tr_b16 a[40:41], v6 offset:2048
    ds_read_b64_tr_b16 a[42:43], v6 offset:3072
    ds_read_b64_tr_b16 a[44:45], v6 offset:2056
    ds_read_b64_tr_b16 a[46:47], v6 offset:3080
    s_waitcnt lgkmcnt(0)
    s_add_u32 s18, s19, 811008
    s_add_u32 m0, s21, 32768
    s_nop 0
    buffer_load_dwordx4 v3, s[12:15], s18 offen lds
    s_add_u32 m0, s21, 33792
    s_add_u32 s18, s18, 18432
    buffer_load_dwordx4 v3, s[12:15], s18 offen lds
    s_add_u32 m0, s21, 34816
    s_add_u32 s18, s18, 18432
    buffer_load_dwordx4 v3, s[12:15], s18 offen lds
    s_add_u32 m0, s21, 35840
    s_add_u32 s18, s18, 18432
    buffer_load_dwordx4 v3, s[12:15], s18 offen lds
    v_add_u32 v6, 49152, v4
    v_xor_b32 v7, 32, v6
    s_waitcnt vmcnt(32)
    ds_read_b64_tr_b16 a[48:49], v6 offset:0
    ds_read_b64_tr_b16 a[50:51], v6 offset:1024
    ds_read_b64_tr_b16 a[52:53], v6 offset:8
    ds_read_b64_tr_b16 a[54:55], v6 offset:1032
    ds_read_b64_tr_b16 a[56:57], v6 offset:2048
    ds_read_b64_tr_b16 a[58:59], v6 offset:3072
    ds_read_b64_tr_b16 a[60:61], v6 offset:2056
    ds_read_b64_tr_b16 a[62:63], v6 offset:3080
    s_waitcnt lgkmcnt(0)
    s_add_u32 s18, s19, 884736
    s_add_u32 m0, s21, 49152
    s_nop 0
    buffer_load_dwordx4 v3, s[12:15], s18 offen lds
    s_add_u32 m0, s21, 50176
    s_add_u32 s18, s18, 18432
    buffer_load_dwordx4 v3, s[12:15], s18 offen lds
    s_add_u32 m0, s21, 51200
    s_add_u32 s18, s18, 18432
    buffer_load_dwordx4 v3, s[12:15], s18 offen lds
    s_add_u32 m0, s21, 52224
    s_add_u32 s18, s18, 18432
    buffer_load_dwordx4 v3, s[12:15], s18 offen lds
    v_add_u32 v6, 65536, v4
    v_xor_b32 v7, 32, v6
    s_waitcnt vmcnt(32)
    ds_read_b64_tr_b16 a[64:65], v6 offset:0
    ds_read_b64_tr_b16 a[66:67], v6 offset:1024
    ds_read_b64_tr_b16 a[68:69], v6 offset:8
    ds_read_b64_tr_b16 a[70:71], v6 offset:1032
    ds_read_b64_tr_b16 a[72:73], v6 offset:2048
    ds_read_b64_tr_b16 a[74:75], v6 offset:3072
    ds_read_b64_tr_b16 a[76:77], v6 offset:2056
    ds_read_b64_tr_b16 a[78:79], v6 offset:3080
    s_waitcnt lgkmcnt(0)
    s_add_u32 s18, s19, 958464
    s_add_u32 m0, s21, 65536
    s_nop 0
    buffer_load_dwordx4 v3, s[12:15], s18 offen lds
    s_add_u32 m0, s21, 66560
    s_add_u32 s18, s18, 18432
    buffer_load_dwordx4 v3, s[12:15], s18 offen lds
    s_add_u32 m0, s21, 67584
    s_add_u32 s18, s18, 18432
    buffer_load_dwordx4 v3, s[12:15], s18 offen lds
    s_add_u32 m0, s21, 68608
    s_add_u32 s18, s18, 18432
    buffer_load_dwordx4 v3, s[12:15], s18 offen lds
    v_add_u32 v6, 81920, v4
    v_xor_b32 v7, 32, v6
    s_waitcnt vmcnt(32)
    ds_read_b64_tr_b16 a[80:81], v6 offset:0
    ds_read_b64_tr_b16 a[82:83], v6 offset:1024
    ds_read_b64_tr_b16 a[84:85], v6 offset:8
    ds_read_b64_tr_b16 a[86:87], v6 offset:1032
    ds_read_b64_tr_b16 a[88:89], v6 offset:2048
    ds_read_b64_tr_b16 a[90:91], v6 offset:3072
    ds_read_b64_tr_b16 a[92:93], v6 offset:2056
    ds_read_b64_tr_b16 a[94:95], v6 offset:3080
    s_waitcnt lgkmcnt(0)
    s_add_u32 s18, s19, 1032192
    s_add_u32 m0, s21, 81920
    s_nop 0
    buffer_load_dwordx4 v3, s[12:15], s18 offen lds
    s_add_u32 m0, s21, 82944
    s_add_u32 s18, s18, 18432
    buffer_load_dwordx4 v3, s[12:15], s18 offen lds
    s_add_u32 m0, s21, 83968
    s_add_u32 s18, s18, 18432
    buffer_load_dwordx4 v3, s[12:15], s18 offen lds
    s_add_u32 m0, s21, 84992
    s_add_u32 s18, s18, 18432
    buffer_load_dwordx4 v3, s[12:15], s18 offen lds
    v_add_u32 v6, 98304, v4
    v_xor_b32 v7, 32, v6
    s_waitcnt vmcnt(32)
    ds_read_b64_tr_b16 a[96:97], v6 offset:0
    ds_read_b64_tr_b16 a[98:99], v6 offset:1024
    ds_read_b64_tr_b16 a[100:101], v6 offset:8
    ds_read_b64_tr_b16 a[102:103], v6 offset:1032
    ds_read_b64_tr_b16 a[104:105], v6 offset:2048
    ds_read_b64_tr_b16 a[106:107], v6 offset:3072
    ds_read_b64_tr_b16 a[108:109], v6 offset:2056
    ds_read_b64_tr_b16 a[110:111], v6 offset:3080
    s_waitcnt lgkmcnt(0)
    s_add_u32 s18, s19, 1105920
    s_add_u32 m0, s21, 98304
    s_nop 0
    buffer_load_dwordx4 v3, s[12:15], s18 offen lds
    s_add_u32 m0, s21, 99328
    s_add_u32 s18, s18, 18432
    buffer_load_dwordx4 v3, s[12:15], s18 offen lds
    s_add_u32 m0, s21, 100352
    s_add_u32 s18, s18, 18432
    buffer_load_dwordx4 v3, s[12:15], s18 offen lds
    s_add_u32 m0, s21, 101376
    s_add_u32 s18, s18, 18432
    buffer_load_dwordx4 v3, s[12:15], s18 offen lds
    v_add_u32 v6, 114688, v4
    v_xor_b32 v7, 32, v6
    s_waitcnt vmcnt(32)
    ds_read_b64_tr_b16 a[112:113], v6 offset:0
    ds_read_b64_tr_b16 a[114:115], v6 offset:1024
    ds_read_b64_tr_b16 a[116:117], v6 offset:8
    ds_read_b64_tr_b16 a[118:119], v6 offset:1032
    ds_read_b64_tr_b16 a[120:121], v6 offset:2048
    ds_read_b64_tr_b16 a[122:123], v6 offset:3072
    ds_read_b64_tr_b16 a[124:125], v6 offset:2056
    ds_read_b64_tr_b16 a[126:127], v6 offset:3080
    s_waitcnt lgkmcnt(0)
    v_add_u32 v6, 131072, v4
    v_xor_b32 v7, 32, v6
    s_waitcnt vmcnt(28)
    ds_read_b64_tr_b16 a[128:129], v6 offset:0
    ds_read_b64_tr_b16 a[130:131], v6 offset:1024
    ds_read_b64_tr_b16 a[132:133], v6 offset:8
    ds_read_b64_tr_b16 a[134:135], v6 offset:1032
    ds_read_b64_tr_b16 a[136:137], v6 offset:2048
    ds_read_b64_tr_b16 a[138:139], v6 offset:3072
    ds_read_b64_tr_b16 a[140:141], v6 offset:2056
    ds_read_b64_tr_b16 a[142:143], v6 offset:3080
    s_waitcnt lgkmcnt(0)
    v_add_u32 v6, 0, v4
    v_xor_b32 v7, 32, v6
    s_waitcnt vmcnt(24)
    ds_read_b64_tr_b16 a[144:145], v6 offset:0
    ds_read_b64_tr_b16 a[146:147], v6 offset:1024
    ds_read_b64_tr_b16 a[148:149], v6 offset:8
    ds_read_b64_tr_b16 a[150:151], v6 offset:1032
    ds_read_b64_tr_b16 a[152:153], v6 offset:2048
    ds_read_b64_tr_b16 a[154:155], v6 offset:3072
    ds_read_b64_tr_b16 a[156:157], v6 offset:2056
    ds_read_b64_tr_b16 a[158:159], v6 offset:3080
    s_waitcnt lgkmcnt(0)
    v_add_u32 v6, 16384, v4
    v_xor_b32 v7, 32, v6
    s_waitcnt vmcnt(20)
    ds_read_b64_tr_b16 a[160:161], v6 offset:0
    ds_read_b64_tr_b16 a[162:163], v6 offset:1024
    ds_read_b64_tr_b16 a[164:165], v6 offset:8
    ds_read_b64_tr_b16 a[166:167], v6 offset:1032
    ds_read_b64_tr_b16 a[168:169], v6 offset:2048
    ds_read_b64_tr_b16 a[170:171], v6 offset:3072
    ds_read_b64_tr_b16 a[172:173], v6 offset:2056
    ds_read_b64_tr_b16 a[174:175], v6 offset:3080
    s_waitcnt lgkmcnt(0)
    v_add_u32 v6, 32768, v4
    v_xor_b32 v7, 32, v6
    s_waitcnt vmcnt(16)
    ds_read_b64_tr_b16 a[176:177], v6 offset:0
    ds_read_b64_tr_b16 a[178:179], v6 offset:1024
    ds_read_b64_tr_b16 a[180:181], v6 offset:8
    ds_read_b64_tr_b16 a[182:183], v6 offset:1032
    ds_read_b64_tr_b16 a[184:185], v6 offset:2048
    ds_read_b64_tr_b16 a[186:187], v6 offset:3072
    ds_read_b64_tr_b16 a[188:189], v6 offset:2056
    ds_read_b64_tr_b16 a[190:191], v6 offset:3080
    s_waitcnt lgkmcnt(0)
    v_add_u32 v6, 49152, v4
    v_xor_b32 v7, 32, v6
    s_waitcnt vmcnt(12)
    ds_read_b64_tr_b16 a[192:193], v6 offset:0
    ds_read_b64_tr_b16 a[194:195], v6 offset:1024
    ds_read_b64_tr_b16 a[196:197], v6 offset:8
    ds_read_b64_tr_b16 a[198:199], v6 offset:1032
    ds_read_b64_tr_b16 a[200:201], v6 offset:2048
    ds_read_b64_tr_b16 a[202:203], v6 offset:3072
    ds_read_b64_tr_b16 a[204:205], v6 offset:2056
    ds_read_b64_tr_b16 a[206:207], v6 offset:3080
    s_waitcnt lgkmcnt(0)
    v_add_u32 v6, 65536, v4
    v_xor_b32 v7, 32, v6
    s_waitcnt vmcnt(8)
    ds_read_b64_tr_b16 a[208:209], v6 offset:0
    ds_read_b64_tr_b16 a[210:211], v6 offset:1024
    ds_read_b64_tr_b16 a[212:213], v6 offset:8
    ds_read_b64_tr_b16 a[214:215], v6 offset:1032
    ds_read_b64_tr_b16 a[216:217], v6 offset:2048
    ds_read_b64_tr_b16 a[218:219], v6 offset:3072
    ds_read_b64_tr_b16 a[220:221], v6 offset:2056
    ds_read_b64_tr_b16 a[222:223], v6 offset:3080
    s_waitcnt lgkmcnt(0)
    v_add_u32 v6, 81920, v4
    v_xor_b32 v7, 32, v6
    s_waitcnt vmcnt(4)
    ds_read_b64_tr_b16 a[224:225], v6 offset:0
    ds_read_b64_tr_b16 a[226:227], v6 offset:1024
    ds_read_b64_tr_b16 a[228:229], v6 offset:8
    ds_read_b64_tr_b16 a[230:231], v6 offset:1032
    ds_read_b64_tr_b16 a[232:233], v6 offset:2048
    ds_read_b64_tr_b16 a[234:235], v6 offset:3072
    ds_read_b64_tr_b16 a[236:237], v6 offset:2056
    ds_read_b64_tr_b16 a[238:239], v6 offset:3080
    s_waitcnt lgkmcnt(0)
    v_add_u32 v6, 98304, v4
    v_xor_b32 v7, 32, v6
    s_waitcnt vmcnt(0)
    ds_read_b64_tr_b16 a[240:241], v6 offset:0
    ds_read_b64_tr_b16 a[242:243], v6 offset:1024
    ds_read_b64_tr_b16 a[244:245], v6 offset:8
    ds_read_b64_tr_b16 a[246:247], v6 offset:1032
    ds_read_b64_tr_b16 a[248:249], v6 offset:2048
    ds_read_b64_tr_b16 a[250:251], v6 offset:3072
    ds_read_b64_tr_b16 a[252:253], v6 offset:2056
    ds_read_b64_tr_b16 a[254:255], v6 offset:3080
    s_waitcnt lgkmcnt(0)
    s_barrier
    s_mov_b32 s35, s16
L_op_seg:
    s_sub_u32 s40, s35, 126
    s_lshr_b32 s41, s40, 1
    s_add_u32 s41, s41, 126
    s_and_b32 s40, s40, 1
    s_lshl_b32 s40, s40, 3
    s_lshl_b32 s44, 0x00ff00ff, s40
    s_cmp_ge_u32 s35, 999
    s_cselect_b32 s16, s41, s35
    s_cselect_b32 s44, s44, -1
    s_mov_b32 s45, s44
    s_lshr_b32 s43, s16, 1
    s_add_u32 s43, s43, 1
    s_min_u32 s43, s43, 63
    s_and_b32 s36, s33, 15
    s_lshl_b32 s36, s36, 8
    s_add_u32 s36, s36, 125829120
    s_lshl_b32 s94, s33, 7
    s_add_u32 s94, s94, s16
    s_cmp_ge_u32 s16, 120
    s_cbranch_scc1 L_nocw
    s_mov_b32 s88, 65536
    s_cmp_ge_u32 s47, s43
    s_cbranch_scc1 cw16x
cw16:
    buffer_load_dword v3, off, s[4:7], s36 offset:128 sc1
    s_waitcnt vmcnt(0)
    v_readfirstlane_b32 s42, v3
    s_nop 0
    s_sub_u32 s42, s42, s95
    s_cmp_gt_u32 s42, 64
    s_cselect_b32 s42, 0, s42
    s_add_u32 s42, s42, 2
    s_mov_b32 s47, s42
    s_cmp_ge_u32 s42, s43
    s_cbranch_scc1 cw16x
    s_sub_u32 s88, s88, 1
    s_cbranch_scc1 cw16x
    s_sub_u32 s42, s43, s42
    s_min_u32 s42, s42, 6
cw16s:
    s_sleep 24
    s_sub_u32 s42, s42, 1
    s_cmp_lg_u32 s42, 0
    s_cbranch_scc1 cw16s
    s_branch cw16
cw16x:
L_nocw:
    s_lshr_b32 s89, s16, 1
    s_lshl_b32 s89, s89, 2
    s_add_u32 s89, s89, s32
    s_lshl_b32 s89, s89, 7
    s_add_u32 s89, s89, 125894656
    s_cmp_lg_u32 s46, 0
    s_cbranch_scc1 L_opgo
    v_mbcnt_lo_u32_b32 v2, -1, 0
    v_mbcnt_hi_u32_b32 v2, -1, v2
    v_min_u32 v2, 7, v2
    v_lshlrev_b32 v2, 2, v2
    s_mov_b32 s88, 4194304
fw17:
    buffer_load_dword v3, v2, s[4:7], s89 offen offset:0 sc1
    s_sub_u32 s88, s88, 1
    s_cbranch_scc1 fw17x
    s_waitcnt vmcnt(0)
    v_cmp_ne_u32 vcc, s95, v3
    s_cbranch_vccz fw17x
    s_sleep 2
    s_cmp_gt_u32 s88, 4194256
    s_cbranch_scc1 fw17
    s_sleep 40
    s_branch fw17
fw17x:
L_opgo:
    v_lshrrev_b32 v5, 2, v1
    v_and_b32 v5, 28, v5
    s_add_u32 s89, s89, 1536
    s_mov_b32 s21, 4096
os_again:
    s_lshl_b32 s18, s16, 17
    s_lshl_b32 s19, s32, 15
    s_add_u32 s18, s18, s19
    s_add_u32 s18, s18, 50331648
    s_mov_b64 exec, s[44:45]
    buffer_load_dwordx4 v[32:35], v1, s[4:7], s18 offen offset:0 sc1
    buffer_load_dwordx4 v[36:39], v1, s[4:7], s18 offen offset:1024 sc1
    buffer_load_dwordx4 v[40:43], v1, s[4:7], s18 offen offset:2048 sc1
    buffer_load_dwordx4 v[44:47], v1, s[4:7], s18 offen offset:3072 sc1
    s_add_u32 s18, s18, 4096
    buffer_load_dwordx4 v[48:51], v1, s[4:7], s18 offen offset:0 sc1
    buffer_load_dwordx4 v[52:55], v1, s[4:7], s18 offen offset:1024 sc1
    buffer_load_dwordx4 v[56:59], v1, s[4:7], s18 offen offset:2048 sc1
    buffer_load_dwordx4 v[60:63], v1, s[4:7], s18 offen offset:3072 sc1
    s_add_u32 s18, s18, 4096
    buffer_load_dwordx4 v[64:67], v1, s[4:7], s18 offen offset:0 sc1
    buffer_load_dwordx4 v[68:71], v1, s[4:7], s18 offen offset:1024 sc1
    buffer_load_dwordx4 v[72:75], v1, s[4:7], s18 offen offset:2048 sc1
    buffer_load_dwordx4 v[76:79], v1, s[4:7], s18 offen offset:3072 sc1
    s_add_u32 s18, s18, 4096
    buffer_load_dwordx4 v[80:83], v1, s[4:7], s18 offen offset:0 sc1
    buffer_load_dwordx4 v[84:87], v1, s[4:7], s18 offen offset:1024 sc1
    buffer_load_dwordx4 v[88:91], v1, s[4:7], s18 offen offset:2048 sc1
    buffer_load_dwordx4 v[92:95], v1, s[4:7], s18 offen offset:3072 sc1
    s_add_u32 s18, s18, 4096
    buffer_load_dwordx4 v[96:99], v1, s[4:7], s18 offen offset:0 sc1
    buffer_load_dwordx4 v[100:103], v1, s[4:7], s18 offen offset:1024 sc1
    buffer_load_dwordx4 v[104:107], v1, s[4:7], s18 offen offset:2048 sc1
    buffer_load_dwordx4 v[108:111], v1, s[4:7], s18 offen offset:3072 sc1
    s_add_u32 s18, s18, 4096
    buffer_load_dwordx4 v[112:115], v1, s[4:7], s18 offen offset:0 sc1
    buffer_load_dwordx4 v[116:119], v1, s[4:7], s18 offen offset:1024 sc1
    buffer_load_dwordx4 v[120:123], v1, s[4:7], s18 offen offset:2048 sc1
    buffer_load_dwordx4 v[124:127], v1, s[4:7], s18 offen offset:3072 sc1
    s_add_u32 s18, s18, 4096
    buffer_load_dwordx4 v[128:131], v1, s[4:7], s18 offen offset:0 sc1
    buffer_load_dwordx4 v[132:135], v1, s[4:7], s18 offen offset:1024 sc1
    buffer_load_dwordx4 v[136:139], v1, s[4:7], s18 offen offset:2048 sc1
    buffer_load_dwordx4 v[140:143], v1, s[4:7], s18 offen offset:3072 sc1
    s_add_u32 s18, s18, 4096
    buffer_load_dwordx4 v[144:147], v1, s[4:7], s18 offen offset:0 sc1
    buffer_load_dwordx4 v[148:151], v1, s[4:7], s18 offen offset:1024 sc1
    buffer_load_dwordx4 v[152:155], v1, s[4:7], s18 offen offset:2048 sc1
    buffer_load_dwordx4 v[156:159], v1, s[4:7], s18 offen offset:3072 sc1
    s_mov_b64 exec, -1
    buffer_load_dword v6, v5, s[4:7], s89 offen sc1
    v_lshlrev_b32 v2, 4, v0
    v_and_b32 v3, 3072, v2
    v_lshl_add_u32 v2, v3, 1, v1
    s_waitcnt vmcnt(32)
    v_mfma_f32_16x16x32_bf16 v[8:11], a[0:3], v[32:35], 0
    v_mfma_f32_16x16x32_bf16 v[12:15], a[4:7], v[32:35], 0
    v_mov_b32 v4, v32
    s_waitcnt vmcnt(31)
    v_mfma_f32_16x16x32_bf16 v[8:11], a[8:11], v[36:39], v[8:11]
    v_mfma_f32_16x16x32_bf16 v[12:15], a[12:15], v[36:39], v[12:15]
    v_max_u32 v4, v4, v36
    s_waitcnt vmcnt(30)
    v_mfma_f32_16x16x32_bf16 v[8:11], a[16:19], v[40:43], v[8:11]
    v_mfma_f32_16x16x32_bf16 v[12:15], a[20:23], v[40:43], v[12:15]
    v_max_u32 v4, v4, v40
    s_waitcnt vmcnt(29)
    v_mfma_f32_16x16x32_bf16 v[8:11], a[24:27], v[44:47], v[8:11]
    v_mfma_f32_16x16x32_bf16 v[12:15], a[28:31], v[44:47], v[12:15]
    v_max_u32 v4, v4, v44
    s_waitcnt vmcnt(28)
    v_mfma_f32_16x16x32_bf16 v[8:11], a[32:35], v[48:51], v[8:11]
    v_mfma_f32_16x16x32_bf16 v[12:15], a[36:39], v[48:51], v[12:15]
    v_max_u32 v4, v4, v48
    s_waitcnt vmcnt(27)
    v_mfma_f32_16x16x32_bf16 v[8:11], a[40:43], v[52:55], v[8:11]
    v_mfma_f32_16x16x32_bf16 v[12:15], a[44:47], v[52:55], v[12:15]
    v_max_u32 v4, v4, v52
    s_waitcnt vmcnt(26)
    v_mfma_f32_16x16x32_bf16 v[8:11], a[48:51], v[56:59], v[8:11]
    v_mfma_f32_16x16x32_bf16 v[12:15], a[52:55], v[56:59], v[12:15]
    v_max_u32 v4, v4, v56
    s_waitcnt vmcnt(25)
    v_mfma_f32_16x16x32_bf16 v[8:11], a[56:59], v[60:63], v[8:11]
    v_mfma_f32_16x16x32_bf16 v[12:15], a[60:63], v[60:63], v[12:15]
    v_max_u32 v4, v4, v60
    s_waitcnt vmcnt(24)
    v_mfma_f32_16x16x32_bf16 v[8:11], a[64:67], v[64:67], v[8:11]
    v_mfma_f32_16x16x32_bf16 v[12:15], a[68:71], v[64:67], v[12:15]
    v_max_u32 v4, v4, v64
    s_waitcnt vmcnt(23)
    v_mfma_f32_16x16x32_bf16 v[8:11], a[72:75], v[68:71], v[8:11]
    v_mfma_f32_16x16x32_bf16 v[12:15], a[76:79], v[68:71], v[12:15]
    v_max_u32 v4, v4, v68
    s_waitcnt vmcnt(22)
    v_mfma_f32_16x16x32_bf16 v[8:11], a[80:83], v[72:75], v[8:11]
    v_mfma_f32_16x16x32_bf16 v[12:15], a[84:87], v[72:75], v[12:15]
    v_max_u32 v4, v4, v72
    s_waitcnt vmcnt(21)
    v_mfma_f32_16x16x32_bf16 v[8:11], a[88:91], v[76:79], v[8:11]
    v_mfma_f32_16x16x32_bf16 v[12:15], a[92:95], v[76:79], v[12:15]
    v_max_u32 v4, v4, v76
    s_waitcnt vmcnt(20)
    v_mfma_f32_16x16x32_bf16 v[8:11], a[96:99], v[80:83], v[8:11]
    v_mfma_f32_16x16x32_bf16 v[12:15], a[100:103], v[80:83], v[12:15]
    v_max_u32 v4, v4, v80
    s_waitcnt vmcnt(19)
    v_mfma_f32_16x16x32_bf16 v[8:11], a[104:107], v[84:87], v[8:11]
    v_mfma_f32_16x16x32_bf16 v[12:15], a[108:111], v[84:87], v[12:15]
    v_max_u32 v4, v4, v84
    s_waitcnt vmcnt(18)
    v_mfma_f32_16x16x32_bf16 v[8:11], a[112:115], v[88:91], v[8:11]
    v_mfma_f32_16x16x32_bf16 v[12:15], a[116:119], v[88:91], v[12:15]
    v_max_u32 v4, v4, v88
    s_waitcnt vmcnt(17)
    v_mfma_f32_16x16x32_bf16 v[8:11], a[120:123], v[92:95], v[8:11]
    v_mfma_f32_16x16x32_bf16 v[12:15], a[124:127], v[92:95], v[12:15]
    v_max_u32 v4, v4, v92
    s_waitcnt vmcnt(16)
    v_mfma_f32_16x16x32_bf16 v[8:11], a[128:131], v[96:99], v[8:11]
    v_mfma_f32_16x16x32_bf16 v[12:15], a[132:135], v[96:99], v[12:15]
    v_max_u32 v4, v4, v96
    s_waitcnt vmcnt(15)
    v_mfma_f32_16x16x32_bf16 v[8:11], a[136:139], v[100:103], v[8:11]
    v_mfma_f32_16x16x32_bf16 v[12:15], a[140:143], v[100:103], v[12:15]
    v_max_u32 v4, v4, v100
    s_waitcnt vmcnt(14)
    v_mfma_f32_16x16x32_bf16 v[8:11], a[144:147], v[104:107], v[8:11]
    v_mfma_f32_16x16x32_bf16 v[12:15], a[148:151], v[104:107], v[12:15]
    v_max_u32 v4, v4, v104
    s_waitcnt vmcnt(13)
    v_mfma_f32_16x16x32_bf16 v[8:11], a[152:155], v[108:111], v[8:11]
    v_mfma_f32_16x16x32_bf16 v[12:15], a[156:159], v[108:111], v[12:15]
    v_max_u32 v4, v4, v108
    s_waitcnt vmcnt(12)
    v_mfma_f32_16x16x32_bf16 v[8:11], a[160:163], v[112:115], v[8:11]
    v_mfma_f32_16x16x32_bf16 v[12:15], a[164:167], v[112:115], v[12:15]
    v_max_u32 v4, v4, v112
    s_waitcnt vmcnt(11)
    v_mfma_f32_16x16x32_bf16 v[8:11], a[168:171], v[116:119], v[8:11]
    v_mfma_f32_16x16x32_bf16 v[12:15], a[172:175], v[116:119], v[12:15]
    v_max_u32 v4, v4, v116
    s_waitcnt vmcnt(10)
    v_mfma_f32_16x16x32_bf16 v[8:11], a[176:179], v[120:123], v[8:11]
    v_mfma_f32_16x16x32_bf16 v[12:15], a[180:183], v[120:123], v[12:15]
    v_max_u32 v4, v4, v120
    s_waitcnt vmcnt(9)
    v_mfma_f32_16x16x32_bf16 v[8:11], a[184:187], v[124:127], v[8:11]
    v_mfma_f32_16x16x32_bf16 v[12:15], a[188:191], v[124:127], v[12:15]
    v_max_u32 v4, v4, v124
    s_waitcnt vmcnt(8)
    v_mfma_f32_16x16x32_bf16 v[8:11], a[192:195], v[128:131], v[8:11]
    v_mfma_f32_16x16x32_bf16 v[12:15], a[196:199], v[128:131], v[12:15]
    v_max_u32 v4, v4, v128
    s_waitcnt vmcnt(7)
    v_mfma_f32_16x16x32_bf16 v[8:11], a[200:203], v[132:135], v[8:11]
    v_mfma_f32_16x16x32_bf16 v[12:15], a[204:207], v[132:135], v[12:15]
    v_max_u32 v4, v4, v132
    s_waitcnt vmcnt(6)
    v_mfma_f32_16x16x32_bf16 v[8:11], a[208:211], v[136:139], v[8:11]
    v_mfma_f32_16x16x32_bf16 v[12:15], a[212:215], v[136:139], v[12:15]
    v_max_u32 v4, v4, v136
    s_waitcnt vmcnt(5)
    v_mfma_f32_16x16x32_bf16 v[8:11], a[216:219], v[140:143], v[8:11]
    v_mfma_f32_16x16x32_bf16 v[12:15], a[220:223], v[140:143], v[12:15]
    v_max_u32 v4, v4, v140
    s_waitcnt vmcnt(4)
    v_mfma_f32_16x16x32_bf16 v[8:11], a[224:227], v[144:147], v[8:11]
    v_mfma_f32_16x16x32_bf16 v[12:15], a[228:231], v[144:147], v[12:15]
    v_max_u32 v4, v4, v144
    s_waitcnt vmcnt(3)
    v_mfma_f32_16x16x32_bf16 v[8:11], a[232:235], v[148:151], v[8:11]
    v_mfma_f32_16x16x32_bf16 v[12:15], a[236:239], v[148:151], v[12:15]
    v_max_u32 v4, v4, v148
    s_waitcnt vmcnt(2)
    v_mfma_f32_16x16x32_bf16 v[8:11], a[240:243], v[152:155], v[8:11]
    v_mfma_f32_16x16x32_bf16 v[12:15], a[244:247], v[152:155], v[12:15]
    v_max_u32 v4, v4, v152
    s_waitcnt vmcnt(1)
    v_mfma_f32_16x16x32_bf16 v[8:11], a[248:251], v[156:159], v[8:11]
    v_mfma_f32_16x16x32_bf16 v[12:15], a[252:255], v[156:159], v[12:15]
    v_max_u32 v4, v4, v156
    v_cmp_eq_u32 vcc, -1, v4
    s_nop 0
    s_and_b64 vcc, vcc, s[44:45]
    s_sub_u32 s21, s21, 1
    s_nop 1
    s_cbranch_scc1 os_ok
    s_cbranch_vccnz os_again
os_ok:
    ds_write_b128 v2, v[8:11] offset:0
    ds_write_b128 v2, v[12:15] offset:1024
    s_waitcnt lgkmcnt(0)
    s_barrier
    s_waitcnt vmcnt(0)
    v_cmp_ne_u32 vcc, s95, v6
    s_nop 0
    s_cmp_eq_u64 vcc, 0
    s_cselect_b32 s46, 1, 0
    s_cmp_lg_u32 s32, 0
    s_cbranch_scc1 os_skip
    ds_read_b128 v[40:43], v1 offset:2048
    ds_read_b128 v[44:47], v1 offset:3072
    ds_read_b128 v[48:51], v1 offset:4096
    ds_read_b128 v[52:55], v1 offset:5120
    ds_read_b128 v[56:59], v1 offset:6144
    ds_read_b128 v[60:63], v1 offset:7168
    v_lshrrev_b32 v3, 4, v1
    v_bfe_u32 v4, v3, 2, 2
    v_lshlrev_b32 v4, 3, v4
    v_and_b32 v2, 3, v3
    v_add_u32 v4, v4, v2
    v_mul_u32_u24 v4, 2304, v4
    v_lshrrev_b32 v3, 4, v3
    v_lshl_add_u32 v4, v3, 4, v4
    s_lshr_b32 s18, s16, 1
    s_lshl_b32 s18, s18, 3
    s_and_b32 s19, s16, 1
    s_add_u32 s18, s18, s19
    s_mul_i32 s18, s18, 9216
    s_lshl_b32 s19, s33, 6
    s_add_u32 s18, s18, s19
    s_waitcnt lgkmcnt(0)
    v_pk_add_f32 v[8:9], v[8:9], v[40:41]
    v_pk_add_f32 v[48:49], v[48:49], v[56:57]
    v_pk_add_f32 v[8:9], v[8:9], v[48:49]
    v_pk_add_f32 v[10:11], v[10:11], v[42:43]
    v_pk_add_f32 v[50:51], v[50:51], v[58:59]
    v_pk_add_f32 v[10:11], v[10:11], v[50:51]
    v_pk_add_f32 v[12:13], v[12:13], v[44:45]
    v_pk_add_f32 v[52:53], v[52:53], v[60:61]
    v_pk_add_f32 v[12:13], v[12:13], v[52:53]
    v_pk_add_f32 v[14:15], v[14:15], v[46:47]
    v_pk_add_f32 v[54:55], v[54:55], v[62:63]
    v_pk_add_f32 v[14:15], v[14:15], v[54:55]
    v_cvt_pk_bf16_f32 v32, v8, v9
    v_cvt_pk_bf16_f32 v33, v10, v11
    v_cvt_pk_bf16_f32 v34, v12, v13
    v_cvt_pk_bf16_f32 v35, v14, v15
    s_mov_b64 exec, s[44:45]
    buffer_store_dwordx4 v[32:35], v4, s[8:11], s18 offen sc1
    s_mov_b64 exec, -1
os_skip:
    s_nop 0
    s_add_u32 s35, s35, 6
    s_cmp_ge_u32 s35, 128
    s_cbranch_scc1 L_done
    s_barrier
    s_branch L_op_seg
L_done:
L_exit:
    s_endpgm
.section .rodata,"a"
.p2align 6
.amdhsa_kernel concat_heads__memory_aug_recurrent_mem_tr__ssm_conv_s4d__prompt_kernel
  .amdhsa_next_free_vgpr 512
  .amdhsa_next_free_sgpr 102
  .amdhsa_accum_offset 256
  .amdhsa_group_segment_fixed_size 0
  .amdhsa_kernarg_size 136
  .amdhsa_user_sgpr_count 2
  .amdhsa_user_sgpr_kernarg_segment_ptr 1
  .amdhsa_system_sgpr_workgroup_id_x 1
.end_amdhsa_kernel
.text
```

```asm
; @launch grid=(256,1,1) block=(256,1,1) lds=163840
.amdgcn_target "amdgcn-amd-amdhsa--gfx950"
.text
.globl concat_heads__memory_aug_recurrent_mem_tr__ssm_conv_s4d__prompt_kernel
.p2align 8
.type concat_heads__memory_aug_recurrent_mem_tr__ssm_conv_s4d__prompt_kernel,@function
concat_heads__memory_aug_recurrent_mem_tr__ssm_conv_s4d__prompt_kernel:
    s_cmp_ge_u32 s2, 256
    s_cbranch_scc1 L_exit
    s_load_dwordx4 s[84:87], s[0:1], 120
    s_load_dwordx16 s[48:63], s[0:1], 0
    v_lshrrev_b32 v1, 6, v0
    s_nop 0
    v_readfirstlane_b32 s32, v1
    s_getreg_b32 s3, hwreg(HW_REG_XCC_ID)
    s_and_b32 s3, s3, 15
    s_cmp_lg_u32 s32, 3
    s_cbranch_scc1 L_nowarm
    s_getpc_b64 s[44:45]
L_pcw:
    v_and_b32 v1, 63, v0
    v_lshlrev_b32 v1, 7, v1
    s_cmp_lg_u32 s3, 3
    s_cselect_b32 s33, L_helper-L_pcw, 0
    v_add_u32 v1, s33, v1
    v_min_u32 v2, L_exit-L_pcw, v1
    global_load_dword v240, v2, s[44:45]
    v_add_u32 v1, 8192, v1
    v_min_u32 v2, L_exit-L_pcw, v1
    global_load_dword v241, v2, s[44:45]
    v_add_u32 v1, 8192, v1
    s_cbranch_scc0 L_nowarm
    v_min_u32 v2, L_exit-L_pcw, v1
    global_load_dword v242, v2, s[44:45]
    v_add_u32 v1, 8192, v1
    v_min_u32 v2, L_exit-L_pcw, v1
    global_load_dword v243, v2, s[44:45]
    v_add_u32 v1, 8192, v1
L_nowarm:
    s_waitcnt lgkmcnt(0)
    s_mov_b32 s4, s86
    s_mov_b32 s5, s87
    s_mov_b32 s6, 268435456
    s_mov_b32 s7, 0x20000
    s_mov_b32 s96, s84
    s_mov_b32 s97, s85
    s_mov_b32 s98, 256
    s_mov_b32 s99, 0x20000
    s_mov_b32 s95, 0
    s_cmp_lg_u32 s3, 3
    s_cbranch_scc1 L_helper
    s_mov_b32 s37, 128
    v_mov_b32 v250, 1
    v_mov_b32 v251, 163832
    v_cmp_eq_u32 vcc, 0, v0
    s_nop 0
    s_and_saveexec_b64 s[38:39], vcc
    s_cbranch_execz tk1m
    buffer_atomic_add v250, off, s[96:99], s37 sc0
tk1m:
    s_mov_b64 s[38:39], exec
    s_mov_b64 exec, -1
    v_lshrrev_b32 v54, 6, v0
    s_nop 0
    v_readfirstlane_b32 s13, v54
    v_and_b32 v57, 63, v0
    v_bfe_u32 v54, v57, 2, 1
    v_lshlrev_b32 v48, 13, v54
    v_bfe_u32 v54, v57, 3, 1
    v_lshl_add_u32 v48, v54, 15, v48
    v_bfe_u32 v54, v57, 4, 1
    v_lshl_add_u32 v48, v54, 14, v48
    v_bfe_u32 v54, v57, 5, 1
    v_lshl_add_u32 v48, v54, 16, v48
    v_lshrrev_b32 v55, 4, v57
    v_and_b32 v55, 2, v55
    v_xor_b32 v55, v55, v57
    v_and_b32 v55, 3, v55
    v_lshl_add_u32 v48, v55, 4, v48
    v_bfe_u32 v54, v57, 2, 1
    v_lshlrev_b32 v51, 6, v54
    v_bfe_u32 v54, v57, 3, 1
    v_lshl_add_u32 v51, v54, 9, v51
    v_bfe_u32 v54, v57, 4, 1
    v_lshl_add_u32 v51, v54, 7, v51
    v_bfe_u32 v54, v57, 5, 1
    v_lshl_add_u32 v51, v54, 12, v51
    v_bfe_u32 v54, v57, 0, 1
    v_lshl_add_u32 v51, v54, 3, v51
    v_bfe_u32 v54, v57, 1, 1
    v_lshl_add_u32 v51, v54, 4, v51
    v_bfe_u32 v54, v57, 3, 1
    v_lshl_add_u32 v51, v54, 5, v51
    v_lshrrev_b32 v55, 3, v57
    v_mul_u32_u24 v49, 1152, v55
    v_and_b32 v55, 7, v57
    v_lshl_add_u32 v49, v55, 4, v49
    v_bfe_u32 v54, v57, 4, 1
    v_lshlrev_b32 v52, 13, v54
    v_bfe_u32 v54, v57, 5, 1
    v_lshl_add_u32 v52, v54, 9, v52
    v_bfe_u32 v54, v57, 2, 1
    v_lshl_add_u32 v52, v54, 7, v52
    v_bfe_u32 v54, v57, 3, 1
    v_lshl_add_u32 v52, v54, 5, v52
    v_and_b32 v55, 3, v57
    v_lshl_add_u32 v52, v55, 3, v52
    v_lshrrev_b32 v55, 2, v57
    v_mul_u32_u24 v50, 1152, v55
    v_and_b32 v55, 3, v57
    v_lshl_add_u32 v50, v55, 4, v50
    v_bfe_u32 v54, v57, 4, 1
    v_lshlrev_b32 v53, 12, v54
    v_bfe_u32 v54, v57, 5, 1
    v_lshl_add_u32 v53, v54, 8, v53
    v_bfe_u32 v54, v57, 2, 1
    v_lshl_add_u32 v53, v54, 6, v53
    v_bfe_u32 v54, v57, 3, 1
    v_lshl_add_u32 v53, v54, 5, v53
    v_and_b32 v55, 3, v57
    v_lshl_add_u32 v53, v55, 3, v53
    s_lshl_b32 s66, s13, 10
    s_and_b32 s93, s13, 1
    s_lshl_b32 s93, s93, 14
    s_and_b32 s75, s13, 2
    s_lshl_b32 s75, s75, 19
    v_add_u32 v51, s66, v51
    v_add_u32 v52, s66, v52
    v_add_u32 v53, s66, v53
    v_mov_b32 v58, v48
    s_mov_b32 s10, 4718592
    s_mov_b32 s11, 0x20000
    s_mov_b64 exec, s[38:39]
    s_cbranch_execz tk1
    s_waitcnt vmcnt(0)
    ds_write_b32 v251, v250
    s_waitcnt lgkmcnt(0)
tk1:
    s_mov_b64 exec, -1
    s_barrier
    ds_read_b32 v252, v251
    s_waitcnt lgkmcnt(0)
    v_readfirstlane_b32 s12, v252
    s_barrier
    s_nop 3
    s_cmp_ge_u32 s12, 32
    s_cbranch_scc1 L_helper
L_chain:
    s_mov_b64 s[48:49], s[50:51]
    s_mov_b64 s[50:51], s[52:53]
    s_mov_b64 s[52:53], s[54:55]
    s_mov_b64 s[54:55], s[56:57]
    s_mov_b64 s[56:57], s[58:59]
    s_lshl_b32 s67, s12, 8
    s_lshl_b32 s40, s13, 6
    s_add_u32 s67, s67, s40
    s_mul_i32 s92, s12, 147456
    s_lshr_b32 s73, s50, 8
    s_add_u32 s73, s73, s12
    s_and_b32 s73, s73, 31
    s_bitcmp1_b32 0xa2222222, s73
    s_cselect_b32 s88, 1, 0
    s_mov_b32 s72, 0
    s_add_u32 s73, s73, 1
    s_lshr_b32 s73, s73, 2
    s_xor_b32 s94, s13, 0
    s_mul_i32 s94, s94, 36864
    s_add_u32 s94, s94, s92
    s_lshl_b32 s74, s13, 7
    s_add_u32 s94, s94, s74
    s_add_u32 s78, s94, 0
    s_mov_b64 s[8:9], s[56:57]
    v_mov_b32 v58, v49
    s_mov_b32 s79, 9216
    s_mov_b32 s81, 0
    s_add_u32 s80, s66, 114688
    s_mov_b32 s76, 0
    s_mov_b32 s77, 8192
    s_call_b64 s[82:83], cf_dma
    s_mov_b32 s77, 16384
    s_call_b64 s[82:83], cf_dma
    s_xor_b32 s94, s13, 1
    s_mul_i32 s94, s94, 36864
    s_add_u32 s94, s94, s92
    s_lshl_b32 s74, s13, 7
    s_add_u32 s94, s94, s74
    s_add_u32 s78, s94, 0
    s_add_u32 s80, s66, 81920
    s_mov_b32 s76, 0
    s_mov_b32 s77, 8192
    s_call_b64 s[82:83], cf_dma
    s_mov_b32 s77, 16384
    s_call_b64 s[82:83], cf_dma
    s_xor_b32 s94, s13, 2
    s_mul_i32 s94, s94, 36864
    s_add_u32 s94, s94, s92
    s_lshl_b32 s74, s13, 7
    s_add_u32 s94, s94, s74
    s_add_u32 s78, s94, 0
    s_add_u32 s80, s66, 16384
    s_mov_b32 s76, 0
    s_mov_b32 s77, 8192
    s_call_b64 s[82:83], cf_dma
    s_mov_b32 s77, 16384
    s_call_b64 s[82:83], cf_dma
    s_xor_b32 s94, s13, 3
    s_mul_i32 s94, s94, 36864
    s_add_u32 s94, s94, s92
    s_lshl_b32 s74, s13, 7
    s_add_u32 s94, s94, s74
    s_add_u32 s78, s94, 0
    s_add_u32 s80, s66, 0
    s_mov_b32 s76, 0
    s_mov_b32 s77, 8192
    s_call_b64 s[82:83], cf_dma
    s_mov_b32 s77, 16384
    s_call_b64 s[82:83], cf_dma
    v_lshrrev_b32 v24, 6, v0
    v_lshlrev_b32 v61, 4, v0
    v_add_u32 v62, 57344, v61
    v_xor_b32 v63, 1024, v61
    v_add_u32 v63, 98304, v63
    v_xor_b32 v64, 2048, v61
    v_add_u32 v64, 98304, v64
    v_and_b32 v65, 1023, v61
    v_add_u32 v65, 98304, v65
    v_and_b32 v26, 15, v0
    v_bfe_u32 v27, v0, 4, 2
    v_mov_b32 v60, 0x4444
    v_mov_b32 v25, 0xeeee
    v_cmp_lt_u32 vcc, 7, v26
    s_nop 1
    v_cndmask_b32 v60, v60, v25, vcc
    s_nop 1
    v_and_b32 v67, 12, v26
    v_lshlrev_b32 v67, 3, v67
    v_and_b32 v25, 1, v26
    v_lshl_add_u32 v67, v25, 4, v67
    v_bfe_u32 v25, v26, 1, 1
    v_lshl_add_u32 v67, v25, 3, v67
    v_lshl_add_u32 v66, v27, 14, v67
    v_lshl_add_u32 v66, v24, 17, v66
    s_nop 1
    v_and_b32 v67, 63, v67
    v_lshrrev_b32 v25, 1, v24
    v_lshl_add_u32 v67, v25, 18, v67
    v_lshl_add_u32 v67, v27, 16, v67
    v_lshrrev_b32 v25, 3, v26
    v_lshl_add_u32 v67, v25, 15, v67
    v_and_b32 v25, 1, v24
    v_lshl_add_u32 v67, v25, 6, v67
    s_nop 1
    s_waitcnt vmcnt(12)
    v_add_u32 v55, 114688, v52
    ds_read_b64_tr_b16 v[160:161], v55 offset:0
    ds_read_b64_tr_b16 v[162:163], v55 offset:256
    ds_read_b64_tr_b16 v[164:165], v55 offset:4096
    ds_read_b64_tr_b16 v[166:167], v55 offset:4352
    s_xor_b32 s94, s13, 0
    s_mul_i32 s94, s94, 36864
    s_add_u32 s94, s94, s92
    s_lshl_b32 s74, s13, 7
    s_add_u32 s94, s94, s74
    s_add_u32 s78, s94, 512
    s_add_u32 s80, s66, 147456
    s_mov_b32 s76, 0
    s_mov_b32 s77, 8192
    s_call_b64 s[82:83], cf_dma
    ds_read_b64_tr_b16 v[192:193], v55 offset:64
    ds_read_b64_tr_b16 v[194:195], v55 offset:320
    ds_read_b64_tr_b16 v[196:197], v55 offset:4160
    ds_read_b64_tr_b16 v[198:199], v55 offset:4416
    s_mov_b32 s77, 16384
    s_call_b64 s[82:83], cf_dma
    v_and_b32 v25, 31, v0
    v_lshlrev_b32 v70, 4, v25
    v_lshlrev_b32 v28, 3, v25
    v_add_u32 v28, 108032, v28
    v_lshrrev_b32 v25, 1, v24
    v_lshl_add_u32 v70, v25, 9, v70
    v_and_b32 v25, 1, v24
    v_lshl_add_u32 v70, v25, 3, v70
    v_add_u32 v70, 109568, v70
    v_cmp_gt_u32 vcc, 2, v27
    s_nop 1
    v_cndmask_b32 v70, v70, v28, vcc
    s_nop 1
    s_waitcnt lgkmcnt(0)
    s_waitcnt vmcnt(12)
    v_add_u32 v55, 81920, v52
    ds_read_b64_tr_b16 v[168:169], v55 offset:0
    ds_read_b64_tr_b16 v[170:171], v55 offset:256
    ds_read_b64_tr_b16 v[172:173], v55 offset:4096
    ds_read_b64_tr_b16 v[174:175], v55 offset:4352
    s_xor_b32 s94, s13, 1
    s_mul_i32 s94, s94, 36864
    s_add_u32 s94, s94, s92
    s_lshl_b32 s74, s13, 7
    s_add_u32 s94, s94, s74
    s_add_u32 s78, s94, 512
    s_add_u32 s80, s66, 98304
    s_mov_b32 s76, 0
    s_mov_b32 s77, 8192
    s_call_b64 s[82:83], cf_dma
    ds_read_b64_tr_b16 v[200:201], v55 offset:64
    ds_read_b64_tr_b16 v[202:203], v55 offset:320
    ds_read_b64_tr_b16 v[204:205], v55 offset:4160
    ds_read_b64_tr_b16 v[206:207], v55 offset:4416
    s_mov_b32 s77, 16384
    s_call_b64 s[82:83], cf_dma
    v_xor_b32 v71, 2048, v63
    v_lshrrev_b32 v68, 4, v0
    v_lshlrev_b32 v68, 7, v68
    v_and_b32 v25, 7, v26
    v_lshl_add_u32 v68, v25, 4, v68
    v_add_u32 v68, 102400, v68
    v_xor_b32 v74, 512, v68
    v_xor_b32 v75, 1024, v68
    v_xor_b32 v76, 1536, v68
    v_lshrrev_b32 v25, 3, v26
    v_lshl_add_u32 v77, v25, 3, v68
    v_or_b32 v78, 512, v65
    v_lshlrev_b32 v79, 2, v61
    v_mov_b64 v[72:73], 0
    v_and_b32 v25, 1, v27
    v_lshlrev_b32 v69, 7, v25
    v_lshrrev_b32 v25, 1, v27
    v_lshl_add_u32 v69, v25, 3, v69
    v_and_b32 v25, 3, v26
    v_lshl_add_u32 v69, v25, 4, v69
    v_bfe_u32 v25, v26, 2, 1
    v_lshl_add_u32 v69, v25, 2, v69
    s_nop 1
    s_waitcnt lgkmcnt(0)
    s_waitcnt vmcnt(12)
    v_add_u32 v55, 16384, v52
    ds_read_b64_tr_b16 v[176:177], v55 offset:0
    ds_read_b64_tr_b16 v[178:179], v55 offset:256
    ds_read_b64_tr_b16 v[180:181], v55 offset:4096
    ds_read_b64_tr_b16 v[182:183], v55 offset:4352
    s_add_u32 s78, s67, 4194304
    s_mov_b64 s[8:9], s[54:55]
    v_mov_b32 v58, v48
    s_mov_b32 s79, 131072
    s_add_u32 s80, s66, 32768
    s_mov_b32 s76, 0
    s_mov_b32 s77, 8192
    s_call_b64 s[82:83], cf_dma
    ds_read_b64_tr_b16 v[208:209], v55 offset:64
    ds_read_b64_tr_b16 v[210:211], v55 offset:320
    ds_read_b64_tr_b16 v[212:213], v55 offset:4160
    ds_read_b64_tr_b16 v[214:215], v55 offset:4416
    s_mov_b32 s77, 16384
    s_call_b64 s[82:83], cf_dma
    s_mov_b32 s32, 0x00ff00ff
    s_mov_b32 s33, 0x00ff00ff
    s_not_b64 s[34:35], s[32:33]
    s_lshr_b32 s31, s12, 1
    s_lshl_b32 s31, s31, 8
    s_and_b32 s40, s12, 1
    s_lshl_b32 s40, s40, 6
    s_add_u32 s31, s31, s40
    s_and_b32 s40, s13, 1
    s_lshl_b32 s40, s40, 12
    s_add_u32 s31, s31, s40
    s_lshl_b32 s19, s12, 14
    s_add_u32 s19, s19, 67076096
    s_add_u32 s41, s19, 8192
    s_add_u32 s19, s19, s40
    s_and_b32 s40, s12, 1
    s_lshl_b32 s40, s40, 2
    s_or_b32 s40, s40, s13
    s_cmp_eq_u32 s40, 5
    s_cselect_b32 s64, 0, s13
    s_cmp_lg_u32 s13, 1
    s_cbranch_scc1 cf_notx
    s_mov_b32 s32, 0xff
    s_mov_b32 s33, 0xff
    s_mov_b32 s19, s41
    s_lshr_b32 s31, s12, 3
    s_lshl_b32 s31, s31, 8
    s_and_b32 s40, s12, 2
    s_lshl_b32 s40, s40, 6
    s_add_u32 s31, s31, s40
    s_and_b32 s40, s12, 4
    s_lshl_b32 s40, s40, 4
    s_add_u32 s31, s31, s40
    s_add_u32 s31, s31, 8192
cf_notx:
    s_cmp_lg_u32 s13, 0
    s_cbranch_scc1 cf_notp
    s_min_u32 s40, s12, 23
    s_mul_i32 s40, s40, 384
    s_add_u32 s40, s40, 98304
    v_add_u32 v69, s40, v61
    v_mov_b32 v25, 108288
    v_cmp_lt_u32 vcc, 23, v0
    s_nop 1
    v_cndmask_b32 v69, v69, v25, vcc
cf_notp:
    s_nop 1
    s_waitcnt lgkmcnt(0)
    s_waitcnt vmcnt(12)
    v_add_u32 v55, 0, v52
    ds_read_b64_tr_b16 v[184:185], v55 offset:0
    ds_read_b64_tr_b16 v[186:187], v55 offset:256
    ds_read_b64_tr_b16 v[188:189], v55 offset:4096
    ds_read_b64_tr_b16 v[190:191], v55 offset:4352
    s_xor_b32 s78, s75, 0
    s_add_u32 s78, s78, s67
    s_mov_b32 s81, s93
    s_add_u32 s80, s66, 114688
    s_mov_b32 s76, 0
    s_mov_b32 s77, 8192
    s_call_b64 s[82:83], cf_dma
    ds_read_b64_tr_b16 v[216:217], v55 offset:64
    ds_read_b64_tr_b16 v[218:219], v55 offset:320
    ds_read_b64_tr_b16 v[220:221], v55 offset:4160
    ds_read_b64_tr_b16 v[222:223], v55 offset:4416
    s_mov_b32 s77, 16384
    s_call_b64 s[82:83], cf_dma
    v_mov_b32 v28, 1
    v_mov_b32 v29, 1
    v_mov_b32 v30, 1
    v_mov_b32 v31, 1
    s_lshl_b32 s40, s12, 14
    s_add_u32 s40, s40, 67174400
    s_add_u32 s41, s40, 0
    buffer_store_dwordx4 v[28:31], v61, s[4:7], s41 offen
    s_add_u32 s41, s40, 4096
    buffer_store_dwordx4 v[28:31], v61, s[4:7], s41 offen
    s_add_u32 s41, s40, 8192
    buffer_store_dwordx4 v[28:31], v61, s[4:7], s41 offen
    s_cmp_eq_u32 s64, 0
    s_cselect_b64 exec, 0, s[32:33]
    v_mov_b32 v27, -1
    s_add_u32 s41, s31, 67108864
    buffer_store_dword v27, v69, s[4:7], s41 offen
    s_add_u32 s41, s31, 67125248
    buffer_store_dword v27, v69, s[4:7], s41 offen
    s_add_u32 s41, s31, 67141632
    buffer_store_dword v27, v69, s[4:7], s41 offen
    s_add_u32 s41, s31, 67158016
    buffer_store_dword v27, v69, s[4:7], s41 offen
    s_mov_b64 exec, -1
    s_waitcnt lgkmcnt(0)
    s_waitcnt vmcnt(12)
    v_add_u32 v55, 147456, v52
    ds_read_b64_tr_b16 v[224:225], v55 offset:0
    ds_read_b64_tr_b16 v[226:227], v55 offset:256
    ds_read_b64_tr_b16 v[228:229], v55 offset:4096
    ds_read_b64_tr_b16 v[230:231], v55 offset:4352
    s_mov_b32 s77, 24576
    s_call_b64 s[82:83], cf_dma
    ds_read_b64_tr_b16 v[240:241], v55 offset:64
    ds_read_b64_tr_b16 v[242:243], v55 offset:320
    ds_read_b64_tr_b16 v[244:245], v55 offset:4160
    ds_read_b64_tr_b16 v[246:247], v55 offset:4416
    s_mov_b32 s77, 32768
    s_call_b64 s[82:83], cf_dma
    s_mov_b64 s[68:69], s[48:49]
    s_mov_b32 s70, 9216
    s_mov_b32 s71, 0x20000
    v_and_b32 v25, 7, v0
    v_mul_u32_u24 v25, 1152, v25
    v_lshrrev_b32 v26, 3, v0
    v_lshl_add_u32 v25, v26, 4, v25
    buffer_load_dwordx4 v[36:39], v25, s[68:71], 0 offen
    buffer_load_dwordx4 v[40:43], v25, s[68:71], 0 offen offset:512
    v_bfe_u32 v25, v0, 2, 3
    v_mul_u32_u24 v25, 1152, v25
    v_lshrrev_b32 v26, 5, v0
    v_lshl_add_u32 v25, v26, 4, v25
    v_and_b32 v26, 3, v0
    v_lshl_add_u32 v25, v26, 2, v25
    buffer_load_dword v44, v25, s[68:71], 0 offen offset:1024
    s_nop 0
    s_waitcnt lgkmcnt(0)
    s_waitcnt vmcnt(15)
    v_add_u32 v55, 98304, v52
    ds_read_b64_tr_b16 v[232:233], v55 offset:0
    ds_read_b64_tr_b16 v[234:235], v55 offset:256
    ds_read_b64_tr_b16 v[236:237], v55 offset:4096
    ds_read_b64_tr_b16 v[238:239], v55 offset:4352
    s_xor_b32 s78, s75, 1048576
    s_add_u32 s78, s78, s67
    s_add_u32 s80, s66, 65536
    s_mov_b32 s76, 0
    s_mov_b32 s77, 8192
    s_call_b64 s[82:83], cf_dma
    ds_read_b64_tr_b16 v[248:249], v55 offset:64
    ds_read_b64_tr_b16 v[250:251], v55 offset:320
    ds_read_b64_tr_b16 v[252:253], v55 offset:4160
    ds_read_b64_tr_b16 v[254:255], v55 offset:4416
    s_mov_b32 s77, 16384
    s_call_b64 s[82:83], cf_dma
    s_mov_b32 s44, 0x3e0293ee
    s_mov_b32 s45, s44
    s_mov_b32 s46, 0x42000000
    s_mov_b32 s60, 0x3f803f80
    s_mov_b32 s61, s60
    s_mov_b32 s62, 0x3e803e80
    s_mov_b32 s63, s62
    s_mov_b32 s28, 0
    s_lshl_b32 s58, s13, 10
    s_add_u32 s58, s58, 102400
    s_lshl_b32 s59, s13, 8
    s_add_u32 s59, s59, 106496
    s_lshl_b32 s24, s12, 14
    s_add_u32 s24, s24, 0
    s_add_u32 s47, s24, 33030144
    s_mul_i32 s40, s13, 3072
    s_add_u32 s23, s24, s40
    s_lshl_b32 s20, s12, 7
    s_add_u32 s20, s20, 67174400
    s_add_u32 s21, s20, 65536
    s_add_u32 s38, s20, 4096
    s_add_u32 s39, s21, 4096
    s_lshl_b32 s22, s12, 7
    s_add_u32 s22, s22, 67182592
    s_waitcnt lgkmcnt(0)
    s_waitcnt vmcnt(15)
    v_add_u32 v55, 32768, v51
    v_xor_b32 v56, 32, v55
    ds_read_b64_tr_b16 v[144:145], v55 offset:0
    ds_read_b64_tr_b16 v[146:147], v55 offset:256
    ds_read_b64_tr_b16 v[148:149], v55 offset:8192
    ds_read_b64_tr_b16 v[150:151], v55 offset:8448
    s_mov_b32 s77, 24576
    s_call_b64 s[82:83], cf_dma
    ds_read_b64_tr_b16 v[152:153], v56 offset:0
    ds_read_b64_tr_b16 v[154:155], v56 offset:256
    ds_read_b64_tr_b16 v[156:157], v56 offset:8192
    ds_read_b64_tr_b16 v[158:159], v56 offset:8448
    s_mov_b32 s77, 32768
    s_call_b64 s[82:83], cf_dma
    s_lshl_b32 s40, s12, 12
    s_add_u32 s25, s40, 79429632
    s_add_u32 s26, s40, 88866816
    s_lshl_b32 s65, s12, 9
    s_add_u32 s65, s65, 90177536
    s_lshl_b32 s40, s13, 5
    s_or_b32 s40, s40, s12
    s_cmp_lt_u32 s40, 24
    s_cselect_b32 s36, 0x1ffffff, 0
    s_mov_b32 s37, 0
    s_lshl_b32 s27, s12, 7
    s_add_u32 s27, s27, 125845504
    s_lshl_b32 s40, s13, 2
    s_add_u32 s27, s27, s40
    v_bfe_u32 v28, v61, 4, 4
    v_bfe_u32 v29, v61, 8, 1
    v_lshlrev_b32 v29, 2, v29
    v_sub_u32 v29, v28, v29
    v_mov_b32 v31, 0x3f80
    v_mov_b32 v32, 0x3f800000
    s_nop 1
    s_waitcnt lgkmcnt(0)
    s_waitcnt vmcnt(11)
    v_add_u32 v55, 114688, v51
    v_xor_b32 v56, 32, v55
    ds_read_b64_tr_b16 a[192:193], v55 offset:0
    ds_read_b64_tr_b16 a[194:195], v55 offset:256
    ds_read_b64_tr_b16 a[196:197], v55 offset:8192
    ds_read_b64_tr_b16 a[198:199], v55 offset:8448
    s_xor_b32 s78, s75, 2097152
    s_add_u32 s78, s78, s67
    s_add_u32 s80, s66, 0
    s_mov_b32 s76, 0
    s_mov_b32 s77, 8192
    s_call_b64 s[82:83], cf_dma
    ds_read_b64_tr_b16 a[200:201], v56 offset:0
    ds_read_b64_tr_b16 a[202:203], v56 offset:256
    ds_read_b64_tr_b16 a[204:205], v56 offset:8192
    ds_read_b64_tr_b16 a[206:207], v56 offset:8448
    s_mov_b32 s77, 16384
    s_call_b64 s[82:83], cf_dma
    v_cmp_eq_u32 vcc, 0, v29
    s_nop 1
    v_cndmask_b32 v16, 0, v31, vcc
    v_cmp_eq_u32 vcc, 1, v29
    s_nop 1
    v_cndmask_b32 v16, v16, v32, vcc
    v_cmp_eq_u32 vcc, 0, v28
    s_nop 1
    v_cndmask_b32 v20, 0, v31, vcc
    v_cmp_eq_u32 vcc, 1, v28
    s_nop 1
    v_cndmask_b32 v20, v20, v32, vcc
    s_nop 1
    s_waitcnt lgkmcnt(0)
    v_add_u32 v55, 131072, v51
    v_xor_b32 v56, 32, v55
    ds_read_b64_tr_b16 a[208:209], v55 offset:0
    ds_read_b64_tr_b16 a[210:211], v55 offset:256
    ds_read_b64_tr_b16 a[212:213], v55 offset:8192
    ds_read_b64_tr_b16 a[214:215], v55 offset:8448
    s_mov_b32 s77, 24576
    s_call_b64 s[82:83], cf_dma
    ds_read_b64_tr_b16 a[216:217], v56 offset:0
    ds_read_b64_tr_b16 a[218:219], v56 offset:256
    ds_read_b64_tr_b16 a[220:221], v56 offset:8192
    ds_read_b64_tr_b16 a[222:223], v56 offset:8448
    s_mov_b32 s77, 32768
    s_call_b64 s[82:83], cf_dma
    v_cmp_eq_u32 vcc, 2, v29
    s_nop 1
    v_cndmask_b32 v17, 0, v31, vcc
    v_cmp_eq_u32 vcc, 3, v29
    s_nop 1
    v_cndmask_b32 v17, v17, v32, vcc
    v_cmp_eq_u32 vcc, 2, v28
    s_nop 1
    v_cndmask_b32 v21, 0, v31, vcc
    v_cmp_eq_u32 vcc, 3, v28
    s_nop 1
    v_cndmask_b32 v21, v21, v32, vcc
    s_nop 1
    s_waitcnt lgkmcnt(0)
    s_waitcnt vmcnt(8)
    v_add_u32 v55, 65536, v51
    v_xor_b32 v56, 32, v55
    ds_read_b64_tr_b16 a[224:225], v55 offset:0
    ds_read_b64_tr_b16 a[226:227], v55 offset:256
    ds_read_b64_tr_b16 a[228:229], v55 offset:8192
    ds_read_b64_tr_b16 a[230:231], v55 offset:8448
    s_cmp_eq_u32 s88, 0
    s_cbranch_scc1 cf_cpe623
    s_lshl_b32 s89, s73, 7
    s_add_u32 s89, s89, 125853696
    v_min_u32 v33, 11, v57
    v_lshlrev_b32 v33, 2, v33
    buffer_load_dword v34, off, s[96:99], 0 offset:64 sc1
    buffer_load_dword v35, v33, s[4:7], s89 offen sc1
cf_cpe623:
    s_xor_b32 s78, s75, 3145728
    s_add_u32 s78, s78, s67
    s_add_u32 s80, s66, 32768
    s_mov_b32 s76, 0
    s_mov_b32 s77, 8192
    s_call_b64 s[82:83], cf_dma
    ds_read_b64_tr_b16 a[232:233], v56 offset:0
    ds_read_b64_tr_b16 a[234:235], v56 offset:256
    ds_read_b64_tr_b16 a[236:237], v56 offset:8192
    ds_read_b64_tr_b16 a[238:239], v56 offset:8448
    s_mov_b32 s77, 16384
    s_call_b64 s[82:83], cf_dma
    v_cmp_eq_u32 vcc, 8, v29
    s_nop 1
    v_cndmask_b32 v18, 0, v31, vcc
    v_cmp_eq_u32 vcc, 9, v29
    s_nop 1
    v_cndmask_b32 v18, v18, v32, vcc
    v_cmp_eq_u32 vcc, 4, v28
    s_nop 1
    v_cndmask_b32 v22, 0, v31, vcc
    v_cmp_eq_u32 vcc, 5, v28
    s_nop 1
    v_cndmask_b32 v22, v22, v32, vcc
    s_nop 1
    s_waitcnt lgkmcnt(0)
    v_add_u32 v55, 81920, v51
    v_xor_b32 v56, 32, v55
    ds_read_b64_tr_b16 a[240:241], v55 offset:0
    ds_read_b64_tr_b16 a[242:243], v55 offset:256
    ds_read_b64_tr_b16 a[244:245], v55 offset:8192
    ds_read_b64_tr_b16 a[246:247], v55 offset:8448
    s_mov_b32 s77, 24576
    s_call_b64 s[82:83], cf_dma
    ds_read_b64_tr_b16 a[248:249], v56 offset:0
    ds_read_b64_tr_b16 a[250:251], v56 offset:256
    ds_read_b64_tr_b16 a[252:253], v56 offset:8192
    ds_read_b64_tr_b16 a[254:255], v56 offset:8448
    s_mov_b32 s77, 32768
    s_call_b64 s[82:83], cf_dma
    v_cmp_eq_u32 vcc, 10, v29
    s_nop 1
    v_cndmask_b32 v19, 0, v31, vcc
    v_cmp_eq_u32 vcc, 11, v29
    s_nop 1
    v_cndmask_b32 v19, v19, v32, vcc
    v_cmp_eq_u32 vcc, 6, v28
    s_nop 1
    v_cndmask_b32 v23, 0, v31, vcc
    v_cmp_eq_u32 vcc, 7, v28
    s_nop 1
    v_cndmask_b32 v23, v23, v32, vcc
    s_nop 1
    s_waitcnt lgkmcnt(0)
    s_waitcnt vmcnt(8)
    v_add_u32 v55, 0, v51
    v_xor_b32 v56, 32, v55
    ds_read_b64_tr_b16 v[80:81], v55 offset:0
    ds_read_b64_tr_b16 v[82:83], v55 offset:256
    ds_read_b64_tr_b16 v[84:85], v55 offset:8192
    ds_read_b64_tr_b16 v[86:87], v55 offset:8448
    s_cmp_eq_u32 s88, 0
    s_cbranch_scc1 cf_ncp693
    s_waitcnt vmcnt(8)
    v_max_u32 v34, 1, v34
    v_cmp_eq_u32 vcc, 1, v34
    s_cbranch_vccnz cf_ncp693
    v_cmp_ne_u32 vcc, v34, v35
    s_cbranch_vccnz cf_ncp693
    s_mov_b32 s88, 0
    s_mov_b32 s72, 5
    s_lshl_b32 s74, s73, 19
    s_add_u32 s74, s74, 96468992
    s_add_u32 s50, s4, s74
    s_addc_u32 s51, s5, 0
    s_add_u32 s52, s50, 147456
    s_addc_u32 s53, s51, 0
    s_lshl_b32 s67, s13, 6
    v_and_b32 v54, 63, v48
    v_lshrrev_b32 v48, 13, v48
    v_lshl_add_u32 v48, v48, 8, v54
cf_ncp693:
    s_cmp_eq_u32 s88, 0
    s_cbranch_scc1 cf_cpe714
    s_lshl_b32 s89, s73, 7
    s_add_u32 s89, s89, 125853696
    v_min_u32 v33, 11, v57
    v_lshlrev_b32 v33, 2, v33
    buffer_load_dword v34, off, s[96:99], 0 offset:64 sc1
    buffer_load_dword v35, v33, s[4:7], s89 offen sc1
cf_cpe714:
    s_xor_b32 s78, s75, 2097152
    s_lshr_b32 s78, s78, s72
    s_add_u32 s78, s78, s67
    s_mov_b64 s[8:9], s[52:53]
    v_mov_b32 v58, v48
    s_lshr_b32 s79, 131072, s72
    s_add_u32 s80, s66, 131072
    s_mov_b32 s76, 0
    s_mov_b32 s77, 8192
    s_call_b64 s[82:83], cf_dma
    ds_read_b64_tr_b16 v[88:89], v56 offset:0
    ds_read_b64_tr_b16 v[90:91], v56 offset:256
    ds_read_b64_tr_b16 v[92:93], v56 offset:8192
    ds_read_b64_tr_b16 v[94:95], v56 offset:8448
    s_mov_b32 s77, 16384
    s_call_b64 s[82:83], cf_dma
    v_mov_b32 v46, 1
    s_mov_b64 exec, 1
    buffer_atomic_add v46, off, s[96:99], 0 offset:132 sc0
    s_mov_b64 exec, -1
    s_waitcnt lgkmcnt(0)
    v_add_u32 v55, 16384, v51
    v_xor_b32 v56, 32, v55
    ds_read_b64_tr_b16 v[96:97], v55 offset:0
    ds_read_b64_tr_b16 v[98:99], v55 offset:256
    ds_read_b64_tr_b16 v[100:101], v55 offset:8192
    ds_read_b64_tr_b16 v[102:103], v55 offset:8448
    s_mov_b32 s77, 24576
    s_call_b64 s[82:83], cf_dma
    ds_read_b64_tr_b16 v[104:105], v56 offset:0
    ds_read_b64_tr_b16 v[106:107], v56 offset:256
    ds_read_b64_tr_b16 v[108:109], v56 offset:8192
    ds_read_b64_tr_b16 v[110:111], v56 offset:8448
    s_mov_b32 s77, 32768
    s_call_b64 s[82:83], cf_dma
    s_waitcnt lgkmcnt(0)
    s_waitcnt vmcnt(9)
    v_add_u32 v55, 32768, v51
    v_xor_b32 v56, 32, v55
    ds_read_b64_tr_b16 v[112:113], v55 offset:0
    ds_read_b64_tr_b16 v[114:115], v55 offset:256
    ds_read_b64_tr_b16 v[116:117], v55 offset:8192
    ds_read_b64_tr_b16 v[118:119], v55 offset:8448
    s_cmp_eq_u32 s88, 0
    s_cbranch_scc1 cf_ncp766
    s_waitcnt vmcnt(9)
    v_max_u32 v34, 1, v34
    v_cmp_eq_u32 vcc, 1, v34
    s_cbranch_vccnz cf_ncp766
    v_cmp_ne_u32 vcc, v34, v35
    s_cbranch_vccnz cf_ncp766
    s_mov_b32 s88, 0
    s_mov_b32 s72, 5
    s_lshl_b32 s74, s73, 19
    s_add_u32 s74, s74, 96468992
    s_add_u32 s50, s4, s74
    s_addc_u32 s51, s5, 0
    s_add_u32 s52, s50, 147456
    s_addc_u32 s53, s51, 0
    s_lshl_b32 s67, s13, 6
    v_and_b32 v54, 63, v48
    v_lshrrev_b32 v48, 13, v48
    v_lshl_add_u32 v48, v48, 8, v54
cf_ncp766:
    s_cmp_eq_u32 s88, 0
    s_cbranch_scc1 cf_cpe787
    s_lshl_b32 s89, s73, 7
    s_add_u32 s89, s89, 125853696
    v_min_u32 v33, 11, v57
    v_lshlrev_b32 v33, 2, v33
    buffer_load_dword v34, off, s[96:99], 0 offset:64 sc1
    buffer_load_dword v35, v33, s[4:7], s89 offen sc1
cf_cpe787:
    s_xor_b32 s78, s75, 3145728
    s_lshr_b32 s78, s78, s72
    s_add_u32 s78, s78, s67
    s_mov_b64 s[8:9], s[52:53]
    v_mov_b32 v58, v48
    s_lshr_b32 s79, 131072, s72
    s_add_u32 s80, s66, 65536
    s_mov_b32 s76, 0
    s_mov_b32 s77, 8192
    s_call_b64 s[82:83], cf_dma
    ds_read_b64_tr_b16 v[120:121], v56 offset:0
    ds_read_b64_tr_b16 v[122:123], v56 offset:256
    ds_read_b64_tr_b16 v[124:125], v56 offset:8192
    ds_read_b64_tr_b16 v[126:127], v56 offset:8448
    s_mov_b32 s77, 16384
    s_call_b64 s[82:83], cf_dma
    s_waitcnt lgkmcnt(0)
    v_add_u32 v55, 49152, v51
    v_xor_b32 v56, 32, v55
    ds_read_b64_tr_b16 v[128:129], v55 offset:0
    ds_read_b64_tr_b16 v[130:131], v55 offset:256
    ds_read_b64_tr_b16 v[132:133], v55 offset:8192
    ds_read_b64_tr_b16 v[134:135], v55 offset:8448
    s_mov_b32 s77, 24576
    s_call_b64 s[82:83], cf_dma
    ds_read_b64_tr_b16 v[136:137], v56 offset:0
    ds_read_b64_tr_b16 v[138:139], v56 offset:256
    ds_read_b64_tr_b16 v[140:141], v56 offset:8192
    ds_read_b64_tr_b16 v[142:143], v56 offset:8448
    s_mov_b32 s77, 32768
    s_call_b64 s[82:83], cf_dma
    s_waitcnt lgkmcnt(0)
    s_waitcnt vmcnt(8)
    v_add_u32 v55, 131072, v51
    v_xor_b32 v56, 32, v55
    ds_read_b64_tr_b16 a[128:129], v55 offset:0
    ds_read_b64_tr_b16 a[130:131], v55 offset:256
    ds_read_b64_tr_b16 a[132:133], v55 offset:8192
    ds_read_b64_tr_b16 a[134:135], v55 offset:8448
    s_cmp_eq_u32 s88, 0
    s_cbranch_scc1 cf_ncp835
    s_waitcnt vmcnt(8)
    v_max_u32 v34, 1, v34
    v_cmp_eq_u32 vcc, 1, v34
    s_cbranch_vccnz cf_ncp835
    v_cmp_ne_u32 vcc, v34, v35
    s_cbranch_vccnz cf_ncp835
    s_mov_b32 s88, 0
    s_mov_b32 s72, 5
    s_lshl_b32 s74, s73, 19
    s_add_u32 s74, s74, 96468992
    s_add_u32 s50, s4, s74
    s_addc_u32 s51, s5, 0
    s_add_u32 s52, s50, 147456
    s_addc_u32 s53, s51, 0
    s_lshl_b32 s67, s13, 6
    v_and_b32 v54, 63, v48
    v_lshrrev_b32 v48, 13, v48
    v_lshl_add_u32 v48, v48, 8, v54
cf_ncp835:
    s_cmp_eq_u32 s88, 0
    s_cbranch_scc1 cf_cpe856
    s_lshl_b32 s89, s73, 7
    s_add_u32 s89, s89, 125853696
    v_min_u32 v33, 11, v57
    v_lshlrev_b32 v33, 2, v33
    buffer_load_dword v34, off, s[96:99], 0 offset:64 sc1
    buffer_load_dword v35, v33, s[4:7], s89 offen sc1
cf_cpe856:
    s_xor_b32 s78, s75, 2097152
    s_lshr_b32 s78, s78, s72
    s_add_u32 s78, s78, s67
    s_mov_b64 s[8:9], s[50:51]
    v_mov_b32 v58, v48
    s_lshr_b32 s79, 131072, s72
    s_add_u32 s80, s66, 0
    s_mov_b32 s76, 0
    s_mov_b32 s77, 8192
    s_call_b64 s[82:83], cf_dma
    ds_read_b64_tr_b16 a[136:137], v56 offset:0
    ds_read_b64_tr_b16 a[138:139], v56 offset:256
    ds_read_b64_tr_b16 a[140:141], v56 offset:8192
    ds_read_b64_tr_b16 a[142:143], v56 offset:8448
    s_mov_b32 s77, 16384
    s_call_b64 s[82:83], cf_dma
    s_waitcnt lgkmcnt(0)
    v_add_u32 v55, 147456, v51
    v_xor_b32 v56, 32, v55
    ds_read_b64_tr_b16 a[144:145], v55 offset:0
    ds_read_b64_tr_b16 a[146:147], v55 offset:256
    ds_read_b64_tr_b16 a[148:149], v55 offset:8192
    ds_read_b64_tr_b16 a[150:151], v55 offset:8448
    s_mov_b32 s77, 24576
    s_call_b64 s[82:83], cf_dma
    ds_read_b64_tr_b16 a[152:153], v56 offset:0
    ds_read_b64_tr_b16 a[154:155], v56 offset:256
    ds_read_b64_tr_b16 a[156:157], v56 offset:8192
    ds_read_b64_tr_b16 a[158:159], v56 offset:8448
    s_mov_b32 s77, 32768
    s_call_b64 s[82:83], cf_dma
    s_waitcnt lgkmcnt(0)
    s_waitcnt vmcnt(8)
    v_add_u32 v55, 65536, v51
    v_xor_b32 v56, 32, v55
    ds_read_b64_tr_b16 a[160:161], v55 offset:0
    ds_read_b64_tr_b16 a[162:163], v55 offset:256
    ds_read_b64_tr_b16 a[164:165], v55 offset:8192
    ds_read_b64_tr_b16 a[166:167], v55 offset:8448
    s_cmp_eq_u32 s88, 0
    s_cbranch_scc1 cf_ncp904
    s_waitcnt vmcnt(8)
    v_max_u32 v34, 1, v34
    v_cmp_eq_u32 vcc, 1, v34
    s_cbranch_vccnz cf_ncp904
    v_cmp_ne_u32 vcc, v34, v35
    s_cbranch_vccnz cf_ncp904
    s_mov_b32 s88, 0
    s_mov_b32 s72, 5
    s_lshl_b32 s74, s73, 19
    s_add_u32 s74, s74, 96468992
    s_add_u32 s50, s4, s74
    s_addc_u32 s51, s5, 0
    s_add_u32 s52, s50, 147456
    s_addc_u32 s53, s51, 0
    s_lshl_b32 s67, s13, 6
    v_and_b32 v54, 63, v48
    v_lshrrev_b32 v48, 13, v48
    v_lshl_add_u32 v48, v48, 8, v54
cf_ncp904:
    s_cmp_eq_u32 s88, 0
    s_cbranch_scc1 cf_cpe925
    s_lshl_b32 s89, s73, 7
    s_add_u32 s89, s89, 125853696
    v_min_u32 v33, 11, v57
    v_lshlrev_b32 v33, 2, v33
    buffer_load_dword v34, off, s[96:99], 0 offset:64 sc1
    buffer_load_dword v35, v33, s[4:7], s89 offen sc1
cf_cpe925:
    s_xor_b32 s78, s75, 3145728
    s_lshr_b32 s78, s78, s72
    s_add_u32 s78, s78, s67
    s_mov_b64 s[8:9], s[50:51]
    v_mov_b32 v58, v48
    s_lshr_b32 s79, 131072, s72
    s_add_u32 s80, s66, 32768
    s_mov_b32 s76, 0
    s_mov_b32 s77, 8192
    s_call_b64 s[82:83], cf_dma
    ds_read_b64_tr_b16 a[168:169], v56 offset:0
    ds_read_b64_tr_b16 a[170:171], v56 offset:256
    ds_read_b64_tr_b16 a[172:173], v56 offset:8192
    ds_read_b64_tr_b16 a[174:175], v56 offset:8448
    s_mov_b32 s77, 16384
    s_call_b64 s[82:83], cf_dma
    v_readfirstlane_b32 s41, v46
    v_mov_b32 v46, 1
    v_mov_b32 v47, 0
    s_cmp_eq_u32 s41, 127
    s_cselect_b64 exec, 1, 0
    buffer_atomic_cmpswap v[46:47], off, s[96:99], 0 offset:140
    s_mov_b64 exec, -1
    s_waitcnt lgkmcnt(0)
    v_add_u32 v55, 81920, v51
    v_xor_b32 v56, 32, v55
    ds_read_b64_tr_b16 a[176:177], v55 offset:0
    ds_read_b64_tr_b16 a[178:179], v55 offset:256
    ds_read_b64_tr_b16 a[180:181], v55 offset:8192
    ds_read_b64_tr_b16 a[182:183], v55 offset:8448
    s_mov_b32 s77, 24576
    s_call_b64 s[82:83], cf_dma
    ds_read_b64_tr_b16 a[184:185], v56 offset:0
    ds_read_b64_tr_b16 a[186:187], v56 offset:256
    ds_read_b64_tr_b16 a[188:189], v56 offset:8192
    ds_read_b64_tr_b16 a[190:191], v56 offset:8448
    s_mov_b32 s77, 32768
    s_call_b64 s[82:83], cf_dma
    s_waitcnt lgkmcnt(0)
    s_waitcnt vmcnt(8)
    v_add_u32 v55, 0, v51
    v_xor_b32 v56, 32, v55
    ds_read_b64_tr_b16 a[48:49], v55 offset:0
    ds_read_b64_tr_b16 a[50:51], v55 offset:256
    ds_read_b64_tr_b16 a[52:53], v55 offset:8192
    ds_read_b64_tr_b16 a[54:55], v55 offset:8448
    s_lshr_b32 s78, 4194304, s72
    s_add_u32 s78, s78, s67
    s_mov_b32 s81, 0
    s_add_u32 s80, s66, 98304
    s_mov_b32 s76, 0
    s_mov_b32 s77, 8192
    s_call_b64 s[82:83], cf_dma
    ds_read_b64_tr_b16 a[56:57], v56 offset:0
    ds_read_b64_tr_b16 a[58:59], v56 offset:256
    ds_read_b64_tr_b16 a[60:61], v56 offset:8192
    ds_read_b64_tr_b16 a[62:63], v56 offset:8448
    s_mov_b32 s77, 16384
    s_call_b64 s[82:83], cf_dma
    s_waitcnt lgkmcnt(0)
    v_add_u32 v55, 16384, v51
    v_xor_b32 v56, 32, v55
    ds_read_b64_tr_b16 a[64:65], v55 offset:0
    ds_read_b64_tr_b16 a[66:67], v55 offset:256
    ds_read_b64_tr_b16 a[68:69], v55 offset:8192
    ds_read_b64_tr_b16 a[70:71], v55 offset:8448
    s_cmp_eq_u32 s88, 0
    s_cbranch_scc1 cf_ncp1000
    s_waitcnt vmcnt(12)
    v_max_u32 v34, 1, v34
    v_cmp_eq_u32 vcc, 1, v34
    s_cbranch_vccnz cf_ncp1000
    v_cmp_ne_u32 vcc, v34, v35
    s_cbranch_vccnz cf_ncp1000
    s_mov_b32 s88, 0
    s_mov_b32 s72, 5
    s_lshl_b32 s74, s73, 19
    s_add_u32 s74, s74, 96468992
    s_add_u32 s50, s4, s74
    s_addc_u32 s51, s5, 0
    s_add_u32 s52, s50, 147456
    s_addc_u32 s53, s51, 0
    s_lshl_b32 s67, s13, 6
    v_and_b32 v54, 63, v48
    v_lshrrev_b32 v48, 13, v48
    v_lshl_add_u32 v48, v48, 8, v54
cf_ncp1000:
    s_xor_b32 s78, s75, 1048576
    s_lshr_b32 s78, s78, s72
    s_add_u32 s78, s78, s67
    s_mov_b64 s[8:9], s[50:51]
    v_mov_b32 v58, v48
    s_lshr_b32 s79, 131072, s72
    s_mov_b32 s81, s93
    s_add_u32 s80, s66, 114688
    s_mov_b32 s76, 0
    s_mov_b32 s77, 8192
    s_call_b64 s[82:83], cf_dma
    ds_read_b64_tr_b16 a[72:73], v56 offset:0
    ds_read_b64_tr_b16 a[74:75], v56 offset:256
    ds_read_b64_tr_b16 a[76:77], v56 offset:8192
    ds_read_b64_tr_b16 a[78:79], v56 offset:8448
    s_mov_b32 s77, 16384
    s_call_b64 s[82:83], cf_dma
    s_waitcnt lgkmcnt(0)
    s_waitcnt vmcnt(8)
    v_add_u32 v55, 32768, v51
    v_xor_b32 v56, 32, v55
    ds_read_b64_tr_b16 a[80:81], v55 offset:0
    ds_read_b64_tr_b16 a[82:83], v55 offset:256
    ds_read_b64_tr_b16 a[84:85], v55 offset:8192
    ds_read_b64_tr_b16 a[86:87], v55 offset:8448
    s_mov_b32 s77, 24576
    s_call_b64 s[82:83], cf_dma
    ds_read_b64_tr_b16 a[88:89], v56 offset:0
    ds_read_b64_tr_b16 a[90:91], v56 offset:256
    ds_read_b64_tr_b16 a[92:93], v56 offset:8192
    ds_read_b64_tr_b16 a[94:95], v56 offset:8448
    s_mov_b32 s77, 32768
    s_call_b64 s[82:83], cf_dma
    s_waitcnt lgkmcnt(0)
    v_add_u32 v55, 49152, v51
    v_xor_b32 v56, 32, v55
    ds_read_b64_tr_b16 a[96:97], v55 offset:0
    ds_read_b64_tr_b16 a[98:99], v55 offset:256
    ds_read_b64_tr_b16 a[100:101], v55 offset:8192
    ds_read_b64_tr_b16 a[102:103], v55 offset:8448
    s_xor_b32 s78, s75, 0
    s_lshr_b32 s78, s78, s72
    s_add_u32 s78, s78, s67
    s_add_u32 s80, s66, 65536
    s_mov_b32 s76, 0
    s_mov_b32 s77, 8192
    s_call_b64 s[82:83], cf_dma
    ds_read_b64_tr_b16 a[104:105], v56 offset:0
    ds_read_b64_tr_b16 a[106:107], v56 offset:256
    ds_read_b64_tr_b16 a[108:109], v56 offset:8192
    ds_read_b64_tr_b16 a[110:111], v56 offset:8448
    s_mov_b32 s77, 16384
    s_call_b64 s[82:83], cf_dma
    s_waitcnt lgkmcnt(0)
    s_waitcnt vmcnt(12)
    v_add_u32 v55, 98304, v51
    v_xor_b32 v56, 32, v55
    ds_read_b64_tr_b16 a[112:113], v55 offset:0
    ds_read_b64_tr_b16 a[114:115], v55 offset:256
    ds_read_b64_tr_b16 a[116:117], v55 offset:8192
    ds_read_b64_tr_b16 a[118:119], v55 offset:8448
    s_mov_b32 s77, 24576
    s_call_b64 s[82:83], cf_dma
    ds_read_b64_tr_b16 a[120:121], v56 offset:0
    ds_read_b64_tr_b16 a[122:123], v56 offset:256
    ds_read_b64_tr_b16 a[124:125], v56 offset:8192
    ds_read_b64_tr_b16 a[126:127], v56 offset:8448
    s_mov_b32 s77, 32768
    s_call_b64 s[82:83], cf_dma
    s_waitcnt lgkmcnt(0)
    s_waitcnt vmcnt(8)
    v_add_u32 v55, 114688, v51
    v_xor_b32 v56, 32, v55
    ds_read_b64_tr_b16 a[16:17], v55 offset:0
    ds_read_b64_tr_b16 a[18:19], v55 offset:256
    ds_read_b64_tr_b16 a[20:21], v55 offset:8192
    ds_read_b64_tr_b16 a[22:23], v55 offset:8448
    s_xor_b32 s78, s75, 0
    s_lshr_b32 s78, s78, s72
    s_add_u32 s78, s78, s67
    s_mov_b64 s[8:9], s[52:53]
    s_add_u32 s80, s66, 0
    s_mov_b32 s76, 0
    s_mov_b32 s77, 8192
    s_call_b64 s[82:83], cf_dma
    ds_read_b64_tr_b16 a[24:25], v56 offset:0
    ds_read_b64_tr_b16 a[26:27], v56 offset:256
    ds_read_b64_tr_b16 a[28:29], v56 offset:8192
    ds_read_b64_tr_b16 a[30:31], v56 offset:8448
    s_mov_b32 s77, 16384
    s_call_b64 s[82:83], cf_dma
    s_waitcnt lgkmcnt(0)
    v_add_u32 v55, 131072, v51
    v_xor_b32 v56, 32, v55
    ds_read_b64_tr_b16 a[32:33], v55 offset:0
    ds_read_b64_tr_b16 a[34:35], v55 offset:256
    ds_read_b64_tr_b16 a[36:37], v55 offset:8192
    ds_read_b64_tr_b16 a[38:39], v55 offset:8448
    s_mov_b32 s77, 24576
    s_call_b64 s[82:83], cf_dma
    ds_read_b64_tr_b16 a[40:41], v56 offset:0
    ds_read_b64_tr_b16 a[42:43], v56 offset:256
    ds_read_b64_tr_b16 a[44:45], v56 offset:8192
    ds_read_b64_tr_b16 a[46:47], v56 offset:8448
    s_mov_b32 s77, 32768
    s_call_b64 s[82:83], cf_dma
    s_waitcnt lgkmcnt(0)
    s_waitcnt vmcnt(8)
    v_add_u32 v55, 65536, v51
    v_xor_b32 v56, 32, v55
    ds_read_b64_tr_b16 v[0:1], v55 offset:0
    ds_read_b64_tr_b16 v[2:3], v55 offset:256
    ds_read_b64_tr_b16 v[4:5], v55 offset:8192
    ds_read_b64_tr_b16 v[6:7], v55 offset:8448
    s_xor_b32 s78, s75, 1048576
    s_lshr_b32 s78, s78, s72
    s_add_u32 s78, s78, s67
    s_add_u32 s80, s66, 32768
    s_mov_b32 s76, 0
    s_mov_b32 s77, 8192
    s_call_b64 s[82:83], cf_dma
    ds_read_b64_tr_b16 v[8:9], v56 offset:0
    ds_read_b64_tr_b16 v[10:11], v56 offset:256
    ds_read_b64_tr_b16 v[12:13], v56 offset:8192
    ds_read_b64_tr_b16 v[14:15], v56 offset:8448
    s_mov_b32 s77, 16384
    s_call_b64 s[82:83], cf_dma
    s_waitcnt lgkmcnt(0)
    ds_write_b128 v62, v[0:3] offset:8192
    ds_write_b128 v62, v[4:7] offset:12288
    ds_write_b128 v62, v[8:11] offset:16384
    ds_write_b128 v62, v[12:15] offset:20480
    s_waitcnt lgkmcnt(0)
    v_add_u32 v55, 81920, v51
    v_xor_b32 v56, 32, v55
    ds_read_b64_tr_b16 a[0:1], v55 offset:0
    ds_read_b64_tr_b16 a[2:3], v55 offset:256
    ds_read_b64_tr_b16 a[4:5], v55 offset:8192
    ds_read_b64_tr_b16 a[6:7], v55 offset:8448
    s_mov_b32 s77, 24576
    s_call_b64 s[82:83], cf_dma
    ds_read_b64_tr_b16 a[8:9], v56 offset:0
    ds_read_b64_tr_b16 a[10:11], v56 offset:256
    ds_read_b64_tr_b16 a[12:13], v56 offset:8192
    ds_read_b64_tr_b16 a[14:15], v56 offset:8448
    s_mov_b32 s77, 32768
    s_call_b64 s[82:83], cf_dma
    s_waitcnt lgkmcnt(0)
    s_waitcnt vmcnt(8)
    v_add_u32 v55, 0, v51
    v_xor_b32 v56, 32, v55
    ds_read_b64_tr_b16 v[0:1], v55 offset:0
    ds_read_b64_tr_b16 v[2:3], v55 offset:256
    ds_read_b64_tr_b16 v[4:5], v55 offset:8192
    ds_read_b64_tr_b16 v[6:7], v55 offset:8448
    s_xor_b32 s94, s13, 0
    s_mul_i32 s94, s94, 36864
    s_add_u32 s94, s94, s92
    s_lshr_b32 s74, s13, 1
    s_lshl_b32 s74, s74, 6
    s_add_u32 s94, s94, s74
    s_add_u32 s78, s94, 1024
    s_mov_b64 s[8:9], s[56:57]
    v_mov_b32 v58, v50
    s_mov_b32 s79, 18432
    s_mov_b32 s81, 0
    s_add_u32 s80, s66, 147456
    s_mov_b32 s76, 0
    s_mov_b32 s77, 8192
    s_call_b64 s[82:83], cf_dma
    ds_read_b64_tr_b16 v[8:9], v56 offset:0
    ds_read_b64_tr_b16 v[10:11], v56 offset:256
    ds_read_b64_tr_b16 v[12:13], v56 offset:8192
    ds_read_b64_tr_b16 v[14:15], v56 offset:8448
    s_xor_b32 s94, s13, 2
    s_mul_i32 s94, s94, 36864
    s_add_u32 s94, s94, s92
    s_lshr_b32 s74, s13, 1
    s_lshl_b32 s74, s74, 6
    s_add_u32 s94, s94, s74
    s_add_u32 s78, s94, 1024
    s_mov_b32 s77, 16384
    s_call_b64 s[82:83], cf_dma
    s_waitcnt lgkmcnt(0)
    ds_write_b128 v61, v[0:3] offset:0
    ds_write_b128 v61, v[4:7] offset:4096
    ds_write_b128 v61, v[8:11] offset:8192
    ds_write_b128 v61, v[12:15] offset:12288
    s_waitcnt lgkmcnt(0)
    v_add_u32 v55, 16384, v51
    v_xor_b32 v56, 32, v55
    ds_read_b64_tr_b16 v[0:1], v55 offset:0
    ds_read_b64_tr_b16 v[2:3], v55 offset:256
    ds_read_b64_tr_b16 v[4:5], v55 offset:8192
    ds_read_b64_tr_b16 v[6:7], v55 offset:8448
    s_xor_b32 s94, s13, 3
    s_mul_i32 s94, s94, 36864
    s_add_u32 s94, s94, s92
    s_lshl_b32 s74, s13, 7
    s_add_u32 s94, s94, s74
    s_add_u32 s78, s94, 512
    v_mov_b32 v58, v49
    s_mov_b32 s79, 9216
    s_add_u32 s80, s66, 131072
    s_mov_b32 s76, 0
    s_mov_b32 s77, 8192
    s_call_b64 s[82:83], cf_dma
    ds_read_b64_tr_b16 v[8:9], v56 offset:0
    ds_read_b64_tr_b16 v[10:11], v56 offset:256
    ds_read_b64_tr_b16 v[12:13], v56 offset:8192
    ds_read_b64_tr_b16 v[14:15], v56 offset:8448
    s_mov_b32 s77, 16384
    s_call_b64 s[82:83], cf_dma
    s_waitcnt lgkmcnt(0)
    ds_write_b128 v61, v[0:3] offset:16384
    ds_write_b128 v61, v[4:7] offset:20480
    ds_write_b128 v61, v[8:11] offset:24576
    ds_write_b128 v61, v[12:15] offset:28672
    s_waitcnt lgkmcnt(0)
    s_waitcnt vmcnt(8)
    v_add_u32 v55, 32768, v51
    v_xor_b32 v56, 32, v55
    ds_read_b64_tr_b16 v[0:1], v55 offset:0
    ds_read_b64_tr_b16 v[2:3], v55 offset:256
    ds_read_b64_tr_b16 v[4:5], v55 offset:8192
    ds_read_b64_tr_b16 v[6:7], v55 offset:8448
    s_xor_b32 s94, s13, 2
    s_mul_i32 s94, s94, 36864
    s_add_u32 s94, s94, s92
    s_lshl_b32 s74, s13, 7
    s_add_u32 s94, s94, s74
    s_add_u32 s78, s94, 512
    s_add_u32 s80, s66, 114688
    s_mov_b32 s76, 0
    s_mov_b32 s77, 8192
    s_call_b64 s[82:83], cf_dma
    ds_read_b64_tr_b16 v[8:9], v56 offset:0
    ds_read_b64_tr_b16 v[10:11], v56 offset:256
    ds_read_b64_tr_b16 v[12:13], v56 offset:8192
    ds_read_b64_tr_b16 v[14:15], v56 offset:8448
    s_mov_b32 s77, 16384
    s_call_b64 s[82:83], cf_dma
    s_waitcnt lgkmcnt(0)
    ds_write_b128 v61, v[0:3] offset:32768
    ds_write_b128 v61, v[4:7] offset:36864
    ds_write_b128 v61, v[8:11] offset:40960
    ds_write_b128 v61, v[12:15] offset:45056
    s_waitcnt lgkmcnt(0)
    v_add_u32 v55, 49152, v51
    v_xor_b32 v56, 32, v55
    ds_read_b64_tr_b16 v[0:1], v55 offset:0
    ds_read_b64_tr_b16 v[2:3], v55 offset:256
    ds_read_b64_tr_b16 v[4:5], v55 offset:8192
    ds_read_b64_tr_b16 v[6:7], v55 offset:8448
    s_lshr_b32 s78, 4194304, s72
    s_add_u32 s78, s78, s67
    s_mov_b64 s[8:9], s[52:53]
    v_mov_b32 v58, v48
    s_lshr_b32 s79, 131072, s72
    s_add_u32 s80, s66, 81920
    s_mov_b32 s76, 0
    s_mov_b32 s77, 8192
    s_call_b64 s[82:83], cf_dma
    ds_read_b64_tr_b16 v[8:9], v56 offset:0
    ds_read_b64_tr_b16 v[10:11], v56 offset:256
    ds_read_b64_tr_b16 v[12:13], v56 offset:8192
    ds_read_b64_tr_b16 v[14:15], v56 offset:8448
    s_mov_b32 s77, 16384
    s_call_b64 s[82:83], cf_dma
    s_waitcnt lgkmcnt(0)
    ds_write_b128 v61, v[0:3] offset:49152
    ds_write_b128 v61, v[4:7] offset:53248
    ds_write_b128 v61, v[8:11] offset:57344
    ds_write_b128 v61, v[12:15] offset:61440
    s_waitcnt lgkmcnt(0)
    v_lshlrev_b32 v45, 3, v61
    s_lshl_b32 s40, s12, 14
    s_add_u32 s40, s40, 65536
    s_lshl_b32 s41, s12, 11
    s_sub_u32 s41, s41, 12288
    v_add_u32 v30, s40, v45
    v_add_u32 v45, s41, v45
    v_cmp_gt_u32 vcc, 1536, v61
    s_nop 1
    v_cndmask_b32 v45, v45, v30, vcc
    s_lshl_b32 s40, s12, 16
    s_add_u32 s40, s40, 25151488
    v_lshlrev_b32 v30, 3, v61
    v_add_u32 v30, s40, v30
    v_cmp_gt_u32 vcc, 1792, v61
    s_nop 1
    v_cndmask_b32 v45, v30, v45, vcc
    v_cmp_gt_u32 vcc, 2944, v61
    s_mov_b32 s40, 67108864
    s_mov_b64 exec, vcc
    buffer_load_dword v30, v45, s[4:7], s40 offen sc1
    s_mov_b64 exec, -1
    s_waitcnt vmcnt(12)
    v_add_u32 v55, 147456, v53
    ds_read_b64_tr_b16 v[0:1], v55 offset:0
    ds_read_b64_tr_b16 v[2:3], v55 offset:128
    ds_read_b64_tr_b16 v[4:5], v55 offset:512
    ds_read_b64_tr_b16 v[6:7], v55 offset:640
    ds_read_b64_tr_b16 v[8:9], v55 offset:8192
    ds_read_b64_tr_b16 v[10:11], v55 offset:8320
    ds_read_b64_tr_b16 v[12:13], v55 offset:8704
    ds_read_b64_tr_b16 v[14:15], v55 offset:8832
    s_waitcnt lgkmcnt(0)
    s_barrier
    ds_write_b128 v63, v[0:3] offset:49152
    ds_write_b128 v63, v[4:7] offset:53248
    s_barrier
    ds_write_b128 v63, v[8:11] offset:57344
    ds_write_b128 v63, v[12:15] offset:61440
    s_waitcnt lgkmcnt(0)
    buffer_load_dword v24, off, s[96:99], 0 offset:140 sc1
    buffer_load_dword v25, off, s[96:99], 0 offset:64 sc1
    s_lshr_b32 s84, s12, 1
    s_lshl_b32 s84, s84, 8
    s_add_u32 s84, s84, 125829120
    v_bfe_u32 v26, v61, 4, 6
    v_min_u32 v26, 11, v26
    v_lshlrev_b32 v26, 2, v26
    buffer_load_dword v27, v26, s[4:7], s84 offen sc1
    s_waitcnt vmcnt(11)
    v_add_u32 v55, 131072, v52
    ds_read_b64_tr_b16 v[0:1], v55 offset:0
    ds_read_b64_tr_b16 v[2:3], v55 offset:256
    ds_read_b64_tr_b16 v[4:5], v55 offset:4096
    ds_read_b64_tr_b16 v[6:7], v55 offset:4352
    ds_read_b64_tr_b16 v[8:9], v55 offset:64
    ds_read_b64_tr_b16 v[10:11], v55 offset:320
    ds_read_b64_tr_b16 v[12:13], v55 offset:4160
    ds_read_b64_tr_b16 v[14:15], v55 offset:4416
    s_waitcnt lgkmcnt(0)
    s_barrier
    ds_write_b128 v63, v[0:3] offset:32768
    ds_write_b128 v63, v[4:7] offset:36864
    s_barrier
    ds_write_b128 v63, v[8:11] offset:40960
    ds_write_b128 v63, v[12:15] offset:45056
    s_waitcnt lgkmcnt(0)
    s_waitcnt vmcnt(7)
    v_add_u32 v55, 114688, v52
    ds_read_b64_tr_b16 v[0:1], v55 offset:0
    ds_read_b64_tr_b16 v[2:3], v55 offset:256
    ds_read_b64_tr_b16 v[4:5], v55 offset:4096
    ds_read_b64_tr_b16 v[6:7], v55 offset:4352
    ds_read_b64_tr_b16 v[8:9], v55 offset:64
    ds_read_b64_tr_b16 v[10:11], v55 offset:320
    ds_read_b64_tr_b16 v[12:13], v55 offset:4160
    ds_read_b64_tr_b16 v[14:15], v55 offset:4416
    s_waitcnt lgkmcnt(0)
    s_barrier
    ds_write_b128 v63, v[0:3] offset:16384
    ds_write_b128 v63, v[4:7] offset:20480
    s_barrier
    ds_write_b128 v63, v[8:11] offset:24576
    ds_write_b128 v63, v[12:15] offset:28672
    s_waitcnt lgkmcnt(0)
    v_min_u32 v36, -2, v36
    v_min_u32 v37, -2, v37
    v_min_u32 v38, -2, v38
    v_min_u32 v39, -2, v39
    v_min_u32 v40, -2, v40
    v_min_u32 v41, -2, v41
    v_min_u32 v42, -2, v42
    v_min_u32 v43, -2, v43
    v_min_u32 v44, -2, v44
    s_lshl_b32 s14, s12, 16
    s_add_u32 s14, s14, 92274688
    s_add_u32 s41, s14, 4096
    s_add_u32 s42, s14, 8192
    v_lshrrev_b32 v45, 2, v61
    buffer_store_dwordx4 v[36:39], v61, s[4:7], s14 offen
    buffer_store_dwordx4 v[40:43], v61, s[4:7], s41 offen
    buffer_store_dword v44, v45, s[4:7], s42 offen
    s_waitcnt vmcnt(1)
    v_readfirstlane_b32 s95, v25
    v_readfirstlane_b32 s85, v24
    s_add_u32 s86, s95, 1
    s_waitcnt vmcnt(0)
    v_subrev_u32 v27, s86, v27
    v_cmp_lt_u32 s[86:87], 64, v27
    s_cmp_eq_u32 s95, 0
    s_cselect_b64 s[86:87], -1, s[86:87]
    s_cmp_lg_u64 s[86:87], 0
    s_cbranch_scc1 cf_nt
    s_add_u32 s40, s24, 524288
    buffer_load_dword v30, v79, s[4:7], s24 offen sc1
    buffer_load_dword v30, v79, s[4:7], s40 offen sc1
cf_nt:
    s_waitcnt vmcnt(3)
    v_add_u32 v55, 81920, v51
    v_xor_b32 v56, 32, v55
    ds_read_b64_tr_b16 v[0:1], v55 offset:0
    ds_read_b64_tr_b16 v[2:3], v55 offset:256
    ds_read_b64_tr_b16 v[4:5], v55 offset:8192
    ds_read_b64_tr_b16 v[6:7], v55 offset:8448
    ds_read_b64_tr_b16 v[8:9], v56 offset:0
    ds_read_b64_tr_b16 v[10:11], v56 offset:256
    ds_read_b64_tr_b16 v[12:13], v56 offset:8192
    ds_read_b64_tr_b16 v[14:15], v56 offset:8448
    s_waitcnt lgkmcnt(0)
    ds_write_b128 v62, v[0:3] offset:24576
    ds_write_b128 v62, v[4:7] offset:28672
    ds_write_b128 v62, v[8:11] offset:32768
    ds_write_b128 v62, v[12:15] offset:36864
    s_waitcnt lgkmcnt(0)
    s_barrier
    s_mov_b32 s88, 4194304
gn2:
    s_cmp_lg_u32 s95, 0
    s_cbranch_scc1 gn2x
    buffer_load_dword v27, off, s[96:99], 0 offset:64 sc1
    s_sub_u32 s88, s88, 1
    s_cbranch_scc1 gn2x
    s_waitcnt vmcnt(0)
    v_readfirstlane_b32 s95, v27
    s_nop 1
    s_branch gn2
gn2x:
    ds_write_b128 v78, v[16:19] offset:8704
    ds_write_b128 v65, v[20:23] offset:10240
    v_mov_b32 v44, s95
    v_mov_b32 v45, s95
    v_mov_b32 v46, s95
    v_mov_b32 v47, s95
    v_mov_b32 v48, 108288
    ds_write_b128 v48, v[44:47]
    s_waitcnt vmcnt(0) lgkmcnt(0)
    s_cmp_eq_u32 s85, 1
    s_cbranch_scc1 cf_run
    s_mov_b32 s40, 131072
cf_startpoll:
    buffer_load_dword v3, off, s[96:99], 0 offset:140 sc1
    s_waitcnt vmcnt(0)
    v_readfirstlane_b32 s85, v3
    s_nop 0
    s_cmp_eq_u32 s85, 1
    s_cbranch_scc1 cf_run
    s_cmp_eq_u32 s85, 2
    s_cbranch_scc1 cf_leave
    s_sleep 1
    s_sub_u32 s40, s40, 1
    s_cbranch_scc0 cf_startpoll
    v_mov_b32 v4, 2
    v_mov_b32 v5, 0
    s_mov_b64 exec, 1
    buffer_atomic_cmpswap v[4:5], off, s[96:99], 0 offset:140
    s_mov_b64 exec, -1
    s_mov_b32 s40, 1048576
    s_branch cf_startpoll
cf_leave:
    v_lshrrev_b32 v0, 4, v61
    s_mov_b32 s32, s13
    s_load_dwordx16 s[48:63], s[0:1], 0
    s_waitcnt lgkmcnt(0)
    s_branch L_helper
cf_run:
    s_cmp_eq_u64 s[86:87], 0
    s_cbranch_scc1 cf_kvok
    s_lshr_b32 s92, s12, 1
    s_lshl_b32 s92, s92, 8
    s_add_u32 s92, s92, 125829120
    v_bfe_u32 v2, v61, 4, 6
    v_min_u32 v2, 11, v2
    v_lshlrev_b32 v2, 2, v2
    s_add_u32 s93, s95, 1
    s_mov_b32 s94, 4194304
cf_kv0:
    buffer_load_dword v3, v2, s[4:7], s92 offen sc1
    s_sub_u32 s94, s94, 1
    s_cbranch_scc1 cf_kv0_go
    s_waitcnt vmcnt(0)
    v_subrev_u32 v3, s93, v3
    v_cmp_lt_u32 vcc, 64, v3
    s_cbranch_vccz cf_kv0_go
    s_sleep 2
    s_branch cf_kv0
cf_kv0_go:
    s_add_u32 s40, s24, 524288
    buffer_load_dword v30, v79, s[4:7], s24 offen sc1
    buffer_load_dword v30, v79, s[4:7], s40 offen sc1
    s_waitcnt vmcnt(0)
cf_kvok:
    s_mov_b32 m0, 108032
    s_add_u32 s24, s24, 1048576
    s_mov_b32 s66, 0x200009
    s_mov_b32 s67, 0xc0000000
    s_add_u32 s15, s14, 4096
    s_add_u32 s16, s14, 8192
    ds_read_b128 v[32:35], v62 offset:16384
    ds_read_b128 v[36:39], v62 offset:20480
    ds_read_b128 v[40:43], v61 offset:0
    ds_read_b128 v[44:47], v61 offset:4096
    ds_read_b128 v[48:51], v61 offset:8192
    ds_read_b128 v[52:55], v61 offset:12288
    s_add_u32 s18, s14, s31
    s_mov_b32 s29, 1048576
    buffer_load_dwordx4 v[24:27], v61, s[4:7], s14 offen nt
.p2align 6
cf_loop:
    v_mov_b64 v[0:1], 0
    v_mov_b64 v[2:3], 0
    v_mov_b64 v[4:5], 0
    v_mov_b64 v[6:7], 0
    v_mov_b64 v[8:9], 0
    v_mov_b64 v[10:11], 0
    v_mov_b64 v[12:13], 0
    v_mov_b64 v[14:15], 0
cf_loop2:
    ds_read_b128 v[16:19], v62 offset:8192
    ds_read_b128 v[20:23], v62 offset:12288
    v_lshrrev_b32 v56, 2, v61
    v_add_u32 v58, 106496, v56
    s_mov_b32 s29, 1048576
    s_nop 13
    buffer_load_dwordx4 v[24:27], v61, s[4:7], s14 offen nt
    s_waitcnt lgkmcnt(0)
cf_chk0:
    s_waitcnt vmcnt(1)
cf_chk0b:
    v_max3_u32 v57, v24, v25, v26
    v_max_u32 v57, v57, v27
    v_cmp_eq_u32 vcc, -1, v57
    ds_write_b128 v62, v[24:27] offset:40960
    s_cbranch_vccnz cf_spin0
    v_smfmac_f32_16x16x64_bf16 v[0:3], v[24:27], v[16:23], v60
    s_mov_b32 m0, s58
    s_nop 0
    buffer_load_dwordx4 v61, s[4:7], s15 offen nt lds
    v_smfmac_f32_16x16x64_bf16 v[8:11], v[24:27], v[32:39], v60
    s_mov_b32 m0, s59
    s_nop 0
    buffer_load_dword v56, s[4:7], s16 offen nt lds
    v_smfmac_f32_16x16x64_bf16 v[12:15], v[24:27], v[48:55], v60
    ds_read_b128 v[32:35], v61 offset:16384
    v_mfma_f32_16x16x16_bf16 v[16:19], v[72:73], v[72:73], 0
    ds_read_b128 v[36:39], v61 offset:20480
    s_waitcnt lgkmcnt(2)
    s_barrier
    ds_read_b128 v[48:51], v63 offset:0
    v_mfma_f32_16x16x16_bf16 v[20:23], v[72:73], v[72:73], 0
    ds_read_b128 v[52:55], v64 offset:0
    v_smfmac_f32_16x16x64_bf16 v[4:7], v[24:27], v[40:47], v60
    ds_read_b128 v[40:43], v61 offset:24576
    v_smfmac_f32_16x16x64_bf16 v[16:19], v[24:27], a[192:199], v60
    ds_read_b128 v[44:47], v61 offset:28672
    v_smfmac_f32_16x16x64_bf16 v[20:23], v[24:27], a[200:207], v60
    s_mov_b32 m0, 108032
    s_waitcnt lgkmcnt(3)
    v_smfmac_f32_16x16x64_bf16 v[0:3], v[48:51], a[0:7], v60
    s_add_u32 s43, s14, s31
    s_add_u32 s41, s14, 16384
    v_smfmac_f32_16x16x64_bf16 v[4:7], v[48:51], v[32:39], v60
    ds_read_b128 v[32:35], v61 offset:32768
    v_smfmac_f32_16x16x64_bf16 v[8:11], v[48:51], a[8:15], v60
    ds_read_b128 v[36:39], v61 offset:36864
    s_waitcnt lgkmcnt(2)
    v_smfmac_f32_16x16x64_bf16 v[12:15], v[48:51], v[40:47], v60
    ds_read_b128 v[40:43], v61 offset:40960
    v_smfmac_f32_16x16x64_bf16 v[16:19], v[48:51], a[208:215], v60
    ds_read_b128 v[44:47], v61 offset:45056
    v_smfmac_f32_16x16x64_bf16 v[20:23], v[48:51], a[216:223], v60
    ds_read_b128 v[48:51], v71 offset:0
    v_smfmac_f32_16x16x64_bf16 v[0:3], v[52:55], a[16:23], v60
    s_waitcnt vmcnt(0)
    ds_read_b128 v[28:31], v62 offset:45056
    s_waitcnt lgkmcnt(4)
    v_smfmac_f32_16x16x64_bf16 v[4:7], v[52:55], v[32:39], v60
    ds_read_b32 v59, v58
    buffer_load_dwordx4 v[24:27], v61, s[4:7], s23 offen offset:0 sc1
    v_smfmac_f32_16x16x64_bf16 v[8:11], v[52:55], a[24:31], v60
    ds_read_b128 v[32:35], v61 offset:49152
    s_waitcnt lgkmcnt(4)
    v_smfmac_f32_16x16x64_bf16 v[12:15], v[52:55], v[40:47], v60
    ds_read_b128 v[36:39], v61 offset:53248
    v_smfmac_f32_16x16x64_bf16 v[16:19], v[52:55], a[224:231], v60
    ds_read_b128 v[40:43], v61 offset:57344
    v_smfmac_f32_16x16x64_bf16 v[20:23], v[52:55], a[232:239], v60
    ds_read_b128 v[44:47], v61 offset:61440
    s_waitcnt lgkmcnt(4)
    v_smfmac_f32_16x16x64_bf16 v[0:3], v[48:51], a[32:39], v60
    v_max3_u32 v57, v28, v29, v30
    v_smfmac_f32_16x16x64_bf16 v[8:11], v[48:51], a[40:47], v60
    v_max3_u32 v57, v57, v31, v59
    s_waitcnt lgkmcnt(2)
    v_smfmac_f32_16x16x64_bf16 v[4:7], v[48:51], v[32:39], v60
    buffer_load_dwordx4 v[32:35], v61, s[4:7], s23 offen offset:1024 sc1
    v_cmp_eq_u32 vcc, -1, v57
    v_smfmac_f32_16x16x64_bf16 v[16:19], v[48:51], a[240:247], v60
    v_smfmac_f32_16x16x64_bf16 v[20:23], v[48:51], a[248:255], v60
    s_cbranch_vccnz cf_spin1
cf_go1:
    s_barrier
    ds_read_b128 v[52:55], v63 offset:4096
    s_waitcnt lgkmcnt(1)
    v_smfmac_f32_16x16x64_bf16 v[12:15], v[48:51], v[40:47], v60
    ds_read_b128 v[48:51], v64 offset:4096
    v_smfmac_f32_16x16x64_bf16 v[0:3], v[28:31], a[48:55], v60
    buffer_load_dwordx4 v[40:43], v61, s[4:7], s23 offen offset:2048 sc1
    v_smfmac_f32_16x16x64_bf16 v[8:11], v[28:31], a[56:63], v60
    ds_read_b128 v[56:59], v71 offset:4096
    s_and_b32 s41, s41, 65535
    v_smfmac_f32_16x16x64_bf16 v[4:7], v[28:31], a[128:135], v60
    ds_read_b128 v[36:39], v65 offset:8192
    s_add_u32 s41, s41, 67108864
    v_smfmac_f32_16x16x64_bf16 v[12:15], v[28:31], a[136:143], v60
    s_add_u32 s17, s41, s31
    s_and_b32 s30, s28, 1
    s_waitcnt lgkmcnt(3)
    v_smfmac_f32_16x16x64_bf16 v[0:3], v[52:55], a[64:71], v60
    buffer_load_dwordx4 v[44:47], v61, s[4:7], s23 offen offset:3072 sc1
    v_smfmac_f32_16x16x64_bf16 v[4:7], v[52:55], a[144:151], v60
    ds_read_b128 v[28:31], v78 offset:8704
    v_smfmac_f32_16x16x64_bf16 v[8:11], v[52:55], a[72:79], v60
    v_smfmac_f32_16x16x64_bf16 v[12:15], v[52:55], a[152:159], v60
    ds_read_b128 v[52:55], v62 offset:28672
    s_waitcnt lgkmcnt(4)
    v_smfmac_f32_16x16x64_bf16 v[0:3], v[48:51], a[80:87], v60
    v_smfmac_f32_16x16x64_bf16 v[4:7], v[48:51], a[160:167], v60
    v_smfmac_f32_16x16x64_bf16 v[8:11], v[48:51], a[88:95], v60
    buffer_load_dword v79, s[4:7], s24 offen sc1 lds
    v_smfmac_f32_16x16x64_bf16 v[12:15], v[48:51], a[168:175], v60
    v_smfmac_f32_16x16x64_bf16 v[16:19], v[48:51], v[112:119], v60
    v_smfmac_f32_16x16x64_bf16 v[20:23], v[48:51], v[120:127], v60
    ds_read_b128 v[48:51], v62 offset:24576
    s_waitcnt lgkmcnt(4)
    v_smfmac_f32_16x16x64_bf16 v[0:3], v[56:59], a[96:103], v60
    s_bitcmp1_b64 s[66:67], s28
    v_smfmac_f32_16x16x64_bf16 v[8:11], v[56:59], a[104:111], v60
    s_waitcnt lgkmcnt(3)
    v_smfmac_f32_16x16x64_bf16 v[0:3], v[36:39], a[112:119], v60
    v_smfmac_f32_16x16x64_bf16 v[8:11], v[36:39], a[120:127], v60
    v_smfmac_f32_16x16x64_bf16 v[4:7], v[56:59], a[176:183], v60
    s_waitcnt lgkmcnt(0)
    v_cvt_pk_bf16_f32 v0, v0, v1
    v_smfmac_f32_16x16x64_bf16 v[4:7], v[36:39], v[48:55], v60
    ds_read_b128 v[48:51], v62 offset:32768
    v_cvt_pk_bf16_f32 v8, v8, v9
    v_smfmac_f32_16x16x64_bf16 v[12:15], v[56:59], a[184:191], v60
    ds_read_b128 v[52:55], v62 offset:36864
    v_cvt_pk_bf16_f32 v9, v10, v11
    v_smfmac_f32_16x16x64_bf16 v[16:19], v[56:59], v[128:135], v60
    v_cvt_pk_bf16_f32 v1, v2, v3
    v_mfma_f32_16x16x16_bf16 v[8:11], v[8:9], v[28:29], 0
    v_cvt_pk_bf16_f32 v2, v4, v5
    v_cvt_pk_bf16_f32 v3, v6, v7
    v_smfmac_f32_16x16x64_bf16 v[20:23], v[56:59], v[136:143], v60
    s_mov_b64 exec, s[36:37]
    ds_read_b128 v[56:59], v69
    s_mov_b64 exec, -1
    v_mfma_f32_16x16x32_bf16 v[4:7], v[0:3], v[28:31], 0
    v_cvt_pk_bf16_f32 v2, v8, v9
    s_waitcnt lgkmcnt(1)
    v_smfmac_f32_16x16x64_bf16 v[12:15], v[36:39], v[48:55], v60
    ds_read_b128 v[48:51], v63 offset:4096
    v_cvt_pk_bf16_f32 v3, v10, v11
    s_waitcnt vmcnt(3)
    v_cvt_pk_bf16_f32 v0, v4, v5
    v_cvt_pk_bf16_f32 v1, v6, v7
    s_nop 1
    v_mfma_f32_16x16x32_bf16 v[4:7], v[32:35], v[0:3], 0
    v_cvt_pk_bf16_f32 v12, v12, v13
    v_cvt_pk_bf16_f32 v13, v14, v15
    s_nop 1
    v_mfma_f32_16x16x16_bf16 v[12:15], v[12:13], v[30:31], 0
    ds_read_b128 v[52:55], v62 offset:45056
    ds_read_b128 v[32:35], v63 offset:49152
    v_mfma_f32_16x16x32_bf16 v[28:31], v[24:27], v[0:3], 0
    s_waitcnt vmcnt(1)
    s_mov_b64 exec, s[34:35]
    s_nop 1
    v_cvt_pk_bf16_f32 v2, v12, v13
    v_cvt_pk_bf16_f32 v3, v14, v15
    s_mov_b64 exec, -1
    s_nop 0
    v_mfma_f32_16x16x32_bf16 v[8:11], v[0:3], v[0:3], 0
    v_mov_b32_dpp v28, v4 row_ror:8 row_mask:0xf bank_mask:0xc
    v_mov_b32_dpp v29, v5 row_ror:8 row_mask:0xf bank_mask:0xc
    v_mov_b32_dpp v30, v6 row_ror:8 row_mask:0xf bank_mask:0xc
    v_mov_b32_dpp v31, v7 row_ror:8 row_mask:0xf bank_mask:0xc
    v_smfmac_f32_16x16x64_bf16 v[16:19], v[36:39], v[144:151], v60
    ds_write_b128 v62, v[28:31] offset:53248
    v_mov_b32_dpp v8, v10 row_ror:8 row_mask:0xf bank_mask:0xc
    v_mov_b32_dpp v9, v11 row_ror:8 row_mask:0xf bank_mask:0xc
    v_smfmac_f32_16x16x64_bf16 v[20:23], v[36:39], v[152:159], v60
    ds_write_b64 v70, v[8:9]
    s_waitcnt lgkmcnt(4)
    v_smfmac_f32_16x16x64_bf16 v[16:19], v[48:51], v[96:103], v60
    s_mov_b64 exec, s[36:37]
    buffer_store_dwordx4 v[56:59], v61, s[4:7], s65 offen sc1
    s_mov_b64 exec, -1
    v_smfmac_f32_16x16x64_bf16 v[20:23], v[48:51], v[104:111], v60
    s_cbranch_scc1 cf_last
cf_back:
    s_waitcnt lgkmcnt(0)
    s_barrier
    ds_read_b128 v[56:59], v78 offset:10752
    v_smfmac_f32_16x16x64_bf16 v[16:19], v[52:55], v[80:87], v60
    ds_read_b128 v[12:15], v78 offset:11264
    ds_read_b128 v[4:7], v63 offset:12288
    v_smfmac_f32_16x16x64_bf16 v[20:23], v[52:55], v[88:95], v60
    ds_read_b128 v[8:11], v64 offset:12288
    ds_read_b128 v[0:3], v71 offset:12288
    v_mov_b64 v[24:25], s[62:63]
    v_mov_b64 v[26:27], s[60:61]
    v_cvt_pk_bf16_f32 v16, v16, v17
    v_cvt_pk_bf16_f32 v17, v18, v19
    v_pk_mul_f32 v[28:29], v[28:29], s[44:45]
    v_pk_mul_f32 v[30:31], v[30:31], s[44:45]
    s_waitcnt lgkmcnt(3)
    v_pk_add_f32 v[56:57], v[56:57], v[58:59]
    v_pk_add_f32 v[12:13], v[12:13], v[14:15]
    v_pk_add_f32 v[56:57], v[56:57], v[12:13]
    v_pk_mul_f32 v[56:57], v[56:57], s[44:45]
    v_exp_f32 v58, v56
    v_exp_f32 v59, v57
    s_waitcnt lgkmcnt(1)
    v_pk_fma_f32 v[28:29], v[4:5], s[44:45], v[28:29]
    v_pk_fma_f32 v[30:31], v[6:7], s[44:45], v[30:31]
    v_cvt_pk_bf16_f32 v6, v58, v59
    v_pk_fma_f32 v[28:29], v[8:9], s[44:45], v[28:29]
    v_pk_fma_f32 v[30:31], v[10:11], s[44:45], v[30:31]
    s_waitcnt lgkmcnt(0)
    v_pk_fma_f32 v[28:29], v[0:1], s[44:45], v[28:29]
    v_mov_b32_dpp v7, v6 row_ror:8 row_mask:0xf bank_mask:0xf
    v_pk_fma_f32 v[30:31], v[2:3], s[44:45], v[30:31]
    v_exp_f32 v0, v28
    v_mfma_f32_16x16x16_bf16 v[12:15], v[16:17], v[6:7], 0
    ds_read_b128 v[48:51], v63 offset:57344
    v_exp_f32 v1, v29
    v_cvt_pk_bf16_f32 v18, v20, v21
    v_exp_f32 v2, v30
    v_cvt_pk_bf16_f32 v19, v22, v23
    v_cvt_pk_bf16_f32 v8, v0, v1
    v_exp_f32 v3, v31
    v_mfma_f32_16x16x16_bf16 v[20:23], v[18:19], v[6:7], 0
    ds_read_b128 v[52:55], v63 offset:61440
    v_cvt_pk_bf16_f32 v9, v2, v3
    v_mov_b32_dpp v10, v8 row_ror:8 row_mask:0xf bank_mask:0xf
    v_max3_f32 v4, |v28|, |v29|, |v30|
    v_mov_b32_dpp v11, v9 row_ror:8 row_mask:0xf bank_mask:0xf
    v_mfma_f32_16x16x32_bf16 v[0:3], v[24:27], v[6:9], 0
    ds_read_b128 v[36:39], v63 offset:53248
    v_max3_f32 v4, v4, |v31|, |v56|
    v_max_f32_e64 v4, v4, |v57|
    v_mfma_f32_16x16x32_bf16 v[12:15], v[40:43], v[8:11], v[12:15]
    v_cmp_nge_f32 vcc, s46, v4
    v_mfma_f32_16x16x32_bf16 v[20:23], v[44:47], v[8:11], v[20:23]
    v_add_f32_dpp v0, v0, v0 row_ror:8 row_mask:0xf bank_mask:0xf
    v_rcp_f32 v0, v0
    s_cbranch_vccnz cf_guard
cf_norm:
    v_mfma_f32_16x16x16_bf16 v[28:31], v[72:73], v[72:73], 0
    v_mul_f32 v12, v12, v0
    v_mul_f32 v13, v13, v0
    v_mul_f32 v14, v14, v0
    v_mul_f32 v15, v15, v0
    v_mul_f32_dpp v12, v20, v0 row_ror:8 row_mask:0xf bank_mask:0xc
    v_mul_f32_dpp v13, v21, v0 row_ror:8 row_mask:0xf bank_mask:0xc
    v_mul_f32_dpp v14, v22, v0 row_ror:8 row_mask:0xf bank_mask:0xc
    v_mul_f32_dpp v15, v23, v0 row_ror:8 row_mask:0xf bank_mask:0xc
    v_cvt_pk_bf16_f32 v12, v12, v13
    v_cvt_pk_bf16_f32 v13, v14, v15
    v_mfma_f32_16x16x16_bf16 v[8:11], v[72:73], v[72:73], 0
    ds_write_b64 v77, v[12:13]
    v_mfma_f32_16x16x16_bf16 v[4:7], v[72:73], v[72:73], 0
    ds_read_b128 v[0:3], v68
    v_mfma_f32_16x16x16_bf16 v[16:19], v[72:73], v[72:73], 0
    ds_read_b128 v[40:43], v63 offset:16384
    v_mfma_f32_16x16x16_bf16 v[20:23], v[72:73], v[72:73], 0
    ds_read_b128 v[44:47], v63 offset:20480
    s_waitcnt lgkmcnt(3)
    s_barrier
    ds_read_b128 v[24:27], v74
    ds_read_b128 v[12:15], v75
    ds_read_b128 v[56:59], v76
    s_waitcnt lgkmcnt(5)
    v_smfmac_f32_16x16x64_bf16 v[28:31], v[0:3], v[160:167], v60
    v_smfmac_f32_16x16x64_bf16 v[8:11], v[0:3], v[192:199], v60
    v_smfmac_f32_16x16x64_bf16 v[4:7], v[0:3], v[32:39], v60
    ds_read_b128 v[32:35], v63 offset:32768
    v_smfmac_f32_16x16x64_bf16 v[16:19], v[0:3], v[224:231], v60
    ds_read_b128 v[36:39], v63 offset:36864
    s_waitcnt lgkmcnt(3)
    v_smfmac_f32_16x16x64_bf16 v[28:31], v[24:27], v[168:175], v60
    v_smfmac_f32_16x16x64_bf16 v[4:7], v[12:15], v[48:55], v60
    ds_read_b128 v[48:51], v63 offset:24576
    v_smfmac_f32_16x16x64_bf16 v[28:31], v[12:15], v[176:183], v60
    ds_read_b128 v[52:55], v63 offset:28672
    s_waitcnt lgkmcnt(4)
    v_smfmac_f32_16x16x64_bf16 v[28:31], v[56:59], v[184:191], v60
    v_cvt_pk_bf16_f32 v4, v4, v5
    v_smfmac_f32_16x16x64_bf16 v[16:19], v[12:15], v[40:47], v60
    ds_read_b128 v[40:43], v63 offset:40960
    v_and_or_b32 v4, v4, -2, s30
    v_smfmac_f32_16x16x64_bf16 v[8:11], v[24:27], v[200:207], v60
    ds_read_b128 v[44:47], v63 offset:45056
    v_cvt_pk_bf16_f32 v5, v6, v7
    v_smfmac_f32_16x16x64_bf16 v[8:11], v[12:15], v[208:215], v60
    buffer_store_dwordx2 v[4:5], v67, s[4:7], s22 offen
    v_cvt_pk_bf16_f32 v28, v28, v29
    v_smfmac_f32_16x16x64_bf16 v[8:11], v[56:59], v[216:223], v60
    v_and_or_b32 v28, v28, -2, s30
    v_smfmac_f32_16x16x64_bf16 v[16:19], v[24:27], v[232:239], v60
    v_cvt_pk_bf16_f32 v29, v30, v31
    s_waitcnt lgkmcnt(4)
    v_smfmac_f32_16x16x64_bf16 v[16:19], v[56:59], v[32:39], v60
    buffer_store_dwordx2 v[28:29], v66, s[4:7], s20 offen
    v_cvt_pk_bf16_f32 v8, v8, v9
    s_waitcnt lgkmcnt(0)
    v_smfmac_f32_16x16x64_bf16 v[20:23], v[0:3], v[240:247], v60
    v_and_or_b32 v8, v8, -2, s30
    v_smfmac_f32_16x16x64_bf16 v[20:23], v[24:27], v[248:255], v60
    v_cvt_pk_bf16_f32 v9, v10, v11
    v_smfmac_f32_16x16x64_bf16 v[20:23], v[12:15], v[48:55], v60
    buffer_store_dwordx2 v[8:9], v66, s[4:7], s21 offen
    v_cvt_pk_bf16_f32 v16, v16, v17
    v_smfmac_f32_16x16x64_bf16 v[20:23], v[56:59], v[40:47], v60
    v_and_or_b32 v16, v16, -2, s30
    v_cvt_pk_bf16_f32 v17, v18, v19
    buffer_store_dwordx2 v[16:17], v66, s[4:7], s38 offen
    s_cmp_lg_u32 s13, 2
    s_nop 1
    v_cvt_pk_bf16_f32 v20, v20, v21
    v_and_or_b32 v20, v20, -2, s30
    v_cvt_pk_bf16_f32 v21, v22, v23
    buffer_store_dwordx2 v[20:21], v66, s[4:7], s39 offen
    s_cbranch_scc1 cf_w013
    v_mov_b32 v21, -1
    s_mov_b64 exec, s[32:33]
    buffer_store_dword v21, v69, s[4:7], s18 offen
    s_mov_b64 exec, -1
    s_mov_b32 s18, s43
    s_nop 15
    s_nop 15
    s_nop 15
    s_nop 14
    buffer_load_dwordx4 v[40:43], v65, s[4:7], s19 offen offset:0 nt
    buffer_load_dwordx4 v[44:47], v65, s[4:7], s19 offen offset:1024 nt
    buffer_load_dwordx4 v[48:51], v65, s[4:7], s19 offen offset:2048 nt
    buffer_load_dwordx4 v[52:55], v65, s[4:7], s19 offen offset:3072 nt
    ds_read_b128 v[56:59], v65 offset:10240
    s_add_u32 s28, s28, 1
    s_mov_b32 s14, s41
    s_add_u32 s23, s23, 524288
    s_add_u32 s24, s24, 524288
    s_min_u32 s24, s24, s47
    s_add_u32 s15, s14, 4096
    s_add_u32 s16, s14, 8192
    s_add_u32 s65, s65, 12288
    s_mov_b32 s40, 1
    v_mov_b64 v[0:1], 0
    v_mov_b64 v[2:3], 0
    v_mov_b64 v[4:5], 0
    v_mov_b64 v[6:7], 0
    v_mov_b64 v[8:9], 0
    v_mov_b64 v[10:11], 0
    v_mov_b64 v[12:13], 0
    v_mov_b64 v[14:15], 0
cf_chkF:
    v_mov_b32 v20, 0
    s_waitcnt vmcnt(3)
    s_waitcnt lgkmcnt(0)
    v_mfma_f32_16x16x32_bf16 v[28:31], v[40:43], v[56:59], 0
    v_bitop3_b32 v20, v20, v40, s30 bitop3:0xf6
    v_bitop3_b32 v20, v20, v42, s30 bitop3:0xf6
    s_waitcnt vmcnt(2)
    v_mfma_f32_16x16x32_bf16 v[28:31], v[44:47], v[56:59], v[28:31]
    v_bitop3_b32 v20, v20, v44, s30 bitop3:0xf6
    v_bitop3_b32 v20, v20, v46, s30 bitop3:0xf6
    s_waitcnt vmcnt(1)
    v_mfma_f32_16x16x32_bf16 v[28:31], v[48:51], v[56:59], v[28:31]
    v_bitop3_b32 v20, v20, v48, s30 bitop3:0xf6
    v_bitop3_b32 v20, v20, v50, s30 bitop3:0xf6
    s_waitcnt vmcnt(0)
    v_mfma_f32_16x16x32_bf16 v[28:31], v[52:55], v[56:59], v[28:31]
    v_bitop3_b32 v20, v20, v52, s30 bitop3:0xf6
    v_bitop3_b32 v20, v20, v54, s30 bitop3:0xf6
    v_and_b32 v20, s40, v20
    v_cmp_ne_u32 vcc, 0, v20
    s_cbranch_vccnz cf_spinF
    v_permlane32_swap_b32 v28, v30
    v_permlane32_swap_b32 v29, v31
    v_add_f32 v28, v28, v30
    v_add_f32 v30, v29, v31
    v_cvt_pk_bf16_f32 v28, v28, v30
    s_mov_b64 exec, s[32:33]
    buffer_store_dword v28, v69, s[4:7], s17 offen
    s_mov_b64 exec, -1
    ds_read_b128 v[32:35], v62 offset:16384
    ds_read_b128 v[36:39], v62 offset:20480
    ds_read_b128 v[40:43], v61 offset:0
    ds_read_b128 v[44:47], v61 offset:4096
    ds_read_b128 v[48:51], v61 offset:8192
    ds_read_b128 v[52:55], v61 offset:12288
    s_nop 15
    s_nop 1
    buffer_load_dwordx4 v[24:27], v61, s[4:7], s14 offen nt
    s_branch cf_loop2
cf_w013:
    ds_read_b128 v[56:59], v65 offset:10240
    ds_read_b128 v[32:35], v62 offset:16384
    ds_read_b128 v[36:39], v62 offset:20480
    ds_read_b128 v[40:43], v61 offset:0
    ds_read_b128 v[44:47], v61 offset:4096
    ds_read_b128 v[48:51], v61 offset:8192
    ds_read_b128 v[52:55], v61 offset:12288
    s_add_u32 s28, s28, 1
    s_mov_b32 s14, s41
    s_add_u32 s23, s23, 524288
    s_add_u32 s24, s24, 524288
    s_min_u32 s24, s24, s47
    s_add_u32 s15, s14, 4096
    s_add_u32 s16, s14, 8192
    s_add_u32 s65, s65, 12288
    s_mov_b32 s40, 1
    s_cmp_eq_u32 s64, 0
    s_cbranch_scc1 cf_w0
    v_mov_b32 v21, -1
    s_mov_b64 exec, s[32:33]
    buffer_store_dword v21, v69, s[4:7], s18 offen
    s_mov_b64 exec, -1
    s_mov_b32 s18, s43
    s_cmp_eq_u32 s13, 1
    s_nop 15
    s_nop 15
    s_nop 1
    s_cbranch_scc1 cf_sx
    s_nop 15
    s_nop 11
cf_sx:
    buffer_load_dwordx4 v[0:3], v65, s[4:7], s19 offen offset:0 nt
    buffer_load_dwordx4 v[4:7], v65, s[4:7], s19 offen offset:1024 nt
    buffer_load_dwordx4 v[8:11], v65, s[4:7], s19 offen offset:2048 nt
    buffer_load_dwordx4 v[12:15], v65, s[4:7], s19 offen offset:3072 nt
cf_chkG:
    v_mov_b32 v20, 0
    s_waitcnt vmcnt(3)
    s_waitcnt lgkmcnt(6)
    v_mfma_f32_16x16x32_bf16 v[28:31], v[0:3], v[56:59], 0
    v_bitop3_b32 v20, v20, v0, s30 bitop3:0xf6
    v_bitop3_b32 v20, v20, v2, s30 bitop3:0xf6
    s_waitcnt vmcnt(2)
    v_mfma_f32_16x16x32_bf16 v[28:31], v[4:7], v[56:59], v[28:31]
    v_bitop3_b32 v20, v20, v4, s30 bitop3:0xf6
    v_bitop3_b32 v20, v20, v6, s30 bitop3:0xf6
    s_waitcnt vmcnt(1)
    v_mfma_f32_16x16x32_bf16 v[28:31], v[8:11], v[56:59], v[28:31]
    v_bitop3_b32 v20, v20, v8, s30 bitop3:0xf6
    v_bitop3_b32 v20, v20, v10, s30 bitop3:0xf6
    s_waitcnt vmcnt(0)
    v_mfma_f32_16x16x32_bf16 v[28:31], v[12:15], v[56:59], v[28:31]
    v_bitop3_b32 v20, v20, v12, s30 bitop3:0xf6
    v_bitop3_b32 v20, v20, v14, s30 bitop3:0xf6
    v_and_b32 v20, s40, v20
    v_cmp_ne_u32 vcc, 0, v20
    s_cbranch_vccnz cf_spinG
    v_permlane32_swap_b32 v28, v30
    v_permlane32_swap_b32 v29, v31
    v_add_f32 v28, v28, v30
    v_add_f32 v30, v29, v31
    s_cmp_eq_u32 s13, 3
    s_cbranch_scc1 cf_w3
    v_mov_b32 v29, v28
    v_mov_b32 v31, v30
    s_nop 0
    v_permlane16_swap_b32 v28, v29
    v_permlane16_swap_b32 v30, v31
    v_add_f32 v28, v28, v29
    v_add_f32 v30, v30, v31
cf_w3:
    v_cvt_pk_bf16_f32 v28, v28, v30
    s_mov_b64 exec, s[32:33]
    buffer_store_dword v28, v69, s[4:7], s17 offen
    s_mov_b64 exec, -1
    buffer_load_dwordx4 v[24:27], v61, s[4:7], s14 offen nt
    s_branch cf_loop
cf_w0:
    v_mov_b64 v[0:1], 0
    v_mov_b64 v[2:3], 0
    v_mov_b64 v[4:5], 0
    v_mov_b64 v[6:7], 0
    v_mov_b64 v[8:9], 0
    v_mov_b64 v[10:11], 0
    v_mov_b64 v[12:13], 0
    v_mov_b64 v[14:15], 0
    s_nop 15
    s_nop 15
    s_nop 15
    s_nop 5
    s_bitcmp0_b32 0x400010, s28
    s_cbranch_scc1 cf_nokv
    s_cmp_ge_u32 s28, 32
    s_cbranch_scc1 cf_nokv
    s_lshr_b32 s92, s12, 1
    s_lshl_b32 s92, s92, 8
    s_add_u32 s92, s92, 125829120
    v_bfe_u32 v28, v61, 4, 6
    v_min_u32 v28, 11, v28
    v_lshlrev_b32 v28, 2, v28
    s_cmp_eq_u32 s28, 22
    s_cselect_b32 s93, 63, 4
    s_cselect_b32 s94, 4096, 0
    s_add_u32 s93, s93, s95
    s_add_u32 s92, s92, s94
    v_add_u32 v30, 108304, v28
    s_waitcnt vmcnt(0)
    ds_read_b32 v29, v30
    s_waitcnt lgkmcnt(0)
    v_subrev_u32 v29, s93, v29
    v_cmp_lt_u32 vcc, 64, v29
    s_cbranch_vccz cf_kv1_go
    s_mov_b32 s94, 4194304
cf_kv1:
    buffer_load_dword v29, v28, s[4:7], s92 offen sc1
    s_sub_u32 s94, s94, 1
    s_cbranch_scc1 cf_kv1_go
    s_waitcnt vmcnt(0)
    v_subrev_u32 v29, s93, v29
    v_cmp_lt_u32 vcc, 64, v29
    s_cbranch_vccz cf_kv1_go
    s_sleep 2
    s_branch cf_kv1
cf_kv1_go:
    s_branch cf_w0p
cf_nokv:
    s_nop 15
    s_nop 15
    s_nop 15
    s_nop 15
    s_nop 15
    s_nop 15
    s_nop 13
cf_w0p:
    buffer_load_dwordx4 v[24:27], v61, s[4:7], s14 offen nt
    s_branch cf_loop2
cf_spinF:
    buffer_load_dwordx4 v[40:43], v65, s[4:7], s19 offen offset:0 nt
    buffer_load_dwordx4 v[44:47], v65, s[4:7], s19 offen offset:1024 nt
    buffer_load_dwordx4 v[48:51], v65, s[4:7], s19 offen offset:2048 nt
    buffer_load_dwordx4 v[52:55], v65, s[4:7], s19 offen offset:3072 nt
    s_sub_u32 s29, s29, 1
    s_cmp_lt_i32 s29, 0
    s_cselect_b32 s40, 0, 1
    s_branch cf_chkF
cf_spinG:
    buffer_load_dwordx4 v[0:3], v65, s[4:7], s19 offen offset:0 nt
    buffer_load_dwordx4 v[4:7], v65, s[4:7], s19 offen offset:1024 nt
    buffer_load_dwordx4 v[8:11], v65, s[4:7], s19 offen offset:2048 nt
    buffer_load_dwordx4 v[12:15], v65, s[4:7], s19 offen offset:3072 nt
    s_sub_u32 s29, s29, 1
    s_cmp_lt_i32 s29, 0
    s_cselect_b32 s40, 0, 1
    s_branch cf_chkG
cf_guard:
    s_cbranch_scc0 cf_guard2
    buffer_store_dwordx4 v[16:19], v61, s[4:7], s26 offen sc1
    s_add_u32 s26, s26, 131072
    s_add_u32 s40, s95, 63
    v_mov_b32 v5, s40
    s_mov_b64 exec, 1
    buffer_store_dword v5, off, s[4:7], s27 sc1
    s_mov_b64 exec, -1
cf_guard2:
    s_nop 7
    v_max3_f32 v6, v28, v29, v30
    v_max3_f32 v7, v31, v56, v57
    v_max_f32 v6, v6, v7
    s_nop 1
    v_max_f32_dpp v6, v6, v6 row_ror:8 row_mask:0xf bank_mask:0xf
    v_mov_b32 v7, v6
    s_nop 1
    v_permlane32_swap_b32 v6, v7
    v_max_f32 v6, v6, v7
    v_mov_b32 v7, v6
    s_nop 1
    v_permlane16_swap_b32 v6, v7
    v_max_f32 v6, v6, v7
    v_sub_f32 v28, v28, v6
    v_sub_f32 v29, v29, v6
    v_sub_f32 v30, v30, v6
    v_sub_f32 v31, v31, v6
    v_sub_f32 v56, v56, v6
    v_sub_f32 v57, v57, v6
    v_exp_f32 v58, v56
    v_exp_f32 v59, v57
    s_nop 0
    v_cvt_pk_bf16_f32 v6, v58, v59
    s_nop 1
    v_mov_b32_dpp v7, v6 row_ror:8 row_mask:0xf bank_mask:0xf
    v_exp_f32 v0, v28
    s_nop 0
    v_mfma_f32_16x16x16_bf16 v[12:15], v[16:17], v[6:7], 0
    v_exp_f32 v1, v29
    v_exp_f32 v2, v30
    v_cvt_pk_bf16_f32 v8, v0, v1
    v_exp_f32 v3, v31
    v_mfma_f32_16x16x16_bf16 v[20:23], v[18:19], v[6:7], 0
    v_cvt_pk_bf16_f32 v9, v2, v3
    v_mov_b32_dpp v10, v8 row_ror:8 row_mask:0xf bank_mask:0xf
    v_max3_f32 v4, |v28|, |v29|, |v30|
    v_mov_b32_dpp v11, v9 row_ror:8 row_mask:0xf bank_mask:0xf
    v_mfma_f32_16x16x32_bf16 v[0:3], v[24:27], v[6:9], 0
    v_max3_f32 v4, v4, |v31|, |v56|
    v_max_f32_e64 v4, v4, |v57|
    v_mfma_f32_16x16x32_bf16 v[12:15], v[40:43], v[8:11], v[12:15]
    v_cmp_nge_f32 vcc, s46, v4
    v_mfma_f32_16x16x32_bf16 v[20:23], v[44:47], v[8:11], v[20:23]
    v_add_f32_dpp v0, v0, v0 row_ror:8 row_mask:0xf bank_mask:0xf
    v_rcp_f32 v0, v0
    s_nop 4
    s_branch cf_norm
cf_spin0:
    buffer_load_dwordx4 v[24:27], v61, s[4:7], s14 offen nt
    s_sub_u32 s29, s29, 1
    s_cmp_lt_i32 s29, 0
    s_cbranch_scc0 cf_chk0
    s_waitcnt vmcnt(0)
    v_min_u32 v24, -2, v24
    v_min_u32 v25, -2, v25
    v_min_u32 v26, -2, v26
    v_min_u32 v27, -2, v27
    s_branch cf_chk0
cf_spin1:
    s_mov_b32 m0, s58
    s_nop 0
    buffer_load_dwordx4 v61, s[4:7], s15 offen nt lds
    s_mov_b32 m0, s59
    s_nop 0
    buffer_load_dword v56, s[4:7], s16 offen nt lds
    s_mov_b32 m0, 108032
    s_sub_u32 s29, s29, 1
    s_cmp_lt_i32 s29, 0
    s_waitcnt vmcnt(0)
    ds_read_b128 v[28:31], v62 offset:45056
    ds_read_b32 v59, v58
    s_waitcnt lgkmcnt(0)
    v_max3_u32 v57, v28, v29, v30
    v_max3_u32 v57, v57, v31, v59
    v_cmp_eq_u32 vcc, -1, v57
    s_cbranch_scc1 cf_go1
    s_cbranch_vccnz cf_spin1
    s_branch cf_go1
cf_last:
    s_nop 1
    s_cmp_ge_u32 s28, 2
    s_cbranch_scc1 cf_last0
    s_and_b32 s40, s12, 3
    s_lshl_b32 s40, s40, 14
    s_add_u32 s40, s40, 67108864
    s_lshr_b32 s42, s12, 2
    s_lshl_b32 s42, s42, 3
    s_lshl_b64 exec, 0x55, s42
    buffer_load_dword v79, s[4:7], s40 offen sc1 lds
    s_mov_b64 exec, -1
    s_cmp_eq_u32 0, 1
    s_branch cf_back
cf_last0:
    s_cmp_ge_u32 s28, 62
    s_cbranch_scc1 cf_last1
    s_lshr_b32 s92, s12, 1
    s_lshl_b32 s92, s92, 8
    s_add_u32 s92, s92, 125829120
    v_bfe_u32 v48, v61, 4, 6
    v_min_u32 v48, 11, v48
    v_lshlrev_b32 v48, 2, v48
    s_cmp_eq_u32 s28, 21
    s_cselect_b32 s93, 63, 4
    s_cselect_b32 s94, 4096, 0
    s_add_u32 s93, s93, s95
    s_add_u32 s92, s92, s94
    s_mov_b32 m0, 108304
    s_mov_b64 exec, 0xfff
    buffer_load_dword v48, s[4:7], s92 offen sc1 lds
    s_mov_b64 exec, -1
    s_mov_b32 m0, 108032
    s_cmp_eq_u32 0, 1
    s_branch cf_back
cf_last1:
    s_cmp_eq_u32 s28, 63
    s_cbranch_scc1 cf_last2
    s_mov_b64 exec, s[34:35]
    buffer_store_dwordx4 v[0:3], v61, s[4:7], s25 offen sc1
    s_mov_b64 exec, -1
    s_add_u32 s25, s25, 131072
    s_mov_b32 s46, 0xbf800000
    s_cmp_eq_u32 0, 0
    s_branch cf_back
cf_last2:
    s_waitcnt lgkmcnt(0)
    s_mov_b64 exec, s[34:35]
    buffer_store_dwordx4 v[0:3], v61, s[4:7], s25 offen sc1
    s_mov_b64 exec, -1
    s_add_u32 s40, s95, 64
    v_mov_b32 v40, s40
    v_smfmac_f32_16x16x64_bf16 v[16:19], v[52:55], v[80:87], v60
    v_smfmac_f32_16x16x64_bf16 v[20:23], v[52:55], v[88:95], v60
    s_nop 3
    v_cvt_pk_bf16_f32 v16, v16, v17
    v_cvt_pk_bf16_f32 v17, v18, v19
    s_nop 1
    v_cvt_pk_bf16_f32 v18, v20, v21
    v_cvt_pk_bf16_f32 v19, v22, v23
    buffer_store_dwordx4 v[16:19], v61, s[4:7], s26 offen sc1
    s_mov_b64 exec, 1
    buffer_store_dword v40, off, s[4:7], s27 sc1
    s_mov_b64 exec, -1
    s_endpgm
cf_dma:
    s_xor_b32 s74, s76, s81
    s_add_u32 m0, s74, s80
    s_add_u32 s76, s76, 4096
    buffer_load_dwordx4 v58, s[8:11], s78 offen lds
    s_add_u32 s78, s78, s79
    s_cmp_lt_u32 s76, s77
    s_cbranch_scc1 cf_dma
    s_setpc_b64 s[82:83]
L_chain_safe:
    s_mov_b64 s[48:49], s[50:51]
    s_mov_b64 s[50:51], s[52:53]
    s_mov_b64 s[52:53], s[54:55]
    s_mov_b64 s[54:55], s[56:57]
    s_mov_b64 s[56:57], s[58:59]
    v_lshrrev_b32 v54, 6, v0
    s_nop 0
    v_readfirstlane_b32 s13, v54
    v_and_b32 v57, 63, v0
    v_bfe_u32 v54, v57, 2, 1
    v_lshlrev_b32 v48, 13, v54
    v_bfe_u32 v54, v57, 3, 1
    v_lshl_add_u32 v48, v54, 15, v48
    v_bfe_u32 v54, v57, 4, 1
    v_lshl_add_u32 v48, v54, 14, v48
    v_bfe_u32 v54, v57, 5, 1
    v_lshl_add_u32 v48, v54, 16, v48
    v_lshrrev_b32 v55, 4, v57
    v_and_b32 v55, 2, v55
    v_xor_b32 v55, v55, v57
    v_and_b32 v55, 3, v55
    v_lshl_add_u32 v48, v55, 4, v48
    v_bfe_u32 v54, v57, 2, 1
    v_lshlrev_b32 v51, 6, v54
    v_bfe_u32 v54, v57, 3, 1
    v_lshl_add_u32 v51, v54, 9, v51
    v_bfe_u32 v54, v57, 4, 1
    v_lshl_add_u32 v51, v54, 7, v51
    v_bfe_u32 v54, v57, 5, 1
    v_lshl_add_u32 v51, v54, 12, v51
    v_bfe_u32 v54, v57, 0, 1
    v_lshl_add_u32 v51, v54, 3, v51
    v_bfe_u32 v54, v57, 1, 1
    v_lshl_add_u32 v51, v54, 4, v51
    v_bfe_u32 v54, v57, 3, 1
    v_lshl_add_u32 v51, v54, 5, v51
    v_lshrrev_b32 v55, 3, v57
    v_mul_u32_u24 v49, 1152, v55
    v_and_b32 v55, 7, v57
    v_lshl_add_u32 v49, v55, 4, v49
    v_bfe_u32 v54, v57, 4, 1
    v_lshlrev_b32 v52, 13, v54
    v_bfe_u32 v54, v57, 5, 1
    v_lshl_add_u32 v52, v54, 9, v52
    v_bfe_u32 v54, v57, 2, 1
    v_lshl_add_u32 v52, v54, 7, v52
    v_bfe_u32 v54, v57, 3, 1
    v_lshl_add_u32 v52, v54, 5, v52
    v_and_b32 v55, 3, v57
    v_lshl_add_u32 v52, v55, 3, v52
    v_lshrrev_b32 v55, 2, v57
    v_mul_u32_u24 v50, 1152, v55
    v_and_b32 v55, 3, v57
    v_lshl_add_u32 v50, v55, 4, v50
    v_bfe_u32 v54, v57, 4, 1
    v_lshlrev_b32 v53, 12, v54
    v_bfe_u32 v54, v57, 5, 1
    v_lshl_add_u32 v53, v54, 8, v53
    v_bfe_u32 v54, v57, 2, 1
    v_lshl_add_u32 v53, v54, 6, v53
    v_bfe_u32 v54, v57, 3, 1
    v_lshl_add_u32 v53, v54, 5, v53
    v_and_b32 v55, 3, v57
    v_lshl_add_u32 v53, v55, 3, v53
    s_lshl_b32 s66, s13, 10
    s_and_b32 s93, s13, 1
    s_lshl_b32 s93, s93, 14
    s_and_b32 s75, s13, 2
    s_lshl_b32 s75, s75, 19
    v_add_u32 v51, s66, v51
    v_add_u32 v52, s66, v52
    v_add_u32 v53, s66, v53
    v_mov_b32 v58, v48
    s_mov_b32 s10, 4718592
    s_mov_b32 s11, 0x20000
    s_lshl_b32 s67, s12, 8
    s_lshl_b32 s40, s13, 6
    s_add_u32 s67, s67, s40
    s_mul_i32 s92, s12, 147456
    s_lshr_b32 s73, s50, 8
    s_add_u32 s73, s73, s12
    s_and_b32 s73, s73, 31
    s_bitcmp1_b32 0xa2222222, s73
    s_cselect_b32 s88, 0, 0
    s_mov_b32 s72, 0
    s_add_u32 s73, s73, 1
    s_lshr_b32 s73, s73, 2
    s_xor_b32 s94, s13, 0
    s_mul_i32 s94, s94, 36864
    s_add_u32 s94, s94, s92
    s_lshl_b32 s74, s13, 7
    s_add_u32 s94, s94, s74
    s_add_u32 s78, s94, 0
    s_mov_b64 s[8:9], s[56:57]
    v_mov_b32 v58, v49
    s_mov_b32 s79, 9216
    s_mov_b32 s81, 0
    s_add_u32 s80, s66, 114688
    s_mov_b32 s76, 0
    s_mov_b32 s77, 8192
    s_call_b64 s[82:83], cs_dma
    s_mov_b32 s77, 16384
    s_call_b64 s[82:83], cs_dma
    s_xor_b32 s94, s13, 1
    s_mul_i32 s94, s94, 36864
    s_add_u32 s94, s94, s92
    s_lshl_b32 s74, s13, 7
    s_add_u32 s94, s94, s74
    s_add_u32 s78, s94, 0
    s_add_u32 s80, s66, 81920
    s_mov_b32 s76, 0
    s_mov_b32 s77, 8192
    s_call_b64 s[82:83], cs_dma
    s_mov_b32 s77, 16384
    s_call_b64 s[82:83], cs_dma
    s_xor_b32 s94, s13, 2
    s_mul_i32 s94, s94, 36864
    s_add_u32 s94, s94, s92
    s_lshl_b32 s74, s13, 7
    s_add_u32 s94, s94, s74
    s_add_u32 s78, s94, 0
    s_add_u32 s80, s66, 16384
    s_mov_b32 s76, 0
    s_mov_b32 s77, 8192
    s_call_b64 s[82:83], cs_dma
    s_mov_b32 s77, 16384
    s_call_b64 s[82:83], cs_dma
    s_xor_b32 s94, s13, 3
    s_mul_i32 s94, s94, 36864
    s_add_u32 s94, s94, s92
    s_lshl_b32 s74, s13, 7
    s_add_u32 s94, s94, s74
    s_add_u32 s78, s94, 0
    s_add_u32 s80, s66, 0
    s_mov_b32 s76, 0
    s_mov_b32 s77, 8192
    s_call_b64 s[82:83], cs_dma
    s_mov_b32 s77, 16384
    s_call_b64 s[82:83], cs_dma
    v_lshrrev_b32 v24, 6, v0
    v_lshlrev_b32 v61, 4, v0
    v_add_u32 v62, 57344, v61
    v_xor_b32 v63, 1024, v61
    v_add_u32 v63, 98304, v63
    v_xor_b32 v64, 2048, v61
    v_add_u32 v64, 98304, v64
    v_and_b32 v65, 1023, v61
    v_add_u32 v65, 98304, v65
    v_and_b32 v26, 15, v0
    v_bfe_u32 v27, v0, 4, 2
    v_mov_b32 v60, 0x4444
    v_mov_b32 v25, 0xeeee
    v_cmp_lt_u32 vcc, 7, v26
    s_nop 1
    v_cndmask_b32 v60, v60, v25, vcc
    s_nop 1
    v_and_b32 v67, 12, v26
    v_lshlrev_b32 v67, 3, v67
    v_and_b32 v25, 1, v26
    v_lshl_add_u32 v67, v25, 4, v67
    v_bfe_u32 v25, v26, 1, 1
    v_lshl_add_u32 v67, v25, 3, v67
    v_lshl_add_u32 v66, v27, 14, v67
    v_lshl_add_u32 v66, v24, 17, v66
    s_nop 1
    v_and_b32 v67, 63, v67
    v_lshrrev_b32 v25, 1, v24
    v_lshl_add_u32 v67, v25, 18, v67
    v_lshl_add_u32 v67, v27, 16, v67
    v_lshrrev_b32 v25, 3, v26
    v_lshl_add_u32 v67, v25, 15, v67
    v_and_b32 v25, 1, v24
    v_lshl_add_u32 v67, v25, 6, v67
    s_nop 1
    s_waitcnt vmcnt(12)
    v_add_u32 v55, 114688, v52
    ds_read_b64_tr_b16 v[160:161], v55 offset:0
    ds_read_b64_tr_b16 v[162:163], v55 offset:256
    ds_read_b64_tr_b16 v[164:165], v55 offset:4096
    ds_read_b64_tr_b16 v[166:167], v55 offset:4352
    s_xor_b32 s94, s13, 0
    s_mul_i32 s94, s94, 36864
    s_add_u32 s94, s94, s92
    s_lshl_b32 s74, s13, 7
    s_add_u32 s94, s94, s74
    s_add_u32 s78, s94, 512
    s_add_u32 s80, s66, 147456
    s_mov_b32 s76, 0
    s_mov_b32 s77, 8192
    s_call_b64 s[82:83], cs_dma
    ds_read_b64_tr_b16 v[192:193], v55 offset:64
    ds_read_b64_tr_b16 v[194:195], v55 offset:320
    ds_read_b64_tr_b16 v[196:197], v55 offset:4160
    ds_read_b64_tr_b16 v[198:199], v55 offset:4416
    s_mov_b32 s77, 16384
    s_call_b64 s[82:83], cs_dma
    v_and_b32 v25, 31, v0
    v_lshlrev_b32 v70, 4, v25
    v_lshlrev_b32 v28, 3, v25
    v_add_u32 v28, 108032, v28
    v_lshrrev_b32 v25, 1, v24
    v_lshl_add_u32 v70, v25, 9, v70
    v_and_b32 v25, 1, v24
    v_lshl_add_u32 v70, v25, 3, v70
    v_add_u32 v70, 109568, v70
    v_cmp_gt_u32 vcc, 2, v27
    s_nop 1
    v_cndmask_b32 v70, v70, v28, vcc
    s_nop 1
    s_waitcnt lgkmcnt(0)
    s_waitcnt vmcnt(12)
    v_add_u32 v55, 81920, v52
    ds_read_b64_tr_b16 v[168:169], v55 offset:0
    ds_read_b64_tr_b16 v[170:171], v55 offset:256
    ds_read_b64_tr_b16 v[172:173], v55 offset:4096
    ds_read_b64_tr_b16 v[174:175], v55 offset:4352
    s_xor_b32 s94, s13, 1
    s_mul_i32 s94, s94, 36864
    s_add_u32 s94, s94, s92
    s_lshl_b32 s74, s13, 7
    s_add_u32 s94, s94, s74
    s_add_u32 s78, s94, 512
    s_add_u32 s80, s66, 98304
    s_mov_b32 s76, 0
    s_mov_b32 s77, 8192
    s_call_b64 s[82:83], cs_dma
    ds_read_b64_tr_b16 v[200:201], v55 offset:64
    ds_read_b64_tr_b16 v[202:203], v55 offset:320
    ds_read_b64_tr_b16 v[204:205], v55 offset:4160
    ds_read_b64_tr_b16 v[206:207], v55 offset:4416
    s_mov_b32 s77, 16384
    s_call_b64 s[82:83], cs_dma
    v_xor_b32 v71, 2048, v63
    v_lshrrev_b32 v68, 4, v0
    v_lshlrev_b32 v68, 7, v68
    v_and_b32 v25, 7, v26
    v_lshl_add_u32 v68, v25, 4, v68
    v_add_u32 v68, 102400, v68
    v_xor_b32 v74, 512, v68
    v_xor_b32 v75, 1024, v68
    v_xor_b32 v76, 1536, v68
    v_lshrrev_b32 v25, 3, v26
    v_lshl_add_u32 v77, v25, 3, v68
    v_or_b32 v78, 512, v65
    v_lshlrev_b32 v79, 2, v61
    v_mov_b64 v[72:73], 0
    v_and_b32 v25, 1, v27
    v_lshlrev_b32 v69, 7, v25
    v_lshrrev_b32 v25, 1, v27
    v_lshl_add_u32 v69, v25, 3, v69
    v_and_b32 v25, 3, v26
    v_lshl_add_u32 v69, v25, 4, v69
    v_bfe_u32 v25, v26, 2, 1
    v_lshl_add_u32 v69, v25, 2, v69
    s_nop 1
    s_waitcnt lgkmcnt(0)
    s_waitcnt vmcnt(12)
    v_add_u32 v55, 16384, v52
    ds_read_b64_tr_b16 v[176:177], v55 offset:0
    ds_read_b64_tr_b16 v[178:179], v55 offset:256
    ds_read_b64_tr_b16 v[180:181], v55 offset:4096
    ds_read_b64_tr_b16 v[182:183], v55 offset:4352
    s_add_u32 s78, s67, 4194304
    s_mov_b64 s[8:9], s[54:55]
    v_mov_b32 v58, v48
    s_mov_b32 s79, 131072
    s_add_u32 s80, s66, 32768
    s_mov_b32 s76, 0
    s_mov_b32 s77, 8192
    s_call_b64 s[82:83], cs_dma
    ds_read_b64_tr_b16 v[208:209], v55 offset:64
    ds_read_b64_tr_b16 v[210:211], v55 offset:320
    ds_read_b64_tr_b16 v[212:213], v55 offset:4160
    ds_read_b64_tr_b16 v[214:215], v55 offset:4416
    s_mov_b32 s77, 16384
    s_call_b64 s[82:83], cs_dma
    s_mov_b32 s32, 0x00ff00ff
    s_mov_b32 s33, 0x00ff00ff
    s_not_b64 s[34:35], s[32:33]
    s_lshr_b32 s31, s12, 1
    s_lshl_b32 s31, s31, 8
    s_and_b32 s40, s12, 1
    s_lshl_b32 s40, s40, 6
    s_add_u32 s31, s31, s40
    s_and_b32 s40, s13, 1
    s_lshl_b32 s40, s40, 12
    s_add_u32 s31, s31, s40
    s_lshl_b32 s19, s12, 14
    s_add_u32 s19, s19, 68124672
    s_add_u32 s41, s19, 8192
    s_add_u32 s19, s19, s40
    s_and_b32 s40, s12, 1
    s_lshl_b32 s40, s40, 2
    s_or_b32 s40, s40, s13
    s_cmp_eq_u32 s40, 5
    s_cselect_b32 s64, 0, s13
    s_cmp_lg_u32 s13, 1
    s_cbranch_scc1 cs_notx
    s_mov_b32 s32, 0xff
    s_mov_b32 s33, 0xff
    s_mov_b32 s19, s41
    s_lshr_b32 s31, s12, 3
    s_lshl_b32 s31, s31, 8
    s_and_b32 s40, s12, 2
    s_lshl_b32 s40, s40, 6
    s_add_u32 s31, s31, s40
    s_and_b32 s40, s12, 4
    s_lshl_b32 s40, s40, 4
    s_add_u32 s31, s31, s40
    s_add_u32 s31, s31, 8192
cs_notx:
    s_cmp_lg_u32 s13, 0
    s_cbranch_scc1 cs_notp
    s_min_u32 s40, s12, 23
    s_mul_i32 s40, s40, 384
    s_add_u32 s40, s40, 98304
    v_add_u32 v69, s40, v61
    v_mov_b32 v25, 108288
    v_cmp_lt_u32 vcc, 23, v0
    s_nop 1
    v_cndmask_b32 v69, v69, v25, vcc
cs_notp:
    s_nop 1
    s_waitcnt lgkmcnt(0)
    s_waitcnt vmcnt(12)
    v_add_u32 v55, 0, v52
    ds_read_b64_tr_b16 v[184:185], v55 offset:0
    ds_read_b64_tr_b16 v[186:187], v55 offset:256
    ds_read_b64_tr_b16 v[188:189], v55 offset:4096
    ds_read_b64_tr_b16 v[190:191], v55 offset:4352
    s_xor_b32 s78, s75, 0
    s_add_u32 s78, s78, s67
    s_mov_b32 s81, s93
    s_add_u32 s80, s66, 114688
    s_mov_b32 s76, 0
    s_mov_b32 s77, 8192
    s_call_b64 s[82:83], cs_dma
    ds_read_b64_tr_b16 v[216:217], v55 offset:64
    ds_read_b64_tr_b16 v[218:219], v55 offset:320
    ds_read_b64_tr_b16 v[220:221], v55 offset:4160
    ds_read_b64_tr_b16 v[222:223], v55 offset:4416
    s_mov_b32 s77, 16384
    s_call_b64 s[82:83], cs_dma
    v_mov_b32 v28, 1
    v_mov_b32 v29, 1
    v_mov_b32 v30, 1
    v_mov_b32 v31, 1
    s_lshl_b32 s40, s12, 14
    s_add_u32 s40, s40, 68222976
    s_add_u32 s41, s40, 0
    buffer_store_dwordx4 v[28:31], v61, s[4:7], s41 offen sc1
    s_add_u32 s41, s40, 4096
    buffer_store_dwordx4 v[28:31], v61, s[4:7], s41 offen sc1
    s_add_u32 s41, s40, 8192
    buffer_store_dwordx4 v[28:31], v61, s[4:7], s41 offen sc1
    s_cmp_eq_u32 s64, 0
    s_cselect_b64 exec, 0, s[32:33]
    v_mov_b32 v27, -1
    s_add_u32 s41, s31, 68157440
    buffer_store_dword v27, v69, s[4:7], s41 offen sc1
    s_add_u32 s41, s31, 68173824
    buffer_store_dword v27, v69, s[4:7], s41 offen sc1
    s_add_u32 s41, s31, 68190208
    buffer_store_dword v27, v69, s[4:7], s41 offen sc1
    s_add_u32 s41, s31, 68206592
    buffer_store_dword v27, v69, s[4:7], s41 offen sc1
    s_mov_b64 exec, -1
    s_waitcnt lgkmcnt(0)
    s_waitcnt vmcnt(12)
    v_add_u32 v55, 147456, v52
    ds_read_b64_tr_b16 v[224:225], v55 offset:0
    ds_read_b64_tr_b16 v[226:227], v55 offset:256
    ds_read_b64_tr_b16 v[228:229], v55 offset:4096
    ds_read_b64_tr_b16 v[230:231], v55 offset:4352
    s_mov_b32 s77, 24576
    s_call_b64 s[82:83], cs_dma
    ds_read_b64_tr_b16 v[240:241], v55 offset:64
    ds_read_b64_tr_b16 v[242:243], v55 offset:320
    ds_read_b64_tr_b16 v[244:245], v55 offset:4160
    ds_read_b64_tr_b16 v[246:247], v55 offset:4416
    s_mov_b32 s77, 32768
    s_call_b64 s[82:83], cs_dma
    s_mov_b64 s[68:69], s[48:49]
    s_mov_b32 s70, 9216
    s_mov_b32 s71, 0x20000
    v_and_b32 v25, 7, v0
    v_mul_u32_u24 v25, 1152, v25
    v_lshrrev_b32 v26, 3, v0
    v_lshl_add_u32 v25, v26, 4, v25
    buffer_load_dwordx4 v[36:39], v25, s[68:71], 0 offen
    buffer_load_dwordx4 v[40:43], v25, s[68:71], 0 offen offset:512
    v_bfe_u32 v25, v0, 2, 3
    v_mul_u32_u24 v25, 1152, v25
    v_lshrrev_b32 v26, 5, v0
    v_lshl_add_u32 v25, v26, 4, v25
    v_and_b32 v26, 3, v0
    v_lshl_add_u32 v25, v26, 2, v25
    buffer_load_dword v44, v25, s[68:71], 0 offen offset:1024
    s_nop 0
    s_waitcnt lgkmcnt(0)
    s_waitcnt vmcnt(15)
    v_add_u32 v55, 98304, v52
    ds_read_b64_tr_b16 v[232:233], v55 offset:0
    ds_read_b64_tr_b16 v[234:235], v55 offset:256
    ds_read_b64_tr_b16 v[236:237], v55 offset:4096
    ds_read_b64_tr_b16 v[238:239], v55 offset:4352
    s_xor_b32 s78, s75, 1048576
    s_add_u32 s78, s78, s67
    s_add_u32 s80, s66, 65536
    s_mov_b32 s76, 0
    s_mov_b32 s77, 8192
    s_call_b64 s[82:83], cs_dma
    ds_read_b64_tr_b16 v[248:249], v55 offset:64
    ds_read_b64_tr_b16 v[250:251], v55 offset:320
    ds_read_b64_tr_b16 v[252:253], v55 offset:4160
    ds_read_b64_tr_b16 v[254:255], v55 offset:4416
    s_mov_b32 s77, 16384
    s_call_b64 s[82:83], cs_dma
    s_mov_b32 s44, 0x3e0293ee
    s_mov_b32 s45, s44
    s_mov_b32 s46, 0x42000000
    s_mov_b32 s60, 0x3f803f80
    s_mov_b32 s61, s60
    s_mov_b32 s62, 0x3e803e80
    s_mov_b32 s63, s62
    s_mov_b32 s28, 0
    s_lshl_b32 s58, s13, 10
    s_add_u32 s58, s58, 102400
    s_lshl_b32 s59, s13, 8
    s_add_u32 s59, s59, 106496
    s_lshl_b32 s24, s12, 14
    s_add_u32 s24, s24, 0
    s_add_u32 s47, s24, 33030144
    s_mul_i32 s40, s13, 3072
    s_add_u32 s23, s24, s40
    s_lshl_b32 s20, s12, 7
    s_add_u32 s20, s20, 68222976
    s_add_u32 s21, s20, 65536
    s_add_u32 s38, s20, 4096
    s_add_u32 s39, s21, 4096
    s_lshl_b32 s22, s12, 7
    s_add_u32 s22, s22, 68231168
    s_waitcnt lgkmcnt(0)
    s_waitcnt vmcnt(15)
    v_add_u32 v55, 32768, v51
    v_xor_b32 v56, 32, v55
    ds_read_b64_tr_b16 v[144:145], v55 offset:0
    ds_read_b64_tr_b16 v[146:147], v55 offset:256
    ds_read_b64_tr_b16 v[148:149], v55 offset:8192
    ds_read_b64_tr_b16 v[150:151], v55 offset:8448
    s_mov_b32 s77, 24576
    s_call_b64 s[82:83], cs_dma
    ds_read_b64_tr_b16 v[152:153], v56 offset:0
    ds_read_b64_tr_b16 v[154:155], v56 offset:256
    ds_read_b64_tr_b16 v[156:157], v56 offset:8192
    ds_read_b64_tr_b16 v[158:159], v56 offset:8448
    s_mov_b32 s77, 32768
    s_call_b64 s[82:83], cs_dma
    s_lshl_b32 s40, s12, 12
    s_add_u32 s25, s40, 79429632
    s_add_u32 s26, s40, 88866816
    s_lshl_b32 s65, s12, 9
    s_add_u32 s65, s65, 90177536
    s_lshl_b32 s40, s13, 5
    s_or_b32 s40, s40, s12
    s_cmp_lt_u32 s40, 24
    s_cselect_b32 s36, 0x1ffffff, 0
    s_mov_b32 s37, 0
    s_lshl_b32 s27, s12, 7
    s_add_u32 s27, s27, 125845504
    s_lshl_b32 s40, s13, 2
    s_add_u32 s27, s27, s40
    v_bfe_u32 v28, v61, 4, 4
    v_bfe_u32 v29, v61, 8, 1
    v_lshlrev_b32 v29, 2, v29
    v_sub_u32 v29, v28, v29
    v_mov_b32 v31, 0x3f80
    v_mov_b32 v32, 0x3f800000
    s_nop 1
    s_waitcnt lgkmcnt(0)
    s_waitcnt vmcnt(11)
    v_add_u32 v55, 114688, v51
    v_xor_b32 v56, 32, v55
    ds_read_b64_tr_b16 a[192:193], v55 offset:0
    ds_read_b64_tr_b16 a[194:195], v55 offset:256
    ds_read_b64_tr_b16 a[196:197], v55 offset:8192
    ds_read_b64_tr_b16 a[198:199], v55 offset:8448
    s_xor_b32 s78, s75, 2097152
    s_add_u32 s78, s78, s67
    s_add_u32 s80, s66, 0
    s_mov_b32 s76, 0
    s_mov_b32 s77, 8192
    s_call_b64 s[82:83], cs_dma
    ds_read_b64_tr_b16 a[200:201], v56 offset:0
    ds_read_b64_tr_b16 a[202:203], v56 offset:256
    ds_read_b64_tr_b16 a[204:205], v56 offset:8192
    ds_read_b64_tr_b16 a[206:207], v56 offset:8448
    s_mov_b32 s77, 16384
    s_call_b64 s[82:83], cs_dma
    v_cmp_eq_u32 vcc, 0, v29
    s_nop 1
    v_cndmask_b32 v16, 0, v31, vcc
    v_cmp_eq_u32 vcc, 1, v29
    s_nop 1
    v_cndmask_b32 v16, v16, v32, vcc
    v_cmp_eq_u32 vcc, 0, v28
    s_nop 1
    v_cndmask_b32 v20, 0, v31, vcc
    v_cmp_eq_u32 vcc, 1, v28
    s_nop 1
    v_cndmask_b32 v20, v20, v32, vcc
    s_nop 1
    s_waitcnt lgkmcnt(0)
    v_add_u32 v55, 131072, v51
    v_xor_b32 v56, 32, v55
    ds_read_b64_tr_b16 a[208:209], v55 offset:0
    ds_read_b64_tr_b16 a[210:211], v55 offset:256
    ds_read_b64_tr_b16 a[212:213], v55 offset:8192
    ds_read_b64_tr_b16 a[214:215], v55 offset:8448
    s_mov_b32 s77, 24576
    s_call_b64 s[82:83], cs_dma
    ds_read_b64_tr_b16 a[216:217], v56 offset:0
    ds_read_b64_tr_b16 a[218:219], v56 offset:256
    ds_read_b64_tr_b16 a[220:221], v56 offset:8192
    ds_read_b64_tr_b16 a[222:223], v56 offset:8448
    s_mov_b32 s77, 32768
    s_call_b64 s[82:83], cs_dma
    v_cmp_eq_u32 vcc, 2, v29
    s_nop 1
    v_cndmask_b32 v17, 0, v31, vcc
    v_cmp_eq_u32 vcc, 3, v29
    s_nop 1
    v_cndmask_b32 v17, v17, v32, vcc
    v_cmp_eq_u32 vcc, 2, v28
    s_nop 1
    v_cndmask_b32 v21, 0, v31, vcc
    v_cmp_eq_u32 vcc, 3, v28
    s_nop 1
    v_cndmask_b32 v21, v21, v32, vcc
    s_nop 1
    s_waitcnt lgkmcnt(0)
    s_waitcnt vmcnt(8)
    v_add_u32 v55, 65536, v51
    v_xor_b32 v56, 32, v55
    ds_read_b64_tr_b16 a[224:225], v55 offset:0
    ds_read_b64_tr_b16 a[226:227], v55 offset:256
    ds_read_b64_tr_b16 a[228:229], v55 offset:8192
    ds_read_b64_tr_b16 a[230:231], v55 offset:8448
    s_xor_b32 s78, s75, 3145728
    s_add_u32 s78, s78, s67
    s_add_u32 s80, s66, 32768
    s_mov_b32 s76, 0
    s_mov_b32 s77, 8192
    s_call_b64 s[82:83], cs_dma
    ds_read_b64_tr_b16 a[232:233], v56 offset:0
    ds_read_b64_tr_b16 a[234:235], v56 offset:256
    ds_read_b64_tr_b16 a[236:237], v56 offset:8192
    ds_read_b64_tr_b16 a[238:239], v56 offset:8448
    s_mov_b32 s77, 16384
    s_call_b64 s[82:83], cs_dma
    v_cmp_eq_u32 vcc, 8, v29
    s_nop 1
    v_cndmask_b32 v18, 0, v31, vcc
    v_cmp_eq_u32 vcc, 9, v29
    s_nop 1
    v_cndmask_b32 v18, v18, v32, vcc
    v_cmp_eq_u32 vcc, 4, v28
    s_nop 1
    v_cndmask_b32 v22, 0, v31, vcc
    v_cmp_eq_u32 vcc, 5, v28
    s_nop 1
    v_cndmask_b32 v22, v22, v32, vcc
    s_nop 1
    s_waitcnt lgkmcnt(0)
    v_add_u32 v55, 81920, v51
    v_xor_b32 v56, 32, v55
    ds_read_b64_tr_b16 a[240:241], v55 offset:0
    ds_read_b64_tr_b16 a[242:243], v55 offset:256
    ds_read_b64_tr_b16 a[244:245], v55 offset:8192
    ds_read_b64_tr_b16 a[246:247], v55 offset:8448
    s_mov_b32 s77, 24576
    s_call_b64 s[82:83], cs_dma
    ds_read_b64_tr_b16 a[248:249], v56 offset:0
    ds_read_b64_tr_b16 a[250:251], v56 offset:256
    ds_read_b64_tr_b16 a[252:253], v56 offset:8192
    ds_read_b64_tr_b16 a[254:255], v56 offset:8448
    s_mov_b32 s77, 32768
    s_call_b64 s[82:83], cs_dma
    v_cmp_eq_u32 vcc, 10, v29
    s_nop 1
    v_cndmask_b32 v19, 0, v31, vcc
    v_cmp_eq_u32 vcc, 11, v29
    s_nop 1
    v_cndmask_b32 v19, v19, v32, vcc
    v_cmp_eq_u32 vcc, 6, v28
    s_nop 1
    v_cndmask_b32 v23, 0, v31, vcc
    v_cmp_eq_u32 vcc, 7, v28
    s_nop 1
    v_cndmask_b32 v23, v23, v32, vcc
    s_nop 1
    s_waitcnt lgkmcnt(0)
    s_waitcnt vmcnt(8)
    v_add_u32 v55, 0, v51
    v_xor_b32 v56, 32, v55
    ds_read_b64_tr_b16 v[80:81], v55 offset:0
    ds_read_b64_tr_b16 v[82:83], v55 offset:256
    ds_read_b64_tr_b16 v[84:85], v55 offset:8192
    ds_read_b64_tr_b16 v[86:87], v55 offset:8448
    s_xor_b32 s78, s75, 2097152
    s_add_u32 s78, s78, s67
    s_mov_b64 s[8:9], s[52:53]
    s_add_u32 s80, s66, 131072
    s_mov_b32 s76, 0
    s_mov_b32 s77, 8192
    s_call_b64 s[82:83], cs_dma
    ds_read_b64_tr_b16 v[88:89], v56 offset:0
    ds_read_b64_tr_b16 v[90:91], v56 offset:256
    ds_read_b64_tr_b16 v[92:93], v56 offset:8192
    ds_read_b64_tr_b16 v[94:95], v56 offset:8448
    s_mov_b32 s77, 16384
    s_call_b64 s[82:83], cs_dma
    v_mov_b32 v46, 1
    s_mov_b64 exec, 1
    buffer_atomic_add v46, off, s[96:99], 0 offset:212 sc0
    s_mov_b64 exec, -1
    s_waitcnt lgkmcnt(0)
    v_add_u32 v55, 16384, v51
    v_xor_b32 v56, 32, v55
    ds_read_b64_tr_b16 v[96:97], v55 offset:0
    ds_read_b64_tr_b16 v[98:99], v55 offset:256
    ds_read_b64_tr_b16 v[100:101], v55 offset:8192
    ds_read_b64_tr_b16 v[102:103], v55 offset:8448
    s_mov_b32 s77, 24576
    s_call_b64 s[82:83], cs_dma
    ds_read_b64_tr_b16 v[104:105], v56 offset:0
    ds_read_b64_tr_b16 v[106:107], v56 offset:256
    ds_read_b64_tr_b16 v[108:109], v56 offset:8192
    ds_read_b64_tr_b16 v[110:111], v56 offset:8448
    s_mov_b32 s77, 32768
    s_call_b64 s[82:83], cs_dma
    s_waitcnt lgkmcnt(0)
    s_waitcnt vmcnt(9)
    v_add_u32 v55, 32768, v51
    v_xor_b32 v56, 32, v55
    ds_read_b64_tr_b16 v[112:113], v55 offset:0
    ds_read_b64_tr_b16 v[114:115], v55 offset:256
    ds_read_b64_tr_b16 v[116:117], v55 offset:8192
    ds_read_b64_tr_b16 v[118:119], v55 offset:8448
    s_xor_b32 s78, s75, 3145728
    s_add_u32 s78, s78, s67
    s_add_u32 s80, s66, 65536
    s_mov_b32 s76, 0
    s_mov_b32 s77, 8192
    s_call_b64 s[82:83], cs_dma
    ds_read_b64_tr_b16 v[120:121], v56 offset:0
    ds_read_b64_tr_b16 v[122:123], v56 offset:256
    ds_read_b64_tr_b16 v[124:125], v56 offset:8192
    ds_read_b64_tr_b16 v[126:127], v56 offset:8448
    s_mov_b32 s77, 16384
    s_call_b64 s[82:83], cs_dma
    s_waitcnt lgkmcnt(0)
    v_add_u32 v55, 49152, v51
    v_xor_b32 v56, 32, v55
    ds_read_b64_tr_b16 v[128:129], v55 offset:0
    ds_read_b64_tr_b16 v[130:131], v55 offset:256
    ds_read_b64_tr_b16 v[132:133], v55 offset:8192
    ds_read_b64_tr_b16 v[134:135], v55 offset:8448
    s_mov_b32 s77, 24576
    s_call_b64 s[82:83], cs_dma
    ds_read_b64_tr_b16 v[136:137], v56 offset:0
    ds_read_b64_tr_b16 v[138:139], v56 offset:256
    ds_read_b64_tr_b16 v[140:141], v56 offset:8192
    ds_read_b64_tr_b16 v[142:143], v56 offset:8448
    s_mov_b32 s77, 32768
    s_call_b64 s[82:83], cs_dma
    s_waitcnt lgkmcnt(0)
    s_waitcnt vmcnt(8)
    v_add_u32 v55, 131072, v51
    v_xor_b32 v56, 32, v55
    ds_read_b64_tr_b16 a[128:129], v55 offset:0
    ds_read_b64_tr_b16 a[130:131], v55 offset:256
    ds_read_b64_tr_b16 a[132:133], v55 offset:8192
    ds_read_b64_tr_b16 a[134:135], v55 offset:8448
    s_xor_b32 s78, s75, 2097152
    s_add_u32 s78, s78, s67
    s_mov_b64 s[8:9], s[50:51]
    s_add_u32 s80, s66, 0
    s_mov_b32 s76, 0
    s_mov_b32 s77, 8192
    s_call_b64 s[82:83], cs_dma
    ds_read_b64_tr_b16 a[136:137], v56 offset:0
    ds_read_b64_tr_b16 a[138:139], v56 offset:256
    ds_read_b64_tr_b16 a[140:141], v56 offset:8192
    ds_read_b64_tr_b16 a[142:143], v56 offset:8448
    s_mov_b32 s77, 16384
    s_call_b64 s[82:83], cs_dma
    s_waitcnt lgkmcnt(0)
    v_add_u32 v55, 147456, v51
    v_xor_b32 v56, 32, v55
    ds_read_b64_tr_b16 a[144:145], v55 offset:0
    ds_read_b64_tr_b16 a[146:147], v55 offset:256
    ds_read_b64_tr_b16 a[148:149], v55 offset:8192
    ds_read_b64_tr_b16 a[150:151], v55 offset:8448
    s_mov_b32 s77, 24576
    s_call_b64 s[82:83], cs_dma
    ds_read_b64_tr_b16 a[152:153], v56 offset:0
    ds_read_b64_tr_b16 a[154:155], v56 offset:256
    ds_read_b64_tr_b16 a[156:157], v56 offset:8192
    ds_read_b64_tr_b16 a[158:159], v56 offset:8448
    s_mov_b32 s77, 32768
    s_call_b64 s[82:83], cs_dma
    s_waitcnt lgkmcnt(0)
    s_waitcnt vmcnt(8)
    v_add_u32 v55, 65536, v51
    v_xor_b32 v56, 32, v55
    ds_read_b64_tr_b16 a[160:161], v55 offset:0
    ds_read_b64_tr_b16 a[162:163], v55 offset:256
    ds_read_b64_tr_b16 a[164:165], v55 offset:8192
    ds_read_b64_tr_b16 a[166:167], v55 offset:8448
    s_xor_b32 s78, s75, 3145728
    s_add_u32 s78, s78, s67
    s_add_u32 s80, s66, 32768
    s_mov_b32 s76, 0
    s_mov_b32 s77, 8192
    s_call_b64 s[82:83], cs_dma
    ds_read_b64_tr_b16 a[168:169], v56 offset:0
    ds_read_b64_tr_b16 a[170:171], v56 offset:256
    ds_read_b64_tr_b16 a[172:173], v56 offset:8192
    ds_read_b64_tr_b16 a[174:175], v56 offset:8448
    s_mov_b32 s77, 16384
    s_call_b64 s[82:83], cs_dma
    v_readfirstlane_b32 s41, v46
    v_mov_b32 v46, 1
    v_mov_b32 v47, 0
    s_cmp_eq_u32 s41, 127
    s_cselect_b64 exec, 1, 0
    buffer_atomic_cmpswap v[46:47], off, s[96:99], 0 offset:216
    s_mov_b64 exec, -1
    s_waitcnt lgkmcnt(0)
    v_add_u32 v55, 81920, v51
    v_xor_b32 v56, 32, v55
    ds_read_b64_tr_b16 a[176:177], v55 offset:0
    ds_read_b64_tr_b16 a[178:179], v55 offset:256
    ds_read_b64_tr_b16 a[180:181], v55 offset:8192
    ds_read_b64_tr_b16 a[182:183], v55 offset:8448
    s_mov_b32 s77, 24576
    s_call_b64 s[82:83], cs_dma
    ds_read_b64_tr_b16 a[184:185], v56 offset:0
    ds_read_b64_tr_b16 a[186:187], v56 offset:256
    ds_read_b64_tr_b16 a[188:189], v56 offset:8192
    ds_read_b64_tr_b16 a[190:191], v56 offset:8448
    s_mov_b32 s77, 32768
    s_call_b64 s[82:83], cs_dma
    s_waitcnt lgkmcnt(0)
    s_waitcnt vmcnt(8)
    v_add_u32 v55, 0, v51
    v_xor_b32 v56, 32, v55
    ds_read_b64_tr_b16 a[48:49], v55 offset:0
    ds_read_b64_tr_b16 a[50:51], v55 offset:256
    ds_read_b64_tr_b16 a[52:53], v55 offset:8192
    ds_read_b64_tr_b16 a[54:55], v55 offset:8448
    s_add_u32 s78, s67, 4194304
    s_mov_b32 s81, 0
    s_add_u32 s80, s66, 98304
    s_mov_b32 s76, 0
    s_mov_b32 s77, 8192
    s_call_b64 s[82:83], cs_dma
    ds_read_b64_tr_b16 a[56:57], v56 offset:0
    ds_read_b64_tr_b16 a[58:59], v56 offset:256
    ds_read_b64_tr_b16 a[60:61], v56 offset:8192
    ds_read_b64_tr_b16 a[62:63], v56 offset:8448
    s_mov_b32 s77, 16384
    s_call_b64 s[82:83], cs_dma
    s_waitcnt lgkmcnt(0)
    v_add_u32 v55, 16384, v51
    v_xor_b32 v56, 32, v55
    ds_read_b64_tr_b16 a[64:65], v55 offset:0
    ds_read_b64_tr_b16 a[66:67], v55 offset:256
    ds_read_b64_tr_b16 a[68:69], v55 offset:8192
    ds_read_b64_tr_b16 a[70:71], v55 offset:8448
    s_xor_b32 s78, s75, 1048576
    s_add_u32 s78, s78, s67
    s_mov_b32 s81, s93
    s_add_u32 s80, s66, 114688
    s_mov_b32 s76, 0
    s_mov_b32 s77, 8192
    s_call_b64 s[82:83], cs_dma
    ds_read_b64_tr_b16 a[72:73], v56 offset:0
    ds_read_b64_tr_b16 a[74:75], v56 offset:256
    ds_read_b64_tr_b16 a[76:77], v56 offset:8192
    ds_read_b64_tr_b16 a[78:79], v56 offset:8448
    s_mov_b32 s77, 16384
    s_call_b64 s[82:83], cs_dma
    s_waitcnt lgkmcnt(0)
    s_waitcnt vmcnt(8)
    v_add_u32 v55, 32768, v51
    v_xor_b32 v56, 32, v55
    ds_read_b64_tr_b16 a[80:81], v55 offset:0
    ds_read_b64_tr_b16 a[82:83], v55 offset:256
    ds_read_b64_tr_b16 a[84:85], v55 offset:8192
    ds_read_b64_tr_b16 a[86:87], v55 offset:8448
    s_mov_b32 s77, 24576
    s_call_b64 s[82:83], cs_dma
    ds_read_b64_tr_b16 a[88:89], v56 offset:0
    ds_read_b64_tr_b16 a[90:91], v56 offset:256
    ds_read_b64_tr_b16 a[92:93], v56 offset:8192
    ds_read_b64_tr_b16 a[94:95], v56 offset:8448
    s_mov_b32 s77, 32768
    s_call_b64 s[82:83], cs_dma
    s_waitcnt lgkmcnt(0)
    v_add_u32 v55, 49152, v51
    v_xor_b32 v56, 32, v55
    ds_read_b64_tr_b16 a[96:97], v55 offset:0
    ds_read_b64_tr_b16 a[98:99], v55 offset:256
    ds_read_b64_tr_b16 a[100:101], v55 offset:8192
    ds_read_b64_tr_b16 a[102:103], v55 offset:8448
    s_xor_b32 s78, s75, 0
    s_add_u32 s78, s78, s67
    s_add_u32 s80, s66, 65536
    s_mov_b32 s76, 0
    s_mov_b32 s77, 8192
    s_call_b64 s[82:83], cs_dma
    ds_read_b64_tr_b16 a[104:105], v56 offset:0
    ds_read_b64_tr_b16 a[106:107], v56 offset:256
    ds_read_b64_tr_b16 a[108:109], v56 offset:8192
    ds_read_b64_tr_b16 a[110:111], v56 offset:8448
    s_mov_b32 s77, 16384
    s_call_b64 s[82:83], cs_dma
    s_waitcnt lgkmcnt(0)
    s_waitcnt vmcnt(12)
    v_add_u32 v55, 98304, v51
    v_xor_b32 v56, 32, v55
    ds_read_b64_tr_b16 a[112:113], v55 offset:0
    ds_read_b64_tr_b16 a[114:115], v55 offset:256
    ds_read_b64_tr_b16 a[116:117], v55 offset:8192
    ds_read_b64_tr_b16 a[118:119], v55 offset:8448
    s_mov_b32 s77, 24576
    s_call_b64 s[82:83], cs_dma
    ds_read_b64_tr_b16 a[120:121], v56 offset:0
    ds_read_b64_tr_b16 a[122:123], v56 offset:256
    ds_read_b64_tr_b16 a[124:125], v56 offset:8192
    ds_read_b64_tr_b16 a[126:127], v56 offset:8448
    s_mov_b32 s77, 32768
    s_call_b64 s[82:83], cs_dma
    s_waitcnt lgkmcnt(0)
    s_waitcnt vmcnt(8)
    v_add_u32 v55, 114688, v51
    v_xor_b32 v56, 32, v55
    ds_read_b64_tr_b16 a[16:17], v55 offset:0
    ds_read_b64_tr_b16 a[18:19], v55 offset:256
    ds_read_b64_tr_b16 a[20:21], v55 offset:8192
    ds_read_b64_tr_b16 a[22:23], v55 offset:8448
    s_xor_b32 s78, s75, 0
    s_add_u32 s78, s78, s67
    s_mov_b64 s[8:9], s[52:53]
    s_add_u32 s80, s66, 0
    s_mov_b32 s76, 0
    s_mov_b32 s77, 8192
    s_call_b64 s[82:83], cs_dma
    ds_read_b64_tr_b16 a[24:25], v56 offset:0
    ds_read_b64_tr_b16 a[26:27], v56 offset:256
    ds_read_b64_tr_b16 a[28:29], v56 offset:8192
    ds_read_b64_tr_b16 a[30:31], v56 offset:8448
    s_mov_b32 s77, 16384
    s_call_b64 s[82:83], cs_dma
    s_waitcnt lgkmcnt(0)
    v_add_u32 v55, 131072, v51
    v_xor_b32 v56, 32, v55
    ds_read_b64_tr_b16 a[32:33], v55 offset:0
    ds_read_b64_tr_b16 a[34:35], v55 offset:256
    ds_read_b64_tr_b16 a[36:37], v55 offset:8192
    ds_read_b64_tr_b16 a[38:39], v55 offset:8448
    s_mov_b32 s77, 24576
    s_call_b64 s[82:83], cs_dma
    ds_read_b64_tr_b16 a[40:41], v56 offset:0
    ds_read_b64_tr_b16 a[42:43], v56 offset:256
    ds_read_b64_tr_b16 a[44:45], v56 offset:8192
    ds_read_b64_tr_b16 a[46:47], v56 offset:8448
    s_mov_b32 s77, 32768
    s_call_b64 s[82:83], cs_dma
    s_waitcnt lgkmcnt(0)
    s_waitcnt vmcnt(8)
    v_add_u32 v55, 65536, v51
    v_xor_b32 v56, 32, v55
    ds_read_b64_tr_b16 v[0:1], v55 offset:0
    ds_read_b64_tr_b16 v[2:3], v55 offset:256
    ds_read_b64_tr_b16 v[4:5], v55 offset:8192
    ds_read_b64_tr_b16 v[6:7], v55 offset:8448
    s_xor_b32 s78, s75, 1048576
    s_add_u32 s78, s78, s67
    s_add_u32 s80, s66, 32768
    s_mov_b32 s76, 0
    s_mov_b32 s77, 8192
    s_call_b64 s[82:83], cs_dma
    ds_read_b64_tr_b16 v[8:9], v56 offset:0
    ds_read_b64_tr_b16 v[10:11], v56 offset:256
    ds_read_b64_tr_b16 v[12:13], v56 offset:8192
    ds_read_b64_tr_b16 v[14:15], v56 offset:8448
    s_mov_b32 s77, 16384
    s_call_b64 s[82:83], cs_dma
    s_waitcnt lgkmcnt(0)
    ds_write_b128 v62, v[0:3] offset:8192
    ds_write_b128 v62, v[4:7] offset:12288
    ds_write_b128 v62, v[8:11] offset:16384
    ds_write_b128 v62, v[12:15] offset:20480
    s_waitcnt lgkmcnt(0)
    v_add_u32 v55, 81920, v51
    v_xor_b32 v56, 32, v55
    ds_read_b64_tr_b16 a[0:1], v55 offset:0
    ds_read_b64_tr_b16 a[2:3], v55 offset:256
    ds_read_b64_tr_b16 a[4:5], v55 offset:8192
    ds_read_b64_tr_b16 a[6:7], v55 offset:8448
    s_mov_b32 s77, 24576
    s_call_b64 s[82:83], cs_dma
    ds_read_b64_tr_b16 a[8:9], v56 offset:0
    ds_read_b64_tr_b16 a[10:11], v56 offset:256
    ds_read_b64_tr_b16 a[12:13], v56 offset:8192
    ds_read_b64_tr_b16 a[14:15], v56 offset:8448
    s_mov_b32 s77, 32768
    s_call_b64 s[82:83], cs_dma
    s_waitcnt lgkmcnt(0)
    s_waitcnt vmcnt(8)
    v_add_u32 v55, 0, v51
    v_xor_b32 v56, 32, v55
    ds_read_b64_tr_b16 v[0:1], v55 offset:0
    ds_read_b64_tr_b16 v[2:3], v55 offset:256
    ds_read_b64_tr_b16 v[4:5], v55 offset:8192
    ds_read_b64_tr_b16 v[6:7], v55 offset:8448
    s_xor_b32 s94, s13, 0
    s_mul_i32 s94, s94, 36864
    s_add_u32 s94, s94, s92
    s_lshr_b32 s74, s13, 1
    s_lshl_b32 s74, s74, 6
    s_add_u32 s94, s94, s74
    s_add_u32 s78, s94, 1024
    s_mov_b64 s[8:9], s[56:57]
    v_mov_b32 v58, v50
    s_mov_b32 s79, 18432
    s_mov_b32 s81, 0
    s_add_u32 s80, s66, 147456
    s_mov_b32 s76, 0
    s_mov_b32 s77, 8192
    s_call_b64 s[82:83], cs_dma
    ds_read_b64_tr_b16 v[8:9], v56 offset:0
    ds_read_b64_tr_b16 v[10:11], v56 offset:256
    ds_read_b64_tr_b16 v[12:13], v56 offset:8192
    ds_read_b64_tr_b16 v[14:15], v56 offset:8448
    s_xor_b32 s94, s13, 2
    s_mul_i32 s94, s94, 36864
    s_add_u32 s94, s94, s92
    s_lshr_b32 s74, s13, 1
    s_lshl_b32 s74, s74, 6
    s_add_u32 s94, s94, s74
    s_add_u32 s78, s94, 1024
    s_mov_b32 s77, 16384
    s_call_b64 s[82:83], cs_dma
    s_waitcnt lgkmcnt(0)
    ds_write_b128 v61, v[0:3] offset:0
    ds_write_b128 v61, v[4:7] offset:4096
    ds_write_b128 v61, v[8:11] offset:8192
    ds_write_b128 v61, v[12:15] offset:12288
    s_waitcnt lgkmcnt(0)
    v_add_u32 v55, 16384, v51
    v_xor_b32 v56, 32, v55
    ds_read_b64_tr_b16 v[0:1], v55 offset:0
    ds_read_b64_tr_b16 v[2:3], v55 offset:256
    ds_read_b64_tr_b16 v[4:5], v55 offset:8192
    ds_read_b64_tr_b16 v[6:7], v55 offset:8448
    s_xor_b32 s94, s13, 3
    s_mul_i32 s94, s94, 36864
    s_add_u32 s94, s94, s92
    s_lshl_b32 s74, s13, 7
    s_add_u32 s94, s94, s74
    s_add_u32 s78, s94, 512
    v_mov_b32 v58, v49
    s_mov_b32 s79, 9216
    s_add_u32 s80, s66, 131072
    s_mov_b32 s76, 0
    s_mov_b32 s77, 8192
    s_call_b64 s[82:83], cs_dma
    ds_read_b64_tr_b16 v[8:9], v56 offset:0
    ds_read_b64_tr_b16 v[10:11], v56 offset:256
    ds_read_b64_tr_b16 v[12:13], v56 offset:8192
    ds_read_b64_tr_b16 v[14:15], v56 offset:8448
    s_mov_b32 s77, 16384
    s_call_b64 s[82:83], cs_dma
    s_waitcnt lgkmcnt(0)
    ds_write_b128 v61, v[0:3] offset:16384
    ds_write_b128 v61, v[4:7] offset:20480
    ds_write_b128 v61, v[8:11] offset:24576
    ds_write_b128 v61, v[12:15] offset:28672
    s_waitcnt lgkmcnt(0)
    s_waitcnt vmcnt(8)
    v_add_u32 v55, 32768, v51
    v_xor_b32 v56, 32, v55
    ds_read_b64_tr_b16 v[0:1], v55 offset:0
    ds_read_b64_tr_b16 v[2:3], v55 offset:256
    ds_read_b64_tr_b16 v[4:5], v55 offset:8192
    ds_read_b64_tr_b16 v[6:7], v55 offset:8448
    s_xor_b32 s94, s13, 2
    s_mul_i32 s94, s94, 36864
    s_add_u32 s94, s94, s92
    s_lshl_b32 s74, s13, 7
    s_add_u32 s94, s94, s74
    s_add_u32 s78, s94, 512
    s_add_u32 s80, s66, 114688
    s_mov_b32 s76, 0
    s_mov_b32 s77, 8192
    s_call_b64 s[82:83], cs_dma
    ds_read_b64_tr_b16 v[8:9], v56 offset:0
    ds_read_b64_tr_b16 v[10:11], v56 offset:256
    ds_read_b64_tr_b16 v[12:13], v56 offset:8192
    ds_read_b64_tr_b16 v[14:15], v56 offset:8448
    s_mov_b32 s77, 16384
    s_call_b64 s[82:83], cs_dma
    s_waitcnt lgkmcnt(0)
    ds_write_b128 v61, v[0:3] offset:32768
    ds_write_b128 v61, v[4:7] offset:36864
    ds_write_b128 v61, v[8:11] offset:40960
    ds_write_b128 v61, v[12:15] offset:45056
    s_waitcnt lgkmcnt(0)
    v_add_u32 v55, 49152, v51
    v_xor_b32 v56, 32, v55
    ds_read_b64_tr_b16 v[0:1], v55 offset:0
    ds_read_b64_tr_b16 v[2:3], v55 offset:256
    ds_read_b64_tr_b16 v[4:5], v55 offset:8192
    ds_read_b64_tr_b16 v[6:7], v55 offset:8448
    s_add_u32 s78, s67, 4194304
    s_mov_b64 s[8:9], s[52:53]
    v_mov_b32 v58, v48
    s_mov_b32 s79, 131072
    s_add_u32 s80, s66, 81920
    s_mov_b32 s76, 0
    s_mov_b32 s77, 8192
    s_call_b64 s[82:83], cs_dma
    ds_read_b64_tr_b16 v[8:9], v56 offset:0
    ds_read_b64_tr_b16 v[10:11], v56 offset:256
    ds_read_b64_tr_b16 v[12:13], v56 offset:8192
    ds_read_b64_tr_b16 v[14:15], v56 offset:8448
    s_mov_b32 s77, 16384
    s_call_b64 s[82:83], cs_dma
    s_waitcnt lgkmcnt(0)
    ds_write_b128 v61, v[0:3] offset:49152
    ds_write_b128 v61, v[4:7] offset:53248
    ds_write_b128 v61, v[8:11] offset:57344
    ds_write_b128 v61, v[12:15] offset:61440
    s_waitcnt lgkmcnt(0)
    v_lshlrev_b32 v45, 3, v61
    s_lshl_b32 s40, s12, 14
    s_add_u32 s40, s40, 65536
    s_lshl_b32 s41, s12, 11
    s_sub_u32 s41, s41, 12288
    v_add_u32 v30, s40, v45
    v_add_u32 v45, s41, v45
    v_cmp_gt_u32 vcc, 1536, v61
    s_nop 1
    v_cndmask_b32 v45, v45, v30, vcc
    s_lshl_b32 s40, s12, 16
    s_add_u32 s40, s40, 24102912
    v_lshlrev_b32 v30, 3, v61
    v_add_u32 v30, s40, v30
    v_cmp_gt_u32 vcc, 1792, v61
    s_nop 1
    v_cndmask_b32 v45, v30, v45, vcc
    v_cmp_gt_u32 vcc, 2944, v61
    s_mov_b32 s40, 68157440
    s_mov_b64 exec, vcc
    buffer_load_dword v30, v45, s[4:7], s40 offen sc1
    s_mov_b64 exec, -1
    s_waitcnt vmcnt(12)
    v_add_u32 v55, 147456, v53
    ds_read_b64_tr_b16 v[0:1], v55 offset:0
    ds_read_b64_tr_b16 v[2:3], v55 offset:128
    ds_read_b64_tr_b16 v[4:5], v55 offset:512
    ds_read_b64_tr_b16 v[6:7], v55 offset:640
    ds_read_b64_tr_b16 v[8:9], v55 offset:8192
    ds_read_b64_tr_b16 v[10:11], v55 offset:8320
    ds_read_b64_tr_b16 v[12:13], v55 offset:8704
    ds_read_b64_tr_b16 v[14:15], v55 offset:8832
    s_waitcnt lgkmcnt(0)
    s_barrier
    ds_write_b128 v63, v[0:3] offset:49152
    ds_write_b128 v63, v[4:7] offset:53248
    s_barrier
    ds_write_b128 v63, v[8:11] offset:57344
    ds_write_b128 v63, v[12:15] offset:61440
    s_waitcnt lgkmcnt(0)
    buffer_load_dword v24, off, s[96:99], 0 offset:216 sc1
    buffer_load_dword v25, off, s[96:99], 0 offset:64 sc1
    s_lshr_b32 s84, s12, 1
    s_lshl_b32 s84, s84, 8
    s_add_u32 s84, s84, 125829120
    v_bfe_u32 v26, v61, 4, 6
    v_min_u32 v26, 11, v26
    v_lshlrev_b32 v26, 2, v26
    buffer_load_dword v27, v26, s[4:7], s84 offen sc1
    s_waitcnt vmcnt(11)
    v_add_u32 v55, 131072, v52
    ds_read_b64_tr_b16 v[0:1], v55 offset:0
    ds_read_b64_tr_b16 v[2:3], v55 offset:256
    ds_read_b64_tr_b16 v[4:5], v55 offset:4096
    ds_read_b64_tr_b16 v[6:7], v55 offset:4352
    ds_read_b64_tr_b16 v[8:9], v55 offset:64
    ds_read_b64_tr_b16 v[10:11], v55 offset:320
    ds_read_b64_tr_b16 v[12:13], v55 offset:4160
    ds_read_b64_tr_b16 v[14:15], v55 offset:4416
    s_waitcnt lgkmcnt(0)
    s_barrier
    ds_write_b128 v63, v[0:3] offset:32768
    ds_write_b128 v63, v[4:7] offset:36864
    s_barrier
    ds_write_b128 v63, v[8:11] offset:40960
    ds_write_b128 v63, v[12:15] offset:45056
    s_waitcnt lgkmcnt(0)
    s_waitcnt vmcnt(7)
    v_add_u32 v55, 114688, v52
    ds_read_b64_tr_b16 v[0:1], v55 offset:0
    ds_read_b64_tr_b16 v[2:3], v55 offset:256
    ds_read_b64_tr_b16 v[4:5], v55 offset:4096
    ds_read_b64_tr_b16 v[6:7], v55 offset:4352
    ds_read_b64_tr_b16 v[8:9], v55 offset:64
    ds_read_b64_tr_b16 v[10:11], v55 offset:320
    ds_read_b64_tr_b16 v[12:13], v55 offset:4160
    ds_read_b64_tr_b16 v[14:15], v55 offset:4416
    s_waitcnt lgkmcnt(0)
    s_barrier
    ds_write_b128 v63, v[0:3] offset:16384
    ds_write_b128 v63, v[4:7] offset:20480
    s_barrier
    ds_write_b128 v63, v[8:11] offset:24576
    ds_write_b128 v63, v[12:15] offset:28672
    s_waitcnt lgkmcnt(0)
    v_min_u32 v36, -2, v36
    v_min_u32 v37, -2, v37
    v_min_u32 v38, -2, v38
    v_min_u32 v39, -2, v39
    v_min_u32 v40, -2, v40
    v_min_u32 v41, -2, v41
    v_min_u32 v42, -2, v42
    v_min_u32 v43, -2, v43
    v_min_u32 v44, -2, v44
    s_lshl_b32 s14, s12, 16
    s_add_u32 s14, s14, 92274688
    s_add_u32 s41, s14, 4096
    s_add_u32 s42, s14, 8192
    v_lshrrev_b32 v45, 2, v61
    buffer_store_dwordx4 v[36:39], v61, s[4:7], s14 offen sc1
    buffer_store_dwordx4 v[40:43], v61, s[4:7], s41 offen sc1
    buffer_store_dword v44, v45, s[4:7], s42 offen sc1
    s_waitcnt vmcnt(1)
    v_readfirstlane_b32 s95, v25
    v_readfirstlane_b32 s85, v24
    s_add_u32 s86, s95, 1
    s_waitcnt vmcnt(0)
    v_subrev_u32 v27, s86, v27
    v_cmp_lt_u32 s[86:87], 64, v27
    s_cmp_eq_u32 s95, 0
    s_cselect_b64 s[86:87], -1, s[86:87]
    s_cmp_lg_u64 s[86:87], 0
    s_cbranch_scc1 cs_nt
    s_add_u32 s40, s24, 524288
    buffer_load_dword v30, v79, s[4:7], s24 offen sc1
    buffer_load_dword v30, v79, s[4:7], s40 offen sc1
cs_nt:
    s_waitcnt vmcnt(3)
    v_add_u32 v55, 81920, v51
    v_xor_b32 v56, 32, v55
    ds_read_b64_tr_b16 v[0:1], v55 offset:0
    ds_read_b64_tr_b16 v[2:3], v55 offset:256
    ds_read_b64_tr_b16 v[4:5], v55 offset:8192
    ds_read_b64_tr_b16 v[6:7], v55 offset:8448
    ds_read_b64_tr_b16 v[8:9], v56 offset:0
    ds_read_b64_tr_b16 v[10:11], v56 offset:256
    ds_read_b64_tr_b16 v[12:13], v56 offset:8192
    ds_read_b64_tr_b16 v[14:15], v56 offset:8448
    s_waitcnt lgkmcnt(0)
    ds_write_b128 v62, v[0:3] offset:24576
    ds_write_b128 v62, v[4:7] offset:28672
    ds_write_b128 v62, v[8:11] offset:32768
    ds_write_b128 v62, v[12:15] offset:36864
    s_waitcnt lgkmcnt(0)
    s_barrier
    s_mov_b32 s88, 4194304
gn3:
    s_cmp_lg_u32 s95, 0
    s_cbranch_scc1 gn3x
    buffer_load_dword v27, off, s[96:99], 0 offset:64 sc1
    s_sub_u32 s88, s88, 1
    s_cbranch_scc1 gn3x
    s_waitcnt vmcnt(0)
    v_readfirstlane_b32 s95, v27
    s_nop 1
    s_branch gn3
gn3x:
    ds_write_b128 v78, v[16:19] offset:8704
    ds_write_b128 v65, v[20:23] offset:10240
    v_mov_b32 v44, s95
    v_mov_b32 v45, s95
    v_mov_b32 v46, s95
    v_mov_b32 v47, s95
    v_mov_b32 v48, 108288
    ds_write_b128 v48, v[44:47]
    s_waitcnt vmcnt(0) lgkmcnt(0)
    s_cmp_eq_u32 s85, 1
    s_cbranch_scc1 cs_run
    s_mov_b32 s40, 16777216
cs_startpoll:
    buffer_load_dword v3, off, s[96:99], 0 offset:216 sc1
    s_waitcnt vmcnt(0)
    v_readfirstlane_b32 s85, v3
    s_nop 0
    s_cmp_eq_u32 s85, 1
    s_cbranch_scc1 cs_run
    s_sleep 1
    s_sub_u32 s40, s40, 1
    s_cbranch_scc0 cs_startpoll
    s_endpgm
cs_run:
    s_cmp_eq_u64 s[86:87], 0
    s_cbranch_scc1 cs_kvok
    s_lshr_b32 s92, s12, 1
    s_lshl_b32 s92, s92, 8
    s_add_u32 s92, s92, 125829120
    v_bfe_u32 v2, v61, 4, 6
    v_min_u32 v2, 11, v2
    v_lshlrev_b32 v2, 2, v2
    s_add_u32 s93, s95, 1
    s_mov_b32 s94, 4194304
cs_kv0:
    buffer_load_dword v3, v2, s[4:7], s92 offen sc1
    s_sub_u32 s94, s94, 1
    s_cbranch_scc1 cs_kv0_go
    s_waitcnt vmcnt(0)
    v_subrev_u32 v3, s93, v3
    v_cmp_lt_u32 vcc, 64, v3
    s_cbranch_vccz cs_kv0_go
    s_sleep 2
    s_branch cs_kv0
cs_kv0_go:
    s_add_u32 s40, s24, 524288
    buffer_load_dword v30, v79, s[4:7], s24 offen sc1
    buffer_load_dword v30, v79, s[4:7], s40 offen sc1
    s_waitcnt vmcnt(0)
cs_kvok:
    s_mov_b32 m0, 108032
    s_add_u32 s24, s24, 1048576
    s_mov_b32 s66, 0x200009
    s_mov_b32 s67, 0xc0000000
    s_add_u32 s15, s14, 4096
    s_add_u32 s16, s14, 8192
    ds_read_b128 v[32:35], v62 offset:16384
    ds_read_b128 v[36:39], v62 offset:20480
    ds_read_b128 v[40:43], v61 offset:0
    ds_read_b128 v[44:47], v61 offset:4096
    ds_read_b128 v[48:51], v61 offset:8192
    ds_read_b128 v[52:55], v61 offset:12288
    s_add_u32 s18, s14, s31
    s_mov_b32 s29, 1048576
    buffer_load_dwordx4 v[24:27], v61, s[4:7], s14 offen sc1
.p2align 6
cs_loop:
    v_mov_b64 v[0:1], 0
    v_mov_b64 v[2:3], 0
    v_mov_b64 v[4:5], 0
    v_mov_b64 v[6:7], 0
    v_mov_b64 v[8:9], 0
    v_mov_b64 v[10:11], 0
    v_mov_b64 v[12:13], 0
    v_mov_b64 v[14:15], 0
cs_loop2:
    ds_read_b128 v[16:19], v62 offset:8192
    ds_read_b128 v[20:23], v62 offset:12288
    v_lshrrev_b32 v56, 2, v61
    v_add_u32 v58, 106496, v56
    s_mov_b32 s29, 1048576
    s_waitcnt lgkmcnt(0)
cs_chk0:
    s_waitcnt vmcnt(0)
cs_chk0b:
    v_max3_u32 v57, v24, v25, v26
    v_max_u32 v57, v57, v27
    v_cmp_eq_u32 vcc, -1, v57
    ds_write_b128 v62, v[24:27] offset:40960
    s_cbranch_vccnz cs_spin0
    v_smfmac_f32_16x16x64_bf16 v[0:3], v[24:27], v[16:23], v60
    buffer_load_dwordx4 v[28:31], v61, s[4:7], s15 offen sc1
    buffer_load_dword v59, v56, s[4:7], s16 offen sc1
    v_smfmac_f32_16x16x64_bf16 v[8:11], v[24:27], v[32:39], v60
    ds_read_b128 v[32:35], v61 offset:16384
    v_smfmac_f32_16x16x64_bf16 v[12:15], v[24:27], v[48:55], v60
    ds_read_b128 v[36:39], v61 offset:20480
    v_mfma_f32_16x16x16_bf16 v[16:19], v[72:73], v[72:73], 0
    s_waitcnt lgkmcnt(2)
    s_barrier
    ds_read_b128 v[48:51], v63 offset:0
    v_mfma_f32_16x16x16_bf16 v[20:23], v[72:73], v[72:73], 0
    ds_read_b128 v[52:55], v64 offset:0
    v_smfmac_f32_16x16x64_bf16 v[4:7], v[24:27], v[40:47], v60
    ds_read_b128 v[40:43], v61 offset:24576
    v_smfmac_f32_16x16x64_bf16 v[16:19], v[24:27], a[192:199], v60
    ds_read_b128 v[44:47], v61 offset:28672
    v_smfmac_f32_16x16x64_bf16 v[20:23], v[24:27], a[200:207], v60
    s_waitcnt lgkmcnt(3)
    v_smfmac_f32_16x16x64_bf16 v[0:3], v[48:51], a[0:7], v60
    s_add_u32 s43, s14, s31
    s_add_u32 s41, s14, 16384
    v_smfmac_f32_16x16x64_bf16 v[4:7], v[48:51], v[32:39], v60
    ds_read_b128 v[32:35], v61 offset:32768
    v_smfmac_f32_16x16x64_bf16 v[8:11], v[48:51], a[8:15], v60
    ds_read_b128 v[36:39], v61 offset:36864
    s_waitcnt lgkmcnt(2)
    v_smfmac_f32_16x16x64_bf16 v[12:15], v[48:51], v[40:47], v60
    ds_read_b128 v[40:43], v61 offset:40960
    v_smfmac_f32_16x16x64_bf16 v[0:3], v[52:55], a[16:23], v60
    ds_read_b128 v[44:47], v61 offset:45056
    v_smfmac_f32_16x16x64_bf16 v[8:11], v[52:55], a[24:31], v60
    ds_read_b128 v[48:51], v71 offset:0
    s_waitcnt lgkmcnt(3)
    v_smfmac_f32_16x16x64_bf16 v[4:7], v[52:55], v[32:39], v60
    s_waitcnt vmcnt(0)
    ds_write_b128 v62, v[28:31] offset:45056
    s_waitcnt lgkmcnt(2)
    v_smfmac_f32_16x16x64_bf16 v[12:15], v[52:55], v[40:47], v60
    ds_write_b32 v58, v59
    v_max3_u32 v57, v28, v29, v30
    s_waitcnt lgkmcnt(2)
    v_smfmac_f32_16x16x64_bf16 v[0:3], v[48:51], a[32:39], v60
    ds_read_b128 v[32:35], v61 offset:49152
    v_max3_u32 v57, v57, v31, v59
    v_smfmac_f32_16x16x64_bf16 v[8:11], v[48:51], a[40:47], v60
    ds_read_b128 v[36:39], v61 offset:53248
    v_cmp_eq_u32 vcc, -1, v57
    v_smfmac_f32_16x16x64_bf16 v[16:19], v[52:55], a[224:231], v60
    ds_read_b128 v[40:43], v61 offset:57344
    v_smfmac_f32_16x16x64_bf16 v[20:23], v[52:55], a[232:239], v60
    ds_read_b128 v[44:47], v61 offset:61440
    s_cbranch_vccnz cs_spin1
cs_go1:
    v_smfmac_f32_16x16x64_bf16 v[0:3], v[28:31], a[48:55], v60
    s_waitcnt lgkmcnt(4)
    s_barrier
    ds_read_b128 v[52:55], v63 offset:4096
    v_smfmac_f32_16x16x64_bf16 v[8:11], v[28:31], a[56:63], v60
    ds_read_b128 v[56:59], v71 offset:4096
    v_smfmac_f32_16x16x64_bf16 v[4:7], v[28:31], a[128:135], v60
    s_waitcnt lgkmcnt(2)
    v_smfmac_f32_16x16x64_bf16 v[4:7], v[48:51], v[32:39], v60
    buffer_load_dwordx4 v[32:35], v61, s[4:7], s23 offen offset:0 sc1
    v_smfmac_f32_16x16x64_bf16 v[12:15], v[48:51], v[40:47], v60
    ds_read_b128 v[48:51], v64 offset:4096
    v_smfmac_f32_16x16x64_bf16 v[12:15], v[28:31], a[136:143], v60
    ds_read_b128 v[24:27], v65 offset:8192
    s_and_b32 s41, s41, 65535
    s_add_u32 s41, s41, 68157440
    v_smfmac_f32_16x16x64_bf16 v[16:19], v[28:31], v[80:87], v60
    buffer_load_dwordx4 v[36:39], v61, s[4:7], s23 offen offset:1024 sc1
    v_smfmac_f32_16x16x64_bf16 v[20:23], v[28:31], v[88:95], v60
    s_add_u32 s17, s41, s31
    s_and_b32 s30, s28, 1
    s_waitcnt lgkmcnt(3)
    v_smfmac_f32_16x16x64_bf16 v[0:3], v[52:55], a[64:71], v60
    ds_read_b128 v[28:31], v78 offset:8704
    v_smfmac_f32_16x16x64_bf16 v[4:7], v[52:55], a[144:151], v60
    buffer_load_dwordx4 v[40:43], v61, s[4:7], s23 offen offset:2048 sc1
    v_smfmac_f32_16x16x64_bf16 v[8:11], v[52:55], a[72:79], v60
    v_smfmac_f32_16x16x64_bf16 v[12:15], v[52:55], a[152:159], v60
    v_smfmac_f32_16x16x64_bf16 v[16:19], v[52:55], v[96:103], v60
    buffer_load_dwordx4 v[44:47], v61, s[4:7], s23 offen offset:3072 sc1
    v_smfmac_f32_16x16x64_bf16 v[20:23], v[52:55], v[104:111], v60
    ds_read_b128 v[52:55], v62 offset:28672
    s_waitcnt lgkmcnt(3)
    v_smfmac_f32_16x16x64_bf16 v[0:3], v[48:51], a[80:87], v60
    v_smfmac_f32_16x16x64_bf16 v[4:7], v[48:51], a[160:167], v60
    v_smfmac_f32_16x16x64_bf16 v[8:11], v[48:51], a[88:95], v60
    v_smfmac_f32_16x16x64_bf16 v[12:15], v[48:51], a[168:175], v60
    v_smfmac_f32_16x16x64_bf16 v[16:19], v[48:51], v[112:119], v60
    buffer_load_dword v79, s[4:7], s24 offen sc1 lds
    v_smfmac_f32_16x16x64_bf16 v[20:23], v[48:51], v[120:127], v60
    ds_read_b128 v[48:51], v62 offset:24576
    v_smfmac_f32_16x16x64_bf16 v[0:3], v[56:59], a[96:103], v60
    s_bitcmp1_b64 s[66:67], s28
    v_smfmac_f32_16x16x64_bf16 v[8:11], v[56:59], a[104:111], v60
    s_waitcnt lgkmcnt(3)
    v_smfmac_f32_16x16x64_bf16 v[0:3], v[24:27], a[112:119], v60
    v_smfmac_f32_16x16x64_bf16 v[8:11], v[24:27], a[120:127], v60
    v_smfmac_f32_16x16x64_bf16 v[4:7], v[56:59], a[176:183], v60
    s_waitcnt lgkmcnt(0)
    v_cvt_pk_bf16_f32 v0, v0, v1
    v_smfmac_f32_16x16x64_bf16 v[4:7], v[24:27], v[48:55], v60
    ds_read_b128 v[48:51], v62 offset:32768
    v_cvt_pk_bf16_f32 v8, v8, v9
    v_smfmac_f32_16x16x64_bf16 v[12:15], v[56:59], a[184:191], v60
    ds_read_b128 v[52:55], v62 offset:36864
    v_cvt_pk_bf16_f32 v9, v10, v11
    v_smfmac_f32_16x16x64_bf16 v[16:19], v[56:59], v[128:135], v60
    v_cvt_pk_bf16_f32 v1, v2, v3
    v_mfma_f32_16x16x16_bf16 v[8:11], v[8:9], v[28:29], 0
    v_cvt_pk_bf16_f32 v2, v4, v5
    v_cvt_pk_bf16_f32 v3, v6, v7
    v_smfmac_f32_16x16x64_bf16 v[20:23], v[56:59], v[136:143], v60
    s_mov_b64 exec, s[36:37]
    ds_read_b128 v[56:59], v69
    s_mov_b64 exec, -1
    v_mfma_f32_16x16x32_bf16 v[4:7], v[0:3], v[28:31], 0
    v_cvt_pk_bf16_f32 v2, v8, v9
    s_waitcnt lgkmcnt(1)
    v_smfmac_f32_16x16x64_bf16 v[12:15], v[24:27], v[48:55], v60
    ds_read_b128 v[48:51], v63 offset:0
    v_cvt_pk_bf16_f32 v3, v10, v11
    s_waitcnt vmcnt(3)
    v_cvt_pk_bf16_f32 v0, v4, v5
    v_cvt_pk_bf16_f32 v1, v6, v7
    s_nop 1
    v_mfma_f32_16x16x32_bf16 v[4:7], v[36:39], v[0:3], 0
    v_cvt_pk_bf16_f32 v12, v12, v13
    v_cvt_pk_bf16_f32 v13, v14, v15
    s_nop 1
    v_mfma_f32_16x16x16_bf16 v[12:15], v[12:13], v[30:31], 0
    ds_read_b128 v[52:55], v71 offset:0
    ds_read_b128 v[36:39], v63 offset:53248
    v_mfma_f32_16x16x32_bf16 v[28:31], v[32:35], v[0:3], 0
    s_waitcnt vmcnt(1)
    ds_read_b128 v[32:35], v63 offset:49152
    s_mov_b64 exec, s[34:35]
    s_nop 0
    v_cvt_pk_bf16_f32 v2, v12, v13
    v_cvt_pk_bf16_f32 v3, v14, v15
    s_mov_b64 exec, -1
    s_nop 0
    v_mfma_f32_16x16x32_bf16 v[8:11], v[0:3], v[0:3], 0
    v_mov_b32_dpp v28, v4 row_ror:8 row_mask:0xf bank_mask:0xc
    v_mov_b32_dpp v29, v5 row_ror:8 row_mask:0xf bank_mask:0xc
    v_mov_b32_dpp v30, v6 row_ror:8 row_mask:0xf bank_mask:0xc
    v_mov_b32_dpp v31, v7 row_ror:8 row_mask:0xf bank_mask:0xc
    v_smfmac_f32_16x16x64_bf16 v[16:19], v[24:27], v[144:151], v60
    ds_write_b128 v62, v[28:31] offset:53248
    v_mov_b32_dpp v8, v10 row_ror:8 row_mask:0xf bank_mask:0xc
    v_mov_b32_dpp v9, v11 row_ror:8 row_mask:0xf bank_mask:0xc
    v_smfmac_f32_16x16x64_bf16 v[20:23], v[24:27], v[152:159], v60
    ds_write_b64 v70, v[8:9]
    s_waitcnt lgkmcnt(5)
    v_smfmac_f32_16x16x64_bf16 v[16:19], v[48:51], a[208:215], v60
    s_mov_b64 exec, s[36:37]
    s_cbranch_execz cs_np3685
    buffer_store_dwordx4 v[56:59], v61, s[4:7], s65 offen sc1
cs_np3685:
    s_mov_b64 exec, -1
    v_smfmac_f32_16x16x64_bf16 v[20:23], v[48:51], a[216:223], v60
    s_cbranch_scc1 cs_last
cs_back:
    s_waitcnt lgkmcnt(0)
    s_barrier
    ds_read_b128 v[56:59], v78 offset:10752
    v_smfmac_f32_16x16x64_bf16 v[16:19], v[52:55], a[240:247], v60
    ds_read_b128 v[12:15], v78 offset:11264
    ds_read_b128 v[4:7], v63 offset:12288
    v_smfmac_f32_16x16x64_bf16 v[20:23], v[52:55], a[248:255], v60
    ds_read_b128 v[8:11], v64 offset:12288
    ds_read_b128 v[0:3], v71 offset:12288
    v_mov_b64 v[24:25], s[62:63]
    v_mov_b64 v[26:27], s[60:61]
    v_cvt_pk_bf16_f32 v16, v16, v17
    v_cvt_pk_bf16_f32 v17, v18, v19
    v_pk_mul_f32 v[28:29], v[28:29], s[44:45]
    v_pk_mul_f32 v[30:31], v[30:31], s[44:45]
    s_waitcnt lgkmcnt(3)
    v_pk_add_f32 v[56:57], v[56:57], v[58:59]
    v_pk_add_f32 v[12:13], v[12:13], v[14:15]
    v_pk_add_f32 v[56:57], v[56:57], v[12:13]
    v_pk_mul_f32 v[56:57], v[56:57], s[44:45]
    v_exp_f32 v58, v56
    v_exp_f32 v59, v57
    s_waitcnt lgkmcnt(1)
    v_pk_fma_f32 v[28:29], v[4:5], s[44:45], v[28:29]
    v_pk_fma_f32 v[30:31], v[6:7], s[44:45], v[30:31]
    v_cvt_pk_bf16_f32 v6, v58, v59
    v_pk_fma_f32 v[28:29], v[8:9], s[44:45], v[28:29]
    v_pk_fma_f32 v[30:31], v[10:11], s[44:45], v[30:31]
    s_waitcnt lgkmcnt(0)
    v_pk_fma_f32 v[28:29], v[0:1], s[44:45], v[28:29]
    v_mov_b32_dpp v7, v6 row_ror:8 row_mask:0xf bank_mask:0xf
    v_pk_fma_f32 v[30:31], v[2:3], s[44:45], v[30:31]
    v_exp_f32 v0, v28
    v_mfma_f32_16x16x16_bf16 v[12:15], v[16:17], v[6:7], 0
    ds_read_b128 v[48:51], v63 offset:57344
    v_exp_f32 v1, v29
    v_cvt_pk_bf16_f32 v18, v20, v21
    v_exp_f32 v2, v30
    v_cvt_pk_bf16_f32 v19, v22, v23
    v_cvt_pk_bf16_f32 v8, v0, v1
    v_exp_f32 v3, v31
    v_mfma_f32_16x16x16_bf16 v[20:23], v[18:19], v[6:7], 0
    ds_read_b128 v[52:55], v63 offset:61440
    v_cvt_pk_bf16_f32 v9, v2, v3
    v_mov_b32_dpp v10, v8 row_ror:8 row_mask:0xf bank_mask:0xf
    v_max3_f32 v4, |v28|, |v29|, |v30|
    v_mov_b32_dpp v11, v9 row_ror:8 row_mask:0xf bank_mask:0xf
    v_mfma_f32_16x16x32_bf16 v[0:3], v[24:27], v[6:9], 0
    v_max3_f32 v4, v4, |v31|, |v56|
    v_max_f32_e64 v4, v4, |v57|
    v_mfma_f32_16x16x32_bf16 v[12:15], v[40:43], v[8:11], v[12:15]
    v_cmp_nge_f32 vcc, s46, v4
    v_mfma_f32_16x16x32_bf16 v[20:23], v[44:47], v[8:11], v[20:23]
    v_add_f32_dpp v0, v0, v0 row_ror:8 row_mask:0xf bank_mask:0xf
    v_rcp_f32 v0, v0
    s_cbranch_vccnz cs_guard
cs_norm:
    v_mfma_f32_16x16x16_bf16 v[28:31], v[72:73], v[72:73], 0
    v_mul_f32 v12, v12, v0
    v_mul_f32 v13, v13, v0
    v_mul_f32 v14, v14, v0
    v_mul_f32 v15, v15, v0
    v_mul_f32_dpp v12, v20, v0 row_ror:8 row_mask:0xf bank_mask:0xc
    v_mul_f32_dpp v13, v21, v0 row_ror:8 row_mask:0xf bank_mask:0xc
    v_mul_f32_dpp v14, v22, v0 row_ror:8 row_mask:0xf bank_mask:0xc
    v_mul_f32_dpp v15, v23, v0 row_ror:8 row_mask:0xf bank_mask:0xc
    v_cvt_pk_bf16_f32 v12, v12, v13
    v_cvt_pk_bf16_f32 v13, v14, v15
    v_mfma_f32_16x16x16_bf16 v[8:11], v[72:73], v[72:73], 0
    ds_write_b64 v77, v[12:13]
    v_mfma_f32_16x16x16_bf16 v[4:7], v[72:73], v[72:73], 0
    ds_read_b128 v[0:3], v68
    v_mfma_f32_16x16x16_bf16 v[16:19], v[72:73], v[72:73], 0
    ds_read_b128 v[40:43], v63 offset:16384
    v_mfma_f32_16x16x16_bf16 v[20:23], v[72:73], v[72:73], 0
    ds_read_b128 v[44:47], v63 offset:20480
    s_waitcnt lgkmcnt(3)
    s_barrier
    ds_read_b128 v[24:27], v74
    ds_read_b128 v[12:15], v75
    ds_read_b128 v[56:59], v76
    s_waitcnt lgkmcnt(5)
    v_smfmac_f32_16x16x64_bf16 v[28:31], v[0:3], v[160:167], v60
    v_smfmac_f32_16x16x64_bf16 v[8:11], v[0:3], v[192:199], v60
    v_smfmac_f32_16x16x64_bf16 v[4:7], v[0:3], v[32:39], v60
    ds_read_b128 v[32:35], v63 offset:32768
    v_smfmac_f32_16x16x64_bf16 v[16:19], v[0:3], v[224:231], v60
    ds_read_b128 v[36:39], v63 offset:36864
    s_waitcnt lgkmcnt(3)
    v_smfmac_f32_16x16x64_bf16 v[28:31], v[24:27], v[168:175], v60
    v_smfmac_f32_16x16x64_bf16 v[4:7], v[12:15], v[48:55], v60
    ds_read_b128 v[48:51], v63 offset:24576
    v_smfmac_f32_16x16x64_bf16 v[28:31], v[12:15], v[176:183], v60
    ds_read_b128 v[52:55], v63 offset:28672
    s_waitcnt lgkmcnt(4)
    v_smfmac_f32_16x16x64_bf16 v[28:31], v[56:59], v[184:191], v60
    v_cvt_pk_bf16_f32 v4, v4, v5
    v_smfmac_f32_16x16x64_bf16 v[16:19], v[12:15], v[40:47], v60
    ds_read_b128 v[40:43], v63 offset:40960
    v_and_or_b32 v4, v4, -2, s30
    v_smfmac_f32_16x16x64_bf16 v[8:11], v[24:27], v[200:207], v60
    ds_read_b128 v[44:47], v63 offset:45056
    v_cvt_pk_bf16_f32 v5, v6, v7
    v_smfmac_f32_16x16x64_bf16 v[8:11], v[12:15], v[208:215], v60
    buffer_store_dwordx2 v[4:5], v67, s[4:7], s22 offen sc1
    v_cvt_pk_bf16_f32 v28, v28, v29
    v_smfmac_f32_16x16x64_bf16 v[8:11], v[56:59], v[216:223], v60
    v_and_or_b32 v28, v28, -2, s30
    v_smfmac_f32_16x16x64_bf16 v[16:19], v[24:27], v[232:239], v60
    v_cvt_pk_bf16_f32 v29, v30, v31
    s_waitcnt lgkmcnt(4)
    v_smfmac_f32_16x16x64_bf16 v[16:19], v[56:59], v[32:39], v60
    buffer_store_dwordx2 v[28:29], v66, s[4:7], s20 offen sc1
    v_cvt_pk_bf16_f32 v8, v8, v9
    s_waitcnt lgkmcnt(0)
    v_smfmac_f32_16x16x64_bf16 v[20:23], v[0:3], v[240:247], v60
    v_and_or_b32 v8, v8, -2, s30
    v_smfmac_f32_16x16x64_bf16 v[20:23], v[24:27], v[248:255], v60
    v_cvt_pk_bf16_f32 v9, v10, v11
    v_smfmac_f32_16x16x64_bf16 v[20:23], v[12:15], v[48:55], v60
    buffer_store_dwordx2 v[8:9], v66, s[4:7], s21 offen sc1
    v_cvt_pk_bf16_f32 v16, v16, v17
    v_smfmac_f32_16x16x64_bf16 v[20:23], v[56:59], v[40:47], v60
    v_and_or_b32 v16, v16, -2, s30
    v_cvt_pk_bf16_f32 v17, v18, v19
    buffer_store_dwordx2 v[16:17], v66, s[4:7], s38 offen sc1
    s_cmp_lg_u32 s13, 2
    s_nop 1
    v_cvt_pk_bf16_f32 v20, v20, v21
    v_and_or_b32 v20, v20, -2, s30
    v_cvt_pk_bf16_f32 v21, v22, v23
    buffer_store_dwordx2 v[20:21], v66, s[4:7], s39 offen sc1
    s_cbranch_scc1 cs_w013
    v_mov_b32 v21, -1
    s_mov_b64 exec, s[32:33]
    buffer_store_dword v21, v69, s[4:7], s18 offen sc1
    s_mov_b64 exec, -1
    s_mov_b32 s18, s43
    s_nop 15
    s_nop 15
    s_nop 15
    s_nop 15
    s_nop 15
    s_nop 15
    s_nop 15
    s_nop 15
    s_nop 15
    s_nop 15
    s_nop 15
    s_nop 15
    s_nop 0
    buffer_load_dwordx4 v[40:43], v65, s[4:7], s19 offen offset:0 sc1
    buffer_load_dwordx4 v[44:47], v65, s[4:7], s19 offen offset:1024 sc1
    buffer_load_dwordx4 v[48:51], v65, s[4:7], s19 offen offset:2048 sc1
    buffer_load_dwordx4 v[52:55], v65, s[4:7], s19 offen offset:3072 sc1
    ds_read_b128 v[56:59], v65 offset:10240
    s_add_u32 s28, s28, 1
    s_mov_b32 s14, s41
    s_add_u32 s23, s23, 524288
    s_add_u32 s24, s24, 524288
    s_min_u32 s24, s24, s47
    s_add_u32 s15, s14, 4096
    s_add_u32 s16, s14, 8192
    s_add_u32 s65, s65, 12288
    s_mov_b32 s40, 1
    v_mov_b64 v[0:1], 0
    v_mov_b64 v[2:3], 0
    v_mov_b64 v[4:5], 0
    v_mov_b64 v[6:7], 0
    v_mov_b64 v[8:9], 0
    v_mov_b64 v[10:11], 0
    v_mov_b64 v[12:13], 0
    v_mov_b64 v[14:15], 0
cs_chkF:
    v_mov_b32 v20, 0
    s_waitcnt vmcnt(3)
    s_waitcnt lgkmcnt(0)
    v_mfma_f32_16x16x32_bf16 v[28:31], v[40:43], v[56:59], 0
    v_bitop3_b32 v20, v20, v40, s30 bitop3:0xf6
    v_bitop3_b32 v20, v20, v42, s30 bitop3:0xf6
    s_waitcnt vmcnt(2)
    v_mfma_f32_16x16x32_bf16 v[28:31], v[44:47], v[56:59], v[28:31]
    v_bitop3_b32 v20, v20, v44, s30 bitop3:0xf6
    v_bitop3_b32 v20, v20, v46, s30 bitop3:0xf6
    s_waitcnt vmcnt(1)
    v_mfma_f32_16x16x32_bf16 v[28:31], v[48:51], v[56:59], v[28:31]
    v_bitop3_b32 v20, v20, v48, s30 bitop3:0xf6
    v_bitop3_b32 v20, v20, v50, s30 bitop3:0xf6
    s_waitcnt vmcnt(0)
    v_mfma_f32_16x16x32_bf16 v[28:31], v[52:55], v[56:59], v[28:31]
    v_bitop3_b32 v20, v20, v52, s30 bitop3:0xf6
    v_bitop3_b32 v20, v20, v54, s30 bitop3:0xf6
    v_and_b32 v20, s40, v20
    v_cmp_ne_u32 vcc, 0, v20
    s_cbranch_vccnz cs_spinF
    v_permlane32_swap_b32 v28, v30
    v_permlane32_swap_b32 v29, v31
    v_add_f32 v28, v28, v30
    v_add_f32 v30, v29, v31
    v_cvt_pk_bf16_f32 v28, v28, v30
    s_mov_b64 exec, s[32:33]
    buffer_store_dword v28, v69, s[4:7], s17 offen sc1
    s_mov_b64 exec, -1
    ds_read_b128 v[32:35], v62 offset:16384
    ds_read_b128 v[36:39], v62 offset:20480
    ds_read_b128 v[40:43], v61 offset:0
    ds_read_b128 v[44:47], v61 offset:4096
    ds_read_b128 v[48:51], v61 offset:8192
    ds_read_b128 v[52:55], v61 offset:12288
    s_nop 15
    s_nop 15
    s_nop 15
    s_nop 15
    s_nop 15
    s_nop 15
    s_nop 3
    buffer_load_dwordx4 v[24:27], v61, s[4:7], s14 offen sc1
    s_branch cs_loop2
cs_w013:
    ds_read_b128 v[56:59], v65 offset:10240
    ds_read_b128 v[32:35], v62 offset:16384
    ds_read_b128 v[36:39], v62 offset:20480
    ds_read_b128 v[40:43], v61 offset:0
    ds_read_b128 v[44:47], v61 offset:4096
    ds_read_b128 v[48:51], v61 offset:8192
    ds_read_b128 v[52:55], v61 offset:12288
    s_add_u32 s28, s28, 1
    s_mov_b32 s14, s41
    s_add_u32 s23, s23, 524288
    s_add_u32 s24, s24, 524288
    s_min_u32 s24, s24, s47
    s_add_u32 s15, s14, 4096
    s_add_u32 s16, s14, 8192
    s_add_u32 s65, s65, 12288
    s_mov_b32 s40, 1
    s_cmp_eq_u32 s64, 0
    s_cbranch_scc1 cs_w0
    v_mov_b32 v21, -1
    s_mov_b64 exec, s[32:33]
    buffer_store_dword v21, v69, s[4:7], s18 offen sc1
    s_mov_b64 exec, -1
    s_mov_b32 s18, s43
    s_cmp_eq_u32 s13, 1
    s_cbranch_scc1 cs_sx
    s_nop 15
    s_nop 15
    s_nop 15
    s_nop 15
    s_nop 15
    s_nop 15
    s_nop 15
    s_nop 15
    s_nop 15
    s_nop 15
    s_nop 15
    s_nop 15
    s_nop 7
cs_sx:
    buffer_load_dwordx4 v[0:3], v65, s[4:7], s19 offen offset:0 sc1
    buffer_load_dwordx4 v[4:7], v65, s[4:7], s19 offen offset:1024 sc1
    buffer_load_dwordx4 v[8:11], v65, s[4:7], s19 offen offset:2048 sc1
    buffer_load_dwordx4 v[12:15], v65, s[4:7], s19 offen offset:3072 sc1
cs_chkG:
    v_mov_b32 v20, 0
    s_waitcnt vmcnt(3)
    s_waitcnt lgkmcnt(6)
    v_mfma_f32_16x16x32_bf16 v[28:31], v[0:3], v[56:59], 0
    v_bitop3_b32 v20, v20, v0, s30 bitop3:0xf6
    v_bitop3_b32 v20, v20, v2, s30 bitop3:0xf6
    s_waitcnt vmcnt(2)
    v_mfma_f32_16x16x32_bf16 v[28:31], v[4:7], v[56:59], v[28:31]
    v_bitop3_b32 v20, v20, v4, s30 bitop3:0xf6
    v_bitop3_b32 v20, v20, v6, s30 bitop3:0xf6
    s_waitcnt vmcnt(1)
    v_mfma_f32_16x16x32_bf16 v[28:31], v[8:11], v[56:59], v[28:31]
    v_bitop3_b32 v20, v20, v8, s30 bitop3:0xf6
    v_bitop3_b32 v20, v20, v10, s30 bitop3:0xf6
    s_waitcnt vmcnt(0)
    v_mfma_f32_16x16x32_bf16 v[28:31], v[12:15], v[56:59], v[28:31]
    v_bitop3_b32 v20, v20, v12, s30 bitop3:0xf6
    v_bitop3_b32 v20, v20, v14, s30 bitop3:0xf6
    v_and_b32 v20, s40, v20
    v_cmp_ne_u32 vcc, 0, v20
    s_cbranch_vccnz cs_spinG
    v_permlane32_swap_b32 v28, v30
    v_permlane32_swap_b32 v29, v31
    v_add_f32 v28, v28, v30
    v_add_f32 v30, v29, v31
    s_cmp_eq_u32 s13, 3
    s_cbranch_scc1 cs_w3
    v_mov_b32 v29, v28
    v_mov_b32 v31, v30
    s_nop 0
    v_permlane16_swap_b32 v28, v29
    v_permlane16_swap_b32 v30, v31
    v_add_f32 v28, v28, v29
    v_add_f32 v30, v30, v31
cs_w3:
    v_cvt_pk_bf16_f32 v28, v28, v30
    s_mov_b64 exec, s[32:33]
    buffer_store_dword v28, v69, s[4:7], s17 offen sc1
    s_mov_b64 exec, -1
    buffer_load_dwordx4 v[24:27], v61, s[4:7], s14 offen sc1
    s_branch cs_loop
cs_w0:
    v_mov_b64 v[0:1], 0
    v_mov_b64 v[2:3], 0
    v_mov_b64 v[4:5], 0
    v_mov_b64 v[6:7], 0
    v_mov_b64 v[8:9], 0
    v_mov_b64 v[10:11], 0
    v_mov_b64 v[12:13], 0
    v_mov_b64 v[14:15], 0
    s_nop 15
    s_nop 15
    s_nop 15
    s_nop 15
    s_nop 15
    s_nop 15
    s_nop 15
    s_nop 15
    s_nop 4
    s_bitcmp0_b32 0x400010, s28
    s_cbranch_scc1 cs_nokv
    s_cmp_ge_u32 s28, 32
    s_cbranch_scc1 cs_nokv
    s_lshr_b32 s92, s12, 1
    s_lshl_b32 s92, s92, 8
    s_add_u32 s92, s92, 125829120
    v_bfe_u32 v28, v61, 4, 6
    v_min_u32 v28, 11, v28
    v_lshlrev_b32 v28, 2, v28
    s_cmp_eq_u32 s28, 22
    s_cselect_b32 s93, 63, 4
    s_cselect_b32 s94, 4096, 0
    s_add_u32 s93, s93, s95
    s_add_u32 s92, s92, s94
    v_add_u32 v30, 108304, v28
    s_waitcnt vmcnt(0)
    ds_read_b32 v29, v30
    s_waitcnt lgkmcnt(0)
    v_subrev_u32 v29, s93, v29
    v_cmp_lt_u32 vcc, 64, v29
    s_cbranch_vccz cs_kv1_go
    s_mov_b32 s94, 4194304
cs_kv1:
    buffer_load_dword v29, v28, s[4:7], s92 offen sc1
    s_sub_u32 s94, s94, 1
    s_cbranch_scc1 cs_kv1_go
    s_waitcnt vmcnt(0)
    v_subrev_u32 v29, s93, v29
    v_cmp_lt_u32 vcc, 64, v29
    s_cbranch_vccz cs_kv1_go
    s_sleep 2
    s_branch cs_kv1
cs_kv1_go:
    s_branch cs_w0p
cs_nokv:
    s_nop 15
    s_nop 15
    s_nop 15
    s_nop 15
    s_nop 15
    s_nop 15
    s_nop 15
    s_nop 15
    s_nop 15
    s_nop 15
    s_nop 15
    s_nop 15
    s_nop 15
    s_nop 15
    s_nop 15
    s_nop 15
    s_nop 10
cs_w0p:
    buffer_load_dwordx4 v[24:27], v61, s[4:7], s14 offen sc1
    s_branch cs_loop2
cs_spinF:
    buffer_load_dwordx4 v[40:43], v65, s[4:7], s19 offen offset:0 sc1
    buffer_load_dwordx4 v[44:47], v65, s[4:7], s19 offen offset:1024 sc1
    buffer_load_dwordx4 v[48:51], v65, s[4:7], s19 offen offset:2048 sc1
    buffer_load_dwordx4 v[52:55], v65, s[4:7], s19 offen offset:3072 sc1
    s_sub_u32 s29, s29, 1
    s_cmp_lt_i32 s29, 0
    s_cselect_b32 s40, 0, 1
    s_branch cs_chkF
cs_spinG:
    buffer_load_dwordx4 v[0:3], v65, s[4:7], s19 offen offset:0 sc1
    buffer_load_dwordx4 v[4:7], v65, s[4:7], s19 offen offset:1024 sc1
    buffer_load_dwordx4 v[8:11], v65, s[4:7], s19 offen offset:2048 sc1
    buffer_load_dwordx4 v[12:15], v65, s[4:7], s19 offen offset:3072 sc1
    s_sub_u32 s29, s29, 1
    s_cmp_lt_i32 s29, 0
    s_cselect_b32 s40, 0, 1
    s_branch cs_chkG
cs_guard:
    s_cbranch_scc0 cs_guard2
    buffer_store_dwordx4 v[16:19], v61, s[4:7], s26 offen sc1
    s_add_u32 s26, s26, 131072
    s_add_u32 s40, s95, 63
    v_mov_b32 v5, s40
    s_mov_b64 exec, 1
    buffer_store_dword v5, off, s[4:7], s27 sc1
    s_mov_b64 exec, -1
cs_guard2:
    s_nop 7
    v_max3_f32 v6, v28, v29, v30
    v_max3_f32 v7, v31, v56, v57
    v_max_f32 v6, v6, v7
    s_nop 1
    v_max_f32_dpp v6, v6, v6 row_ror:8 row_mask:0xf bank_mask:0xf
    v_mov_b32 v7, v6
    s_nop 1
    v_permlane32_swap_b32 v6, v7
    v_max_f32 v6, v6, v7
    v_mov_b32 v7, v6
    s_nop 1
    v_permlane16_swap_b32 v6, v7
    v_max_f32 v6, v6, v7
    v_sub_f32 v28, v28, v6
    v_sub_f32 v29, v29, v6
    v_sub_f32 v30, v30, v6
    v_sub_f32 v31, v31, v6
    v_sub_f32 v56, v56, v6
    v_sub_f32 v57, v57, v6
    v_exp_f32 v58, v56
    v_exp_f32 v59, v57
    s_nop 0
    v_cvt_pk_bf16_f32 v6, v58, v59
    s_nop 1
    v_mov_b32_dpp v7, v6 row_ror:8 row_mask:0xf bank_mask:0xf
    v_exp_f32 v0, v28
    s_nop 0
    v_mfma_f32_16x16x16_bf16 v[12:15], v[16:17], v[6:7], 0
    v_exp_f32 v1, v29
    v_exp_f32 v2, v30
    v_cvt_pk_bf16_f32 v8, v0, v1
    v_exp_f32 v3, v31
    v_mfma_f32_16x16x16_bf16 v[20:23], v[18:19], v[6:7], 0
    v_cvt_pk_bf16_f32 v9, v2, v3
    v_mov_b32_dpp v10, v8 row_ror:8 row_mask:0xf bank_mask:0xf
    v_max3_f32 v4, |v28|, |v29|, |v30|
    v_mov_b32_dpp v11, v9 row_ror:8 row_mask:0xf bank_mask:0xf
    v_mfma_f32_16x16x32_bf16 v[0:3], v[24:27], v[6:9], 0
    v_max3_f32 v4, v4, |v31|, |v56|
    v_max_f32_e64 v4, v4, |v57|
    v_mfma_f32_16x16x32_bf16 v[12:15], v[40:43], v[8:11], v[12:15]
    v_cmp_nge_f32 vcc, s46, v4
    v_mfma_f32_16x16x32_bf16 v[20:23], v[44:47], v[8:11], v[20:23]
    v_add_f32_dpp v0, v0, v0 row_ror:8 row_mask:0xf bank_mask:0xf
    v_rcp_f32 v0, v0
    s_nop 4
    s_branch cs_norm
cs_spin0:
    buffer_load_dwordx4 v[24:27], v61, s[4:7], s14 offen sc1
    s_sub_u32 s29, s29, 1
    s_cmp_lt_i32 s29, 0
    s_cbranch_scc0 cs_chk0
    s_waitcnt vmcnt(0)
    v_min_u32 v24, -2, v24
    v_min_u32 v25, -2, v25
    v_min_u32 v26, -2, v26
    v_min_u32 v27, -2, v27
    s_branch cs_chk0
cs_spin1:
    buffer_load_dwordx4 v[28:31], v61, s[4:7], s15 offen sc1
    buffer_load_dword v59, v56, s[4:7], s16 offen sc1
    s_sub_u32 s29, s29, 1
    s_cmp_lt_i32 s29, 0
    s_waitcnt vmcnt(0)
    v_max3_u32 v57, v28, v29, v30
    v_max3_u32 v57, v57, v31, v59
    v_cmp_eq_u32 vcc, -1, v57
    ds_write_b128 v62, v[28:31] offset:45056
    ds_write_b32 v58, v59
    s_waitcnt lgkmcnt(0)
    s_cbranch_scc1 cs_go1
    s_cbranch_vccnz cs_spin1
    s_branch cs_go1
cs_last:
    s_nop 1
    s_cmp_ge_u32 s28, 2
    s_cbranch_scc1 cs_last0
    s_and_b32 s40, s12, 3
    s_lshl_b32 s40, s40, 14
    s_add_u32 s40, s40, 68157440
    s_lshr_b32 s42, s12, 2
    s_lshl_b32 s42, s42, 3
    s_lshl_b64 exec, 0x55, s42
    buffer_load_dword v79, s[4:7], s40 offen sc1 lds
    s_mov_b64 exec, -1
    s_cmp_eq_u32 0, 1
    s_branch cs_back
cs_last0:
    s_cmp_ge_u32 s28, 62
    s_cbranch_scc1 cs_last1
    s_lshr_b32 s92, s12, 1
    s_lshl_b32 s92, s92, 8
    s_add_u32 s92, s92, 125829120
    v_bfe_u32 v48, v61, 4, 6
    v_min_u32 v48, 11, v48
    v_lshlrev_b32 v48, 2, v48
    s_cmp_eq_u32 s28, 21
    s_cselect_b32 s93, 63, 4
    s_cselect_b32 s94, 4096, 0
    s_add_u32 s93, s93, s95
    s_add_u32 s92, s92, s94
    s_mov_b32 m0, 108304
    s_mov_b64 exec, 0xfff
    buffer_load_dword v48, s[4:7], s92 offen sc1 lds
    s_mov_b64 exec, -1
    s_mov_b32 m0, 108032
    s_cmp_eq_u32 0, 1
    s_branch cs_back
cs_last1:
    s_cmp_eq_u32 s28, 63
    s_cbranch_scc1 cs_last2
    s_mov_b64 exec, s[34:35]
    buffer_store_dwordx4 v[0:3], v61, s[4:7], s25 offen sc1
    s_mov_b64 exec, -1
    s_add_u32 s25, s25, 131072
    s_mov_b32 s46, 0xbf800000
    s_cmp_eq_u32 0, 0
    s_branch cs_back
cs_last2:
    s_waitcnt lgkmcnt(0)
    s_mov_b64 exec, s[34:35]
    buffer_store_dwordx4 v[0:3], v61, s[4:7], s25 offen sc1
    s_mov_b64 exec, -1
    s_add_u32 s40, s95, 64
    v_mov_b32 v40, s40
    v_smfmac_f32_16x16x64_bf16 v[16:19], v[52:55], a[240:247], v60
    v_smfmac_f32_16x16x64_bf16 v[20:23], v[52:55], a[248:255], v60
    s_nop 3
    v_cvt_pk_bf16_f32 v16, v16, v17
    v_cvt_pk_bf16_f32 v17, v18, v19
    s_nop 1
    v_cvt_pk_bf16_f32 v18, v20, v21
    v_cvt_pk_bf16_f32 v19, v22, v23
    buffer_store_dwordx4 v[16:19], v61, s[4:7], s26 offen sc1
    s_mov_b64 exec, 1
    buffer_store_dword v40, off, s[4:7], s27 sc1
    s_mov_b64 exec, -1
    s_endpgm
cs_dma:
    s_xor_b32 s74, s76, s81
    s_add_u32 m0, s74, s80
    s_add_u32 s76, s76, 4096
    buffer_load_dwordx4 v58, s[8:11], s78 offen lds
    s_add_u32 s78, s78, s79
    s_cmp_lt_u32 s76, s77
    s_cbranch_scc1 cs_dma
    s_setpc_b64 s[82:83]
L_helper:
    s_load_dwordx16 s[64:79], s[0:1], 64
    s_sub_u32 s33, s3, 4
    s_and_b32 s33, s33, 7
L_pool:
    s_lshl_b32 s35, s33, 2
    s_add_u32 s35, s35, 32
    s_mov_b32 s37, s35
    v_mov_b32 v250, 1
    v_mov_b32 v251, 163832
    v_cmp_eq_u32 vcc, 0, v0
    s_nop 0
    s_and_saveexec_b64 s[38:39], vcc
    s_cbranch_execz tk4
    buffer_atomic_add v250, off, s[96:99], s37 sc0
    s_waitcnt vmcnt(0)
    ds_write_b32 v251, v250
    s_waitcnt lgkmcnt(0)
tk4:
    s_mov_b64 exec, -1
    s_barrier
    ds_read_b32 v252, v251
    s_waitcnt lgkmcnt(0)
    v_readfirstlane_b32 s34, v252
    s_barrier
    s_nop 3
    s_mov_b32 s36, s33
    s_or_b32 s33, s34, s32
    s_cmp_lg_u32 s33, 0
    s_cbranch_scc1 L_helper1
    s_memrealtime s[90:91]
    s_waitcnt lgkmcnt(0)
    s_lshl_b32 s90, s90, 8
    s_or_b32 s90, s90, 1
    v_mov_b32 v250, s90
    v_mov_b32 v251, 0
    s_mov_b64 exec, 1
    buffer_atomic_cmpswap v[250:251], off, s[96:99], 0 offset:64
    s_mov_b64 exec, -1
L_helper1:
    s_cmp_ge_u32 s34, 32
    s_cbranch_scc1 L_qkv_next
    s_cmp_ge_u32 s36, 7
    s_cbranch_scc1 L_qkv_next
    s_mov_b32 s38, 0
    s_cmp_eq_u32 s36, 6
    s_cbranch_scc1 L_copy
    s_lshl_b32 s36, s36, 5
    s_add_u32 s36, s36, s34
    s_mul_i32 s37, s36, 171
    s_lshr_b32 s37, s37, 10
    s_mul_i32 s38, s37, 6
    s_sub_u32 s36, s36, s38
    s_lshl_b32 s36, s36, 5
    s_add_u32 s36, s36, s37
    s_branch L_job
    s_cmp_eq_u32 s36, 6
    s_cselect_b32 s36, s34, s36
    s_cbranch_scc1 L_job
    s_max_u32 s37, s36, 4
    s_sub_u32 s37, s37, 4
    s_mul_i32 s37, s37, 5
    s_mul_i32 s38, s36, 7
    s_sub_u32 s38, s38, s37
    s_cmp_lt_u32 s36, 4
    s_cselect_b32 s39, 7, 2
    s_mul_i32 s36, s36, 25
    s_add_u32 s36, s36, s37
    s_cmp_lt_u32 s34, s39
    s_cbranch_scc1 L_copy
    s_add_u32 s36, s36, s34
    s_sub_u32 s36, s36, s39
    s_mul_i32 s37, s36, 205
    s_lshr_b32 s37, s37, 10
    s_mul_i32 s38, s37, 5
    s_sub_u32 s36, s36, s38
    s_add_u32 s36, s36, 1
    s_lshl_b32 s36, s36, 5
    s_add_u32 s36, s36, s37
    s_branch L_job
L_copy:
    s_add_u32 s36, s38, s34
    s_mul_i32 s36, s36, 11
    s_and_b32 s36, s36, 31
    s_cmp_ge_u32 s36, 27
    s_cbranch_scc1 L_cdone
    s_mul_i32 s33, s36, 57
    s_lshr_b32 s33, s33, 9
    s_mul_i32 s37, s33, 9
    s_sub_u32 s37, s36, s37
    s_lshl_b32 s36, s37, 2
    s_add_u32 s36, s36, 1
    s_min_u32 s36, s36, 31
    s_lshr_b32 s39, s52, 8
    s_sub_u32 s36, s36, s39
    s_and_b32 s36, s36, 31
    s_lshl_b32 s36, s36, 8
    s_mov_b32 s14, 4718592
    s_mov_b32 s15, 0x20000
    v_lshrrev_b32 v1, 4, v0
    v_lshlrev_b32 v1, 13, v1
    v_and_b32 v2, 15, v0
    v_lshl_add_u32 v1, v2, 4, v1
    v_lshlrev_b32 v2, 4, v0
    s_mul_i32 s40, s33, 2
    s_mul_i32 s39, s40, 49152
    s_lshl_b32 s41, s37, 19
    s_add_u32 s39, s39, s41
    s_add_u32 s39, s39, 96468992
    s_add_u32 s41, s40, 0
    s_cmp_lt_u32 s41, 3
    s_cselect_b64 s[12:13], s[52:53], s[54:55]
    s_cselect_b32 s42, 0, 3
    s_cmp_ge_u32 s41, 6
    s_cselect_b64 s[12:13], s[56:57], s[12:13]
    s_cselect_b32 s42, 6, s42
    s_sub_u32 s41, s41, s42
    s_mul_i32 s38, s41, 1572864
    s_add_u32 s38, s38, s36
    buffer_load_dwordx4 v[8:11], v1, s[12:15], s38 offen
    s_add_u32 s38, s38, 131072
    buffer_load_dwordx4 v[12:15], v1, s[12:15], s38 offen
    s_add_u32 s38, s38, 131072
    buffer_load_dwordx4 v[16:19], v1, s[12:15], s38 offen
    s_add_u32 s38, s38, 131072
    buffer_load_dwordx4 v[20:23], v1, s[12:15], s38 offen
    s_add_u32 s38, s38, 131072
    buffer_load_dwordx4 v[24:27], v1, s[12:15], s38 offen
    s_add_u32 s38, s38, 131072
    buffer_load_dwordx4 v[28:31], v1, s[12:15], s38 offen
    s_add_u32 s38, s38, 131072
    buffer_load_dwordx4 v[32:35], v1, s[12:15], s38 offen
    s_add_u32 s38, s38, 131072
    buffer_load_dwordx4 v[36:39], v1, s[12:15], s38 offen
    s_add_u32 s38, s38, 131072
    buffer_load_dwordx4 v[40:43], v1, s[12:15], s38 offen
    s_add_u32 s38, s38, 131072
    buffer_load_dwordx4 v[44:47], v1, s[12:15], s38 offen
    s_add_u32 s38, s38, 131072
    buffer_load_dwordx4 v[48:51], v1, s[12:15], s38 offen
    s_add_u32 s38, s38, 131072
    buffer_load_dwordx4 v[52:55], v1, s[12:15], s38 offen
    s_add_u32 s38, s38, 131072
    s_add_u32 s41, s40, 1
    s_cmp_lt_u32 s41, 3
    s_cselect_b64 s[12:13], s[52:53], s[54:55]
    s_cselect_b32 s42, 0, 3
    s_cmp_ge_u32 s41, 6
    s_cselect_b64 s[12:13], s[56:57], s[12:13]
    s_cselect_b32 s42, 6, s42
    s_sub_u32 s41, s41, s42
    s_mul_i32 s38, s41, 1572864
    s_add_u32 s38, s38, s36
    buffer_load_dwordx4 v[56:59], v1, s[12:15], s38 offen
    s_add_u32 s38, s38, 131072
    buffer_load_dwordx4 v[60:63], v1, s[12:15], s38 offen
    s_add_u32 s38, s38, 131072
    buffer_load_dwordx4 v[64:67], v1, s[12:15], s38 offen
    s_add_u32 s38, s38, 131072
    buffer_load_dwordx4 v[68:71], v1, s[12:15], s38 offen
    s_add_u32 s38, s38, 131072
    buffer_load_dwordx4 v[72:75], v1, s[12:15], s38 offen
    s_add_u32 s38, s38, 131072
    buffer_load_dwordx4 v[76:79], v1, s[12:15], s38 offen
    s_add_u32 s38, s38, 131072
    buffer_load_dwordx4 v[80:83], v1, s[12:15], s38 offen
    s_add_u32 s38, s38, 131072
    buffer_load_dwordx4 v[84:87], v1, s[12:15], s38 offen
    s_add_u32 s38, s38, 131072
    buffer_load_dwordx4 v[88:91], v1, s[12:15], s38 offen
    s_add_u32 s38, s38, 131072
    buffer_load_dwordx4 v[92:95], v1, s[12:15], s38 offen
    s_add_u32 s38, s38, 131072
    buffer_load_dwordx4 v[96:99], v1, s[12:15], s38 offen
    s_add_u32 s38, s38, 131072
    buffer_load_dwordx4 v[100:103], v1, s[12:15], s38 offen
    s_add_u32 s38, s38, 131072
    buffer_load_dword v3, off, s[96:99], 0 offset:64 sc1
    s_waitcnt vmcnt(0)
    buffer_store_dwordx4 v[8:11], v2, s[4:7], s39 offen sc1
    s_add_u32 s39, s39, 4096
    buffer_store_dwordx4 v[12:15], v2, s[4:7], s39 offen sc1
    s_add_u32 s39, s39, 4096
    buffer_store_dwordx4 v[16:19], v2, s[4:7], s39 offen sc1
    s_add_u32 s39, s39, 4096
    buffer_store_dwordx4 v[20:23], v2, s[4:7], s39 offen sc1
    s_add_u32 s39, s39, 4096
    buffer_store_dwordx4 v[24:27], v2, s[4:7], s39 offen sc1
    s_add_u32 s39, s39, 4096
    buffer_store_dwordx4 v[28:31], v2, s[4:7], s39 offen sc1
    s_add_u32 s39, s39, 4096
    buffer_store_dwordx4 v[32:35], v2, s[4:7], s39 offen sc1
    s_add_u32 s39, s39, 4096
    buffer_store_dwordx4 v[36:39], v2, s[4:7], s39 offen sc1
    s_add_u32 s39, s39, 4096
    buffer_store_dwordx4 v[40:43], v2, s[4:7], s39 offen sc1
    s_add_u32 s39, s39, 4096
    buffer_store_dwordx4 v[44:47], v2, s[4:7], s39 offen sc1
    s_add_u32 s39, s39, 4096
    buffer_store_dwordx4 v[48:51], v2, s[4:7], s39 offen sc1
    s_add_u32 s39, s39, 4096
    buffer_store_dwordx4 v[52:55], v2, s[4:7], s39 offen sc1
    s_add_u32 s39, s39, 4096
    buffer_store_dwordx4 v[56:59], v2, s[4:7], s39 offen sc1
    s_add_u32 s39, s39, 4096
    buffer_store_dwordx4 v[60:63], v2, s[4:7], s39 offen sc1
    s_add_u32 s39, s39, 4096
    buffer_store_dwordx4 v[64:67], v2, s[4:7], s39 offen sc1
    s_add_u32 s39, s39, 4096
    buffer_store_dwordx4 v[68:71], v2, s[4:7], s39 offen sc1
    s_add_u32 s39, s39, 4096
    buffer_store_dwordx4 v[72:75], v2, s[4:7], s39 offen sc1
    s_add_u32 s39, s39, 4096
    buffer_store_dwordx4 v[76:79], v2, s[4:7], s39 offen sc1
    s_add_u32 s39, s39, 4096
    buffer_store_dwordx4 v[80:83], v2, s[4:7], s39 offen sc1
    s_add_u32 s39, s39, 4096
    buffer_store_dwordx4 v[84:87], v2, s[4:7], s39 offen sc1
    s_add_u32 s39, s39, 4096
    buffer_store_dwordx4 v[88:91], v2, s[4:7], s39 offen sc1
    s_add_u32 s39, s39, 4096
    buffer_store_dwordx4 v[92:95], v2, s[4:7], s39 offen sc1
    s_add_u32 s39, s39, 4096
    buffer_store_dwordx4 v[96:99], v2, s[4:7], s39 offen sc1
    s_add_u32 s39, s39, 4096
    buffer_store_dwordx4 v[100:103], v2, s[4:7], s39 offen sc1
    s_add_u32 s39, s39, 4096
    v_readfirstlane_b32 s95, v3
    s_nop 4
    s_mov_b32 s88, 4194304
gn5:
    s_cmp_lg_u32 s95, 0
    s_cbranch_scc1 gn5x
    buffer_load_dword v3, off, s[96:99], 0 offset:64 sc1
    s_sub_u32 s88, s88, 1
    s_cbranch_scc1 gn5x
    s_waitcnt vmcnt(0)
    v_readfirstlane_b32 s95, v3
    s_nop 1
    s_branch gn5
gn5x:
    s_lshl_b32 s37, s37, 7
    s_lshl_b32 s36, s33, 2
    s_add_u32 s36, s36, s32
    s_lshl_b32 s36, s36, 2
    s_add_u32 s37, s37, s36
    s_add_u32 s37, s37, 125853696
    v_mov_b32 v3, s95
    s_waitcnt vmcnt(0)
    s_mov_b64 exec, 1
    buffer_store_dword v3, off, s[4:7], s37 sc1
    s_mov_b64 exec, -1
L_cdone:
    s_add_u32 s20, s34, 112
    s_waitcnt lgkmcnt(0)
    s_branch L_sjob
L_qkv_next:
    s_mov_b32 s37, 4
    v_mov_b32 v250, 1
    v_mov_b32 v251, 163832
    v_cmp_eq_u32 vcc, 0, v0
    s_nop 0
    s_and_saveexec_b64 s[38:39], vcc
    s_cbranch_execz tk6
    buffer_atomic_add v250, off, s[96:99], s37 sc0
    s_waitcnt vmcnt(0)
    ds_write_b32 v251, v250
    s_waitcnt lgkmcnt(0)
tk6:
    s_mov_b64 exec, -1
    s_barrier
    ds_read_b32 v252, v251
    s_waitcnt lgkmcnt(0)
    v_readfirstlane_b32 s36, v252
    s_barrier
    s_nop 3
    s_add_u32 s36, s36, 192
    s_cmp_ge_u32 s36, 320
    s_cbranch_scc1 L_ssm_next
L_job:
    s_and_b32 s17, s36, 15
    s_lshl_b32 s17, s17, 1
    s_bfe_u32 s16, s36, 0x10004
    s_lshr_b32 s19, s36, 5
    s_mul_i32 s33, s16, 6
    s_add_u32 s33, s33, s19
    s_add_u32 s16, s16, 1
    s_lshr_b32 s37, s36, 4
    s_sub_u32 s38, s37, 12
    s_cmp_ge_u32 s36, 192
    s_cselect_b32 s16, 0, s16
    s_cselect_b32 s19, s38, s19
    s_cselect_b32 s33, s37, s33
    s_cselect_b32 s20, 8, 6
    v_lshrrev_b32 v4, 6, v0
    s_nop 0
    v_readfirstlane_b32 s18, v4
    v_lshlrev_b32 v7, 4, v0
    v_and_b32 v4, 63, v0
    v_lshrrev_b32 v6, 2, v4
    v_lshlrev_b32 v6, 13, v6
    v_lshrrev_b32 v5, 4, v4
    v_and_b32 v5, 2, v5
    v_xor_b32 v5, v5, v4
    v_and_b32 v5, 3, v5
    v_lshl_add_u32 v6, v5, 4, v6
    v_lshrrev_b32 v24, 4, v4
    v_lshlrev_b32 v24, 9, v24
    v_bfe_u32 v5, v4, 2, 2
    v_lshl_add_u32 v24, v5, 6, v24
    v_bfe_u32 v5, v4, 4, 1
    v_lshl_add_u32 v24, v5, 5, v24
    v_and_b32 v5, 3, v4
    v_lshl_add_u32 v24, v5, 3, v24
    s_lshl_b32 s31, s18, 12
    v_add_u32 v24, s31, v24
    s_cmp_eq_u32 s16, 1
    s_cselect_b64 s[12:13], s[54:55], s[52:53]
    s_cmp_eq_u32 s16, 2
    s_cselect_b64 s[12:13], s[56:57], s[12:13]
    s_mov_b32 s14, 4718592
    s_mov_b32 s15, 0x20000
    s_lshl_b32 s28, s17, 8
    s_lshl_b32 s21, s18, 6
    s_add_u32 s28, s28, s21
    s_add_u32 s21, s28, 0
    s_add_u32 m0, s31, 40960
    s_nop 0
    buffer_load_dwordx4 v6, s[12:15], s21 offen lds
    s_add_u32 m0, s31, 41984
    s_add_u32 s21, s21, 131072
    buffer_load_dwordx4 v6, s[12:15], s21 offen lds
    s_add_u32 m0, s31, 43008
    s_add_u32 s21, s21, 131072
    buffer_load_dwordx4 v6, s[12:15], s21 offen lds
    s_add_u32 m0, s31, 44032
    s_add_u32 s21, s21, 131072
    buffer_load_dwordx4 v6, s[12:15], s21 offen lds
    s_add_u32 s21, s28, 256
    s_add_u32 m0, s31, 57344
    s_nop 0
    buffer_load_dwordx4 v6, s[12:15], s21 offen lds
    s_add_u32 m0, s31, 58368
    s_add_u32 s21, s21, 131072
    buffer_load_dwordx4 v6, s[12:15], s21 offen lds
    s_add_u32 m0, s31, 59392
    s_add_u32 s21, s21, 131072
    buffer_load_dwordx4 v6, s[12:15], s21 offen lds
    s_add_u32 m0, s31, 60416
    s_add_u32 s21, s21, 131072
    buffer_load_dwordx4 v6, s[12:15], s21 offen lds
    s_add_u32 s21, s28, 524288
    s_add_u32 m0, s31, 73728
    s_nop 0
    buffer_load_dwordx4 v6, s[12:15], s21 offen lds
    s_add_u32 m0, s31, 74752
    s_add_u32 s21, s21, 131072
    buffer_load_dwordx4 v6, s[12:15], s21 offen lds
    s_add_u32 m0, s31, 75776
    s_add_u32 s21, s21, 131072
    buffer_load_dwordx4 v6, s[12:15], s21 offen lds
    s_add_u32 m0, s31, 76800
    s_add_u32 s21, s21, 131072
    buffer_load_dwordx4 v6, s[12:15], s21 offen lds
    s_add_u32 s21, s28, 524544
    s_add_u32 m0, s31, 90112
    s_nop 0
    buffer_load_dwordx4 v6, s[12:15], s21 offen lds
    s_add_u32 m0, s31, 91136
    s_add_u32 s21, s21, 131072
    buffer_load_dwordx4 v6, s[12:15], s21 offen lds
    s_add_u32 m0, s31, 92160
    s_add_u32 s21, s21, 131072
    buffer_load_dwordx4 v6, s[12:15], s21 offen lds
    s_add_u32 m0, s31, 93184
    s_add_u32 s21, s21, 131072
    buffer_load_dwordx4 v6, s[12:15], s21 offen lds
    s_add_u32 s21, s28, 1048576
    s_add_u32 m0, s31, 106496
    s_nop 0
    buffer_load_dwordx4 v6, s[12:15], s21 offen lds
    s_add_u32 m0, s31, 107520
    s_add_u32 s21, s21, 131072
    buffer_load_dwordx4 v6, s[12:15], s21 offen lds
    s_add_u32 m0, s31, 108544
    s_add_u32 s21, s21, 131072
    buffer_load_dwordx4 v6, s[12:15], s21 offen lds
    s_add_u32 m0, s31, 109568
    s_add_u32 s21, s21, 131072
    buffer_load_dwordx4 v6, s[12:15], s21 offen lds
    s_add_u32 s21, s28, 1048832
    s_add_u32 m0, s31, 122880
    s_nop 0
    buffer_load_dwordx4 v6, s[12:15], s21 offen lds
    s_add_u32 m0, s31, 123904
    s_add_u32 s21, s21, 131072
    buffer_load_dwordx4 v6, s[12:15], s21 offen lds
    s_add_u32 m0, s31, 124928
    s_add_u32 s21, s21, 131072
    buffer_load_dwordx4 v6, s[12:15], s21 offen lds
    s_add_u32 m0, s31, 125952
    s_add_u32 s21, s21, 131072
    buffer_load_dwordx4 v6, s[12:15], s21 offen lds
    s_add_u32 s21, s28, 1572864
    s_add_u32 m0, s31, 139264
    s_nop 0
    buffer_load_dwordx4 v6, s[12:15], s21 offen lds
    s_add_u32 m0, s31, 140288
    s_add_u32 s21, s21, 131072
    buffer_load_dwordx4 v6, s[12:15], s21 offen lds
    s_add_u32 m0, s31, 141312
    s_add_u32 s21, s21, 131072
    buffer_load_dwordx4 v6, s[12:15], s21 offen lds
    s_add_u32 m0, s31, 142336
    s_add_u32 s21, s21, 131072
    buffer_load_dwordx4 v6, s[12:15], s21 offen lds
    v_and_b32 v5, 15, v4
    v_lshrrev_b32 v3, 4, v4
    v_lshrrev_b32 v2, 2, v5
    v_xor_b32 v3, v3, v2
    v_lshl_add_u32 v3, v5, 2, v3
    v_lshlrev_b32 v1, 4, v3
    v_lshrrev_b32 v5, 2, v4
    v_lshrrev_b32 v3, 4, v4
    v_and_b32 v4, 3, v4
    v_xor_b32 v4, v4, v3
    v_lshlrev_b32 v3, 3, v3
    v_and_b32 v5, 3, v5
    v_add_u32 v3, v3, v5
    v_mul_u32_u24 v2, 1152, v3
    v_lshl_add_u32 v2, v4, 4, v2
    s_mov_b32 s8, s48
    s_mov_b32 s9, s49
    s_mov_b32 s10, 2359296
    s_mov_b32 s11, 0x20000
    s_lshr_b32 s22, s18, 1
    s_mul_i32 s24, s22, 4608
    s_and_b32 s22, s18, 1
    s_mul_i32 s23, s22, 576
    s_add_u32 s24, s24, s23
    s_mul_i32 s25, s18, 9216
    s_mul_i32 s22, s19, 36864
    s_add_u32 s24, s24, s22
    s_mul_i32 s42, s20, 36864
    s_mov_b32 s27, 0
    s_add_u32 s23, s27, s25
    s_add_u32 m0, s23, 0
    s_nop 0
    buffer_load_dwordx4 v2, s[8:11], s24 offen offset:0 lds
    s_add_u32 m0, s23, 960
    s_nop 0
    buffer_load_dwordx4 v2, s[8:11], s24 offen offset:64 lds
    s_add_u32 m0, s23, 1920
    s_nop 0
    buffer_load_dwordx4 v2, s[8:11], s24 offen offset:128 lds
    s_add_u32 m0, s23, 2880
    s_nop 0
    buffer_load_dwordx4 v2, s[8:11], s24 offen offset:192 lds
    s_add_u32 m0, s23, 3840
    s_nop 0
    buffer_load_dwordx4 v2, s[8:11], s24 offen offset:256 lds
    s_add_u32 m0, s23, 4800
    s_nop 0
    buffer_load_dwordx4 v2, s[8:11], s24 offen offset:320 lds
    s_add_u32 m0, s23, 5760
    s_nop 0
    buffer_load_dwordx4 v2, s[8:11], s24 offen offset:384 lds
    s_add_u32 m0, s23, 6720
    s_nop 0
    buffer_load_dwordx4 v2, s[8:11], s24 offen offset:448 lds
    s_add_u32 m0, s23, 7680
    s_nop 0
    buffer_load_dwordx4 v2, s[8:11], s24 offen offset:512 lds
    s_add_u32 s24, s24, s42
    s_lshl_b32 s22, s19, 5
    s_add_u32 s22, s22, s17
    s_lshl_b32 s26, s22, 14
    s_mul_i32 s23, s18, 3072
    s_add_u32 s26, s26, s23
    s_lshl_b32 s23, s16, 11
    s_add_u32 s26, s26, s23
    s_add_u32 s26, s26, -2048
    s_lshl_b32 s22, s22, 13
    s_add_u32 s22, s22, 33554432
    s_cmp_eq_u32 s16, 0
    s_cselect_b32 s26, s22, s26
    s_cselect_b32 s40, 4, 1
    s_cselect_b32 s43, 1, 2
    s_lshl_b32 s40, s40, 10
    s_lshl_b32 s43, s43, 13
    s_lshl_b32 s41, s43, 5
    s_mul_i32 s41, s41, s20
    s_lshl_b32 s29, s17, 7
    s_lshl_b32 s22, s33, 2
    s_add_u32 s29, s29, s22
    s_add_u32 s29, s29, 125829120
    v_add_u32 v25, 40960, v24
    v_xor_b32 v26, 32, v25
    s_waitcnt vmcnt(33)
    ds_read_b64_tr_b16 v[64:65], v25 offset:0
    ds_read_b64_tr_b16 v[66:67], v25 offset:256
    ds_read_b64_tr_b16 v[136:137], v26 offset:0
    ds_read_b64_tr_b16 v[138:139], v26 offset:256
    ds_read_b64_tr_b16 v[68:69], v25 offset:2048
    ds_read_b64_tr_b16 v[70:71], v25 offset:2304
    ds_read_b64_tr_b16 v[140:141], v26 offset:2048
    ds_read_b64_tr_b16 v[142:143], v26 offset:2304
    s_waitcnt lgkmcnt(0)
    s_add_u32 s21, s28, 1573120
    s_add_u32 m0, s31, 40960
    s_nop 0
    buffer_load_dwordx4 v6, s[12:15], s21 offen lds
    s_add_u32 m0, s31, 41984
    s_add_u32 s21, s21, 131072
    buffer_load_dwordx4 v6, s[12:15], s21 offen lds
    s_add_u32 m0, s31, 43008
    s_add_u32 s21, s21, 131072
    buffer_load_dwordx4 v6, s[12:15], s21 offen lds
    s_add_u32 m0, s31, 44032
    s_add_u32 s21, s21, 131072
    buffer_load_dwordx4 v6, s[12:15], s21 offen lds
    v_add_u32 v25, 57344, v24
    v_xor_b32 v26, 32, v25
    s_waitcnt vmcnt(33)
    ds_read_b64_tr_b16 a[0:1], v25 offset:0
    ds_read_b64_tr_b16 a[2:3], v25 offset:256
    ds_read_b64_tr_b16 a[72:73], v26 offset:0
    ds_read_b64_tr_b16 a[74:75], v26 offset:256
    ds_read_b64_tr_b16 a[4:5], v25 offset:2048
    ds_read_b64_tr_b16 a[6:7], v25 offset:2304
    ds_read_b64_tr_b16 a[76:77], v26 offset:2048
    ds_read_b64_tr_b16 a[78:79], v26 offset:2304
    s_waitcnt lgkmcnt(0)
    s_add_u32 s21, s28, 2097152
    s_add_u32 m0, s31, 57344
    s_nop 0
    buffer_load_dwordx4 v6, s[12:15], s21 offen lds
    s_add_u32 m0, s31, 58368
    s_add_u32 s21, s21, 131072
    buffer_load_dwordx4 v6, s[12:15], s21 offen lds
    s_add_u32 m0, s31, 59392
    s_add_u32 s21, s21, 131072
    buffer_load_dwordx4 v6, s[12:15], s21 offen lds
    s_add_u32 m0, s31, 60416
    s_add_u32 s21, s21, 131072
    buffer_load_dwordx4 v6, s[12:15], s21 offen lds
    v_add_u32 v25, 73728, v24
    v_xor_b32 v26, 32, v25
    s_waitcnt vmcnt(33)
    ds_read_b64_tr_b16 v[72:73], v25 offset:0
    ds_read_b64_tr_b16 v[74:75], v25 offset:256
    ds_read_b64_tr_b16 v[144:145], v26 offset:0
    ds_read_b64_tr_b16 v[146:147], v26 offset:256
    ds_read_b64_tr_b16 v[76:77], v25 offset:2048
    ds_read_b64_tr_b16 v[78:79], v25 offset:2304
    ds_read_b64_tr_b16 v[148:149], v26 offset:2048
    ds_read_b64_tr_b16 v[150:151], v26 offset:2304
    s_waitcnt lgkmcnt(0)
    s_add_u32 s21, s28, 2097408
    s_add_u32 m0, s31, 73728
    s_nop 0
    buffer_load_dwordx4 v6, s[12:15], s21 offen lds
    s_add_u32 m0, s31, 74752
    s_add_u32 s21, s21, 131072
    buffer_load_dwordx4 v6, s[12:15], s21 offen lds
    s_add_u32 m0, s31, 75776
    s_add_u32 s21, s21, 131072
    buffer_load_dwordx4 v6, s[12:15], s21 offen lds
    s_add_u32 m0, s31, 76800
    s_add_u32 s21, s21, 131072
    buffer_load_dwordx4 v6, s[12:15], s21 offen lds
    v_add_u32 v25, 90112, v24
    v_xor_b32 v26, 32, v25
    s_waitcnt vmcnt(33)
    ds_read_b64_tr_b16 a[8:9], v25 offset:0
    ds_read_b64_tr_b16 a[10:11], v25 offset:256
    ds_read_b64_tr_b16 a[80:81], v26 offset:0
    ds_read_b64_tr_b16 a[82:83], v26 offset:256
    ds_read_b64_tr_b16 a[12:13], v25 offset:2048
    ds_read_b64_tr_b16 a[14:15], v25 offset:2304
    ds_read_b64_tr_b16 a[84:85], v26 offset:2048
    ds_read_b64_tr_b16 a[86:87], v26 offset:2304
    s_waitcnt lgkmcnt(0)
    s_add_u32 s21, s28, 2621440
    s_add_u32 m0, s31, 90112
    s_nop 0
    buffer_load_dwordx4 v6, s[12:15], s21 offen lds
    s_add_u32 m0, s31, 91136
    s_add_u32 s21, s21, 131072
    buffer_load_dwordx4 v6, s[12:15], s21 offen lds
    s_add_u32 m0, s31, 92160
    s_add_u32 s21, s21, 131072
    buffer_load_dwordx4 v6, s[12:15], s21 offen lds
    s_add_u32 m0, s31, 93184
    s_add_u32 s21, s21, 131072
    buffer_load_dwordx4 v6, s[12:15], s21 offen lds
    v_add_u32 v25, 106496, v24
    v_xor_b32 v26, 32, v25
    s_waitcnt vmcnt(33)
    ds_read_b64_tr_b16 v[80:81], v25 offset:0
    ds_read_b64_tr_b16 v[82:83], v25 offset:256
    ds_read_b64_tr_b16 v[152:153], v26 offset:0
    ds_read_b64_tr_b16 v[154:155], v26 offset:256
    ds_read_b64_tr_b16 v[84:85], v25 offset:2048
    ds_read_b64_tr_b16 v[86:87], v25 offset:2304
    ds_read_b64_tr_b16 v[156:157], v26 offset:2048
    ds_read_b64_tr_b16 v[158:159], v26 offset:2304
    s_waitcnt lgkmcnt(0)
    s_add_u32 s21, s28, 2621696
    s_add_u32 m0, s31, 106496
    s_nop 0
    buffer_load_dwordx4 v6, s[12:15], s21 offen lds
    s_add_u32 m0, s31, 107520
    s_add_u32 s21, s21, 131072
    buffer_load_dwordx4 v6, s[12:15], s21 offen lds
    s_add_u32 m0, s31, 108544
    s_add_u32 s21, s21, 131072
    buffer_load_dwordx4 v6, s[12:15], s21 offen lds
    s_add_u32 m0, s31, 109568
    s_add_u32 s21, s21, 131072
    buffer_load_dwordx4 v6, s[12:15], s21 offen lds
    v_add_u32 v25, 122880, v24
    v_xor_b32 v26, 32, v25
    s_waitcnt vmcnt(33)
    ds_read_b64_tr_b16 a[16:17], v25 offset:0
    ds_read_b64_tr_b16 a[18:19], v25 offset:256
    ds_read_b64_tr_b16 a[88:89], v26 offset:0
    ds_read_b64_tr_b16 a[90:91], v26 offset:256
    ds_read_b64_tr_b16 a[20:21], v25 offset:2048
    ds_read_b64_tr_b16 a[22:23], v25 offset:2304
    ds_read_b64_tr_b16 a[92:93], v26 offset:2048
    ds_read_b64_tr_b16 a[94:95], v26 offset:2304
    s_waitcnt lgkmcnt(0)
    s_add_u32 s21, s28, 3145728
    s_add_u32 m0, s31, 122880
    s_nop 0
    buffer_load_dwordx4 v6, s[12:15], s21 offen lds
    s_add_u32 m0, s31, 123904
    s_add_u32 s21, s21, 131072
    buffer_load_dwordx4 v6, s[12:15], s21 offen lds
    s_add_u32 m0, s31, 124928
    s_add_u32 s21, s21, 131072
    buffer_load_dwordx4 v6, s[12:15], s21 offen lds
    s_add_u32 m0, s31, 125952
    s_add_u32 s21, s21, 131072
    buffer_load_dwordx4 v6, s[12:15], s21 offen lds
    v_add_u32 v25, 139264, v24
    v_xor_b32 v26, 32, v25
    s_waitcnt vmcnt(33)
    ds_read_b64_tr_b16 v[88:89], v25 offset:0
    ds_read_b64_tr_b16 v[90:91], v25 offset:256
    ds_read_b64_tr_b16 v[160:161], v26 offset:0
    ds_read_b64_tr_b16 v[162:163], v26 offset:256
    ds_read_b64_tr_b16 v[92:93], v25 offset:2048
    ds_read_b64_tr_b16 v[94:95], v25 offset:2304
    ds_read_b64_tr_b16 v[164:165], v26 offset:2048
    ds_read_b64_tr_b16 v[166:167], v26 offset:2304
    s_waitcnt lgkmcnt(0)
    s_add_u32 s21, s28, 3145984
    s_add_u32 m0, s31, 139264
    s_nop 0
    buffer_load_dwordx4 v6, s[12:15], s21 offen lds
    s_add_u32 m0, s31, 140288
    s_add_u32 s21, s21, 131072
    buffer_load_dwordx4 v6, s[12:15], s21 offen lds
    s_add_u32 m0, s31, 141312
    s_add_u32 s21, s21, 131072
    buffer_load_dwordx4 v6, s[12:15], s21 offen lds
    s_add_u32 m0, s31, 142336
    s_add_u32 s21, s21, 131072
    buffer_load_dwordx4 v6, s[12:15], s21 offen lds
    v_add_u32 v25, 40960, v24
    v_xor_b32 v26, 32, v25
    s_waitcnt vmcnt(24)
    ds_read_b64_tr_b16 a[24:25], v25 offset:0
    ds_read_b64_tr_b16 a[26:27], v25 offset:256
    ds_read_b64_tr_b16 a[96:97], v26 offset:0
    ds_read_b64_tr_b16 a[98:99], v26 offset:256
    ds_read_b64_tr_b16 a[28:29], v25 offset:2048
    ds_read_b64_tr_b16 a[30:31], v25 offset:2304
    ds_read_b64_tr_b16 a[100:101], v26 offset:2048
    ds_read_b64_tr_b16 a[102:103], v26 offset:2304
    s_waitcnt lgkmcnt(0)
    s_add_u32 s21, s28, 3670016
    s_add_u32 m0, s31, 40960
    s_nop 0
    buffer_load_dwordx4 v6, s[12:15], s21 offen lds
    s_add_u32 m0, s31, 41984
    s_add_u32 s21, s21, 131072
    buffer_load_dwordx4 v6, s[12:15], s21 offen lds
    s_add_u32 m0, s31, 43008
    s_add_u32 s21, s21, 131072
    buffer_load_dwordx4 v6, s[12:15], s21 offen lds
    s_add_u32 m0, s31, 44032
    s_add_u32 s21, s21, 131072
    buffer_load_dwordx4 v6, s[12:15], s21 offen lds
    v_add_u32 v25, 57344, v24
    v_xor_b32 v26, 32, v25
    s_waitcnt vmcnt(24)
    ds_read_b64_tr_b16 v[96:97], v25 offset:0
    ds_read_b64_tr_b16 v[98:99], v25 offset:256
    ds_read_b64_tr_b16 v[168:169], v26 offset:0
    ds_read_b64_tr_b16 v[170:171], v26 offset:256
    ds_read_b64_tr_b16 v[100:101], v25 offset:2048
    ds_read_b64_tr_b16 v[102:103], v25 offset:2304
    ds_read_b64_tr_b16 v[172:173], v26 offset:2048
    ds_read_b64_tr_b16 v[174:175], v26 offset:2304
    s_waitcnt lgkmcnt(0)
    s_add_u32 s21, s28, 3670272
    s_add_u32 m0, s31, 57344
    s_nop 0
    buffer_load_dwordx4 v6, s[12:15], s21 offen lds
    s_add_u32 m0, s31, 58368
    s_add_u32 s21, s21, 131072
    buffer_load_dwordx4 v6, s[12:15], s21 offen lds
    s_add_u32 m0, s31, 59392
    s_add_u32 s21, s21, 131072
    buffer_load_dwordx4 v6, s[12:15], s21 offen lds
    s_add_u32 m0, s31, 60416
    s_add_u32 s21, s21, 131072
    buffer_load_dwordx4 v6, s[12:15], s21 offen lds
    v_add_u32 v25, 73728, v24
    v_xor_b32 v26, 32, v25
    s_waitcnt vmcnt(24)
    ds_read_b64_tr_b16 a[32:33], v25 offset:0
    ds_read_b64_tr_b16 a[34:35], v25 offset:256
    ds_read_b64_tr_b16 a[104:105], v26 offset:0
    ds_read_b64_tr_b16 a[106:107], v26 offset:256
    ds_read_b64_tr_b16 a[36:37], v25 offset:2048
    ds_read_b64_tr_b16 a[38:39], v25 offset:2304
    ds_read_b64_tr_b16 a[108:109], v26 offset:2048
    ds_read_b64_tr_b16 a[110:111], v26 offset:2304
    s_waitcnt lgkmcnt(0)
    s_add_u32 s21, s28, 4194304
    s_add_u32 m0, s31, 73728
    s_nop 0
    buffer_load_dwordx4 v6, s[12:15], s21 offen lds
    s_add_u32 m0, s31, 74752
    s_add_u32 s21, s21, 131072
    buffer_load_dwordx4 v6, s[12:15], s21 offen lds
    s_add_u32 m0, s31, 75776
    s_add_u32 s21, s21, 131072
    buffer_load_dwordx4 v6, s[12:15], s21 offen lds
    s_add_u32 m0, s31, 76800
    s_add_u32 s21, s21, 131072
    buffer_load_dwordx4 v6, s[12:15], s21 offen lds
    v_add_u32 v25, 90112, v24
    v_xor_b32 v26, 32, v25
    s_waitcnt vmcnt(24)
    ds_read_b64_tr_b16 v[104:105], v25 offset:0
    ds_read_b64_tr_b16 v[106:107], v25 offset:256
    ds_read_b64_tr_b16 v[176:177], v26 offset:0
    ds_read_b64_tr_b16 v[178:179], v26 offset:256
    ds_read_b64_tr_b16 v[108:109], v25 offset:2048
    ds_read_b64_tr_b16 v[110:111], v25 offset:2304
    ds_read_b64_tr_b16 v[180:181], v26 offset:2048
    ds_read_b64_tr_b16 v[182:183], v26 offset:2304
    s_waitcnt lgkmcnt(0)
    v_mov_b32 v28, s95
    s_cmp_lg_u32 s95, 0
    s_cbranch_scc1 L_ne
    buffer_load_dword v28, off, s[96:99], 0 offset:64 sc1
    s_cmp_ge_u32 s36, 192
    s_cbranch_scc1 L_ne
    s_mul_i32 s37, s36, 24576
    s_mov_b32 s46, 4718592
    s_mov_b32 s47, 0x20000
    v_lshlrev_b32 v29, 7, v0
    v_min_u32 v29, 24448, v29
    s_mov_b64 s[44:45], s[58:59]
    buffer_load_dword v30, v29, s[44:47], s37 offen
    s_mov_b64 s[44:45], s[52:53]
    buffer_load_dword v30, v29, s[44:47], s37 offen
L_ne:
    s_add_u32 s21, s28, 4194560
    s_add_u32 m0, s31, 90112
    s_nop 0
    buffer_load_dwordx4 v6, s[12:15], s21 offen lds
    s_add_u32 m0, s31, 91136
    s_add_u32 s21, s21, 131072
    buffer_load_dwordx4 v6, s[12:15], s21 offen lds
    s_add_u32 m0, s31, 92160
    s_add_u32 s21, s21, 131072
    buffer_load_dwordx4 v6, s[12:15], s21 offen lds
    s_add_u32 m0, s31, 93184
    s_add_u32 s21, s21, 131072
    buffer_load_dwordx4 v6, s[12:15], s21 offen lds
    v_add_u32 v25, 106496, v24
    v_xor_b32 v26, 32, v25
    s_waitcnt vmcnt(24)
    ds_read_b64_tr_b16 a[40:41], v25 offset:0
    ds_read_b64_tr_b16 a[42:43], v25 offset:256
    ds_read_b64_tr_b16 a[112:113], v26 offset:0
    ds_read_b64_tr_b16 a[114:115], v26 offset:256
    ds_read_b64_tr_b16 a[44:45], v25 offset:2048
    ds_read_b64_tr_b16 a[46:47], v25 offset:2304
    ds_read_b64_tr_b16 a[116:117], v26 offset:2048
    ds_read_b64_tr_b16 a[118:119], v26 offset:2304
    s_waitcnt lgkmcnt(0)
    v_add_u32 v25, 122880, v24
    v_xor_b32 v26, 32, v25
    s_waitcnt vmcnt(20)
    ds_read_b64_tr_b16 v[112:113], v25 offset:0
    ds_read_b64_tr_b16 v[114:115], v25 offset:256
    ds_read_b64_tr_b16 v[184:185], v26 offset:0
    ds_read_b64_tr_b16 v[186:187], v26 offset:256
    ds_read_b64_tr_b16 v[116:117], v25 offset:2048
    ds_read_b64_tr_b16 v[118:119], v25 offset:2304
    ds_read_b64_tr_b16 v[188:189], v26 offset:2048
    ds_read_b64_tr_b16 v[190:191], v26 offset:2304
    s_waitcnt lgkmcnt(0)
    v_add_u32 v25, 139264, v24
    v_xor_b32 v26, 32, v25
    s_waitcnt vmcnt(16)
    ds_read_b64_tr_b16 a[48:49], v25 offset:0
    ds_read_b64_tr_b16 a[50:51], v25 offset:256
    ds_read_b64_tr_b16 a[120:121], v26 offset:0
    ds_read_b64_tr_b16 a[122:123], v26 offset:256
    ds_read_b64_tr_b16 a[52:53], v25 offset:2048
    ds_read_b64_tr_b16 a[54:55], v25 offset:2304
    ds_read_b64_tr_b16 a[124:125], v26 offset:2048
    ds_read_b64_tr_b16 a[126:127], v26 offset:2304
    s_waitcnt lgkmcnt(0)
    v_add_u32 v25, 40960, v24
    v_xor_b32 v26, 32, v25
    s_waitcnt vmcnt(12)
    ds_read_b64_tr_b16 v[120:121], v25 offset:0
    ds_read_b64_tr_b16 v[122:123], v25 offset:256
    ds_read_b64_tr_b16 v[192:193], v26 offset:0
    ds_read_b64_tr_b16 v[194:195], v26 offset:256
    ds_read_b64_tr_b16 v[124:125], v25 offset:2048
    ds_read_b64_tr_b16 v[126:127], v25 offset:2304
    ds_read_b64_tr_b16 v[196:197], v26 offset:2048
    ds_read_b64_tr_b16 v[198:199], v26 offset:2304
    s_waitcnt lgkmcnt(0)
    v_add_u32 v25, 57344, v24
    v_xor_b32 v26, 32, v25
    s_waitcnt vmcnt(8)
    ds_read_b64_tr_b16 a[56:57], v25 offset:0
    ds_read_b64_tr_b16 a[58:59], v25 offset:256
    ds_read_b64_tr_b16 a[128:129], v26 offset:0
    ds_read_b64_tr_b16 a[130:131], v26 offset:256
    ds_read_b64_tr_b16 a[60:61], v25 offset:2048
    ds_read_b64_tr_b16 a[62:63], v25 offset:2304
    ds_read_b64_tr_b16 a[132:133], v26 offset:2048
    ds_read_b64_tr_b16 a[134:135], v26 offset:2304
    s_waitcnt lgkmcnt(0)
    v_add_u32 v25, 73728, v24
    v_xor_b32 v26, 32, v25
    s_waitcnt vmcnt(4)
    ds_read_b64_tr_b16 v[128:129], v25 offset:0
    ds_read_b64_tr_b16 v[130:131], v25 offset:256
    ds_read_b64_tr_b16 v[200:201], v26 offset:0
    ds_read_b64_tr_b16 v[202:203], v26 offset:256
    ds_read_b64_tr_b16 v[132:133], v25 offset:2048
    ds_read_b64_tr_b16 v[134:135], v25 offset:2304
    ds_read_b64_tr_b16 v[204:205], v26 offset:2048
    ds_read_b64_tr_b16 v[206:207], v26 offset:2304
    s_waitcnt lgkmcnt(0)
    v_add_u32 v25, 90112, v24
    v_xor_b32 v26, 32, v25
    s_waitcnt vmcnt(0)
    ds_read_b64_tr_b16 a[64:65], v25 offset:0
    ds_read_b64_tr_b16 a[66:67], v25 offset:256
    ds_read_b64_tr_b16 a[136:137], v26 offset:0
    ds_read_b64_tr_b16 a[138:139], v26 offset:256
    ds_read_b64_tr_b16 a[68:69], v25 offset:2048
    ds_read_b64_tr_b16 a[70:71], v25 offset:2304
    ds_read_b64_tr_b16 a[140:141], v26 offset:2048
    ds_read_b64_tr_b16 a[142:143], v26 offset:2304
    s_waitcnt lgkmcnt(0)
    s_lshr_b32 s21, s17, 3
    s_cmp_eq_u32 s21, 3
    s_cselect_b32 s21, 1, s33
    s_cmp_lg_u32 s21, 0
    s_cbranch_scc1 qk_noclr
    v_mov_b32 v8, -1
    v_mov_b32 v9, -1
    v_mov_b32 v10, -1
    v_mov_b32 v11, -1
    v_lshrrev_b32 v25, 6, v0
    v_mul_u32_u24 v25, 11264, v25
    v_add_u32 v25, v25, v7
    s_lshl_b32 s21, s17, 9
    s_add_u32 s21, s21, 90177536
    s_add_u32 s22, s21, 786432
qk_clr:
    buffer_store_dwordx4 v[8:11], v25, s[4:7], s21 offen sc1
    s_add_u32 s21, s21, 49152
    s_cmp_lt_u32 s21, s22
    s_cbranch_scc1 qk_clr
qk_noclr:
    s_cmp_ge_u32 s33, 6
    s_cbranch_scc1 qk_noclr2
    v_mov_b32 v8, -1
    v_mov_b32 v9, -1
    v_mov_b32 v10, -1
    v_mov_b32 v11, -1
    s_cmp_lt_u32 s33, 4
    s_cselect_b32 s21, 60, 54
    s_add_u32 s21, s21, s33
    s_lshl_b32 s23, s17, 12
    s_lshl_b32 s22, s21, 17
    s_add_u32 s22, s22, s23
    s_add_u32 s22, s22, 71303168
    buffer_store_dwordx4 v[8:11], v7, s[4:7], s22 offen sc1
    s_add_u32 s22, s22, 4096
    buffer_store_dwordx4 v[8:11], v7, s[4:7], s22 offen sc1
    s_lshl_b32 s22, s21, 17
    s_add_u32 s22, s22, s23
    s_add_u32 s22, s22, 80740352
    buffer_store_dwordx4 v[8:11], v7, s[4:7], s22 offen sc1
    s_add_u32 s22, s22, 4096
    buffer_store_dwordx4 v[8:11], v7, s[4:7], s22 offen sc1
    s_lshl_b32 s22, s21, 18
    s_add_u32 s22, s22, s23
    s_add_u32 s22, s22, 50331648
    buffer_store_dwordx4 v[8:11], v7, s[4:7], s22 offen sc1
    s_add_u32 s22, s22, 4096
    buffer_store_dwordx4 v[8:11], v7, s[4:7], s22 offen sc1
    s_lshl_b32 s22, s21, 18
    s_add_u32 s22, s22, s23
    s_add_u32 s22, s22, 50462720
    buffer_store_dwordx4 v[8:11], v7, s[4:7], s22 offen sc1
    s_add_u32 s22, s22, 4096
    buffer_store_dwordx4 v[8:11], v7, s[4:7], s22 offen sc1
qk_noclr2:
    v_readfirstlane_b32 s95, v28
    s_nop 4
    s_mov_b32 s88, 4194304
gn7:
    s_cmp_lg_u32 s95, 0
    s_cbranch_scc1 gn7x
    buffer_load_dword v25, off, s[96:99], 0 offset:64 sc1
    s_sub_u32 s88, s88, 1
    s_cbranch_scc1 gn7x
    s_waitcnt vmcnt(0)
    v_readfirstlane_b32 s95, v25
    s_nop 1
    s_branch gn7
gn7x:
    s_barrier
    s_mov_b32 s27, 36864
    s_add_u32 s23, s27, s25
    s_add_u32 m0, s23, 0
    s_nop 0
    buffer_load_dwordx4 v2, s[8:11], s24 offen offset:0 lds
    s_add_u32 m0, s23, 960
    s_nop 0
    buffer_load_dwordx4 v2, s[8:11], s24 offen offset:64 lds
    s_add_u32 m0, s23, 1920
    s_nop 0
    buffer_load_dwordx4 v2, s[8:11], s24 offen offset:128 lds
    s_add_u32 m0, s23, 2880
    s_nop 0
    buffer_load_dwordx4 v2, s[8:11], s24 offen offset:192 lds
    s_add_u32 m0, s23, 3840
    s_nop 0
    buffer_load_dwordx4 v2, s[8:11], s24 offen offset:256 lds
    s_add_u32 m0, s23, 4800
    s_nop 0
    buffer_load_dwordx4 v2, s[8:11], s24 offen offset:320 lds
    s_add_u32 m0, s23, 5760
    s_nop 0
    buffer_load_dwordx4 v2, s[8:11], s24 offen offset:384 lds
    s_add_u32 m0, s23, 6720
    s_nop 0
    buffer_load_dwordx4 v2, s[8:11], s24 offen offset:448 lds
    s_add_u32 m0, s23, 7680
    s_nop 0
    buffer_load_dwordx4 v2, s[8:11], s24 offen offset:512 lds
    s_add_u32 s24, s24, s42
    s_mov_b32 s27, 0
    s_mov_b32 s30, s95
    s_cmp_eq_u32 s18, 0
    s_cselect_b32 s34, 1, 0
    s_mov_b32 s35, 0
    s_mov_b32 s31, 0x80000000
    v_mov_b32 v3, v1
    ds_read_b128 v[32:35], v3 offset:0
    ds_read_b128 v[36:39], v3 offset:18432
    ds_read_b128 v[40:43], v3 offset:1024
    ds_read_b128 v[44:47], v3 offset:19456
    s_cmp_eq_u32 s16, 2
    s_cbranch_scc1 qk_vloop
qk_loop:
    s_add_u32 s22, s27, 73728
    s_sub_u32 s21, s22, 147456
    s_cselect_b32 s22, s22, s21
    s_add_u32 s27, s27, 36864
    s_cmp_eq_u32 s27, 147456
    s_cselect_b32 s27, 0, s27
    s_waitcnt lgkmcnt(2)
    v_cvt_pk_bf16_f32 v8, v208, v209
    v_cvt_pk_bf16_f32 v9, v210, v211
    v_mfma_f32_16x16x32_bf16 v[208:211], v[64:67], v[32:35], 0
    ds_read_b128 v[48:51], v3 offset:2048
    ds_read_b128 v[52:55], v3 offset:20480
    v_cvt_pk_bf16_f32 v10, v212, v213
    v_cvt_pk_bf16_f32 v11, v214, v215
    v_mfma_f32_16x16x32_bf16 v[212:215], v[136:139], v[32:35], 0
    v_cvt_pk_bf16_f32 v12, v216, v217
    v_cvt_pk_bf16_f32 v13, v218, v219
    v_mfma_f32_16x16x32_bf16 v[216:219], v[64:67], v[36:39], 0
    v_cvt_pk_bf16_f32 v14, v220, v221
    v_cvt_pk_bf16_f32 v15, v222, v223
    v_mfma_f32_16x16x32_bf16 v[220:223], v[136:139], v[36:39], 0
    v_cvt_pk_bf16_f32 v16, v224, v225
    v_cvt_pk_bf16_f32 v17, v226, v227
    v_mfma_f32_16x16x32_bf16 v[224:227], a[0:3], v[32:35], 0
    v_cvt_pk_bf16_f32 v18, v228, v229
    v_cvt_pk_bf16_f32 v19, v230, v231
    v_mfma_f32_16x16x32_bf16 v[228:231], a[72:75], v[32:35], 0
    v_cvt_pk_bf16_f32 v20, v232, v233
    v_cvt_pk_bf16_f32 v21, v234, v235
    v_mfma_f32_16x16x32_bf16 v[232:235], a[0:3], v[36:39], 0
    v_cvt_pk_bf16_f32 v22, v236, v237
    v_cvt_pk_bf16_f32 v23, v238, v239
    v_mfma_f32_16x16x32_bf16 v[236:239], a[72:75], v[36:39], 0
    s_waitcnt lgkmcnt(2)
    v_mfma_f32_16x16x32_bf16 v[208:211], v[68:71], v[40:43], v[208:211]
    ds_read_b128 v[32:35], v3 offset:3072
    ds_read_b128 v[36:39], v3 offset:21504
    v_mfma_f32_16x16x32_bf16 v[212:215], v[140:143], v[40:43], v[212:215]
    v_mfma_f32_16x16x32_bf16 v[216:219], v[68:71], v[44:47], v[216:219]
    s_mov_b32 s28, s31
    buffer_store_dwordx4 v[8:11], v7, s[4:7], s28 offen sc1
    v_mfma_f32_16x16x32_bf16 v[220:223], v[140:143], v[44:47], v[220:223]
    v_mfma_f32_16x16x32_bf16 v[224:227], a[4:7], v[40:43], v[224:227]
    v_mfma_f32_16x16x32_bf16 v[228:231], a[76:79], v[40:43], v[228:231]
    v_mfma_f32_16x16x32_bf16 v[232:235], a[4:7], v[44:47], v[232:235]
    v_mfma_f32_16x16x32_bf16 v[236:239], a[76:79], v[44:47], v[236:239]
    s_waitcnt lgkmcnt(2)
    v_mfma_f32_16x16x32_bf16 v[208:211], v[72:75], v[48:51], v[208:211]
    ds_read_b128 v[40:43], v3 offset:4096
    ds_read_b128 v[44:47], v3 offset:22528
    v_mfma_f32_16x16x32_bf16 v[212:215], v[144:147], v[48:51], v[212:215]
    v_mfma_f32_16x16x32_bf16 v[216:219], v[72:75], v[52:55], v[216:219]
    s_add_u32 s28, s28, s40
    buffer_store_dwordx4 v[12:15], v7, s[4:7], s28 offen sc1
    v_mfma_f32_16x16x32_bf16 v[220:223], v[144:147], v[52:55], v[220:223]
    v_mfma_f32_16x16x32_bf16 v[224:227], a[8:11], v[48:51], v[224:227]
    v_mfma_f32_16x16x32_bf16 v[228:231], a[80:83], v[48:51], v[228:231]
    v_mfma_f32_16x16x32_bf16 v[232:235], a[8:11], v[52:55], v[232:235]
    v_mfma_f32_16x16x32_bf16 v[236:239], a[80:83], v[52:55], v[236:239]
    s_waitcnt lgkmcnt(2)
    v_mfma_f32_16x16x32_bf16 v[208:211], v[76:79], v[32:35], v[208:211]
    ds_read_b128 v[48:51], v3 offset:5120
    ds_read_b128 v[52:55], v3 offset:23552
    v_mfma_f32_16x16x32_bf16 v[212:215], v[148:151], v[32:35], v[212:215]
    v_mfma_f32_16x16x32_bf16 v[216:219], v[76:79], v[36:39], v[216:219]
    s_add_u32 s28, s31, s43
    buffer_store_dwordx4 v[16:19], v7, s[4:7], s28 offen sc1
    v_mfma_f32_16x16x32_bf16 v[220:223], v[148:151], v[36:39], v[220:223]
    v_mfma_f32_16x16x32_bf16 v[224:227], a[12:15], v[32:35], v[224:227]
    v_mfma_f32_16x16x32_bf16 v[228:231], a[84:87], v[32:35], v[228:231]
    v_mfma_f32_16x16x32_bf16 v[232:235], a[12:15], v[36:39], v[232:235]
    v_mfma_f32_16x16x32_bf16 v[236:239], a[84:87], v[36:39], v[236:239]
    s_waitcnt lgkmcnt(2)
    v_mfma_f32_16x16x32_bf16 v[208:211], v[80:83], v[40:43], v[208:211]
    ds_read_b128 v[32:35], v3 offset:6144
    ds_read_b128 v[36:39], v3 offset:24576
    v_mfma_f32_16x16x32_bf16 v[212:215], v[152:155], v[40:43], v[212:215]
    v_mfma_f32_16x16x32_bf16 v[216:219], v[80:83], v[44:47], v[216:219]
    s_add_u32 s28, s28, s40
    buffer_store_dwordx4 v[20:23], v7, s[4:7], s28 offen sc1
    v_mfma_f32_16x16x32_bf16 v[220:223], v[152:155], v[44:47], v[220:223]
    v_mfma_f32_16x16x32_bf16 v[224:227], a[16:19], v[40:43], v[224:227]
    v_mfma_f32_16x16x32_bf16 v[228:231], a[88:91], v[40:43], v[228:231]
    v_mfma_f32_16x16x32_bf16 v[232:235], a[16:19], v[44:47], v[232:235]
    v_mfma_f32_16x16x32_bf16 v[236:239], a[88:91], v[44:47], v[236:239]
    s_waitcnt lgkmcnt(2)
    v_mfma_f32_16x16x32_bf16 v[208:211], v[84:87], v[48:51], v[208:211]
    ds_read_b128 v[40:43], v3 offset:7168
    ds_read_b128 v[44:47], v3 offset:25600
    v_mfma_f32_16x16x32_bf16 v[212:215], v[156:159], v[48:51], v[212:215]
    v_mfma_f32_16x16x32_bf16 v[216:219], v[84:87], v[52:55], v[216:219]
    s_add_u32 s23, s22, s25
    s_add_u32 m0, s23, 0
    s_nop 0
    buffer_load_dwordx4 v2, s[8:11], s24 offen offset:0 lds
    v_mfma_f32_16x16x32_bf16 v[220:223], v[156:159], v[52:55], v[220:223]
    v_mfma_f32_16x16x32_bf16 v[224:227], a[20:23], v[48:51], v[224:227]
    v_mfma_f32_16x16x32_bf16 v[228:231], a[92:95], v[48:51], v[228:231]
    v_mfma_f32_16x16x32_bf16 v[232:235], a[20:23], v[52:55], v[232:235]
    v_mfma_f32_16x16x32_bf16 v[236:239], a[92:95], v[52:55], v[236:239]
    s_waitcnt lgkmcnt(2)
    v_mfma_f32_16x16x32_bf16 v[208:211], v[88:91], v[32:35], v[208:211]
    ds_read_b128 v[48:51], v3 offset:8192
    ds_read_b128 v[52:55], v3 offset:26624
    v_mfma_f32_16x16x32_bf16 v[212:215], v[160:163], v[32:35], v[212:215]
    v_mfma_f32_16x16x32_bf16 v[216:219], v[88:91], v[36:39], v[216:219]
    s_add_u32 m0, s23, 960
    s_nop 0
    buffer_load_dwordx4 v2, s[8:11], s24 offen offset:64 lds
    v_mfma_f32_16x16x32_bf16 v[220:223], v[160:163], v[36:39], v[220:223]
    v_mfma_f32_16x16x32_bf16 v[224:227], a[24:27], v[32:35], v[224:227]
    v_mfma_f32_16x16x32_bf16 v[228:231], a[96:99], v[32:35], v[228:231]
    v_mfma_f32_16x16x32_bf16 v[232:235], a[24:27], v[36:39], v[232:235]
    v_mfma_f32_16x16x32_bf16 v[236:239], a[96:99], v[36:39], v[236:239]
    s_waitcnt lgkmcnt(2)
    v_mfma_f32_16x16x32_bf16 v[208:211], v[92:95], v[40:43], v[208:211]
    ds_read_b128 v[32:35], v3 offset:9216
    ds_read_b128 v[36:39], v3 offset:27648
    v_mfma_f32_16x16x32_bf16 v[212:215], v[164:167], v[40:43], v[212:215]
    v_mfma_f32_16x16x32_bf16 v[216:219], v[92:95], v[44:47], v[216:219]
    s_add_u32 m0, s23, 1920
    s_nop 0
    buffer_load_dwordx4 v2, s[8:11], s24 offen offset:128 lds
    v_mfma_f32_16x16x32_bf16 v[220:223], v[164:167], v[44:47], v[220:223]
    v_mfma_f32_16x16x32_bf16 v[224:227], a[28:31], v[40:43], v[224:227]
    v_mfma_f32_16x16x32_bf16 v[228:231], a[100:103], v[40:43], v[228:231]
    v_mfma_f32_16x16x32_bf16 v[232:235], a[28:31], v[44:47], v[232:235]
    v_mfma_f32_16x16x32_bf16 v[236:239], a[100:103], v[44:47], v[236:239]
    s_waitcnt lgkmcnt(2)
    v_mfma_f32_16x16x32_bf16 v[208:211], v[96:99], v[48:51], v[208:211]
    ds_read_b128 v[40:43], v3 offset:10240
    ds_read_b128 v[44:47], v3 offset:28672
    v_mfma_f32_16x16x32_bf16 v[212:215], v[168:171], v[48:51], v[212:215]
    v_mfma_f32_16x16x32_bf16 v[216:219], v[96:99], v[52:55], v[216:219]
    s_add_u32 m0, s23, 2880
    s_nop 0
    buffer_load_dwordx4 v2, s[8:11], s24 offen offset:192 lds
    v_mfma_f32_16x16x32_bf16 v[220:223], v[168:171], v[52:55], v[220:223]
    v_mfma_f32_16x16x32_bf16 v[224:227], a[32:35], v[48:51], v[224:227]
    v_mfma_f32_16x16x32_bf16 v[228:231], a[104:107], v[48:51], v[228:231]
    v_mfma_f32_16x16x32_bf16 v[232:235], a[32:35], v[52:55], v[232:235]
    v_mfma_f32_16x16x32_bf16 v[236:239], a[104:107], v[52:55], v[236:239]
    s_waitcnt lgkmcnt(2)
    v_mfma_f32_16x16x32_bf16 v[208:211], v[100:103], v[32:35], v[208:211]
    ds_read_b128 v[48:51], v3 offset:11264
    ds_read_b128 v[52:55], v3 offset:29696
    v_mfma_f32_16x16x32_bf16 v[212:215], v[172:175], v[32:35], v[212:215]
    v_mfma_f32_16x16x32_bf16 v[216:219], v[100:103], v[36:39], v[216:219]
    s_add_u32 m0, s23, 3840
    s_nop 0
    buffer_load_dwordx4 v2, s[8:11], s24 offen offset:256 lds
    v_mfma_f32_16x16x32_bf16 v[220:223], v[172:175], v[36:39], v[220:223]
    v_mfma_f32_16x16x32_bf16 v[224:227], a[36:39], v[32:35], v[224:227]
    v_mfma_f32_16x16x32_bf16 v[228:231], a[108:111], v[32:35], v[228:231]
    v_mfma_f32_16x16x32_bf16 v[232:235], a[36:39], v[36:39], v[232:235]
    v_mfma_f32_16x16x32_bf16 v[236:239], a[108:111], v[36:39], v[236:239]
    s_waitcnt lgkmcnt(2)
    v_mfma_f32_16x16x32_bf16 v[208:211], v[104:107], v[40:43], v[208:211]
    ds_read_b128 v[32:35], v3 offset:12288
    ds_read_b128 v[36:39], v3 offset:30720
    v_mfma_f32_16x16x32_bf16 v[212:215], v[176:179], v[40:43], v[212:215]
    v_mfma_f32_16x16x32_bf16 v[216:219], v[104:107], v[44:47], v[216:219]
    s_add_u32 m0, s23, 4800
    s_nop 0
    buffer_load_dwordx4 v2, s[8:11], s24 offen offset:320 lds
    v_mfma_f32_16x16x32_bf16 v[220:223], v[176:179], v[44:47], v[220:223]
    v_mfma_f32_16x16x32_bf16 v[224:227], a[40:43], v[40:43], v[224:227]
    v_mfma_f32_16x16x32_bf16 v[228:231], a[112:115], v[40:43], v[228:231]
    v_mfma_f32_16x16x32_bf16 v[232:235], a[40:43], v[44:47], v[232:235]
    v_mfma_f32_16x16x32_bf16 v[236:239], a[112:115], v[44:47], v[236:239]
    s_waitcnt lgkmcnt(2)
    v_mfma_f32_16x16x32_bf16 v[208:211], v[108:111], v[48:51], v[208:211]
    ds_read_b128 v[40:43], v3 offset:13312
    ds_read_b128 v[44:47], v3 offset:31744
    v_mfma_f32_16x16x32_bf16 v[212:215], v[180:183], v[48:51], v[212:215]
    v_mfma_f32_16x16x32_bf16 v[216:219], v[108:111], v[52:55], v[216:219]
    s_add_u32 m0, s23, 5760
    s_nop 0
    buffer_load_dwordx4 v2, s[8:11], s24 offen offset:384 lds
    v_mfma_f32_16x16x32_bf16 v[220:223], v[180:183], v[52:55], v[220:223]
    v_mfma_f32_16x16x32_bf16 v[224:227], a[44:47], v[48:51], v[224:227]
    v_mfma_f32_16x16x32_bf16 v[228:231], a[116:119], v[48:51], v[228:231]
    v_mfma_f32_16x16x32_bf16 v[232:235], a[44:47], v[52:55], v[232:235]
    v_mfma_f32_16x16x32_bf16 v[236:239], a[116:119], v[52:55], v[236:239]
    s_waitcnt lgkmcnt(2)
    v_mfma_f32_16x16x32_bf16 v[208:211], v[112:115], v[32:35], v[208:211]
    ds_read_b128 v[48:51], v3 offset:14336
    ds_read_b128 v[52:55], v3 offset:32768
    v_mfma_f32_16x16x32_bf16 v[212:215], v[184:187], v[32:35], v[212:215]
    v_mfma_f32_16x16x32_bf16 v[216:219], v[112:115], v[36:39], v[216:219]
    s_add_u32 m0, s23, 6720
    s_nop 0
    buffer_load_dwordx4 v2, s[8:11], s24 offen offset:448 lds
    v_mfma_f32_16x16x32_bf16 v[220:223], v[184:187], v[36:39], v[220:223]
    v_mfma_f32_16x16x32_bf16 v[224:227], a[48:51], v[32:35], v[224:227]
    v_mfma_f32_16x16x32_bf16 v[228:231], a[120:123], v[32:35], v[228:231]
    v_mfma_f32_16x16x32_bf16 v[232:235], a[48:51], v[36:39], v[232:235]
    v_mfma_f32_16x16x32_bf16 v[236:239], a[120:123], v[36:39], v[236:239]
    s_waitcnt lgkmcnt(2)
    v_mfma_f32_16x16x32_bf16 v[208:211], v[116:119], v[40:43], v[208:211]
    ds_read_b128 v[32:35], v3 offset:15360
    ds_read_b128 v[36:39], v3 offset:33792
    v_mfma_f32_16x16x32_bf16 v[212:215], v[188:191], v[40:43], v[212:215]
    v_mfma_f32_16x16x32_bf16 v[216:219], v[116:119], v[44:47], v[216:219]
    s_add_u32 m0, s23, 7680
    s_nop 0
    buffer_load_dwordx4 v2, s[8:11], s24 offen offset:512 lds
    s_add_u32 s24, s24, s42
    v_mfma_f32_16x16x32_bf16 v[220:223], v[188:191], v[44:47], v[220:223]
    v_mfma_f32_16x16x32_bf16 v[224:227], a[52:55], v[40:43], v[224:227]
    v_mfma_f32_16x16x32_bf16 v[228:231], a[124:127], v[40:43], v[228:231]
    v_mfma_f32_16x16x32_bf16 v[232:235], a[52:55], v[44:47], v[232:235]
    v_mfma_f32_16x16x32_bf16 v[236:239], a[124:127], v[44:47], v[236:239]
    s_waitcnt lgkmcnt(2)
    v_mfma_f32_16x16x32_bf16 v[208:211], v[120:123], v[48:51], v[208:211]
    ds_read_b128 v[40:43], v3 offset:16384
    ds_read_b128 v[44:47], v3 offset:34816
    v_mfma_f32_16x16x32_bf16 v[212:215], v[192:195], v[48:51], v[212:215]
    v_mfma_f32_16x16x32_bf16 v[216:219], v[120:123], v[52:55], v[216:219]
    v_add_u32 v24, s27, v1
    v_mfma_f32_16x16x32_bf16 v[220:223], v[192:195], v[52:55], v[220:223]
    v_mfma_f32_16x16x32_bf16 v[224:227], a[56:59], v[48:51], v[224:227]
    v_mfma_f32_16x16x32_bf16 v[228:231], a[128:131], v[48:51], v[228:231]
    v_mfma_f32_16x16x32_bf16 v[232:235], a[56:59], v[52:55], v[232:235]
    v_mfma_f32_16x16x32_bf16 v[236:239], a[128:131], v[52:55], v[236:239]
    s_waitcnt lgkmcnt(2)
    v_mfma_f32_16x16x32_bf16 v[208:211], v[124:127], v[32:35], v[208:211]
    ds_read_b128 v[48:51], v3 offset:17408
    ds_read_b128 v[52:55], v3 offset:35840
    v_mfma_f32_16x16x32_bf16 v[212:215], v[196:199], v[32:35], v[212:215]
    v_mfma_f32_16x16x32_bf16 v[216:219], v[124:127], v[36:39], v[216:219]
    v_mfma_f32_16x16x32_bf16 v[220:223], v[196:199], v[36:39], v[220:223]
    v_mfma_f32_16x16x32_bf16 v[224:227], a[60:63], v[32:35], v[224:227]
    v_mfma_f32_16x16x32_bf16 v[228:231], a[132:135], v[32:35], v[228:231]
    s_waitcnt vmcnt(9)
    s_barrier
    v_mfma_f32_16x16x32_bf16 v[232:235], a[60:63], v[36:39], v[232:235]
    v_mfma_f32_16x16x32_bf16 v[236:239], a[132:135], v[36:39], v[236:239]
    s_waitcnt lgkmcnt(2)
    v_mfma_f32_16x16x32_bf16 v[208:211], v[128:131], v[40:43], v[208:211]
    ds_read_b128 v[32:35], v24 offset:0
    ds_read_b128 v[36:39], v24 offset:18432
    v_mfma_f32_16x16x32_bf16 v[212:215], v[200:203], v[40:43], v[212:215]
    v_mfma_f32_16x16x32_bf16 v[216:219], v[128:131], v[44:47], v[216:219]
    v_mov_b32 v4, s30
    s_mov_b64 exec, s[34:35]
    buffer_store_dword v4, off, s[4:7], s29 sc1
    s_mov_b64 exec, -1
    v_mfma_f32_16x16x32_bf16 v[220:223], v[200:203], v[44:47], v[220:223]
    v_mfma_f32_16x16x32_bf16 v[224:227], a[64:67], v[40:43], v[224:227]
    v_mfma_f32_16x16x32_bf16 v[228:231], a[136:139], v[40:43], v[228:231]
    v_mfma_f32_16x16x32_bf16 v[232:235], a[64:67], v[44:47], v[232:235]
    v_mfma_f32_16x16x32_bf16 v[236:239], a[136:139], v[44:47], v[236:239]
    s_waitcnt lgkmcnt(2)
    v_mfma_f32_16x16x32_bf16 v[208:211], v[132:135], v[48:51], v[208:211]
    ds_read_b128 v[40:43], v24 offset:1024
    ds_read_b128 v[44:47], v24 offset:19456
    v_mfma_f32_16x16x32_bf16 v[212:215], v[204:207], v[48:51], v[212:215]
    v_mfma_f32_16x16x32_bf16 v[216:219], v[132:135], v[52:55], v[216:219]
    v_mfma_f32_16x16x32_bf16 v[220:223], v[204:207], v[52:55], v[220:223]
    v_mfma_f32_16x16x32_bf16 v[224:227], a[68:71], v[48:51], v[224:227]
    v_mfma_f32_16x16x32_bf16 v[228:231], a[140:143], v[48:51], v[228:231]
    v_mfma_f32_16x16x32_bf16 v[232:235], a[68:71], v[52:55], v[232:235]
    v_mfma_f32_16x16x32_bf16 v[236:239], a[140:143], v[52:55], v[236:239]
    v_mov_b32 v3, v24
    s_mov_b32 s31, s26
    s_add_u32 s26, s26, s41
    s_add_u32 s30, s30, 1
    s_add_u32 s19, s19, s20
    s_cmp_lt_u32 s19, 64
    s_cbranch_scc1 qk_loop
    v_cvt_pk_bf16_f32 v8, v208, v209
    v_cvt_pk_bf16_f32 v9, v210, v211
    v_cvt_pk_bf16_f32 v10, v212, v213
    v_cvt_pk_bf16_f32 v11, v214, v215
    v_cvt_pk_bf16_f32 v12, v216, v217
    v_cvt_pk_bf16_f32 v13, v218, v219
    v_cvt_pk_bf16_f32 v14, v220, v221
    v_cvt_pk_bf16_f32 v15, v222, v223
    v_cvt_pk_bf16_f32 v16, v224, v225
    v_cvt_pk_bf16_f32 v17, v226, v227
    v_cvt_pk_bf16_f32 v18, v228, v229
    v_cvt_pk_bf16_f32 v19, v230, v231
    v_cvt_pk_bf16_f32 v20, v232, v233
    v_cvt_pk_bf16_f32 v21, v234, v235
    v_cvt_pk_bf16_f32 v22, v236, v237
    v_cvt_pk_bf16_f32 v23, v238, v239
    s_branch qk_done
    s_nop 0
qk_vloop:
    s_add_u32 s22, s27, 73728
    s_sub_u32 s21, s22, 147456
    s_cselect_b32 s22, s22, s21
    s_add_u32 s27, s27, 36864
    s_cmp_eq_u32 s27, 147456
    s_cselect_b32 s27, 0, s27
    s_waitcnt lgkmcnt(2)
    v_cvt_pk_bf16_f32 v8, v208, v209
    v_cvt_pk_bf16_f32 v9, v210, v211
    v_mfma_f32_16x16x32_bf16 v[208:211], v[32:35], v[64:67], 0
    ds_read_b128 v[48:51], v3 offset:2048
    ds_read_b128 v[52:55], v3 offset:20480
    v_cvt_pk_bf16_f32 v12, v212, v213
    v_cvt_pk_bf16_f32 v13, v214, v215
    v_mfma_f32_16x16x32_bf16 v[212:215], v[32:35], v[136:139], 0
    v_cvt_pk_bf16_f32 v10, v216, v217
    v_cvt_pk_bf16_f32 v11, v218, v219
    v_mfma_f32_16x16x32_bf16 v[216:219], v[36:39], v[64:67], 0
    v_cvt_pk_bf16_f32 v14, v220, v221
    v_cvt_pk_bf16_f32 v15, v222, v223
    v_mfma_f32_16x16x32_bf16 v[220:223], v[36:39], v[136:139], 0
    v_cvt_pk_bf16_f32 v16, v224, v225
    v_cvt_pk_bf16_f32 v17, v226, v227
    v_mfma_f32_16x16x32_bf16 v[224:227], v[32:35], a[0:3], 0
    v_cvt_pk_bf16_f32 v20, v228, v229
    v_cvt_pk_bf16_f32 v21, v230, v231
    v_mfma_f32_16x16x32_bf16 v[228:231], v[32:35], a[72:75], 0
    v_cvt_pk_bf16_f32 v18, v232, v233
    v_cvt_pk_bf16_f32 v19, v234, v235
    v_mfma_f32_16x16x32_bf16 v[232:235], v[36:39], a[0:3], 0
    v_cvt_pk_bf16_f32 v22, v236, v237
    v_cvt_pk_bf16_f32 v23, v238, v239
    v_mfma_f32_16x16x32_bf16 v[236:239], v[36:39], a[72:75], 0
    s_waitcnt lgkmcnt(2)
    v_mfma_f32_16x16x32_bf16 v[208:211], v[40:43], v[68:71], v[208:211]
    ds_read_b128 v[32:35], v3 offset:3072
    ds_read_b128 v[36:39], v3 offset:21504
    v_mfma_f32_16x16x32_bf16 v[212:215], v[40:43], v[140:143], v[212:215]
    v_mfma_f32_16x16x32_bf16 v[216:219], v[44:47], v[68:71], v[216:219]
    s_mov_b32 s28, s31
    buffer_store_dwordx4 v[8:11], v7, s[4:7], s28 offen sc1
    v_mfma_f32_16x16x32_bf16 v[220:223], v[44:47], v[140:143], v[220:223]
    v_mfma_f32_16x16x32_bf16 v[224:227], v[40:43], a[4:7], v[224:227]
    v_mfma_f32_16x16x32_bf16 v[228:231], v[40:43], a[76:79], v[228:231]
    v_mfma_f32_16x16x32_bf16 v[232:235], v[44:47], a[4:7], v[232:235]
    v_mfma_f32_16x16x32_bf16 v[236:239], v[44:47], a[76:79], v[236:239]
    s_waitcnt lgkmcnt(2)
    v_mfma_f32_16x16x32_bf16 v[208:211], v[48:51], v[72:75], v[208:211]
    ds_read_b128 v[40:43], v3 offset:4096
    ds_read_b128 v[44:47], v3 offset:22528
    v_mfma_f32_16x16x32_bf16 v[212:215], v[48:51], v[144:147], v[212:215]
    v_mfma_f32_16x16x32_bf16 v[216:219], v[52:55], v[72:75], v[216:219]
    s_add_u32 s28, s28, s40
    buffer_store_dwordx4 v[12:15], v7, s[4:7], s28 offen sc1
    v_mfma_f32_16x16x32_bf16 v[220:223], v[52:55], v[144:147], v[220:223]
    v_mfma_f32_16x16x32_bf16 v[224:227], v[48:51], a[8:11], v[224:227]
    v_mfma_f32_16x16x32_bf16 v[228:231], v[48:51], a[80:83], v[228:231]
    v_mfma_f32_16x16x32_bf16 v[232:235], v[52:55], a[8:11], v[232:235]
    v_mfma_f32_16x16x32_bf16 v[236:239], v[52:55], a[80:83], v[236:239]
    s_waitcnt lgkmcnt(2)
    v_mfma_f32_16x16x32_bf16 v[208:211], v[32:35], v[76:79], v[208:211]
    ds_read_b128 v[48:51], v3 offset:5120
    ds_read_b128 v[52:55], v3 offset:23552
    v_mfma_f32_16x16x32_bf16 v[212:215], v[32:35], v[148:151], v[212:215]
    v_mfma_f32_16x16x32_bf16 v[216:219], v[36:39], v[76:79], v[216:219]
    s_add_u32 s28, s31, s43
    buffer_store_dwordx4 v[16:19], v7, s[4:7], s28 offen sc1
    v_mfma_f32_16x16x32_bf16 v[220:223], v[36:39], v[148:151], v[220:223]
    v_mfma_f32_16x16x32_bf16 v[224:227], v[32:35], a[12:15], v[224:227]
    v_mfma_f32_16x16x32_bf16 v[228:231], v[32:35], a[84:87], v[228:231]
    v_mfma_f32_16x16x32_bf16 v[232:235], v[36:39], a[12:15], v[232:235]
    v_mfma_f32_16x16x32_bf16 v[236:239], v[36:39], a[84:87], v[236:239]
    s_waitcnt lgkmcnt(2)
    v_mfma_f32_16x16x32_bf16 v[208:211], v[40:43], v[80:83], v[208:211]
    ds_read_b128 v[32:35], v3 offset:6144
    ds_read_b128 v[36:39], v3 offset:24576
    v_mfma_f32_16x16x32_bf16 v[212:215], v[40:43], v[152:155], v[212:215]
    v_mfma_f32_16x16x32_bf16 v[216:219], v[44:47], v[80:83], v[216:219]
    s_add_u32 s28, s28, s40
    buffer_store_dwordx4 v[20:23], v7, s[4:7], s28 offen sc1
    v_mfma_f32_16x16x32_bf16 v[220:223], v[44:47], v[152:155], v[220:223]
    v_mfma_f32_16x16x32_bf16 v[224:227], v[40:43], a[16:19], v[224:227]
    v_mfma_f32_16x16x32_bf16 v[228:231], v[40:43], a[88:91], v[228:231]
    v_mfma_f32_16x16x32_bf16 v[232:235], v[44:47], a[16:19], v[232:235]
    v_mfma_f32_16x16x32_bf16 v[236:239], v[44:47], a[88:91], v[236:239]
    s_waitcnt lgkmcnt(2)
    v_mfma_f32_16x16x32_bf16 v[208:211], v[48:51], v[84:87], v[208:211]
    ds_read_b128 v[40:43], v3 offset:7168
    ds_read_b128 v[44:47], v3 offset:25600
    v_mfma_f32_16x16x32_bf16 v[212:215], v[48:51], v[156:159], v[212:215]
    v_mfma_f32_16x16x32_bf16 v[216:219], v[52:55], v[84:87], v[216:219]
    s_add_u32 s23, s22, s25
    s_add_u32 m0, s23, 0
    s_nop 0
    buffer_load_dwordx4 v2, s[8:11], s24 offen offset:0 lds
    v_mfma_f32_16x16x32_bf16 v[220:223], v[52:55], v[156:159], v[220:223]
    v_mfma_f32_16x16x32_bf16 v[224:227], v[48:51], a[20:23], v[224:227]
    v_mfma_f32_16x16x32_bf16 v[228:231], v[48:51], a[92:95], v[228:231]
    v_mfma_f32_16x16x32_bf16 v[232:235], v[52:55], a[20:23], v[232:235]
    v_mfma_f32_16x16x32_bf16 v[236:239], v[52:55], a[92:95], v[236:239]
    s_waitcnt lgkmcnt(2)
    v_mfma_f32_16x16x32_bf16 v[208:211], v[32:35], v[88:91], v[208:211]
    ds_read_b128 v[48:51], v3 offset:8192
    ds_read_b128 v[52:55], v3 offset:26624
    v_mfma_f32_16x16x32_bf16 v[212:215], v[32:35], v[160:163], v[212:215]
    v_mfma_f32_16x16x32_bf16 v[216:219], v[36:39], v[88:91], v[216:219]
    s_add_u32 m0, s23, 960
    s_nop 0
    buffer_load_dwordx4 v2, s[8:11], s24 offen offset:64 lds
    v_mfma_f32_16x16x32_bf16 v[220:223], v[36:39], v[160:163], v[220:223]
    v_mfma_f32_16x16x32_bf16 v[224:227], v[32:35], a[24:27], v[224:227]
    v_mfma_f32_16x16x32_bf16 v[228:231], v[32:35], a[96:99], v[228:231]
    v_mfma_f32_16x16x32_bf16 v[232:235], v[36:39], a[24:27], v[232:235]
    v_mfma_f32_16x16x32_bf16 v[236:239], v[36:39], a[96:99], v[236:239]
    s_waitcnt lgkmcnt(2)
    v_mfma_f32_16x16x32_bf16 v[208:211], v[40:43], v[92:95], v[208:211]
    ds_read_b128 v[32:35], v3 offset:9216
    ds_read_b128 v[36:39], v3 offset:27648
    v_mfma_f32_16x16x32_bf16 v[212:215], v[40:43], v[164:167], v[212:215]
    v_mfma_f32_16x16x32_bf16 v[216:219], v[44:47], v[92:95], v[216:219]
    s_add_u32 m0, s23, 1920
    s_nop 0
    buffer_load_dwordx4 v2, s[8:11], s24 offen offset:128 lds
    v_mfma_f32_16x16x32_bf16 v[220:223], v[44:47], v[164:167], v[220:223]
    v_mfma_f32_16x16x32_bf16 v[224:227], v[40:43], a[28:31], v[224:227]
    v_mfma_f32_16x16x32_bf16 v[228:231], v[40:43], a[100:103], v[228:231]
    v_mfma_f32_16x16x32_bf16 v[232:235], v[44:47], a[28:31], v[232:235]
    v_mfma_f32_16x16x32_bf16 v[236:239], v[44:47], a[100:103], v[236:239]
    s_waitcnt lgkmcnt(2)
    v_mfma_f32_16x16x32_bf16 v[208:211], v[48:51], v[96:99], v[208:211]
    ds_read_b128 v[40:43], v3 offset:10240
    ds_read_b128 v[44:47], v3 offset:28672
    v_mfma_f32_16x16x32_bf16 v[212:215], v[48:51], v[168:171], v[212:215]
    v_mfma_f32_16x16x32_bf16 v[216:219], v[52:55], v[96:99], v[216:219]
    s_add_u32 m0, s23, 2880
    s_nop 0
    buffer_load_dwordx4 v2, s[8:11], s24 offen offset:192 lds
    v_mfma_f32_16x16x32_bf16 v[220:223], v[52:55], v[168:171], v[220:223]
    v_mfma_f32_16x16x32_bf16 v[224:227], v[48:51], a[32:35], v[224:227]
    v_mfma_f32_16x16x32_bf16 v[228:231], v[48:51], a[104:107], v[228:231]
    v_mfma_f32_16x16x32_bf16 v[232:235], v[52:55], a[32:35], v[232:235]
    v_mfma_f32_16x16x32_bf16 v[236:239], v[52:55], a[104:107], v[236:239]
    s_waitcnt lgkmcnt(2)
    v_mfma_f32_16x16x32_bf16 v[208:211], v[32:35], v[100:103], v[208:211]
    ds_read_b128 v[48:51], v3 offset:11264
    ds_read_b128 v[52:55], v3 offset:29696
    v_mfma_f32_16x16x32_bf16 v[212:215], v[32:35], v[172:175], v[212:215]
    v_mfma_f32_16x16x32_bf16 v[216:219], v[36:39], v[100:103], v[216:219]
    s_add_u32 m0, s23, 3840
    s_nop 0
    buffer_load_dwordx4 v2, s[8:11], s24 offen offset:256 lds
    v_mfma_f32_16x16x32_bf16 v[220:223], v[36:39], v[172:175], v[220:223]
    v_mfma_f32_16x16x32_bf16 v[224:227], v[32:35], a[36:39], v[224:227]
    v_mfma_f32_16x16x32_bf16 v[228:231], v[32:35], a[108:111], v[228:231]
    v_mfma_f32_16x16x32_bf16 v[232:235], v[36:39], a[36:39], v[232:235]
    v_mfma_f32_16x16x32_bf16 v[236:239], v[36:39], a[108:111], v[236:239]
    s_waitcnt lgkmcnt(2)
    v_mfma_f32_16x16x32_bf16 v[208:211], v[40:43], v[104:107], v[208:211]
    ds_read_b128 v[32:35], v3 offset:12288
    ds_read_b128 v[36:39], v3 offset:30720
    v_mfma_f32_16x16x32_bf16 v[212:215], v[40:43], v[176:179], v[212:215]
    v_mfma_f32_16x16x32_bf16 v[216:219], v[44:47], v[104:107], v[216:219]
    s_add_u32 m0, s23, 4800
    s_nop 0
    buffer_load_dwordx4 v2, s[8:11], s24 offen offset:320 lds
    v_mfma_f32_16x16x32_bf16 v[220:223], v[44:47], v[176:179], v[220:223]
    v_mfma_f32_16x16x32_bf16 v[224:227], v[40:43], a[40:43], v[224:227]
    v_mfma_f32_16x16x32_bf16 v[228:231], v[40:43], a[112:115], v[228:231]
    v_mfma_f32_16x16x32_bf16 v[232:235], v[44:47], a[40:43], v[232:235]
    v_mfma_f32_16x16x32_bf16 v[236:239], v[44:47], a[112:115], v[236:239]
    s_waitcnt lgkmcnt(2)
    v_mfma_f32_16x16x32_bf16 v[208:211], v[48:51], v[108:111], v[208:211]
    ds_read_b128 v[40:43], v3 offset:13312
    ds_read_b128 v[44:47], v3 offset:31744
    v_mfma_f32_16x16x32_bf16 v[212:215], v[48:51], v[180:183], v[212:215]
    v_mfma_f32_16x16x32_bf16 v[216:219], v[52:55], v[108:111], v[216:219]
    s_add_u32 m0, s23, 5760
    s_nop 0
    buffer_load_dwordx4 v2, s[8:11], s24 offen offset:384 lds
    v_mfma_f32_16x16x32_bf16 v[220:223], v[52:55], v[180:183], v[220:223]
    v_mfma_f32_16x16x32_bf16 v[224:227], v[48:51], a[44:47], v[224:227]
    v_mfma_f32_16x16x32_bf16 v[228:231], v[48:51], a[116:119], v[228:231]
    v_mfma_f32_16x16x32_bf16 v[232:235], v[52:55], a[44:47], v[232:235]
    v_mfma_f32_16x16x32_bf16 v[236:239], v[52:55], a[116:119], v[236:239]
    s_waitcnt lgkmcnt(2)
    v_mfma_f32_16x16x32_bf16 v[208:211], v[32:35], v[112:115], v[208:211]
    ds_read_b128 v[48:51], v3 offset:14336
    ds_read_b128 v[52:55], v3 offset:32768
    v_mfma_f32_16x16x32_bf16 v[212:215], v[32:35], v[184:187], v[212:215]
    v_mfma_f32_16x16x32_bf16 v[216:219], v[36:39], v[112:115], v[216:219]
    s_add_u32 m0, s23, 6720
    s_nop 0
    buffer_load_dwordx4 v2, s[8:11], s24 offen offset:448 lds
    v_mfma_f32_16x16x32_bf16 v[220:223], v[36:39], v[184:187], v[220:223]
    v_mfma_f32_16x16x32_bf16 v[224:227], v[32:35], a[48:51], v[224:227]
    v_mfma_f32_16x16x32_bf16 v[228:231], v[32:35], a[120:123], v[228:231]
    v_mfma_f32_16x16x32_bf16 v[232:235], v[36:39], a[48:51], v[232:235]
    v_mfma_f32_16x16x32_bf16 v[236:239], v[36:39], a[120:123], v[236:239]
    s_waitcnt lgkmcnt(2)
    v_mfma_f32_16x16x32_bf16 v[208:211], v[40:43], v[116:119], v[208:211]
    ds_read_b128 v[32:35], v3 offset:15360
    ds_read_b128 v[36:39], v3 offset:33792
    v_mfma_f32_16x16x32_bf16 v[212:215], v[40:43], v[188:191], v[212:215]
    v_mfma_f32_16x16x32_bf16 v[216:219], v[44:47], v[116:119], v[216:219]
    s_add_u32 m0, s23, 7680
    s_nop 0
    buffer_load_dwordx4 v2, s[8:11], s24 offen offset:512 lds
    s_add_u32 s24, s24, s42
    v_mfma_f32_16x16x32_bf16 v[220:223], v[44:47], v[188:191], v[220:223]
    v_mfma_f32_16x16x32_bf16 v[224:227], v[40:43], a[52:55], v[224:227]
    v_mfma_f32_16x16x32_bf16 v[228:231], v[40:43], a[124:127], v[228:231]
    v_mfma_f32_16x16x32_bf16 v[232:235], v[44:47], a[52:55], v[232:235]
    v_mfma_f32_16x16x32_bf16 v[236:239], v[44:47], a[124:127], v[236:239]
    s_waitcnt lgkmcnt(2)
    v_mfma_f32_16x16x32_bf16 v[208:211], v[48:51], v[120:123], v[208:211]
    ds_read_b128 v[40:43], v3 offset:16384
    ds_read_b128 v[44:47], v3 offset:34816
    v_mfma_f32_16x16x32_bf16 v[212:215], v[48:51], v[192:195], v[212:215]
    v_mfma_f32_16x16x32_bf16 v[216:219], v[52:55], v[120:123], v[216:219]
    v_add_u32 v24, s27, v1
    v_mfma_f32_16x16x32_bf16 v[220:223], v[52:55], v[192:195], v[220:223]
    v_mfma_f32_16x16x32_bf16 v[224:227], v[48:51], a[56:59], v[224:227]
    v_mfma_f32_16x16x32_bf16 v[228:231], v[48:51], a[128:131], v[228:231]
    v_mfma_f32_16x16x32_bf16 v[232:235], v[52:55], a[56:59], v[232:235]
    v_mfma_f32_16x16x32_bf16 v[236:239], v[52:55], a[128:131], v[236:239]
    s_waitcnt lgkmcnt(2)
    v_mfma_f32_16x16x32_bf16 v[208:211], v[32:35], v[124:127], v[208:211]
    ds_read_b128 v[48:51], v3 offset:17408
    ds_read_b128 v[52:55], v3 offset:35840
    v_mfma_f32_16x16x32_bf16 v[212:215], v[32:35], v[196:199], v[212:215]
    v_mfma_f32_16x16x32_bf16 v[216:219], v[36:39], v[124:127], v[216:219]
    v_mfma_f32_16x16x32_bf16 v[220:223], v[36:39], v[196:199], v[220:223]
    v_mfma_f32_16x16x32_bf16 v[224:227], v[32:35], a[60:63], v[224:227]
    v_mfma_f32_16x16x32_bf16 v[228:231], v[32:35], a[132:135], v[228:231]
    s_waitcnt vmcnt(9)
    s_barrier
    v_mfma_f32_16x16x32_bf16 v[232:235], v[36:39], a[60:63], v[232:235]
    v_mfma_f32_16x16x32_bf16 v[236:239], v[36:39], a[132:135], v[236:239]
    s_waitcnt lgkmcnt(2)
    v_mfma_f32_16x16x32_bf16 v[208:211], v[40:43], v[128:131], v[208:211]
    ds_read_b128 v[32:35], v24 offset:0
    ds_read_b128 v[36:39], v24 offset:18432
    v_mfma_f32_16x16x32_bf16 v[212:215], v[40:43], v[200:203], v[212:215]
    v_mfma_f32_16x16x32_bf16 v[216:219], v[44:47], v[128:131], v[216:219]
    v_mov_b32 v4, s30
    s_mov_b64 exec, s[34:35]
    buffer_store_dword v4, off, s[4:7], s29 sc1
    s_mov_b64 exec, -1
    v_mfma_f32_16x16x32_bf16 v[220:223], v[44:47], v[200:203], v[220:223]
    v_mfma_f32_16x16x32_bf16 v[224:227], v[40:43], a[64:67], v[224:227]
    v_mfma_f32_16x16x32_bf16 v[228:231], v[40:43], a[136:139], v[228:231]
    v_mfma_f32_16x16x32_bf16 v[232:235], v[44:47], a[64:67], v[232:235]
    v_mfma_f32_16x16x32_bf16 v[236:239], v[44:47], a[136:139], v[236:239]
    s_waitcnt lgkmcnt(2)
    v_mfma_f32_16x16x32_bf16 v[208:211], v[48:51], v[132:135], v[208:211]
    ds_read_b128 v[40:43], v24 offset:1024
    ds_read_b128 v[44:47], v24 offset:19456
    v_mfma_f32_16x16x32_bf16 v[212:215], v[48:51], v[204:207], v[212:215]
    v_mfma_f32_16x16x32_bf16 v[216:219], v[52:55], v[132:135], v[216:219]
    v_mfma_f32_16x16x32_bf16 v[220:223], v[52:55], v[204:207], v[220:223]
    v_mfma_f32_16x16x32_bf16 v[224:227], v[48:51], a[68:71], v[224:227]
    v_mfma_f32_16x16x32_bf16 v[228:231], v[48:51], a[140:143], v[228:231]
    v_mfma_f32_16x16x32_bf16 v[232:235], v[52:55], a[68:71], v[232:235]
    v_mfma_f32_16x16x32_bf16 v[236:239], v[52:55], a[140:143], v[236:239]
    v_mov_b32 v3, v24
    s_mov_b32 s31, s26
    s_add_u32 s26, s26, s41
    s_add_u32 s30, s30, 1
    s_add_u32 s19, s19, s20
    s_cmp_lt_u32 s19, 64
    s_cbranch_scc1 qk_vloop
    v_cvt_pk_bf16_f32 v8, v208, v209
    v_cvt_pk_bf16_f32 v9, v210, v211
    v_cvt_pk_bf16_f32 v12, v212, v213
    v_cvt_pk_bf16_f32 v13, v214, v215
    v_cvt_pk_bf16_f32 v10, v216, v217
    v_cvt_pk_bf16_f32 v11, v218, v219
    v_cvt_pk_bf16_f32 v14, v220, v221
    v_cvt_pk_bf16_f32 v15, v222, v223
    v_cvt_pk_bf16_f32 v16, v224, v225
    v_cvt_pk_bf16_f32 v17, v226, v227
    v_cvt_pk_bf16_f32 v20, v228, v229
    v_cvt_pk_bf16_f32 v21, v230, v231
    v_cvt_pk_bf16_f32 v18, v232, v233
    v_cvt_pk_bf16_f32 v19, v234, v235
    v_cvt_pk_bf16_f32 v22, v236, v237
    v_cvt_pk_bf16_f32 v23, v238, v239
qk_done:
    s_mov_b32 s28, s31
    buffer_store_dwordx4 v[8:11], v7, s[4:7], s28 offen sc1
    s_add_u32 s28, s28, s40
    buffer_store_dwordx4 v[12:15], v7, s[4:7], s28 offen sc1
    s_add_u32 s28, s31, s43
    buffer_store_dwordx4 v[16:19], v7, s[4:7], s28 offen sc1
    s_add_u32 s28, s28, s40
    buffer_store_dwordx4 v[20:23], v7, s[4:7], s28 offen sc1
    s_waitcnt vmcnt(0) lgkmcnt(0)
    s_barrier
    s_add_u32 s22, s95, 63
    v_mov_b32 v4, s22
    s_mov_b64 exec, s[34:35]
    buffer_store_dword v4, off, s[4:7], s29 sc1
    s_mov_b64 exec, -1
    s_cmp_eq_u32 s16, 0
    s_cbranch_scc1 qk_nq
    s_add_u32 s29, s29, 4096
    v_mov_b32 v4, s22
    s_mov_b64 exec, s[34:35]
    buffer_store_dword v4, off, s[4:7], s29 sc1
    s_mov_b64 exec, -1
qk_nq:
    s_cmp_ge_u32 s36, 64
    s_cbranch_scc1 L_qkv_next
    s_cmp_lt_u32 s36, 32
    s_cbranch_scc1 L_qkv_next
    v_and_b32 v4, 63, v0
    v_lshrrev_b32 v5, 4, v4
    v_bfe_u32 v240, v4, 3, 1
    v_lshlrev_b32 v243, 17, v240
    v_mul_u32_u24 v240, 12288, v240
    v_add_u32 v1, 0, v5
    v_mul_u32_u24 v6, 11, v1
    v_lshrrev_b32 v6, 5, v6
    v_add_u32 v1, v1, v6
    v_lshlrev_b32 v1, 7, v1
    v_and_b32 v6, 7, v4
    v_lshl_add_u32 v1, v6, 4, v1
    v_add_u32 v1, v1, v240
    v_add_u32 v2, 4, v5
    v_mul_u32_u24 v6, 11, v2
    v_lshrrev_b32 v6, 5, v6
    v_add_u32 v2, v2, v6
    v_lshlrev_b32 v2, 7, v2
    v_and_b32 v6, 7, v4
    v_lshl_add_u32 v2, v6, 4, v2
    v_add_u32 v2, v2, v240
    v_add_u32 v3, 8, v5
    v_mul_u32_u24 v6, 11, v3
    v_lshrrev_b32 v6, 5, v6
    v_add_u32 v3, v3, v6
    v_lshlrev_b32 v3, 7, v3
    v_and_b32 v6, 7, v4
    v_lshl_add_u32 v3, v6, 4, v3
    v_add_u32 v3, v3, v240
    v_min_u32 v6, 23, v4
    v_lshlrev_b32 v6, 9, v6
    v_or_b32 v241, 128, v7
    v_mov_b32 v242, v241
    s_cmp_lg_u32 s16, 2
    s_cbranch_scc1 mk_isk
    v_lshrrev_b32 v243, 5, v4
    v_lshlrev_b32 v243, 17, v243
    v_mov_b32 v241, v7
    v_xor_b32 v242, 512, v7
mk_isk:
    v_add_u32 v241, v241, v243
    v_add_u32 v242, v242, v243
    s_mov_b32 s19, 0
    s_mov_b32 s27, 2
    s_mov_b32 s24, 90177536
    s_lshl_b32 s26, s17, 12
    s_mov_b32 s21, 71303168
    s_cmp_eq_u32 s16, 2
    s_cselect_b32 s21, 80740352, s21
    s_add_u32 s26, s26, s21
    s_lshl_b32 s29, s17, 7
    s_lshl_b32 s21, s16, 3
    s_add_u32 s29, s29, s21
    s_add_u32 s29, s29, 125829240
mk_loop:
    s_cmp_lg_u32 s19, 58
    s_cbranch_scc1 mk_same
    s_mov_b32 s27, 1
    v_sub_u32 v1, v1, v240
    v_sub_u32 v2, v2, v240
    v_sub_u32 v3, v3, v240
    v_sub_u32 v241, v241, v243
    v_sub_u32 v242, v242, v243
mk_same:
    s_mov_b32 s30, 4096
    s_cmp_eq_u32 s27, 1
    s_cbranch_scc1 mk_again
    s_cmp_lg_u32 s18, 0
    s_cbranch_scc1 mk_go
mk_look:
    s_mul_i32 s23, s27, 12288
    s_add_u32 s23, s23, s24
    s_sub_u32 s23, s23, 12288
    s_mov_b32 s21, 4194304
mk_wait:
    buffer_load_dword v4, v6, s[4:7], s23 offen offset:384 sc1
    s_sub_u32 s21, s21, 1
    s_cbranch_scc1 mk_go
    s_waitcnt vmcnt(0)
    v_cmp_ne_u32 vcc, s95, v4
    s_cbranch_vccz mk_go
    s_sleep 4
    s_branch mk_wait
mk_go:
    s_cmp_eq_u32 s27, 1
    s_cbranch_scc1 mk_again
    s_barrier
mk_again:
    v_mov_b32 v5, 0
    s_add_u32 s23, s24, 0
    buffer_load_dwordx4 v[24:27], v1, s[4:7], s23 offen offset:0 sc1
    buffer_load_dwordx4 v[28:31], v2, s[4:7], s23 offen offset:0 sc1
    buffer_load_dwordx4 v[32:35], v3, s[4:7], s23 offen offset:0 sc1
    buffer_load_dwordx4 v[36:39], v1, s[4:7], s23 offen offset:2048 sc1
    buffer_load_dwordx4 v[40:43], v2, s[4:7], s23 offen offset:2048 sc1
    buffer_load_dwordx4 v[44:47], v3, s[4:7], s23 offen offset:2048 sc1
    s_add_u32 s23, s24, 4096
    buffer_load_dwordx4 v[48:51], v1, s[4:7], s23 offen offset:0 sc1
    buffer_load_dwordx4 v[52:55], v2, s[4:7], s23 offen offset:0 sc1
    buffer_load_dwordx4 v[56:59], v3, s[4:7], s23 offen offset:0 sc1
    buffer_load_dwordx4 v[60:63], v1, s[4:7], s23 offen offset:2048 sc1
    buffer_load_dwordx4 v[208:211], v2, s[4:7], s23 offen offset:2048 sc1
    buffer_load_dwordx4 v[212:215], v3, s[4:7], s23 offen offset:2048 sc1
    s_add_u32 s23, s24, 8192
    buffer_load_dwordx4 v[216:219], v1, s[4:7], s23 offen offset:0 sc1
    buffer_load_dwordx4 v[220:223], v2, s[4:7], s23 offen offset:0 sc1
    buffer_load_dwordx4 v[224:227], v3, s[4:7], s23 offen offset:0 sc1
    buffer_load_dwordx4 v[228:231], v1, s[4:7], s23 offen offset:2048 sc1
    buffer_load_dwordx4 v[232:235], v2, s[4:7], s23 offen offset:2048 sc1
    buffer_load_dwordx4 v[236:239], v3, s[4:7], s23 offen offset:2048 sc1
    s_cmp_eq_u32 s16, 2
    s_cbranch_scc1 mk_v
    s_waitcnt vmcnt(17)
    v_mfma_f32_16x16x32_bf16 v[8:11], v[64:67], v[24:27], 0
    v_mfma_f32_16x16x32_bf16 v[12:15], v[136:139], v[24:27], 0
    v_max3_u32 v5, v5, v24, v25
    v_mfma_f32_16x16x32_bf16 v[16:19], a[0:3], v[24:27], 0
    v_mfma_f32_16x16x32_bf16 v[20:23], a[72:75], v[24:27], 0
    v_max3_u32 v5, v5, v26, v27
    s_waitcnt vmcnt(16)
    v_mfma_f32_16x16x32_bf16 v[8:11], v[68:71], v[28:31], v[8:11]
    v_mfma_f32_16x16x32_bf16 v[12:15], v[140:143], v[28:31], v[12:15]
    v_max3_u32 v5, v5, v28, v29
    v_mfma_f32_16x16x32_bf16 v[16:19], a[4:7], v[28:31], v[16:19]
    v_mfma_f32_16x16x32_bf16 v[20:23], a[76:79], v[28:31], v[20:23]
    v_max3_u32 v5, v5, v30, v31
    s_waitcnt vmcnt(15)
    v_mfma_f32_16x16x32_bf16 v[8:11], v[72:75], v[32:35], v[8:11]
    v_mfma_f32_16x16x32_bf16 v[12:15], v[144:147], v[32:35], v[12:15]
    v_max3_u32 v5, v5, v32, v33
    v_mfma_f32_16x16x32_bf16 v[16:19], a[8:11], v[32:35], v[16:19]
    v_mfma_f32_16x16x32_bf16 v[20:23], a[80:83], v[32:35], v[20:23]
    v_max3_u32 v5, v5, v34, v35
    s_waitcnt vmcnt(14)
    v_mfma_f32_16x16x32_bf16 v[8:11], v[76:79], v[36:39], v[8:11]
    v_mfma_f32_16x16x32_bf16 v[12:15], v[148:151], v[36:39], v[12:15]
    v_max3_u32 v5, v5, v36, v37
    v_mfma_f32_16x16x32_bf16 v[16:19], a[12:15], v[36:39], v[16:19]
    v_mfma_f32_16x16x32_bf16 v[20:23], a[84:87], v[36:39], v[20:23]
    v_max3_u32 v5, v5, v38, v39
    s_waitcnt vmcnt(13)
    v_mfma_f32_16x16x32_bf16 v[8:11], v[80:83], v[40:43], v[8:11]
    v_mfma_f32_16x16x32_bf16 v[12:15], v[152:155], v[40:43], v[12:15]
    v_max3_u32 v5, v5, v40, v41
    v_mfma_f32_16x16x32_bf16 v[16:19], a[16:19], v[40:43], v[16:19]
    v_mfma_f32_16x16x32_bf16 v[20:23], a[88:91], v[40:43], v[20:23]
    v_max3_u32 v5, v5, v42, v43
    s_waitcnt vmcnt(12)
    v_mfma_f32_16x16x32_bf16 v[8:11], v[84:87], v[44:47], v[8:11]
    v_mfma_f32_16x16x32_bf16 v[12:15], v[156:159], v[44:47], v[12:15]
    v_max3_u32 v5, v5, v44, v45
    v_mfma_f32_16x16x32_bf16 v[16:19], a[20:23], v[44:47], v[16:19]
    v_mfma_f32_16x16x32_bf16 v[20:23], a[92:95], v[44:47], v[20:23]
    v_max3_u32 v5, v5, v46, v47
    s_waitcnt vmcnt(11)
    v_mfma_f32_16x16x32_bf16 v[8:11], v[88:91], v[48:51], v[8:11]
    v_mfma_f32_16x16x32_bf16 v[12:15], v[160:163], v[48:51], v[12:15]
    v_max3_u32 v5, v5, v48, v49
    v_mfma_f32_16x16x32_bf16 v[16:19], a[24:27], v[48:51], v[16:19]
    v_mfma_f32_16x16x32_bf16 v[20:23], a[96:99], v[48:51], v[20:23]
    v_max3_u32 v5, v5, v50, v51
    s_waitcnt vmcnt(10)
    v_mfma_f32_16x16x32_bf16 v[8:11], v[92:95], v[52:55], v[8:11]
    v_mfma_f32_16x16x32_bf16 v[12:15], v[164:167], v[52:55], v[12:15]
    v_max3_u32 v5, v5, v52, v53
    v_mfma_f32_16x16x32_bf16 v[16:19], a[28:31], v[52:55], v[16:19]
    v_mfma_f32_16x16x32_bf16 v[20:23], a[100:103], v[52:55], v[20:23]
    v_max3_u32 v5, v5, v54, v55
    s_waitcnt vmcnt(9)
    v_mfma_f32_16x16x32_bf16 v[8:11], v[96:99], v[56:59], v[8:11]
    v_mfma_f32_16x16x32_bf16 v[12:15], v[168:171], v[56:59], v[12:15]
    v_max3_u32 v5, v5, v56, v57
    v_mfma_f32_16x16x32_bf16 v[16:19], a[32:35], v[56:59], v[16:19]
    v_mfma_f32_16x16x32_bf16 v[20:23], a[104:107], v[56:59], v[20:23]
    v_max3_u32 v5, v5, v58, v59
    s_waitcnt vmcnt(8)
    v_mfma_f32_16x16x32_bf16 v[8:11], v[100:103], v[60:63], v[8:11]
    v_mfma_f32_16x16x32_bf16 v[12:15], v[172:175], v[60:63], v[12:15]
    v_max3_u32 v5, v5, v60, v61
    v_mfma_f32_16x16x32_bf16 v[16:19], a[36:39], v[60:63], v[16:19]
    v_mfma_f32_16x16x32_bf16 v[20:23], a[108:111], v[60:63], v[20:23]
    v_max3_u32 v5, v5, v62, v63
    s_waitcnt vmcnt(7)
    v_mfma_f32_16x16x32_bf16 v[8:11], v[104:107], v[208:211], v[8:11]
    v_mfma_f32_16x16x32_bf16 v[12:15], v[176:179], v[208:211], v[12:15]
    v_max3_u32 v5, v5, v208, v209
    v_mfma_f32_16x16x32_bf16 v[16:19], a[40:43], v[208:211], v[16:19]
    v_mfma_f32_16x16x32_bf16 v[20:23], a[112:115], v[208:211], v[20:23]
    v_max3_u32 v5, v5, v210, v211
    s_waitcnt vmcnt(6)
    v_mfma_f32_16x16x32_bf16 v[8:11], v[108:111], v[212:215], v[8:11]
    v_mfma_f32_16x16x32_bf16 v[12:15], v[180:183], v[212:215], v[12:15]
    v_max3_u32 v5, v5, v212, v213
    v_mfma_f32_16x16x32_bf16 v[16:19], a[44:47], v[212:215], v[16:19]
    v_mfma_f32_16x16x32_bf16 v[20:23], a[116:119], v[212:215], v[20:23]
    v_max3_u32 v5, v5, v214, v215
    s_waitcnt vmcnt(5)
    v_mfma_f32_16x16x32_bf16 v[8:11], v[112:115], v[216:219], v[8:11]
    v_mfma_f32_16x16x32_bf16 v[12:15], v[184:187], v[216:219], v[12:15]
    v_max3_u32 v5, v5, v216, v217
    v_mfma_f32_16x16x32_bf16 v[16:19], a[48:51], v[216:219], v[16:19]
    v_mfma_f32_16x16x32_bf16 v[20:23], a[120:123], v[216:219], v[20:23]
    v_max3_u32 v5, v5, v218, v219
    s_waitcnt vmcnt(4)
    v_mfma_f32_16x16x32_bf16 v[8:11], v[116:119], v[220:223], v[8:11]
    v_mfma_f32_16x16x32_bf16 v[12:15], v[188:191], v[220:223], v[12:15]
    v_max3_u32 v5, v5, v220, v221
    v_mfma_f32_16x16x32_bf16 v[16:19], a[52:55], v[220:223], v[16:19]
    v_mfma_f32_16x16x32_bf16 v[20:23], a[124:127], v[220:223], v[20:23]
    v_max3_u32 v5, v5, v222, v223
    s_waitcnt vmcnt(3)
    v_mfma_f32_16x16x32_bf16 v[8:11], v[120:123], v[224:227], v[8:11]
    v_mfma_f32_16x16x32_bf16 v[12:15], v[192:195], v[224:227], v[12:15]
    v_max3_u32 v5, v5, v224, v225
    v_mfma_f32_16x16x32_bf16 v[16:19], a[56:59], v[224:227], v[16:19]
    v_mfma_f32_16x16x32_bf16 v[20:23], a[128:131], v[224:227], v[20:23]
    v_max3_u32 v5, v5, v226, v227
    s_waitcnt vmcnt(2)
    v_mfma_f32_16x16x32_bf16 v[8:11], v[124:127], v[228:231], v[8:11]
    v_mfma_f32_16x16x32_bf16 v[12:15], v[196:199], v[228:231], v[12:15]
    v_max3_u32 v5, v5, v228, v229
    v_mfma_f32_16x16x32_bf16 v[16:19], a[60:63], v[228:231], v[16:19]
    v_mfma_f32_16x16x32_bf16 v[20:23], a[132:135], v[228:231], v[20:23]
    v_max3_u32 v5, v5, v230, v231
    s_waitcnt vmcnt(1)
    v_mfma_f32_16x16x32_bf16 v[8:11], v[128:131], v[232:235], v[8:11]
    v_mfma_f32_16x16x32_bf16 v[12:15], v[200:203], v[232:235], v[12:15]
    v_max3_u32 v5, v5, v232, v233
    v_mfma_f32_16x16x32_bf16 v[16:19], a[64:67], v[232:235], v[16:19]
    v_mfma_f32_16x16x32_bf16 v[20:23], a[136:139], v[232:235], v[20:23]
    v_max3_u32 v5, v5, v234, v235
    s_waitcnt vmcnt(0)
    v_mfma_f32_16x16x32_bf16 v[8:11], v[132:135], v[236:239], v[8:11]
    v_mfma_f32_16x16x32_bf16 v[12:15], v[204:207], v[236:239], v[12:15]
    v_max3_u32 v5, v5, v236, v237
    v_mfma_f32_16x16x32_bf16 v[16:19], a[68:71], v[236:239], v[16:19]
    v_mfma_f32_16x16x32_bf16 v[20:23], a[140:143], v[236:239], v[20:23]
    v_max3_u32 v5, v5, v238, v239
    s_nop 5
    s_branch mk_st
mk_v:
    s_waitcnt vmcnt(17)
    v_mfma_f32_16x16x32_bf16 v[8:11], v[24:27], v[64:67], 0
    v_mfma_f32_16x16x32_bf16 v[12:15], v[24:27], v[136:139], 0
    v_max3_u32 v5, v5, v24, v25
    v_mfma_f32_16x16x32_bf16 v[16:19], v[24:27], a[0:3], 0
    v_mfma_f32_16x16x32_bf16 v[20:23], v[24:27], a[72:75], 0
    v_max3_u32 v5, v5, v26, v27
    s_waitcnt vmcnt(16)
    v_mfma_f32_16x16x32_bf16 v[8:11], v[28:31], v[68:71], v[8:11]
    v_mfma_f32_16x16x32_bf16 v[12:15], v[28:31], v[140:143], v[12:15]
    v_max3_u32 v5, v5, v28, v29
    v_mfma_f32_16x16x32_bf16 v[16:19], v[28:31], a[4:7], v[16:19]
    v_mfma_f32_16x16x32_bf16 v[20:23], v[28:31], a[76:79], v[20:23]
    v_max3_u32 v5, v5, v30, v31
    s_waitcnt vmcnt(15)
    v_mfma_f32_16x16x32_bf16 v[8:11], v[32:35], v[72:75], v[8:11]
    v_mfma_f32_16x16x32_bf16 v[12:15], v[32:35], v[144:147], v[12:15]
    v_max3_u32 v5, v5, v32, v33
    v_mfma_f32_16x16x32_bf16 v[16:19], v[32:35], a[8:11], v[16:19]
    v_mfma_f32_16x16x32_bf16 v[20:23], v[32:35], a[80:83], v[20:23]
    v_max3_u32 v5, v5, v34, v35
    s_waitcnt vmcnt(14)
    v_mfma_f32_16x16x32_bf16 v[8:11], v[36:39], v[76:79], v[8:11]
    v_mfma_f32_16x16x32_bf16 v[12:15], v[36:39], v[148:151], v[12:15]
    v_max3_u32 v5, v5, v36, v37
    v_mfma_f32_16x16x32_bf16 v[16:19], v[36:39], a[12:15], v[16:19]
    v_mfma_f32_16x16x32_bf16 v[20:23], v[36:39], a[84:87], v[20:23]
    v_max3_u32 v5, v5, v38, v39
    s_waitcnt vmcnt(13)
    v_mfma_f32_16x16x32_bf16 v[8:11], v[40:43], v[80:83], v[8:11]
    v_mfma_f32_16x16x32_bf16 v[12:15], v[40:43], v[152:155], v[12:15]
    v_max3_u32 v5, v5, v40, v41
    v_mfma_f32_16x16x32_bf16 v[16:19], v[40:43], a[16:19], v[16:19]
    v_mfma_f32_16x16x32_bf16 v[20:23], v[40:43], a[88:91], v[20:23]
    v_max3_u32 v5, v5, v42, v43
    s_waitcnt vmcnt(12)
    v_mfma_f32_16x16x32_bf16 v[8:11], v[44:47], v[84:87], v[8:11]
    v_mfma_f32_16x16x32_bf16 v[12:15], v[44:47], v[156:159], v[12:15]
    v_max3_u32 v5, v5, v44, v45
    v_mfma_f32_16x16x32_bf16 v[16:19], v[44:47], a[20:23], v[16:19]
    v_mfma_f32_16x16x32_bf16 v[20:23], v[44:47], a[92:95], v[20:23]
    v_max3_u32 v5, v5, v46, v47
    s_waitcnt vmcnt(11)
    v_mfma_f32_16x16x32_bf16 v[8:11], v[48:51], v[88:91], v[8:11]
    v_mfma_f32_16x16x32_bf16 v[12:15], v[48:51], v[160:163], v[12:15]
    v_max3_u32 v5, v5, v48, v49
    v_mfma_f32_16x16x32_bf16 v[16:19], v[48:51], a[24:27], v[16:19]
    v_mfma_f32_16x16x32_bf16 v[20:23], v[48:51], a[96:99], v[20:23]
    v_max3_u32 v5, v5, v50, v51
    s_waitcnt vmcnt(10)
    v_mfma_f32_16x16x32_bf16 v[8:11], v[52:55], v[92:95], v[8:11]
    v_mfma_f32_16x16x32_bf16 v[12:15], v[52:55], v[164:167], v[12:15]
    v_max3_u32 v5, v5, v52, v53
    v_mfma_f32_16x16x32_bf16 v[16:19], v[52:55], a[28:31], v[16:19]
    v_mfma_f32_16x16x32_bf16 v[20:23], v[52:55], a[100:103], v[20:23]
    v_max3_u32 v5, v5, v54, v55
    s_waitcnt vmcnt(9)
    v_mfma_f32_16x16x32_bf16 v[8:11], v[56:59], v[96:99], v[8:11]
    v_mfma_f32_16x16x32_bf16 v[12:15], v[56:59], v[168:171], v[12:15]
    v_max3_u32 v5, v5, v56, v57
    v_mfma_f32_16x16x32_bf16 v[16:19], v[56:59], a[32:35], v[16:19]
    v_mfma_f32_16x16x32_bf16 v[20:23], v[56:59], a[104:107], v[20:23]
    v_max3_u32 v5, v5, v58, v59
    s_waitcnt vmcnt(8)
    v_mfma_f32_16x16x32_bf16 v[8:11], v[60:63], v[100:103], v[8:11]
    v_mfma_f32_16x16x32_bf16 v[12:15], v[60:63], v[172:175], v[12:15]
    v_max3_u32 v5, v5, v60, v61
    v_mfma_f32_16x16x32_bf16 v[16:19], v[60:63], a[36:39], v[16:19]
    v_mfma_f32_16x16x32_bf16 v[20:23], v[60:63], a[108:111], v[20:23]
    v_max3_u32 v5, v5, v62, v63
    s_waitcnt vmcnt(7)
    v_mfma_f32_16x16x32_bf16 v[8:11], v[208:211], v[104:107], v[8:11]
    v_mfma_f32_16x16x32_bf16 v[12:15], v[208:211], v[176:179], v[12:15]
    v_max3_u32 v5, v5, v208, v209
    v_mfma_f32_16x16x32_bf16 v[16:19], v[208:211], a[40:43], v[16:19]
    v_mfma_f32_16x16x32_bf16 v[20:23], v[208:211], a[112:115], v[20:23]
    v_max3_u32 v5, v5, v210, v211
    s_waitcnt vmcnt(6)
    v_mfma_f32_16x16x32_bf16 v[8:11], v[212:215], v[108:111], v[8:11]
    v_mfma_f32_16x16x32_bf16 v[12:15], v[212:215], v[180:183], v[12:15]
    v_max3_u32 v5, v5, v212, v213
    v_mfma_f32_16x16x32_bf16 v[16:19], v[212:215], a[44:47], v[16:19]
    v_mfma_f32_16x16x32_bf16 v[20:23], v[212:215], a[116:119], v[20:23]
    v_max3_u32 v5, v5, v214, v215
    s_waitcnt vmcnt(5)
    v_mfma_f32_16x16x32_bf16 v[8:11], v[216:219], v[112:115], v[8:11]
    v_mfma_f32_16x16x32_bf16 v[12:15], v[216:219], v[184:187], v[12:15]
    v_max3_u32 v5, v5, v216, v217
    v_mfma_f32_16x16x32_bf16 v[16:19], v[216:219], a[48:51], v[16:19]
    v_mfma_f32_16x16x32_bf16 v[20:23], v[216:219], a[120:123], v[20:23]
    v_max3_u32 v5, v5, v218, v219
    s_waitcnt vmcnt(4)
    v_mfma_f32_16x16x32_bf16 v[8:11], v[220:223], v[116:119], v[8:11]
    v_mfma_f32_16x16x32_bf16 v[12:15], v[220:223], v[188:191], v[12:15]
    v_max3_u32 v5, v5, v220, v221
    v_mfma_f32_16x16x32_bf16 v[16:19], v[220:223], a[52:55], v[16:19]
    v_mfma_f32_16x16x32_bf16 v[20:23], v[220:223], a[124:127], v[20:23]
    v_max3_u32 v5, v5, v222, v223
    s_waitcnt vmcnt(3)
    v_mfma_f32_16x16x32_bf16 v[8:11], v[224:227], v[120:123], v[8:11]
    v_mfma_f32_16x16x32_bf16 v[12:15], v[224:227], v[192:195], v[12:15]
    v_max3_u32 v5, v5, v224, v225
    v_mfma_f32_16x16x32_bf16 v[16:19], v[224:227], a[56:59], v[16:19]
    v_mfma_f32_16x16x32_bf16 v[20:23], v[224:227], a[128:131], v[20:23]
    v_max3_u32 v5, v5, v226, v227
    s_waitcnt vmcnt(2)
    v_mfma_f32_16x16x32_bf16 v[8:11], v[228:231], v[124:127], v[8:11]
    v_mfma_f32_16x16x32_bf16 v[12:15], v[228:231], v[196:199], v[12:15]
    v_max3_u32 v5, v5, v228, v229
    v_mfma_f32_16x16x32_bf16 v[16:19], v[228:231], a[60:63], v[16:19]
    v_mfma_f32_16x16x32_bf16 v[20:23], v[228:231], a[132:135], v[20:23]
    v_max3_u32 v5, v5, v230, v231
    s_waitcnt vmcnt(1)
    v_mfma_f32_16x16x32_bf16 v[8:11], v[232:235], v[128:131], v[8:11]
    v_mfma_f32_16x16x32_bf16 v[12:15], v[232:235], v[200:203], v[12:15]
    v_max3_u32 v5, v5, v232, v233
    v_mfma_f32_16x16x32_bf16 v[16:19], v[232:235], a[64:67], v[16:19]
    v_mfma_f32_16x16x32_bf16 v[20:23], v[232:235], a[136:139], v[20:23]
    v_max3_u32 v5, v5, v234, v235
    s_waitcnt vmcnt(0)
    v_mfma_f32_16x16x32_bf16 v[8:11], v[236:239], v[132:135], v[8:11]
    v_mfma_f32_16x16x32_bf16 v[12:15], v[236:239], v[204:207], v[12:15]
    v_max3_u32 v5, v5, v236, v237
    v_mfma_f32_16x16x32_bf16 v[16:19], v[236:239], a[68:71], v[16:19]
    v_mfma_f32_16x16x32_bf16 v[20:23], v[236:239], a[140:143], v[20:23]
    v_max3_u32 v5, v5, v238, v239
    v_pk_mul_f32 v[8:9], v[8:9], 0.5 op_sel_hi:[1,0]
    v_pk_mul_f32 v[10:11], v[10:11], 0.5 op_sel_hi:[1,0]
    v_pk_mul_f32 v[12:13], v[12:13], 0.5 op_sel_hi:[1,0]
    v_pk_mul_f32 v[14:15], v[14:15], 0.5 op_sel_hi:[1,0]
    v_pk_mul_f32 v[16:17], v[16:17], 0.5 op_sel_hi:[1,0]
    v_pk_mul_f32 v[18:19], v[18:19], 0.5 op_sel_hi:[1,0]
    v_pk_mul_f32 v[20:21], v[20:21], 0.5 op_sel_hi:[1,0]
    v_pk_mul_f32 v[22:23], v[22:23], 0.5 op_sel_hi:[1,0]
    s_nop 1
mk_st:
    v_cmp_eq_u32 vcc, -1, v5
    s_sub_u32 s30, s30, 1
    s_cbranch_scc1 mk_ok
    s_cbranch_vccz mk_ok
    s_cmp_eq_u32 s27, 1
    s_cbranch_scc1 mk_look
    s_branch mk_again
mk_ok:
    v_cvt_pk_bf16_f32 v24, v8, v9
    v_cvt_pk_bf16_f32 v25, v10, v11
    v_cvt_pk_bf16_f32 v26, v12, v13
    v_cvt_pk_bf16_f32 v27, v14, v15
    v_cvt_pk_bf16_f32 v28, v16, v17
    v_cvt_pk_bf16_f32 v29, v18, v19
    v_cvt_pk_bf16_f32 v30, v20, v21
    v_cvt_pk_bf16_f32 v31, v22, v23
    s_add_u32 s21, s26, 4096
    buffer_store_dwordx4 v[24:27], v241, s[4:7], s26 offen sc1
    buffer_store_dwordx4 v[28:31], v241, s[4:7], s21 offen sc1
    s_add_u32 s19, s19, s27
    s_cmp_eq_u32 s27, 1
    s_cbranch_scc1 mk_fl
    s_cmp_lg_u32 s16, 2
    s_cbranch_scc1 mk_wt
    buffer_store_dwordx4 v[24:27], v242, s[4:7], s26 offen sc1
    buffer_store_dwordx4 v[28:31], v242, s[4:7], s21 offen sc1
mk_wt:
    s_waitcnt vmcnt(0)
mk_fl:
    s_barrier
    s_add_u32 s22, s19, s95
    v_mov_b32 v4, s22
    s_mov_b64 exec, s[34:35]
    buffer_store_dword v4, off, s[4:7], s29 sc1
    s_mov_b64 exec, -1
    s_mul_i32 s21, s27, 12288
    s_add_u32 s24, s24, s21
    s_lshl_b32 s21, s27, 17
    s_add_u32 s26, s26, s21
    s_cmp_lt_u32 s19, 62
    s_cbranch_scc1 mk_loop
    s_endpgm
L_ssm_next:
    s_sub_u32 s33, s3, 4
    s_and_b32 s33, s33, 7
    s_cmp_ge_u32 s33, 6
    s_cbranch_scc1 L_sscan
L_stake:
    s_lshl_b32 s35, s33, 2
    s_add_u32 s35, s35, 96
    s_mov_b32 s37, s35
    v_mov_b32 v250, 1
    v_mov_b32 v251, 163832
    v_cmp_eq_u32 vcc, 0, v0
    s_nop 0
    s_and_saveexec_b64 s[38:39], vcc
    s_cbranch_execz tk8
    buffer_atomic_add v250, off, s[96:99], s37 sc0
    s_waitcnt vmcnt(0)
    ds_write_b32 v251, v250
    s_waitcnt lgkmcnt(0)
tk8:
    s_mov_b64 exec, -1
    s_barrier
    ds_read_b32 v252, v251
    s_waitcnt lgkmcnt(0)
    v_readfirstlane_b32 s34, v252
    s_barrier
    s_nop 3
    s_mul_i32 s20, s33, 19
    s_add_u32 s20, s20, s34
    s_cmp_ge_u32 s20, 112
    s_cselect_b32 s34, 99, s34
    s_cmp_lt_u32 s34, 19
    s_cbranch_scc1 L_sjob
L_sscan:
    v_and_b32 v1, 63, v0
    v_min_u32 v1, 5, v1
    v_lshlrev_b32 v2, 2, v1
    s_cmp_lg_u32 s32, 0
    v_mov_b32 v251, 163832
    s_cbranch_scc1 sw9
    buffer_load_dword v3, v2, s[96:99], 0 offen offset:96 sc1
    v_mov_b32 v4, 19
    v_cmp_eq_u32 vcc, 5, v1
    s_nop 1
    v_cndmask_b32 v4, v4, 17, vcc
    s_waitcnt vmcnt(0)
    v_cmp_lt_u32 vcc, v3, v4
    s_nop 0
    s_ff1_i32_b64 s40, vcc
    v_mov_b32 v250, s40
    ds_write_b32 v251, v250
    s_waitcnt lgkmcnt(0)
sw9:
    s_barrier
    ds_read_b32 v252, v251
    s_waitcnt lgkmcnt(0)
    v_readfirstlane_b32 s33, v252
    s_barrier
    s_nop 1
    s_cmp_lt_u32 s33, 7
    s_cbranch_scc1 L_stake
    s_branch L_phase2
L_sjob:
    s_lshl_b32 s20, s20, 2
    v_lshrrev_b32 v5, 6, v0
    s_nop 0
    v_readfirstlane_b32 s21, v5
    v_and_b32 v1, 63, v0
    v_and_b32 v2, 15, v1
    v_lshrrev_b32 v3, 4, v1
    v_lshlrev_b32 v4, 14, v5
    s_mov_b32 s8, s62
    s_mov_b32 s9, s63
    s_mov_b32 s10, 2359296
    s_mov_b32 s11, 0x20000
    s_mov_b32 s16, s76
    s_mov_b32 s17, s77
    s_mov_b32 s18, 4718592
    s_mov_b32 s19, 0x20000
    s_add_u32 s22, s20, s21
    s_lshl_b32 s23, s22, 8
    v_lshlrev_b32 v6, 3, v2
    v_lshl_add_u32 v6, v3, 1, v6
    s_mov_b32 s12, s64
    s_mov_b32 s13, s65
    s_mov_b32 s14, 147456
    s_mov_b32 s15, 0x20000
    buffer_load_ushort v24, v6, s[12:15], s23 offen offset:0
    buffer_load_ushort v28, v6, s[12:15], s23 offen offset:128
    s_mov_b32 s12, s66
    s_mov_b32 s13, s67
    s_mov_b32 s14, 147456
    s_mov_b32 s15, 0x20000
    buffer_load_ushort v25, v6, s[12:15], s23 offen offset:0
    buffer_load_ushort v29, v6, s[12:15], s23 offen offset:128
    s_mov_b32 s12, s68
    s_mov_b32 s13, s69
    s_mov_b32 s14, 147456
    s_mov_b32 s15, 0x20000
    buffer_load_ushort v26, v6, s[12:15], s23 offen offset:0
    buffer_load_ushort v30, v6, s[12:15], s23 offen offset:128
    s_mov_b32 s12, s70
    s_mov_b32 s13, s71
    s_mov_b32 s14, 147456
    s_mov_b32 s15, 0x20000
    buffer_load_ushort v27, v6, s[12:15], s23 offen offset:0
    buffer_load_ushort v31, v6, s[12:15], s23 offen offset:128
    s_mov_b32 s12, s72
    s_mov_b32 s13, s73
    s_mov_b32 s14, 1152
    s_mov_b32 s15, 0x20000
    s_lshl_b32 s23, s22, 1
    buffer_load_ushort v32, off, s[12:15], s23
    v_mul_u32_u24 v5, 9216, v0
    s_lshl_b32 s22, s20, 1
    s_add_u32 s23, s22, 0
    buffer_load_dwordx2 v[8:9], v5, s[8:11], s23 offen
    s_add_u32 s23, s22, 1152
    buffer_load_dwordx2 v[10:11], v5, s[8:11], s23 offen
    s_add_u32 s23, s22, 2304
    buffer_load_dwordx2 v[12:13], v5, s[8:11], s23 offen
    s_add_u32 s23, s22, 3456
    buffer_load_dwordx2 v[14:15], v5, s[8:11], s23 offen
    s_add_u32 s23, s22, 4608
    buffer_load_dwordx2 v[16:17], v5, s[8:11], s23 offen
    s_add_u32 s23, s22, 5760
    buffer_load_dwordx2 v[18:19], v5, s[8:11], s23 offen
    s_add_u32 s23, s22, 6912
    buffer_load_dwordx2 v[20:21], v5, s[8:11], s23 offen
    s_add_u32 s23, s22, 8064
    buffer_load_dwordx2 v[22:23], v5, s[8:11], s23 offen
    s_mov_b32 s26, 0x3fb8aa3b
    s_mov_b32 s27, 0x3e22f983
    v_mov_b32 v34, 0
    v_mov_b32 v35, 0
    v_lshl_add_u32 v6, v1, 3, v4
    ds_write_b64 v6, v[34:35] offset:0
    s_waitcnt vmcnt(8)
    v_lshlrev_b32 v32, 16, v32
    v_mul_f32 v32, s26, v32
    v_exp_f32 v32, v32
    s_nop 0
    v_cvt_pk_bf16_f32 v32, v32, v32
    v_and_b32 v32, 0xffff0000, v32
    v_add_f32 v33, v32, v32
    v_lshlrev_b32 v24, 16, v24
    v_mul_f32 v24, s26, v24
    v_exp_f32 v24, v24
    s_nop 0
    v_cvt_pk_bf16_f32 v24, v24, v24
    v_and_b32 v24, 0xffff0000, v24
    v_mul_f32 v24, v24, v32
    v_mul_f32 v24, s26, v24
    v_sub_f32 v24, 0, v24
    v_lshlrev_b32 v25, 16, v25
    v_mul_f32 v25, v25, v32
    v_mul_f32 v25, s27, v25
    v_lshlrev_b32 v26, 16, v26
    v_mul_f32 v26, v26, v33
    v_lshlrev_b32 v27, 16, v27
    v_mul_f32 v27, v27, v33
    v_lshlrev_b32 v28, 16, v28
    v_mul_f32 v28, s26, v28
    v_exp_f32 v28, v28
    s_nop 0
    v_cvt_pk_bf16_f32 v28, v28, v28
    v_and_b32 v28, 0xffff0000, v28
    v_mul_f32 v28, v28, v32
    v_mul_f32 v28, s26, v28
    v_sub_f32 v28, 0, v28
    v_lshlrev_b32 v29, 16, v29
    v_mul_f32 v29, v29, v32
    v_mul_f32 v29, s27, v29
    v_lshlrev_b32 v30, 16, v30
    v_mul_f32 v30, v30, v33
    v_lshlrev_b32 v31, 16, v31
    v_mul_f32 v31, v31, v33
    v_cvt_f32_u32 v47, v2
    v_mul_f32 v44, 0x41800000, v47
    v_and_b32 v5, 7, v2
    v_add_u32 v5, 8, v5
    v_cvt_f32_u32 v5, v5
    v_mul_f32 v45, 0x42000000, v5
    v_mul_f32 v6, 0x42800000, v5
    v_cmp_lt_u32 vcc, 7, v2
    s_nop 1
    v_cndmask_b32 v45, v45, v6, vcc
    v_add_f32 v5, 0x41000000, v47
    v_mul_f32 v46, 0x43000000, v5
    v_mov_b32 v48, 0
    v_mov_b32 v49, 0
    v_mov_b32 v50, 0
    v_mov_b32 v51, 0
    v_mov_b32 v52, 0
    v_mov_b32 v53, 0
    v_mov_b32 v54, 0
    v_mov_b32 v55, 0
    v_mov_b32 v56, 0
    v_mov_b32 v57, 0
    v_mov_b32 v58, 0
    v_mov_b32 v59, 0
    v_mov_b32 v60, 0
    v_mov_b32 v61, 0
    v_mov_b32 v62, 0
    v_mov_b32 v63, 0
    s_mov_b32 s25, 8
    s_nop 0
ss_kg:
    v_mov_b32_dpp v64, v24 row_newbcast:0 row_mask:0xf bank_mask:0xf
    v_mov_b32_dpp v65, v25 row_newbcast:0 row_mask:0xf bank_mask:0xf
    v_mov_b32_dpp v66, v26 row_newbcast:0 row_mask:0xf bank_mask:0xf
    v_mov_b32_dpp v67, v27 row_newbcast:0 row_mask:0xf bank_mask:0xf
    v_mul_f32 v82, v64, v47
    v_mul_f32 v83, v65, v47
    v_mul_f32 v84, v64, v45
    v_mul_f32 v85, v65, v45
    v_exp_f32 v82, v82
    v_fract_f32 v83, v83
    v_exp_f32 v84, v84
    v_fract_f32 v85, v85
    v_cos_f32 v74, v83
    v_sin_f32 v75, v83
    v_cos_f32 v70, v85
    v_sin_f32 v71, v85
    v_mul_f32 v74, v74, v82
    v_mul_f32 v75, v75, v82
    v_mul_f32 v70, v70, v84
    v_mul_f32 v71, v71, v84
    v_mul_f32 v82, v75, v75
    v_add_f32 v83, v74, v74
    v_fma_f32 v76, v74, v74, -v82
    v_mul_f32 v77, v83, v75
    v_mul_f32 v82, v77, v77
    v_add_f32 v83, v76, v76
    v_fma_f32 v78, v76, v76, -v82
    v_mul_f32 v79, v83, v77
    v_mul_f32 v82, v79, v79
    v_add_f32 v83, v78, v78
    v_fma_f32 v80, v78, v78, -v82
    v_mul_f32 v81, v83, v79
    v_mul_f32 v82, v81, v81
    v_add_f32 v83, v80, v80
    v_fma_f32 v68, v80, v80, -v82
    v_mul_f32 v69, v83, v81
    v_mul_f32 v84, v71, v71
    v_add_f32 v85, v70, v70
    v_fma_f32 v86, v70, v70, -v84
    v_mul_f32 v87, v85, v71
    v_mul_f32 v84, v87, v87
    v_add_f32 v85, v86, v86
    v_fma_f32 v72, v86, v86, -v84
    v_mul_f32 v73, v85, v87
    v_cvt_pk_bf16_f32 v108, v74, v75
    v_cvt_pk_bf16_f32 v112, v76, v77
    v_cvt_pk_bf16_f32 v116, v78, v79
    v_cvt_pk_bf16_f32 v120, v80, v81
    v_mul_f32 v84, v67, v69
    v_mul_f32 v85, v67, v68
    v_fma_f32 v68, v66, v68, -v84
    v_fma_f32 v69, -v66, v69, -v85
    v_cvt_pk_bf16_f32 v96, v68, v69
    v_mul_f32 v84, v67, v71
    v_mul_f32 v85, v67, v70
    v_fma_f32 v70, v66, v70, -v84
    v_fma_f32 v71, -v66, v71, -v85
    v_cvt_pk_bf16_f32 v100, v70, v71
    v_mul_f32 v84, v67, v73
    v_mul_f32 v85, v67, v72
    v_fma_f32 v72, v66, v72, -v84
    v_fma_f32 v73, -v66, v73, -v85
    v_cvt_pk_bf16_f32 v104, v72, v73
    v_mov_b32_dpp v64, v28 row_newbcast:0 row_mask:0xf bank_mask:0xf
    v_mov_b32_dpp v65, v29 row_newbcast:0 row_mask:0xf bank_mask:0xf
    v_mov_b32_dpp v66, v30 row_newbcast:0 row_mask:0xf bank_mask:0xf
    v_mov_b32_dpp v67, v31 row_newbcast:0 row_mask:0xf bank_mask:0xf
    v_mul_f32 v82, v64, v47
    v_mul_f32 v83, v65, v47
    v_mul_f32 v84, v64, v45
    v_mul_f32 v85, v65, v45
    v_exp_f32 v82, v82
    v_fract_f32 v83, v83
    v_exp_f32 v84, v84
    v_fract_f32 v85, v85
    v_cos_f32 v74, v83
    v_sin_f32 v75, v83
    v_cos_f32 v70, v85
    v_sin_f32 v71, v85
    v_mul_f32 v74, v74, v82
    v_mul_f32 v75, v75, v82
    v_mul_f32 v70, v70, v84
    v_mul_f32 v71, v71, v84
    v_mul_f32 v82, v75, v75
    v_add_f32 v83, v74, v74
    v_fma_f32 v76, v74, v74, -v82
    v_mul_f32 v77, v83, v75
    v_mul_f32 v82, v77, v77
    v_add_f32 v83, v76, v76
    v_fma_f32 v78, v76, v76, -v82
    v_mul_f32 v79, v83, v77
    v_mul_f32 v82, v79, v79
    v_add_f32 v83, v78, v78
    v_fma_f32 v80, v78, v78, -v82
    v_mul_f32 v81, v83, v79
    v_mul_f32 v82, v81, v81
    v_add_f32 v83, v80, v80
    v_fma_f32 v68, v80, v80, -v82
    v_mul_f32 v69, v83, v81
    v_mul_f32 v84, v71, v71
    v_add_f32 v85, v70, v70
    v_fma_f32 v86, v70, v70, -v84
    v_mul_f32 v87, v85, v71
    v_mul_f32 v84, v87, v87
    v_add_f32 v85, v86, v86
    v_fma_f32 v72, v86, v86, -v84
    v_mul_f32 v73, v85, v87
    v_cvt_pk_bf16_f32 v109, v74, v75
    v_cvt_pk_bf16_f32 v113, v76, v77
    v_cvt_pk_bf16_f32 v117, v78, v79
    v_cvt_pk_bf16_f32 v121, v80, v81
    v_mul_f32 v84, v67, v69
    v_mul_f32 v85, v67, v68
    v_fma_f32 v68, v66, v68, -v84
    v_fma_f32 v69, -v66, v69, -v85
    v_cvt_pk_bf16_f32 v97, v68, v69
    v_mul_f32 v84, v67, v71
    v_mul_f32 v85, v67, v70
    v_fma_f32 v70, v66, v70, -v84
    v_fma_f32 v71, -v66, v71, -v85
    v_cvt_pk_bf16_f32 v101, v70, v71
    v_mul_f32 v84, v67, v73
    v_mul_f32 v85, v67, v72
    v_fma_f32 v72, v66, v72, -v84
    v_fma_f32 v73, -v66, v73, -v85
    v_cvt_pk_bf16_f32 v105, v72, v73
    v_mov_b32_dpp v64, v24 row_newbcast:1 row_mask:0xf bank_mask:0xf
    v_mov_b32_dpp v65, v25 row_newbcast:1 row_mask:0xf bank_mask:0xf
    v_mov_b32_dpp v66, v26 row_newbcast:1 row_mask:0xf bank_mask:0xf
    v_mov_b32_dpp v67, v27 row_newbcast:1 row_mask:0xf bank_mask:0xf
    v_mul_f32 v82, v64, v47
    v_mul_f32 v83, v65, v47
    v_mul_f32 v84, v64, v45
    v_mul_f32 v85, v65, v45
    v_exp_f32 v82, v82
    v_fract_f32 v83, v83
    v_exp_f32 v84, v84
    v_fract_f32 v85, v85
    v_cos_f32 v74, v83
    v_sin_f32 v75, v83
    v_cos_f32 v70, v85
    v_sin_f32 v71, v85
    v_mov_b32_dpp v24, v24 row_ror:2 row_mask:0xf bank_mask:0xf
    v_mov_b32_dpp v25, v25 row_ror:2 row_mask:0xf bank_mask:0xf
    v_mov_b32_dpp v26, v26 row_ror:2 row_mask:0xf bank_mask:0xf
    v_mov_b32_dpp v27, v27 row_ror:2 row_mask:0xf bank_mask:0xf
    v_mul_f32 v74, v74, v82
    v_mul_f32 v75, v75, v82
    v_mul_f32 v70, v70, v84
    v_mul_f32 v71, v71, v84
    v_mul_f32 v82, v75, v75
    v_add_f32 v83, v74, v74
    v_fma_f32 v76, v74, v74, -v82
    v_mul_f32 v77, v83, v75
    v_mul_f32 v82, v77, v77
    v_add_f32 v83, v76, v76
    v_fma_f32 v78, v76, v76, -v82
    v_mul_f32 v79, v83, v77
    v_mul_f32 v82, v79, v79
    v_add_f32 v83, v78, v78
    v_fma_f32 v80, v78, v78, -v82
    v_mul_f32 v81, v83, v79
    v_mul_f32 v82, v81, v81
    v_add_f32 v83, v80, v80
    v_fma_f32 v68, v80, v80, -v82
    v_mul_f32 v69, v83, v81
    v_mul_f32 v84, v71, v71
    v_add_f32 v85, v70, v70
    v_fma_f32 v86, v70, v70, -v84
    v_mul_f32 v87, v85, v71
    v_mul_f32 v84, v87, v87
    v_add_f32 v85, v86, v86
    v_fma_f32 v72, v86, v86, -v84
    v_mul_f32 v73, v85, v87
    v_cvt_pk_bf16_f32 v110, v74, v75
    v_cvt_pk_bf16_f32 v114, v76, v77
    v_cvt_pk_bf16_f32 v118, v78, v79
    v_cvt_pk_bf16_f32 v122, v80, v81
    v_mul_f32 v84, v67, v69
    v_mul_f32 v85, v67, v68
    v_fma_f32 v68, v66, v68, -v84
    v_fma_f32 v69, -v66, v69, -v85
    v_cvt_pk_bf16_f32 v98, v68, v69
    v_mul_f32 v84, v67, v71
    v_mul_f32 v85, v67, v70
    v_fma_f32 v70, v66, v70, -v84
    v_fma_f32 v71, -v66, v71, -v85
    v_cvt_pk_bf16_f32 v102, v70, v71
    v_mul_f32 v84, v67, v73
    v_mul_f32 v85, v67, v72
    v_fma_f32 v72, v66, v72, -v84
    v_fma_f32 v73, -v66, v73, -v85
    v_cvt_pk_bf16_f32 v106, v72, v73
    v_mov_b32_dpp v64, v28 row_newbcast:1 row_mask:0xf bank_mask:0xf
    v_mov_b32_dpp v65, v29 row_newbcast:1 row_mask:0xf bank_mask:0xf
    v_mov_b32_dpp v66, v30 row_newbcast:1 row_mask:0xf bank_mask:0xf
    v_mov_b32_dpp v67, v31 row_newbcast:1 row_mask:0xf bank_mask:0xf
    v_mul_f32 v82, v64, v47
    v_mul_f32 v83, v65, v47
    v_mul_f32 v84, v64, v45
    v_mul_f32 v85, v65, v45
    v_exp_f32 v82, v82
    v_fract_f32 v83, v83
    v_exp_f32 v84, v84
    v_fract_f32 v85, v85
    v_cos_f32 v74, v83
    v_sin_f32 v75, v83
    v_cos_f32 v70, v85
    v_sin_f32 v71, v85
    v_mov_b32_dpp v28, v28 row_ror:2 row_mask:0xf bank_mask:0xf
    v_mov_b32_dpp v29, v29 row_ror:2 row_mask:0xf bank_mask:0xf
    v_mov_b32_dpp v30, v30 row_ror:2 row_mask:0xf bank_mask:0xf
    v_mov_b32_dpp v31, v31 row_ror:2 row_mask:0xf bank_mask:0xf
    v_mul_f32 v74, v74, v82
    v_mul_f32 v75, v75, v82
    v_mul_f32 v70, v70, v84
    v_mul_f32 v71, v71, v84
    v_mul_f32 v82, v75, v75
    v_add_f32 v83, v74, v74
    v_fma_f32 v76, v74, v74, -v82
    v_mul_f32 v77, v83, v75
    v_mul_f32 v82, v77, v77
    v_add_f32 v83, v76, v76
    v_fma_f32 v78, v76, v76, -v82
    v_mul_f32 v79, v83, v77
    v_mul_f32 v82, v79, v79
    v_add_f32 v83, v78, v78
    v_fma_f32 v80, v78, v78, -v82
    v_mul_f32 v81, v83, v79
    v_mul_f32 v82, v81, v81
    v_add_f32 v83, v80, v80
    v_fma_f32 v68, v80, v80, -v82
    v_mul_f32 v69, v83, v81
    v_mul_f32 v84, v71, v71
    v_add_f32 v85, v70, v70
    v_fma_f32 v86, v70, v70, -v84
    v_mul_f32 v87, v85, v71
    v_mul_f32 v84, v87, v87
    v_add_f32 v85, v86, v86
    v_fma_f32 v72, v86, v86, -v84
    v_mul_f32 v73, v85, v87
    v_cvt_pk_bf16_f32 v111, v74, v75
    v_cvt_pk_bf16_f32 v115, v76, v77
    v_cvt_pk_bf16_f32 v119, v78, v79
    v_cvt_pk_bf16_f32 v123, v80, v81
    v_mul_f32 v84, v67, v69
    v_mul_f32 v85, v67, v68
    v_fma_f32 v68, v66, v68, -v84
    v_fma_f32 v69, -v66, v69, -v85
    v_cvt_pk_bf16_f32 v99, v68, v69
    v_mul_f32 v84, v67, v71
    v_mul_f32 v85, v67, v70
    v_fma_f32 v70, v66, v70, -v84
    v_fma_f32 v71, -v66, v71, -v85
    v_cvt_pk_bf16_f32 v103, v70, v71
    v_mul_f32 v84, v67, v73
    v_mul_f32 v85, v67, v72
    v_fma_f32 v72, v66, v72, -v84
    v_fma_f32 v73, -v66, v73, -v85
    v_cvt_pk_bf16_f32 v107, v72, v73
    v_mfma_f32_16x16x32_bf16 v[48:51], v[96:99], v[108:111], v[48:51]
    v_mfma_f32_16x16x32_bf16 v[52:55], v[100:103], v[112:115], v[52:55]
    v_mfma_f32_16x16x32_bf16 v[56:59], v[100:103], v[116:119], v[56:59]
    v_mfma_f32_16x16x32_bf16 v[60:63], v[104:107], v[120:123], v[60:63]
    s_sub_u32 s25, s25, 1
    s_cmp_lg_u32 s25, 0
    s_cbranch_scc1 ss_kg
    s_waitcnt vmcnt(0)
    v_mov_b32 v36, 0x05040100
    v_mov_b32 v37, 0x07060302
    v_lshlrev_b32 v6, 4, v0
    v_perm_b32 v40, v10, v8, v36
    v_perm_b32 v41, v14, v12, v36
    v_perm_b32 v42, v18, v16, v36
    v_perm_b32 v43, v22, v20, v36
    ds_write_b128 v6, v[40:43] offset:512
    s_nop 1
    v_perm_b32 v40, v10, v8, v37
    v_perm_b32 v41, v14, v12, v37
    v_perm_b32 v42, v18, v16, v37
    v_perm_b32 v43, v22, v20, v37
    ds_write_b128 v6, v[40:43] offset:16896
    s_nop 1
    v_perm_b32 v40, v11, v9, v36
    v_perm_b32 v41, v15, v13, v36
    v_perm_b32 v42, v19, v17, v36
    v_perm_b32 v43, v23, v21, v36
    ds_write_b128 v6, v[40:43] offset:33280
    s_nop 1
    v_perm_b32 v40, v11, v9, v37
    v_perm_b32 v41, v15, v13, v37
    v_perm_b32 v42, v19, v17, v37
    v_perm_b32 v43, v23, v21, v37
    ds_write_b128 v6, v[40:43] offset:49664
    s_nop 1
    v_lshlrev_b32 v5, 8, v3
    v_lshl_add_u32 v5, v2, 2, v5
    v_add_u32 v5, v5, v4
    ds_write_b32 v5, v48 offset:4608
    ds_write_b32 v5, v49 offset:4672
    ds_write_b32 v5, v50 offset:4736
    ds_write_b32 v5, v51 offset:4800
    v_cmp_gt_u32 vcc, 2, v3
    s_nop 0
    s_mov_b64 exec, vcc
    ds_write_b32 v5, v52 offset:5632
    ds_write_b32 v5, v53 offset:5696
    ds_write_b32 v5, v54 offset:5760
    ds_write_b32 v5, v55 offset:5824
    ds_write_b32 v5, v60 offset:6656
    ds_write_b32 v5, v61 offset:6720
    ds_write_b32 v5, v62 offset:6784
    ds_write_b32 v5, v63 offset:6848
    s_not_b64 exec, exec
    ds_write_b32 v5, v56 offset:5632
    ds_write_b32 v5, v57 offset:5696
    ds_write_b32 v5, v58 offset:5760
    ds_write_b32 v5, v59 offset:5824
    s_mov_b32 exec_lo, 0
    s_mov_b32 exec_hi, 3
    v_cmp_eq_u32 vcc, 0, v2
    s_nop 1
    v_cndmask_b32 v6, 0, v60, vcc
    ds_write_b32 v5, v6 offset:6656
    s_mov_b64 exec, -1
    s_waitcnt lgkmcnt(0)
    v_lshlrev_b32 v7, 1, v1
    v_sub_u32 v7, 2065, v7
    v_lshl_add_u32 v64, v1, 2, v4
    v_mov_b32 v65, 641
    s_mov_b32 s25, 17
ss_exp:
    v_subrev_u32 v66, 0, v7
    v_cvt_f32_u32 v70, v66
    v_cvt_pk_bf16_f32 v70, v70, v70
    v_and_b32 v70, 0xffff, v70
    v_subrev_u32 v70, 0x4280, v70
    v_cmp_gt_u32 vcc, 256, v66
    s_nop 1
    v_cndmask_b32 v70, v70, v66, vcc
    v_cmp_gt_u32 vcc, 2048, v66
    s_nop 1
    v_cndmask_b32 v70, v65, v70, vcc
    v_lshl_add_u32 v70, v70, 2, v4
    ds_read_b32 v74, v70 offset:4608
    v_subrev_u32 v67, 1, v7
    v_cvt_f32_u32 v71, v67
    v_cvt_pk_bf16_f32 v71, v71, v71
    v_and_b32 v71, 0xffff, v71
    v_subrev_u32 v71, 0x4280, v71
    v_cmp_gt_u32 vcc, 256, v67
    s_nop 1
    v_cndmask_b32 v71, v71, v67, vcc
    v_cmp_gt_u32 vcc, 2048, v67
    s_nop 1
    v_cndmask_b32 v71, v65, v71, vcc
    v_lshl_add_u32 v71, v71, 2, v4
    ds_read_b32 v75, v71 offset:4608
    v_subrev_u32 v68, 2, v7
    v_cvt_f32_u32 v72, v68
    v_cvt_pk_bf16_f32 v72, v72, v72
    v_and_b32 v72, 0xffff, v72
    v_subrev_u32 v72, 0x4280, v72
    v_cmp_gt_u32 vcc, 256, v68
    s_nop 1
    v_cndmask_b32 v72, v72, v68, vcc
    v_cmp_gt_u32 vcc, 2048, v68
    s_nop 1
    v_cndmask_b32 v72, v65, v72, vcc
    v_lshl_add_u32 v72, v72, 2, v4
    ds_read_b32 v76, v72 offset:4608
    s_waitcnt lgkmcnt(0)
    v_cvt_pk_bf16_f32 v78, v75, v76
    v_cvt_pk_bf16_f32 v79, v74, v75
    ds_write_b32 v64, v78 offset:7424
    ds_write_b32 v64, v79 offset:11776
    v_subrev_u32 v7, 128, v7
    v_add_u32 v64, 256, v64
    s_sub_u32 s25, s25, 1
    s_cmp_lg_u32 s25, 0
    s_cbranch_scc1 ss_exp
    s_waitcnt lgkmcnt(0)
    s_barrier
    v_and_b32 v5, 1, v2
    v_mul_u32_u24 v64, 4352, v5
    v_sub_u32 v5, v5, v2
    v_lshl_add_u32 v5, v3, 3, v5
    v_lshl_add_u32 v64, v5, 1, v64
    v_add_u32 v64, 11520, v64
    v_add_u32 v64, v64, v4
    v_lshlrev_b32 v65, 5, v2
    v_lshl_add_u32 v65, v3, 4, v65
    v_add_u32 v65, 480, v65
    v_add_u32 v65, v65, v4
    v_mov_b32 v96, 0
    v_mov_b32 v97, 0
    v_mov_b32 v98, 0
    v_mov_b32 v99, 0
    v_mov_b32 v100, 0
    v_mov_b32 v101, 0
    v_mov_b32 v102, 0
    v_mov_b32 v103, 0
    v_mov_b32 v104, 0
    v_mov_b32 v105, 0
    v_mov_b32 v106, 0
    v_mov_b32 v107, 0
    v_mov_b32 v108, 0
    v_mov_b32 v109, 0
    v_mov_b32 v110, 0
    v_mov_b32 v111, 0
    v_mov_b32 v112, 0
    v_mov_b32 v113, 0
    v_mov_b32 v114, 0
    v_mov_b32 v115, 0
    v_mov_b32 v116, 0
    v_mov_b32 v117, 0
    v_mov_b32 v118, 0
    v_mov_b32 v119, 0
    v_mov_b32 v120, 0
    v_mov_b32 v121, 0
    v_mov_b32 v122, 0
    v_mov_b32 v123, 0
    v_mov_b32 v124, 0
    v_mov_b32 v125, 0
    v_mov_b32 v126, 0
    v_mov_b32 v127, 0
    v_subrev_u32 v66, 512, v64
    v_subrev_u32 v67, 1536, v64
    v_subrev_u32 v68, 2560, v64
    v_subrev_u32 v69, 3584, v64
    s_mov_b32 s25, 8
    s_nop 0
ss_cv:
    ds_read2_b32 v[160:161], v66 offset0:128 offset1:129
    ds_read2_b32 v[162:163], v66 offset0:130 offset1:131
    ds_read_b128 v[128:131], v65 offset:0
    ds_read_b128 v[132:135], v65 offset:512
    ds_read_b128 v[136:139], v65 offset:1024
    ds_read_b128 v[140:143], v65 offset:1536
    ds_read_b128 v[144:147], v65 offset:2048
    ds_read_b128 v[148:151], v65 offset:2560
    ds_read_b128 v[152:155], v65 offset:3072
    ds_read_b128 v[156:159], v65 offset:3584
    ds_read2_b32 v[164:165], v66 offset0:0 offset1:1
    ds_read2_b32 v[166:167], v66 offset0:2 offset1:3
    s_waitcnt lgkmcnt(9)
    v_mfma_f32_16x16x32_bf16 v[96:99], v[160:163], v[128:131], v[96:99]
    s_waitcnt lgkmcnt(8)
    v_mfma_f32_16x16x32_bf16 v[100:103], v[160:163], v[132:135], v[100:103]
    s_waitcnt lgkmcnt(7)
    v_mfma_f32_16x16x32_bf16 v[104:107], v[160:163], v[136:139], v[104:107]
    ds_read2_b32 v[168:169], v67 offset0:128 offset1:129
    ds_read2_b32 v[170:171], v67 offset0:130 offset1:131
    s_waitcnt lgkmcnt(8)
    v_mfma_f32_16x16x32_bf16 v[108:111], v[160:163], v[140:143], v[108:111]
    s_waitcnt lgkmcnt(7)
    v_mfma_f32_16x16x32_bf16 v[112:115], v[160:163], v[144:147], v[112:115]
    ds_read2_b32 v[172:173], v67 offset0:0 offset1:1
    ds_read2_b32 v[174:175], v67 offset0:2 offset1:3
    s_waitcnt lgkmcnt(8)
    v_mfma_f32_16x16x32_bf16 v[116:119], v[160:163], v[148:151], v[116:119]
    s_waitcnt lgkmcnt(7)
    v_mfma_f32_16x16x32_bf16 v[120:123], v[160:163], v[152:155], v[120:123]
    ds_read2_b32 v[176:177], v68 offset0:128 offset1:129
    ds_read2_b32 v[178:179], v68 offset0:130 offset1:131
    s_waitcnt lgkmcnt(8)
    v_mfma_f32_16x16x32_bf16 v[124:127], v[160:163], v[156:159], v[124:127]
    s_waitcnt lgkmcnt(6)
    v_mfma_f32_16x16x32_bf16 v[100:103], v[164:167], v[128:131], v[100:103]
    v_mfma_f32_16x16x32_bf16 v[104:107], v[164:167], v[132:135], v[104:107]
    ds_read2_b32 v[180:181], v68 offset0:0 offset1:1
    ds_read2_b32 v[182:183], v68 offset0:2 offset1:3
    v_mfma_f32_16x16x32_bf16 v[108:111], v[164:167], v[136:139], v[108:111]
    v_mfma_f32_16x16x32_bf16 v[112:115], v[164:167], v[140:143], v[112:115]
    ds_read2_b32 v[184:185], v69 offset0:128 offset1:129
    ds_read2_b32 v[186:187], v69 offset0:130 offset1:131
    v_mfma_f32_16x16x32_bf16 v[116:119], v[164:167], v[144:147], v[116:119]
    v_mfma_f32_16x16x32_bf16 v[120:123], v[164:167], v[148:151], v[120:123]
    ds_read2_b32 v[188:189], v69 offset0:0 offset1:1
    ds_read2_b32 v[190:191], v69 offset0:2 offset1:3
    v_mfma_f32_16x16x32_bf16 v[124:127], v[164:167], v[152:155], v[124:127]
    s_waitcnt lgkmcnt(10)
    v_mfma_f32_16x16x32_bf16 v[104:107], v[168:171], v[128:131], v[104:107]
    v_mfma_f32_16x16x32_bf16 v[108:111], v[168:171], v[132:135], v[108:111]
    v_mfma_f32_16x16x32_bf16 v[112:115], v[168:171], v[136:139], v[112:115]
    v_mfma_f32_16x16x32_bf16 v[116:119], v[168:171], v[140:143], v[116:119]
    v_mfma_f32_16x16x32_bf16 v[120:123], v[168:171], v[144:147], v[120:123]
    v_mfma_f32_16x16x32_bf16 v[124:127], v[168:171], v[148:151], v[124:127]
    s_waitcnt lgkmcnt(8)
    v_mfma_f32_16x16x32_bf16 v[108:111], v[172:175], v[128:131], v[108:111]
    v_subrev_u32 v66, 64, v66
    v_mfma_f32_16x16x32_bf16 v[112:115], v[172:175], v[132:135], v[112:115]
    v_subrev_u32 v67, 64, v67
    v_mfma_f32_16x16x32_bf16 v[116:119], v[172:175], v[136:139], v[116:119]
    v_subrev_u32 v68, 64, v68
    v_mfma_f32_16x16x32_bf16 v[120:123], v[172:175], v[140:143], v[120:123]
    v_subrev_u32 v69, 64, v69
    v_mfma_f32_16x16x32_bf16 v[124:127], v[172:175], v[144:147], v[124:127]
    v_subrev_u32 v65, 64, v65
    s_waitcnt lgkmcnt(6)
    v_mfma_f32_16x16x32_bf16 v[112:115], v[176:179], v[128:131], v[112:115]
    v_mfma_f32_16x16x32_bf16 v[116:119], v[176:179], v[132:135], v[116:119]
    v_mfma_f32_16x16x32_bf16 v[120:123], v[176:179], v[136:139], v[120:123]
    v_mfma_f32_16x16x32_bf16 v[124:127], v[176:179], v[140:143], v[124:127]
    s_waitcnt lgkmcnt(4)
    v_mfma_f32_16x16x32_bf16 v[116:119], v[180:183], v[128:131], v[116:119]
    v_mfma_f32_16x16x32_bf16 v[120:123], v[180:183], v[132:135], v[120:123]
    v_mfma_f32_16x16x32_bf16 v[124:127], v[180:183], v[136:139], v[124:127]
    s_waitcnt lgkmcnt(2)
    v_mfma_f32_16x16x32_bf16 v[120:123], v[184:187], v[128:131], v[120:123]
    v_mfma_f32_16x16x32_bf16 v[124:127], v[184:187], v[132:135], v[124:127]
    s_waitcnt lgkmcnt(0)
    v_mfma_f32_16x16x32_bf16 v[124:127], v[188:191], v[128:131], v[124:127]
    s_sub_u32 s25, s25, 1
    s_cmp_lg_u32 s25, 0
    s_cbranch_scc1 ss_cv
    s_nop 4
    v_lshlrev_b32 v5, 6, v2
    v_lshl_add_u32 v5, v3, 4, v5
    v_add_u32 v5, v5, v4
    ds_write_b128 v5, v[96:99] offset:7424
    ds_write_b128 v5, v[100:103] offset:8448
    ds_write_b128 v5, v[104:107] offset:9472
    ds_write_b128 v5, v[108:111] offset:10496
    ds_write_b128 v5, v[112:115] offset:11520
    ds_write_b128 v5, v[116:119] offset:12544
    ds_write_b128 v5, v[120:123] offset:13568
    ds_write_b128 v5, v[124:127] offset:14592
    s_mov_b32 s12, s74
    s_mov_b32 s13, s75
    s_mov_b32 s14, 1152
    s_mov_b32 s15, 0x20000
    s_lshl_b32 s23, s20, 1
    buffer_load_dwordx2 v[24:25], off, s[12:15], s23
    s_waitcnt vmcnt(0) lgkmcnt(0)
    s_barrier
    v_lshlrev_b32 v26, 16, v24
    v_and_b32 v27, 0xffff0000, v24
    v_lshlrev_b32 v28, 16, v25
    v_and_b32 v29, 0xffff0000, v25
    v_lshlrev_b32 v5, 5, v0
    ds_read_b128 v[64:67], v5 offset:7424
    ds_read_b128 v[68:71], v5 offset:7440
    ds_read_b128 v[72:75], v5 offset:23808
    ds_read_b128 v[76:79], v5 offset:23824
    ds_read_b128 v[80:83], v5 offset:40192
    ds_read_b128 v[84:87], v5 offset:40208
    ds_read_b128 v[88:91], v5 offset:56576
    ds_read_b128 v[92:95], v5 offset:56592
    s_waitcnt lgkmcnt(0)
    v_mul_u32_u24 v5, 18432, v0
    s_lshl_b32 s22, s20, 1
    s_add_u32 s22, s22, 1152
    v_lshlrev_b32 v6, 16, v8
    v_fmac_f32 v64, v6, v26
    v_and_b32 v6, 0xffff0000, v8
    v_fmac_f32 v72, v6, v27
    v_lshlrev_b32 v6, 16, v9
    v_fmac_f32 v80, v6, v28
    v_and_b32 v6, 0xffff0000, v9
    v_fmac_f32 v88, v6, v29
    v_cvt_pk_bf16_f32 v8, v64, v72
    v_cvt_pk_bf16_f32 v9, v80, v88
    s_add_u32 s23, s22, 0
    buffer_store_dwordx2 v[8:9], v5, s[16:19], s23 offen
    v_lshlrev_b32 v6, 16, v10
    v_fmac_f32 v65, v6, v26
    v_and_b32 v6, 0xffff0000, v10
    v_fmac_f32 v73, v6, v27
    v_lshlrev_b32 v6, 16, v11
    v_fmac_f32 v81, v6, v28
    v_and_b32 v6, 0xffff0000, v11
    v_fmac_f32 v89, v6, v29
    v_cvt_pk_bf16_f32 v10, v65, v73
    v_cvt_pk_bf16_f32 v11, v81, v89
    s_add_u32 s23, s22, 2304
    buffer_store_dwordx2 v[10:11], v5, s[16:19], s23 offen
    v_lshlrev_b32 v6, 16, v12
    v_fmac_f32 v66, v6, v26
    v_and_b32 v6, 0xffff0000, v12
    v_fmac_f32 v74, v6, v27
    v_lshlrev_b32 v6, 16, v13
    v_fmac_f32 v82, v6, v28
    v_and_b32 v6, 0xffff0000, v13
    v_fmac_f32 v90, v6, v29
    v_cvt_pk_bf16_f32 v12, v66, v74
    v_cvt_pk_bf16_f32 v13, v82, v90
    s_add_u32 s23, s22, 4608
    buffer_store_dwordx2 v[12:13], v5, s[16:19], s23 offen
    v_lshlrev_b32 v6, 16, v14
    v_fmac_f32 v67, v6, v26
    v_and_b32 v6, 0xffff0000, v14
    v_fmac_f32 v75, v6, v27
    v_lshlrev_b32 v6, 16, v15
    v_fmac_f32 v83, v6, v28
    v_and_b32 v6, 0xffff0000, v15
    v_fmac_f32 v91, v6, v29
    v_cvt_pk_bf16_f32 v14, v67, v75
    v_cvt_pk_bf16_f32 v15, v83, v91
    s_add_u32 s23, s22, 6912
    buffer_store_dwordx2 v[14:15], v5, s[16:19], s23 offen
    v_lshlrev_b32 v6, 16, v16
    v_fmac_f32 v68, v6, v26
    v_and_b32 v6, 0xffff0000, v16
    v_fmac_f32 v76, v6, v27
    v_lshlrev_b32 v6, 16, v17
    v_fmac_f32 v84, v6, v28
    v_and_b32 v6, 0xffff0000, v17
    v_fmac_f32 v92, v6, v29
    v_cvt_pk_bf16_f32 v16, v68, v76
    v_cvt_pk_bf16_f32 v17, v84, v92
    s_add_u32 s23, s22, 9216
    buffer_store_dwordx2 v[16:17], v5, s[16:19], s23 offen
    v_lshlrev_b32 v6, 16, v18
    v_fmac_f32 v69, v6, v26
    v_and_b32 v6, 0xffff0000, v18
    v_fmac_f32 v77, v6, v27
    v_lshlrev_b32 v6, 16, v19
    v_fmac_f32 v85, v6, v28
    v_and_b32 v6, 0xffff0000, v19
    v_fmac_f32 v93, v6, v29
    v_cvt_pk_bf16_f32 v18, v69, v77
    v_cvt_pk_bf16_f32 v19, v85, v93
    s_add_u32 s23, s22, 11520
    buffer_store_dwordx2 v[18:19], v5, s[16:19], s23 offen
    v_lshlrev_b32 v6, 16, v20
    v_fmac_f32 v70, v6, v26
    v_and_b32 v6, 0xffff0000, v20
    v_fmac_f32 v78, v6, v27
    v_lshlrev_b32 v6, 16, v21
    v_fmac_f32 v86, v6, v28
    v_and_b32 v6, 0xffff0000, v21
    v_fmac_f32 v94, v6, v29
    v_cvt_pk_bf16_f32 v20, v70, v78
    v_cvt_pk_bf16_f32 v21, v86, v94
    s_add_u32 s23, s22, 13824
    buffer_store_dwordx2 v[20:21], v5, s[16:19], s23 offen
    v_lshlrev_b32 v6, 16, v22
    v_fmac_f32 v71, v6, v26
    v_and_b32 v6, 0xffff0000, v22
    v_fmac_f32 v79, v6, v27
    v_lshlrev_b32 v6, 16, v23
    v_fmac_f32 v87, v6, v28
    v_and_b32 v6, 0xffff0000, v23
    v_fmac_f32 v95, v6, v29
    v_cvt_pk_bf16_f32 v22, v71, v79
    v_cvt_pk_bf16_f32 v23, v87, v95
    s_add_u32 s23, s22, 16128
    buffer_store_dwordx2 v[22:23], v5, s[16:19], s23 offen
    s_cmp_ge_u32 s20, 448
    s_cbranch_scc1 L_exit
    s_branch L_ssm_next
L_phase2:
    v_and_b32 v1, 63, v0
    v_min_u32 v1, 6, v1
    v_lshlrev_b32 v2, 2, v1
    s_cmp_lg_u32 s32, 0
    v_mov_b32 v251, 163832
    s_cbranch_scc1 sw10
    buffer_load_dword v3, v2, s[96:99], 0 offen offset:32 sc1
    v_mov_b32 v4, 32
    s_waitcnt vmcnt(0)
    v_cmp_lt_u32 vcc, v3, v4
    s_nop 0
    s_ff1_i32_b64 s40, vcc
    v_mov_b32 v250, s40
    ds_write_b32 v251, v250
    s_waitcnt lgkmcnt(0)
sw10:
    s_barrier
    ds_read_b32 v252, v251
    s_waitcnt lgkmcnt(0)
    v_readfirstlane_b32 s33, v252
    s_barrier
    s_nop 1
    s_cmp_lt_u32 s33, 7
    s_cbranch_scc1 L_pool
    s_mov_b32 s88, 4194304
gn11:
    s_cmp_lg_u32 s95, 0
    s_cbranch_scc1 gn11x
    buffer_load_dword v250, off, s[96:99], 0 offset:64 sc1
    s_sub_u32 s88, s88, 1
    s_cbranch_scc1 gn11x
    s_waitcnt vmcnt(0)
    v_readfirstlane_b32 s95, v250
    s_nop 1
    s_branch gn11
gn11x:
    s_mov_b32 s40, 524288
mc2_w:
    buffer_load_dword v250, off, s[96:99], 0 offset:140 sc1
    s_waitcnt vmcnt(0)
    v_readfirstlane_b32 s41, v250
    s_nop 0
    s_cmp_lg_u32 s41, 0
    s_cbranch_scc1 mc2_known
    s_sub_u32 s40, s40, 1
    s_cbranch_scc1 mc2_force
    s_sleep 2
    s_branch mc2_w
mc2_force:
    v_mov_b32 v250, 2
    v_mov_b32 v251, 0
    s_mov_b64 exec, 1
    buffer_atomic_cmpswap v[250:251], off, s[96:99], 0 offset:140
    s_mov_b64 exec, -1
    s_waitcnt vmcnt(0)
    s_mov_b32 s40, 524288
    s_branch mc2_w
mc2_known:
    s_cmp_eq_u32 s41, 1
    s_cbranch_scc1 L_phase2b
    s_mov_b32 s37, 208
    v_mov_b32 v250, 1
    v_mov_b32 v251, 163832
    v_cmp_eq_u32 vcc, 0, v0
    s_nop 0
    s_and_saveexec_b64 s[38:39], vcc
    s_cbranch_execz tk12
    buffer_atomic_add v250, off, s[96:99], s37 sc0
    s_waitcnt vmcnt(0)
    ds_write_b32 v251, v250
    s_waitcnt lgkmcnt(0)
tk12:
    s_mov_b64 exec, -1
    s_barrier
    ds_read_b32 v252, v251
    s_waitcnt lgkmcnt(0)
    v_readfirstlane_b32 s12, v252
    s_barrier
    s_nop 3
    s_cmp_lt_u32 s12, 32
    s_cbranch_scc1 L_chain_safe
L_phase2b:
    s_mov_b32 s47, 0
    s_mov_b32 s46, 0
    s_mov_b32 s8, s76
    s_mov_b32 s9, s77
    s_mov_b32 s10, 4718592
    s_mov_b32 s11, 0x20000
    s_sub_u32 s33, s3, 4
    s_and_b32 s33, s33, 7
    s_cmp_ge_u32 s33, 6
    s_cbranch_scc1 L_p2scan
L_p2take:
    s_lshl_b32 s35, s33, 2
    s_add_u32 s35, s35, 160
    s_mov_b32 s37, s35
    v_mov_b32 v250, 1
    v_mov_b32 v251, 163832
    v_cmp_eq_u32 vcc, 0, v0
    s_nop 0
    s_and_saveexec_b64 s[38:39], vcc
    s_cbranch_execz tk13
    buffer_atomic_add v250, off, s[96:99], s37 sc0
    s_waitcnt vmcnt(0)
    ds_write_b32 v251, v250
    s_waitcnt lgkmcnt(0)
tk13:
    s_mov_b64 exec, -1
    s_barrier
    ds_read_b32 v252, v251
    s_waitcnt lgkmcnt(0)
    v_readfirstlane_b32 s34, v252
    s_barrier
    s_nop 3
    s_bitcmp1_b32 54, s33
    s_cselect_b32 s36, 9, 8
    s_cmp_lt_u32 s34, s36
    s_cbranch_scc1 L_att0
    s_sub_u32 s34, s34, s36
    s_cmp_ge_u32 s34, 18
    s_cbranch_scc1 L_p2scan
    s_branch L_op_start
    s_mul_i32 s36, s33, 3
    s_add_u32 s36, s36, s34
    s_sub_u32 s37, s34, 3
    s_cmp_lt_u32 s34, 3
    s_cselect_b32 s34, s36, s37
    s_cselect_b32 s33, 6, s33
    s_branch L_op_start
L_p2scan:
    v_and_b32 v1, 63, v0
    v_min_u32 v1, 5, v1
    v_lshlrev_b32 v2, 2, v1
    s_cmp_lg_u32 s32, 0
    v_mov_b32 v251, 163832
    s_cbranch_scc1 sw14
    buffer_load_dword v3, v2, s[96:99], 0 offen offset:160 sc1
    v_mov_b32 v4, 26
    v_lshrrev_b32 v5, v1, 54
    v_and_b32 v5, 1, v5
    v_add_u32 v4, v4, v5
    s_waitcnt vmcnt(0)
    v_cmp_lt_u32 vcc, v3, v4
    s_nop 0
    s_ff1_i32_b64 s40, vcc
    v_mov_b32 v250, s40
    ds_write_b32 v251, v250
    s_waitcnt lgkmcnt(0)
sw14:
    s_barrier
    ds_read_b32 v252, v251
    s_waitcnt lgkmcnt(0)
    v_readfirstlane_b32 s33, v252
    s_barrier
    s_nop 1
    s_cmp_lt_u32 s33, 7
    s_cbranch_scc1 L_p2take
    s_branch L_done
L_att0:
    s_mul_i32 s34, s34, 6
    s_add_u32 s34, s34, s33
    s_cmp_ge_u32 s34, 48
    s_cbranch_scc1 L_done
L_att_next:
    s_lshr_b32 s16, s34, 3
    s_and_b32 s17, s34, 7
    s_lshl_b32 s17, s17, 2
    s_add_u32 s17, s17, s32
    s_lshr_b32 s36, s17, 1
    s_lshl_b32 s36, s36, 8
    s_add_u32 s36, s36, 125829120
    s_mul_i32 s37, s16, 43
    s_lshr_b32 s37, s37, 8
    s_mul_i32 s41, s37, 6
    s_sub_u32 s41, s16, s41
    v_and_b32 v1, 63, v0
    v_mul_u32_u24 v2, 6, v1
    v_add_u32 v2, s41, v2
    v_mov_b32 v4, s37
    s_and_b32 s41, s16, 7
    s_add_u32 s41, s41, 12
    s_lshr_b32 s37, s16, 3
    v_mov_b32 v5, s41
    v_mov_b32 v6, s37
    v_cmp_lt_u32 vcc, 1, v1
    s_nop 1
    v_cndmask_b32 v2, v2, v5, vcc
    v_cndmask_b32 v4, v4, v6, vcc
    v_lshlrev_b32 v2, 2, v2
    v_add3_u32 v4, v4, s95, 1
    s_mov_b32 s40, 4194304
L_aw1:
    buffer_load_dword v3, v2, s[4:7], s36 offen sc1
    s_sub_u32 s40, s40, 1
    s_cbranch_scc1 L_aw1_go
    s_waitcnt vmcnt(0)
    v_subrev_u32 v3, v4, v3
    v_cmp_lt_u32 vcc, 64, v3
    s_cbranch_vccz L_aw1_go
    s_sleep 4
    s_branch L_aw1
L_aw1_go:
    v_and_b32 v5, 63, v0
    v_lshlrev_b32 v1, 4, v5
    v_or_b32 v3, 128, v1
    v_lshrrev_b32 v4, 4, v5
    v_bfe_u32 v6, v5, 2, 2
    v_sub_u32 v4, v6, v4
    v_lshlrev_b32 v4, 3, v4
    v_and_b32 v6, 3, v5
    v_add_u32 v4, v4, v6
    v_mov_b32 v6, 0xf149f2ca
    s_mov_b32 s22, 0x3e0293ee
    s_lshl_b32 s18, s16, 5
    s_add_u32 s18, s18, s17
    s_lshl_b32 s19, s18, 13
    s_add_u32 s20, s19, 33554432
    buffer_load_dwordx4 v[8:11], v1, s[4:7], s20 offen offset:0 sc1
    s_add_u32 s20, s19, 33554432
    buffer_load_dwordx4 v[12:15], v1, s[4:7], s20 offen offset:1024 sc1
    s_add_u32 s20, s19, 33554432
    buffer_load_dwordx4 v[16:19], v1, s[4:7], s20 offen offset:2048 sc1
    s_add_u32 s20, s19, 33554432
    buffer_load_dwordx4 v[20:23], v1, s[4:7], s20 offen offset:3072 sc1
    s_add_u32 s20, s19, 33558528
    buffer_load_dwordx4 v[24:27], v1, s[4:7], s20 offen offset:0 sc1
    s_add_u32 s20, s19, 33558528
    buffer_load_dwordx4 v[28:31], v1, s[4:7], s20 offen offset:1024 sc1
    s_add_u32 s20, s19, 33558528
    buffer_load_dwordx4 v[32:35], v1, s[4:7], s20 offen offset:2048 sc1
    s_add_u32 s20, s19, 33558528
    buffer_load_dwordx4 v[36:39], v1, s[4:7], s20 offen offset:3072 sc1
    s_lshl_b32 s21, s18, 14
    s_add_u32 s20, s21, 0
    buffer_load_dwordx4 v[40:43], v1, s[4:7], s20 offen offset:0 sc1
    s_add_u32 s20, s21, 4096
    buffer_load_dwordx4 v[44:47], v1, s[4:7], s20 offen offset:0 sc1
    s_add_u32 s20, s21, 8192
    buffer_load_dwordx4 v[48:51], v1, s[4:7], s20 offen offset:0 sc1
    s_add_u32 s20, s21, 12288
    buffer_load_dwordx4 v[52:55], v1, s[4:7], s20 offen offset:0 sc1
    s_add_u32 s20, s21, 0
    buffer_load_dwordx4 v[56:59], v1, s[4:7], s20 offen offset:1024 sc1
    s_add_u32 s20, s21, 4096
    buffer_load_dwordx4 v[60:63], v1, s[4:7], s20 offen offset:1024 sc1
    s_add_u32 s20, s21, 8192
    buffer_load_dwordx4 v[64:67], v1, s[4:7], s20 offen offset:1024 sc1
    s_add_u32 s20, s21, 12288
    buffer_load_dwordx4 v[68:71], v1, s[4:7], s20 offen offset:1024 sc1
    s_add_u32 s20, s21, 0
    buffer_load_dwordx4 v[88:91], v1, s[4:7], s20 offen offset:2048 sc1
    s_add_u32 s20, s21, 4096
    buffer_load_dwordx4 v[92:95], v1, s[4:7], s20 offen offset:2048 sc1
    s_add_u32 s20, s21, 8192
    buffer_load_dwordx4 v[96:99], v1, s[4:7], s20 offen offset:2048 sc1
    s_add_u32 s20, s21, 12288
    buffer_load_dwordx4 v[100:103], v1, s[4:7], s20 offen offset:2048 sc1
    s_add_u32 s20, s21, 0
    buffer_load_dwordx4 v[104:107], v1, s[4:7], s20 offen offset:3072 sc1
    s_add_u32 s20, s21, 4096
    buffer_load_dwordx4 v[108:111], v1, s[4:7], s20 offen offset:3072 sc1
    s_add_u32 s20, s21, 8192
    buffer_load_dwordx4 v[112:115], v1, s[4:7], s20 offen offset:3072 sc1
    s_add_u32 s20, s21, 12288
    buffer_load_dwordx4 v[116:119], v1, s[4:7], s20 offen offset:3072 sc1
    v_mov_b32 v172, 0x3f803f80
    v_mov_b32 v173, 0x3f803f80
    v_mov_b32 v174, 0x3f803f80
    v_mov_b32 v175, 0x3f803f80
    v_mov_b32 v176, 0x3f003f00
    v_mov_b32 v177, 0x3f003f00
    s_waitcnt vmcnt(8)
    v_mfma_f32_16x16x32_bf16 v[136:139], v[40:43], v[8:11], 0
    v_mfma_f32_16x16x32_bf16 v[140:143], v[56:59], v[8:11], 0
    v_mfma_f32_16x16x32_bf16 v[148:151], v[40:43], v[24:27], 0
    v_mfma_f32_16x16x32_bf16 v[152:155], v[56:59], v[24:27], 0
    v_mfma_f32_16x16x32_bf16 v[136:139], v[44:47], v[12:15], v[136:139]
    v_mfma_f32_16x16x32_bf16 v[140:143], v[60:63], v[12:15], v[140:143]
    v_mfma_f32_16x16x32_bf16 v[148:151], v[44:47], v[28:31], v[148:151]
    v_mfma_f32_16x16x32_bf16 v[152:155], v[60:63], v[28:31], v[152:155]
    v_mfma_f32_16x16x32_bf16 v[136:139], v[48:51], v[16:19], v[136:139]
    v_mfma_f32_16x16x32_bf16 v[140:143], v[64:67], v[16:19], v[140:143]
    v_mfma_f32_16x16x32_bf16 v[148:151], v[48:51], v[32:35], v[148:151]
    v_mfma_f32_16x16x32_bf16 v[152:155], v[64:67], v[32:35], v[152:155]
    v_mfma_f32_16x16x32_bf16 v[136:139], v[52:55], v[20:23], v[136:139]
    v_mfma_f32_16x16x32_bf16 v[140:143], v[68:71], v[20:23], v[140:143]
    v_mfma_f32_16x16x32_bf16 v[148:151], v[52:55], v[36:39], v[148:151]
    v_mfma_f32_16x16x32_bf16 v[152:155], v[68:71], v[36:39], v[152:155]
    v_cmp_le_i32 vcc, 0, v4
    s_nop 1
    v_cndmask_b32 v136, v6, v136, vcc
    v_cmp_le_i32 vcc, 1, v4
    s_nop 1
    v_cndmask_b32 v137, v6, v137, vcc
    v_cmp_le_i32 vcc, 2, v4
    s_nop 1
    v_cndmask_b32 v138, v6, v138, vcc
    v_cmp_le_i32 vcc, 3, v4
    s_nop 1
    v_cndmask_b32 v139, v6, v139, vcc
    v_cmp_le_i32 vcc, 4, v4
    s_nop 1
    v_cndmask_b32 v140, v6, v140, vcc
    v_cmp_le_i32 vcc, 5, v4
    s_nop 1
    v_cndmask_b32 v141, v6, v141, vcc
    v_cmp_le_i32 vcc, 6, v4
    s_nop 1
    v_cndmask_b32 v142, v6, v142, vcc
    v_cmp_le_i32 vcc, 7, v4
    s_nop 1
    v_cndmask_b32 v143, v6, v143, vcc
    v_cmp_le_i32 vcc, -4, v4
    s_nop 1
    v_cndmask_b32 v148, v6, v148, vcc
    v_cmp_le_i32 vcc, -3, v4
    s_nop 1
    v_cndmask_b32 v149, v6, v149, vcc
    v_cmp_le_i32 vcc, -2, v4
    s_nop 1
    v_cndmask_b32 v150, v6, v150, vcc
    v_cmp_le_i32 vcc, -1, v4
    s_nop 1
    v_cndmask_b32 v151, v6, v151, vcc
    v_cmp_le_i32 vcc, 0, v4
    s_nop 1
    v_cndmask_b32 v152, v6, v152, vcc
    v_cmp_le_i32 vcc, 1, v4
    s_nop 1
    v_cndmask_b32 v153, v6, v153, vcc
    v_cmp_le_i32 vcc, 2, v4
    s_nop 1
    v_cndmask_b32 v154, v6, v154, vcc
    v_cmp_le_i32 vcc, 3, v4
    s_nop 1
    v_cndmask_b32 v155, v6, v155, vcc
    v_max3_f32 v196, v136, v137, v138
    v_max3_f32 v196, v196, v139, v140
    v_max3_f32 v196, v196, v141, v142
    v_max_f32 v196, v196, v143
    v_mov_b32 v197, v196
    s_nop 1
    v_permlane32_swap_b32 v196, v197
    v_max_f32 v196, v196, v197
    v_mov_b32 v197, v196
    s_nop 1
    v_permlane16_swap_b32 v196, v197
    v_max_f32 v196, v196, v197
    v_mul_f32 v192, s22, v196
    v_fma_f32 v136, v136, s22, -v192
    v_fma_f32 v137, v137, s22, -v192
    v_fma_f32 v138, v138, s22, -v192
    v_fma_f32 v139, v139, s22, -v192
    v_fma_f32 v140, v140, s22, -v192
    v_fma_f32 v141, v141, s22, -v192
    v_fma_f32 v142, v142, s22, -v192
    v_fma_f32 v143, v143, s22, -v192
    v_exp_f32 v136, v136
    v_exp_f32 v137, v137
    v_exp_f32 v138, v138
    v_exp_f32 v139, v139
    v_exp_f32 v140, v140
    v_exp_f32 v141, v141
    v_exp_f32 v142, v142
    v_exp_f32 v143, v143
    v_cvt_pk_bf16_f32 v160, v136, v137
    v_cvt_pk_bf16_f32 v161, v138, v139
    v_cvt_pk_bf16_f32 v162, v140, v141
    v_cvt_pk_bf16_f32 v163, v142, v143
    v_max3_f32 v196, v148, v149, v150
    v_max3_f32 v196, v196, v151, v152
    v_max3_f32 v196, v196, v153, v154
    v_max_f32 v196, v196, v155
    v_mov_b32 v197, v196
    s_nop 1
    v_permlane32_swap_b32 v196, v197
    v_max_f32 v196, v196, v197
    v_mov_b32 v197, v196
    s_nop 1
    v_permlane16_swap_b32 v196, v197
    v_max_f32 v196, v196, v197
    v_mul_f32 v193, s22, v196
    v_fma_f32 v148, v148, s22, -v193
    v_fma_f32 v149, v149, s22, -v193
    v_fma_f32 v150, v150, s22, -v193
    v_fma_f32 v151, v151, s22, -v193
    v_fma_f32 v152, v152, s22, -v193
    v_fma_f32 v153, v153, s22, -v193
    v_fma_f32 v154, v154, s22, -v193
    v_fma_f32 v155, v155, s22, -v193
    v_exp_f32 v148, v148
    v_exp_f32 v149, v149
    v_exp_f32 v150, v150
    v_exp_f32 v151, v151
    v_exp_f32 v152, v152
    v_exp_f32 v153, v153
    v_exp_f32 v154, v154
    v_exp_f32 v155, v155
    v_cvt_pk_bf16_f32 v166, v148, v149
    v_cvt_pk_bf16_f32 v167, v150, v151
    v_cvt_pk_bf16_f32 v168, v152, v153
    v_cvt_pk_bf16_f32 v169, v154, v155
    v_mfma_f32_16x16x32_bf16 v[180:183], v[172:175], v[160:163], 0
    v_mfma_f32_16x16x32_bf16 v[184:187], v[172:175], v[166:169], 0
    s_waitcnt vmcnt(7)
    v_mfma_f32_16x16x32_bf16 v[40:43], v[88:91], v[160:163], 0
    s_waitcnt vmcnt(3)
    v_mfma_f32_16x16x32_bf16 v[44:47], v[104:107], v[160:163], 0
    v_mfma_f32_16x16x32_bf16 v[48:51], v[88:91], v[166:169], 0
    v_mfma_f32_16x16x32_bf16 v[52:55], v[104:107], v[166:169], 0
    v_mfma_f32_16x16x32_bf16 v[56:59], v[92:95], v[160:163], 0
    s_waitcnt vmcnt(2)
    v_mfma_f32_16x16x32_bf16 v[60:63], v[108:111], v[160:163], 0
    v_mfma_f32_16x16x32_bf16 v[64:67], v[92:95], v[166:169], 0
    v_mfma_f32_16x16x32_bf16 v[68:71], v[108:111], v[166:169], 0
    v_mfma_f32_16x16x32_bf16 v[200:203], v[96:99], v[160:163], 0
    s_waitcnt vmcnt(1)
    v_mfma_f32_16x16x32_bf16 v[204:207], v[112:115], v[160:163], 0
    v_mfma_f32_16x16x32_bf16 v[208:211], v[96:99], v[166:169], 0
    v_mfma_f32_16x16x32_bf16 v[212:215], v[112:115], v[166:169], 0
    v_mfma_f32_16x16x32_bf16 v[216:219], v[100:103], v[160:163], 0
    s_waitcnt vmcnt(0)
    v_mfma_f32_16x16x32_bf16 v[220:223], v[116:119], v[160:163], 0
    v_mfma_f32_16x16x32_bf16 v[224:227], v[100:103], v[166:169], 0
    v_mfma_f32_16x16x32_bf16 v[228:231], v[116:119], v[166:169], 0
    s_nop 7
    s_mov_b32 s88, 65536
    s_cmp_ge_u32 s47, s16
    s_cbranch_scc1 cw15x
cw15:
    buffer_load_dword v199, off, s[4:7], s36 offset:128 sc1
    s_waitcnt vmcnt(0)
    v_readfirstlane_b32 s42, v199
    s_nop 0
    s_sub_u32 s42, s42, s95
    s_cmp_gt_u32 s42, 64
    s_cselect_b32 s42, 0, s42
    s_add_u32 s42, s42, 2
    s_mov_b32 s47, s42
    s_cmp_ge_u32 s42, s16
    s_cbranch_scc1 cw15x
    s_sub_u32 s88, s88, 1
    s_cbranch_scc1 cw15x
    s_sub_u32 s42, s16, s42
    s_min_u32 s42, s42, 6
cw15s:
    s_sleep 24
    s_sub_u32 s42, s42, 1
    s_cmp_lg_u32 s42, 0
    s_cbranch_scc1 cw15s
    s_branch cw15
cw15x:
    s_add_u32 s37, s36, 128
    s_add_u32 s41, s16, s95
    s_add_u32 s41, s41, 1
    s_lshl_b32 s42, s17, 7
    s_add_u32 s42, s42, 125845504
    s_cmp_ge_u32 s16, 62
    s_cselect_b32 s37, s42, s37
    s_cselect_b32 s42, 12, 8
    v_lshlrev_b32 v198, 2, v0
    v_and_b32 v198, s42, v198
    s_mov_b32 s40, 4194304
L_aw2:
    buffer_load_dword v199, v198, s[4:7], s37 offen sc1
    s_sub_u32 s40, s40, 1
    s_cbranch_scc1 L_aw2_go
    s_waitcnt vmcnt(0)
    v_subrev_u32 v199, s41, v199
    v_cmp_lt_u32 vcc, 64, v199
    s_cbranch_vccz L_aw2_go
    s_sleep 1
    s_branch L_aw2
L_aw2_go:
    s_mov_b32 s21, 4096
at_again:
    s_lshl_b32 s20, s18, 12
    s_add_u32 s20, s20, 71303168
    buffer_load_dwordx4 v[72:75], v3, s[4:7], s20 offen offset:0 sc1
    buffer_load_dwordx4 v[76:79], v3, s[4:7], s20 offen offset:1024 sc1
    buffer_load_dwordx4 v[80:83], v3, s[4:7], s20 offen offset:2048 sc1
    buffer_load_dwordx4 v[84:87], v3, s[4:7], s20 offen offset:3072 sc1
    s_lshl_b32 s20, s18, 12
    s_add_u32 s20, s20, 80740352
    buffer_load_dwordx4 v[120:123], v1, s[4:7], s20 offen offset:0 sc1
    buffer_load_dwordx4 v[124:127], v1, s[4:7], s20 offen offset:1024 sc1
    buffer_load_dwordx4 v[128:131], v1, s[4:7], s20 offen offset:2048 sc1
    buffer_load_dwordx4 v[132:135], v1, s[4:7], s20 offen offset:3072 sc1
    s_waitcnt vmcnt(7)
    v_mfma_f32_16x16x32_bf16 v[144:147], v[72:75], v[8:11], 0
    v_mfma_f32_16x16x32_bf16 v[156:159], v[72:75], v[24:27], 0
    s_waitcnt vmcnt(6)
    v_mfma_f32_16x16x32_bf16 v[144:147], v[76:79], v[12:15], v[144:147]
    v_mfma_f32_16x16x32_bf16 v[156:159], v[76:79], v[28:31], v[156:159]
    s_waitcnt vmcnt(5)
    v_mfma_f32_16x16x32_bf16 v[144:147], v[80:83], v[16:19], v[144:147]
    v_mfma_f32_16x16x32_bf16 v[156:159], v[80:83], v[32:35], v[156:159]
    s_waitcnt vmcnt(4)
    v_mfma_f32_16x16x32_bf16 v[144:147], v[84:87], v[20:23], v[144:147]
    v_mfma_f32_16x16x32_bf16 v[156:159], v[84:87], v[36:39], v[156:159]
    v_max3_u32 v196, v72, v76, v80
    s_waitcnt vmcnt(0)
    v_max3_u32 v196, v196, v84, v120
    v_max3_u32 v196, v196, v124, v128
    v_max_u32 v196, v196, v132
    v_cmp_eq_u32 vcc, -1, v196
    s_sub_u32 s21, s21, 1
    s_nop 3
    s_cbranch_scc1 at_ok
    s_cbranch_vccnz at_again
at_ok:
    v_max3_f32 v196, v144, v145, v146
    v_max_f32 v196, v196, v147
    v_mov_b32 v197, v196
    s_nop 1
    v_permlane16_swap_b32 v196, v197
    v_max_f32 v196, v196, v197
    v_mul_f32 v196, s22, v196
    v_max_f32 v196, v196, v192
    v_sub_f32 v192, v192, v196
    v_fma_f32 v144, v144, s22, -v196
    v_fma_f32 v145, v145, s22, -v196
    v_fma_f32 v146, v146, s22, -v196
    v_fma_f32 v147, v147, s22, -v196
    v_exp_f32 v192, v192
    v_exp_f32 v144, v144
    v_exp_f32 v145, v145
    v_exp_f32 v146, v146
    v_exp_f32 v147, v147
    v_add_f32 v196, v144, v145
    v_add_f32 v197, v146, v147
    v_add_f32 v196, v196, v197
    v_mov_b32 v197, v196
    s_nop 1
    v_permlane16_swap_b32 v196, v197
    v_add_f32 v196, v196, v197
    v_fmac_f32 v196, v192, v180
    v_rcp_f32 v196, v196
    s_nop 0
    v_mul_f32 v144, v144, v196
    v_mul_f32 v145, v145, v196
    v_mul_f32 v146, v146, v196
    v_mul_f32 v147, v147, v196
    v_mul_f32 v192, v192, v196
    v_cvt_pk_bf16_f32 v164, v144, v145
    v_cvt_pk_bf16_f32 v165, v146, v147
    v_max3_f32 v196, v156, v157, v158
    v_max_f32 v196, v196, v159
    v_mov_b32 v197, v196
    s_nop 1
    v_permlane16_swap_b32 v196, v197
    v_max_f32 v196, v196, v197
    v_mul_f32 v196, s22, v196
    v_max_f32 v196, v196, v193
    v_sub_f32 v193, v193, v196
    v_fma_f32 v156, v156, s22, -v196
    v_fma_f32 v157, v157, s22, -v196
    v_fma_f32 v158, v158, s22, -v196
    v_fma_f32 v159, v159, s22, -v196
    v_exp_f32 v193, v193
    v_exp_f32 v156, v156
    v_exp_f32 v157, v157
    v_exp_f32 v158, v158
    v_exp_f32 v159, v159
    v_add_f32 v196, v156, v157
    v_add_f32 v197, v158, v159
    v_add_f32 v196, v196, v197
    v_mov_b32 v197, v196
    s_nop 1
    v_permlane16_swap_b32 v196, v197
    v_add_f32 v196, v196, v197
    v_fmac_f32 v196, v193, v184
    v_rcp_f32 v196, v196
    s_nop 0
    v_mul_f32 v156, v156, v196
    v_mul_f32 v157, v157, v196
    v_mul_f32 v158, v158, v196
    v_mul_f32 v159, v159, v196
    v_mul_f32 v193, v193, v196
    v_cvt_pk_bf16_f32 v170, v156, v157
    v_cvt_pk_bf16_f32 v171, v158, v159
    s_lshl_b32 s18, s16, 18
    s_lshl_b32 s19, s17, 12
    s_add_u32 s18, s18, s19
    s_add_u32 s18, s18, 50331648
    s_add_u32 s19, s18, 131072
    v_mul_f32 v40, v40, v192
    v_mul_f32 v41, v41, v192
    v_mul_f32 v42, v42, v192
    v_mul_f32 v43, v43, v192
    v_mul_f32 v44, v44, v192
    v_mul_f32 v45, v45, v192
    v_mul_f32 v46, v46, v192
    v_mul_f32 v47, v47, v192
    v_mfma_f32_16x16x16_bf16 v[40:43], v[120:121], v[164:165], v[40:43]
    v_mfma_f32_16x16x16_bf16 v[44:47], v[122:123], v[164:165], v[44:47]
    v_mul_f32 v48, v48, v193
    v_mul_f32 v49, v49, v193
    v_mul_f32 v50, v50, v193
    v_mul_f32 v51, v51, v193
    v_mul_f32 v52, v52, v193
    v_mul_f32 v53, v53, v193
    v_mul_f32 v54, v54, v193
    v_mul_f32 v55, v55, v193
    v_mfma_f32_16x16x16_bf16 v[48:51], v[120:121], v[170:171], v[48:51]
    v_mfma_f32_16x16x16_bf16 v[52:55], v[122:123], v[170:171], v[52:55]
    v_cvt_pk_bf16_f32 v40, v40, v41
    v_cvt_pk_bf16_f32 v41, v42, v43
    v_cvt_pk_bf16_f32 v42, v44, v45
    v_cvt_pk_bf16_f32 v43, v46, v47
    buffer_store_dwordx4 v[40:43], v1, s[4:7], s18 offen offset:0 sc1
    v_mul_f32 v56, v56, v192
    v_mul_f32 v57, v57, v192
    v_mul_f32 v58, v58, v192
    v_mul_f32 v59, v59, v192
    v_mul_f32 v60, v60, v192
    v_mul_f32 v61, v61, v192
    v_mul_f32 v62, v62, v192
    v_mul_f32 v63, v63, v192
    v_mfma_f32_16x16x16_bf16 v[56:59], v[124:125], v[164:165], v[56:59]
    v_mfma_f32_16x16x16_bf16 v[60:63], v[126:127], v[164:165], v[60:63]
    v_cvt_pk_bf16_f32 v48, v48, v49
    v_cvt_pk_bf16_f32 v49, v50, v51
    v_cvt_pk_bf16_f32 v50, v52, v53
    v_cvt_pk_bf16_f32 v51, v54, v55
    buffer_store_dwordx4 v[48:51], v1, s[4:7], s19 offen offset:0 sc1
    v_mul_f32 v64, v64, v193
    v_mul_f32 v65, v65, v193
    v_mul_f32 v66, v66, v193
    v_mul_f32 v67, v67, v193
    v_mul_f32 v68, v68, v193
    v_mul_f32 v69, v69, v193
    v_mul_f32 v70, v70, v193
    v_mul_f32 v71, v71, v193
    v_mfma_f32_16x16x16_bf16 v[64:67], v[124:125], v[170:171], v[64:67]
    v_mfma_f32_16x16x16_bf16 v[68:71], v[126:127], v[170:171], v[68:71]
    v_cvt_pk_bf16_f32 v56, v56, v57
    v_cvt_pk_bf16_f32 v57, v58, v59
    v_cvt_pk_bf16_f32 v58, v60, v61
    v_cvt_pk_bf16_f32 v59, v62, v63
    buffer_store_dwordx4 v[56:59], v1, s[4:7], s18 offen offset:1024 sc1
    v_mul_f32 v200, v200, v192
    v_mul_f32 v201, v201, v192
    v_mul_f32 v202, v202, v192
    v_mul_f32 v203, v203, v192
    v_mul_f32 v204, v204, v192
    v_mul_f32 v205, v205, v192
    v_mul_f32 v206, v206, v192
    v_mul_f32 v207, v207, v192
    v_mfma_f32_16x16x16_bf16 v[200:203], v[128:129], v[164:165], v[200:203]
    v_mfma_f32_16x16x16_bf16 v[204:207], v[130:131], v[164:165], v[204:207]
    v_cvt_pk_bf16_f32 v64, v64, v65
    v_cvt_pk_bf16_f32 v65, v66, v67
    v_cvt_pk_bf16_f32 v66, v68, v69
    v_cvt_pk_bf16_f32 v67, v70, v71
    buffer_store_dwordx4 v[64:67], v1, s[4:7], s19 offen offset:1024 sc1
    v_mul_f32 v208, v208, v193
    v_mul_f32 v209, v209, v193
    v_mul_f32 v210, v210, v193
    v_mul_f32 v211, v211, v193
    v_mul_f32 v212, v212, v193
    v_mul_f32 v213, v213, v193
    v_mul_f32 v214, v214, v193
    v_mul_f32 v215, v215, v193
    v_mfma_f32_16x16x16_bf16 v[208:211], v[128:129], v[170:171], v[208:211]
    v_mfma_f32_16x16x16_bf16 v[212:215], v[130:131], v[170:171], v[212:215]
    v_cvt_pk_bf16_f32 v200, v200, v201
    v_cvt_pk_bf16_f32 v201, v202, v203
    v_cvt_pk_bf16_f32 v202, v204, v205
    v_cvt_pk_bf16_f32 v203, v206, v207
    buffer_store_dwordx4 v[200:203], v1, s[4:7], s18 offen offset:2048 sc1
    v_mul_f32 v216, v216, v192
    v_mul_f32 v217, v217, v192
    v_mul_f32 v218, v218, v192
    v_mul_f32 v219, v219, v192
    v_mul_f32 v220, v220, v192
    v_mul_f32 v221, v221, v192
    v_mul_f32 v222, v222, v192
    v_mul_f32 v223, v223, v192
    v_mfma_f32_16x16x16_bf16 v[216:219], v[132:133], v[164:165], v[216:219]
    v_mfma_f32_16x16x16_bf16 v[220:223], v[134:135], v[164:165], v[220:223]
    v_cvt_pk_bf16_f32 v208, v208, v209
    v_cvt_pk_bf16_f32 v209, v210, v211
    v_cvt_pk_bf16_f32 v210, v212, v213
    v_cvt_pk_bf16_f32 v211, v214, v215
    buffer_store_dwordx4 v[208:211], v1, s[4:7], s19 offen offset:2048 sc1
    v_mul_f32 v224, v224, v193
    v_mul_f32 v225, v225, v193
    v_mul_f32 v226, v226, v193
    v_mul_f32 v227, v227, v193
    v_mul_f32 v228, v228, v193
    v_mul_f32 v229, v229, v193
    v_mul_f32 v230, v230, v193
    v_mul_f32 v231, v231, v193
    v_mfma_f32_16x16x16_bf16 v[224:227], v[132:133], v[170:171], v[224:227]
    v_mfma_f32_16x16x16_bf16 v[228:231], v[134:135], v[170:171], v[228:231]
    v_cvt_pk_bf16_f32 v216, v216, v217
    v_cvt_pk_bf16_f32 v217, v218, v219
    v_cvt_pk_bf16_f32 v218, v220, v221
    v_cvt_pk_bf16_f32 v219, v222, v223
    buffer_store_dwordx4 v[216:219], v1, s[4:7], s18 offen offset:3072 sc1
    v_cvt_pk_bf16_f32 v224, v224, v225
    v_cvt_pk_bf16_f32 v225, v226, v227
    v_cvt_pk_bf16_f32 v226, v228, v229
    v_cvt_pk_bf16_f32 v227, v230, v231
    buffer_store_dwordx4 v[224:227], v1, s[4:7], s19 offen offset:3072 sc1
    s_lshr_b32 s40, s34, 1
    s_lshl_b32 s40, s40, 7
    s_and_b32 s41, s17, 7
    s_lshl_b32 s41, s41, 2
    s_add_u32 s40, s40, s41
    s_add_u32 s40, s40, 125894656
    v_mov_b32 v250, s95
    s_cmp_ge_u32 s16, 58
    s_cbranch_scc1 L_afl
    s_waitcnt vmcnt(0)
L_afl:
    s_mov_b64 exec, 1
    buffer_store_dword v250, off, s[4:7], s40 sc1
    s_mov_b64 exec, -1
    s_add_u32 s34, s34, 48
    s_cmp_lt_u32 s34, 512
    s_cbranch_scc1 L_att_next
    s_branch L_done
L_op_start:
    s_mov_b32 s16, s33
    s_mov_b32 s33, s34
    v_and_b32 v2, 63, v0
    v_lshlrev_b32 v1, 4, v2
    v_lshrrev_b32 v5, 2, v2
    v_mul_u32_u24 v3, 1152, v5
    v_and_b32 v5, 3, v2
    v_lshl_add_u32 v3, v5, 4, v3
    s_lshl_b32 s21, s32, 12
    v_add_u32 v4, s21, v1
    s_mov_b64 s[12:13], s[58:59]
    s_mov_b32 s14, 4718592
    s_mov_b32 s15, 0x20000
    s_mul_i32 s19, s32, 1179648
    s_lshl_b32 s18, s33, 6
    s_add_u32 s19, s19, s18
    s_add_u32 s18, s19, 0
    s_add_u32 m0, s21, 0
    s_nop 0
    buffer_load_dwordx4 v3, s[12:15], s18 offen lds
    s_add_u32 m0, s21, 1024
    s_add_u32 s18, s18, 18432
    buffer_load_dwordx4 v3, s[12:15], s18 offen lds
    s_add_u32 m0, s21, 2048
    s_add_u32 s18, s18, 18432
    buffer_load_dwordx4 v3, s[12:15], s18 offen lds
    s_add_u32 m0, s21, 3072
    s_add_u32 s18, s18, 18432
    buffer_load_dwordx4 v3, s[12:15], s18 offen lds
    s_add_u32 s18, s19, 73728
    s_add_u32 m0, s21, 16384
    s_nop 0
    buffer_load_dwordx4 v3, s[12:15], s18 offen lds
    s_add_u32 m0, s21, 17408
    s_add_u32 s18, s18, 18432
    buffer_load_dwordx4 v3, s[12:15], s18 offen lds
    s_add_u32 m0, s21, 18432
    s_add_u32 s18, s18, 18432
    buffer_load_dwordx4 v3, s[12:15], s18 offen lds
    s_add_u32 m0, s21, 19456
    s_add_u32 s18, s18, 18432
    buffer_load_dwordx4 v3, s[12:15], s18 offen lds
    s_add_u32 s18, s19, 147456
    s_add_u32 m0, s21, 32768
    s_nop 0
    buffer_load_dwordx4 v3, s[12:15], s18 offen lds
    s_add_u32 m0, s21, 33792
    s_add_u32 s18, s18, 18432
    buffer_load_dwordx4 v3, s[12:15], s18 offen lds
    s_add_u32 m0, s21, 34816
    s_add_u32 s18, s18, 18432
    buffer_load_dwordx4 v3, s[12:15], s18 offen lds
    s_add_u32 m0, s21, 35840
    s_add_u32 s18, s18, 18432
    buffer_load_dwordx4 v3, s[12:15], s18 offen lds
    s_add_u32 s18, s19, 221184
    s_add_u32 m0, s21, 49152
    s_nop 0
    buffer_load_dwordx4 v3, s[12:15], s18 offen lds
    s_add_u32 m0, s21, 50176
    s_add_u32 s18, s18, 18432
    buffer_load_dwordx4 v3, s[12:15], s18 offen lds
    s_add_u32 m0, s21, 51200
    s_add_u32 s18, s18, 18432
    buffer_load_dwordx4 v3, s[12:15], s18 offen lds
    s_add_u32 m0, s21, 52224
    s_add_u32 s18, s18, 18432
    buffer_load_dwordx4 v3, s[12:15], s18 offen lds
    s_add_u32 s18, s19, 294912
    s_add_u32 m0, s21, 65536
    s_nop 0
    buffer_load_dwordx4 v3, s[12:15], s18 offen lds
    s_add_u32 m0, s21, 66560
    s_add_u32 s18, s18, 18432
    buffer_load_dwordx4 v3, s[12:15], s18 offen lds
    s_add_u32 m0, s21, 67584
    s_add_u32 s18, s18, 18432
    buffer_load_dwordx4 v3, s[12:15], s18 offen lds
    s_add_u32 m0, s21, 68608
    s_add_u32 s18, s18, 18432
    buffer_load_dwordx4 v3, s[12:15], s18 offen lds
    s_add_u32 s18, s19, 368640
    s_add_u32 m0, s21, 81920
    s_nop 0
    buffer_load_dwordx4 v3, s[12:15], s18 offen lds
    s_add_u32 m0, s21, 82944
    s_add_u32 s18, s18, 18432
    buffer_load_dwordx4 v3, s[12:15], s18 offen lds
    s_add_u32 m0, s21, 83968
    s_add_u32 s18, s18, 18432
    buffer_load_dwordx4 v3, s[12:15], s18 offen lds
    s_add_u32 m0, s21, 84992
    s_add_u32 s18, s18, 18432
    buffer_load_dwordx4 v3, s[12:15], s18 offen lds
    s_add_u32 s18, s19, 442368
    s_add_u32 m0, s21, 98304
    s_nop 0
    buffer_load_dwordx4 v3, s[12:15], s18 offen lds
    s_add_u32 m0, s21, 99328
    s_add_u32 s18, s18, 18432
    buffer_load_dwordx4 v3, s[12:15], s18 offen lds
    s_add_u32 m0, s21, 100352
    s_add_u32 s18, s18, 18432
    buffer_load_dwordx4 v3, s[12:15], s18 offen lds
    s_add_u32 m0, s21, 101376
    s_add_u32 s18, s18, 18432
    buffer_load_dwordx4 v3, s[12:15], s18 offen lds
    s_add_u32 s18, s19, 516096
    s_add_u32 m0, s21, 114688
    s_nop 0
    buffer_load_dwordx4 v3, s[12:15], s18 offen lds
    s_add_u32 m0, s21, 115712
    s_add_u32 s18, s18, 18432
    buffer_load_dwordx4 v3, s[12:15], s18 offen lds
    s_add_u32 m0, s21, 116736
    s_add_u32 s18, s18, 18432
    buffer_load_dwordx4 v3, s[12:15], s18 offen lds
    s_add_u32 m0, s21, 117760
    s_add_u32 s18, s18, 18432
    buffer_load_dwordx4 v3, s[12:15], s18 offen lds
    s_add_u32 s18, s19, 589824
    s_add_u32 m0, s21, 131072
    s_nop 0
    buffer_load_dwordx4 v3, s[12:15], s18 offen lds
    s_add_u32 m0, s21, 132096
    s_add_u32 s18, s18, 18432
    buffer_load_dwordx4 v3, s[12:15], s18 offen lds
    s_add_u32 m0, s21, 133120
    s_add_u32 s18, s18, 18432
    buffer_load_dwordx4 v3, s[12:15], s18 offen lds
    s_add_u32 m0, s21, 134144
    s_add_u32 s18, s18, 18432
    buffer_load_dwordx4 v3, s[12:15], s18 offen lds
    v_add_u32 v6, 0, v4
    v_xor_b32 v7, 32, v6
    s_waitcnt vmcnt(32)
    ds_read_b64_tr_b16 a[0:1], v6 offset:0
    ds_read_b64_tr_b16 a[2:3], v6 offset:1024
    ds_read_b64_tr_b16 a[4:5], v6 offset:8
    ds_read_b64_tr_b16 a[6:7], v6 offset:1032
    ds_read_b64_tr_b16 a[8:9], v6 offset:2048
    ds_read_b64_tr_b16 a[10:11], v6 offset:3072
    ds_read_b64_tr_b16 a[12:13], v6 offset:2056
    ds_read_b64_tr_b16 a[14:15], v6 offset:3080
    s_waitcnt lgkmcnt(0)
    s_add_u32 s18, s19, 663552
    s_add_u32 m0, s21, 0
    s_nop 0
    buffer_load_dwordx4 v3, s[12:15], s18 offen lds
    s_add_u32 m0, s21, 1024
    s_add_u32 s18, s18, 18432
    buffer_load_dwordx4 v3, s[12:15], s18 offen lds
    s_add_u32 m0, s21, 2048
    s_add_u32 s18, s18, 18432
    buffer_load_dwordx4 v3, s[12:15], s18 offen lds
    s_add_u32 m0, s21, 3072
    s_add_u32 s18, s18, 18432
    buffer_load_dwordx4 v3, s[12:15], s18 offen lds
    v_add_u32 v6, 16384, v4
    v_xor_b32 v7, 32, v6
    s_waitcnt vmcnt(32)
    ds_read_b64_tr_b16 a[16:17], v6 offset:0
    ds_read_b64_tr_b16 a[18:19], v6 offset:1024
    ds_read_b64_tr_b16 a[20:21], v6 offset:8
    ds_read_b64_tr_b16 a[22:23], v6 offset:1032
    ds_read_b64_tr_b16 a[24:25], v6 offset:2048
    ds_read_b64_tr_b16 a[26:27], v6 offset:3072
    ds_read_b64_tr_b16 a[28:29], v6 offset:2056
    ds_read_b64_tr_b16 a[30:31], v6 offset:3080
    s_waitcnt lgkmcnt(0)
    s_add_u32 s18, s19, 737280
    s_add_u32 m0, s21, 16384
    s_nop 0
    buffer_load_dwordx4 v3, s[12:15], s18 offen lds
    s_add_u32 m0, s21, 17408
    s_add_u32 s18, s18, 18432
    buffer_load_dwordx4 v3, s[12:15], s18 offen lds
    s_add_u32 m0, s21, 18432
    s_add_u32 s18, s18, 18432
    buffer_load_dwordx4 v3, s[12:15], s18 offen lds
    s_add_u32 m0, s21, 19456
    s_add_u32 s18, s18, 18432
    buffer_load_dwordx4 v3, s[12:15], s18 offen lds
    v_add_u32 v6, 32768, v4
    v_xor_b32 v7, 32, v6
    s_waitcnt vmcnt(32)
    ds_read_b64_tr_b16 a[32:33], v6 offset:0
    ds_read_b64_tr_b16 a[34:35], v6 offset:1024
    ds_read_b64_tr_b16 a[36:37], v6 offset:8
    ds_read_b64_tr_b16 a[38:39], v6 offset:1032
    ds_read_b64_tr_b16 a[40:41], v6 offset:2048
    ds_read_b64_tr_b16 a[42:43], v6 offset:3072
    ds_read_b64_tr_b16 a[44:45], v6 offset:2056
    ds_read_b64_tr_b16 a[46:47], v6 offset:3080
    s_waitcnt lgkmcnt(0)
    s_add_u32 s18, s19, 811008
    s_add_u32 m0, s21, 32768
    s_nop 0
    buffer_load_dwordx4 v3, s[12:15], s18 offen lds
    s_add_u32 m0, s21, 33792
    s_add_u32 s18, s18, 18432
    buffer_load_dwordx4 v3, s[12:15], s18 offen lds
    s_add_u32 m0, s21, 34816
    s_add_u32 s18, s18, 18432
    buffer_load_dwordx4 v3, s[12:15], s18 offen lds
    s_add_u32 m0, s21, 35840
    s_add_u32 s18, s18, 18432
    buffer_load_dwordx4 v3, s[12:15], s18 offen lds
    v_add_u32 v6, 49152, v4
    v_xor_b32 v7, 32, v6
    s_waitcnt vmcnt(32)
    ds_read_b64_tr_b16 a[48:49], v6 offset:0
    ds_read_b64_tr_b16 a[50:51], v6 offset:1024
    ds_read_b64_tr_b16 a[52:53], v6 offset:8
    ds_read_b64_tr_b16 a[54:55], v6 offset:1032
    ds_read_b64_tr_b16 a[56:57], v6 offset:2048
    ds_read_b64_tr_b16 a[58:59], v6 offset:3072
    ds_read_b64_tr_b16 a[60:61], v6 offset:2056
    ds_read_b64_tr_b16 a[62:63], v6 offset:3080
    s_waitcnt lgkmcnt(0)
    s_add_u32 s18, s19, 884736
    s_add_u32 m0, s21, 49152
    s_nop 0
    buffer_load_dwordx4 v3, s[12:15], s18 offen lds
    s_add_u32 m0, s21, 50176
    s_add_u32 s18, s18, 18432
    buffer_load_dwordx4 v3, s[12:15], s18 offen lds
    s_add_u32 m0, s21, 51200
    s_add_u32 s18, s18, 18432
    buffer_load_dwordx4 v3, s[12:15], s18 offen lds
    s_add_u32 m0, s21, 52224
    s_add_u32 s18, s18, 18432
    buffer_load_dwordx4 v3, s[12:15], s18 offen lds
    v_add_u32 v6, 65536, v4
    v_xor_b32 v7, 32, v6
    s_waitcnt vmcnt(32)
    ds_read_b64_tr_b16 a[64:65], v6 offset:0
    ds_read_b64_tr_b16 a[66:67], v6 offset:1024
    ds_read_b64_tr_b16 a[68:69], v6 offset:8
    ds_read_b64_tr_b16 a[70:71], v6 offset:1032
    ds_read_b64_tr_b16 a[72:73], v6 offset:2048
    ds_read_b64_tr_b16 a[74:75], v6 offset:3072
    ds_read_b64_tr_b16 a[76:77], v6 offset:2056
    ds_read_b64_tr_b16 a[78:79], v6 offset:3080
    s_waitcnt lgkmcnt(0)
    s_add_u32 s18, s19, 958464
    s_add_u32 m0, s21, 65536
    s_nop 0
    buffer_load_dwordx4 v3, s[12:15], s18 offen lds
    s_add_u32 m0, s21, 66560
    s_add_u32 s18, s18, 18432
    buffer_load_dwordx4 v3, s[12:15], s18 offen lds
    s_add_u32 m0, s21, 67584
    s_add_u32 s18, s18, 18432
    buffer_load_dwordx4 v3, s[12:15], s18 offen lds
    s_add_u32 m0, s21, 68608
    s_add_u32 s18, s18, 18432
    buffer_load_dwordx4 v3, s[12:15], s18 offen lds
    v_add_u32 v6, 81920, v4
    v_xor_b32 v7, 32, v6
    s_waitcnt vmcnt(32)
    ds_read_b64_tr_b16 a[80:81], v6 offset:0
    ds_read_b64_tr_b16 a[82:83], v6 offset:1024
    ds_read_b64_tr_b16 a[84:85], v6 offset:8
    ds_read_b64_tr_b16 a[86:87], v6 offset:1032
    ds_read_b64_tr_b16 a[88:89], v6 offset:2048
    ds_read_b64_tr_b16 a[90:91], v6 offset:3072
    ds_read_b64_tr_b16 a[92:93], v6 offset:2056
    ds_read_b64_tr_b16 a[94:95], v6 offset:3080
    s_waitcnt lgkmcnt(0)
    s_add_u32 s18, s19, 1032192
    s_add_u32 m0, s21, 81920
    s_nop 0
    buffer_load_dwordx4 v3, s[12:15], s18 offen lds
    s_add_u32 m0, s21, 82944
    s_add_u32 s18, s18, 18432
    buffer_load_dwordx4 v3, s[12:15], s18 offen lds
    s_add_u32 m0, s21, 83968
    s_add_u32 s18, s18, 18432
    buffer_load_dwordx4 v3, s[12:15], s18 offen lds
    s_add_u32 m0, s21, 84992
    s_add_u32 s18, s18, 18432
    buffer_load_dwordx4 v3, s[12:15], s18 offen lds
    v_add_u32 v6, 98304, v4
    v_xor_b32 v7, 32, v6
    s_waitcnt vmcnt(32)
    ds_read_b64_tr_b16 a[96:97], v6 offset:0
    ds_read_b64_tr_b16 a[98:99], v6 offset:1024
    ds_read_b64_tr_b16 a[100:101], v6 offset:8
    ds_read_b64_tr_b16 a[102:103], v6 offset:1032
    ds_read_b64_tr_b16 a[104:105], v6 offset:2048
    ds_read_b64_tr_b16 a[106:107], v6 offset:3072
    ds_read_b64_tr_b16 a[108:109], v6 offset:2056
    ds_read_b64_tr_b16 a[110:111], v6 offset:3080
    s_waitcnt lgkmcnt(0)
    s_add_u32 s18, s19, 1105920
    s_add_u32 m0, s21, 98304
    s_nop 0
    buffer_load_dwordx4 v3, s[12:15], s18 offen lds
    s_add_u32 m0, s21, 99328
    s_add_u32 s18, s18, 18432
    buffer_load_dwordx4 v3, s[12:15], s18 offen lds
    s_add_u32 m0, s21, 100352
    s_add_u32 s18, s18, 18432
    buffer_load_dwordx4 v3, s[12:15], s18 offen lds
    s_add_u32 m0, s21, 101376
    s_add_u32 s18, s18, 18432
    buffer_load_dwordx4 v3, s[12:15], s18 offen lds
    v_add_u32 v6, 114688, v4
    v_xor_b32 v7, 32, v6
    s_waitcnt vmcnt(32)
    ds_read_b64_tr_b16 a[112:113], v6 offset:0
    ds_read_b64_tr_b16 a[114:115], v6 offset:1024
    ds_read_b64_tr_b16 a[116:117], v6 offset:8
    ds_read_b64_tr_b16 a[118:119], v6 offset:1032
    ds_read_b64_tr_b16 a[120:121], v6 offset:2048
    ds_read_b64_tr_b16 a[122:123], v6 offset:3072
    ds_read_b64_tr_b16 a[124:125], v6 offset:2056
    ds_read_b64_tr_b16 a[126:127], v6 offset:3080
    s_waitcnt lgkmcnt(0)
    v_add_u32 v6, 131072, v4
    v_xor_b32 v7, 32, v6
    s_waitcnt vmcnt(28)
    ds_read_b64_tr_b16 a[128:129], v6 offset:0
    ds_read_b64_tr_b16 a[130:131], v6 offset:1024
    ds_read_b64_tr_b16 a[132:133], v6 offset:8
    ds_read_b64_tr_b16 a[134:135], v6 offset:1032
    ds_read_b64_tr_b16 a[136:137], v6 offset:2048
    ds_read_b64_tr_b16 a[138:139], v6 offset:3072
    ds_read_b64_tr_b16 a[140:141], v6 offset:2056
    ds_read_b64_tr_b16 a[142:143], v6 offset:3080
    s_waitcnt lgkmcnt(0)
    v_add_u32 v6, 0, v4
    v_xor_b32 v7, 32, v6
    s_waitcnt vmcnt(24)
    ds_read_b64_tr_b16 a[144:145], v6 offset:0
    ds_read_b64_tr_b16 a[146:147], v6 offset:1024
    ds_read_b64_tr_b16 a[148:149], v6 offset:8
    ds_read_b64_tr_b16 a[150:151], v6 offset:1032
    ds_read_b64_tr_b16 a[152:153], v6 offset:2048
    ds_read_b64_tr_b16 a[154:155], v6 offset:3072
    ds_read_b64_tr_b16 a[156:157], v6 offset:2056
    ds_read_b64_tr_b16 a[158:159], v6 offset:3080
    s_waitcnt lgkmcnt(0)
    v_add_u32 v6, 16384, v4
    v_xor_b32 v7, 32, v6
    s_waitcnt vmcnt(20)
    ds_read_b64_tr_b16 a[160:161], v6 offset:0
    ds_read_b64_tr_b16 a[162:163], v6 offset:1024
    ds_read_b64_tr_b16 a[164:165], v6 offset:8
    ds_read_b64_tr_b16 a[166:167], v6 offset:1032
    ds_read_b64_tr_b16 a[168:169], v6 offset:2048
    ds_read_b64_tr_b16 a[170:171], v6 offset:3072
    ds_read_b64_tr_b16 a[172:173], v6 offset:2056
    ds_read_b64_tr_b16 a[174:175], v6 offset:3080
    s_waitcnt lgkmcnt(0)
    v_add_u32 v6, 32768, v4
    v_xor_b32 v7, 32, v6
    s_waitcnt vmcnt(16)
    ds_read_b64_tr_b16 a[176:177], v6 offset:0
    ds_read_b64_tr_b16 a[178:179], v6 offset:1024
    ds_read_b64_tr_b16 a[180:181], v6 offset:8
    ds_read_b64_tr_b16 a[182:183], v6 offset:1032
    ds_read_b64_tr_b16 a[184:185], v6 offset:2048
    ds_read_b64_tr_b16 a[186:187], v6 offset:3072
    ds_read_b64_tr_b16 a[188:189], v6 offset:2056
    ds_read_b64_tr_b16 a[190:191], v6 offset:3080
    s_waitcnt lgkmcnt(0)
    v_add_u32 v6, 49152, v4
    v_xor_b32 v7, 32, v6
    s_waitcnt vmcnt(12)
    ds_read_b64_tr_b16 a[192:193], v6 offset:0
    ds_read_b64_tr_b16 a[194:195], v6 offset:1024
    ds_read_b64_tr_b16 a[196:197], v6 offset:8
    ds_read_b64_tr_b16 a[198:199], v6 offset:1032
    ds_read_b64_tr_b16 a[200:201], v6 offset:2048
    ds_read_b64_tr_b16 a[202:203], v6 offset:3072
    ds_read_b64_tr_b16 a[204:205], v6 offset:2056
    ds_read_b64_tr_b16 a[206:207], v6 offset:3080
    s_waitcnt lgkmcnt(0)
    v_add_u32 v6, 65536, v4
    v_xor_b32 v7, 32, v6
    s_waitcnt vmcnt(8)
    ds_read_b64_tr_b16 a[208:209], v6 offset:0
    ds_read_b64_tr_b16 a[210:211], v6 offset:1024
    ds_read_b64_tr_b16 a[212:213], v6 offset:8
    ds_read_b64_tr_b16 a[214:215], v6 offset:1032
    ds_read_b64_tr_b16 a[216:217], v6 offset:2048
    ds_read_b64_tr_b16 a[218:219], v6 offset:3072
    ds_read_b64_tr_b16 a[220:221], v6 offset:2056
    ds_read_b64_tr_b16 a[222:223], v6 offset:3080
    s_waitcnt lgkmcnt(0)
    v_add_u32 v6, 81920, v4
    v_xor_b32 v7, 32, v6
    s_waitcnt vmcnt(4)
    ds_read_b64_tr_b16 a[224:225], v6 offset:0
    ds_read_b64_tr_b16 a[226:227], v6 offset:1024
    ds_read_b64_tr_b16 a[228:229], v6 offset:8
    ds_read_b64_tr_b16 a[230:231], v6 offset:1032
    ds_read_b64_tr_b16 a[232:233], v6 offset:2048
    ds_read_b64_tr_b16 a[234:235], v6 offset:3072
    ds_read_b64_tr_b16 a[236:237], v6 offset:2056
    ds_read_b64_tr_b16 a[238:239], v6 offset:3080
    s_waitcnt lgkmcnt(0)
    v_add_u32 v6, 98304, v4
    v_xor_b32 v7, 32, v6
    s_waitcnt vmcnt(0)
    ds_read_b64_tr_b16 a[240:241], v6 offset:0
    ds_read_b64_tr_b16 a[242:243], v6 offset:1024
    ds_read_b64_tr_b16 a[244:245], v6 offset:8
    ds_read_b64_tr_b16 a[246:247], v6 offset:1032
    ds_read_b64_tr_b16 a[248:249], v6 offset:2048
    ds_read_b64_tr_b16 a[250:251], v6 offset:3072
    ds_read_b64_tr_b16 a[252:253], v6 offset:2056
    ds_read_b64_tr_b16 a[254:255], v6 offset:3080
    s_waitcnt lgkmcnt(0)
    s_barrier
    s_mov_b32 s35, s16
L_op_seg:
    s_sub_u32 s40, s35, 126
    s_lshr_b32 s41, s40, 1
    s_add_u32 s41, s41, 126
    s_and_b32 s40, s40, 1
    s_lshl_b32 s40, s40, 3
    s_lshl_b32 s44, 0x00ff00ff, s40
    s_cmp_ge_u32 s35, 999
    s_cselect_b32 s16, s41, s35
    s_cselect_b32 s44, s44, -1
    s_mov_b32 s45, s44
    s_lshr_b32 s43, s16, 1
    s_add_u32 s43, s43, 1
    s_min_u32 s43, s43, 63
    s_and_b32 s36, s33, 15
    s_lshl_b32 s36, s36, 8
    s_add_u32 s36, s36, 125829120
    s_lshl_b32 s94, s33, 7
    s_add_u32 s94, s94, s16
    s_cmp_ge_u32 s16, 120
    s_cbranch_scc1 L_nocw
    s_mov_b32 s88, 65536
    s_cmp_ge_u32 s47, s43
    s_cbranch_scc1 cw16x
cw16:
    buffer_load_dword v3, off, s[4:7], s36 offset:128 sc1
    s_waitcnt vmcnt(0)
    v_readfirstlane_b32 s42, v3
    s_nop 0
    s_sub_u32 s42, s42, s95
    s_cmp_gt_u32 s42, 64
    s_cselect_b32 s42, 0, s42
    s_add_u32 s42, s42, 2
    s_mov_b32 s47, s42
    s_cmp_ge_u32 s42, s43
    s_cbranch_scc1 cw16x
    s_sub_u32 s88, s88, 1
    s_cbranch_scc1 cw16x
    s_sub_u32 s42, s43, s42
    s_min_u32 s42, s42, 6
cw16s:
    s_sleep 24
    s_sub_u32 s42, s42, 1
    s_cmp_lg_u32 s42, 0
    s_cbranch_scc1 cw16s
    s_branch cw16
cw16x:
L_nocw:
    s_lshr_b32 s89, s16, 1
    s_lshl_b32 s89, s89, 2
    s_add_u32 s89, s89, s32
    s_lshl_b32 s89, s89, 7
    s_add_u32 s89, s89, 125894656
    s_cmp_lg_u32 s46, 0
    s_cbranch_scc1 L_opgo
    v_mbcnt_lo_u32_b32 v2, -1, 0
    v_mbcnt_hi_u32_b32 v2, -1, v2
    v_min_u32 v2, 7, v2
    v_lshlrev_b32 v2, 2, v2
    s_mov_b32 s88, 4194304
fw17:
    buffer_load_dword v3, v2, s[4:7], s89 offen offset:0 sc1
    s_sub_u32 s88, s88, 1
    s_cbranch_scc1 fw17x
    s_waitcnt vmcnt(0)
    v_cmp_ne_u32 vcc, s95, v3
    s_cbranch_vccz fw17x
    s_sleep 2
    s_cmp_gt_u32 s88, 4194256
    s_cbranch_scc1 fw17
    s_sleep 40
    s_branch fw17
fw17x:
L_opgo:
    v_lshrrev_b32 v5, 2, v1
    v_and_b32 v5, 28, v5
    s_add_u32 s89, s89, 1536
    s_mov_b32 s21, 4096
os_again:
    s_lshl_b32 s18, s16, 17
    s_lshl_b32 s19, s32, 15
    s_add_u32 s18, s18, s19
    s_add_u32 s18, s18, 50331648
    s_mov_b64 exec, s[44:45]
    buffer_load_dwordx4 v[32:35], v1, s[4:7], s18 offen offset:0 sc1
    buffer_load_dwordx4 v[36:39], v1, s[4:7], s18 offen offset:1024 sc1
    buffer_load_dwordx4 v[40:43], v1, s[4:7], s18 offen offset:2048 sc1
    buffer_load_dwordx4 v[44:47], v1, s[4:7], s18 offen offset:3072 sc1
    s_add_u32 s18, s18, 4096
    buffer_load_dwordx4 v[48:51], v1, s[4:7], s18 offen offset:0 sc1
    buffer_load_dwordx4 v[52:55], v1, s[4:7], s18 offen offset:1024 sc1
    buffer_load_dwordx4 v[56:59], v1, s[4:7], s18 offen offset:2048 sc1
    buffer_load_dwordx4 v[60:63], v1, s[4:7], s18 offen offset:3072 sc1
    s_add_u32 s18, s18, 4096
    buffer_load_dwordx4 v[64:67], v1, s[4:7], s18 offen offset:0 sc1
    buffer_load_dwordx4 v[68:71], v1, s[4:7], s18 offen offset:1024 sc1
    buffer_load_dwordx4 v[72:75], v1, s[4:7], s18 offen offset:2048 sc1
    buffer_load_dwordx4 v[76:79], v1, s[4:7], s18 offen offset:3072 sc1
    s_add_u32 s18, s18, 4096
    buffer_load_dwordx4 v[80:83], v1, s[4:7], s18 offen offset:0 sc1
    buffer_load_dwordx4 v[84:87], v1, s[4:7], s18 offen offset:1024 sc1
    buffer_load_dwordx4 v[88:91], v1, s[4:7], s18 offen offset:2048 sc1
    buffer_load_dwordx4 v[92:95], v1, s[4:7], s18 offen offset:3072 sc1
    s_add_u32 s18, s18, 4096
    buffer_load_dwordx4 v[96:99], v1, s[4:7], s18 offen offset:0 sc1
    buffer_load_dwordx4 v[100:103], v1, s[4:7], s18 offen offset:1024 sc1
    buffer_load_dwordx4 v[104:107], v1, s[4:7], s18 offen offset:2048 sc1
    buffer_load_dwordx4 v[108:111], v1, s[4:7], s18 offen offset:3072 sc1
    s_add_u32 s18, s18, 4096
    buffer_load_dwordx4 v[112:115], v1, s[4:7], s18 offen offset:0 sc1
    buffer_load_dwordx4 v[116:119], v1, s[4:7], s18 offen offset:1024 sc1
    buffer_load_dwordx4 v[120:123], v1, s[4:7], s18 offen offset:2048 sc1
    buffer_load_dwordx4 v[124:127], v1, s[4:7], s18 offen offset:3072 sc1
    s_add_u32 s18, s18, 4096
    buffer_load_dwordx4 v[128:131], v1, s[4:7], s18 offen offset:0 sc1
    buffer_load_dwordx4 v[132:135], v1, s[4:7], s18 offen offset:1024 sc1
    buffer_load_dwordx4 v[136:139], v1, s[4:7], s18 offen offset:2048 sc1
    buffer_load_dwordx4 v[140:143], v1, s[4:7], s18 offen offset:3072 sc1
    s_add_u32 s18, s18, 4096
    buffer_load_dwordx4 v[144:147], v1, s[4:7], s18 offen offset:0 sc1
    buffer_load_dwordx4 v[148:151], v1, s[4:7], s18 offen offset:1024 sc1
    buffer_load_dwordx4 v[152:155], v1, s[4:7], s18 offen offset:2048 sc1
    buffer_load_dwordx4 v[156:159], v1, s[4:7], s18 offen offset:3072 sc1
    s_mov_b64 exec, -1
    buffer_load_dword v6, v5, s[4:7], s89 offen sc1
    v_lshlrev_b32 v2, 4, v0
    v_and_b32 v3, 3072, v2
    v_lshl_add_u32 v2, v3, 1, v1
    s_waitcnt vmcnt(32)
    v_mfma_f32_16x16x32_bf16 v[8:11], a[0:3], v[32:35], 0
    v_mfma_f32_16x16x32_bf16 v[12:15], a[4:7], v[32:35], 0
    v_mov_b32 v4, v32
    s_waitcnt vmcnt(31)
    v_mfma_f32_16x16x32_bf16 v[8:11], a[8:11], v[36:39], v[8:11]
    v_mfma_f32_16x16x32_bf16 v[12:15], a[12:15], v[36:39], v[12:15]
    v_max_u32 v4, v4, v36
    s_waitcnt vmcnt(30)
    v_mfma_f32_16x16x32_bf16 v[8:11], a[16:19], v[40:43], v[8:11]
    v_mfma_f32_16x16x32_bf16 v[12:15], a[20:23], v[40:43], v[12:15]
    v_max_u32 v4, v4, v40
    s_waitcnt vmcnt(29)
    v_mfma_f32_16x16x32_bf16 v[8:11], a[24:27], v[44:47], v[8:11]
    v_mfma_f32_16x16x32_bf16 v[12:15], a[28:31], v[44:47], v[12:15]
    v_max_u32 v4, v4, v44
    s_waitcnt vmcnt(28)
    v_mfma_f32_16x16x32_bf16 v[8:11], a[32:35], v[48:51], v[8:11]
    v_mfma_f32_16x16x32_bf16 v[12:15], a[36:39], v[48:51], v[12:15]
    v_max_u32 v4, v4, v48
    s_waitcnt vmcnt(27)
    v_mfma_f32_16x16x32_bf16 v[8:11], a[40:43], v[52:55], v[8:11]
    v_mfma_f32_16x16x32_bf16 v[12:15], a[44:47], v[52:55], v[12:15]
    v_max_u32 v4, v4, v52
    s_waitcnt vmcnt(26)
    v_mfma_f32_16x16x32_bf16 v[8:11], a[48:51], v[56:59], v[8:11]
    v_mfma_f32_16x16x32_bf16 v[12:15], a[52:55], v[56:59], v[12:15]
    v_max_u32 v4, v4, v56
    s_waitcnt vmcnt(25)
    v_mfma_f32_16x16x32_bf16 v[8:11], a[56:59], v[60:63], v[8:11]
    v_mfma_f32_16x16x32_bf16 v[12:15], a[60:63], v[60:63], v[12:15]
    v_max_u32 v4, v4, v60
    s_waitcnt vmcnt(24)
    v_mfma_f32_16x16x32_bf16 v[8:11], a[64:67], v[64:67], v[8:11]
    v_mfma_f32_16x16x32_bf16 v[12:15], a[68:71], v[64:67], v[12:15]
    v_max_u32 v4, v4, v64
    s_waitcnt vmcnt(23)
    v_mfma_f32_16x16x32_bf16 v[8:11], a[72:75], v[68:71], v[8:11]
    v_mfma_f32_16x16x32_bf16 v[12:15], a[76:79], v[68:71], v[12:15]
    v_max_u32 v4, v4, v68
    s_waitcnt vmcnt(22)
    v_mfma_f32_16x16x32_bf16 v[8:11], a[80:83], v[72:75], v[8:11]
    v_mfma_f32_16x16x32_bf16 v[12:15], a[84:87], v[72:75], v[12:15]
    v_max_u32 v4, v4, v72
    s_waitcnt vmcnt(21)
    v_mfma_f32_16x16x32_bf16 v[8:11], a[88:91], v[76:79], v[8:11]
    v_mfma_f32_16x16x32_bf16 v[12:15], a[92:95], v[76:79], v[12:15]
    v_max_u32 v4, v4, v76
    s_waitcnt vmcnt(20)
    v_mfma_f32_16x16x32_bf16 v[8:11], a[96:99], v[80:83], v[8:11]
    v_mfma_f32_16x16x32_bf16 v[12:15], a[100:103], v[80:83], v[12:15]
    v_max_u32 v4, v4, v80
    s_waitcnt vmcnt(19)
    v_mfma_f32_16x16x32_bf16 v[8:11], a[104:107], v[84:87], v[8:11]
    v_mfma_f32_16x16x32_bf16 v[12:15], a[108:111], v[84:87], v[12:15]
    v_max_u32 v4, v4, v84
    s_waitcnt vmcnt(18)
    v_mfma_f32_16x16x32_bf16 v[8:11], a[112:115], v[88:91], v[8:11]
    v_mfma_f32_16x16x32_bf16 v[12:15], a[116:119], v[88:91], v[12:15]
    v_max_u32 v4, v4, v88
    s_waitcnt vmcnt(17)
    v_mfma_f32_16x16x32_bf16 v[8:11], a[120:123], v[92:95], v[8:11]
    v_mfma_f32_16x16x32_bf16 v[12:15], a[124:127], v[92:95], v[12:15]
    v_max_u32 v4, v4, v92
    s_waitcnt vmcnt(16)
    v_mfma_f32_16x16x32_bf16 v[8:11], a[128:131], v[96:99], v[8:11]
    v_mfma_f32_16x16x32_bf16 v[12:15], a[132:135], v[96:99], v[12:15]
    v_max_u32 v4, v4, v96
    s_waitcnt vmcnt(15)
    v_mfma_f32_16x16x32_bf16 v[8:11], a[136:139], v[100:103], v[8:11]
    v_mfma_f32_16x16x32_bf16 v[12:15], a[140:143], v[100:103], v[12:15]
    v_max_u32 v4, v4, v100
    s_waitcnt vmcnt(14)
    v_mfma_f32_16x16x32_bf16 v[8:11], a[144:147], v[104:107], v[8:11]
    v_mfma_f32_16x16x32_bf16 v[12:15], a[148:151], v[104:107], v[12:15]
    v_max_u32 v4, v4, v104
    s_waitcnt vmcnt(13)
    v_mfma_f32_16x16x32_bf16 v[8:11], a[152:155], v[108:111], v[8:11]
    v_mfma_f32_16x16x32_bf16 v[12:15], a[156:159], v[108:111], v[12:15]
    v_max_u32 v4, v4, v108
    s_waitcnt vmcnt(12)
    v_mfma_f32_16x16x32_bf16 v[8:11], a[160:163], v[112:115], v[8:11]
    v_mfma_f32_16x16x32_bf16 v[12:15], a[164:167], v[112:115], v[12:15]
    v_max_u32 v4, v4, v112
    s_waitcnt vmcnt(11)
    v_mfma_f32_16x16x32_bf16 v[8:11], a[168:171], v[116:119], v[8:11]
    v_mfma_f32_16x16x32_bf16 v[12:15], a[172:175], v[116:119], v[12:15]
    v_max_u32 v4, v4, v116
    s_waitcnt vmcnt(10)
    v_mfma_f32_16x16x32_bf16 v[8:11], a[176:179], v[120:123], v[8:11]
    v_mfma_f32_16x16x32_bf16 v[12:15], a[180:183], v[120:123], v[12:15]
    v_max_u32 v4, v4, v120
    s_waitcnt vmcnt(9)
    v_mfma_f32_16x16x32_bf16 v[8:11], a[184:187], v[124:127], v[8:11]
    v_mfma_f32_16x16x32_bf16 v[12:15], a[188:191], v[124:127], v[12:15]
    v_max_u32 v4, v4, v124
    s_waitcnt vmcnt(8)
    v_mfma_f32_16x16x32_bf16 v[8:11], a[192:195], v[128:131], v[8:11]
    v_mfma_f32_16x16x32_bf16 v[12:15], a[196:199], v[128:131], v[12:15]
    v_max_u32 v4, v4, v128
    s_waitcnt vmcnt(7)
    v_mfma_f32_16x16x32_bf16 v[8:11], a[200:203], v[132:135], v[8:11]
    v_mfma_f32_16x16x32_bf16 v[12:15], a[204:207], v[132:135], v[12:15]
    v_max_u32 v4, v4, v132
    s_waitcnt vmcnt(6)
    v_mfma_f32_16x16x32_bf16 v[8:11], a[208:211], v[136:139], v[8:11]
    v_mfma_f32_16x16x32_bf16 v[12:15], a[212:215], v[136:139], v[12:15]
    v_max_u32 v4, v4, v136
    s_waitcnt vmcnt(5)
    v_mfma_f32_16x16x32_bf16 v[8:11], a[216:219], v[140:143], v[8:11]
    v_mfma_f32_16x16x32_bf16 v[12:15], a[220:223], v[140:143], v[12:15]
    v_max_u32 v4, v4, v140
    s_waitcnt vmcnt(4)
    v_mfma_f32_16x16x32_bf16 v[8:11], a[224:227], v[144:147], v[8:11]
    v_mfma_f32_16x16x32_bf16 v[12:15], a[228:231], v[144:147], v[12:15]
    v_max_u32 v4, v4, v144
    s_waitcnt vmcnt(3)
    v_mfma_f32_16x16x32_bf16 v[8:11], a[232:235], v[148:151], v[8:11]
    v_mfma_f32_16x16x32_bf16 v[12:15], a[236:239], v[148:151], v[12:15]
    v_max_u32 v4, v4, v148
    s_waitcnt vmcnt(2)
    v_mfma_f32_16x16x32_bf16 v[8:11], a[240:243], v[152:155], v[8:11]
    v_mfma_f32_16x16x32_bf16 v[12:15], a[244:247], v[152:155], v[12:15]
    v_max_u32 v4, v4, v152
    s_waitcnt vmcnt(1)
    v_mfma_f32_16x16x32_bf16 v[8:11], a[248:251], v[156:159], v[8:11]
    v_mfma_f32_16x16x32_bf16 v[12:15], a[252:255], v[156:159], v[12:15]
    v_max_u32 v4, v4, v156
    v_cmp_eq_u32 vcc, -1, v4
    s_nop 0
    s_and_b64 vcc, vcc, s[44:45]
    s_sub_u32 s21, s21, 1
    s_nop 1
    s_cbranch_scc1 os_ok
    s_cbranch_vccnz os_again
os_ok:
    ds_write_b128 v2, v[8:11] offset:0
    ds_write_b128 v2, v[12:15] offset:1024
    s_waitcnt lgkmcnt(0)
    s_barrier
    s_waitcnt vmcnt(0)
    v_cmp_ne_u32 vcc, s95, v6
    s_nop 0
    s_cmp_eq_u64 vcc, 0
    s_cselect_b32 s46, 1, 0
    s_cmp_lg_u32 s32, 0
    s_cbranch_scc1 os_skip
    ds_read_b128 v[40:43], v1 offset:2048
    ds_read_b128 v[44:47], v1 offset:3072
    ds_read_b128 v[48:51], v1 offset:4096
    ds_read_b128 v[52:55], v1 offset:5120
    ds_read_b128 v[56:59], v1 offset:6144
    ds_read_b128 v[60:63], v1 offset:7168
    v_lshrrev_b32 v3, 4, v1
    v_bfe_u32 v4, v3, 2, 2
    v_lshlrev_b32 v4, 3, v4
    v_and_b32 v2, 3, v3
    v_add_u32 v4, v4, v2
    v_mul_u32_u24 v4, 2304, v4
    v_lshrrev_b32 v3, 4, v3
    v_lshl_add_u32 v4, v3, 4, v4
    s_lshr_b32 s18, s16, 1
    s_lshl_b32 s18, s18, 3
    s_and_b32 s19, s16, 1
    s_add_u32 s18, s18, s19
    s_mul_i32 s18, s18, 9216
    s_lshl_b32 s19, s33, 6
    s_add_u32 s18, s18, s19
    s_waitcnt lgkmcnt(0)
    v_pk_add_f32 v[8:9], v[8:9], v[40:41]
    v_pk_add_f32 v[48:49], v[48:49], v[56:57]
    v_pk_add_f32 v[8:9], v[8:9], v[48:49]
    v_pk_add_f32 v[10:11], v[10:11], v[42:43]
    v_pk_add_f32 v[50:51], v[50:51], v[58:59]
    v_pk_add_f32 v[10:11], v[10:11], v[50:51]
    v_pk_add_f32 v[12:13], v[12:13], v[44:45]
    v_pk_add_f32 v[52:53], v[52:53], v[60:61]
    v_pk_add_f32 v[12:13], v[12:13], v[52:53]
    v_pk_add_f32 v[14:15], v[14:15], v[46:47]
    v_pk_add_f32 v[54:55], v[54:55], v[62:63]
    v_pk_add_f32 v[14:15], v[14:15], v[54:55]
    v_cvt_pk_bf16_f32 v32, v8, v9
    v_cvt_pk_bf16_f32 v33, v10, v11
    v_cvt_pk_bf16_f32 v34, v12, v13
    v_cvt_pk_bf16_f32 v35, v14, v15
    s_mov_b64 exec, s[44:45]
    buffer_store_dwordx4 v[32:35], v4, s[8:11], s18 offen sc1
    s_mov_b64 exec, -1
os_skip:
    s_nop 0
    s_add_u32 s35, s35, 6
    s_cmp_ge_u32 s35, 128
    s_cbranch_scc1 L_done
    s_barrier
    s_branch L_op_seg
L_done:
L_exit:
    s_endpgm
.section .rodata,"a"
.p2align 6
.amdhsa_kernel concat_heads__memory_aug_recurrent_mem_tr__ssm_conv_s4d__prompt_kernel
  .amdhsa_next_free_vgpr 512
  .amdhsa_next_free_sgpr 102
  .amdhsa_accum_offset 256
  .amdhsa_group_segment_fixed_size 0
  .amdhsa_kernarg_size 136
  .amdhsa_user_sgpr_count 2
  .amdhsa_user_sgpr_kernarg_segment_ptr 1
  .amdhsa_system_sgpr_workgroup_id_x 1
.end_amdhsa_kernel
.text
```
